```python
import torch

def _softmax(x, axis=-1):
    return torch.softmax(x, dim=axis)

def _gelu(x):
    return torch.nn.functional.gelu(x, approximate='tanh')

def _silu(x):
    return torch.nn.functional.silu(x)

def _sigmoid(x):
    return torch.sigmoid(x)

def _layernorm(x, axis=-1, eps=1e-05):
    m = x.mean(dim=axis, keepdim=True)
    v = x.var(dim=axis, keepdim=True, unbiased=False)
    return (x - m) / torch.sqrt(v + eps)

def _scatter_add(tgt, idx, src, axis=0):
    return tgt.clone().index_add_(axis, idx, src)

def _segment_sum(src, seg, n):
    out = torch.zeros((n,) + src.shape[1:], dtype=src.dtype)
    return out.index_add_(0, seg, src)

def _pad(x, pw):
    flat = tuple((v for pair in reversed(pw) for v in pair))
    return torch.nn.functional.pad(x, flat)
kernel_name = 'adaLN_cond__linear_kernel_hedgehog__moe_arch_mod__prompt'

def setup_inputs():

    _w = lambda a: (lambda t: t.to(torch.bfloat16) if t.is_floating_point() else t)(torch.as_tensor(a))

    def _A_setup():
        B, S, D, H = (1, 2048, 1024, 32)
        Dh = D // H
        return {'x': _w((lambda *s: torch.randn(*s, dtype=torch.bfloat16) * 0.05)(B, S, D)), 'wqkv': _w((lambda *s: torch.randn(*s, dtype=torch.bfloat16) * 0.4)(D, 3 * D)), 'w_phi': _w((lambda *s: torch.randn(*s, dtype=torch.bfloat16) * 0.4)(H, Dh, Dh) * Dh ** (-0.5)), 'wo': _w((lambda *s: torch.randn(*s, dtype=torch.bfloat16) * 0.05)(D, D))}
    _A_in = _A_setup()

    def _B_setup():
        B, S, D, F, C = (1, 2048, 1024, 3584, 2)
        return {'x': _w((lambda *s: torch.randn(*s, dtype=torch.bfloat16) * 0.05)(B, S, D)), 'w_r': _w((lambda *s: torch.randn(*s, dtype=torch.bfloat16) * 0.1)(D)), 'w_gate': _w((lambda *s: torch.randn(*s, dtype=torch.bfloat16) * 0.05)(D, F)), 'w_up': _w((lambda *s: torch.randn(*s, dtype=torch.bfloat16) * 0.05)(D, F)), 'w_down': _w((lambda *s: torch.randn(*s, dtype=torch.bfloat16) * 0.05)(F, D))}
    _B_in = _B_setup()
    return {'A_x': _A_in['x'], 'A_wqkv': _A_in['wqkv'], 'A_w_phi': _A_in['w_phi'], 'A_wo': _A_in['wo'], 'B_x': _B_in['x'], 'B_w_r': _B_in['w_r'], 'B_w_gate': _B_in['w_gate'], 'B_w_up': _B_in['w_up'], 'B_w_down': _B_in['w_down'], 'c': _w((lambda *s: torch.randn(*s, dtype=torch.bfloat16) * 0.2)(1, 1024) * 8.0), 'w_mod': _w((lambda *s: torch.randn(*s, dtype=torch.bfloat16) * 0.2)(1024, 6 * 1024) * 1024 ** (-0.5) * 8.0)}

def reference(A_x, A_wqkv, A_w_phi, A_wo, B_x, B_w_r, B_w_gate, B_w_up, B_w_down, c, w_mod):

    def _A_ref(x, wqkv, w_phi, wo):
        B, S, D = x.shape
        H = 32
        Dh = D // H
        qkv = (lambda x, *d: x.permute(*d))((x @ wqkv).reshape(B, S, 3, H, Dh), 2, 0, 3, 1, 4)
        q, k, v = (qkv[0], qkv[1], qkv[2])
        pq = torch.einsum('bhsd,hdf->bhsf', q, w_phi)
        pk = torch.einsum('bhsd,hdf->bhsf', k, w_phi)
        phi_q = torch.concatenate([_softmax(pq, axis=-1), _softmax(-pq, axis=-1)], axis=-1)
        phi_k = torch.concatenate([_softmax(pk, axis=-1), _softmax(-pk, axis=-1)], axis=-1)
        kv = torch.einsum('bhsf,bhsd->bhfd', phi_k, v)
        z = torch.einsum('bhsf->bhf', phi_k)
        num = torch.einsum('bhqf,bhfd->bhqd', phi_q, kv)
        den = torch.einsum('bhqf,bhf->bhq', phi_q, z)[..., None] + 1e-06
        o = num / den
        return (lambda x, *d: x.permute(*d))(o, 0, 2, 1, 3).reshape(B, S, D) @ wo

    def _B_ref(x, w_r, w_gate, w_up, w_down):
        B, S, D = x.shape
        C = 2
        r = x @ w_r
        idx = torch.argsort(-r, axis=-1)[:, :C]
        idx_e = (lambda x, n, axis: torch.repeat_interleave(x, n, dim=axis))(idx.reshape(B, C, 1), D, axis=2)
        x_sel = (lambda x, i, axis: torch.take_along_dim(x, i, dim=axis))(x, idx_e, axis=1)
        g = _silu(x_sel @ w_gate)
        u = x_sel @ w_up
        y = g * u @ w_down
        r_sel = _sigmoid((lambda x, i, axis: torch.take_along_dim(x, i, dim=axis))(r, idx, axis=1))
        y = y * r_sel.reshape(B, C, 1)
        b_off = (torch.arange(B) * S).reshape(B, 1)
        flat_idx = (idx + b_off).reshape(B * C)
        zero = (x * 0.0).reshape(B * S, D)
        upd = _scatter_add(zero, flat_idx, y.reshape(B * C, D), axis=0)
        return x + upd.reshape(B, S, D)
    x = A_x
    mod = (_silu(c) @ w_mod).reshape(c.shape[0], 6, 1, -1)
    sa, ca, ga, sb, cb, gb = (mod[:, 0].clone(), mod[:, 1].clone(), mod[:, 2].clone(), mod[:, 3].clone(), mod[:, 4].clone(), mod[:, 5].clone())
    h = _layernorm(x, axis=-1) * (1 + ca) + sa
    x = x + ga * _A_ref(h, A_wqkv, A_w_phi, A_wo)
    h = _layernorm(x, axis=-1) * (1 + cb) + sb
    x = x + gb * _B_ref(h, B_w_r, B_w_gate, B_w_up, B_w_down)
    return x
```

```asm
; @launch grid=(256,1,1) block=(512,1,1) lds=163840
.amdgcn_target "amdgcn-amd-amdhsa--gfx950"
.text
.globl adaLN_cond__linear_kernel_hedgehog__moe_arch_mod__prompt_kernel
.p2align 8
.type adaLN_cond__linear_kernel_hedgehog__moe_arch_mod__prompt_kernel,@function
adaLN_cond__linear_kernel_hedgehog__moe_arch_mod__prompt_kernel:
    s_load_dwordx16 s[68:83], s[0:1], 0
    s_load_dwordx8 s[84:91], s[0:1], 64
    s_load_dwordx2 s[32:33], s[0:1], 104
    s_cmp_ge_u32 s2, 256
    s_cbranch_scc1 L_END
    v_lshrrev_b32 v4, 6, v0
    v_and_b32 v1, 63, v0
    v_mov_b32 v3, 0
    v_readfirstlane_b32 s3, v4
    v_lshlrev_b32 v2, 4, v1
    s_mov_b32 s38, 4194304
    s_mov_b32 s39, 0x20000
    s_mov_b32 s50, 12582912
    s_mov_b32 s51, 0x20000
    s_mov_b32 s34, 268435456
    s_mov_b32 s35, 0x20000
    s_mov_b32 s42, 6291456
    s_mov_b32 s43, 0x20000
    s_mov_b32 s46, 2097152
    s_mov_b32 s47, 0x20000
    s_mov_b32 s54, 7340032
    s_mov_b32 s55, 0x20000
    s_mov_b32 s58, 7340032
    s_mov_b32 s59, 0x20000
    s_mov_b32 s62, 7340032
    s_mov_b32 s63, 0x20000
    s_mov_b32 s66, 4194304
    s_mov_b32 s67, 0x20000
    s_mov_b32 s5, 0
    s_mov_b32 s6, 0xffff0000
    s_mov_b32 s7, 0x3fb8aa3b
    s_and_b32 s8, s2, 7
    s_lshr_b32 s9, s2, 3
    s_lshl_b32 s96, s8, 5
    s_add_u32 s97, s96, s9
    s_lshl3_add_u32 s93, s97, s3
    s_and_b32 s96, s8, 4
    s_lshr_b32 s97, s9, 2
    s_lshl1_add_u32 s10, s96, s97
    s_and_b32 s96, s8, 3
    s_and_b32 s97, s9, 3
    s_xor_b32 s98, s97, 2
    s_lshl2_add_u32 s11, s96, s98
    s_and_b32 s96, s8, 1
    s_and_b32 s97, s9, 7
    s_lshl3_add_u32 s12, s96, s97
    s_lshr_b32 s96, s8, 1
    s_lshr_b32 s97, s9, 3
    s_lshl2_add_u32 s21, s96, s97
    s_and_b32 s96, s3, 3
    s_lshl2_add_u32 s94, s21, s96
    s_lshr_b32 s96, s3, 2
    s_lshl1_add_u32 s95, s12, s96
    s_lshl_b32 s96, s2, 6
    s_add_u32 s97, s96, s3
    s_lshl_b32 s98, s97, 6
    s_add_u32 s92, s98, 1048576
    s_lshl_b32 s16, s93, 11
    s_lshl3_add_u32 s96, s8, s3
    s_lshl_b32 s15, s96, 5
    s_mul_i32 s96, s15, 6144
    s_xor_b32 s97, s9, 1
    s_lshl_b32 s98, s97, 7
    s_add_u32 s13, s96, s98
    s_add_u32 s14, s13, 98304
    s_lshl_b32 s96, s94, 16
    s_lshl_b32 s97, s95, 6
    s_add_u32 s18, s96, s97
    s_lshr_b32 s96, s8, 1
    s_lshl4_add_u32 s97, s96, s12
    s_lshl4_add_u32 s98, s97, s3
    s_lshl_b32 s99, s98, 9
    s_add_u32 s17, s99, 524288
    v_lshrrev_b32 v60, 3, v1
    v_mul_u32_u24 v60, 12288, v60
    v_and_b32 v9, 7, v1
    v_lshl_add_u32 v60, v9, 4, v60
    v_lshrrev_b32 v61, 3, v1
    v_lshl_add_u32 v61, v61, 1, s15
    v_and_b32 v10, 31, v1
    v_lshlrev_b32 v10, 11, v10
    v_lshrrev_b32 v9, 5, v1
    v_lshl_add_u32 v10, v9, 5, v10
    s_waitcnt lgkmcnt(0)
    s_mov_b64 s[36:37], s[68:69]
    buffer_load_dwordx4 v[88:91], v2, s[36:39], s16 offen
    buffer_load_dwordx4 v[92:95], v2, s[36:39], s16 offen offset:1024
    s_load_dword s4, s[32:33], 0
    s_mov_b64 s[48:49], s[88:89]
    s_load_dword s24, s[32:33], s92 offset:0 glc
    s_load_dword s25, s[32:33], s17 offset:508 glc
    s_load_dword s26, s[32:33], s17 offset:4604 glc
    global_load_ushort v78, v61, s[86:87]
    global_load_ushort v79, v61, s[86:87] offset:16
    s_barrier
    buffer_load_dwordx4 v[80:83], v60, s[48:51], s13 offen nt
    buffer_load_dwordx4 v[84:87], v60, s[48:51], s14 offen nt
    s_mov_b64 s[40:41], s[70:71]
    s_mov_b64 s[44:45], s[74:75]
    s_mov_b64 s[52:53], s[80:81]
    s_mov_b64 s[56:57], s[82:83]
    s_mov_b64 s[60:61], s[84:85]
    s_mov_b64 s[64:65], s[90:91]
    s_getpc_b64 s[22:23]
    s_and_b32 s22, s22, 0xfffffc00
    s_lshl3_add_u32 s96, s9, s3
    s_lshl_b32 s19, s96, 7
    v_lshrrev_b32 v4, 5, v1
    v_lshl_add_u32 v4, v4, 15, s19
    v_min_u32 v4, 36864, v4
    global_load_dword v11, v4, s[22:23]
    s_lshr_b32 s76, s3, 2
    s_lshr_b32 s96, s3, 2
    s_lshr_b32 s97, s9, 4
    s_xor_b32 s77, s96, s97
    s_lshr_b32 s96, s9, 3
    s_xor_b32 s97, s96, s9
    s_and_b32 s98, s97, 1
    s_lshl_b32 s83, s98, 3
    s_mul_i32 s96, s8, 7
    s_lshr_b32 s97, s9, 2
    s_add_u32 s74, s96, s97
    s_and_b32 s75, s9, 3
    s_and_b32 s85, s9, 12
    v_bfe_u32 v6, v1, 4, 1
    v_lshlrev_b32 v6, 6, v6
    v_and_b32 v62, 7, v1
    v_lshlrev_b32 v62, 4, v62
    v_xor_b32 v62, v62, v6
    v_lshrrev_b32 v6, 3, v1
    v_mul_u32_u24 v6, 6144, v6
    v_add_u32 v62, v62, v6
    v_lshlrev_b32 v63, 3, v1
    v_lshlrev_b32 v64, 5, v1
    v_add_u32 v64, 147456, v64
    s_lshl2_add_u32 s13, s3, 147456
    v_lshrrev_b32 v65, 4, v1
    v_lshl_add_u32 v65, v65, 6, s13
    v_and_b32 v9, 7, v1
    v_lshl_add_u32 v65, v9, 8, v65
    v_bfe_u32 v9, v1, 3, 1
    v_lshl_add_u32 v65, v9, 5, v65
    s_waitcnt vmcnt(5)
    v_mov_b32 v8, 0x3f803f80
    v_dot2_f32_bf16 v4, v88, v8, 0
    v_dot2_f32_bf16 v5, v88, v88, 0
    v_dot2_f32_bf16 v6, v89, v8, 0
    v_dot2_f32_bf16 v7, v89, v89, 0
    v_dot2_f32_bf16 v4, v90, v8, v4
    v_dot2_f32_bf16 v5, v90, v90, v5
    v_dot2_f32_bf16 v6, v91, v8, v6
    v_dot2_f32_bf16 v7, v91, v91, v7
    v_dot2_f32_bf16 v4, v92, v8, v4
    v_dot2_f32_bf16 v5, v92, v92, v5
    v_dot2_f32_bf16 v6, v93, v8, v6
    v_dot2_f32_bf16 v7, v93, v93, v7
    v_dot2_f32_bf16 v4, v94, v8, v4
    v_dot2_f32_bf16 v5, v94, v94, v5
    v_dot2_f32_bf16 v6, v95, v8, v6
    v_dot2_f32_bf16 v7, v95, v95, v7
    s_nop 2
    v_pk_add_f32 v[4:5], v[4:5], v[6:7]
    s_nop 1
    v_add_f32_dpp v4, v4, v4 quad_perm:[1,0,3,2] row_mask:0xf bank_mask:0xf
    v_add_f32_dpp v5, v5, v5 quad_perm:[1,0,3,2] row_mask:0xf bank_mask:0xf
    s_nop 0
    v_add_f32_dpp v4, v4, v4 quad_perm:[2,3,0,1] row_mask:0xf bank_mask:0xf
    v_add_f32_dpp v5, v5, v5 quad_perm:[2,3,0,1] row_mask:0xf bank_mask:0xf
    s_nop 0
    v_add_f32_dpp v4, v4, v4 row_half_mirror row_mask:0xf bank_mask:0xf
    v_add_f32_dpp v5, v5, v5 row_half_mirror row_mask:0xf bank_mask:0xf
    s_nop 0
    v_add_f32_dpp v4, v4, v4 row_ror:8 row_mask:0xf bank_mask:0xf
    v_add_f32_dpp v5, v5, v5 row_ror:8 row_mask:0xf bank_mask:0xf
    s_nop 1
    v_permlane16_swap_b32 v4, v5
    v_add_f32 v8, v4, v5
    v_add_f32 v4, v4, v5
    s_nop 1
    v_permlane32_swap_b32 v4, v8
    v_add_f32 v4, v4, v8
    v_mul_f32 v8, 0x3a800000, v4
    v_mul_f32 v4, 0x3a800000, v4
    s_nop 1
    v_permlane16_swap_b32 v4, v8
    v_fma_f32 v113, -v4, v4, v8
    v_cvt_pk_bf16_f32 v112, 0, v4
    v_max_f32 v113, 0, v113
    v_cvt_pk_bf16_f32 v113, 0, v113
    v_add_f32 v113, 0x3727c5ac, v113
    v_cvt_pk_bf16_f32 v113, 0, v113
    v_sqrt_f32 v113, v113
    s_nop 0
    v_cvt_pk_bf16_f32 v113, 0, v113
    s_lshl3_add_u32 s13, s3, 153600
    s_waitcnt lgkmcnt(0)
    s_mul_i32 s4, s4, 0x9e3779b1
    s_add_u32 s4, s4, 0x7f4a7c15
    v_lshrrev_b32 v112, 16, v112
    v_or_b32 v112, v112, v113
    v_mov_b32 v113, s4
    v_mov_b32 v4, s13
    ds_write_b64 v4, v[112:113]
    v_and_b32 v5, 3, v1
    v_lshlrev_b32 v5, 4, v5
    v_add_u32 v5, 153600, v5
    v_and_b32 v4, 3, v1
    v_lshlrev_b32 v4, 4, v4
    v_bfe_u32 v9, v1, 2, 1
    v_lshl_add_u32 v4, v9, 10, v4
    s_and_b32 s96, s8, 6
    s_and_b32 s97, s8, 1
    s_lshr_b32 s98, s9, 4
    s_lshl1_add_u32 s99, s97, s98
    s_lshl_b32 s97, s99, 6
    s_add_u32 s98, s96, s97
    s_lshl3_add_u32 s99, s3, s98
    s_lshl_b32 s96, s99, 10
    s_and_b32 s97, s9, 15
    s_lshl_b32 s98, s97, 6
    s_add_u32 s99, s96, s98
    s_add_u32 s13, s99, 262144
    s_waitcnt lgkmcnt(0)
    s_barrier
    ds_read_b128 v[112:115], v5
    s_waitcnt lgkmcnt(0)
    s_mov_b64 exec, 0xff
    buffer_store_dwordx4 v[112:115], v4, s[32:35], s13 offen sc1
    s_mov_b64 exec, -1
    buffer_load_dwordx4 v[12:15], v10, s[36:39], s18 offen
    buffer_load_dwordx4 v[16:19], v10, s[36:39], s18 offen offset:16
    s_lshl_b32 s96, s11, 12
    s_lshl_b32 s97, s3, 9
    s_add_u32 s13, s96, s97
    v_add_u32 v4, s13, v2
    s_lshl_b32 s96, s3, 9
    s_add_u32 m0, s96, 159744
    s_mov_b32 exec_hi, 0
    global_load_lds_dwordx4 v4, s[72:73]
    s_mov_b32 exec_hi, -1
    s_lshr_b32 s96, s9, 4
    s_lshl_b32 s20, s96, 1
    s_add_u32 s96, s20, s85
    s_and_b32 s97, s96, 15
    s_lshl3_add_u32 s98, s97, s3
    s_mul_i32 s99, s98, 49152
    s_lshl_b32 s96, s11, 7
    s_add_u32 s82, s99, s96
    s_mul_i32 s96, s20, 24576
    s_lshl_b32 s97, s3, 10
    s_add_u32 s20, s96, s97
    s_mov_b32 m0, s20
    s_nop 0
    buffer_load_dwordx4 v62, s[40:43], s82 offen lds
    s_add_u32 s82, s82, 2048
    s_add_u32 m0, s20, 8192
    s_nop 0
    buffer_load_dwordx4 v62, s[40:43], s82 offen lds
    s_add_u32 s82, s82, 2048
    s_waitcnt vmcnt(9)
    v_lshlrev_b32 v78, 16, v78
    v_mul_f32 v4, s7, v78
    v_exp_f32 v4, -v4
    s_nop 0
    v_add_f32 v4, 1.0, v4
    v_rcp_f32 v4, v4
    s_nop 0
    v_mul_f32 v78, v78, v4
    v_cvt_pk_bf16_f32 v78, 0, v78
    v_lshlrev_b32 v79, 16, v79
    v_mul_f32 v5, s7, v79
    v_exp_f32 v5, -v5
    s_nop 0
    v_add_f32 v5, 1.0, v5
    v_rcp_f32 v5, v5
    s_nop 0
    v_mul_f32 v79, v79, v5
    v_cvt_pk_bf16_f32 v79, 0, v79
    s_lshr_b32 s96, s3, 1
    s_xor_b32 s97, s9, 1
    s_and_b32 s98, s97, 15
    s_lshl4_add_u32 s99, s96, s98
    s_lshr_b32 s97, s9, 4
    s_lshl1_add_u32 s96, s99, s97
    s_lshl3_add_u32 s98, s96, s8
    s_lshl_b32 s99, s98, 9
    s_add_u32 s13, s99, 524288
    s_and_b32 s96, s3, 3
    s_lshl2_add_u32 s97, s2, s96
    s_lshl_b32 s98, s97, 8
    s_add_u32 s14, s98, 262144
    v_and_b32 v8, 31, v1
    v_lshlrev_b32 v8, 3, v8
    s_waitcnt vmcnt(7)
    v_lshlrev_b32 v4, 16, v80
    v_and_b32 v5, s6, v80
    v_pk_mul_f32 v[20:21], v[4:5], v[78:79] op_sel:[0,0] op_sel_hi:[1,0]
    v_lshlrev_b32 v6, 16, v81
    v_and_b32 v7, s6, v81
    v_pk_mul_f32 v[22:23], v[6:7], v[78:79] op_sel:[0,0] op_sel_hi:[1,0]
    v_lshlrev_b32 v4, 16, v82
    v_and_b32 v5, s6, v82
    v_pk_mul_f32 v[24:25], v[4:5], v[78:79] op_sel:[0,0] op_sel_hi:[1,0]
    v_lshlrev_b32 v6, 16, v83
    v_and_b32 v7, s6, v83
    v_pk_mul_f32 v[26:27], v[6:7], v[78:79] op_sel:[0,0] op_sel_hi:[1,0]
    v_lshlrev_b32 v4, 16, v84
    v_and_b32 v5, s6, v84
    v_pk_fma_f32 v[20:21], v[4:5], v[78:79], v[20:21] op_sel:[0,1,0] op_sel_hi:[1,1,1]
    v_lshlrev_b32 v6, 16, v85
    v_and_b32 v7, s6, v85
    v_pk_fma_f32 v[22:23], v[6:7], v[78:79], v[22:23] op_sel:[0,1,0] op_sel_hi:[1,1,1]
    v_lshlrev_b32 v4, 16, v86
    v_and_b32 v5, s6, v86
    v_pk_fma_f32 v[24:25], v[4:5], v[78:79], v[24:25] op_sel:[0,1,0] op_sel_hi:[1,1,1]
    v_lshlrev_b32 v6, 16, v87
    v_and_b32 v7, s6, v87
    v_pk_fma_f32 v[26:27], v[6:7], v[78:79], v[26:27] op_sel:[0,1,0] op_sel_hi:[1,1,1]
    v_permlane32_swap_b32 v20, v24
    v_permlane32_swap_b32 v21, v25
    v_permlane32_swap_b32 v22, v26
    v_permlane32_swap_b32 v23, v27
    v_add_f32 v20, v20, v24
    v_add_f32 v21, v21, v25
    v_add_f32 v22, v22, v26
    v_add_f32 v23, v23, v27
    s_nop 0
    v_permlane16_swap_b32 v20, v22
    v_permlane16_swap_b32 v21, v23
    v_add_f32 v20, v20, v22
    v_add_f32 v21, v21, v23
    s_nop 0
    v_add_f32_dpp v20, v20, v20 row_ror:8 row_mask:0xf bank_mask:0xf
    v_add_f32_dpp v21, v21, v21 row_ror:8 row_mask:0xf bank_mask:0xf
    s_nop 1
    v_mov_b32_dpp v20, v21 quad_perm:[0,1,2,3] row_mask:0xf bank_mask:0xc
    ds_write_b32 v65, v20
    s_waitcnt lgkmcnt(0)
    s_barrier
    buffer_load_dwordx2 v[112:113], v8, s[32:35], s14 offen sc1
    ds_read_b128 v[20:23], v64 offset:0
    ds_read_b128 v[24:27], v64 offset:16
    s_waitcnt lgkmcnt(0)
    v_pk_add_f32 v[20:21], v[20:21], v[22:23]
    v_pk_add_f32 v[24:25], v[24:25], v[26:27]
    v_pk_add_f32 v[20:21], v[20:21], v[24:25]
    v_add_f32 v20, v20, v21
    v_mov_b32 v21, s4
    s_bitcmp1_b32 s3, 0
    s_cselect_b32 exec_lo, 0, -1
    s_cselect_b32 exec_hi, -1, 0
    buffer_store_dwordx2 v[20:21], v63, s[32:35], s13 offen sc1
    s_mov_b64 exec, -1
    s_add_u32 m0, s20, 16384
    s_nop 0
    buffer_load_dwordx4 v62, s[40:43], s82 offen lds
    s_waitcnt vmcnt(2)
    v_cmp_ne_u32 vcc, s4, v113
    s_cbranch_vccz TOK_2
SPOLL_3:
    s_load_dword s24, s[32:33], s14 offset:60 glc
    s_load_dword s25, s[32:33], s14 offset:124 glc
    s_load_dword s26, s[32:33], s14 offset:188 glc
    s_load_dword s27, s[32:33], s14 offset:252 glc
SCHK_4:
    s_add_u32 s5, s5, 1
    s_cmp_ge_u32 s5, 200000
    s_waitcnt lgkmcnt(0)
    s_cbranch_scc1 SDONE_5
    s_cmp_lg_u32 s24, s4
    s_cbranch_scc1 SPOLL_3
    s_cmp_lg_u32 s25, s4
    s_cbranch_scc1 SPOLL_3
    s_cmp_lg_u32 s26, s4
    s_cbranch_scc1 SPOLL_3
    s_cmp_lg_u32 s27, s4
    s_cbranch_scc1 SPOLL_3
SDONE_5:
POLL_6:
    buffer_load_dwordx2 v[112:113], v8, s[32:35], s14 offen sc1
    s_waitcnt vmcnt(0)
    v_cmp_ne_u32 vcc, s4, v113
    s_cbranch_vccz PDONE_7
    s_add_u32 s5, s5, 1
    s_cmp_lt_u32 s5, 200000
    s_cbranch_scc1 POLL_6
PDONE_7:
TOK_2:
    v_and_b32 v4, 31, v1
    v_lshlrev_b32 v4, 4, v4
    v_lshrrev_b32 v9, 5, v1
    v_lshl_add_u32 v4, v9, 12, v4
    s_mov_b32 s13, s17
    s_lshl2_add_u32 s14, s3, 155648
    v_lshl_add_u32 v5, v1, 6, s14
    s_lshl_b32 s96, s76, 10
    s_add_u32 s14, s96, 155648
    v_and_b32 v6, 15, v1
    v_lshl_add_u32 v6, v6, 5, s14
    v_lshrrev_b32 v9, 5, v1
    v_lshl_add_u32 v6, v9, 9, v6
    s_load_dword s24, s[32:33], s13 offset:508 glc
    s_load_dword s25, s[32:33], s13 offset:4604 glc
    v_lshlrev_b32 v113, 16, v112
    v_and_b32 v112, s6, v112
    v_rcp_f32 v112, v112
    v_lshlrev_b32 v96, 16, v12
    v_and_b32 v97, s6, v12
    v_lshlrev_b32 v98, 16, v13
    v_and_b32 v99, s6, v13
    v_lshlrev_b32 v100, 16, v14
    v_and_b32 v101, s6, v14
    v_lshlrev_b32 v102, 16, v15
    v_and_b32 v103, s6, v15
    v_lshlrev_b32 v104, 16, v16
    v_and_b32 v105, s6, v16
    v_lshlrev_b32 v106, 16, v17
    v_and_b32 v107, s6, v17
    v_lshlrev_b32 v108, 16, v18
    v_and_b32 v109, s6, v18
    v_lshlrev_b32 v110, 16, v19
    v_and_b32 v111, s6, v19
    v_pk_add_f32 v[96:97], v[96:97], v[112:113] op_sel:[0,1] neg_lo:[0,1] neg_hi:[0,1]
    v_pk_add_f32 v[98:99], v[98:99], v[112:113] op_sel:[0,1] neg_lo:[0,1] neg_hi:[0,1]
    v_pk_add_f32 v[100:101], v[100:101], v[112:113] op_sel:[0,1] neg_lo:[0,1] neg_hi:[0,1]
    v_pk_add_f32 v[102:103], v[102:103], v[112:113] op_sel:[0,1] neg_lo:[0,1] neg_hi:[0,1]
    v_pk_add_f32 v[104:105], v[104:105], v[112:113] op_sel:[0,1] neg_lo:[0,1] neg_hi:[0,1]
    v_pk_add_f32 v[106:107], v[106:107], v[112:113] op_sel:[0,1] neg_lo:[0,1] neg_hi:[0,1]
    v_pk_add_f32 v[108:109], v[108:109], v[112:113] op_sel:[0,1] neg_lo:[0,1] neg_hi:[0,1]
    v_pk_add_f32 v[110:111], v[110:111], v[112:113] op_sel:[0,1] neg_lo:[0,1] neg_hi:[0,1]
    v_cvt_pk_bf16_f32 v96, 0, v96
    v_cvt_pk_bf16_f32 v97, 0, v97
    v_cvt_pk_bf16_f32 v98, 0, v98
    v_cvt_pk_bf16_f32 v99, 0, v99
    v_cvt_pk_bf16_f32 v100, 0, v100
    v_cvt_pk_bf16_f32 v101, 0, v101
    v_cvt_pk_bf16_f32 v102, 0, v102
    v_cvt_pk_bf16_f32 v103, 0, v103
    v_cvt_pk_bf16_f32 v104, 0, v104
    v_cvt_pk_bf16_f32 v105, 0, v105
    v_cvt_pk_bf16_f32 v106, 0, v106
    v_cvt_pk_bf16_f32 v107, 0, v107
    v_cvt_pk_bf16_f32 v108, 0, v108
    v_cvt_pk_bf16_f32 v109, 0, v109
    v_cvt_pk_bf16_f32 v110, 0, v110
    v_cvt_pk_bf16_f32 v111, 0, v111
    v_pk_mul_f32 v[96:97], v[96:97], v[112:113] op_sel_hi:[1,0]
    v_pk_mul_f32 v[98:99], v[98:99], v[112:113] op_sel_hi:[1,0]
    v_pk_mul_f32 v[100:101], v[100:101], v[112:113] op_sel_hi:[1,0]
    v_pk_mul_f32 v[102:103], v[102:103], v[112:113] op_sel_hi:[1,0]
    v_pk_mul_f32 v[104:105], v[104:105], v[112:113] op_sel_hi:[1,0]
    v_pk_mul_f32 v[106:107], v[106:107], v[112:113] op_sel_hi:[1,0]
    v_pk_mul_f32 v[108:109], v[108:109], v[112:113] op_sel_hi:[1,0]
    v_pk_mul_f32 v[110:111], v[110:111], v[112:113] op_sel_hi:[1,0]
    v_cvt_pk_bf16_f32 v96, 0, v96
    v_cvt_pk_bf16_f32 v97, 0, v97
    v_cvt_pk_bf16_f32 v98, 0, v98
    v_cvt_pk_bf16_f32 v99, 0, v99
    v_cvt_pk_bf16_f32 v100, 0, v100
    v_cvt_pk_bf16_f32 v101, 0, v101
    v_cvt_pk_bf16_f32 v102, 0, v102
    v_cvt_pk_bf16_f32 v103, 0, v103
    v_cvt_pk_bf16_f32 v104, 0, v104
    v_cvt_pk_bf16_f32 v105, 0, v105
    v_cvt_pk_bf16_f32 v106, 0, v106
    v_cvt_pk_bf16_f32 v107, 0, v107
    v_cvt_pk_bf16_f32 v108, 0, v108
    v_cvt_pk_bf16_f32 v109, 0, v109
    v_cvt_pk_bf16_f32 v110, 0, v110
    v_cvt_pk_bf16_f32 v111, 0, v111
    s_branch SCHK_9
SPOLL_8:
    s_load_dword s24, s[32:33], s13 offset:508 glc
    s_load_dword s25, s[32:33], s13 offset:4604 glc
SCHK_9:
    s_add_u32 s5, s5, 1
    s_cmp_ge_u32 s5, 200000
    s_waitcnt lgkmcnt(0)
    s_cbranch_scc1 SDONE_10
    s_cmp_lg_u32 s24, s4
    s_cbranch_scc1 SPOLL_8
    s_cmp_lg_u32 s25, s4
    s_cbranch_scc1 SPOLL_8
SDONE_10:
    s_barrier
    buffer_load_dwordx4 v[112:115], v4, s[32:35], s13 offen sc1
    s_lshr_b32 s96, s9, 4
    s_lshl_b32 s97, s96, 1
    s_xor_b32 s20, s97, 1
    s_add_u32 s96, s20, s85
    s_and_b32 s97, s96, 15
    s_lshl3_add_u32 s98, s97, s3
    s_mul_i32 s99, s98, 49152
    s_lshl_b32 s96, s11, 7
    s_add_u32 s82, s99, s96
    s_mul_i32 s96, s20, 24576
    s_lshl_b32 s97, s3, 10
    s_add_u32 s20, s96, s97
    s_mov_b32 m0, s20
    s_nop 0
    buffer_load_dwordx4 v62, s[40:43], s82 offen lds
    s_add_u32 s82, s82, 2048
    s_add_u32 m0, s20, 8192
    s_nop 0
    buffer_load_dwordx4 v62, s[40:43], s82 offen lds
    s_add_u32 s82, s82, 2048
    s_add_u32 m0, s20, 16384
    s_nop 0
    buffer_load_dwordx4 v62, s[40:43], s82 offen lds
    s_waitcnt vmcnt(3)
    v_bitop3_b32 v7, v113, v115, s4 bitop3:0x7e
    v_cmp_ne_u32 vcc, 0, v7
    s_cbranch_vccz TOK_12
POLL_13:
    buffer_load_dwordx4 v[112:115], v4, s[32:35], s13 offen sc1
    s_waitcnt vmcnt(0)
    v_bitop3_b32 v7, v113, v115, s4 bitop3:0x7e
    v_cmp_ne_u32 vcc, 0, v7
    s_cbranch_vccz PDONE_14
    s_add_u32 s5, s5, 1
    s_cmp_lt_u32 s5, 200000
    s_cbranch_scc1 POLL_13
PDONE_14:
TOK_12:
    ds_write2_b32 v5, v112, v114 offset0:0 offset1:8
    s_waitcnt lgkmcnt(0)
    s_barrier
    ds_read_b128 v[88:91], v6 offset:2048
    ds_read_b128 v[92:95], v6 offset:2064
    ds_read_b128 v[80:83], v6
    ds_read_b128 v[84:87], v6 offset:16
    s_lshl4_add_u32 s96, s21, s12
    s_and_b32 s97, s3, 3
    s_lshl2_add_u32 s98, s96, s97
    s_lshl1_add_u32 s99, s98, s76
    s_lshl_b32 s96, s99, 11
    s_add_u32 s13, s96, 4194304
    s_waitcnt lgkmcnt(2)
    v_pk_add_f32 v[88:89], v[88:89], v[90:91]
    v_pk_add_f32 v[92:93], v[92:93], v[94:95]
    v_pk_add_f32 v[88:89], v[88:89], v[92:93]
    v_add_f32 v88, v88, v89
    v_cvt_pk_bf16_f32 v88, 0, v88
    s_waitcnt lgkmcnt(0)
    v_pk_add_f32 v[80:81], v[80:81], v[82:83]
    v_pk_add_f32 v[84:85], v[84:85], v[86:87]
    v_pk_add_f32 v[80:81], v[80:81], v[84:85]
    v_add_f32 v80, v80, v81
    v_add_f32 v88, 1.0, v88
    v_cvt_pk_bf16_f32 v88, 0, v88
    v_cvt_pk_bf16_f32 v80, 0, v80
    s_nop 0
    v_mul_f32_dpp v96, v88, v96 row_newbcast:0 row_mask:0xf bank_mask:0xf
    v_mul_f32_dpp v97, v88, v97 row_newbcast:1 row_mask:0xf bank_mask:0xf
    v_mul_f32_dpp v98, v88, v98 row_newbcast:2 row_mask:0xf bank_mask:0xf
    v_mul_f32_dpp v99, v88, v99 row_newbcast:3 row_mask:0xf bank_mask:0xf
    v_mul_f32_dpp v100, v88, v100 row_newbcast:4 row_mask:0xf bank_mask:0xf
    v_mul_f32_dpp v101, v88, v101 row_newbcast:5 row_mask:0xf bank_mask:0xf
    v_mul_f32_dpp v102, v88, v102 row_newbcast:6 row_mask:0xf bank_mask:0xf
    v_mul_f32_dpp v103, v88, v103 row_newbcast:7 row_mask:0xf bank_mask:0xf
    v_cvt_pk_bf16_f32 v96, 0, v96
    v_cvt_pk_bf16_f32 v97, 0, v97
    v_cvt_pk_bf16_f32 v98, 0, v98
    v_cvt_pk_bf16_f32 v99, 0, v99
    v_cvt_pk_bf16_f32 v100, 0, v100
    v_cvt_pk_bf16_f32 v101, 0, v101
    v_cvt_pk_bf16_f32 v102, 0, v102
    v_cvt_pk_bf16_f32 v103, 0, v103
    v_add_f32_dpp v96, v80, v96 row_newbcast:0 row_mask:0xf bank_mask:0xf
    v_add_f32_dpp v97, v80, v97 row_newbcast:1 row_mask:0xf bank_mask:0xf
    v_add_f32_dpp v98, v80, v98 row_newbcast:2 row_mask:0xf bank_mask:0xf
    v_add_f32_dpp v99, v80, v99 row_newbcast:3 row_mask:0xf bank_mask:0xf
    v_add_f32_dpp v100, v80, v100 row_newbcast:4 row_mask:0xf bank_mask:0xf
    v_add_f32_dpp v101, v80, v101 row_newbcast:5 row_mask:0xf bank_mask:0xf
    v_add_f32_dpp v102, v80, v102 row_newbcast:6 row_mask:0xf bank_mask:0xf
    v_add_f32_dpp v103, v80, v103 row_newbcast:7 row_mask:0xf bank_mask:0xf
    v_cvt_pk_bf16_f32 v116, v96, v97
    v_cvt_pk_bf16_f32 v117, v98, v99
    v_cvt_pk_bf16_f32 v118, v100, v101
    v_cvt_pk_bf16_f32 v119, v102, v103
    buffer_store_dwordx4 v[116:119], v2, s[32:35], s13 offen sc1
    v_mul_f32_dpp v104, v88, v104 row_newbcast:8 row_mask:0xf bank_mask:0xf
    v_mul_f32_dpp v105, v88, v105 row_newbcast:9 row_mask:0xf bank_mask:0xf
    v_mul_f32_dpp v106, v88, v106 row_newbcast:10 row_mask:0xf bank_mask:0xf
    v_mul_f32_dpp v107, v88, v107 row_newbcast:11 row_mask:0xf bank_mask:0xf
    v_mul_f32_dpp v108, v88, v108 row_newbcast:12 row_mask:0xf bank_mask:0xf
    v_mul_f32_dpp v109, v88, v109 row_newbcast:13 row_mask:0xf bank_mask:0xf
    v_mul_f32_dpp v110, v88, v110 row_newbcast:14 row_mask:0xf bank_mask:0xf
    v_mul_f32_dpp v111, v88, v111 row_newbcast:15 row_mask:0xf bank_mask:0xf
    v_cvt_pk_bf16_f32 v104, 0, v104
    v_cvt_pk_bf16_f32 v105, 0, v105
    v_cvt_pk_bf16_f32 v106, 0, v106
    v_cvt_pk_bf16_f32 v107, 0, v107
    v_cvt_pk_bf16_f32 v108, 0, v108
    v_cvt_pk_bf16_f32 v109, 0, v109
    v_cvt_pk_bf16_f32 v110, 0, v110
    v_cvt_pk_bf16_f32 v111, 0, v111
    v_add_f32_dpp v104, v80, v104 row_newbcast:8 row_mask:0xf bank_mask:0xf
    v_add_f32_dpp v105, v80, v105 row_newbcast:9 row_mask:0xf bank_mask:0xf
    v_add_f32_dpp v106, v80, v106 row_newbcast:10 row_mask:0xf bank_mask:0xf
    v_add_f32_dpp v107, v80, v107 row_newbcast:11 row_mask:0xf bank_mask:0xf
    v_add_f32_dpp v108, v80, v108 row_newbcast:12 row_mask:0xf bank_mask:0xf
    v_add_f32_dpp v109, v80, v109 row_newbcast:13 row_mask:0xf bank_mask:0xf
    v_add_f32_dpp v110, v80, v110 row_newbcast:14 row_mask:0xf bank_mask:0xf
    v_add_f32_dpp v111, v80, v111 row_newbcast:15 row_mask:0xf bank_mask:0xf
    v_cvt_pk_bf16_f32 v120, v104, v105
    v_cvt_pk_bf16_f32 v121, v106, v107
    v_cvt_pk_bf16_f32 v122, v108, v109
    v_cvt_pk_bf16_f32 v123, v110, v111
    buffer_store_dwordx4 v[120:123], v2, s[32:35], s13 offen offset:1024 sc1
    v_bfe_u32 v66, v1, 2, 2
    v_lshlrev_b32 v66, 7, v66
    v_bfe_u32 v9, v1, 3, 1
    v_lshl_add_u32 v66, v9, 6, v66
    v_bfe_u32 v9, v1, 4, 1
    v_lshl_add_u32 v66, v9, 5, v66
    v_and_b32 v9, 3, v1
    v_lshl_add_u32 v66, v9, 3, v66
    v_lshrrev_b32 v9, 5, v1
    v_lshl_add_u32 v66, v9, 11, v66
    v_xor_b32 v67, 64, v66
    v_add_u32 v68, 49152, v66
    v_add_u32 v69, 49152, v67
    v_add_u32 v70, 98304, v66
    v_add_u32 v71, 98304, v67
    s_lshl_b32 s96, s76, 11
    s_add_u32 s14, s96, 159744
    v_bfe_u32 v4, v1, 2, 2
    v_lshl_add_u32 v4, v4, 6, s14
    v_bfe_u32 v9, v1, 4, 1
    v_lshl_add_u32 v4, v9, 5, v4
    v_and_b32 v9, 3, v1
    v_lshl_add_u32 v4, v9, 3, v4
    v_lshrrev_b32 v9, 5, v1
    v_lshl_add_u32 v4, v9, 8, v4
    v_and_b32 v5, 3, v1
    v_lshlrev_b32 v5, 15, v5
    v_bfe_u32 v9, v1, 2, 2
    v_lshl_add_u32 v5, v9, 12, v5
    s_and_b32 s96, s12, 1
    s_lshr_b32 s97, s21, 3
    s_and_b32 s98, s21, 7
    s_lshl_b32 s99, s98, 5
    s_lshl2_add_u32 s98, s97, s99
    s_lshl_b32 s97, s98, 12
    s_lshr_b32 s99, s12, 1
    s_lshl_b32 s98, s99, 6
    s_add_u32 s99, s97, s98
    s_lshl2_add_u32 s97, s96, s99
    s_add_u32 s13, s97, 1048576
    v_bfe_u32 v6, v1, 4, 1
    v_lshlrev_b32 v6, 6, v6
    v_and_b32 v74, 7, v1
    v_lshlrev_b32 v74, 4, v74
    v_xor_b32 v74, v74, v6
    v_lshrrev_b32 v6, 3, v1
    v_lshlrev_b32 v6, 11, v6
    v_add_u32 v74, v74, v6
    s_and_b32 s96, s3, 2
    s_lshl_b32 s14, s96, 5
    v_bfe_u32 v6, v1, 4, 1
    v_lshl_add_u32 v6, v6, 5, s14
    v_and_b32 v72, 7, v1
    v_lshlrev_b32 v72, 4, v72
    v_xor_b32 v72, v72, v6
    v_lshrrev_b32 v6, 3, v1
    v_mul_u32_u24 v6, 7168, v6
    v_add_u32 v72, v72, v6
    s_and_b32 s96, s3, 1
    s_lshl_b32 s14, s96, 7
    v_lshrrev_b32 v6, 5, v1
    v_lshl_add_u32 v6, v6, 6, s14
    v_and_b32 v73, 31, v1
    v_lshlrev_b32 v73, 4, v73
    v_lshrrev_b32 v9, 5, v1
    v_lshl_add_u32 v73, v9, 11, v73
    v_xor_b32 v73, v73, v6
    s_lshl3_add_u32 s96, s75, s3
    s_mul_i32 s97, s96, 229376
    s_lshl_b32 s98, s74, 7
    s_add_u32 s80, s97, s98
    s_lshl3_add_u32 s96, s74, s3
    s_lshl_b32 s97, s96, 14
    s_lshl_b32 s98, s75, 9
    s_add_u32 s81, s97, s98
    s_cmp_ge_u32 s9, 28
    s_cselect_b32 s54, 0, s54
    s_cselect_b32 s58, 0, s58
    s_cselect_b32 s62, 0, s62
    s_waitcnt vmcnt(0)
    s_barrier
    s_cmp_lg_u32 s3, 0
    s_cbranch_scc1 L_PB
    v_mov_b32 v6, s4
    s_mov_b32 exec_hi, 0
    s_mov_b32 exec_lo, 65535
    buffer_store_dword v6, v5, s[32:35], s13 offen sc1
    s_mov_b64 exec, -1
L_PB:
    s_lshr_b32 s96, s9, 4
    s_lshl_b32 s97, s96, 1
    s_xor_b32 s20, s97, 2
    s_add_u32 s96, s20, s85
    s_and_b32 s97, s96, 15
    s_lshl3_add_u32 s98, s97, s3
    s_mul_i32 s99, s98, 49152
    s_lshl_b32 s96, s11, 7
    s_add_u32 s82, s99, s96
    s_mul_i32 s96, s20, 24576
    s_lshl_b32 s97, s3, 10
    s_add_u32 s20, s96, s97
    s_mov_b32 m0, s20
    s_nop 0
    buffer_load_dwordx4 v62, s[40:43], s82 offen lds
    s_add_u32 s82, s82, 2048
    s_add_u32 m0, s20, 8192
    s_nop 0
    buffer_load_dwordx4 v62, s[40:43], s82 offen lds
    s_add_u32 s82, s82, 2048
    s_add_u32 m0, s20, 16384
    s_nop 0
    buffer_load_dwordx4 v62, s[40:43], s82 offen lds
    s_lshr_b32 s96, s9, 4
    s_lshl_b32 s97, s96, 1
    s_xor_b32 s20, s97, 3
    s_add_u32 s96, s20, s85
    s_and_b32 s97, s96, 15
    s_lshl3_add_u32 s98, s97, s3
    s_mul_i32 s99, s98, 49152
    s_lshl_b32 s96, s11, 7
    s_add_u32 s82, s99, s96
    s_mul_i32 s96, s20, 24576
    s_lshl_b32 s97, s3, 10
    s_add_u32 s20, s96, s97
    s_mov_b32 m0, s20
    s_nop 0
    buffer_load_dwordx4 v62, s[40:43], s82 offen lds
    s_add_u32 s82, s82, 2048
    s_add_u32 m0, s20, 8192
    s_nop 0
    buffer_load_dwordx4 v62, s[40:43], s82 offen lds
    s_add_u32 s82, s82, 2048
    s_add_u32 m0, s20, 16384
    s_nop 0
    buffer_load_dwordx4 v62, s[40:43], s82 offen lds
    ds_read_b64_tr_b16 v[28:29], v4
    ds_read_b64_tr_b16 v[30:31], v4 offset:512
    ds_read_b64_tr_b16 v[32:33], v4 offset:1024
    ds_read_b64_tr_b16 v[34:35], v4 offset:1536
    s_lshl_b32 s96, s10, 6
    s_add_u32 s97, s96, s3
    s_lshl_b32 s98, s97, 12
    s_add_u32 s15, s98, 4194304
    s_and_b32 s96, s3, 3
    s_lshl_b32 s97, s96, 12
    s_add_u32 s13, s97, 147456
    v_add_u32 v76, s13, v2
    s_and_b32 s96, s3, 3
    s_lshl_b32 s97, s96, 10
    s_lshl_b32 s98, s76, 14
    s_add_u32 s13, s97, s98
    v_and_b32 v75, 31, v1
    v_lshl_add_u32 v75, v75, 5, s13
    v_lshrrev_b32 v9, 5, v1
    v_lshl_add_u32 v75, v9, 4, v75
    s_lshl2_add_u32 s96, s83, s3
    s_lshl_b32 s84, s96, 14
    s_lshr_b32 s96, s9, 4
    s_lshl_b32 s97, s96, 20
    s_lshl_b32 s98, s12, 7
    s_add_u32 s88, s97, s98
    s_lshl_b32 s89, s3, 10
    s_lshl4_add_u32 s96, s8, s9
    s_add_u32 s97, s96, 16
    s_lshl_b32 s98, s97, 11
    s_add_u32 s90, s98, 131072
    s_cmp_ge_u32 s8, 3
    s_cselect_b32 s90, 0, s90
    s_cmp_ge_u32 s9, 16
    s_cselect_b32 s90, 0, s90
    s_cmp_lg_u32 s3, 1
    s_cselect_b32 s90, 0, s90
    s_load_dwordx2 s[24:25], s[32:33], s92 offset:0 glc
    s_add_u32 s96, s85, 4
    s_and_b32 s97, s96, 15
    s_lshl3_add_u32 s98, s97, s3
    s_mul_i32 s99, s98, 49152
    s_lshl_b32 s96, s11, 7
    s_add_u32 s82, s99, s96
    s_lshl_b32 s96, s3, 10
    s_add_u32 s20, s96, 98304
    s_mov_b32 m0, s20
    s_nop 0
    buffer_load_dwordx4 v62, s[40:43], s82 offen lds
    s_add_u32 s82, s82, 2048
    s_add_u32 m0, s20, 8192
    s_nop 0
    buffer_load_dwordx4 v62, s[40:43], s82 offen lds
    s_add_u32 s82, s82, 2048
    s_add_u32 m0, s20, 16384
    s_nop 0
    buffer_load_dwordx4 v62, s[40:43], s82 offen lds
    s_branch SCHK_16
SPOLL_15:
    s_load_dwordx2 s[24:25], s[32:33], s92 offset:0 glc
SCHK_16:
    s_add_u32 s5, s5, 1
    s_cmp_ge_u32 s5, 200000
    s_waitcnt lgkmcnt(0)
    s_cbranch_scc1 SDONE_17
    s_cmp_lg_u32 s24, s4
    s_cbranch_scc1 SPOLL_15
    s_cmp_lg_u32 s25, s4
    s_cbranch_scc1 SPOLL_15
SDONE_17:
    s_waitcnt vmcnt(6)
    s_barrier
    s_cmp_ge_u32 s3, 4
    s_cbranch_scc1 L_HELP
    s_setprio 2
    s_and_b32 s96, s85, 15
    s_lshl_b32 s97, s96, 14
    s_add_u32 s16, s97, s15
    buffer_load_dwordx4 v[176:179], v2, s[32:35], s16 offen sc1
    ds_read_b64_tr_b16 v[224:225], v66 offset:8192
    ds_read_b64_tr_b16 v[226:227], v66 offset:8704
    ds_read_b64_tr_b16 v[228:229], v67 offset:8192
    ds_read_b64_tr_b16 v[230:231], v67 offset:8704
    ds_read_b64_tr_b16 v[232:233], v66
    ds_read_b64_tr_b16 v[234:235], v66 offset:512
    ds_read_b64_tr_b16 v[236:237], v67
    ds_read_b64_tr_b16 v[238:239], v67 offset:512
    ds_read_b64_tr_b16 v[240:241], v66 offset:16384
    ds_read_b64_tr_b16 v[242:243], v66 offset:16896
    ds_read_b64_tr_b16 v[244:245], v67 offset:16384
    ds_read_b64_tr_b16 v[246:247], v67 offset:16896
    buffer_load_dwordx4 v[180:183], v2, s[32:35], s16 offen offset:1024 sc1
    buffer_load_dwordx4 v[184:187], v2, s[32:35], s16 offen offset:2048 sc1
    buffer_load_dwordx4 v[188:191], v2, s[32:35], s16 offen offset:3072 sc1
    s_waitcnt vmcnt(3)
    s_waitcnt lgkmcnt(10)
    v_mfma_f32_32x32x16_bf16 v[112:127], v[224:227], v[176:179], 0
    ds_read_b64_tr_b16 v[248:249], v66 offset:9216
    ds_read_b64_tr_b16 v[250:251], v66 offset:9728
    s_waitcnt lgkmcnt(10)
    v_mfma_f32_32x32x16_bf16 v[128:143], v[228:231], v[176:179], 0
    ds_read_b64_tr_b16 v[224:225], v67 offset:9216
    ds_read_b64_tr_b16 v[226:227], v67 offset:9728
    s_waitcnt lgkmcnt(10)
    v_mfma_f32_32x32x16_bf16 v[80:95], v[232:235], v[176:179], 0
    ds_read_b64_tr_b16 v[228:229], v66 offset:1024
    ds_read_b64_tr_b16 v[230:231], v66 offset:1536
    s_waitcnt lgkmcnt(10)
    v_mfma_f32_32x32x16_bf16 v[96:111], v[236:239], v[176:179], 0
    ds_read_b64_tr_b16 v[232:233], v67 offset:1024
    ds_read_b64_tr_b16 v[234:235], v67 offset:1536
    s_waitcnt lgkmcnt(10)
    v_mfma_f32_32x32x16_bf16 v[144:159], v[240:243], v[176:179], 0
    ds_read_b64_tr_b16 v[236:237], v66 offset:17408
    ds_read_b64_tr_b16 v[238:239], v66 offset:17920
    s_waitcnt lgkmcnt(10)
    v_mfma_f32_32x32x16_bf16 v[160:175], v[244:247], v[176:179], 0
    ds_read_b64_tr_b16 v[240:241], v67 offset:17408
    ds_read_b64_tr_b16 v[242:243], v67 offset:17920
    s_add_u32 s96, s85, 1
    s_and_b32 s97, s96, 15
    s_lshl_b32 s98, s97, 14
    s_add_u32 s16, s98, s15
    buffer_load_dwordx4 v[192:195], v2, s[32:35], s16 offen sc1
    buffer_load_dwordx4 v[196:199], v2, s[32:35], s16 offen offset:1024 sc1
    s_waitcnt vmcnt(4)
    s_waitcnt lgkmcnt(10)
    v_mfma_f32_32x32x16_bf16 v[112:127], v[248:251], v[180:183], v[112:127]
    ds_read_b64_tr_b16 v[244:245], v66 offset:12288
    ds_read_b64_tr_b16 v[246:247], v66 offset:12800
    s_waitcnt lgkmcnt(10)
    v_mfma_f32_32x32x16_bf16 v[128:143], v[224:227], v[180:183], v[128:143]
    ds_read_b64_tr_b16 v[248:249], v67 offset:12288
    ds_read_b64_tr_b16 v[250:251], v67 offset:12800
    s_waitcnt lgkmcnt(10)
    v_mfma_f32_32x32x16_bf16 v[80:95], v[228:231], v[180:183], v[80:95]
    ds_read_b64_tr_b16 v[224:225], v66 offset:4096
    ds_read_b64_tr_b16 v[226:227], v66 offset:4608
    s_waitcnt lgkmcnt(10)
    v_mfma_f32_32x32x16_bf16 v[96:111], v[232:235], v[180:183], v[96:111]
    ds_read_b64_tr_b16 v[228:229], v67 offset:4096
    ds_read_b64_tr_b16 v[230:231], v67 offset:4608
    s_waitcnt lgkmcnt(10)
    v_mfma_f32_32x32x16_bf16 v[144:159], v[236:239], v[180:183], v[144:159]
    ds_read_b64_tr_b16 v[232:233], v66 offset:20480
    ds_read_b64_tr_b16 v[234:235], v66 offset:20992
    s_waitcnt lgkmcnt(10)
    v_mfma_f32_32x32x16_bf16 v[160:175], v[240:243], v[180:183], v[160:175]
    ds_read_b64_tr_b16 v[236:237], v67 offset:20480
    ds_read_b64_tr_b16 v[238:239], v67 offset:20992
    buffer_load_dwordx4 v[200:203], v2, s[32:35], s16 offen offset:2048 sc1
    buffer_load_dwordx4 v[204:207], v2, s[32:35], s16 offen offset:3072 sc1
    s_waitcnt vmcnt(5)
    s_waitcnt lgkmcnt(10)
    v_mfma_f32_32x32x16_bf16 v[112:127], v[244:247], v[184:187], v[112:127]
    ds_read_b64_tr_b16 v[240:241], v66 offset:13312
    ds_read_b64_tr_b16 v[242:243], v66 offset:13824
    s_waitcnt lgkmcnt(10)
    v_mfma_f32_32x32x16_bf16 v[128:143], v[248:251], v[184:187], v[128:143]
    ds_read_b64_tr_b16 v[244:245], v67 offset:13312
    ds_read_b64_tr_b16 v[246:247], v67 offset:13824
    s_waitcnt lgkmcnt(10)
    v_mfma_f32_32x32x16_bf16 v[80:95], v[224:227], v[184:187], v[80:95]
    ds_read_b64_tr_b16 v[248:249], v66 offset:5120
    ds_read_b64_tr_b16 v[250:251], v66 offset:5632
    s_waitcnt lgkmcnt(10)
    v_mfma_f32_32x32x16_bf16 v[96:111], v[228:231], v[184:187], v[96:111]
    ds_read_b64_tr_b16 v[224:225], v67 offset:5120
    ds_read_b64_tr_b16 v[226:227], v67 offset:5632
    s_waitcnt lgkmcnt(10)
    v_mfma_f32_32x32x16_bf16 v[144:159], v[232:235], v[184:187], v[144:159]
    ds_read_b64_tr_b16 v[228:229], v66 offset:21504
    ds_read_b64_tr_b16 v[230:231], v66 offset:22016
    s_waitcnt lgkmcnt(10)
    v_mfma_f32_32x32x16_bf16 v[160:175], v[236:239], v[184:187], v[160:175]
    ds_read_b64_tr_b16 v[232:233], v67 offset:21504
    ds_read_b64_tr_b16 v[234:235], v67 offset:22016
    s_add_u32 s96, s85, 2
    s_and_b32 s97, s96, 15
    s_lshl_b32 s98, s97, 14
    s_add_u32 s16, s98, s15
    buffer_load_dwordx4 v[208:211], v2, s[32:35], s16 offen sc1
    buffer_load_dwordx4 v[212:215], v2, s[32:35], s16 offen offset:1024 sc1
    s_waitcnt vmcnt(6)
    s_waitcnt lgkmcnt(10)
    v_mfma_f32_32x32x16_bf16 v[112:127], v[240:243], v[188:191], v[112:127]
    s_barrier
    ds_read_b64_tr_b16 v[236:237], v66 offset:32768
    ds_read_b64_tr_b16 v[238:239], v66 offset:33280
    s_waitcnt lgkmcnt(10)
    v_mfma_f32_32x32x16_bf16 v[128:143], v[244:247], v[188:191], v[128:143]
    ds_read_b64_tr_b16 v[240:241], v67 offset:32768
    ds_read_b64_tr_b16 v[242:243], v67 offset:33280
    s_waitcnt lgkmcnt(10)
    v_mfma_f32_32x32x16_bf16 v[80:95], v[248:251], v[188:191], v[80:95]
    ds_read_b64_tr_b16 v[244:245], v66 offset:24576
    ds_read_b64_tr_b16 v[246:247], v66 offset:25088
    s_waitcnt lgkmcnt(10)
    v_mfma_f32_32x32x16_bf16 v[96:111], v[224:227], v[188:191], v[96:111]
    ds_read_b64_tr_b16 v[248:249], v67 offset:24576
    ds_read_b64_tr_b16 v[250:251], v67 offset:25088
    s_waitcnt lgkmcnt(10)
    v_mfma_f32_32x32x16_bf16 v[144:159], v[228:231], v[188:191], v[144:159]
    ds_read_b64_tr_b16 v[224:225], v66 offset:40960
    ds_read_b64_tr_b16 v[226:227], v66 offset:41472
    s_waitcnt lgkmcnt(10)
    v_mfma_f32_32x32x16_bf16 v[160:175], v[232:235], v[188:191], v[160:175]
    ds_read_b64_tr_b16 v[228:229], v67 offset:40960
    ds_read_b64_tr_b16 v[230:231], v67 offset:41472
    buffer_load_dwordx4 v[216:219], v2, s[32:35], s16 offen offset:2048 sc1
    buffer_load_dwordx4 v[220:223], v2, s[32:35], s16 offen offset:3072 sc1
    s_waitcnt vmcnt(7)
    s_waitcnt lgkmcnt(10)
    v_mfma_f32_32x32x16_bf16 v[112:127], v[236:239], v[192:195], v[112:127]
    ds_read_b64_tr_b16 v[232:233], v66 offset:33792
    ds_read_b64_tr_b16 v[234:235], v66 offset:34304
    s_waitcnt lgkmcnt(10)
    v_mfma_f32_32x32x16_bf16 v[128:143], v[240:243], v[192:195], v[128:143]
    ds_read_b64_tr_b16 v[236:237], v67 offset:33792
    ds_read_b64_tr_b16 v[238:239], v67 offset:34304
    s_waitcnt lgkmcnt(10)
    v_mfma_f32_32x32x16_bf16 v[80:95], v[244:247], v[192:195], v[80:95]
    ds_read_b64_tr_b16 v[240:241], v66 offset:25600
    ds_read_b64_tr_b16 v[242:243], v66 offset:26112
    s_waitcnt lgkmcnt(10)
    v_mfma_f32_32x32x16_bf16 v[96:111], v[248:251], v[192:195], v[96:111]
    ds_read_b64_tr_b16 v[244:245], v67 offset:25600
    ds_read_b64_tr_b16 v[246:247], v67 offset:26112
    s_waitcnt lgkmcnt(10)
    v_mfma_f32_32x32x16_bf16 v[144:159], v[224:227], v[192:195], v[144:159]
    ds_read_b64_tr_b16 v[248:249], v66 offset:41984
    ds_read_b64_tr_b16 v[250:251], v66 offset:42496
    s_waitcnt lgkmcnt(10)
    v_mfma_f32_32x32x16_bf16 v[160:175], v[228:231], v[192:195], v[160:175]
    ds_read_b64_tr_b16 v[224:225], v67 offset:41984
    ds_read_b64_tr_b16 v[226:227], v67 offset:42496
    s_add_u32 s96, s85, 3
    s_and_b32 s97, s96, 15
    s_lshl_b32 s98, s97, 14
    s_add_u32 s16, s98, s15
    buffer_load_dwordx4 v[176:179], v2, s[32:35], s16 offen sc1
    buffer_load_dwordx4 v[180:183], v2, s[32:35], s16 offen offset:1024 sc1
    s_waitcnt vmcnt(8)
    s_waitcnt lgkmcnt(10)
    v_mfma_f32_32x32x16_bf16 v[112:127], v[232:235], v[196:199], v[112:127]
    ds_read_b64_tr_b16 v[228:229], v66 offset:36864
    ds_read_b64_tr_b16 v[230:231], v66 offset:37376
    s_waitcnt lgkmcnt(10)
    v_mfma_f32_32x32x16_bf16 v[128:143], v[236:239], v[196:199], v[128:143]
    ds_read_b64_tr_b16 v[232:233], v67 offset:36864
    ds_read_b64_tr_b16 v[234:235], v67 offset:37376
    s_waitcnt lgkmcnt(10)
    v_mfma_f32_32x32x16_bf16 v[80:95], v[240:243], v[196:199], v[80:95]
    ds_read_b64_tr_b16 v[236:237], v66 offset:28672
    ds_read_b64_tr_b16 v[238:239], v66 offset:29184
    s_waitcnt lgkmcnt(10)
    v_mfma_f32_32x32x16_bf16 v[96:111], v[244:247], v[196:199], v[96:111]
    ds_read_b64_tr_b16 v[240:241], v67 offset:28672
    ds_read_b64_tr_b16 v[242:243], v67 offset:29184
    s_waitcnt lgkmcnt(10)
    v_mfma_f32_32x32x16_bf16 v[144:159], v[248:251], v[196:199], v[144:159]
    ds_read_b64_tr_b16 v[244:245], v66 offset:45056
    ds_read_b64_tr_b16 v[246:247], v66 offset:45568
    s_waitcnt lgkmcnt(10)
    v_mfma_f32_32x32x16_bf16 v[160:175], v[224:227], v[196:199], v[160:175]
    ds_read_b64_tr_b16 v[248:249], v67 offset:45056
    ds_read_b64_tr_b16 v[250:251], v67 offset:45568
    buffer_load_dwordx4 v[184:187], v2, s[32:35], s16 offen offset:2048 sc1
    buffer_load_dwordx4 v[188:191], v2, s[32:35], s16 offen offset:3072 sc1
    s_waitcnt vmcnt(9)
    s_waitcnt lgkmcnt(10)
    v_mfma_f32_32x32x16_bf16 v[112:127], v[228:231], v[200:203], v[112:127]
    ds_read_b64_tr_b16 v[224:225], v66 offset:37888
    ds_read_b64_tr_b16 v[226:227], v66 offset:38400
    s_waitcnt lgkmcnt(10)
    v_mfma_f32_32x32x16_bf16 v[128:143], v[232:235], v[200:203], v[128:143]
    ds_read_b64_tr_b16 v[228:229], v67 offset:37888
    ds_read_b64_tr_b16 v[230:231], v67 offset:38400
    s_waitcnt lgkmcnt(10)
    v_mfma_f32_32x32x16_bf16 v[80:95], v[236:239], v[200:203], v[80:95]
    ds_read_b64_tr_b16 v[232:233], v66 offset:29696
    ds_read_b64_tr_b16 v[234:235], v66 offset:30208
    s_waitcnt lgkmcnt(10)
    v_mfma_f32_32x32x16_bf16 v[96:111], v[240:243], v[200:203], v[96:111]
    ds_read_b64_tr_b16 v[236:237], v67 offset:29696
    ds_read_b64_tr_b16 v[238:239], v67 offset:30208
    s_waitcnt lgkmcnt(10)
    v_mfma_f32_32x32x16_bf16 v[144:159], v[244:247], v[200:203], v[144:159]
    ds_read_b64_tr_b16 v[240:241], v66 offset:46080
    ds_read_b64_tr_b16 v[242:243], v66 offset:46592
    s_waitcnt lgkmcnt(10)
    v_mfma_f32_32x32x16_bf16 v[160:175], v[248:251], v[200:203], v[160:175]
    ds_read_b64_tr_b16 v[244:245], v67 offset:46080
    ds_read_b64_tr_b16 v[246:247], v67 offset:46592
    s_add_u32 s96, s85, 4
    s_and_b32 s97, s96, 15
    s_lshl_b32 s98, s97, 14
    s_add_u32 s16, s98, s15
    buffer_load_dwordx4 v[192:195], v2, s[32:35], s16 offen sc1
    buffer_load_dwordx4 v[196:199], v2, s[32:35], s16 offen offset:1024 sc1
    s_waitcnt vmcnt(10)
    s_waitcnt lgkmcnt(10)
    v_mfma_f32_32x32x16_bf16 v[112:127], v[224:227], v[204:207], v[112:127]
    s_barrier
    ds_read_b64_tr_b16 v[248:249], v68 offset:8192
    ds_read_b64_tr_b16 v[250:251], v68 offset:8704
    s_waitcnt lgkmcnt(10)
    v_mfma_f32_32x32x16_bf16 v[128:143], v[228:231], v[204:207], v[128:143]
    ds_read_b64_tr_b16 v[224:225], v69 offset:8192
    ds_read_b64_tr_b16 v[226:227], v69 offset:8704
    s_waitcnt lgkmcnt(10)
    v_mfma_f32_32x32x16_bf16 v[80:95], v[232:235], v[204:207], v[80:95]
    ds_read_b64_tr_b16 v[228:229], v68
    ds_read_b64_tr_b16 v[230:231], v68 offset:512
    s_waitcnt lgkmcnt(10)
    v_mfma_f32_32x32x16_bf16 v[96:111], v[236:239], v[204:207], v[96:111]
    ds_read_b64_tr_b16 v[232:233], v69
    ds_read_b64_tr_b16 v[234:235], v69 offset:512
    s_waitcnt lgkmcnt(10)
    v_mfma_f32_32x32x16_bf16 v[144:159], v[240:243], v[204:207], v[144:159]
    ds_read_b64_tr_b16 v[236:237], v68 offset:16384
    ds_read_b64_tr_b16 v[238:239], v68 offset:16896
    s_waitcnt lgkmcnt(10)
    v_mfma_f32_32x32x16_bf16 v[160:175], v[244:247], v[204:207], v[160:175]
    ds_read_b64_tr_b16 v[240:241], v69 offset:16384
    ds_read_b64_tr_b16 v[242:243], v69 offset:16896
    buffer_load_dwordx4 v[200:203], v2, s[32:35], s16 offen offset:2048 sc1
    buffer_load_dwordx4 v[204:207], v2, s[32:35], s16 offen offset:3072 sc1
    s_waitcnt vmcnt(11)
    s_waitcnt lgkmcnt(10)
    v_mfma_f32_32x32x16_bf16 v[112:127], v[248:251], v[208:211], v[112:127]
    ds_read_b64_tr_b16 v[244:245], v68 offset:9216
    ds_read_b64_tr_b16 v[246:247], v68 offset:9728
    s_waitcnt lgkmcnt(10)
    v_mfma_f32_32x32x16_bf16 v[128:143], v[224:227], v[208:211], v[128:143]
    ds_read_b64_tr_b16 v[248:249], v69 offset:9216
    ds_read_b64_tr_b16 v[250:251], v69 offset:9728
    s_waitcnt lgkmcnt(10)
    v_mfma_f32_32x32x16_bf16 v[80:95], v[228:231], v[208:211], v[80:95]
    ds_read_b64_tr_b16 v[224:225], v68 offset:1024
    ds_read_b64_tr_b16 v[226:227], v68 offset:1536
    s_waitcnt lgkmcnt(10)
    v_mfma_f32_32x32x16_bf16 v[96:111], v[232:235], v[208:211], v[96:111]
    ds_read_b64_tr_b16 v[228:229], v69 offset:1024
    ds_read_b64_tr_b16 v[230:231], v69 offset:1536
    s_waitcnt lgkmcnt(10)
    v_mfma_f32_32x32x16_bf16 v[144:159], v[236:239], v[208:211], v[144:159]
    ds_read_b64_tr_b16 v[232:233], v68 offset:17408
    ds_read_b64_tr_b16 v[234:235], v68 offset:17920
    s_waitcnt lgkmcnt(10)
    v_mfma_f32_32x32x16_bf16 v[160:175], v[240:243], v[208:211], v[160:175]
    ds_read_b64_tr_b16 v[236:237], v69 offset:17408
    ds_read_b64_tr_b16 v[238:239], v69 offset:17920
    s_add_u32 s96, s85, 5
    s_and_b32 s97, s96, 15
    s_lshl_b32 s98, s97, 14
    s_add_u32 s16, s98, s15
    buffer_load_dwordx4 v[208:211], v2, s[32:35], s16 offen sc1
    s_waitcnt vmcnt(11)
    s_waitcnt lgkmcnt(10)
    v_mfma_f32_32x32x16_bf16 v[112:127], v[244:247], v[212:215], v[112:127]
    ds_read_b64_tr_b16 v[240:241], v68 offset:12288
    ds_read_b64_tr_b16 v[242:243], v68 offset:12800
    s_waitcnt lgkmcnt(10)
    v_mfma_f32_32x32x16_bf16 v[128:143], v[248:251], v[212:215], v[128:143]
    ds_read_b64_tr_b16 v[244:245], v69 offset:12288
    ds_read_b64_tr_b16 v[246:247], v69 offset:12800
    s_waitcnt lgkmcnt(10)
    v_mfma_f32_32x32x16_bf16 v[80:95], v[224:227], v[212:215], v[80:95]
    ds_read_b64_tr_b16 v[248:249], v68 offset:4096
    ds_read_b64_tr_b16 v[250:251], v68 offset:4608
    s_waitcnt lgkmcnt(10)
    v_mfma_f32_32x32x16_bf16 v[96:111], v[228:231], v[212:215], v[96:111]
    ds_read_b64_tr_b16 v[224:225], v69 offset:4096
    ds_read_b64_tr_b16 v[226:227], v69 offset:4608
    s_waitcnt lgkmcnt(10)
    v_mfma_f32_32x32x16_bf16 v[144:159], v[232:235], v[212:215], v[144:159]
    ds_read_b64_tr_b16 v[228:229], v68 offset:20480
    ds_read_b64_tr_b16 v[230:231], v68 offset:20992
    s_waitcnt lgkmcnt(10)
    v_mfma_f32_32x32x16_bf16 v[160:175], v[236:239], v[212:215], v[160:175]
    ds_read_b64_tr_b16 v[232:233], v69 offset:20480
    ds_read_b64_tr_b16 v[234:235], v69 offset:20992
    buffer_load_dwordx4 v[212:215], v2, s[32:35], s16 offen offset:1024 sc1
    s_waitcnt vmcnt(11)
    s_waitcnt lgkmcnt(10)
    v_mfma_f32_32x32x16_bf16 v[112:127], v[240:243], v[216:219], v[112:127]
    ds_read_b64_tr_b16 v[236:237], v68 offset:13312
    ds_read_b64_tr_b16 v[238:239], v68 offset:13824
    s_waitcnt lgkmcnt(10)
    v_mfma_f32_32x32x16_bf16 v[128:143], v[244:247], v[216:219], v[128:143]
    ds_read_b64_tr_b16 v[240:241], v69 offset:13312
    ds_read_b64_tr_b16 v[242:243], v69 offset:13824
    s_waitcnt lgkmcnt(10)
    v_mfma_f32_32x32x16_bf16 v[80:95], v[248:251], v[216:219], v[80:95]
    ds_read_b64_tr_b16 v[244:245], v68 offset:5120
    ds_read_b64_tr_b16 v[246:247], v68 offset:5632
    s_waitcnt lgkmcnt(10)
    v_mfma_f32_32x32x16_bf16 v[96:111], v[224:227], v[216:219], v[96:111]
    ds_read_b64_tr_b16 v[248:249], v69 offset:5120
    ds_read_b64_tr_b16 v[250:251], v69 offset:5632
    s_waitcnt lgkmcnt(10)
    v_mfma_f32_32x32x16_bf16 v[144:159], v[228:231], v[216:219], v[144:159]
    ds_read_b64_tr_b16 v[224:225], v68 offset:21504
    ds_read_b64_tr_b16 v[226:227], v68 offset:22016
    s_waitcnt lgkmcnt(10)
    v_mfma_f32_32x32x16_bf16 v[160:175], v[232:235], v[216:219], v[160:175]
    ds_read_b64_tr_b16 v[228:229], v69 offset:21504
    ds_read_b64_tr_b16 v[230:231], v69 offset:22016
    buffer_load_dwordx4 v[216:219], v2, s[32:35], s16 offen offset:2048 sc1
    s_waitcnt vmcnt(11)
    s_waitcnt lgkmcnt(10)
    v_mfma_f32_32x32x16_bf16 v[112:127], v[236:239], v[220:223], v[112:127]
    s_barrier
    ds_read_b64_tr_b16 v[232:233], v68 offset:32768
    ds_read_b64_tr_b16 v[234:235], v68 offset:33280
    s_waitcnt lgkmcnt(10)
    v_mfma_f32_32x32x16_bf16 v[128:143], v[240:243], v[220:223], v[128:143]
    ds_read_b64_tr_b16 v[236:237], v69 offset:32768
    ds_read_b64_tr_b16 v[238:239], v69 offset:33280
    s_waitcnt lgkmcnt(10)
    v_mfma_f32_32x32x16_bf16 v[80:95], v[244:247], v[220:223], v[80:95]
    ds_read_b64_tr_b16 v[240:241], v68 offset:24576
    ds_read_b64_tr_b16 v[242:243], v68 offset:25088
    s_waitcnt lgkmcnt(10)
    v_mfma_f32_32x32x16_bf16 v[96:111], v[248:251], v[220:223], v[96:111]
    ds_read_b64_tr_b16 v[244:245], v69 offset:24576
    ds_read_b64_tr_b16 v[246:247], v69 offset:25088
    s_waitcnt lgkmcnt(10)
    v_mfma_f32_32x32x16_bf16 v[144:159], v[224:227], v[220:223], v[144:159]
    ds_read_b64_tr_b16 v[248:249], v68 offset:40960
    ds_read_b64_tr_b16 v[250:251], v68 offset:41472
    s_waitcnt lgkmcnt(10)
    v_mfma_f32_32x32x16_bf16 v[160:175], v[228:231], v[220:223], v[160:175]
    ds_read_b64_tr_b16 v[224:225], v69 offset:40960
    ds_read_b64_tr_b16 v[226:227], v69 offset:41472
    buffer_load_dwordx4 v[220:223], v2, s[32:35], s16 offen offset:3072 sc1
    s_waitcnt vmcnt(11)
    s_waitcnt lgkmcnt(10)
    v_mfma_f32_32x32x16_bf16 v[112:127], v[232:235], v[176:179], v[112:127]
    ds_read_b64_tr_b16 v[228:229], v68 offset:33792
    ds_read_b64_tr_b16 v[230:231], v68 offset:34304
    s_waitcnt lgkmcnt(10)
    v_mfma_f32_32x32x16_bf16 v[128:143], v[236:239], v[176:179], v[128:143]
    ds_read_b64_tr_b16 v[232:233], v69 offset:33792
    ds_read_b64_tr_b16 v[234:235], v69 offset:34304
    s_waitcnt lgkmcnt(10)
    v_mfma_f32_32x32x16_bf16 v[80:95], v[240:243], v[176:179], v[80:95]
    ds_read_b64_tr_b16 v[236:237], v68 offset:25600
    ds_read_b64_tr_b16 v[238:239], v68 offset:26112
    s_waitcnt lgkmcnt(10)
    v_mfma_f32_32x32x16_bf16 v[96:111], v[244:247], v[176:179], v[96:111]
    ds_read_b64_tr_b16 v[240:241], v69 offset:25600
    ds_read_b64_tr_b16 v[242:243], v69 offset:26112
    s_waitcnt lgkmcnt(10)
    v_mfma_f32_32x32x16_bf16 v[144:159], v[248:251], v[176:179], v[144:159]
    ds_read_b64_tr_b16 v[244:245], v68 offset:41984
    ds_read_b64_tr_b16 v[246:247], v68 offset:42496
    s_waitcnt lgkmcnt(10)
    v_mfma_f32_32x32x16_bf16 v[160:175], v[224:227], v[176:179], v[160:175]
    ds_read_b64_tr_b16 v[248:249], v69 offset:41984
    ds_read_b64_tr_b16 v[250:251], v69 offset:42496
    s_add_u32 s96, s85, 6
    s_and_b32 s97, s96, 15
    s_lshl_b32 s98, s97, 14
    s_add_u32 s16, s98, s15
    buffer_load_dwordx4 v[176:179], v2, s[32:35], s16 offen sc1
    s_waitcnt vmcnt(11)
    s_waitcnt lgkmcnt(10)
    v_mfma_f32_32x32x16_bf16 v[112:127], v[228:231], v[180:183], v[112:127]
    ds_read_b64_tr_b16 v[224:225], v68 offset:36864
    ds_read_b64_tr_b16 v[226:227], v68 offset:37376
    s_waitcnt lgkmcnt(10)
    v_mfma_f32_32x32x16_bf16 v[128:143], v[232:235], v[180:183], v[128:143]
    ds_read_b64_tr_b16 v[228:229], v69 offset:36864
    ds_read_b64_tr_b16 v[230:231], v69 offset:37376
    s_waitcnt lgkmcnt(10)
    v_mfma_f32_32x32x16_bf16 v[80:95], v[236:239], v[180:183], v[80:95]
    ds_read_b64_tr_b16 v[232:233], v68 offset:28672
    ds_read_b64_tr_b16 v[234:235], v68 offset:29184
    s_waitcnt lgkmcnt(10)
    v_mfma_f32_32x32x16_bf16 v[96:111], v[240:243], v[180:183], v[96:111]
    ds_read_b64_tr_b16 v[236:237], v69 offset:28672
    ds_read_b64_tr_b16 v[238:239], v69 offset:29184
    s_waitcnt lgkmcnt(10)
    v_mfma_f32_32x32x16_bf16 v[144:159], v[244:247], v[180:183], v[144:159]
    ds_read_b64_tr_b16 v[240:241], v68 offset:45056
    ds_read_b64_tr_b16 v[242:243], v68 offset:45568
    s_waitcnt lgkmcnt(10)
    v_mfma_f32_32x32x16_bf16 v[160:175], v[248:251], v[180:183], v[160:175]
    ds_read_b64_tr_b16 v[244:245], v69 offset:45056
    ds_read_b64_tr_b16 v[246:247], v69 offset:45568
    buffer_load_dwordx4 v[180:183], v2, s[32:35], s16 offen offset:1024 sc1
    s_waitcnt vmcnt(11)
    s_waitcnt lgkmcnt(10)
    v_mfma_f32_32x32x16_bf16 v[112:127], v[224:227], v[184:187], v[112:127]
    ds_read_b64_tr_b16 v[248:249], v68 offset:37888
    ds_read_b64_tr_b16 v[250:251], v68 offset:38400
    s_waitcnt lgkmcnt(10)
    v_mfma_f32_32x32x16_bf16 v[128:143], v[228:231], v[184:187], v[128:143]
    ds_read_b64_tr_b16 v[224:225], v69 offset:37888
    ds_read_b64_tr_b16 v[226:227], v69 offset:38400
    s_waitcnt lgkmcnt(10)
    v_mfma_f32_32x32x16_bf16 v[80:95], v[232:235], v[184:187], v[80:95]
    ds_read_b64_tr_b16 v[228:229], v68 offset:29696
    ds_read_b64_tr_b16 v[230:231], v68 offset:30208
    s_waitcnt lgkmcnt(10)
    v_mfma_f32_32x32x16_bf16 v[96:111], v[236:239], v[184:187], v[96:111]
    ds_read_b64_tr_b16 v[232:233], v69 offset:29696
    ds_read_b64_tr_b16 v[234:235], v69 offset:30208
    s_waitcnt lgkmcnt(10)
    v_mfma_f32_32x32x16_bf16 v[144:159], v[240:243], v[184:187], v[144:159]
    ds_read_b64_tr_b16 v[236:237], v68 offset:46080
    ds_read_b64_tr_b16 v[238:239], v68 offset:46592
    s_waitcnt lgkmcnt(10)
    v_mfma_f32_32x32x16_bf16 v[160:175], v[244:247], v[184:187], v[160:175]
    ds_read_b64_tr_b16 v[240:241], v69 offset:46080
    ds_read_b64_tr_b16 v[242:243], v69 offset:46592
    buffer_load_dwordx4 v[184:187], v2, s[32:35], s16 offen offset:2048 sc1
    s_waitcnt vmcnt(11)
    s_waitcnt lgkmcnt(10)
    v_mfma_f32_32x32x16_bf16 v[112:127], v[248:251], v[188:191], v[112:127]
    s_barrier
    ds_read_b64_tr_b16 v[244:245], v70 offset:8192
    ds_read_b64_tr_b16 v[246:247], v70 offset:8704
    s_waitcnt lgkmcnt(10)
    v_mfma_f32_32x32x16_bf16 v[128:143], v[224:227], v[188:191], v[128:143]
    ds_read_b64_tr_b16 v[248:249], v71 offset:8192
    ds_read_b64_tr_b16 v[250:251], v71 offset:8704
    s_waitcnt lgkmcnt(10)
    v_mfma_f32_32x32x16_bf16 v[80:95], v[228:231], v[188:191], v[80:95]
    ds_read_b64_tr_b16 v[224:225], v70
    ds_read_b64_tr_b16 v[226:227], v70 offset:512
    s_waitcnt lgkmcnt(10)
    v_mfma_f32_32x32x16_bf16 v[96:111], v[232:235], v[188:191], v[96:111]
    ds_read_b64_tr_b16 v[228:229], v71
    ds_read_b64_tr_b16 v[230:231], v71 offset:512
    s_waitcnt lgkmcnt(10)
    v_mfma_f32_32x32x16_bf16 v[144:159], v[236:239], v[188:191], v[144:159]
    ds_read_b64_tr_b16 v[232:233], v70 offset:16384
    ds_read_b64_tr_b16 v[234:235], v70 offset:16896
    s_waitcnt lgkmcnt(10)
    v_mfma_f32_32x32x16_bf16 v[160:175], v[240:243], v[188:191], v[160:175]
    ds_read_b64_tr_b16 v[236:237], v71 offset:16384
    ds_read_b64_tr_b16 v[238:239], v71 offset:16896
    buffer_load_dwordx4 v[188:191], v2, s[32:35], s16 offen offset:3072 sc1
    s_waitcnt vmcnt(11)
    s_waitcnt lgkmcnt(10)
    v_mfma_f32_32x32x16_bf16 v[112:127], v[244:247], v[192:195], v[112:127]
    ds_read_b64_tr_b16 v[240:241], v70 offset:9216
    ds_read_b64_tr_b16 v[242:243], v70 offset:9728
    s_waitcnt lgkmcnt(10)
    v_mfma_f32_32x32x16_bf16 v[128:143], v[248:251], v[192:195], v[128:143]
    ds_read_b64_tr_b16 v[244:245], v71 offset:9216
    ds_read_b64_tr_b16 v[246:247], v71 offset:9728
    s_waitcnt lgkmcnt(10)
    v_mfma_f32_32x32x16_bf16 v[80:95], v[224:227], v[192:195], v[80:95]
    ds_read_b64_tr_b16 v[248:249], v70 offset:1024
    ds_read_b64_tr_b16 v[250:251], v70 offset:1536
    s_waitcnt lgkmcnt(10)
    v_mfma_f32_32x32x16_bf16 v[96:111], v[228:231], v[192:195], v[96:111]
    ds_read_b64_tr_b16 v[224:225], v71 offset:1024
    ds_read_b64_tr_b16 v[226:227], v71 offset:1536
    s_waitcnt lgkmcnt(10)
    v_mfma_f32_32x32x16_bf16 v[144:159], v[232:235], v[192:195], v[144:159]
    ds_read_b64_tr_b16 v[228:229], v70 offset:17408
    ds_read_b64_tr_b16 v[230:231], v70 offset:17920
    s_waitcnt lgkmcnt(10)
    v_mfma_f32_32x32x16_bf16 v[160:175], v[236:239], v[192:195], v[160:175]
    ds_read_b64_tr_b16 v[232:233], v71 offset:17408
    ds_read_b64_tr_b16 v[234:235], v71 offset:17920
    s_add_u32 s96, s85, 7
    s_and_b32 s97, s96, 15
    s_lshl_b32 s98, s97, 14
    s_add_u32 s16, s98, s15
    buffer_load_dwordx4 v[192:195], v2, s[32:35], s16 offen sc1
    s_waitcnt vmcnt(11)
    s_waitcnt lgkmcnt(10)
    v_mfma_f32_32x32x16_bf16 v[112:127], v[240:243], v[196:199], v[112:127]
    ds_read_b64_tr_b16 v[236:237], v70 offset:12288
    ds_read_b64_tr_b16 v[238:239], v70 offset:12800
    s_waitcnt lgkmcnt(10)
    v_mfma_f32_32x32x16_bf16 v[128:143], v[244:247], v[196:199], v[128:143]
    ds_read_b64_tr_b16 v[240:241], v71 offset:12288
    ds_read_b64_tr_b16 v[242:243], v71 offset:12800
    s_waitcnt lgkmcnt(10)
    v_mfma_f32_32x32x16_bf16 v[80:95], v[248:251], v[196:199], v[80:95]
    ds_read_b64_tr_b16 v[244:245], v70 offset:4096
    ds_read_b64_tr_b16 v[246:247], v70 offset:4608
    s_waitcnt lgkmcnt(10)
    v_mfma_f32_32x32x16_bf16 v[96:111], v[224:227], v[196:199], v[96:111]
    ds_read_b64_tr_b16 v[248:249], v71 offset:4096
    ds_read_b64_tr_b16 v[250:251], v71 offset:4608
    s_waitcnt lgkmcnt(10)
    v_mfma_f32_32x32x16_bf16 v[144:159], v[228:231], v[196:199], v[144:159]
    ds_read_b64_tr_b16 v[224:225], v70 offset:20480
    ds_read_b64_tr_b16 v[226:227], v70 offset:20992
    s_waitcnt lgkmcnt(10)
    v_mfma_f32_32x32x16_bf16 v[160:175], v[232:235], v[196:199], v[160:175]
    ds_read_b64_tr_b16 v[228:229], v71 offset:20480
    ds_read_b64_tr_b16 v[230:231], v71 offset:20992
    buffer_load_dwordx4 v[196:199], v2, s[32:35], s16 offen offset:1024 sc1
    s_waitcnt vmcnt(11)
    s_waitcnt lgkmcnt(10)
    v_mfma_f32_32x32x16_bf16 v[112:127], v[236:239], v[200:203], v[112:127]
    ds_read_b64_tr_b16 v[232:233], v70 offset:13312
    ds_read_b64_tr_b16 v[234:235], v70 offset:13824
    s_waitcnt lgkmcnt(10)
    v_mfma_f32_32x32x16_bf16 v[128:143], v[240:243], v[200:203], v[128:143]
    ds_read_b64_tr_b16 v[236:237], v71 offset:13312
    ds_read_b64_tr_b16 v[238:239], v71 offset:13824
    s_waitcnt lgkmcnt(10)
    v_mfma_f32_32x32x16_bf16 v[80:95], v[244:247], v[200:203], v[80:95]
    ds_read_b64_tr_b16 v[240:241], v70 offset:5120
    ds_read_b64_tr_b16 v[242:243], v70 offset:5632
    s_waitcnt lgkmcnt(10)
    v_mfma_f32_32x32x16_bf16 v[96:111], v[248:251], v[200:203], v[96:111]
    ds_read_b64_tr_b16 v[244:245], v71 offset:5120
    ds_read_b64_tr_b16 v[246:247], v71 offset:5632
    s_waitcnt lgkmcnt(10)
    v_mfma_f32_32x32x16_bf16 v[144:159], v[224:227], v[200:203], v[144:159]
    ds_read_b64_tr_b16 v[248:249], v70 offset:21504
    ds_read_b64_tr_b16 v[250:251], v70 offset:22016
    s_waitcnt lgkmcnt(10)
    v_mfma_f32_32x32x16_bf16 v[160:175], v[228:231], v[200:203], v[160:175]
    ds_read_b64_tr_b16 v[224:225], v71 offset:21504
    ds_read_b64_tr_b16 v[226:227], v71 offset:22016
    buffer_load_dwordx4 v[200:203], v2, s[32:35], s16 offen offset:2048 sc1
    s_waitcnt vmcnt(11)
    s_waitcnt lgkmcnt(10)
    v_mfma_f32_32x32x16_bf16 v[112:127], v[232:235], v[204:207], v[112:127]
    s_barrier
    ds_read_b64_tr_b16 v[228:229], v70 offset:32768
    ds_read_b64_tr_b16 v[230:231], v70 offset:33280
    s_waitcnt lgkmcnt(10)
    v_mfma_f32_32x32x16_bf16 v[128:143], v[236:239], v[204:207], v[128:143]
    ds_read_b64_tr_b16 v[232:233], v71 offset:32768
    ds_read_b64_tr_b16 v[234:235], v71 offset:33280
    s_waitcnt lgkmcnt(10)
    v_mfma_f32_32x32x16_bf16 v[80:95], v[240:243], v[204:207], v[80:95]
    ds_read_b64_tr_b16 v[236:237], v70 offset:24576
    ds_read_b64_tr_b16 v[238:239], v70 offset:25088
    s_waitcnt lgkmcnt(10)
    v_mfma_f32_32x32x16_bf16 v[96:111], v[244:247], v[204:207], v[96:111]
    ds_read_b64_tr_b16 v[240:241], v71 offset:24576
    ds_read_b64_tr_b16 v[242:243], v71 offset:25088
    s_waitcnt lgkmcnt(10)
    v_mfma_f32_32x32x16_bf16 v[144:159], v[248:251], v[204:207], v[144:159]
    ds_read_b64_tr_b16 v[244:245], v70 offset:40960
    ds_read_b64_tr_b16 v[246:247], v70 offset:41472
    s_waitcnt lgkmcnt(10)
    v_mfma_f32_32x32x16_bf16 v[160:175], v[224:227], v[204:207], v[160:175]
    ds_read_b64_tr_b16 v[248:249], v71 offset:40960
    ds_read_b64_tr_b16 v[250:251], v71 offset:41472
    buffer_load_dwordx4 v[204:207], v2, s[32:35], s16 offen offset:3072 sc1
    s_waitcnt vmcnt(11)
    s_waitcnt lgkmcnt(10)
    v_mfma_f32_32x32x16_bf16 v[112:127], v[228:231], v[208:211], v[112:127]
    ds_read_b64_tr_b16 v[224:225], v70 offset:33792
    ds_read_b64_tr_b16 v[226:227], v70 offset:34304
    s_waitcnt lgkmcnt(10)
    v_mfma_f32_32x32x16_bf16 v[128:143], v[232:235], v[208:211], v[128:143]
    ds_read_b64_tr_b16 v[228:229], v71 offset:33792
    ds_read_b64_tr_b16 v[230:231], v71 offset:34304
    s_waitcnt lgkmcnt(10)
    v_mfma_f32_32x32x16_bf16 v[80:95], v[236:239], v[208:211], v[80:95]
    ds_read_b64_tr_b16 v[232:233], v70 offset:25600
    ds_read_b64_tr_b16 v[234:235], v70 offset:26112
    s_waitcnt lgkmcnt(10)
    v_mfma_f32_32x32x16_bf16 v[96:111], v[240:243], v[208:211], v[96:111]
    ds_read_b64_tr_b16 v[236:237], v71 offset:25600
    ds_read_b64_tr_b16 v[238:239], v71 offset:26112
    s_waitcnt lgkmcnt(10)
    v_mfma_f32_32x32x16_bf16 v[144:159], v[244:247], v[208:211], v[144:159]
    ds_read_b64_tr_b16 v[240:241], v70 offset:41984
    ds_read_b64_tr_b16 v[242:243], v70 offset:42496
    s_waitcnt lgkmcnt(10)
    v_mfma_f32_32x32x16_bf16 v[160:175], v[248:251], v[208:211], v[160:175]
    ds_read_b64_tr_b16 v[244:245], v71 offset:41984
    ds_read_b64_tr_b16 v[246:247], v71 offset:42496
    s_add_u32 s96, s85, 8
    s_and_b32 s97, s96, 15
    s_lshl_b32 s98, s97, 14
    s_add_u32 s16, s98, s15
    buffer_load_dwordx4 v[208:211], v2, s[32:35], s16 offen sc1
    s_waitcnt vmcnt(11)
    s_waitcnt lgkmcnt(10)
    v_mfma_f32_32x32x16_bf16 v[112:127], v[224:227], v[212:215], v[112:127]
    ds_read_b64_tr_b16 v[248:249], v70 offset:36864
    ds_read_b64_tr_b16 v[250:251], v70 offset:37376
    s_waitcnt lgkmcnt(10)
    v_mfma_f32_32x32x16_bf16 v[128:143], v[228:231], v[212:215], v[128:143]
    ds_read_b64_tr_b16 v[224:225], v71 offset:36864
    ds_read_b64_tr_b16 v[226:227], v71 offset:37376
    s_waitcnt lgkmcnt(10)
    v_mfma_f32_32x32x16_bf16 v[80:95], v[232:235], v[212:215], v[80:95]
    ds_read_b64_tr_b16 v[228:229], v70 offset:28672
    ds_read_b64_tr_b16 v[230:231], v70 offset:29184
    s_waitcnt lgkmcnt(10)
    v_mfma_f32_32x32x16_bf16 v[96:111], v[236:239], v[212:215], v[96:111]
    ds_read_b64_tr_b16 v[232:233], v71 offset:28672
    ds_read_b64_tr_b16 v[234:235], v71 offset:29184
    s_waitcnt lgkmcnt(10)
    v_mfma_f32_32x32x16_bf16 v[144:159], v[240:243], v[212:215], v[144:159]
    ds_read_b64_tr_b16 v[236:237], v70 offset:45056
    ds_read_b64_tr_b16 v[238:239], v70 offset:45568
    s_waitcnt lgkmcnt(10)
    v_mfma_f32_32x32x16_bf16 v[160:175], v[244:247], v[212:215], v[160:175]
    ds_read_b64_tr_b16 v[240:241], v71 offset:45056
    ds_read_b64_tr_b16 v[242:243], v71 offset:45568
    buffer_load_dwordx4 v[212:215], v2, s[32:35], s16 offen offset:1024 sc1
    s_waitcnt vmcnt(11)
    s_waitcnt lgkmcnt(10)
    v_mfma_f32_32x32x16_bf16 v[112:127], v[248:251], v[216:219], v[112:127]
    ds_read_b64_tr_b16 v[244:245], v70 offset:37888
    ds_read_b64_tr_b16 v[246:247], v70 offset:38400
    s_waitcnt lgkmcnt(10)
    v_mfma_f32_32x32x16_bf16 v[128:143], v[224:227], v[216:219], v[128:143]
    ds_read_b64_tr_b16 v[248:249], v71 offset:37888
    ds_read_b64_tr_b16 v[250:251], v71 offset:38400
    s_waitcnt lgkmcnt(10)
    v_mfma_f32_32x32x16_bf16 v[80:95], v[228:231], v[216:219], v[80:95]
    ds_read_b64_tr_b16 v[224:225], v70 offset:29696
    ds_read_b64_tr_b16 v[226:227], v70 offset:30208
    s_waitcnt lgkmcnt(10)
    v_mfma_f32_32x32x16_bf16 v[96:111], v[232:235], v[216:219], v[96:111]
    ds_read_b64_tr_b16 v[228:229], v71 offset:29696
    ds_read_b64_tr_b16 v[230:231], v71 offset:30208
    s_waitcnt lgkmcnt(10)
    v_mfma_f32_32x32x16_bf16 v[144:159], v[236:239], v[216:219], v[144:159]
    ds_read_b64_tr_b16 v[232:233], v70 offset:46080
    ds_read_b64_tr_b16 v[234:235], v70 offset:46592
    s_waitcnt lgkmcnt(10)
    v_mfma_f32_32x32x16_bf16 v[160:175], v[240:243], v[216:219], v[160:175]
    ds_read_b64_tr_b16 v[236:237], v71 offset:46080
    ds_read_b64_tr_b16 v[238:239], v71 offset:46592
    buffer_load_dwordx4 v[216:219], v2, s[32:35], s16 offen offset:2048 sc1
    s_waitcnt vmcnt(11)
    s_waitcnt lgkmcnt(10)
    v_mfma_f32_32x32x16_bf16 v[112:127], v[244:247], v[220:223], v[112:127]
    s_barrier
    ds_read_b64_tr_b16 v[240:241], v66 offset:8192
    ds_read_b64_tr_b16 v[242:243], v66 offset:8704
    s_waitcnt lgkmcnt(10)
    v_mfma_f32_32x32x16_bf16 v[128:143], v[248:251], v[220:223], v[128:143]
    ds_read_b64_tr_b16 v[244:245], v67 offset:8192
    ds_read_b64_tr_b16 v[246:247], v67 offset:8704
    s_waitcnt lgkmcnt(10)
    v_mfma_f32_32x32x16_bf16 v[80:95], v[224:227], v[220:223], v[80:95]
    ds_read_b64_tr_b16 v[248:249], v66
    ds_read_b64_tr_b16 v[250:251], v66 offset:512
    s_waitcnt lgkmcnt(10)
    v_mfma_f32_32x32x16_bf16 v[96:111], v[228:231], v[220:223], v[96:111]
    ds_read_b64_tr_b16 v[224:225], v67
    ds_read_b64_tr_b16 v[226:227], v67 offset:512
    s_waitcnt lgkmcnt(10)
    v_mfma_f32_32x32x16_bf16 v[144:159], v[232:235], v[220:223], v[144:159]
    ds_read_b64_tr_b16 v[228:229], v66 offset:16384
    ds_read_b64_tr_b16 v[230:231], v66 offset:16896
    s_waitcnt lgkmcnt(10)
    v_mfma_f32_32x32x16_bf16 v[160:175], v[236:239], v[220:223], v[160:175]
    ds_read_b64_tr_b16 v[232:233], v67 offset:16384
    ds_read_b64_tr_b16 v[234:235], v67 offset:16896
    buffer_load_dwordx4 v[220:223], v2, s[32:35], s16 offen offset:3072 sc1
    s_waitcnt vmcnt(11)
    s_waitcnt lgkmcnt(10)
    v_mfma_f32_32x32x16_bf16 v[112:127], v[240:243], v[176:179], v[112:127]
    ds_read_b64_tr_b16 v[236:237], v66 offset:9216
    ds_read_b64_tr_b16 v[238:239], v66 offset:9728
    s_waitcnt lgkmcnt(10)
    v_mfma_f32_32x32x16_bf16 v[128:143], v[244:247], v[176:179], v[128:143]
    ds_read_b64_tr_b16 v[240:241], v67 offset:9216
    ds_read_b64_tr_b16 v[242:243], v67 offset:9728
    s_waitcnt lgkmcnt(10)
    v_mfma_f32_32x32x16_bf16 v[80:95], v[248:251], v[176:179], v[80:95]
    ds_read_b64_tr_b16 v[244:245], v66 offset:1024
    ds_read_b64_tr_b16 v[246:247], v66 offset:1536
    s_waitcnt lgkmcnt(10)
    v_mfma_f32_32x32x16_bf16 v[96:111], v[224:227], v[176:179], v[96:111]
    ds_read_b64_tr_b16 v[248:249], v67 offset:1024
    ds_read_b64_tr_b16 v[250:251], v67 offset:1536
    s_waitcnt lgkmcnt(10)
    v_mfma_f32_32x32x16_bf16 v[144:159], v[228:231], v[176:179], v[144:159]
    ds_read_b64_tr_b16 v[224:225], v66 offset:17408
    ds_read_b64_tr_b16 v[226:227], v66 offset:17920
    s_waitcnt lgkmcnt(10)
    v_mfma_f32_32x32x16_bf16 v[160:175], v[232:235], v[176:179], v[160:175]
    ds_read_b64_tr_b16 v[228:229], v67 offset:17408
    ds_read_b64_tr_b16 v[230:231], v67 offset:17920
    s_add_u32 s96, s85, 9
    s_and_b32 s97, s96, 15
    s_lshl_b32 s98, s97, 14
    s_add_u32 s16, s98, s15
    buffer_load_dwordx4 v[176:179], v2, s[32:35], s16 offen sc1
    s_waitcnt vmcnt(11)
    s_waitcnt lgkmcnt(10)
    v_mfma_f32_32x32x16_bf16 v[112:127], v[236:239], v[180:183], v[112:127]
    ds_read_b64_tr_b16 v[232:233], v66 offset:12288
    ds_read_b64_tr_b16 v[234:235], v66 offset:12800
    s_waitcnt lgkmcnt(10)
    v_mfma_f32_32x32x16_bf16 v[128:143], v[240:243], v[180:183], v[128:143]
    ds_read_b64_tr_b16 v[236:237], v67 offset:12288
    ds_read_b64_tr_b16 v[238:239], v67 offset:12800
    s_waitcnt lgkmcnt(10)
    v_mfma_f32_32x32x16_bf16 v[80:95], v[244:247], v[180:183], v[80:95]
    ds_read_b64_tr_b16 v[240:241], v66 offset:4096
    ds_read_b64_tr_b16 v[242:243], v66 offset:4608
    s_waitcnt lgkmcnt(10)
    v_mfma_f32_32x32x16_bf16 v[96:111], v[248:251], v[180:183], v[96:111]
    ds_read_b64_tr_b16 v[244:245], v67 offset:4096
    ds_read_b64_tr_b16 v[246:247], v67 offset:4608
    s_waitcnt lgkmcnt(10)
    v_mfma_f32_32x32x16_bf16 v[144:159], v[224:227], v[180:183], v[144:159]
    ds_read_b64_tr_b16 v[248:249], v66 offset:20480
    ds_read_b64_tr_b16 v[250:251], v66 offset:20992
    s_waitcnt lgkmcnt(10)
    v_mfma_f32_32x32x16_bf16 v[160:175], v[228:231], v[180:183], v[160:175]
    ds_read_b64_tr_b16 v[224:225], v67 offset:20480
    ds_read_b64_tr_b16 v[226:227], v67 offset:20992
    buffer_load_dwordx4 v[180:183], v2, s[32:35], s16 offen offset:1024 sc1
    s_waitcnt vmcnt(11)
    s_waitcnt lgkmcnt(10)
    v_mfma_f32_32x32x16_bf16 v[112:127], v[232:235], v[184:187], v[112:127]
    ds_read_b64_tr_b16 v[228:229], v66 offset:13312
    ds_read_b64_tr_b16 v[230:231], v66 offset:13824
    s_waitcnt lgkmcnt(10)
    v_mfma_f32_32x32x16_bf16 v[128:143], v[236:239], v[184:187], v[128:143]
    ds_read_b64_tr_b16 v[232:233], v67 offset:13312
    ds_read_b64_tr_b16 v[234:235], v67 offset:13824
    s_waitcnt lgkmcnt(10)
    v_mfma_f32_32x32x16_bf16 v[80:95], v[240:243], v[184:187], v[80:95]
    ds_read_b64_tr_b16 v[236:237], v66 offset:5120
    ds_read_b64_tr_b16 v[238:239], v66 offset:5632
    s_waitcnt lgkmcnt(10)
    v_mfma_f32_32x32x16_bf16 v[96:111], v[244:247], v[184:187], v[96:111]
    ds_read_b64_tr_b16 v[240:241], v67 offset:5120
    ds_read_b64_tr_b16 v[242:243], v67 offset:5632
    s_waitcnt lgkmcnt(10)
    v_mfma_f32_32x32x16_bf16 v[144:159], v[248:251], v[184:187], v[144:159]
    ds_read_b64_tr_b16 v[244:245], v66 offset:21504
    ds_read_b64_tr_b16 v[246:247], v66 offset:22016
    s_waitcnt lgkmcnt(10)
    v_mfma_f32_32x32x16_bf16 v[160:175], v[224:227], v[184:187], v[160:175]
    ds_read_b64_tr_b16 v[248:249], v67 offset:21504
    ds_read_b64_tr_b16 v[250:251], v67 offset:22016
    buffer_load_dwordx4 v[184:187], v2, s[32:35], s16 offen offset:2048 sc1
    s_waitcnt vmcnt(11)
    s_waitcnt lgkmcnt(10)
    v_mfma_f32_32x32x16_bf16 v[112:127], v[228:231], v[188:191], v[112:127]
    s_barrier
    ds_read_b64_tr_b16 v[224:225], v66 offset:32768
    ds_read_b64_tr_b16 v[226:227], v66 offset:33280
    s_waitcnt lgkmcnt(10)
    v_mfma_f32_32x32x16_bf16 v[128:143], v[232:235], v[188:191], v[128:143]
    ds_read_b64_tr_b16 v[228:229], v67 offset:32768
    ds_read_b64_tr_b16 v[230:231], v67 offset:33280
    s_waitcnt lgkmcnt(10)
    v_mfma_f32_32x32x16_bf16 v[80:95], v[236:239], v[188:191], v[80:95]
    ds_read_b64_tr_b16 v[232:233], v66 offset:24576
    ds_read_b64_tr_b16 v[234:235], v66 offset:25088
    s_waitcnt lgkmcnt(10)
    v_mfma_f32_32x32x16_bf16 v[96:111], v[240:243], v[188:191], v[96:111]
    ds_read_b64_tr_b16 v[236:237], v67 offset:24576
    ds_read_b64_tr_b16 v[238:239], v67 offset:25088
    s_waitcnt lgkmcnt(10)
    v_mfma_f32_32x32x16_bf16 v[144:159], v[244:247], v[188:191], v[144:159]
    ds_read_b64_tr_b16 v[240:241], v66 offset:40960
    ds_read_b64_tr_b16 v[242:243], v66 offset:41472
    s_waitcnt lgkmcnt(10)
    v_mfma_f32_32x32x16_bf16 v[160:175], v[248:251], v[188:191], v[160:175]
    ds_read_b64_tr_b16 v[244:245], v67 offset:40960
    ds_read_b64_tr_b16 v[246:247], v67 offset:41472
    buffer_load_dwordx4 v[188:191], v2, s[32:35], s16 offen offset:3072 sc1
    s_waitcnt vmcnt(11)
    s_waitcnt lgkmcnt(10)
    v_mfma_f32_32x32x16_bf16 v[112:127], v[224:227], v[192:195], v[112:127]
    ds_read_b64_tr_b16 v[248:249], v66 offset:33792
    ds_read_b64_tr_b16 v[250:251], v66 offset:34304
    s_waitcnt lgkmcnt(10)
    v_mfma_f32_32x32x16_bf16 v[128:143], v[228:231], v[192:195], v[128:143]
    ds_read_b64_tr_b16 v[224:225], v67 offset:33792
    ds_read_b64_tr_b16 v[226:227], v67 offset:34304
    s_waitcnt lgkmcnt(10)
    v_mfma_f32_32x32x16_bf16 v[80:95], v[232:235], v[192:195], v[80:95]
    ds_read_b64_tr_b16 v[228:229], v66 offset:25600
    ds_read_b64_tr_b16 v[230:231], v66 offset:26112
    s_waitcnt lgkmcnt(10)
    v_mfma_f32_32x32x16_bf16 v[96:111], v[236:239], v[192:195], v[96:111]
    ds_read_b64_tr_b16 v[232:233], v67 offset:25600
    ds_read_b64_tr_b16 v[234:235], v67 offset:26112
    s_waitcnt lgkmcnt(10)
    v_mfma_f32_32x32x16_bf16 v[144:159], v[240:243], v[192:195], v[144:159]
    ds_read_b64_tr_b16 v[236:237], v66 offset:41984
    ds_read_b64_tr_b16 v[238:239], v66 offset:42496
    s_waitcnt lgkmcnt(10)
    v_mfma_f32_32x32x16_bf16 v[160:175], v[244:247], v[192:195], v[160:175]
    ds_read_b64_tr_b16 v[240:241], v67 offset:41984
    ds_read_b64_tr_b16 v[242:243], v67 offset:42496
    s_add_u32 s96, s85, 10
    s_and_b32 s97, s96, 15
    s_lshl_b32 s98, s97, 14
    s_add_u32 s16, s98, s15
    buffer_load_dwordx4 v[192:195], v2, s[32:35], s16 offen sc1
    s_waitcnt vmcnt(11)
    s_waitcnt lgkmcnt(10)
    v_mfma_f32_32x32x16_bf16 v[112:127], v[248:251], v[196:199], v[112:127]
    ds_read_b64_tr_b16 v[244:245], v66 offset:36864
    ds_read_b64_tr_b16 v[246:247], v66 offset:37376
    s_waitcnt lgkmcnt(10)
    v_mfma_f32_32x32x16_bf16 v[128:143], v[224:227], v[196:199], v[128:143]
    ds_read_b64_tr_b16 v[248:249], v67 offset:36864
    ds_read_b64_tr_b16 v[250:251], v67 offset:37376
    s_waitcnt lgkmcnt(10)
    v_mfma_f32_32x32x16_bf16 v[80:95], v[228:231], v[196:199], v[80:95]
    ds_read_b64_tr_b16 v[224:225], v66 offset:28672
    ds_read_b64_tr_b16 v[226:227], v66 offset:29184
    s_waitcnt lgkmcnt(10)
    v_mfma_f32_32x32x16_bf16 v[96:111], v[232:235], v[196:199], v[96:111]
    ds_read_b64_tr_b16 v[228:229], v67 offset:28672
    ds_read_b64_tr_b16 v[230:231], v67 offset:29184
    s_waitcnt lgkmcnt(10)
    v_mfma_f32_32x32x16_bf16 v[144:159], v[236:239], v[196:199], v[144:159]
    ds_read_b64_tr_b16 v[232:233], v66 offset:45056
    ds_read_b64_tr_b16 v[234:235], v66 offset:45568
    s_waitcnt lgkmcnt(10)
    v_mfma_f32_32x32x16_bf16 v[160:175], v[240:243], v[196:199], v[160:175]
    ds_read_b64_tr_b16 v[236:237], v67 offset:45056
    ds_read_b64_tr_b16 v[238:239], v67 offset:45568
    buffer_load_dwordx4 v[196:199], v2, s[32:35], s16 offen offset:1024 sc1
    s_waitcnt vmcnt(11)
    s_waitcnt lgkmcnt(10)
    v_mfma_f32_32x32x16_bf16 v[112:127], v[244:247], v[200:203], v[112:127]
    ds_read_b64_tr_b16 v[240:241], v66 offset:37888
    ds_read_b64_tr_b16 v[242:243], v66 offset:38400
    s_waitcnt lgkmcnt(10)
    v_mfma_f32_32x32x16_bf16 v[128:143], v[248:251], v[200:203], v[128:143]
    ds_read_b64_tr_b16 v[244:245], v67 offset:37888
    ds_read_b64_tr_b16 v[246:247], v67 offset:38400
    s_waitcnt lgkmcnt(10)
    v_mfma_f32_32x32x16_bf16 v[80:95], v[224:227], v[200:203], v[80:95]
    ds_read_b64_tr_b16 v[248:249], v66 offset:29696
    ds_read_b64_tr_b16 v[250:251], v66 offset:30208
    s_waitcnt lgkmcnt(10)
    v_mfma_f32_32x32x16_bf16 v[96:111], v[228:231], v[200:203], v[96:111]
    ds_read_b64_tr_b16 v[224:225], v67 offset:29696
    ds_read_b64_tr_b16 v[226:227], v67 offset:30208
    s_waitcnt lgkmcnt(10)
    v_mfma_f32_32x32x16_bf16 v[144:159], v[232:235], v[200:203], v[144:159]
    ds_read_b64_tr_b16 v[228:229], v66 offset:46080
    ds_read_b64_tr_b16 v[230:231], v66 offset:46592
    s_waitcnt lgkmcnt(10)
    v_mfma_f32_32x32x16_bf16 v[160:175], v[236:239], v[200:203], v[160:175]
    ds_read_b64_tr_b16 v[232:233], v67 offset:46080
    ds_read_b64_tr_b16 v[234:235], v67 offset:46592
    buffer_load_dwordx4 v[200:203], v2, s[32:35], s16 offen offset:2048 sc1
    s_waitcnt vmcnt(11)
    s_waitcnt lgkmcnt(10)
    v_mfma_f32_32x32x16_bf16 v[112:127], v[240:243], v[204:207], v[112:127]
    s_barrier
    ds_read_b64_tr_b16 v[236:237], v68 offset:8192
    ds_read_b64_tr_b16 v[238:239], v68 offset:8704
    s_waitcnt lgkmcnt(10)
    v_mfma_f32_32x32x16_bf16 v[128:143], v[244:247], v[204:207], v[128:143]
    ds_read_b64_tr_b16 v[240:241], v69 offset:8192
    ds_read_b64_tr_b16 v[242:243], v69 offset:8704
    s_waitcnt lgkmcnt(10)
    v_mfma_f32_32x32x16_bf16 v[80:95], v[248:251], v[204:207], v[80:95]
    ds_read_b64_tr_b16 v[244:245], v68
    ds_read_b64_tr_b16 v[246:247], v68 offset:512
    s_waitcnt lgkmcnt(10)
    v_mfma_f32_32x32x16_bf16 v[96:111], v[224:227], v[204:207], v[96:111]
    ds_read_b64_tr_b16 v[248:249], v69
    ds_read_b64_tr_b16 v[250:251], v69 offset:512
    s_waitcnt lgkmcnt(10)
    v_mfma_f32_32x32x16_bf16 v[144:159], v[228:231], v[204:207], v[144:159]
    ds_read_b64_tr_b16 v[224:225], v68 offset:16384
    ds_read_b64_tr_b16 v[226:227], v68 offset:16896
    s_waitcnt lgkmcnt(10)
    v_mfma_f32_32x32x16_bf16 v[160:175], v[232:235], v[204:207], v[160:175]
    ds_read_b64_tr_b16 v[228:229], v69 offset:16384
    ds_read_b64_tr_b16 v[230:231], v69 offset:16896
    buffer_load_dwordx4 v[204:207], v2, s[32:35], s16 offen offset:3072 sc1
    s_waitcnt vmcnt(11)
    s_waitcnt lgkmcnt(10)
    v_mfma_f32_32x32x16_bf16 v[112:127], v[236:239], v[208:211], v[112:127]
    ds_read_b64_tr_b16 v[232:233], v68 offset:9216
    ds_read_b64_tr_b16 v[234:235], v68 offset:9728
    s_waitcnt lgkmcnt(10)
    v_mfma_f32_32x32x16_bf16 v[128:143], v[240:243], v[208:211], v[128:143]
    ds_read_b64_tr_b16 v[236:237], v69 offset:9216
    ds_read_b64_tr_b16 v[238:239], v69 offset:9728
    s_waitcnt lgkmcnt(10)
    v_mfma_f32_32x32x16_bf16 v[80:95], v[244:247], v[208:211], v[80:95]
    ds_read_b64_tr_b16 v[240:241], v68 offset:1024
    ds_read_b64_tr_b16 v[242:243], v68 offset:1536
    s_waitcnt lgkmcnt(10)
    v_mfma_f32_32x32x16_bf16 v[96:111], v[248:251], v[208:211], v[96:111]
    ds_read_b64_tr_b16 v[244:245], v69 offset:1024
    ds_read_b64_tr_b16 v[246:247], v69 offset:1536
    s_waitcnt lgkmcnt(10)
    v_mfma_f32_32x32x16_bf16 v[144:159], v[224:227], v[208:211], v[144:159]
    ds_read_b64_tr_b16 v[248:249], v68 offset:17408
    ds_read_b64_tr_b16 v[250:251], v68 offset:17920
    s_waitcnt lgkmcnt(10)
    v_mfma_f32_32x32x16_bf16 v[160:175], v[228:231], v[208:211], v[160:175]
    ds_read_b64_tr_b16 v[224:225], v69 offset:17408
    ds_read_b64_tr_b16 v[226:227], v69 offset:17920
    s_add_u32 s96, s85, 11
    s_and_b32 s97, s96, 15
    s_lshl_b32 s98, s97, 14
    s_add_u32 s16, s98, s15
    buffer_load_dwordx4 v[208:211], v2, s[32:35], s16 offen sc1
    s_waitcnt vmcnt(11)
    s_waitcnt lgkmcnt(10)
    v_mfma_f32_32x32x16_bf16 v[112:127], v[232:235], v[212:215], v[112:127]
    ds_read_b64_tr_b16 v[228:229], v68 offset:12288
    ds_read_b64_tr_b16 v[230:231], v68 offset:12800
    s_waitcnt lgkmcnt(10)
    v_mfma_f32_32x32x16_bf16 v[128:143], v[236:239], v[212:215], v[128:143]
    ds_read_b64_tr_b16 v[232:233], v69 offset:12288
    ds_read_b64_tr_b16 v[234:235], v69 offset:12800
    s_waitcnt lgkmcnt(10)
    v_mfma_f32_32x32x16_bf16 v[80:95], v[240:243], v[212:215], v[80:95]
    ds_read_b64_tr_b16 v[236:237], v68 offset:4096
    ds_read_b64_tr_b16 v[238:239], v68 offset:4608
    s_waitcnt lgkmcnt(10)
    v_mfma_f32_32x32x16_bf16 v[96:111], v[244:247], v[212:215], v[96:111]
    ds_read_b64_tr_b16 v[240:241], v69 offset:4096
    ds_read_b64_tr_b16 v[242:243], v69 offset:4608
    s_waitcnt lgkmcnt(10)
    v_mfma_f32_32x32x16_bf16 v[144:159], v[248:251], v[212:215], v[144:159]
    ds_read_b64_tr_b16 v[244:245], v68 offset:20480
    ds_read_b64_tr_b16 v[246:247], v68 offset:20992
    s_waitcnt lgkmcnt(10)
    v_mfma_f32_32x32x16_bf16 v[160:175], v[224:227], v[212:215], v[160:175]
    ds_read_b64_tr_b16 v[248:249], v69 offset:20480
    ds_read_b64_tr_b16 v[250:251], v69 offset:20992
    buffer_load_dwordx4 v[212:215], v2, s[32:35], s16 offen offset:1024 sc1
    s_waitcnt vmcnt(11)
    s_waitcnt lgkmcnt(10)
    v_mfma_f32_32x32x16_bf16 v[112:127], v[228:231], v[216:219], v[112:127]
    ds_read_b64_tr_b16 v[224:225], v68 offset:13312
    ds_read_b64_tr_b16 v[226:227], v68 offset:13824
    s_waitcnt lgkmcnt(10)
    v_mfma_f32_32x32x16_bf16 v[128:143], v[232:235], v[216:219], v[128:143]
    ds_read_b64_tr_b16 v[228:229], v69 offset:13312
    ds_read_b64_tr_b16 v[230:231], v69 offset:13824
    s_waitcnt lgkmcnt(10)
    v_mfma_f32_32x32x16_bf16 v[80:95], v[236:239], v[216:219], v[80:95]
    ds_read_b64_tr_b16 v[232:233], v68 offset:5120
    ds_read_b64_tr_b16 v[234:235], v68 offset:5632
    s_waitcnt lgkmcnt(10)
    v_mfma_f32_32x32x16_bf16 v[96:111], v[240:243], v[216:219], v[96:111]
    ds_read_b64_tr_b16 v[236:237], v69 offset:5120
    ds_read_b64_tr_b16 v[238:239], v69 offset:5632
    s_waitcnt lgkmcnt(10)
    v_mfma_f32_32x32x16_bf16 v[144:159], v[244:247], v[216:219], v[144:159]
    ds_read_b64_tr_b16 v[240:241], v68 offset:21504
    ds_read_b64_tr_b16 v[242:243], v68 offset:22016
    s_waitcnt lgkmcnt(10)
    v_mfma_f32_32x32x16_bf16 v[160:175], v[248:251], v[216:219], v[160:175]
    ds_read_b64_tr_b16 v[244:245], v69 offset:21504
    ds_read_b64_tr_b16 v[246:247], v69 offset:22016
    buffer_load_dwordx4 v[216:219], v2, s[32:35], s16 offen offset:2048 sc1
    s_waitcnt vmcnt(11)
    s_waitcnt lgkmcnt(10)
    v_mfma_f32_32x32x16_bf16 v[112:127], v[224:227], v[220:223], v[112:127]
    s_barrier
    ds_read_b64_tr_b16 v[248:249], v68 offset:32768
    ds_read_b64_tr_b16 v[250:251], v68 offset:33280
    s_waitcnt lgkmcnt(10)
    v_mfma_f32_32x32x16_bf16 v[128:143], v[228:231], v[220:223], v[128:143]
    ds_read_b64_tr_b16 v[224:225], v69 offset:32768
    ds_read_b64_tr_b16 v[226:227], v69 offset:33280
    s_waitcnt lgkmcnt(10)
    v_mfma_f32_32x32x16_bf16 v[80:95], v[232:235], v[220:223], v[80:95]
    ds_read_b64_tr_b16 v[228:229], v68 offset:24576
    ds_read_b64_tr_b16 v[230:231], v68 offset:25088
    s_waitcnt lgkmcnt(10)
    v_mfma_f32_32x32x16_bf16 v[96:111], v[236:239], v[220:223], v[96:111]
    ds_read_b64_tr_b16 v[232:233], v69 offset:24576
    ds_read_b64_tr_b16 v[234:235], v69 offset:25088
    s_waitcnt lgkmcnt(10)
    v_mfma_f32_32x32x16_bf16 v[144:159], v[240:243], v[220:223], v[144:159]
    ds_read_b64_tr_b16 v[236:237], v68 offset:40960
    ds_read_b64_tr_b16 v[238:239], v68 offset:41472
    s_waitcnt lgkmcnt(10)
    v_mfma_f32_32x32x16_bf16 v[160:175], v[244:247], v[220:223], v[160:175]
    ds_read_b64_tr_b16 v[240:241], v69 offset:40960
    ds_read_b64_tr_b16 v[242:243], v69 offset:41472
    buffer_load_dwordx4 v[220:223], v2, s[32:35], s16 offen offset:3072 sc1
    s_waitcnt vmcnt(11)
    s_waitcnt lgkmcnt(10)
    v_mfma_f32_32x32x16_bf16 v[112:127], v[248:251], v[176:179], v[112:127]
    ds_read_b64_tr_b16 v[244:245], v68 offset:33792
    ds_read_b64_tr_b16 v[246:247], v68 offset:34304
    s_waitcnt lgkmcnt(10)
    v_mfma_f32_32x32x16_bf16 v[128:143], v[224:227], v[176:179], v[128:143]
    ds_read_b64_tr_b16 v[248:249], v69 offset:33792
    ds_read_b64_tr_b16 v[250:251], v69 offset:34304
    s_waitcnt lgkmcnt(10)
    v_mfma_f32_32x32x16_bf16 v[80:95], v[228:231], v[176:179], v[80:95]
    ds_read_b64_tr_b16 v[224:225], v68 offset:25600
    ds_read_b64_tr_b16 v[226:227], v68 offset:26112
    s_waitcnt lgkmcnt(10)
    v_mfma_f32_32x32x16_bf16 v[96:111], v[232:235], v[176:179], v[96:111]
    ds_read_b64_tr_b16 v[228:229], v69 offset:25600
    ds_read_b64_tr_b16 v[230:231], v69 offset:26112
    s_waitcnt lgkmcnt(10)
    v_mfma_f32_32x32x16_bf16 v[144:159], v[236:239], v[176:179], v[144:159]
    ds_read_b64_tr_b16 v[232:233], v68 offset:41984
    ds_read_b64_tr_b16 v[234:235], v68 offset:42496
    s_waitcnt lgkmcnt(10)
    v_mfma_f32_32x32x16_bf16 v[160:175], v[240:243], v[176:179], v[160:175]
    ds_read_b64_tr_b16 v[236:237], v69 offset:41984
    ds_read_b64_tr_b16 v[238:239], v69 offset:42496
    s_add_u32 s96, s85, 12
    s_and_b32 s97, s96, 15
    s_lshl_b32 s98, s97, 14
    s_add_u32 s16, s98, s15
    buffer_load_dwordx4 v[176:179], v2, s[32:35], s16 offen sc1
    s_waitcnt vmcnt(11)
    s_waitcnt lgkmcnt(10)
    v_mfma_f32_32x32x16_bf16 v[112:127], v[244:247], v[180:183], v[112:127]
    ds_read_b64_tr_b16 v[240:241], v68 offset:36864
    ds_read_b64_tr_b16 v[242:243], v68 offset:37376
    s_waitcnt lgkmcnt(10)
    v_mfma_f32_32x32x16_bf16 v[128:143], v[248:251], v[180:183], v[128:143]
    ds_read_b64_tr_b16 v[244:245], v69 offset:36864
    ds_read_b64_tr_b16 v[246:247], v69 offset:37376
    s_waitcnt lgkmcnt(10)
    v_mfma_f32_32x32x16_bf16 v[80:95], v[224:227], v[180:183], v[80:95]
    ds_read_b64_tr_b16 v[248:249], v68 offset:28672
    ds_read_b64_tr_b16 v[250:251], v68 offset:29184
    s_waitcnt lgkmcnt(10)
    v_mfma_f32_32x32x16_bf16 v[96:111], v[228:231], v[180:183], v[96:111]
    ds_read_b64_tr_b16 v[224:225], v69 offset:28672
    ds_read_b64_tr_b16 v[226:227], v69 offset:29184
    s_waitcnt lgkmcnt(10)
    v_mfma_f32_32x32x16_bf16 v[144:159], v[232:235], v[180:183], v[144:159]
    ds_read_b64_tr_b16 v[228:229], v68 offset:45056
    ds_read_b64_tr_b16 v[230:231], v68 offset:45568
    s_waitcnt lgkmcnt(10)
    v_mfma_f32_32x32x16_bf16 v[160:175], v[236:239], v[180:183], v[160:175]
    ds_read_b64_tr_b16 v[232:233], v69 offset:45056
    ds_read_b64_tr_b16 v[234:235], v69 offset:45568
    buffer_load_dwordx4 v[180:183], v2, s[32:35], s16 offen offset:1024 sc1
    s_waitcnt vmcnt(11)
    s_waitcnt lgkmcnt(10)
    v_mfma_f32_32x32x16_bf16 v[112:127], v[240:243], v[184:187], v[112:127]
    ds_read_b64_tr_b16 v[236:237], v68 offset:37888
    ds_read_b64_tr_b16 v[238:239], v68 offset:38400
    s_waitcnt lgkmcnt(10)
    v_mfma_f32_32x32x16_bf16 v[128:143], v[244:247], v[184:187], v[128:143]
    ds_read_b64_tr_b16 v[240:241], v69 offset:37888
    ds_read_b64_tr_b16 v[242:243], v69 offset:38400
    s_waitcnt lgkmcnt(10)
    v_mfma_f32_32x32x16_bf16 v[80:95], v[248:251], v[184:187], v[80:95]
    ds_read_b64_tr_b16 v[244:245], v68 offset:29696
    ds_read_b64_tr_b16 v[246:247], v68 offset:30208
    s_waitcnt lgkmcnt(10)
    v_mfma_f32_32x32x16_bf16 v[96:111], v[224:227], v[184:187], v[96:111]
    ds_read_b64_tr_b16 v[248:249], v69 offset:29696
    ds_read_b64_tr_b16 v[250:251], v69 offset:30208
    s_waitcnt lgkmcnt(10)
    v_mfma_f32_32x32x16_bf16 v[144:159], v[228:231], v[184:187], v[144:159]
    ds_read_b64_tr_b16 v[224:225], v68 offset:46080
    ds_read_b64_tr_b16 v[226:227], v68 offset:46592
    s_waitcnt lgkmcnt(10)
    v_mfma_f32_32x32x16_bf16 v[160:175], v[232:235], v[184:187], v[160:175]
    ds_read_b64_tr_b16 v[228:229], v69 offset:46080
    ds_read_b64_tr_b16 v[230:231], v69 offset:46592
    buffer_load_dwordx4 v[184:187], v2, s[32:35], s16 offen offset:2048 sc1
    s_waitcnt vmcnt(11)
    s_waitcnt lgkmcnt(10)
    v_mfma_f32_32x32x16_bf16 v[112:127], v[236:239], v[188:191], v[112:127]
    s_barrier
    ds_read_b64_tr_b16 v[232:233], v70 offset:8192
    ds_read_b64_tr_b16 v[234:235], v70 offset:8704
    s_waitcnt lgkmcnt(10)
    v_mfma_f32_32x32x16_bf16 v[128:143], v[240:243], v[188:191], v[128:143]
    ds_read_b64_tr_b16 v[236:237], v71 offset:8192
    ds_read_b64_tr_b16 v[238:239], v71 offset:8704
    s_waitcnt lgkmcnt(10)
    v_mfma_f32_32x32x16_bf16 v[80:95], v[244:247], v[188:191], v[80:95]
    ds_read_b64_tr_b16 v[240:241], v70
    ds_read_b64_tr_b16 v[242:243], v70 offset:512
    s_waitcnt lgkmcnt(10)
    v_mfma_f32_32x32x16_bf16 v[96:111], v[248:251], v[188:191], v[96:111]
    ds_read_b64_tr_b16 v[244:245], v71
    ds_read_b64_tr_b16 v[246:247], v71 offset:512
    s_waitcnt lgkmcnt(10)
    v_mfma_f32_32x32x16_bf16 v[144:159], v[224:227], v[188:191], v[144:159]
    ds_read_b64_tr_b16 v[248:249], v70 offset:16384
    ds_read_b64_tr_b16 v[250:251], v70 offset:16896
    s_waitcnt lgkmcnt(10)
    v_mfma_f32_32x32x16_bf16 v[160:175], v[228:231], v[188:191], v[160:175]
    ds_read_b64_tr_b16 v[224:225], v71 offset:16384
    ds_read_b64_tr_b16 v[226:227], v71 offset:16896
    buffer_load_dwordx4 v[188:191], v2, s[32:35], s16 offen offset:3072 sc1
    s_waitcnt vmcnt(11)
    s_waitcnt lgkmcnt(10)
    v_mfma_f32_32x32x16_bf16 v[112:127], v[232:235], v[192:195], v[112:127]
    ds_read_b64_tr_b16 v[228:229], v70 offset:9216
    ds_read_b64_tr_b16 v[230:231], v70 offset:9728
    s_waitcnt lgkmcnt(10)
    v_mfma_f32_32x32x16_bf16 v[128:143], v[236:239], v[192:195], v[128:143]
    ds_read_b64_tr_b16 v[232:233], v71 offset:9216
    ds_read_b64_tr_b16 v[234:235], v71 offset:9728
    s_waitcnt lgkmcnt(10)
    v_mfma_f32_32x32x16_bf16 v[80:95], v[240:243], v[192:195], v[80:95]
    ds_read_b64_tr_b16 v[236:237], v70 offset:1024
    ds_read_b64_tr_b16 v[238:239], v70 offset:1536
    s_waitcnt lgkmcnt(10)
    v_mfma_f32_32x32x16_bf16 v[96:111], v[244:247], v[192:195], v[96:111]
    ds_read_b64_tr_b16 v[240:241], v71 offset:1024
    ds_read_b64_tr_b16 v[242:243], v71 offset:1536
    s_waitcnt lgkmcnt(10)
    v_mfma_f32_32x32x16_bf16 v[144:159], v[248:251], v[192:195], v[144:159]
    ds_read_b64_tr_b16 v[244:245], v70 offset:17408
    ds_read_b64_tr_b16 v[246:247], v70 offset:17920
    s_waitcnt lgkmcnt(10)
    v_mfma_f32_32x32x16_bf16 v[160:175], v[224:227], v[192:195], v[160:175]
    ds_read_b64_tr_b16 v[248:249], v71 offset:17408
    ds_read_b64_tr_b16 v[250:251], v71 offset:17920
    s_add_u32 s96, s85, 13
    s_and_b32 s97, s96, 15
    s_lshl_b32 s98, s97, 14
    s_add_u32 s16, s98, s15
    buffer_load_dwordx4 v[192:195], v2, s[32:35], s16 offen sc1
    s_waitcnt vmcnt(11)
    s_waitcnt lgkmcnt(10)
    v_mfma_f32_32x32x16_bf16 v[112:127], v[228:231], v[196:199], v[112:127]
    ds_read_b64_tr_b16 v[224:225], v70 offset:12288
    ds_read_b64_tr_b16 v[226:227], v70 offset:12800
    s_waitcnt lgkmcnt(10)
    v_mfma_f32_32x32x16_bf16 v[128:143], v[232:235], v[196:199], v[128:143]
    ds_read_b64_tr_b16 v[228:229], v71 offset:12288
    ds_read_b64_tr_b16 v[230:231], v71 offset:12800
    s_waitcnt lgkmcnt(10)
    v_mfma_f32_32x32x16_bf16 v[80:95], v[236:239], v[196:199], v[80:95]
    ds_read_b64_tr_b16 v[232:233], v70 offset:4096
    ds_read_b64_tr_b16 v[234:235], v70 offset:4608
    s_waitcnt lgkmcnt(10)
    v_mfma_f32_32x32x16_bf16 v[96:111], v[240:243], v[196:199], v[96:111]
    ds_read_b64_tr_b16 v[236:237], v71 offset:4096
    ds_read_b64_tr_b16 v[238:239], v71 offset:4608
    s_waitcnt lgkmcnt(10)
    v_mfma_f32_32x32x16_bf16 v[144:159], v[244:247], v[196:199], v[144:159]
    ds_read_b64_tr_b16 v[240:241], v70 offset:20480
    ds_read_b64_tr_b16 v[242:243], v70 offset:20992
    s_waitcnt lgkmcnt(10)
    v_mfma_f32_32x32x16_bf16 v[160:175], v[248:251], v[196:199], v[160:175]
    ds_read_b64_tr_b16 v[244:245], v71 offset:20480
    ds_read_b64_tr_b16 v[246:247], v71 offset:20992
    buffer_load_dwordx4 v[196:199], v2, s[32:35], s16 offen offset:1024 sc1
    s_waitcnt vmcnt(11)
    s_waitcnt lgkmcnt(10)
    v_mfma_f32_32x32x16_bf16 v[112:127], v[224:227], v[200:203], v[112:127]
    ds_read_b64_tr_b16 v[248:249], v70 offset:13312
    ds_read_b64_tr_b16 v[250:251], v70 offset:13824
    s_waitcnt lgkmcnt(10)
    v_mfma_f32_32x32x16_bf16 v[128:143], v[228:231], v[200:203], v[128:143]
    ds_read_b64_tr_b16 v[224:225], v71 offset:13312
    ds_read_b64_tr_b16 v[226:227], v71 offset:13824
    s_waitcnt lgkmcnt(10)
    v_mfma_f32_32x32x16_bf16 v[80:95], v[232:235], v[200:203], v[80:95]
    ds_read_b64_tr_b16 v[228:229], v70 offset:5120
    ds_read_b64_tr_b16 v[230:231], v70 offset:5632
    s_waitcnt lgkmcnt(10)
    v_mfma_f32_32x32x16_bf16 v[96:111], v[236:239], v[200:203], v[96:111]
    ds_read_b64_tr_b16 v[232:233], v71 offset:5120
    ds_read_b64_tr_b16 v[234:235], v71 offset:5632
    s_waitcnt lgkmcnt(10)
    v_mfma_f32_32x32x16_bf16 v[144:159], v[240:243], v[200:203], v[144:159]
    ds_read_b64_tr_b16 v[236:237], v70 offset:21504
    ds_read_b64_tr_b16 v[238:239], v70 offset:22016
    s_waitcnt lgkmcnt(10)
    v_mfma_f32_32x32x16_bf16 v[160:175], v[244:247], v[200:203], v[160:175]
    ds_read_b64_tr_b16 v[240:241], v71 offset:21504
    ds_read_b64_tr_b16 v[242:243], v71 offset:22016
    buffer_load_dwordx4 v[200:203], v2, s[32:35], s16 offen offset:2048 sc1
    s_waitcnt vmcnt(11)
    s_waitcnt lgkmcnt(10)
    v_mfma_f32_32x32x16_bf16 v[112:127], v[248:251], v[204:207], v[112:127]
    s_barrier
    ds_read_b64_tr_b16 v[244:245], v70 offset:32768
    ds_read_b64_tr_b16 v[246:247], v70 offset:33280
    s_waitcnt lgkmcnt(10)
    v_mfma_f32_32x32x16_bf16 v[128:143], v[224:227], v[204:207], v[128:143]
    ds_read_b64_tr_b16 v[248:249], v71 offset:32768
    ds_read_b64_tr_b16 v[250:251], v71 offset:33280
    s_waitcnt lgkmcnt(10)
    v_mfma_f32_32x32x16_bf16 v[80:95], v[228:231], v[204:207], v[80:95]
    ds_read_b64_tr_b16 v[224:225], v70 offset:24576
    ds_read_b64_tr_b16 v[226:227], v70 offset:25088
    s_waitcnt lgkmcnt(10)
    v_mfma_f32_32x32x16_bf16 v[96:111], v[232:235], v[204:207], v[96:111]
    ds_read_b64_tr_b16 v[228:229], v71 offset:24576
    ds_read_b64_tr_b16 v[230:231], v71 offset:25088
    s_waitcnt lgkmcnt(10)
    v_mfma_f32_32x32x16_bf16 v[144:159], v[236:239], v[204:207], v[144:159]
    ds_read_b64_tr_b16 v[232:233], v70 offset:40960
    ds_read_b64_tr_b16 v[234:235], v70 offset:41472
    s_waitcnt lgkmcnt(10)
    v_mfma_f32_32x32x16_bf16 v[160:175], v[240:243], v[204:207], v[160:175]
    ds_read_b64_tr_b16 v[236:237], v71 offset:40960
    ds_read_b64_tr_b16 v[238:239], v71 offset:41472
    buffer_load_dwordx4 v[204:207], v2, s[32:35], s16 offen offset:3072 sc1
    s_waitcnt vmcnt(11)
    s_waitcnt lgkmcnt(10)
    v_mfma_f32_32x32x16_bf16 v[112:127], v[244:247], v[208:211], v[112:127]
    ds_read_b64_tr_b16 v[240:241], v70 offset:33792
    ds_read_b64_tr_b16 v[242:243], v70 offset:34304
    s_waitcnt lgkmcnt(10)
    v_mfma_f32_32x32x16_bf16 v[128:143], v[248:251], v[208:211], v[128:143]
    ds_read_b64_tr_b16 v[244:245], v71 offset:33792
    ds_read_b64_tr_b16 v[246:247], v71 offset:34304
    s_waitcnt lgkmcnt(10)
    v_mfma_f32_32x32x16_bf16 v[80:95], v[224:227], v[208:211], v[80:95]
    ds_read_b64_tr_b16 v[248:249], v70 offset:25600
    ds_read_b64_tr_b16 v[250:251], v70 offset:26112
    s_waitcnt lgkmcnt(10)
    v_mfma_f32_32x32x16_bf16 v[96:111], v[228:231], v[208:211], v[96:111]
    ds_read_b64_tr_b16 v[224:225], v71 offset:25600
    ds_read_b64_tr_b16 v[226:227], v71 offset:26112
    s_waitcnt lgkmcnt(10)
    v_mfma_f32_32x32x16_bf16 v[144:159], v[232:235], v[208:211], v[144:159]
    ds_read_b64_tr_b16 v[228:229], v70 offset:41984
    ds_read_b64_tr_b16 v[230:231], v70 offset:42496
    s_waitcnt lgkmcnt(10)
    v_mfma_f32_32x32x16_bf16 v[160:175], v[236:239], v[208:211], v[160:175]
    ds_read_b64_tr_b16 v[232:233], v71 offset:41984
    ds_read_b64_tr_b16 v[234:235], v71 offset:42496
    s_add_u32 s96, s85, 14
    s_and_b32 s97, s96, 15
    s_lshl_b32 s98, s97, 14
    s_add_u32 s16, s98, s15
    buffer_load_dwordx4 v[208:211], v2, s[32:35], s16 offen sc1
    s_waitcnt vmcnt(11)
    s_waitcnt lgkmcnt(10)
    v_mfma_f32_32x32x16_bf16 v[112:127], v[240:243], v[212:215], v[112:127]
    ds_read_b64_tr_b16 v[236:237], v70 offset:36864
    ds_read_b64_tr_b16 v[238:239], v70 offset:37376
    s_waitcnt lgkmcnt(10)
    v_mfma_f32_32x32x16_bf16 v[128:143], v[244:247], v[212:215], v[128:143]
    ds_read_b64_tr_b16 v[240:241], v71 offset:36864
    ds_read_b64_tr_b16 v[242:243], v71 offset:37376
    s_waitcnt lgkmcnt(10)
    v_mfma_f32_32x32x16_bf16 v[80:95], v[248:251], v[212:215], v[80:95]
    ds_read_b64_tr_b16 v[244:245], v70 offset:28672
    ds_read_b64_tr_b16 v[246:247], v70 offset:29184
    s_waitcnt lgkmcnt(10)
    v_mfma_f32_32x32x16_bf16 v[96:111], v[224:227], v[212:215], v[96:111]
    ds_read_b64_tr_b16 v[248:249], v71 offset:28672
    ds_read_b64_tr_b16 v[250:251], v71 offset:29184
    s_waitcnt lgkmcnt(10)
    v_mfma_f32_32x32x16_bf16 v[144:159], v[228:231], v[212:215], v[144:159]
    ds_read_b64_tr_b16 v[224:225], v70 offset:45056
    ds_read_b64_tr_b16 v[226:227], v70 offset:45568
    s_waitcnt lgkmcnt(10)
    v_mfma_f32_32x32x16_bf16 v[160:175], v[232:235], v[212:215], v[160:175]
    ds_read_b64_tr_b16 v[228:229], v71 offset:45056
    ds_read_b64_tr_b16 v[230:231], v71 offset:45568
    buffer_load_dwordx4 v[212:215], v2, s[32:35], s16 offen offset:1024 sc1
    s_waitcnt vmcnt(11)
    s_waitcnt lgkmcnt(10)
    v_mfma_f32_32x32x16_bf16 v[112:127], v[236:239], v[216:219], v[112:127]
    ds_read_b64_tr_b16 v[232:233], v70 offset:37888
    ds_read_b64_tr_b16 v[234:235], v70 offset:38400
    s_waitcnt lgkmcnt(10)
    v_mfma_f32_32x32x16_bf16 v[128:143], v[240:243], v[216:219], v[128:143]
    ds_read_b64_tr_b16 v[236:237], v71 offset:37888
    ds_read_b64_tr_b16 v[238:239], v71 offset:38400
    s_waitcnt lgkmcnt(10)
    v_mfma_f32_32x32x16_bf16 v[80:95], v[244:247], v[216:219], v[80:95]
    ds_read_b64_tr_b16 v[240:241], v70 offset:29696
    ds_read_b64_tr_b16 v[242:243], v70 offset:30208
    s_waitcnt lgkmcnt(10)
    v_mfma_f32_32x32x16_bf16 v[96:111], v[248:251], v[216:219], v[96:111]
    ds_read_b64_tr_b16 v[244:245], v71 offset:29696
    ds_read_b64_tr_b16 v[246:247], v71 offset:30208
    s_waitcnt lgkmcnt(10)
    v_mfma_f32_32x32x16_bf16 v[144:159], v[224:227], v[216:219], v[144:159]
    ds_read_b64_tr_b16 v[248:249], v70 offset:46080
    ds_read_b64_tr_b16 v[250:251], v70 offset:46592
    s_waitcnt lgkmcnt(10)
    v_mfma_f32_32x32x16_bf16 v[160:175], v[228:231], v[216:219], v[160:175]
    ds_read_b64_tr_b16 v[224:225], v71 offset:46080
    ds_read_b64_tr_b16 v[226:227], v71 offset:46592
    buffer_load_dwordx4 v[216:219], v2, s[32:35], s16 offen offset:2048 sc1
    s_waitcnt vmcnt(11)
    s_waitcnt lgkmcnt(10)
    v_mfma_f32_32x32x16_bf16 v[112:127], v[232:235], v[220:223], v[112:127]
    s_barrier
    ds_read_b64_tr_b16 v[228:229], v66 offset:8192
    ds_read_b64_tr_b16 v[230:231], v66 offset:8704
    s_waitcnt lgkmcnt(10)
    v_mfma_f32_32x32x16_bf16 v[128:143], v[236:239], v[220:223], v[128:143]
    ds_read_b64_tr_b16 v[232:233], v67 offset:8192
    ds_read_b64_tr_b16 v[234:235], v67 offset:8704
    s_waitcnt lgkmcnt(10)
    v_mfma_f32_32x32x16_bf16 v[80:95], v[240:243], v[220:223], v[80:95]
    ds_read_b64_tr_b16 v[236:237], v66
    ds_read_b64_tr_b16 v[238:239], v66 offset:512
    s_waitcnt lgkmcnt(10)
    v_mfma_f32_32x32x16_bf16 v[96:111], v[244:247], v[220:223], v[96:111]
    ds_read_b64_tr_b16 v[240:241], v67
    ds_read_b64_tr_b16 v[242:243], v67 offset:512
    s_waitcnt lgkmcnt(10)
    v_mfma_f32_32x32x16_bf16 v[144:159], v[248:251], v[220:223], v[144:159]
    ds_read_b64_tr_b16 v[244:245], v66 offset:16384
    ds_read_b64_tr_b16 v[246:247], v66 offset:16896
    s_waitcnt lgkmcnt(10)
    v_mfma_f32_32x32x16_bf16 v[160:175], v[224:227], v[220:223], v[160:175]
    ds_read_b64_tr_b16 v[248:249], v67 offset:16384
    ds_read_b64_tr_b16 v[250:251], v67 offset:16896
    buffer_load_dwordx4 v[220:223], v2, s[32:35], s16 offen offset:3072 sc1
    s_waitcnt vmcnt(11)
    s_waitcnt lgkmcnt(10)
    v_mfma_f32_32x32x16_bf16 v[112:127], v[228:231], v[176:179], v[112:127]
    ds_read_b64_tr_b16 v[224:225], v66 offset:9216
    ds_read_b64_tr_b16 v[226:227], v66 offset:9728
    s_waitcnt lgkmcnt(10)
    v_mfma_f32_32x32x16_bf16 v[128:143], v[232:235], v[176:179], v[128:143]
    ds_read_b64_tr_b16 v[228:229], v67 offset:9216
    ds_read_b64_tr_b16 v[230:231], v67 offset:9728
    s_waitcnt lgkmcnt(10)
    v_mfma_f32_32x32x16_bf16 v[80:95], v[236:239], v[176:179], v[80:95]
    ds_read_b64_tr_b16 v[232:233], v66 offset:1024
    ds_read_b64_tr_b16 v[234:235], v66 offset:1536
    s_waitcnt lgkmcnt(10)
    v_mfma_f32_32x32x16_bf16 v[96:111], v[240:243], v[176:179], v[96:111]
    ds_read_b64_tr_b16 v[236:237], v67 offset:1024
    ds_read_b64_tr_b16 v[238:239], v67 offset:1536
    s_waitcnt lgkmcnt(10)
    v_mfma_f32_32x32x16_bf16 v[144:159], v[244:247], v[176:179], v[144:159]
    ds_read_b64_tr_b16 v[240:241], v66 offset:17408
    ds_read_b64_tr_b16 v[242:243], v66 offset:17920
    s_waitcnt lgkmcnt(10)
    v_mfma_f32_32x32x16_bf16 v[160:175], v[248:251], v[176:179], v[160:175]
    ds_read_b64_tr_b16 v[244:245], v67 offset:17408
    ds_read_b64_tr_b16 v[246:247], v67 offset:17920
    s_add_u32 s96, s85, 15
    s_and_b32 s97, s96, 15
    s_lshl_b32 s98, s97, 14
    s_add_u32 s16, s98, s15
    buffer_load_dwordx4 v[176:179], v2, s[32:35], s16 offen sc1
    s_waitcnt vmcnt(11)
    s_waitcnt lgkmcnt(10)
    v_mfma_f32_32x32x16_bf16 v[112:127], v[224:227], v[180:183], v[112:127]
    ds_read_b64_tr_b16 v[248:249], v66 offset:12288
    ds_read_b64_tr_b16 v[250:251], v66 offset:12800
    s_waitcnt lgkmcnt(10)
    v_mfma_f32_32x32x16_bf16 v[128:143], v[228:231], v[180:183], v[128:143]
    ds_read_b64_tr_b16 v[224:225], v67 offset:12288
    ds_read_b64_tr_b16 v[226:227], v67 offset:12800
    s_waitcnt lgkmcnt(10)
    v_mfma_f32_32x32x16_bf16 v[80:95], v[232:235], v[180:183], v[80:95]
    ds_read_b64_tr_b16 v[228:229], v66 offset:4096
    ds_read_b64_tr_b16 v[230:231], v66 offset:4608
    s_waitcnt lgkmcnt(10)
    v_mfma_f32_32x32x16_bf16 v[96:111], v[236:239], v[180:183], v[96:111]
    ds_read_b64_tr_b16 v[232:233], v67 offset:4096
    ds_read_b64_tr_b16 v[234:235], v67 offset:4608
    s_waitcnt lgkmcnt(10)
    v_mfma_f32_32x32x16_bf16 v[144:159], v[240:243], v[180:183], v[144:159]
    ds_read_b64_tr_b16 v[236:237], v66 offset:20480
    ds_read_b64_tr_b16 v[238:239], v66 offset:20992
    s_waitcnt lgkmcnt(10)
    v_mfma_f32_32x32x16_bf16 v[160:175], v[244:247], v[180:183], v[160:175]
    ds_read_b64_tr_b16 v[240:241], v67 offset:20480
    ds_read_b64_tr_b16 v[242:243], v67 offset:20992
    buffer_load_dwordx4 v[180:183], v2, s[32:35], s16 offen offset:1024 sc1
    s_waitcnt vmcnt(11)
    s_waitcnt lgkmcnt(10)
    v_mfma_f32_32x32x16_bf16 v[112:127], v[248:251], v[184:187], v[112:127]
    ds_read_b64_tr_b16 v[244:245], v66 offset:13312
    ds_read_b64_tr_b16 v[246:247], v66 offset:13824
    s_waitcnt lgkmcnt(10)
    v_mfma_f32_32x32x16_bf16 v[128:143], v[224:227], v[184:187], v[128:143]
    ds_read_b64_tr_b16 v[248:249], v67 offset:13312
    ds_read_b64_tr_b16 v[250:251], v67 offset:13824
    s_waitcnt lgkmcnt(10)
    v_mfma_f32_32x32x16_bf16 v[80:95], v[228:231], v[184:187], v[80:95]
    ds_read_b64_tr_b16 v[224:225], v66 offset:5120
    ds_read_b64_tr_b16 v[226:227], v66 offset:5632
    s_waitcnt lgkmcnt(10)
    v_mfma_f32_32x32x16_bf16 v[96:111], v[232:235], v[184:187], v[96:111]
    ds_read_b64_tr_b16 v[228:229], v67 offset:5120
    ds_read_b64_tr_b16 v[230:231], v67 offset:5632
    s_waitcnt lgkmcnt(10)
    v_mfma_f32_32x32x16_bf16 v[144:159], v[236:239], v[184:187], v[144:159]
    ds_read_b64_tr_b16 v[232:233], v66 offset:21504
    ds_read_b64_tr_b16 v[234:235], v66 offset:22016
    s_waitcnt lgkmcnt(10)
    v_mfma_f32_32x32x16_bf16 v[160:175], v[240:243], v[184:187], v[160:175]
    ds_read_b64_tr_b16 v[236:237], v67 offset:21504
    ds_read_b64_tr_b16 v[238:239], v67 offset:22016
    buffer_load_dwordx4 v[184:187], v2, s[32:35], s16 offen offset:2048 sc1
    s_waitcnt vmcnt(11)
    s_waitcnt lgkmcnt(10)
    v_mfma_f32_32x32x16_bf16 v[112:127], v[244:247], v[188:191], v[112:127]
    s_barrier
    ds_read_b64_tr_b16 v[240:241], v66 offset:32768
    ds_read_b64_tr_b16 v[242:243], v66 offset:33280
    s_waitcnt lgkmcnt(10)
    v_mfma_f32_32x32x16_bf16 v[128:143], v[248:251], v[188:191], v[128:143]
    ds_read_b64_tr_b16 v[244:245], v67 offset:32768
    ds_read_b64_tr_b16 v[246:247], v67 offset:33280
    s_waitcnt lgkmcnt(10)
    v_mfma_f32_32x32x16_bf16 v[80:95], v[224:227], v[188:191], v[80:95]
    ds_read_b64_tr_b16 v[248:249], v66 offset:24576
    ds_read_b64_tr_b16 v[250:251], v66 offset:25088
    s_waitcnt lgkmcnt(10)
    v_mfma_f32_32x32x16_bf16 v[96:111], v[228:231], v[188:191], v[96:111]
    ds_read_b64_tr_b16 v[224:225], v67 offset:24576
    ds_read_b64_tr_b16 v[226:227], v67 offset:25088
    s_waitcnt lgkmcnt(10)
    v_mfma_f32_32x32x16_bf16 v[144:159], v[232:235], v[188:191], v[144:159]
    ds_read_b64_tr_b16 v[228:229], v66 offset:40960
    ds_read_b64_tr_b16 v[230:231], v66 offset:41472
    s_waitcnt lgkmcnt(10)
    v_mfma_f32_32x32x16_bf16 v[160:175], v[236:239], v[188:191], v[160:175]
    ds_read_b64_tr_b16 v[232:233], v67 offset:40960
    ds_read_b64_tr_b16 v[234:235], v67 offset:41472
    buffer_load_dwordx4 v[188:191], v2, s[32:35], s16 offen offset:3072 sc1
    s_barrier
    s_waitcnt vmcnt(11)
    s_waitcnt lgkmcnt(10)
    v_mfma_f32_32x32x16_bf16 v[112:127], v[240:243], v[192:195], v[112:127]
    ds_read_b64_tr_b16 v[236:237], v66 offset:33792
    ds_read_b64_tr_b16 v[238:239], v66 offset:34304
    s_waitcnt lgkmcnt(10)
    v_mfma_f32_32x32x16_bf16 v[128:143], v[244:247], v[192:195], v[128:143]
    ds_read_b64_tr_b16 v[240:241], v67 offset:33792
    ds_read_b64_tr_b16 v[242:243], v67 offset:34304
    s_waitcnt lgkmcnt(10)
    v_mfma_f32_32x32x16_bf16 v[80:95], v[248:251], v[192:195], v[80:95]
    ds_read_b64_tr_b16 v[244:245], v66 offset:25600
    ds_read_b64_tr_b16 v[246:247], v66 offset:26112
    s_waitcnt lgkmcnt(10)
    v_mfma_f32_32x32x16_bf16 v[96:111], v[224:227], v[192:195], v[96:111]
    ds_read_b64_tr_b16 v[248:249], v67 offset:25600
    ds_read_b64_tr_b16 v[250:251], v67 offset:26112
    s_waitcnt lgkmcnt(10)
    v_mfma_f32_32x32x16_bf16 v[144:159], v[228:231], v[192:195], v[144:159]
    ds_read_b64_tr_b16 v[224:225], v66 offset:41984
    ds_read_b64_tr_b16 v[226:227], v66 offset:42496
    s_waitcnt lgkmcnt(10)
    v_mfma_f32_32x32x16_bf16 v[160:175], v[232:235], v[192:195], v[160:175]
    ds_read_b64_tr_b16 v[228:229], v67 offset:41984
    ds_read_b64_tr_b16 v[230:231], v67 offset:42496
    s_waitcnt vmcnt(10)
    s_waitcnt lgkmcnt(10)
    v_mfma_f32_32x32x16_bf16 v[112:127], v[236:239], v[196:199], v[112:127]
    ds_read_b64_tr_b16 v[232:233], v66 offset:36864
    ds_read_b64_tr_b16 v[234:235], v66 offset:37376
    s_waitcnt lgkmcnt(10)
    v_mfma_f32_32x32x16_bf16 v[128:143], v[240:243], v[196:199], v[128:143]
    ds_read_b64_tr_b16 v[236:237], v67 offset:36864
    ds_read_b64_tr_b16 v[238:239], v67 offset:37376
    s_waitcnt lgkmcnt(10)
    v_mfma_f32_32x32x16_bf16 v[80:95], v[244:247], v[196:199], v[80:95]
    ds_read_b64_tr_b16 v[240:241], v66 offset:28672
    ds_read_b64_tr_b16 v[242:243], v66 offset:29184
    s_waitcnt lgkmcnt(10)
    v_mfma_f32_32x32x16_bf16 v[96:111], v[248:251], v[196:199], v[96:111]
    ds_read_b64_tr_b16 v[244:245], v67 offset:28672
    ds_read_b64_tr_b16 v[246:247], v67 offset:29184
    s_waitcnt lgkmcnt(10)
    v_mfma_f32_32x32x16_bf16 v[144:159], v[224:227], v[196:199], v[144:159]
    ds_read_b64_tr_b16 v[248:249], v66 offset:45056
    ds_read_b64_tr_b16 v[250:251], v66 offset:45568
    s_waitcnt lgkmcnt(10)
    v_mfma_f32_32x32x16_bf16 v[160:175], v[228:231], v[196:199], v[160:175]
    ds_read_b64_tr_b16 v[224:225], v67 offset:45056
    ds_read_b64_tr_b16 v[226:227], v67 offset:45568
    s_waitcnt vmcnt(9)
    s_waitcnt lgkmcnt(10)
    v_mfma_f32_32x32x16_bf16 v[112:127], v[232:235], v[200:203], v[112:127]
    ds_read_b64_tr_b16 v[228:229], v66 offset:37888
    ds_read_b64_tr_b16 v[230:231], v66 offset:38400
    s_waitcnt lgkmcnt(10)
    v_mfma_f32_32x32x16_bf16 v[128:143], v[236:239], v[200:203], v[128:143]
    ds_read_b64_tr_b16 v[232:233], v67 offset:37888
    ds_read_b64_tr_b16 v[234:235], v67 offset:38400
    s_waitcnt lgkmcnt(10)
    v_mfma_f32_32x32x16_bf16 v[80:95], v[240:243], v[200:203], v[80:95]
    ds_read_b64_tr_b16 v[236:237], v66 offset:29696
    ds_read_b64_tr_b16 v[238:239], v66 offset:30208
    s_waitcnt lgkmcnt(10)
    v_mfma_f32_32x32x16_bf16 v[96:111], v[244:247], v[200:203], v[96:111]
    ds_read_b64_tr_b16 v[240:241], v67 offset:29696
    ds_read_b64_tr_b16 v[242:243], v67 offset:30208
    s_waitcnt lgkmcnt(10)
    v_mfma_f32_32x32x16_bf16 v[144:159], v[248:251], v[200:203], v[144:159]
    ds_read_b64_tr_b16 v[244:245], v66 offset:46080
    ds_read_b64_tr_b16 v[246:247], v66 offset:46592
    s_waitcnt lgkmcnt(10)
    v_mfma_f32_32x32x16_bf16 v[160:175], v[224:227], v[200:203], v[160:175]
    ds_read_b64_tr_b16 v[248:249], v67 offset:46080
    ds_read_b64_tr_b16 v[250:251], v67 offset:46592
    s_waitcnt vmcnt(8)
    s_waitcnt lgkmcnt(10)
    v_mfma_f32_32x32x16_bf16 v[112:127], v[228:231], v[204:207], v[112:127]
    ds_read_b64_tr_b16 v[224:225], v68 offset:8192
    ds_read_b64_tr_b16 v[226:227], v68 offset:8704
    s_waitcnt lgkmcnt(10)
    v_mfma_f32_32x32x16_bf16 v[128:143], v[232:235], v[204:207], v[128:143]
    ds_read_b64_tr_b16 v[228:229], v69 offset:8192
    ds_read_b64_tr_b16 v[230:231], v69 offset:8704
    s_waitcnt lgkmcnt(10)
    v_mfma_f32_32x32x16_bf16 v[80:95], v[236:239], v[204:207], v[80:95]
    ds_read_b64_tr_b16 v[232:233], v68
    ds_read_b64_tr_b16 v[234:235], v68 offset:512
    s_waitcnt lgkmcnt(10)
    v_mfma_f32_32x32x16_bf16 v[96:111], v[240:243], v[204:207], v[96:111]
    ds_read_b64_tr_b16 v[236:237], v69
    ds_read_b64_tr_b16 v[238:239], v69 offset:512
    s_waitcnt lgkmcnt(10)
    v_mfma_f32_32x32x16_bf16 v[144:159], v[244:247], v[204:207], v[144:159]
    ds_read_b64_tr_b16 v[240:241], v68 offset:16384
    ds_read_b64_tr_b16 v[242:243], v68 offset:16896
    s_waitcnt lgkmcnt(10)
    v_mfma_f32_32x32x16_bf16 v[160:175], v[248:251], v[204:207], v[160:175]
    ds_read_b64_tr_b16 v[244:245], v69 offset:16384
    ds_read_b64_tr_b16 v[246:247], v69 offset:16896
    s_waitcnt vmcnt(7)
    s_waitcnt lgkmcnt(10)
    v_mfma_f32_32x32x16_bf16 v[112:127], v[224:227], v[208:211], v[112:127]
    ds_read_b64_tr_b16 v[248:249], v68 offset:9216
    ds_read_b64_tr_b16 v[250:251], v68 offset:9728
    s_waitcnt lgkmcnt(10)
    v_mfma_f32_32x32x16_bf16 v[128:143], v[228:231], v[208:211], v[128:143]
    ds_read_b64_tr_b16 v[224:225], v69 offset:9216
    ds_read_b64_tr_b16 v[226:227], v69 offset:9728
    s_waitcnt lgkmcnt(10)
    v_mfma_f32_32x32x16_bf16 v[80:95], v[232:235], v[208:211], v[80:95]
    ds_read_b64_tr_b16 v[228:229], v68 offset:1024
    ds_read_b64_tr_b16 v[230:231], v68 offset:1536
    s_waitcnt lgkmcnt(10)
    v_mfma_f32_32x32x16_bf16 v[96:111], v[236:239], v[208:211], v[96:111]
    ds_read_b64_tr_b16 v[232:233], v69 offset:1024
    ds_read_b64_tr_b16 v[234:235], v69 offset:1536
    s_waitcnt lgkmcnt(10)
    v_mfma_f32_32x32x16_bf16 v[144:159], v[240:243], v[208:211], v[144:159]
    ds_read_b64_tr_b16 v[236:237], v68 offset:17408
    ds_read_b64_tr_b16 v[238:239], v68 offset:17920
    s_waitcnt lgkmcnt(10)
    v_mfma_f32_32x32x16_bf16 v[160:175], v[244:247], v[208:211], v[160:175]
    ds_read_b64_tr_b16 v[240:241], v69 offset:17408
    ds_read_b64_tr_b16 v[242:243], v69 offset:17920
    s_waitcnt vmcnt(6)
    s_waitcnt lgkmcnt(10)
    v_mfma_f32_32x32x16_bf16 v[112:127], v[248:251], v[212:215], v[112:127]
    ds_read_b64_tr_b16 v[244:245], v68 offset:12288
    ds_read_b64_tr_b16 v[246:247], v68 offset:12800
    s_waitcnt lgkmcnt(10)
    v_mfma_f32_32x32x16_bf16 v[128:143], v[224:227], v[212:215], v[128:143]
    ds_read_b64_tr_b16 v[248:249], v69 offset:12288
    ds_read_b64_tr_b16 v[250:251], v69 offset:12800
    s_waitcnt lgkmcnt(10)
    v_mfma_f32_32x32x16_bf16 v[80:95], v[228:231], v[212:215], v[80:95]
    ds_read_b64_tr_b16 v[224:225], v68 offset:4096
    ds_read_b64_tr_b16 v[226:227], v68 offset:4608
    s_waitcnt lgkmcnt(10)
    v_mfma_f32_32x32x16_bf16 v[96:111], v[232:235], v[212:215], v[96:111]
    ds_read_b64_tr_b16 v[228:229], v69 offset:4096
    ds_read_b64_tr_b16 v[230:231], v69 offset:4608
    s_waitcnt lgkmcnt(10)
    v_mfma_f32_32x32x16_bf16 v[144:159], v[236:239], v[212:215], v[144:159]
    ds_read_b64_tr_b16 v[232:233], v68 offset:20480
    ds_read_b64_tr_b16 v[234:235], v68 offset:20992
    s_waitcnt lgkmcnt(10)
    v_mfma_f32_32x32x16_bf16 v[160:175], v[240:243], v[212:215], v[160:175]
    ds_read_b64_tr_b16 v[236:237], v69 offset:20480
    ds_read_b64_tr_b16 v[238:239], v69 offset:20992
    s_waitcnt vmcnt(5)
    s_waitcnt lgkmcnt(10)
    v_mfma_f32_32x32x16_bf16 v[112:127], v[244:247], v[216:219], v[112:127]
    ds_read_b64_tr_b16 v[240:241], v68 offset:13312
    ds_read_b64_tr_b16 v[242:243], v68 offset:13824
    s_waitcnt lgkmcnt(10)
    v_mfma_f32_32x32x16_bf16 v[128:143], v[248:251], v[216:219], v[128:143]
    ds_read_b64_tr_b16 v[244:245], v69 offset:13312
    ds_read_b64_tr_b16 v[246:247], v69 offset:13824
    s_waitcnt lgkmcnt(10)
    v_mfma_f32_32x32x16_bf16 v[80:95], v[224:227], v[216:219], v[80:95]
    ds_read_b64_tr_b16 v[248:249], v68 offset:5120
    ds_read_b64_tr_b16 v[250:251], v68 offset:5632
    s_waitcnt lgkmcnt(10)
    v_mfma_f32_32x32x16_bf16 v[96:111], v[228:231], v[216:219], v[96:111]
    ds_read_b64_tr_b16 v[224:225], v69 offset:5120
    ds_read_b64_tr_b16 v[226:227], v69 offset:5632
    s_waitcnt lgkmcnt(10)
    v_mfma_f32_32x32x16_bf16 v[144:159], v[232:235], v[216:219], v[144:159]
    ds_read_b64_tr_b16 v[228:229], v68 offset:21504
    ds_read_b64_tr_b16 v[230:231], v68 offset:22016
    s_waitcnt lgkmcnt(10)
    v_mfma_f32_32x32x16_bf16 v[160:175], v[236:239], v[216:219], v[160:175]
    ds_read_b64_tr_b16 v[232:233], v69 offset:21504
    ds_read_b64_tr_b16 v[234:235], v69 offset:22016
    s_waitcnt vmcnt(4)
    s_waitcnt lgkmcnt(10)
    v_mfma_f32_32x32x16_bf16 v[112:127], v[240:243], v[220:223], v[112:127]
    ds_read_b64_tr_b16 v[236:237], v68 offset:32768
    ds_read_b64_tr_b16 v[238:239], v68 offset:33280
    s_waitcnt lgkmcnt(10)
    v_mfma_f32_32x32x16_bf16 v[128:143], v[244:247], v[220:223], v[128:143]
    ds_read_b64_tr_b16 v[240:241], v69 offset:32768
    ds_read_b64_tr_b16 v[242:243], v69 offset:33280
    s_waitcnt lgkmcnt(10)
    v_mfma_f32_32x32x16_bf16 v[80:95], v[248:251], v[220:223], v[80:95]
    ds_read_b64_tr_b16 v[244:245], v68 offset:24576
    ds_read_b64_tr_b16 v[246:247], v68 offset:25088
    s_waitcnt lgkmcnt(10)
    v_mfma_f32_32x32x16_bf16 v[96:111], v[224:227], v[220:223], v[96:111]
    ds_read_b64_tr_b16 v[248:249], v69 offset:24576
    ds_read_b64_tr_b16 v[250:251], v69 offset:25088
    s_waitcnt lgkmcnt(10)
    v_mfma_f32_32x32x16_bf16 v[144:159], v[228:231], v[220:223], v[144:159]
    ds_read_b64_tr_b16 v[224:225], v68 offset:40960
    ds_read_b64_tr_b16 v[226:227], v68 offset:41472
    s_waitcnt lgkmcnt(10)
    v_mfma_f32_32x32x16_bf16 v[160:175], v[232:235], v[220:223], v[160:175]
    ds_read_b64_tr_b16 v[228:229], v69 offset:40960
    ds_read_b64_tr_b16 v[230:231], v69 offset:41472
    s_waitcnt vmcnt(3)
    s_waitcnt lgkmcnt(10)
    v_mfma_f32_32x32x16_bf16 v[112:127], v[236:239], v[176:179], v[112:127]
    ds_read_b64_tr_b16 v[232:233], v68 offset:33792
    ds_read_b64_tr_b16 v[234:235], v68 offset:34304
    s_waitcnt lgkmcnt(10)
    v_mfma_f32_32x32x16_bf16 v[128:143], v[240:243], v[176:179], v[128:143]
    ds_read_b64_tr_b16 v[236:237], v69 offset:33792
    ds_read_b64_tr_b16 v[238:239], v69 offset:34304
    s_waitcnt lgkmcnt(10)
    v_mfma_f32_32x32x16_bf16 v[80:95], v[244:247], v[176:179], v[80:95]
    ds_read_b64_tr_b16 v[240:241], v68 offset:25600
    ds_read_b64_tr_b16 v[242:243], v68 offset:26112
    s_waitcnt lgkmcnt(10)
    v_mfma_f32_32x32x16_bf16 v[96:111], v[248:251], v[176:179], v[96:111]
    ds_read_b64_tr_b16 v[244:245], v69 offset:25600
    ds_read_b64_tr_b16 v[246:247], v69 offset:26112
    s_waitcnt lgkmcnt(10)
    v_mfma_f32_32x32x16_bf16 v[144:159], v[224:227], v[176:179], v[144:159]
    ds_read_b64_tr_b16 v[248:249], v68 offset:41984
    ds_read_b64_tr_b16 v[250:251], v68 offset:42496
    s_waitcnt lgkmcnt(10)
    v_mfma_f32_32x32x16_bf16 v[160:175], v[228:231], v[176:179], v[160:175]
    ds_read_b64_tr_b16 v[224:225], v69 offset:41984
    ds_read_b64_tr_b16 v[226:227], v69 offset:42496
    s_waitcnt vmcnt(2)
    s_waitcnt lgkmcnt(10)
    v_mfma_f32_32x32x16_bf16 v[112:127], v[232:235], v[180:183], v[112:127]
    ds_read_b64_tr_b16 v[228:229], v68 offset:36864
    ds_read_b64_tr_b16 v[230:231], v68 offset:37376
    s_waitcnt lgkmcnt(10)
    v_mfma_f32_32x32x16_bf16 v[128:143], v[236:239], v[180:183], v[128:143]
    ds_read_b64_tr_b16 v[232:233], v69 offset:36864
    ds_read_b64_tr_b16 v[234:235], v69 offset:37376
    s_waitcnt lgkmcnt(10)
    v_mfma_f32_32x32x16_bf16 v[80:95], v[240:243], v[180:183], v[80:95]
    ds_read_b64_tr_b16 v[236:237], v68 offset:28672
    ds_read_b64_tr_b16 v[238:239], v68 offset:29184
    s_waitcnt lgkmcnt(10)
    v_mfma_f32_32x32x16_bf16 v[96:111], v[244:247], v[180:183], v[96:111]
    ds_read_b64_tr_b16 v[240:241], v69 offset:28672
    ds_read_b64_tr_b16 v[242:243], v69 offset:29184
    s_waitcnt lgkmcnt(10)
    v_mfma_f32_32x32x16_bf16 v[144:159], v[248:251], v[180:183], v[144:159]
    ds_read_b64_tr_b16 v[244:245], v68 offset:45056
    ds_read_b64_tr_b16 v[246:247], v68 offset:45568
    s_waitcnt lgkmcnt(10)
    v_mfma_f32_32x32x16_bf16 v[160:175], v[224:227], v[180:183], v[160:175]
    ds_read_b64_tr_b16 v[248:249], v69 offset:45056
    ds_read_b64_tr_b16 v[250:251], v69 offset:45568
    s_waitcnt vmcnt(1)
    s_waitcnt lgkmcnt(10)
    v_mfma_f32_32x32x16_bf16 v[112:127], v[228:231], v[184:187], v[112:127]
    ds_read_b64_tr_b16 v[224:225], v68 offset:37888
    ds_read_b64_tr_b16 v[226:227], v68 offset:38400
    s_waitcnt lgkmcnt(10)
    v_mfma_f32_32x32x16_bf16 v[128:143], v[232:235], v[184:187], v[128:143]
    ds_read_b64_tr_b16 v[228:229], v69 offset:37888
    ds_read_b64_tr_b16 v[230:231], v69 offset:38400
    s_waitcnt lgkmcnt(10)
    v_mfma_f32_32x32x16_bf16 v[80:95], v[236:239], v[184:187], v[80:95]
    ds_read_b64_tr_b16 v[232:233], v68 offset:29696
    ds_read_b64_tr_b16 v[234:235], v68 offset:30208
    s_waitcnt lgkmcnt(10)
    v_mfma_f32_32x32x16_bf16 v[96:111], v[240:243], v[184:187], v[96:111]
    ds_read_b64_tr_b16 v[236:237], v69 offset:29696
    ds_read_b64_tr_b16 v[238:239], v69 offset:30208
    s_waitcnt lgkmcnt(10)
    v_mfma_f32_32x32x16_bf16 v[144:159], v[244:247], v[184:187], v[144:159]
    ds_read_b64_tr_b16 v[240:241], v68 offset:46080
    ds_read_b64_tr_b16 v[242:243], v68 offset:46592
    s_waitcnt lgkmcnt(10)
    v_mfma_f32_32x32x16_bf16 v[160:175], v[248:251], v[184:187], v[160:175]
    ds_read_b64_tr_b16 v[244:245], v69 offset:46080
    ds_read_b64_tr_b16 v[246:247], v69 offset:46592
    s_waitcnt vmcnt(0)
    s_waitcnt lgkmcnt(10)
    v_mfma_f32_32x32x16_bf16 v[112:127], v[224:227], v[188:191], v[112:127]
    s_waitcnt lgkmcnt(8)
    v_mfma_f32_32x32x16_bf16 v[128:143], v[228:231], v[188:191], v[128:143]
    s_waitcnt lgkmcnt(6)
    v_mfma_f32_32x32x16_bf16 v[80:95], v[232:235], v[188:191], v[80:95]
    s_waitcnt lgkmcnt(4)
    v_mfma_f32_32x32x16_bf16 v[96:111], v[236:239], v[188:191], v[96:111]
    s_waitcnt lgkmcnt(2)
    v_mfma_f32_32x32x16_bf16 v[144:159], v[240:243], v[188:191], v[144:159]
    s_waitcnt lgkmcnt(0)
    v_mfma_f32_32x32x16_bf16 v[160:175], v[244:247], v[188:191], v[160:175]
    s_nop 3
    v_cvt_pk_bf16_f32 v52, v128, v129
    v_cvt_pk_bf16_f32 v53, v130, v131
    v_cvt_pk_bf16_f32 v54, v132, v133
    v_cvt_pk_bf16_f32 v55, v134, v135
    v_cvt_pk_bf16_f32 v56, v136, v137
    v_cvt_pk_bf16_f32 v57, v138, v139
    v_cvt_pk_bf16_f32 v58, v140, v141
    v_cvt_pk_bf16_f32 v59, v142, v143
    ds_write_b128 v76, v[52:55]
    ds_write_b128 v76, v[56:59] offset:1024
    v_cvt_pk_bf16_f32 v36, v112, v113
    v_cvt_pk_bf16_f32 v37, v114, v115
    v_cvt_pk_bf16_f32 v38, v116, v117
    v_cvt_pk_bf16_f32 v39, v118, v119
    v_cvt_pk_bf16_f32 v40, v120, v121
    v_cvt_pk_bf16_f32 v41, v122, v123
    v_cvt_pk_bf16_f32 v42, v124, v125
    v_cvt_pk_bf16_f32 v43, v126, v127
    s_waitcnt lgkmcnt(0)
    s_barrier
    s_setprio 0
    v_mfma_f32_32x32x16_bf16 v[112:127], v[28:31], v[36:39], 0
    v_mfma_f32_32x32x16_bf16 v[112:127], v[32:35], v[40:43], v[112:127]
    v_cvt_pk_bf16_f32 v52, v144, v145
    v_cvt_pk_bf16_f32 v53, v146, v147
    v_cvt_pk_bf16_f32 v54, v148, v149
    v_cvt_pk_bf16_f32 v55, v150, v151
    v_cvt_pk_bf16_f32 v56, v152, v153
    v_cvt_pk_bf16_f32 v57, v154, v155
    v_cvt_pk_bf16_f32 v58, v156, v157
    v_cvt_pk_bf16_f32 v59, v158, v159
    ds_write_b128 v75, v[52:55] offset:32768
    ds_write_b128 v75, v[56:59] offset:36864
    v_cvt_pk_bf16_f32 v44, v160, v161
    v_cvt_pk_bf16_f32 v45, v162, v163
    v_cvt_pk_bf16_f32 v46, v164, v165
    v_cvt_pk_bf16_f32 v47, v166, v167
    v_cvt_pk_bf16_f32 v48, v168, v169
    v_cvt_pk_bf16_f32 v49, v170, v171
    v_cvt_pk_bf16_f32 v50, v172, v173
    v_cvt_pk_bf16_f32 v51, v174, v175
    ds_write_b128 v75, v[44:47] offset:40960
    ds_write_b128 v75, v[48:51] offset:45056
    v_cvt_pk_bf16_f32 v36, v96, v97
    v_cvt_pk_bf16_f32 v37, v98, v99
    v_cvt_pk_bf16_f32 v38, v100, v101
    v_cvt_pk_bf16_f32 v39, v102, v103
    v_cvt_pk_bf16_f32 v40, v104, v105
    v_cvt_pk_bf16_f32 v41, v106, v107
    v_cvt_pk_bf16_f32 v42, v108, v109
    v_cvt_pk_bf16_f32 v43, v110, v111
    ds_write_b128 v76, v[36:39] offset:2048
    ds_write_b128 v76, v[40:43] offset:3072
    v_cvt_pk_bf16_f32 v44, v80, v81
    v_cvt_pk_bf16_f32 v45, v82, v83
    v_cvt_pk_bf16_f32 v46, v84, v85
    v_cvt_pk_bf16_f32 v47, v86, v87
    v_cvt_pk_bf16_f32 v48, v88, v89
    v_cvt_pk_bf16_f32 v49, v90, v91
    v_cvt_pk_bf16_f32 v50, v92, v93
    v_cvt_pk_bf16_f32 v51, v94, v95
    s_branch L_JOIN
L_HELP:
    s_add_u32 s96, s85, 5
    s_and_b32 s97, s96, 15
    s_lshl3_add_u32 s98, s97, s3
    s_sub_u32 s99, s98, 4
    s_mul_i32 s96, s99, 49152
    s_lshl_b32 s97, s11, 7
    s_add_u32 s82, s96, s97
    s_sub_u32 s96, s3, 4
    s_lshl_b32 s97, s96, 10
    s_add_u32 s20, s97, 122880
    s_mov_b32 m0, s20
    s_nop 0
    buffer_load_dwordx4 v62, s[40:43], s82 offen lds
    s_add_u32 s82, s82, 2048
    s_add_u32 m0, s20, 8192
    s_nop 0
    buffer_load_dwordx4 v62, s[40:43], s82 offen lds
    s_add_u32 s82, s82, 2048
    s_add_u32 m0, s20, 16384
    s_nop 0
    buffer_load_dwordx4 v62, s[40:43], s82 offen lds
    s_add_u32 s96, s85, 5
    s_and_b32 s97, s96, 15
    s_lshl3_add_u32 s98, s97, s3
    s_mul_i32 s99, s98, 49152
    s_lshl_b32 s96, s11, 7
    s_add_u32 s82, s99, s96
    s_lshl_b32 s96, s3, 10
    s_add_u32 s20, s96, 122880
    s_mov_b32 m0, s20
    s_nop 0
    buffer_load_dwordx4 v62, s[40:43], s82 offen lds
    s_add_u32 s82, s82, 2048
    s_add_u32 m0, s20, 8192
    s_nop 0
    buffer_load_dwordx4 v62, s[40:43], s82 offen lds
    s_add_u32 s82, s82, 2048
    s_add_u32 m0, s20, 16384
    s_nop 0
    buffer_load_dwordx4 v62, s[40:43], s82 offen lds
    s_and_b32 s96, s8, 3
    s_lshl2_add_u32 s97, s96, s3
    s_sub_u32 s98, s97, 4
    s_lshl_b32 s13, s98, 7
    v_lshrrev_b32 v61, 3, v1
    v_lshl_add_u32 v61, v61, 1, s13
    s_mul_i32 s96, s13, 6144
    s_lshr_b32 s97, s8, 2
    s_lshl1_add_u32 s98, s9, s97
    s_lshl_b32 s99, s98, 7
    s_add_u32 s97, s96, s99
    s_add_u32 s17, s97, 4096
    global_load_ushort v112, v61, s[86:87] offset:0
    global_load_ushort v113, v61, s[86:87] offset:16
    global_load_ushort v114, v61, s[86:87] offset:32
    global_load_ushort v115, v61, s[86:87] offset:48
    global_load_ushort v116, v61, s[86:87] offset:64
    global_load_ushort v117, v61, s[86:87] offset:80
    global_load_ushort v118, v61, s[86:87] offset:96
    global_load_ushort v119, v61, s[86:87] offset:112
    s_waitcnt vmcnt(14)
    s_barrier
    buffer_load_dwordx4 v[80:83], v60, s[48:51], s17 offen nt
    s_add_u32 s17, s17, 98304
    buffer_load_dwordx4 v[84:87], v60, s[48:51], s17 offen nt
    s_add_u32 s17, s17, 98304
    s_waitcnt lgkmcnt(0)
    s_load_dword s24, s[32:33], s92 offset:512 glc
    s_load_dword s25, s[32:33], s92 offset:256 glc
    s_load_dword s26, s[32:33], s92 offset:1024 glc
    s_load_dword s27, s[32:33], s92 offset:768 glc
    s_barrier
    s_add_u32 s96, s85, 6
    s_and_b32 s97, s96, 15
    s_lshl3_add_u32 s98, s97, s3
    s_sub_u32 s99, s98, 4
    s_mul_i32 s96, s99, 49152
    s_lshl_b32 s97, s11, 7
    s_add_u32 s82, s96, s97
    s_sub_u32 s96, s3, 4
    s_lshl_b32 s20, s96, 10
    s_mov_b32 m0, s20
    s_nop 0
    buffer_load_dwordx4 v62, s[40:43], s82 offen lds
    s_add_u32 s82, s82, 2048
    s_add_u32 m0, s20, 8192
    s_nop 0
    buffer_load_dwordx4 v62, s[40:43], s82 offen lds
    s_add_u32 s82, s82, 2048
    s_add_u32 m0, s20, 16384
    s_nop 0
    buffer_load_dwordx4 v62, s[40:43], s82 offen lds
    s_add_u32 s96, s85, 6
    s_and_b32 s97, s96, 15
    s_lshl3_add_u32 s98, s97, s3
    s_mul_i32 s99, s98, 49152
    s_lshl_b32 s96, s11, 7
    s_add_u32 s82, s99, s96
    s_lshl_b32 s20, s3, 10
    s_mov_b32 m0, s20
    s_nop 0
    buffer_load_dwordx4 v62, s[40:43], s82 offen lds
    s_add_u32 s82, s82, 2048
    s_add_u32 m0, s20, 8192
    s_nop 0
    buffer_load_dwordx4 v62, s[40:43], s82 offen lds
    s_add_u32 s82, s82, 2048
    s_add_u32 m0, s20, 16384
    s_nop 0
    buffer_load_dwordx4 v62, s[40:43], s82 offen lds
    s_waitcnt vmcnt(8)
    v_lshlrev_b32 v112, 16, v112
    v_mul_f32 v4, s7, v112
    v_exp_f32 v4, -v4
    s_nop 0
    v_add_f32 v4, 1.0, v4
    v_rcp_f32 v4, v4
    s_nop 0
    v_mul_f32 v112, v112, v4
    v_cvt_pk_bf16_f32 v112, 0, v112
    v_lshlrev_b32 v113, 16, v113
    v_mul_f32 v5, s7, v113
    v_exp_f32 v5, -v5
    s_nop 0
    v_add_f32 v5, 1.0, v5
    v_rcp_f32 v5, v5
    s_nop 0
    v_mul_f32 v113, v113, v5
    v_cvt_pk_bf16_f32 v113, 0, v113
    v_lshlrev_b32 v114, 16, v114
    v_mul_f32 v4, s7, v114
    v_exp_f32 v4, -v4
    s_nop 0
    v_add_f32 v4, 1.0, v4
    v_rcp_f32 v4, v4
    s_nop 0
    v_mul_f32 v114, v114, v4
    v_cvt_pk_bf16_f32 v114, 0, v114
    v_lshlrev_b32 v115, 16, v115
    v_mul_f32 v5, s7, v115
    v_exp_f32 v5, -v5
    s_nop 0
    v_add_f32 v5, 1.0, v5
    v_rcp_f32 v5, v5
    s_nop 0
    v_mul_f32 v115, v115, v5
    v_cvt_pk_bf16_f32 v115, 0, v115
    s_barrier
    s_add_u32 s96, s85, 7
    s_and_b32 s97, s96, 15
    s_lshl3_add_u32 s98, s97, s3
    s_sub_u32 s99, s98, 4
    s_mul_i32 s96, s99, 49152
    s_lshl_b32 s97, s11, 7
    s_add_u32 s82, s96, s97
    s_sub_u32 s96, s3, 4
    s_lshl_b32 s97, s96, 10
    s_add_u32 s20, s97, 24576
    s_mov_b32 m0, s20
    s_nop 0
    buffer_load_dwordx4 v62, s[40:43], s82 offen lds
    s_add_u32 s82, s82, 2048
    s_add_u32 m0, s20, 8192
    s_nop 0
    buffer_load_dwordx4 v62, s[40:43], s82 offen lds
    s_add_u32 s82, s82, 2048
    s_add_u32 m0, s20, 16384
    s_nop 0
    buffer_load_dwordx4 v62, s[40:43], s82 offen lds
    s_add_u32 s96, s85, 7
    s_and_b32 s97, s96, 15
    s_lshl3_add_u32 s98, s97, s3
    s_mul_i32 s99, s98, 49152
    s_lshl_b32 s96, s11, 7
    s_add_u32 s82, s99, s96
    s_lshl_b32 s96, s3, 10
    s_add_u32 s20, s96, 24576
    s_mov_b32 m0, s20
    s_nop 0
    buffer_load_dwordx4 v62, s[40:43], s82 offen lds
    s_add_u32 s82, s82, 2048
    s_add_u32 m0, s20, 8192
    s_nop 0
    buffer_load_dwordx4 v62, s[40:43], s82 offen lds
    s_add_u32 s82, s82, 2048
    s_add_u32 m0, s20, 16384
    s_nop 0
    buffer_load_dwordx4 v62, s[40:43], s82 offen lds
    buffer_load_dwordx4 v[88:91], v60, s[48:51], s17 offen nt
    s_add_u32 s17, s17, 98304
    buffer_load_dwordx4 v[92:95], v60, s[48:51], s17 offen nt
    s_add_u32 s17, s17, 98304
    v_lshlrev_b32 v116, 16, v116
    v_mul_f32 v4, s7, v116
    v_exp_f32 v4, -v4
    s_nop 0
    v_add_f32 v4, 1.0, v4
    v_rcp_f32 v4, v4
    s_nop 0
    v_mul_f32 v116, v116, v4
    v_cvt_pk_bf16_f32 v116, 0, v116
    v_lshlrev_b32 v117, 16, v117
    v_mul_f32 v5, s7, v117
    v_exp_f32 v5, -v5
    s_nop 0
    v_add_f32 v5, 1.0, v5
    v_rcp_f32 v5, v5
    s_nop 0
    v_mul_f32 v117, v117, v5
    v_cvt_pk_bf16_f32 v117, 0, v117
    v_lshlrev_b32 v118, 16, v118
    v_mul_f32 v4, s7, v118
    v_exp_f32 v4, -v4
    s_nop 0
    v_add_f32 v4, 1.0, v4
    v_rcp_f32 v4, v4
    s_nop 0
    v_mul_f32 v118, v118, v4
    v_cvt_pk_bf16_f32 v118, 0, v118
    v_lshlrev_b32 v119, 16, v119
    v_mul_f32 v5, s7, v119
    v_exp_f32 v5, -v5
    s_nop 0
    v_add_f32 v5, 1.0, v5
    v_rcp_f32 v5, v5
    s_nop 0
    v_mul_f32 v119, v119, v5
    v_cvt_pk_bf16_f32 v119, 0, v119
    s_barrier
    s_add_u32 s96, s85, 8
    s_and_b32 s97, s96, 15
    s_lshl3_add_u32 s98, s97, s3
    s_sub_u32 s99, s98, 4
    s_mul_i32 s96, s99, 49152
    s_lshl_b32 s97, s11, 7
    s_add_u32 s82, s96, s97
    s_sub_u32 s96, s3, 4
    s_lshl_b32 s97, s96, 10
    s_add_u32 s20, s97, 49152
    s_mov_b32 m0, s20
    s_nop 0
    buffer_load_dwordx4 v62, s[40:43], s82 offen lds
    s_add_u32 s82, s82, 2048
    s_add_u32 m0, s20, 8192
    s_nop 0
    buffer_load_dwordx4 v62, s[40:43], s82 offen lds
    s_add_u32 s82, s82, 2048
    s_add_u32 m0, s20, 16384
    s_nop 0
    buffer_load_dwordx4 v62, s[40:43], s82 offen lds
    s_add_u32 s96, s85, 8
    s_and_b32 s97, s96, 15
    s_lshl3_add_u32 s98, s97, s3
    s_mul_i32 s99, s98, 49152
    s_lshl_b32 s96, s11, 7
    s_add_u32 s82, s99, s96
    s_lshl_b32 s96, s3, 10
    s_add_u32 s20, s96, 49152
    s_mov_b32 m0, s20
    s_nop 0
    buffer_load_dwordx4 v62, s[40:43], s82 offen lds
    s_add_u32 s82, s82, 2048
    s_add_u32 m0, s20, 8192
    s_nop 0
    buffer_load_dwordx4 v62, s[40:43], s82 offen lds
    s_add_u32 s82, s82, 2048
    s_add_u32 m0, s20, 16384
    s_nop 0
    buffer_load_dwordx4 v62, s[40:43], s82 offen lds
    s_waitcnt lgkmcnt(0)
    s_load_dword s24, s[32:33], s92 offset:1536 glc
    s_load_dword s25, s[32:33], s92 offset:1280 glc
    s_load_dword s26, s[32:33], s92 offset:2048 glc
    s_load_dword s27, s[32:33], s92 offset:1792 glc
    s_barrier
    s_add_u32 s96, s85, 9
    s_and_b32 s97, s96, 15
    s_lshl3_add_u32 s98, s97, s3
    s_sub_u32 s99, s98, 4
    s_mul_i32 s96, s99, 49152
    s_lshl_b32 s97, s11, 7
    s_add_u32 s82, s96, s97
    s_sub_u32 s96, s3, 4
    s_lshl_b32 s97, s96, 10
    s_add_u32 s20, s97, 73728
    s_mov_b32 m0, s20
    s_nop 0
    buffer_load_dwordx4 v62, s[40:43], s82 offen lds
    s_add_u32 s82, s82, 2048
    s_add_u32 m0, s20, 8192
    s_nop 0
    buffer_load_dwordx4 v62, s[40:43], s82 offen lds
    s_add_u32 s82, s82, 2048
    s_add_u32 m0, s20, 16384
    s_nop 0
    buffer_load_dwordx4 v62, s[40:43], s82 offen lds
    s_add_u32 s96, s85, 9
    s_and_b32 s97, s96, 15
    s_lshl3_add_u32 s98, s97, s3
    s_mul_i32 s99, s98, 49152
    s_lshl_b32 s96, s11, 7
    s_add_u32 s82, s99, s96
    s_lshl_b32 s96, s3, 10
    s_add_u32 s20, s96, 73728
    s_mov_b32 m0, s20
    s_nop 0
    buffer_load_dwordx4 v62, s[40:43], s82 offen lds
    s_add_u32 s82, s82, 2048
    s_add_u32 m0, s20, 8192
    s_nop 0
    buffer_load_dwordx4 v62, s[40:43], s82 offen lds
    s_add_u32 s82, s82, 2048
    s_add_u32 m0, s20, 16384
    s_nop 0
    buffer_load_dwordx4 v62, s[40:43], s82 offen lds
    buffer_load_dwordx4 v[96:99], v60, s[48:51], s17 offen nt
    s_add_u32 s17, s17, 98304
    buffer_load_dwordx4 v[100:103], v60, s[48:51], s17 offen nt
    s_add_u32 s17, s17, 98304
    s_waitcnt vmcnt(29)
    v_lshlrev_b32 v4, 16, v80
    v_and_b32 v5, s6, v80
    v_mul_f32 v20, v4, v112
    v_mul_f32 v21, v5, v112
    v_lshlrev_b32 v6, 16, v81
    v_and_b32 v7, s6, v81
    v_mul_f32 v22, v6, v112
    v_mul_f32 v23, v7, v112
    v_lshlrev_b32 v4, 16, v82
    v_and_b32 v5, s6, v82
    v_mul_f32 v24, v4, v112
    v_mul_f32 v25, v5, v112
    v_lshlrev_b32 v6, 16, v83
    v_and_b32 v7, s6, v83
    v_mul_f32 v26, v6, v112
    v_mul_f32 v27, v7, v112
    s_waitcnt vmcnt(28)
    v_lshlrev_b32 v4, 16, v84
    v_and_b32 v5, s6, v84
    v_fmac_f32 v20, v4, v113
    v_fmac_f32 v21, v5, v113
    v_lshlrev_b32 v6, 16, v85
    v_and_b32 v7, s6, v85
    v_fmac_f32 v22, v6, v113
    v_fmac_f32 v23, v7, v113
    v_lshlrev_b32 v4, 16, v86
    v_and_b32 v5, s6, v86
    v_fmac_f32 v24, v4, v113
    v_fmac_f32 v25, v5, v113
    v_lshlrev_b32 v6, 16, v87
    v_and_b32 v7, s6, v87
    v_fmac_f32 v26, v6, v113
    v_fmac_f32 v27, v7, v113
    s_waitcnt vmcnt(22)
    s_barrier
    s_add_u32 s96, s85, 10
    s_and_b32 s97, s96, 15
    s_lshl3_add_u32 s98, s97, s3
    s_sub_u32 s99, s98, 4
    s_mul_i32 s96, s99, 49152
    s_lshl_b32 s97, s11, 7
    s_add_u32 s82, s96, s97
    s_sub_u32 s96, s3, 4
    s_lshl_b32 s97, s96, 10
    s_add_u32 s20, s97, 98304
    s_mov_b32 m0, s20
    s_nop 0
    buffer_load_dwordx4 v62, s[40:43], s82 offen lds
    s_add_u32 s82, s82, 2048
    s_add_u32 m0, s20, 8192
    s_nop 0
    buffer_load_dwordx4 v62, s[40:43], s82 offen lds
    s_add_u32 s82, s82, 2048
    s_add_u32 m0, s20, 16384
    s_nop 0
    buffer_load_dwordx4 v62, s[40:43], s82 offen lds
    s_add_u32 s96, s85, 10
    s_and_b32 s97, s96, 15
    s_lshl3_add_u32 s98, s97, s3
    s_mul_i32 s99, s98, 49152
    s_lshl_b32 s96, s11, 7
    s_add_u32 s82, s99, s96
    s_lshl_b32 s96, s3, 10
    s_add_u32 s20, s96, 98304
    s_mov_b32 m0, s20
    s_nop 0
    buffer_load_dwordx4 v62, s[40:43], s82 offen lds
    s_add_u32 s82, s82, 2048
    s_add_u32 m0, s20, 8192
    s_nop 0
    buffer_load_dwordx4 v62, s[40:43], s82 offen lds
    s_add_u32 s82, s82, 2048
    s_add_u32 m0, s20, 16384
    s_nop 0
    buffer_load_dwordx4 v62, s[40:43], s82 offen lds
    s_waitcnt vmcnt(22)
    s_barrier
    s_add_u32 s96, s85, 11
    s_and_b32 s97, s96, 15
    s_lshl3_add_u32 s98, s97, s3
    s_sub_u32 s99, s98, 4
    s_mul_i32 s96, s99, 49152
    s_lshl_b32 s97, s11, 7
    s_add_u32 s82, s96, s97
    s_sub_u32 s96, s3, 4
    s_lshl_b32 s97, s96, 10
    s_add_u32 s20, s97, 122880
    s_mov_b32 m0, s20
    s_nop 0
    buffer_load_dwordx4 v62, s[40:43], s82 offen lds
    s_add_u32 s82, s82, 2048
    s_add_u32 m0, s20, 8192
    s_nop 0
    buffer_load_dwordx4 v62, s[40:43], s82 offen lds
    s_add_u32 s82, s82, 2048
    s_add_u32 m0, s20, 16384
    s_nop 0
    buffer_load_dwordx4 v62, s[40:43], s82 offen lds
    s_add_u32 s96, s85, 11
    s_and_b32 s97, s96, 15
    s_lshl3_add_u32 s98, s97, s3
    s_mul_i32 s99, s98, 49152
    s_lshl_b32 s96, s11, 7
    s_add_u32 s82, s99, s96
    s_lshl_b32 s96, s3, 10
    s_add_u32 s20, s96, 122880
    s_mov_b32 m0, s20
    s_nop 0
    buffer_load_dwordx4 v62, s[40:43], s82 offen lds
    s_add_u32 s82, s82, 2048
    s_add_u32 m0, s20, 8192
    s_nop 0
    buffer_load_dwordx4 v62, s[40:43], s82 offen lds
    s_add_u32 s82, s82, 2048
    s_add_u32 m0, s20, 16384
    s_nop 0
    buffer_load_dwordx4 v62, s[40:43], s82 offen lds
    buffer_load_dwordx4 v[104:107], v60, s[48:51], s17 offen nt
    s_add_u32 s17, s17, 98304
    buffer_load_dwordx4 v[108:111], v60, s[48:51], s17 offen nt
    s_waitcnt vmcnt(29)
    v_lshlrev_b32 v4, 16, v88
    v_and_b32 v5, s6, v88
    v_fmac_f32 v20, v4, v114
    v_fmac_f32 v21, v5, v114
    v_lshlrev_b32 v6, 16, v89
    v_and_b32 v7, s6, v89
    v_fmac_f32 v22, v6, v114
    v_fmac_f32 v23, v7, v114
    v_lshlrev_b32 v4, 16, v90
    v_and_b32 v5, s6, v90
    v_fmac_f32 v24, v4, v114
    v_fmac_f32 v25, v5, v114
    v_lshlrev_b32 v6, 16, v91
    v_and_b32 v7, s6, v91
    v_fmac_f32 v26, v6, v114
    v_fmac_f32 v27, v7, v114
    s_waitcnt vmcnt(28)
    v_lshlrev_b32 v4, 16, v92
    v_and_b32 v5, s6, v92
    v_fmac_f32 v20, v4, v115
    v_fmac_f32 v21, v5, v115
    v_lshlrev_b32 v6, 16, v93
    v_and_b32 v7, s6, v93
    v_fmac_f32 v22, v6, v115
    v_fmac_f32 v23, v7, v115
    v_lshlrev_b32 v4, 16, v94
    v_and_b32 v5, s6, v94
    v_fmac_f32 v24, v4, v115
    v_fmac_f32 v25, v5, v115
    v_lshlrev_b32 v6, 16, v95
    v_and_b32 v7, s6, v95
    v_fmac_f32 v26, v6, v115
    v_fmac_f32 v27, v7, v115
    s_waitcnt lgkmcnt(0)
    s_load_dword s24, s[32:33], s92 offset:2560 glc
    s_load_dword s25, s[32:33], s92 offset:2304 glc
    s_load_dword s26, s[32:33], s92 offset:3072 glc
    s_load_dword s27, s[32:33], s92 offset:2816 glc
    s_load_dword s28, s[32:33], s92 offset:3584 glc
    s_load_dword s29, s[32:33], s92 offset:3328 glc
    s_waitcnt vmcnt(22)
    s_barrier
    s_add_u32 s96, s85, 12
    s_and_b32 s97, s96, 15
    s_lshl3_add_u32 s98, s97, s3
    s_sub_u32 s99, s98, 4
    s_mul_i32 s96, s99, 49152
    s_lshl_b32 s97, s11, 7
    s_add_u32 s82, s96, s97
    s_sub_u32 s96, s3, 4
    s_lshl_b32 s20, s96, 10
    s_mov_b32 m0, s20
    s_nop 0
    buffer_load_dwordx4 v62, s[40:43], s82 offen lds
    s_add_u32 s82, s82, 2048
    s_add_u32 m0, s20, 8192
    s_nop 0
    buffer_load_dwordx4 v62, s[40:43], s82 offen lds
    s_add_u32 s82, s82, 2048
    s_add_u32 m0, s20, 16384
    s_nop 0
    buffer_load_dwordx4 v62, s[40:43], s82 offen lds
    s_add_u32 s96, s85, 12
    s_and_b32 s97, s96, 15
    s_lshl3_add_u32 s98, s97, s3
    s_mul_i32 s99, s98, 49152
    s_lshl_b32 s96, s11, 7
    s_add_u32 s82, s99, s96
    s_lshl_b32 s20, s3, 10
    s_mov_b32 m0, s20
    s_nop 0
    buffer_load_dwordx4 v62, s[40:43], s82 offen lds
    s_add_u32 s82, s82, 2048
    s_add_u32 m0, s20, 8192
    s_nop 0
    buffer_load_dwordx4 v62, s[40:43], s82 offen lds
    s_add_u32 s82, s82, 2048
    s_add_u32 m0, s20, 16384
    s_nop 0
    buffer_load_dwordx4 v62, s[40:43], s82 offen lds
    s_waitcnt vmcnt(22)
    s_barrier
    s_add_u32 s96, s85, 13
    s_and_b32 s97, s96, 15
    s_lshl3_add_u32 s98, s97, s3
    s_sub_u32 s99, s98, 4
    s_mul_i32 s96, s99, 49152
    s_lshl_b32 s97, s11, 7
    s_add_u32 s82, s96, s97
    s_sub_u32 s96, s3, 4
    s_lshl_b32 s97, s96, 10
    s_add_u32 s20, s97, 24576
    s_mov_b32 m0, s20
    s_nop 0
    buffer_load_dwordx4 v62, s[40:43], s82 offen lds
    s_add_u32 s82, s82, 2048
    s_add_u32 m0, s20, 8192
    s_nop 0
    buffer_load_dwordx4 v62, s[40:43], s82 offen lds
    s_add_u32 s82, s82, 2048
    s_add_u32 m0, s20, 16384
    s_nop 0
    buffer_load_dwordx4 v62, s[40:43], s82 offen lds
    s_add_u32 s96, s85, 13
    s_and_b32 s97, s96, 15
    s_lshl3_add_u32 s98, s97, s3
    s_mul_i32 s99, s98, 49152
    s_lshl_b32 s96, s11, 7
    s_add_u32 s82, s99, s96
    s_lshl_b32 s96, s3, 10
    s_add_u32 s20, s96, 24576
    s_mov_b32 m0, s20
    s_nop 0
    buffer_load_dwordx4 v62, s[40:43], s82 offen lds
    s_add_u32 s82, s82, 2048
    s_add_u32 m0, s20, 8192
    s_nop 0
    buffer_load_dwordx4 v62, s[40:43], s82 offen lds
    s_add_u32 s82, s82, 2048
    s_add_u32 m0, s20, 16384
    s_nop 0
    buffer_load_dwordx4 v62, s[40:43], s82 offen lds
    s_waitcnt vmcnt(27)
    v_lshlrev_b32 v4, 16, v96
    v_and_b32 v5, s6, v96
    v_fmac_f32 v20, v4, v116
    v_fmac_f32 v21, v5, v116
    v_lshlrev_b32 v6, 16, v97
    v_and_b32 v7, s6, v97
    v_fmac_f32 v22, v6, v116
    v_fmac_f32 v23, v7, v116
    v_lshlrev_b32 v4, 16, v98
    v_and_b32 v5, s6, v98
    v_fmac_f32 v24, v4, v116
    v_fmac_f32 v25, v5, v116
    v_lshlrev_b32 v6, 16, v99
    v_and_b32 v7, s6, v99
    v_fmac_f32 v26, v6, v116
    v_fmac_f32 v27, v7, v116
    s_waitcnt vmcnt(26)
    v_lshlrev_b32 v4, 16, v100
    v_and_b32 v5, s6, v100
    v_fmac_f32 v20, v4, v117
    v_fmac_f32 v21, v5, v117
    v_lshlrev_b32 v6, 16, v101
    v_and_b32 v7, s6, v101
    v_fmac_f32 v22, v6, v117
    v_fmac_f32 v23, v7, v117
    v_lshlrev_b32 v4, 16, v102
    v_and_b32 v5, s6, v102
    v_fmac_f32 v24, v4, v117
    v_fmac_f32 v25, v5, v117
    v_lshlrev_b32 v6, 16, v103
    v_and_b32 v7, s6, v103
    v_fmac_f32 v26, v6, v117
    v_fmac_f32 v27, v7, v117
    s_lshl_b32 s96, s74, 13
    s_sub_u32 s97, s3, 4
    s_lshl_b32 s98, s97, 8
    s_add_u32 s99, s96, s98
    s_add_u32 s13, s99, 20971520
    s_waitcnt lgkmcnt(0)
    s_load_dword s24, s[32:33], s13 offset:1276 glc
    s_load_dword s25, s[32:33], s13 offset:3324 glc
    s_load_dword s26, s[32:33], s13 offset:5372 glc
    s_load_dword s27, s[32:33], s13 offset:7420 glc
    s_waitcnt vmcnt(20)
    s_barrier
    s_add_u32 s96, s85, 14
    s_and_b32 s97, s96, 15
    s_lshl3_add_u32 s98, s97, s3
    s_sub_u32 s99, s98, 4
    s_mul_i32 s96, s99, 49152
    s_lshl_b32 s97, s11, 7
    s_add_u32 s82, s96, s97
    s_sub_u32 s96, s3, 4
    s_lshl_b32 s97, s96, 10
    s_add_u32 s20, s97, 49152
    s_mov_b32 m0, s20
    s_nop 0
    buffer_load_dwordx4 v62, s[40:43], s82 offen lds
    s_add_u32 s82, s82, 2048
    s_add_u32 m0, s20, 8192
    s_nop 0
    buffer_load_dwordx4 v62, s[40:43], s82 offen lds
    s_add_u32 s82, s82, 2048
    s_add_u32 m0, s20, 16384
    s_nop 0
    buffer_load_dwordx4 v62, s[40:43], s82 offen lds
    s_add_u32 s96, s85, 14
    s_and_b32 s97, s96, 15
    s_lshl3_add_u32 s98, s97, s3
    s_mul_i32 s99, s98, 49152
    s_lshl_b32 s96, s11, 7
    s_add_u32 s82, s99, s96
    s_lshl_b32 s96, s3, 10
    s_add_u32 s20, s96, 49152
    s_mov_b32 m0, s20
    s_nop 0
    buffer_load_dwordx4 v62, s[40:43], s82 offen lds
    s_add_u32 s82, s82, 2048
    s_add_u32 m0, s20, 8192
    s_nop 0
    buffer_load_dwordx4 v62, s[40:43], s82 offen lds
    s_add_u32 s82, s82, 2048
    s_add_u32 m0, s20, 16384
    s_nop 0
    buffer_load_dwordx4 v62, s[40:43], s82 offen lds
    s_waitcnt vmcnt(19)
    v_lshlrev_b32 v4, 16, v104
    v_and_b32 v5, s6, v104
    v_fmac_f32 v20, v4, v118
    v_fmac_f32 v21, v5, v118
    v_lshlrev_b32 v6, 16, v105
    v_and_b32 v7, s6, v105
    v_fmac_f32 v22, v6, v118
    v_fmac_f32 v23, v7, v118
    v_lshlrev_b32 v4, 16, v106
    v_and_b32 v5, s6, v106
    v_fmac_f32 v24, v4, v118
    v_fmac_f32 v25, v5, v118
    v_lshlrev_b32 v6, 16, v107
    v_and_b32 v7, s6, v107
    v_fmac_f32 v26, v6, v118
    v_fmac_f32 v27, v7, v118
    s_waitcnt vmcnt(18)
    v_lshlrev_b32 v4, 16, v108
    v_and_b32 v5, s6, v108
    v_fmac_f32 v20, v4, v119
    v_fmac_f32 v21, v5, v119
    v_lshlrev_b32 v6, 16, v109
    v_and_b32 v7, s6, v109
    v_fmac_f32 v22, v6, v119
    v_fmac_f32 v23, v7, v119
    v_lshlrev_b32 v4, 16, v110
    v_and_b32 v5, s6, v110
    v_fmac_f32 v24, v4, v119
    v_fmac_f32 v25, v5, v119
    v_lshlrev_b32 v6, 16, v111
    v_and_b32 v7, s6, v111
    v_fmac_f32 v26, v6, v119
    v_fmac_f32 v27, v7, v119
    s_barrier
    s_add_u32 s96, s85, 15
    s_and_b32 s97, s96, 15
    s_lshl3_add_u32 s98, s97, s3
    s_sub_u32 s99, s98, 4
    s_mul_i32 s96, s99, 49152
    s_lshl_b32 s97, s11, 7
    s_add_u32 s82, s96, s97
    s_sub_u32 s96, s3, 4
    s_lshl_b32 s97, s96, 10
    s_add_u32 s20, s97, 73728
    s_mov_b32 m0, s20
    s_nop 0
    buffer_load_dwordx4 v62, s[40:43], s82 offen lds
    s_add_u32 s82, s82, 2048
    s_add_u32 m0, s20, 8192
    s_nop 0
    buffer_load_dwordx4 v62, s[40:43], s82 offen lds
    s_add_u32 s82, s82, 2048
    s_add_u32 m0, s20, 16384
    s_nop 0
    buffer_load_dwordx4 v62, s[40:43], s82 offen lds
    s_add_u32 s96, s85, 15
    s_and_b32 s97, s96, 15
    s_lshl3_add_u32 s98, s97, s3
    s_mul_i32 s99, s98, 49152
    s_lshl_b32 s96, s11, 7
    s_add_u32 s82, s99, s96
    s_lshl_b32 s96, s3, 10
    s_add_u32 s20, s96, 73728
    s_mov_b32 m0, s20
    s_nop 0
    buffer_load_dwordx4 v62, s[40:43], s82 offen lds
    s_add_u32 s82, s82, 2048
    s_add_u32 m0, s20, 8192
    s_nop 0
    buffer_load_dwordx4 v62, s[40:43], s82 offen lds
    s_add_u32 s82, s82, 2048
    s_add_u32 m0, s20, 16384
    s_nop 0
    buffer_load_dwordx4 v62, s[40:43], s82 offen lds
    v_permlane32_swap_b32 v20, v24
    v_permlane32_swap_b32 v21, v25
    v_permlane32_swap_b32 v22, v26
    v_permlane32_swap_b32 v23, v27
    v_add_f32 v20, v20, v24
    v_add_f32 v21, v21, v25
    v_add_f32 v22, v22, v26
    v_add_f32 v23, v23, v27
    s_nop 0
    v_permlane16_swap_b32 v20, v22
    v_permlane16_swap_b32 v21, v23
    v_add_f32 v20, v20, v22
    v_add_f32 v21, v21, v23
    s_nop 0
    v_add_f32_dpp v20, v20, v20 row_ror:8 row_mask:0xf bank_mask:0xf
    v_add_f32_dpp v21, v21, v21 row_ror:8 row_mask:0xf bank_mask:0xf
    s_nop 1
    v_mov_b32_dpp v20, v21 quad_perm:[0,1,2,3] row_mask:0xf bank_mask:0xc
    ds_write_b32 v65, v20 offset:2048
    s_waitcnt lgkmcnt(0)
    s_waitcnt vmcnt(18)
    s_barrier
    s_cmp_lg_u32 s3, 4
    s_cbranch_scc1 L_M2F
    ds_read_b128 v[20:23], v64 offset:2064
    s_lshr_b32 s96, s8, 2
    s_lshl1_add_u32 s97, s9, s96
    s_and_b32 s98, s8, 3
    s_lshl2_add_u32 s99, s97, s98
    s_lshl_b32 s96, s99, 9
    s_add_u32 s13, s96, 131072
    s_waitcnt lgkmcnt(0)
    v_add_f32 v20, v20, v21
    v_add_f32 v22, v22, v23
    v_mov_b32 v21, s4
    v_add_f32 v20, v20, v22
    buffer_store_dwordx2 v[20:21], v63, s[32:35], s13 offen sc1
L_M2F:
    s_waitcnt vmcnt(12)
    s_waitcnt vmcnt(6)
    s_waitcnt vmcnt(0)
    s_barrier
    s_barrier
    s_add_u32 s96, s84, 983040
    s_and_b32 s97, s96, 1048575
    s_xor_b32 s98, s88, 1048576
    s_add_u32 s13, s97, s98
    s_add_u32 m0, s89, 94208
    s_nop 0
    buffer_load_dwordx4 v74, s[44:47], s13 offen lds
    s_add_u32 s96, s84, 1048576
    s_and_b32 s97, s96, 1048575
    s_xor_b32 s98, s88, 1048576
    s_add_u32 s13, s97, s98
    s_add_u32 m0, s89, 98304
    s_nop 0
    buffer_load_dwordx4 v74, s[44:47], s13 offen lds
    s_add_u32 s96, s84, 1114112
    s_and_b32 s97, s96, 1048575
    s_xor_b32 s98, s88, 1048576
    s_add_u32 s13, s97, s98
    s_add_u32 m0, s89, 102400
    s_nop 0
    buffer_load_dwordx4 v74, s[44:47], s13 offen lds
    s_add_u32 s96, s84, 1179648
    s_and_b32 s97, s96, 1048575
    s_xor_b32 s98, s88, 1048576
    s_add_u32 s13, s97, s98
    s_add_u32 m0, s89, 106496
    s_nop 0
    buffer_load_dwordx4 v74, s[44:47], s13 offen lds
    s_add_u32 s96, s84, 1245184
    s_and_b32 s97, s96, 1048575
    s_xor_b32 s98, s88, 1048576
    s_add_u32 s13, s97, s98
    s_add_u32 m0, s89, 110592
    s_nop 0
    buffer_load_dwordx4 v74, s[44:47], s13 offen lds
    s_add_u32 s96, s84, 1310720
    s_and_b32 s97, s96, 1048575
    s_xor_b32 s98, s88, 1048576
    s_add_u32 s13, s97, s98
    s_add_u32 m0, s89, 114688
    s_nop 0
    buffer_load_dwordx4 v74, s[44:47], s13 offen lds
    s_add_u32 s96, s84, 1376256
    s_and_b32 s97, s96, 1048575
    s_xor_b32 s98, s88, 1048576
    s_add_u32 s13, s97, s98
    s_add_u32 m0, s89, 118784
    s_nop 0
    buffer_load_dwordx4 v74, s[44:47], s13 offen lds
    s_add_u32 s96, s84, 1441792
    s_and_b32 s97, s96, 1048575
    s_xor_b32 s98, s88, 1048576
    s_add_u32 s13, s97, s98
    s_add_u32 m0, s89, 122880
    s_nop 0
    buffer_load_dwordx4 v74, s[44:47], s13 offen lds
    s_mov_b32 s13, s80
    buffer_load_dwordx4 v[176:179], v72, s[52:55], s13 offen nt
    s_add_u32 s13, s80, 4294049792
    buffer_load_dwordx4 v[180:183], v72, s[52:55], s13 offen nt
    s_add_u32 s13, s80, 57344
    buffer_load_dwordx4 v[184:187], v72, s[52:55], s13 offen nt
    s_add_u32 s13, s80, 4294107136
    buffer_load_dwordx4 v[188:191], v72, s[52:55], s13 offen nt
    s_add_u32 s13, s80, 114688
    buffer_load_dwordx4 v[192:195], v72, s[52:55], s13 offen nt
    s_add_u32 s13, s80, 4294164480
    buffer_load_dwordx4 v[196:199], v72, s[52:55], s13 offen nt
    s_add_u32 s13, s80, 172032
    buffer_load_dwordx4 v[200:203], v72, s[52:55], s13 offen nt
    s_add_u32 s13, s80, 4294221824
    buffer_load_dwordx4 v[204:207], v72, s[52:55], s13 offen nt
    s_waitcnt lgkmcnt(0)
    s_barrier
    ds_read_b128 v[36:39], v76
    ds_read_b128 v[40:43], v76 offset:1024
    s_waitcnt lgkmcnt(0)
    v_mfma_f32_32x32x16_bf16 v[112:127], v[28:31], v[36:39], 0
    v_mfma_f32_32x32x16_bf16 v[112:127], v[32:35], v[40:43], v[112:127]
    s_mov_b32 s13, s80
    buffer_load_dwordx4 v[208:211], v72, s[56:59], s13 offen nt
    s_add_u32 s13, s80, 4294049792
    buffer_load_dwordx4 v[212:215], v72, s[56:59], s13 offen nt
    s_add_u32 s13, s80, 57344
    buffer_load_dwordx4 v[216:219], v72, s[56:59], s13 offen nt
    s_add_u32 s13, s80, 4294107136
    buffer_load_dwordx4 v[220:223], v72, s[56:59], s13 offen nt
L_JOIN:
    s_nop 3
    v_cvt_pk_bf16_f32 v112, 0, v112
    v_cvt_pk_bf16_f32 v113, 0, v113
    v_cvt_pk_bf16_f32 v114, 0, v114
    v_cvt_pk_bf16_f32 v115, 0, v115
    v_cvt_pk_bf16_f32 v116, 0, v116
    v_cvt_pk_bf16_f32 v117, 0, v117
    v_cvt_pk_bf16_f32 v118, 0, v118
    v_cvt_pk_bf16_f32 v119, 0, v119
    v_cvt_pk_bf16_f32 v120, 0, v120
    v_cvt_pk_bf16_f32 v121, 0, v121
    v_cvt_pk_bf16_f32 v122, 0, v122
    v_cvt_pk_bf16_f32 v123, 0, v123
    v_cvt_pk_bf16_f32 v124, 0, v124
    v_cvt_pk_bf16_f32 v125, 0, v125
    v_cvt_pk_bf16_f32 v126, 0, v126
    v_cvt_pk_bf16_f32 v127, 0, v127
    v_max3_f32 v4, v112, v113, v114
    v_min3_f32 v5, v112, v113, v114
    v_max3_f32 v4, v4, v115, v116
    v_min3_f32 v5, v5, v115, v116
    v_max3_f32 v4, v4, v117, v118
    v_min3_f32 v5, v5, v117, v118
    v_max3_f32 v4, v4, v119, v120
    v_min3_f32 v5, v5, v119, v120
    v_max3_f32 v4, v4, v121, v122
    v_min3_f32 v5, v5, v121, v122
    v_max3_f32 v4, v4, v123, v124
    v_min3_f32 v5, v5, v123, v124
    v_max3_f32 v4, v4, v125, v126
    v_min3_f32 v5, v5, v125, v126
    v_max_f32 v6, v4, v127
    v_min_f32 v7, v5, v127
    v_max_f32 v4, v4, v127
    v_min_f32 v5, v5, v127
    s_nop 0
    v_permlane32_swap_b32 v4, v6
    v_permlane32_swap_b32 v5, v7
    v_max_f32 v4, v4, v6
    v_min_f32 v5, v5, v7
    v_pk_mul_f32 v[4:5], v[4:5], s[6:7] op_sel:[0,1]
    v_pk_fma_f32 v[128:129], v[112:113], s[6:7], v[4:5] op_sel:[0,1,0] op_sel_hi:[1,1,0] neg_lo:[0,0,1] neg_hi:[0,0,1]
    v_pk_fma_f32 v[112:113], v[112:113], s[6:7], v[4:5] op_sel:[0,1,1] neg_lo:[1,0,0] neg_hi:[1,0,0]
    v_pk_fma_f32 v[130:131], v[114:115], s[6:7], v[4:5] op_sel:[0,1,0] op_sel_hi:[1,1,0] neg_lo:[0,0,1] neg_hi:[0,0,1]
    v_pk_fma_f32 v[114:115], v[114:115], s[6:7], v[4:5] op_sel:[0,1,1] neg_lo:[1,0,0] neg_hi:[1,0,0]
    v_pk_fma_f32 v[132:133], v[116:117], s[6:7], v[4:5] op_sel:[0,1,0] op_sel_hi:[1,1,0] neg_lo:[0,0,1] neg_hi:[0,0,1]
    v_pk_fma_f32 v[116:117], v[116:117], s[6:7], v[4:5] op_sel:[0,1,1] neg_lo:[1,0,0] neg_hi:[1,0,0]
    v_pk_fma_f32 v[134:135], v[118:119], s[6:7], v[4:5] op_sel:[0,1,0] op_sel_hi:[1,1,0] neg_lo:[0,0,1] neg_hi:[0,0,1]
    v_pk_fma_f32 v[118:119], v[118:119], s[6:7], v[4:5] op_sel:[0,1,1] neg_lo:[1,0,0] neg_hi:[1,0,0]
    v_pk_fma_f32 v[136:137], v[120:121], s[6:7], v[4:5] op_sel:[0,1,0] op_sel_hi:[1,1,0] neg_lo:[0,0,1] neg_hi:[0,0,1]
    v_pk_fma_f32 v[120:121], v[120:121], s[6:7], v[4:5] op_sel:[0,1,1] neg_lo:[1,0,0] neg_hi:[1,0,0]
    v_pk_fma_f32 v[138:139], v[122:123], s[6:7], v[4:5] op_sel:[0,1,0] op_sel_hi:[1,1,0] neg_lo:[0,0,1] neg_hi:[0,0,1]
    v_pk_fma_f32 v[122:123], v[122:123], s[6:7], v[4:5] op_sel:[0,1,1] neg_lo:[1,0,0] neg_hi:[1,0,0]
    v_pk_fma_f32 v[140:141], v[124:125], s[6:7], v[4:5] op_sel:[0,1,0] op_sel_hi:[1,1,0] neg_lo:[0,0,1] neg_hi:[0,0,1]
    v_pk_fma_f32 v[124:125], v[124:125], s[6:7], v[4:5] op_sel:[0,1,1] neg_lo:[1,0,0] neg_hi:[1,0,0]
    v_pk_fma_f32 v[142:143], v[126:127], s[6:7], v[4:5] op_sel:[0,1,0] op_sel_hi:[1,1,0] neg_lo:[0,0,1] neg_hi:[0,0,1]
    v_pk_fma_f32 v[126:127], v[126:127], s[6:7], v[4:5] op_sel:[0,1,1] neg_lo:[1,0,0] neg_hi:[1,0,0]
    v_exp_f32 v128, v128
    v_exp_f32 v112, v112
    v_exp_f32 v129, v129
    v_exp_f32 v113, v113
    v_exp_f32 v130, v130
    v_exp_f32 v114, v114
    v_exp_f32 v131, v131
    v_exp_f32 v115, v115
    v_exp_f32 v132, v132
    v_exp_f32 v116, v116
    v_exp_f32 v133, v133
    v_exp_f32 v117, v117
    v_exp_f32 v134, v134
    v_exp_f32 v118, v118
    v_exp_f32 v135, v135
    v_exp_f32 v119, v119
    v_exp_f32 v136, v136
    v_exp_f32 v120, v120
    v_exp_f32 v137, v137
    v_exp_f32 v121, v121
    v_exp_f32 v138, v138
    v_exp_f32 v122, v122
    v_exp_f32 v139, v139
    v_exp_f32 v123, v123
    v_exp_f32 v140, v140
    v_exp_f32 v124, v124
    v_exp_f32 v141, v141
    v_exp_f32 v125, v125
    v_exp_f32 v142, v142
    v_exp_f32 v126, v126
    v_exp_f32 v143, v143
    v_exp_f32 v127, v127
    v_pk_add_f32 v[8:9], v[128:129], v[130:131]
    v_pk_add_f32 v[10:11], v[112:113], v[114:115]
    v_pk_add_f32 v[8:9], v[8:9], v[132:133]
    v_pk_add_f32 v[10:11], v[10:11], v[116:117]
    v_pk_add_f32 v[8:9], v[8:9], v[134:135]
    v_pk_add_f32 v[10:11], v[10:11], v[118:119]
    v_pk_add_f32 v[8:9], v[8:9], v[136:137]
    v_pk_add_f32 v[10:11], v[10:11], v[120:121]
    v_pk_add_f32 v[8:9], v[8:9], v[138:139]
    v_pk_add_f32 v[10:11], v[10:11], v[122:123]
    v_pk_add_f32 v[8:9], v[8:9], v[140:141]
    v_pk_add_f32 v[10:11], v[10:11], v[124:125]
    v_pk_add_f32 v[8:9], v[8:9], v[142:143]
    v_pk_add_f32 v[10:11], v[10:11], v[126:127]
    v_add_f32 v6, v8, v9
    v_add_f32 v7, v10, v11
    v_add_f32 v4, v8, v9
    v_add_f32 v5, v10, v11
    s_nop 0
    v_permlane32_swap_b32 v4, v6
    v_permlane32_swap_b32 v5, v7
    v_pk_add_f32 v[4:5], v[4:5], v[6:7]
    v_rcp_f32 v4, v4
    v_rcp_f32 v5, v5
    s_nop 0
    v_pk_mul_f32 v[128:129], v[128:129], v[4:5] op_sel_hi:[1,0]
    v_pk_mul_f32 v[112:113], v[112:113], v[4:5] op_sel:[0,1]
    v_pk_mul_f32 v[130:131], v[130:131], v[4:5] op_sel_hi:[1,0]
    v_pk_mul_f32 v[114:115], v[114:115], v[4:5] op_sel:[0,1]
    v_pk_mul_f32 v[132:133], v[132:133], v[4:5] op_sel_hi:[1,0]
    v_pk_mul_f32 v[116:117], v[116:117], v[4:5] op_sel:[0,1]
    v_pk_mul_f32 v[134:135], v[134:135], v[4:5] op_sel_hi:[1,0]
    v_pk_mul_f32 v[118:119], v[118:119], v[4:5] op_sel:[0,1]
    v_pk_mul_f32 v[136:137], v[136:137], v[4:5] op_sel_hi:[1,0]
    v_pk_mul_f32 v[120:121], v[120:121], v[4:5] op_sel:[0,1]
    v_pk_mul_f32 v[138:139], v[138:139], v[4:5] op_sel_hi:[1,0]
    v_pk_mul_f32 v[122:123], v[122:123], v[4:5] op_sel:[0,1]
    v_pk_mul_f32 v[140:141], v[140:141], v[4:5] op_sel_hi:[1,0]
    v_pk_mul_f32 v[124:125], v[124:125], v[4:5] op_sel:[0,1]
    v_pk_mul_f32 v[142:143], v[142:143], v[4:5] op_sel_hi:[1,0]
    v_pk_mul_f32 v[126:127], v[126:127], v[4:5] op_sel:[0,1]
    v_cvt_pk_bf16_f32 v80, v128, v129
    v_cvt_pk_bf16_f32 v88, v112, v113
    v_cvt_pk_bf16_f32 v81, v130, v131
    v_cvt_pk_bf16_f32 v89, v114, v115
    v_cvt_pk_bf16_f32 v82, v132, v133
    v_cvt_pk_bf16_f32 v90, v116, v117
    v_cvt_pk_bf16_f32 v83, v134, v135
    v_cvt_pk_bf16_f32 v91, v118, v119
    v_cvt_pk_bf16_f32 v84, v136, v137
    v_cvt_pk_bf16_f32 v92, v120, v121
    v_cvt_pk_bf16_f32 v85, v138, v139
    v_cvt_pk_bf16_f32 v93, v122, v123
    v_cvt_pk_bf16_f32 v86, v140, v141
    v_cvt_pk_bf16_f32 v94, v124, v125
    v_cvt_pk_bf16_f32 v87, v142, v143
    v_cvt_pk_bf16_f32 v95, v126, v127
    ds_write_b128 v75, v[80:83]
    ds_write_b128 v75, v[84:87] offset:4096
    ds_write_b128 v75, v[88:91] offset:8192
    ds_write_b128 v75, v[92:95] offset:12288
    s_lshl_b32 s13, s3, 12
    v_add_u32 v20, s13, v63
    s_lshl_b32 s96, s76, 13
    s_add_u32 s13, s96, 32768
    v_add_u32 v21, s13, v63
    v_mov_b32 v36, 0x3f803f80
    v_mov_b32 v37, 0x3f803f80
    v_mov_b32 v38, 0x3f803f80
    v_mov_b32 v39, 0x3f803f80
    s_lshl3_add_u32 s96, s11, s3
    s_lshl_b32 s97, s96, 5
    s_add_u32 s98, s97, s10
    s_lshl_b32 s99, s98, 10
    s_add_u32 s13, s99, 25165824
    s_add_u32 s15, s13, 16384
    s_lshl3_add_u32 s96, s11, s3
    s_lshl_b32 s97, s96, 10
    s_add_u32 s16, s97, 21495808
    s_lshl_b32 s96, s10, 6
    s_add_u32 s14, s96, s16
    s_waitcnt lgkmcnt(0)
    s_barrier
    ds_read_b64_tr_b16 v[128:129], v20
    ds_read_b64_tr_b16 v[130:131], v20 offset:512
    ds_read_b64_tr_b16 v[144:145], v21
    ds_read_b64_tr_b16 v[146:147], v21 offset:512
    ds_read_b64_tr_b16 v[148:149], v21 offset:4096
    ds_read_b64_tr_b16 v[150:151], v21 offset:4608
    ds_read_b64_tr_b16 v[132:133], v20 offset:1024
    ds_read_b64_tr_b16 v[134:135], v20 offset:1536
    ds_read_b64_tr_b16 v[152:153], v21 offset:1024
    ds_read_b64_tr_b16 v[154:155], v21 offset:1536
    ds_read_b64_tr_b16 v[156:157], v21 offset:5120
    ds_read_b64_tr_b16 v[158:159], v21 offset:5632
    ds_read_b64_tr_b16 v[136:137], v20 offset:2048
    ds_read_b64_tr_b16 v[138:139], v20 offset:2560
    ds_read_b64_tr_b16 v[160:161], v21 offset:2048
    ds_read_b64_tr_b16 v[162:163], v21 offset:2560
    ds_read_b64_tr_b16 v[164:165], v21 offset:6144
    ds_read_b64_tr_b16 v[166:167], v21 offset:6656
    s_waitcnt lgkmcnt(12)
    v_mfma_f32_16x16x32_bf16 v[52:55], v[128:131], v[144:147], 0
    v_mfma_f32_16x16x32_bf16 v[56:59], v[128:131], v[148:151], 0
    v_mfma_f32_16x16x32_bf16 v[40:43], v[128:131], v[36:39], 0
    ds_read_b64_tr_b16 v[140:141], v20 offset:3072
    ds_read_b64_tr_b16 v[142:143], v20 offset:3584
    ds_read_b64_tr_b16 v[168:169], v21 offset:3072
    ds_read_b64_tr_b16 v[170:171], v21 offset:3584
    ds_read_b64_tr_b16 v[172:173], v21 offset:7168
    ds_read_b64_tr_b16 v[174:175], v21 offset:7680
    s_waitcnt lgkmcnt(12)
    v_mfma_f32_16x16x32_bf16 v[52:55], v[132:135], v[152:155], v[52:55]
    v_mfma_f32_16x16x32_bf16 v[56:59], v[132:135], v[156:159], v[56:59]
    v_mfma_f32_16x16x32_bf16 v[40:43], v[132:135], v[36:39], v[40:43]
    s_waitcnt lgkmcnt(6)
    v_mfma_f32_16x16x32_bf16 v[52:55], v[136:139], v[160:163], v[52:55]
    v_mfma_f32_16x16x32_bf16 v[56:59], v[136:139], v[164:167], v[56:59]
    v_mfma_f32_16x16x32_bf16 v[40:43], v[136:139], v[36:39], v[40:43]
    s_waitcnt lgkmcnt(0)
    v_mfma_f32_16x16x32_bf16 v[52:55], v[140:143], v[168:171], v[52:55]
    v_mfma_f32_16x16x32_bf16 v[56:59], v[140:143], v[172:175], v[56:59]
    v_mfma_f32_16x16x32_bf16 v[40:43], v[140:143], v[36:39], v[40:43]
    s_cmp_lt_u32 s3, 4
    s_cbranch_scc1 L_NOQX
    ds_read_b128 v[44:47], v76 offset:2048
    ds_read_b128 v[48:51], v76 offset:3072
L_NOQX:
    s_nop 3
    buffer_store_dwordx4 v[52:55], v2, s[32:35], s13 offen sc1
    buffer_store_dwordx4 v[56:59], v2, s[32:35], s15 offen sc1
    s_mov_b32 exec_lo, 0x00010001
    s_mov_b32 exec_hi, 0x00010001
    buffer_store_dwordx4 v[40:43], v1, s[32:35], s14 offen sc1
    s_mov_b64 exec, -1
    s_waitcnt lgkmcnt(0)
    v_mfma_f32_32x32x16_bf16 v[112:127], v[28:31], v[44:47], 0
    v_mfma_f32_32x32x16_bf16 v[112:127], v[32:35], v[48:51], v[112:127]
    v_and_b32 v75, 7, v1
    v_lshlrev_b32 v75, 17, v75
    v_bfe_u32 v9, v1, 3, 1
    v_lshl_add_u32 v75, v9, 14, v75
    s_and_b32 s96, s10, 1
    s_and_b32 s97, s2, 27
    s_lshl_b32 s98, s97, 12
    s_lshr_b32 s99, s10, 1
    s_lshl_b32 s97, s99, 6
    s_add_u32 s99, s98, s97
    s_lshl2_add_u32 s98, s96, s99
    s_add_u32 s97, s98, 1048576
    s_add_u32 s17, s97, 512
    v_and_b32 v22, 15, v1
    v_lshlrev_b32 v22, 3, v22
    v_lshrrev_b32 v9, 5, v1
    v_lshl_add_u32 v22, v9, 7, v22
    v_lshrrev_b32 v23, 3, v1
    v_lshlrev_b32 v23, 10, v23
    v_and_b32 v9, 7, v1
    v_lshl_add_u32 v23, v9, 4, v23
    v_and_b32 v76, 7, v1
    v_lshlrev_b32 v76, 4, v76
    v_lshrrev_b32 v9, 5, v1
    v_lshl_add_u32 v76, v9, 3, v76
    s_lshl_b32 s96, s12, 11
    s_lshl_b32 s97, s76, 8
    s_add_u32 s98, s96, s97
    s_add_u32 s18, s98, 131072
    v_cvt_pk_bf16_f32 v112, 0, v112
    v_cvt_pk_bf16_f32 v113, 0, v113
    v_cvt_pk_bf16_f32 v114, 0, v114
    v_cvt_pk_bf16_f32 v115, 0, v115
    v_cvt_pk_bf16_f32 v116, 0, v116
    v_cvt_pk_bf16_f32 v117, 0, v117
    v_cvt_pk_bf16_f32 v118, 0, v118
    v_cvt_pk_bf16_f32 v119, 0, v119
    v_cvt_pk_bf16_f32 v120, 0, v120
    v_cvt_pk_bf16_f32 v121, 0, v121
    v_cvt_pk_bf16_f32 v122, 0, v122
    v_cvt_pk_bf16_f32 v123, 0, v123
    v_cvt_pk_bf16_f32 v124, 0, v124
    v_cvt_pk_bf16_f32 v125, 0, v125
    v_cvt_pk_bf16_f32 v126, 0, v126
    v_cvt_pk_bf16_f32 v127, 0, v127
    v_max3_f32 v4, v112, v113, v114
    v_min3_f32 v5, v112, v113, v114
    v_max3_f32 v4, v4, v115, v116
    v_min3_f32 v5, v5, v115, v116
    v_max3_f32 v4, v4, v117, v118
    v_min3_f32 v5, v5, v117, v118
    v_max3_f32 v4, v4, v119, v120
    v_min3_f32 v5, v5, v119, v120
    v_max3_f32 v4, v4, v121, v122
    v_min3_f32 v5, v5, v121, v122
    v_max3_f32 v4, v4, v123, v124
    v_min3_f32 v5, v5, v123, v124
    v_max3_f32 v4, v4, v125, v126
    v_min3_f32 v5, v5, v125, v126
    v_max_f32 v6, v4, v127
    v_min_f32 v7, v5, v127
    v_max_f32 v4, v4, v127
    v_min_f32 v5, v5, v127
    s_nop 0
    v_permlane32_swap_b32 v4, v6
    v_permlane32_swap_b32 v5, v7
    v_max_f32 v4, v4, v6
    v_min_f32 v5, v5, v7
    v_pk_mul_f32 v[4:5], v[4:5], s[6:7] op_sel:[0,1]
    v_pk_fma_f32 v[128:129], v[112:113], s[6:7], v[4:5] op_sel:[0,1,0] op_sel_hi:[1,1,0] neg_lo:[0,0,1] neg_hi:[0,0,1]
    v_pk_fma_f32 v[112:113], v[112:113], s[6:7], v[4:5] op_sel:[0,1,1] neg_lo:[1,0,0] neg_hi:[1,0,0]
    v_pk_fma_f32 v[130:131], v[114:115], s[6:7], v[4:5] op_sel:[0,1,0] op_sel_hi:[1,1,0] neg_lo:[0,0,1] neg_hi:[0,0,1]
    v_pk_fma_f32 v[114:115], v[114:115], s[6:7], v[4:5] op_sel:[0,1,1] neg_lo:[1,0,0] neg_hi:[1,0,0]
    v_pk_fma_f32 v[132:133], v[116:117], s[6:7], v[4:5] op_sel:[0,1,0] op_sel_hi:[1,1,0] neg_lo:[0,0,1] neg_hi:[0,0,1]
    v_pk_fma_f32 v[116:117], v[116:117], s[6:7], v[4:5] op_sel:[0,1,1] neg_lo:[1,0,0] neg_hi:[1,0,0]
    v_pk_fma_f32 v[134:135], v[118:119], s[6:7], v[4:5] op_sel:[0,1,0] op_sel_hi:[1,1,0] neg_lo:[0,0,1] neg_hi:[0,0,1]
    v_pk_fma_f32 v[118:119], v[118:119], s[6:7], v[4:5] op_sel:[0,1,1] neg_lo:[1,0,0] neg_hi:[1,0,0]
    v_pk_fma_f32 v[136:137], v[120:121], s[6:7], v[4:5] op_sel:[0,1,0] op_sel_hi:[1,1,0] neg_lo:[0,0,1] neg_hi:[0,0,1]
    v_pk_fma_f32 v[120:121], v[120:121], s[6:7], v[4:5] op_sel:[0,1,1] neg_lo:[1,0,0] neg_hi:[1,0,0]
    v_pk_fma_f32 v[138:139], v[122:123], s[6:7], v[4:5] op_sel:[0,1,0] op_sel_hi:[1,1,0] neg_lo:[0,0,1] neg_hi:[0,0,1]
    v_pk_fma_f32 v[122:123], v[122:123], s[6:7], v[4:5] op_sel:[0,1,1] neg_lo:[1,0,0] neg_hi:[1,0,0]
    v_pk_fma_f32 v[140:141], v[124:125], s[6:7], v[4:5] op_sel:[0,1,0] op_sel_hi:[1,1,0] neg_lo:[0,0,1] neg_hi:[0,0,1]
    v_pk_fma_f32 v[124:125], v[124:125], s[6:7], v[4:5] op_sel:[0,1,1] neg_lo:[1,0,0] neg_hi:[1,0,0]
    v_pk_fma_f32 v[142:143], v[126:127], s[6:7], v[4:5] op_sel:[0,1,0] op_sel_hi:[1,1,0] neg_lo:[0,0,1] neg_hi:[0,0,1]
    v_pk_fma_f32 v[126:127], v[126:127], s[6:7], v[4:5] op_sel:[0,1,1] neg_lo:[1,0,0] neg_hi:[1,0,0]
    v_exp_f32 v128, v128
    v_exp_f32 v112, v112
    v_exp_f32 v129, v129
    v_exp_f32 v113, v113
    v_exp_f32 v130, v130
    v_exp_f32 v114, v114
    v_exp_f32 v131, v131
    v_exp_f32 v115, v115
    v_exp_f32 v132, v132
    v_exp_f32 v116, v116
    v_exp_f32 v133, v133
    v_exp_f32 v117, v117
    v_exp_f32 v134, v134
    v_exp_f32 v118, v118
    v_exp_f32 v135, v135
    v_exp_f32 v119, v119
    s_waitcnt vmcnt(0)
    s_barrier
    s_cmp_lg_u32 s3, 0
    s_cbranch_scc1 L_PC
    v_mov_b32 v21, s4
    s_mov_b32 exec_hi, 0
    s_mov_b32 exec_lo, 65535
    buffer_store_dword v21, v75, s[32:35], s17 offen sc1
    s_mov_b64 exec, -1
L_PC:
    s_cmp_eq_u32 s90, 0
    s_cbranch_scc1 L_NOMF0
    buffer_load_dwordx2 v[52:53], v63, s[32:35], s90 offen sc1
    buffer_load_dwordx2 v[54:55], v63, s[32:35], s90 offen offset:512 sc1
    buffer_load_dwordx2 v[56:57], v63, s[32:35], s90 offen offset:1024 sc1
    buffer_load_dwordx2 v[58:59], v63, s[32:35], s90 offen offset:1536 sc1
L_NOMF0:
    s_add_u32 s96, s84, 262144
    s_and_b32 s97, s96, 1048575
    s_add_u32 s19, s97, s88
    s_add_u32 m0, s89, 49152
    s_nop 0
    buffer_load_dwordx4 v74, s[44:47], s19 offen lds
    v_exp_f32 v136, v136
    v_exp_f32 v120, v120
    v_exp_f32 v137, v137
    v_exp_f32 v121, v121
    v_exp_f32 v138, v138
    v_exp_f32 v122, v122
    v_exp_f32 v139, v139
    v_exp_f32 v123, v123
    s_add_u32 s96, s84, 393216
    s_and_b32 s97, s96, 1048575
    s_add_u32 s19, s97, s88
    s_add_u32 m0, s89, 57344
    s_nop 0
    buffer_load_dwordx4 v74, s[44:47], s19 offen lds
    v_exp_f32 v140, v140
    v_exp_f32 v124, v124
    v_exp_f32 v141, v141
    v_exp_f32 v125, v125
    v_exp_f32 v142, v142
    v_exp_f32 v126, v126
    v_exp_f32 v143, v143
    v_exp_f32 v127, v127
    s_lshl4_add_u32 s96, s11, s10
    s_lshl_b32 s97, s96, 14
    s_lshl_b32 s98, s3, 7
    s_add_u32 s99, s97, s98
    s_add_u32 s13, s99, 25165824
    s_add_u32 s14, s13, 8192
    s_lshl4_add_u32 s96, s11, s10
    s_lshl_b32 s97, s96, 10
    s_lshl_b32 s98, s3, 7
    s_add_u32 s99, s97, s98
    s_add_u32 s15, s99, 29360128
    s_add_u32 s17, s17, 3072
    s_load_dwordx2 s[24:25], s[32:33], s92 offset:512 glc
    s_add_u32 s96, s84, 524288
    s_and_b32 s97, s96, 1048575
    s_add_u32 s19, s97, s88
    s_add_u32 m0, s89, 65536
    s_nop 0
    buffer_load_dwordx4 v74, s[44:47], s19 offen lds
    v_pk_add_f32 v[8:9], v[128:129], v[130:131]
    v_pk_add_f32 v[10:11], v[112:113], v[114:115]
    v_pk_add_f32 v[8:9], v[8:9], v[132:133]
    v_pk_add_f32 v[10:11], v[10:11], v[116:117]
    v_pk_add_f32 v[8:9], v[8:9], v[134:135]
    v_pk_add_f32 v[10:11], v[10:11], v[118:119]
    v_pk_add_f32 v[8:9], v[8:9], v[136:137]
    v_pk_add_f32 v[10:11], v[10:11], v[120:121]
    v_pk_add_f32 v[8:9], v[8:9], v[138:139]
    v_pk_add_f32 v[10:11], v[10:11], v[122:123]
    v_pk_add_f32 v[8:9], v[8:9], v[140:141]
    v_pk_add_f32 v[10:11], v[10:11], v[124:125]
    v_pk_add_f32 v[8:9], v[8:9], v[142:143]
    v_pk_add_f32 v[10:11], v[10:11], v[126:127]
    s_add_u32 s96, s84, 655360
    s_and_b32 s97, s96, 1048575
    s_add_u32 s19, s97, s88
    s_add_u32 m0, s89, 73728
    s_nop 0
    buffer_load_dwordx4 v74, s[44:47], s19 offen lds
    v_add_f32 v6, v8, v9
    v_add_f32 v7, v10, v11
    v_add_f32 v4, v8, v9
    v_add_f32 v5, v10, v11
    s_nop 0
    v_permlane32_swap_b32 v4, v6
    v_permlane32_swap_b32 v5, v7
    v_pk_add_f32 v[4:5], v[4:5], v[6:7]
    v_rcp_f32 v4, v4
    v_rcp_f32 v5, v5
    s_nop 0
    v_pk_mul_f32 v[128:129], v[128:129], v[4:5] op_sel_hi:[1,0]
    v_pk_mul_f32 v[112:113], v[112:113], v[4:5] op_sel:[0,1]
    v_pk_mul_f32 v[130:131], v[130:131], v[4:5] op_sel_hi:[1,0]
    v_pk_mul_f32 v[114:115], v[114:115], v[4:5] op_sel:[0,1]
    v_pk_mul_f32 v[132:133], v[132:133], v[4:5] op_sel_hi:[1,0]
    s_add_u32 s96, s84, 786432
    s_and_b32 s97, s96, 1048575
    s_add_u32 s19, s97, s88
    s_add_u32 m0, s89, 81920
    s_nop 0
    buffer_load_dwordx4 v74, s[44:47], s19 offen lds
    v_pk_mul_f32 v[116:117], v[116:117], v[4:5] op_sel:[0,1]
    v_pk_mul_f32 v[134:135], v[134:135], v[4:5] op_sel_hi:[1,0]
    v_pk_mul_f32 v[118:119], v[118:119], v[4:5] op_sel:[0,1]
    v_pk_mul_f32 v[136:137], v[136:137], v[4:5] op_sel_hi:[1,0]
    v_pk_mul_f32 v[120:121], v[120:121], v[4:5] op_sel:[0,1]
    v_pk_mul_f32 v[138:139], v[138:139], v[4:5] op_sel_hi:[1,0]
    v_pk_mul_f32 v[122:123], v[122:123], v[4:5] op_sel:[0,1]
    v_pk_mul_f32 v[140:141], v[140:141], v[4:5] op_sel_hi:[1,0]
    v_pk_mul_f32 v[124:125], v[124:125], v[4:5] op_sel:[0,1]
    v_pk_mul_f32 v[142:143], v[142:143], v[4:5] op_sel_hi:[1,0]
    v_pk_mul_f32 v[126:127], v[126:127], v[4:5] op_sel:[0,1]
    v_cvt_pk_bf16_f32 v80, v128, v129
    v_cvt_pk_bf16_f32 v88, v112, v113
    v_cvt_pk_bf16_f32 v81, v130, v131
    s_add_u32 s96, s84, 917504
    s_and_b32 s97, s96, 1048575
    s_add_u32 s19, s97, s88
    s_add_u32 m0, s89, 90112
    s_nop 0
    buffer_load_dwordx4 v74, s[44:47], s19 offen lds
    v_cvt_pk_bf16_f32 v89, v114, v115
    v_cvt_pk_bf16_f32 v82, v132, v133
    v_cvt_pk_bf16_f32 v90, v116, v117
    v_cvt_pk_bf16_f32 v83, v134, v135
    v_cvt_pk_bf16_f32 v91, v118, v119
    v_cvt_pk_bf16_f32 v84, v136, v137
    v_cvt_pk_bf16_f32 v92, v120, v121
    v_cvt_pk_bf16_f32 v85, v138, v139
    v_cvt_pk_bf16_f32 v93, v122, v123
    v_cvt_pk_bf16_f32 v86, v140, v141
    v_cvt_pk_bf16_f32 v94, v124, v125
    v_cvt_pk_bf16_f32 v87, v142, v143
    v_cvt_pk_bf16_f32 v95, v126, v127
    s_branch SCHK_19
SPOLL_18:
    s_load_dwordx2 s[24:25], s[32:33], s92 offset:512 glc
SCHK_19:
    s_add_u32 s5, s5, 1
    s_cmp_ge_u32 s5, 200000
    s_waitcnt lgkmcnt(0)
    s_cbranch_scc1 SDONE_20
    s_cmp_lg_u32 s24, s4
    s_cbranch_scc1 SPOLL_18
    s_cmp_lg_u32 s25, s4
    s_cbranch_scc1 SPOLL_18
SDONE_20:
    s_barrier
    buffer_load_dwordx4 v[144:147], v23, s[32:35], s13 offen sc1
    buffer_load_dwordx4 v[148:151], v23, s[32:35], s14 offen sc1
    s_lshl_b32 s96, s3, 5
    s_add_u32 s14, s96, 8192
    v_and_b32 v6, 3, v1
    v_lshl_add_u32 v6, v6, 3, s14
    v_lshrrev_b32 v9, 5, v1
    v_lshl_add_u32 v6, v9, 2, v6
    s_lshl_b32 s14, s3, 10
    v_and_b32 v5, 15, v1
    v_lshl_add_u32 v5, v5, 4, s14
    v_lshrrev_b32 v9, 5, v1
    v_lshl_add_u32 v5, v9, 9, v5
    v_bfe_u32 v9, v1, 4, 1
    v_lshl_add_u32 v5, v9, 3, v5
    s_lshl_b32 s96, s76, 7
    s_add_u32 s14, s96, 8192
    v_lshrrev_b32 v7, 5, v1
    v_lshl_add_u32 v7, v7, 4, s14
    s_lshl_b32 s14, s76, 12
    v_add_u32 v20, s14, v2
    buffer_load_dwordx4 v[160:163], v2, s[32:35], s16 offen sc1
    s_waitcnt vmcnt(1)
    v_pk_add_f32 v[144:145], v[144:145], v[148:149]
    v_pk_add_f32 v[146:147], v[146:147], v[150:151]
    s_nop 1
    v_permlane32_swap_b32 v144, v146
    v_permlane32_swap_b32 v145, v147
    v_pk_add_f32 v[144:145], v[144:145], v[146:147]
    s_nop 1
    v_add_f32_dpp v144, v144, v144 row_ror:8 row_mask:0xf bank_mask:0xf
    v_add_f32_dpp v145, v145, v145 row_ror:8 row_mask:0xf bank_mask:0xf
    v_mov_b32 v146, v144
    v_mov_b32 v147, v145
    s_nop 0
    v_permlane16_swap_b32 v144, v146
    v_permlane16_swap_b32 v145, v147
    v_pk_add_f32 v[144:145], v[144:145], v[146:147]
    v_cvt_pk_bf16_f32 v144, v144, v145
    v_mov_b32 v145, s4
    s_mov_b32 exec_lo, 0xff
    s_mov_b32 exec_hi, 0xff
    buffer_store_dwordx2 v[144:145], v76, s[32:35], s15 offen sc1
    s_mov_b64 exec, -1
    s_barrier
    s_cmp_lg_u32 s3, 0
    s_cbranch_scc1 L_PC2
    v_mov_b32 v21, s4
    s_mov_b32 exec_hi, 0
    s_mov_b32 exec_lo, 65535
    buffer_store_dword v21, v75, s[32:35], s17 offen sc1
    s_mov_b64 exec, -1
L_PC2:
    s_waitcnt vmcnt(1)
    s_add_u32 s96, s84, 1572864
    s_and_b32 s97, s96, 1048575
    s_xor_b32 s98, s88, 1048576
    s_add_u32 s19, s97, s98
    s_add_u32 m0, s89, 131072
    s_nop 0
    buffer_load_dwordx4 v74, s[44:47], s19 offen lds
    v_permlane32_swap_b32 v160, v162
    v_permlane32_swap_b32 v161, v163
    v_pk_add_f32 v[160:161], v[160:161], v[162:163]
    s_nop 1
    v_add_f32_dpp v160, v160, v160 row_ror:4 row_mask:0xf bank_mask:0xf
    v_add_f32_dpp v161, v161, v161 row_ror:4 row_mask:0xf bank_mask:0xf
    s_add_u32 s96, s84, 1703936
    s_and_b32 s97, s96, 1048575
    s_xor_b32 s98, s88, 1048576
    s_add_u32 s19, s97, s98
    s_add_u32 m0, s89, 139264
    s_nop 0
    buffer_load_dwordx4 v74, s[44:47], s19 offen lds
    v_add_f32_dpp v160, v160, v160 row_ror:8 row_mask:0xf bank_mask:0xf
    v_add_f32_dpp v161, v161, v161 row_ror:8 row_mask:0xf bank_mask:0xf
    v_mov_b32 v162, v160
    v_mov_b32 v163, v161
    s_add_u32 s96, s84, 1835008
    s_and_b32 s97, s96, 1048575
    s_xor_b32 s98, s88, 1048576
    s_add_u32 s19, s97, s98
    s_add_u32 m0, s89, 147456
    s_nop 0
    buffer_load_dwordx4 v74, s[44:47], s19 offen lds
    v_permlane16_swap_b32 v160, v162
    v_permlane16_swap_b32 v161, v163
    v_pk_add_f32 v[160:161], v[160:161], v[162:163]
    v_cvt_pk_bf16_f32 v160, v160, v161
    ds_write_b32 v6, v160
    s_waitcnt lgkmcnt(0)
    s_barrier
    ds_read_b128 v[160:163], v7
    ds_read_b128 v[164:167], v7 offset:32
    ds_read_b128 v[168:171], v7 offset:64
    ds_read_b128 v[172:175], v7 offset:96
    s_waitcnt lgkmcnt(0)
    s_lshl3_add_u32 s96, s11, s3
    s_lshl_b32 s97, s96, 11
    s_add_u32 s13, s97, 29360128
    s_load_dwordx2 s[24:25], s[32:33], s92 offset:3584 glc
    v_mfma_f32_32x32x16_bf16 v[128:143], v[160:163], v[80:83], 0
    v_mfma_f32_32x32x16_bf16 v[128:143], v[164:167], v[84:87], v[128:143]
    v_mfma_f32_32x32x16_bf16 v[128:143], v[168:171], v[88:91], v[128:143]
    v_mfma_f32_32x32x16_bf16 v[128:143], v[172:175], v[92:95], v[128:143]
    s_nop 11
    v_cvt_pk_bf16_f32 v128, 0, v128
    v_add_f32 v128, 0x358637bd, v128
    v_cvt_pk_bf16_f32 v128, 0, v128
    v_rcp_f32 v128, v128
    s_cmp_eq_u32 s90, 0
    s_cbranch_scc1 L_NOMF1
    v_bitop3_b32 v4, v53, v55, s4 bitop3:0x7e
    v_bitop3_b32 v4, v4, v57, s4 bitop3:0xf6
    v_bitop3_b32 v4, v4, v59, s4 bitop3:0xf6
    v_cmp_ne_u32 vcc, 0, v4
    s_cbranch_vccz L_MFOK
POLL_24:
    buffer_load_dwordx2 v[52:53], v63, s[32:35], s90 offen sc1
    buffer_load_dwordx2 v[54:55], v63, s[32:35], s90 offen offset:512 sc1
    buffer_load_dwordx2 v[56:57], v63, s[32:35], s90 offen offset:1024 sc1
    buffer_load_dwordx2 v[58:59], v63, s[32:35], s90 offen offset:1536 sc1
    s_waitcnt vmcnt(0)
    v_bitop3_b32 v4, v53, v55, s4 bitop3:0x7e
    v_bitop3_b32 v4, v4, v57, s4 bitop3:0xf6
    v_bitop3_b32 v4, v4, v59, s4 bitop3:0xf6
    v_cmp_ne_u32 vcc, 0, v4
    s_cbranch_vccz PDONE_25
    s_add_u32 s5, s5, 1
    s_cmp_lt_u32 s5, 200000
    s_cbranch_scc1 POLL_24
PDONE_25:
L_MFOK:
    v_add_f32 v52, v52, v54
    v_add_f32 v56, v56, v58
    v_add_f32 v52, v52, v56
    v_cvt_pk_bf16_f32 v52, 0, v52
    s_cmp_eq_u32 s8, 1
    s_cselect_b32 s19, 1.0, 0
    v_add_f32 v52, s19, v52
    v_cvt_pk_bf16_f32 v52, 0, v52
    s_lshl4_add_u32 s96, s8, s9
    s_lshl_b32 s97, s96, 9
    s_add_u32 s19, s97, 65536
    buffer_store_dwordx2 v[52:53], v63, s[32:35], s19 offen sc1
L_NOMF1:
    s_branch SCHK_22
SPOLL_21:
    s_load_dwordx2 s[24:25], s[32:33], s92 offset:3584 glc
SCHK_22:
    s_add_u32 s5, s5, 1
    s_cmp_ge_u32 s5, 200000
    s_waitcnt lgkmcnt(0)
    s_cbranch_scc1 SDONE_23
    s_cmp_lg_u32 s24, s4
    s_cbranch_scc1 SPOLL_21
    s_cmp_lg_u32 s25, s4
    s_cbranch_scc1 SPOLL_21
SDONE_23:
POLL_26:
    buffer_load_dwordx4 v[152:155], v2, s[32:35], s13 offen sc1
    buffer_load_dwordx4 v[156:159], v2, s[32:35], s13 offen offset:1024 sc1
    s_waitcnt vmcnt(0)
    v_bitop3_b32 v4, v153, v155, s4 bitop3:0x7e
    v_bitop3_b32 v4, v4, v157, s4 bitop3:0xf6
    v_bitop3_b32 v4, v4, v159, s4 bitop3:0xf6
    v_cmp_ne_u32 vcc, 0, v4
    s_cbranch_vccz PDONE_27
    s_add_u32 s5, s5, 1
    s_cmp_lt_u32 s5, 200000
    s_cbranch_scc1 POLL_26
PDONE_27:
    ds_write2_b32 v5, v152, v154 offset0:0 offset1:1
    ds_write2_b32 v5, v156, v158 offset0:64 offset1:65
    s_waitcnt lgkmcnt(0)
    s_barrier
    ds_read_b128 v[144:147], v20
    ds_read_b128 v[148:151], v20 offset:1024
    ds_read_b128 v[152:155], v20 offset:2048
    ds_read_b128 v[156:159], v20 offset:3072
    buffer_load_dwordx2 v[96:97], v22, s[32:35], s18 offen sc1
    buffer_load_dwordx2 v[98:99], v22, s[32:35], s18 offen offset:512 sc1
    buffer_load_dwordx2 v[100:101], v22, s[32:35], s18 offen offset:1024 sc1
    buffer_load_dwordx2 v[102:103], v22, s[32:35], s18 offen offset:1536 sc1
    s_lshl_b32 s13, s3, 8
    v_lshl_add_u32 v4, v1, 2, s13
    global_load_dword v104, v4, s[78:79]
    s_and_b32 s96, s3, 3
    s_lshl2_add_u32 s97, s10, s96
    s_lshl4_add_u32 s98, s97, s11
    s_lshl1_add_u32 s99, s98, s76
    s_lshl_b32 s96, s99, 11
    s_add_u32 s13, s96, 8388608
    s_waitcnt lgkmcnt(3)
    v_mfma_f32_32x32x16_bf16 v[112:127], v[144:147], v[80:83], 0
    s_waitcnt lgkmcnt(2)
    v_mfma_f32_32x32x16_bf16 v[112:127], v[148:151], v[84:87], v[112:127]
    s_waitcnt lgkmcnt(1)
    v_mfma_f32_32x32x16_bf16 v[112:127], v[152:155], v[88:91], v[112:127]
    s_waitcnt lgkmcnt(0)
    v_mfma_f32_32x32x16_bf16 v[112:127], v[156:159], v[92:95], v[112:127]
    s_nop 11
    v_cvt_pk_bf16_f32 v112, 0, v112
    v_cvt_pk_bf16_f32 v113, 0, v113
    v_cvt_pk_bf16_f32 v114, 0, v114
    v_cvt_pk_bf16_f32 v115, 0, v115
    v_cvt_pk_bf16_f32 v116, 0, v116
    v_cvt_pk_bf16_f32 v117, 0, v117
    v_cvt_pk_bf16_f32 v118, 0, v118
    v_cvt_pk_bf16_f32 v119, 0, v119
    v_pk_mul_f32 v[112:113], v[112:113], v[128:129] op_sel_hi:[1,0]
    v_pk_mul_f32 v[114:115], v[114:115], v[128:129] op_sel_hi:[1,0]
    v_pk_mul_f32 v[116:117], v[116:117], v[128:129] op_sel_hi:[1,0]
    v_pk_mul_f32 v[118:119], v[118:119], v[128:129] op_sel_hi:[1,0]
    v_cvt_pk_bf16_f32 v44, v112, v113
    v_cvt_pk_bf16_f32 v45, v114, v115
    v_cvt_pk_bf16_f32 v46, v116, v117
    v_cvt_pk_bf16_f32 v47, v118, v119
    buffer_store_dwordx4 v[44:47], v2, s[32:35], s13 offen sc1
    v_cvt_pk_bf16_f32 v120, 0, v120
    v_cvt_pk_bf16_f32 v121, 0, v121
    v_cvt_pk_bf16_f32 v122, 0, v122
    v_cvt_pk_bf16_f32 v123, 0, v123
    v_cvt_pk_bf16_f32 v124, 0, v124
    v_cvt_pk_bf16_f32 v125, 0, v125
    v_cvt_pk_bf16_f32 v126, 0, v126
    v_cvt_pk_bf16_f32 v127, 0, v127
    v_pk_mul_f32 v[120:121], v[120:121], v[128:129] op_sel_hi:[1,0]
    v_pk_mul_f32 v[122:123], v[122:123], v[128:129] op_sel_hi:[1,0]
    v_pk_mul_f32 v[124:125], v[124:125], v[128:129] op_sel_hi:[1,0]
    v_pk_mul_f32 v[126:127], v[126:127], v[128:129] op_sel_hi:[1,0]
    v_cvt_pk_bf16_f32 v48, v120, v121
    v_cvt_pk_bf16_f32 v49, v122, v123
    v_cvt_pk_bf16_f32 v50, v124, v125
    v_cvt_pk_bf16_f32 v51, v126, v127
    buffer_store_dwordx4 v[48:51], v2, s[32:35], s13 offen offset:1024 sc1
    s_mul_i32 s96, s76, 65600
    s_add_u32 s17, s96, 32768
    v_bfe_u32 v20, v1, 2, 2
    v_lshlrev_b32 v20, 7, v20
    v_bfe_u32 v9, v1, 3, 1
    v_lshl_add_u32 v20, v9, 6, v20
    v_lshrrev_b32 v9, 5, v1
    v_lshl_add_u32 v20, v9, 10, v20
    v_and_b32 v9, 1, v1
    v_lshl_add_u32 v20, v9, 5, v20
    v_bfe_u32 v9, v1, 4, 1
    v_lshl_add_u32 v20, v9, 4, v20
    v_bfe_u32 v9, v1, 1, 1
    v_lshl_add_u32 v20, v9, 3, v20
    v_xor_b32 v20, s17, v20
    v_xor_b32 v21, 64, v20
    v_and_b32 v5, 7, v1
    v_lshlrev_b32 v5, 15, v5
    v_bfe_u32 v9, v1, 3, 1
    v_lshl_add_u32 v5, v9, 12, v5
    s_and_b32 s96, s11, 1
    s_lshr_b32 s97, s10, 2
    s_and_b32 s98, s10, 3
    s_lshl_b32 s99, s98, 6
    s_lshl1_add_u32 s98, s97, s99
    s_lshl_b32 s97, s98, 12
    s_lshr_b32 s99, s11, 1
    s_lshl_b32 s98, s99, 6
    s_add_u32 s99, s97, s98
    s_lshl2_add_u32 s97, s96, s99
    s_add_u32 s98, s97, 1048576
    s_add_u32 s15, s98, 1024
    v_lshlrev_b32 v24, 16, v12
    v_and_b32 v25, s6, v12
    v_lshlrev_b32 v26, 16, v13
    v_and_b32 v27, s6, v13
    v_lshlrev_b32 v28, 16, v14
    v_and_b32 v29, s6, v14
    v_lshlrev_b32 v30, 16, v15
    v_and_b32 v31, s6, v15
    v_lshlrev_b32 v32, 16, v16
    v_and_b32 v33, s6, v16
    v_lshlrev_b32 v34, 16, v17
    v_and_b32 v35, s6, v17
    v_lshlrev_b32 v36, 16, v18
    v_and_b32 v37, s6, v18
    v_lshlrev_b32 v38, 16, v19
    v_and_b32 v39, s6, v19
    s_lshl1_add_u32 s96, s94, s77
    s_lshl_b32 s97, s96, 15
    s_add_u32 s19, s97, 8388608
    s_waitcnt vmcnt(0)
    s_barrier
    s_cmp_lg_u32 s3, 0
    s_cbranch_scc1 L_PD
    v_mov_b32 v6, s4
    s_mov_b32 exec_hi, 0
    s_mov_b32 exec_lo, 65535
    buffer_store_dword v6, v5, s[32:35], s15 offen sc1
    s_mov_b64 exec, -1
L_PD:
    s_add_u32 s96, s84, 1966080
    s_and_b32 s97, s96, 1048575
    s_xor_b32 s98, s88, 1048576
    s_add_u32 s13, s97, s98
    s_add_u32 m0, s89, 155648
    s_nop 0
    buffer_load_dwordx4 v74, s[44:47], s13 offen lds
    s_and_b32 s96, s84, 1048575
    s_add_u32 s13, s96, s88
    s_add_u32 m0, s89, 32768
    s_nop 0
    buffer_load_dwordx4 v74, s[44:47], s13 offen lds
    s_add_u32 s96, s84, 131072
    s_and_b32 s97, s96, 1048575
    s_add_u32 s13, s97, s88
    s_add_u32 m0, s89, 40960
    s_nop 0
    buffer_load_dwordx4 v74, s[44:47], s13 offen lds
    s_lshl_b32 s96, s3, 10
    s_add_u32 s13, s96, 65536
    s_add_u32 s14, s13, 8192
    s_add_u32 s15, s13, 16384
    buffer_load_dwordx4 v[76:79], v2, s[32:35], s13 offen sc1
    buffer_load_dwordx4 v[80:83], v2, s[32:35], s14 offen sc1
    buffer_load_dwordx4 v[84:87], v2, s[32:35], s15 offen sc1
    s_load_dwordx2 s[24:25], s[32:33], s92 offset:1024 glc
    s_waitcnt vmcnt(0)
    v_bitop3_b32 v4, v97, v99, s4 bitop3:0x7e
    v_bitop3_b32 v4, v4, v101, s4 bitop3:0xf6
    v_bitop3_b32 v4, v4, v103, s4 bitop3:0xf6
    v_bitop3_b32 v4, v4, v77, s4 bitop3:0xf6
    v_bitop3_b32 v4, v4, v79, s4 bitop3:0xf6
    v_bitop3_b32 v4, v4, v81, s4 bitop3:0xf6
    v_bitop3_b32 v4, v4, v83, s4 bitop3:0xf6
    v_bitop3_b32 v4, v4, v85, s4 bitop3:0xf6
    v_bitop3_b32 v4, v4, v87, s4 bitop3:0xf6
    v_cmp_ne_u32 vcc, 0, v4
    s_cbranch_vccz L_MGOK
POLL_31:
    buffer_load_dwordx2 v[96:97], v22, s[32:35], s18 offen sc1
    buffer_load_dwordx2 v[98:99], v22, s[32:35], s18 offen offset:512 sc1
    buffer_load_dwordx2 v[100:101], v22, s[32:35], s18 offen offset:1024 sc1
    buffer_load_dwordx2 v[102:103], v22, s[32:35], s18 offen offset:1536 sc1
    buffer_load_dwordx4 v[76:79], v2, s[32:35], s13 offen sc1
    buffer_load_dwordx4 v[80:83], v2, s[32:35], s14 offen sc1
    buffer_load_dwordx4 v[84:87], v2, s[32:35], s15 offen sc1
    s_waitcnt vmcnt(0)
    v_bitop3_b32 v4, v97, v99, s4 bitop3:0x7e
    v_bitop3_b32 v4, v4, v101, s4 bitop3:0xf6
    v_bitop3_b32 v4, v4, v103, s4 bitop3:0xf6
    v_bitop3_b32 v4, v4, v77, s4 bitop3:0xf6
    v_bitop3_b32 v4, v4, v79, s4 bitop3:0xf6
    v_bitop3_b32 v4, v4, v81, s4 bitop3:0xf6
    v_bitop3_b32 v4, v4, v83, s4 bitop3:0xf6
    v_bitop3_b32 v4, v4, v85, s4 bitop3:0xf6
    v_bitop3_b32 v4, v4, v87, s4 bitop3:0xf6
    v_cmp_ne_u32 vcc, 0, v4
    s_cbranch_vccz PDONE_32
    s_add_u32 s5, s5, 1
    s_cmp_lt_u32 s5, 200000
    s_cbranch_scc1 POLL_31
PDONE_32:
L_MGOK:
    v_add_f32 v96, v96, v98
    v_add_f32 v100, v100, v102
    v_add_f32 v96, v96, v100
    v_cvt_pk_bf16_f32 v96, 0, v96
    v_cvt_pk_bf16_f32 v97, v76, v78
    v_cvt_pk_bf16_f32 v98, v80, v82
    v_cvt_pk_bf16_f32 v99, v84, v86
    v_mov_b32_dpp v40, v96 row_newbcast:0 row_mask:0xf bank_mask:0xf
    v_mov_b32_dpp v41, v96 row_newbcast:1 row_mask:0xf bank_mask:0xf
    v_mov_b32_dpp v42, v96 row_newbcast:2 row_mask:0xf bank_mask:0xf
    v_mov_b32_dpp v43, v96 row_newbcast:3 row_mask:0xf bank_mask:0xf
    v_mov_b32_dpp v44, v96 row_newbcast:4 row_mask:0xf bank_mask:0xf
    v_mov_b32_dpp v45, v96 row_newbcast:5 row_mask:0xf bank_mask:0xf
    v_mov_b32_dpp v46, v96 row_newbcast:6 row_mask:0xf bank_mask:0xf
    v_mov_b32_dpp v47, v96 row_newbcast:7 row_mask:0xf bank_mask:0xf
    v_mov_b32_dpp v48, v96 row_newbcast:8 row_mask:0xf bank_mask:0xf
    v_mov_b32_dpp v49, v96 row_newbcast:9 row_mask:0xf bank_mask:0xf
    v_mov_b32_dpp v50, v96 row_newbcast:10 row_mask:0xf bank_mask:0xf
    v_mov_b32_dpp v51, v96 row_newbcast:11 row_mask:0xf bank_mask:0xf
    v_mov_b32_dpp v52, v96 row_newbcast:12 row_mask:0xf bank_mask:0xf
    v_mov_b32_dpp v53, v96 row_newbcast:13 row_mask:0xf bank_mask:0xf
    v_mov_b32_dpp v54, v96 row_newbcast:14 row_mask:0xf bank_mask:0xf
    v_mov_b32_dpp v55, v96 row_newbcast:15 row_mask:0xf bank_mask:0xf
    s_branch SCHK_29
SPOLL_28:
    s_load_dwordx2 s[24:25], s[32:33], s92 offset:1024 glc
SCHK_29:
    s_add_u32 s5, s5, 1
    s_cmp_ge_u32 s5, 200000
    s_waitcnt lgkmcnt(0)
    s_cbranch_scc1 SDONE_30
    s_cmp_lg_u32 s24, s4
    s_cbranch_scc1 SPOLL_28
    s_cmp_lg_u32 s25, s4
    s_cbranch_scc1 SPOLL_28
SDONE_30:
    s_barrier
    s_and_b32 s96, s83, 15
    s_lshl_b32 s97, s96, 11
    s_add_u32 s20, s97, s19
    buffer_load_dwordx4 v[144:147], v2, s[32:35], s20 offen sc1
    ds_read_b64_tr_b16 v[164:165], v21
    ds_read_b64_tr_b16 v[166:167], v21 offset:512
    ds_read_b64_tr_b16 v[160:161], v20
    ds_read_b64_tr_b16 v[162:163], v20 offset:512
    buffer_load_dwordx4 v[148:151], v2, s[32:35], s20 offen offset:1024 sc1
    s_add_u32 s96, s83, 1
    s_and_b32 s97, s96, 15
    s_lshl_b32 s98, s97, 11
    s_add_u32 s20, s98, s19
    buffer_load_dwordx4 v[152:155], v2, s[32:35], s20 offen sc1
    buffer_load_dwordx4 v[156:159], v2, s[32:35], s20 offen offset:1024 sc1
    s_waitcnt vmcnt(3)
    s_waitcnt lgkmcnt(2)
    v_mfma_f32_32x32x16_bf16 v[128:143], v[164:167], v[144:147], 0
    ds_read_b64_tr_b16 v[172:173], v21 offset:2048
    ds_read_b64_tr_b16 v[174:175], v21 offset:2560
    s_waitcnt lgkmcnt(2)
    v_mfma_f32_32x32x16_bf16 v[112:127], v[160:163], v[144:147], 0
    ds_read_b64_tr_b16 v[168:169], v20 offset:2048
    ds_read_b64_tr_b16 v[170:171], v20 offset:2560
    s_add_u32 s96, s83, 2
    s_and_b32 s97, s96, 15
    s_lshl_b32 s98, s97, 11
    s_add_u32 s20, s98, s19
    buffer_load_dwordx4 v[144:147], v2, s[32:35], s20 offen sc1
    s_waitcnt vmcnt(3)
    s_waitcnt lgkmcnt(2)
    v_mfma_f32_32x32x16_bf16 v[128:143], v[172:175], v[148:151], v[128:143]
    ds_read_b64_tr_b16 v[164:165], v21 offset:4096
    ds_read_b64_tr_b16 v[166:167], v21 offset:4608
    s_waitcnt lgkmcnt(2)
    v_mfma_f32_32x32x16_bf16 v[112:127], v[168:171], v[148:151], v[112:127]
    ds_read_b64_tr_b16 v[160:161], v20 offset:4096
    ds_read_b64_tr_b16 v[162:163], v20 offset:4608
    buffer_load_dwordx4 v[148:151], v2, s[32:35], s20 offen offset:1024 sc1
    s_waitcnt vmcnt(3)
    s_waitcnt lgkmcnt(2)
    v_mfma_f32_32x32x16_bf16 v[128:143], v[164:167], v[152:155], v[128:143]
    ds_read_b64_tr_b16 v[172:173], v21 offset:6144
    ds_read_b64_tr_b16 v[174:175], v21 offset:6656
    s_waitcnt lgkmcnt(2)
    v_mfma_f32_32x32x16_bf16 v[112:127], v[160:163], v[152:155], v[112:127]
    ds_read_b64_tr_b16 v[168:169], v20 offset:6144
    ds_read_b64_tr_b16 v[170:171], v20 offset:6656
    s_add_u32 s96, s83, 3
    s_and_b32 s97, s96, 15
    s_lshl_b32 s98, s97, 11
    s_add_u32 s20, s98, s19
    buffer_load_dwordx4 v[152:155], v2, s[32:35], s20 offen sc1
    s_waitcnt vmcnt(3)
    s_waitcnt lgkmcnt(2)
    v_mfma_f32_32x32x16_bf16 v[128:143], v[172:175], v[156:159], v[128:143]
    ds_read_b64_tr_b16 v[164:165], v21 offset:8192
    ds_read_b64_tr_b16 v[166:167], v21 offset:8704
    s_waitcnt lgkmcnt(2)
    v_mfma_f32_32x32x16_bf16 v[112:127], v[168:171], v[156:159], v[112:127]
    ds_read_b64_tr_b16 v[160:161], v20 offset:8192
    ds_read_b64_tr_b16 v[162:163], v20 offset:8704
    buffer_load_dwordx4 v[156:159], v2, s[32:35], s20 offen offset:1024 sc1
    s_waitcnt vmcnt(3)
    s_waitcnt lgkmcnt(2)
    v_mfma_f32_32x32x16_bf16 v[128:143], v[164:167], v[144:147], v[128:143]
    ds_read_b64_tr_b16 v[172:173], v21 offset:10240
    ds_read_b64_tr_b16 v[174:175], v21 offset:10752
    s_waitcnt lgkmcnt(2)
    v_mfma_f32_32x32x16_bf16 v[112:127], v[160:163], v[144:147], v[112:127]
    ds_read_b64_tr_b16 v[168:169], v20 offset:10240
    ds_read_b64_tr_b16 v[170:171], v20 offset:10752
    s_add_u32 s96, s83, 4
    s_and_b32 s97, s96, 15
    s_lshl_b32 s98, s97, 11
    s_add_u32 s20, s98, s19
    buffer_load_dwordx4 v[144:147], v2, s[32:35], s20 offen sc1
    s_waitcnt vmcnt(3)
    s_waitcnt lgkmcnt(2)
    v_mfma_f32_32x32x16_bf16 v[128:143], v[172:175], v[148:151], v[128:143]
    ds_read_b64_tr_b16 v[164:165], v21 offset:12288
    ds_read_b64_tr_b16 v[166:167], v21 offset:12800
    s_waitcnt lgkmcnt(2)
    v_mfma_f32_32x32x16_bf16 v[112:127], v[168:171], v[148:151], v[112:127]
    ds_read_b64_tr_b16 v[160:161], v20 offset:12288
    ds_read_b64_tr_b16 v[162:163], v20 offset:12800
    buffer_load_dwordx4 v[148:151], v2, s[32:35], s20 offen offset:1024 sc1
    s_waitcnt vmcnt(3)
    s_waitcnt lgkmcnt(2)
    v_mfma_f32_32x32x16_bf16 v[128:143], v[164:167], v[152:155], v[128:143]
    ds_read_b64_tr_b16 v[172:173], v21 offset:14336
    ds_read_b64_tr_b16 v[174:175], v21 offset:14848
    s_waitcnt lgkmcnt(2)
    v_mfma_f32_32x32x16_bf16 v[112:127], v[160:163], v[152:155], v[112:127]
    ds_read_b64_tr_b16 v[168:169], v20 offset:14336
    ds_read_b64_tr_b16 v[170:171], v20 offset:14848
    s_add_u32 s96, s83, 5
    s_and_b32 s97, s96, 15
    s_lshl_b32 s98, s97, 11
    s_add_u32 s20, s98, s19
    buffer_load_dwordx4 v[152:155], v2, s[32:35], s20 offen sc1
    s_waitcnt vmcnt(3)
    s_waitcnt lgkmcnt(2)
    v_mfma_f32_32x32x16_bf16 v[128:143], v[172:175], v[156:159], v[128:143]
    ds_read_b64_tr_b16 v[164:165], v21 offset:16384
    ds_read_b64_tr_b16 v[166:167], v21 offset:16896
    s_waitcnt lgkmcnt(2)
    v_mfma_f32_32x32x16_bf16 v[112:127], v[168:171], v[156:159], v[112:127]
    ds_read_b64_tr_b16 v[160:161], v20 offset:16384
    ds_read_b64_tr_b16 v[162:163], v20 offset:16896
    buffer_load_dwordx4 v[156:159], v2, s[32:35], s20 offen offset:1024 sc1
    s_waitcnt vmcnt(3)
    s_waitcnt lgkmcnt(2)
    v_mfma_f32_32x32x16_bf16 v[128:143], v[164:167], v[144:147], v[128:143]
    ds_read_b64_tr_b16 v[172:173], v21 offset:18432
    ds_read_b64_tr_b16 v[174:175], v21 offset:18944
    s_waitcnt lgkmcnt(2)
    v_mfma_f32_32x32x16_bf16 v[112:127], v[160:163], v[144:147], v[112:127]
    ds_read_b64_tr_b16 v[168:169], v20 offset:18432
    ds_read_b64_tr_b16 v[170:171], v20 offset:18944
    s_add_u32 s96, s83, 6
    s_and_b32 s97, s96, 15
    s_lshl_b32 s98, s97, 11
    s_add_u32 s20, s98, s19
    buffer_load_dwordx4 v[144:147], v2, s[32:35], s20 offen sc1
    s_waitcnt vmcnt(3)
    s_waitcnt lgkmcnt(2)
    v_mfma_f32_32x32x16_bf16 v[128:143], v[172:175], v[148:151], v[128:143]
    ds_read_b64_tr_b16 v[164:165], v21 offset:20480
    ds_read_b64_tr_b16 v[166:167], v21 offset:20992
    s_waitcnt lgkmcnt(2)
    v_mfma_f32_32x32x16_bf16 v[112:127], v[168:171], v[148:151], v[112:127]
    ds_read_b64_tr_b16 v[160:161], v20 offset:20480
    ds_read_b64_tr_b16 v[162:163], v20 offset:20992
    buffer_load_dwordx4 v[148:151], v2, s[32:35], s20 offen offset:1024 sc1
    s_waitcnt vmcnt(3)
    s_waitcnt lgkmcnt(2)
    v_mfma_f32_32x32x16_bf16 v[128:143], v[164:167], v[152:155], v[128:143]
    ds_read_b64_tr_b16 v[172:173], v21 offset:22528
    ds_read_b64_tr_b16 v[174:175], v21 offset:23040
    s_waitcnt lgkmcnt(2)
    v_mfma_f32_32x32x16_bf16 v[112:127], v[160:163], v[152:155], v[112:127]
    ds_read_b64_tr_b16 v[168:169], v20 offset:22528
    ds_read_b64_tr_b16 v[170:171], v20 offset:23040
    s_add_u32 s96, s83, 7
    s_and_b32 s97, s96, 15
    s_lshl_b32 s98, s97, 11
    s_add_u32 s20, s98, s19
    buffer_load_dwordx4 v[152:155], v2, s[32:35], s20 offen sc1
    s_waitcnt vmcnt(3)
    s_waitcnt lgkmcnt(2)
    v_mfma_f32_32x32x16_bf16 v[128:143], v[172:175], v[156:159], v[128:143]
    ds_read_b64_tr_b16 v[164:165], v21 offset:24576
    ds_read_b64_tr_b16 v[166:167], v21 offset:25088
    s_waitcnt lgkmcnt(2)
    v_mfma_f32_32x32x16_bf16 v[112:127], v[168:171], v[156:159], v[112:127]
    ds_read_b64_tr_b16 v[160:161], v20 offset:24576
    ds_read_b64_tr_b16 v[162:163], v20 offset:25088
    buffer_load_dwordx4 v[156:159], v2, s[32:35], s20 offen offset:1024 sc1
    s_waitcnt vmcnt(3)
    s_waitcnt lgkmcnt(2)
    v_mfma_f32_32x32x16_bf16 v[128:143], v[164:167], v[144:147], v[128:143]
    ds_read_b64_tr_b16 v[172:173], v21 offset:26624
    ds_read_b64_tr_b16 v[174:175], v21 offset:27136
    s_waitcnt lgkmcnt(2)
    v_mfma_f32_32x32x16_bf16 v[112:127], v[160:163], v[144:147], v[112:127]
    ds_read_b64_tr_b16 v[168:169], v20 offset:26624
    ds_read_b64_tr_b16 v[170:171], v20 offset:27136
    s_add_u32 s96, s83, 8
    s_and_b32 s97, s96, 15
    s_lshl_b32 s98, s97, 11
    s_add_u32 s20, s98, s19
    buffer_load_dwordx4 v[144:147], v2, s[32:35], s20 offen sc1
    s_waitcnt vmcnt(3)
    s_waitcnt lgkmcnt(2)
    v_mfma_f32_32x32x16_bf16 v[128:143], v[172:175], v[148:151], v[128:143]
    ds_read_b64_tr_b16 v[164:165], v21 offset:28672
    ds_read_b64_tr_b16 v[166:167], v21 offset:29184
    s_waitcnt lgkmcnt(2)
    v_mfma_f32_32x32x16_bf16 v[112:127], v[168:171], v[148:151], v[112:127]
    ds_read_b64_tr_b16 v[160:161], v20 offset:28672
    ds_read_b64_tr_b16 v[162:163], v20 offset:29184
    buffer_load_dwordx4 v[148:151], v2, s[32:35], s20 offen offset:1024 sc1
    s_waitcnt vmcnt(3)
    s_waitcnt lgkmcnt(2)
    v_mfma_f32_32x32x16_bf16 v[128:143], v[164:167], v[152:155], v[128:143]
    ds_read_b64_tr_b16 v[172:173], v21 offset:30720
    ds_read_b64_tr_b16 v[174:175], v21 offset:31232
    s_waitcnt lgkmcnt(2)
    v_mfma_f32_32x32x16_bf16 v[112:127], v[160:163], v[152:155], v[112:127]
    ds_read_b64_tr_b16 v[168:169], v20 offset:30720
    ds_read_b64_tr_b16 v[170:171], v20 offset:31232
    s_add_u32 s96, s83, 9
    s_and_b32 s97, s96, 15
    s_lshl_b32 s98, s97, 11
    s_add_u32 s20, s98, s19
    buffer_load_dwordx4 v[152:155], v2, s[32:35], s20 offen sc1
    s_waitcnt vmcnt(3)
    s_waitcnt lgkmcnt(2)
    v_mfma_f32_32x32x16_bf16 v[128:143], v[172:175], v[156:159], v[128:143]
    ds_read_b64_tr_b16 v[164:165], v21 offset:32768
    ds_read_b64_tr_b16 v[166:167], v21 offset:33280
    s_waitcnt lgkmcnt(2)
    v_mfma_f32_32x32x16_bf16 v[112:127], v[168:171], v[156:159], v[112:127]
    ds_read_b64_tr_b16 v[160:161], v20 offset:32768
    ds_read_b64_tr_b16 v[162:163], v20 offset:33280
    buffer_load_dwordx4 v[156:159], v2, s[32:35], s20 offen offset:1024 sc1
    s_waitcnt vmcnt(3)
    s_waitcnt lgkmcnt(2)
    v_mfma_f32_32x32x16_bf16 v[128:143], v[164:167], v[144:147], v[128:143]
    ds_read_b64_tr_b16 v[172:173], v21 offset:34816
    ds_read_b64_tr_b16 v[174:175], v21 offset:35328
    s_waitcnt lgkmcnt(2)
    v_mfma_f32_32x32x16_bf16 v[112:127], v[160:163], v[144:147], v[112:127]
    ds_read_b64_tr_b16 v[168:169], v20 offset:34816
    ds_read_b64_tr_b16 v[170:171], v20 offset:35328
    s_add_u32 s96, s83, 10
    s_and_b32 s97, s96, 15
    s_lshl_b32 s98, s97, 11
    s_add_u32 s20, s98, s19
    buffer_load_dwordx4 v[144:147], v2, s[32:35], s20 offen sc1
    s_waitcnt vmcnt(3)
    s_waitcnt lgkmcnt(2)
    v_mfma_f32_32x32x16_bf16 v[128:143], v[172:175], v[148:151], v[128:143]
    ds_read_b64_tr_b16 v[164:165], v21 offset:36864
    ds_read_b64_tr_b16 v[166:167], v21 offset:37376
    s_waitcnt lgkmcnt(2)
    v_mfma_f32_32x32x16_bf16 v[112:127], v[168:171], v[148:151], v[112:127]
    ds_read_b64_tr_b16 v[160:161], v20 offset:36864
    ds_read_b64_tr_b16 v[162:163], v20 offset:37376
    buffer_load_dwordx4 v[148:151], v2, s[32:35], s20 offen offset:1024 sc1
    s_waitcnt vmcnt(3)
    s_waitcnt lgkmcnt(2)
    v_mfma_f32_32x32x16_bf16 v[128:143], v[164:167], v[152:155], v[128:143]
    ds_read_b64_tr_b16 v[172:173], v21 offset:38912
    ds_read_b64_tr_b16 v[174:175], v21 offset:39424
    s_waitcnt lgkmcnt(2)
    v_mfma_f32_32x32x16_bf16 v[112:127], v[160:163], v[152:155], v[112:127]
    ds_read_b64_tr_b16 v[168:169], v20 offset:38912
    ds_read_b64_tr_b16 v[170:171], v20 offset:39424
    s_add_u32 s96, s83, 11
    s_and_b32 s97, s96, 15
    s_lshl_b32 s98, s97, 11
    s_add_u32 s20, s98, s19
    buffer_load_dwordx4 v[152:155], v2, s[32:35], s20 offen sc1
    s_waitcnt vmcnt(3)
    s_waitcnt lgkmcnt(2)
    v_mfma_f32_32x32x16_bf16 v[128:143], v[172:175], v[156:159], v[128:143]
    ds_read_b64_tr_b16 v[164:165], v21 offset:40960
    ds_read_b64_tr_b16 v[166:167], v21 offset:41472
    s_waitcnt lgkmcnt(2)
    v_mfma_f32_32x32x16_bf16 v[112:127], v[168:171], v[156:159], v[112:127]
    ds_read_b64_tr_b16 v[160:161], v20 offset:40960
    ds_read_b64_tr_b16 v[162:163], v20 offset:41472
    buffer_load_dwordx4 v[156:159], v2, s[32:35], s20 offen offset:1024 sc1
    s_waitcnt vmcnt(3)
    s_waitcnt lgkmcnt(2)
    v_mfma_f32_32x32x16_bf16 v[128:143], v[164:167], v[144:147], v[128:143]
    ds_read_b64_tr_b16 v[172:173], v21 offset:43008
    ds_read_b64_tr_b16 v[174:175], v21 offset:43520
    s_waitcnt lgkmcnt(2)
    v_mfma_f32_32x32x16_bf16 v[112:127], v[160:163], v[144:147], v[112:127]
    ds_read_b64_tr_b16 v[168:169], v20 offset:43008
    ds_read_b64_tr_b16 v[170:171], v20 offset:43520
    s_add_u32 s96, s83, 12
    s_and_b32 s97, s96, 15
    s_lshl_b32 s98, s97, 11
    s_add_u32 s20, s98, s19
    buffer_load_dwordx4 v[144:147], v2, s[32:35], s20 offen sc1
    s_waitcnt vmcnt(3)
    s_waitcnt lgkmcnt(2)
    v_mfma_f32_32x32x16_bf16 v[128:143], v[172:175], v[148:151], v[128:143]
    ds_read_b64_tr_b16 v[164:165], v21 offset:45056
    ds_read_b64_tr_b16 v[166:167], v21 offset:45568
    s_waitcnt lgkmcnt(2)
    v_mfma_f32_32x32x16_bf16 v[112:127], v[168:171], v[148:151], v[112:127]
    ds_read_b64_tr_b16 v[160:161], v20 offset:45056
    ds_read_b64_tr_b16 v[162:163], v20 offset:45568
    buffer_load_dwordx4 v[148:151], v2, s[32:35], s20 offen offset:1024 sc1
    s_waitcnt vmcnt(3)
    s_waitcnt lgkmcnt(2)
    v_mfma_f32_32x32x16_bf16 v[128:143], v[164:167], v[152:155], v[128:143]
    ds_read_b64_tr_b16 v[172:173], v21 offset:47104
    ds_read_b64_tr_b16 v[174:175], v21 offset:47616
    s_waitcnt lgkmcnt(2)
    v_mfma_f32_32x32x16_bf16 v[112:127], v[160:163], v[152:155], v[112:127]
    ds_read_b64_tr_b16 v[168:169], v20 offset:47104
    ds_read_b64_tr_b16 v[170:171], v20 offset:47616
    s_add_u32 s96, s83, 13
    s_and_b32 s97, s96, 15
    s_lshl_b32 s98, s97, 11
    s_add_u32 s20, s98, s19
    buffer_load_dwordx4 v[152:155], v2, s[32:35], s20 offen sc1
    s_waitcnt vmcnt(3)
    s_waitcnt lgkmcnt(2)
    v_mfma_f32_32x32x16_bf16 v[128:143], v[172:175], v[156:159], v[128:143]
    ds_read_b64_tr_b16 v[164:165], v21 offset:49152
    ds_read_b64_tr_b16 v[166:167], v21 offset:49664
    s_waitcnt lgkmcnt(2)
    v_mfma_f32_32x32x16_bf16 v[112:127], v[168:171], v[156:159], v[112:127]
    ds_read_b64_tr_b16 v[160:161], v20 offset:49152
    ds_read_b64_tr_b16 v[162:163], v20 offset:49664
    buffer_load_dwordx4 v[156:159], v2, s[32:35], s20 offen offset:1024 sc1
    s_waitcnt vmcnt(3)
    s_waitcnt lgkmcnt(2)
    v_mfma_f32_32x32x16_bf16 v[128:143], v[164:167], v[144:147], v[128:143]
    ds_read_b64_tr_b16 v[172:173], v21 offset:51200
    ds_read_b64_tr_b16 v[174:175], v21 offset:51712
    s_waitcnt lgkmcnt(2)
    v_mfma_f32_32x32x16_bf16 v[112:127], v[160:163], v[144:147], v[112:127]
    ds_read_b64_tr_b16 v[168:169], v20 offset:51200
    ds_read_b64_tr_b16 v[170:171], v20 offset:51712
    s_add_u32 s96, s83, 14
    s_and_b32 s97, s96, 15
    s_lshl_b32 s98, s97, 11
    s_add_u32 s20, s98, s19
    buffer_load_dwordx4 v[144:147], v2, s[32:35], s20 offen sc1
    s_waitcnt vmcnt(3)
    s_waitcnt lgkmcnt(2)
    v_mfma_f32_32x32x16_bf16 v[128:143], v[172:175], v[148:151], v[128:143]
    ds_read_b64_tr_b16 v[164:165], v21 offset:53248
    ds_read_b64_tr_b16 v[166:167], v21 offset:53760
    s_waitcnt lgkmcnt(2)
    v_mfma_f32_32x32x16_bf16 v[112:127], v[168:171], v[148:151], v[112:127]
    ds_read_b64_tr_b16 v[160:161], v20 offset:53248
    ds_read_b64_tr_b16 v[162:163], v20 offset:53760
    buffer_load_dwordx4 v[148:151], v2, s[32:35], s20 offen offset:1024 sc1
    s_waitcnt vmcnt(3)
    s_waitcnt lgkmcnt(2)
    v_mfma_f32_32x32x16_bf16 v[128:143], v[164:167], v[152:155], v[128:143]
    ds_read_b64_tr_b16 v[172:173], v21 offset:55296
    ds_read_b64_tr_b16 v[174:175], v21 offset:55808
    s_waitcnt lgkmcnt(2)
    v_mfma_f32_32x32x16_bf16 v[112:127], v[160:163], v[152:155], v[112:127]
    ds_read_b64_tr_b16 v[168:169], v20 offset:55296
    ds_read_b64_tr_b16 v[170:171], v20 offset:55808
    s_add_u32 s96, s83, 15
    s_and_b32 s97, s96, 15
    s_lshl_b32 s98, s97, 11
    s_add_u32 s20, s98, s19
    buffer_load_dwordx4 v[152:155], v2, s[32:35], s20 offen sc1
    s_waitcnt vmcnt(3)
    s_waitcnt lgkmcnt(2)
    v_mfma_f32_32x32x16_bf16 v[128:143], v[172:175], v[156:159], v[128:143]
    ds_read_b64_tr_b16 v[164:165], v21 offset:57344
    ds_read_b64_tr_b16 v[166:167], v21 offset:57856
    s_waitcnt lgkmcnt(2)
    v_mfma_f32_32x32x16_bf16 v[112:127], v[168:171], v[156:159], v[112:127]
    ds_read_b64_tr_b16 v[160:161], v20 offset:57344
    ds_read_b64_tr_b16 v[162:163], v20 offset:57856
    buffer_load_dwordx4 v[156:159], v2, s[32:35], s20 offen offset:1024 sc1
    s_waitcnt vmcnt(3)
    s_waitcnt lgkmcnt(2)
    v_mfma_f32_32x32x16_bf16 v[128:143], v[164:167], v[144:147], v[128:143]
    ds_read_b64_tr_b16 v[172:173], v21 offset:59392
    ds_read_b64_tr_b16 v[174:175], v21 offset:59904
    s_waitcnt lgkmcnt(2)
    v_mfma_f32_32x32x16_bf16 v[112:127], v[160:163], v[144:147], v[112:127]
    ds_read_b64_tr_b16 v[168:169], v20 offset:59392
    ds_read_b64_tr_b16 v[170:171], v20 offset:59904
    s_waitcnt vmcnt(2)
    s_waitcnt lgkmcnt(2)
    v_mfma_f32_32x32x16_bf16 v[128:143], v[172:175], v[148:151], v[128:143]
    ds_read_b64_tr_b16 v[164:165], v21 offset:61440
    ds_read_b64_tr_b16 v[166:167], v21 offset:61952
    s_waitcnt lgkmcnt(2)
    v_mfma_f32_32x32x16_bf16 v[112:127], v[168:171], v[148:151], v[112:127]
    ds_read_b64_tr_b16 v[160:161], v20 offset:61440
    ds_read_b64_tr_b16 v[162:163], v20 offset:61952
    s_waitcnt vmcnt(1)
    s_waitcnt lgkmcnt(2)
    v_mfma_f32_32x32x16_bf16 v[128:143], v[164:167], v[152:155], v[128:143]
    ds_read_b64_tr_b16 v[172:173], v21 offset:63488
    ds_read_b64_tr_b16 v[174:175], v21 offset:64000
    s_waitcnt lgkmcnt(2)
    v_mfma_f32_32x32x16_bf16 v[112:127], v[160:163], v[152:155], v[112:127]
    ds_read_b64_tr_b16 v[168:169], v20 offset:63488
    ds_read_b64_tr_b16 v[170:171], v20 offset:64000
    s_waitcnt vmcnt(0)
    s_waitcnt lgkmcnt(2)
    v_mfma_f32_32x32x16_bf16 v[128:143], v[172:175], v[156:159], v[128:143]
    s_waitcnt lgkmcnt(0)
    v_mfma_f32_32x32x16_bf16 v[112:127], v[168:171], v[156:159], v[112:127]
    s_lshl_b32 s13, s3, 12
    v_add_u32 v4, s13, v2
    v_xor_b32 v5, 0x4000, v4
    s_lshl_b32 s96, s94, 5
    s_add_u32 s97, s96, s95
    s_lshl_b32 s98, s97, 11
    s_add_u32 s13, s98, 12582912
    v_and_b32 v6, 31, v1
    v_lshlrev_b32 v6, 4, v6
    v_lshrrev_b32 v9, 5, v1
    v_lshl_add_u32 v6, v9, 10, v6
    ds_write_b128 v4, v[128:131]
    ds_write_b128 v4, v[132:135] offset:1024
    ds_write_b128 v4, v[136:139] offset:2048
    ds_write_b128 v4, v[140:143] offset:3072
    s_waitcnt lgkmcnt(0)
    s_barrier
    ds_read_b128 v[128:131], v5
    ds_read_b128 v[132:135], v5 offset:1024
    ds_read_b128 v[136:139], v5 offset:2048
    ds_read_b128 v[140:143], v5 offset:3072
    s_waitcnt lgkmcnt(3)
    v_pk_add_f32 v[112:113], v[112:113], v[128:129]
    v_pk_add_f32 v[114:115], v[114:115], v[130:131]
    s_waitcnt lgkmcnt(2)
    v_pk_add_f32 v[116:117], v[116:117], v[132:133]
    v_pk_add_f32 v[118:119], v[118:119], v[134:135]
    v_cvt_pk_bf16_f32 v112, 0, v112
    v_cvt_pk_bf16_f32 v113, 0, v113
    v_cvt_pk_bf16_f32 v114, 0, v114
    v_cvt_pk_bf16_f32 v115, 0, v115
    v_cvt_pk_bf16_f32 v116, 0, v116
    v_cvt_pk_bf16_f32 v117, 0, v117
    v_cvt_pk_bf16_f32 v118, 0, v118
    v_cvt_pk_bf16_f32 v119, 0, v119
    v_pk_mul_f32 v[112:113], v[112:113], v[40:41]
    v_pk_mul_f32 v[114:115], v[114:115], v[42:43]
    v_pk_mul_f32 v[116:117], v[116:117], v[44:45]
    v_pk_mul_f32 v[118:119], v[118:119], v[46:47]
    v_cvt_pk_bf16_f32 v112, 0, v112
    v_cvt_pk_bf16_f32 v113, 0, v113
    v_cvt_pk_bf16_f32 v114, 0, v114
    v_cvt_pk_bf16_f32 v115, 0, v115
    v_cvt_pk_bf16_f32 v116, 0, v116
    v_cvt_pk_bf16_f32 v117, 0, v117
    v_cvt_pk_bf16_f32 v118, 0, v118
    v_cvt_pk_bf16_f32 v119, 0, v119
    v_pk_add_f32 v[112:113], v[112:113], v[24:25]
    v_pk_add_f32 v[114:115], v[114:115], v[26:27]
    v_pk_add_f32 v[116:117], v[116:117], v[28:29]
    v_pk_add_f32 v[118:119], v[118:119], v[30:31]
    v_cvt_pk_bf16_f32 v12, v112, v113
    v_cvt_pk_bf16_f32 v13, v114, v115
    v_cvt_pk_bf16_f32 v14, v116, v117
    v_cvt_pk_bf16_f32 v15, v118, v119
    buffer_store_dwordx4 v[12:15], v6, s[32:35], s13 offen sc1
    s_waitcnt lgkmcnt(1)
    v_pk_add_f32 v[120:121], v[120:121], v[136:137]
    v_pk_add_f32 v[122:123], v[122:123], v[138:139]
    s_waitcnt lgkmcnt(0)
    v_pk_add_f32 v[124:125], v[124:125], v[140:141]
    v_pk_add_f32 v[126:127], v[126:127], v[142:143]
    v_cvt_pk_bf16_f32 v120, 0, v120
    v_cvt_pk_bf16_f32 v121, 0, v121
    v_cvt_pk_bf16_f32 v122, 0, v122
    v_cvt_pk_bf16_f32 v123, 0, v123
    v_cvt_pk_bf16_f32 v124, 0, v124
    v_cvt_pk_bf16_f32 v125, 0, v125
    v_cvt_pk_bf16_f32 v126, 0, v126
    v_cvt_pk_bf16_f32 v127, 0, v127
    v_pk_mul_f32 v[120:121], v[120:121], v[48:49]
    v_pk_mul_f32 v[122:123], v[122:123], v[50:51]
    v_pk_mul_f32 v[124:125], v[124:125], v[52:53]
    v_pk_mul_f32 v[126:127], v[126:127], v[54:55]
    v_cvt_pk_bf16_f32 v120, 0, v120
    v_cvt_pk_bf16_f32 v121, 0, v121
    v_cvt_pk_bf16_f32 v122, 0, v122
    v_cvt_pk_bf16_f32 v123, 0, v123
    v_cvt_pk_bf16_f32 v124, 0, v124
    v_cvt_pk_bf16_f32 v125, 0, v125
    v_cvt_pk_bf16_f32 v126, 0, v126
    v_cvt_pk_bf16_f32 v127, 0, v127
    v_pk_add_f32 v[120:121], v[120:121], v[32:33]
    v_pk_add_f32 v[122:123], v[122:123], v[34:35]
    v_pk_add_f32 v[124:125], v[124:125], v[36:37]
    v_pk_add_f32 v[126:127], v[126:127], v[38:39]
    v_cvt_pk_bf16_f32 v16, v120, v121
    v_cvt_pk_bf16_f32 v17, v122, v123
    v_cvt_pk_bf16_f32 v18, v124, v125
    v_cvt_pk_bf16_f32 v19, v126, v127
    buffer_store_dwordx4 v[16:19], v6, s[32:35], s13 offen offset:512 sc1
    s_cmp_lt_u32 s3, 4
    s_cbranch_scc1 L_NOST
    s_sub_u32 s96, s3, 4
    s_lshl_b32 s97, s96, 12
    s_add_u32 s13, s97, 32768
    v_add_u32 v4, s13, v2
    v_add_u32 v7, 65536, v4
    ds_write_b128 v4, v[176:179] offset:16384
    ds_write_b128 v4, v[180:183]
    ds_write_b128 v4, v[184:187] offset:17408
    ds_write_b128 v4, v[188:191] offset:1024
    ds_write_b128 v4, v[192:195] offset:18432
    ds_write_b128 v4, v[196:199] offset:2048
    ds_write_b128 v4, v[200:203] offset:19456
    ds_write_b128 v4, v[204:207] offset:3072
    ds_write_b128 v4, v[208:211] offset:49152
    ds_write_b128 v4, v[212:215] offset:32768
    ds_write_b128 v4, v[216:219] offset:50176
    ds_write_b128 v4, v[220:223] offset:33792
L_NOST:
    v_and_b32 v5, 15, v1
    v_lshlrev_b32 v5, 15, v5
    s_and_b32 s96, s12, 1
    s_lshr_b32 s97, s21, 1
    s_and_b32 s98, s21, 1
    s_lshl_b32 s99, s98, 7
    s_add_u32 s98, s97, s99
    s_lshl_b32 s97, s98, 12
    s_lshr_b32 s99, s12, 1
    s_lshl_b32 s98, s99, 6
    s_add_u32 s99, s97, s98
    s_lshl2_add_u32 s97, s96, s99
    s_add_u32 s98, s97, 1048576
    s_add_u32 s16, s98, 1536
    s_waitcnt vmcnt(0)
    s_barrier
    s_cmp_lg_u32 s3, 0
    s_cbranch_scc1 L_PE
    v_mov_b32 v6, s4
    s_mov_b32 exec_hi, 0
    s_mov_b32 exec_lo, 65535
    buffer_store_dword v6, v5, s[32:35], s16 offen sc1
    s_mov_b64 exec, -1
L_PE:
    s_add_u32 s13, s80, 114688
    s_lshl2_add_u32 m0, s89, 67584
    s_nop 0
    buffer_load_dwordx4 v72, s[56:59], s13 offen nt lds
    s_lshl_b32 s96, s3, 8
    s_add_u32 s13, s96, 16640
    v_lshl_add_u32 v4, v1, 2, s13
    ds_write_b32 v4, v97
    ds_write_b32 v4, v98 offset:2048
    ds_write_b32 v4, v99 offset:4096
    ds_write_b32 v4, v104 offset:6144
    s_waitcnt lgkmcnt(0)
    s_barrier
    ds_read_b128 v[20:23], v2 offset:16640
    ds_read_b128 v[24:27], v2 offset:17664
    ds_read_b128 v[28:31], v2 offset:18688
    ds_read_b128 v[32:35], v2 offset:19712
    ds_read_b128 v[36:39], v2 offset:20736
    ds_read_b128 v[40:43], v2 offset:21760
    ds_read_b128 v[44:47], v2 offset:22784
    ds_read_b128 v[48:51], v2 offset:23808
    s_lshr_b32 s96, s93, 5
    s_lshl3_add_u32 s97, s96, s3
    s_lshl_b32 s98, s97, 13
    s_lshl_b32 s99, s75, 7
    s_add_u32 s96, s98, s99
    s_add_u32 s14, s96, 12582912
    s_add_u32 s16, s14, 4096
    v_lshrrev_b32 v7, 3, v1
    v_lshlrev_b32 v7, 9, v7
    v_and_b32 v9, 7, v1
    v_lshl_add_u32 v7, v9, 4, v7
    s_lshl_b32 s17, s3, 8
    v_and_b32 v10, 7, v1
    v_mul_u32_u24 v10, 2064, v10
    v_lshrrev_b32 v9, 3, v1
    v_lshl_add_u32 v10, v9, 4, v10
    v_add_u32 v10, s17, v10
    s_mul_i32 s17, s3, 2064
    v_add_u32 v11, s17, v2
    s_waitcnt lgkmcnt(0)
    s_load_dwordx2 s[24:25], s[32:33], s92 offset:1536 glc
    v_lshlrev_b32 v124, 16, v20
    v_and_b32 v125, s6, v20
    v_lshlrev_b32 v126, 16, v21
    v_and_b32 v127, s6, v21
    v_lshlrev_b32 v128, 16, v22
    v_and_b32 v129, s6, v22
    v_lshlrev_b32 v130, 16, v23
    v_and_b32 v131, s6, v23
    v_lshlrev_b32 v132, 16, v24
    v_and_b32 v133, s6, v24
    v_lshlrev_b32 v134, 16, v25
    v_and_b32 v135, s6, v25
    v_lshlrev_b32 v136, 16, v26
    v_and_b32 v137, s6, v26
    v_lshlrev_b32 v138, 16, v27
    v_and_b32 v139, s6, v27
    v_lshlrev_b32 v140, 16, v28
    v_and_b32 v141, s6, v28
    v_lshlrev_b32 v142, 16, v29
    v_and_b32 v143, s6, v29
    v_lshlrev_b32 v144, 16, v30
    v_and_b32 v145, s6, v30
    v_lshlrev_b32 v146, 16, v31
    v_and_b32 v147, s6, v31
    v_lshlrev_b32 v148, 16, v32
    v_and_b32 v149, s6, v32
    v_lshlrev_b32 v150, 16, v33
    v_and_b32 v151, s6, v33
    v_lshlrev_b32 v152, 16, v34
    v_and_b32 v153, s6, v34
    v_lshlrev_b32 v154, 16, v35
    v_and_b32 v155, s6, v35
    v_mov_b32 v205, s4
    v_mov_b32 v207, s4
    v_mov_b32 v209, s4
    v_mov_b32 v211, s4
    v_mov_b32 v213, s4
    v_mov_b32 v215, s4
    v_mov_b32 v217, s4
    v_mov_b32 v219, s4
    s_branch SCHK_34
SPOLL_33:
    s_load_dwordx2 s[24:25], s[32:33], s92 offset:1536 glc
SCHK_34:
    s_add_u32 s5, s5, 1
    s_cmp_ge_u32 s5, 200000
    s_waitcnt lgkmcnt(0)
    s_cbranch_scc1 SDONE_35
    s_cmp_lg_u32 s24, s4
    s_cbranch_scc1 SPOLL_33
    s_cmp_lg_u32 s25, s4
    s_cbranch_scc1 SPOLL_33
SDONE_35:
    buffer_load_dwordx4 v[12:15], v7, s[32:35], s14 offen sc1
    buffer_load_dwordx4 v[16:19], v7, s[32:35], s16 offen sc1
    s_waitcnt vmcnt(1)
    ds_write_b128 v10, v[12:15]
    s_waitcnt vmcnt(0)
    ds_write_b128 v10, v[16:19] offset:128
    s_waitcnt lgkmcnt(0)
    s_barrier
    ds_read_b128 v[12:15], v11
    ds_read_b128 v[16:19], v11 offset:1024
    s_add_u32 s13, s80, 172032
    s_lshl2_add_u32 m0, s89, 68608
    s_nop 0
    buffer_load_dwordx4 v72, s[56:59], s13 offen nt lds
    s_mov_b32 s13, s81
    s_lshl2_add_u32 m0, s89, 98304
    s_nop 0
    buffer_load_dwordx4 v73, s[60:63], s13 offen nt lds
    s_add_u32 s13, s81, 4096
    s_lshl2_add_u32 m0, s89, 99328
    s_nop 0
    buffer_load_dwordx4 v73, s[60:63], s13 offen nt lds
    s_add_u32 s13, s81, 8192
    s_lshl2_add_u32 m0, s89, 100352
    s_nop 0
    buffer_load_dwordx4 v73, s[60:63], s13 offen nt lds
    s_waitcnt lgkmcnt(0)
    v_mov_b32 v8, 0x3f803f80
    v_dot2_f32_bf16 v4, v12, v8, 0
    v_dot2_f32_bf16 v5, v12, v12, 0
    v_dot2_f32_bf16 v6, v13, v8, 0
    v_dot2_f32_bf16 v7, v13, v13, 0
    v_dot2_f32_bf16 v4, v14, v8, v4
    v_dot2_f32_bf16 v5, v14, v14, v5
    v_dot2_f32_bf16 v6, v15, v8, v6
    v_dot2_f32_bf16 v7, v15, v15, v7
    v_dot2_f32_bf16 v4, v16, v8, v4
    v_dot2_f32_bf16 v5, v16, v16, v5
    v_dot2_f32_bf16 v6, v17, v8, v6
    v_dot2_f32_bf16 v7, v17, v17, v7
    v_dot2_f32_bf16 v4, v18, v8, v4
    v_dot2_f32_bf16 v5, v18, v18, v5
    v_dot2_f32_bf16 v6, v19, v8, v6
    v_dot2_f32_bf16 v7, v19, v19, v7
    v_lshlrev_b32 v156, 16, v12
    v_and_b32 v157, s6, v12
    v_lshlrev_b32 v158, 16, v13
    v_pk_add_f32 v[4:5], v[4:5], v[6:7]
    v_and_b32 v159, s6, v13
    v_lshlrev_b32 v160, 16, v14
    v_add_f32_dpp v4, v4, v4 quad_perm:[1,0,3,2] row_mask:0xf bank_mask:0xf
    v_add_f32_dpp v5, v5, v5 quad_perm:[1,0,3,2] row_mask:0xf bank_mask:0xf
    v_and_b32 v161, s6, v14
    v_add_f32_dpp v4, v4, v4 quad_perm:[2,3,0,1] row_mask:0xf bank_mask:0xf
    v_add_f32_dpp v5, v5, v5 quad_perm:[2,3,0,1] row_mask:0xf bank_mask:0xf
    v_lshlrev_b32 v162, 16, v15
    v_add_f32_dpp v4, v4, v4 row_half_mirror row_mask:0xf bank_mask:0xf
    v_add_f32_dpp v5, v5, v5 row_half_mirror row_mask:0xf bank_mask:0xf
    v_and_b32 v163, s6, v15
    v_add_f32_dpp v4, v4, v4 row_ror:8 row_mask:0xf bank_mask:0xf
    v_add_f32_dpp v5, v5, v5 row_ror:8 row_mask:0xf bank_mask:0xf
    v_lshlrev_b32 v164, 16, v16
    v_and_b32 v165, s6, v16
    v_permlane16_swap_b32 v4, v5
    v_add_f32 v8, v4, v5
    v_add_f32 v4, v4, v5
    v_lshlrev_b32 v166, 16, v17
    v_and_b32 v167, s6, v17
    v_permlane32_swap_b32 v4, v8
    v_add_f32 v4, v4, v8
    v_mul_f32 v8, 0x3a800000, v4
    v_mul_f32 v4, 0x3a800000, v4
    v_lshlrev_b32 v168, 16, v18
    v_and_b32 v169, s6, v18
    v_permlane16_swap_b32 v4, v8
    v_fma_f32 v53, -v4, v4, v8
    v_cvt_pk_bf16_f32 v52, 0, v4
    v_max_f32 v53, 0, v53
    v_cvt_pk_bf16_f32 v53, 0, v53
    v_add_f32 v53, 0x3727c5ac, v53
    v_cvt_pk_bf16_f32 v53, 0, v53
    v_sqrt_f32 v53, v53
    v_lshlrev_b32 v170, 16, v19
    v_and_b32 v171, s6, v19
    v_cvt_pk_bf16_f32 v53, 0, v53
    v_rcp_f32 v53, v53
    s_nop 0
    v_pk_add_f32 v[172:173], v[156:157], v[52:53] op_sel_hi:[1,0] neg_lo:[0,1] neg_hi:[0,1]
    v_pk_add_f32 v[174:175], v[158:159], v[52:53] op_sel_hi:[1,0] neg_lo:[0,1] neg_hi:[0,1]
    v_pk_add_f32 v[176:177], v[160:161], v[52:53] op_sel_hi:[1,0] neg_lo:[0,1] neg_hi:[0,1]
    v_pk_add_f32 v[178:179], v[162:163], v[52:53] op_sel_hi:[1,0] neg_lo:[0,1] neg_hi:[0,1]
    v_pk_add_f32 v[180:181], v[164:165], v[52:53] op_sel_hi:[1,0] neg_lo:[0,1] neg_hi:[0,1]
    v_pk_add_f32 v[182:183], v[166:167], v[52:53] op_sel_hi:[1,0] neg_lo:[0,1] neg_hi:[0,1]
    v_pk_add_f32 v[184:185], v[168:169], v[52:53] op_sel_hi:[1,0] neg_lo:[0,1] neg_hi:[0,1]
    v_pk_add_f32 v[186:187], v[170:171], v[52:53] op_sel_hi:[1,0] neg_lo:[0,1] neg_hi:[0,1]
    v_cvt_pk_bf16_f32 v172, 0, v172
    v_cvt_pk_bf16_f32 v173, 0, v173
    v_cvt_pk_bf16_f32 v174, 0, v174
    v_cvt_pk_bf16_f32 v175, 0, v175
    v_cvt_pk_bf16_f32 v176, 0, v176
    v_cvt_pk_bf16_f32 v177, 0, v177
    v_cvt_pk_bf16_f32 v178, 0, v178
    v_cvt_pk_bf16_f32 v179, 0, v179
    v_cvt_pk_bf16_f32 v180, 0, v180
    v_cvt_pk_bf16_f32 v181, 0, v181
    v_cvt_pk_bf16_f32 v182, 0, v182
    v_cvt_pk_bf16_f32 v183, 0, v183
    v_cvt_pk_bf16_f32 v184, 0, v184
    v_cvt_pk_bf16_f32 v185, 0, v185
    v_cvt_pk_bf16_f32 v186, 0, v186
    v_cvt_pk_bf16_f32 v187, 0, v187
    v_pk_mul_f32 v[172:173], v[172:173], v[52:53] op_sel:[0,1]
    v_pk_mul_f32 v[174:175], v[174:175], v[52:53] op_sel:[0,1]
    v_pk_mul_f32 v[176:177], v[176:177], v[52:53] op_sel:[0,1]
    v_pk_mul_f32 v[178:179], v[178:179], v[52:53] op_sel:[0,1]
    v_pk_mul_f32 v[180:181], v[180:181], v[52:53] op_sel:[0,1]
    v_pk_mul_f32 v[182:183], v[182:183], v[52:53] op_sel:[0,1]
    v_pk_mul_f32 v[184:185], v[184:185], v[52:53] op_sel:[0,1]
    v_pk_mul_f32 v[186:187], v[186:187], v[52:53] op_sel:[0,1]
    v_cvt_pk_bf16_f32 v172, 0, v172
    v_cvt_pk_bf16_f32 v173, 0, v173
    v_cvt_pk_bf16_f32 v174, 0, v174
    v_cvt_pk_bf16_f32 v175, 0, v175
    v_cvt_pk_bf16_f32 v176, 0, v176
    v_cvt_pk_bf16_f32 v177, 0, v177
    v_cvt_pk_bf16_f32 v178, 0, v178
    v_cvt_pk_bf16_f32 v179, 0, v179
    v_cvt_pk_bf16_f32 v180, 0, v180
    v_cvt_pk_bf16_f32 v181, 0, v181
    v_cvt_pk_bf16_f32 v182, 0, v182
    v_cvt_pk_bf16_f32 v183, 0, v183
    v_cvt_pk_bf16_f32 v184, 0, v184
    v_cvt_pk_bf16_f32 v185, 0, v185
    v_cvt_pk_bf16_f32 v186, 0, v186
    v_cvt_pk_bf16_f32 v187, 0, v187
    v_pk_mul_f32 v[172:173], v[172:173], v[140:141]
    v_pk_mul_f32 v[174:175], v[174:175], v[142:143]
    v_pk_mul_f32 v[176:177], v[176:177], v[144:145]
    v_pk_mul_f32 v[178:179], v[178:179], v[146:147]
    v_pk_mul_f32 v[180:181], v[180:181], v[148:149]
    v_pk_mul_f32 v[182:183], v[182:183], v[150:151]
    v_pk_mul_f32 v[184:185], v[184:185], v[152:153]
    v_pk_mul_f32 v[186:187], v[186:187], v[154:155]
    v_cvt_pk_bf16_f32 v172, 0, v172
    v_cvt_pk_bf16_f32 v173, 0, v173
    v_cvt_pk_bf16_f32 v174, 0, v174
    v_cvt_pk_bf16_f32 v175, 0, v175
    v_cvt_pk_bf16_f32 v176, 0, v176
    v_cvt_pk_bf16_f32 v177, 0, v177
    v_cvt_pk_bf16_f32 v178, 0, v178
    v_cvt_pk_bf16_f32 v179, 0, v179
    v_cvt_pk_bf16_f32 v180, 0, v180
    v_cvt_pk_bf16_f32 v181, 0, v181
    v_cvt_pk_bf16_f32 v182, 0, v182
    v_cvt_pk_bf16_f32 v183, 0, v183
    v_cvt_pk_bf16_f32 v184, 0, v184
    v_cvt_pk_bf16_f32 v185, 0, v185
    v_cvt_pk_bf16_f32 v186, 0, v186
    v_cvt_pk_bf16_f32 v187, 0, v187
    v_pk_add_f32 v[172:173], v[172:173], v[124:125]
    v_pk_add_f32 v[174:175], v[174:175], v[126:127]
    v_pk_add_f32 v[176:177], v[176:177], v[128:129]
    v_pk_add_f32 v[178:179], v[178:179], v[130:131]
    v_pk_add_f32 v[180:181], v[180:181], v[132:133]
    v_pk_add_f32 v[182:183], v[182:183], v[134:135]
    v_pk_add_f32 v[184:185], v[184:185], v[136:137]
    v_pk_add_f32 v[186:187], v[186:187], v[138:139]
    v_cvt_pk_bf16_f32 v204, v172, v173
    v_cvt_pk_bf16_f32 v206, v174, v175
    v_cvt_pk_bf16_f32 v208, v176, v177
    v_cvt_pk_bf16_f32 v210, v178, v179
    v_cvt_pk_bf16_f32 v212, v180, v181
    v_cvt_pk_bf16_f32 v214, v182, v183
    v_cvt_pk_bf16_f32 v216, v184, v185
    v_cvt_pk_bf16_f32 v218, v186, v187
    v_dot2_f32_bf16 v52, v204, v44, 0
    v_dot2_f32_bf16 v53, v206, v45, 0
    v_dot2_f32_bf16 v52, v208, v46, v52
    v_dot2_f32_bf16 v53, v210, v47, v53
    v_dot2_f32_bf16 v52, v212, v48, v52
    v_dot2_f32_bf16 v53, v214, v49, v53
    v_dot2_f32_bf16 v52, v216, v50, v52
    v_dot2_f32_bf16 v53, v218, v51, v53
    s_nop 2
    v_add_f32 v52, v52, v53
    s_nop 1
    v_add_f32_dpp v52, v52, v52 quad_perm:[1,0,3,2] row_mask:0xf bank_mask:0xf
    s_nop 1
    v_add_f32_dpp v52, v52, v52 quad_perm:[2,3,0,1] row_mask:0xf bank_mask:0xf
    s_nop 1
    v_add_f32_dpp v52, v52, v52 row_half_mirror row_mask:0xf bank_mask:0xf
    s_nop 1
    v_add_f32_dpp v52, v52, v52 row_ror:8 row_mask:0xf bank_mask:0xf
    v_mov_b32 v53, v52
    s_nop 1
    v_permlane16_swap_b32 v52, v53
    v_add_f32 v52, v52, v53
    v_mov_b32 v53, v52
    s_nop 1
    v_permlane32_swap_b32 v52, v53
    v_add_f32 v52, v52, v53
    s_sub_u32 s13, 2047, s93
    s_lshl2_add_u32 s14, s3, 24832
    v_cvt_pk_bf16_f32 v52, 0, v52
    v_ashrrev_i32 v53, 31, v52
    v_or_b32 v53, 0x80000000, v53
    v_xor_b32 v52, v52, v53
    v_lshrrev_b32 v52, 16, v52
    v_lshl_or_b32 v52, v52, 11, s13
    v_mov_b32 v53, s14
    v_readfirstlane_b32 s13, v52
    s_nop 1
    v_mov_b32 v52, s13
    ds_write_b32 v53, v52
    v_and_b32 v4, 7, v1
    v_lshlrev_b32 v4, 2, v4
    v_add_u32 v4, 24832, v4
    v_and_b32 v6, 15, v1
    v_lshlrev_b32 v6, 15, v6
    s_lshl_b32 s16, s93, 11
    s_lshl_b32 s96, s93, 12
    s_add_u32 s17, s96, 33554432
    s_and_b32 s96, s9, 1
    s_and_b32 s97, s2, 135
    s_lshl_b32 s98, s97, 12
    s_bfe_u32 s99, s9, 196609
    s_lshl_b32 s97, s99, 6
    s_add_u32 s99, s98, s97
    s_lshl4_add_u32 s98, s96, s99
    s_add_u32 s97, s98, 1048576
    s_add_u32 s14, s97, 2048
    s_waitcnt lgkmcnt(0)
    s_barrier
    ds_read_b32 v5, v4
    v_mov_b32 v53, s4
    s_waitcnt lgkmcnt(0)
    v_cmp_gt_u32 vcc, v5, v52
    s_nop 0
    s_and_b32 s15, vcc_lo, 0xff
    s_bcnt1_i32_b32 s15, s15
    s_cmp_ge_u32 s15, 2
    s_cbranch_scc1 L_NOC1
    s_lshl3_add_u32 s14, s15, s14
    s_mov_b64 exec, 0xffff
    buffer_store_dwordx2 v[52:53], v6, s[32:35], s14 offen sc1
    s_mov_b64 exec, -1
L_NOC1:
    s_add_u32 s13, s81, 12288
    s_lshl2_add_u32 m0, s89, 101376
    s_nop 0
    buffer_load_dwordx4 v73, s[60:63], s13 offen nt lds
    v_lshlrev_b32 v172, 16, v204
    v_and_b32 v173, s6, v204
    v_lshlrev_b32 v174, 16, v206
    v_and_b32 v175, s6, v206
    v_lshlrev_b32 v176, 16, v208
    v_and_b32 v177, s6, v208
    v_lshlrev_b32 v178, 16, v210
    v_and_b32 v179, s6, v210
    v_lshlrev_b32 v180, 16, v212
    v_and_b32 v181, s6, v212
    v_lshlrev_b32 v182, 16, v214
    v_and_b32 v183, s6, v214
    v_lshlrev_b32 v184, 16, v216
    v_and_b32 v185, s6, v216
    v_lshlrev_b32 v186, 16, v218
    v_and_b32 v187, s6, v218
    v_lshlrev_b32 v124, 16, v36
    v_and_b32 v125, s6, v36
    v_lshlrev_b32 v126, 16, v37
    v_and_b32 v127, s6, v37
    v_lshlrev_b32 v128, 16, v38
    v_and_b32 v129, s6, v38
    v_lshlrev_b32 v130, 16, v39
    v_and_b32 v131, s6, v39
    v_lshlrev_b32 v132, 16, v40
    v_and_b32 v133, s6, v40
    v_lshlrev_b32 v134, 16, v41
    v_and_b32 v135, s6, v41
    v_lshlrev_b32 v136, 16, v42
    v_and_b32 v137, s6, v42
    v_lshlrev_b32 v138, 16, v43
    v_and_b32 v139, s6, v43
    v_bfe_u32 v7, v1, 1, 3
    v_lshlrev_b32 v7, 12, v7
    v_and_b32 v9, 1, v1
    v_lshl_add_u32 v7, v9, 19, v7
    s_lshr_b32 s96, s9, 4
    s_and_b32 s97, s9, 15
    s_lshl_b32 s98, s97, 15
    s_lshl_b32 s99, s8, 6
    s_add_u32 s97, s98, s99
    s_lshl4_add_u32 s98, s96, s97
    s_add_u32 s99, s98, 1048576
    s_add_u32 s14, s99, 2560
    s_lshl3_add_u32 s13, s3, 24896
    v_mov_b32 v4, s13
    v_mov_b32 v5, 24896
SPOLL_36:
    s_load_dwordx8 s[24:31], s[32:33], s92 offset:2048 glc
SCHK_37:
    s_add_u32 s5, s5, 1
    s_cmp_ge_u32 s5, 200000
    s_waitcnt lgkmcnt(0)
    s_cbranch_scc1 SDONE_38
    s_cmp_lg_u32 s25, s4
    s_cbranch_scc1 SPOLL_36
    s_cmp_lg_u32 s27, s4
    s_cbranch_scc1 SPOLL_36
    s_cmp_lg_u32 s29, s4
    s_cbranch_scc1 SPOLL_36
    s_cmp_lg_u32 s31, s4
    s_cbranch_scc1 SPOLL_36
SDONE_38:
    s_min_u32 s25, s24, s28
    s_max_u32 s24, s24, s28
    s_max_u32 s26, s26, s30
    s_max_u32 s25, s25, s26
    v_mov_b32 v188, s24
    v_mov_b32 v189, s25
    ds_write_b64 v4, v[188:189]
    s_cmp_ge_u32 s15, 2
    s_cbranch_scc1 L_NOC3
    buffer_store_dwordx4 v[204:207], v2, s[32:35], s17 offen sc1
    buffer_store_dwordx4 v[208:211], v2, s[32:35], s17 offen offset:2048 sc1
    buffer_store_dwordx4 v[212:215], v2, s[32:35], s17 offen offset:1024 sc1
    buffer_store_dwordx4 v[216:219], v2, s[32:35], s17 offen offset:3072 sc1
L_NOC3:
    s_waitcnt lgkmcnt(0)
    s_barrier
    s_cmp_lg_u32 s3, 0
    s_cbranch_scc1 L_NOF2
    ds_read_b128 v[188:191], v5 offset:0
    ds_read_b128 v[192:195], v5 offset:16
    ds_read_b128 v[196:199], v5 offset:32
    ds_read_b128 v[200:203], v5 offset:48
    s_waitcnt lgkmcnt(0)
    v_min_u32 v6, v188, v190
    v_max_u32 v188, v188, v190
    v_max3_u32 v189, v189, v191, v6
    v_min_u32 v6, v192, v194
    v_max_u32 v192, v192, v194
    v_max3_u32 v193, v193, v195, v6
    v_min_u32 v6, v196, v198
    v_max_u32 v196, v196, v198
    v_max3_u32 v197, v197, v199, v6
    v_min_u32 v6, v200, v202
    v_max_u32 v200, v200, v202
    v_max3_u32 v201, v201, v203, v6
    v_min_u32 v6, v188, v192
    v_max_u32 v188, v188, v192
    v_max3_u32 v189, v189, v193, v6
    v_min_u32 v6, v196, v200
    v_max_u32 v196, v196, v200
    v_max3_u32 v197, v197, v201, v6
    v_min_u32 v6, v188, v196
    v_max_u32 v188, v188, v196
    v_max3_u32 v189, v189, v197, v6
    v_mov_b32 v190, v189
    v_mov_b32 v189, s4
    v_mov_b32 v191, s4
    s_mov_b64 exec, 0xffff
    buffer_store_dwordx4 v[188:191], v7, s[32:35], s14 offen sc1
    s_mov_b64 exec, -1
L_NOF2:
    s_lshr_b32 s96, s3, 2
    s_lshl_b32 s97, s96, 15
    s_and_b32 s98, s3, 3
    s_lshl_b32 s99, s98, 5
    s_add_u32 s96, s97, s99
    s_add_u32 s13, s96, 32768
    v_lshrrev_b32 v54, 4, v1
    v_lshlrev_b32 v54, 13, v54
    v_bfe_u32 v9, v1, 2, 2
    v_lshl_add_u32 v54, v9, 7, v54
    v_bfe_u32 v9, v1, 3, 2
    v_lshl_add_u32 v54, v9, 5, v54
    v_and_b32 v9, 3, v1
    v_lshl_add_u32 v54, v9, 3, v54
    v_xor_b32 v54, s13, v54
    s_lshl_b32 s13, s3, 6
    v_bfe_u32 v55, v1, 2, 1
    v_lshlrev_b32 v55, 9, v55
    v_bfe_u32 v9, v1, 3, 1
    v_lshl_add_u32 v55, v9, 12, v55
    v_lshrrev_b32 v9, 5, v1
    v_lshl_add_u32 v55, v9, 11, v55
    v_bfe_u32 v9, v1, 2, 2
    v_lshl_add_u32 v55, v9, 6, v55
    v_bfe_u32 v9, v1, 4, 1
    v_lshl_add_u32 v55, v9, 5, v55
    v_and_b32 v9, 3, v1
    v_lshl_add_u32 v55, v9, 3, v55
    v_xor_b32 v55, s13, v55
    v_add_u32 v55, 98304, v55
    s_lshl_b32 s96, s75, 9
    s_add_u32 s13, s96, 33554432
    v_and_b32 v56, 7, v1
    v_lshl_add_u32 v56, v56, 4, s13
    v_lshrrev_b32 v9, 4, v1
    v_lshl_add_u32 v56, v9, 7, v56
    v_and_b32 v8, 8, v1
    v_cmp_eq_u32 s[22:23], 0, v8
    v_and_b32 v8, 15, v1
    v_lshlrev_b32 v8, 4, v8
    v_lshrrev_b32 v9, 5, v1
    v_lshl_add_u32 v8, v9, 3, v8
    s_lshl_b32 s96, s74, 13
    s_add_u32 s14, s96, 20971520
    s_lshl3_add_u32 s96, s75, s3
    s_lshl_b32 s97, s96, 8
    s_add_u32 s20, s97, s14
    s_lshl3_add_u32 s13, s3, 24960
    v_mov_b32 v4, s13
    v_mov_b32 v5, 24960
    s_load_dwordx8 s[24:31], s[32:33], s92 offset:2560 glc
    v_pk_mul_f32 v[172:173], v[172:173], v[124:125]
    v_pk_mul_f32 v[174:175], v[174:175], v[126:127]
    v_pk_mul_f32 v[176:177], v[176:177], v[128:129]
    v_pk_mul_f32 v[178:179], v[178:179], v[130:131]
    v_pk_mul_f32 v[180:181], v[180:181], v[132:133]
    v_pk_mul_f32 v[182:183], v[182:183], v[134:135]
    v_pk_mul_f32 v[184:185], v[184:185], v[136:137]
    v_pk_mul_f32 v[186:187], v[186:187], v[138:139]
    v_cvt_pk_bf16_f32 v172, 0, v172
    v_cvt_pk_bf16_f32 v173, 0, v173
    v_cvt_pk_bf16_f32 v174, 0, v174
    v_cvt_pk_bf16_f32 v175, 0, v175
    v_cvt_pk_bf16_f32 v176, 0, v176
    v_cvt_pk_bf16_f32 v177, 0, v177
    v_cvt_pk_bf16_f32 v178, 0, v178
    v_cvt_pk_bf16_f32 v179, 0, v179
    v_cvt_pk_bf16_f32 v180, 0, v180
    v_cvt_pk_bf16_f32 v181, 0, v181
    v_cvt_pk_bf16_f32 v182, 0, v182
    v_cvt_pk_bf16_f32 v183, 0, v183
    v_cvt_pk_bf16_f32 v184, 0, v184
    v_cvt_pk_bf16_f32 v185, 0, v185
    v_cvt_pk_bf16_f32 v186, 0, v186
    v_cvt_pk_bf16_f32 v187, 0, v187
    v_pk_add_f32 v[172:173], v[172:173], v[156:157]
    v_pk_add_f32 v[174:175], v[174:175], v[158:159]
    v_pk_add_f32 v[176:177], v[176:177], v[160:161]
    v_pk_add_f32 v[178:179], v[178:179], v[162:163]
    v_pk_add_f32 v[180:181], v[180:181], v[164:165]
    v_pk_add_f32 v[182:183], v[182:183], v[166:167]
    v_pk_add_f32 v[184:185], v[184:185], v[168:169]
    v_pk_add_f32 v[186:187], v[186:187], v[170:171]
    v_cvt_pk_bf16_f32 v64, v172, v173
    v_cvt_pk_bf16_f32 v65, v174, v175
    v_cvt_pk_bf16_f32 v66, v176, v177
    v_cvt_pk_bf16_f32 v67, v178, v179
    v_cvt_pk_bf16_f32 v68, v180, v181
    v_cvt_pk_bf16_f32 v69, v182, v183
    v_cvt_pk_bf16_f32 v70, v184, v185
    v_cvt_pk_bf16_f32 v71, v186, v187
    s_cmp_lt_u32 s15, 2
    s_cbranch_scc1 L_NOC2
    buffer_store_dwordx4 v[64:67], v2, s[64:67], s16 offen
    buffer_store_dwordx4 v[68:71], v2, s[64:67], s16 offen offset:1024
L_NOC2:
    s_branch SCHK_40
SPOLL_39:
    s_load_dwordx8 s[24:31], s[32:33], s92 offset:2560 glc
SCHK_40:
    s_add_u32 s5, s5, 1
    s_cmp_ge_u32 s5, 200000
    s_waitcnt lgkmcnt(0)
    s_cbranch_scc1 SDONE_41
    s_cmp_lg_u32 s25, s4
    s_cbranch_scc1 SPOLL_39
    s_cmp_lg_u32 s27, s4
    s_cbranch_scc1 SPOLL_39
    s_cmp_lg_u32 s29, s4
    s_cbranch_scc1 SPOLL_39
    s_cmp_lg_u32 s31, s4
    s_cbranch_scc1 SPOLL_39
SDONE_41:
    s_min_u32 s25, s24, s28
    s_max_u32 s24, s24, s28
    s_max_u32 s26, s26, s30
    s_max_u32 s25, s25, s26
    v_mov_b32 v188, s24
    v_mov_b32 v189, s25
    ds_write_b64 v4, v[188:189]
    s_waitcnt vmcnt(0)
    s_waitcnt lgkmcnt(0)
    s_barrier
    ds_read_b128 v[188:191], v5
    ds_read_b128 v[192:195], v5 offset:16
    ds_read_b128 v[196:199], v5 offset:32
    ds_read_b128 v[200:203], v5 offset:48
    s_waitcnt lgkmcnt(0)
    v_min_u32 v6, v188, v190
    v_max_u32 v188, v188, v190
    v_max3_u32 v189, v189, v191, v6
    v_min_u32 v6, v192, v194
    v_max_u32 v192, v192, v194
    v_max3_u32 v193, v193, v195, v6
    v_min_u32 v6, v196, v198
    v_max_u32 v196, v196, v198
    v_max3_u32 v197, v197, v199, v6
    v_min_u32 v6, v200, v202
    v_max_u32 v200, v200, v202
    v_max3_u32 v201, v201, v203, v6
    v_min_u32 v6, v188, v192
    v_max_u32 v188, v188, v192
    v_max3_u32 v189, v189, v193, v6
    v_min_u32 v6, v196, v200
    v_max_u32 v196, v196, v200
    v_max3_u32 v197, v197, v201, v6
    v_min_u32 v6, v188, v196
    v_max_u32 v188, v188, v196
    v_max3_u32 v189, v189, v197, v6
    v_cndmask_b32 v4, v189, v188, s[22:23]
    v_readfirstlane_b32 s68, v188
    v_not_b32 v4, v4
    v_readfirstlane_b32 s69, v189
    v_and_b32 v4, 2047, v4
    v_lshl_add_u32 v4, v4, 12, v56
    buffer_load_dwordx4 v[192:195], v4, s[32:35], 0 offen sc1
    buffer_load_dwordx4 v[196:199], v4, s[32:35], 0 offen offset:2048 sc1
    ds_read_b64_tr_b16 v[76:77], v54
    ds_read_b64_tr_b16 v[78:79], v54 offset:512
    ds_read_b64_tr_b16 v[80:81], v54 offset:1024
    ds_read_b64_tr_b16 v[82:83], v54 offset:1536
    ds_read_b64_tr_b16 v[84:85], v54 offset:2048
    ds_read_b64_tr_b16 v[86:87], v54 offset:2560
    ds_read_b64_tr_b16 v[88:89], v54 offset:3072
    ds_read_b64_tr_b16 v[90:91], v54 offset:3584
    ds_read_b64_tr_b16 v[92:93], v54 offset:4096
    ds_read_b64_tr_b16 v[94:95], v54 offset:4608
    ds_read_b64_tr_b16 v[96:97], v54 offset:5120
    ds_read_b64_tr_b16 v[98:99], v54 offset:5632
    ds_read_b64_tr_b16 v[100:101], v54 offset:6144
    ds_read_b64_tr_b16 v[102:103], v54 offset:6656
    ds_read_b64_tr_b16 v[104:105], v54 offset:7168
    ds_read_b64_tr_b16 v[106:107], v54 offset:7680
    s_andn2_b32 s70, 2047, s68
    s_andn2_b32 s71, 2047, s69
    s_waitcnt lgkmcnt(0)
    s_waitcnt vmcnt(0)
    v_bitop3_b32 v5, v193, v195, s4 bitop3:0x7e
    v_bitop3_b32 v5, v5, v197, s4 bitop3:0xf6
    v_bitop3_b32 v5, v5, v199, s4 bitop3:0xf6
    v_cmp_ne_u32 vcc, 0, v5
    s_cbranch_vccz TOK_43
POLL_44:
    buffer_load_dwordx4 v[192:195], v4, s[32:35], 0 offen sc1
    buffer_load_dwordx4 v[196:199], v4, s[32:35], 0 offen offset:2048 sc1
    s_waitcnt vmcnt(0)
    v_bitop3_b32 v5, v193, v195, s4 bitop3:0x7e
    v_bitop3_b32 v5, v5, v197, s4 bitop3:0xf6
    v_bitop3_b32 v5, v5, v199, s4 bitop3:0xf6
    v_cmp_ne_u32 vcc, 0, v5
    s_cbranch_vccz PDONE_45
    s_add_u32 s5, s5, 1
    s_cmp_lt_u32 s5, 200000
    s_cbranch_scc1 POLL_44
PDONE_45:
TOK_43:
    v_mov_b32 v193, v194
    v_mov_b32 v194, v196
    v_mov_b32 v195, v198
    s_nop 1
    v_mfma_f32_16x16x32_bf16 v[156:159], v[192:195], v[76:79], 0
    v_mfma_f32_16x16x32_bf16 v[160:163], v[192:195], v[80:83], 0
    v_mfma_f32_16x16x32_bf16 v[164:167], v[192:195], v[84:87], 0
    v_mfma_f32_16x16x32_bf16 v[168:171], v[192:195], v[88:91], 0
    v_mfma_f32_16x16x32_bf16 v[172:175], v[192:195], v[92:95], 0
    v_mfma_f32_16x16x32_bf16 v[176:179], v[192:195], v[96:99], 0
    v_mfma_f32_16x16x32_bf16 v[180:183], v[192:195], v[100:103], 0
    v_mfma_f32_16x16x32_bf16 v[184:187], v[192:195], v[104:107], 0
    ds_read_b64_tr_b16 v[108:109], v55
    ds_read_b64_tr_b16 v[110:111], v55 offset:1024
    ds_read_b64_tr_b16 v[112:113], v55 offset:8192
    ds_read_b64_tr_b16 v[114:115], v55 offset:9216
    ds_read_b64_tr_b16 v[116:117], v55 offset:16384
    ds_read_b64_tr_b16 v[118:119], v55 offset:17408
    ds_read_b64_tr_b16 v[120:121], v55 offset:24576
    ds_read_b64_tr_b16 v[122:123], v55 offset:25600
    v_add_f32 v188, v156, v161
    v_add_f32 v189, v166, v171
    v_add_f32 v190, v172, v177
    v_add_f32 v191, v182, v187
    v_add_f32 v188, v188, v189
    v_add_f32 v190, v190, v191
    v_mov_b32 v189, s4
    s_nop 0
    v_permlane16_swap_b32 v190, v191
    s_cmp_ge_u32 s9, 28
    s_cbranch_scc1 L_NOHP
    v_add_f32 v188, v188, v191
    s_mov_b32 exec_lo, 0xffff
    s_mov_b32 exec_hi, 0xffff
    buffer_store_dwordx2 v[188:189], v8, s[32:35], s20 offen sc1
    s_mov_b64 exec, -1
L_NOHP:
    s_bitcmp1_b32 s9, 1
    s_cselect_b32 s17, s71, s70
    s_cselect_b32 s18, s69, s68
    s_cmp_ge_u32 s15, 2
    s_cbranch_scc1 L_NOOUT
    s_cmp_eq_u32 s93, s70
    s_cbranch_scc1 L_NOOUT
    s_cmp_eq_u32 s93, s71
    s_cbranch_scc1 L_NOOUT
    buffer_store_dwordx4 v[64:67], v2, s[64:67], s16 offen
    buffer_store_dwordx4 v[68:71], v2, s[64:67], s16 offen offset:1024
L_NOOUT:
    s_cmp_lg_u32 s93, 7
    s_cbranch_scc1 L_NONON
    v_mov_b32 v6, s4
    s_mov_b64 exec, 1
    buffer_store_dword v6, v3, s[32:35], 0 offen sc1
    s_mov_b64 exec, -1
L_NONON:
    s_cmp_ge_u32 s9, 28
    s_cbranch_scc1 L_FIN
    s_cmp_lg_u32 s3, 7
    s_cbranch_scc1 L_NOFZ
    s_bfe_u32 s96, s9, 131074
    s_lshl2_add_u32 s97, s8, s96
    s_and_b32 s98, s9, 1
    s_lshl1_add_u32 s19, s97, s98
    s_and_b32 s96, s9, 15
    s_lshl4_add_u32 s97, s8, s96
    s_mul_i32 s98, s97, 7168
    s_add_u32 s20, s98, 22020096
    s_lshl_b32 s96, s17, 11
    s_lshl_b32 s97, s19, 5
    s_add_u32 s82, s96, s97
    v_and_b32 v10, 7, v1
    v_lshlrev_b32 v10, 2, v10
    s_lshl_b32 s96, s19, 5
    s_add_u32 s97, s96, 16640
    s_add_u32 s13, s97, 4096
    v_add_u32 v5, s13, v10
    ds_read_b32 v74, v5
    s_lshl_b32 s96, s17, 12
    s_lshl_b32 s97, s19, 5
    s_add_u32 s98, s96, s97
    s_add_u32 s68, s98, 33554432
    v_bfe_u32 v11, v1, 2, 1
    v_lshlrev_b32 v11, 4, v11
    v_bfe_u32 v9, v1, 1, 1
    v_lshl_add_u32 v11, v9, 11, v11
    v_and_b32 v9, 1, v1
    v_lshl_add_u32 v11, v9, 3, v11
    s_and_b32 s96, s17, 31
    s_lshr_b32 s97, s17, 5
    s_lshl_b32 s98, s97, 6
    s_add_u32 s99, s98, s19
    s_lshl_b32 s97, s99, 10
    s_lshl4_add_u32 s98, s96, s97
    s_add_u32 s13, s98, 12582912
    v_bfe_u32 v5, v1, 2, 1
    v_lshlrev_b32 v5, 9, v5
    v_and_b32 v9, 3, v1
    v_lshl_add_u32 v5, v9, 2, v5
    buffer_load_dword v73, v5, s[32:35], s13 offen sc1
    s_lshr_b32 s13, s18, 11
    s_lshl_b32 s13, s13, 16
    s_ashr_i32 s15, s13, 31
    s_andn2_b32 s15, 0x7fff0000, s15
    s_or_b32 s15, s15, 0x80000000
    s_xor_b32 s13, s13, s15
    v_mov_b32 v75, s13
    v_mul_f32 v75, s7, v75
    v_exp_f32 v75, -v75
    s_nop 0
    v_add_f32 v75, 1.0, v75
    v_rcp_f32 v75, v75
    s_nop 0
    v_cvt_pk_bf16_f32 v75, 0, v75
L_NOFZ:
    s_cmp_ge_u32 s3, 4
    s_cbranch_scc1 L_NOH
    s_lshl_b32 s96, s3, 8
    s_add_u32 s13, s96, s14
    v_lshrrev_b32 v4, 4, v1
    v_lshlrev_b32 v4, 11, v4
    v_and_b32 v9, 15, v1
    v_lshl_add_u32 v4, v9, 4, v4
    s_lshl_b32 s96, s3, 5
    s_add_u32 s15, s96, 25088
    v_lshrrev_b32 v5, 5, v1
    v_lshl_add_u32 v5, v5, 7, s15
    v_bfe_u32 v9, v1, 2, 1
    v_lshl_add_u32 v5, v9, 4, v5
    v_bfe_u32 v9, v1, 1, 1
    v_lshl_add_u32 v5, v9, 3, v5
    v_bfe_u32 v9, v1, 3, 1
    v_lshl_add_u32 v5, v9, 2, v5
    v_and_b32 v9, 1, v1
    v_lshl_add_u32 v5, v9, 1, v5
SPOLL_46:
    s_load_dword s24, s[32:33], s13 offset:1276 glc
    s_load_dword s25, s[32:33], s13 offset:3324 glc
    s_load_dword s26, s[32:33], s13 offset:5372 glc
    s_load_dword s27, s[32:33], s13 offset:7420 glc
SCHK_47:
    s_add_u32 s5, s5, 1
    s_cmp_ge_u32 s5, 200000
    s_waitcnt lgkmcnt(0)
    s_cbranch_scc1 SDONE_48
    s_cmp_lg_u32 s24, s4
    s_cbranch_scc1 SPOLL_46
    s_cmp_lg_u32 s25, s4
    s_cbranch_scc1 SPOLL_46
    s_cmp_lg_u32 s26, s4
    s_cbranch_scc1 SPOLL_46
    s_cmp_lg_u32 s27, s4
    s_cbranch_scc1 SPOLL_46
SDONE_48:
POLL_49:
    buffer_load_dwordx4 v[156:159], v4, s[32:35], s13 offen sc1
    buffer_load_dwordx4 v[160:163], v4, s[32:35], s13 offen offset:1024 sc1
    s_waitcnt vmcnt(0)
    v_bitop3_b32 v6, v157, v159, s4 bitop3:0x7e
    v_bitop3_b32 v6, v6, v161, s4 bitop3:0xf6
    v_bitop3_b32 v6, v6, v163, s4 bitop3:0xf6
    v_cmp_ne_u32 vcc, 0, v6
    s_cbranch_vccz PDONE_50
    s_add_u32 s5, s5, 1
    s_cmp_lt_u32 s5, 200000
    s_cbranch_scc1 POLL_49
PDONE_50:
    v_permlane32_swap_b32 v156, v158
    v_permlane32_swap_b32 v160, v162
    v_add_f32 v156, v156, v158
    v_add_f32 v160, v160, v162
    v_mov_b32 v158, v156
    v_mov_b32 v162, v160
    s_nop 0
    v_permlane16_swap_b32 v156, v158
    v_permlane16_swap_b32 v160, v162
    v_add_f32 v156, v156, v158
    v_add_f32 v160, v160, v162
    v_cvt_pk_bf16_f32 v156, 0, v156
    v_cvt_pk_bf16_f32 v160, 0, v160
    v_mul_f32 v6, s7, v156
    v_exp_f32 v6, -v6
    s_nop 0
    v_add_f32 v6, 1.0, v6
    v_rcp_f32 v6, v6
    s_nop 0
    v_mul_f32 v156, v156, v6
    v_cvt_pk_bf16_f32 v156, 0, v156
    v_mul_f32 v156, v156, v160
    v_cvt_pk_bf16_f32 v156, v156, v156
    ds_write_b16 v5, v156
L_NOH:
    v_bfe_u32 v4, v1, 2, 1
    v_lshlrev_b32 v4, 7, v4
    v_lshrrev_b32 v9, 5, v1
    v_lshl_add_u32 v4, v9, 4, v4
    v_add_u32 v4, 25088, v4
    v_lshrrev_b32 v5, 4, v1
    v_mul_u32_u24 v5, 7168, v5
    v_and_b32 v9, 15, v1
    v_lshl_add_u32 v5, v9, 3, v5
    v_and_b32 v6, 3, v1
    v_lshlrev_b32 v6, 15, v6
    s_lshl3_add_u32 s96, s75, s3
    s_mul_i32 s97, s96, 28672
    s_lshl_b32 s98, s74, 7
    s_add_u32 s99, s97, s98
    s_add_u32 s13, s99, 22020096
    s_lshr_b32 s96, s9, 2
    s_lshr_b32 s97, s3, 2
    s_lshl1_add_u32 s98, s75, s97
    s_and_b32 s99, s3, 3
    s_lshl_b32 s97, s99, 5
    s_add_u32 s99, s98, s97
    s_lshl_b32 s98, s99, 12
    s_lshl_b32 s97, s8, 6
    s_add_u32 s99, s98, s97
    s_lshl2_add_u32 s98, s96, s99
    s_add_u32 s97, s98, 1048576
    s_add_u32 s14, s97, 3072
    s_waitcnt lgkmcnt(0)
    s_barrier
    ds_read_b128 v[156:159], v4
    ds_read_b128 v[160:163], v4 offset:32
    ds_read_b128 v[164:167], v4 offset:64
    ds_read_b128 v[168:171], v4 offset:96
    s_waitcnt lgkmcnt(3)
    v_mfma_f32_32x32x16_bf16 v[172:187], v[156:159], v[108:111], 0
    s_waitcnt lgkmcnt(2)
    v_mfma_f32_32x32x16_bf16 v[172:187], v[160:163], v[112:115], v[172:187]
    s_waitcnt lgkmcnt(1)
    v_mfma_f32_32x32x16_bf16 v[172:187], v[164:167], v[116:119], v[172:187]
    s_waitcnt lgkmcnt(0)
    v_mfma_f32_32x32x16_bf16 v[172:187], v[168:171], v[120:123], v[172:187]
    s_nop 11
    v_mov_b32 v173, s4
    buffer_store_dwordx2 v[172:173], v5, s[32:35], s13 offen sc1
    s_mov_b64 exec, 15
    buffer_store_dword v173, v6, s[32:35], s14 offen sc1
    s_mov_b64 exec, -1
    s_cmp_ge_u32 s9, 16
    s_cbranch_scc1 L_FIN
SPOLL_51:
    s_load_dwordx8 s[24:31], s[32:33], s92 offset:3072 glc
SCHK_52:
    s_add_u32 s5, s5, 1
    s_cmp_ge_u32 s5, 200000
    s_waitcnt lgkmcnt(0)
    s_cbranch_scc1 SDONE_53
    s_cmp_lg_u32 s24, s4
    s_cbranch_scc1 SPOLL_51
    s_cmp_lg_u32 s25, s4
    s_cbranch_scc1 SPOLL_51
    s_cmp_lg_u32 s26, s4
    s_cbranch_scc1 SPOLL_51
    s_cmp_lg_u32 s27, s4
    s_cbranch_scc1 SPOLL_51
    s_cmp_lg_u32 s28, s4
    s_cbranch_scc1 SPOLL_51
    s_cmp_lg_u32 s29, s4
    s_cbranch_scc1 SPOLL_51
    s_cmp_lg_u32 s30, s4
    s_cbranch_scc1 SPOLL_51
SDONE_53:
    s_barrier
    s_cmp_lg_u32 s3, 7
    s_cbranch_scc1 L_FIN
    s_add_u32 s13, s20, 4096
POLL_54:
    buffer_load_dwordx4 v[156:159], v2, s[32:35], s20 offen sc1
    buffer_load_dwordx4 v[160:163], v2, s[32:35], s20 offen offset:1024 sc1
    buffer_load_dwordx4 v[164:167], v2, s[32:35], s20 offen offset:2048 sc1
    buffer_load_dwordx4 v[168:171], v2, s[32:35], s20 offen offset:3072 sc1
    buffer_load_dwordx4 v[188:191], v2, s[32:35], s13 offen sc1
    buffer_load_dwordx4 v[192:195], v2, s[32:35], s13 offen offset:1024 sc1
    buffer_load_dwordx4 v[196:199], v2, s[32:35], s13 offen offset:2048 sc1
    buffer_load_dwordx2 v[52:53], v11, s[32:35], s68 offen sc1
    s_waitcnt vmcnt(0)
    v_bitop3_b32 v4, v157, v159, s4 bitop3:0x7e
    v_bitop3_b32 v4, v4, v161, s4 bitop3:0xf6
    v_bitop3_b32 v4, v4, v163, s4 bitop3:0xf6
    v_bitop3_b32 v4, v4, v165, s4 bitop3:0xf6
    v_bitop3_b32 v4, v4, v167, s4 bitop3:0xf6
    v_bitop3_b32 v4, v4, v169, s4 bitop3:0xf6
    v_bitop3_b32 v4, v4, v171, s4 bitop3:0xf6
    v_bitop3_b32 v4, v4, v189, s4 bitop3:0xf6
    v_bitop3_b32 v4, v4, v191, s4 bitop3:0xf6
    v_bitop3_b32 v4, v4, v193, s4 bitop3:0xf6
    v_bitop3_b32 v4, v4, v195, s4 bitop3:0xf6
    v_bitop3_b32 v4, v4, v197, s4 bitop3:0xf6
    v_bitop3_b32 v4, v4, v199, s4 bitop3:0xf6
    v_bitop3_b32 v4, v4, v53, s4 bitop3:0xf6
    v_cmp_ne_u32 vcc, 0, v4
    s_cbranch_vccz PDONE_55
    s_add_u32 s5, s5, 1
    s_cmp_lt_u32 s5, 200000
    s_cbranch_scc1 POLL_54
PDONE_55:
    v_add_f32 v156, v156, v160
    v_add_f32 v158, v158, v162
    v_add_f32 v156, v156, v164
    v_add_f32 v158, v158, v166
    v_add_f32 v156, v156, v168
    v_add_f32 v158, v158, v170
    v_add_f32 v156, v156, v188
    v_add_f32 v158, v158, v190
    v_add_f32 v156, v156, v192
    v_add_f32 v158, v158, v194
    v_add_f32 v156, v156, v196
    v_add_f32 v158, v158, v198
    v_mov_b32 v157, v158
    v_add_f32_dpp v156, v156, v156 row_ror:8 row_mask:0xf bank_mask:0xf
    s_nop 0
    v_add_f32_dpp v157, v157, v157 row_ror:8 row_mask:0xf bank_mask:0xf
    v_mov_b32 v158, v156
    v_mov_b32 v159, v157
    s_nop 0
    v_permlane16_swap_b32 v156, v158
    v_permlane16_swap_b32 v157, v159
    v_pk_add_f32 v[156:157], v[156:157], v[158:159]
    v_mov_b32 v158, v156
    v_mov_b32 v159, v157
    s_nop 0
    v_permlane32_swap_b32 v156, v158
    v_permlane32_swap_b32 v157, v159
    v_pk_add_f32 v[156:157], v[156:157], v[158:159]
    v_cvt_pk_bf16_f32 v156, 0, v156
    v_cvt_pk_bf16_f32 v157, 0, v157
    v_pk_mul_f32 v[156:157], v[156:157], v[74:75] op_sel:[0,1]
    v_lshlrev_b32 v4, 16, v52
    v_and_b32 v5, s6, v52
    v_cvt_pk_bf16_f32 v156, 0, v156
    v_cvt_pk_bf16_f32 v157, 0, v157
    v_pk_add_f32 v[156:157], v[156:157], v[4:5]
    v_lshlrev_b32 v4, 16, v74
    v_and_b32 v5, s6, v74
    v_cvt_pk_bf16_f32 v156, 0, v156
    v_cvt_pk_bf16_f32 v157, 0, v157
    v_pk_mul_f32 v[156:157], v[156:157], v[4:5]
    v_lshlrev_b32 v4, 16, v73
    v_and_b32 v5, s6, v73
    v_cvt_pk_bf16_f32 v156, 0, v156
    v_cvt_pk_bf16_f32 v157, 0, v157
    v_pk_add_f32 v[156:157], v[156:157], v[4:5]
    v_cvt_pk_bf16_f32 v156, v156, v157
    s_mov_b64 exec, 0xff
    buffer_store_dword v156, v10, s[64:67], s82 offen sc1
    s_mov_b64 exec, -1
L_FIN:
L_END:
    s_endpgm
.p2align 10
.fill 768, 4, 0xbf800000
.section .rodata,"a"
.p2align 6
.amdhsa_kernel adaLN_cond__linear_kernel_hedgehog__moe_arch_mod__prompt_kernel
  .amdhsa_next_free_vgpr 256
  .amdhsa_next_free_sgpr 102
  .amdhsa_accum_offset 256
  .amdhsa_group_segment_fixed_size 0
  .amdhsa_kernarg_size 112
  .amdhsa_user_sgpr_count 2
  .amdhsa_user_sgpr_kernarg_segment_ptr 1
  .amdhsa_system_sgpr_workgroup_id_x 1
  .amdhsa_float_denorm_mode_32 3
  .amdhsa_float_denorm_mode_16_64 3
.end_amdhsa_kernel
```

```asm
; @launch grid=(256,1,1) block=(512,1,1) lds=163840
.amdgcn_target "amdgcn-amd-amdhsa--gfx950"
.text
.globl adaLN_cond__linear_kernel_hedgehog__moe_arch_mod__prompt_kernel
.p2align 12
.type adaLN_cond__linear_kernel_hedgehog__moe_arch_mod__prompt_kernel,@function
adaLN_cond__linear_kernel_hedgehog__moe_arch_mod__prompt_kernel:
    s_load_dwordx16 s[68:83], s[0:1], 0
    s_load_dwordx8 s[84:91], s[0:1], 64
    s_load_dwordx2 s[32:33], s[0:1], 104
    s_cmp_ge_u32 s2, 256
    s_cbranch_scc1 L_END
    v_lshrrev_b32 v4, 6, v0
    v_and_b32 v1, 63, v0
    s_nop 0
    v_readfirstlane_b32 s3, v4
    v_lshlrev_b32 v2, 4, v1
    s_mov_b32 s38, 4194304
    s_mov_b32 s39, 0x20000
    s_mov_b32 s50, 12582912
    s_mov_b32 s51, 0x20000
    s_mov_b32 s34, 268435456
    s_mov_b32 s35, 0x20000
    s_mov_b32 s42, 6291456
    s_mov_b32 s43, 0x20000
    s_mov_b32 s46, 2097152
    s_mov_b32 s47, 0x20000
    s_mov_b32 s54, 7340032
    s_mov_b32 s55, 0x20000
    s_mov_b32 s58, 7340032
    s_mov_b32 s59, 0x20000
    s_mov_b32 s62, 7340032
    s_mov_b32 s63, 0x20000
    s_mov_b32 s66, 4194304
    s_mov_b32 s67, 0x20000
    s_mov_b32 s5, 0
    s_mov_b32 s6, 0xffff0000
    s_mov_b32 s7, 0x3fb8aa3b
    s_and_b32 s8, s2, 7
    s_lshr_b32 s9, s2, 3
    s_lshl_b32 s96, s8, 5
    s_add_u32 s97, s96, s9
    s_lshl3_add_u32 s93, s97, s3
    s_and_b32 s96, s8, 4
    s_lshr_b32 s97, s9, 2
    s_lshl1_add_u32 s10, s96, s97
    s_and_b32 s96, s8, 3
    s_and_b32 s97, s9, 3
    s_xor_b32 s98, s97, 2
    s_lshl2_add_u32 s11, s96, s98
    s_and_b32 s96, s8, 1
    s_and_b32 s97, s9, 7
    s_lshl3_add_u32 s12, s96, s97
    s_lshr_b32 s96, s8, 1
    s_lshr_b32 s97, s9, 3
    s_lshl2_add_u32 s21, s96, s97
    s_lshl_b32 s96, s2, 6
    s_add_u32 s97, s96, s3
    s_lshl_b32 s98, s97, 6
    s_add_u32 s92, s98, 1048576
    s_lshl_b32 s16, s93, 11
    s_lshl3_add_u32 s96, s8, s3
    s_lshl_b32 s15, s96, 5
    s_mul_i32 s96, s15, 6144
    s_xor_b32 s97, s9, 1
    s_lshl_b32 s98, s97, 7
    s_add_u32 s13, s96, s98
    s_add_u32 s14, s13, 98304
    s_lshl3_add_u32 s96, s21, s3
    s_lshl_b32 s97, s96, 15
    s_lshl_b32 s98, s12, 7
    s_add_u32 s18, s97, s98
    s_lshr_b32 s96, s8, 1
    s_lshl4_add_u32 s97, s96, s12
    s_lshl4_add_u32 s98, s97, s3
    s_lshl_b32 s99, s98, 9
    s_add_u32 s17, s99, 524288
    v_lshrrev_b32 v248, 3, v1
    v_mul_u32_u24 v248, 12288, v248
    v_and_b32 v9, 7, v1
    v_lshl_add_u32 v248, v9, 4, v248
    v_lshrrev_b32 v249, 3, v1
    v_lshl_add_u32 v249, v249, 1, s15
    v_and_b32 v10, 15, v1
    v_lshlrev_b32 v10, 11, v10
    v_lshrrev_b32 v9, 4, v1
    v_lshl_add_u32 v10, v9, 4, v10
    s_waitcnt lgkmcnt(0)
    s_mov_b64 s[36:37], s[68:69]
    buffer_load_dwordx4 v[152:155], v2, s[36:39], s16 offen
    buffer_load_dwordx4 v[156:159], v2, s[36:39], s16 offen offset:1024
    s_load_dword s4, s[32:33], 0
    s_mov_b64 s[48:49], s[88:89]
    s_load_dword s24, s[32:33], s92 offset:0 glc
    s_load_dword s25, s[32:33], s17 offset:508 glc
    s_load_dword s26, s[32:33], s17 offset:4604 glc
    global_load_ushort v168, v249, s[86:87]
    global_load_ushort v169, v249, s[86:87] offset:16
    s_barrier
    buffer_load_dwordx4 v[160:163], v248, s[48:51], s13 offen nt
    buffer_load_dwordx4 v[164:167], v248, s[48:51], s14 offen nt
    s_mov_b64 s[40:41], s[70:71]
    s_mov_b64 s[44:45], s[74:75]
    s_mov_b64 s[52:53], s[80:81]
    s_mov_b64 s[56:57], s[82:83]
    s_mov_b64 s[60:61], s[84:85]
    s_mov_b64 s[64:65], s[90:91]
    s_getpc_b64 s[22:23]
    s_and_b32 s22, s22, 0xfffffc00
    s_lshl3_add_u32 s96, s9, s3
    s_lshl_b32 s19, s96, 7
    v_lshrrev_b32 v4, 5, v1
    v_lshl_add_u32 v4, v4, 15, s19
    v_min_u32 v4, 41984, v4
    global_load_dword v11, v4, s[22:23]
    s_lshr_b32 s76, s3, 2
    s_and_b32 s77, s3, 3
    s_lshl_b32 s83, s3, 10
    s_mul_i32 s96, s8, 7
    s_lshr_b32 s97, s9, 2
    s_add_u32 s74, s96, s97
    s_and_b32 s75, s9, 3
    v_bfe_u32 v6, v1, 4, 1
    v_lshlrev_b32 v6, 6, v6
    v_and_b32 v3, 7, v1
    v_lshlrev_b32 v3, 4, v3
    v_xor_b32 v3, v3, v6
    v_lshrrev_b32 v6, 3, v1
    v_mul_u32_u24 v6, 6144, v6
    v_add_u32 v3, v3, v6
    s_and_b32 s84, s9, 12
    s_mul_i32 s96, s3, 49152
    s_lshl_b32 s97, s11, 7
    s_add_u32 s85, s96, s97
    v_lshlrev_b32 v250, 3, v1
    v_lshlrev_b32 v251, 5, v1
    v_add_u32 v251, 147456, v251
    s_lshl2_add_u32 s13, s3, 147456
    v_lshrrev_b32 v252, 4, v1
    v_lshl_add_u32 v252, v252, 6, s13
    v_and_b32 v9, 7, v1
    v_lshl_add_u32 v252, v9, 8, v252
    v_bfe_u32 v9, v1, 3, 1
    v_lshl_add_u32 v252, v9, 5, v252
    s_waitcnt vmcnt(5)
    v_mov_b32 v8, 0x3f803f80
    v_dot2_f32_bf16 v4, v152, v8, 0
    v_dot2_f32_bf16 v5, v152, v152, 0
    v_dot2_f32_bf16 v6, v153, v8, 0
    v_dot2_f32_bf16 v7, v153, v153, 0
    v_dot2_f32_bf16 v4, v154, v8, v4
    v_dot2_f32_bf16 v5, v154, v154, v5
    v_dot2_f32_bf16 v6, v155, v8, v6
    v_dot2_f32_bf16 v7, v155, v155, v7
    v_dot2_f32_bf16 v4, v156, v8, v4
    v_dot2_f32_bf16 v5, v156, v156, v5
    v_dot2_f32_bf16 v6, v157, v8, v6
    v_dot2_f32_bf16 v7, v157, v157, v7
    v_dot2_f32_bf16 v4, v158, v8, v4
    v_dot2_f32_bf16 v5, v158, v158, v5
    v_dot2_f32_bf16 v6, v159, v8, v6
    v_dot2_f32_bf16 v7, v159, v159, v7
    s_nop 2
    v_pk_add_f32 v[4:5], v[4:5], v[6:7]
    s_nop 1
    v_add_f32_dpp v4, v4, v4 quad_perm:[1,0,3,2] row_mask:0xf bank_mask:0xf
    v_add_f32_dpp v5, v5, v5 quad_perm:[1,0,3,2] row_mask:0xf bank_mask:0xf
    s_nop 0
    v_add_f32_dpp v4, v4, v4 quad_perm:[2,3,0,1] row_mask:0xf bank_mask:0xf
    v_add_f32_dpp v5, v5, v5 quad_perm:[2,3,0,1] row_mask:0xf bank_mask:0xf
    s_nop 0
    v_add_f32_dpp v4, v4, v4 row_half_mirror row_mask:0xf bank_mask:0xf
    v_add_f32_dpp v5, v5, v5 row_half_mirror row_mask:0xf bank_mask:0xf
    s_nop 0
    v_add_f32_dpp v4, v4, v4 row_ror:8 row_mask:0xf bank_mask:0xf
    v_add_f32_dpp v5, v5, v5 row_ror:8 row_mask:0xf bank_mask:0xf
    s_nop 1
    v_permlane16_swap_b32 v4, v5
    v_add_f32 v8, v4, v5
    v_add_f32 v4, v4, v5
    s_nop 1
    v_permlane32_swap_b32 v4, v8
    v_add_f32 v4, v4, v8
    v_mul_f32 v8, 0x3a800000, v4
    v_mul_f32 v4, 0x3a800000, v4
    s_nop 1
    v_permlane16_swap_b32 v4, v8
    v_fma_f32 v173, -v4, v4, v8
    v_cvt_pk_bf16_f32 v172, 0, v4
    v_max_f32 v173, 0, v173
    v_cvt_pk_bf16_f32 v173, 0, v173
    v_add_f32 v173, 0x3727c5ac, v173
    v_cvt_pk_bf16_f32 v173, 0, v173
    v_sqrt_f32 v173, v173
    s_nop 0
    v_cvt_pk_bf16_f32 v173, 0, v173
    s_lshl3_add_u32 s13, s3, 153600
    s_waitcnt lgkmcnt(0)
    s_mul_i32 s4, s4, 0x9e3779b1
    s_add_u32 s4, s4, 0x7f4a7c15
    v_lshrrev_b32 v172, 16, v172
    v_or_b32 v172, v172, v173
    v_mov_b32 v173, s4
    v_mov_b32 v4, s13
    ds_write_b64 v4, v[172:173]
    v_and_b32 v5, 3, v1
    v_lshlrev_b32 v5, 4, v5
    v_add_u32 v5, 153600, v5
    v_and_b32 v4, 3, v1
    v_lshlrev_b32 v4, 4, v4
    v_bfe_u32 v9, v1, 2, 1
    v_lshl_add_u32 v4, v9, 10, v4
    s_and_b32 s96, s8, 6
    s_and_b32 s97, s8, 1
    s_lshr_b32 s98, s9, 4
    s_lshl1_add_u32 s99, s97, s98
    s_lshl_b32 s97, s99, 6
    s_add_u32 s98, s96, s97
    s_lshl3_add_u32 s99, s3, s98
    s_lshl_b32 s96, s99, 10
    s_and_b32 s97, s9, 15
    s_lshl_b32 s98, s97, 6
    s_add_u32 s99, s96, s98
    s_add_u32 s13, s99, 262144
    s_waitcnt lgkmcnt(0)
    s_barrier
    ds_read_b128 v[172:175], v5
    s_waitcnt lgkmcnt(0)
    s_mov_b64 exec, 0xff
    buffer_store_dwordx4 v[172:175], v4, s[32:35], s13 offen sc1
    s_mov_b64 exec, -1
    buffer_load_dwordx4 v[12:15], v10, s[36:39], s18 offen
    buffer_load_dwordx4 v[16:19], v10, s[36:39], s18 offen offset:64
    s_lshl_b32 s96, s11, 12
    s_lshl_b32 s97, s3, 9
    s_add_u32 s13, s96, s97
    v_add_u32 v4, s13, v2
    s_lshl_b32 s96, s3, 9
    s_add_u32 m0, s96, 159744
    s_mov_b32 exec_hi, 0
    global_load_lds_dwordx4 v4, s[72:73]
    s_mov_b32 exec_hi, -1
    s_lshr_b32 s96, s9, 4
    s_lshl_b32 s94, s96, 1
    s_add_u32 s96, s94, s84
    s_and_b32 s97, s96, 15
    s_mul_i32 s98, s97, 393216
    s_add_u32 s91, s98, s85
    s_lshl_b32 s96, s94, 13
    s_add_u32 s94, s96, s83
    s_add_u32 s82, s91, 2048
    s_mov_b32 m0, s94
    s_nop 0
    buffer_load_dwordx4 v3, s[40:43], s82 offen lds
    s_add_u32 s82, s91, 4096
    s_add_u32 m0, s94, 49152
    s_nop 0
    buffer_load_dwordx4 v3, s[40:43], s82 offen lds
    s_waitcnt vmcnt(9)
    v_lshlrev_b32 v168, 16, v168
    v_mul_f32 v4, s7, v168
    v_exp_f32 v4, -v4
    s_nop 0
    v_add_f32 v4, 1.0, v4
    v_rcp_f32 v4, v4
    s_nop 0
    v_mul_f32 v168, v168, v4
    v_cvt_pk_bf16_f32 v168, 0, v168
    v_lshlrev_b32 v169, 16, v169
    v_mul_f32 v5, s7, v169
    v_exp_f32 v5, -v5
    s_nop 0
    v_add_f32 v5, 1.0, v5
    v_rcp_f32 v5, v5
    s_nop 0
    v_mul_f32 v169, v169, v5
    v_cvt_pk_bf16_f32 v169, 0, v169
    s_lshr_b32 s96, s3, 1
    s_xor_b32 s97, s9, 1
    s_and_b32 s98, s97, 15
    s_lshl4_add_u32 s99, s96, s98
    s_lshr_b32 s97, s9, 4
    s_lshl1_add_u32 s96, s99, s97
    s_lshl3_add_u32 s98, s96, s8
    s_lshl_b32 s99, s98, 9
    s_add_u32 s13, s99, 524288
    s_lshl3_add_u32 s96, s2, s3
    s_lshl_b32 s97, s96, 7
    s_add_u32 s14, s97, 262144
    v_and_b32 v8, 15, v1
    v_lshlrev_b32 v8, 3, v8
    s_waitcnt vmcnt(7)
    v_lshlrev_b32 v4, 16, v160
    v_and_b32 v5, s6, v160
    v_pk_mul_f32 v[176:177], v[4:5], v[168:169] op_sel:[0,0] op_sel_hi:[1,0]
    v_lshlrev_b32 v6, 16, v161
    v_and_b32 v7, s6, v161
    v_pk_mul_f32 v[178:179], v[6:7], v[168:169] op_sel:[0,0] op_sel_hi:[1,0]
    v_lshlrev_b32 v4, 16, v162
    v_and_b32 v5, s6, v162
    v_pk_mul_f32 v[180:181], v[4:5], v[168:169] op_sel:[0,0] op_sel_hi:[1,0]
    v_lshlrev_b32 v6, 16, v163
    v_and_b32 v7, s6, v163
    v_pk_mul_f32 v[182:183], v[6:7], v[168:169] op_sel:[0,0] op_sel_hi:[1,0]
    v_lshlrev_b32 v4, 16, v164
    v_and_b32 v5, s6, v164
    v_pk_fma_f32 v[176:177], v[4:5], v[168:169], v[176:177] op_sel:[0,1,0] op_sel_hi:[1,1,1]
    v_lshlrev_b32 v6, 16, v165
    v_and_b32 v7, s6, v165
    v_pk_fma_f32 v[178:179], v[6:7], v[168:169], v[178:179] op_sel:[0,1,0] op_sel_hi:[1,1,1]
    v_lshlrev_b32 v4, 16, v166
    v_and_b32 v5, s6, v166
    v_pk_fma_f32 v[180:181], v[4:5], v[168:169], v[180:181] op_sel:[0,1,0] op_sel_hi:[1,1,1]
    v_lshlrev_b32 v6, 16, v167
    v_and_b32 v7, s6, v167
    v_pk_fma_f32 v[182:183], v[6:7], v[168:169], v[182:183] op_sel:[0,1,0] op_sel_hi:[1,1,1]
    v_permlane32_swap_b32 v176, v180
    v_permlane32_swap_b32 v177, v181
    v_permlane32_swap_b32 v178, v182
    v_permlane32_swap_b32 v179, v183
    v_add_f32 v176, v176, v180
    v_add_f32 v177, v177, v181
    v_add_f32 v178, v178, v182
    v_add_f32 v179, v179, v183
    s_nop 0
    v_permlane16_swap_b32 v176, v178
    v_permlane16_swap_b32 v177, v179
    v_add_f32 v176, v176, v178
    v_add_f32 v177, v177, v179
    s_nop 0
    v_add_f32_dpp v176, v176, v176 row_ror:8 row_mask:0xf bank_mask:0xf
    v_add_f32_dpp v177, v177, v177 row_ror:8 row_mask:0xf bank_mask:0xf
    s_nop 1
    v_mov_b32_dpp v176, v177 quad_perm:[0,1,2,3] row_mask:0xf bank_mask:0xc
    ds_write_b32 v252, v176
    s_waitcnt lgkmcnt(0)
    s_barrier
    buffer_load_dwordx2 v[172:173], v8, s[32:35], s14 offen sc1
    ds_read_b128 v[176:179], v251 offset:0
    ds_read_b128 v[180:183], v251 offset:16
    s_waitcnt lgkmcnt(0)
    v_pk_add_f32 v[176:177], v[176:177], v[178:179]
    v_pk_add_f32 v[180:181], v[180:181], v[182:183]
    v_pk_add_f32 v[176:177], v[176:177], v[180:181]
    v_add_f32 v176, v176, v177
    v_mov_b32 v177, s4
    s_bitcmp1_b32 s3, 0
    s_cselect_b32 exec_lo, 0, -1
    s_cselect_b32 exec_hi, -1, 0
    buffer_store_dwordx2 v[176:177], v250, s[32:35], s13 offen sc1
    s_mov_b64 exec, -1
    s_mov_b32 s82, s91
    s_add_u32 m0, s94, 98304
    s_nop 0
    buffer_load_dwordx4 v3, s[40:43], s82 offen lds
    s_waitcnt vmcnt(2)
    v_cmp_ne_u32 vcc, s4, v173
    s_cbranch_vccz TOK_2
SPOLL_3:
    s_load_dword s24, s[32:33], s14 offset:60 glc
    s_load_dword s25, s[32:33], s14 offset:124 glc
SCHK_4:
    s_add_u32 s5, s5, 1
    s_cmp_ge_u32 s5, 200000
    s_waitcnt lgkmcnt(0)
    s_cbranch_scc1 SDONE_5
    s_cmp_lg_u32 s24, s4
    s_cbranch_scc1 SPOLL_3
    s_cmp_lg_u32 s25, s4
    s_cbranch_scc1 SPOLL_3
SDONE_5:
POLL_6:
    buffer_load_dwordx2 v[172:173], v8, s[32:35], s14 offen sc1
    s_waitcnt vmcnt(0)
    v_cmp_ne_u32 vcc, s4, v173
    s_cbranch_vccz PDONE_7
    s_add_u32 s5, s5, 1
    s_cmp_lt_u32 s5, 200000
    s_cbranch_scc1 POLL_6
PDONE_7:
TOK_2:
    v_and_b32 v4, 31, v1
    v_lshlrev_b32 v4, 4, v4
    v_lshrrev_b32 v9, 5, v1
    v_lshl_add_u32 v4, v9, 12, v4
    s_mov_b32 s13, s17
    s_lshl2_add_u32 s14, s3, 155648
    v_lshl_add_u32 v5, v1, 6, s14
    v_and_b32 v6, 3, v1
    v_lshlrev_b32 v6, 5, v6
    v_lshrrev_b32 v9, 5, v1
    v_lshl_add_u32 v6, v9, 7, v6
    v_bfe_u32 v9, v1, 4, 1
    v_lshl_add_u32 v6, v9, 8, v6
    v_bfe_u32 v9, v1, 2, 2
    v_lshl_add_u32 v6, v9, 9, v6
    v_add_u32 v6, 155648, v6
    s_load_dword s24, s[32:33], s13 offset:508 glc
    s_load_dword s25, s[32:33], s13 offset:4604 glc
    v_permlane32_swap_b32 v12, v14
    v_permlane32_swap_b32 v13, v15
    v_permlane32_swap_b32 v16, v18
    v_permlane32_swap_b32 v17, v19
    v_lshlrev_b32 v173, 16, v172
    v_and_b32 v172, s6, v172
    v_rcp_f32 v172, v172
    v_lshlrev_b32 v184, 16, v12
    v_and_b32 v185, s6, v12
    v_lshlrev_b32 v186, 16, v13
    v_and_b32 v187, s6, v13
    v_lshlrev_b32 v188, 16, v14
    v_and_b32 v189, s6, v14
    v_lshlrev_b32 v190, 16, v15
    v_and_b32 v191, s6, v15
    v_lshlrev_b32 v192, 16, v16
    v_and_b32 v193, s6, v16
    v_lshlrev_b32 v194, 16, v17
    v_and_b32 v195, s6, v17
    v_lshlrev_b32 v196, 16, v18
    v_and_b32 v197, s6, v18
    v_lshlrev_b32 v198, 16, v19
    v_and_b32 v199, s6, v19
    v_pk_add_f32 v[184:185], v[184:185], v[172:173] op_sel:[0,1] neg_lo:[0,1] neg_hi:[0,1]
    v_pk_add_f32 v[186:187], v[186:187], v[172:173] op_sel:[0,1] neg_lo:[0,1] neg_hi:[0,1]
    v_pk_add_f32 v[188:189], v[188:189], v[172:173] op_sel:[0,1] neg_lo:[0,1] neg_hi:[0,1]
    v_pk_add_f32 v[190:191], v[190:191], v[172:173] op_sel:[0,1] neg_lo:[0,1] neg_hi:[0,1]
    v_pk_add_f32 v[192:193], v[192:193], v[172:173] op_sel:[0,1] neg_lo:[0,1] neg_hi:[0,1]
    v_pk_add_f32 v[194:195], v[194:195], v[172:173] op_sel:[0,1] neg_lo:[0,1] neg_hi:[0,1]
    v_pk_add_f32 v[196:197], v[196:197], v[172:173] op_sel:[0,1] neg_lo:[0,1] neg_hi:[0,1]
    v_pk_add_f32 v[198:199], v[198:199], v[172:173] op_sel:[0,1] neg_lo:[0,1] neg_hi:[0,1]
    v_cvt_pk_bf16_f32 v184, 0, v184
    v_cvt_pk_bf16_f32 v185, 0, v185
    v_cvt_pk_bf16_f32 v186, 0, v186
    v_cvt_pk_bf16_f32 v187, 0, v187
    v_cvt_pk_bf16_f32 v188, 0, v188
    v_cvt_pk_bf16_f32 v189, 0, v189
    v_cvt_pk_bf16_f32 v190, 0, v190
    v_cvt_pk_bf16_f32 v191, 0, v191
    v_cvt_pk_bf16_f32 v192, 0, v192
    v_cvt_pk_bf16_f32 v193, 0, v193
    v_cvt_pk_bf16_f32 v194, 0, v194
    v_cvt_pk_bf16_f32 v195, 0, v195
    v_cvt_pk_bf16_f32 v196, 0, v196
    v_cvt_pk_bf16_f32 v197, 0, v197
    v_cvt_pk_bf16_f32 v198, 0, v198
    v_cvt_pk_bf16_f32 v199, 0, v199
    v_pk_mul_f32 v[184:185], v[184:185], v[172:173] op_sel_hi:[1,0]
    v_pk_mul_f32 v[186:187], v[186:187], v[172:173] op_sel_hi:[1,0]
    v_pk_mul_f32 v[188:189], v[188:189], v[172:173] op_sel_hi:[1,0]
    v_pk_mul_f32 v[190:191], v[190:191], v[172:173] op_sel_hi:[1,0]
    v_pk_mul_f32 v[192:193], v[192:193], v[172:173] op_sel_hi:[1,0]
    v_pk_mul_f32 v[194:195], v[194:195], v[172:173] op_sel_hi:[1,0]
    v_pk_mul_f32 v[196:197], v[196:197], v[172:173] op_sel_hi:[1,0]
    v_pk_mul_f32 v[198:199], v[198:199], v[172:173] op_sel_hi:[1,0]
    v_cvt_pk_bf16_f32 v184, 0, v184
    v_cvt_pk_bf16_f32 v185, 0, v185
    v_cvt_pk_bf16_f32 v186, 0, v186
    v_cvt_pk_bf16_f32 v187, 0, v187
    v_cvt_pk_bf16_f32 v188, 0, v188
    v_cvt_pk_bf16_f32 v189, 0, v189
    v_cvt_pk_bf16_f32 v190, 0, v190
    v_cvt_pk_bf16_f32 v191, 0, v191
    v_cvt_pk_bf16_f32 v192, 0, v192
    v_cvt_pk_bf16_f32 v193, 0, v193
    v_cvt_pk_bf16_f32 v194, 0, v194
    v_cvt_pk_bf16_f32 v195, 0, v195
    v_cvt_pk_bf16_f32 v196, 0, v196
    v_cvt_pk_bf16_f32 v197, 0, v197
    v_cvt_pk_bf16_f32 v198, 0, v198
    v_cvt_pk_bf16_f32 v199, 0, v199
    s_branch SCHK_9
SPOLL_8:
    s_load_dword s24, s[32:33], s13 offset:508 glc
    s_load_dword s25, s[32:33], s13 offset:4604 glc
SCHK_9:
    s_add_u32 s5, s5, 1
    s_cmp_ge_u32 s5, 200000
    s_waitcnt lgkmcnt(0)
    s_cbranch_scc1 SDONE_10
    s_cmp_lg_u32 s24, s4
    s_cbranch_scc1 SPOLL_8
    s_cmp_lg_u32 s25, s4
    s_cbranch_scc1 SPOLL_8
SDONE_10:
    s_barrier
    buffer_load_dwordx4 v[172:175], v4, s[32:35], s13 offen sc1
    s_lshr_b32 s96, s9, 4
    s_lshl_b32 s97, s96, 1
    s_xor_b32 s94, s97, 1
    s_add_u32 s96, s94, s84
    s_and_b32 s97, s96, 15
    s_mul_i32 s98, s97, 393216
    s_add_u32 s91, s98, s85
    s_lshl_b32 s96, s94, 13
    s_add_u32 s94, s96, s83
    s_add_u32 s82, s91, 2048
    s_mov_b32 m0, s94
    s_nop 0
    buffer_load_dwordx4 v3, s[40:43], s82 offen lds
    s_add_u32 s82, s91, 4096
    s_add_u32 m0, s94, 49152
    s_nop 0
    buffer_load_dwordx4 v3, s[40:43], s82 offen lds
    s_mov_b32 s82, s91
    s_add_u32 m0, s94, 98304
    s_nop 0
    buffer_load_dwordx4 v3, s[40:43], s82 offen lds
    s_waitcnt vmcnt(3)
    v_bitop3_b32 v7, v173, v175, s4 bitop3:0x7e
    v_cmp_ne_u32 vcc, 0, v7
    s_cbranch_vccz TOK_12
POLL_13:
    buffer_load_dwordx4 v[172:175], v4, s[32:35], s13 offen sc1
    s_waitcnt vmcnt(0)
    v_bitop3_b32 v7, v173, v175, s4 bitop3:0x7e
    v_cmp_ne_u32 vcc, 0, v7
    s_cbranch_vccz PDONE_14
    s_add_u32 s5, s5, 1
    s_cmp_lt_u32 s5, 200000
    s_cbranch_scc1 POLL_13
PDONE_14:
TOK_12:
    ds_write2_b32 v5, v172, v174 offset0:0 offset1:8
    s_waitcnt lgkmcnt(0)
    s_barrier
    ds_read_b128 v[208:211], v6 offset:2048
    ds_read_b128 v[212:215], v6 offset:2064
    ds_read_b128 v[200:203], v6
    ds_read_b128 v[204:207], v6 offset:16
    s_lshl4_add_u32 s96, s21, s12
    s_lshr_b32 s97, s3, 1
    s_lshl2_add_u32 s98, s96, s97
    s_lshl_b32 s99, s98, 12
    s_and_b32 s96, s3, 1
    s_lshl_b32 s97, s96, 8
    s_add_u32 s98, s99, s97
    s_add_u32 s13, s98, 4194304
    v_and_b32 v4, 15, v1
    v_lshlrev_b32 v4, 4, v4
    v_bfe_u32 v9, v1, 4, 1
    v_lshl_add_u32 v4, v9, 10, v4
    v_lshrrev_b32 v9, 5, v1
    v_lshl_add_u32 v4, v9, 9, v4
    s_waitcnt lgkmcnt(2)
    v_pk_add_f32 v[208:209], v[208:209], v[210:211]
    v_pk_add_f32 v[212:213], v[212:213], v[214:215]
    v_pk_add_f32 v[208:209], v[208:209], v[212:213]
    v_add_f32 v208, v208, v209
    v_cvt_pk_bf16_f32 v208, 0, v208
    s_waitcnt lgkmcnt(0)
    v_pk_add_f32 v[200:201], v[200:201], v[202:203]
    v_pk_add_f32 v[204:205], v[204:205], v[206:207]
    v_pk_add_f32 v[200:201], v[200:201], v[204:205]
    v_add_f32 v200, v200, v201
    v_add_f32 v208, 1.0, v208
    v_cvt_pk_bf16_f32 v208, 0, v208
    v_cvt_pk_bf16_f32 v200, 0, v200
    s_nop 0
    v_mul_f32_dpp v184, v208, v184 row_newbcast:0 row_mask:0xf bank_mask:0xf
    v_mul_f32_dpp v185, v208, v185 row_newbcast:1 row_mask:0xf bank_mask:0xf
    v_mul_f32_dpp v186, v208, v186 row_newbcast:2 row_mask:0xf bank_mask:0xf
    v_mul_f32_dpp v187, v208, v187 row_newbcast:3 row_mask:0xf bank_mask:0xf
    v_mul_f32_dpp v188, v208, v188 row_newbcast:4 row_mask:0xf bank_mask:0xf
    v_mul_f32_dpp v189, v208, v189 row_newbcast:5 row_mask:0xf bank_mask:0xf
    v_mul_f32_dpp v190, v208, v190 row_newbcast:6 row_mask:0xf bank_mask:0xf
    v_mul_f32_dpp v191, v208, v191 row_newbcast:7 row_mask:0xf bank_mask:0xf
    v_cvt_pk_bf16_f32 v184, 0, v184
    v_cvt_pk_bf16_f32 v185, 0, v185
    v_cvt_pk_bf16_f32 v186, 0, v186
    v_cvt_pk_bf16_f32 v187, 0, v187
    v_cvt_pk_bf16_f32 v188, 0, v188
    v_cvt_pk_bf16_f32 v189, 0, v189
    v_cvt_pk_bf16_f32 v190, 0, v190
    v_cvt_pk_bf16_f32 v191, 0, v191
    v_add_f32_dpp v184, v200, v184 row_newbcast:0 row_mask:0xf bank_mask:0xf
    v_add_f32_dpp v185, v200, v185 row_newbcast:1 row_mask:0xf bank_mask:0xf
    v_add_f32_dpp v186, v200, v186 row_newbcast:2 row_mask:0xf bank_mask:0xf
    v_add_f32_dpp v187, v200, v187 row_newbcast:3 row_mask:0xf bank_mask:0xf
    v_add_f32_dpp v188, v200, v188 row_newbcast:4 row_mask:0xf bank_mask:0xf
    v_add_f32_dpp v189, v200, v189 row_newbcast:5 row_mask:0xf bank_mask:0xf
    v_add_f32_dpp v190, v200, v190 row_newbcast:6 row_mask:0xf bank_mask:0xf
    v_add_f32_dpp v191, v200, v191 row_newbcast:7 row_mask:0xf bank_mask:0xf
    v_cvt_pk_bf16_f32 v216, v184, v185
    v_cvt_pk_bf16_f32 v217, v186, v187
    v_cvt_pk_bf16_f32 v218, v188, v189
    v_cvt_pk_bf16_f32 v219, v190, v191
    buffer_store_dwordx4 v[216:219], v4, s[32:35], s13 offen sc1
    v_mul_f32_dpp v192, v208, v192 row_newbcast:8 row_mask:0xf bank_mask:0xf
    v_mul_f32_dpp v193, v208, v193 row_newbcast:9 row_mask:0xf bank_mask:0xf
    v_mul_f32_dpp v194, v208, v194 row_newbcast:10 row_mask:0xf bank_mask:0xf
    v_mul_f32_dpp v195, v208, v195 row_newbcast:11 row_mask:0xf bank_mask:0xf
    v_mul_f32_dpp v196, v208, v196 row_newbcast:12 row_mask:0xf bank_mask:0xf
    v_mul_f32_dpp v197, v208, v197 row_newbcast:13 row_mask:0xf bank_mask:0xf
    v_mul_f32_dpp v198, v208, v198 row_newbcast:14 row_mask:0xf bank_mask:0xf
    v_mul_f32_dpp v199, v208, v199 row_newbcast:15 row_mask:0xf bank_mask:0xf
    v_cvt_pk_bf16_f32 v192, 0, v192
    v_cvt_pk_bf16_f32 v193, 0, v193
    v_cvt_pk_bf16_f32 v194, 0, v194
    v_cvt_pk_bf16_f32 v195, 0, v195
    v_cvt_pk_bf16_f32 v196, 0, v196
    v_cvt_pk_bf16_f32 v197, 0, v197
    v_cvt_pk_bf16_f32 v198, 0, v198
    v_cvt_pk_bf16_f32 v199, 0, v199
    v_add_f32_dpp v192, v200, v192 row_newbcast:8 row_mask:0xf bank_mask:0xf
    v_add_f32_dpp v193, v200, v193 row_newbcast:9 row_mask:0xf bank_mask:0xf
    v_add_f32_dpp v194, v200, v194 row_newbcast:10 row_mask:0xf bank_mask:0xf
    v_add_f32_dpp v195, v200, v195 row_newbcast:11 row_mask:0xf bank_mask:0xf
    v_add_f32_dpp v196, v200, v196 row_newbcast:12 row_mask:0xf bank_mask:0xf
    v_add_f32_dpp v197, v200, v197 row_newbcast:13 row_mask:0xf bank_mask:0xf
    v_add_f32_dpp v198, v200, v198 row_newbcast:14 row_mask:0xf bank_mask:0xf
    v_add_f32_dpp v199, v200, v199 row_newbcast:15 row_mask:0xf bank_mask:0xf
    v_cvt_pk_bf16_f32 v220, v192, v193
    v_cvt_pk_bf16_f32 v221, v194, v195
    v_cvt_pk_bf16_f32 v222, v196, v197
    v_cvt_pk_bf16_f32 v223, v198, v199
    buffer_store_dwordx4 v[220:223], v4, s[32:35], s13 offen offset:2048 sc1
    v_bfe_u32 v20, v1, 2, 2
    v_lshlrev_b32 v20, 7, v20
    v_bfe_u32 v9, v1, 3, 1
    v_lshl_add_u32 v20, v9, 6, v20
    v_bfe_u32 v9, v1, 4, 1
    v_lshl_add_u32 v20, v9, 5, v20
    v_and_b32 v9, 3, v1
    v_lshl_add_u32 v20, v9, 3, v20
    v_lshrrev_b32 v9, 5, v1
    v_lshl_add_u32 v20, v9, 9, v20
    v_xor_b32 v21, 64, v20
    v_add_u32 v22, 49152, v20
    v_add_u32 v23, 49152, v21
    v_add_u32 v24, 98304, v20
    v_add_u32 v25, 98304, v21
    v_and_b32 v5, 3, v1
    v_lshlrev_b32 v5, 15, v5
    v_bfe_u32 v9, v1, 2, 2
    v_lshl_add_u32 v5, v9, 12, v5
    s_and_b32 s96, s12, 1
    s_lshr_b32 s97, s21, 3
    s_and_b32 s98, s21, 7
    s_lshl_b32 s99, s98, 5
    s_lshl2_add_u32 s98, s97, s99
    s_lshl_b32 s97, s98, 12
    s_lshr_b32 s99, s12, 1
    s_lshl_b32 s98, s99, 6
    s_add_u32 s99, s97, s98
    s_lshl2_add_u32 s97, s96, s99
    s_add_u32 s13, s97, 1048576
    s_lshl_b32 s96, s10, 18
    s_lshl_b32 s97, s77, 12
    s_add_u32 s98, s96, s97
    s_add_u32 s88, s98, 4194304
    s_cmp_ge_u32 s9, 28
    s_cselect_b32 s54, 0, s54
    s_cselect_b32 s58, 0, s58
    s_cselect_b32 s62, 0, s62
    s_waitcnt vmcnt(0)
    s_barrier
    s_cmp_lg_u32 s3, 0
    s_cbranch_scc1 L_PB
    v_mov_b32 v6, s4
    s_mov_b32 exec_hi, 0
    s_mov_b32 exec_lo, 65535
    buffer_store_dword v6, v5, s[32:35], s13 offen sc1
    s_mov_b64 exec, -1
L_PB:
    s_lshr_b32 s96, s9, 4
    s_lshl_b32 s97, s96, 1
    s_xor_b32 s94, s97, 2
    s_add_u32 s96, s94, s84
    s_and_b32 s97, s96, 15
    s_mul_i32 s98, s97, 393216
    s_add_u32 s91, s98, s85
    s_lshl_b32 s96, s94, 13
    s_add_u32 s94, s96, s83
    s_add_u32 s82, s91, 2048
    s_mov_b32 m0, s94
    s_nop 0
    buffer_load_dwordx4 v3, s[40:43], s82 offen lds
    s_add_u32 s82, s91, 4096
    s_add_u32 m0, s94, 49152
    s_nop 0
    buffer_load_dwordx4 v3, s[40:43], s82 offen lds
    s_mov_b32 s82, s91
    s_add_u32 m0, s94, 98304
    s_nop 0
    buffer_load_dwordx4 v3, s[40:43], s82 offen lds
    s_lshr_b32 s96, s9, 4
    s_lshl_b32 s97, s96, 1
    s_xor_b32 s94, s97, 3
    s_add_u32 s96, s94, s84
    s_and_b32 s97, s96, 15
    s_mul_i32 s98, s97, 393216
    s_add_u32 s91, s98, s85
    s_lshl_b32 s96, s94, 13
    s_add_u32 s94, s96, s83
    s_add_u32 s82, s91, 2048
    s_mov_b32 m0, s94
    s_nop 0
    buffer_load_dwordx4 v3, s[40:43], s82 offen lds
    s_add_u32 s82, s91, 4096
    s_add_u32 m0, s94, 49152
    s_nop 0
    buffer_load_dwordx4 v3, s[40:43], s82 offen lds
    s_mov_b32 s82, s91
    s_add_u32 m0, s94, 98304
    s_nop 0
    buffer_load_dwordx4 v3, s[40:43], s82 offen lds
    s_lshl_b32 s96, s2, 12
    s_add_u32 s19, s96, 1048576
    s_and_b32 s96, s3, 3
    s_lshl_b32 s97, s96, 7
    s_add_u32 s20, s97, s19
    s_lshl_b32 s96, s84, 5
    s_add_u32 s19, s96, s19
    s_cmp_ge_u32 s3, 4
    s_cselect_b32 s19, s20, s19
    s_load_dwordx2 s[24:25], s[32:33], s19 offset:0 glc
    s_load_dwordx2 s[26:27], s[32:33], s19 offset:64 glc
    s_add_u32 s96, s84, 4
    s_and_b32 s97, s96, 15
    s_mul_i32 s98, s97, 393216
    s_add_u32 s91, s98, s85
    s_add_u32 s94, s83, 32768
    s_add_u32 s82, s91, 2048
    s_mov_b32 m0, s94
    s_nop 0
    buffer_load_dwordx4 v3, s[40:43], s82 offen lds
    s_add_u32 s82, s91, 4096
    s_add_u32 m0, s94, 49152
    s_nop 0
    buffer_load_dwordx4 v3, s[40:43], s82 offen lds
    s_mov_b32 s82, s91
    s_add_u32 m0, s94, 98304
    s_nop 0
    buffer_load_dwordx4 v3, s[40:43], s82 offen lds
    s_lshl_b32 s96, s3, 14
    s_lshl_b32 s97, s12, 7
    s_add_u32 s90, s96, s97
    s_and_b32 s96, s9, 1
    s_lshr_b32 s97, s9, 3
    s_lshl_b32 s98, s97, 1
    s_lshl3_add_u32 s99, s96, s98
    s_lshl_b32 s95, s99, 17
    s_lshl3_add_u32 s96, s75, s3
    s_mul_i32 s97, s96, 229376
    s_lshl_b32 s98, s74, 7
    s_add_u32 s80, s97, s98
    s_lshl3_add_u32 s96, s74, s3
    s_lshl_b32 s97, s96, 14
    s_lshl_b32 s98, s75, 9
    s_add_u32 s81, s97, s98
    s_and_b32 s96, s8, 3
    s_lshl3_add_u32 s97, s96, s3
    s_mul_i32 s98, s97, 393216
    s_lshr_b32 s99, s8, 2
    s_lshl1_add_u32 s96, s9, s99
    s_lshl_b32 s97, s96, 7
    s_add_u32 s99, s98, s97
    s_add_u32 s89, s99, 4096
    s_and_b32 s96, s3, 1
    s_lshl_b32 s14, s96, 6
    v_bfe_u32 v6, v1, 4, 1
    v_lshl_add_u32 v6, v6, 5, s14
    v_and_b32 v26, 7, v1
    v_lshlrev_b32 v26, 4, v26
    v_xor_b32 v26, v26, v6
    v_lshrrev_b32 v6, 3, v1
    v_lshlrev_b32 v6, 11, v6
    v_add_u32 v26, v26, v6
    s_and_b32 s96, s3, 2
    s_lshl_b32 s14, s96, 5
    v_bfe_u32 v6, v1, 4, 1
    v_lshl_add_u32 v6, v6, 5, s14
    v_and_b32 v27, 7, v1
    v_lshlrev_b32 v27, 4, v27
    v_xor_b32 v27, v27, v6
    v_lshrrev_b32 v6, 3, v1
    v_mul_u32_u24 v6, 7168, v6
    v_add_u32 v27, v27, v6
    s_and_b32 s96, s3, 1
    s_lshl_b32 s14, s96, 7
    v_lshrrev_b32 v6, 5, v1
    v_lshl_add_u32 v6, v6, 6, s14
    v_and_b32 v253, 31, v1
    v_lshlrev_b32 v253, 4, v253
    v_lshrrev_b32 v9, 5, v1
    v_lshl_add_u32 v253, v9, 11, v253
    v_xor_b32 v253, v253, v6
    s_lshl_b32 s16, s84, 14
    v_add_u32 v249, s88, v2
    s_lshl_b32 s96, s77, 11
    s_add_u32 s14, s96, 151552
    v_add_u32 v0, s14, v2
    s_mov_b64 exec, 0
    s_cmp_eq_u32 s3, 4
    s_cbranch_scc1 L_PAD2
    s_cmp_eq_u32 s3, 5
    s_cbranch_scc1 L_PAD3
    s_cmp_eq_u32 s3, 6
    s_cbranch_scc1 L_PAD4
    s_cmp_eq_u32 s3, 7
    s_cbranch_scc1 L_PAD5
    s_branch L_TEND
L_RET2:
    s_branch L_PAD6
L_RET6:
    s_branch L_PAD10
L_RET10:
    s_branch L_TEND
L_RET3:
    s_branch L_PAD7
L_RET7:
    s_branch L_TEND
L_RET4:
    s_branch L_PAD8
L_RET8:
    s_branch L_TEND
L_RET5:
    s_branch L_PAD9
L_RET9:
    s_branch L_TEND
    s_nop 0
    s_nop 0
    s_nop 0
    s_nop 0
    s_nop 0
    s_nop 0
    s_nop 0
    s_nop 0
    s_nop 0
    s_nop 0
    s_nop 0
    s_nop 0
    s_nop 0
    s_nop 0
    s_nop 0
    s_nop 0
    s_nop 0
    s_nop 0
    s_nop 0
    s_nop 0
    s_nop 0
    s_nop 0
    s_nop 0
    s_nop 0
    s_nop 0
    s_nop 0
    s_nop 0
    s_nop 0
L_TEND:
    s_mov_b64 exec, -1
    s_branch SCHK_16
SPOLL_15:
    s_load_dwordx2 s[24:25], s[32:33], s19 offset:0 glc
    s_load_dwordx2 s[26:27], s[32:33], s19 offset:64 glc
SCHK_16:
    s_add_u32 s5, s5, 1
    s_cmp_ge_u32 s5, 200000
    s_waitcnt lgkmcnt(0)
    s_cbranch_scc1 SDONE_17
    s_cmp_lg_u32 s24, s4
    s_cbranch_scc1 SPOLL_15
    s_cmp_lg_u32 s25, s4
    s_cbranch_scc1 SPOLL_15
    s_cmp_lg_u32 s26, s4
    s_cbranch_scc1 SPOLL_15
    s_cmp_lg_u32 s27, s4
    s_cbranch_scc1 SPOLL_15
SDONE_17:
    s_cmp_ge_u32 s3, 4
    s_cbranch_scc1 L_HELP
    s_setprio 2
    buffer_load_dwordx4 v[152:155], v249, s[32:35], s16 offen sc1
    buffer_load_dwordx4 v[156:159], v249, s[32:35], s16 offen offset:1024 sc1
    buffer_load_dwordx4 v[160:163], v249, s[32:35], s16 offen offset:2048 sc1
    buffer_load_dwordx4 v[164:167], v249, s[32:35], s16 offen offset:3072 sc1
    s_add_u32 s16, s16, 16384
    s_and_b32 s16, s16, 0x3ffff
    buffer_load_dwordx4 v[168:171], v249, s[32:35], s16 offen sc1
    buffer_load_dwordx4 v[172:175], v249, s[32:35], s16 offen offset:1024 sc1
    s_waitcnt vmcnt(9)
    s_barrier
    ds_read_b64_tr_b16 v[28:29], v20
    ds_read_b64_tr_b16 v[30:31], v20 offset:2048
    ds_read_b64_tr_b16 v[32:33], v21
    ds_read_b64_tr_b16 v[34:35], v21 offset:2048
    ds_read_b64_tr_b16 v[36:37], v24
    ds_read_b64_tr_b16 v[38:39], v24 offset:2048
    ds_read_b64_tr_b16 v[40:41], v25
    ds_read_b64_tr_b16 v[42:43], v25 offset:2048
    ds_read_b64_tr_b16 v[44:45], v22
    ds_read_b64_tr_b16 v[46:47], v22 offset:2048
    ds_read_b64_tr_b16 v[48:49], v23
    ds_read_b64_tr_b16 v[50:51], v23 offset:2048
    s_waitcnt vmcnt(5)
    s_waitcnt lgkmcnt(10)
    v_mfma_f32_32x32x16_bf16 v[56:71], v[28:31], v[152:155], 0
    ds_read_b64_tr_b16 v[52:53], v20 offset:1024
    ds_read_b64_tr_b16 v[54:55], v20 offset:3072
    s_waitcnt lgkmcnt(10)
    v_mfma_f32_32x32x16_bf16 v[72:87], v[32:35], v[152:155], 0
    ds_read_b64_tr_b16 v[28:29], v21 offset:1024
    ds_read_b64_tr_b16 v[30:31], v21 offset:3072
    s_waitcnt lgkmcnt(10)
    v_mfma_f32_32x32x16_bf16 v[120:135], v[36:39], v[152:155], 0
    ds_read_b64_tr_b16 v[32:33], v24 offset:1024
    ds_read_b64_tr_b16 v[34:35], v24 offset:3072
    s_waitcnt lgkmcnt(10)
    v_mfma_f32_32x32x16_bf16 v[136:151], v[40:43], v[152:155], 0
    ds_read_b64_tr_b16 v[36:37], v25 offset:1024
    ds_read_b64_tr_b16 v[38:39], v25 offset:3072
    s_waitcnt lgkmcnt(10)
    v_mfma_f32_32x32x16_bf16 v[88:103], v[44:47], v[152:155], 0
    buffer_load_dwordx4 v[176:179], v249, s[32:35], s16 offen offset:2048 sc1
    ds_read_b64_tr_b16 v[40:41], v22 offset:1024
    ds_read_b64_tr_b16 v[42:43], v22 offset:3072
    s_waitcnt lgkmcnt(10)
    v_mfma_f32_32x32x16_bf16 v[104:119], v[48:51], v[152:155], 0
    ds_read_b64_tr_b16 v[44:45], v23 offset:1024
    ds_read_b64_tr_b16 v[46:47], v23 offset:3072
    s_waitcnt vmcnt(5)
    s_waitcnt lgkmcnt(10)
    v_mfma_f32_32x32x16_bf16 v[56:71], v[52:55], v[156:159], v[56:71]
    ds_read_b64_tr_b16 v[48:49], v20 offset:4096
    ds_read_b64_tr_b16 v[50:51], v20 offset:6144
    s_waitcnt lgkmcnt(10)
    v_mfma_f32_32x32x16_bf16 v[72:87], v[28:31], v[156:159], v[72:87]
    ds_read_b64_tr_b16 v[52:53], v21 offset:4096
    ds_read_b64_tr_b16 v[54:55], v21 offset:6144
    s_waitcnt lgkmcnt(10)
    v_mfma_f32_32x32x16_bf16 v[120:135], v[32:35], v[156:159], v[120:135]
    ds_read_b64_tr_b16 v[28:29], v24 offset:4096
    ds_read_b64_tr_b16 v[30:31], v24 offset:6144
    s_waitcnt lgkmcnt(10)
    v_mfma_f32_32x32x16_bf16 v[136:151], v[36:39], v[156:159], v[136:151]
    buffer_load_dwordx4 v[180:183], v249, s[32:35], s16 offen offset:3072 sc1
    ds_read_b64_tr_b16 v[32:33], v25 offset:4096
    ds_read_b64_tr_b16 v[34:35], v25 offset:6144
    s_waitcnt lgkmcnt(10)
    v_mfma_f32_32x32x16_bf16 v[88:103], v[40:43], v[156:159], v[88:103]
    s_add_u32 s16, s16, 16384
    ds_read_b64_tr_b16 v[36:37], v22 offset:4096
    ds_read_b64_tr_b16 v[38:39], v22 offset:6144
    s_waitcnt lgkmcnt(10)
    v_mfma_f32_32x32x16_bf16 v[104:119], v[44:47], v[156:159], v[104:119]
    s_and_b32 s16, s16, 0x3ffff
    ds_read_b64_tr_b16 v[40:41], v23 offset:4096
    ds_read_b64_tr_b16 v[42:43], v23 offset:6144
    s_waitcnt vmcnt(5)
    s_waitcnt lgkmcnt(10)
    v_mfma_f32_32x32x16_bf16 v[56:71], v[48:51], v[160:163], v[56:71]
    ds_read_b64_tr_b16 v[44:45], v20 offset:5120
    ds_read_b64_tr_b16 v[46:47], v20 offset:7168
    s_waitcnt lgkmcnt(10)
    v_mfma_f32_32x32x16_bf16 v[72:87], v[52:55], v[160:163], v[72:87]
    ds_read_b64_tr_b16 v[48:49], v21 offset:5120
    ds_read_b64_tr_b16 v[50:51], v21 offset:7168
    s_waitcnt lgkmcnt(10)
    v_mfma_f32_32x32x16_bf16 v[120:135], v[28:31], v[160:163], v[120:135]
    buffer_load_dwordx4 v[184:187], v249, s[32:35], s16 offen sc1
    ds_read_b64_tr_b16 v[52:53], v24 offset:5120
    ds_read_b64_tr_b16 v[54:55], v24 offset:7168
    s_waitcnt lgkmcnt(10)
    v_mfma_f32_32x32x16_bf16 v[136:151], v[32:35], v[160:163], v[136:151]
    ds_read_b64_tr_b16 v[28:29], v25 offset:5120
    ds_read_b64_tr_b16 v[30:31], v25 offset:7168
    s_waitcnt lgkmcnt(10)
    v_mfma_f32_32x32x16_bf16 v[88:103], v[36:39], v[160:163], v[88:103]
    ds_read_b64_tr_b16 v[32:33], v22 offset:5120
    ds_read_b64_tr_b16 v[34:35], v22 offset:7168
    s_waitcnt lgkmcnt(10)
    v_mfma_f32_32x32x16_bf16 v[104:119], v[40:43], v[160:163], v[104:119]
    ds_read_b64_tr_b16 v[36:37], v23 offset:5120
    ds_read_b64_tr_b16 v[38:39], v23 offset:7168
    s_waitcnt vmcnt(5)
    s_waitcnt lgkmcnt(10)
    v_mfma_f32_32x32x16_bf16 v[56:71], v[44:47], v[164:167], v[56:71]
    ds_read_b64_tr_b16 v[40:41], v20 offset:8192
    ds_read_b64_tr_b16 v[42:43], v20 offset:10240
    s_waitcnt lgkmcnt(10)
    v_mfma_f32_32x32x16_bf16 v[72:87], v[48:51], v[164:167], v[72:87]
    buffer_load_dwordx4 v[188:191], v249, s[32:35], s16 offen offset:1024 sc1
    ds_read_b64_tr_b16 v[44:45], v21 offset:8192
    ds_read_b64_tr_b16 v[46:47], v21 offset:10240
    s_waitcnt lgkmcnt(10)
    v_mfma_f32_32x32x16_bf16 v[120:135], v[52:55], v[164:167], v[120:135]
    ds_read_b64_tr_b16 v[48:49], v24 offset:8192
    ds_read_b64_tr_b16 v[50:51], v24 offset:10240
    s_waitcnt lgkmcnt(10)
    v_mfma_f32_32x32x16_bf16 v[136:151], v[28:31], v[164:167], v[136:151]
    ds_read_b64_tr_b16 v[52:53], v25 offset:8192
    ds_read_b64_tr_b16 v[54:55], v25 offset:10240
    s_waitcnt lgkmcnt(10)
    v_mfma_f32_32x32x16_bf16 v[88:103], v[32:35], v[164:167], v[88:103]
    ds_read_b64_tr_b16 v[28:29], v22 offset:8192
    ds_read_b64_tr_b16 v[30:31], v22 offset:10240
    s_waitcnt lgkmcnt(10)
    v_mfma_f32_32x32x16_bf16 v[104:119], v[36:39], v[164:167], v[104:119]
    buffer_load_dwordx4 v[192:195], v249, s[32:35], s16 offen offset:2048 sc1
    ds_read_b64_tr_b16 v[32:33], v23 offset:8192
    ds_read_b64_tr_b16 v[34:35], v23 offset:10240
    s_barrier
    s_waitcnt vmcnt(6)
    s_waitcnt lgkmcnt(10)
    v_mfma_f32_32x32x16_bf16 v[56:71], v[40:43], v[168:171], v[56:71]
    ds_read_b64_tr_b16 v[36:37], v20 offset:9216
    ds_read_b64_tr_b16 v[38:39], v20 offset:11264
    s_waitcnt lgkmcnt(10)
    v_mfma_f32_32x32x16_bf16 v[72:87], v[44:47], v[168:171], v[72:87]
    ds_read_b64_tr_b16 v[40:41], v21 offset:9216
    ds_read_b64_tr_b16 v[42:43], v21 offset:11264
    s_waitcnt lgkmcnt(10)
    v_mfma_f32_32x32x16_bf16 v[120:135], v[48:51], v[168:171], v[120:135]
    ds_read_b64_tr_b16 v[44:45], v24 offset:9216
    ds_read_b64_tr_b16 v[46:47], v24 offset:11264
    s_waitcnt lgkmcnt(10)
    v_mfma_f32_32x32x16_bf16 v[136:151], v[52:55], v[168:171], v[136:151]
    ds_read_b64_tr_b16 v[48:49], v25 offset:9216
    ds_read_b64_tr_b16 v[50:51], v25 offset:11264
    s_waitcnt lgkmcnt(10)
    v_mfma_f32_32x32x16_bf16 v[88:103], v[28:31], v[168:171], v[88:103]
    buffer_load_dwordx4 v[196:199], v249, s[32:35], s16 offen offset:3072 sc1
    ds_read_b64_tr_b16 v[52:53], v22 offset:9216
    ds_read_b64_tr_b16 v[54:55], v22 offset:11264
    s_waitcnt lgkmcnt(10)
    v_mfma_f32_32x32x16_bf16 v[104:119], v[32:35], v[168:171], v[104:119]
    s_add_u32 s16, s16, 16384
    ds_read_b64_tr_b16 v[28:29], v23 offset:9216
    ds_read_b64_tr_b16 v[30:31], v23 offset:11264
    s_waitcnt vmcnt(6)
    s_waitcnt lgkmcnt(10)
    v_mfma_f32_32x32x16_bf16 v[56:71], v[36:39], v[172:175], v[56:71]
    s_and_b32 s16, s16, 0x3ffff
    ds_read_b64_tr_b16 v[32:33], v20 offset:12288
    ds_read_b64_tr_b16 v[34:35], v20 offset:14336
    s_waitcnt lgkmcnt(10)
    v_mfma_f32_32x32x16_bf16 v[72:87], v[40:43], v[172:175], v[72:87]
    ds_read_b64_tr_b16 v[36:37], v21 offset:12288
    ds_read_b64_tr_b16 v[38:39], v21 offset:14336
    s_waitcnt lgkmcnt(10)
    v_mfma_f32_32x32x16_bf16 v[120:135], v[44:47], v[172:175], v[120:135]
    ds_read_b64_tr_b16 v[40:41], v24 offset:12288
    ds_read_b64_tr_b16 v[42:43], v24 offset:14336
    s_waitcnt lgkmcnt(10)
    v_mfma_f32_32x32x16_bf16 v[136:151], v[48:51], v[172:175], v[136:151]
    buffer_load_dwordx4 v[200:203], v249, s[32:35], s16 offen sc1
    ds_read_b64_tr_b16 v[44:45], v25 offset:12288
    ds_read_b64_tr_b16 v[46:47], v25 offset:14336
    s_waitcnt lgkmcnt(10)
    v_mfma_f32_32x32x16_bf16 v[88:103], v[52:55], v[172:175], v[88:103]
    ds_read_b64_tr_b16 v[48:49], v22 offset:12288
    ds_read_b64_tr_b16 v[50:51], v22 offset:14336
    s_waitcnt lgkmcnt(10)
    v_mfma_f32_32x32x16_bf16 v[104:119], v[28:31], v[172:175], v[104:119]
    ds_read_b64_tr_b16 v[52:53], v23 offset:12288
    ds_read_b64_tr_b16 v[54:55], v23 offset:14336
    s_waitcnt vmcnt(6)
    s_waitcnt lgkmcnt(10)
    v_mfma_f32_32x32x16_bf16 v[56:71], v[32:35], v[176:179], v[56:71]
    ds_read_b64_tr_b16 v[28:29], v20 offset:13312
    ds_read_b64_tr_b16 v[30:31], v20 offset:15360
    s_waitcnt lgkmcnt(10)
    v_mfma_f32_32x32x16_bf16 v[72:87], v[36:39], v[176:179], v[72:87]
    ds_read_b64_tr_b16 v[32:33], v21 offset:13312
    ds_read_b64_tr_b16 v[34:35], v21 offset:15360
    s_waitcnt lgkmcnt(10)
    v_mfma_f32_32x32x16_bf16 v[120:135], v[40:43], v[176:179], v[120:135]
    buffer_load_dwordx4 v[204:207], v249, s[32:35], s16 offen offset:1024 sc1
    ds_read_b64_tr_b16 v[36:37], v24 offset:13312
    ds_read_b64_tr_b16 v[38:39], v24 offset:15360
    s_waitcnt lgkmcnt(10)
    v_mfma_f32_32x32x16_bf16 v[136:151], v[44:47], v[176:179], v[136:151]
    ds_read_b64_tr_b16 v[40:41], v25 offset:13312
    ds_read_b64_tr_b16 v[42:43], v25 offset:15360
    s_waitcnt lgkmcnt(10)
    v_mfma_f32_32x32x16_bf16 v[88:103], v[48:51], v[176:179], v[88:103]
    ds_read_b64_tr_b16 v[44:45], v22 offset:13312
    ds_read_b64_tr_b16 v[46:47], v22 offset:15360
    s_waitcnt lgkmcnt(10)
    v_mfma_f32_32x32x16_bf16 v[104:119], v[52:55], v[176:179], v[104:119]
    ds_read_b64_tr_b16 v[48:49], v23 offset:13312
    ds_read_b64_tr_b16 v[50:51], v23 offset:15360
    s_waitcnt vmcnt(6)
    s_waitcnt lgkmcnt(10)
    v_mfma_f32_32x32x16_bf16 v[56:71], v[28:31], v[180:183], v[56:71]
    ds_read_b64_tr_b16 v[52:53], v20 offset:16384
    ds_read_b64_tr_b16 v[54:55], v20 offset:18432
    s_waitcnt lgkmcnt(10)
    v_mfma_f32_32x32x16_bf16 v[72:87], v[32:35], v[180:183], v[72:87]
    buffer_load_dwordx4 v[208:211], v249, s[32:35], s16 offen offset:2048 sc1
    ds_read_b64_tr_b16 v[28:29], v21 offset:16384
    ds_read_b64_tr_b16 v[30:31], v21 offset:18432
    s_waitcnt lgkmcnt(10)
    v_mfma_f32_32x32x16_bf16 v[120:135], v[36:39], v[180:183], v[120:135]
    ds_read_b64_tr_b16 v[32:33], v24 offset:16384
    ds_read_b64_tr_b16 v[34:35], v24 offset:18432
    s_waitcnt lgkmcnt(10)
    v_mfma_f32_32x32x16_bf16 v[136:151], v[40:43], v[180:183], v[136:151]
    ds_read_b64_tr_b16 v[36:37], v25 offset:16384
    ds_read_b64_tr_b16 v[38:39], v25 offset:18432
    s_waitcnt lgkmcnt(10)
    v_mfma_f32_32x32x16_bf16 v[88:103], v[44:47], v[180:183], v[88:103]
    ds_read_b64_tr_b16 v[40:41], v22 offset:16384
    ds_read_b64_tr_b16 v[42:43], v22 offset:18432
    s_waitcnt lgkmcnt(10)
    v_mfma_f32_32x32x16_bf16 v[104:119], v[48:51], v[180:183], v[104:119]
    buffer_load_dwordx4 v[212:215], v249, s[32:35], s16 offen offset:3072 sc1
    ds_read_b64_tr_b16 v[44:45], v23 offset:16384
    ds_read_b64_tr_b16 v[46:47], v23 offset:18432
    s_barrier
    s_waitcnt vmcnt(7)
    s_waitcnt lgkmcnt(10)
    v_mfma_f32_32x32x16_bf16 v[56:71], v[52:55], v[184:187], v[56:71]
    s_add_u32 s16, s16, 16384
    ds_read_b64_tr_b16 v[48:49], v20 offset:17408
    ds_read_b64_tr_b16 v[50:51], v20 offset:19456
    s_waitcnt lgkmcnt(10)
    v_mfma_f32_32x32x16_bf16 v[72:87], v[28:31], v[184:187], v[72:87]
    s_and_b32 s16, s16, 0x3ffff
    ds_read_b64_tr_b16 v[52:53], v21 offset:17408
    ds_read_b64_tr_b16 v[54:55], v21 offset:19456
    s_waitcnt lgkmcnt(10)
    v_mfma_f32_32x32x16_bf16 v[120:135], v[32:35], v[184:187], v[120:135]
    ds_read_b64_tr_b16 v[28:29], v24 offset:17408
    ds_read_b64_tr_b16 v[30:31], v24 offset:19456
    s_waitcnt lgkmcnt(10)
    v_mfma_f32_32x32x16_bf16 v[136:151], v[36:39], v[184:187], v[136:151]
    ds_read_b64_tr_b16 v[32:33], v25 offset:17408
    ds_read_b64_tr_b16 v[34:35], v25 offset:19456
    s_waitcnt lgkmcnt(10)
    v_mfma_f32_32x32x16_bf16 v[88:103], v[40:43], v[184:187], v[88:103]
    buffer_load_dwordx4 v[216:219], v249, s[32:35], s16 offen sc1
    ds_read_b64_tr_b16 v[36:37], v22 offset:17408
    ds_read_b64_tr_b16 v[38:39], v22 offset:19456
    s_waitcnt lgkmcnt(10)
    v_mfma_f32_32x32x16_bf16 v[104:119], v[44:47], v[184:187], v[104:119]
    ds_read_b64_tr_b16 v[40:41], v23 offset:17408
    ds_read_b64_tr_b16 v[42:43], v23 offset:19456
    s_waitcnt vmcnt(7)
    s_waitcnt lgkmcnt(10)
    v_mfma_f32_32x32x16_bf16 v[56:71], v[48:51], v[188:191], v[56:71]
    ds_read_b64_tr_b16 v[44:45], v20 offset:20480
    ds_read_b64_tr_b16 v[46:47], v20 offset:22528
    s_waitcnt lgkmcnt(10)
    v_mfma_f32_32x32x16_bf16 v[72:87], v[52:55], v[188:191], v[72:87]
    ds_read_b64_tr_b16 v[48:49], v21 offset:20480
    ds_read_b64_tr_b16 v[50:51], v21 offset:22528
    s_waitcnt lgkmcnt(10)
    v_mfma_f32_32x32x16_bf16 v[120:135], v[28:31], v[188:191], v[120:135]
    ds_read_b64_tr_b16 v[52:53], v24 offset:20480
    ds_read_b64_tr_b16 v[54:55], v24 offset:22528
    s_waitcnt lgkmcnt(10)
    v_mfma_f32_32x32x16_bf16 v[136:151], v[32:35], v[188:191], v[136:151]
    buffer_load_dwordx4 v[220:223], v249, s[32:35], s16 offen offset:1024 sc1
    ds_read_b64_tr_b16 v[28:29], v25 offset:20480
    ds_read_b64_tr_b16 v[30:31], v25 offset:22528
    s_waitcnt lgkmcnt(10)
    v_mfma_f32_32x32x16_bf16 v[88:103], v[36:39], v[188:191], v[88:103]
    ds_read_b64_tr_b16 v[32:33], v22 offset:20480
    ds_read_b64_tr_b16 v[34:35], v22 offset:22528
    s_waitcnt lgkmcnt(10)
    v_mfma_f32_32x32x16_bf16 v[104:119], v[40:43], v[188:191], v[104:119]
    ds_read_b64_tr_b16 v[36:37], v23 offset:20480
    ds_read_b64_tr_b16 v[38:39], v23 offset:22528
    s_waitcnt vmcnt(7)
    s_waitcnt lgkmcnt(10)
    v_mfma_f32_32x32x16_bf16 v[56:71], v[44:47], v[192:195], v[56:71]
    ds_read_b64_tr_b16 v[40:41], v20 offset:21504
    ds_read_b64_tr_b16 v[42:43], v20 offset:23552
    s_waitcnt lgkmcnt(10)
    v_mfma_f32_32x32x16_bf16 v[72:87], v[48:51], v[192:195], v[72:87]
    ds_read_b64_tr_b16 v[44:45], v21 offset:21504
    ds_read_b64_tr_b16 v[46:47], v21 offset:23552
    s_waitcnt lgkmcnt(10)
    v_mfma_f32_32x32x16_bf16 v[120:135], v[52:55], v[192:195], v[120:135]
    buffer_load_dwordx4 v[224:227], v249, s[32:35], s16 offen offset:2048 sc1
    ds_read_b64_tr_b16 v[48:49], v24 offset:21504
    ds_read_b64_tr_b16 v[50:51], v24 offset:23552
    s_waitcnt lgkmcnt(10)
    v_mfma_f32_32x32x16_bf16 v[136:151], v[28:31], v[192:195], v[136:151]
    ds_read_b64_tr_b16 v[52:53], v25 offset:21504
    ds_read_b64_tr_b16 v[54:55], v25 offset:23552
    s_waitcnt lgkmcnt(10)
    v_mfma_f32_32x32x16_bf16 v[88:103], v[32:35], v[192:195], v[88:103]
    ds_read_b64_tr_b16 v[28:29], v22 offset:21504
    ds_read_b64_tr_b16 v[30:31], v22 offset:23552
    s_waitcnt lgkmcnt(10)
    v_mfma_f32_32x32x16_bf16 v[104:119], v[36:39], v[192:195], v[104:119]
    ds_read_b64_tr_b16 v[32:33], v23 offset:21504
    ds_read_b64_tr_b16 v[34:35], v23 offset:23552
    s_waitcnt vmcnt(7)
    s_waitcnt lgkmcnt(10)
    v_mfma_f32_32x32x16_bf16 v[56:71], v[40:43], v[196:199], v[56:71]
    ds_read_b64_tr_b16 v[36:37], v20 offset:24576
    ds_read_b64_tr_b16 v[38:39], v20 offset:26624
    s_waitcnt lgkmcnt(10)
    v_mfma_f32_32x32x16_bf16 v[72:87], v[44:47], v[196:199], v[72:87]
    buffer_load_dwordx4 v[228:231], v249, s[32:35], s16 offen offset:3072 sc1
    ds_read_b64_tr_b16 v[40:41], v21 offset:24576
    ds_read_b64_tr_b16 v[42:43], v21 offset:26624
    s_waitcnt lgkmcnt(10)
    v_mfma_f32_32x32x16_bf16 v[120:135], v[48:51], v[196:199], v[120:135]
    s_add_u32 s16, s16, 16384
    ds_read_b64_tr_b16 v[44:45], v24 offset:24576
    ds_read_b64_tr_b16 v[46:47], v24 offset:26624
    s_waitcnt lgkmcnt(10)
    v_mfma_f32_32x32x16_bf16 v[136:151], v[52:55], v[196:199], v[136:151]
    s_and_b32 s16, s16, 0x3ffff
    ds_read_b64_tr_b16 v[48:49], v25 offset:24576
    ds_read_b64_tr_b16 v[50:51], v25 offset:26624
    s_waitcnt lgkmcnt(10)
    v_mfma_f32_32x32x16_bf16 v[88:103], v[28:31], v[196:199], v[88:103]
    ds_read_b64_tr_b16 v[52:53], v22 offset:24576
    ds_read_b64_tr_b16 v[54:55], v22 offset:26624
    s_waitcnt lgkmcnt(10)
    v_mfma_f32_32x32x16_bf16 v[104:119], v[32:35], v[196:199], v[104:119]
    buffer_load_dwordx4 v[232:235], v249, s[32:35], s16 offen sc1
    ds_read_b64_tr_b16 v[28:29], v23 offset:24576
    ds_read_b64_tr_b16 v[30:31], v23 offset:26624
    s_barrier
    s_waitcnt vmcnt(8)
    s_waitcnt lgkmcnt(10)
    v_mfma_f32_32x32x16_bf16 v[56:71], v[36:39], v[200:203], v[56:71]
    ds_read_b64_tr_b16 v[32:33], v20 offset:25600
    ds_read_b64_tr_b16 v[34:35], v20 offset:27648
    s_waitcnt lgkmcnt(10)
    v_mfma_f32_32x32x16_bf16 v[72:87], v[40:43], v[200:203], v[72:87]
    ds_read_b64_tr_b16 v[36:37], v21 offset:25600
    ds_read_b64_tr_b16 v[38:39], v21 offset:27648
    s_waitcnt lgkmcnt(10)
    v_mfma_f32_32x32x16_bf16 v[120:135], v[44:47], v[200:203], v[120:135]
    ds_read_b64_tr_b16 v[40:41], v24 offset:25600
    ds_read_b64_tr_b16 v[42:43], v24 offset:27648
    s_waitcnt lgkmcnt(10)
    v_mfma_f32_32x32x16_bf16 v[136:151], v[48:51], v[200:203], v[136:151]
    ds_read_b64_tr_b16 v[44:45], v25 offset:25600
    ds_read_b64_tr_b16 v[46:47], v25 offset:27648
    s_waitcnt lgkmcnt(10)
    v_mfma_f32_32x32x16_bf16 v[88:103], v[52:55], v[200:203], v[88:103]
    buffer_load_dwordx4 v[236:239], v249, s[32:35], s16 offen offset:1024 sc1
    ds_read_b64_tr_b16 v[48:49], v22 offset:25600
    ds_read_b64_tr_b16 v[50:51], v22 offset:27648
    s_waitcnt lgkmcnt(10)
    v_mfma_f32_32x32x16_bf16 v[104:119], v[28:31], v[200:203], v[104:119]
    ds_read_b64_tr_b16 v[52:53], v23 offset:25600
    ds_read_b64_tr_b16 v[54:55], v23 offset:27648
    s_waitcnt vmcnt(8)
    s_waitcnt lgkmcnt(10)
    v_mfma_f32_32x32x16_bf16 v[56:71], v[32:35], v[204:207], v[56:71]
    ds_read_b64_tr_b16 v[28:29], v20 offset:28672
    ds_read_b64_tr_b16 v[30:31], v20 offset:30720
    s_waitcnt lgkmcnt(10)
    v_mfma_f32_32x32x16_bf16 v[72:87], v[36:39], v[204:207], v[72:87]
    ds_read_b64_tr_b16 v[32:33], v21 offset:28672
    ds_read_b64_tr_b16 v[34:35], v21 offset:30720
L_PAD2:
    s_cbranch_execz L_RET2
    s_waitcnt lgkmcnt(10)
    v_mfma_f32_32x32x16_bf16 v[120:135], v[40:43], v[204:207], v[120:135]
    ds_read_b64_tr_b16 v[36:37], v24 offset:28672
    ds_read_b64_tr_b16 v[38:39], v24 offset:30720
    s_waitcnt lgkmcnt(10)
    v_mfma_f32_32x32x16_bf16 v[136:151], v[44:47], v[204:207], v[136:151]
    buffer_load_dwordx4 v[240:243], v249, s[32:35], s16 offen offset:2048 sc1
    ds_read_b64_tr_b16 v[40:41], v25 offset:28672
    ds_read_b64_tr_b16 v[42:43], v25 offset:30720
    s_waitcnt lgkmcnt(10)
    v_mfma_f32_32x32x16_bf16 v[88:103], v[48:51], v[204:207], v[88:103]
    ds_read_b64_tr_b16 v[44:45], v22 offset:28672
    ds_read_b64_tr_b16 v[46:47], v22 offset:30720
    s_waitcnt lgkmcnt(10)
    v_mfma_f32_32x32x16_bf16 v[104:119], v[52:55], v[204:207], v[104:119]
    ds_read_b64_tr_b16 v[48:49], v23 offset:28672
    ds_read_b64_tr_b16 v[50:51], v23 offset:30720
    s_waitcnt vmcnt(8)
    s_waitcnt lgkmcnt(10)
    v_mfma_f32_32x32x16_bf16 v[56:71], v[28:31], v[208:211], v[56:71]
    ds_read_b64_tr_b16 v[52:53], v20 offset:29696
    ds_read_b64_tr_b16 v[54:55], v20 offset:31744
    s_waitcnt lgkmcnt(10)
    v_mfma_f32_32x32x16_bf16 v[72:87], v[32:35], v[208:211], v[72:87]
    ds_read_b64_tr_b16 v[28:29], v21 offset:29696
    ds_read_b64_tr_b16 v[30:31], v21 offset:31744
    s_waitcnt lgkmcnt(10)
    v_mfma_f32_32x32x16_bf16 v[120:135], v[36:39], v[208:211], v[120:135]
    buffer_load_dwordx4 v[244:247], v249, s[32:35], s16 offen offset:3072 sc1
    ds_read_b64_tr_b16 v[32:33], v24 offset:29696
    ds_read_b64_tr_b16 v[34:35], v24 offset:31744
    s_waitcnt lgkmcnt(10)
    v_mfma_f32_32x32x16_bf16 v[136:151], v[40:43], v[208:211], v[136:151]
    s_add_u32 s16, s16, 16384
    ds_read_b64_tr_b16 v[36:37], v25 offset:29696
    ds_read_b64_tr_b16 v[38:39], v25 offset:31744
    s_waitcnt lgkmcnt(10)
    v_mfma_f32_32x32x16_bf16 v[88:103], v[44:47], v[208:211], v[88:103]
    s_and_b32 s16, s16, 0x3ffff
    ds_read_b64_tr_b16 v[40:41], v22 offset:29696
    ds_read_b64_tr_b16 v[42:43], v22 offset:31744
    s_waitcnt lgkmcnt(10)
    v_mfma_f32_32x32x16_bf16 v[104:119], v[48:51], v[208:211], v[104:119]
    ds_read_b64_tr_b16 v[44:45], v23 offset:29696
    ds_read_b64_tr_b16 v[46:47], v23 offset:31744
    s_waitcnt vmcnt(8)
    s_waitcnt lgkmcnt(10)
    v_mfma_f32_32x32x16_bf16 v[56:71], v[52:55], v[212:215], v[56:71]
    ds_read_b64_tr_b16 v[48:49], v20 offset:32768
    ds_read_b64_tr_b16 v[50:51], v20 offset:34816
    s_waitcnt lgkmcnt(10)
    v_mfma_f32_32x32x16_bf16 v[72:87], v[28:31], v[212:215], v[72:87]
    buffer_load_dwordx4 v[152:155], v249, s[32:35], s16 offen sc1
    ds_read_b64_tr_b16 v[52:53], v21 offset:32768
    ds_read_b64_tr_b16 v[54:55], v21 offset:34816
    s_waitcnt lgkmcnt(10)
    v_mfma_f32_32x32x16_bf16 v[120:135], v[32:35], v[212:215], v[120:135]
    ds_read_b64_tr_b16 v[28:29], v24 offset:32768
    ds_read_b64_tr_b16 v[30:31], v24 offset:34816
    s_waitcnt lgkmcnt(10)
    v_mfma_f32_32x32x16_bf16 v[136:151], v[36:39], v[212:215], v[136:151]
    ds_read_b64_tr_b16 v[32:33], v25 offset:32768
    ds_read_b64_tr_b16 v[34:35], v25 offset:34816
    s_waitcnt lgkmcnt(10)
    v_mfma_f32_32x32x16_bf16 v[88:103], v[40:43], v[212:215], v[88:103]
    ds_read_b64_tr_b16 v[36:37], v22 offset:32768
    ds_read_b64_tr_b16 v[38:39], v22 offset:34816
    s_waitcnt lgkmcnt(10)
    v_mfma_f32_32x32x16_bf16 v[104:119], v[44:47], v[212:215], v[104:119]
    buffer_load_dwordx4 v[156:159], v249, s[32:35], s16 offen offset:1024 sc1
    ds_read_b64_tr_b16 v[40:41], v23 offset:32768
    ds_read_b64_tr_b16 v[42:43], v23 offset:34816
    s_barrier
    s_waitcnt vmcnt(9)
    s_waitcnt lgkmcnt(10)
    v_mfma_f32_32x32x16_bf16 v[56:71], v[48:51], v[216:219], v[56:71]
    ds_read_b64_tr_b16 v[44:45], v20 offset:33792
    ds_read_b64_tr_b16 v[46:47], v20 offset:35840
    s_waitcnt lgkmcnt(10)
    v_mfma_f32_32x32x16_bf16 v[72:87], v[52:55], v[216:219], v[72:87]
    ds_read_b64_tr_b16 v[48:49], v21 offset:33792
    ds_read_b64_tr_b16 v[50:51], v21 offset:35840
    s_waitcnt lgkmcnt(10)
    v_mfma_f32_32x32x16_bf16 v[120:135], v[28:31], v[216:219], v[120:135]
    ds_read_b64_tr_b16 v[52:53], v24 offset:33792
    ds_read_b64_tr_b16 v[54:55], v24 offset:35840
    s_waitcnt lgkmcnt(10)
    v_mfma_f32_32x32x16_bf16 v[136:151], v[32:35], v[216:219], v[136:151]
    ds_read_b64_tr_b16 v[28:29], v25 offset:33792
    ds_read_b64_tr_b16 v[30:31], v25 offset:35840
    s_waitcnt lgkmcnt(10)
    v_mfma_f32_32x32x16_bf16 v[88:103], v[36:39], v[216:219], v[88:103]
    buffer_load_dwordx4 v[160:163], v249, s[32:35], s16 offen offset:2048 sc1
    ds_read_b64_tr_b16 v[32:33], v22 offset:33792
    ds_read_b64_tr_b16 v[34:35], v22 offset:35840
    s_waitcnt lgkmcnt(10)
    v_mfma_f32_32x32x16_bf16 v[104:119], v[40:43], v[216:219], v[104:119]
    ds_read_b64_tr_b16 v[36:37], v23 offset:33792
    ds_read_b64_tr_b16 v[38:39], v23 offset:35840
    s_waitcnt vmcnt(9)
    s_waitcnt lgkmcnt(10)
    v_mfma_f32_32x32x16_bf16 v[56:71], v[44:47], v[220:223], v[56:71]
    ds_read_b64_tr_b16 v[40:41], v20 offset:36864
    ds_read_b64_tr_b16 v[42:43], v20 offset:38912
    s_waitcnt lgkmcnt(10)
    v_mfma_f32_32x32x16_bf16 v[72:87], v[48:51], v[220:223], v[72:87]
    ds_read_b64_tr_b16 v[44:45], v21 offset:36864
    ds_read_b64_tr_b16 v[46:47], v21 offset:38912
    s_waitcnt lgkmcnt(10)
    v_mfma_f32_32x32x16_bf16 v[120:135], v[52:55], v[220:223], v[120:135]
    ds_read_b64_tr_b16 v[48:49], v24 offset:36864
    ds_read_b64_tr_b16 v[50:51], v24 offset:38912
    s_waitcnt lgkmcnt(10)
    v_mfma_f32_32x32x16_bf16 v[136:151], v[28:31], v[220:223], v[136:151]
    buffer_load_dwordx4 v[164:167], v249, s[32:35], s16 offen offset:3072 sc1
    ds_read_b64_tr_b16 v[52:53], v25 offset:36864
    ds_read_b64_tr_b16 v[54:55], v25 offset:38912
    s_waitcnt lgkmcnt(10)
    v_mfma_f32_32x32x16_bf16 v[88:103], v[32:35], v[220:223], v[88:103]
    s_add_u32 s16, s16, 16384
    ds_read_b64_tr_b16 v[28:29], v22 offset:36864
    ds_read_b64_tr_b16 v[30:31], v22 offset:38912
    s_waitcnt lgkmcnt(10)
    v_mfma_f32_32x32x16_bf16 v[104:119], v[36:39], v[220:223], v[104:119]
    s_and_b32 s16, s16, 0x3ffff
    ds_read_b64_tr_b16 v[32:33], v23 offset:36864
    ds_read_b64_tr_b16 v[34:35], v23 offset:38912
    s_waitcnt vmcnt(9)
    s_waitcnt lgkmcnt(10)
    v_mfma_f32_32x32x16_bf16 v[56:71], v[40:43], v[224:227], v[56:71]
    ds_read_b64_tr_b16 v[36:37], v20 offset:37888
    ds_read_b64_tr_b16 v[38:39], v20 offset:39936
    s_waitcnt lgkmcnt(10)
    v_mfma_f32_32x32x16_bf16 v[72:87], v[44:47], v[224:227], v[72:87]
    ds_read_b64_tr_b16 v[40:41], v21 offset:37888
    ds_read_b64_tr_b16 v[42:43], v21 offset:39936
    s_waitcnt lgkmcnt(10)
    v_mfma_f32_32x32x16_bf16 v[120:135], v[48:51], v[224:227], v[120:135]
    buffer_load_dwordx4 v[168:171], v249, s[32:35], s16 offen sc1
    ds_read_b64_tr_b16 v[44:45], v24 offset:37888
    ds_read_b64_tr_b16 v[46:47], v24 offset:39936
    s_waitcnt lgkmcnt(10)
    v_mfma_f32_32x32x16_bf16 v[136:151], v[52:55], v[224:227], v[136:151]
    ds_read_b64_tr_b16 v[48:49], v25 offset:37888
    ds_read_b64_tr_b16 v[50:51], v25 offset:39936
    s_waitcnt lgkmcnt(10)
    v_mfma_f32_32x32x16_bf16 v[88:103], v[28:31], v[224:227], v[88:103]
    ds_read_b64_tr_b16 v[52:53], v22 offset:37888
    ds_read_b64_tr_b16 v[54:55], v22 offset:39936
    s_waitcnt lgkmcnt(10)
    v_mfma_f32_32x32x16_bf16 v[104:119], v[32:35], v[224:227], v[104:119]
    ds_read_b64_tr_b16 v[28:29], v23 offset:37888
    ds_read_b64_tr_b16 v[30:31], v23 offset:39936
    s_waitcnt vmcnt(9)
    s_waitcnt lgkmcnt(10)
    v_mfma_f32_32x32x16_bf16 v[56:71], v[36:39], v[228:231], v[56:71]
    ds_read_b64_tr_b16 v[32:33], v20 offset:40960
    ds_read_b64_tr_b16 v[34:35], v20 offset:43008
    s_waitcnt lgkmcnt(10)
    v_mfma_f32_32x32x16_bf16 v[72:87], v[40:43], v[228:231], v[72:87]
    buffer_load_dwordx4 v[172:175], v249, s[32:35], s16 offen offset:1024 sc1
    ds_read_b64_tr_b16 v[36:37], v21 offset:40960
    ds_read_b64_tr_b16 v[38:39], v21 offset:43008
    s_waitcnt lgkmcnt(10)
    v_mfma_f32_32x32x16_bf16 v[120:135], v[44:47], v[228:231], v[120:135]
    ds_read_b64_tr_b16 v[40:41], v24 offset:40960
    ds_read_b64_tr_b16 v[42:43], v24 offset:43008
    s_waitcnt lgkmcnt(10)
    v_mfma_f32_32x32x16_bf16 v[136:151], v[48:51], v[228:231], v[136:151]
    ds_read_b64_tr_b16 v[44:45], v25 offset:40960
    ds_read_b64_tr_b16 v[46:47], v25 offset:43008
    s_waitcnt lgkmcnt(10)
    v_mfma_f32_32x32x16_bf16 v[88:103], v[52:55], v[228:231], v[88:103]
    ds_read_b64_tr_b16 v[48:49], v22 offset:40960
    ds_read_b64_tr_b16 v[50:51], v22 offset:43008
    s_waitcnt lgkmcnt(10)
    v_mfma_f32_32x32x16_bf16 v[104:119], v[28:31], v[228:231], v[104:119]
    buffer_load_dwordx4 v[176:179], v249, s[32:35], s16 offen offset:2048 sc1
    ds_read_b64_tr_b16 v[52:53], v23 offset:40960
    ds_read_b64_tr_b16 v[54:55], v23 offset:43008
    s_barrier
    s_waitcnt vmcnt(10)
    s_waitcnt lgkmcnt(10)
    v_mfma_f32_32x32x16_bf16 v[56:71], v[32:35], v[232:235], v[56:71]
    ds_read_b64_tr_b16 v[28:29], v20 offset:41984
    ds_read_b64_tr_b16 v[30:31], v20 offset:44032
    s_waitcnt lgkmcnt(10)
    v_mfma_f32_32x32x16_bf16 v[72:87], v[36:39], v[232:235], v[72:87]
    ds_read_b64_tr_b16 v[32:33], v21 offset:41984
    ds_read_b64_tr_b16 v[34:35], v21 offset:44032
    s_waitcnt lgkmcnt(10)
    v_mfma_f32_32x32x16_bf16 v[120:135], v[40:43], v[232:235], v[120:135]
    ds_read_b64_tr_b16 v[36:37], v24 offset:41984
    ds_read_b64_tr_b16 v[38:39], v24 offset:44032
    s_waitcnt lgkmcnt(10)
    v_mfma_f32_32x32x16_bf16 v[136:151], v[44:47], v[232:235], v[136:151]
    buffer_load_dwordx4 v[180:183], v249, s[32:35], s16 offen offset:3072 sc1
    ds_read_b64_tr_b16 v[40:41], v25 offset:41984
    ds_read_b64_tr_b16 v[42:43], v25 offset:44032
    s_waitcnt lgkmcnt(10)
    v_mfma_f32_32x32x16_bf16 v[88:103], v[48:51], v[232:235], v[88:103]
    s_add_u32 s16, s16, 16384
    ds_read_b64_tr_b16 v[44:45], v22 offset:41984
    ds_read_b64_tr_b16 v[46:47], v22 offset:44032
    s_waitcnt lgkmcnt(10)
    v_mfma_f32_32x32x16_bf16 v[104:119], v[52:55], v[232:235], v[104:119]
    s_and_b32 s16, s16, 0x3ffff
    ds_read_b64_tr_b16 v[48:49], v23 offset:41984
    ds_read_b64_tr_b16 v[50:51], v23 offset:44032
    s_waitcnt vmcnt(10)
    s_waitcnt lgkmcnt(10)
    v_mfma_f32_32x32x16_bf16 v[56:71], v[28:31], v[236:239], v[56:71]
    buffer_load_dwordx4 v[184:187], v249, s[32:35], s16 offen sc1
    ds_read_b64_tr_b16 v[52:53], v20 offset:45056
    ds_read_b64_tr_b16 v[54:55], v20 offset:47104
    s_waitcnt lgkmcnt(10)
    v_mfma_f32_32x32x16_bf16 v[72:87], v[32:35], v[236:239], v[72:87]
    ds_read_b64_tr_b16 v[28:29], v21 offset:45056
    ds_read_b64_tr_b16 v[30:31], v21 offset:47104
    s_waitcnt lgkmcnt(10)
    v_mfma_f32_32x32x16_bf16 v[120:135], v[36:39], v[236:239], v[120:135]
    ds_read_b64_tr_b16 v[32:33], v24 offset:45056
    ds_read_b64_tr_b16 v[34:35], v24 offset:47104
    s_waitcnt lgkmcnt(10)
    v_mfma_f32_32x32x16_bf16 v[136:151], v[40:43], v[236:239], v[136:151]
    ds_read_b64_tr_b16 v[36:37], v25 offset:45056
    ds_read_b64_tr_b16 v[38:39], v25 offset:47104
    s_waitcnt lgkmcnt(10)
    v_mfma_f32_32x32x16_bf16 v[88:103], v[44:47], v[236:239], v[88:103]
    buffer_load_dwordx4 v[188:191], v249, s[32:35], s16 offen offset:1024 sc1
    ds_read_b64_tr_b16 v[40:41], v22 offset:45056
    ds_read_b64_tr_b16 v[42:43], v22 offset:47104
    s_waitcnt lgkmcnt(10)
    v_mfma_f32_32x32x16_bf16 v[104:119], v[48:51], v[236:239], v[104:119]
    ds_read_b64_tr_b16 v[44:45], v23 offset:45056
    ds_read_b64_tr_b16 v[46:47], v23 offset:47104
    s_waitcnt vmcnt(11)
    s_waitcnt lgkmcnt(10)
    v_mfma_f32_32x32x16_bf16 v[56:71], v[52:55], v[240:243], v[56:71]
    ds_read_b64_tr_b16 v[48:49], v20 offset:46080
    ds_read_b64_tr_b16 v[50:51], v20 offset:48128
    s_waitcnt lgkmcnt(10)
    v_mfma_f32_32x32x16_bf16 v[72:87], v[28:31], v[240:243], v[72:87]
    buffer_load_dwordx4 v[192:195], v249, s[32:35], s16 offen offset:2048 sc1
    ds_read_b64_tr_b16 v[52:53], v21 offset:46080
    ds_read_b64_tr_b16 v[54:55], v21 offset:48128
    s_waitcnt lgkmcnt(10)
    v_mfma_f32_32x32x16_bf16 v[120:135], v[32:35], v[240:243], v[120:135]
    ds_read_b64_tr_b16 v[28:29], v24 offset:46080
    ds_read_b64_tr_b16 v[30:31], v24 offset:48128
    s_waitcnt lgkmcnt(10)
    v_mfma_f32_32x32x16_bf16 v[136:151], v[36:39], v[240:243], v[136:151]
    ds_read_b64_tr_b16 v[32:33], v25 offset:46080
    ds_read_b64_tr_b16 v[34:35], v25 offset:48128
    s_waitcnt lgkmcnt(10)
    v_mfma_f32_32x32x16_bf16 v[88:103], v[40:43], v[240:243], v[88:103]
    ds_read_b64_tr_b16 v[36:37], v22 offset:46080
    ds_read_b64_tr_b16 v[38:39], v22 offset:48128
    s_waitcnt lgkmcnt(10)
    v_mfma_f32_32x32x16_bf16 v[104:119], v[44:47], v[240:243], v[104:119]
    buffer_load_dwordx4 v[196:199], v249, s[32:35], s16 offen offset:3072 sc1
    ds_read_b64_tr_b16 v[40:41], v23 offset:46080
    ds_read_b64_tr_b16 v[42:43], v23 offset:48128
    s_waitcnt vmcnt(12)
    s_waitcnt lgkmcnt(10)
    v_mfma_f32_32x32x16_bf16 v[56:71], v[48:51], v[244:247], v[56:71]
    s_add_u32 s16, s16, 16384
    ds_read_b64_tr_b16 v[44:45], v20
    ds_read_b64_tr_b16 v[46:47], v20 offset:2048
    s_waitcnt lgkmcnt(10)
    v_mfma_f32_32x32x16_bf16 v[72:87], v[52:55], v[244:247], v[72:87]
    s_and_b32 s16, s16, 0x3ffff
    ds_read_b64_tr_b16 v[48:49], v21
    ds_read_b64_tr_b16 v[50:51], v21 offset:2048
    s_waitcnt lgkmcnt(10)
    v_mfma_f32_32x32x16_bf16 v[120:135], v[28:31], v[244:247], v[120:135]
    buffer_load_dwordx4 v[200:203], v249, s[32:35], s16 offen sc1
    ds_read_b64_tr_b16 v[52:53], v24
    ds_read_b64_tr_b16 v[54:55], v24 offset:2048
    s_waitcnt lgkmcnt(10)
    v_mfma_f32_32x32x16_bf16 v[136:151], v[32:35], v[244:247], v[136:151]
    ds_read_b64_tr_b16 v[28:29], v25
    ds_read_b64_tr_b16 v[30:31], v25 offset:2048
    s_waitcnt lgkmcnt(10)
    v_mfma_f32_32x32x16_bf16 v[88:103], v[36:39], v[244:247], v[88:103]
    ds_read_b64_tr_b16 v[32:33], v22
    ds_read_b64_tr_b16 v[34:35], v22 offset:2048
    s_waitcnt lgkmcnt(10)
    v_mfma_f32_32x32x16_bf16 v[104:119], v[40:43], v[244:247], v[104:119]
    buffer_load_dwordx4 v[204:207], v249, s[32:35], s16 offen offset:1024 sc1
    ds_read_b64_tr_b16 v[36:37], v23
    ds_read_b64_tr_b16 v[38:39], v23 offset:2048
    s_barrier
    s_waitcnt vmcnt(13)
    s_waitcnt lgkmcnt(10)
    v_mfma_f32_32x32x16_bf16 v[56:71], v[44:47], v[152:155], v[56:71]
    ds_read_b64_tr_b16 v[40:41], v20 offset:1024
    ds_read_b64_tr_b16 v[42:43], v20 offset:3072
    s_waitcnt lgkmcnt(10)
    v_mfma_f32_32x32x16_bf16 v[72:87], v[48:51], v[152:155], v[72:87]
    ds_read_b64_tr_b16 v[44:45], v21 offset:1024
    ds_read_b64_tr_b16 v[46:47], v21 offset:3072
    s_waitcnt lgkmcnt(10)
    v_mfma_f32_32x32x16_bf16 v[120:135], v[52:55], v[152:155], v[120:135]
    ds_read_b64_tr_b16 v[48:49], v24 offset:1024
    ds_read_b64_tr_b16 v[50:51], v24 offset:3072
    s_waitcnt lgkmcnt(10)
    v_mfma_f32_32x32x16_bf16 v[136:151], v[28:31], v[152:155], v[136:151]
    buffer_load_dwordx4 v[208:211], v249, s[32:35], s16 offen offset:2048 sc1
    ds_read_b64_tr_b16 v[52:53], v25 offset:1024
    ds_read_b64_tr_b16 v[54:55], v25 offset:3072
    s_waitcnt lgkmcnt(10)
    v_mfma_f32_32x32x16_bf16 v[88:103], v[32:35], v[152:155], v[88:103]
    ds_read_b64_tr_b16 v[28:29], v22 offset:1024
    ds_read_b64_tr_b16 v[30:31], v22 offset:3072
    s_waitcnt lgkmcnt(10)
    v_mfma_f32_32x32x16_bf16 v[104:119], v[36:39], v[152:155], v[104:119]
    ds_read_b64_tr_b16 v[32:33], v23 offset:1024
    ds_read_b64_tr_b16 v[34:35], v23 offset:3072
    s_waitcnt vmcnt(13)
    s_waitcnt lgkmcnt(10)
    v_mfma_f32_32x32x16_bf16 v[56:71], v[40:43], v[156:159], v[56:71]
    buffer_load_dwordx4 v[212:215], v249, s[32:35], s16 offen offset:3072 sc1
    ds_read_b64_tr_b16 v[36:37], v20 offset:4096
    ds_read_b64_tr_b16 v[38:39], v20 offset:6144
    s_waitcnt lgkmcnt(10)
    v_mfma_f32_32x32x16_bf16 v[72:87], v[44:47], v[156:159], v[72:87]
    s_add_u32 s16, s16, 16384
    ds_read_b64_tr_b16 v[40:41], v21 offset:4096
    ds_read_b64_tr_b16 v[42:43], v21 offset:6144
    s_waitcnt lgkmcnt(10)
    v_mfma_f32_32x32x16_bf16 v[120:135], v[48:51], v[156:159], v[120:135]
    s_and_b32 s16, s16, 0x3ffff
    ds_read_b64_tr_b16 v[44:45], v24 offset:4096
    ds_read_b64_tr_b16 v[46:47], v24 offset:6144
    s_waitcnt lgkmcnt(10)
    v_mfma_f32_32x32x16_bf16 v[136:151], v[52:55], v[156:159], v[136:151]
    ds_read_b64_tr_b16 v[48:49], v25 offset:4096
    ds_read_b64_tr_b16 v[50:51], v25 offset:6144
    s_waitcnt lgkmcnt(10)
    v_mfma_f32_32x32x16_bf16 v[88:103], v[28:31], v[156:159], v[88:103]
    buffer_load_dwordx4 v[216:219], v249, s[32:35], s16 offen sc1
    ds_read_b64_tr_b16 v[52:53], v22 offset:4096
    ds_read_b64_tr_b16 v[54:55], v22 offset:6144
    s_waitcnt lgkmcnt(10)
    v_mfma_f32_32x32x16_bf16 v[104:119], v[32:35], v[156:159], v[104:119]
    ds_read_b64_tr_b16 v[28:29], v23 offset:4096
    ds_read_b64_tr_b16 v[30:31], v23 offset:6144
    s_waitcnt vmcnt(14)
    s_waitcnt lgkmcnt(10)
    v_mfma_f32_32x32x16_bf16 v[56:71], v[36:39], v[160:163], v[56:71]
    ds_read_b64_tr_b16 v[32:33], v20 offset:5120
    ds_read_b64_tr_b16 v[34:35], v20 offset:7168
    s_waitcnt lgkmcnt(10)
    v_mfma_f32_32x32x16_bf16 v[72:87], v[40:43], v[160:163], v[72:87]
    buffer_load_dwordx4 v[220:223], v249, s[32:35], s16 offen offset:1024 sc1
    ds_read_b64_tr_b16 v[36:37], v21 offset:5120
    ds_read_b64_tr_b16 v[38:39], v21 offset:7168
    s_waitcnt lgkmcnt(10)
    v_mfma_f32_32x32x16_bf16 v[120:135], v[44:47], v[160:163], v[120:135]
    ds_read_b64_tr_b16 v[40:41], v24 offset:5120
    ds_read_b64_tr_b16 v[42:43], v24 offset:7168
    s_waitcnt lgkmcnt(10)
    v_mfma_f32_32x32x16_bf16 v[136:151], v[48:51], v[160:163], v[136:151]
    ds_read_b64_tr_b16 v[44:45], v25 offset:5120
    ds_read_b64_tr_b16 v[46:47], v25 offset:7168
    s_waitcnt lgkmcnt(10)
    v_mfma_f32_32x32x16_bf16 v[88:103], v[52:55], v[160:163], v[88:103]
    ds_read_b64_tr_b16 v[48:49], v22 offset:5120
    ds_read_b64_tr_b16 v[50:51], v22 offset:7168
    s_waitcnt lgkmcnt(10)
    v_mfma_f32_32x32x16_bf16 v[104:119], v[28:31], v[160:163], v[104:119]
    buffer_load_dwordx4 v[224:227], v249, s[32:35], s16 offen offset:2048 sc1
    ds_read_b64_tr_b16 v[52:53], v23 offset:5120
    ds_read_b64_tr_b16 v[54:55], v23 offset:7168
    s_waitcnt vmcnt(15)
    s_waitcnt lgkmcnt(10)
    v_mfma_f32_32x32x16_bf16 v[56:71], v[32:35], v[164:167], v[56:71]
    ds_read_b64_tr_b16 v[28:29], v20 offset:8192
    ds_read_b64_tr_b16 v[30:31], v20 offset:10240
    s_waitcnt lgkmcnt(10)
    v_mfma_f32_32x32x16_bf16 v[72:87], v[36:39], v[164:167], v[72:87]
    ds_read_b64_tr_b16 v[32:33], v21 offset:8192
    ds_read_b64_tr_b16 v[34:35], v21 offset:10240
    s_waitcnt lgkmcnt(10)
    v_mfma_f32_32x32x16_bf16 v[120:135], v[40:43], v[164:167], v[120:135]
    buffer_load_dwordx4 v[228:231], v249, s[32:35], s16 offen offset:3072 sc1
    ds_read_b64_tr_b16 v[36:37], v24 offset:8192
    ds_read_b64_tr_b16 v[38:39], v24 offset:10240
    s_waitcnt lgkmcnt(10)
    v_mfma_f32_32x32x16_bf16 v[136:151], v[44:47], v[164:167], v[136:151]
    s_add_u32 s16, s16, 16384
    ds_read_b64_tr_b16 v[40:41], v25 offset:8192
    ds_read_b64_tr_b16 v[42:43], v25 offset:10240
    s_waitcnt lgkmcnt(10)
    v_mfma_f32_32x32x16_bf16 v[88:103], v[48:51], v[164:167], v[88:103]
    s_and_b32 s16, s16, 0x3ffff
    ds_read_b64_tr_b16 v[44:45], v22 offset:8192
    ds_read_b64_tr_b16 v[46:47], v22 offset:10240
    s_waitcnt lgkmcnt(10)
    v_mfma_f32_32x32x16_bf16 v[104:119], v[52:55], v[164:167], v[104:119]
    buffer_load_dwordx4 v[232:235], v249, s[32:35], s16 offen sc1
    ds_read_b64_tr_b16 v[48:49], v23 offset:8192
    ds_read_b64_tr_b16 v[50:51], v23 offset:10240
    s_barrier
    s_waitcnt vmcnt(16)
    s_waitcnt lgkmcnt(10)
    v_mfma_f32_32x32x16_bf16 v[56:71], v[28:31], v[168:171], v[56:71]
    ds_read_b64_tr_b16 v[52:53], v20 offset:9216
    ds_read_b64_tr_b16 v[54:55], v20 offset:11264
    s_waitcnt lgkmcnt(10)
    v_mfma_f32_32x32x16_bf16 v[72:87], v[32:35], v[168:171], v[72:87]
    ds_read_b64_tr_b16 v[28:29], v21 offset:9216
    ds_read_b64_tr_b16 v[30:31], v21 offset:11264
    s_waitcnt lgkmcnt(10)
    v_mfma_f32_32x32x16_bf16 v[120:135], v[36:39], v[168:171], v[120:135]
    ds_read_b64_tr_b16 v[32:33], v24 offset:9216
    ds_read_b64_tr_b16 v[34:35], v24 offset:11264
    s_waitcnt lgkmcnt(10)
    v_mfma_f32_32x32x16_bf16 v[136:151], v[40:43], v[168:171], v[136:151]
    buffer_load_dwordx4 v[236:239], v249, s[32:35], s16 offen offset:1024 sc1
    ds_read_b64_tr_b16 v[36:37], v25 offset:9216
    ds_read_b64_tr_b16 v[38:39], v25 offset:11264
    s_waitcnt lgkmcnt(10)
    v_mfma_f32_32x32x16_bf16 v[88:103], v[44:47], v[168:171], v[88:103]
    ds_read_b64_tr_b16 v[40:41], v22 offset:9216
    ds_read_b64_tr_b16 v[42:43], v22 offset:11264
    s_waitcnt lgkmcnt(10)
    v_mfma_f32_32x32x16_bf16 v[104:119], v[48:51], v[168:171], v[104:119]
    ds_read_b64_tr_b16 v[44:45], v23 offset:9216
    ds_read_b64_tr_b16 v[46:47], v23 offset:11264
    s_waitcnt vmcnt(16)
    s_waitcnt lgkmcnt(10)
    v_mfma_f32_32x32x16_bf16 v[56:71], v[52:55], v[172:175], v[56:71]
    buffer_load_dwordx4 v[240:243], v249, s[32:35], s16 offen offset:2048 sc1
    ds_read_b64_tr_b16 v[48:49], v20 offset:12288
    ds_read_b64_tr_b16 v[50:51], v20 offset:14336
    s_waitcnt lgkmcnt(10)
    v_mfma_f32_32x32x16_bf16 v[72:87], v[28:31], v[172:175], v[72:87]
    ds_read_b64_tr_b16 v[52:53], v21 offset:12288
    ds_read_b64_tr_b16 v[54:55], v21 offset:14336
    s_waitcnt lgkmcnt(10)
    v_mfma_f32_32x32x16_bf16 v[120:135], v[32:35], v[172:175], v[120:135]
    ds_read_b64_tr_b16 v[28:29], v24 offset:12288
    ds_read_b64_tr_b16 v[30:31], v24 offset:14336
    s_waitcnt lgkmcnt(10)
    v_mfma_f32_32x32x16_bf16 v[136:151], v[36:39], v[172:175], v[136:151]
    ds_read_b64_tr_b16 v[32:33], v25 offset:12288
    ds_read_b64_tr_b16 v[34:35], v25 offset:14336
    s_waitcnt lgkmcnt(10)
    v_mfma_f32_32x32x16_bf16 v[88:103], v[40:43], v[172:175], v[88:103]
    buffer_load_dwordx4 v[244:247], v249, s[32:35], s16 offen offset:3072 sc1
    ds_read_b64_tr_b16 v[36:37], v22 offset:12288
    ds_read_b64_tr_b16 v[38:39], v22 offset:14336
    s_waitcnt lgkmcnt(10)
    v_mfma_f32_32x32x16_bf16 v[104:119], v[44:47], v[172:175], v[104:119]
    s_add_u32 s16, s16, 16384
    ds_read_b64_tr_b16 v[40:41], v23 offset:12288
    ds_read_b64_tr_b16 v[42:43], v23 offset:14336
    s_waitcnt vmcnt(17)
    s_waitcnt lgkmcnt(10)
    v_mfma_f32_32x32x16_bf16 v[56:71], v[48:51], v[176:179], v[56:71]
    s_and_b32 s16, s16, 0x3ffff
    ds_read_b64_tr_b16 v[44:45], v20 offset:13312
    ds_read_b64_tr_b16 v[46:47], v20 offset:15360
    s_waitcnt lgkmcnt(10)
    v_mfma_f32_32x32x16_bf16 v[72:87], v[52:55], v[176:179], v[72:87]
    buffer_load_dwordx4 v[152:155], v249, s[32:35], s16 offen sc1
    ds_read_b64_tr_b16 v[48:49], v21 offset:13312
    ds_read_b64_tr_b16 v[50:51], v21 offset:15360
    s_waitcnt lgkmcnt(10)
    v_mfma_f32_32x32x16_bf16 v[120:135], v[28:31], v[176:179], v[120:135]
    ds_read_b64_tr_b16 v[52:53], v24 offset:13312
    ds_read_b64_tr_b16 v[54:55], v24 offset:15360
    s_waitcnt lgkmcnt(10)
    v_mfma_f32_32x32x16_bf16 v[136:151], v[32:35], v[176:179], v[136:151]
    ds_read_b64_tr_b16 v[28:29], v25 offset:13312
    ds_read_b64_tr_b16 v[30:31], v25 offset:15360
    s_waitcnt lgkmcnt(10)
    v_mfma_f32_32x32x16_bf16 v[88:103], v[36:39], v[176:179], v[88:103]
    ds_read_b64_tr_b16 v[32:33], v22 offset:13312
    ds_read_b64_tr_b16 v[34:35], v22 offset:15360
    s_waitcnt lgkmcnt(10)
    v_mfma_f32_32x32x16_bf16 v[104:119], v[40:43], v[176:179], v[104:119]
    buffer_load_dwordx4 v[156:159], v249, s[32:35], s16 offen offset:1024 sc1
    ds_read_b64_tr_b16 v[36:37], v23 offset:13312
    ds_read_b64_tr_b16 v[38:39], v23 offset:15360
    s_waitcnt vmcnt(18)
    s_waitcnt lgkmcnt(10)
    v_mfma_f32_32x32x16_bf16 v[56:71], v[44:47], v[180:183], v[56:71]
    ds_read_b64_tr_b16 v[40:41], v20 offset:16384
    ds_read_b64_tr_b16 v[42:43], v20 offset:18432
    s_waitcnt lgkmcnt(10)
    v_mfma_f32_32x32x16_bf16 v[72:87], v[48:51], v[180:183], v[72:87]
    ds_read_b64_tr_b16 v[44:45], v21 offset:16384
    ds_read_b64_tr_b16 v[46:47], v21 offset:18432
    s_waitcnt lgkmcnt(10)
    v_mfma_f32_32x32x16_bf16 v[120:135], v[52:55], v[180:183], v[120:135]
    buffer_load_dwordx4 v[160:163], v249, s[32:35], s16 offen offset:2048 sc1
    ds_read_b64_tr_b16 v[48:49], v24 offset:16384
    ds_read_b64_tr_b16 v[50:51], v24 offset:18432
    s_waitcnt lgkmcnt(10)
    v_mfma_f32_32x32x16_bf16 v[136:151], v[28:31], v[180:183], v[136:151]
    ds_read_b64_tr_b16 v[52:53], v25 offset:16384
    ds_read_b64_tr_b16 v[54:55], v25 offset:18432
    s_waitcnt lgkmcnt(10)
    v_mfma_f32_32x32x16_bf16 v[88:103], v[32:35], v[180:183], v[88:103]
    ds_read_b64_tr_b16 v[28:29], v22 offset:16384
    ds_read_b64_tr_b16 v[30:31], v22 offset:18432
    s_waitcnt lgkmcnt(10)
    v_mfma_f32_32x32x16_bf16 v[104:119], v[36:39], v[180:183], v[104:119]
    buffer_load_dwordx4 v[164:167], v249, s[32:35], s16 offen offset:3072 sc1
    ds_read_b64_tr_b16 v[32:33], v23 offset:16384
    ds_read_b64_tr_b16 v[34:35], v23 offset:18432
    s_barrier
    s_waitcnt vmcnt(19)
    s_waitcnt lgkmcnt(10)
    v_mfma_f32_32x32x16_bf16 v[56:71], v[40:43], v[184:187], v[56:71]
    s_add_u32 s16, s16, 16384
    ds_read_b64_tr_b16 v[36:37], v20 offset:17408
    ds_read_b64_tr_b16 v[38:39], v20 offset:19456
    s_waitcnt lgkmcnt(10)
    v_mfma_f32_32x32x16_bf16 v[72:87], v[44:47], v[184:187], v[72:87]
    s_and_b32 s16, s16, 0x3ffff
    ds_read_b64_tr_b16 v[40:41], v21 offset:17408
    ds_read_b64_tr_b16 v[42:43], v21 offset:19456
    s_waitcnt lgkmcnt(10)
    v_mfma_f32_32x32x16_bf16 v[120:135], v[48:51], v[184:187], v[120:135]
    ds_read_b64_tr_b16 v[44:45], v24 offset:17408
    ds_read_b64_tr_b16 v[46:47], v24 offset:19456
    s_waitcnt lgkmcnt(10)
    v_mfma_f32_32x32x16_bf16 v[136:151], v[52:55], v[184:187], v[136:151]
    buffer_load_dwordx4 v[168:171], v249, s[32:35], s16 offen sc1
    ds_read_b64_tr_b16 v[48:49], v25 offset:17408
    ds_read_b64_tr_b16 v[50:51], v25 offset:19456
    s_waitcnt lgkmcnt(10)
    v_mfma_f32_32x32x16_bf16 v[88:103], v[28:31], v[184:187], v[88:103]
    ds_read_b64_tr_b16 v[52:53], v22 offset:17408
    ds_read_b64_tr_b16 v[54:55], v22 offset:19456
    s_waitcnt lgkmcnt(10)
    v_mfma_f32_32x32x16_bf16 v[104:119], v[32:35], v[184:187], v[104:119]
    ds_read_b64_tr_b16 v[28:29], v23 offset:17408
    ds_read_b64_tr_b16 v[30:31], v23 offset:19456
    s_waitcnt vmcnt(19)
    s_waitcnt lgkmcnt(10)
    v_mfma_f32_32x32x16_bf16 v[56:71], v[36:39], v[188:191], v[56:71]
    ds_read_b64_tr_b16 v[32:33], v20 offset:20480
    ds_read_b64_tr_b16 v[34:35], v20 offset:22528
    s_waitcnt lgkmcnt(10)
    v_mfma_f32_32x32x16_bf16 v[72:87], v[40:43], v[188:191], v[72:87]
    buffer_load_dwordx4 v[172:175], v249, s[32:35], s16 offen offset:1024 sc1
    ds_read_b64_tr_b16 v[36:37], v21 offset:20480
    ds_read_b64_tr_b16 v[38:39], v21 offset:22528
    s_waitcnt lgkmcnt(10)
    v_mfma_f32_32x32x16_bf16 v[120:135], v[44:47], v[188:191], v[120:135]
    ds_read_b64_tr_b16 v[40:41], v24 offset:20480
    ds_read_b64_tr_b16 v[42:43], v24 offset:22528
    s_waitcnt lgkmcnt(10)
    v_mfma_f32_32x32x16_bf16 v[136:151], v[48:51], v[188:191], v[136:151]
    ds_read_b64_tr_b16 v[44:45], v25 offset:20480
    ds_read_b64_tr_b16 v[46:47], v25 offset:22528
    s_waitcnt lgkmcnt(10)
    v_mfma_f32_32x32x16_bf16 v[88:103], v[52:55], v[188:191], v[88:103]
    ds_read_b64_tr_b16 v[48:49], v22 offset:20480
    ds_read_b64_tr_b16 v[50:51], v22 offset:22528
    s_waitcnt lgkmcnt(10)
    v_mfma_f32_32x32x16_bf16 v[104:119], v[28:31], v[188:191], v[104:119]
    buffer_load_dwordx4 v[176:179], v249, s[32:35], s16 offen offset:2048 sc1
    ds_read_b64_tr_b16 v[52:53], v23 offset:20480
    ds_read_b64_tr_b16 v[54:55], v23 offset:22528
    s_waitcnt vmcnt(20)
    s_waitcnt lgkmcnt(10)
    v_mfma_f32_32x32x16_bf16 v[56:71], v[32:35], v[192:195], v[56:71]
    ds_read_b64_tr_b16 v[28:29], v20 offset:21504
    ds_read_b64_tr_b16 v[30:31], v20 offset:23552
    s_waitcnt lgkmcnt(10)
    v_mfma_f32_32x32x16_bf16 v[72:87], v[36:39], v[192:195], v[72:87]
    ds_read_b64_tr_b16 v[32:33], v21 offset:21504
    ds_read_b64_tr_b16 v[34:35], v21 offset:23552
    s_waitcnt lgkmcnt(10)
    v_mfma_f32_32x32x16_bf16 v[120:135], v[40:43], v[192:195], v[120:135]
    ds_read_b64_tr_b16 v[36:37], v24 offset:21504
    ds_read_b64_tr_b16 v[38:39], v24 offset:23552
    s_waitcnt lgkmcnt(10)
    v_mfma_f32_32x32x16_bf16 v[136:151], v[44:47], v[192:195], v[136:151]
    buffer_load_dwordx4 v[180:183], v249, s[32:35], s16 offen offset:3072 sc1
    ds_read_b64_tr_b16 v[40:41], v25 offset:21504
    ds_read_b64_tr_b16 v[42:43], v25 offset:23552
L_PAD3:
    s_cbranch_execz L_RET3
    s_waitcnt lgkmcnt(10)
    v_mfma_f32_32x32x16_bf16 v[88:103], v[48:51], v[192:195], v[88:103]
    s_add_u32 s16, s16, 16384
    ds_read_b64_tr_b16 v[44:45], v22 offset:21504
    ds_read_b64_tr_b16 v[46:47], v22 offset:23552
    s_waitcnt lgkmcnt(10)
    v_mfma_f32_32x32x16_bf16 v[104:119], v[52:55], v[192:195], v[104:119]
    s_and_b32 s16, s16, 0x3ffff
    ds_read_b64_tr_b16 v[48:49], v23 offset:21504
    ds_read_b64_tr_b16 v[50:51], v23 offset:23552
    s_waitcnt vmcnt(20)
    s_waitcnt lgkmcnt(10)
    v_mfma_f32_32x32x16_bf16 v[56:71], v[28:31], v[196:199], v[56:71]
    ds_read_b64_tr_b16 v[52:53], v20 offset:24576
    ds_read_b64_tr_b16 v[54:55], v20 offset:26624
    s_waitcnt lgkmcnt(10)
    v_mfma_f32_32x32x16_bf16 v[72:87], v[32:35], v[196:199], v[72:87]
    buffer_load_dwordx4 v[184:187], v249, s[32:35], s16 offen sc1
    ds_read_b64_tr_b16 v[28:29], v21 offset:24576
    ds_read_b64_tr_b16 v[30:31], v21 offset:26624
    s_waitcnt lgkmcnt(10)
    v_mfma_f32_32x32x16_bf16 v[120:135], v[36:39], v[196:199], v[120:135]
    ds_read_b64_tr_b16 v[32:33], v20 offset:25600
    ds_read_b64_tr_b16 v[34:35], v20 offset:27648
    s_waitcnt lgkmcnt(10)
    v_mfma_f32_32x32x16_bf16 v[136:151], v[40:43], v[196:199], v[136:151]
    ds_read_b64_tr_b16 v[36:37], v21 offset:25600
    ds_read_b64_tr_b16 v[38:39], v21 offset:27648
    s_waitcnt lgkmcnt(10)
    v_mfma_f32_32x32x16_bf16 v[88:103], v[44:47], v[196:199], v[88:103]
    ds_read_b64_tr_b16 v[40:41], v20 offset:28672
    ds_read_b64_tr_b16 v[42:43], v20 offset:30720
    s_waitcnt lgkmcnt(10)
    v_mfma_f32_32x32x16_bf16 v[104:119], v[48:51], v[196:199], v[104:119]
    buffer_load_dwordx4 v[188:191], v249, s[32:35], s16 offen offset:1024 sc1
    ds_read_b64_tr_b16 v[44:45], v21 offset:28672
    ds_read_b64_tr_b16 v[46:47], v21 offset:30720
    s_barrier
    s_waitcnt vmcnt(21)
    s_waitcnt lgkmcnt(10)
    v_mfma_f32_32x32x16_bf16 v[56:71], v[52:55], v[200:203], v[56:71]
    ds_read_b64_tr_b16 v[48:49], v20 offset:29696
    ds_read_b64_tr_b16 v[50:51], v20 offset:31744
    s_waitcnt lgkmcnt(10)
    v_mfma_f32_32x32x16_bf16 v[72:87], v[28:31], v[200:203], v[72:87]
    ds_read_b64_tr_b16 v[52:53], v21 offset:29696
    ds_read_b64_tr_b16 v[54:55], v21 offset:31744
    s_waitcnt vmcnt(20)
    s_waitcnt lgkmcnt(10)
    v_mfma_f32_32x32x16_bf16 v[56:71], v[32:35], v[204:207], v[56:71]
    ds_read_b64_tr_b16 v[28:29], v24 offset:24576
    ds_read_b64_tr_b16 v[30:31], v24 offset:26624
    s_waitcnt lgkmcnt(10)
    v_mfma_f32_32x32x16_bf16 v[72:87], v[36:39], v[204:207], v[72:87]
    buffer_load_dwordx4 v[192:195], v249, s[32:35], s16 offen offset:2048 sc1
    ds_read_b64_tr_b16 v[32:33], v25 offset:24576
    ds_read_b64_tr_b16 v[34:35], v25 offset:26624
    s_waitcnt vmcnt(20)
    s_waitcnt lgkmcnt(10)
    v_mfma_f32_32x32x16_bf16 v[56:71], v[40:43], v[208:211], v[56:71]
    ds_read_b64_tr_b16 v[36:37], v22 offset:24576
    ds_read_b64_tr_b16 v[38:39], v22 offset:26624
    s_waitcnt lgkmcnt(10)
    v_mfma_f32_32x32x16_bf16 v[72:87], v[44:47], v[208:211], v[72:87]
    ds_read_b64_tr_b16 v[40:41], v23 offset:24576
    ds_read_b64_tr_b16 v[42:43], v23 offset:26624
    s_waitcnt vmcnt(19)
    s_waitcnt lgkmcnt(10)
    v_mfma_f32_32x32x16_bf16 v[56:71], v[48:51], v[212:215], v[56:71]
    ds_read_b64_tr_b16 v[44:45], v24 offset:25600
    ds_read_b64_tr_b16 v[46:47], v24 offset:27648
    s_waitcnt lgkmcnt(10)
    v_mfma_f32_32x32x16_bf16 v[72:87], v[52:55], v[212:215], v[72:87]
    buffer_load_dwordx4 v[196:199], v249, s[32:35], s16 offen offset:3072 sc1
    ds_read_b64_tr_b16 v[48:49], v25 offset:25600
    ds_read_b64_tr_b16 v[50:51], v25 offset:27648
    s_barrier
    s_waitcnt lgkmcnt(10)
    v_mfma_f32_32x32x16_bf16 v[120:135], v[28:31], v[200:203], v[120:135]
    s_add_u32 s16, s16, 16384
    ds_read_b64_tr_b16 v[52:53], v22 offset:25600
    ds_read_b64_tr_b16 v[54:55], v22 offset:27648
    s_waitcnt lgkmcnt(10)
    v_mfma_f32_32x32x16_bf16 v[136:151], v[32:35], v[200:203], v[136:151]
    s_and_b32 s16, s16, 0x3ffff
    ds_read_b64_tr_b16 v[28:29], v23 offset:25600
    ds_read_b64_tr_b16 v[30:31], v23 offset:27648
    s_waitcnt lgkmcnt(10)
    v_mfma_f32_32x32x16_bf16 v[88:103], v[36:39], v[200:203], v[88:103]
    ds_read_b64_tr_b16 v[32:33], v24 offset:28672
    ds_read_b64_tr_b16 v[34:35], v24 offset:30720
    s_waitcnt lgkmcnt(10)
    v_mfma_f32_32x32x16_bf16 v[104:119], v[40:43], v[200:203], v[104:119]
    buffer_load_dwordx4 v[200:203], v249, s[32:35], s16 offen sc1
    ds_read_b64_tr_b16 v[36:37], v25 offset:28672
    ds_read_b64_tr_b16 v[38:39], v25 offset:30720
    s_waitcnt lgkmcnt(10)
    v_mfma_f32_32x32x16_bf16 v[120:135], v[44:47], v[204:207], v[120:135]
    ds_read_b64_tr_b16 v[40:41], v22 offset:28672
    ds_read_b64_tr_b16 v[42:43], v22 offset:30720
    s_waitcnt lgkmcnt(10)
    v_mfma_f32_32x32x16_bf16 v[136:151], v[48:51], v[204:207], v[136:151]
    ds_read_b64_tr_b16 v[44:45], v23 offset:28672
    ds_read_b64_tr_b16 v[46:47], v23 offset:30720
    s_waitcnt lgkmcnt(10)
    v_mfma_f32_32x32x16_bf16 v[88:103], v[52:55], v[204:207], v[88:103]
    ds_read_b64_tr_b16 v[48:49], v24 offset:29696
    ds_read_b64_tr_b16 v[50:51], v24 offset:31744
    s_waitcnt lgkmcnt(10)
    v_mfma_f32_32x32x16_bf16 v[104:119], v[28:31], v[204:207], v[104:119]
    buffer_load_dwordx4 v[204:207], v249, s[32:35], s16 offen offset:1024 sc1
    ds_read_b64_tr_b16 v[52:53], v25 offset:29696
    ds_read_b64_tr_b16 v[54:55], v25 offset:31744
    s_waitcnt lgkmcnt(10)
    v_mfma_f32_32x32x16_bf16 v[120:135], v[32:35], v[208:211], v[120:135]
    ds_read_b64_tr_b16 v[28:29], v22 offset:29696
    ds_read_b64_tr_b16 v[30:31], v22 offset:31744
    s_waitcnt lgkmcnt(10)
    v_mfma_f32_32x32x16_bf16 v[136:151], v[36:39], v[208:211], v[136:151]
    ds_read_b64_tr_b16 v[32:33], v23 offset:29696
    ds_read_b64_tr_b16 v[34:35], v23 offset:31744
    s_waitcnt lgkmcnt(10)
    v_mfma_f32_32x32x16_bf16 v[88:103], v[40:43], v[208:211], v[88:103]
    ds_read_b64_tr_b16 v[36:37], v20 offset:32768
    ds_read_b64_tr_b16 v[38:39], v20 offset:34816
    s_waitcnt lgkmcnt(10)
    v_mfma_f32_32x32x16_bf16 v[104:119], v[44:47], v[208:211], v[104:119]
    buffer_load_dwordx4 v[208:211], v249, s[32:35], s16 offen offset:2048 sc1
    ds_read_b64_tr_b16 v[40:41], v20 offset:33792
    ds_read_b64_tr_b16 v[42:43], v20 offset:35840
    s_waitcnt lgkmcnt(10)
    v_mfma_f32_32x32x16_bf16 v[120:135], v[48:51], v[212:215], v[120:135]
    ds_read_b64_tr_b16 v[44:45], v20 offset:36864
    ds_read_b64_tr_b16 v[46:47], v20 offset:38912
    s_waitcnt lgkmcnt(10)
    v_mfma_f32_32x32x16_bf16 v[136:151], v[52:55], v[212:215], v[136:151]
    ds_read_b64_tr_b16 v[48:49], v20 offset:37888
    ds_read_b64_tr_b16 v[50:51], v20 offset:39936
    s_waitcnt lgkmcnt(10)
    v_mfma_f32_32x32x16_bf16 v[88:103], v[28:31], v[212:215], v[88:103]
    ds_read_b64_tr_b16 v[52:53], v20 offset:40960
    ds_read_b64_tr_b16 v[54:55], v20 offset:43008
    s_waitcnt lgkmcnt(10)
    v_mfma_f32_32x32x16_bf16 v[104:119], v[32:35], v[212:215], v[104:119]
    buffer_load_dwordx4 v[212:215], v249, s[32:35], s16 offen offset:3072 sc1
    ds_read_b64_tr_b16 v[28:29], v20 offset:41984
    ds_read_b64_tr_b16 v[30:31], v20 offset:44032
    s_barrier
    s_waitcnt vmcnt(23)
    s_waitcnt lgkmcnt(10)
    v_mfma_f32_32x32x16_bf16 v[56:71], v[36:39], v[216:219], v[56:71]
    s_add_u32 s16, s16, 16384
    ds_read_b64_tr_b16 v[32:33], v20 offset:45056
    ds_read_b64_tr_b16 v[34:35], v20 offset:47104
    s_waitcnt vmcnt(22)
    s_waitcnt lgkmcnt(10)
    v_mfma_f32_32x32x16_bf16 v[56:71], v[40:43], v[220:223], v[56:71]
    s_and_b32 s16, s16, 0x3ffff
    ds_read_b64_tr_b16 v[36:37], v20 offset:46080
    ds_read_b64_tr_b16 v[38:39], v20 offset:48128
    s_waitcnt vmcnt(21)
    s_waitcnt lgkmcnt(10)
    v_mfma_f32_32x32x16_bf16 v[56:71], v[44:47], v[224:227], v[56:71]
    ds_read_b64_tr_b16 v[40:41], v20
    ds_read_b64_tr_b16 v[42:43], v20 offset:2048
    s_waitcnt vmcnt(20)
    s_waitcnt lgkmcnt(10)
    v_mfma_f32_32x32x16_bf16 v[56:71], v[48:51], v[228:231], v[56:71]
    ds_read_b64_tr_b16 v[44:45], v20 offset:1024
    ds_read_b64_tr_b16 v[46:47], v20 offset:3072
    s_waitcnt vmcnt(19)
    s_waitcnt lgkmcnt(10)
    v_mfma_f32_32x32x16_bf16 v[56:71], v[52:55], v[232:235], v[56:71]
    ds_read_b64_tr_b16 v[48:49], v20 offset:4096
    ds_read_b64_tr_b16 v[50:51], v20 offset:6144
    s_waitcnt vmcnt(18)
    s_waitcnt lgkmcnt(10)
    v_mfma_f32_32x32x16_bf16 v[56:71], v[28:31], v[236:239], v[56:71]
    ds_read_b64_tr_b16 v[52:53], v20 offset:5120
    ds_read_b64_tr_b16 v[54:55], v20 offset:7168
    s_waitcnt vmcnt(17)
    s_waitcnt lgkmcnt(10)
    v_mfma_f32_32x32x16_bf16 v[56:71], v[32:35], v[240:243], v[56:71]
    ds_read_b64_tr_b16 v[28:29], v20 offset:8192
    ds_read_b64_tr_b16 v[30:31], v20 offset:10240
    s_waitcnt vmcnt(16)
    s_waitcnt lgkmcnt(10)
    v_mfma_f32_32x32x16_bf16 v[56:71], v[36:39], v[244:247], v[56:71]
    ds_read_b64_tr_b16 v[32:33], v20 offset:9216
    ds_read_b64_tr_b16 v[34:35], v20 offset:11264
    s_waitcnt vmcnt(15)
    s_waitcnt lgkmcnt(10)
    v_mfma_f32_32x32x16_bf16 v[56:71], v[40:43], v[152:155], v[56:71]
    ds_read_b64_tr_b16 v[36:37], v20 offset:12288
    ds_read_b64_tr_b16 v[38:39], v20 offset:14336
    s_waitcnt vmcnt(14)
    s_waitcnt lgkmcnt(10)
    v_mfma_f32_32x32x16_bf16 v[56:71], v[44:47], v[156:159], v[56:71]
    ds_read_b64_tr_b16 v[40:41], v20 offset:13312
    ds_read_b64_tr_b16 v[42:43], v20 offset:15360
    s_waitcnt vmcnt(13)
    s_waitcnt lgkmcnt(10)
    v_mfma_f32_32x32x16_bf16 v[56:71], v[48:51], v[160:163], v[56:71]
    ds_read_b64_tr_b16 v[44:45], v20 offset:16384
    ds_read_b64_tr_b16 v[46:47], v20 offset:18432
    s_waitcnt vmcnt(12)
    s_waitcnt lgkmcnt(10)
    v_mfma_f32_32x32x16_bf16 v[56:71], v[52:55], v[164:167], v[56:71]
    ds_read_b64_tr_b16 v[48:49], v20 offset:17408
    ds_read_b64_tr_b16 v[50:51], v20 offset:19456
    s_waitcnt vmcnt(11)
    s_waitcnt lgkmcnt(10)
    v_mfma_f32_32x32x16_bf16 v[56:71], v[28:31], v[168:171], v[56:71]
    ds_read_b64_tr_b16 v[52:53], v20 offset:20480
    ds_read_b64_tr_b16 v[54:55], v20 offset:22528
    s_waitcnt vmcnt(10)
    s_waitcnt lgkmcnt(10)
    v_mfma_f32_32x32x16_bf16 v[56:71], v[32:35], v[172:175], v[56:71]
    ds_read_b64_tr_b16 v[28:29], v20 offset:21504
    ds_read_b64_tr_b16 v[30:31], v20 offset:23552
    s_barrier
    s_waitcnt vmcnt(9)
    s_waitcnt lgkmcnt(10)
    v_mfma_f32_32x32x16_bf16 v[56:71], v[36:39], v[176:179], v[56:71]
    ds_read_b64_tr_b16 v[32:33], v20 offset:24576
    ds_read_b64_tr_b16 v[34:35], v20 offset:26624
    s_waitcnt vmcnt(8)
    s_waitcnt lgkmcnt(10)
    v_mfma_f32_32x32x16_bf16 v[56:71], v[40:43], v[180:183], v[56:71]
    ds_read_b64_tr_b16 v[36:37], v20 offset:25600
    ds_read_b64_tr_b16 v[38:39], v20 offset:27648
    s_waitcnt vmcnt(7)
    s_waitcnt lgkmcnt(10)
    v_mfma_f32_32x32x16_bf16 v[56:71], v[44:47], v[184:187], v[56:71]
    ds_read_b64_tr_b16 v[40:41], v20 offset:28672
    ds_read_b64_tr_b16 v[42:43], v20 offset:30720
    s_waitcnt vmcnt(6)
    s_waitcnt lgkmcnt(10)
    v_mfma_f32_32x32x16_bf16 v[56:71], v[48:51], v[188:191], v[56:71]
    ds_read_b64_tr_b16 v[44:45], v20 offset:29696
    ds_read_b64_tr_b16 v[46:47], v20 offset:31744
    s_waitcnt vmcnt(5)
    s_waitcnt lgkmcnt(10)
    v_mfma_f32_32x32x16_bf16 v[56:71], v[52:55], v[192:195], v[56:71]
    ds_read_b64_tr_b16 v[48:49], v21 offset:32768
    ds_read_b64_tr_b16 v[50:51], v21 offset:34816
    s_waitcnt vmcnt(4)
    s_waitcnt lgkmcnt(10)
    v_mfma_f32_32x32x16_bf16 v[56:71], v[28:31], v[196:199], v[56:71]
    ds_read_b64_tr_b16 v[52:53], v21 offset:33792
    ds_read_b64_tr_b16 v[54:55], v21 offset:35840
    s_waitcnt vmcnt(3)
    s_waitcnt lgkmcnt(10)
    v_mfma_f32_32x32x16_bf16 v[56:71], v[32:35], v[200:203], v[56:71]
    ds_read_b64_tr_b16 v[28:29], v21 offset:36864
    ds_read_b64_tr_b16 v[30:31], v21 offset:38912
    s_waitcnt vmcnt(2)
    s_waitcnt lgkmcnt(10)
    v_mfma_f32_32x32x16_bf16 v[56:71], v[36:39], v[204:207], v[56:71]
    ds_read_b64_tr_b16 v[32:33], v21 offset:37888
    ds_read_b64_tr_b16 v[34:35], v21 offset:39936
    s_waitcnt vmcnt(1)
    s_waitcnt lgkmcnt(10)
    v_mfma_f32_32x32x16_bf16 v[56:71], v[40:43], v[208:211], v[56:71]
    ds_read_b64_tr_b16 v[36:37], v21 offset:40960
    ds_read_b64_tr_b16 v[38:39], v21 offset:43008
    s_waitcnt vmcnt(0)
    s_waitcnt lgkmcnt(10)
    v_mfma_f32_32x32x16_bf16 v[56:71], v[44:47], v[212:215], v[56:71]
    ds_read_b64_tr_b16 v[40:41], v21 offset:41984
    ds_read_b64_tr_b16 v[42:43], v21 offset:44032
    s_waitcnt lgkmcnt(10)
    v_mfma_f32_32x32x16_bf16 v[72:87], v[48:51], v[216:219], v[72:87]
    ds_read_b64_tr_b16 v[44:45], v21 offset:45056
    ds_read_b64_tr_b16 v[46:47], v21 offset:47104
    s_waitcnt lgkmcnt(10)
    v_mfma_f32_32x32x16_bf16 v[72:87], v[52:55], v[220:223], v[72:87]
    s_nop 3
    v_cvt_pk_bf16_f32 v56, v56, v57
    v_cvt_pk_bf16_f32 v57, v58, v59
    ds_read_b64_tr_b16 v[48:49], v21 offset:46080
    ds_read_b64_tr_b16 v[50:51], v21 offset:48128
    s_waitcnt lgkmcnt(10)
    v_mfma_f32_32x32x16_bf16 v[72:87], v[28:31], v[224:227], v[72:87]
    v_cvt_pk_bf16_f32 v58, v60, v61
    v_cvt_pk_bf16_f32 v59, v62, v63
    ds_write_b128 v0, v[56:59]
    ds_read_b64_tr_b16 v[52:53], v21
    ds_read_b64_tr_b16 v[54:55], v21 offset:2048
    s_waitcnt lgkmcnt(11)
    v_mfma_f32_32x32x16_bf16 v[72:87], v[32:35], v[228:231], v[72:87]
    v_cvt_pk_bf16_f32 v60, v64, v65
    v_cvt_pk_bf16_f32 v61, v66, v67
    ds_read_b64_tr_b16 v[28:29], v21 offset:1024
    ds_read_b64_tr_b16 v[30:31], v21 offset:3072
    s_waitcnt lgkmcnt(11)
    v_mfma_f32_32x32x16_bf16 v[72:87], v[36:39], v[232:235], v[72:87]
    v_cvt_pk_bf16_f32 v62, v68, v69
    v_cvt_pk_bf16_f32 v63, v70, v71
    ds_write_b128 v0, v[60:63] offset:1024
    ds_read_b64_tr_b16 v[32:33], v21 offset:4096
    ds_read_b64_tr_b16 v[34:35], v21 offset:6144
    s_waitcnt lgkmcnt(12)
    v_mfma_f32_32x32x16_bf16 v[72:87], v[40:43], v[236:239], v[72:87]
    v_subrev_u32 v0, 118784, v0
    ds_read_b64_tr_b16 v[36:37], v21 offset:5120
    ds_read_b64_tr_b16 v[38:39], v21 offset:7168
    s_waitcnt lgkmcnt(12)
    v_mfma_f32_32x32x16_bf16 v[72:87], v[44:47], v[240:243], v[72:87]
    ds_read_b64_tr_b16 v[40:41], v21 offset:8192
    ds_read_b64_tr_b16 v[42:43], v21 offset:10240
    s_waitcnt lgkmcnt(12)
    v_mfma_f32_32x32x16_bf16 v[72:87], v[48:51], v[244:247], v[72:87]
    ds_read_b64_tr_b16 v[44:45], v21 offset:9216
    ds_read_b64_tr_b16 v[46:47], v21 offset:11264
    s_waitcnt lgkmcnt(8)
    s_barrier
    v_mfma_f32_32x32x16_bf16 v[72:87], v[52:55], v[152:155], v[72:87]
    ds_read_b64_tr_b16 v[48:49], v21 offset:12288
    ds_read_b64_tr_b16 v[50:51], v21 offset:14336
    v_mfma_f32_32x32x16_bf16 v[72:87], v[28:31], v[156:159], v[72:87]
    ds_read_b64_tr_b16 v[52:53], v21 offset:13312
    ds_read_b64_tr_b16 v[54:55], v21 offset:15360
    s_waitcnt lgkmcnt(10)
    v_mfma_f32_32x32x16_bf16 v[72:87], v[32:35], v[160:163], v[72:87]
    ds_read_b64_tr_b16 v[28:29], v21 offset:16384
    ds_read_b64_tr_b16 v[30:31], v21 offset:18432
    s_waitcnt lgkmcnt(10)
    v_mfma_f32_32x32x16_bf16 v[72:87], v[36:39], v[164:167], v[72:87]
    ds_read_b64_tr_b16 v[32:33], v21 offset:17408
    ds_read_b64_tr_b16 v[34:35], v21 offset:19456
    s_waitcnt lgkmcnt(10)
    v_mfma_f32_32x32x16_bf16 v[72:87], v[40:43], v[168:171], v[72:87]
    ds_read_b64_tr_b16 v[36:37], v21 offset:20480
    ds_read_b64_tr_b16 v[38:39], v21 offset:22528
    s_waitcnt lgkmcnt(10)
    v_mfma_f32_32x32x16_bf16 v[72:87], v[44:47], v[172:175], v[72:87]
    ds_read_b64_tr_b16 v[40:41], v21 offset:21504
    ds_read_b64_tr_b16 v[42:43], v21 offset:23552
    s_waitcnt lgkmcnt(10)
    v_mfma_f32_32x32x16_bf16 v[72:87], v[48:51], v[176:179], v[72:87]
    ds_read_b64_tr_b16 v[44:45], v21 offset:24576
    ds_read_b64_tr_b16 v[46:47], v21 offset:26624
    s_waitcnt lgkmcnt(10)
    v_mfma_f32_32x32x16_bf16 v[72:87], v[52:55], v[180:183], v[72:87]
    ds_read_b64_tr_b16 v[48:49], v21 offset:25600
    ds_read_b64_tr_b16 v[50:51], v21 offset:27648
    s_waitcnt lgkmcnt(10)
    v_mfma_f32_32x32x16_bf16 v[72:87], v[28:31], v[184:187], v[72:87]
    ds_read_b64_tr_b16 v[52:53], v21 offset:28672
    ds_read_b64_tr_b16 v[54:55], v21 offset:30720
    s_waitcnt lgkmcnt(10)
    v_mfma_f32_32x32x16_bf16 v[72:87], v[32:35], v[188:191], v[72:87]
    ds_read_b64_tr_b16 v[28:29], v21 offset:29696
    ds_read_b64_tr_b16 v[30:31], v21 offset:31744
    s_waitcnt lgkmcnt(10)
    v_mfma_f32_32x32x16_bf16 v[72:87], v[36:39], v[192:195], v[72:87]
    ds_read_b64_tr_b16 v[32:33], v22 offset:32768
    ds_read_b64_tr_b16 v[34:35], v22 offset:34816
    s_waitcnt lgkmcnt(10)
    v_mfma_f32_32x32x16_bf16 v[72:87], v[40:43], v[196:199], v[72:87]
    ds_read_b64_tr_b16 v[36:37], v23 offset:32768
    ds_read_b64_tr_b16 v[38:39], v23 offset:34816
    s_waitcnt lgkmcnt(10)
    v_mfma_f32_32x32x16_bf16 v[72:87], v[44:47], v[200:203], v[72:87]
    ds_read_b64_tr_b16 v[40:41], v22 offset:33792
    ds_read_b64_tr_b16 v[42:43], v22 offset:35840
    s_waitcnt lgkmcnt(10)
    v_mfma_f32_32x32x16_bf16 v[72:87], v[48:51], v[204:207], v[72:87]
    ds_read_b64_tr_b16 v[44:45], v23 offset:33792
    ds_read_b64_tr_b16 v[46:47], v23 offset:35840
    s_waitcnt lgkmcnt(10)
    v_mfma_f32_32x32x16_bf16 v[72:87], v[52:55], v[208:211], v[72:87]
    ds_read_b64_tr_b16 v[48:49], v22 offset:36864
    ds_read_b64_tr_b16 v[50:51], v22 offset:38912
    s_waitcnt lgkmcnt(10)
    v_mfma_f32_32x32x16_bf16 v[72:87], v[28:31], v[212:215], v[72:87]
    ds_read_b64_tr_b16 v[52:53], v23 offset:36864
    ds_read_b64_tr_b16 v[54:55], v23 offset:38912
    s_waitcnt lgkmcnt(10)
    v_mfma_f32_32x32x16_bf16 v[88:103], v[32:35], v[216:219], v[88:103]
    ds_read_b64_tr_b16 v[28:29], v22 offset:37888
    ds_read_b64_tr_b16 v[30:31], v22 offset:39936
    s_waitcnt lgkmcnt(10)
    v_mfma_f32_32x32x16_bf16 v[104:119], v[36:39], v[216:219], v[104:119]
    s_nop 3
    v_cvt_pk_bf16_f32 v72, v72, v73
    v_cvt_pk_bf16_f32 v73, v74, v75
    ds_read_b64_tr_b16 v[32:33], v23 offset:37888
    ds_read_b64_tr_b16 v[34:35], v23 offset:39936
    s_waitcnt lgkmcnt(10)
    v_mfma_f32_32x32x16_bf16 v[88:103], v[40:43], v[220:223], v[88:103]
    v_cvt_pk_bf16_f32 v74, v76, v77
    v_cvt_pk_bf16_f32 v75, v78, v79
    ds_write_b128 v0, v[72:75]
    ds_read_b64_tr_b16 v[36:37], v22 offset:40960
    ds_read_b64_tr_b16 v[38:39], v22 offset:43008
    s_waitcnt lgkmcnt(11)
    v_mfma_f32_32x32x16_bf16 v[104:119], v[44:47], v[220:223], v[104:119]
    v_cvt_pk_bf16_f32 v76, v80, v81
    v_cvt_pk_bf16_f32 v77, v82, v83
    ds_read_b64_tr_b16 v[40:41], v23 offset:40960
    ds_read_b64_tr_b16 v[42:43], v23 offset:43008
    s_waitcnt lgkmcnt(11)
    v_mfma_f32_32x32x16_bf16 v[88:103], v[48:51], v[224:227], v[88:103]
    v_cvt_pk_bf16_f32 v78, v84, v85
    v_cvt_pk_bf16_f32 v79, v86, v87
    ds_write_b128 v0, v[76:79] offset:1024
    ds_read_b64_tr_b16 v[44:45], v22 offset:41984
    ds_read_b64_tr_b16 v[46:47], v22 offset:44032
    s_waitcnt lgkmcnt(12)
    v_mfma_f32_32x32x16_bf16 v[104:119], v[52:55], v[224:227], v[104:119]
    ds_read_b64_tr_b16 v[48:49], v23 offset:41984
    ds_read_b64_tr_b16 v[50:51], v23 offset:44032
    s_waitcnt lgkmcnt(4)
    s_barrier
    v_mfma_f32_32x32x16_bf16 v[88:103], v[28:31], v[228:231], v[88:103]
    s_lshl_b32 s96, s77, 11
    s_add_u32 s14, s96, 32768
    v_and_b32 v0, 7, v1
    ds_read_b64_tr_b16 v[52:53], v22 offset:45056
    ds_read_b64_tr_b16 v[54:55], v22 offset:47104
    v_mfma_f32_32x32x16_bf16 v[104:119], v[32:35], v[228:231], v[104:119]
    v_lshl_add_u32 v0, v0, 4, s14
    ds_read_b64_tr_b16 v[28:29], v23 offset:45056
    ds_read_b64_tr_b16 v[30:31], v23 offset:47104
    v_mfma_f32_32x32x16_bf16 v[88:103], v[36:39], v[232:235], v[88:103]
    v_bfe_u32 v4, v1, 3, 2
    ds_read_b64_tr_b16 v[32:33], v22 offset:46080
    ds_read_b64_tr_b16 v[34:35], v22 offset:48128
    v_mfma_f32_32x32x16_bf16 v[104:119], v[40:43], v[232:235], v[104:119]
    v_lshl_add_u32 v0, v4, 8, v0
    v_lshrrev_b32 v4, 5, v1
    ds_read_b64_tr_b16 v[36:37], v23 offset:46080
    ds_read_b64_tr_b16 v[38:39], v23 offset:48128
    s_waitcnt lgkmcnt(10)
    v_mfma_f32_32x32x16_bf16 v[88:103], v[44:47], v[236:239], v[88:103]
    v_lshl_add_u32 v0, v4, 7, v0
    ds_read_b64_tr_b16 v[40:41], v22
    ds_read_b64_tr_b16 v[42:43], v22 offset:2048
    s_waitcnt lgkmcnt(10)
    v_mfma_f32_32x32x16_bf16 v[104:119], v[48:51], v[236:239], v[104:119]
    ds_read_b64_tr_b16 v[44:45], v23
    ds_read_b64_tr_b16 v[46:47], v23 offset:2048
    s_waitcnt lgkmcnt(10)
    v_mfma_f32_32x32x16_bf16 v[88:103], v[52:55], v[240:243], v[88:103]
    ds_read_b64_tr_b16 v[48:49], v22 offset:1024
    ds_read_b64_tr_b16 v[50:51], v22 offset:3072
    s_waitcnt lgkmcnt(10)
    v_mfma_f32_32x32x16_bf16 v[104:119], v[28:31], v[240:243], v[104:119]
    ds_read_b64_tr_b16 v[52:53], v23 offset:1024
    ds_read_b64_tr_b16 v[54:55], v23 offset:3072
    s_waitcnt lgkmcnt(10)
    v_mfma_f32_32x32x16_bf16 v[88:103], v[32:35], v[244:247], v[88:103]
    ds_read_b64_tr_b16 v[28:29], v22 offset:4096
    ds_read_b64_tr_b16 v[30:31], v22 offset:6144
    s_waitcnt lgkmcnt(10)
    v_mfma_f32_32x32x16_bf16 v[104:119], v[36:39], v[244:247], v[104:119]
    ds_read_b64_tr_b16 v[32:33], v23 offset:4096
    ds_read_b64_tr_b16 v[34:35], v23 offset:6144
    s_waitcnt lgkmcnt(10)
    v_mfma_f32_32x32x16_bf16 v[88:103], v[40:43], v[152:155], v[88:103]
    ds_read_b64_tr_b16 v[36:37], v22 offset:5120
    ds_read_b64_tr_b16 v[38:39], v22 offset:7168
    s_waitcnt lgkmcnt(10)
    v_mfma_f32_32x32x16_bf16 v[104:119], v[44:47], v[152:155], v[104:119]
    ds_read_b64_tr_b16 v[40:41], v23 offset:5120
    ds_read_b64_tr_b16 v[42:43], v23 offset:7168
    s_waitcnt lgkmcnt(10)
    v_mfma_f32_32x32x16_bf16 v[88:103], v[48:51], v[156:159], v[88:103]
    ds_read_b64_tr_b16 v[44:45], v22 offset:8192
    ds_read_b64_tr_b16 v[46:47], v22 offset:10240
    s_waitcnt lgkmcnt(10)
    v_mfma_f32_32x32x16_bf16 v[104:119], v[52:55], v[156:159], v[104:119]
    ds_read_b64_tr_b16 v[48:49], v23 offset:8192
    ds_read_b64_tr_b16 v[50:51], v23 offset:10240
    s_waitcnt lgkmcnt(10)
    v_mfma_f32_32x32x16_bf16 v[88:103], v[28:31], v[160:163], v[88:103]
    ds_read_b64_tr_b16 v[52:53], v22 offset:9216
    ds_read_b64_tr_b16 v[54:55], v22 offset:11264
    s_waitcnt lgkmcnt(10)
    v_mfma_f32_32x32x16_bf16 v[104:119], v[32:35], v[160:163], v[104:119]
    ds_read_b64_tr_b16 v[28:29], v23 offset:9216
    ds_read_b64_tr_b16 v[30:31], v23 offset:11264
    s_waitcnt lgkmcnt(10)
    v_mfma_f32_32x32x16_bf16 v[88:103], v[36:39], v[164:167], v[88:103]
    ds_read_b64_tr_b16 v[32:33], v22 offset:12288
    ds_read_b64_tr_b16 v[34:35], v22 offset:14336
    s_waitcnt lgkmcnt(10)
    v_mfma_f32_32x32x16_bf16 v[104:119], v[40:43], v[164:167], v[104:119]
    ds_read_b64_tr_b16 v[36:37], v23 offset:12288
    ds_read_b64_tr_b16 v[38:39], v23 offset:14336
    s_waitcnt lgkmcnt(10)
    v_mfma_f32_32x32x16_bf16 v[88:103], v[44:47], v[168:171], v[88:103]
    ds_read_b64_tr_b16 v[40:41], v22 offset:13312
    ds_read_b64_tr_b16 v[42:43], v22 offset:15360
    s_waitcnt lgkmcnt(10)
    v_mfma_f32_32x32x16_bf16 v[104:119], v[48:51], v[168:171], v[104:119]
    ds_read_b64_tr_b16 v[44:45], v23 offset:13312
    ds_read_b64_tr_b16 v[46:47], v23 offset:15360
    s_waitcnt lgkmcnt(10)
    v_mfma_f32_32x32x16_bf16 v[88:103], v[52:55], v[172:175], v[88:103]
    ds_read_b64_tr_b16 v[48:49], v22 offset:16384
    ds_read_b64_tr_b16 v[50:51], v22 offset:18432
    s_waitcnt lgkmcnt(10)
    v_mfma_f32_32x32x16_bf16 v[104:119], v[28:31], v[172:175], v[104:119]
    ds_read_b64_tr_b16 v[52:53], v23 offset:16384
    ds_read_b64_tr_b16 v[54:55], v23 offset:18432
    s_waitcnt lgkmcnt(10)
    v_mfma_f32_32x32x16_bf16 v[88:103], v[32:35], v[176:179], v[88:103]
    ds_read_b64_tr_b16 v[28:29], v22 offset:17408
    ds_read_b64_tr_b16 v[30:31], v22 offset:19456
    s_waitcnt lgkmcnt(10)
    v_mfma_f32_32x32x16_bf16 v[104:119], v[36:39], v[176:179], v[104:119]
    ds_read_b64_tr_b16 v[32:33], v23 offset:17408
    ds_read_b64_tr_b16 v[34:35], v23 offset:19456
    s_waitcnt lgkmcnt(10)
    v_mfma_f32_32x32x16_bf16 v[88:103], v[40:43], v[180:183], v[88:103]
    ds_read_b64_tr_b16 v[36:37], v22 offset:20480
    ds_read_b64_tr_b16 v[38:39], v22 offset:22528
    s_waitcnt lgkmcnt(10)
    v_mfma_f32_32x32x16_bf16 v[104:119], v[44:47], v[180:183], v[104:119]
    ds_read_b64_tr_b16 v[40:41], v23 offset:20480
    ds_read_b64_tr_b16 v[42:43], v23 offset:22528
    s_waitcnt lgkmcnt(10)
    v_mfma_f32_32x32x16_bf16 v[88:103], v[48:51], v[184:187], v[88:103]
    ds_read_b64_tr_b16 v[44:45], v22 offset:21504
    ds_read_b64_tr_b16 v[46:47], v22 offset:23552
    s_waitcnt lgkmcnt(10)
    v_mfma_f32_32x32x16_bf16 v[104:119], v[52:55], v[184:187], v[104:119]
    ds_read_b64_tr_b16 v[48:49], v23 offset:21504
    ds_read_b64_tr_b16 v[50:51], v23 offset:23552
    s_waitcnt lgkmcnt(10)
    v_mfma_f32_32x32x16_bf16 v[88:103], v[28:31], v[188:191], v[88:103]
    ds_read_b64_tr_b16 v[52:53], v22 offset:24576
    ds_read_b64_tr_b16 v[54:55], v22 offset:26624
    s_waitcnt lgkmcnt(10)
    v_mfma_f32_32x32x16_bf16 v[104:119], v[32:35], v[188:191], v[104:119]
    ds_read_b64_tr_b16 v[28:29], v23 offset:24576
    ds_read_b64_tr_b16 v[30:31], v23 offset:26624
    s_waitcnt lgkmcnt(10)
    v_mfma_f32_32x32x16_bf16 v[88:103], v[36:39], v[192:195], v[88:103]
    ds_read_b64_tr_b16 v[32:33], v22 offset:25600
    ds_read_b64_tr_b16 v[34:35], v22 offset:27648
    s_waitcnt lgkmcnt(10)
    v_mfma_f32_32x32x16_bf16 v[104:119], v[40:43], v[192:195], v[104:119]
    ds_read_b64_tr_b16 v[36:37], v23 offset:25600
    ds_read_b64_tr_b16 v[38:39], v23 offset:27648
    s_waitcnt lgkmcnt(10)
    v_mfma_f32_32x32x16_bf16 v[88:103], v[44:47], v[196:199], v[88:103]
    ds_read_b64_tr_b16 v[40:41], v22 offset:28672
    ds_read_b64_tr_b16 v[42:43], v22 offset:30720
    s_waitcnt lgkmcnt(10)
    v_mfma_f32_32x32x16_bf16 v[104:119], v[48:51], v[196:199], v[104:119]
    ds_read_b64_tr_b16 v[44:45], v23 offset:28672
    ds_read_b64_tr_b16 v[46:47], v23 offset:30720
    s_waitcnt lgkmcnt(10)
    v_mfma_f32_32x32x16_bf16 v[88:103], v[52:55], v[200:203], v[88:103]
    ds_read_b64_tr_b16 v[48:49], v22 offset:29696
    ds_read_b64_tr_b16 v[50:51], v22 offset:31744
    s_waitcnt lgkmcnt(10)
    v_mfma_f32_32x32x16_bf16 v[104:119], v[28:31], v[200:203], v[104:119]
    ds_read_b64_tr_b16 v[52:53], v23 offset:29696
    ds_read_b64_tr_b16 v[54:55], v23 offset:31744
    s_waitcnt lgkmcnt(10)
    v_mfma_f32_32x32x16_bf16 v[88:103], v[32:35], v[204:207], v[88:103]
    ds_read_b64_tr_b16 v[28:29], v24 offset:32768
    ds_read_b64_tr_b16 v[30:31], v24 offset:34816
    s_waitcnt lgkmcnt(10)
    v_mfma_f32_32x32x16_bf16 v[104:119], v[36:39], v[204:207], v[104:119]
    ds_read_b64_tr_b16 v[32:33], v25 offset:32768
    ds_read_b64_tr_b16 v[34:35], v25 offset:34816
    s_waitcnt lgkmcnt(10)
    v_mfma_f32_32x32x16_bf16 v[88:103], v[40:43], v[208:211], v[88:103]
    ds_read_b64_tr_b16 v[36:37], v24 offset:33792
    ds_read_b64_tr_b16 v[38:39], v24 offset:35840
    s_waitcnt lgkmcnt(10)
    v_mfma_f32_32x32x16_bf16 v[104:119], v[44:47], v[208:211], v[104:119]
    ds_read_b64_tr_b16 v[40:41], v25 offset:33792
    ds_read_b64_tr_b16 v[42:43], v25 offset:35840
    s_waitcnt lgkmcnt(10)
    v_mfma_f32_32x32x16_bf16 v[88:103], v[48:51], v[212:215], v[88:103]
    ds_read_b64_tr_b16 v[44:45], v24 offset:36864
    ds_read_b64_tr_b16 v[46:47], v24 offset:38912
    s_waitcnt lgkmcnt(10)
    v_mfma_f32_32x32x16_bf16 v[104:119], v[52:55], v[212:215], v[104:119]
    ds_read_b64_tr_b16 v[48:49], v25 offset:36864
    ds_read_b64_tr_b16 v[50:51], v25 offset:38912
    s_barrier
    s_waitcnt lgkmcnt(10)
    v_mfma_f32_32x32x16_bf16 v[120:135], v[28:31], v[216:219], v[120:135]
    ds_read_b64_tr_b16 v[52:53], v24 offset:37888
    ds_read_b64_tr_b16 v[54:55], v24 offset:39936
    s_waitcnt lgkmcnt(10)
    v_mfma_f32_32x32x16_bf16 v[136:151], v[32:35], v[216:219], v[136:151]
L_PAD4:
    s_cbranch_execz L_RET4
    v_cvt_pk_bf16_f32 v88, v88, v89
    v_cvt_pk_bf16_f32 v89, v90, v91
    ds_read_b64_tr_b16 v[28:29], v25 offset:37888
    ds_read_b64_tr_b16 v[30:31], v25 offset:39936
    s_waitcnt lgkmcnt(10)
    v_mfma_f32_32x32x16_bf16 v[120:135], v[36:39], v[220:223], v[120:135]
    v_cvt_pk_bf16_f32 v90, v92, v93
    v_cvt_pk_bf16_f32 v91, v94, v95
    ds_write_b128 v0, v[88:91]
    ds_read_b64_tr_b16 v[32:33], v24 offset:40960
    ds_read_b64_tr_b16 v[34:35], v24 offset:43008
    s_waitcnt lgkmcnt(11)
    v_mfma_f32_32x32x16_bf16 v[136:151], v[40:43], v[220:223], v[136:151]
    v_cvt_pk_bf16_f32 v92, v96, v97
    v_cvt_pk_bf16_f32 v93, v98, v99
    ds_read_b64_tr_b16 v[36:37], v25 offset:40960
    ds_read_b64_tr_b16 v[38:39], v25 offset:43008
    s_waitcnt lgkmcnt(11)
    v_mfma_f32_32x32x16_bf16 v[120:135], v[44:47], v[224:227], v[120:135]
    v_cvt_pk_bf16_f32 v94, v100, v101
    v_cvt_pk_bf16_f32 v95, v102, v103
    ds_write_b128 v0, v[92:95] offset:1024
    ds_read_b64_tr_b16 v[40:41], v24 offset:41984
    ds_read_b64_tr_b16 v[42:43], v24 offset:44032
    s_waitcnt lgkmcnt(12)
    v_mfma_f32_32x32x16_bf16 v[136:151], v[48:51], v[224:227], v[136:151]
    v_cvt_pk_bf16_f32 v104, v104, v105
    v_cvt_pk_bf16_f32 v105, v106, v107
    ds_read_b64_tr_b16 v[44:45], v25 offset:41984
    ds_read_b64_tr_b16 v[46:47], v25 offset:44032
    s_waitcnt lgkmcnt(12)
    v_mfma_f32_32x32x16_bf16 v[120:135], v[52:55], v[228:231], v[120:135]
    v_cvt_pk_bf16_f32 v106, v108, v109
    v_cvt_pk_bf16_f32 v107, v110, v111
    ds_write_b128 v0, v[104:107] offset:8192
    ds_read_b64_tr_b16 v[48:49], v24 offset:45056
    ds_read_b64_tr_b16 v[50:51], v24 offset:47104
    s_waitcnt lgkmcnt(13)
    v_mfma_f32_32x32x16_bf16 v[136:151], v[28:31], v[228:231], v[136:151]
    v_cvt_pk_bf16_f32 v108, v112, v113
    v_cvt_pk_bf16_f32 v109, v114, v115
    ds_read_b64_tr_b16 v[52:53], v25 offset:45056
    ds_read_b64_tr_b16 v[54:55], v25 offset:47104
    s_waitcnt lgkmcnt(12)
    v_mfma_f32_32x32x16_bf16 v[120:135], v[32:35], v[232:235], v[120:135]
    v_cvt_pk_bf16_f32 v110, v116, v117
    v_cvt_pk_bf16_f32 v111, v118, v119
    ds_write_b128 v0, v[108:111] offset:9216
    ds_read_b64_tr_b16 v[28:29], v24 offset:46080
    ds_read_b64_tr_b16 v[30:31], v24 offset:48128
    s_waitcnt lgkmcnt(13)
    v_mfma_f32_32x32x16_bf16 v[136:151], v[36:39], v[232:235], v[136:151]
    ds_read_b64_tr_b16 v[32:33], v25 offset:46080
    ds_read_b64_tr_b16 v[34:35], v25 offset:48128
    s_waitcnt lgkmcnt(12)
    v_mfma_f32_32x32x16_bf16 v[120:135], v[40:43], v[236:239], v[120:135]
    ds_read_b64_tr_b16 v[36:37], v24
    ds_read_b64_tr_b16 v[38:39], v24 offset:2048
    s_waitcnt lgkmcnt(12)
    v_mfma_f32_32x32x16_bf16 v[136:151], v[44:47], v[236:239], v[136:151]
    ds_read_b64_tr_b16 v[40:41], v25
    ds_read_b64_tr_b16 v[42:43], v25 offset:2048
    s_waitcnt lgkmcnt(11)
    v_mfma_f32_32x32x16_bf16 v[120:135], v[48:51], v[240:243], v[120:135]
    ds_read_b64_tr_b16 v[44:45], v24 offset:1024
    ds_read_b64_tr_b16 v[46:47], v24 offset:3072
    s_waitcnt lgkmcnt(11)
    v_mfma_f32_32x32x16_bf16 v[136:151], v[52:55], v[240:243], v[136:151]
    ds_read_b64_tr_b16 v[48:49], v25 offset:1024
    ds_read_b64_tr_b16 v[50:51], v25 offset:3072
    s_waitcnt lgkmcnt(10)
    v_mfma_f32_32x32x16_bf16 v[120:135], v[28:31], v[244:247], v[120:135]
    ds_read_b64_tr_b16 v[52:53], v24 offset:4096
    ds_read_b64_tr_b16 v[54:55], v24 offset:6144
    s_waitcnt lgkmcnt(10)
    v_mfma_f32_32x32x16_bf16 v[136:151], v[32:35], v[244:247], v[136:151]
    ds_read_b64_tr_b16 v[28:29], v25 offset:4096
    ds_read_b64_tr_b16 v[30:31], v25 offset:6144
    s_waitcnt lgkmcnt(10)
    v_mfma_f32_32x32x16_bf16 v[120:135], v[36:39], v[152:155], v[120:135]
    ds_read_b64_tr_b16 v[32:33], v24 offset:5120
    ds_read_b64_tr_b16 v[34:35], v24 offset:7168
    s_waitcnt lgkmcnt(10)
    v_mfma_f32_32x32x16_bf16 v[136:151], v[40:43], v[152:155], v[136:151]
    ds_read_b64_tr_b16 v[36:37], v25 offset:5120
    ds_read_b64_tr_b16 v[38:39], v25 offset:7168
    s_waitcnt lgkmcnt(10)
    v_mfma_f32_32x32x16_bf16 v[120:135], v[44:47], v[156:159], v[120:135]
    ds_read_b64_tr_b16 v[40:41], v24 offset:8192
    ds_read_b64_tr_b16 v[42:43], v24 offset:10240
    s_waitcnt lgkmcnt(10)
    v_mfma_f32_32x32x16_bf16 v[136:151], v[48:51], v[156:159], v[136:151]
    ds_read_b64_tr_b16 v[44:45], v25 offset:8192
    ds_read_b64_tr_b16 v[46:47], v25 offset:10240
    s_waitcnt lgkmcnt(10)
    v_mfma_f32_32x32x16_bf16 v[120:135], v[52:55], v[160:163], v[120:135]
    ds_read_b64_tr_b16 v[48:49], v24 offset:9216
    ds_read_b64_tr_b16 v[50:51], v24 offset:11264
    s_waitcnt lgkmcnt(10)
    v_mfma_f32_32x32x16_bf16 v[136:151], v[28:31], v[160:163], v[136:151]
    ds_read_b64_tr_b16 v[52:53], v25 offset:9216
    ds_read_b64_tr_b16 v[54:55], v25 offset:11264
    s_waitcnt lgkmcnt(10)
    v_mfma_f32_32x32x16_bf16 v[120:135], v[32:35], v[164:167], v[120:135]
    ds_read_b64_tr_b16 v[28:29], v24 offset:12288
    ds_read_b64_tr_b16 v[30:31], v24 offset:14336
    s_waitcnt lgkmcnt(10)
    v_mfma_f32_32x32x16_bf16 v[136:151], v[36:39], v[164:167], v[136:151]
    ds_read_b64_tr_b16 v[32:33], v25 offset:12288
    ds_read_b64_tr_b16 v[34:35], v25 offset:14336
    s_waitcnt lgkmcnt(10)
    v_mfma_f32_32x32x16_bf16 v[120:135], v[40:43], v[168:171], v[120:135]
    ds_read_b64_tr_b16 v[36:37], v24 offset:13312
    ds_read_b64_tr_b16 v[38:39], v24 offset:15360
    s_waitcnt lgkmcnt(10)
    v_mfma_f32_32x32x16_bf16 v[136:151], v[44:47], v[168:171], v[136:151]
    ds_read_b64_tr_b16 v[40:41], v25 offset:13312
    ds_read_b64_tr_b16 v[42:43], v25 offset:15360
    s_waitcnt lgkmcnt(10)
    v_mfma_f32_32x32x16_bf16 v[120:135], v[48:51], v[172:175], v[120:135]
    ds_read_b64_tr_b16 v[44:45], v24 offset:16384
    ds_read_b64_tr_b16 v[46:47], v24 offset:18432
    s_waitcnt lgkmcnt(10)
    v_mfma_f32_32x32x16_bf16 v[136:151], v[52:55], v[172:175], v[136:151]
    ds_read_b64_tr_b16 v[48:49], v25 offset:16384
    ds_read_b64_tr_b16 v[50:51], v25 offset:18432
    s_waitcnt lgkmcnt(10)
    v_mfma_f32_32x32x16_bf16 v[120:135], v[28:31], v[176:179], v[120:135]
    ds_read_b64_tr_b16 v[52:53], v24 offset:17408
    ds_read_b64_tr_b16 v[54:55], v24 offset:19456
    s_waitcnt lgkmcnt(10)
    v_mfma_f32_32x32x16_bf16 v[136:151], v[32:35], v[176:179], v[136:151]
    ds_read_b64_tr_b16 v[28:29], v25 offset:17408
    ds_read_b64_tr_b16 v[30:31], v25 offset:19456
    s_waitcnt lgkmcnt(10)
    v_mfma_f32_32x32x16_bf16 v[120:135], v[36:39], v[180:183], v[120:135]
    ds_read_b64_tr_b16 v[32:33], v24 offset:20480
    ds_read_b64_tr_b16 v[34:35], v24 offset:22528
    s_waitcnt lgkmcnt(10)
    v_mfma_f32_32x32x16_bf16 v[136:151], v[40:43], v[180:183], v[136:151]
    ds_read_b64_tr_b16 v[36:37], v25 offset:20480
    ds_read_b64_tr_b16 v[38:39], v25 offset:22528
    s_waitcnt lgkmcnt(10)
    v_mfma_f32_32x32x16_bf16 v[120:135], v[44:47], v[184:187], v[120:135]
    ds_read_b64_tr_b16 v[40:41], v24 offset:21504
    ds_read_b64_tr_b16 v[42:43], v24 offset:23552
    s_waitcnt lgkmcnt(10)
    v_mfma_f32_32x32x16_bf16 v[136:151], v[48:51], v[184:187], v[136:151]
    ds_read_b64_tr_b16 v[44:45], v25 offset:21504
    ds_read_b64_tr_b16 v[46:47], v25 offset:23552
    s_waitcnt lgkmcnt(10)
    v_mfma_f32_32x32x16_bf16 v[120:135], v[52:55], v[188:191], v[120:135]
    ds_read_b64_tr_b16 v[48:49], v24 offset:24576
    ds_read_b64_tr_b16 v[50:51], v24 offset:26624
    s_waitcnt lgkmcnt(10)
    v_mfma_f32_32x32x16_bf16 v[136:151], v[28:31], v[188:191], v[136:151]
    ds_read_b64_tr_b16 v[52:53], v25 offset:24576
    ds_read_b64_tr_b16 v[54:55], v25 offset:26624
    s_waitcnt lgkmcnt(10)
    v_mfma_f32_32x32x16_bf16 v[120:135], v[32:35], v[192:195], v[120:135]
    ds_read_b64_tr_b16 v[28:29], v24 offset:25600
    ds_read_b64_tr_b16 v[30:31], v24 offset:27648
    s_waitcnt lgkmcnt(10)
    v_mfma_f32_32x32x16_bf16 v[136:151], v[36:39], v[192:195], v[136:151]
    ds_read_b64_tr_b16 v[32:33], v25 offset:25600
    ds_read_b64_tr_b16 v[34:35], v25 offset:27648
    s_waitcnt lgkmcnt(10)
    v_mfma_f32_32x32x16_bf16 v[120:135], v[40:43], v[196:199], v[120:135]
    ds_read_b64_tr_b16 v[36:37], v24 offset:28672
    ds_read_b64_tr_b16 v[38:39], v24 offset:30720
    s_waitcnt lgkmcnt(10)
    v_mfma_f32_32x32x16_bf16 v[136:151], v[44:47], v[196:199], v[136:151]
    ds_read_b64_tr_b16 v[40:41], v25 offset:28672
    ds_read_b64_tr_b16 v[42:43], v25 offset:30720
    s_waitcnt lgkmcnt(10)
    v_mfma_f32_32x32x16_bf16 v[120:135], v[48:51], v[200:203], v[120:135]
    ds_read_b64_tr_b16 v[44:45], v25 offset:29696
    ds_read_b64_tr_b16 v[46:47], v25 offset:31744
    s_waitcnt lgkmcnt(10)
    v_mfma_f32_32x32x16_bf16 v[136:151], v[52:55], v[200:203], v[136:151]
    ds_read_b64_tr_b16 v[48:49], v24 offset:29696
    ds_read_b64_tr_b16 v[50:51], v24 offset:31744
    s_waitcnt lgkmcnt(10)
    v_mfma_f32_32x32x16_bf16 v[120:135], v[28:31], v[204:207], v[120:135]
    s_waitcnt lgkmcnt(8)
    v_mfma_f32_32x32x16_bf16 v[136:151], v[32:35], v[204:207], v[136:151]
    s_waitcnt lgkmcnt(6)
    v_mfma_f32_32x32x16_bf16 v[120:135], v[36:39], v[208:211], v[120:135]
    s_waitcnt lgkmcnt(4)
    v_mfma_f32_32x32x16_bf16 v[136:151], v[40:43], v[208:211], v[136:151]
    s_waitcnt lgkmcnt(2)
    v_mfma_f32_32x32x16_bf16 v[136:151], v[44:47], v[212:215], v[136:151]
    s_waitcnt lgkmcnt(0)
    v_mfma_f32_32x32x16_bf16 v[120:135], v[48:51], v[212:215], v[120:135]
    s_lshl_b32 s96, s77, 11
    s_add_u32 s14, s96, 151552
    v_add_u32 v0, s14, v2
    v_bfe_u32 v4, v1, 2, 2
    v_lshlrev_b32 v4, 6, v4
    v_bfe_u32 v9, v1, 4, 1
    v_lshl_add_u32 v4, v9, 5, v4
    v_and_b32 v9, 3, v1
    v_lshl_add_u32 v4, v9, 3, v4
    v_lshrrev_b32 v9, 5, v1
    v_lshl_add_u32 v4, v9, 8, v4
    v_add_u32 v4, 159744, v4
    ds_read_b64_tr_b16 v[176:177], v4
    ds_read_b64_tr_b16 v[178:179], v4 offset:512
    ds_read_b64_tr_b16 v[180:181], v4 offset:1024
    ds_read_b64_tr_b16 v[182:183], v4 offset:1536
    v_cvt_pk_bf16_f32 v152, v136, v137
    v_cvt_pk_bf16_f32 v153, v138, v139
    v_cvt_pk_bf16_f32 v154, v140, v141
    v_cvt_pk_bf16_f32 v155, v142, v143
    v_cvt_pk_bf16_f32 v156, v144, v145
    v_cvt_pk_bf16_f32 v157, v146, v147
    v_cvt_pk_bf16_f32 v158, v148, v149
    v_cvt_pk_bf16_f32 v159, v150, v151
    ds_write_b128 v0, v[152:155]
    ds_write_b128 v0, v[156:159] offset:1024
    v_cvt_pk_bf16_f32 v168, v120, v121
    v_cvt_pk_bf16_f32 v169, v122, v123
    v_cvt_pk_bf16_f32 v170, v124, v125
    v_cvt_pk_bf16_f32 v171, v126, v127
    v_cvt_pk_bf16_f32 v172, v128, v129
    v_cvt_pk_bf16_f32 v173, v130, v131
    v_cvt_pk_bf16_f32 v174, v132, v133
    v_cvt_pk_bf16_f32 v175, v134, v135
    s_setprio 0
    s_branch L_JOIN
L_HELP:
    s_waitcnt vmcnt(3)
    s_barrier
    s_add_u32 s96, s84, 5
    s_and_b32 s97, s96, 15
    s_mul_i32 s98, s97, 393216
    s_add_u32 s99, s98, s85
    s_add_u32 s82, s99, 4294772736
    s_add_u32 m0, s83, 36864
    s_nop 0
    buffer_load_dwordx4 v3, s[40:43], s82 offen lds
    s_add_u32 s96, s84, 5
    s_and_b32 s97, s96, 15
    s_mul_i32 s98, s97, 393216
    s_add_u32 s99, s98, s85
    s_add_u32 s82, s99, 2048
    s_add_u32 m0, s83, 40960
    s_nop 0
    buffer_load_dwordx4 v3, s[40:43], s82 offen lds
    s_add_u32 s96, s84, 5
    s_and_b32 s97, s96, 15
    s_mul_i32 s98, s97, 393216
    s_add_u32 s99, s98, s85
    s_add_u32 s82, s99, 4294774784
    s_add_u32 m0, s83, 86016
    s_nop 0
    buffer_load_dwordx4 v3, s[40:43], s82 offen lds
    s_add_u32 s96, s84, 5
    s_and_b32 s97, s96, 15
    s_mul_i32 s98, s97, 393216
    s_add_u32 s99, s98, s85
    s_add_u32 s82, s99, 4096
    s_add_u32 m0, s83, 90112
    s_nop 0
    buffer_load_dwordx4 v3, s[40:43], s82 offen lds
    s_add_u32 s96, s84, 5
    s_and_b32 s97, s96, 15
    s_mul_i32 s98, s97, 393216
    s_add_u32 s99, s98, s85
    s_add_u32 s82, s99, 4294770688
    s_add_u32 m0, s83, 135168
    s_nop 0
    buffer_load_dwordx4 v3, s[40:43], s82 offen lds
    s_add_u32 s96, s84, 5
    s_and_b32 s97, s96, 15
    s_mul_i32 s98, s97, 393216
    s_add_u32 s82, s98, s85
    s_add_u32 m0, s83, 139264
    s_nop 0
    buffer_load_dwordx4 v3, s[40:43], s82 offen lds
    v_bfe_u32 v4, v1, 2, 2
    v_lshlrev_b32 v4, 6, v4
    v_bfe_u32 v9, v1, 4, 1
    v_lshl_add_u32 v4, v9, 5, v4
    v_and_b32 v9, 3, v1
    v_lshl_add_u32 v4, v9, 3, v4
    v_lshrrev_b32 v9, 5, v1
    v_lshl_add_u32 v4, v9, 8, v4
    v_add_u32 v4, 159744, v4
    ds_read_b64_tr_b16 v[168:169], v4
    ds_read_b64_tr_b16 v[170:171], v4 offset:512
    ds_read_b64_tr_b16 v[172:173], v4 offset:1024
    ds_read_b64_tr_b16 v[174:175], v4 offset:1536
    ds_read_b64_tr_b16 v[176:177], v4 offset:2048
    ds_read_b64_tr_b16 v[178:179], v4 offset:2560
    ds_read_b64_tr_b16 v[180:181], v4 offset:3072
    ds_read_b64_tr_b16 v[182:183], v4 offset:3584
    s_lshl_b32 s14, s77, 10
    v_and_b32 v232, 7, v1
    v_lshl_add_u32 v232, v232, 4, s14
    v_bfe_u32 v9, v1, 3, 2
    v_lshl_add_u32 v232, v9, 8, v232
    v_lshrrev_b32 v9, 5, v1
    v_lshl_add_u32 v232, v9, 7, v232
    s_and_b32 s96, s9, 1
    s_lshl1_add_u32 s18, s96, 1
    s_and_b32 s96, s8, 3
    s_lshl2_add_u32 s97, s96, s3
    s_sub_u32 s98, s97, 4
    s_lshl_b32 s82, s98, 7
    v_lshrrev_b32 v136, 3, v1
    v_lshl_add_u32 v136, v136, 1, s82
    global_load_ushort v120, v136, s[86:87] offset:0
    global_load_ushort v121, v136, s[86:87] offset:16
    global_load_ushort v122, v136, s[86:87] offset:32
    global_load_ushort v123, v136, s[86:87] offset:48
    global_load_ushort v124, v136, s[86:87] offset:64
    global_load_ushort v125, v136, s[86:87] offset:80
    global_load_ushort v126, v136, s[86:87] offset:96
    global_load_ushort v127, v136, s[86:87] offset:112
    s_and_b32 s96, s8, 3
    s_lshl2_add_u32 s97, s96, s3
    s_sub_u32 s98, s97, 4
    s_mul_i32 s99, s98, 786432
    s_lshr_b32 s96, s8, 2
    s_lshl1_add_u32 s97, s9, s96
    s_lshl_b32 s98, s97, 7
    s_add_u32 s96, s99, s98
    s_add_u32 s19, s96, 4096
    s_waitcnt vmcnt(14)
    s_barrier
    s_add_u32 s96, s84, 6
    s_and_b32 s97, s96, 15
    s_mul_i32 s98, s97, 393216
    s_add_u32 s99, s98, s85
    s_add_u32 s82, s99, 4294772736
    s_add_u32 m0, s83, 4294963200
    s_nop 0
    buffer_load_dwordx4 v3, s[40:43], s82 offen lds
    s_add_u32 s96, s84, 6
    s_and_b32 s97, s96, 15
    s_mul_i32 s98, s97, 393216
    s_add_u32 s99, s98, s85
    s_add_u32 s82, s99, 2048
    s_mov_b32 m0, s83
    s_nop 0
    buffer_load_dwordx4 v3, s[40:43], s82 offen lds
    s_add_u32 s96, s84, 6
    s_and_b32 s97, s96, 15
    s_mul_i32 s98, s97, 393216
    s_add_u32 s99, s98, s85
    s_add_u32 s82, s99, 4294770688
    s_add_u32 m0, s83, 94208
    s_nop 0
    buffer_load_dwordx4 v3, s[40:43], s82 offen lds
    s_add_u32 s96, s84, 6
    s_and_b32 s97, s96, 15
    s_mul_i32 s98, s97, 393216
    s_add_u32 s82, s98, s85
    s_add_u32 m0, s83, 98304
    s_nop 0
    buffer_load_dwordx4 v3, s[40:43], s82 offen lds
    s_add_u32 s96, s84, 6
    s_and_b32 s97, s96, 15
    s_mul_i32 s98, s97, 393216
    s_add_u32 s99, s98, s85
    s_add_u32 s82, s99, 4294774784
    s_add_u32 m0, s83, 45056
    s_nop 0
    buffer_load_dwordx4 v3, s[40:43], s82 offen lds
    s_add_u32 s96, s84, 6
    s_and_b32 s97, s96, 15
    s_mul_i32 s98, s97, 393216
    s_add_u32 s99, s98, s85
    s_add_u32 s82, s99, 4096
    s_add_u32 m0, s83, 49152
    s_nop 0
    buffer_load_dwordx4 v3, s[40:43], s82 offen lds
    s_cmp_lg_u32 s18, 1
    s_cbranch_scc1 L_NM2_1
    s_mov_b32 s82, s19
    buffer_load_dwordx4 v[88:91], v248, s[48:51], s82 offen nt
    s_add_u32 s82, s19, 98304
    buffer_load_dwordx4 v[92:95], v248, s[48:51], s82 offen nt
    s_add_u32 s82, s19, 196608
    buffer_load_dwordx4 v[96:99], v248, s[48:51], s82 offen nt
    s_add_u32 s82, s19, 294912
    buffer_load_dwordx4 v[100:103], v248, s[48:51], s82 offen nt
    s_add_u32 s82, s19, 393216
    buffer_load_dwordx4 v[104:107], v248, s[48:51], s82 offen nt
    s_add_u32 s82, s19, 491520
    buffer_load_dwordx4 v[108:111], v248, s[48:51], s82 offen nt
    s_add_u32 s82, s19, 589824
    buffer_load_dwordx4 v[112:115], v248, s[48:51], s82 offen nt
    s_add_u32 s82, s19, 688128
    buffer_load_dwordx4 v[116:119], v248, s[48:51], s82 offen nt
L_NM2_1:
    s_waitcnt lgkmcnt(0)
    s_load_dword s24, s[32:33], s92 offset:512 glc
    s_load_dword s25, s[32:33], s92 offset:256 glc
    s_load_dword s26, s[32:33], s92 offset:3584 glc
    s_load_dword s27, s[32:33], s92 offset:3328 glc
    s_barrier
    s_add_u32 s96, s84, 7
    s_and_b32 s97, s96, 15
    s_mul_i32 s98, s97, 393216
    s_add_u32 s99, s98, s85
    s_add_u32 s82, s99, 4294772736
    s_add_u32 m0, s83, 4096
    s_nop 0
    buffer_load_dwordx4 v3, s[40:43], s82 offen lds
    s_add_u32 s96, s84, 7
    s_and_b32 s97, s96, 15
    s_mul_i32 s98, s97, 393216
    s_add_u32 s99, s98, s85
    s_add_u32 s82, s99, 2048
    s_add_u32 m0, s83, 8192
    s_nop 0
    buffer_load_dwordx4 v3, s[40:43], s82 offen lds
    s_add_u32 s96, s84, 7
    s_and_b32 s97, s96, 15
    s_mul_i32 s98, s97, 393216
    s_add_u32 s99, s98, s85
    s_add_u32 s82, s99, 4294770688
    s_add_u32 m0, s83, 102400
    s_nop 0
    buffer_load_dwordx4 v3, s[40:43], s82 offen lds
    s_add_u32 s96, s84, 7
    s_and_b32 s97, s96, 15
    s_mul_i32 s98, s97, 393216
    s_add_u32 s82, s98, s85
    s_add_u32 m0, s83, 106496
    s_nop 0
    buffer_load_dwordx4 v3, s[40:43], s82 offen lds
    s_add_u32 s96, s84, 7
    s_and_b32 s97, s96, 15
    s_mul_i32 s98, s97, 393216
    s_add_u32 s99, s98, s85
    s_add_u32 s82, s99, 4294774784
    s_add_u32 m0, s83, 53248
    s_nop 0
    buffer_load_dwordx4 v3, s[40:43], s82 offen lds
    s_add_u32 s96, s84, 7
    s_and_b32 s97, s96, 15
    s_mul_i32 s98, s97, 393216
    s_add_u32 s99, s98, s85
    s_add_u32 s82, s99, 4096
    s_add_u32 m0, s83, 57344
    s_nop 0
    buffer_load_dwordx4 v3, s[40:43], s82 offen lds
    s_cmp_lg_u32 s18, 2
    s_cbranch_scc1 L_NM2_2
    s_mov_b32 s82, s19
    buffer_load_dwordx4 v[88:91], v248, s[48:51], s82 offen nt
    s_add_u32 s82, s19, 98304
    buffer_load_dwordx4 v[92:95], v248, s[48:51], s82 offen nt
    s_add_u32 s82, s19, 196608
    buffer_load_dwordx4 v[96:99], v248, s[48:51], s82 offen nt
    s_add_u32 s82, s19, 294912
    buffer_load_dwordx4 v[100:103], v248, s[48:51], s82 offen nt
    s_add_u32 s82, s19, 393216
    buffer_load_dwordx4 v[104:107], v248, s[48:51], s82 offen nt
    s_add_u32 s82, s19, 491520
    buffer_load_dwordx4 v[108:111], v248, s[48:51], s82 offen nt
    s_add_u32 s82, s19, 589824
    buffer_load_dwordx4 v[112:115], v248, s[48:51], s82 offen nt
    s_add_u32 s82, s19, 688128
    buffer_load_dwordx4 v[116:119], v248, s[48:51], s82 offen nt
L_NM2_2:
    v_mov_b32 v4, -1
    v_mov_b32 v5, -1
    v_mov_b32 v6, -1
    v_mov_b32 v7, -1
    s_lshl3_add_u32 s96, s21, s3
    s_lshl4_add_u32 s97, s96, s12
    s_lshl_b32 s98, s97, 8
    s_add_u32 s14, s98, 12582912
    v_lshlrev_b32 v8, 2, v1
    buffer_store_dword v4, v8, s[32:35], s14 offen sc1
    s_lshl3_add_u32 s96, s21, s3
    s_sub_u32 s97, s96, 4
    s_lshl4_add_u32 s98, s97, s12
    s_lshl_b32 s99, s98, 8
    s_add_u32 s14, s99, 12582912
    v_lshlrev_b32 v8, 2, v1
    buffer_store_dword v4, v8, s[32:35], s14 offen sc1
    s_lshl_b32 s96, s21, 14
    s_lshl_b32 s97, s12, 9
    s_add_u32 s98, s96, s97
    s_add_u32 s14, s98, 13631488
    v_and_b32 v8, 31, v1
    v_lshlrev_b32 v8, 4, v8
    v_lshrrev_b32 v9, 5, v1
    v_lshl_add_u32 v8, v9, 13, v8
    s_cmp_lg_u32 s3, 5
    s_cbranch_scc1 L_NOPO
    buffer_store_dwordx4 v[4:7], v8, s[32:35], s14 offen sc1
L_NOPO:
    s_barrier
    s_add_u32 s96, s84, 8
    s_and_b32 s97, s96, 15
    s_mul_i32 s98, s97, 393216
    s_add_u32 s99, s98, s85
    s_add_u32 s82, s99, 4294772736
    s_add_u32 m0, s83, 12288
    s_nop 0
    buffer_load_dwordx4 v3, s[40:43], s82 offen lds
    s_add_u32 s96, s84, 8
    s_and_b32 s97, s96, 15
    s_mul_i32 s98, s97, 393216
    s_add_u32 s99, s98, s85
    s_add_u32 s82, s99, 2048
    s_add_u32 m0, s83, 16384
    s_nop 0
    buffer_load_dwordx4 v3, s[40:43], s82 offen lds
    s_add_u32 s96, s84, 8
    s_and_b32 s97, s96, 15
    s_mul_i32 s98, s97, 393216
    s_add_u32 s99, s98, s85
    s_add_u32 s82, s99, 4294770688
    s_add_u32 m0, s83, 110592
    s_nop 0
    buffer_load_dwordx4 v3, s[40:43], s82 offen lds
    s_add_u32 s96, s84, 8
    s_and_b32 s97, s96, 15
    s_mul_i32 s98, s97, 393216
    s_add_u32 s82, s98, s85
    s_add_u32 m0, s83, 114688
    s_nop 0
    buffer_load_dwordx4 v3, s[40:43], s82 offen lds
    s_add_u32 s96, s84, 8
    s_and_b32 s97, s96, 15
    s_mul_i32 s98, s97, 393216
    s_add_u32 s99, s98, s85
    s_add_u32 s82, s99, 4294774784
    s_add_u32 m0, s83, 61440
    s_nop 0
    buffer_load_dwordx4 v3, s[40:43], s82 offen lds
    s_add_u32 s96, s84, 8
    s_and_b32 s97, s96, 15
    s_mul_i32 s98, s97, 393216
    s_add_u32 s99, s98, s85
    s_add_u32 s82, s99, 4096
    s_add_u32 m0, s83, 65536
    s_nop 0
    buffer_load_dwordx4 v3, s[40:43], s82 offen lds
    s_cmp_lg_u32 s18, 3
    s_cbranch_scc1 L_NM2_3
    s_mov_b32 s82, s19
    buffer_load_dwordx4 v[88:91], v248, s[48:51], s82 offen nt
    s_add_u32 s82, s19, 98304
    buffer_load_dwordx4 v[92:95], v248, s[48:51], s82 offen nt
    s_add_u32 s82, s19, 196608
    buffer_load_dwordx4 v[96:99], v248, s[48:51], s82 offen nt
    s_add_u32 s82, s19, 294912
    buffer_load_dwordx4 v[100:103], v248, s[48:51], s82 offen nt
    s_add_u32 s82, s19, 393216
    buffer_load_dwordx4 v[104:107], v248, s[48:51], s82 offen nt
    s_add_u32 s82, s19, 491520
    buffer_load_dwordx4 v[108:111], v248, s[48:51], s82 offen nt
    s_add_u32 s82, s19, 589824
    buffer_load_dwordx4 v[112:115], v248, s[48:51], s82 offen nt
    s_add_u32 s82, s19, 688128
    buffer_load_dwordx4 v[116:119], v248, s[48:51], s82 offen nt
L_NM2_3:
    s_waitcnt vmcnt(20)
    v_lshlrev_b32 v120, 16, v120
    v_mul_f32 v136, s7, v120
    v_exp_f32 v136, -v136
    s_nop 0
    v_add_f32 v136, 1.0, v136
    v_rcp_f32 v136, v136
    s_nop 0
    v_mul_f32 v120, v120, v136
    v_cvt_pk_bf16_f32 v120, 0, v120
    v_lshlrev_b32 v121, 16, v121
    v_mul_f32 v137, s7, v121
    v_exp_f32 v137, -v137
    s_nop 0
    v_add_f32 v137, 1.0, v137
    v_rcp_f32 v137, v137
    s_nop 0
    v_mul_f32 v121, v121, v137
    v_cvt_pk_bf16_f32 v121, 0, v121
    v_lshlrev_b32 v122, 16, v122
    v_mul_f32 v136, s7, v122
    v_exp_f32 v136, -v136
    s_nop 0
    v_add_f32 v136, 1.0, v136
    v_rcp_f32 v136, v136
    s_nop 0
    v_mul_f32 v122, v122, v136
    v_cvt_pk_bf16_f32 v122, 0, v122
    v_lshlrev_b32 v123, 16, v123
    v_mul_f32 v137, s7, v123
    v_exp_f32 v137, -v137
    s_nop 0
    v_add_f32 v137, 1.0, v137
    v_rcp_f32 v137, v137
    s_nop 0
    v_mul_f32 v123, v123, v137
    v_cvt_pk_bf16_f32 v123, 0, v123
    v_lshlrev_b32 v124, 16, v124
    v_mul_f32 v136, s7, v124
    v_exp_f32 v136, -v136
    s_nop 0
    v_add_f32 v136, 1.0, v136
    v_rcp_f32 v136, v136
    s_nop 0
    v_mul_f32 v124, v124, v136
    v_cvt_pk_bf16_f32 v124, 0, v124
    v_lshlrev_b32 v125, 16, v125
    v_mul_f32 v137, s7, v125
    v_exp_f32 v137, -v137
    s_nop 0
    v_add_f32 v137, 1.0, v137
    v_rcp_f32 v137, v137
    s_nop 0
    v_mul_f32 v125, v125, v137
    v_cvt_pk_bf16_f32 v125, 0, v125
    v_lshlrev_b32 v126, 16, v126
    v_mul_f32 v136, s7, v126
    v_exp_f32 v136, -v136
    s_nop 0
    v_add_f32 v136, 1.0, v136
    v_rcp_f32 v136, v136
    s_nop 0
    v_mul_f32 v126, v126, v136
    v_cvt_pk_bf16_f32 v126, 0, v126
    v_lshlrev_b32 v127, 16, v127
    v_mul_f32 v137, s7, v127
    v_exp_f32 v137, -v137
    s_nop 0
    v_add_f32 v137, 1.0, v137
    v_rcp_f32 v137, v137
    s_nop 0
    v_mul_f32 v127, v127, v137
    v_cvt_pk_bf16_f32 v127, 0, v127
    s_waitcnt lgkmcnt(0)
    s_load_dword s24, s[32:33], s92 offset:1024 glc
    s_load_dword s25, s[32:33], s92 offset:768 glc
    s_load_dword s26, s[32:33], s92 offset:1536 glc
    s_load_dword s27, s[32:33], s92 offset:1280 glc
    s_barrier
    s_add_u32 s96, s84, 9
    s_and_b32 s97, s96, 15
    s_mul_i32 s98, s97, 393216
    s_add_u32 s99, s98, s85
    s_add_u32 s82, s99, 4294772736
    s_add_u32 m0, s83, 20480
    s_nop 0
    buffer_load_dwordx4 v3, s[40:43], s82 offen lds
L_PAD5:
    s_cbranch_execz L_RET5
    s_add_u32 s96, s84, 9
    s_and_b32 s97, s96, 15
    s_mul_i32 s98, s97, 393216
    s_add_u32 s99, s98, s85
    s_add_u32 s82, s99, 2048
    s_add_u32 m0, s83, 24576
    s_nop 0
    buffer_load_dwordx4 v3, s[40:43], s82 offen lds
    s_add_u32 s96, s84, 9
    s_and_b32 s97, s96, 15
    s_mul_i32 s98, s97, 393216
    s_add_u32 s99, s98, s85
    s_add_u32 s82, s99, 4294770688
    s_add_u32 m0, s83, 118784
    s_nop 0
    buffer_load_dwordx4 v3, s[40:43], s82 offen lds
    s_add_u32 s96, s84, 9
    s_and_b32 s97, s96, 15
    s_mul_i32 s98, s97, 393216
    s_add_u32 s82, s98, s85
    s_add_u32 m0, s83, 122880
    s_nop 0
    buffer_load_dwordx4 v3, s[40:43], s82 offen lds
    s_add_u32 s96, s84, 9
    s_and_b32 s97, s96, 15
    s_mul_i32 s98, s97, 393216
    s_add_u32 s99, s98, s85
    s_add_u32 s82, s99, 4294774784
    s_add_u32 m0, s83, 69632
    s_nop 0
    buffer_load_dwordx4 v3, s[40:43], s82 offen lds
    s_add_u32 s96, s84, 9
    s_and_b32 s97, s96, 15
    s_mul_i32 s98, s97, 393216
    s_add_u32 s99, s98, s85
    s_add_u32 s82, s99, 4096
    s_add_u32 m0, s83, 73728
    s_nop 0
    buffer_load_dwordx4 v3, s[40:43], s82 offen lds
    s_waitcnt vmcnt(24)
    s_waitcnt vmcnt(22)
    s_waitcnt vmcnt(20)
    s_barrier
    s_add_u32 s96, s84, 10
    s_and_b32 s97, s96, 15
    s_mul_i32 s98, s97, 393216
    s_add_u32 s99, s98, s85
    s_add_u32 s82, s99, 4294772736
    s_add_u32 m0, s83, 28672
    s_nop 0
    buffer_load_dwordx4 v3, s[40:43], s82 offen lds
    s_add_u32 s96, s84, 10
    s_and_b32 s97, s96, 15
    s_mul_i32 s98, s97, 393216
    s_add_u32 s99, s98, s85
    s_add_u32 s82, s99, 2048
    s_add_u32 m0, s83, 32768
    s_nop 0
    buffer_load_dwordx4 v3, s[40:43], s82 offen lds
    s_add_u32 s96, s84, 10
    s_and_b32 s97, s96, 15
    s_mul_i32 s98, s97, 393216
    s_add_u32 s99, s98, s85
    s_add_u32 s82, s99, 4294774784
    s_add_u32 m0, s83, 77824
    s_nop 0
    buffer_load_dwordx4 v3, s[40:43], s82 offen lds
    s_add_u32 s96, s84, 10
    s_and_b32 s97, s96, 15
    s_mul_i32 s98, s97, 393216
    s_add_u32 s99, s98, s85
    s_add_u32 s82, s99, 4096
    s_add_u32 m0, s83, 81920
    s_nop 0
    buffer_load_dwordx4 v3, s[40:43], s82 offen lds
    s_waitcnt vmcnt(8)
    v_lshlrev_b32 v136, 16, v88
    v_and_b32 v137, s6, v88
    v_mul_f32 v128, v136, v120
    v_mul_f32 v129, v137, v120
    v_lshlrev_b32 v138, 16, v89
    v_and_b32 v139, s6, v89
    v_mul_f32 v130, v138, v120
    v_mul_f32 v131, v139, v120
    v_lshlrev_b32 v136, 16, v90
    v_and_b32 v137, s6, v90
    v_mul_f32 v132, v136, v120
    v_mul_f32 v133, v137, v120
    v_lshlrev_b32 v138, 16, v91
    v_and_b32 v139, s6, v91
    v_mul_f32 v134, v138, v120
    v_mul_f32 v135, v139, v120
    v_lshlrev_b32 v136, 16, v92
    v_and_b32 v137, s6, v92
    v_fmac_f32 v128, v136, v121
    v_fmac_f32 v129, v137, v121
    v_lshlrev_b32 v138, 16, v93
    v_and_b32 v139, s6, v93
    v_fmac_f32 v130, v138, v121
    v_fmac_f32 v131, v139, v121
    v_lshlrev_b32 v136, 16, v94
    v_and_b32 v137, s6, v94
    v_fmac_f32 v132, v136, v121
    v_fmac_f32 v133, v137, v121
    v_lshlrev_b32 v138, 16, v95
    v_and_b32 v139, s6, v95
    v_fmac_f32 v134, v138, v121
    v_fmac_f32 v135, v139, v121
    v_lshlrev_b32 v136, 16, v96
    v_and_b32 v137, s6, v96
    v_fmac_f32 v128, v136, v122
    v_fmac_f32 v129, v137, v122
    v_lshlrev_b32 v138, 16, v97
    v_and_b32 v139, s6, v97
    v_fmac_f32 v130, v138, v122
    v_fmac_f32 v131, v139, v122
    v_lshlrev_b32 v136, 16, v98
    v_and_b32 v137, s6, v98
    v_fmac_f32 v132, v136, v122
    v_fmac_f32 v133, v137, v122
    v_lshlrev_b32 v138, 16, v99
    v_and_b32 v139, s6, v99
    v_fmac_f32 v134, v138, v122
    v_fmac_f32 v135, v139, v122
    s_waitcnt lgkmcnt(0)
    s_load_dword s24, s[32:33], s92 offset:2560 glc
    s_load_dword s25, s[32:33], s92 offset:2304 glc
    s_load_dword s26, s[32:33], s92 offset:3072 glc
    s_load_dword s27, s[32:33], s92 offset:2816 glc
    s_barrier
    s_add_u32 s96, s84, 11
    s_and_b32 s97, s96, 15
    s_mul_i32 s98, s97, 393216
    s_add_u32 s99, s98, s85
    s_add_u32 s82, s99, 4294772736
    s_add_u32 m0, s83, 36864
    s_nop 0
    buffer_load_dwordx4 v3, s[40:43], s82 offen lds
    s_add_u32 s96, s84, 11
    s_and_b32 s97, s96, 15
    s_mul_i32 s98, s97, 393216
    s_add_u32 s99, s98, s85
    s_add_u32 s82, s99, 2048
    s_add_u32 m0, s83, 40960
    s_nop 0
    buffer_load_dwordx4 v3, s[40:43], s82 offen lds
    s_add_u32 s96, s84, 11
    s_and_b32 s97, s96, 15
    s_mul_i32 s98, s97, 393216
    s_add_u32 s99, s98, s85
    s_add_u32 s82, s99, 4294774784
    s_add_u32 m0, s83, 86016
    s_nop 0
    buffer_load_dwordx4 v3, s[40:43], s82 offen lds
    s_add_u32 s96, s84, 11
    s_and_b32 s97, s96, 15
    s_mul_i32 s98, s97, 393216
    s_add_u32 s99, s98, s85
    s_add_u32 s82, s99, 4096
    s_add_u32 m0, s83, 90112
    s_nop 0
    buffer_load_dwordx4 v3, s[40:43], s82 offen lds
    v_lshlrev_b32 v136, 16, v100
    v_and_b32 v137, s6, v100
    v_fmac_f32 v128, v136, v123
    v_fmac_f32 v129, v137, v123
    v_lshlrev_b32 v138, 16, v101
    v_and_b32 v139, s6, v101
    v_fmac_f32 v130, v138, v123
    v_fmac_f32 v131, v139, v123
    v_lshlrev_b32 v136, 16, v102
    v_and_b32 v137, s6, v102
    v_fmac_f32 v132, v136, v123
    v_fmac_f32 v133, v137, v123
    v_lshlrev_b32 v138, 16, v103
    v_and_b32 v139, s6, v103
    v_fmac_f32 v134, v138, v123
    v_fmac_f32 v135, v139, v123
    v_lshlrev_b32 v136, 16, v104
    v_and_b32 v137, s6, v104
    v_fmac_f32 v128, v136, v124
    v_fmac_f32 v129, v137, v124
    v_lshlrev_b32 v138, 16, v105
    v_and_b32 v139, s6, v105
    v_fmac_f32 v130, v138, v124
    v_fmac_f32 v131, v139, v124
    v_lshlrev_b32 v136, 16, v106
    v_and_b32 v137, s6, v106
    v_fmac_f32 v132, v136, v124
    v_fmac_f32 v133, v137, v124
    v_lshlrev_b32 v138, 16, v107
    v_and_b32 v139, s6, v107
    v_fmac_f32 v134, v138, v124
    v_fmac_f32 v135, v139, v124
    v_lshlrev_b32 v136, 16, v108
    v_and_b32 v137, s6, v108
    v_fmac_f32 v128, v136, v125
    v_fmac_f32 v129, v137, v125
    v_lshlrev_b32 v138, 16, v109
    v_and_b32 v139, s6, v109
    v_fmac_f32 v130, v138, v125
    v_fmac_f32 v131, v139, v125
    v_lshlrev_b32 v136, 16, v110
    v_and_b32 v137, s6, v110
    v_fmac_f32 v132, v136, v125
    v_fmac_f32 v133, v137, v125
    v_lshlrev_b32 v138, 16, v111
    v_and_b32 v139, s6, v111
    v_fmac_f32 v134, v138, v125
    v_fmac_f32 v135, v139, v125
    s_barrier
    s_add_u32 s96, s84, 12
    s_and_b32 s97, s96, 15
    s_mul_i32 s98, s97, 393216
    s_add_u32 s99, s98, s85
    s_add_u32 s82, s99, 4294772736
    s_add_u32 m0, s83, 4294963200
    s_nop 0
    buffer_load_dwordx4 v3, s[40:43], s82 offen lds
    s_add_u32 s96, s84, 12
    s_and_b32 s97, s96, 15
    s_mul_i32 s98, s97, 393216
    s_add_u32 s99, s98, s85
    s_add_u32 s82, s99, 2048
    s_mov_b32 m0, s83
    s_nop 0
    buffer_load_dwordx4 v3, s[40:43], s82 offen lds
    s_add_u32 s96, s84, 12
    s_and_b32 s97, s96, 15
    s_mul_i32 s98, s97, 393216
    s_add_u32 s99, s98, s85
    s_add_u32 s82, s99, 4294774784
    s_add_u32 m0, s83, 45056
    s_nop 0
    buffer_load_dwordx4 v3, s[40:43], s82 offen lds
    s_add_u32 s96, s84, 12
    s_and_b32 s97, s96, 15
    s_mul_i32 s98, s97, 393216
    s_add_u32 s99, s98, s85
    s_add_u32 s82, s99, 4096
    s_add_u32 m0, s83, 49152
    s_nop 0
    buffer_load_dwordx4 v3, s[40:43], s82 offen lds
    v_lshlrev_b32 v136, 16, v112
    v_and_b32 v137, s6, v112
    v_fmac_f32 v128, v136, v126
    v_fmac_f32 v129, v137, v126
    v_lshlrev_b32 v138, 16, v113
    v_and_b32 v139, s6, v113
    v_fmac_f32 v130, v138, v126
    v_fmac_f32 v131, v139, v126
    v_lshlrev_b32 v136, 16, v114
    v_and_b32 v137, s6, v114
    v_fmac_f32 v132, v136, v126
    v_fmac_f32 v133, v137, v126
    v_lshlrev_b32 v138, 16, v115
    v_and_b32 v139, s6, v115
    v_fmac_f32 v134, v138, v126
    v_fmac_f32 v135, v139, v126
    v_lshlrev_b32 v136, 16, v116
    v_and_b32 v137, s6, v116
    v_fmac_f32 v128, v136, v127
    v_fmac_f32 v129, v137, v127
    v_lshlrev_b32 v138, 16, v117
    v_and_b32 v139, s6, v117
    v_fmac_f32 v130, v138, v127
    v_fmac_f32 v131, v139, v127
    v_lshlrev_b32 v136, 16, v118
    v_and_b32 v137, s6, v118
    v_fmac_f32 v132, v136, v127
    v_fmac_f32 v133, v137, v127
    v_lshlrev_b32 v138, 16, v119
    v_and_b32 v139, s6, v119
    v_fmac_f32 v134, v138, v127
    v_fmac_f32 v135, v139, v127
    v_permlane32_swap_b32 v128, v132
    v_permlane32_swap_b32 v129, v133
    v_permlane32_swap_b32 v130, v134
    v_permlane32_swap_b32 v131, v135
    v_add_f32 v128, v128, v132
    v_add_f32 v129, v129, v133
    v_add_f32 v130, v130, v134
    v_add_f32 v131, v131, v135
    s_nop 0
    v_permlane16_swap_b32 v128, v130
    v_permlane16_swap_b32 v129, v131
    v_add_f32 v128, v128, v130
    v_add_f32 v129, v129, v131
    s_nop 0
    v_add_f32_dpp v128, v128, v128 row_ror:8 row_mask:0xf bank_mask:0xf
    v_add_f32_dpp v129, v129, v129 row_ror:8 row_mask:0xf bank_mask:0xf
    s_nop 1
    v_mov_b32_dpp v128, v129 quad_perm:[0,1,2,3] row_mask:0xf bank_mask:0xc
    ds_write_b32 v252, v128 offset:9984
    s_waitcnt lgkmcnt(0)
    s_barrier
    s_add_u32 s96, s84, 13
    s_and_b32 s97, s96, 15
    s_mul_i32 s98, s97, 393216
    s_add_u32 s99, s98, s85
    s_add_u32 s82, s99, 4294772736
    s_add_u32 m0, s83, 4096
    s_nop 0
    buffer_load_dwordx4 v3, s[40:43], s82 offen lds
    s_add_u32 s96, s84, 13
    s_and_b32 s97, s96, 15
    s_mul_i32 s98, s97, 393216
    s_add_u32 s99, s98, s85
    s_add_u32 s82, s99, 2048
    s_add_u32 m0, s83, 8192
    s_nop 0
    buffer_load_dwordx4 v3, s[40:43], s82 offen lds
    s_add_u32 s96, s84, 13
    s_and_b32 s97, s96, 15
    s_mul_i32 s98, s97, 393216
    s_add_u32 s99, s98, s85
    s_add_u32 s82, s99, 4294774784
    s_add_u32 m0, s83, 53248
    s_nop 0
    buffer_load_dwordx4 v3, s[40:43], s82 offen lds
    s_add_u32 s96, s84, 13
    s_and_b32 s97, s96, 15
    s_mul_i32 s98, s97, 393216
    s_add_u32 s99, s98, s85
    s_add_u32 s82, s99, 4096
    s_add_u32 m0, s83, 57344
    s_nop 0
    buffer_load_dwordx4 v3, s[40:43], s82 offen lds
    s_cmp_lg_u32 s3, 4
    s_cbranch_scc1 L_M2F
    ds_read_b128 v[128:131], v251 offset:10000
    s_lshr_b32 s96, s8, 2
    s_lshl1_add_u32 s97, s9, s96
    s_and_b32 s98, s8, 3
    s_lshl2_add_u32 s99, s97, s98
    s_lshl_b32 s96, s99, 9
    s_add_u32 s13, s96, 131072
    s_waitcnt lgkmcnt(0)
    v_add_f32 v128, v128, v129
    v_add_f32 v130, v130, v131
    v_mov_b32 v129, s4
    v_add_f32 v128, v128, v130
    buffer_store_dwordx2 v[128:129], v250, s[32:35], s13 offen sc1
L_M2F:
    s_lshl_b32 s96, s74, 13
    s_sub_u32 s97, s3, 4
    s_lshl_b32 s98, s97, 8
    s_add_u32 s99, s96, s98
    s_add_u32 s13, s99, 20971520
    s_waitcnt lgkmcnt(0)
    s_load_dword s24, s[32:33], s13 offset:1276 glc
    s_load_dword s25, s[32:33], s13 offset:3324 glc
    s_load_dword s26, s[32:33], s13 offset:5372 glc
    s_load_dword s27, s[32:33], s13 offset:7420 glc
    s_waitcnt vmcnt(18)
    s_waitcnt vmcnt(16)
    s_barrier
    s_add_u32 s96, s84, 14
    s_and_b32 s97, s96, 15
    s_mul_i32 s98, s97, 393216
    s_add_u32 s99, s98, s85
    s_add_u32 s82, s99, 4294772736
    s_add_u32 m0, s83, 12288
    s_nop 0
    buffer_load_dwordx4 v3, s[40:43], s82 offen lds
    s_add_u32 s96, s84, 14
    s_and_b32 s97, s96, 15
    s_mul_i32 s98, s97, 393216
    s_add_u32 s99, s98, s85
    s_add_u32 s82, s99, 2048
    s_add_u32 m0, s83, 16384
    s_nop 0
    buffer_load_dwordx4 v3, s[40:43], s82 offen lds
    s_waitcnt vmcnt(16)
    s_waitcnt vmcnt(12)
    s_barrier
    s_add_u32 s96, s84, 15
    s_and_b32 s97, s96, 15
    s_mul_i32 s98, s97, 393216
    s_add_u32 s99, s98, s85
    s_add_u32 s82, s99, 4294772736
    s_add_u32 m0, s83, 20480
    s_nop 0
    buffer_load_dwordx4 v3, s[40:43], s82 offen lds
    s_add_u32 s96, s84, 15
    s_and_b32 s97, s96, 15
    s_mul_i32 s98, s97, 393216
    s_add_u32 s99, s98, s85
    s_add_u32 s82, s99, 2048
    s_add_u32 m0, s83, 24576
    s_nop 0
    buffer_load_dwordx4 v3, s[40:43], s82 offen lds
    s_waitcnt vmcnt(10)
    s_waitcnt vmcnt(6)
    s_waitcnt vmcnt(2)
    s_barrier
    s_add_u32 s96, s84, 14
    s_and_b32 s97, s96, 15
    s_mul_i32 s98, s97, 393216
    s_add_u32 s99, s98, s85
    s_add_u32 s82, s99, 4294774784
    s_add_u32 m0, s83, 61440
    s_nop 0
    buffer_load_dwordx4 v3, s[40:43], s82 offen lds
    s_add_u32 s96, s84, 14
    s_and_b32 s97, s96, 15
    s_mul_i32 s98, s97, 393216
    s_add_u32 s99, s98, s85
    s_add_u32 s82, s99, 4096
    s_add_u32 m0, s83, 65536
    s_nop 0
    buffer_load_dwordx4 v3, s[40:43], s82 offen lds
    s_add_u32 s96, s84, 15
    s_and_b32 s97, s96, 15
    s_mul_i32 s98, s97, 393216
    s_add_u32 s99, s98, s85
    s_add_u32 s82, s99, 4294774784
    s_add_u32 m0, s83, 69632
    s_nop 0
    buffer_load_dwordx4 v3, s[40:43], s82 offen lds
    s_add_u32 s96, s84, 15
    s_and_b32 s97, s96, 15
    s_mul_i32 s98, s97, 393216
    s_add_u32 s99, s98, s85
    s_add_u32 s82, s99, 4096
    s_add_u32 m0, s83, 73728
    s_nop 0
    buffer_load_dwordx4 v3, s[40:43], s82 offen lds
    s_waitcnt vmcnt(4)
    s_barrier
    s_add_u32 s96, s84, 10
    s_and_b32 s97, s96, 15
    s_mul_i32 s98, s97, 393216
    s_add_u32 s99, s98, s85
    s_add_u32 s82, s99, 4294770688
    s_add_u32 m0, s83, 126976
    s_nop 0
    buffer_load_dwordx4 v3, s[40:43], s82 offen lds
    s_add_u32 s96, s84, 10
    s_and_b32 s97, s96, 15
    s_mul_i32 s98, s97, 393216
    s_add_u32 s82, s98, s85
    s_add_u32 m0, s83, 131072
    s_nop 0
    buffer_load_dwordx4 v3, s[40:43], s82 offen lds
    s_add_u32 s96, s84, 11
    s_and_b32 s97, s96, 15
    s_mul_i32 s98, s97, 393216
    s_add_u32 s99, s98, s85
    s_add_u32 s82, s99, 4294770688
    s_add_u32 m0, s83, 135168
    s_nop 0
    buffer_load_dwordx4 v3, s[40:43], s82 offen lds
    s_add_u32 s96, s84, 11
    s_and_b32 s97, s96, 15
    s_mul_i32 s98, s97, 393216
    s_add_u32 s82, s98, s85
    s_add_u32 m0, s83, 139264
    s_nop 0
    buffer_load_dwordx4 v3, s[40:43], s82 offen lds
    s_waitcnt lgkmcnt(0)
    s_barrier
    s_add_u32 s96, s84, 12
    s_and_b32 s97, s96, 15
    s_mul_i32 s98, s97, 393216
    s_add_u32 s99, s98, s85
    s_add_u32 s82, s99, 4294770688
    s_add_u32 m0, s83, 94208
    s_nop 0
    buffer_load_dwordx4 v3, s[40:43], s82 offen lds
    s_add_u32 s96, s84, 12
    s_and_b32 s97, s96, 15
    s_mul_i32 s98, s97, 393216
    s_add_u32 s82, s98, s85
    s_add_u32 m0, s83, 98304
    s_nop 0
    buffer_load_dwordx4 v3, s[40:43], s82 offen lds
    s_add_u32 s96, s84, 13
    s_and_b32 s97, s96, 15
    s_mul_i32 s98, s97, 393216
    s_add_u32 s99, s98, s85
    s_add_u32 s82, s99, 4294770688
    s_add_u32 m0, s83, 102400
    s_nop 0
    buffer_load_dwordx4 v3, s[40:43], s82 offen lds
    s_add_u32 s96, s84, 13
    s_and_b32 s97, s96, 15
    s_mul_i32 s98, s97, 393216
    s_add_u32 s82, s98, s85
    s_add_u32 m0, s83, 106496
    s_nop 0
    buffer_load_dwordx4 v3, s[40:43], s82 offen lds
    s_setprio 3
    ds_read_b128 v[152:155], v0
    ds_read_b128 v[156:159], v0 offset:1024
    v_subrev_u32 v0, 118784, v0
    s_waitcnt lgkmcnt(1)
    v_mfma_f32_32x32x16_bf16 v[184:199], v[168:171], v[152:155], 0
    s_waitcnt lgkmcnt(0)
    v_mfma_f32_32x32x16_bf16 v[184:199], v[172:175], v[156:159], v[184:199]
    s_setprio 0
    s_nop 10
    v_cvt_pk_bf16_f32 v184, 0, v184
    v_cvt_pk_bf16_f32 v185, 0, v185
    v_cvt_pk_bf16_f32 v186, 0, v186
    v_cvt_pk_bf16_f32 v187, 0, v187
    v_cvt_pk_bf16_f32 v188, 0, v188
    v_cvt_pk_bf16_f32 v189, 0, v189
    v_cvt_pk_bf16_f32 v190, 0, v190
    v_cvt_pk_bf16_f32 v191, 0, v191
    v_cvt_pk_bf16_f32 v192, 0, v192
    v_cvt_pk_bf16_f32 v193, 0, v193
    v_cvt_pk_bf16_f32 v194, 0, v194
    v_cvt_pk_bf16_f32 v195, 0, v195
    v_cvt_pk_bf16_f32 v196, 0, v196
    v_cvt_pk_bf16_f32 v197, 0, v197
    v_cvt_pk_bf16_f32 v198, 0, v198
    v_cvt_pk_bf16_f32 v199, 0, v199
    v_max3_f32 v4, v184, v185, v186
    v_min3_f32 v5, v184, v185, v186
    v_max3_f32 v4, v4, v187, v188
    v_min3_f32 v5, v5, v187, v188
    v_max3_f32 v4, v4, v189, v190
    v_min3_f32 v5, v5, v189, v190
    v_max3_f32 v4, v4, v191, v192
    v_min3_f32 v5, v5, v191, v192
    v_max3_f32 v4, v4, v193, v194
    v_min3_f32 v5, v5, v193, v194
    v_max3_f32 v4, v4, v195, v196
    v_min3_f32 v5, v5, v195, v196
    v_max3_f32 v4, v4, v197, v198
    v_min3_f32 v5, v5, v197, v198
    v_max_f32 v6, v4, v199
    v_min_f32 v7, v5, v199
    v_max_f32 v4, v4, v199
    v_min_f32 v5, v5, v199
    s_nop 0
    v_permlane32_swap_b32 v4, v6
    v_permlane32_swap_b32 v5, v7
    v_max_f32 v4, v4, v6
    v_min_f32 v5, v5, v7
    v_mul_f32_e64 v4, v4, s7
    v_mul_f32_e64 v5, v5, s7
    v_fma_f32 v216, v184, s7, -v4
    v_fma_f32 v217, v185, s7, -v4
    v_fma_f32 v184, -v184, s7, v5
    v_fma_f32 v185, -v185, s7, v5
    v_fma_f32 v218, v186, s7, -v4
    v_fma_f32 v219, v187, s7, -v4
    v_fma_f32 v186, -v186, s7, v5
    v_fma_f32 v187, -v187, s7, v5
    s_waitcnt vmcnt(10)
    s_waitcnt vmcnt(8)
    s_waitcnt vmcnt(6)
    s_barrier
    s_add_u32 s96, s84, 14
    s_and_b32 s97, s96, 15
    s_mul_i32 s98, s97, 393216
    s_add_u32 s99, s98, s85
    s_add_u32 s82, s99, 4294770688
    s_add_u32 m0, s83, 110592
    s_nop 0
    buffer_load_dwordx4 v3, s[40:43], s82 offen lds
    s_add_u32 s96, s84, 14
    s_and_b32 s97, s96, 15
    s_mul_i32 s98, s97, 393216
    s_add_u32 s82, s98, s85
    s_add_u32 m0, s83, 114688
    s_nop 0
    buffer_load_dwordx4 v3, s[40:43], s82 offen lds
    s_add_u32 s96, s84, 15
    s_and_b32 s97, s96, 15
    s_mul_i32 s98, s97, 393216
    s_add_u32 s99, s98, s85
    s_add_u32 s82, s99, 4294770688
    s_add_u32 m0, s83, 118784
    s_nop 0
    buffer_load_dwordx4 v3, s[40:43], s82 offen lds
    s_add_u32 s96, s84, 15
    s_and_b32 s97, s96, 15
    s_mul_i32 s98, s97, 393216
    s_add_u32 s82, s98, s85
    s_add_u32 m0, s83, 122880
    s_nop 0
    buffer_load_dwordx4 v3, s[40:43], s82 offen lds
    s_setprio 3
    ds_read_b128 v[152:155], v0
    ds_read_b128 v[156:159], v0 offset:1024
    s_waitcnt lgkmcnt(1)
    v_mfma_f32_32x32x16_bf16 v[200:215], v[176:179], v[152:155], 0
    s_waitcnt lgkmcnt(0)
    v_mfma_f32_32x32x16_bf16 v[200:215], v[180:183], v[156:159], v[200:215]
    s_setprio 0
    v_fma_f32 v220, v188, s7, -v4
    v_fma_f32 v221, v189, s7, -v4
    v_fma_f32 v188, -v188, s7, v5
    v_fma_f32 v189, -v189, s7, v5
    v_fma_f32 v222, v190, s7, -v4
    s_mov_b32 s82, s80
    buffer_load_dwordx4 v[56:59], v27, s[52:55], s82 offen nt
    v_fma_f32 v223, v191, s7, -v4
    v_fma_f32 v190, -v190, s7, v5
    v_fma_f32 v191, -v191, s7, v5
    v_fma_f32 v224, v192, s7, -v4
    v_fma_f32 v225, v193, s7, -v4
    v_fma_f32 v192, -v192, s7, v5
    v_fma_f32 v193, -v193, s7, v5
    v_fma_f32 v226, v194, s7, -v4
    v_fma_f32 v227, v195, s7, -v4
    v_fma_f32 v194, -v194, s7, v5
    v_fma_f32 v195, -v195, s7, v5
    v_fma_f32 v228, v196, s7, -v4
    v_fma_f32 v229, v197, s7, -v4
    v_fma_f32 v196, -v196, s7, v5
    v_fma_f32 v197, -v197, s7, v5
    v_fma_f32 v230, v198, s7, -v4
    v_fma_f32 v231, v199, s7, -v4
    v_fma_f32 v198, -v198, s7, v5
    v_fma_f32 v199, -v199, s7, v5
    v_exp_f32 v216, v216
    v_exp_f32 v184, v184
    v_exp_f32 v217, v217
    v_exp_f32 v185, v185
    v_exp_f32 v218, v218
    v_exp_f32 v186, v186
    v_exp_f32 v219, v219
    v_exp_f32 v187, v187
    v_exp_f32 v220, v220
    v_exp_f32 v188, v188
    v_exp_f32 v221, v221
    v_exp_f32 v189, v189
    v_exp_f32 v222, v222
    v_exp_f32 v190, v190
    v_exp_f32 v223, v223
    v_exp_f32 v191, v191
    v_exp_f32 v224, v224
    v_exp_f32 v192, v192
    v_exp_f32 v225, v225
    v_exp_f32 v193, v193
    v_exp_f32 v226, v226
    s_add_u32 s82, s80, 4294049792
    buffer_load_dwordx4 v[60:63], v27, s[52:55], s82 offen nt
    v_exp_f32 v194, v194
    v_exp_f32 v227, v227
    v_exp_f32 v195, v195
    v_exp_f32 v228, v228
    v_exp_f32 v196, v196
    v_exp_f32 v229, v229
    v_exp_f32 v197, v197
    v_exp_f32 v230, v230
    v_exp_f32 v198, v198
    v_exp_f32 v231, v231
    v_exp_f32 v199, v199
    v_add_f32 v8, v216, v218
    v_add_f32 v9, v217, v219
    v_add_f32 v10, v184, v186
    v_add_f32 v11, v185, v187
    v_add_f32 v8, v8, v220
    v_add_f32 v9, v9, v221
    v_add_f32 v10, v10, v188
    v_add_f32 v11, v11, v189
    v_add_f32 v8, v8, v222
    v_add_f32 v9, v9, v223
    v_add_f32 v10, v10, v190
    v_add_f32 v11, v11, v191
    v_add_f32 v8, v8, v224
    v_add_f32 v9, v9, v225
    v_add_f32 v10, v10, v192
    v_add_f32 v11, v11, v193
    v_add_f32 v8, v8, v226
    v_add_f32 v9, v9, v227
    v_add_f32 v10, v10, v194
    v_add_f32 v11, v11, v195
    v_add_f32 v8, v8, v228
    v_add_f32 v9, v9, v229
    v_add_f32 v10, v10, v196
    v_add_f32 v11, v11, v197
    v_add_f32 v8, v8, v230
    v_add_f32 v9, v9, v231
    v_add_f32 v10, v10, v198
    v_add_f32 v11, v11, v199
    v_add_f32 v6, v8, v9
    s_add_u32 s82, s80, 57344
    buffer_load_dwordx4 v[64:67], v27, s[52:55], s82 offen nt
    v_add_f32 v7, v10, v11
    v_add_f32 v4, v8, v9
    v_add_f32 v5, v10, v11
    s_nop 0
    v_permlane32_swap_b32 v4, v6
    v_permlane32_swap_b32 v5, v7
    v_add_f32 v4, v4, v6
    v_add_f32 v5, v5, v7
    v_rcp_f32 v4, v4
    v_rcp_f32 v5, v5
    v_mul_f32 v216, v216, v4
    v_mul_f32 v217, v217, v4
    v_mul_f32 v184, v184, v5
    v_mul_f32 v185, v185, v5
    v_mul_f32 v218, v218, v4
    v_mul_f32 v219, v219, v4
    v_mul_f32 v186, v186, v5
    v_mul_f32 v187, v187, v5
    v_mul_f32 v220, v220, v4
    v_mul_f32 v221, v221, v4
    v_mul_f32 v188, v188, v5
    v_mul_f32 v189, v189, v5
    v_mul_f32 v222, v222, v4
    v_mul_f32 v223, v223, v4
    v_mul_f32 v190, v190, v5
    v_mul_f32 v191, v191, v5
    v_mul_f32 v224, v224, v4
    v_mul_f32 v225, v225, v4
    v_mul_f32 v192, v192, v5
    v_mul_f32 v193, v193, v5
    v_mul_f32 v226, v226, v4
    v_mul_f32 v227, v227, v4
    v_mul_f32 v194, v194, v5
    v_mul_f32 v195, v195, v5
    v_mul_f32 v228, v228, v4
    v_mul_f32 v229, v229, v4
    v_mul_f32 v196, v196, v5
    v_mul_f32 v197, v197, v5
    v_mul_f32 v230, v230, v4
    v_mul_f32 v231, v231, v4
    v_mul_f32 v198, v198, v5
    s_add_u32 s82, s80, 4294107136
    buffer_load_dwordx4 v[68:71], v27, s[52:55], s82 offen nt
    v_mul_f32 v199, v199, v5
    v_cvt_pk_bf16_f32 v216, v216, v217
    v_cvt_pk_bf16_f32 v217, v218, v219
    v_cvt_pk_bf16_f32 v218, v220, v221
    v_cvt_pk_bf16_f32 v219, v222, v223
    v_cvt_pk_bf16_f32 v220, v224, v225
    v_cvt_pk_bf16_f32 v221, v226, v227
    v_cvt_pk_bf16_f32 v222, v228, v229
    v_cvt_pk_bf16_f32 v223, v230, v231
    ds_write_b128 v232, v[216:219]
    v_cvt_pk_bf16_f32 v224, v184, v185
    v_cvt_pk_bf16_f32 v225, v186, v187
    v_cvt_pk_bf16_f32 v226, v188, v189
    v_cvt_pk_bf16_f32 v227, v190, v191
    ds_write_b128 v232, v[220:223] offset:4096
    ds_write_b128 v232, v[224:227] offset:8192
    v_cvt_pk_bf16_f32 v228, v192, v193
    v_cvt_pk_bf16_f32 v229, v194, v195
    v_cvt_pk_bf16_f32 v230, v196, v197
    v_cvt_pk_bf16_f32 v231, v198, v199
    ds_write_b128 v232, v[228:231] offset:12288
    s_waitcnt vmcnt(12)
    s_waitcnt vmcnt(10)
    s_waitcnt vmcnt(8)
L_PAD6:
    s_cbranch_execz L_RET6
    s_waitcnt vmcnt(6)
    s_waitcnt vmcnt(4)
    s_barrier
    v_cvt_pk_bf16_f32 v200, 0, v200
    v_cvt_pk_bf16_f32 v201, 0, v201
    v_cvt_pk_bf16_f32 v202, 0, v202
    v_cvt_pk_bf16_f32 v203, 0, v203
    s_xor_b32 s96, s95, 786432
    s_add_u32 s97, s96, s90
    s_sub_u32 s82, s97, 65536
    s_add_u32 m0, s83, 45056
    s_nop 0
    buffer_load_dwordx4 v26, s[44:47], s82 offen lds
    v_cvt_pk_bf16_f32 v204, 0, v204
    v_cvt_pk_bf16_f32 v205, 0, v205
    v_cvt_pk_bf16_f32 v206, 0, v206
    v_cvt_pk_bf16_f32 v207, 0, v207
    v_cvt_pk_bf16_f32 v208, 0, v208
    v_cvt_pk_bf16_f32 v209, 0, v209
    v_cvt_pk_bf16_f32 v210, 0, v210
    v_cvt_pk_bf16_f32 v211, 0, v211
    v_cvt_pk_bf16_f32 v212, 0, v212
    v_cvt_pk_bf16_f32 v213, 0, v213
    v_cvt_pk_bf16_f32 v214, 0, v214
    v_cvt_pk_bf16_f32 v215, 0, v215
    v_max3_f32 v4, v200, v201, v202
    v_min3_f32 v5, v200, v201, v202
    s_xor_b32 s96, s95, 786432
    s_add_u32 s82, s96, s90
    s_add_u32 m0, s83, 49152
    s_nop 0
    buffer_load_dwordx4 v26, s[44:47], s82 offen lds
    v_max3_f32 v4, v4, v203, v204
    v_min3_f32 v5, v5, v203, v204
    v_max3_f32 v4, v4, v205, v206
    v_min3_f32 v5, v5, v205, v206
    v_max3_f32 v4, v4, v207, v208
    v_min3_f32 v5, v5, v207, v208
    v_max3_f32 v4, v4, v209, v210
    v_min3_f32 v5, v5, v209, v210
    v_max3_f32 v4, v4, v211, v212
    v_min3_f32 v5, v5, v211, v212
    v_max3_f32 v4, v4, v213, v214
    v_min3_f32 v5, v5, v213, v214
    v_max_f32 v6, v4, v215
    v_min_f32 v7, v5, v215
    s_xor_b32 s96, s95, 917504
    s_add_u32 s97, s96, s90
    s_sub_u32 s82, s97, 65536
    s_add_u32 m0, s83, 53248
    s_nop 0
    buffer_load_dwordx4 v26, s[44:47], s82 offen lds
    v_max_f32 v4, v4, v215
    s_waitcnt lgkmcnt(0)
    v_min_f32 v5, v5, v215
    v_permlane32_swap_b32 v4, v6
    s_nop 0
    v_permlane32_swap_b32 v5, v7
    v_max_f32 v4, v4, v6
    v_min_f32 v5, v5, v7
    v_mul_f32_e64 v4, v4, s7
    v_mul_f32_e64 v5, v5, s7
    v_fma_f32 v216, v200, s7, -v4
    v_fma_f32 v217, v201, s7, -v4
    v_fma_f32 v200, -v200, s7, v5
    v_fma_f32 v201, -v201, s7, v5
    v_fma_f32 v218, v202, s7, -v4
    s_xor_b32 s96, s95, 917504
    s_add_u32 s82, s96, s90
    s_add_u32 m0, s83, 57344
    s_nop 0
    buffer_load_dwordx4 v26, s[44:47], s82 offen lds
    v_fma_f32 v219, v203, s7, -v4
    v_fma_f32 v202, -v202, s7, v5
    v_fma_f32 v203, -v203, s7, v5
    v_fma_f32 v220, v204, s7, -v4
    v_fma_f32 v221, v205, s7, -v4
    v_fma_f32 v204, -v204, s7, v5
    v_fma_f32 v205, -v205, s7, v5
    v_fma_f32 v222, v206, s7, -v4
    v_fma_f32 v223, v207, s7, -v4
    v_fma_f32 v206, -v206, s7, v5
    v_fma_f32 v207, -v207, s7, v5
    v_fma_f32 v224, v208, s7, -v4
    v_fma_f32 v225, v209, s7, -v4
    v_fma_f32 v208, -v208, s7, v5
    s_xor_b32 s96, s95, 1048576
    s_add_u32 s97, s96, s90
    s_sub_u32 s82, s97, 65536
    s_add_u32 m0, s83, 61440
    s_nop 0
    buffer_load_dwordx4 v26, s[44:47], s82 offen lds
    v_fma_f32 v209, -v209, s7, v5
    v_fma_f32 v226, v210, s7, -v4
    v_fma_f32 v227, v211, s7, -v4
    v_fma_f32 v210, -v210, s7, v5
    v_fma_f32 v211, -v211, s7, v5
    v_fma_f32 v228, v212, s7, -v4
    v_fma_f32 v229, v213, s7, -v4
    v_fma_f32 v212, -v212, s7, v5
    v_fma_f32 v213, -v213, s7, v5
    v_fma_f32 v230, v214, s7, -v4
    v_fma_f32 v231, v215, s7, -v4
    v_fma_f32 v214, -v214, s7, v5
    v_fma_f32 v215, -v215, s7, v5
    v_exp_f32 v216, v216
    s_xor_b32 s96, s95, 1048576
    s_add_u32 s82, s96, s90
    s_add_u32 m0, s83, 65536
    s_nop 0
    buffer_load_dwordx4 v26, s[44:47], s82 offen lds
    v_exp_f32 v200, v200
    v_exp_f32 v217, v217
    v_exp_f32 v201, v201
    v_exp_f32 v218, v218
    v_exp_f32 v202, v202
    v_exp_f32 v219, v219
    v_exp_f32 v203, v203
    v_exp_f32 v220, v220
    v_exp_f32 v204, v204
    v_exp_f32 v221, v221
    v_exp_f32 v205, v205
    v_exp_f32 v222, v222
    v_exp_f32 v206, v206
    v_exp_f32 v223, v223
    s_xor_b32 s96, s95, 1179648
    s_add_u32 s97, s96, s90
    s_sub_u32 s82, s97, 65536
    s_add_u32 m0, s83, 69632
    s_nop 0
    buffer_load_dwordx4 v26, s[44:47], s82 offen lds
    v_exp_f32 v207, v207
    v_exp_f32 v224, v224
    v_exp_f32 v208, v208
    v_exp_f32 v225, v225
    v_exp_f32 v209, v209
    v_exp_f32 v226, v226
    v_exp_f32 v210, v210
    v_exp_f32 v227, v227
    v_exp_f32 v211, v211
    v_exp_f32 v228, v228
    v_exp_f32 v212, v212
    v_exp_f32 v229, v229
    v_exp_f32 v213, v213
    v_exp_f32 v230, v230
    s_xor_b32 s96, s95, 1179648
    s_add_u32 s82, s96, s90
    s_add_u32 m0, s83, 73728
    s_nop 0
    buffer_load_dwordx4 v26, s[44:47], s82 offen lds
    v_exp_f32 v214, v214
    v_exp_f32 v231, v231
    v_exp_f32 v215, v215
    v_add_f32 v8, v216, v218
    v_add_f32 v9, v217, v219
    v_add_f32 v10, v200, v202
    v_add_f32 v11, v201, v203
    v_add_f32 v8, v8, v220
    v_add_f32 v9, v9, v221
    v_add_f32 v10, v10, v204
    v_add_f32 v11, v11, v205
    v_add_f32 v8, v8, v222
    v_add_f32 v9, v9, v223
    v_add_f32 v10, v10, v206
    s_add_u32 s82, s80, 114688
    buffer_load_dwordx4 v[72:75], v27, s[52:55], s82 offen nt
    v_add_f32 v11, v11, v207
    v_add_f32 v8, v8, v224
    v_add_f32 v9, v9, v225
    v_add_f32 v10, v10, v208
    v_add_f32 v11, v11, v209
    v_add_f32 v8, v8, v226
    v_add_f32 v9, v9, v227
    v_add_f32 v10, v10, v210
    v_add_f32 v11, v11, v211
    v_add_f32 v8, v8, v228
    v_add_f32 v9, v9, v229
    v_add_f32 v10, v10, v212
    v_add_f32 v11, v11, v213
    v_add_f32 v8, v8, v230
    s_add_u32 s82, s80, 4294164480
    buffer_load_dwordx4 v[76:79], v27, s[52:55], s82 offen nt
    v_add_f32 v9, v9, v231
    v_add_f32 v10, v10, v214
    v_add_f32 v11, v11, v215
    v_add_f32 v6, v8, v9
    v_add_f32 v7, v10, v11
    v_add_f32 v4, v8, v9
    v_add_f32 v5, v10, v11
    s_nop 0
    v_permlane32_swap_b32 v4, v6
    v_permlane32_swap_b32 v5, v7
    v_add_f32 v4, v4, v6
    v_add_f32 v5, v5, v7
    v_rcp_f32 v4, v4
    v_rcp_f32 v5, v5
    v_mul_f32 v216, v216, v4
    s_add_u32 s82, s80, 172032
    buffer_load_dwordx4 v[80:83], v27, s[52:55], s82 offen nt
    v_mul_f32 v217, v217, v4
    v_mul_f32 v200, v200, v5
    v_mul_f32 v201, v201, v5
    v_mul_f32 v218, v218, v4
    v_mul_f32 v219, v219, v4
    v_mul_f32 v202, v202, v5
    v_mul_f32 v203, v203, v5
    v_mul_f32 v220, v220, v4
    v_mul_f32 v221, v221, v4
    v_mul_f32 v204, v204, v5
    v_mul_f32 v205, v205, v5
    v_mul_f32 v222, v222, v4
    v_mul_f32 v223, v223, v4
    v_mul_f32 v206, v206, v5
    s_add_u32 s82, s80, 4294221824
    buffer_load_dwordx4 v[84:87], v27, s[52:55], s82 offen nt
    v_mul_f32 v207, v207, v5
    v_mul_f32 v224, v224, v4
    v_mul_f32 v225, v225, v4
    v_mul_f32 v208, v208, v5
    v_mul_f32 v209, v209, v5
    v_mul_f32 v226, v226, v4
    v_mul_f32 v227, v227, v4
    v_mul_f32 v210, v210, v5
    v_mul_f32 v211, v211, v5
    v_mul_f32 v228, v228, v4
    v_mul_f32 v229, v229, v4
    v_mul_f32 v212, v212, v5
    v_mul_f32 v213, v213, v5
    v_mul_f32 v230, v230, v4
    s_xor_b32 s96, s95, 1310720
    s_add_u32 s97, s96, s90
    s_sub_u32 s82, s97, 65536
    s_add_u32 m0, s83, 77824
    s_nop 0
    buffer_load_dwordx4 v26, s[44:47], s82 offen lds
    v_mul_f32 v231, v231, v4
    v_mul_f32 v214, v214, v5
    v_mul_f32 v215, v215, v5
    v_cvt_pk_bf16_f32 v216, v216, v217
    v_cvt_pk_bf16_f32 v217, v218, v219
    v_cvt_pk_bf16_f32 v218, v220, v221
    v_cvt_pk_bf16_f32 v219, v222, v223
    v_cvt_pk_bf16_f32 v220, v224, v225
    v_cvt_pk_bf16_f32 v221, v226, v227
    v_cvt_pk_bf16_f32 v222, v228, v229
    v_cvt_pk_bf16_f32 v223, v230, v231
    ds_write_b128 v232, v[216:219] offset:16384
    v_cvt_pk_bf16_f32 v224, v200, v201
    v_cvt_pk_bf16_f32 v225, v202, v203
    s_xor_b32 s96, s95, 1310720
    s_add_u32 s82, s96, s90
    s_add_u32 m0, s83, 81920
    s_nop 0
    buffer_load_dwordx4 v26, s[44:47], s82 offen lds
    v_cvt_pk_bf16_f32 v226, v204, v205
    v_cvt_pk_bf16_f32 v227, v206, v207
    ds_write_b128 v232, v[220:223] offset:20480
    ds_write_b128 v232, v[224:227] offset:24576
    v_cvt_pk_bf16_f32 v228, v208, v209
    v_cvt_pk_bf16_f32 v229, v210, v211
    v_cvt_pk_bf16_f32 v230, v212, v213
    v_cvt_pk_bf16_f32 v231, v214, v215
    ds_write_b128 v232, v[228:231] offset:28672
    s_xor_b32 s96, s95, 1441792
    s_add_u32 s97, s96, s90
    s_sub_u32 s82, s97, 65536
    s_add_u32 m0, s83, 86016
    s_nop 0
    buffer_load_dwordx4 v26, s[44:47], s82 offen lds
    s_xor_b32 s96, s95, 1441792
    s_add_u32 s82, s96, s90
    s_add_u32 m0, s83, 90112
    s_nop 0
    buffer_load_dwordx4 v26, s[44:47], s82 offen lds
    s_lshl_b32 s96, s77, 11
    s_add_u32 s14, s96, 151552
    v_add_u32 v0, s14, v2
    s_setprio 0
L_JOIN:
    v_and_b32 v45, 1, v1
    v_lshlrev_b32 v45, 3, v45
    v_bfe_u32 v9, v1, 2, 2
    v_lshl_add_u32 v45, v9, 4, v45
    v_bfe_u32 v9, v1, 4, 1
    v_lshl_add_u32 v45, v9, 6, v45
    v_bfe_u32 v9, v1, 1, 1
    v_lshl_add_u32 v45, v9, 7, v45
    v_lshrrev_b32 v9, 5, v1
    v_lshl_add_u32 v45, v9, 8, v45
    s_lshl_b32 s13, s3, 12
    v_add_u32 v44, s13, v45
    s_lshl_b32 s96, s76, 13
    s_add_u32 s13, s96, 32768
    v_add_u32 v45, s13, v45
    v_mov_b32 v244, 0x3f803f80
    v_mov_b32 v245, 0x3f803f80
    v_mov_b32 v246, 0x3f803f80
    v_mov_b32 v247, 0x3f803f80
    s_lshl3_add_u32 s96, s11, s3
    s_lshl_b32 s97, s96, 5
    s_add_u32 s98, s97, s10
    s_lshl_b32 s99, s98, 10
    s_add_u32 s13, s99, 25165824
    s_add_u32 s15, s13, 16384
    s_lshl3_add_u32 s96, s11, s3
    s_lshl_b32 s97, s96, 10
    s_add_u32 s16, s97, 21495808
    s_lshl_b32 s96, s10, 6
    s_add_u32 s14, s96, s16
    s_waitcnt lgkmcnt(0)
    s_barrier
    ds_read_b64_tr_b16 v[184:185], v44
    ds_read_b64_tr_b16 v[186:187], v44 offset:512
    ds_read_b64_tr_b16 v[200:201], v45
    ds_read_b64_tr_b16 v[202:203], v45 offset:512
    ds_read_b64_tr_b16 v[204:205], v45 offset:1024
    ds_read_b64_tr_b16 v[206:207], v45 offset:1536
    ds_read_b64_tr_b16 v[188:189], v44 offset:1024
    ds_read_b64_tr_b16 v[190:191], v44 offset:1536
    ds_read_b64_tr_b16 v[208:209], v45 offset:2048
    ds_read_b64_tr_b16 v[210:211], v45 offset:2560
    ds_read_b64_tr_b16 v[212:213], v45 offset:3072
    ds_read_b64_tr_b16 v[214:215], v45 offset:3584
    ds_read_b64_tr_b16 v[192:193], v44 offset:2048
    ds_read_b64_tr_b16 v[194:195], v44 offset:2560
    ds_read_b64_tr_b16 v[216:217], v45 offset:4096
    ds_read_b64_tr_b16 v[218:219], v45 offset:4608
    ds_read_b64_tr_b16 v[220:221], v45 offset:5120
    ds_read_b64_tr_b16 v[222:223], v45 offset:5632
    s_waitcnt lgkmcnt(12)
    v_mfma_f32_16x16x32_bf16 v[232:235], v[184:187], v[200:203], 0
    v_mfma_f32_16x16x32_bf16 v[236:239], v[184:187], v[204:207], 0
    v_mfma_f32_16x16x32_bf16 v[240:243], v[184:187], v[244:247], 0
    ds_read_b64_tr_b16 v[196:197], v44 offset:3072
    ds_read_b64_tr_b16 v[198:199], v44 offset:3584
    ds_read_b64_tr_b16 v[224:225], v45 offset:6144
    ds_read_b64_tr_b16 v[226:227], v45 offset:6656
    ds_read_b64_tr_b16 v[228:229], v45 offset:7168
    ds_read_b64_tr_b16 v[230:231], v45 offset:7680
    s_waitcnt lgkmcnt(12)
    v_mfma_f32_16x16x32_bf16 v[232:235], v[188:191], v[208:211], v[232:235]
    v_mfma_f32_16x16x32_bf16 v[236:239], v[188:191], v[212:215], v[236:239]
    v_mfma_f32_16x16x32_bf16 v[240:243], v[188:191], v[244:247], v[240:243]
    s_waitcnt lgkmcnt(6)
    v_mfma_f32_16x16x32_bf16 v[232:235], v[192:195], v[216:219], v[232:235]
    v_mfma_f32_16x16x32_bf16 v[236:239], v[192:195], v[220:223], v[236:239]
    v_mfma_f32_16x16x32_bf16 v[240:243], v[192:195], v[244:247], v[240:243]
    s_waitcnt lgkmcnt(0)
    v_mfma_f32_16x16x32_bf16 v[232:235], v[196:199], v[224:227], v[232:235]
    v_mfma_f32_16x16x32_bf16 v[236:239], v[196:199], v[228:231], v[236:239]
    v_mfma_f32_16x16x32_bf16 v[240:243], v[196:199], v[244:247], v[240:243]
    s_cmp_lt_u32 s3, 4
    s_cbranch_scc1 L_NOQX
    ds_read_b128 v[168:171], v0
    ds_read_b128 v[172:175], v0 offset:1024
L_NOQX:
    s_nop 3
    buffer_store_dwordx4 v[232:235], v2, s[32:35], s13 offen sc1
    buffer_store_dwordx4 v[236:239], v2, s[32:35], s15 offen sc1
    s_mov_b32 exec_lo, 0x00010001
    s_mov_b32 exec_hi, 0x00010001
    buffer_store_dwordx4 v[240:243], v1, s[32:35], s14 offen sc1
    s_mov_b64 exec, -1
    s_waitcnt lgkmcnt(0)
    v_mfma_f32_32x32x16_bf16 v[120:135], v[176:179], v[168:171], 0
    v_mfma_f32_32x32x16_bf16 v[120:135], v[180:183], v[172:175], v[120:135]
    v_and_b32 v46, 7, v1
    v_lshlrev_b32 v46, 17, v46
    v_bfe_u32 v9, v1, 3, 1
    v_lshl_add_u32 v46, v9, 14, v46
    s_and_b32 s96, s10, 1
    s_and_b32 s97, s2, 27
    s_lshl_b32 s98, s97, 12
    s_lshr_b32 s99, s10, 1
    s_lshl_b32 s97, s99, 6
    s_add_u32 s99, s98, s97
    s_lshl2_add_u32 s98, s96, s99
    s_add_u32 s97, s98, 1048576
    s_add_u32 s17, s97, 512
    v_lshrrev_b32 v47, 3, v1
    v_lshlrev_b32 v47, 10, v47
    v_and_b32 v9, 7, v1
    v_lshl_add_u32 v47, v9, 4, v47
    v_and_b32 v48, 7, v1
    v_lshlrev_b32 v48, 4, v48
    v_lshrrev_b32 v9, 5, v1
    v_lshl_add_u32 v48, v9, 3, v48
    v_cvt_pk_bf16_f32 v120, 0, v120
    v_cvt_pk_bf16_f32 v121, 0, v121
    v_cvt_pk_bf16_f32 v122, 0, v122
    v_cvt_pk_bf16_f32 v123, 0, v123
    v_cvt_pk_bf16_f32 v124, 0, v124
    v_cvt_pk_bf16_f32 v125, 0, v125
    v_cvt_pk_bf16_f32 v126, 0, v126
    v_cvt_pk_bf16_f32 v127, 0, v127
    v_cvt_pk_bf16_f32 v128, 0, v128
    v_cvt_pk_bf16_f32 v129, 0, v129
    v_cvt_pk_bf16_f32 v130, 0, v130
    v_cvt_pk_bf16_f32 v131, 0, v131
    v_cvt_pk_bf16_f32 v132, 0, v132
    v_cvt_pk_bf16_f32 v133, 0, v133
    v_cvt_pk_bf16_f32 v134, 0, v134
    v_cvt_pk_bf16_f32 v135, 0, v135
    v_max3_f32 v4, v120, v121, v122
    v_min3_f32 v5, v120, v121, v122
    v_max3_f32 v4, v4, v123, v124
    v_min3_f32 v5, v5, v123, v124
    v_max3_f32 v4, v4, v125, v126
    v_min3_f32 v5, v5, v125, v126
    v_max3_f32 v4, v4, v127, v128
    v_min3_f32 v5, v5, v127, v128
    v_max3_f32 v4, v4, v129, v130
    v_min3_f32 v5, v5, v129, v130
    v_max3_f32 v4, v4, v131, v132
    v_min3_f32 v5, v5, v131, v132
    v_max3_f32 v4, v4, v133, v134
    v_min3_f32 v5, v5, v133, v134
    v_max_f32 v6, v4, v135
    v_min_f32 v7, v5, v135
    v_max_f32 v4, v4, v135
    v_min_f32 v5, v5, v135
    s_nop 0
    v_permlane32_swap_b32 v4, v6
    v_permlane32_swap_b32 v5, v7
    v_max_f32 v4, v4, v6
    v_min_f32 v5, v5, v7
    v_pk_mul_f32 v[4:5], v[4:5], s[6:7] op_sel:[0,1]
    v_pk_fma_f32 v[136:137], v[120:121], s[6:7], v[4:5] op_sel:[0,1,0] op_sel_hi:[1,1,0] neg_lo:[0,0,1] neg_hi:[0,0,1]
    v_pk_fma_f32 v[120:121], v[120:121], s[6:7], v[4:5] op_sel:[0,1,1] neg_lo:[1,0,0] neg_hi:[1,0,0]
    v_pk_fma_f32 v[138:139], v[122:123], s[6:7], v[4:5] op_sel:[0,1,0] op_sel_hi:[1,1,0] neg_lo:[0,0,1] neg_hi:[0,0,1]
    v_pk_fma_f32 v[122:123], v[122:123], s[6:7], v[4:5] op_sel:[0,1,1] neg_lo:[1,0,0] neg_hi:[1,0,0]
    v_pk_fma_f32 v[140:141], v[124:125], s[6:7], v[4:5] op_sel:[0,1,0] op_sel_hi:[1,1,0] neg_lo:[0,0,1] neg_hi:[0,0,1]
    v_pk_fma_f32 v[124:125], v[124:125], s[6:7], v[4:5] op_sel:[0,1,1] neg_lo:[1,0,0] neg_hi:[1,0,0]
    v_pk_fma_f32 v[142:143], v[126:127], s[6:7], v[4:5] op_sel:[0,1,0] op_sel_hi:[1,1,0] neg_lo:[0,0,1] neg_hi:[0,0,1]
    v_pk_fma_f32 v[126:127], v[126:127], s[6:7], v[4:5] op_sel:[0,1,1] neg_lo:[1,0,0] neg_hi:[1,0,0]
    v_pk_fma_f32 v[144:145], v[128:129], s[6:7], v[4:5] op_sel:[0,1,0] op_sel_hi:[1,1,0] neg_lo:[0,0,1] neg_hi:[0,0,1]
    v_pk_fma_f32 v[128:129], v[128:129], s[6:7], v[4:5] op_sel:[0,1,1] neg_lo:[1,0,0] neg_hi:[1,0,0]
    v_pk_fma_f32 v[146:147], v[130:131], s[6:7], v[4:5] op_sel:[0,1,0] op_sel_hi:[1,1,0] neg_lo:[0,0,1] neg_hi:[0,0,1]
    v_pk_fma_f32 v[130:131], v[130:131], s[6:7], v[4:5] op_sel:[0,1,1] neg_lo:[1,0,0] neg_hi:[1,0,0]
    v_pk_fma_f32 v[148:149], v[132:133], s[6:7], v[4:5] op_sel:[0,1,0] op_sel_hi:[1,1,0] neg_lo:[0,0,1] neg_hi:[0,0,1]
    v_pk_fma_f32 v[132:133], v[132:133], s[6:7], v[4:5] op_sel:[0,1,1] neg_lo:[1,0,0] neg_hi:[1,0,0]
    v_pk_fma_f32 v[150:151], v[134:135], s[6:7], v[4:5] op_sel:[0,1,0] op_sel_hi:[1,1,0] neg_lo:[0,0,1] neg_hi:[0,0,1]
    v_pk_fma_f32 v[134:135], v[134:135], s[6:7], v[4:5] op_sel:[0,1,1] neg_lo:[1,0,0] neg_hi:[1,0,0]
    v_exp_f32 v136, v136
    v_exp_f32 v120, v120
    v_exp_f32 v137, v137
    v_exp_f32 v121, v121
    v_exp_f32 v138, v138
    v_exp_f32 v122, v122
    v_exp_f32 v139, v139
    v_exp_f32 v123, v123
    v_exp_f32 v140, v140
    v_exp_f32 v124, v124
    v_exp_f32 v141, v141
    v_exp_f32 v125, v125
    v_exp_f32 v142, v142
    v_exp_f32 v126, v126
    v_exp_f32 v143, v143
    v_exp_f32 v127, v127
    s_waitcnt vmcnt(0)
    s_barrier
    s_cmp_lg_u32 s3, 0
    s_cbranch_scc1 L_PC
    v_mov_b32 v45, s4
    s_mov_b32 exec_hi, 0
    s_mov_b32 exec_lo, 65535
    buffer_store_dword v45, v46, s[32:35], s17 offen sc1
    s_mov_b64 exec, -1
L_PC:
    s_xor_b32 s96, s95, 1572864
    s_add_u32 s82, s96, s90
    s_add_u32 m0, s83, 98304
    s_nop 0
    buffer_load_dwordx4 v26, s[44:47], s82 offen lds
    v_exp_f32 v144, v144
    v_exp_f32 v128, v128
    v_exp_f32 v145, v145
    v_exp_f32 v129, v129
    v_exp_f32 v146, v146
    v_exp_f32 v130, v130
    v_exp_f32 v147, v147
    v_exp_f32 v131, v131
    s_xor_b32 s96, s95, 1703936
    s_add_u32 s82, s96, s90
    s_add_u32 m0, s83, 106496
    s_nop 0
    buffer_load_dwordx4 v26, s[44:47], s82 offen lds
    v_exp_f32 v148, v148
    v_exp_f32 v132, v132
    v_exp_f32 v149, v149
    v_exp_f32 v133, v133
    v_exp_f32 v150, v150
    v_exp_f32 v134, v134
    v_exp_f32 v151, v151
    v_exp_f32 v135, v135
    s_lshl4_add_u32 s96, s11, s10
    s_lshl_b32 s97, s96, 14
    s_lshl_b32 s98, s3, 7
    s_add_u32 s99, s97, s98
    s_add_u32 s13, s99, 25165824
    s_add_u32 s14, s13, 8192
    s_lshl4_add_u32 s96, s11, s10
    s_lshl_b32 s97, s96, 10
    s_lshl_b32 s98, s3, 7
    s_add_u32 s99, s97, s98
    s_add_u32 s15, s99, 29360128
    s_add_u32 s17, s17, 3072
    s_load_dwordx2 s[24:25], s[32:33], s92 offset:512 glc
    s_xor_b32 s96, s95, 1835008
    s_add_u32 s82, s96, s90
    s_add_u32 m0, s83, 114688
    s_nop 0
    buffer_load_dwordx4 v26, s[44:47], s82 offen lds
    v_pk_add_f32 v[8:9], v[136:137], v[138:139]
    v_pk_add_f32 v[10:11], v[120:121], v[122:123]
    v_pk_add_f32 v[8:9], v[8:9], v[140:141]
    v_pk_add_f32 v[10:11], v[10:11], v[124:125]
    v_pk_add_f32 v[8:9], v[8:9], v[142:143]
    v_pk_add_f32 v[10:11], v[10:11], v[126:127]
    v_pk_add_f32 v[8:9], v[8:9], v[144:145]
    v_pk_add_f32 v[10:11], v[10:11], v[128:129]
    v_pk_add_f32 v[8:9], v[8:9], v[146:147]
    v_pk_add_f32 v[10:11], v[10:11], v[130:131]
    v_pk_add_f32 v[8:9], v[8:9], v[148:149]
    v_pk_add_f32 v[10:11], v[10:11], v[132:133]
    v_pk_add_f32 v[8:9], v[8:9], v[150:151]
    v_pk_add_f32 v[10:11], v[10:11], v[134:135]
    s_xor_b32 s96, s95, 1966080
    s_add_u32 s82, s96, s90
    s_add_u32 m0, s83, 122880
    s_nop 0
    buffer_load_dwordx4 v26, s[44:47], s82 offen lds
    v_add_f32 v6, v8, v9
    v_add_f32 v7, v10, v11
    v_add_f32 v4, v8, v9
    v_add_f32 v5, v10, v11
    s_nop 0
    v_permlane32_swap_b32 v4, v6
    v_permlane32_swap_b32 v5, v7
    v_pk_add_f32 v[4:5], v[4:5], v[6:7]
    v_rcp_f32 v4, v4
    v_rcp_f32 v5, v5
    s_nop 0
    v_pk_mul_f32 v[136:137], v[136:137], v[4:5] op_sel_hi:[1,0]
    v_pk_mul_f32 v[120:121], v[120:121], v[4:5] op_sel:[0,1]
    v_pk_mul_f32 v[138:139], v[138:139], v[4:5] op_sel_hi:[1,0]
    v_pk_mul_f32 v[122:123], v[122:123], v[4:5] op_sel:[0,1]
    v_pk_mul_f32 v[140:141], v[140:141], v[4:5] op_sel_hi:[1,0]
    s_add_u32 s82, s95, s90
    s_mov_b32 m0, s83
    s_nop 0
    buffer_load_dwordx4 v26, s[44:47], s82 offen lds
    v_pk_mul_f32 v[124:125], v[124:125], v[4:5] op_sel:[0,1]
    v_pk_mul_f32 v[142:143], v[142:143], v[4:5] op_sel_hi:[1,0]
    v_pk_mul_f32 v[126:127], v[126:127], v[4:5] op_sel:[0,1]
    v_pk_mul_f32 v[144:145], v[144:145], v[4:5] op_sel_hi:[1,0]
    v_pk_mul_f32 v[128:129], v[128:129], v[4:5] op_sel:[0,1]
    v_pk_mul_f32 v[146:147], v[146:147], v[4:5] op_sel_hi:[1,0]
    v_pk_mul_f32 v[130:131], v[130:131], v[4:5] op_sel:[0,1]
    v_pk_mul_f32 v[148:149], v[148:149], v[4:5] op_sel_hi:[1,0]
    v_pk_mul_f32 v[132:133], v[132:133], v[4:5] op_sel:[0,1]
    v_pk_mul_f32 v[150:151], v[150:151], v[4:5] op_sel_hi:[1,0]
    v_pk_mul_f32 v[134:135], v[134:135], v[4:5] op_sel:[0,1]
    v_cvt_pk_bf16_f32 v152, v136, v137
    v_cvt_pk_bf16_f32 v153, v138, v139
    v_cvt_pk_bf16_f32 v154, v140, v141
    s_xor_b32 s96, s95, 131072
    s_add_u32 s82, s96, s90
    s_add_u32 m0, s83, 8192
    s_nop 0
    buffer_load_dwordx4 v26, s[44:47], s82 offen lds
    v_cvt_pk_bf16_f32 v155, v142, v143
    v_cvt_pk_bf16_f32 v156, v144, v145
    v_cvt_pk_bf16_f32 v157, v146, v147
    v_cvt_pk_bf16_f32 v158, v148, v149
    v_cvt_pk_bf16_f32 v159, v150, v151
    v_cvt_pk_bf16_f32 v160, v120, v121
    v_cvt_pk_bf16_f32 v161, v122, v123
    v_cvt_pk_bf16_f32 v162, v124, v125
    v_cvt_pk_bf16_f32 v163, v126, v127
    v_cvt_pk_bf16_f32 v164, v128, v129
    v_cvt_pk_bf16_f32 v165, v130, v131
    v_cvt_pk_bf16_f32 v166, v132, v133
    v_cvt_pk_bf16_f32 v167, v134, v135
    s_branch SCHK_19
SPOLL_18:
    s_load_dwordx2 s[24:25], s[32:33], s92 offset:512 glc
SCHK_19:
    s_add_u32 s5, s5, 1
    s_cmp_ge_u32 s5, 200000
    s_waitcnt lgkmcnt(0)
    s_cbranch_scc1 SDONE_20
    s_cmp_lg_u32 s24, s4
    s_cbranch_scc1 SPOLL_18
    s_cmp_lg_u32 s25, s4
    s_cbranch_scc1 SPOLL_18
SDONE_20:
    s_barrier
    buffer_load_dwordx4 v[184:187], v47, s[32:35], s13 offen sc1
    buffer_load_dwordx4 v[188:191], v47, s[32:35], s14 offen sc1
    buffer_load_dwordx4 v[192:195], v2, s[32:35], s16 offen sc1
    s_lshl_b32 s96, s3, 5
    s_add_u32 s14, s96, 155648
    v_and_b32 v6, 3, v1
    v_lshl_add_u32 v6, v6, 3, s14
    v_lshrrev_b32 v9, 5, v1
    v_lshl_add_u32 v6, v9, 2, v6
    s_lshl_b32 s96, s3, 10
    s_add_u32 s14, s96, 147456
    v_and_b32 v5, 15, v1
    v_lshl_add_u32 v5, v5, 4, s14
    v_lshrrev_b32 v9, 5, v1
    v_lshl_add_u32 v5, v9, 9, v5
    v_bfe_u32 v9, v1, 4, 1
    v_lshl_add_u32 v5, v9, 3, v5
    s_lshl_b32 s96, s76, 7
    s_add_u32 s14, s96, 155648
    v_lshrrev_b32 v7, 5, v1
    v_lshl_add_u32 v7, v7, 4, s14
    s_lshl_b32 s96, s76, 12
    s_add_u32 s14, s96, 147456
    v_add_u32 v44, s14, v2
    s_waitcnt vmcnt(1)
    v_pk_add_f32 v[184:185], v[184:185], v[188:189]
    v_pk_add_f32 v[186:187], v[186:187], v[190:191]
    s_nop 1
    v_permlane32_swap_b32 v184, v186
    v_permlane32_swap_b32 v185, v187
    v_pk_add_f32 v[184:185], v[184:185], v[186:187]
    s_nop 1
    v_add_f32_dpp v184, v184, v184 row_ror:8 row_mask:0xf bank_mask:0xf
    v_add_f32_dpp v185, v185, v185 row_ror:8 row_mask:0xf bank_mask:0xf
    v_mov_b32 v186, v184
    v_mov_b32 v187, v185
    s_nop 0
    v_permlane16_swap_b32 v184, v186
    v_permlane16_swap_b32 v185, v187
    v_pk_add_f32 v[184:185], v[184:185], v[186:187]
    v_cvt_pk_bf16_f32 v184, v184, v185
    v_mov_b32 v185, s4
    s_mov_b32 exec_lo, 0xff
    s_mov_b32 exec_hi, 0xff
    buffer_store_dwordx2 v[184:185], v48, s[32:35], s15 offen sc1
    s_mov_b64 exec, -1
    s_barrier
    s_cmp_lg_u32 s3, 0
    s_cbranch_scc1 L_PC2
    v_mov_b32 v45, s4
    s_mov_b32 exec_hi, 0
    s_mov_b32 exec_lo, 65535
    buffer_store_dword v45, v46, s[32:35], s17 offen sc1
    s_mov_b64 exec, -1
L_PC2:
    s_waitcnt vmcnt(1)
    s_xor_b32 s96, s95, 262144
    s_add_u32 s82, s96, s90
    s_add_u32 m0, s83, 16384
    s_nop 0
    buffer_load_dwordx4 v26, s[44:47], s82 offen lds
    v_permlane32_swap_b32 v192, v194
    v_permlane32_swap_b32 v193, v195
    v_pk_add_f32 v[192:193], v[192:193], v[194:195]
    s_nop 1
    v_add_f32_dpp v192, v192, v192 row_ror:4 row_mask:0xf bank_mask:0xf
    s_xor_b32 s96, s95, 393216
    s_add_u32 s82, s96, s90
    s_add_u32 m0, s83, 24576
    s_nop 0
    buffer_load_dwordx4 v26, s[44:47], s82 offen lds
    v_add_f32_dpp v193, v193, v193 row_ror:4 row_mask:0xf bank_mask:0xf
    v_add_f32_dpp v192, v192, v192 row_ror:8 row_mask:0xf bank_mask:0xf
    s_nop 0
    v_add_f32_dpp v193, v193, v193 row_ror:8 row_mask:0xf bank_mask:0xf
L_PAD7:
    s_cbranch_execz L_RET7
    s_xor_b32 s96, s95, 524288
    s_add_u32 s82, s96, s90
    s_add_u32 m0, s83, 32768
    s_nop 0
    buffer_load_dwordx4 v26, s[44:47], s82 offen lds
    v_mov_b32 v194, v192
    v_mov_b32 v195, v193
    s_nop 0
    v_permlane16_swap_b32 v192, v194
    s_xor_b32 s96, s95, 655360
    s_add_u32 s82, s96, s90
    s_add_u32 m0, s83, 40960
    s_nop 0
    buffer_load_dwordx4 v26, s[44:47], s82 offen lds
    v_permlane16_swap_b32 v193, v195
    v_pk_add_f32 v[192:193], v[192:193], v[194:195]
    v_cvt_pk_bf16_f32 v192, v192, v193
    ds_write_b32 v6, v192
    s_waitcnt lgkmcnt(0)
    s_barrier
    ds_read_b128 v[196:199], v7
    ds_read_b128 v[200:203], v7 offset:32
    ds_read_b128 v[204:207], v7 offset:64
    ds_read_b128 v[208:211], v7 offset:96
    s_lshr_b32 s96, s8, 2
    s_lshl1_add_u32 s97, s9, s96
    s_and_b32 s98, s8, 3
    s_lshl2_add_u32 s99, s97, s98
    s_lshl_b32 s96, s99, 9
    s_add_u32 s18, s96, 131072
    s_waitcnt lgkmcnt(0)
    s_lshl3_add_u32 s96, s11, s3
    s_lshl_b32 s97, s96, 11
    s_add_u32 s13, s97, 29360128
    s_load_dwordx2 s[24:25], s[32:33], s92 offset:3584 glc
    v_mfma_f32_32x32x16_bf16 v[136:151], v[196:199], v[152:155], 0
    v_mfma_f32_32x32x16_bf16 v[136:151], v[200:203], v[156:159], v[136:151]
    v_mfma_f32_32x32x16_bf16 v[136:151], v[204:207], v[160:163], v[136:151]
    v_mfma_f32_32x32x16_bf16 v[136:151], v[208:211], v[164:167], v[136:151]
    s_nop 11
    v_cvt_pk_bf16_f32 v136, 0, v136
    v_add_f32 v136, 0x358637bd, v136
    v_cvt_pk_bf16_f32 v136, 0, v136
    v_rcp_f32 v136, v136
    s_branch SCHK_22
SPOLL_21:
    s_load_dwordx2 s[24:25], s[32:33], s92 offset:3584 glc
SCHK_22:
    s_add_u32 s5, s5, 1
    s_cmp_ge_u32 s5, 200000
    s_waitcnt lgkmcnt(0)
    s_cbranch_scc1 SDONE_23
    s_cmp_lg_u32 s24, s4
    s_cbranch_scc1 SPOLL_21
    s_cmp_lg_u32 s25, s4
    s_cbranch_scc1 SPOLL_21
SDONE_23:
    buffer_load_dwordx4 v[228:231], v2, s[32:35], s13 offen sc1
    buffer_load_dwordx4 v[232:235], v2, s[32:35], s13 offen offset:1024 sc1
    s_waitcnt vmcnt(0)
    v_bitop3_b32 v4, v229, v231, s4 bitop3:0x7e
    v_bitop3_b32 v4, v4, v233, s4 bitop3:0xf6
    v_bitop3_b32 v4, v4, v235, s4 bitop3:0xf6
    v_cmp_ne_u32 vcc, 0, v4
    s_cbranch_vccz TOK_25
POLL_26:
    buffer_load_dwordx4 v[228:231], v2, s[32:35], s13 offen sc1
    buffer_load_dwordx4 v[232:235], v2, s[32:35], s13 offen offset:1024 sc1
    s_waitcnt vmcnt(0)
    v_bitop3_b32 v4, v229, v231, s4 bitop3:0x7e
    v_bitop3_b32 v4, v4, v233, s4 bitop3:0xf6
    v_bitop3_b32 v4, v4, v235, s4 bitop3:0xf6
    v_cmp_ne_u32 vcc, 0, v4
    s_cbranch_vccz PDONE_27
    s_add_u32 s5, s5, 1
    s_cmp_lt_u32 s5, 200000
    s_cbranch_scc1 POLL_26
PDONE_27:
TOK_25:
    ds_write2_b32 v5, v228, v230 offset0:0 offset1:1
    ds_write2_b32 v5, v232, v234 offset0:64 offset1:65
    s_waitcnt lgkmcnt(0)
    s_barrier
    ds_read_b128 v[212:215], v44
    ds_read_b128 v[216:219], v44 offset:1024
    ds_read_b128 v[220:223], v44 offset:2048
    ds_read_b128 v[224:227], v44 offset:3072
    s_lshl_b32 s96, s77, 1
    s_lshl3_add_u32 s97, s10, s96
    s_lshl_b32 s98, s97, 5
    s_lshl1_add_u32 s99, s11, s98
    s_add_u32 s96, s99, s76
    s_lshl_b32 s97, s96, 10
    s_add_u32 s13, s97, 8388608
    v_and_b32 v47, 15, v1
    v_lshlrev_b32 v47, 4, v47
    v_bfe_u32 v9, v1, 4, 1
    v_lshl_add_u32 v47, v9, 15, v47
    v_lshrrev_b32 v9, 5, v1
    v_lshl_add_u32 v47, v9, 8, v47
    s_waitcnt lgkmcnt(3)
    v_mfma_f32_32x32x16_bf16 v[120:135], v[212:215], v[152:155], 0
    s_waitcnt lgkmcnt(2)
    v_mfma_f32_32x32x16_bf16 v[120:135], v[216:219], v[156:159], v[120:135]
    s_waitcnt lgkmcnt(1)
    v_mfma_f32_32x32x16_bf16 v[120:135], v[220:223], v[160:163], v[120:135]
    s_waitcnt lgkmcnt(0)
    v_mfma_f32_32x32x16_bf16 v[120:135], v[224:227], v[164:167], v[120:135]
    s_lshr_b32 s96, s3, 1
    s_lshl4_add_u32 s97, s96, s12
    s_lshl_b32 s98, s97, 11
    s_and_b32 s99, s3, 1
    s_lshl_b32 s96, s99, 10
    s_add_u32 s97, s98, s96
    s_add_u32 s18, s97, 131072
    s_lshl_b32 s19, s12, 7
    v_and_b32 v44, 3, v1
    v_lshl_add_u32 v44, v44, 1, s19
    v_lshrrev_b32 v9, 5, v1
    v_lshl_add_u32 v44, v9, 3, v44
    v_bfe_u32 v9, v1, 4, 1
    v_lshl_add_u32 v44, v9, 4, v44
    v_bfe_u32 v9, v1, 2, 2
    v_lshl_add_u32 v44, v9, 5, v44
    global_load_ushort v32, v44, s[78:79]
    buffer_load_dwordx4 v[28:31], v2, s[32:35], s18 offen sc1
    v_cvt_pk_bf16_f32 v120, 0, v120
    v_cvt_pk_bf16_f32 v121, 0, v121
    v_cvt_pk_bf16_f32 v122, 0, v122
    v_cvt_pk_bf16_f32 v123, 0, v123
    v_cvt_pk_bf16_f32 v124, 0, v124
    v_cvt_pk_bf16_f32 v125, 0, v125
    v_cvt_pk_bf16_f32 v126, 0, v126
    v_cvt_pk_bf16_f32 v127, 0, v127
    v_pk_mul_f32 v[120:121], v[120:121], v[136:137] op_sel_hi:[1,0]
    v_pk_mul_f32 v[122:123], v[122:123], v[136:137] op_sel_hi:[1,0]
    v_pk_mul_f32 v[124:125], v[124:125], v[136:137] op_sel_hi:[1,0]
    v_pk_mul_f32 v[126:127], v[126:127], v[136:137] op_sel_hi:[1,0]
    v_cvt_pk_bf16_f32 v168, v120, v121
    v_cvt_pk_bf16_f32 v169, v122, v123
    v_cvt_pk_bf16_f32 v170, v124, v125
    v_cvt_pk_bf16_f32 v171, v126, v127
    buffer_store_dwordx4 v[168:171], v47, s[32:35], s13 offen sc1
    v_cvt_pk_bf16_f32 v128, 0, v128
    v_cvt_pk_bf16_f32 v129, 0, v129
    v_cvt_pk_bf16_f32 v130, 0, v130
    v_cvt_pk_bf16_f32 v131, 0, v131
    v_cvt_pk_bf16_f32 v132, 0, v132
    v_cvt_pk_bf16_f32 v133, 0, v133
    v_cvt_pk_bf16_f32 v134, 0, v134
    v_cvt_pk_bf16_f32 v135, 0, v135
    v_pk_mul_f32 v[128:129], v[128:129], v[136:137] op_sel_hi:[1,0]
    v_pk_mul_f32 v[130:131], v[130:131], v[136:137] op_sel_hi:[1,0]
    v_pk_mul_f32 v[132:133], v[132:133], v[136:137] op_sel_hi:[1,0]
    v_pk_mul_f32 v[134:135], v[134:135], v[136:137] op_sel_hi:[1,0]
    v_cvt_pk_bf16_f32 v172, v128, v129
    v_cvt_pk_bf16_f32 v173, v130, v131
    v_cvt_pk_bf16_f32 v174, v132, v133
    v_cvt_pk_bf16_f32 v175, v134, v135
    buffer_store_dwordx4 v[172:175], v47, s[32:35], s13 offen offset:512 sc1
    v_bfe_u32 v36, v1, 2, 2
    v_lshlrev_b32 v36, 7, v36
    v_lshrrev_b32 v9, 4, v1
    v_lshl_add_u32 v36, v9, 10, v36
    v_and_b32 v9, 1, v1
    v_lshl_add_u32 v36, v9, 4, v36
    v_bfe_u32 v9, v1, 1, 1
    v_lshl_add_u32 v36, v9, 3, v36
    v_bfe_u32 v9, v1, 3, 2
    v_lshl_add_u32 v36, v9, 5, v36
    s_and_b32 s96, s9, 1
    s_lshl_b32 s97, s96, 2
    s_xor_b32 s98, s3, s97
    s_lshl_b32 s17, s98, 12
    s_lshl_b32 s96, s17, 2
    s_lshr_b32 s97, s95, 4
    s_xor_b32 s14, s96, s97
    v_add_u32 v36, s14, v36
    v_xor_b32 v37, 32, v36
    v_xor_b32 v38, 64, v36
    v_xor_b32 v39, 96, v36
    v_and_b32 v5, 7, v1
    v_lshlrev_b32 v5, 15, v5
    v_bfe_u32 v9, v1, 3, 1
    v_lshl_add_u32 v5, v9, 12, v5
    s_and_b32 s96, s11, 1
    s_lshr_b32 s97, s10, 2
    s_and_b32 s98, s10, 3
    s_lshl_b32 s99, s98, 6
    s_lshl1_add_u32 s98, s97, s99
    s_lshl_b32 s97, s98, 12
    s_lshr_b32 s99, s11, 1
    s_lshl_b32 s98, s99, 6
    s_add_u32 s99, s97, s98
    s_lshl2_add_u32 s97, s96, s99
    s_add_u32 s98, s97, 1048576
    s_add_u32 s15, s98, 1024
    v_lshlrev_b32 v152, 16, v12
    v_and_b32 v153, s6, v12
    v_lshlrev_b32 v154, 16, v13
    v_and_b32 v155, s6, v13
    v_lshlrev_b32 v156, 16, v14
    v_and_b32 v157, s6, v14
    v_lshlrev_b32 v158, 16, v15
    v_and_b32 v159, s6, v15
    v_lshlrev_b32 v160, 16, v16
    v_and_b32 v161, s6, v16
    v_lshlrev_b32 v162, 16, v17
    v_and_b32 v163, s6, v17
    v_lshlrev_b32 v164, 16, v18
    v_and_b32 v165, s6, v18
    v_lshlrev_b32 v166, 16, v19
    v_and_b32 v167, s6, v19
    s_lshl3_add_u32 s96, s21, s3
    s_lshl_b32 s97, s96, 15
    s_add_u32 s19, s97, 8388608
    s_waitcnt vmcnt(2)
    v_bitop3_b32 v4, v29, v31, s4 bitop3:0x7e
    v_cmp_ne_u32 vcc, 0, v4
    s_cbranch_vccz L_MGOK
POLL_28:
    buffer_load_dwordx4 v[28:31], v2, s[32:35], s18 offen sc1
    s_waitcnt vmcnt(0)
    v_bitop3_b32 v4, v29, v31, s4 bitop3:0x7e
    v_cmp_ne_u32 vcc, 0, v4
    s_cbranch_vccz PDONE_29
    s_add_u32 s5, s5, 1
    s_cmp_lt_u32 s5, 200000
    s_cbranch_scc1 POLL_28
PDONE_29:
L_MGOK:
    s_and_b32 s96, s3, 1
    s_lshr_b32 s97, s3, 1
    s_lshl_b32 s98, s97, 10
    s_lshl3_add_u32 s99, s96, s98
    s_add_u32 s14, s99, 159744
    v_and_b32 v4, 31, v1
    v_lshl_add_u32 v4, v4, 5, s14
    v_lshrrev_b32 v9, 5, v1
    v_lshl_add_u32 v4, v9, 2, v4
    ds_write2_b32 v4, v28, v30 offset0:0 offset1:4
    v_and_b32 v7, 3, v1
    v_lshlrev_b32 v7, 4, v7
    v_lshrrev_b32 v9, 5, v1
    v_lshl_add_u32 v7, v9, 6, v7
    v_bfe_u32 v9, v1, 4, 1
    v_lshl_add_u32 v7, v9, 7, v7
    v_bfe_u32 v9, v1, 2, 2
    v_lshl_add_u32 v7, v9, 8, v7
    v_add_u32 v7, 159744, v7
    s_lshl_b32 s96, s2, 12
    s_lshr_b32 s97, s17, 6
    s_add_u32 s98, s96, s97
    s_add_u32 s99, s98, 1048576
    s_add_u32 s18, s99, 1024
    s_waitcnt vmcnt(0)
    s_waitcnt lgkmcnt(0)
    s_barrier
    s_cmp_lg_u32 s3, 0
    s_cbranch_scc1 L_PD
    v_mov_b32 v6, s4
    s_mov_b32 exec_hi, 0
    s_mov_b32 exec_lo, 65535
    buffer_store_dword v6, v5, s[32:35], s15 offen sc1
    s_mov_b64 exec, -1
L_PD:
    ds_read_b128 v[192:195], v7
    ds_read_b128 v[196:199], v7 offset:1024
    ds_read_b128 v[200:203], v7 offset:2048
    ds_read_b128 v[204:207], v7 offset:3072
    v_and_b32 v8, 3, v1
    v_lshlrev_b32 v8, 2, v8
    v_lshrrev_b32 v9, 5, v1
    v_lshl_add_u32 v8, v9, 4, v8
    v_bfe_u32 v9, v1, 4, 1
    v_lshl_add_u32 v8, v9, 5, v8
    v_bfe_u32 v9, v1, 2, 2
    v_lshl_add_u32 v8, v9, 6, v8
    v_add_u32 v8, 157184, v8
    s_lshl4_add_u32 s96, s21, s12
    s_lshl_b32 s97, s96, 6
    s_add_u32 s13, s97, 14155776
    s_waitcnt lgkmcnt(0)
    s_load_dwordx2 s[24:25], s[32:33], s18 offset:0 glc
    v_pk_add_f32 v[192:193], v[192:193], v[194:195]
    v_add_f32 v28, v192, v193
    v_pk_add_f32 v[196:197], v[196:197], v[198:199]
    v_add_f32 v29, v196, v197
    v_pk_add_f32 v[200:201], v[200:201], v[202:203]
    v_add_f32 v30, v200, v201
    v_pk_add_f32 v[204:205], v[204:205], v[206:207]
    v_add_f32 v31, v204, v205
    v_cvt_pk_bf16_f32 v28, 0, v28
    v_cvt_pk_bf16_f32 v29, 0, v29
    v_cvt_pk_bf16_f32 v30, 0, v30
    v_cvt_pk_bf16_f32 v31, 0, v31
    v_add_f32 v30, 1.0, v30
    v_lshlrev_b32 v32, 16, v32
    v_cvt_pk_bf16_f32 v30, 0, v30
    ds_write_b32 v8, v31
    v_mul_f32 v192, v30, v32
    v_cvt_pk_bf16_f32 v193, 0, v192
    v_sub_f32 v194, v192, v193
    v_add_f32_dpp v192, v192, v192 quad_perm:[1,0,3,2] row_mask:0xf bank_mask:0xf
    s_nop 1
    v_add_f32_dpp v192, v192, v192 quad_perm:[2,3,0,1] row_mask:0xf bank_mask:0xf
    s_nop 1
    v_add_f32_dpp v192, v192, v192 row_half_mirror row_mask:0xf bank_mask:0xf
    s_nop 1
    v_add_f32_dpp v192, v192, v192 row_ror:8 row_mask:0xf bank_mask:0xf
    v_mov_b32 v199, v192
    s_nop 1
    v_permlane16_swap_b32 v192, v199
    v_add_f32 v192, v192, v199
    v_mov_b32 v199, v192
    s_nop 1
    v_permlane32_swap_b32 v192, v199
    v_add_f32 v192, v192, v199
    v_mov_b32_dpp v196, v193 row_shl:1 row_mask:0xf bank_mask:0xf
    v_mov_b32_dpp v197, v194 row_shl:1 row_mask:0xf bank_mask:0xf
    v_mov_b32_dpp v198, v32 row_shl:1 row_mask:0xf bank_mask:0xf
    v_cvt_pk_bf16_f32 v196, v193, v196
    v_cvt_pk_bf16_f32 v197, v194, v197
    v_cvt_pk_bf16_f32 v198, v32, v198
    v_mov_b32 v193, s4
    v_mov_b32 v194, 0
    s_cmp_lg_u32 s3, 2
    s_cbranch_scc1 L_NOUP
    s_mov_b64 exec, 1
    buffer_store_dwordx2 v[192:193], v194, s[32:35], s13 offen sc1
    s_mov_b64 exec, -1
L_NOUP:
    v_mov_b32 v184, 0x3f803f80
    s_nop 1
    v_mov_b32_dpp v184, v196 row_newbcast:0 row_mask:0xf bank_mask:0x2
    s_nop 1
    v_mov_b32_dpp v184, v197 row_newbcast:0 row_mask:0xf bank_mask:0x4
    s_nop 1
    v_mov_b32_dpp v184, v198 row_newbcast:0 row_mask:0xf bank_mask:0x8
    v_mov_b32 v185, 0x3f803f80
    s_nop 1
    v_mov_b32_dpp v185, v196 row_newbcast:2 row_mask:0xf bank_mask:0x2
    s_nop 1
    v_mov_b32_dpp v185, v197 row_newbcast:2 row_mask:0xf bank_mask:0x4
    s_nop 1
    v_mov_b32_dpp v185, v198 row_newbcast:2 row_mask:0xf bank_mask:0x8
    v_mov_b32 v186, 0x3f803f80
    s_nop 1
    v_mov_b32_dpp v186, v196 row_newbcast:4 row_mask:0xf bank_mask:0x2
    s_nop 1
    v_mov_b32_dpp v186, v197 row_newbcast:4 row_mask:0xf bank_mask:0x4
    s_nop 1
    v_mov_b32_dpp v186, v198 row_newbcast:4 row_mask:0xf bank_mask:0x8
    v_mov_b32 v187, 0x3f803f80
    s_nop 1
    v_mov_b32_dpp v187, v196 row_newbcast:6 row_mask:0xf bank_mask:0x2
    s_nop 1
    v_mov_b32_dpp v187, v197 row_newbcast:6 row_mask:0xf bank_mask:0x4
    s_nop 1
    v_mov_b32_dpp v187, v198 row_newbcast:6 row_mask:0xf bank_mask:0x8
    v_mov_b32 v188, 0x3f803f80
    s_nop 1
    v_mov_b32_dpp v188, v196 row_newbcast:8 row_mask:0xf bank_mask:0x2
    s_nop 1
    v_mov_b32_dpp v188, v197 row_newbcast:8 row_mask:0xf bank_mask:0x4
    s_nop 1
    v_mov_b32_dpp v188, v198 row_newbcast:8 row_mask:0xf bank_mask:0x8
    v_mov_b32 v189, 0x3f803f80
    s_nop 1
    v_mov_b32_dpp v189, v196 row_newbcast:10 row_mask:0xf bank_mask:0x2
    s_nop 1
    v_mov_b32_dpp v189, v197 row_newbcast:10 row_mask:0xf bank_mask:0x4
    s_nop 1
    v_mov_b32_dpp v189, v198 row_newbcast:10 row_mask:0xf bank_mask:0x8
    v_mov_b32 v190, 0x3f803f80
    s_nop 1
    v_mov_b32_dpp v190, v196 row_newbcast:12 row_mask:0xf bank_mask:0x2
    s_nop 1
    v_mov_b32_dpp v190, v197 row_newbcast:12 row_mask:0xf bank_mask:0x4
    s_nop 1
    v_mov_b32_dpp v190, v198 row_newbcast:12 row_mask:0xf bank_mask:0x8
    v_mov_b32 v191, 0x3f803f80
    s_nop 1
    v_mov_b32_dpp v191, v196 row_newbcast:14 row_mask:0xf bank_mask:0x2
    s_nop 1
    v_mov_b32_dpp v191, v197 row_newbcast:14 row_mask:0xf bank_mask:0x4
    s_nop 1
    v_mov_b32_dpp v191, v198 row_newbcast:14 row_mask:0xf bank_mask:0x8
    v_mov_b32_dpp v136, v28 row_newbcast:0 row_mask:0xf bank_mask:0xf
    v_mov_b32_dpp v137, v28 row_newbcast:1 row_mask:0xf bank_mask:0xf
    v_mov_b32_dpp v138, v28 row_newbcast:2 row_mask:0xf bank_mask:0xf
    v_mov_b32_dpp v139, v28 row_newbcast:3 row_mask:0xf bank_mask:0xf
    v_mov_b32_dpp v140, v28 row_newbcast:4 row_mask:0xf bank_mask:0xf
    v_mov_b32_dpp v141, v28 row_newbcast:5 row_mask:0xf bank_mask:0xf
    v_mov_b32_dpp v142, v28 row_newbcast:6 row_mask:0xf bank_mask:0xf
    v_mov_b32_dpp v143, v28 row_newbcast:7 row_mask:0xf bank_mask:0xf
    v_mov_b32_dpp v144, v28 row_newbcast:8 row_mask:0xf bank_mask:0xf
    v_mov_b32_dpp v145, v28 row_newbcast:9 row_mask:0xf bank_mask:0xf
    v_mov_b32_dpp v146, v28 row_newbcast:10 row_mask:0xf bank_mask:0xf
    v_mov_b32_dpp v147, v28 row_newbcast:11 row_mask:0xf bank_mask:0xf
    v_mov_b32_dpp v148, v28 row_newbcast:12 row_mask:0xf bank_mask:0xf
    v_mov_b32_dpp v149, v28 row_newbcast:13 row_mask:0xf bank_mask:0xf
    v_mov_b32_dpp v150, v28 row_newbcast:14 row_mask:0xf bank_mask:0xf
    v_mov_b32_dpp v151, v28 row_newbcast:15 row_mask:0xf bank_mask:0xf
    v_mov_b32_dpp v168, v30 row_newbcast:0 row_mask:0xf bank_mask:0xf
    v_mov_b32_dpp v169, v30 row_newbcast:1 row_mask:0xf bank_mask:0xf
    v_mov_b32_dpp v170, v30 row_newbcast:2 row_mask:0xf bank_mask:0xf
    v_mov_b32_dpp v171, v30 row_newbcast:3 row_mask:0xf bank_mask:0xf
    v_mov_b32_dpp v172, v30 row_newbcast:4 row_mask:0xf bank_mask:0xf
    v_mov_b32_dpp v173, v30 row_newbcast:5 row_mask:0xf bank_mask:0xf
    v_mov_b32_dpp v174, v30 row_newbcast:6 row_mask:0xf bank_mask:0xf
    v_mov_b32_dpp v175, v30 row_newbcast:7 row_mask:0xf bank_mask:0xf
    v_mov_b32_dpp v176, v30 row_newbcast:8 row_mask:0xf bank_mask:0xf
    v_mov_b32_dpp v177, v30 row_newbcast:9 row_mask:0xf bank_mask:0xf
    v_mov_b32_dpp v178, v30 row_newbcast:10 row_mask:0xf bank_mask:0xf
    v_mov_b32_dpp v179, v30 row_newbcast:11 row_mask:0xf bank_mask:0xf
    v_mov_b32_dpp v180, v30 row_newbcast:12 row_mask:0xf bank_mask:0xf
    v_mov_b32_dpp v181, v30 row_newbcast:13 row_mask:0xf bank_mask:0xf
    v_mov_b32_dpp v182, v30 row_newbcast:14 row_mask:0xf bank_mask:0xf
    v_mov_b32_dpp v183, v30 row_newbcast:15 row_mask:0xf bank_mask:0xf
    v_mov_b32_dpp v88, v29 row_newbcast:0 row_mask:0xf bank_mask:0xf
    v_mov_b32_dpp v89, v29 row_newbcast:1 row_mask:0xf bank_mask:0xf
    v_mov_b32_dpp v90, v29 row_newbcast:2 row_mask:0xf bank_mask:0xf
    v_mov_b32_dpp v91, v29 row_newbcast:3 row_mask:0xf bank_mask:0xf
    v_mov_b32_dpp v92, v29 row_newbcast:4 row_mask:0xf bank_mask:0xf
    v_mov_b32_dpp v93, v29 row_newbcast:5 row_mask:0xf bank_mask:0xf
    v_mov_b32_dpp v94, v29 row_newbcast:6 row_mask:0xf bank_mask:0xf
    v_mov_b32_dpp v95, v29 row_newbcast:7 row_mask:0xf bank_mask:0xf
    v_mov_b32_dpp v96, v29 row_newbcast:8 row_mask:0xf bank_mask:0xf
    v_mov_b32_dpp v97, v29 row_newbcast:9 row_mask:0xf bank_mask:0xf
    v_mov_b32_dpp v98, v29 row_newbcast:10 row_mask:0xf bank_mask:0xf
    v_mov_b32_dpp v99, v29 row_newbcast:11 row_mask:0xf bank_mask:0xf
    v_mov_b32_dpp v100, v29 row_newbcast:12 row_mask:0xf bank_mask:0xf
    v_mov_b32_dpp v101, v29 row_newbcast:13 row_mask:0xf bank_mask:0xf
    v_mov_b32_dpp v102, v29 row_newbcast:14 row_mask:0xf bank_mask:0xf
    v_mov_b32_dpp v103, v29 row_newbcast:15 row_mask:0xf bank_mask:0xf
    v_mov_b32_dpp v104, v31 row_newbcast:0 row_mask:0xf bank_mask:0xf
    v_mov_b32_dpp v105, v31 row_newbcast:1 row_mask:0xf bank_mask:0xf
    v_mov_b32_dpp v106, v31 row_newbcast:2 row_mask:0xf bank_mask:0xf
    v_mov_b32_dpp v107, v31 row_newbcast:3 row_mask:0xf bank_mask:0xf
    v_mov_b32_dpp v108, v31 row_newbcast:4 row_mask:0xf bank_mask:0xf
    v_mov_b32_dpp v109, v31 row_newbcast:5 row_mask:0xf bank_mask:0xf
    v_mov_b32_dpp v110, v31 row_newbcast:6 row_mask:0xf bank_mask:0xf
    v_mov_b32_dpp v111, v31 row_newbcast:7 row_mask:0xf bank_mask:0xf
    v_mov_b32_dpp v112, v31 row_newbcast:8 row_mask:0xf bank_mask:0xf
    v_mov_b32_dpp v113, v31 row_newbcast:9 row_mask:0xf bank_mask:0xf
    v_mov_b32_dpp v114, v31 row_newbcast:10 row_mask:0xf bank_mask:0xf
    v_mov_b32_dpp v115, v31 row_newbcast:11 row_mask:0xf bank_mask:0xf
    v_mov_b32_dpp v116, v31 row_newbcast:12 row_mask:0xf bank_mask:0xf
    v_mov_b32_dpp v117, v31 row_newbcast:13 row_mask:0xf bank_mask:0xf
    v_mov_b32_dpp v118, v31 row_newbcast:14 row_mask:0xf bank_mask:0xf
    v_mov_b32_dpp v119, v31 row_newbcast:15 row_mask:0xf bank_mask:0xf
    s_branch SCHK_31
SPOLL_30:
    s_load_dwordx2 s[24:25], s[32:33], s18 offset:0 glc
SCHK_31:
    s_add_u32 s5, s5, 1
    s_cmp_ge_u32 s5, 200000
    s_waitcnt lgkmcnt(0)
    s_cbranch_scc1 SDONE_32
    s_cmp_lg_u32 s24, s4
    s_cbranch_scc1 SPOLL_30
    s_cmp_lg_u32 s25, s4
    s_cbranch_scc1 SPOLL_30
SDONE_32:
    s_add_u32 s20, s17, s19
    buffer_load_dwordx4 v[224:227], v2, s[32:35], s20 offen sc1
    ds_read_b64_tr_b16 v[192:193], v36
    ds_read_b64_tr_b16 v[194:195], v36 offset:512
    ds_read_b64_tr_b16 v[196:197], v37
    ds_read_b64_tr_b16 v[198:199], v37 offset:512
    ds_read_b64_tr_b16 v[200:201], v38
    ds_read_b64_tr_b16 v[202:203], v38 offset:512
    ds_read_b64_tr_b16 v[204:205], v39
    ds_read_b64_tr_b16 v[206:207], v39 offset:512
    ds_read_b64_tr_b16 v[208:209], v36 offset:4096
    ds_read_b64_tr_b16 v[210:211], v36 offset:4608
    ds_read_b64_tr_b16 v[212:213], v37 offset:4096
    ds_read_b64_tr_b16 v[214:215], v37 offset:4608
    ds_read_b64_tr_b16 v[216:217], v38 offset:4096
    ds_read_b64_tr_b16 v[218:219], v38 offset:4608
    buffer_load_dwordx4 v[228:231], v2, s[32:35], s20 offen offset:1024 sc1
    buffer_load_dwordx4 v[232:235], v2, s[32:35], s20 offen offset:2048 sc1
    buffer_load_dwordx4 v[236:239], v2, s[32:35], s20 offen offset:3072 sc1
    s_barrier
    s_xor_b32 s96, s17, 4096
    s_add_u32 s20, s96, s19
    buffer_load_dwordx4 v[240:243], v2, s[32:35], s20 offen sc1
    buffer_load_dwordx4 v[244:247], v2, s[32:35], s20 offen offset:1024 sc1
    buffer_load_dwordx4 v[44:47], v2, s[32:35], s20 offen offset:2048 sc1
    buffer_load_dwordx4 v[48:51], v2, s[32:35], s20 offen offset:3072 sc1
    s_lshl_b32 s96, s21, 10
    s_add_u32 s13, s96, 14155776
    v_and_b32 v10, 15, v1
    v_lshlrev_b32 v10, 6, v10
    s_waitcnt vmcnt(7)
    s_waitcnt lgkmcnt(10)
    v_mfma_f32_16x16x32_bf16 v[120:123], v[192:195], v[224:227], 0
    ds_read_b64_tr_b16 v[220:221], v39 offset:4096
    ds_read_b64_tr_b16 v[222:223], v39 offset:4608
    v_mfma_f32_16x16x32_bf16 v[124:127], v[196:199], v[224:227], 0
    ds_read_b64_tr_b16 v[192:193], v36 offset:8192
    ds_read_b64_tr_b16 v[194:195], v36 offset:8704
    s_waitcnt lgkmcnt(10)
    v_mfma_f32_16x16x32_bf16 v[128:131], v[200:203], v[224:227], 0
    ds_read_b64_tr_b16 v[196:197], v37 offset:8192
    ds_read_b64_tr_b16 v[198:199], v37 offset:8704
    v_mfma_f32_16x16x32_bf16 v[132:135], v[204:207], v[224:227], 0
    ds_read_b64_tr_b16 v[200:201], v38 offset:8192
    ds_read_b64_tr_b16 v[202:203], v38 offset:8704
    s_xor_b32 s96, s17, 8192
    s_add_u32 s20, s96, s19
    buffer_load_dwordx4 v[224:227], v2, s[32:35], s20 offen sc1
    s_waitcnt vmcnt(7)
    s_waitcnt lgkmcnt(10)
    v_mfma_f32_16x16x32_bf16 v[120:123], v[208:211], v[228:231], v[120:123]
    ds_read_b64_tr_b16 v[204:205], v39 offset:8192
    ds_read_b64_tr_b16 v[206:207], v39 offset:8704
    v_mfma_f32_16x16x32_bf16 v[124:127], v[212:215], v[228:231], v[124:127]
    ds_read_b64_tr_b16 v[208:209], v36 offset:12288
    ds_read_b64_tr_b16 v[210:211], v36 offset:12800
    s_waitcnt lgkmcnt(10)
    v_mfma_f32_16x16x32_bf16 v[128:131], v[216:219], v[228:231], v[128:131]
    ds_read_b64_tr_b16 v[212:213], v37 offset:12288
    ds_read_b64_tr_b16 v[214:215], v37 offset:12800
    v_mfma_f32_16x16x32_bf16 v[132:135], v[220:223], v[228:231], v[132:135]
    ds_read_b64_tr_b16 v[216:217], v38 offset:12288
    ds_read_b64_tr_b16 v[218:219], v38 offset:12800
    buffer_load_dwordx4 v[228:231], v2, s[32:35], s20 offen offset:1024 sc1
    s_waitcnt vmcnt(7)
    s_waitcnt lgkmcnt(10)
    v_mfma_f32_16x16x32_bf16 v[120:123], v[192:195], v[232:235], v[120:123]
    ds_read_b64_tr_b16 v[220:221], v39 offset:12288
    ds_read_b64_tr_b16 v[222:223], v39 offset:12800
    v_mfma_f32_16x16x32_bf16 v[124:127], v[196:199], v[232:235], v[124:127]
    v_xor_b32 v36, 16384, v36
    ds_read_b64_tr_b16 v[192:193], v36
    ds_read_b64_tr_b16 v[194:195], v36 offset:512
    s_waitcnt lgkmcnt(10)
    v_mfma_f32_16x16x32_bf16 v[128:131], v[200:203], v[232:235], v[128:131]
    v_xor_b32 v37, 16384, v37
    ds_read_b64_tr_b16 v[196:197], v37
    ds_read_b64_tr_b16 v[198:199], v37 offset:512
    v_mfma_f32_16x16x32_bf16 v[132:135], v[204:207], v[232:235], v[132:135]
    v_xor_b32 v38, 16384, v38
    ds_read_b64_tr_b16 v[200:201], v38
    ds_read_b64_tr_b16 v[202:203], v38 offset:512
    buffer_load_dwordx4 v[232:235], v2, s[32:35], s20 offen offset:2048 sc1
    s_waitcnt vmcnt(7)
    s_waitcnt lgkmcnt(10)
    v_mfma_f32_16x16x32_bf16 v[120:123], v[208:211], v[236:239], v[120:123]
    v_xor_b32 v39, 16384, v39
    ds_read_b64_tr_b16 v[204:205], v39
    ds_read_b64_tr_b16 v[206:207], v39 offset:512
    v_mfma_f32_16x16x32_bf16 v[124:127], v[212:215], v[236:239], v[124:127]
    ds_read_b64_tr_b16 v[208:209], v36 offset:4096
    ds_read_b64_tr_b16 v[210:211], v36 offset:4608
    s_waitcnt lgkmcnt(10)
    v_mfma_f32_16x16x32_bf16 v[128:131], v[216:219], v[236:239], v[128:131]
    ds_read_b64_tr_b16 v[212:213], v37 offset:4096
    ds_read_b64_tr_b16 v[214:215], v37 offset:4608
    v_mfma_f32_16x16x32_bf16 v[132:135], v[220:223], v[236:239], v[132:135]
    ds_read_b64_tr_b16 v[216:217], v38 offset:4096
    ds_read_b64_tr_b16 v[218:219], v38 offset:4608
    buffer_load_dwordx4 v[236:239], v2, s[32:35], s20 offen offset:3072 sc1
    s_waitcnt vmcnt(7)
    s_waitcnt lgkmcnt(10)
    v_mfma_f32_16x16x32_bf16 v[120:123], v[192:195], v[240:243], v[120:123]
    ds_read_b64_tr_b16 v[220:221], v39 offset:4096
    ds_read_b64_tr_b16 v[222:223], v39 offset:4608
    v_mfma_f32_16x16x32_bf16 v[124:127], v[196:199], v[240:243], v[124:127]
    ds_read_b64_tr_b16 v[192:193], v36 offset:8192
    ds_read_b64_tr_b16 v[194:195], v36 offset:8704
    s_waitcnt lgkmcnt(10)
    v_mfma_f32_16x16x32_bf16 v[128:131], v[200:203], v[240:243], v[128:131]
    ds_read_b64_tr_b16 v[196:197], v37 offset:8192
    ds_read_b64_tr_b16 v[198:199], v37 offset:8704
    v_mfma_f32_16x16x32_bf16 v[132:135], v[204:207], v[240:243], v[132:135]
    ds_read_b64_tr_b16 v[200:201], v38 offset:8192
    ds_read_b64_tr_b16 v[202:203], v38 offset:8704
    s_xor_b32 s96, s17, 12288
    s_add_u32 s20, s96, s19
    buffer_load_dwordx4 v[240:243], v2, s[32:35], s20 offen sc1
    s_waitcnt vmcnt(7)
    s_waitcnt lgkmcnt(10)
    v_mfma_f32_16x16x32_bf16 v[120:123], v[208:211], v[244:247], v[120:123]
    ds_read_b64_tr_b16 v[204:205], v39 offset:8192
    ds_read_b64_tr_b16 v[206:207], v39 offset:8704
    v_mfma_f32_16x16x32_bf16 v[124:127], v[212:215], v[244:247], v[124:127]
    ds_read_b64_tr_b16 v[208:209], v36 offset:12288
    ds_read_b64_tr_b16 v[210:211], v36 offset:12800
    s_waitcnt lgkmcnt(10)
    v_mfma_f32_16x16x32_bf16 v[128:131], v[216:219], v[244:247], v[128:131]
    ds_read_b64_tr_b16 v[212:213], v37 offset:12288
    ds_read_b64_tr_b16 v[214:215], v37 offset:12800
    v_mfma_f32_16x16x32_bf16 v[132:135], v[220:223], v[244:247], v[132:135]
    ds_read_b64_tr_b16 v[216:217], v38 offset:12288
    ds_read_b64_tr_b16 v[218:219], v38 offset:12800
    buffer_load_dwordx4 v[244:247], v2, s[32:35], s20 offen offset:1024 sc1
    s_waitcnt vmcnt(7)
    s_waitcnt lgkmcnt(10)
    v_mfma_f32_16x16x32_bf16 v[120:123], v[192:195], v[44:47], v[120:123]
    ds_read_b64_tr_b16 v[220:221], v39 offset:12288
    ds_read_b64_tr_b16 v[222:223], v39 offset:12800
    v_mfma_f32_16x16x32_bf16 v[124:127], v[196:199], v[44:47], v[124:127]
    v_xor_b32 v36, 49152, v36
    ds_read_b64_tr_b16 v[192:193], v36
    ds_read_b64_tr_b16 v[194:195], v36 offset:512
    s_waitcnt lgkmcnt(10)
    v_mfma_f32_16x16x32_bf16 v[128:131], v[200:203], v[44:47], v[128:131]
    v_xor_b32 v37, 49152, v37
    ds_read_b64_tr_b16 v[196:197], v37
    ds_read_b64_tr_b16 v[198:199], v37 offset:512
    v_mfma_f32_16x16x32_bf16 v[132:135], v[204:207], v[44:47], v[132:135]
    v_xor_b32 v38, 49152, v38
    ds_read_b64_tr_b16 v[200:201], v38
    ds_read_b64_tr_b16 v[202:203], v38 offset:512
    buffer_load_dwordx4 v[44:47], v2, s[32:35], s20 offen offset:2048 sc1
    s_waitcnt vmcnt(7)
    s_waitcnt lgkmcnt(10)
    v_mfma_f32_16x16x32_bf16 v[120:123], v[208:211], v[48:51], v[120:123]
    v_xor_b32 v39, 49152, v39
    ds_read_b64_tr_b16 v[204:205], v39
    ds_read_b64_tr_b16 v[206:207], v39 offset:512
    v_mfma_f32_16x16x32_bf16 v[124:127], v[212:215], v[48:51], v[124:127]
    ds_read_b64_tr_b16 v[208:209], v36 offset:4096
    ds_read_b64_tr_b16 v[210:211], v36 offset:4608
    s_waitcnt lgkmcnt(10)
    v_mfma_f32_16x16x32_bf16 v[128:131], v[216:219], v[48:51], v[128:131]
    ds_read_b64_tr_b16 v[212:213], v37 offset:4096
    ds_read_b64_tr_b16 v[214:215], v37 offset:4608
    v_mfma_f32_16x16x32_bf16 v[132:135], v[220:223], v[48:51], v[132:135]
    ds_read_b64_tr_b16 v[216:217], v38 offset:4096
    ds_read_b64_tr_b16 v[218:219], v38 offset:4608
    buffer_load_dwordx4 v[48:51], v2, s[32:35], s20 offen offset:3072 sc1
    s_waitcnt vmcnt(7)
    s_waitcnt lgkmcnt(10)
    v_mfma_f32_16x16x32_bf16 v[120:123], v[192:195], v[224:227], v[120:123]
    ds_read_b64_tr_b16 v[220:221], v39 offset:4096
    ds_read_b64_tr_b16 v[222:223], v39 offset:4608
L_PAD8:
    s_cbranch_execz L_RET8
    v_mfma_f32_16x16x32_bf16 v[124:127], v[196:199], v[224:227], v[124:127]
    ds_read_b64_tr_b16 v[192:193], v36 offset:8192
    ds_read_b64_tr_b16 v[194:195], v36 offset:8704
    s_waitcnt lgkmcnt(10)
    v_mfma_f32_16x16x32_bf16 v[128:131], v[200:203], v[224:227], v[128:131]
    ds_read_b64_tr_b16 v[196:197], v37 offset:8192
    ds_read_b64_tr_b16 v[198:199], v37 offset:8704
    v_mfma_f32_16x16x32_bf16 v[132:135], v[204:207], v[224:227], v[132:135]
    ds_read_b64_tr_b16 v[200:201], v38 offset:8192
    ds_read_b64_tr_b16 v[202:203], v38 offset:8704
    s_xor_b32 s96, s17, 16384
    s_add_u32 s20, s96, s19
    buffer_load_dwordx4 v[224:227], v2, s[32:35], s20 offen sc1
    s_waitcnt vmcnt(7)
    s_waitcnt lgkmcnt(10)
    v_mfma_f32_16x16x32_bf16 v[120:123], v[208:211], v[228:231], v[120:123]
    ds_read_b64_tr_b16 v[204:205], v39 offset:8192
    ds_read_b64_tr_b16 v[206:207], v39 offset:8704
    v_mfma_f32_16x16x32_bf16 v[124:127], v[212:215], v[228:231], v[124:127]
    ds_read_b64_tr_b16 v[208:209], v36 offset:12288
    ds_read_b64_tr_b16 v[210:211], v36 offset:12800
    s_waitcnt lgkmcnt(10)
    v_mfma_f32_16x16x32_bf16 v[128:131], v[216:219], v[228:231], v[128:131]
    ds_read_b64_tr_b16 v[212:213], v37 offset:12288
    ds_read_b64_tr_b16 v[214:215], v37 offset:12800
    v_mfma_f32_16x16x32_bf16 v[132:135], v[220:223], v[228:231], v[132:135]
    ds_read_b64_tr_b16 v[216:217], v38 offset:12288
    ds_read_b64_tr_b16 v[218:219], v38 offset:12800
    buffer_load_dwordx4 v[228:231], v2, s[32:35], s20 offen offset:1024 sc1
    s_waitcnt vmcnt(7)
    s_waitcnt lgkmcnt(10)
    v_mfma_f32_16x16x32_bf16 v[120:123], v[192:195], v[232:235], v[120:123]
    ds_read_b64_tr_b16 v[220:221], v39 offset:12288
    ds_read_b64_tr_b16 v[222:223], v39 offset:12800
    v_mfma_f32_16x16x32_bf16 v[124:127], v[196:199], v[232:235], v[124:127]
    v_xor_b32 v36, 16384, v36
    ds_read_b64_tr_b16 v[192:193], v36
    ds_read_b64_tr_b16 v[194:195], v36 offset:512
    s_waitcnt lgkmcnt(10)
    v_mfma_f32_16x16x32_bf16 v[128:131], v[200:203], v[232:235], v[128:131]
    v_xor_b32 v37, 16384, v37
    ds_read_b64_tr_b16 v[196:197], v37
    ds_read_b64_tr_b16 v[198:199], v37 offset:512
    v_mfma_f32_16x16x32_bf16 v[132:135], v[204:207], v[232:235], v[132:135]
    v_xor_b32 v38, 16384, v38
    ds_read_b64_tr_b16 v[200:201], v38
    ds_read_b64_tr_b16 v[202:203], v38 offset:512
    buffer_load_dwordx4 v[232:235], v2, s[32:35], s20 offen offset:2048 sc1
    s_waitcnt vmcnt(7)
    s_waitcnt lgkmcnt(10)
    v_mfma_f32_16x16x32_bf16 v[120:123], v[208:211], v[236:239], v[120:123]
    v_xor_b32 v39, 16384, v39
    ds_read_b64_tr_b16 v[204:205], v39
    ds_read_b64_tr_b16 v[206:207], v39 offset:512
    v_mfma_f32_16x16x32_bf16 v[124:127], v[212:215], v[236:239], v[124:127]
    ds_read_b64_tr_b16 v[208:209], v36 offset:4096
    ds_read_b64_tr_b16 v[210:211], v36 offset:4608
    s_waitcnt lgkmcnt(10)
    v_mfma_f32_16x16x32_bf16 v[128:131], v[216:219], v[236:239], v[128:131]
    ds_read_b64_tr_b16 v[212:213], v37 offset:4096
    ds_read_b64_tr_b16 v[214:215], v37 offset:4608
    v_mfma_f32_16x16x32_bf16 v[132:135], v[220:223], v[236:239], v[132:135]
    ds_read_b64_tr_b16 v[216:217], v38 offset:4096
    ds_read_b64_tr_b16 v[218:219], v38 offset:4608
    buffer_load_dwordx4 v[236:239], v2, s[32:35], s20 offen offset:3072 sc1
    s_waitcnt vmcnt(7)
    s_waitcnt lgkmcnt(10)
    v_mfma_f32_16x16x32_bf16 v[120:123], v[192:195], v[240:243], v[120:123]
    ds_read_b64_tr_b16 v[220:221], v39 offset:4096
    ds_read_b64_tr_b16 v[222:223], v39 offset:4608
    v_mfma_f32_16x16x32_bf16 v[124:127], v[196:199], v[240:243], v[124:127]
    ds_read_b64_tr_b16 v[192:193], v36 offset:8192
    ds_read_b64_tr_b16 v[194:195], v36 offset:8704
    s_waitcnt lgkmcnt(10)
    v_mfma_f32_16x16x32_bf16 v[128:131], v[200:203], v[240:243], v[128:131]
    ds_read_b64_tr_b16 v[196:197], v37 offset:8192
    ds_read_b64_tr_b16 v[198:199], v37 offset:8704
    v_mfma_f32_16x16x32_bf16 v[132:135], v[204:207], v[240:243], v[132:135]
    ds_read_b64_tr_b16 v[200:201], v38 offset:8192
    ds_read_b64_tr_b16 v[202:203], v38 offset:8704
    s_xor_b32 s96, s17, 20480
    s_add_u32 s20, s96, s19
    buffer_load_dwordx4 v[240:243], v2, s[32:35], s20 offen sc1
    s_waitcnt vmcnt(7)
    s_waitcnt lgkmcnt(10)
    v_mfma_f32_16x16x32_bf16 v[120:123], v[208:211], v[244:247], v[120:123]
    ds_read_b64_tr_b16 v[204:205], v39 offset:8192
    ds_read_b64_tr_b16 v[206:207], v39 offset:8704
    v_mfma_f32_16x16x32_bf16 v[124:127], v[212:215], v[244:247], v[124:127]
    ds_read_b64_tr_b16 v[208:209], v36 offset:12288
    ds_read_b64_tr_b16 v[210:211], v36 offset:12800
    s_waitcnt lgkmcnt(10)
    v_mfma_f32_16x16x32_bf16 v[128:131], v[216:219], v[244:247], v[128:131]
    ds_read_b64_tr_b16 v[212:213], v37 offset:12288
    ds_read_b64_tr_b16 v[214:215], v37 offset:12800
    v_mfma_f32_16x16x32_bf16 v[132:135], v[220:223], v[244:247], v[132:135]
    ds_read_b64_tr_b16 v[216:217], v38 offset:12288
    ds_read_b64_tr_b16 v[218:219], v38 offset:12800
    buffer_load_dwordx4 v[244:247], v2, s[32:35], s20 offen offset:1024 sc1
    s_waitcnt vmcnt(7)
    s_waitcnt lgkmcnt(10)
    v_mfma_f32_16x16x32_bf16 v[120:123], v[192:195], v[44:47], v[120:123]
    ds_read_b64_tr_b16 v[220:221], v39 offset:12288
    ds_read_b64_tr_b16 v[222:223], v39 offset:12800
    v_mfma_f32_16x16x32_bf16 v[124:127], v[196:199], v[44:47], v[124:127]
    v_xor_b32 v36, 114688, v36
    ds_read_b64_tr_b16 v[192:193], v36
    ds_read_b64_tr_b16 v[194:195], v36 offset:512
    s_waitcnt lgkmcnt(10)
    v_mfma_f32_16x16x32_bf16 v[128:131], v[200:203], v[44:47], v[128:131]
    v_xor_b32 v37, 114688, v37
    ds_read_b64_tr_b16 v[196:197], v37
    ds_read_b64_tr_b16 v[198:199], v37 offset:512
    v_mfma_f32_16x16x32_bf16 v[132:135], v[204:207], v[44:47], v[132:135]
    v_xor_b32 v38, 114688, v38
    ds_read_b64_tr_b16 v[200:201], v38
    ds_read_b64_tr_b16 v[202:203], v38 offset:512
    buffer_load_dwordx4 v[44:47], v2, s[32:35], s20 offen offset:2048 sc1
    s_waitcnt vmcnt(7)
    s_waitcnt lgkmcnt(10)
    v_mfma_f32_16x16x32_bf16 v[120:123], v[208:211], v[48:51], v[120:123]
    v_xor_b32 v39, 114688, v39
    ds_read_b64_tr_b16 v[204:205], v39
    ds_read_b64_tr_b16 v[206:207], v39 offset:512
    v_mfma_f32_16x16x32_bf16 v[124:127], v[212:215], v[48:51], v[124:127]
    ds_read_b64_tr_b16 v[208:209], v36 offset:4096
    ds_read_b64_tr_b16 v[210:211], v36 offset:4608
    s_waitcnt lgkmcnt(10)
    v_mfma_f32_16x16x32_bf16 v[128:131], v[216:219], v[48:51], v[128:131]
    ds_read_b64_tr_b16 v[212:213], v37 offset:4096
    ds_read_b64_tr_b16 v[214:215], v37 offset:4608
    v_mfma_f32_16x16x32_bf16 v[132:135], v[220:223], v[48:51], v[132:135]
    ds_read_b64_tr_b16 v[216:217], v38 offset:4096
    ds_read_b64_tr_b16 v[218:219], v38 offset:4608
    buffer_load_dwordx4 v[48:51], v2, s[32:35], s20 offen offset:3072 sc1
    s_waitcnt vmcnt(7)
    s_waitcnt lgkmcnt(10)
    v_mfma_f32_16x16x32_bf16 v[120:123], v[192:195], v[224:227], v[120:123]
    ds_read_b64_tr_b16 v[220:221], v39 offset:4096
    ds_read_b64_tr_b16 v[222:223], v39 offset:4608
    v_mfma_f32_16x16x32_bf16 v[124:127], v[196:199], v[224:227], v[124:127]
    ds_read_b64_tr_b16 v[192:193], v36 offset:8192
    ds_read_b64_tr_b16 v[194:195], v36 offset:8704
    s_waitcnt lgkmcnt(10)
    v_mfma_f32_16x16x32_bf16 v[128:131], v[200:203], v[224:227], v[128:131]
    ds_read_b64_tr_b16 v[196:197], v37 offset:8192
    ds_read_b64_tr_b16 v[198:199], v37 offset:8704
    v_mfma_f32_16x16x32_bf16 v[132:135], v[204:207], v[224:227], v[132:135]
    ds_read_b64_tr_b16 v[200:201], v38 offset:8192
    ds_read_b64_tr_b16 v[202:203], v38 offset:8704
    s_xor_b32 s96, s17, 24576
    s_add_u32 s20, s96, s19
    buffer_load_dwordx4 v[224:227], v2, s[32:35], s20 offen sc1
    s_waitcnt vmcnt(7)
    s_waitcnt lgkmcnt(10)
    v_mfma_f32_16x16x32_bf16 v[120:123], v[208:211], v[228:231], v[120:123]
    ds_read_b64_tr_b16 v[204:205], v39 offset:8192
    ds_read_b64_tr_b16 v[206:207], v39 offset:8704
    v_mfma_f32_16x16x32_bf16 v[124:127], v[212:215], v[228:231], v[124:127]
    ds_read_b64_tr_b16 v[208:209], v36 offset:12288
    ds_read_b64_tr_b16 v[210:211], v36 offset:12800
    s_waitcnt lgkmcnt(10)
    v_mfma_f32_16x16x32_bf16 v[128:131], v[216:219], v[228:231], v[128:131]
    ds_read_b64_tr_b16 v[212:213], v37 offset:12288
    ds_read_b64_tr_b16 v[214:215], v37 offset:12800
    v_mfma_f32_16x16x32_bf16 v[132:135], v[220:223], v[228:231], v[132:135]
    ds_read_b64_tr_b16 v[216:217], v38 offset:12288
    ds_read_b64_tr_b16 v[218:219], v38 offset:12800
    buffer_load_dwordx4 v[228:231], v2, s[32:35], s20 offen offset:1024 sc1
    s_waitcnt vmcnt(7)
    s_waitcnt lgkmcnt(10)
    v_mfma_f32_16x16x32_bf16 v[120:123], v[192:195], v[232:235], v[120:123]
    ds_read_b64_tr_b16 v[220:221], v39 offset:12288
    ds_read_b64_tr_b16 v[222:223], v39 offset:12800
    v_mfma_f32_16x16x32_bf16 v[124:127], v[196:199], v[232:235], v[124:127]
    v_xor_b32 v36, 16384, v36
    ds_read_b64_tr_b16 v[192:193], v36
    ds_read_b64_tr_b16 v[194:195], v36 offset:512
    s_waitcnt lgkmcnt(10)
    v_mfma_f32_16x16x32_bf16 v[128:131], v[200:203], v[232:235], v[128:131]
    v_xor_b32 v37, 16384, v37
    ds_read_b64_tr_b16 v[196:197], v37
    ds_read_b64_tr_b16 v[198:199], v37 offset:512
    v_mfma_f32_16x16x32_bf16 v[132:135], v[204:207], v[232:235], v[132:135]
    v_xor_b32 v38, 16384, v38
    ds_read_b64_tr_b16 v[200:201], v38
    ds_read_b64_tr_b16 v[202:203], v38 offset:512
    buffer_load_dwordx4 v[232:235], v2, s[32:35], s20 offen offset:2048 sc1
    s_waitcnt vmcnt(7)
    s_waitcnt lgkmcnt(10)
    v_mfma_f32_16x16x32_bf16 v[120:123], v[208:211], v[236:239], v[120:123]
    v_xor_b32 v39, 16384, v39
    ds_read_b64_tr_b16 v[204:205], v39
    ds_read_b64_tr_b16 v[206:207], v39 offset:512
    v_mfma_f32_16x16x32_bf16 v[124:127], v[212:215], v[236:239], v[124:127]
    ds_read_b64_tr_b16 v[208:209], v36 offset:4096
    ds_read_b64_tr_b16 v[210:211], v36 offset:4608
    s_waitcnt lgkmcnt(10)
    v_mfma_f32_16x16x32_bf16 v[128:131], v[216:219], v[236:239], v[128:131]
    ds_read_b64_tr_b16 v[212:213], v37 offset:4096
    ds_read_b64_tr_b16 v[214:215], v37 offset:4608
    v_mfma_f32_16x16x32_bf16 v[132:135], v[220:223], v[236:239], v[132:135]
    ds_read_b64_tr_b16 v[216:217], v38 offset:4096
    ds_read_b64_tr_b16 v[218:219], v38 offset:4608
    buffer_load_dwordx4 v[236:239], v2, s[32:35], s20 offen offset:3072 sc1
    s_waitcnt vmcnt(7)
    s_waitcnt lgkmcnt(10)
    v_mfma_f32_16x16x32_bf16 v[120:123], v[192:195], v[240:243], v[120:123]
    ds_read_b64_tr_b16 v[220:221], v39 offset:4096
    ds_read_b64_tr_b16 v[222:223], v39 offset:4608
    v_mfma_f32_16x16x32_bf16 v[124:127], v[196:199], v[240:243], v[124:127]
    ds_read_b64_tr_b16 v[192:193], v36 offset:8192
    ds_read_b64_tr_b16 v[194:195], v36 offset:8704
    s_waitcnt lgkmcnt(10)
    v_mfma_f32_16x16x32_bf16 v[128:131], v[200:203], v[240:243], v[128:131]
    ds_read_b64_tr_b16 v[196:197], v37 offset:8192
    ds_read_b64_tr_b16 v[198:199], v37 offset:8704
    v_mfma_f32_16x16x32_bf16 v[132:135], v[204:207], v[240:243], v[132:135]
    ds_read_b64_tr_b16 v[200:201], v38 offset:8192
    ds_read_b64_tr_b16 v[202:203], v38 offset:8704
    s_xor_b32 s96, s17, 28672
    s_add_u32 s20, s96, s19
    buffer_load_dwordx4 v[240:243], v2, s[32:35], s20 offen sc1
    s_waitcnt vmcnt(7)
    s_waitcnt lgkmcnt(10)
    v_mfma_f32_16x16x32_bf16 v[120:123], v[208:211], v[244:247], v[120:123]
    ds_read_b64_tr_b16 v[204:205], v39 offset:8192
    ds_read_b64_tr_b16 v[206:207], v39 offset:8704
    v_mfma_f32_16x16x32_bf16 v[124:127], v[212:215], v[244:247], v[124:127]
    ds_read_b64_tr_b16 v[208:209], v36 offset:12288
    ds_read_b64_tr_b16 v[210:211], v36 offset:12800
    s_waitcnt lgkmcnt(10)
    v_mfma_f32_16x16x32_bf16 v[128:131], v[216:219], v[244:247], v[128:131]
    ds_read_b64_tr_b16 v[212:213], v37 offset:12288
    ds_read_b64_tr_b16 v[214:215], v37 offset:12800
    v_mfma_f32_16x16x32_bf16 v[132:135], v[220:223], v[244:247], v[132:135]
    ds_read_b64_tr_b16 v[216:217], v38 offset:12288
    ds_read_b64_tr_b16 v[218:219], v38 offset:12800
    buffer_load_dwordx4 v[244:247], v2, s[32:35], s20 offen offset:1024 sc1
    s_waitcnt vmcnt(7)
    s_waitcnt lgkmcnt(10)
    v_mfma_f32_16x16x32_bf16 v[120:123], v[192:195], v[44:47], v[120:123]
    ds_read_b64_tr_b16 v[220:221], v39 offset:12288
    ds_read_b64_tr_b16 v[222:223], v39 offset:12800
    v_mfma_f32_16x16x32_bf16 v[124:127], v[196:199], v[44:47], v[124:127]
    v_xor_b32 v36, 49152, v36
    ds_read_b64_tr_b16 v[192:193], v36
    ds_read_b64_tr_b16 v[194:195], v36 offset:512
    s_waitcnt lgkmcnt(10)
    v_mfma_f32_16x16x32_bf16 v[128:131], v[200:203], v[44:47], v[128:131]
    v_xor_b32 v37, 49152, v37
    ds_read_b64_tr_b16 v[196:197], v37
    ds_read_b64_tr_b16 v[198:199], v37 offset:512
    v_mfma_f32_16x16x32_bf16 v[132:135], v[204:207], v[44:47], v[132:135]
    v_xor_b32 v38, 49152, v38
    ds_read_b64_tr_b16 v[200:201], v38
    ds_read_b64_tr_b16 v[202:203], v38 offset:512
    buffer_load_dwordx4 v[44:47], v2, s[32:35], s20 offen offset:2048 sc1
    s_waitcnt vmcnt(7)
    s_waitcnt lgkmcnt(10)
    v_mfma_f32_16x16x32_bf16 v[120:123], v[208:211], v[48:51], v[120:123]
    v_xor_b32 v39, 49152, v39
    ds_read_b64_tr_b16 v[204:205], v39
    ds_read_b64_tr_b16 v[206:207], v39 offset:512
    v_mfma_f32_16x16x32_bf16 v[124:127], v[212:215], v[48:51], v[124:127]
    ds_read_b64_tr_b16 v[208:209], v36 offset:4096
    ds_read_b64_tr_b16 v[210:211], v36 offset:4608
    s_waitcnt lgkmcnt(10)
    v_mfma_f32_16x16x32_bf16 v[128:131], v[216:219], v[48:51], v[128:131]
    ds_read_b64_tr_b16 v[212:213], v37 offset:4096
    ds_read_b64_tr_b16 v[214:215], v37 offset:4608
    v_mfma_f32_16x16x32_bf16 v[132:135], v[220:223], v[48:51], v[132:135]
    ds_read_b64_tr_b16 v[216:217], v38 offset:4096
    ds_read_b64_tr_b16 v[218:219], v38 offset:4608
    buffer_load_dwordx4 v[48:51], v2, s[32:35], s20 offen offset:3072 sc1
    buffer_load_dwordx2 v[40:41], v10, s[32:35], s13 offen sc1
    s_cmp_ge_u32 s3, 4
    s_cbranch_scc1 L_FH_33
    s_mov_b32 s82, s80
    buffer_load_dwordx4 v[56:59], v27, s[56:59], s82 offen nt
    s_add_u32 s82, s80, 917504
    buffer_load_dwordx4 v[60:63], v27, s[56:59], s82 offen nt
    s_add_u32 s82, s80, 57344
    buffer_load_dwordx4 v[64:67], v27, s[56:59], s82 offen nt
    s_add_u32 s82, s80, 974848
    buffer_load_dwordx4 v[68:71], v27, s[56:59], s82 offen nt
L_FH_33:
    s_waitcnt vmcnt(8)
    s_waitcnt lgkmcnt(10)
    v_mfma_f32_16x16x32_bf16 v[120:123], v[192:195], v[224:227], v[120:123]
    ds_read_b64_tr_b16 v[220:221], v39 offset:4096
    ds_read_b64_tr_b16 v[222:223], v39 offset:4608
    v_mfma_f32_16x16x32_bf16 v[124:127], v[196:199], v[224:227], v[124:127]
    ds_read_b64_tr_b16 v[192:193], v36 offset:8192
    ds_read_b64_tr_b16 v[194:195], v36 offset:8704
    s_waitcnt lgkmcnt(10)
    v_mfma_f32_16x16x32_bf16 v[128:131], v[200:203], v[224:227], v[128:131]
    ds_read_b64_tr_b16 v[196:197], v37 offset:8192
    ds_read_b64_tr_b16 v[198:199], v37 offset:8704
    v_mfma_f32_16x16x32_bf16 v[132:135], v[204:207], v[224:227], v[132:135]
    ds_read_b64_tr_b16 v[200:201], v38 offset:8192
    ds_read_b64_tr_b16 v[202:203], v38 offset:8704
    s_waitcnt vmcnt(7)
    s_waitcnt lgkmcnt(10)
    v_mfma_f32_16x16x32_bf16 v[120:123], v[208:211], v[228:231], v[120:123]
    ds_read_b64_tr_b16 v[204:205], v39 offset:8192
    ds_read_b64_tr_b16 v[206:207], v39 offset:8704
    v_mfma_f32_16x16x32_bf16 v[124:127], v[212:215], v[228:231], v[124:127]
    ds_read_b64_tr_b16 v[208:209], v36 offset:12288
    ds_read_b64_tr_b16 v[210:211], v36 offset:12800
    s_waitcnt lgkmcnt(10)
    v_mfma_f32_16x16x32_bf16 v[128:131], v[216:219], v[228:231], v[128:131]
    ds_read_b64_tr_b16 v[212:213], v37 offset:12288
    ds_read_b64_tr_b16 v[214:215], v37 offset:12800
    v_mfma_f32_16x16x32_bf16 v[132:135], v[220:223], v[228:231], v[132:135]
    ds_read_b64_tr_b16 v[216:217], v38 offset:12288
    ds_read_b64_tr_b16 v[218:219], v38 offset:12800
    s_waitcnt vmcnt(6)
    s_waitcnt lgkmcnt(10)
    v_mfma_f32_16x16x32_bf16 v[120:123], v[192:195], v[232:235], v[120:123]
    ds_read_b64_tr_b16 v[220:221], v39 offset:12288
    ds_read_b64_tr_b16 v[222:223], v39 offset:12800
    v_mfma_f32_16x16x32_bf16 v[124:127], v[196:199], v[232:235], v[124:127]
    v_xor_b32 v36, 16384, v36
    ds_read_b64_tr_b16 v[192:193], v36
    ds_read_b64_tr_b16 v[194:195], v36 offset:512
    s_waitcnt lgkmcnt(10)
    v_mfma_f32_16x16x32_bf16 v[128:131], v[200:203], v[232:235], v[128:131]
    v_xor_b32 v37, 16384, v37
    ds_read_b64_tr_b16 v[196:197], v37
    ds_read_b64_tr_b16 v[198:199], v37 offset:512
    v_mfma_f32_16x16x32_bf16 v[132:135], v[204:207], v[232:235], v[132:135]
    v_xor_b32 v38, 16384, v38
    ds_read_b64_tr_b16 v[200:201], v38
    ds_read_b64_tr_b16 v[202:203], v38 offset:512
    s_waitcnt vmcnt(5)
    s_waitcnt lgkmcnt(10)
    v_mfma_f32_16x16x32_bf16 v[120:123], v[208:211], v[236:239], v[120:123]
    v_xor_b32 v39, 16384, v39
    ds_read_b64_tr_b16 v[204:205], v39
    ds_read_b64_tr_b16 v[206:207], v39 offset:512
    v_mfma_f32_16x16x32_bf16 v[124:127], v[212:215], v[236:239], v[124:127]
    ds_read_b64_tr_b16 v[208:209], v36 offset:4096
    ds_read_b64_tr_b16 v[210:211], v36 offset:4608
    s_waitcnt lgkmcnt(10)
    v_mfma_f32_16x16x32_bf16 v[128:131], v[216:219], v[236:239], v[128:131]
    ds_read_b64_tr_b16 v[212:213], v37 offset:4096
    ds_read_b64_tr_b16 v[214:215], v37 offset:4608
    v_mfma_f32_16x16x32_bf16 v[132:135], v[220:223], v[236:239], v[132:135]
    ds_read_b64_tr_b16 v[216:217], v38 offset:4096
    ds_read_b64_tr_b16 v[218:219], v38 offset:4608
    s_waitcnt vmcnt(4)
    s_waitcnt lgkmcnt(10)
    v_mfma_f32_16x16x32_bf16 v[120:123], v[192:195], v[240:243], v[120:123]
    ds_read_b64_tr_b16 v[220:221], v39 offset:4096
    ds_read_b64_tr_b16 v[222:223], v39 offset:4608
    v_mfma_f32_16x16x32_bf16 v[124:127], v[196:199], v[240:243], v[124:127]
    ds_read_b64_tr_b16 v[192:193], v36 offset:8192
    ds_read_b64_tr_b16 v[194:195], v36 offset:8704
    s_waitcnt lgkmcnt(10)
    v_mfma_f32_16x16x32_bf16 v[128:131], v[200:203], v[240:243], v[128:131]
    ds_read_b64_tr_b16 v[196:197], v37 offset:8192
    ds_read_b64_tr_b16 v[198:199], v37 offset:8704
    v_mfma_f32_16x16x32_bf16 v[132:135], v[204:207], v[240:243], v[132:135]
    ds_read_b64_tr_b16 v[200:201], v38 offset:8192
    ds_read_b64_tr_b16 v[202:203], v38 offset:8704
    s_waitcnt vmcnt(3)
    s_waitcnt lgkmcnt(10)
    v_mfma_f32_16x16x32_bf16 v[120:123], v[208:211], v[244:247], v[120:123]
    ds_read_b64_tr_b16 v[204:205], v39 offset:8192
    ds_read_b64_tr_b16 v[206:207], v39 offset:8704
    v_mfma_f32_16x16x32_bf16 v[124:127], v[212:215], v[244:247], v[124:127]
    ds_read_b64_tr_b16 v[208:209], v36 offset:12288
    ds_read_b64_tr_b16 v[210:211], v36 offset:12800
    s_waitcnt lgkmcnt(10)
    v_mfma_f32_16x16x32_bf16 v[128:131], v[216:219], v[244:247], v[128:131]
    ds_read_b64_tr_b16 v[212:213], v37 offset:12288
    ds_read_b64_tr_b16 v[214:215], v37 offset:12800
    v_mfma_f32_16x16x32_bf16 v[132:135], v[220:223], v[244:247], v[132:135]
    ds_read_b64_tr_b16 v[216:217], v38 offset:12288
    ds_read_b64_tr_b16 v[218:219], v38 offset:12800
    s_waitcnt vmcnt(2)
    s_waitcnt lgkmcnt(10)
    v_mfma_f32_16x16x32_bf16 v[120:123], v[192:195], v[44:47], v[120:123]
    ds_read_b64_tr_b16 v[220:221], v39 offset:12288
    ds_read_b64_tr_b16 v[222:223], v39 offset:12800
    v_mfma_f32_16x16x32_bf16 v[124:127], v[196:199], v[44:47], v[124:127]
    s_waitcnt lgkmcnt(8)
    v_mfma_f32_16x16x32_bf16 v[128:131], v[200:203], v[44:47], v[128:131]
    v_mfma_f32_16x16x32_bf16 v[132:135], v[204:207], v[44:47], v[132:135]
    s_waitcnt vmcnt(1)
    s_waitcnt lgkmcnt(4)
    v_mfma_f32_16x16x32_bf16 v[120:123], v[208:211], v[48:51], v[120:123]
    v_mfma_f32_16x16x32_bf16 v[124:127], v[212:215], v[48:51], v[124:127]
    s_waitcnt lgkmcnt(0)
    v_mfma_f32_16x16x32_bf16 v[128:131], v[216:219], v[48:51], v[128:131]
    v_mfma_f32_16x16x32_bf16 v[132:135], v[220:223], v[48:51], v[132:135]
    s_lshl3_add_u32 s96, s21, s3
    s_lshl4_add_u32 s97, s96, s12
    s_lshl_b32 s98, s97, 8
    s_add_u32 s14, s98, 12582912
    v_and_b32 v28, 15, v1
    v_lshlrev_b32 v28, 4, v28
    v_lshrrev_b32 v9, 4, v1
    v_lshl_add_u32 v28, v9, 2, v28
    v_cvt_pk_bf16_f32 v120, 0, v120
    v_cvt_pk_bf16_f32 v121, 0, v121
    v_cvt_pk_bf16_f32 v122, 0, v122
    v_cvt_pk_bf16_f32 v123, 0, v123
    v_cvt_pk_bf16_f32 v124, 0, v124
    v_cvt_pk_bf16_f32 v125, 0, v125
    v_cvt_pk_bf16_f32 v126, 0, v126
    v_cvt_pk_bf16_f32 v127, 0, v127
    v_pk_mul_f32 v[120:121], v[120:121], v[136:137]
    v_pk_mul_f32 v[122:123], v[122:123], v[138:139]
    v_pk_mul_f32 v[124:125], v[124:125], v[140:141]
    v_pk_mul_f32 v[126:127], v[126:127], v[142:143]
    v_cvt_pk_bf16_f32 v120, 0, v120
    v_cvt_pk_bf16_f32 v121, 0, v121
    v_cvt_pk_bf16_f32 v122, 0, v122
    v_cvt_pk_bf16_f32 v123, 0, v123
    v_cvt_pk_bf16_f32 v124, 0, v124
    v_cvt_pk_bf16_f32 v125, 0, v125
    v_cvt_pk_bf16_f32 v126, 0, v126
    v_cvt_pk_bf16_f32 v127, 0, v127
    v_pk_add_f32 v[120:121], v[120:121], v[152:153]
    v_pk_add_f32 v[122:123], v[122:123], v[154:155]
    v_pk_add_f32 v[124:125], v[124:125], v[156:157]
    v_pk_add_f32 v[126:127], v[126:127], v[158:159]
    v_cvt_pk_bf16_f32 v12, v120, v121
    v_cvt_pk_bf16_f32 v13, v122, v123
    v_cvt_pk_bf16_f32 v14, v124, v125
    v_cvt_pk_bf16_f32 v15, v126, v127
    v_dot2_f32_bf16 v4, v12, v12, 0
    v_dot2_f32_bf16 v5, v13, v13, 0
    v_dot2_f32_bf16 v4, v14, v14, v4
    v_dot2_f32_bf16 v5, v15, v15, v5
    v_mfma_f32_16x16x32_bf16 v[240:243], v[184:187], v[12:15], 0
    v_cvt_pk_bf16_f32 v128, 0, v128
    v_cvt_pk_bf16_f32 v129, 0, v129
    v_cvt_pk_bf16_f32 v130, 0, v130
    v_cvt_pk_bf16_f32 v131, 0, v131
    v_cvt_pk_bf16_f32 v132, 0, v132
    v_cvt_pk_bf16_f32 v133, 0, v133
    v_cvt_pk_bf16_f32 v134, 0, v134
    v_cvt_pk_bf16_f32 v135, 0, v135
    v_pk_mul_f32 v[128:129], v[128:129], v[144:145]
    v_pk_mul_f32 v[130:131], v[130:131], v[146:147]
    v_pk_mul_f32 v[132:133], v[132:133], v[148:149]
    v_pk_mul_f32 v[134:135], v[134:135], v[150:151]
    v_cvt_pk_bf16_f32 v128, 0, v128
    v_cvt_pk_bf16_f32 v129, 0, v129
    v_cvt_pk_bf16_f32 v130, 0, v130
    v_cvt_pk_bf16_f32 v131, 0, v131
    v_cvt_pk_bf16_f32 v132, 0, v132
    v_cvt_pk_bf16_f32 v133, 0, v133
    v_cvt_pk_bf16_f32 v134, 0, v134
    v_cvt_pk_bf16_f32 v135, 0, v135
    v_pk_add_f32 v[128:129], v[128:129], v[160:161]
    v_pk_add_f32 v[130:131], v[130:131], v[162:163]
    v_pk_add_f32 v[132:133], v[132:133], v[164:165]
    v_pk_add_f32 v[134:135], v[134:135], v[166:167]
    v_cvt_pk_bf16_f32 v16, v128, v129
    v_cvt_pk_bf16_f32 v17, v130, v131
    v_cvt_pk_bf16_f32 v18, v132, v133
    v_cvt_pk_bf16_f32 v19, v134, v135
    v_dot2_f32_bf16 v4, v16, v16, v4
    v_dot2_f32_bf16 v5, v17, v17, v5
    v_dot2_f32_bf16 v4, v18, v18, v4
    v_dot2_f32_bf16 v5, v19, v19, v5
    v_mfma_f32_16x16x32_bf16 v[240:243], v[188:191], v[16:19], v[240:243]
    v_and_b32 v7, 7, v1
    v_lshlrev_b32 v7, 15, v7
    v_bfe_u32 v9, v1, 3, 1
    v_lshl_add_u32 v7, v9, 12, v7
    v_add_f32 v4, v4, v5
    v_mov_b32 v5, v4
    s_nop 1
    v_permlane32_swap_b32 v4, v5
    v_add_f32 v4, v4, v5
    v_mov_b32 v5, v4
    s_nop 1
    v_permlane16_swap_b32 v4, v5
    v_add_f32 v4, v4, v5
    s_nop 1
    v_mov_b32_dpp v240, v4 quad_perm:[0,1,2,3] row_mask:0x8 bank_mask:0xf
    buffer_store_dword v240, v28, s[32:35], s14 offen sc1
    s_and_b32 s96, s12, 1
    s_lshr_b32 s97, s21, 2
    s_and_b32 s98, s21, 3
    s_lshl_b32 s99, s98, 6
    s_lshl1_add_u32 s98, s97, s99
    s_lshl_b32 s97, s98, 12
    s_lshr_b32 s99, s12, 1
    s_lshl_b32 s98, s99, 6
    s_add_u32 s99, s97, s98
    s_lshl2_add_u32 s97, s96, s99
    s_add_u32 s98, s97, 1048576
    s_add_u32 s16, s98, 1536
    s_barrier
    s_cmp_lg_u32 s3, 0
    s_cbranch_scc1 L_PE
    v_mov_b32 v6, s4
    s_mov_b32 exec_hi, 0
    s_mov_b32 exec_lo, 65535
    buffer_store_dword v6, v7, s[32:35], s16 offen sc1
    s_mov_b64 exec, -1
L_PE:
    s_add_u32 s82, s80, 114688
    s_lshl2_add_u32 m0, s83, 34816
    s_nop 0
    buffer_load_dwordx4 v27, s[56:59], s82 offen nt lds
    s_add_u32 s82, s80, 172032
    s_lshl2_add_u32 m0, s83, 35840
    s_nop 0
    buffer_load_dwordx4 v27, s[56:59], s82 offen nt lds
    s_lshl_b32 s15, s3, 12
    v_add_u32 v4, s15, v2
    v_add_u32 v7, 65536, v4
    s_waitcnt vmcnt(3)
    v_cmp_ne_u32 vcc, s4, v41
    s_cbranch_vccz L_UPOK
POLL_34:
    buffer_load_dwordx2 v[40:41], v10, s[32:35], s13 offen sc1
    s_waitcnt vmcnt(0)
    v_cmp_ne_u32 vcc, s4, v41
    s_cbranch_vccz PDONE_35
    s_add_u32 s5, s5, 1
    s_cmp_lt_u32 s5, 200000
    s_cbranch_scc1 POLL_34
PDONE_35:
L_UPOK:
    s_lshl3_add_u32 s96, s21, s3
    s_lshl_b32 s97, s96, 12
    s_add_u32 s14, s97, 12582912
    s_load_dwordx2 s[24:25], s[32:33], s92 offset:1536 glc
    v_add_f32_dpp v40, v40, v40 quad_perm:[1,0,3,2] row_mask:0xf bank_mask:0xf
    s_nop 1
    v_add_f32_dpp v40, v40, v40 quad_perm:[2,3,0,1] row_mask:0xf bank_mask:0xf
    s_nop 1
    v_add_f32_dpp v40, v40, v40 row_half_mirror row_mask:0xf bank_mask:0xf
    s_nop 1
    v_add_f32_dpp v40, v40, v40 row_mirror row_mask:0xf bank_mask:0xf
    v_lshlrev_b32 v152, 16, v12
    v_and_b32 v153, s6, v12
    v_lshlrev_b32 v154, 16, v13
    v_and_b32 v155, s6, v13
    v_lshlrev_b32 v156, 16, v14
    v_and_b32 v157, s6, v14
    v_lshlrev_b32 v158, 16, v15
    v_and_b32 v159, s6, v15
    v_lshlrev_b32 v160, 16, v16
    v_and_b32 v161, s6, v16
    v_lshlrev_b32 v162, 16, v17
    v_and_b32 v163, s6, v17
    v_lshlrev_b32 v164, 16, v18
    v_and_b32 v165, s6, v18
    v_lshlrev_b32 v166, 16, v19
    v_and_b32 v167, s6, v19
    s_lshl_b32 s96, s3, 9
    s_lshl1_add_u32 s15, s21, s96
    v_and_b32 v29, 15, v1
    v_lshl_add_u32 v29, v29, 5, s15
    v_xor_b32 v5, 0x4000, v4
    v_xor_b32 v8, 0x4000, v7
    s_waitcnt vmcnt(2)
    s_cmp_ge_u32 s3, 4
    s_cbranch_scc1 L_FW0
    ds_write_b128 v4, v[56:59] offset:32768
    ds_write_b128 v5, v[60:63] offset:32768
    ds_write_b128 v4, v[64:67] offset:33792
    ds_write_b128 v5, v[68:71] offset:33792
L_FW0:
    s_cmp_lt_u32 s3, 4
    s_cbranch_scc1 L_FW1
    ds_write_b128 v4, v[56:59] offset:0
    ds_write_b128 v5, v[60:63] offset:0
    ds_write_b128 v4, v[64:67] offset:1024
    ds_write_b128 v5, v[68:71] offset:1024
    ds_write_b128 v4, v[72:75] offset:2048
    ds_write_b128 v5, v[76:79] offset:2048
    ds_write_b128 v4, v[80:83] offset:3072
    ds_write_b128 v5, v[84:87] offset:3072
L_FW1:
    s_branch SCHK_37
SPOLL_36:
    s_load_dwordx2 s[24:25], s[32:33], s92 offset:1536 glc
SCHK_37:
    s_add_u32 s5, s5, 1
    s_cmp_ge_u32 s5, 200000
    s_waitcnt lgkmcnt(0)
    s_cbranch_scc1 SDONE_38
    s_cmp_lg_u32 s24, s4
    s_cbranch_scc1 SPOLL_36
    s_cmp_lg_u32 s25, s4
    s_cbranch_scc1 SPOLL_36
SDONE_38:
    s_barrier
    buffer_load_dwordx4 v[192:195], v2, s[32:35], s14 offen sc1
    buffer_load_dwordx4 v[196:199], v2, s[32:35], s14 offen offset:1024 sc1
    buffer_load_dwordx4 v[200:203], v2, s[32:35], s14 offen offset:2048 sc1
    buffer_load_dwordx4 v[204:207], v2, s[32:35], s14 offen offset:3072 sc1
L_PAD9:
    s_cbranch_execz L_RET9
    s_mov_b32 s82, s81
    s_lshl2_add_u32 m0, s83, 65536
    s_nop 0
    buffer_load_dwordx4 v253, s[60:63], s82 offen nt lds
    s_add_u32 s82, s81, 4096
    s_lshl2_add_u32 m0, s83, 66560
    s_nop 0
    buffer_load_dwordx4 v253, s[60:63], s82 offen nt lds
    s_add_u32 s82, s81, 8192
    s_lshl2_add_u32 m0, s83, 67584
    s_nop 0
    buffer_load_dwordx4 v253, s[60:63], s82 offen nt lds
    s_add_u32 s82, s81, 12288
    s_lshl2_add_u32 m0, s83, 68608
    s_nop 0
    buffer_load_dwordx4 v253, s[60:63], s82 offen nt lds
    s_lshl3_add_u32 s15, s3, 156160
    v_mov_b32 v4, s15
    v_and_b32 v5, 7, v1
    v_lshlrev_b32 v5, 3, v5
    v_add_u32 v5, 156160, v5
    v_and_b32 v6, 3, v1
    v_lshlrev_b32 v6, 18, v6
    v_bfe_u32 v9, v1, 2, 2
    v_lshl_add_u32 v6, v9, 13, v6
    s_and_b32 s96, s21, 1
    s_and_b32 s97, s12, 7
    s_lshr_b32 s98, s12, 3
    s_lshl3_add_u32 s99, s97, s98
    s_lshl_b32 s97, s99, 12
    s_lshr_b32 s98, s21, 1
    s_lshl_b32 s99, s98, 6
    s_add_u32 s98, s97, s99
    s_lshl4_add_u32 s97, s96, s98
    s_add_u32 s99, s97, 1048576
    s_add_u32 s16, s99, 2560
    s_waitcnt vmcnt(4)
    v_pk_add_f32 v[192:193], v[192:193], v[196:197]
    v_pk_add_f32 v[200:201], v[200:201], v[204:205]
    v_pk_add_f32 v[194:195], v[194:195], v[198:199]
    v_pk_add_f32 v[202:203], v[202:203], v[206:207]
    v_pk_add_f32 v[192:193], v[192:193], v[200:201]
    v_pk_add_f32 v[194:195], v[194:195], v[202:203]
    v_add_f32 v193, v193, v194
    v_add_f32 v197, v192, v195
    v_cmp_u_f32 vcc, v193, v197
    s_cbranch_vccz POK_40
PRE_41:
    buffer_load_dwordx4 v[192:195], v2, s[32:35], s14 offen sc1
    buffer_load_dwordx4 v[196:199], v2, s[32:35], s14 offen offset:1024 sc1
    buffer_load_dwordx4 v[200:203], v2, s[32:35], s14 offen offset:2048 sc1
    buffer_load_dwordx4 v[204:207], v2, s[32:35], s14 offen offset:3072 sc1
    s_waitcnt vmcnt(0)
    v_pk_add_f32 v[192:193], v[192:193], v[196:197]
    v_pk_add_f32 v[200:201], v[200:201], v[204:205]
    v_pk_add_f32 v[194:195], v[194:195], v[198:199]
    v_pk_add_f32 v[202:203], v[202:203], v[206:207]
    v_pk_add_f32 v[192:193], v[192:193], v[200:201]
    v_pk_add_f32 v[194:195], v[194:195], v[202:203]
    v_add_f32 v193, v193, v194
    v_add_f32 v197, v192, v195
    v_cmp_u_f32 vcc, v193, v197
    s_cbranch_vccz POK_40
    s_add_u32 s5, s5, 1
    s_cmp_lt_u32 s5, 200000
    s_cbranch_scc1 PRE_41
POK_40:
    v_mov_b32 v196, v195
    s_nop 1
    v_permlane32_swap_b32 v195, v196
    v_permlane32_swap_b32 v192, v193
    v_add_f32 v195, v195, v196
    v_add_f32 v192, v192, v193
    s_nop 1
    v_permlane16_swap_b32 v192, v195
    v_add_f32 v193, v192, v195
    v_add_f32 v195, v192, v195
    s_nop 1
    v_permlane16_swap_b32 v193, v195
    v_mov_b32 v192, v193
    v_mul_f32 v195, 0x3a800000, v195
    s_nop 0
    v_permlane32_swap_b32 v192, v193
    v_mul_f32 v192, 0x3a800000, v192
    v_fma_f32 v31, -v192, v192, v195
    v_cvt_pk_bf16_f32 v30, 0, v192
    v_max_f32 v31, 0, v31
    v_cvt_pk_bf16_f32 v31, 0, v31
    v_fma_f32 v193, -v30, v40, v193
    v_add_f32 v31, 0x3727c5ac, v31
    v_cvt_pk_bf16_f32 v31, 0, v31
    v_sqrt_f32 v31, v31
    s_nop 0
    v_cvt_pk_bf16_f32 v31, 0, v31
    v_rcp_f32 v31, v31
    s_nop 0
    v_mul_f32 v32, v193, v31
    v_ashrrev_i32 v196, 31, v32
    v_or_b32 v196, 0x80000000, v196
    v_xor_b32 v32, v32, v196
    s_mov_b32 s15, 0xfffff000
    v_and_or_b32 v32, v32, s15, v29
    s_nop 1
    v_max_u32_dpp v244, v32, v32 quad_perm:[1,0,3,2] row_mask:0xf bank_mask:0xf
    v_min_u32_dpp v245, v32, v32 quad_perm:[1,0,3,2] row_mask:0xf bank_mask:0xf
    s_nop 0
    v_min_u32_dpp v196, v244, v244 quad_perm:[2,3,0,1] row_mask:0xf bank_mask:0xf
    v_max_u32_dpp v245, v245, v245 quad_perm:[2,3,0,1] row_mask:0xf bank_mask:0xf
    v_max_u32_dpp v244, v244, v244 quad_perm:[2,3,0,1] row_mask:0xf bank_mask:0xf
    v_max_u32 v245, v245, v196
    s_nop 0
    v_min_u32_dpp v196, v244, v244 row_half_mirror row_mask:0xf bank_mask:0xf
    v_max_u32_dpp v245, v245, v245 row_half_mirror row_mask:0xf bank_mask:0xf
    v_max_u32_dpp v244, v244, v244 row_half_mirror row_mask:0xf bank_mask:0xf
    v_max_u32 v245, v245, v196
    s_nop 0
    v_min_u32_dpp v196, v244, v244 row_mirror row_mask:0xf bank_mask:0xf
    v_max_u32_dpp v245, v245, v245 row_mirror row_mask:0xf bank_mask:0xf
    v_max_u32_dpp v244, v244, v244 row_mirror row_mask:0xf bank_mask:0xf
    v_max_u32 v245, v245, v196
    ds_write_b64 v4, v[244:245]
    s_waitcnt lgkmcnt(0)
    s_barrier
    ds_read_b64 v[244:245], v5
    v_pk_add_f32 v[208:209], v[152:153], v[30:31] op_sel_hi:[1,0] neg_lo:[0,1] neg_hi:[0,1]
    v_pk_add_f32 v[210:211], v[154:155], v[30:31] op_sel_hi:[1,0] neg_lo:[0,1] neg_hi:[0,1]
    v_pk_add_f32 v[212:213], v[156:157], v[30:31] op_sel_hi:[1,0] neg_lo:[0,1] neg_hi:[0,1]
    v_pk_add_f32 v[214:215], v[158:159], v[30:31] op_sel_hi:[1,0] neg_lo:[0,1] neg_hi:[0,1]
    v_pk_add_f32 v[216:217], v[160:161], v[30:31] op_sel_hi:[1,0] neg_lo:[0,1] neg_hi:[0,1]
    v_pk_add_f32 v[218:219], v[162:163], v[30:31] op_sel_hi:[1,0] neg_lo:[0,1] neg_hi:[0,1]
    v_pk_add_f32 v[220:221], v[164:165], v[30:31] op_sel_hi:[1,0] neg_lo:[0,1] neg_hi:[0,1]
    v_pk_add_f32 v[222:223], v[166:167], v[30:31] op_sel_hi:[1,0] neg_lo:[0,1] neg_hi:[0,1]
    s_waitcnt lgkmcnt(0)
    v_min_u32_dpp v196, v244, v244 quad_perm:[1,0,3,2] row_mask:0xf bank_mask:0xf
    v_max_u32_dpp v245, v245, v245 quad_perm:[1,0,3,2] row_mask:0xf bank_mask:0xf
    v_max_u32_dpp v244, v244, v244 quad_perm:[1,0,3,2] row_mask:0xf bank_mask:0xf
    v_max_u32 v245, v245, v196
    s_nop 0
    v_min_u32_dpp v196, v244, v244 quad_perm:[2,3,0,1] row_mask:0xf bank_mask:0xf
    v_max_u32_dpp v245, v245, v245 quad_perm:[2,3,0,1] row_mask:0xf bank_mask:0xf
    v_max_u32_dpp v244, v244, v244 quad_perm:[2,3,0,1] row_mask:0xf bank_mask:0xf
    v_max_u32 v245, v245, v196
    s_nop 0
    v_min_u32_dpp v196, v244, v244 row_half_mirror row_mask:0xf bank_mask:0xf
    v_max_u32_dpp v245, v245, v245 row_half_mirror row_mask:0xf bank_mask:0xf
    v_max_u32_dpp v244, v244, v244 row_half_mirror row_mask:0xf bank_mask:0xf
    v_max_u32 v245, v245, v196
    v_cmp_eq_u32 s[88:89], v32, v245
    v_cmp_eq_u32 vcc, v32, v244
    v_or_b32 v246, 1, v245
    v_mov_b32 v245, s4
    v_mov_b32 v247, s4
    s_or_b64 s[84:85], vcc, s[88:89]
    s_cmp_lg_u32 s3, 0
    s_cbranch_scc1 L_NOF
    s_mov_b64 exec, 0xffff
    buffer_store_dwordx4 v[244:247], v6, s[32:35], s16 offen sc1
    s_mov_b64 exec, -1
L_NOF:
    s_lshl4_add_u32 s13, s3, 156288
    v_mov_b32 v4, s13
    v_and_b32 v5, 7, v1
    v_lshlrev_b32 v5, 4, v5
    v_add_u32 v5, 156288, v5
    s_load_dwordx8 s[24:31], s[32:33], s92 offset:2560 glc
    v_cvt_pk_bf16_f32 v208, 0, v208
    v_cvt_pk_bf16_f32 v209, 0, v209
    v_cvt_pk_bf16_f32 v210, 0, v210
    v_cvt_pk_bf16_f32 v211, 0, v211
    v_cvt_pk_bf16_f32 v212, 0, v212
    v_cvt_pk_bf16_f32 v213, 0, v213
    v_cvt_pk_bf16_f32 v214, 0, v214
    v_cvt_pk_bf16_f32 v215, 0, v215
    v_cvt_pk_bf16_f32 v216, 0, v216
    v_cvt_pk_bf16_f32 v217, 0, v217
    v_cvt_pk_bf16_f32 v218, 0, v218
    v_cvt_pk_bf16_f32 v219, 0, v219
    v_cvt_pk_bf16_f32 v220, 0, v220
    v_cvt_pk_bf16_f32 v221, 0, v221
    v_cvt_pk_bf16_f32 v222, 0, v222
    v_cvt_pk_bf16_f32 v223, 0, v223
    v_pk_mul_f32 v[208:209], v[208:209], v[30:31] op_sel:[0,1]
    v_pk_mul_f32 v[210:211], v[210:211], v[30:31] op_sel:[0,1]
    v_pk_mul_f32 v[212:213], v[212:213], v[30:31] op_sel:[0,1]
    v_pk_mul_f32 v[214:215], v[214:215], v[30:31] op_sel:[0,1]
    v_pk_mul_f32 v[216:217], v[216:217], v[30:31] op_sel:[0,1]
    v_pk_mul_f32 v[218:219], v[218:219], v[30:31] op_sel:[0,1]
    v_pk_mul_f32 v[220:221], v[220:221], v[30:31] op_sel:[0,1]
    v_pk_mul_f32 v[222:223], v[222:223], v[30:31] op_sel:[0,1]
    v_cvt_pk_bf16_f32 v208, 0, v208
    v_cvt_pk_bf16_f32 v209, 0, v209
    v_cvt_pk_bf16_f32 v210, 0, v210
    v_cvt_pk_bf16_f32 v211, 0, v211
    v_cvt_pk_bf16_f32 v212, 0, v212
    v_cvt_pk_bf16_f32 v213, 0, v213
    v_cvt_pk_bf16_f32 v214, 0, v214
    v_cvt_pk_bf16_f32 v215, 0, v215
    v_cvt_pk_bf16_f32 v216, 0, v216
    v_cvt_pk_bf16_f32 v217, 0, v217
    v_cvt_pk_bf16_f32 v218, 0, v218
    v_cvt_pk_bf16_f32 v219, 0, v219
    v_cvt_pk_bf16_f32 v220, 0, v220
    v_cvt_pk_bf16_f32 v221, 0, v221
    v_cvt_pk_bf16_f32 v222, 0, v222
    v_cvt_pk_bf16_f32 v223, 0, v223
    v_pk_mul_f32 v[208:209], v[208:209], v[168:169]
    v_pk_mul_f32 v[210:211], v[210:211], v[170:171]
    v_pk_mul_f32 v[212:213], v[212:213], v[172:173]
    v_pk_mul_f32 v[214:215], v[214:215], v[174:175]
    v_pk_mul_f32 v[216:217], v[216:217], v[176:177]
    v_pk_mul_f32 v[218:219], v[218:219], v[178:179]
    v_pk_mul_f32 v[220:221], v[220:221], v[180:181]
    v_pk_mul_f32 v[222:223], v[222:223], v[182:183]
    v_cvt_pk_bf16_f32 v208, 0, v208
    v_cvt_pk_bf16_f32 v209, 0, v209
    v_cvt_pk_bf16_f32 v210, 0, v210
    v_cvt_pk_bf16_f32 v211, 0, v211
    v_cvt_pk_bf16_f32 v212, 0, v212
    v_cvt_pk_bf16_f32 v213, 0, v213
    v_cvt_pk_bf16_f32 v214, 0, v214
    v_cvt_pk_bf16_f32 v215, 0, v215
    v_cvt_pk_bf16_f32 v216, 0, v216
    v_cvt_pk_bf16_f32 v217, 0, v217
    v_cvt_pk_bf16_f32 v218, 0, v218
    v_cvt_pk_bf16_f32 v219, 0, v219
    v_cvt_pk_bf16_f32 v220, 0, v220
    v_cvt_pk_bf16_f32 v221, 0, v221
    v_cvt_pk_bf16_f32 v222, 0, v222
    v_cvt_pk_bf16_f32 v223, 0, v223
    v_pk_add_f32 v[208:209], v[208:209], v[88:89]
    v_pk_add_f32 v[210:211], v[210:211], v[90:91]
    v_pk_add_f32 v[212:213], v[212:213], v[92:93]
    v_pk_add_f32 v[214:215], v[214:215], v[94:95]
    v_pk_add_f32 v[216:217], v[216:217], v[96:97]
    v_pk_add_f32 v[218:219], v[218:219], v[98:99]
    v_pk_add_f32 v[220:221], v[220:221], v[100:101]
    v_pk_add_f32 v[222:223], v[222:223], v[102:103]
    v_cvt_pk_bf16_f32 v224, v208, v209
    v_cvt_pk_bf16_f32 v225, v210, v211
    v_cvt_pk_bf16_f32 v226, v212, v213
    v_cvt_pk_bf16_f32 v227, v214, v215
    v_cvt_pk_bf16_f32 v228, v216, v217
    v_cvt_pk_bf16_f32 v229, v218, v219
    v_cvt_pk_bf16_f32 v230, v220, v221
    v_cvt_pk_bf16_f32 v231, v222, v223
    s_cmp_eq_u64 s[84:85], 0
    s_cbranch_scc1 L_NOCAND
    v_mfma_f32_16x16x32_bf16 v[240:243], v[184:187], v[224:227], 0
    v_mfma_f32_16x16x32_bf16 v[240:243], v[188:191], v[228:231], v[240:243]
    v_mov_b32 v232, v224
    v_mov_b32 v233, v225
    v_mov_b32 v234, v226
    v_mov_b32 v235, v227
    v_mov_b32 v236, v228
    v_mov_b32 v237, v229
    v_mov_b32 v238, v230
    v_mov_b32 v239, v231
    s_lshl_b32 s96, s21, 14
    s_lshl_b32 s97, s12, 9
    s_add_u32 s98, s96, s97
    s_add_u32 s15, s98, 13631488
    v_lshrrev_b32 v7, 4, v1
    v_lshlrev_b32 v7, 4, v7
    v_add_u32 v8, 8192, v7
    v_permlane32_swap_b32 v232, v234
    v_permlane32_swap_b32 v233, v235
    v_permlane32_swap_b32 v236, v238
    v_permlane32_swap_b32 v237, v239
    v_permlane32_swap_b32 v12, v14
    v_permlane32_swap_b32 v13, v15
    v_permlane32_swap_b32 v16, v18
    v_permlane32_swap_b32 v17, v19
    v_cndmask_b32 v7, v7, v8, s[88:89]
    s_mov_b64 exec, s[84:85]
    buffer_store_dwordx4 v[232:235], v7, s[32:35], s15 offen sc1
    buffer_store_dwordx4 v[236:239], v7, s[32:35], s15 offen offset:64 sc1
    s_mov_b32 exec_lo, 0
    s_and_b32 exec_hi, s85, 0xffff0000
    buffer_store_dword v240, v7, s[32:35], s15 offen offset:208 sc1
    s_mov_b64 exec, s[84:85]
    buffer_store_dwordx4 v[12:15], v7, s[32:35], s15 offen offset:128 sc1
    buffer_store_dwordx4 v[16:19], v7, s[32:35], s15 offen offset:192 sc1
    s_mov_b64 exec, -1
L_NOCAND:
    v_lshlrev_b32 v208, 16, v224
    v_and_b32 v209, s6, v224
    v_lshlrev_b32 v210, 16, v225
    v_and_b32 v211, s6, v225
    v_lshlrev_b32 v212, 16, v226
    v_and_b32 v213, s6, v226
    v_lshlrev_b32 v214, 16, v227
    v_and_b32 v215, s6, v227
    v_lshlrev_b32 v216, 16, v228
    v_and_b32 v217, s6, v228
    v_lshlrev_b32 v218, 16, v229
    v_and_b32 v219, s6, v229
    v_lshlrev_b32 v220, 16, v230
    v_and_b32 v221, s6, v230
    v_lshlrev_b32 v222, 16, v231
    v_and_b32 v223, s6, v231
    v_pk_mul_f32 v[208:209], v[208:209], v[104:105]
    v_pk_mul_f32 v[210:211], v[210:211], v[106:107]
    v_pk_mul_f32 v[212:213], v[212:213], v[108:109]
    v_pk_mul_f32 v[214:215], v[214:215], v[110:111]
    v_pk_mul_f32 v[216:217], v[216:217], v[112:113]
    v_pk_mul_f32 v[218:219], v[218:219], v[114:115]
    v_pk_mul_f32 v[220:221], v[220:221], v[116:117]
    v_pk_mul_f32 v[222:223], v[222:223], v[118:119]
    v_cvt_pk_bf16_f32 v208, 0, v208
    v_cvt_pk_bf16_f32 v209, 0, v209
    v_cvt_pk_bf16_f32 v210, 0, v210
    v_cvt_pk_bf16_f32 v211, 0, v211
    v_cvt_pk_bf16_f32 v212, 0, v212
    v_cvt_pk_bf16_f32 v213, 0, v213
    v_cvt_pk_bf16_f32 v214, 0, v214
    v_cvt_pk_bf16_f32 v215, 0, v215
    v_cvt_pk_bf16_f32 v216, 0, v216
    v_cvt_pk_bf16_f32 v217, 0, v217
    v_cvt_pk_bf16_f32 v218, 0, v218
    v_cvt_pk_bf16_f32 v219, 0, v219
    v_cvt_pk_bf16_f32 v220, 0, v220
    v_cvt_pk_bf16_f32 v221, 0, v221
    v_cvt_pk_bf16_f32 v222, 0, v222
    v_cvt_pk_bf16_f32 v223, 0, v223
    s_lshl_b32 s96, s3, 11
    s_add_u32 s13, s96, 98304
    v_lshrrev_b32 v202, 4, v1
    v_lshlrev_b32 v202, 4, v202
    v_and_b32 v203, 7, v1
    v_lshlrev_b32 v203, 4, v203
    v_xor_b32 v202, v202, v203
    v_and_b32 v204, 15, v1
    v_lshl_add_u32 v204, v204, 7, s13
    v_add_u32 v202, v202, v204
    v_xor_b32 v204, 64, v202
    v_lshrrev_b32 v205, 3, v1
    v_lshlrev_b32 v205, 4, v205
    v_xor_b32 v203, v205, v203
    v_lshrrev_b32 v205, 3, v1
    v_lshl_add_u32 v205, v205, 7, s13
    v_add_u32 v203, v203, v205
    s_lshl_b32 s96, s21, 7
    s_sub_u32 s97, 2047, s96
    s_lshl_b32 s98, s3, 4
    s_sub_u32 s13, s97, s98
    v_lshrrev_b32 v43, 3, v1
    v_sub_u32 v42, s13, v43
    v_subrev_u32 v43, 8, v42
    v_lshrrev_b32 v33, 3, v1
    v_lshlrev_b32 v33, 11, v33
    v_and_b32 v9, 7, v1
    v_lshl_add_u32 v33, v9, 4, v33
    s_branch SCHK_43
SPOLL_42:
    s_load_dwordx8 s[24:31], s[32:33], s92 offset:2560 glc
SCHK_43:
    s_add_u32 s5, s5, 1
    s_cmp_ge_u32 s5, 200000
    s_waitcnt lgkmcnt(0)
    s_cbranch_scc1 SDONE_44
    s_cmp_lg_u32 s25, s4
    s_cbranch_scc1 SPOLL_42
    s_cmp_lg_u32 s27, s4
    s_cbranch_scc1 SPOLL_42
    s_cmp_lg_u32 s29, s4
    s_cbranch_scc1 SPOLL_42
    s_cmp_lg_u32 s31, s4
    s_cbranch_scc1 SPOLL_42
SDONE_44:
    s_min_u32 s25, s24, s28
    s_min_u32 s27, s26, s28
    s_min_u32 s29, s24, s30
    s_max_u32 s24, s24, s28
    s_max_u32 s26, s26, s30
    s_max_u32 s27, s27, s29
    s_max_u32 s25, s25, s26
    v_mov_b32 v244, s24
    v_mov_b32 v246, s27
    v_mov_b32 v245, s25
    ds_write_b128 v4, v[244:247]
    v_pk_add_f32 v[208:209], v[208:209], v[152:153]
    v_pk_add_f32 v[210:211], v[210:211], v[154:155]
    v_pk_add_f32 v[212:213], v[212:213], v[156:157]
    v_pk_add_f32 v[214:215], v[214:215], v[158:159]
    v_pk_add_f32 v[216:217], v[216:217], v[160:161]
    v_pk_add_f32 v[218:219], v[218:219], v[162:163]
    v_pk_add_f32 v[220:221], v[220:221], v[164:165]
    v_pk_add_f32 v[222:223], v[222:223], v[166:167]
    v_cvt_pk_bf16_f32 v232, v208, v209
    v_cvt_pk_bf16_f32 v233, v210, v211
    v_cvt_pk_bf16_f32 v234, v212, v213
    v_cvt_pk_bf16_f32 v235, v214, v215
    v_cvt_pk_bf16_f32 v236, v216, v217
    v_cvt_pk_bf16_f32 v237, v218, v219
    v_cvt_pk_bf16_f32 v238, v220, v221
    v_cvt_pk_bf16_f32 v239, v222, v223
    v_permlane32_swap_b32 v232, v234
    v_permlane32_swap_b32 v233, v235
    v_permlane32_swap_b32 v236, v238
    v_permlane32_swap_b32 v237, v239
    ds_write_b128 v202, v[232:235]
    ds_write_b128 v204, v[236:239]
    ds_read_b128 v[232:235], v203
    ds_read_b128 v[236:239], v203 offset:1024
    s_lshl3_add_u32 s96, s21, s3
    s_lshl_b32 s97, s96, 15
    s_lshl_b32 s98, s12, 7
    s_add_u32 s16, s97, s98
    s_add_u32 s15, s16, 16384
    s_lshr_b32 s96, s3, 2
    s_lshl_b32 s97, s96, 15
    s_and_b32 s98, s3, 3
    s_lshl_b32 s99, s98, 5
    s_add_u32 s13, s97, s99
    v_lshrrev_b32 v34, 4, v1
    v_lshlrev_b32 v34, 13, v34
    v_bfe_u32 v9, v1, 2, 2
    v_lshl_add_u32 v34, v9, 7, v34
    v_bfe_u32 v9, v1, 3, 2
    v_lshl_add_u32 v34, v9, 5, v34
    v_and_b32 v9, 3, v1
    v_lshl_add_u32 v34, v9, 3, v34
    v_xor_b32 v34, s13, v34
    s_lshl_b32 s96, s75, 11
    s_add_u32 s13, s96, 13631488
    v_and_b32 v36, 7, v1
    v_lshl_add_u32 v36, v36, 4, s13
    v_lshrrev_b32 v9, 4, v1
    v_lshl_add_u32 v36, v9, 9, v36
    v_and_b32 v10, 15, v1
    v_lshlrev_b32 v10, 9, v10
    v_add_u32 v10, 13631744, v10
    s_waitcnt vmcnt(0)
    s_waitcnt lgkmcnt(0)
    s_barrier
    ds_read_b128 v[244:247], v5
    v_and_b32 v8, 8, v1
    v_cmp_eq_u32 s[22:23], 0, v8
    v_cmp_gt_u32 s[24:25], 16, v1
    v_cmp_gt_u32 s[26:27], 32, v1
    s_waitcnt lgkmcnt(0)
    v_min_u32_dpp v192, v244, v244 quad_perm:[1,0,3,2] row_mask:0xf bank_mask:0xf
    v_min_u32_dpp v193, v245, v244 quad_perm:[1,0,3,2] row_mask:0xf bank_mask:0xf
    v_min_u32_dpp v194, v244, v245 quad_perm:[1,0,3,2] row_mask:0xf bank_mask:0xf
    v_max_u32_dpp v246, v246, v246 quad_perm:[1,0,3,2] row_mask:0xf bank_mask:0xf
    v_max_u32_dpp v245, v245, v245 quad_perm:[1,0,3,2] row_mask:0xf bank_mask:0xf
    v_max_u32_dpp v244, v244, v244 quad_perm:[1,0,3,2] row_mask:0xf bank_mask:0xf
    v_max3_u32 v246, v246, v193, v194
    v_max_u32 v245, v245, v192
    v_min_u32_dpp v192, v244, v244 quad_perm:[2,3,0,1] row_mask:0xf bank_mask:0xf
    s_nop 0
    v_min_u32_dpp v193, v245, v244 quad_perm:[2,3,0,1] row_mask:0xf bank_mask:0xf
    v_min_u32_dpp v194, v244, v245 quad_perm:[2,3,0,1] row_mask:0xf bank_mask:0xf
    v_max_u32_dpp v246, v246, v246 quad_perm:[2,3,0,1] row_mask:0xf bank_mask:0xf
    v_max_u32_dpp v245, v245, v245 quad_perm:[2,3,0,1] row_mask:0xf bank_mask:0xf
    v_max_u32_dpp v244, v244, v244 quad_perm:[2,3,0,1] row_mask:0xf bank_mask:0xf
    v_max3_u32 v246, v246, v193, v194
    v_max_u32 v245, v245, v192
    v_min_u32_dpp v192, v244, v244 row_half_mirror row_mask:0xf bank_mask:0xf
    s_nop 0
    v_min_u32_dpp v193, v245, v244 row_half_mirror row_mask:0xf bank_mask:0xf
    v_min_u32_dpp v194, v244, v245 row_half_mirror row_mask:0xf bank_mask:0xf
    v_max_u32_dpp v246, v246, v246 row_half_mirror row_mask:0xf bank_mask:0xf
    v_max_u32_dpp v245, v245, v245 row_half_mirror row_mask:0xf bank_mask:0xf
    v_max_u32_dpp v244, v244, v244 row_half_mirror row_mask:0xf bank_mask:0xf
    v_max3_u32 v246, v246, v193, v194
    v_max_u32 v245, v245, v192
    v_cndmask_b32 v192, v245, v244, s[22:23]
    v_cndmask_b32 v201, v246, v245, s[26:27]
    v_and_b32 v193, 31, v246
    v_and_b32 v192, 31, v192
    v_cndmask_b32 v201, v201, v244, s[24:25]
    v_lshl_add_u32 v4, v192, 13, v36
    v_lshl_add_u32 v5, v193, 13, v36
    v_and_b32 v194, 31, v201
    v_lshl_add_u32 v6, v194, 13, v10
    buffer_load_dwordx4 v[192:195], v4, s[32:35], 0 offen sc1
    buffer_load_dwordx4 v[196:199], v5, s[32:35], 0 offen sc1
    buffer_load_dword v200, v6, s[32:35], 0 offen sc1
    v_readfirstlane_b32 s91, v244
    v_readfirstlane_b32 s94, v245
    v_readfirstlane_b32 s95, v246
    ds_read_b64_tr_b16 v[56:57], v34
    ds_read_b64_tr_b16 v[58:59], v34 offset:512
    ds_read_b64_tr_b16 v[60:61], v34 offset:1024
    ds_read_b64_tr_b16 v[62:63], v34 offset:1536
    ds_read_b64_tr_b16 v[64:65], v34 offset:2048
    ds_read_b64_tr_b16 v[66:67], v34 offset:2560
    ds_read_b64_tr_b16 v[68:69], v34 offset:3072
    ds_read_b64_tr_b16 v[70:71], v34 offset:3584
    ds_read_b64_tr_b16 v[72:73], v34 offset:4096
    ds_read_b64_tr_b16 v[74:75], v34 offset:4608
    ds_read_b64_tr_b16 v[76:77], v34 offset:5120
    ds_read_b64_tr_b16 v[78:79], v34 offset:5632
    ds_read_b64_tr_b16 v[80:81], v34 offset:6144
    ds_read_b64_tr_b16 v[82:83], v34 offset:6656
    ds_read_b64_tr_b16 v[84:85], v34 offset:7168
    ds_read_b64_tr_b16 v[86:87], v34 offset:7680
    s_bfe_u32 s96, s91, 262145
    s_lshl_b32 s97, s96, 7
    s_bfe_u32 s98, s91, 458757
    s_add_u32 s99, s97, s98
    s_xor_b32 s17, s99, 2047
    s_bfe_u32 s96, s94, 262145
    s_lshl_b32 s97, s96, 7
    s_bfe_u32 s98, s94, 458757
    s_add_u32 s99, s97, s98
    s_xor_b32 s18, s99, 2047
    s_bfe_u32 s96, s95, 262145
    s_lshl_b32 s97, s96, 7
    s_bfe_u32 s98, s95, 458757
    s_add_u32 s99, s97, s98
    s_xor_b32 s19, s99, 2047
    s_waitcnt lgkmcnt(0)
    v_cmp_ne_u32 s[24:25], s17, v42
    v_cmp_ne_u32 s[26:27], s18, v42
    v_cmp_ne_u32 s[28:29], s19, v42
    s_and_b64 vcc, s[24:25], s[26:27]
    s_and_b64 exec, vcc, s[28:29]
    buffer_store_dwordx4 v[232:235], v33, s[64:67], s16 offen
    s_mov_b64 exec, -1
    v_cmp_ne_u32 s[24:25], s17, v43
    v_cmp_ne_u32 s[26:27], s18, v43
    v_cmp_ne_u32 s[28:29], s19, v43
    s_and_b64 vcc, s[24:25], s[26:27]
    s_and_b64 exec, vcc, s[28:29]
    buffer_store_dwordx4 v[236:239], v33, s[64:67], s15 offen
    s_mov_b64 exec, -1
    s_lshl_b32 s13, s3, 6
    v_bfe_u32 v35, v1, 2, 1
    v_lshlrev_b32 v35, 9, v35
    v_bfe_u32 v9, v1, 3, 1
    v_lshl_add_u32 v35, v9, 12, v35
    v_lshrrev_b32 v9, 5, v1
    v_lshl_add_u32 v35, v9, 11, v35
    v_bfe_u32 v9, v1, 2, 2
    v_lshl_add_u32 v35, v9, 6, v35
    v_bfe_u32 v9, v1, 4, 1
    v_lshl_add_u32 v35, v9, 5, v35
    v_and_b32 v9, 3, v1
    v_lshl_add_u32 v35, v9, 3, v35
    v_xor_b32 v35, s13, v35
    v_add_u32 v35, 65536, v35
    v_and_b32 v8, 15, v1
    v_lshlrev_b32 v8, 4, v8
    v_lshrrev_b32 v9, 5, v1
    v_lshl_add_u32 v8, v9, 3, v8
    s_lshl_b32 s96, s74, 13
    s_add_u32 s14, s96, 20971520
    s_lshl3_add_u32 s96, s75, s3
    s_lshl_b32 s97, s96, 8
    s_add_u32 s20, s97, s14
    v_bfe_u32 v7, v201, 1, 4
    v_bfe_u32 v201, v201, 5, 7
    v_lshl_or_b32 v201, v7, 7, v201
    v_xor_b32 v201, 0x7ff, v201
    s_waitcnt vmcnt(2)
    v_max3_u32 v7, v192, v196, v200
    v_cmp_eq_u32 vcc, -1, v7
    s_cbranch_vccz POK_46
PRE_47:
    buffer_load_dwordx4 v[192:195], v4, s[32:35], 0 offen sc1
    buffer_load_dwordx4 v[196:199], v5, s[32:35], 0 offen sc1
    buffer_load_dword v200, v6, s[32:35], 0 offen sc1
    s_waitcnt vmcnt(0)
    v_max3_u32 v7, v192, v196, v200
    v_cmp_eq_u32 vcc, -1, v7
    s_cbranch_vccz POK_46
    s_add_u32 s5, s5, 1
    s_cmp_lt_u32 s5, 200000
    s_cbranch_scc1 PRE_47
POK_46:
    v_add_f32_dpp v200, v200, v200 quad_perm:[1,0,3,2] row_mask:0xf bank_mask:0xf
    s_nop 1
    v_add_f32_dpp v200, v200, v200 quad_perm:[2,3,0,1] row_mask:0xf bank_mask:0xf
    s_nop 1
    v_add_f32_dpp v200, v200, v200 row_half_mirror row_mask:0xf bank_mask:0xf
    s_nop 1
    v_add_f32_dpp v200, v200, v200 row_mirror row_mask:0xf bank_mask:0xf
    v_cvt_pk_bf16_f32 v200, 0, v200
    v_ashrrev_i32 v7, 31, v200
    v_or_b32 v7, 0x80000000, v7
    v_xor_b32 v200, v200, v7
    v_lshrrev_b32 v200, 16, v200
    v_lshl_or_b32 v200, v200, 11, v201
    s_nop 0
    v_readlane_b32 s24, v200, 0
    v_readlane_b32 s25, v200, 16
    v_readlane_b32 s26, v200, 32
    s_not_b64 s[28:29], s[22:23]
    s_cmp_lt_u32 s24, s25
    s_cselect_b64 s[28:29], s[22:23], s[28:29]
    s_cselect_b32 s27, s24, s25
    s_cmp_gt_u32 s26, s27
    s_cselect_b64 vcc, s[28:29], 0
    v_cndmask_b32 v192, v192, v196, vcc
    v_cndmask_b32 v193, v193, v197, vcc
    v_cndmask_b32 v194, v194, v198, vcc
    v_cndmask_b32 v195, v195, v199, vcc
    s_bitcmp1_b32 vcc_lo, 0
    s_cselect_b32 s24, s26, s24
    s_cselect_b32 s19, s17, s19
    s_cselect_b32 s17, s95, s91
    s_bitcmp1_b32 vcc_lo, 8
    s_cselect_b32 s25, s26, s25
    s_cselect_b32 s19, s18, s19
    s_cselect_b32 s18, s95, s94
    s_waitcnt lgkmcnt(0)
    v_mfma_f32_16x16x32_bf16 v[136:139], v[192:195], v[56:59], 0
    v_mfma_f32_16x16x32_bf16 v[140:143], v[192:195], v[60:63], 0
    v_mfma_f32_16x16x32_bf16 v[144:147], v[192:195], v[64:67], 0
    v_mfma_f32_16x16x32_bf16 v[148:151], v[192:195], v[68:71], 0
    v_mfma_f32_16x16x32_bf16 v[168:171], v[192:195], v[72:75], 0
    v_mfma_f32_16x16x32_bf16 v[172:175], v[192:195], v[76:79], 0
    v_mfma_f32_16x16x32_bf16 v[176:179], v[192:195], v[80:83], 0
    v_mfma_f32_16x16x32_bf16 v[180:183], v[192:195], v[84:87], 0
    s_andn2_b32 s70, 2047, s24
    s_andn2_b32 s71, 2047, s25
    v_add_f32 v196, v136, v141
    s_nop 0
    v_add_f32 v197, v146, v151
    s_nop 0
    v_add_f32 v198, v168, v173
    s_nop 0
    v_add_f32 v199, v178, v183
    v_add_f32 v196, v196, v197
    v_add_f32 v198, v198, v199
    v_mov_b32 v197, s4
    s_nop 0
    v_permlane16_swap_b32 v198, v199
    s_cmp_ge_u32 s9, 28
    s_cbranch_scc1 L_NOHP
    v_add_f32 v196, v196, v199
    s_mov_b32 exec_lo, 0xffff
    s_mov_b32 exec_hi, 0xffff
    buffer_store_dwordx2 v[196:197], v8, s[32:35], s20 offen sc1
    s_mov_b64 exec, -1
L_NOHP:
    ds_read_b64_tr_b16 v[120:121], v35
    ds_read_b64_tr_b16 v[122:123], v35 offset:1024
    ds_read_b64_tr_b16 v[124:125], v35 offset:8192
    ds_read_b64_tr_b16 v[126:127], v35 offset:9216
    ds_read_b64_tr_b16 v[128:129], v35 offset:16384
    ds_read_b64_tr_b16 v[130:131], v35 offset:17408
    ds_read_b64_tr_b16 v[132:133], v35 offset:24576
    ds_read_b64_tr_b16 v[134:135], v35 offset:25600
    v_cmp_eq_u32 vcc, s19, v42
    s_nop 0
    s_and_b64 exec, vcc, -1
    s_cbranch_execz L_NOLO0
    buffer_store_dwordx4 v[232:235], v33, s[64:67], s16 offen
L_NOLO0:
    s_mov_b64 exec, -1
    v_cmp_eq_u32 vcc, s19, v43
    s_nop 0
    s_and_b64 exec, vcc, -1
    s_cbranch_execz L_NOLO1
    buffer_store_dwordx4 v[236:239], v33, s[64:67], s15 offen
L_NOLO1:
    s_mov_b64 exec, -1
    s_cmp_lg_u32 s93, 7
    s_cbranch_scc1 L_NONON
    v_mov_b32 v6, s4
    v_mov_b32 v7, 0
    s_mov_b64 exec, 1
    buffer_store_dword v6, v7, s[32:35], 0 offen sc1
    s_mov_b64 exec, -1
L_NONON:
    s_cmp_ge_u32 s9, 28
    s_cbranch_scc1 L_FIN
    s_cmp_lg_u32 s3, 7
    s_cbranch_scc1 L_NOFZ
    s_bitcmp1_b32 s9, 3
    s_cselect_b32 s15, s25, s24
    s_cselect_b32 s17, s18, s17
    s_andn2_b32 s18, 2047, s15
    s_lshr_b32 s96, s8, 1
L_PAD10:
    s_cbranch_execz L_RET10
    s_lshl2_add_u32 s19, s12, s96
    s_lshr_b32 s96, s19, 1
    s_lshr_b32 s97, s9, 3
    s_lshl_b32 s98, s97, 1
    s_lshl2_add_u32 s99, s96, s98
    s_and_b32 s97, s19, 1
    s_add_u32 s96, s99, s97
    s_mul_i32 s98, s96, 7168
    s_add_u32 s20, s98, 22020096
    s_lshl_b32 s96, s18, 11
    s_lshl_b32 s97, s19, 5
    s_add_u32 s82, s96, s97
    v_and_b32 v10, 7, v1
    v_lshlrev_b32 v10, 2, v10
    s_lshr_b32 s96, s8, 1
    s_lshl_b32 s97, s96, 6
    s_add_u32 s13, s97, 157184
    v_and_b32 v5, 7, v1
    v_lshl_add_u32 v5, v5, 3, s13
    ds_read_b64 v[206:207], v5
    s_and_b32 s96, s17, 31
    s_lshl_b32 s97, s96, 13
    s_lshl_b32 s98, s12, 9
    s_add_u32 s99, s97, s98
    s_lshr_b32 s96, s8, 1
    s_lshl_b32 s97, s96, 5
    s_add_u32 s98, s99, s97
    s_add_u32 s68, s98, 13631488
    s_lshr_b32 s13, s15, 11
    s_lshl_b32 s13, s13, 16
    s_ashr_i32 s15, s13, 31
    s_andn2_b32 s15, 0x7fff0000, s15
    s_or_b32 s15, s15, 0x80000000
    s_xor_b32 s13, s13, s15
    v_mov_b32 v204, s13
    v_mul_f32 v204, s7, v204
    v_exp_f32 v204, -v204
    s_nop 0
    v_add_f32 v204, 1.0, v204
    v_rcp_f32 v204, v204
    s_nop 0
    v_cvt_pk_bf16_f32 v204, 0, v204
L_NOFZ:
    s_cmp_ge_u32 s3, 4
    s_cbranch_scc1 L_NOH
    s_lshl_b32 s96, s3, 8
    s_add_u32 s13, s96, s14
    v_lshrrev_b32 v4, 4, v1
    v_lshlrev_b32 v4, 11, v4
    v_and_b32 v9, 15, v1
    v_lshl_add_u32 v4, v9, 4, v4
    s_lshl_b32 s96, s3, 5
    s_add_u32 s15, s96, 156672
    v_lshrrev_b32 v5, 5, v1
    v_lshl_add_u32 v5, v5, 7, s15
    v_bfe_u32 v9, v1, 2, 1
    v_lshl_add_u32 v5, v9, 4, v5
    v_bfe_u32 v9, v1, 1, 1
    v_lshl_add_u32 v5, v9, 3, v5
    v_bfe_u32 v9, v1, 3, 1
    v_lshl_add_u32 v5, v9, 2, v5
    v_and_b32 v9, 1, v1
    v_lshl_add_u32 v5, v9, 1, v5
SPOLL_48:
    s_load_dword s24, s[32:33], s13 offset:1276 glc
    s_load_dword s25, s[32:33], s13 offset:3324 glc
    s_load_dword s26, s[32:33], s13 offset:5372 glc
    s_load_dword s27, s[32:33], s13 offset:7420 glc
SCHK_49:
    s_add_u32 s5, s5, 1
    s_cmp_ge_u32 s5, 200000
    s_waitcnt lgkmcnt(0)
    s_cbranch_scc1 SDONE_50
    s_cmp_lg_u32 s24, s4
    s_cbranch_scc1 SPOLL_48
    s_cmp_lg_u32 s25, s4
    s_cbranch_scc1 SPOLL_48
    s_cmp_lg_u32 s26, s4
    s_cbranch_scc1 SPOLL_48
    s_cmp_lg_u32 s27, s4
    s_cbranch_scc1 SPOLL_48
SDONE_50:
POLL_51:
    buffer_load_dwordx4 v[88:91], v4, s[32:35], s13 offen sc1
    buffer_load_dwordx4 v[92:95], v4, s[32:35], s13 offen offset:1024 sc1
    s_waitcnt vmcnt(0)
    v_bitop3_b32 v6, v89, v91, s4 bitop3:0x7e
    v_bitop3_b32 v6, v6, v93, s4 bitop3:0xf6
    v_bitop3_b32 v6, v6, v95, s4 bitop3:0xf6
    v_cmp_ne_u32 vcc, 0, v6
    s_cbranch_vccz PDONE_52
    s_add_u32 s5, s5, 1
    s_cmp_lt_u32 s5, 200000
    s_cbranch_scc1 POLL_51
PDONE_52:
    v_permlane32_swap_b32 v88, v90
    v_permlane32_swap_b32 v92, v94
    v_add_f32 v88, v88, v90
    v_add_f32 v92, v92, v94
    v_mov_b32 v90, v88
    v_mov_b32 v94, v92
    s_nop 0
    v_permlane16_swap_b32 v88, v90
    v_permlane16_swap_b32 v92, v94
    v_add_f32 v88, v88, v90
    v_add_f32 v92, v92, v94
    v_cvt_pk_bf16_f32 v88, 0, v88
    v_cvt_pk_bf16_f32 v92, 0, v92
    v_mul_f32 v6, s7, v88
    v_exp_f32 v6, -v6
    s_nop 0
    v_add_f32 v6, 1.0, v6
    v_rcp_f32 v6, v6
    s_nop 0
    v_mul_f32 v88, v88, v6
    v_cvt_pk_bf16_f32 v88, 0, v88
    v_mul_f32 v88, v88, v92
    v_cvt_pk_bf16_f32 v88, v88, v88
    ds_write_b16 v5, v88
L_NOH:
    v_bfe_u32 v4, v1, 2, 1
    v_lshlrev_b32 v4, 7, v4
    v_lshrrev_b32 v9, 5, v1
    v_lshl_add_u32 v4, v9, 4, v4
    v_add_u32 v4, 156672, v4
    v_lshrrev_b32 v5, 4, v1
    v_mul_u32_u24 v5, 7168, v5
    v_and_b32 v9, 15, v1
    v_lshl_add_u32 v5, v9, 3, v5
    s_lshl3_add_u32 s96, s75, s3
    s_mul_i32 s97, s96, 28672
    s_lshl_b32 s98, s74, 7
    s_add_u32 s99, s97, s98
    s_add_u32 s13, s99, 22020096
    v_and_b32 v6, 1, v1
    v_lshlrev_b32 v6, 13, v6
    v_bfe_u32 v9, v1, 1, 1
    v_lshl_add_u32 v6, v9, 18, v6
    s_lshr_b32 s96, s9, 2
    s_and_b32 s97, s75, 1
    s_lshr_b32 s98, s3, 1
    s_lshl2_add_u32 s99, s97, s98
    s_and_b32 s97, s3, 1
    s_lshr_b32 s98, s75, 1
    s_lshl2_add_u32 s97, s97, s98
    s_lshl3_add_u32 s98, s99, s97
    s_lshl_b32 s99, s98, 12
    s_lshl_b32 s97, s8, 6
    s_add_u32 s98, s99, s97
    s_lshl2_add_u32 s99, s96, s98
    s_add_u32 s97, s99, 1048576
    s_add_u32 s14, s97, 3072
    s_waitcnt lgkmcnt(0)
    s_barrier
    ds_read_b128 v[88:91], v4
    ds_read_b128 v[92:95], v4 offset:32
    ds_read_b128 v[96:99], v4 offset:64
    ds_read_b128 v[100:103], v4 offset:96
    s_waitcnt lgkmcnt(3)
    v_mfma_f32_32x32x16_bf16 v[208:223], v[88:91], v[120:123], 0
    s_waitcnt lgkmcnt(2)
    v_mfma_f32_32x32x16_bf16 v[208:223], v[92:95], v[124:127], v[208:223]
    s_waitcnt lgkmcnt(1)
    v_mfma_f32_32x32x16_bf16 v[208:223], v[96:99], v[128:131], v[208:223]
    s_waitcnt lgkmcnt(0)
    v_mfma_f32_32x32x16_bf16 v[208:223], v[100:103], v[132:135], v[208:223]
    s_nop 11
    v_mov_b32 v209, s4
    buffer_store_dwordx2 v[208:209], v5, s[32:35], s13 offen sc1
    s_mov_b64 exec, 15
    buffer_store_dword v209, v6, s[32:35], s14 offen sc1
    s_mov_b64 exec, -1
    s_cmp_ge_u32 s9, 16
    s_cbranch_scc1 L_FIN
SPOLL_53:
    s_load_dwordx8 s[24:31], s[32:33], s92 offset:3072 glc
SCHK_54:
    s_add_u32 s5, s5, 1
    s_cmp_ge_u32 s5, 200000
    s_waitcnt lgkmcnt(0)
    s_cbranch_scc1 SDONE_55
    s_cmp_lg_u32 s24, s4
    s_cbranch_scc1 SPOLL_53
    s_cmp_lg_u32 s25, s4
    s_cbranch_scc1 SPOLL_53
    s_cmp_lg_u32 s26, s4
    s_cbranch_scc1 SPOLL_53
    s_cmp_lg_u32 s27, s4
    s_cbranch_scc1 SPOLL_53
    s_cmp_lg_u32 s28, s4
    s_cbranch_scc1 SPOLL_53
    s_cmp_lg_u32 s29, s4
    s_cbranch_scc1 SPOLL_53
    s_cmp_lg_u32 s30, s4
    s_cbranch_scc1 SPOLL_53
SDONE_55:
    s_barrier
    s_cmp_lg_u32 s3, 7
    s_cbranch_scc1 L_FIN
    s_add_u32 s13, s20, 4096
    v_mov_b32 v5, s4
    v_not_b32 v6, v5
POLL_56:
    buffer_load_dwordx4 v[88:91], v2, s[32:35], s20 offen sc1
    buffer_load_dwordx4 v[92:95], v2, s[32:35], s20 offen offset:1024 sc1
    buffer_load_dwordx4 v[96:99], v2, s[32:35], s20 offen offset:2048 sc1
    buffer_load_dwordx4 v[100:103], v2, s[32:35], s20 offen offset:3072 sc1
    buffer_load_dwordx4 v[104:107], v2, s[32:35], s13 offen sc1
    buffer_load_dwordx4 v[108:111], v2, s[32:35], s13 offen offset:1024 sc1
    buffer_load_dwordx4 v[112:115], v2, s[32:35], s13 offen offset:2048 sc1
    buffer_load_dword v244, v10, s[32:35], s68 offen sc1
    buffer_load_dword v245, v10, s[32:35], s68 offen offset:128 sc1
    s_waitcnt vmcnt(0)
    v_max_u32 v246, v244, v245
    v_cmp_ne_u32 vcc, -1, v246
    s_nop 1
    v_cndmask_b32 v246, v6, v5, vcc
    v_bitop3_b32 v4, v89, v91, s4 bitop3:0x7e
    v_bitop3_b32 v4, v4, v93, s4 bitop3:0xf6
    v_bitop3_b32 v4, v4, v95, s4 bitop3:0xf6
    v_bitop3_b32 v4, v4, v97, s4 bitop3:0xf6
    v_bitop3_b32 v4, v4, v99, s4 bitop3:0xf6
    v_bitop3_b32 v4, v4, v101, s4 bitop3:0xf6
    v_bitop3_b32 v4, v4, v103, s4 bitop3:0xf6
    v_bitop3_b32 v4, v4, v105, s4 bitop3:0xf6
    v_bitop3_b32 v4, v4, v107, s4 bitop3:0xf6
    v_bitop3_b32 v4, v4, v109, s4 bitop3:0xf6
    v_bitop3_b32 v4, v4, v111, s4 bitop3:0xf6
    v_bitop3_b32 v4, v4, v113, s4 bitop3:0xf6
    v_bitop3_b32 v4, v4, v115, s4 bitop3:0xf6
    v_bitop3_b32 v4, v4, v246, s4 bitop3:0xf6
    v_cmp_ne_u32 vcc, 0, v4
    s_cbranch_vccz PDONE_57
    s_add_u32 s5, s5, 1
    s_cmp_lt_u32 s5, 200000
    s_cbranch_scc1 POLL_56
PDONE_57:
    v_add_f32 v88, v88, v92
    v_add_f32 v90, v90, v94
    v_add_f32 v88, v88, v96
    v_add_f32 v90, v90, v98
    v_add_f32 v88, v88, v100
    v_add_f32 v90, v90, v102
    v_add_f32 v88, v88, v104
    v_add_f32 v90, v90, v106
    v_add_f32 v88, v88, v108
    v_add_f32 v90, v90, v110
    v_add_f32 v88, v88, v112
    v_add_f32 v90, v90, v114
    v_mov_b32 v89, v90
    v_add_f32_dpp v88, v88, v88 row_ror:8 row_mask:0xf bank_mask:0xf
    s_nop 0
    v_add_f32_dpp v89, v89, v89 row_ror:8 row_mask:0xf bank_mask:0xf
    v_mov_b32 v90, v88
    v_mov_b32 v91, v89
    s_nop 0
    v_permlane16_swap_b32 v88, v90
    v_permlane16_swap_b32 v89, v91
    v_pk_add_f32 v[88:89], v[88:89], v[90:91]
    v_mov_b32 v90, v88
    v_mov_b32 v91, v89
    s_nop 0
    v_permlane32_swap_b32 v88, v90
    v_permlane32_swap_b32 v89, v91
    v_pk_add_f32 v[88:89], v[88:89], v[90:91]
    v_cvt_pk_bf16_f32 v88, 0, v88
    v_cvt_pk_bf16_f32 v89, 0, v89
    v_pk_mul_f32 v[88:89], v[88:89], v[204:205] op_sel_hi:[1,0]
    v_lshlrev_b32 v4, 16, v244
    v_and_b32 v5, s6, v244
    v_cvt_pk_bf16_f32 v88, 0, v88
    v_cvt_pk_bf16_f32 v89, 0, v89
    v_pk_add_f32 v[88:89], v[88:89], v[4:5]
    v_cvt_pk_bf16_f32 v88, 0, v88
    v_cvt_pk_bf16_f32 v89, 0, v89
    v_pk_mul_f32 v[88:89], v[88:89], v[206:207]
    v_lshlrev_b32 v4, 16, v245
    v_and_b32 v5, s6, v245
    v_cvt_pk_bf16_f32 v88, 0, v88
    v_cvt_pk_bf16_f32 v89, 0, v89
    v_pk_add_f32 v[88:89], v[88:89], v[4:5]
    v_cvt_pk_bf16_f32 v88, v88, v89
    s_mov_b64 exec, 0xff
    buffer_store_dword v88, v10, s[64:67], s82 offen sc1
    s_mov_b64 exec, -1
L_FIN:
L_END:
    s_endpgm
.p2align 10
.fill 768, 4, 0xbf800000
.section .rodata,"a"
.p2align 6
.amdhsa_kernel adaLN_cond__linear_kernel_hedgehog__moe_arch_mod__prompt_kernel
  .amdhsa_next_free_vgpr 256
  .amdhsa_next_free_sgpr 102
  .amdhsa_accum_offset 256
  .amdhsa_group_segment_fixed_size 0
  .amdhsa_kernarg_size 112
  .amdhsa_user_sgpr_count 2
  .amdhsa_user_sgpr_kernarg_segment_ptr 1
  .amdhsa_system_sgpr_workgroup_id_x 1
  .amdhsa_float_denorm_mode_32 3
  .amdhsa_float_denorm_mode_16_64 3
.end_amdhsa_kernel
```

```asm
; @launch grid=(256,1,1) block=(512,1,1) lds=163840
.amdgcn_target "amdgcn-amd-amdhsa--gfx950"
.text
.globl adaLN_cond__linear_kernel_hedgehog__moe_arch_mod__prompt_kernel
.p2align 12
.type adaLN_cond__linear_kernel_hedgehog__moe_arch_mod__prompt_kernel,@function
adaLN_cond__linear_kernel_hedgehog__moe_arch_mod__prompt_kernel:
    s_load_dwordx16 s[68:83], s[0:1], 0
    s_load_dwordx8 s[84:91], s[0:1], 64
    s_load_dwordx2 s[32:33], s[0:1], 104
    s_cmp_ge_u32 s2, 256
    s_cbranch_scc1 L_END
    v_lshrrev_b32 v4, 6, v0
    v_and_b32 v1, 63, v0
    s_nop 0
    v_readfirstlane_b32 s3, v4
    v_lshlrev_b32 v2, 4, v1
    s_mov_b32 s38, 4194304
    s_mov_b32 s39, 0x20000
    s_mov_b32 s50, 12582912
    s_mov_b32 s51, 0x20000
    s_mov_b32 s34, 268435456
    s_mov_b32 s35, 0x20000
    s_mov_b32 s42, 6291456
    s_mov_b32 s43, 0x20000
    s_mov_b32 s46, 2097152
    s_mov_b32 s47, 0x20000
    s_mov_b32 s54, 7340032
    s_mov_b32 s55, 0x20000
    s_mov_b32 s58, 7340032
    s_mov_b32 s59, 0x20000
    s_mov_b32 s62, 7340032
    s_mov_b32 s63, 0x20000
    s_mov_b32 s66, 4194304
    s_mov_b32 s67, 0x20000
    s_mov_b32 s5, 0
    s_mov_b32 s6, 0xffff0000
    s_mov_b32 s7, 0x3fb8aa3b
    s_and_b32 s8, s2, 7
    s_lshr_b32 s9, s2, 3
    s_lshl_b32 s96, s8, 5
    s_add_u32 s97, s96, s9
    s_lshl3_add_u32 s93, s97, s3
    s_and_b32 s96, s8, 4
    s_lshr_b32 s97, s9, 2
    s_lshl1_add_u32 s10, s96, s97
    s_and_b32 s96, s8, 3
    s_and_b32 s97, s9, 3
    s_xor_b32 s98, s97, 2
    s_lshl2_add_u32 s11, s96, s98
    s_and_b32 s96, s8, 1
    s_and_b32 s97, s9, 7
    s_lshl3_add_u32 s12, s96, s97
    s_lshr_b32 s96, s8, 1
    s_lshr_b32 s97, s9, 3
    s_lshl2_add_u32 s21, s96, s97
    s_lshl_b32 s96, s2, 6
    s_add_u32 s97, s96, s3
    s_lshl_b32 s98, s97, 6
    s_add_u32 s92, s98, 1048576
    s_lshl_b32 s16, s93, 11
    s_lshl3_add_u32 s96, s8, s3
    s_lshl_b32 s15, s96, 5
    s_mul_i32 s96, s15, 6144
    s_xor_b32 s97, s9, 1
    s_lshl_b32 s98, s97, 7
    s_add_u32 s13, s96, s98
    s_add_u32 s14, s13, 98304
    s_lshl3_add_u32 s96, s21, s3
    s_lshl_b32 s97, s96, 15
    s_lshl_b32 s98, s12, 7
    s_add_u32 s18, s97, s98
    s_lshr_b32 s96, s8, 1
    s_lshl4_add_u32 s97, s96, s12
    s_lshl4_add_u32 s98, s97, s3
    s_lshl_b32 s99, s98, 9
    s_add_u32 s17, s99, 524288
    v_lshrrev_b32 v248, 3, v1
    v_mul_u32_u24 v248, 12288, v248
    v_and_b32 v9, 7, v1
    v_lshl_add_u32 v248, v9, 4, v248
    v_lshrrev_b32 v249, 3, v1
    v_lshl_add_u32 v249, v249, 1, s15
    v_and_b32 v10, 15, v1
    v_lshlrev_b32 v10, 11, v10
    v_lshrrev_b32 v9, 4, v1
    v_lshl_add_u32 v10, v9, 4, v10
    s_waitcnt lgkmcnt(0)
    s_mov_b64 s[36:37], s[68:69]
    buffer_load_dwordx4 v[152:155], v2, s[36:39], s16 offen
    buffer_load_dwordx4 v[156:159], v2, s[36:39], s16 offen offset:1024
    s_load_dword s4, s[32:33], 0
    s_mov_b64 s[48:49], s[88:89]
    s_load_dword s24, s[32:33], s92 offset:0 glc
    s_load_dword s25, s[32:33], s17 offset:508 glc
    s_load_dword s26, s[32:33], s17 offset:4604 glc
    global_load_ushort v168, v249, s[86:87]
    global_load_ushort v169, v249, s[86:87] offset:16
    s_barrier
    buffer_load_dwordx4 v[160:163], v248, s[48:51], s13 offen nt
    buffer_load_dwordx4 v[164:167], v248, s[48:51], s14 offen nt
    s_mov_b64 s[40:41], s[70:71]
    s_mov_b64 s[44:45], s[74:75]
    s_mov_b64 s[52:53], s[80:81]
    s_mov_b64 s[56:57], s[82:83]
    s_mov_b64 s[60:61], s[84:85]
    s_mov_b64 s[64:65], s[90:91]
    s_getpc_b64 s[22:23]
    s_and_b32 s22, s22, 0xfffffc00
    s_lshl3_add_u32 s96, s9, s3
    s_lshl_b32 s19, s96, 7
    v_lshrrev_b32 v4, 5, v1
    v_lshl_add_u32 v4, v4, 15, s19
    v_min_u32 v4, 41984, v4
    global_load_dword v11, v4, s[22:23]
    s_lshr_b32 s76, s3, 2
    s_and_b32 s77, s3, 3
    s_lshl_b32 s83, s3, 10
    s_mul_i32 s96, s8, 7
    s_lshr_b32 s97, s9, 2
    s_add_u32 s74, s96, s97
    s_and_b32 s75, s9, 3
    v_bfe_u32 v6, v1, 4, 1
    v_lshlrev_b32 v6, 6, v6
    v_and_b32 v3, 7, v1
    v_lshlrev_b32 v3, 4, v3
    v_xor_b32 v3, v3, v6
    v_lshrrev_b32 v6, 3, v1
    v_mul_u32_u24 v6, 6144, v6
    v_add_u32 v3, v3, v6
    s_and_b32 s84, s9, 12
    s_mul_i32 s96, s3, 49152
    s_lshl_b32 s97, s11, 7
    s_add_u32 s85, s96, s97
    v_lshlrev_b32 v250, 3, v1
    v_lshlrev_b32 v251, 5, v1
    v_add_u32 v251, 147456, v251
    s_lshl2_add_u32 s13, s3, 147456
    v_lshrrev_b32 v252, 4, v1
    v_lshl_add_u32 v252, v252, 6, s13
    v_and_b32 v9, 7, v1
    v_lshl_add_u32 v252, v9, 8, v252
    v_bfe_u32 v9, v1, 3, 1
    v_lshl_add_u32 v252, v9, 5, v252
    s_waitcnt vmcnt(5)
    v_mov_b32 v8, 0x3f803f80
    v_dot2_f32_bf16 v4, v152, v8, 0
    v_dot2_f32_bf16 v5, v152, v152, 0
    v_dot2_f32_bf16 v6, v153, v8, 0
    v_dot2_f32_bf16 v7, v153, v153, 0
    v_dot2_f32_bf16 v4, v154, v8, v4
    v_dot2_f32_bf16 v5, v154, v154, v5
    v_dot2_f32_bf16 v6, v155, v8, v6
    v_dot2_f32_bf16 v7, v155, v155, v7
    v_dot2_f32_bf16 v4, v156, v8, v4
    v_dot2_f32_bf16 v5, v156, v156, v5
    v_dot2_f32_bf16 v6, v157, v8, v6
    v_dot2_f32_bf16 v7, v157, v157, v7
    v_dot2_f32_bf16 v4, v158, v8, v4
    v_dot2_f32_bf16 v5, v158, v158, v5
    v_dot2_f32_bf16 v6, v159, v8, v6
    v_dot2_f32_bf16 v7, v159, v159, v7
    s_nop 2
    v_pk_add_f32 v[4:5], v[4:5], v[6:7]
    s_nop 1
    v_add_f32_dpp v4, v4, v4 quad_perm:[1,0,3,2] row_mask:0xf bank_mask:0xf
    v_add_f32_dpp v5, v5, v5 quad_perm:[1,0,3,2] row_mask:0xf bank_mask:0xf
    s_nop 0
    v_add_f32_dpp v4, v4, v4 quad_perm:[2,3,0,1] row_mask:0xf bank_mask:0xf
    v_add_f32_dpp v5, v5, v5 quad_perm:[2,3,0,1] row_mask:0xf bank_mask:0xf
    s_nop 0
    v_add_f32_dpp v4, v4, v4 row_half_mirror row_mask:0xf bank_mask:0xf
    v_add_f32_dpp v5, v5, v5 row_half_mirror row_mask:0xf bank_mask:0xf
    s_nop 0
    v_add_f32_dpp v4, v4, v4 row_ror:8 row_mask:0xf bank_mask:0xf
    v_add_f32_dpp v5, v5, v5 row_ror:8 row_mask:0xf bank_mask:0xf
    s_nop 1
    v_permlane16_swap_b32 v4, v5
    v_add_f32 v8, v4, v5
    v_add_f32 v4, v4, v5
    s_nop 1
    v_permlane32_swap_b32 v4, v8
    v_add_f32 v4, v4, v8
    v_mul_f32 v8, 0x3a800000, v4
    v_mul_f32 v4, 0x3a800000, v4
    s_nop 1
    v_permlane16_swap_b32 v4, v8
    v_fma_f32 v173, -v4, v4, v8
    v_cvt_pk_bf16_f32 v172, 0, v4
    v_max_f32 v173, 0, v173
    v_cvt_pk_bf16_f32 v173, 0, v173
    v_add_f32 v173, 0x3727c5ac, v173
    v_cvt_pk_bf16_f32 v173, 0, v173
    v_sqrt_f32 v173, v173
    s_nop 0
    v_cvt_pk_bf16_f32 v173, 0, v173
    s_lshl3_add_u32 s13, s3, 153600
    s_waitcnt lgkmcnt(0)
    s_mul_i32 s4, s4, 0x9e3779b1
    s_add_u32 s4, s4, 0x7f4a7c15
    v_lshrrev_b32 v172, 16, v172
    v_or_b32 v172, v172, v173
    v_mov_b32 v173, s4
    v_mov_b32 v4, s13
    ds_write_b64 v4, v[172:173]
    v_and_b32 v5, 3, v1
    v_lshlrev_b32 v5, 4, v5
    v_add_u32 v5, 153600, v5
    v_and_b32 v4, 3, v1
    v_lshlrev_b32 v4, 4, v4
    v_bfe_u32 v9, v1, 2, 1
    v_lshl_add_u32 v4, v9, 10, v4
    s_and_b32 s96, s8, 6
    s_and_b32 s97, s8, 1
    s_lshr_b32 s98, s9, 4
    s_lshl1_add_u32 s99, s97, s98
    s_lshl_b32 s97, s99, 6
    s_add_u32 s98, s96, s97
    s_lshl3_add_u32 s99, s3, s98
    s_lshl_b32 s96, s99, 10
    s_and_b32 s97, s9, 15
    s_lshl_b32 s98, s97, 6
    s_add_u32 s99, s96, s98
    s_add_u32 s13, s99, 262144
    s_waitcnt lgkmcnt(0)
    s_barrier
    ds_read_b128 v[172:175], v5
    s_waitcnt lgkmcnt(0)
    s_mov_b64 exec, 0xff
    buffer_store_dwordx4 v[172:175], v4, s[32:35], s13 offen sc1
    s_mov_b64 exec, -1
    buffer_load_dwordx4 v[12:15], v10, s[36:39], s18 offen
    buffer_load_dwordx4 v[16:19], v10, s[36:39], s18 offen offset:64
    s_lshl_b32 s96, s11, 12
    s_lshl_b32 s97, s3, 9
    s_add_u32 s13, s96, s97
    v_add_u32 v4, s13, v2
    s_lshl_b32 s96, s3, 9
    s_add_u32 m0, s96, 159744
    s_mov_b32 exec_hi, 0
    global_load_lds_dwordx4 v4, s[72:73]
    s_mov_b32 exec_hi, -1
    s_lshr_b32 s96, s9, 4
    s_lshl_b32 s94, s96, 1
    s_add_u32 s96, s94, s84
    s_and_b32 s97, s96, 15
    s_mul_i32 s98, s97, 393216
    s_add_u32 s91, s98, s85
    s_lshl_b32 s96, s94, 13
    s_add_u32 s94, s96, s83
    s_add_u32 s82, s91, 2048
    s_mov_b32 m0, s94
    s_nop 0
    buffer_load_dwordx4 v3, s[40:43], s82 offen lds
    s_add_u32 s82, s91, 4096
    s_add_u32 m0, s94, 49152
    s_nop 0
    buffer_load_dwordx4 v3, s[40:43], s82 offen lds
    s_waitcnt vmcnt(9)
    v_lshlrev_b32 v168, 16, v168
    v_mul_f32 v4, s7, v168
    v_exp_f32 v4, -v4
    s_nop 0
    v_add_f32 v4, 1.0, v4
    v_rcp_f32 v4, v4
    s_nop 0
    v_mul_f32 v168, v168, v4
    v_cvt_pk_bf16_f32 v168, 0, v168
    v_lshlrev_b32 v169, 16, v169
    v_mul_f32 v5, s7, v169
    v_exp_f32 v5, -v5
    s_nop 0
    v_add_f32 v5, 1.0, v5
    v_rcp_f32 v5, v5
    s_nop 0
    v_mul_f32 v169, v169, v5
    v_cvt_pk_bf16_f32 v169, 0, v169
    s_lshr_b32 s96, s3, 1
    s_xor_b32 s97, s9, 1
    s_and_b32 s98, s97, 15
    s_lshl4_add_u32 s99, s96, s98
    s_lshr_b32 s97, s9, 4
    s_lshl1_add_u32 s96, s99, s97
    s_lshl3_add_u32 s98, s96, s8
    s_lshl_b32 s99, s98, 9
    s_add_u32 s13, s99, 524288
    s_lshl3_add_u32 s96, s2, s3
    s_lshl_b32 s97, s96, 7
    s_add_u32 s14, s97, 262144
    v_and_b32 v8, 15, v1
    v_lshlrev_b32 v8, 3, v8
    s_waitcnt vmcnt(7)
    v_lshlrev_b32 v4, 16, v160
    v_and_b32 v5, s6, v160
    v_pk_mul_f32 v[176:177], v[4:5], v[168:169] op_sel:[0,0] op_sel_hi:[1,0]
    v_lshlrev_b32 v6, 16, v161
    v_and_b32 v7, s6, v161
    v_pk_mul_f32 v[178:179], v[6:7], v[168:169] op_sel:[0,0] op_sel_hi:[1,0]
    v_lshlrev_b32 v4, 16, v162
    v_and_b32 v5, s6, v162
    v_pk_mul_f32 v[180:181], v[4:5], v[168:169] op_sel:[0,0] op_sel_hi:[1,0]
    v_lshlrev_b32 v6, 16, v163
    v_and_b32 v7, s6, v163
    v_pk_mul_f32 v[182:183], v[6:7], v[168:169] op_sel:[0,0] op_sel_hi:[1,0]
    v_lshlrev_b32 v4, 16, v164
    v_and_b32 v5, s6, v164
    v_pk_fma_f32 v[176:177], v[4:5], v[168:169], v[176:177] op_sel:[0,1,0] op_sel_hi:[1,1,1]
    v_lshlrev_b32 v6, 16, v165
    v_and_b32 v7, s6, v165
    v_pk_fma_f32 v[178:179], v[6:7], v[168:169], v[178:179] op_sel:[0,1,0] op_sel_hi:[1,1,1]
    v_lshlrev_b32 v4, 16, v166
    v_and_b32 v5, s6, v166
    v_pk_fma_f32 v[180:181], v[4:5], v[168:169], v[180:181] op_sel:[0,1,0] op_sel_hi:[1,1,1]
    v_lshlrev_b32 v6, 16, v167
    v_and_b32 v7, s6, v167
    v_pk_fma_f32 v[182:183], v[6:7], v[168:169], v[182:183] op_sel:[0,1,0] op_sel_hi:[1,1,1]
    v_permlane32_swap_b32 v176, v180
    v_permlane32_swap_b32 v177, v181
    v_permlane32_swap_b32 v178, v182
    v_permlane32_swap_b32 v179, v183
    v_add_f32 v176, v176, v180
    v_add_f32 v177, v177, v181
    v_add_f32 v178, v178, v182
    v_add_f32 v179, v179, v183
    s_nop 0
    v_permlane16_swap_b32 v176, v178
    v_permlane16_swap_b32 v177, v179
    v_add_f32 v176, v176, v178
    v_add_f32 v177, v177, v179
    s_nop 0
    v_add_f32_dpp v176, v176, v176 row_ror:8 row_mask:0xf bank_mask:0xf
    v_add_f32_dpp v177, v177, v177 row_ror:8 row_mask:0xf bank_mask:0xf
    s_nop 1
    v_mov_b32_dpp v176, v177 quad_perm:[0,1,2,3] row_mask:0xf bank_mask:0xc
    ds_write_b32 v252, v176
    s_waitcnt lgkmcnt(0)
    s_barrier
    buffer_load_dwordx2 v[172:173], v8, s[32:35], s14 offen sc1
    ds_read_b128 v[176:179], v251 offset:0
    ds_read_b128 v[180:183], v251 offset:16
    s_waitcnt lgkmcnt(0)
    v_pk_add_f32 v[176:177], v[176:177], v[178:179]
    v_pk_add_f32 v[180:181], v[180:181], v[182:183]
    v_pk_add_f32 v[176:177], v[176:177], v[180:181]
    v_add_f32 v176, v176, v177
    v_mov_b32 v177, s4
    s_bitcmp1_b32 s3, 0
    s_cselect_b32 exec_lo, 0, -1
    s_cselect_b32 exec_hi, -1, 0
    buffer_store_dwordx2 v[176:177], v250, s[32:35], s13 offen sc1
    s_mov_b64 exec, -1
    s_mov_b32 s82, s91
    s_add_u32 m0, s94, 98304
    s_nop 0
    buffer_load_dwordx4 v3, s[40:43], s82 offen lds
    s_waitcnt vmcnt(2)
    v_cmp_ne_u32 vcc, s4, v173
    s_cbranch_vccz TOK_2
SPOLL_3:
    s_load_dword s24, s[32:33], s14 offset:60 glc
    s_load_dword s25, s[32:33], s14 offset:124 glc
SCHK_4:
    s_add_u32 s5, s5, 1
    s_cmp_ge_u32 s5, 200000
    s_waitcnt lgkmcnt(0)
    s_cbranch_scc1 SDONE_5
    s_cmp_lg_u32 s24, s4
    s_cbranch_scc1 SPOLL_3
    s_cmp_lg_u32 s25, s4
    s_cbranch_scc1 SPOLL_3
SDONE_5:
POLL_6:
    buffer_load_dwordx2 v[172:173], v8, s[32:35], s14 offen sc1
    s_waitcnt vmcnt(0)
    v_cmp_ne_u32 vcc, s4, v173
    s_cbranch_vccz PDONE_7
    s_add_u32 s5, s5, 1
    s_cmp_lt_u32 s5, 200000
    s_cbranch_scc1 POLL_6
PDONE_7:
TOK_2:
    v_and_b32 v4, 31, v1
    v_lshlrev_b32 v4, 4, v4
    v_lshrrev_b32 v9, 5, v1
    v_lshl_add_u32 v4, v9, 12, v4
    s_mov_b32 s13, s17
    s_lshl2_add_u32 s14, s3, 155648
    v_lshl_add_u32 v5, v1, 6, s14
    v_and_b32 v6, 3, v1
    v_lshlrev_b32 v6, 5, v6
    v_lshrrev_b32 v9, 5, v1
    v_lshl_add_u32 v6, v9, 7, v6
    v_bfe_u32 v9, v1, 4, 1
    v_lshl_add_u32 v6, v9, 8, v6
    v_bfe_u32 v9, v1, 2, 2
    v_lshl_add_u32 v6, v9, 9, v6
    v_add_u32 v6, 155648, v6
    s_load_dword s24, s[32:33], s13 offset:508 glc
    s_load_dword s25, s[32:33], s13 offset:4604 glc
    v_permlane32_swap_b32 v12, v14
    v_permlane32_swap_b32 v13, v15
    v_permlane32_swap_b32 v16, v18
    v_permlane32_swap_b32 v17, v19
    v_lshlrev_b32 v173, 16, v172
    v_and_b32 v172, s6, v172
    v_rcp_f32 v172, v172
    v_lshlrev_b32 v184, 16, v12
    v_and_b32 v185, s6, v12
    v_lshlrev_b32 v186, 16, v13
    v_and_b32 v187, s6, v13
    v_lshlrev_b32 v188, 16, v14
    v_and_b32 v189, s6, v14
    v_lshlrev_b32 v190, 16, v15
    v_and_b32 v191, s6, v15
    v_lshlrev_b32 v192, 16, v16
    v_and_b32 v193, s6, v16
    v_lshlrev_b32 v194, 16, v17
    v_and_b32 v195, s6, v17
    v_lshlrev_b32 v196, 16, v18
    v_and_b32 v197, s6, v18
    v_lshlrev_b32 v198, 16, v19
    v_and_b32 v199, s6, v19
    v_pk_add_f32 v[184:185], v[184:185], v[172:173] op_sel:[0,1] neg_lo:[0,1] neg_hi:[0,1]
    v_pk_add_f32 v[186:187], v[186:187], v[172:173] op_sel:[0,1] neg_lo:[0,1] neg_hi:[0,1]
    v_pk_add_f32 v[188:189], v[188:189], v[172:173] op_sel:[0,1] neg_lo:[0,1] neg_hi:[0,1]
    v_pk_add_f32 v[190:191], v[190:191], v[172:173] op_sel:[0,1] neg_lo:[0,1] neg_hi:[0,1]
    v_pk_add_f32 v[192:193], v[192:193], v[172:173] op_sel:[0,1] neg_lo:[0,1] neg_hi:[0,1]
    v_pk_add_f32 v[194:195], v[194:195], v[172:173] op_sel:[0,1] neg_lo:[0,1] neg_hi:[0,1]
    v_pk_add_f32 v[196:197], v[196:197], v[172:173] op_sel:[0,1] neg_lo:[0,1] neg_hi:[0,1]
    v_pk_add_f32 v[198:199], v[198:199], v[172:173] op_sel:[0,1] neg_lo:[0,1] neg_hi:[0,1]
    v_cvt_pk_bf16_f32 v184, 0, v184
    v_cvt_pk_bf16_f32 v185, 0, v185
    v_cvt_pk_bf16_f32 v186, 0, v186
    v_cvt_pk_bf16_f32 v187, 0, v187
    v_cvt_pk_bf16_f32 v188, 0, v188
    v_cvt_pk_bf16_f32 v189, 0, v189
    v_cvt_pk_bf16_f32 v190, 0, v190
    v_cvt_pk_bf16_f32 v191, 0, v191
    v_cvt_pk_bf16_f32 v192, 0, v192
    v_cvt_pk_bf16_f32 v193, 0, v193
    v_cvt_pk_bf16_f32 v194, 0, v194
    v_cvt_pk_bf16_f32 v195, 0, v195
    v_cvt_pk_bf16_f32 v196, 0, v196
    v_cvt_pk_bf16_f32 v197, 0, v197
    v_cvt_pk_bf16_f32 v198, 0, v198
    v_cvt_pk_bf16_f32 v199, 0, v199
    v_pk_mul_f32 v[184:185], v[184:185], v[172:173] op_sel_hi:[1,0]
    v_pk_mul_f32 v[186:187], v[186:187], v[172:173] op_sel_hi:[1,0]
    v_pk_mul_f32 v[188:189], v[188:189], v[172:173] op_sel_hi:[1,0]
    v_pk_mul_f32 v[190:191], v[190:191], v[172:173] op_sel_hi:[1,0]
    v_pk_mul_f32 v[192:193], v[192:193], v[172:173] op_sel_hi:[1,0]
    v_pk_mul_f32 v[194:195], v[194:195], v[172:173] op_sel_hi:[1,0]
    v_pk_mul_f32 v[196:197], v[196:197], v[172:173] op_sel_hi:[1,0]
    v_pk_mul_f32 v[198:199], v[198:199], v[172:173] op_sel_hi:[1,0]
    v_cvt_pk_bf16_f32 v184, 0, v184
    v_cvt_pk_bf16_f32 v185, 0, v185
    v_cvt_pk_bf16_f32 v186, 0, v186
    v_cvt_pk_bf16_f32 v187, 0, v187
    v_cvt_pk_bf16_f32 v188, 0, v188
    v_cvt_pk_bf16_f32 v189, 0, v189
    v_cvt_pk_bf16_f32 v190, 0, v190
    v_cvt_pk_bf16_f32 v191, 0, v191
    v_cvt_pk_bf16_f32 v192, 0, v192
    v_cvt_pk_bf16_f32 v193, 0, v193
    v_cvt_pk_bf16_f32 v194, 0, v194
    v_cvt_pk_bf16_f32 v195, 0, v195
    v_cvt_pk_bf16_f32 v196, 0, v196
    v_cvt_pk_bf16_f32 v197, 0, v197
    v_cvt_pk_bf16_f32 v198, 0, v198
    v_cvt_pk_bf16_f32 v199, 0, v199
    s_branch SCHK_9
SPOLL_8:
    s_load_dword s24, s[32:33], s13 offset:508 glc
    s_load_dword s25, s[32:33], s13 offset:4604 glc
SCHK_9:
    s_add_u32 s5, s5, 1
    s_cmp_ge_u32 s5, 200000
    s_waitcnt lgkmcnt(0)
    s_cbranch_scc1 SDONE_10
    s_cmp_lg_u32 s24, s4
    s_cbranch_scc1 SPOLL_8
    s_cmp_lg_u32 s25, s4
    s_cbranch_scc1 SPOLL_8
SDONE_10:
    s_barrier
    buffer_load_dwordx4 v[172:175], v4, s[32:35], s13 offen sc1
    s_lshr_b32 s96, s9, 4
    s_lshl_b32 s97, s96, 1
    s_xor_b32 s94, s97, 1
    s_add_u32 s96, s94, s84
    s_and_b32 s97, s96, 15
    s_mul_i32 s98, s97, 393216
    s_add_u32 s91, s98, s85
    s_lshl_b32 s96, s94, 13
    s_add_u32 s94, s96, s83
    s_add_u32 s82, s91, 2048
    s_mov_b32 m0, s94
    s_nop 0
    buffer_load_dwordx4 v3, s[40:43], s82 offen lds
    s_add_u32 s82, s91, 4096
    s_add_u32 m0, s94, 49152
    s_nop 0
    buffer_load_dwordx4 v3, s[40:43], s82 offen lds
    s_mov_b32 s82, s91
    s_add_u32 m0, s94, 98304
    s_nop 0
    buffer_load_dwordx4 v3, s[40:43], s82 offen lds
    s_waitcnt vmcnt(3)
    v_bitop3_b32 v7, v173, v175, s4 bitop3:0x7e
    v_cmp_ne_u32 vcc, 0, v7
    s_cbranch_vccz TOK_12
POLL_13:
    buffer_load_dwordx4 v[172:175], v4, s[32:35], s13 offen sc1
    s_waitcnt vmcnt(0)
    v_bitop3_b32 v7, v173, v175, s4 bitop3:0x7e
    v_cmp_ne_u32 vcc, 0, v7
    s_cbranch_vccz PDONE_14
    s_add_u32 s5, s5, 1
    s_cmp_lt_u32 s5, 200000
    s_cbranch_scc1 POLL_13
PDONE_14:
TOK_12:
    ds_write2_b32 v5, v172, v174 offset0:0 offset1:8
    s_waitcnt lgkmcnt(0)
    s_barrier
    ds_read_b128 v[208:211], v6 offset:2048
    ds_read_b128 v[212:215], v6 offset:2064
    ds_read_b128 v[200:203], v6
    ds_read_b128 v[204:207], v6 offset:16
    s_lshl4_add_u32 s96, s21, s12
    s_lshr_b32 s97, s3, 1
    s_lshl2_add_u32 s98, s96, s97
    s_lshl_b32 s99, s98, 12
    s_and_b32 s96, s3, 1
    s_lshl_b32 s97, s96, 8
    s_add_u32 s98, s99, s97
    s_add_u32 s13, s98, 4194304
    v_and_b32 v4, 15, v1
    v_lshlrev_b32 v4, 4, v4
    v_bfe_u32 v9, v1, 4, 1
    v_lshl_add_u32 v4, v9, 10, v4
    v_lshrrev_b32 v9, 5, v1
    v_lshl_add_u32 v4, v9, 9, v4
    s_waitcnt lgkmcnt(2)
    v_pk_add_f32 v[208:209], v[208:209], v[210:211]
    v_pk_add_f32 v[212:213], v[212:213], v[214:215]
    v_pk_add_f32 v[208:209], v[208:209], v[212:213]
    v_add_f32 v208, v208, v209
    v_cvt_pk_bf16_f32 v208, 0, v208
    s_waitcnt lgkmcnt(0)
    v_pk_add_f32 v[200:201], v[200:201], v[202:203]
    v_pk_add_f32 v[204:205], v[204:205], v[206:207]
    v_pk_add_f32 v[200:201], v[200:201], v[204:205]
    v_add_f32 v200, v200, v201
    v_add_f32 v208, 1.0, v208
    v_cvt_pk_bf16_f32 v208, 0, v208
    v_cvt_pk_bf16_f32 v200, 0, v200
    s_nop 0
    v_mul_f32_dpp v184, v208, v184 row_newbcast:0 row_mask:0xf bank_mask:0xf
    v_mul_f32_dpp v185, v208, v185 row_newbcast:1 row_mask:0xf bank_mask:0xf
    v_mul_f32_dpp v186, v208, v186 row_newbcast:2 row_mask:0xf bank_mask:0xf
    v_mul_f32_dpp v187, v208, v187 row_newbcast:3 row_mask:0xf bank_mask:0xf
    v_mul_f32_dpp v188, v208, v188 row_newbcast:4 row_mask:0xf bank_mask:0xf
    v_mul_f32_dpp v189, v208, v189 row_newbcast:5 row_mask:0xf bank_mask:0xf
    v_mul_f32_dpp v190, v208, v190 row_newbcast:6 row_mask:0xf bank_mask:0xf
    v_mul_f32_dpp v191, v208, v191 row_newbcast:7 row_mask:0xf bank_mask:0xf
    v_cvt_pk_bf16_f32 v184, 0, v184
    v_cvt_pk_bf16_f32 v185, 0, v185
    v_cvt_pk_bf16_f32 v186, 0, v186
    v_cvt_pk_bf16_f32 v187, 0, v187
    v_cvt_pk_bf16_f32 v188, 0, v188
    v_cvt_pk_bf16_f32 v189, 0, v189
    v_cvt_pk_bf16_f32 v190, 0, v190
    v_cvt_pk_bf16_f32 v191, 0, v191
    v_add_f32_dpp v184, v200, v184 row_newbcast:0 row_mask:0xf bank_mask:0xf
    v_add_f32_dpp v185, v200, v185 row_newbcast:1 row_mask:0xf bank_mask:0xf
    v_add_f32_dpp v186, v200, v186 row_newbcast:2 row_mask:0xf bank_mask:0xf
    v_add_f32_dpp v187, v200, v187 row_newbcast:3 row_mask:0xf bank_mask:0xf
    v_add_f32_dpp v188, v200, v188 row_newbcast:4 row_mask:0xf bank_mask:0xf
    v_add_f32_dpp v189, v200, v189 row_newbcast:5 row_mask:0xf bank_mask:0xf
    v_add_f32_dpp v190, v200, v190 row_newbcast:6 row_mask:0xf bank_mask:0xf
    v_add_f32_dpp v191, v200, v191 row_newbcast:7 row_mask:0xf bank_mask:0xf
    v_cvt_pk_bf16_f32 v216, v184, v185
    v_cvt_pk_bf16_f32 v217, v186, v187
    v_cvt_pk_bf16_f32 v218, v188, v189
    v_cvt_pk_bf16_f32 v219, v190, v191
    buffer_store_dwordx4 v[216:219], v4, s[32:35], s13 offen sc1
    v_mul_f32_dpp v192, v208, v192 row_newbcast:8 row_mask:0xf bank_mask:0xf
    v_mul_f32_dpp v193, v208, v193 row_newbcast:9 row_mask:0xf bank_mask:0xf
    v_mul_f32_dpp v194, v208, v194 row_newbcast:10 row_mask:0xf bank_mask:0xf
    v_mul_f32_dpp v195, v208, v195 row_newbcast:11 row_mask:0xf bank_mask:0xf
    v_mul_f32_dpp v196, v208, v196 row_newbcast:12 row_mask:0xf bank_mask:0xf
    v_mul_f32_dpp v197, v208, v197 row_newbcast:13 row_mask:0xf bank_mask:0xf
    v_mul_f32_dpp v198, v208, v198 row_newbcast:14 row_mask:0xf bank_mask:0xf
    v_mul_f32_dpp v199, v208, v199 row_newbcast:15 row_mask:0xf bank_mask:0xf
    v_cvt_pk_bf16_f32 v192, 0, v192
    v_cvt_pk_bf16_f32 v193, 0, v193
    v_cvt_pk_bf16_f32 v194, 0, v194
    v_cvt_pk_bf16_f32 v195, 0, v195
    v_cvt_pk_bf16_f32 v196, 0, v196
    v_cvt_pk_bf16_f32 v197, 0, v197
    v_cvt_pk_bf16_f32 v198, 0, v198
    v_cvt_pk_bf16_f32 v199, 0, v199
    v_add_f32_dpp v192, v200, v192 row_newbcast:8 row_mask:0xf bank_mask:0xf
    v_add_f32_dpp v193, v200, v193 row_newbcast:9 row_mask:0xf bank_mask:0xf
    v_add_f32_dpp v194, v200, v194 row_newbcast:10 row_mask:0xf bank_mask:0xf
    v_add_f32_dpp v195, v200, v195 row_newbcast:11 row_mask:0xf bank_mask:0xf
    v_add_f32_dpp v196, v200, v196 row_newbcast:12 row_mask:0xf bank_mask:0xf
    v_add_f32_dpp v197, v200, v197 row_newbcast:13 row_mask:0xf bank_mask:0xf
    v_add_f32_dpp v198, v200, v198 row_newbcast:14 row_mask:0xf bank_mask:0xf
    v_add_f32_dpp v199, v200, v199 row_newbcast:15 row_mask:0xf bank_mask:0xf
    v_cvt_pk_bf16_f32 v220, v192, v193
    v_cvt_pk_bf16_f32 v221, v194, v195
    v_cvt_pk_bf16_f32 v222, v196, v197
    v_cvt_pk_bf16_f32 v223, v198, v199
    buffer_store_dwordx4 v[220:223], v4, s[32:35], s13 offen offset:2048 sc1
    v_bfe_u32 v20, v1, 2, 2
    v_lshlrev_b32 v20, 7, v20
    v_bfe_u32 v9, v1, 3, 1
    v_lshl_add_u32 v20, v9, 6, v20
    v_bfe_u32 v9, v1, 4, 1
    v_lshl_add_u32 v20, v9, 5, v20
    v_and_b32 v9, 3, v1
    v_lshl_add_u32 v20, v9, 3, v20
    v_lshrrev_b32 v9, 5, v1
    v_lshl_add_u32 v20, v9, 9, v20
    v_xor_b32 v21, 64, v20
    v_add_u32 v22, 49152, v20
    v_add_u32 v23, 49152, v21
    v_add_u32 v24, 98304, v20
    v_add_u32 v25, 98304, v21
    v_and_b32 v5, 3, v1
    v_lshlrev_b32 v5, 15, v5
    v_bfe_u32 v9, v1, 2, 2
    v_lshl_add_u32 v5, v9, 12, v5
    s_and_b32 s96, s12, 1
    s_lshr_b32 s97, s21, 3
    s_and_b32 s98, s21, 7
    s_lshl_b32 s99, s98, 5
    s_lshl2_add_u32 s98, s97, s99
    s_lshl_b32 s97, s98, 12
    s_lshr_b32 s99, s12, 1
    s_lshl_b32 s98, s99, 6
    s_add_u32 s99, s97, s98
    s_lshl2_add_u32 s97, s96, s99
    s_add_u32 s13, s97, 1048576
    s_lshl_b32 s96, s10, 18
    s_lshl_b32 s97, s77, 12
    s_add_u32 s98, s96, s97
    s_add_u32 s88, s98, 4194304
    s_cmp_ge_u32 s9, 28
    s_cselect_b32 s54, 0, s54
    s_cselect_b32 s58, 0, s58
    s_cselect_b32 s62, 0, s62
    s_waitcnt vmcnt(0)
    s_barrier
    s_cmp_lg_u32 s3, 0
    s_cbranch_scc1 L_PB
    v_mov_b32 v6, s4
    s_mov_b32 exec_hi, 0
    s_mov_b32 exec_lo, 65535
    buffer_store_dword v6, v5, s[32:35], s13 offen sc1
    s_mov_b64 exec, -1
L_PB:
    s_lshr_b32 s96, s9, 4
    s_lshl_b32 s97, s96, 1
    s_xor_b32 s94, s97, 2
    s_add_u32 s96, s94, s84
    s_and_b32 s97, s96, 15
    s_mul_i32 s98, s97, 393216
    s_add_u32 s91, s98, s85
    s_lshl_b32 s96, s94, 13
    s_add_u32 s94, s96, s83
    s_add_u32 s82, s91, 2048
    s_mov_b32 m0, s94
    s_nop 0
    buffer_load_dwordx4 v3, s[40:43], s82 offen lds
    s_add_u32 s82, s91, 4096
    s_add_u32 m0, s94, 49152
    s_nop 0
    buffer_load_dwordx4 v3, s[40:43], s82 offen lds
    s_mov_b32 s82, s91
    s_add_u32 m0, s94, 98304
    s_nop 0
    buffer_load_dwordx4 v3, s[40:43], s82 offen lds
    s_lshr_b32 s96, s9, 4
    s_lshl_b32 s97, s96, 1
    s_xor_b32 s94, s97, 3
    s_add_u32 s96, s94, s84
    s_and_b32 s97, s96, 15
    s_mul_i32 s98, s97, 393216
    s_add_u32 s91, s98, s85
    s_lshl_b32 s96, s94, 13
    s_add_u32 s94, s96, s83
    s_add_u32 s82, s91, 2048
    s_mov_b32 m0, s94
    s_nop 0
    buffer_load_dwordx4 v3, s[40:43], s82 offen lds
    s_add_u32 s82, s91, 4096
    s_add_u32 m0, s94, 49152
    s_nop 0
    buffer_load_dwordx4 v3, s[40:43], s82 offen lds
    s_mov_b32 s82, s91
    s_add_u32 m0, s94, 98304
    s_nop 0
    buffer_load_dwordx4 v3, s[40:43], s82 offen lds
    s_lshl_b32 s96, s2, 12
    s_add_u32 s19, s96, 1048576
    s_and_b32 s96, s3, 3
    s_lshl_b32 s97, s96, 7
    s_add_u32 s20, s97, s19
    s_lshl_b32 s96, s84, 5
    s_add_u32 s19, s96, s19
    s_cmp_ge_u32 s3, 4
    s_cselect_b32 s19, s20, s19
    s_load_dwordx2 s[24:25], s[32:33], s19 offset:0 glc
    s_load_dwordx2 s[26:27], s[32:33], s19 offset:64 glc
    s_add_u32 s96, s84, 4
    s_and_b32 s97, s96, 15
    s_mul_i32 s98, s97, 393216
    s_add_u32 s91, s98, s85
    s_add_u32 s94, s83, 32768
    s_add_u32 s82, s91, 2048
    s_mov_b32 m0, s94
    s_nop 0
    buffer_load_dwordx4 v3, s[40:43], s82 offen lds
    s_add_u32 s82, s91, 4096
    s_add_u32 m0, s94, 49152
    s_nop 0
    buffer_load_dwordx4 v3, s[40:43], s82 offen lds
    s_mov_b32 s82, s91
    s_add_u32 m0, s94, 98304
    s_nop 0
    buffer_load_dwordx4 v3, s[40:43], s82 offen lds
    s_lshl_b32 s96, s3, 14
    s_lshl_b32 s97, s12, 7
    s_add_u32 s90, s96, s97
    s_and_b32 s96, s9, 1
    s_lshr_b32 s97, s9, 3
    s_lshl_b32 s98, s97, 1
    s_lshl3_add_u32 s99, s96, s98
    s_lshl_b32 s95, s99, 17
    s_lshl3_add_u32 s96, s75, s3
    s_mul_i32 s97, s96, 229376
    s_lshl_b32 s98, s74, 7
    s_add_u32 s80, s97, s98
    s_lshl3_add_u32 s96, s74, s3
    s_lshl_b32 s97, s96, 14
    s_lshl_b32 s98, s75, 9
    s_add_u32 s81, s97, s98
    s_and_b32 s96, s8, 3
    s_lshl3_add_u32 s97, s96, s3
    s_mul_i32 s98, s97, 393216
    s_lshr_b32 s99, s8, 2
    s_lshl1_add_u32 s96, s9, s99
    s_lshl_b32 s97, s96, 7
    s_add_u32 s99, s98, s97
    s_add_u32 s89, s99, 4096
    s_and_b32 s96, s3, 1
    s_lshl_b32 s14, s96, 6
    v_bfe_u32 v6, v1, 4, 1
    v_lshl_add_u32 v6, v6, 5, s14
    v_and_b32 v26, 7, v1
    v_lshlrev_b32 v26, 4, v26
    v_xor_b32 v26, v26, v6
    v_lshrrev_b32 v6, 3, v1
    v_lshlrev_b32 v6, 11, v6
    v_add_u32 v26, v26, v6
    s_and_b32 s96, s3, 2
    s_lshl_b32 s14, s96, 5
    v_bfe_u32 v6, v1, 4, 1
    v_lshl_add_u32 v6, v6, 5, s14
    v_and_b32 v27, 7, v1
    v_lshlrev_b32 v27, 4, v27
    v_xor_b32 v27, v27, v6
    v_lshrrev_b32 v6, 3, v1
    v_mul_u32_u24 v6, 7168, v6
    v_add_u32 v27, v27, v6
    s_and_b32 s96, s3, 1
    s_lshl_b32 s14, s96, 7
    v_lshrrev_b32 v6, 5, v1
    v_lshl_add_u32 v6, v6, 6, s14
    v_and_b32 v253, 31, v1
    v_lshlrev_b32 v253, 4, v253
    v_lshrrev_b32 v9, 5, v1
    v_lshl_add_u32 v253, v9, 11, v253
    v_xor_b32 v253, v253, v6
    s_lshl_b32 s16, s84, 14
    v_add_u32 v249, s88, v2
    s_lshl_b32 s96, s77, 11
    s_add_u32 s14, s96, 151552
    v_add_u32 v0, s14, v2
    s_mov_b64 exec, 0
    s_cmp_eq_u32 s3, 4
    s_cbranch_scc1 L_PAD2
    s_cmp_eq_u32 s3, 5
    s_cbranch_scc1 L_PAD3
    s_cmp_eq_u32 s3, 6
    s_cbranch_scc1 L_PAD4
    s_cmp_eq_u32 s3, 7
    s_cbranch_scc1 L_PAD5
    s_branch L_TEND
L_RET2:
    s_branch L_PAD6
L_RET6:
    s_branch L_PAD10
L_RET10:
    s_branch L_TEND
L_RET3:
    s_branch L_PAD7
L_RET7:
    s_branch L_TEND
L_RET4:
    s_branch L_PAD8
L_RET8:
    s_branch L_TEND
L_RET5:
    s_branch L_PAD9
L_RET9:
    s_branch L_TEND
    s_nop 0
    s_nop 0
    s_nop 0
    s_nop 0
    s_nop 0
    s_nop 0
    s_nop 0
    s_nop 0
    s_nop 0
    s_nop 0
    s_nop 0
    s_nop 0
    s_nop 0
    s_nop 0
    s_nop 0
    s_nop 0
    s_nop 0
    s_nop 0
    s_nop 0
    s_nop 0
    s_nop 0
    s_nop 0
    s_nop 0
    s_nop 0
    s_nop 0
    s_nop 0
    s_nop 0
    s_nop 0
L_TEND:
    s_mov_b64 exec, -1
    s_branch SCHK_16
SPOLL_15:
    s_load_dwordx2 s[24:25], s[32:33], s19 offset:0 glc
    s_load_dwordx2 s[26:27], s[32:33], s19 offset:64 glc
SCHK_16:
    s_add_u32 s5, s5, 1
    s_cmp_ge_u32 s5, 200000
    s_waitcnt lgkmcnt(0)
    s_cbranch_scc1 SDONE_17
    s_cmp_lg_u32 s24, s4
    s_cbranch_scc1 SPOLL_15
    s_cmp_lg_u32 s25, s4
    s_cbranch_scc1 SPOLL_15
    s_cmp_lg_u32 s26, s4
    s_cbranch_scc1 SPOLL_15
    s_cmp_lg_u32 s27, s4
    s_cbranch_scc1 SPOLL_15
SDONE_17:
    s_cmp_ge_u32 s3, 4
    s_cbranch_scc1 L_HELP
    s_setprio 2
    buffer_load_dwordx4 v[152:155], v249, s[32:35], s16 offen sc1
    buffer_load_dwordx4 v[156:159], v249, s[32:35], s16 offen offset:1024 sc1
    buffer_load_dwordx4 v[160:163], v249, s[32:35], s16 offen offset:2048 sc1
    buffer_load_dwordx4 v[164:167], v249, s[32:35], s16 offen offset:3072 sc1
    s_add_u32 s16, s16, 16384
    s_and_b32 s16, s16, 0x3ffff
    buffer_load_dwordx4 v[168:171], v249, s[32:35], s16 offen sc1
    buffer_load_dwordx4 v[172:175], v249, s[32:35], s16 offen offset:1024 sc1
    s_waitcnt vmcnt(9)
    s_barrier
    ds_read_b64_tr_b16 v[28:29], v20
    ds_read_b64_tr_b16 v[30:31], v20 offset:2048
    ds_read_b64_tr_b16 v[32:33], v21
    ds_read_b64_tr_b16 v[34:35], v21 offset:2048
    ds_read_b64_tr_b16 v[36:37], v24
    ds_read_b64_tr_b16 v[38:39], v24 offset:2048
    ds_read_b64_tr_b16 v[40:41], v25
    ds_read_b64_tr_b16 v[42:43], v25 offset:2048
    ds_read_b64_tr_b16 v[44:45], v22
    ds_read_b64_tr_b16 v[46:47], v22 offset:2048
    ds_read_b64_tr_b16 v[48:49], v23
    ds_read_b64_tr_b16 v[50:51], v23 offset:2048
    s_waitcnt vmcnt(5)
    s_waitcnt lgkmcnt(10)
    v_mfma_f32_32x32x16_bf16 v[56:71], v[28:31], v[152:155], 0
    ds_read_b64_tr_b16 v[52:53], v20 offset:1024
    ds_read_b64_tr_b16 v[54:55], v20 offset:3072
    s_waitcnt lgkmcnt(10)
    v_mfma_f32_32x32x16_bf16 v[72:87], v[32:35], v[152:155], 0
    ds_read_b64_tr_b16 v[28:29], v21 offset:1024
    ds_read_b64_tr_b16 v[30:31], v21 offset:3072
    s_waitcnt lgkmcnt(10)
    v_mfma_f32_32x32x16_bf16 v[120:135], v[36:39], v[152:155], 0
    ds_read_b64_tr_b16 v[32:33], v24 offset:1024
    ds_read_b64_tr_b16 v[34:35], v24 offset:3072
    s_waitcnt lgkmcnt(10)
    v_mfma_f32_32x32x16_bf16 v[136:151], v[40:43], v[152:155], 0
    ds_read_b64_tr_b16 v[36:37], v25 offset:1024
    ds_read_b64_tr_b16 v[38:39], v25 offset:3072
    s_waitcnt lgkmcnt(10)
    v_mfma_f32_32x32x16_bf16 v[88:103], v[44:47], v[152:155], 0
    buffer_load_dwordx4 v[176:179], v249, s[32:35], s16 offen offset:2048 sc1
    ds_read_b64_tr_b16 v[40:41], v22 offset:1024
    ds_read_b64_tr_b16 v[42:43], v22 offset:3072
    s_waitcnt lgkmcnt(10)
    v_mfma_f32_32x32x16_bf16 v[104:119], v[48:51], v[152:155], 0
    ds_read_b64_tr_b16 v[44:45], v23 offset:1024
    ds_read_b64_tr_b16 v[46:47], v23 offset:3072
    s_waitcnt vmcnt(5)
    s_waitcnt lgkmcnt(10)
    v_mfma_f32_32x32x16_bf16 v[56:71], v[52:55], v[156:159], v[56:71]
    ds_read_b64_tr_b16 v[48:49], v20 offset:4096
    ds_read_b64_tr_b16 v[50:51], v20 offset:6144
    s_waitcnt lgkmcnt(10)
    v_mfma_f32_32x32x16_bf16 v[72:87], v[28:31], v[156:159], v[72:87]
    ds_read_b64_tr_b16 v[52:53], v21 offset:4096
    ds_read_b64_tr_b16 v[54:55], v21 offset:6144
    s_waitcnt lgkmcnt(10)
    v_mfma_f32_32x32x16_bf16 v[120:135], v[32:35], v[156:159], v[120:135]
    ds_read_b64_tr_b16 v[28:29], v24 offset:4096
    ds_read_b64_tr_b16 v[30:31], v24 offset:6144
    s_waitcnt lgkmcnt(10)
    v_mfma_f32_32x32x16_bf16 v[136:151], v[36:39], v[156:159], v[136:151]
    buffer_load_dwordx4 v[180:183], v249, s[32:35], s16 offen offset:3072 sc1
    ds_read_b64_tr_b16 v[32:33], v25 offset:4096
    ds_read_b64_tr_b16 v[34:35], v25 offset:6144
    s_waitcnt lgkmcnt(10)
    v_mfma_f32_32x32x16_bf16 v[88:103], v[40:43], v[156:159], v[88:103]
    s_add_u32 s16, s16, 16384
    ds_read_b64_tr_b16 v[36:37], v22 offset:4096
    ds_read_b64_tr_b16 v[38:39], v22 offset:6144
    s_waitcnt lgkmcnt(10)
    v_mfma_f32_32x32x16_bf16 v[104:119], v[44:47], v[156:159], v[104:119]
    s_and_b32 s16, s16, 0x3ffff
    ds_read_b64_tr_b16 v[40:41], v23 offset:4096
    ds_read_b64_tr_b16 v[42:43], v23 offset:6144
    s_waitcnt vmcnt(5)
    s_waitcnt lgkmcnt(10)
    v_mfma_f32_32x32x16_bf16 v[56:71], v[48:51], v[160:163], v[56:71]
    ds_read_b64_tr_b16 v[44:45], v20 offset:5120
    ds_read_b64_tr_b16 v[46:47], v20 offset:7168
    s_waitcnt lgkmcnt(10)
    v_mfma_f32_32x32x16_bf16 v[72:87], v[52:55], v[160:163], v[72:87]
    ds_read_b64_tr_b16 v[48:49], v21 offset:5120
    ds_read_b64_tr_b16 v[50:51], v21 offset:7168
    s_waitcnt lgkmcnt(10)
    v_mfma_f32_32x32x16_bf16 v[120:135], v[28:31], v[160:163], v[120:135]
    buffer_load_dwordx4 v[184:187], v249, s[32:35], s16 offen sc1
    ds_read_b64_tr_b16 v[52:53], v24 offset:5120
    ds_read_b64_tr_b16 v[54:55], v24 offset:7168
    s_waitcnt lgkmcnt(10)
    v_mfma_f32_32x32x16_bf16 v[136:151], v[32:35], v[160:163], v[136:151]
    ds_read_b64_tr_b16 v[28:29], v25 offset:5120
    ds_read_b64_tr_b16 v[30:31], v25 offset:7168
    s_waitcnt lgkmcnt(10)
    v_mfma_f32_32x32x16_bf16 v[88:103], v[36:39], v[160:163], v[88:103]
    ds_read_b64_tr_b16 v[32:33], v22 offset:5120
    ds_read_b64_tr_b16 v[34:35], v22 offset:7168
    s_waitcnt lgkmcnt(10)
    v_mfma_f32_32x32x16_bf16 v[104:119], v[40:43], v[160:163], v[104:119]
    ds_read_b64_tr_b16 v[36:37], v23 offset:5120
    ds_read_b64_tr_b16 v[38:39], v23 offset:7168
    s_waitcnt vmcnt(5)
    s_waitcnt lgkmcnt(10)
    v_mfma_f32_32x32x16_bf16 v[56:71], v[44:47], v[164:167], v[56:71]
    ds_read_b64_tr_b16 v[40:41], v20 offset:8192
    ds_read_b64_tr_b16 v[42:43], v20 offset:10240
    s_waitcnt lgkmcnt(10)
    v_mfma_f32_32x32x16_bf16 v[72:87], v[48:51], v[164:167], v[72:87]
    buffer_load_dwordx4 v[188:191], v249, s[32:35], s16 offen offset:1024 sc1
    ds_read_b64_tr_b16 v[44:45], v21 offset:8192
    ds_read_b64_tr_b16 v[46:47], v21 offset:10240
    s_waitcnt lgkmcnt(10)
    v_mfma_f32_32x32x16_bf16 v[120:135], v[52:55], v[164:167], v[120:135]
    ds_read_b64_tr_b16 v[48:49], v24 offset:8192
    ds_read_b64_tr_b16 v[50:51], v24 offset:10240
    s_waitcnt lgkmcnt(10)
    v_mfma_f32_32x32x16_bf16 v[136:151], v[28:31], v[164:167], v[136:151]
    ds_read_b64_tr_b16 v[52:53], v25 offset:8192
    ds_read_b64_tr_b16 v[54:55], v25 offset:10240
    s_waitcnt lgkmcnt(10)
    v_mfma_f32_32x32x16_bf16 v[88:103], v[32:35], v[164:167], v[88:103]
    ds_read_b64_tr_b16 v[28:29], v22 offset:8192
    ds_read_b64_tr_b16 v[30:31], v22 offset:10240
    s_waitcnt lgkmcnt(10)
    v_mfma_f32_32x32x16_bf16 v[104:119], v[36:39], v[164:167], v[104:119]
    buffer_load_dwordx4 v[192:195], v249, s[32:35], s16 offen offset:2048 sc1
    ds_read_b64_tr_b16 v[32:33], v23 offset:8192
    ds_read_b64_tr_b16 v[34:35], v23 offset:10240
    s_barrier
    s_waitcnt vmcnt(6)
    s_waitcnt lgkmcnt(10)
    v_mfma_f32_32x32x16_bf16 v[56:71], v[40:43], v[168:171], v[56:71]
    ds_read_b64_tr_b16 v[36:37], v20 offset:9216
    ds_read_b64_tr_b16 v[38:39], v20 offset:11264
    s_waitcnt lgkmcnt(10)
    v_mfma_f32_32x32x16_bf16 v[72:87], v[44:47], v[168:171], v[72:87]
    ds_read_b64_tr_b16 v[40:41], v21 offset:9216
    ds_read_b64_tr_b16 v[42:43], v21 offset:11264
    s_waitcnt lgkmcnt(10)
    v_mfma_f32_32x32x16_bf16 v[120:135], v[48:51], v[168:171], v[120:135]
    ds_read_b64_tr_b16 v[44:45], v24 offset:9216
    ds_read_b64_tr_b16 v[46:47], v24 offset:11264
    s_waitcnt lgkmcnt(10)
    v_mfma_f32_32x32x16_bf16 v[136:151], v[52:55], v[168:171], v[136:151]
    ds_read_b64_tr_b16 v[48:49], v25 offset:9216
    ds_read_b64_tr_b16 v[50:51], v25 offset:11264
    s_waitcnt lgkmcnt(10)
    v_mfma_f32_32x32x16_bf16 v[88:103], v[28:31], v[168:171], v[88:103]
    buffer_load_dwordx4 v[196:199], v249, s[32:35], s16 offen offset:3072 sc1
    ds_read_b64_tr_b16 v[52:53], v22 offset:9216
    ds_read_b64_tr_b16 v[54:55], v22 offset:11264
    s_waitcnt lgkmcnt(10)
    v_mfma_f32_32x32x16_bf16 v[104:119], v[32:35], v[168:171], v[104:119]
    s_add_u32 s16, s16, 16384
    ds_read_b64_tr_b16 v[28:29], v23 offset:9216
    ds_read_b64_tr_b16 v[30:31], v23 offset:11264
    s_waitcnt vmcnt(6)
    s_waitcnt lgkmcnt(10)
    v_mfma_f32_32x32x16_bf16 v[56:71], v[36:39], v[172:175], v[56:71]
    s_and_b32 s16, s16, 0x3ffff
    ds_read_b64_tr_b16 v[32:33], v20 offset:12288
    ds_read_b64_tr_b16 v[34:35], v20 offset:14336
    s_waitcnt lgkmcnt(10)
    v_mfma_f32_32x32x16_bf16 v[72:87], v[40:43], v[172:175], v[72:87]
    ds_read_b64_tr_b16 v[36:37], v21 offset:12288
    ds_read_b64_tr_b16 v[38:39], v21 offset:14336
    s_waitcnt lgkmcnt(10)
    v_mfma_f32_32x32x16_bf16 v[120:135], v[44:47], v[172:175], v[120:135]
    ds_read_b64_tr_b16 v[40:41], v24 offset:12288
    ds_read_b64_tr_b16 v[42:43], v24 offset:14336
    s_waitcnt lgkmcnt(10)
    v_mfma_f32_32x32x16_bf16 v[136:151], v[48:51], v[172:175], v[136:151]
    buffer_load_dwordx4 v[200:203], v249, s[32:35], s16 offen sc1
    ds_read_b64_tr_b16 v[44:45], v25 offset:12288
    ds_read_b64_tr_b16 v[46:47], v25 offset:14336
    s_waitcnt lgkmcnt(10)
    v_mfma_f32_32x32x16_bf16 v[88:103], v[52:55], v[172:175], v[88:103]
    ds_read_b64_tr_b16 v[48:49], v22 offset:12288
    ds_read_b64_tr_b16 v[50:51], v22 offset:14336
    s_waitcnt lgkmcnt(10)
    v_mfma_f32_32x32x16_bf16 v[104:119], v[28:31], v[172:175], v[104:119]
    ds_read_b64_tr_b16 v[52:53], v23 offset:12288
    ds_read_b64_tr_b16 v[54:55], v23 offset:14336
    s_waitcnt vmcnt(6)
    s_waitcnt lgkmcnt(10)
    v_mfma_f32_32x32x16_bf16 v[56:71], v[32:35], v[176:179], v[56:71]
    ds_read_b64_tr_b16 v[28:29], v20 offset:13312
    ds_read_b64_tr_b16 v[30:31], v20 offset:15360
    s_waitcnt lgkmcnt(10)
    v_mfma_f32_32x32x16_bf16 v[72:87], v[36:39], v[176:179], v[72:87]
    ds_read_b64_tr_b16 v[32:33], v21 offset:13312
    ds_read_b64_tr_b16 v[34:35], v21 offset:15360
    s_waitcnt lgkmcnt(10)
    v_mfma_f32_32x32x16_bf16 v[120:135], v[40:43], v[176:179], v[120:135]
    buffer_load_dwordx4 v[204:207], v249, s[32:35], s16 offen offset:1024 sc1
    ds_read_b64_tr_b16 v[36:37], v24 offset:13312
    ds_read_b64_tr_b16 v[38:39], v24 offset:15360
    s_waitcnt lgkmcnt(10)
    v_mfma_f32_32x32x16_bf16 v[136:151], v[44:47], v[176:179], v[136:151]
    ds_read_b64_tr_b16 v[40:41], v25 offset:13312
    ds_read_b64_tr_b16 v[42:43], v25 offset:15360
    s_waitcnt lgkmcnt(10)
    v_mfma_f32_32x32x16_bf16 v[88:103], v[48:51], v[176:179], v[88:103]
    ds_read_b64_tr_b16 v[44:45], v22 offset:13312
    ds_read_b64_tr_b16 v[46:47], v22 offset:15360
    s_waitcnt lgkmcnt(10)
    v_mfma_f32_32x32x16_bf16 v[104:119], v[52:55], v[176:179], v[104:119]
    ds_read_b64_tr_b16 v[48:49], v23 offset:13312
    ds_read_b64_tr_b16 v[50:51], v23 offset:15360
    s_waitcnt vmcnt(6)
    s_waitcnt lgkmcnt(10)
    v_mfma_f32_32x32x16_bf16 v[56:71], v[28:31], v[180:183], v[56:71]
    ds_read_b64_tr_b16 v[52:53], v20 offset:16384
    ds_read_b64_tr_b16 v[54:55], v20 offset:18432
    s_waitcnt lgkmcnt(10)
    v_mfma_f32_32x32x16_bf16 v[72:87], v[32:35], v[180:183], v[72:87]
    buffer_load_dwordx4 v[208:211], v249, s[32:35], s16 offen offset:2048 sc1
    ds_read_b64_tr_b16 v[28:29], v21 offset:16384
    ds_read_b64_tr_b16 v[30:31], v21 offset:18432
    s_waitcnt lgkmcnt(10)
    v_mfma_f32_32x32x16_bf16 v[120:135], v[36:39], v[180:183], v[120:135]
    ds_read_b64_tr_b16 v[32:33], v24 offset:16384
    ds_read_b64_tr_b16 v[34:35], v24 offset:18432
    s_waitcnt lgkmcnt(10)
    v_mfma_f32_32x32x16_bf16 v[136:151], v[40:43], v[180:183], v[136:151]
    ds_read_b64_tr_b16 v[36:37], v25 offset:16384
    ds_read_b64_tr_b16 v[38:39], v25 offset:18432
    s_waitcnt lgkmcnt(10)
    v_mfma_f32_32x32x16_bf16 v[88:103], v[44:47], v[180:183], v[88:103]
    ds_read_b64_tr_b16 v[40:41], v22 offset:16384
    ds_read_b64_tr_b16 v[42:43], v22 offset:18432
    s_waitcnt lgkmcnt(10)
    v_mfma_f32_32x32x16_bf16 v[104:119], v[48:51], v[180:183], v[104:119]
    buffer_load_dwordx4 v[212:215], v249, s[32:35], s16 offen offset:3072 sc1
    ds_read_b64_tr_b16 v[44:45], v23 offset:16384
    ds_read_b64_tr_b16 v[46:47], v23 offset:18432
    s_barrier
    s_waitcnt vmcnt(7)
    s_waitcnt lgkmcnt(10)
    v_mfma_f32_32x32x16_bf16 v[56:71], v[52:55], v[184:187], v[56:71]
    s_add_u32 s16, s16, 16384
    ds_read_b64_tr_b16 v[48:49], v20 offset:17408
    ds_read_b64_tr_b16 v[50:51], v20 offset:19456
    s_waitcnt lgkmcnt(10)
    v_mfma_f32_32x32x16_bf16 v[72:87], v[28:31], v[184:187], v[72:87]
    s_and_b32 s16, s16, 0x3ffff
    ds_read_b64_tr_b16 v[52:53], v21 offset:17408
    ds_read_b64_tr_b16 v[54:55], v21 offset:19456
    s_waitcnt lgkmcnt(10)
    v_mfma_f32_32x32x16_bf16 v[120:135], v[32:35], v[184:187], v[120:135]
    ds_read_b64_tr_b16 v[28:29], v24 offset:17408
    ds_read_b64_tr_b16 v[30:31], v24 offset:19456
    s_waitcnt lgkmcnt(10)
    v_mfma_f32_32x32x16_bf16 v[136:151], v[36:39], v[184:187], v[136:151]
    ds_read_b64_tr_b16 v[32:33], v25 offset:17408
    ds_read_b64_tr_b16 v[34:35], v25 offset:19456
    s_waitcnt lgkmcnt(10)
    v_mfma_f32_32x32x16_bf16 v[88:103], v[40:43], v[184:187], v[88:103]
    buffer_load_dwordx4 v[216:219], v249, s[32:35], s16 offen sc1
    ds_read_b64_tr_b16 v[36:37], v22 offset:17408
    ds_read_b64_tr_b16 v[38:39], v22 offset:19456
    s_waitcnt lgkmcnt(10)
    v_mfma_f32_32x32x16_bf16 v[104:119], v[44:47], v[184:187], v[104:119]
    ds_read_b64_tr_b16 v[40:41], v23 offset:17408
    ds_read_b64_tr_b16 v[42:43], v23 offset:19456
    s_waitcnt vmcnt(7)
    s_waitcnt lgkmcnt(10)
    v_mfma_f32_32x32x16_bf16 v[56:71], v[48:51], v[188:191], v[56:71]
    ds_read_b64_tr_b16 v[44:45], v20 offset:20480
    ds_read_b64_tr_b16 v[46:47], v20 offset:22528
    s_waitcnt lgkmcnt(10)
    v_mfma_f32_32x32x16_bf16 v[72:87], v[52:55], v[188:191], v[72:87]
    ds_read_b64_tr_b16 v[48:49], v21 offset:20480
    ds_read_b64_tr_b16 v[50:51], v21 offset:22528
    s_waitcnt lgkmcnt(10)
    v_mfma_f32_32x32x16_bf16 v[120:135], v[28:31], v[188:191], v[120:135]
    ds_read_b64_tr_b16 v[52:53], v24 offset:20480
    ds_read_b64_tr_b16 v[54:55], v24 offset:22528
    s_waitcnt lgkmcnt(10)
    v_mfma_f32_32x32x16_bf16 v[136:151], v[32:35], v[188:191], v[136:151]
    buffer_load_dwordx4 v[220:223], v249, s[32:35], s16 offen offset:1024 sc1
    ds_read_b64_tr_b16 v[28:29], v25 offset:20480
    ds_read_b64_tr_b16 v[30:31], v25 offset:22528
    s_waitcnt lgkmcnt(10)
    v_mfma_f32_32x32x16_bf16 v[88:103], v[36:39], v[188:191], v[88:103]
    ds_read_b64_tr_b16 v[32:33], v22 offset:20480
    ds_read_b64_tr_b16 v[34:35], v22 offset:22528
    s_waitcnt lgkmcnt(10)
    v_mfma_f32_32x32x16_bf16 v[104:119], v[40:43], v[188:191], v[104:119]
    ds_read_b64_tr_b16 v[36:37], v23 offset:20480
    ds_read_b64_tr_b16 v[38:39], v23 offset:22528
    s_waitcnt vmcnt(7)
    s_waitcnt lgkmcnt(10)
    v_mfma_f32_32x32x16_bf16 v[56:71], v[44:47], v[192:195], v[56:71]
    ds_read_b64_tr_b16 v[40:41], v20 offset:21504
    ds_read_b64_tr_b16 v[42:43], v20 offset:23552
    s_waitcnt lgkmcnt(10)
    v_mfma_f32_32x32x16_bf16 v[72:87], v[48:51], v[192:195], v[72:87]
    ds_read_b64_tr_b16 v[44:45], v21 offset:21504
    ds_read_b64_tr_b16 v[46:47], v21 offset:23552
    s_waitcnt lgkmcnt(10)
    v_mfma_f32_32x32x16_bf16 v[120:135], v[52:55], v[192:195], v[120:135]
    buffer_load_dwordx4 v[224:227], v249, s[32:35], s16 offen offset:2048 sc1
    ds_read_b64_tr_b16 v[48:49], v24 offset:21504
    ds_read_b64_tr_b16 v[50:51], v24 offset:23552
    s_waitcnt lgkmcnt(10)
    v_mfma_f32_32x32x16_bf16 v[136:151], v[28:31], v[192:195], v[136:151]
    ds_read_b64_tr_b16 v[52:53], v25 offset:21504
    ds_read_b64_tr_b16 v[54:55], v25 offset:23552
    s_waitcnt lgkmcnt(10)
    v_mfma_f32_32x32x16_bf16 v[88:103], v[32:35], v[192:195], v[88:103]
    ds_read_b64_tr_b16 v[28:29], v22 offset:21504
    ds_read_b64_tr_b16 v[30:31], v22 offset:23552
    s_waitcnt lgkmcnt(10)
    v_mfma_f32_32x32x16_bf16 v[104:119], v[36:39], v[192:195], v[104:119]
    ds_read_b64_tr_b16 v[32:33], v23 offset:21504
    ds_read_b64_tr_b16 v[34:35], v23 offset:23552
    s_waitcnt vmcnt(7)
    s_waitcnt lgkmcnt(10)
    v_mfma_f32_32x32x16_bf16 v[56:71], v[40:43], v[196:199], v[56:71]
    ds_read_b64_tr_b16 v[36:37], v20 offset:24576
    ds_read_b64_tr_b16 v[38:39], v20 offset:26624
    s_waitcnt lgkmcnt(10)
    v_mfma_f32_32x32x16_bf16 v[72:87], v[44:47], v[196:199], v[72:87]
    buffer_load_dwordx4 v[228:231], v249, s[32:35], s16 offen offset:3072 sc1
    ds_read_b64_tr_b16 v[40:41], v21 offset:24576
    ds_read_b64_tr_b16 v[42:43], v21 offset:26624
    s_waitcnt lgkmcnt(10)
    v_mfma_f32_32x32x16_bf16 v[120:135], v[48:51], v[196:199], v[120:135]
    s_add_u32 s16, s16, 16384
    ds_read_b64_tr_b16 v[44:45], v24 offset:24576
    ds_read_b64_tr_b16 v[46:47], v24 offset:26624
    s_waitcnt lgkmcnt(10)
    v_mfma_f32_32x32x16_bf16 v[136:151], v[52:55], v[196:199], v[136:151]
    s_and_b32 s16, s16, 0x3ffff
    ds_read_b64_tr_b16 v[48:49], v25 offset:24576
    ds_read_b64_tr_b16 v[50:51], v25 offset:26624
    s_waitcnt lgkmcnt(10)
    v_mfma_f32_32x32x16_bf16 v[88:103], v[28:31], v[196:199], v[88:103]
    ds_read_b64_tr_b16 v[52:53], v22 offset:24576
    ds_read_b64_tr_b16 v[54:55], v22 offset:26624
    s_waitcnt lgkmcnt(10)
    v_mfma_f32_32x32x16_bf16 v[104:119], v[32:35], v[196:199], v[104:119]
    buffer_load_dwordx4 v[232:235], v249, s[32:35], s16 offen sc1
    ds_read_b64_tr_b16 v[28:29], v23 offset:24576
    ds_read_b64_tr_b16 v[30:31], v23 offset:26624
    s_barrier
    s_waitcnt vmcnt(8)
    s_waitcnt lgkmcnt(10)
    v_mfma_f32_32x32x16_bf16 v[56:71], v[36:39], v[200:203], v[56:71]
    ds_read_b64_tr_b16 v[32:33], v20 offset:25600
    ds_read_b64_tr_b16 v[34:35], v20 offset:27648
    s_waitcnt lgkmcnt(10)
    v_mfma_f32_32x32x16_bf16 v[72:87], v[40:43], v[200:203], v[72:87]
    ds_read_b64_tr_b16 v[36:37], v21 offset:25600
    ds_read_b64_tr_b16 v[38:39], v21 offset:27648
    s_waitcnt lgkmcnt(10)
    v_mfma_f32_32x32x16_bf16 v[120:135], v[44:47], v[200:203], v[120:135]
    ds_read_b64_tr_b16 v[40:41], v24 offset:25600
    ds_read_b64_tr_b16 v[42:43], v24 offset:27648
    s_waitcnt lgkmcnt(10)
    v_mfma_f32_32x32x16_bf16 v[136:151], v[48:51], v[200:203], v[136:151]
    ds_read_b64_tr_b16 v[44:45], v25 offset:25600
    ds_read_b64_tr_b16 v[46:47], v25 offset:27648
    s_waitcnt lgkmcnt(10)
    v_mfma_f32_32x32x16_bf16 v[88:103], v[52:55], v[200:203], v[88:103]
    buffer_load_dwordx4 v[236:239], v249, s[32:35], s16 offen offset:1024 sc1
    ds_read_b64_tr_b16 v[48:49], v22 offset:25600
    ds_read_b64_tr_b16 v[50:51], v22 offset:27648
    s_waitcnt lgkmcnt(10)
    v_mfma_f32_32x32x16_bf16 v[104:119], v[28:31], v[200:203], v[104:119]
    ds_read_b64_tr_b16 v[52:53], v23 offset:25600
    ds_read_b64_tr_b16 v[54:55], v23 offset:27648
    s_waitcnt vmcnt(8)
    s_waitcnt lgkmcnt(10)
    v_mfma_f32_32x32x16_bf16 v[56:71], v[32:35], v[204:207], v[56:71]
    ds_read_b64_tr_b16 v[28:29], v20 offset:28672
    ds_read_b64_tr_b16 v[30:31], v20 offset:30720
    s_waitcnt lgkmcnt(10)
    v_mfma_f32_32x32x16_bf16 v[72:87], v[36:39], v[204:207], v[72:87]
    ds_read_b64_tr_b16 v[32:33], v21 offset:28672
    ds_read_b64_tr_b16 v[34:35], v21 offset:30720
L_PAD2:
    s_cbranch_execz L_RET2
    s_waitcnt lgkmcnt(10)
    v_mfma_f32_32x32x16_bf16 v[120:135], v[40:43], v[204:207], v[120:135]
    ds_read_b64_tr_b16 v[36:37], v24 offset:28672
    ds_read_b64_tr_b16 v[38:39], v24 offset:30720
    s_waitcnt lgkmcnt(10)
    v_mfma_f32_32x32x16_bf16 v[136:151], v[44:47], v[204:207], v[136:151]
    buffer_load_dwordx4 v[240:243], v249, s[32:35], s16 offen offset:2048 sc1
    ds_read_b64_tr_b16 v[40:41], v25 offset:28672
    ds_read_b64_tr_b16 v[42:43], v25 offset:30720
    s_waitcnt lgkmcnt(10)
    v_mfma_f32_32x32x16_bf16 v[88:103], v[48:51], v[204:207], v[88:103]
    ds_read_b64_tr_b16 v[44:45], v22 offset:28672
    ds_read_b64_tr_b16 v[46:47], v22 offset:30720
    s_waitcnt lgkmcnt(10)
    v_mfma_f32_32x32x16_bf16 v[104:119], v[52:55], v[204:207], v[104:119]
    ds_read_b64_tr_b16 v[48:49], v23 offset:28672
    ds_read_b64_tr_b16 v[50:51], v23 offset:30720
    s_waitcnt vmcnt(8)
    s_waitcnt lgkmcnt(10)
    v_mfma_f32_32x32x16_bf16 v[56:71], v[28:31], v[208:211], v[56:71]
    ds_read_b64_tr_b16 v[52:53], v20 offset:29696
    ds_read_b64_tr_b16 v[54:55], v20 offset:31744
    s_waitcnt lgkmcnt(10)
    v_mfma_f32_32x32x16_bf16 v[72:87], v[32:35], v[208:211], v[72:87]
    ds_read_b64_tr_b16 v[28:29], v21 offset:29696
    ds_read_b64_tr_b16 v[30:31], v21 offset:31744
    s_waitcnt lgkmcnt(10)
    v_mfma_f32_32x32x16_bf16 v[120:135], v[36:39], v[208:211], v[120:135]
    buffer_load_dwordx4 v[244:247], v249, s[32:35], s16 offen offset:3072 sc1
    ds_read_b64_tr_b16 v[32:33], v24 offset:29696
    ds_read_b64_tr_b16 v[34:35], v24 offset:31744
    s_waitcnt lgkmcnt(10)
    v_mfma_f32_32x32x16_bf16 v[136:151], v[40:43], v[208:211], v[136:151]
    s_add_u32 s16, s16, 16384
    ds_read_b64_tr_b16 v[36:37], v25 offset:29696
    ds_read_b64_tr_b16 v[38:39], v25 offset:31744
    s_waitcnt lgkmcnt(10)
    v_mfma_f32_32x32x16_bf16 v[88:103], v[44:47], v[208:211], v[88:103]
    s_and_b32 s16, s16, 0x3ffff
    ds_read_b64_tr_b16 v[40:41], v22 offset:29696
    ds_read_b64_tr_b16 v[42:43], v22 offset:31744
    s_waitcnt lgkmcnt(10)
    v_mfma_f32_32x32x16_bf16 v[104:119], v[48:51], v[208:211], v[104:119]
    ds_read_b64_tr_b16 v[44:45], v23 offset:29696
    ds_read_b64_tr_b16 v[46:47], v23 offset:31744
    s_waitcnt vmcnt(8)
    s_waitcnt lgkmcnt(10)
    v_mfma_f32_32x32x16_bf16 v[56:71], v[52:55], v[212:215], v[56:71]
    ds_read_b64_tr_b16 v[48:49], v20 offset:32768
    ds_read_b64_tr_b16 v[50:51], v20 offset:34816
    s_waitcnt lgkmcnt(10)
    v_mfma_f32_32x32x16_bf16 v[72:87], v[28:31], v[212:215], v[72:87]
    buffer_load_dwordx4 v[152:155], v249, s[32:35], s16 offen sc1
    ds_read_b64_tr_b16 v[52:53], v21 offset:32768
    ds_read_b64_tr_b16 v[54:55], v21 offset:34816
    s_waitcnt lgkmcnt(10)
    v_mfma_f32_32x32x16_bf16 v[120:135], v[32:35], v[212:215], v[120:135]
    ds_read_b64_tr_b16 v[28:29], v24 offset:32768
    ds_read_b64_tr_b16 v[30:31], v24 offset:34816
    s_waitcnt lgkmcnt(10)
    v_mfma_f32_32x32x16_bf16 v[136:151], v[36:39], v[212:215], v[136:151]
    ds_read_b64_tr_b16 v[32:33], v25 offset:32768
    ds_read_b64_tr_b16 v[34:35], v25 offset:34816
    s_waitcnt lgkmcnt(10)
    v_mfma_f32_32x32x16_bf16 v[88:103], v[40:43], v[212:215], v[88:103]
    ds_read_b64_tr_b16 v[36:37], v22 offset:32768
    ds_read_b64_tr_b16 v[38:39], v22 offset:34816
    s_waitcnt lgkmcnt(10)
    v_mfma_f32_32x32x16_bf16 v[104:119], v[44:47], v[212:215], v[104:119]
    buffer_load_dwordx4 v[156:159], v249, s[32:35], s16 offen offset:1024 sc1
    ds_read_b64_tr_b16 v[40:41], v23 offset:32768
    ds_read_b64_tr_b16 v[42:43], v23 offset:34816
    s_barrier
    s_waitcnt vmcnt(9)
    s_waitcnt lgkmcnt(10)
    v_mfma_f32_32x32x16_bf16 v[56:71], v[48:51], v[216:219], v[56:71]
    ds_read_b64_tr_b16 v[44:45], v20 offset:33792
    ds_read_b64_tr_b16 v[46:47], v20 offset:35840
    s_waitcnt lgkmcnt(10)
    v_mfma_f32_32x32x16_bf16 v[72:87], v[52:55], v[216:219], v[72:87]
    ds_read_b64_tr_b16 v[48:49], v21 offset:33792
    ds_read_b64_tr_b16 v[50:51], v21 offset:35840
    s_waitcnt lgkmcnt(10)
    v_mfma_f32_32x32x16_bf16 v[120:135], v[28:31], v[216:219], v[120:135]
    ds_read_b64_tr_b16 v[52:53], v24 offset:33792
    ds_read_b64_tr_b16 v[54:55], v24 offset:35840
    s_waitcnt lgkmcnt(10)
    v_mfma_f32_32x32x16_bf16 v[136:151], v[32:35], v[216:219], v[136:151]
    ds_read_b64_tr_b16 v[28:29], v25 offset:33792
    ds_read_b64_tr_b16 v[30:31], v25 offset:35840
    s_waitcnt lgkmcnt(10)
    v_mfma_f32_32x32x16_bf16 v[88:103], v[36:39], v[216:219], v[88:103]
    buffer_load_dwordx4 v[160:163], v249, s[32:35], s16 offen offset:2048 sc1
    ds_read_b64_tr_b16 v[32:33], v22 offset:33792
    ds_read_b64_tr_b16 v[34:35], v22 offset:35840
    s_waitcnt lgkmcnt(10)
    v_mfma_f32_32x32x16_bf16 v[104:119], v[40:43], v[216:219], v[104:119]
    ds_read_b64_tr_b16 v[36:37], v23 offset:33792
    ds_read_b64_tr_b16 v[38:39], v23 offset:35840
    s_waitcnt vmcnt(9)
    s_waitcnt lgkmcnt(10)
    v_mfma_f32_32x32x16_bf16 v[56:71], v[44:47], v[220:223], v[56:71]
    ds_read_b64_tr_b16 v[40:41], v20 offset:36864
    ds_read_b64_tr_b16 v[42:43], v20 offset:38912
    s_waitcnt lgkmcnt(10)
    v_mfma_f32_32x32x16_bf16 v[72:87], v[48:51], v[220:223], v[72:87]
    ds_read_b64_tr_b16 v[44:45], v21 offset:36864
    ds_read_b64_tr_b16 v[46:47], v21 offset:38912
    s_waitcnt lgkmcnt(10)
    v_mfma_f32_32x32x16_bf16 v[120:135], v[52:55], v[220:223], v[120:135]
    ds_read_b64_tr_b16 v[48:49], v24 offset:36864
    ds_read_b64_tr_b16 v[50:51], v24 offset:38912
    s_waitcnt lgkmcnt(10)
    v_mfma_f32_32x32x16_bf16 v[136:151], v[28:31], v[220:223], v[136:151]
    buffer_load_dwordx4 v[164:167], v249, s[32:35], s16 offen offset:3072 sc1
    ds_read_b64_tr_b16 v[52:53], v25 offset:36864
    ds_read_b64_tr_b16 v[54:55], v25 offset:38912
    s_waitcnt lgkmcnt(10)
    v_mfma_f32_32x32x16_bf16 v[88:103], v[32:35], v[220:223], v[88:103]
    s_add_u32 s16, s16, 16384
    ds_read_b64_tr_b16 v[28:29], v22 offset:36864
    ds_read_b64_tr_b16 v[30:31], v22 offset:38912
    s_waitcnt lgkmcnt(10)
    v_mfma_f32_32x32x16_bf16 v[104:119], v[36:39], v[220:223], v[104:119]
    s_and_b32 s16, s16, 0x3ffff
    ds_read_b64_tr_b16 v[32:33], v23 offset:36864
    ds_read_b64_tr_b16 v[34:35], v23 offset:38912
    s_waitcnt vmcnt(9)
    s_waitcnt lgkmcnt(10)
    v_mfma_f32_32x32x16_bf16 v[56:71], v[40:43], v[224:227], v[56:71]
    ds_read_b64_tr_b16 v[36:37], v20 offset:37888
    ds_read_b64_tr_b16 v[38:39], v20 offset:39936
    s_waitcnt lgkmcnt(10)
    v_mfma_f32_32x32x16_bf16 v[72:87], v[44:47], v[224:227], v[72:87]
    ds_read_b64_tr_b16 v[40:41], v21 offset:37888
    ds_read_b64_tr_b16 v[42:43], v21 offset:39936
    s_waitcnt lgkmcnt(10)
    v_mfma_f32_32x32x16_bf16 v[120:135], v[48:51], v[224:227], v[120:135]
    buffer_load_dwordx4 v[168:171], v249, s[32:35], s16 offen sc1
    ds_read_b64_tr_b16 v[44:45], v24 offset:37888
    ds_read_b64_tr_b16 v[46:47], v24 offset:39936
    s_waitcnt lgkmcnt(10)
    v_mfma_f32_32x32x16_bf16 v[136:151], v[52:55], v[224:227], v[136:151]
    ds_read_b64_tr_b16 v[48:49], v25 offset:37888
    ds_read_b64_tr_b16 v[50:51], v25 offset:39936
    s_waitcnt lgkmcnt(10)
    v_mfma_f32_32x32x16_bf16 v[88:103], v[28:31], v[224:227], v[88:103]
    ds_read_b64_tr_b16 v[52:53], v22 offset:37888
    ds_read_b64_tr_b16 v[54:55], v22 offset:39936
    s_waitcnt lgkmcnt(10)
    v_mfma_f32_32x32x16_bf16 v[104:119], v[32:35], v[224:227], v[104:119]
    ds_read_b64_tr_b16 v[28:29], v23 offset:37888
    ds_read_b64_tr_b16 v[30:31], v23 offset:39936
    s_waitcnt vmcnt(9)
    s_waitcnt lgkmcnt(10)
    v_mfma_f32_32x32x16_bf16 v[56:71], v[36:39], v[228:231], v[56:71]
    ds_read_b64_tr_b16 v[32:33], v20 offset:40960
    ds_read_b64_tr_b16 v[34:35], v20 offset:43008
    s_waitcnt lgkmcnt(10)
    v_mfma_f32_32x32x16_bf16 v[72:87], v[40:43], v[228:231], v[72:87]
    buffer_load_dwordx4 v[172:175], v249, s[32:35], s16 offen offset:1024 sc1
    ds_read_b64_tr_b16 v[36:37], v21 offset:40960
    ds_read_b64_tr_b16 v[38:39], v21 offset:43008
    s_waitcnt lgkmcnt(10)
    v_mfma_f32_32x32x16_bf16 v[120:135], v[44:47], v[228:231], v[120:135]
    ds_read_b64_tr_b16 v[40:41], v24 offset:40960
    ds_read_b64_tr_b16 v[42:43], v24 offset:43008
    s_waitcnt lgkmcnt(10)
    v_mfma_f32_32x32x16_bf16 v[136:151], v[48:51], v[228:231], v[136:151]
    ds_read_b64_tr_b16 v[44:45], v25 offset:40960
    ds_read_b64_tr_b16 v[46:47], v25 offset:43008
    s_waitcnt lgkmcnt(10)
    v_mfma_f32_32x32x16_bf16 v[88:103], v[52:55], v[228:231], v[88:103]
    ds_read_b64_tr_b16 v[48:49], v22 offset:40960
    ds_read_b64_tr_b16 v[50:51], v22 offset:43008
    s_waitcnt lgkmcnt(10)
    v_mfma_f32_32x32x16_bf16 v[104:119], v[28:31], v[228:231], v[104:119]
    buffer_load_dwordx4 v[176:179], v249, s[32:35], s16 offen offset:2048 sc1
    ds_read_b64_tr_b16 v[52:53], v23 offset:40960
    ds_read_b64_tr_b16 v[54:55], v23 offset:43008
    s_barrier
    s_waitcnt vmcnt(10)
    s_waitcnt lgkmcnt(10)
    v_mfma_f32_32x32x16_bf16 v[56:71], v[32:35], v[232:235], v[56:71]
    ds_read_b64_tr_b16 v[28:29], v20 offset:41984
    ds_read_b64_tr_b16 v[30:31], v20 offset:44032
    s_waitcnt lgkmcnt(10)
    v_mfma_f32_32x32x16_bf16 v[72:87], v[36:39], v[232:235], v[72:87]
    ds_read_b64_tr_b16 v[32:33], v21 offset:41984
    ds_read_b64_tr_b16 v[34:35], v21 offset:44032
    s_waitcnt lgkmcnt(10)
    v_mfma_f32_32x32x16_bf16 v[120:135], v[40:43], v[232:235], v[120:135]
    ds_read_b64_tr_b16 v[36:37], v24 offset:41984
    ds_read_b64_tr_b16 v[38:39], v24 offset:44032
    s_waitcnt lgkmcnt(10)
    v_mfma_f32_32x32x16_bf16 v[136:151], v[44:47], v[232:235], v[136:151]
    buffer_load_dwordx4 v[180:183], v249, s[32:35], s16 offen offset:3072 sc1
    ds_read_b64_tr_b16 v[40:41], v25 offset:41984
    ds_read_b64_tr_b16 v[42:43], v25 offset:44032
    s_waitcnt lgkmcnt(10)
    v_mfma_f32_32x32x16_bf16 v[88:103], v[48:51], v[232:235], v[88:103]
    s_add_u32 s16, s16, 16384
    ds_read_b64_tr_b16 v[44:45], v22 offset:41984
    ds_read_b64_tr_b16 v[46:47], v22 offset:44032
    s_waitcnt lgkmcnt(10)
    v_mfma_f32_32x32x16_bf16 v[104:119], v[52:55], v[232:235], v[104:119]
    s_and_b32 s16, s16, 0x3ffff
    ds_read_b64_tr_b16 v[48:49], v23 offset:41984
    ds_read_b64_tr_b16 v[50:51], v23 offset:44032
    s_waitcnt vmcnt(10)
    s_waitcnt lgkmcnt(10)
    v_mfma_f32_32x32x16_bf16 v[56:71], v[28:31], v[236:239], v[56:71]
    buffer_load_dwordx4 v[184:187], v249, s[32:35], s16 offen sc1
    ds_read_b64_tr_b16 v[52:53], v20 offset:45056
    ds_read_b64_tr_b16 v[54:55], v20 offset:47104
    s_waitcnt lgkmcnt(10)
    v_mfma_f32_32x32x16_bf16 v[72:87], v[32:35], v[236:239], v[72:87]
    ds_read_b64_tr_b16 v[28:29], v21 offset:45056
    ds_read_b64_tr_b16 v[30:31], v21 offset:47104
    s_waitcnt lgkmcnt(10)
    v_mfma_f32_32x32x16_bf16 v[120:135], v[36:39], v[236:239], v[120:135]
    ds_read_b64_tr_b16 v[32:33], v24 offset:45056
    ds_read_b64_tr_b16 v[34:35], v24 offset:47104
    s_waitcnt lgkmcnt(10)
    v_mfma_f32_32x32x16_bf16 v[136:151], v[40:43], v[236:239], v[136:151]
    ds_read_b64_tr_b16 v[36:37], v25 offset:45056
    ds_read_b64_tr_b16 v[38:39], v25 offset:47104
    s_waitcnt lgkmcnt(10)
    v_mfma_f32_32x32x16_bf16 v[88:103], v[44:47], v[236:239], v[88:103]
    buffer_load_dwordx4 v[188:191], v249, s[32:35], s16 offen offset:1024 sc1
    ds_read_b64_tr_b16 v[40:41], v22 offset:45056
    ds_read_b64_tr_b16 v[42:43], v22 offset:47104
    s_waitcnt lgkmcnt(10)
    v_mfma_f32_32x32x16_bf16 v[104:119], v[48:51], v[236:239], v[104:119]
    ds_read_b64_tr_b16 v[44:45], v23 offset:45056
    ds_read_b64_tr_b16 v[46:47], v23 offset:47104
    s_waitcnt vmcnt(11)
    s_waitcnt lgkmcnt(10)
    v_mfma_f32_32x32x16_bf16 v[56:71], v[52:55], v[240:243], v[56:71]
    ds_read_b64_tr_b16 v[48:49], v20 offset:46080
    ds_read_b64_tr_b16 v[50:51], v20 offset:48128
    s_waitcnt lgkmcnt(10)
    v_mfma_f32_32x32x16_bf16 v[72:87], v[28:31], v[240:243], v[72:87]
    buffer_load_dwordx4 v[192:195], v249, s[32:35], s16 offen offset:2048 sc1
    ds_read_b64_tr_b16 v[52:53], v21 offset:46080
    ds_read_b64_tr_b16 v[54:55], v21 offset:48128
    s_waitcnt lgkmcnt(10)
    v_mfma_f32_32x32x16_bf16 v[120:135], v[32:35], v[240:243], v[120:135]
    ds_read_b64_tr_b16 v[28:29], v24 offset:46080
    ds_read_b64_tr_b16 v[30:31], v24 offset:48128
    s_waitcnt lgkmcnt(10)
    v_mfma_f32_32x32x16_bf16 v[136:151], v[36:39], v[240:243], v[136:151]
    ds_read_b64_tr_b16 v[32:33], v25 offset:46080
    ds_read_b64_tr_b16 v[34:35], v25 offset:48128
    s_waitcnt lgkmcnt(10)
    v_mfma_f32_32x32x16_bf16 v[88:103], v[40:43], v[240:243], v[88:103]
    ds_read_b64_tr_b16 v[36:37], v22 offset:46080
    ds_read_b64_tr_b16 v[38:39], v22 offset:48128
    s_waitcnt lgkmcnt(10)
    v_mfma_f32_32x32x16_bf16 v[104:119], v[44:47], v[240:243], v[104:119]
    buffer_load_dwordx4 v[196:199], v249, s[32:35], s16 offen offset:3072 sc1
    ds_read_b64_tr_b16 v[40:41], v23 offset:46080
    ds_read_b64_tr_b16 v[42:43], v23 offset:48128
    s_waitcnt vmcnt(12)
    s_waitcnt lgkmcnt(10)
    v_mfma_f32_32x32x16_bf16 v[56:71], v[48:51], v[244:247], v[56:71]
    s_add_u32 s16, s16, 16384
    ds_read_b64_tr_b16 v[44:45], v20
    ds_read_b64_tr_b16 v[46:47], v20 offset:2048
    s_waitcnt lgkmcnt(10)
    v_mfma_f32_32x32x16_bf16 v[72:87], v[52:55], v[244:247], v[72:87]
    s_and_b32 s16, s16, 0x3ffff
    ds_read_b64_tr_b16 v[48:49], v21
    ds_read_b64_tr_b16 v[50:51], v21 offset:2048
    s_waitcnt lgkmcnt(10)
    v_mfma_f32_32x32x16_bf16 v[120:135], v[28:31], v[244:247], v[120:135]
    buffer_load_dwordx4 v[200:203], v249, s[32:35], s16 offen sc1
    ds_read_b64_tr_b16 v[52:53], v24
    ds_read_b64_tr_b16 v[54:55], v24 offset:2048
    s_waitcnt lgkmcnt(10)
    v_mfma_f32_32x32x16_bf16 v[136:151], v[32:35], v[244:247], v[136:151]
    ds_read_b64_tr_b16 v[28:29], v25
    ds_read_b64_tr_b16 v[30:31], v25 offset:2048
    s_waitcnt lgkmcnt(10)
    v_mfma_f32_32x32x16_bf16 v[88:103], v[36:39], v[244:247], v[88:103]
    ds_read_b64_tr_b16 v[32:33], v22
    ds_read_b64_tr_b16 v[34:35], v22 offset:2048
    s_waitcnt lgkmcnt(10)
    v_mfma_f32_32x32x16_bf16 v[104:119], v[40:43], v[244:247], v[104:119]
    buffer_load_dwordx4 v[204:207], v249, s[32:35], s16 offen offset:1024 sc1
    ds_read_b64_tr_b16 v[36:37], v23
    ds_read_b64_tr_b16 v[38:39], v23 offset:2048
    s_barrier
    s_waitcnt vmcnt(13)
    s_waitcnt lgkmcnt(10)
    v_mfma_f32_32x32x16_bf16 v[56:71], v[44:47], v[152:155], v[56:71]
    ds_read_b64_tr_b16 v[40:41], v20 offset:1024
    ds_read_b64_tr_b16 v[42:43], v20 offset:3072
    s_waitcnt lgkmcnt(10)
    v_mfma_f32_32x32x16_bf16 v[72:87], v[48:51], v[152:155], v[72:87]
    ds_read_b64_tr_b16 v[44:45], v21 offset:1024
    ds_read_b64_tr_b16 v[46:47], v21 offset:3072
    s_waitcnt lgkmcnt(10)
    v_mfma_f32_32x32x16_bf16 v[120:135], v[52:55], v[152:155], v[120:135]
    ds_read_b64_tr_b16 v[48:49], v24 offset:1024
    ds_read_b64_tr_b16 v[50:51], v24 offset:3072
    s_waitcnt lgkmcnt(10)
    v_mfma_f32_32x32x16_bf16 v[136:151], v[28:31], v[152:155], v[136:151]
    buffer_load_dwordx4 v[208:211], v249, s[32:35], s16 offen offset:2048 sc1
    ds_read_b64_tr_b16 v[52:53], v25 offset:1024
    ds_read_b64_tr_b16 v[54:55], v25 offset:3072
    s_waitcnt lgkmcnt(10)
    v_mfma_f32_32x32x16_bf16 v[88:103], v[32:35], v[152:155], v[88:103]
    ds_read_b64_tr_b16 v[28:29], v22 offset:1024
    ds_read_b64_tr_b16 v[30:31], v22 offset:3072
    s_waitcnt lgkmcnt(10)
    v_mfma_f32_32x32x16_bf16 v[104:119], v[36:39], v[152:155], v[104:119]
    ds_read_b64_tr_b16 v[32:33], v23 offset:1024
    ds_read_b64_tr_b16 v[34:35], v23 offset:3072
    s_waitcnt vmcnt(13)
    s_waitcnt lgkmcnt(10)
    v_mfma_f32_32x32x16_bf16 v[56:71], v[40:43], v[156:159], v[56:71]
    buffer_load_dwordx4 v[212:215], v249, s[32:35], s16 offen offset:3072 sc1
    ds_read_b64_tr_b16 v[36:37], v20 offset:4096
    ds_read_b64_tr_b16 v[38:39], v20 offset:6144
    s_waitcnt lgkmcnt(10)
    v_mfma_f32_32x32x16_bf16 v[72:87], v[44:47], v[156:159], v[72:87]
    s_add_u32 s16, s16, 16384
    ds_read_b64_tr_b16 v[40:41], v21 offset:4096
    ds_read_b64_tr_b16 v[42:43], v21 offset:6144
    s_waitcnt lgkmcnt(10)
    v_mfma_f32_32x32x16_bf16 v[120:135], v[48:51], v[156:159], v[120:135]
    s_and_b32 s16, s16, 0x3ffff
    ds_read_b64_tr_b16 v[44:45], v24 offset:4096
    ds_read_b64_tr_b16 v[46:47], v24 offset:6144
    s_waitcnt lgkmcnt(10)
    v_mfma_f32_32x32x16_bf16 v[136:151], v[52:55], v[156:159], v[136:151]
    ds_read_b64_tr_b16 v[48:49], v25 offset:4096
    ds_read_b64_tr_b16 v[50:51], v25 offset:6144
    s_waitcnt lgkmcnt(10)
    v_mfma_f32_32x32x16_bf16 v[88:103], v[28:31], v[156:159], v[88:103]
    buffer_load_dwordx4 v[216:219], v249, s[32:35], s16 offen sc1
    ds_read_b64_tr_b16 v[52:53], v22 offset:4096
    ds_read_b64_tr_b16 v[54:55], v22 offset:6144
    s_waitcnt lgkmcnt(10)
    v_mfma_f32_32x32x16_bf16 v[104:119], v[32:35], v[156:159], v[104:119]
    ds_read_b64_tr_b16 v[28:29], v23 offset:4096
    ds_read_b64_tr_b16 v[30:31], v23 offset:6144
    s_waitcnt vmcnt(14)
    s_waitcnt lgkmcnt(10)
    v_mfma_f32_32x32x16_bf16 v[56:71], v[36:39], v[160:163], v[56:71]
    ds_read_b64_tr_b16 v[32:33], v20 offset:5120
    ds_read_b64_tr_b16 v[34:35], v20 offset:7168
    s_waitcnt lgkmcnt(10)
    v_mfma_f32_32x32x16_bf16 v[72:87], v[40:43], v[160:163], v[72:87]
    buffer_load_dwordx4 v[220:223], v249, s[32:35], s16 offen offset:1024 sc1
    ds_read_b64_tr_b16 v[36:37], v21 offset:5120
    ds_read_b64_tr_b16 v[38:39], v21 offset:7168
    s_waitcnt lgkmcnt(10)
    v_mfma_f32_32x32x16_bf16 v[120:135], v[44:47], v[160:163], v[120:135]
    ds_read_b64_tr_b16 v[40:41], v24 offset:5120
    ds_read_b64_tr_b16 v[42:43], v24 offset:7168
    s_waitcnt lgkmcnt(10)
    v_mfma_f32_32x32x16_bf16 v[136:151], v[48:51], v[160:163], v[136:151]
    ds_read_b64_tr_b16 v[44:45], v25 offset:5120
    ds_read_b64_tr_b16 v[46:47], v25 offset:7168
    s_waitcnt lgkmcnt(10)
    v_mfma_f32_32x32x16_bf16 v[88:103], v[52:55], v[160:163], v[88:103]
    ds_read_b64_tr_b16 v[48:49], v22 offset:5120
    ds_read_b64_tr_b16 v[50:51], v22 offset:7168
    s_waitcnt lgkmcnt(10)
    v_mfma_f32_32x32x16_bf16 v[104:119], v[28:31], v[160:163], v[104:119]
    buffer_load_dwordx4 v[224:227], v249, s[32:35], s16 offen offset:2048 sc1
    ds_read_b64_tr_b16 v[52:53], v23 offset:5120
    ds_read_b64_tr_b16 v[54:55], v23 offset:7168
    s_waitcnt vmcnt(15)
    s_waitcnt lgkmcnt(10)
    v_mfma_f32_32x32x16_bf16 v[56:71], v[32:35], v[164:167], v[56:71]
    ds_read_b64_tr_b16 v[28:29], v20 offset:8192
    ds_read_b64_tr_b16 v[30:31], v20 offset:10240
    s_waitcnt lgkmcnt(10)
    v_mfma_f32_32x32x16_bf16 v[72:87], v[36:39], v[164:167], v[72:87]
    ds_read_b64_tr_b16 v[32:33], v21 offset:8192
    ds_read_b64_tr_b16 v[34:35], v21 offset:10240
    s_waitcnt lgkmcnt(10)
    v_mfma_f32_32x32x16_bf16 v[120:135], v[40:43], v[164:167], v[120:135]
    buffer_load_dwordx4 v[228:231], v249, s[32:35], s16 offen offset:3072 sc1
    ds_read_b64_tr_b16 v[36:37], v24 offset:8192
    ds_read_b64_tr_b16 v[38:39], v24 offset:10240
    s_waitcnt lgkmcnt(10)
    v_mfma_f32_32x32x16_bf16 v[136:151], v[44:47], v[164:167], v[136:151]
    s_add_u32 s16, s16, 16384
    ds_read_b64_tr_b16 v[40:41], v25 offset:8192
    ds_read_b64_tr_b16 v[42:43], v25 offset:10240
    s_waitcnt lgkmcnt(10)
    v_mfma_f32_32x32x16_bf16 v[88:103], v[48:51], v[164:167], v[88:103]
    s_and_b32 s16, s16, 0x3ffff
    ds_read_b64_tr_b16 v[44:45], v22 offset:8192
    ds_read_b64_tr_b16 v[46:47], v22 offset:10240
    s_waitcnt lgkmcnt(10)
    v_mfma_f32_32x32x16_bf16 v[104:119], v[52:55], v[164:167], v[104:119]
    buffer_load_dwordx4 v[232:235], v249, s[32:35], s16 offen sc1
    ds_read_b64_tr_b16 v[48:49], v23 offset:8192
    ds_read_b64_tr_b16 v[50:51], v23 offset:10240
    s_barrier
    s_waitcnt vmcnt(16)
    s_waitcnt lgkmcnt(10)
    v_mfma_f32_32x32x16_bf16 v[56:71], v[28:31], v[168:171], v[56:71]
    ds_read_b64_tr_b16 v[52:53], v20 offset:9216
    ds_read_b64_tr_b16 v[54:55], v20 offset:11264
    s_waitcnt lgkmcnt(10)
    v_mfma_f32_32x32x16_bf16 v[72:87], v[32:35], v[168:171], v[72:87]
    ds_read_b64_tr_b16 v[28:29], v21 offset:9216
    ds_read_b64_tr_b16 v[30:31], v21 offset:11264
    s_waitcnt lgkmcnt(10)
    v_mfma_f32_32x32x16_bf16 v[120:135], v[36:39], v[168:171], v[120:135]
    ds_read_b64_tr_b16 v[32:33], v24 offset:9216
    ds_read_b64_tr_b16 v[34:35], v24 offset:11264
    s_waitcnt lgkmcnt(10)
    v_mfma_f32_32x32x16_bf16 v[136:151], v[40:43], v[168:171], v[136:151]
    buffer_load_dwordx4 v[236:239], v249, s[32:35], s16 offen offset:1024 sc1
    ds_read_b64_tr_b16 v[36:37], v25 offset:9216
    ds_read_b64_tr_b16 v[38:39], v25 offset:11264
    s_waitcnt lgkmcnt(10)
    v_mfma_f32_32x32x16_bf16 v[88:103], v[44:47], v[168:171], v[88:103]
    ds_read_b64_tr_b16 v[40:41], v22 offset:9216
    ds_read_b64_tr_b16 v[42:43], v22 offset:11264
    s_waitcnt lgkmcnt(10)
    v_mfma_f32_32x32x16_bf16 v[104:119], v[48:51], v[168:171], v[104:119]
    ds_read_b64_tr_b16 v[44:45], v23 offset:9216
    ds_read_b64_tr_b16 v[46:47], v23 offset:11264
    s_waitcnt vmcnt(16)
    s_waitcnt lgkmcnt(10)
    v_mfma_f32_32x32x16_bf16 v[56:71], v[52:55], v[172:175], v[56:71]
    buffer_load_dwordx4 v[240:243], v249, s[32:35], s16 offen offset:2048 sc1
    ds_read_b64_tr_b16 v[48:49], v20 offset:12288
    ds_read_b64_tr_b16 v[50:51], v20 offset:14336
    s_waitcnt lgkmcnt(10)
    v_mfma_f32_32x32x16_bf16 v[72:87], v[28:31], v[172:175], v[72:87]
    ds_read_b64_tr_b16 v[52:53], v21 offset:12288
    ds_read_b64_tr_b16 v[54:55], v21 offset:14336
    s_waitcnt lgkmcnt(10)
    v_mfma_f32_32x32x16_bf16 v[120:135], v[32:35], v[172:175], v[120:135]
    ds_read_b64_tr_b16 v[28:29], v24 offset:12288
    ds_read_b64_tr_b16 v[30:31], v24 offset:14336
    s_waitcnt lgkmcnt(10)
    v_mfma_f32_32x32x16_bf16 v[136:151], v[36:39], v[172:175], v[136:151]
    ds_read_b64_tr_b16 v[32:33], v25 offset:12288
    ds_read_b64_tr_b16 v[34:35], v25 offset:14336
    s_waitcnt lgkmcnt(10)
    v_mfma_f32_32x32x16_bf16 v[88:103], v[40:43], v[172:175], v[88:103]
    buffer_load_dwordx4 v[244:247], v249, s[32:35], s16 offen offset:3072 sc1
    ds_read_b64_tr_b16 v[36:37], v22 offset:12288
    ds_read_b64_tr_b16 v[38:39], v22 offset:14336
    s_waitcnt lgkmcnt(10)
    v_mfma_f32_32x32x16_bf16 v[104:119], v[44:47], v[172:175], v[104:119]
    s_add_u32 s16, s16, 16384
    ds_read_b64_tr_b16 v[40:41], v23 offset:12288
    ds_read_b64_tr_b16 v[42:43], v23 offset:14336
    s_waitcnt vmcnt(17)
    s_waitcnt lgkmcnt(10)
    v_mfma_f32_32x32x16_bf16 v[56:71], v[48:51], v[176:179], v[56:71]
    s_and_b32 s16, s16, 0x3ffff
    ds_read_b64_tr_b16 v[44:45], v20 offset:13312
    ds_read_b64_tr_b16 v[46:47], v20 offset:15360
    s_waitcnt lgkmcnt(10)
    v_mfma_f32_32x32x16_bf16 v[72:87], v[52:55], v[176:179], v[72:87]
    buffer_load_dwordx4 v[152:155], v249, s[32:35], s16 offen sc1
    ds_read_b64_tr_b16 v[48:49], v21 offset:13312
    ds_read_b64_tr_b16 v[50:51], v21 offset:15360
    s_waitcnt lgkmcnt(10)
    v_mfma_f32_32x32x16_bf16 v[120:135], v[28:31], v[176:179], v[120:135]
    ds_read_b64_tr_b16 v[52:53], v24 offset:13312
    ds_read_b64_tr_b16 v[54:55], v24 offset:15360
    s_waitcnt lgkmcnt(10)
    v_mfma_f32_32x32x16_bf16 v[136:151], v[32:35], v[176:179], v[136:151]
    ds_read_b64_tr_b16 v[28:29], v25 offset:13312
    ds_read_b64_tr_b16 v[30:31], v25 offset:15360
    s_waitcnt lgkmcnt(10)
    v_mfma_f32_32x32x16_bf16 v[88:103], v[36:39], v[176:179], v[88:103]
    ds_read_b64_tr_b16 v[32:33], v22 offset:13312
    ds_read_b64_tr_b16 v[34:35], v22 offset:15360
    s_waitcnt lgkmcnt(10)
    v_mfma_f32_32x32x16_bf16 v[104:119], v[40:43], v[176:179], v[104:119]
    buffer_load_dwordx4 v[156:159], v249, s[32:35], s16 offen offset:1024 sc1
    ds_read_b64_tr_b16 v[36:37], v23 offset:13312
    ds_read_b64_tr_b16 v[38:39], v23 offset:15360
    s_waitcnt vmcnt(18)
    s_waitcnt lgkmcnt(10)
    v_mfma_f32_32x32x16_bf16 v[56:71], v[44:47], v[180:183], v[56:71]
    ds_read_b64_tr_b16 v[40:41], v20 offset:16384
    ds_read_b64_tr_b16 v[42:43], v20 offset:18432
    s_waitcnt lgkmcnt(10)
    v_mfma_f32_32x32x16_bf16 v[72:87], v[48:51], v[180:183], v[72:87]
    ds_read_b64_tr_b16 v[44:45], v21 offset:16384
    ds_read_b64_tr_b16 v[46:47], v21 offset:18432
    s_waitcnt lgkmcnt(10)
    v_mfma_f32_32x32x16_bf16 v[120:135], v[52:55], v[180:183], v[120:135]
    buffer_load_dwordx4 v[160:163], v249, s[32:35], s16 offen offset:2048 sc1
    ds_read_b64_tr_b16 v[48:49], v24 offset:16384
    ds_read_b64_tr_b16 v[50:51], v24 offset:18432
    s_waitcnt lgkmcnt(10)
    v_mfma_f32_32x32x16_bf16 v[136:151], v[28:31], v[180:183], v[136:151]
    ds_read_b64_tr_b16 v[52:53], v25 offset:16384
    ds_read_b64_tr_b16 v[54:55], v25 offset:18432
    s_waitcnt lgkmcnt(10)
    v_mfma_f32_32x32x16_bf16 v[88:103], v[32:35], v[180:183], v[88:103]
    ds_read_b64_tr_b16 v[28:29], v22 offset:16384
    ds_read_b64_tr_b16 v[30:31], v22 offset:18432
    s_waitcnt lgkmcnt(10)
    v_mfma_f32_32x32x16_bf16 v[104:119], v[36:39], v[180:183], v[104:119]
    buffer_load_dwordx4 v[164:167], v249, s[32:35], s16 offen offset:3072 sc1
    ds_read_b64_tr_b16 v[32:33], v23 offset:16384
    ds_read_b64_tr_b16 v[34:35], v23 offset:18432
    s_barrier
    s_waitcnt vmcnt(19)
    s_waitcnt lgkmcnt(10)
    v_mfma_f32_32x32x16_bf16 v[56:71], v[40:43], v[184:187], v[56:71]
    s_add_u32 s16, s16, 16384
    ds_read_b64_tr_b16 v[36:37], v20 offset:17408
    ds_read_b64_tr_b16 v[38:39], v20 offset:19456
    s_waitcnt lgkmcnt(10)
    v_mfma_f32_32x32x16_bf16 v[72:87], v[44:47], v[184:187], v[72:87]
    s_and_b32 s16, s16, 0x3ffff
    ds_read_b64_tr_b16 v[40:41], v21 offset:17408
    ds_read_b64_tr_b16 v[42:43], v21 offset:19456
    s_waitcnt lgkmcnt(10)
    v_mfma_f32_32x32x16_bf16 v[120:135], v[48:51], v[184:187], v[120:135]
    ds_read_b64_tr_b16 v[44:45], v24 offset:17408
    ds_read_b64_tr_b16 v[46:47], v24 offset:19456
    s_waitcnt lgkmcnt(10)
    v_mfma_f32_32x32x16_bf16 v[136:151], v[52:55], v[184:187], v[136:151]
    buffer_load_dwordx4 v[168:171], v249, s[32:35], s16 offen sc1
    ds_read_b64_tr_b16 v[48:49], v25 offset:17408
    ds_read_b64_tr_b16 v[50:51], v25 offset:19456
    s_waitcnt lgkmcnt(10)
    v_mfma_f32_32x32x16_bf16 v[88:103], v[28:31], v[184:187], v[88:103]
    ds_read_b64_tr_b16 v[52:53], v22 offset:17408
    ds_read_b64_tr_b16 v[54:55], v22 offset:19456
    s_waitcnt lgkmcnt(10)
    v_mfma_f32_32x32x16_bf16 v[104:119], v[32:35], v[184:187], v[104:119]
    ds_read_b64_tr_b16 v[28:29], v23 offset:17408
    ds_read_b64_tr_b16 v[30:31], v23 offset:19456
    s_waitcnt vmcnt(19)
    s_waitcnt lgkmcnt(10)
    v_mfma_f32_32x32x16_bf16 v[56:71], v[36:39], v[188:191], v[56:71]
    ds_read_b64_tr_b16 v[32:33], v20 offset:20480
    ds_read_b64_tr_b16 v[34:35], v20 offset:22528
    s_waitcnt lgkmcnt(10)
    v_mfma_f32_32x32x16_bf16 v[72:87], v[40:43], v[188:191], v[72:87]
    buffer_load_dwordx4 v[172:175], v249, s[32:35], s16 offen offset:1024 sc1
    ds_read_b64_tr_b16 v[36:37], v21 offset:20480
    ds_read_b64_tr_b16 v[38:39], v21 offset:22528
    s_waitcnt lgkmcnt(10)
    v_mfma_f32_32x32x16_bf16 v[120:135], v[44:47], v[188:191], v[120:135]
    ds_read_b64_tr_b16 v[40:41], v24 offset:20480
    ds_read_b64_tr_b16 v[42:43], v24 offset:22528
    s_waitcnt lgkmcnt(10)
    v_mfma_f32_32x32x16_bf16 v[136:151], v[48:51], v[188:191], v[136:151]
    ds_read_b64_tr_b16 v[44:45], v25 offset:20480
    ds_read_b64_tr_b16 v[46:47], v25 offset:22528
    s_waitcnt lgkmcnt(10)
    v_mfma_f32_32x32x16_bf16 v[88:103], v[52:55], v[188:191], v[88:103]
    ds_read_b64_tr_b16 v[48:49], v22 offset:20480
    ds_read_b64_tr_b16 v[50:51], v22 offset:22528
    s_waitcnt lgkmcnt(10)
    v_mfma_f32_32x32x16_bf16 v[104:119], v[28:31], v[188:191], v[104:119]
    buffer_load_dwordx4 v[176:179], v249, s[32:35], s16 offen offset:2048 sc1
    ds_read_b64_tr_b16 v[52:53], v23 offset:20480
    ds_read_b64_tr_b16 v[54:55], v23 offset:22528
    s_waitcnt vmcnt(20)
    s_waitcnt lgkmcnt(10)
    v_mfma_f32_32x32x16_bf16 v[56:71], v[32:35], v[192:195], v[56:71]
    ds_read_b64_tr_b16 v[28:29], v20 offset:21504
    ds_read_b64_tr_b16 v[30:31], v20 offset:23552
    s_waitcnt lgkmcnt(10)
    v_mfma_f32_32x32x16_bf16 v[72:87], v[36:39], v[192:195], v[72:87]
    ds_read_b64_tr_b16 v[32:33], v21 offset:21504
    ds_read_b64_tr_b16 v[34:35], v21 offset:23552
    s_waitcnt lgkmcnt(10)
    v_mfma_f32_32x32x16_bf16 v[120:135], v[40:43], v[192:195], v[120:135]
    ds_read_b64_tr_b16 v[36:37], v24 offset:21504
    ds_read_b64_tr_b16 v[38:39], v24 offset:23552
    s_waitcnt lgkmcnt(10)
    v_mfma_f32_32x32x16_bf16 v[136:151], v[44:47], v[192:195], v[136:151]
    buffer_load_dwordx4 v[180:183], v249, s[32:35], s16 offen offset:3072 sc1
    ds_read_b64_tr_b16 v[40:41], v25 offset:21504
    ds_read_b64_tr_b16 v[42:43], v25 offset:23552
L_PAD3:
    s_cbranch_execz L_RET3
    s_waitcnt lgkmcnt(10)
    v_mfma_f32_32x32x16_bf16 v[88:103], v[48:51], v[192:195], v[88:103]
    s_add_u32 s16, s16, 16384
    ds_read_b64_tr_b16 v[44:45], v22 offset:21504
    ds_read_b64_tr_b16 v[46:47], v22 offset:23552
    s_waitcnt lgkmcnt(10)
    v_mfma_f32_32x32x16_bf16 v[104:119], v[52:55], v[192:195], v[104:119]
    s_and_b32 s16, s16, 0x3ffff
    ds_read_b64_tr_b16 v[48:49], v23 offset:21504
    ds_read_b64_tr_b16 v[50:51], v23 offset:23552
    s_waitcnt vmcnt(20)
    s_waitcnt lgkmcnt(10)
    v_mfma_f32_32x32x16_bf16 v[56:71], v[28:31], v[196:199], v[56:71]
    ds_read_b64_tr_b16 v[52:53], v20 offset:24576
    ds_read_b64_tr_b16 v[54:55], v20 offset:26624
    s_waitcnt lgkmcnt(10)
    v_mfma_f32_32x32x16_bf16 v[72:87], v[32:35], v[196:199], v[72:87]
    buffer_load_dwordx4 v[184:187], v249, s[32:35], s16 offen sc1
    ds_read_b64_tr_b16 v[28:29], v21 offset:24576
    ds_read_b64_tr_b16 v[30:31], v21 offset:26624
    s_waitcnt lgkmcnt(10)
    v_mfma_f32_32x32x16_bf16 v[120:135], v[36:39], v[196:199], v[120:135]
    ds_read_b64_tr_b16 v[32:33], v20 offset:25600
    ds_read_b64_tr_b16 v[34:35], v20 offset:27648
    s_waitcnt lgkmcnt(10)
    v_mfma_f32_32x32x16_bf16 v[136:151], v[40:43], v[196:199], v[136:151]
    ds_read_b64_tr_b16 v[36:37], v21 offset:25600
    ds_read_b64_tr_b16 v[38:39], v21 offset:27648
    s_waitcnt lgkmcnt(10)
    v_mfma_f32_32x32x16_bf16 v[88:103], v[44:47], v[196:199], v[88:103]
    ds_read_b64_tr_b16 v[40:41], v20 offset:28672
    ds_read_b64_tr_b16 v[42:43], v20 offset:30720
    s_waitcnt lgkmcnt(10)
    v_mfma_f32_32x32x16_bf16 v[104:119], v[48:51], v[196:199], v[104:119]
    buffer_load_dwordx4 v[188:191], v249, s[32:35], s16 offen offset:1024 sc1
    ds_read_b64_tr_b16 v[44:45], v21 offset:28672
    ds_read_b64_tr_b16 v[46:47], v21 offset:30720
    s_barrier
    s_waitcnt vmcnt(21)
    s_waitcnt lgkmcnt(10)
    v_mfma_f32_32x32x16_bf16 v[56:71], v[52:55], v[200:203], v[56:71]
    ds_read_b64_tr_b16 v[48:49], v20 offset:29696
    ds_read_b64_tr_b16 v[50:51], v20 offset:31744
    s_waitcnt lgkmcnt(10)
    v_mfma_f32_32x32x16_bf16 v[72:87], v[28:31], v[200:203], v[72:87]
    ds_read_b64_tr_b16 v[52:53], v21 offset:29696
    ds_read_b64_tr_b16 v[54:55], v21 offset:31744
    s_waitcnt vmcnt(20)
    s_waitcnt lgkmcnt(10)
    v_mfma_f32_32x32x16_bf16 v[56:71], v[32:35], v[204:207], v[56:71]
    ds_read_b64_tr_b16 v[28:29], v24 offset:24576
    ds_read_b64_tr_b16 v[30:31], v24 offset:26624
    s_waitcnt lgkmcnt(10)
    v_mfma_f32_32x32x16_bf16 v[72:87], v[36:39], v[204:207], v[72:87]
    buffer_load_dwordx4 v[192:195], v249, s[32:35], s16 offen offset:2048 sc1
    ds_read_b64_tr_b16 v[32:33], v25 offset:24576
    ds_read_b64_tr_b16 v[34:35], v25 offset:26624
    s_waitcnt vmcnt(20)
    s_waitcnt lgkmcnt(10)
    v_mfma_f32_32x32x16_bf16 v[56:71], v[40:43], v[208:211], v[56:71]
    ds_read_b64_tr_b16 v[36:37], v22 offset:24576
    ds_read_b64_tr_b16 v[38:39], v22 offset:26624
    s_waitcnt lgkmcnt(10)
    v_mfma_f32_32x32x16_bf16 v[72:87], v[44:47], v[208:211], v[72:87]
    ds_read_b64_tr_b16 v[40:41], v23 offset:24576
    ds_read_b64_tr_b16 v[42:43], v23 offset:26624
    s_waitcnt vmcnt(19)
    s_waitcnt lgkmcnt(10)
    v_mfma_f32_32x32x16_bf16 v[56:71], v[48:51], v[212:215], v[56:71]
    ds_read_b64_tr_b16 v[44:45], v24 offset:25600
    ds_read_b64_tr_b16 v[46:47], v24 offset:27648
    s_waitcnt lgkmcnt(10)
    v_mfma_f32_32x32x16_bf16 v[72:87], v[52:55], v[212:215], v[72:87]
    buffer_load_dwordx4 v[196:199], v249, s[32:35], s16 offen offset:3072 sc1
    ds_read_b64_tr_b16 v[48:49], v25 offset:25600
    ds_read_b64_tr_b16 v[50:51], v25 offset:27648
    s_barrier
    s_waitcnt lgkmcnt(10)
    v_mfma_f32_32x32x16_bf16 v[120:135], v[28:31], v[200:203], v[120:135]
    s_add_u32 s16, s16, 16384
    ds_read_b64_tr_b16 v[52:53], v22 offset:25600
    ds_read_b64_tr_b16 v[54:55], v22 offset:27648
    s_waitcnt lgkmcnt(10)
    v_mfma_f32_32x32x16_bf16 v[136:151], v[32:35], v[200:203], v[136:151]
    s_and_b32 s16, s16, 0x3ffff
    ds_read_b64_tr_b16 v[28:29], v23 offset:25600
    ds_read_b64_tr_b16 v[30:31], v23 offset:27648
    s_waitcnt lgkmcnt(10)
    v_mfma_f32_32x32x16_bf16 v[88:103], v[36:39], v[200:203], v[88:103]
    ds_read_b64_tr_b16 v[32:33], v24 offset:28672
    ds_read_b64_tr_b16 v[34:35], v24 offset:30720
    s_waitcnt lgkmcnt(10)
    v_mfma_f32_32x32x16_bf16 v[104:119], v[40:43], v[200:203], v[104:119]
    buffer_load_dwordx4 v[200:203], v249, s[32:35], s16 offen sc1
    ds_read_b64_tr_b16 v[36:37], v25 offset:28672
    ds_read_b64_tr_b16 v[38:39], v25 offset:30720
    s_waitcnt lgkmcnt(10)
    v_mfma_f32_32x32x16_bf16 v[120:135], v[44:47], v[204:207], v[120:135]
    ds_read_b64_tr_b16 v[40:41], v22 offset:28672
    ds_read_b64_tr_b16 v[42:43], v22 offset:30720
    s_waitcnt lgkmcnt(10)
    v_mfma_f32_32x32x16_bf16 v[136:151], v[48:51], v[204:207], v[136:151]
    ds_read_b64_tr_b16 v[44:45], v23 offset:28672
    ds_read_b64_tr_b16 v[46:47], v23 offset:30720
    s_waitcnt lgkmcnt(10)
    v_mfma_f32_32x32x16_bf16 v[88:103], v[52:55], v[204:207], v[88:103]
    ds_read_b64_tr_b16 v[48:49], v24 offset:29696
    ds_read_b64_tr_b16 v[50:51], v24 offset:31744
    s_waitcnt lgkmcnt(10)
    v_mfma_f32_32x32x16_bf16 v[104:119], v[28:31], v[204:207], v[104:119]
    buffer_load_dwordx4 v[204:207], v249, s[32:35], s16 offen offset:1024 sc1
    ds_read_b64_tr_b16 v[52:53], v25 offset:29696
    ds_read_b64_tr_b16 v[54:55], v25 offset:31744
    s_waitcnt lgkmcnt(10)
    v_mfma_f32_32x32x16_bf16 v[120:135], v[32:35], v[208:211], v[120:135]
    ds_read_b64_tr_b16 v[28:29], v22 offset:29696
    ds_read_b64_tr_b16 v[30:31], v22 offset:31744
    s_waitcnt lgkmcnt(10)
    v_mfma_f32_32x32x16_bf16 v[136:151], v[36:39], v[208:211], v[136:151]
    ds_read_b64_tr_b16 v[32:33], v23 offset:29696
    ds_read_b64_tr_b16 v[34:35], v23 offset:31744
    s_waitcnt lgkmcnt(10)
    v_mfma_f32_32x32x16_bf16 v[88:103], v[40:43], v[208:211], v[88:103]
    ds_read_b64_tr_b16 v[36:37], v20 offset:32768
    ds_read_b64_tr_b16 v[38:39], v20 offset:34816
    s_waitcnt lgkmcnt(10)
    v_mfma_f32_32x32x16_bf16 v[104:119], v[44:47], v[208:211], v[104:119]
    buffer_load_dwordx4 v[208:211], v249, s[32:35], s16 offen offset:2048 sc1
    ds_read_b64_tr_b16 v[40:41], v20 offset:33792
    ds_read_b64_tr_b16 v[42:43], v20 offset:35840
    s_waitcnt lgkmcnt(10)
    v_mfma_f32_32x32x16_bf16 v[120:135], v[48:51], v[212:215], v[120:135]
    ds_read_b64_tr_b16 v[44:45], v20 offset:36864
    ds_read_b64_tr_b16 v[46:47], v20 offset:38912
    s_waitcnt lgkmcnt(10)
    v_mfma_f32_32x32x16_bf16 v[136:151], v[52:55], v[212:215], v[136:151]
    ds_read_b64_tr_b16 v[48:49], v20 offset:37888
    ds_read_b64_tr_b16 v[50:51], v20 offset:39936
    s_waitcnt lgkmcnt(10)
    v_mfma_f32_32x32x16_bf16 v[88:103], v[28:31], v[212:215], v[88:103]
    ds_read_b64_tr_b16 v[52:53], v20 offset:40960
    ds_read_b64_tr_b16 v[54:55], v20 offset:43008
    s_waitcnt lgkmcnt(10)
    v_mfma_f32_32x32x16_bf16 v[104:119], v[32:35], v[212:215], v[104:119]
    buffer_load_dwordx4 v[212:215], v249, s[32:35], s16 offen offset:3072 sc1
    ds_read_b64_tr_b16 v[28:29], v20 offset:41984
    ds_read_b64_tr_b16 v[30:31], v20 offset:44032
    s_barrier
    s_waitcnt vmcnt(23)
    s_waitcnt lgkmcnt(10)
    v_mfma_f32_32x32x16_bf16 v[56:71], v[36:39], v[216:219], v[56:71]
    s_add_u32 s16, s16, 16384
    ds_read_b64_tr_b16 v[32:33], v20 offset:45056
    ds_read_b64_tr_b16 v[34:35], v20 offset:47104
    s_waitcnt vmcnt(22)
    s_waitcnt lgkmcnt(10)
    v_mfma_f32_32x32x16_bf16 v[56:71], v[40:43], v[220:223], v[56:71]
    s_and_b32 s16, s16, 0x3ffff
    ds_read_b64_tr_b16 v[36:37], v20 offset:46080
    ds_read_b64_tr_b16 v[38:39], v20 offset:48128
    s_waitcnt vmcnt(21)
    s_waitcnt lgkmcnt(10)
    v_mfma_f32_32x32x16_bf16 v[56:71], v[44:47], v[224:227], v[56:71]
    ds_read_b64_tr_b16 v[40:41], v20
    ds_read_b64_tr_b16 v[42:43], v20 offset:2048
    s_waitcnt vmcnt(20)
    s_waitcnt lgkmcnt(10)
    v_mfma_f32_32x32x16_bf16 v[56:71], v[48:51], v[228:231], v[56:71]
    ds_read_b64_tr_b16 v[44:45], v20 offset:1024
    ds_read_b64_tr_b16 v[46:47], v20 offset:3072
    s_waitcnt vmcnt(19)
    s_waitcnt lgkmcnt(10)
    v_mfma_f32_32x32x16_bf16 v[56:71], v[52:55], v[232:235], v[56:71]
    ds_read_b64_tr_b16 v[48:49], v20 offset:4096
    ds_read_b64_tr_b16 v[50:51], v20 offset:6144
    s_waitcnt vmcnt(18)
    s_waitcnt lgkmcnt(10)
    v_mfma_f32_32x32x16_bf16 v[56:71], v[28:31], v[236:239], v[56:71]
    ds_read_b64_tr_b16 v[52:53], v20 offset:5120
    ds_read_b64_tr_b16 v[54:55], v20 offset:7168
    s_waitcnt vmcnt(17)
    s_waitcnt lgkmcnt(10)
    v_mfma_f32_32x32x16_bf16 v[56:71], v[32:35], v[240:243], v[56:71]
    ds_read_b64_tr_b16 v[28:29], v20 offset:8192
    ds_read_b64_tr_b16 v[30:31], v20 offset:10240
    s_waitcnt vmcnt(16)
    s_waitcnt lgkmcnt(10)
    v_mfma_f32_32x32x16_bf16 v[56:71], v[36:39], v[244:247], v[56:71]
    ds_read_b64_tr_b16 v[32:33], v20 offset:9216
    ds_read_b64_tr_b16 v[34:35], v20 offset:11264
    s_waitcnt vmcnt(15)
    s_waitcnt lgkmcnt(10)
    v_mfma_f32_32x32x16_bf16 v[56:71], v[40:43], v[152:155], v[56:71]
    ds_read_b64_tr_b16 v[36:37], v20 offset:12288
    ds_read_b64_tr_b16 v[38:39], v20 offset:14336
    s_waitcnt vmcnt(14)
    s_waitcnt lgkmcnt(10)
    v_mfma_f32_32x32x16_bf16 v[56:71], v[44:47], v[156:159], v[56:71]
    ds_read_b64_tr_b16 v[40:41], v20 offset:13312
    ds_read_b64_tr_b16 v[42:43], v20 offset:15360
    s_waitcnt vmcnt(13)
    s_waitcnt lgkmcnt(10)
    v_mfma_f32_32x32x16_bf16 v[56:71], v[48:51], v[160:163], v[56:71]
    ds_read_b64_tr_b16 v[44:45], v20 offset:16384
    ds_read_b64_tr_b16 v[46:47], v20 offset:18432
    s_waitcnt vmcnt(12)
    s_waitcnt lgkmcnt(10)
    v_mfma_f32_32x32x16_bf16 v[56:71], v[52:55], v[164:167], v[56:71]
    ds_read_b64_tr_b16 v[48:49], v20 offset:17408
    ds_read_b64_tr_b16 v[50:51], v20 offset:19456
    s_waitcnt vmcnt(11)
    s_waitcnt lgkmcnt(10)
    v_mfma_f32_32x32x16_bf16 v[56:71], v[28:31], v[168:171], v[56:71]
    ds_read_b64_tr_b16 v[52:53], v20 offset:20480
    ds_read_b64_tr_b16 v[54:55], v20 offset:22528
    s_waitcnt vmcnt(10)
    s_waitcnt lgkmcnt(10)
    v_mfma_f32_32x32x16_bf16 v[56:71], v[32:35], v[172:175], v[56:71]
    ds_read_b64_tr_b16 v[28:29], v20 offset:21504
    ds_read_b64_tr_b16 v[30:31], v20 offset:23552
    s_barrier
    s_waitcnt vmcnt(9)
    s_waitcnt lgkmcnt(10)
    v_mfma_f32_32x32x16_bf16 v[56:71], v[36:39], v[176:179], v[56:71]
    ds_read_b64_tr_b16 v[32:33], v20 offset:24576
    ds_read_b64_tr_b16 v[34:35], v20 offset:26624
    s_waitcnt vmcnt(8)
    s_waitcnt lgkmcnt(10)
    v_mfma_f32_32x32x16_bf16 v[56:71], v[40:43], v[180:183], v[56:71]
    ds_read_b64_tr_b16 v[36:37], v20 offset:25600
    ds_read_b64_tr_b16 v[38:39], v20 offset:27648
    s_waitcnt vmcnt(7)
    s_waitcnt lgkmcnt(10)
    v_mfma_f32_32x32x16_bf16 v[56:71], v[44:47], v[184:187], v[56:71]
    ds_read_b64_tr_b16 v[40:41], v20 offset:28672
    ds_read_b64_tr_b16 v[42:43], v20 offset:30720
    s_waitcnt vmcnt(6)
    s_waitcnt lgkmcnt(10)
    v_mfma_f32_32x32x16_bf16 v[56:71], v[48:51], v[188:191], v[56:71]
    ds_read_b64_tr_b16 v[44:45], v20 offset:29696
    ds_read_b64_tr_b16 v[46:47], v20 offset:31744
    s_waitcnt vmcnt(5)
    s_waitcnt lgkmcnt(10)
    v_mfma_f32_32x32x16_bf16 v[56:71], v[52:55], v[192:195], v[56:71]
    ds_read_b64_tr_b16 v[48:49], v21 offset:32768
    ds_read_b64_tr_b16 v[50:51], v21 offset:34816
    s_waitcnt vmcnt(4)
    s_waitcnt lgkmcnt(10)
    v_mfma_f32_32x32x16_bf16 v[56:71], v[28:31], v[196:199], v[56:71]
    ds_read_b64_tr_b16 v[52:53], v21 offset:33792
    ds_read_b64_tr_b16 v[54:55], v21 offset:35840
    s_waitcnt vmcnt(3)
    s_waitcnt lgkmcnt(10)
    v_mfma_f32_32x32x16_bf16 v[56:71], v[32:35], v[200:203], v[56:71]
    ds_read_b64_tr_b16 v[28:29], v21 offset:36864
    ds_read_b64_tr_b16 v[30:31], v21 offset:38912
    s_waitcnt vmcnt(2)
    s_waitcnt lgkmcnt(10)
    v_mfma_f32_32x32x16_bf16 v[56:71], v[36:39], v[204:207], v[56:71]
    ds_read_b64_tr_b16 v[32:33], v21 offset:37888
    ds_read_b64_tr_b16 v[34:35], v21 offset:39936
    s_waitcnt vmcnt(1)
    s_waitcnt lgkmcnt(10)
    v_mfma_f32_32x32x16_bf16 v[56:71], v[40:43], v[208:211], v[56:71]
    ds_read_b64_tr_b16 v[36:37], v21 offset:40960
    ds_read_b64_tr_b16 v[38:39], v21 offset:43008
    s_waitcnt vmcnt(0)
    s_waitcnt lgkmcnt(10)
    v_mfma_f32_32x32x16_bf16 v[56:71], v[44:47], v[212:215], v[56:71]
    ds_read_b64_tr_b16 v[40:41], v21 offset:41984
    ds_read_b64_tr_b16 v[42:43], v21 offset:44032
    s_waitcnt lgkmcnt(10)
    v_mfma_f32_32x32x16_bf16 v[72:87], v[48:51], v[216:219], v[72:87]
    ds_read_b64_tr_b16 v[44:45], v21 offset:45056
    ds_read_b64_tr_b16 v[46:47], v21 offset:47104
    s_waitcnt lgkmcnt(10)
    v_mfma_f32_32x32x16_bf16 v[72:87], v[52:55], v[220:223], v[72:87]
    s_nop 3
    v_cvt_pk_bf16_f32 v56, v56, v57
    v_cvt_pk_bf16_f32 v57, v58, v59
    ds_read_b64_tr_b16 v[48:49], v21 offset:46080
    ds_read_b64_tr_b16 v[50:51], v21 offset:48128
    s_waitcnt lgkmcnt(10)
    v_mfma_f32_32x32x16_bf16 v[72:87], v[28:31], v[224:227], v[72:87]
    v_cvt_pk_bf16_f32 v58, v60, v61
    v_cvt_pk_bf16_f32 v59, v62, v63
    ds_write_b128 v0, v[56:59]
    ds_read_b64_tr_b16 v[52:53], v21
    ds_read_b64_tr_b16 v[54:55], v21 offset:2048
    s_waitcnt lgkmcnt(11)
    v_mfma_f32_32x32x16_bf16 v[72:87], v[32:35], v[228:231], v[72:87]
    v_cvt_pk_bf16_f32 v60, v64, v65
    v_cvt_pk_bf16_f32 v61, v66, v67
    ds_read_b64_tr_b16 v[28:29], v21 offset:1024
    ds_read_b64_tr_b16 v[30:31], v21 offset:3072
    s_waitcnt lgkmcnt(11)
    v_mfma_f32_32x32x16_bf16 v[72:87], v[36:39], v[232:235], v[72:87]
    v_cvt_pk_bf16_f32 v62, v68, v69
    v_cvt_pk_bf16_f32 v63, v70, v71
    ds_write_b128 v0, v[60:63] offset:1024
    ds_read_b64_tr_b16 v[32:33], v21 offset:4096
    ds_read_b64_tr_b16 v[34:35], v21 offset:6144
    s_waitcnt lgkmcnt(12)
    v_mfma_f32_32x32x16_bf16 v[72:87], v[40:43], v[236:239], v[72:87]
    v_subrev_u32 v0, 118784, v0
    ds_read_b64_tr_b16 v[36:37], v21 offset:5120
    ds_read_b64_tr_b16 v[38:39], v21 offset:7168
    s_waitcnt lgkmcnt(12)
    v_mfma_f32_32x32x16_bf16 v[72:87], v[44:47], v[240:243], v[72:87]
    ds_read_b64_tr_b16 v[40:41], v21 offset:8192
    ds_read_b64_tr_b16 v[42:43], v21 offset:10240
    s_waitcnt lgkmcnt(12)
    v_mfma_f32_32x32x16_bf16 v[72:87], v[48:51], v[244:247], v[72:87]
    ds_read_b64_tr_b16 v[44:45], v21 offset:9216
    ds_read_b64_tr_b16 v[46:47], v21 offset:11264
    s_waitcnt lgkmcnt(8)
    s_barrier
    v_mfma_f32_32x32x16_bf16 v[72:87], v[52:55], v[152:155], v[72:87]
    ds_read_b64_tr_b16 v[48:49], v21 offset:12288
    ds_read_b64_tr_b16 v[50:51], v21 offset:14336
    v_mfma_f32_32x32x16_bf16 v[72:87], v[28:31], v[156:159], v[72:87]
    ds_read_b64_tr_b16 v[52:53], v21 offset:13312
    ds_read_b64_tr_b16 v[54:55], v21 offset:15360
    s_waitcnt lgkmcnt(10)
    v_mfma_f32_32x32x16_bf16 v[72:87], v[32:35], v[160:163], v[72:87]
    ds_read_b64_tr_b16 v[28:29], v21 offset:16384
    ds_read_b64_tr_b16 v[30:31], v21 offset:18432
    s_waitcnt lgkmcnt(10)
    v_mfma_f32_32x32x16_bf16 v[72:87], v[36:39], v[164:167], v[72:87]
    ds_read_b64_tr_b16 v[32:33], v21 offset:17408
    ds_read_b64_tr_b16 v[34:35], v21 offset:19456
    s_waitcnt lgkmcnt(10)
    v_mfma_f32_32x32x16_bf16 v[72:87], v[40:43], v[168:171], v[72:87]
    ds_read_b64_tr_b16 v[36:37], v21 offset:20480
    ds_read_b64_tr_b16 v[38:39], v21 offset:22528
    s_waitcnt lgkmcnt(10)
    v_mfma_f32_32x32x16_bf16 v[72:87], v[44:47], v[172:175], v[72:87]
    ds_read_b64_tr_b16 v[40:41], v21 offset:21504
    ds_read_b64_tr_b16 v[42:43], v21 offset:23552
    s_waitcnt lgkmcnt(10)
    v_mfma_f32_32x32x16_bf16 v[72:87], v[48:51], v[176:179], v[72:87]
    ds_read_b64_tr_b16 v[44:45], v21 offset:24576
    ds_read_b64_tr_b16 v[46:47], v21 offset:26624
    s_waitcnt lgkmcnt(10)
    v_mfma_f32_32x32x16_bf16 v[72:87], v[52:55], v[180:183], v[72:87]
    ds_read_b64_tr_b16 v[48:49], v21 offset:25600
    ds_read_b64_tr_b16 v[50:51], v21 offset:27648
    s_waitcnt lgkmcnt(10)
    v_mfma_f32_32x32x16_bf16 v[72:87], v[28:31], v[184:187], v[72:87]
    ds_read_b64_tr_b16 v[52:53], v21 offset:28672
    ds_read_b64_tr_b16 v[54:55], v21 offset:30720
    s_waitcnt lgkmcnt(10)
    v_mfma_f32_32x32x16_bf16 v[72:87], v[32:35], v[188:191], v[72:87]
    ds_read_b64_tr_b16 v[28:29], v21 offset:29696
    ds_read_b64_tr_b16 v[30:31], v21 offset:31744
    s_waitcnt lgkmcnt(10)
    v_mfma_f32_32x32x16_bf16 v[72:87], v[36:39], v[192:195], v[72:87]
    ds_read_b64_tr_b16 v[32:33], v22 offset:32768
    ds_read_b64_tr_b16 v[34:35], v22 offset:34816
    s_waitcnt lgkmcnt(10)
    v_mfma_f32_32x32x16_bf16 v[72:87], v[40:43], v[196:199], v[72:87]
    ds_read_b64_tr_b16 v[36:37], v23 offset:32768
    ds_read_b64_tr_b16 v[38:39], v23 offset:34816
    s_waitcnt lgkmcnt(10)
    v_mfma_f32_32x32x16_bf16 v[72:87], v[44:47], v[200:203], v[72:87]
    ds_read_b64_tr_b16 v[40:41], v22 offset:33792
    ds_read_b64_tr_b16 v[42:43], v22 offset:35840
    s_waitcnt lgkmcnt(10)
    v_mfma_f32_32x32x16_bf16 v[72:87], v[48:51], v[204:207], v[72:87]
    ds_read_b64_tr_b16 v[44:45], v23 offset:33792
    ds_read_b64_tr_b16 v[46:47], v23 offset:35840
    s_waitcnt lgkmcnt(10)
    v_mfma_f32_32x32x16_bf16 v[72:87], v[52:55], v[208:211], v[72:87]
    ds_read_b64_tr_b16 v[48:49], v22 offset:36864
    ds_read_b64_tr_b16 v[50:51], v22 offset:38912
    s_waitcnt lgkmcnt(10)
    v_mfma_f32_32x32x16_bf16 v[72:87], v[28:31], v[212:215], v[72:87]
    ds_read_b64_tr_b16 v[52:53], v23 offset:36864
    ds_read_b64_tr_b16 v[54:55], v23 offset:38912
    s_waitcnt lgkmcnt(10)
    v_mfma_f32_32x32x16_bf16 v[88:103], v[32:35], v[216:219], v[88:103]
    ds_read_b64_tr_b16 v[28:29], v22 offset:37888
    ds_read_b64_tr_b16 v[30:31], v22 offset:39936
    s_waitcnt lgkmcnt(10)
    v_mfma_f32_32x32x16_bf16 v[104:119], v[36:39], v[216:219], v[104:119]
    s_nop 3
    v_cvt_pk_bf16_f32 v72, v72, v73
    v_cvt_pk_bf16_f32 v73, v74, v75
    ds_read_b64_tr_b16 v[32:33], v23 offset:37888
    ds_read_b64_tr_b16 v[34:35], v23 offset:39936
    s_waitcnt lgkmcnt(10)
    v_mfma_f32_32x32x16_bf16 v[88:103], v[40:43], v[220:223], v[88:103]
    v_cvt_pk_bf16_f32 v74, v76, v77
    v_cvt_pk_bf16_f32 v75, v78, v79
    ds_write_b128 v0, v[72:75]
    ds_read_b64_tr_b16 v[36:37], v22 offset:40960
    ds_read_b64_tr_b16 v[38:39], v22 offset:43008
    s_waitcnt lgkmcnt(11)
    v_mfma_f32_32x32x16_bf16 v[104:119], v[44:47], v[220:223], v[104:119]
    v_cvt_pk_bf16_f32 v76, v80, v81
    v_cvt_pk_bf16_f32 v77, v82, v83
    ds_read_b64_tr_b16 v[40:41], v23 offset:40960
    ds_read_b64_tr_b16 v[42:43], v23 offset:43008
    s_waitcnt lgkmcnt(11)
    v_mfma_f32_32x32x16_bf16 v[88:103], v[48:51], v[224:227], v[88:103]
    v_cvt_pk_bf16_f32 v78, v84, v85
    v_cvt_pk_bf16_f32 v79, v86, v87
    ds_write_b128 v0, v[76:79] offset:1024
    ds_read_b64_tr_b16 v[44:45], v22 offset:41984
    ds_read_b64_tr_b16 v[46:47], v22 offset:44032
    s_waitcnt lgkmcnt(12)
    v_mfma_f32_32x32x16_bf16 v[104:119], v[52:55], v[224:227], v[104:119]
    ds_read_b64_tr_b16 v[48:49], v23 offset:41984
    ds_read_b64_tr_b16 v[50:51], v23 offset:44032
    s_waitcnt lgkmcnt(4)
    s_barrier
    v_mfma_f32_32x32x16_bf16 v[88:103], v[28:31], v[228:231], v[88:103]
    s_lshl_b32 s96, s77, 11
    s_add_u32 s14, s96, 32768
    v_and_b32 v0, 7, v1
    ds_read_b64_tr_b16 v[52:53], v22 offset:45056
    ds_read_b64_tr_b16 v[54:55], v22 offset:47104
    v_mfma_f32_32x32x16_bf16 v[104:119], v[32:35], v[228:231], v[104:119]
    v_lshl_add_u32 v0, v0, 4, s14
    ds_read_b64_tr_b16 v[28:29], v23 offset:45056
    ds_read_b64_tr_b16 v[30:31], v23 offset:47104
    v_mfma_f32_32x32x16_bf16 v[88:103], v[36:39], v[232:235], v[88:103]
    v_bfe_u32 v4, v1, 3, 2
    ds_read_b64_tr_b16 v[32:33], v22 offset:46080
    ds_read_b64_tr_b16 v[34:35], v22 offset:48128
    v_mfma_f32_32x32x16_bf16 v[104:119], v[40:43], v[232:235], v[104:119]
    v_lshl_add_u32 v0, v4, 8, v0
    v_lshrrev_b32 v4, 5, v1
    ds_read_b64_tr_b16 v[36:37], v23 offset:46080
    ds_read_b64_tr_b16 v[38:39], v23 offset:48128
    s_waitcnt lgkmcnt(10)
    v_mfma_f32_32x32x16_bf16 v[88:103], v[44:47], v[236:239], v[88:103]
    v_lshl_add_u32 v0, v4, 7, v0
    ds_read_b64_tr_b16 v[40:41], v22
    ds_read_b64_tr_b16 v[42:43], v22 offset:2048
    s_waitcnt lgkmcnt(10)
    v_mfma_f32_32x32x16_bf16 v[104:119], v[48:51], v[236:239], v[104:119]
    ds_read_b64_tr_b16 v[44:45], v23
    ds_read_b64_tr_b16 v[46:47], v23 offset:2048
    s_waitcnt lgkmcnt(10)
    v_mfma_f32_32x32x16_bf16 v[88:103], v[52:55], v[240:243], v[88:103]
    ds_read_b64_tr_b16 v[48:49], v22 offset:1024
    ds_read_b64_tr_b16 v[50:51], v22 offset:3072
    s_waitcnt lgkmcnt(10)
    v_mfma_f32_32x32x16_bf16 v[104:119], v[28:31], v[240:243], v[104:119]
    ds_read_b64_tr_b16 v[52:53], v23 offset:1024
    ds_read_b64_tr_b16 v[54:55], v23 offset:3072
    s_waitcnt lgkmcnt(10)
    v_mfma_f32_32x32x16_bf16 v[88:103], v[32:35], v[244:247], v[88:103]
    ds_read_b64_tr_b16 v[28:29], v22 offset:4096
    ds_read_b64_tr_b16 v[30:31], v22 offset:6144
    s_waitcnt lgkmcnt(10)
    v_mfma_f32_32x32x16_bf16 v[104:119], v[36:39], v[244:247], v[104:119]
    ds_read_b64_tr_b16 v[32:33], v23 offset:4096
    ds_read_b64_tr_b16 v[34:35], v23 offset:6144
    s_waitcnt lgkmcnt(10)
    v_mfma_f32_32x32x16_bf16 v[88:103], v[40:43], v[152:155], v[88:103]
    ds_read_b64_tr_b16 v[36:37], v22 offset:5120
    ds_read_b64_tr_b16 v[38:39], v22 offset:7168
    s_waitcnt lgkmcnt(10)
    v_mfma_f32_32x32x16_bf16 v[104:119], v[44:47], v[152:155], v[104:119]
    ds_read_b64_tr_b16 v[40:41], v23 offset:5120
    ds_read_b64_tr_b16 v[42:43], v23 offset:7168
    s_waitcnt lgkmcnt(10)
    v_mfma_f32_32x32x16_bf16 v[88:103], v[48:51], v[156:159], v[88:103]
    ds_read_b64_tr_b16 v[44:45], v22 offset:8192
    ds_read_b64_tr_b16 v[46:47], v22 offset:10240
    s_waitcnt lgkmcnt(10)
    v_mfma_f32_32x32x16_bf16 v[104:119], v[52:55], v[156:159], v[104:119]
    ds_read_b64_tr_b16 v[48:49], v23 offset:8192
    ds_read_b64_tr_b16 v[50:51], v23 offset:10240
    s_waitcnt lgkmcnt(10)
    v_mfma_f32_32x32x16_bf16 v[88:103], v[28:31], v[160:163], v[88:103]
    ds_read_b64_tr_b16 v[52:53], v22 offset:9216
    ds_read_b64_tr_b16 v[54:55], v22 offset:11264
    s_waitcnt lgkmcnt(10)
    v_mfma_f32_32x32x16_bf16 v[104:119], v[32:35], v[160:163], v[104:119]
    ds_read_b64_tr_b16 v[28:29], v23 offset:9216
    ds_read_b64_tr_b16 v[30:31], v23 offset:11264
    s_waitcnt lgkmcnt(10)
    v_mfma_f32_32x32x16_bf16 v[88:103], v[36:39], v[164:167], v[88:103]
    ds_read_b64_tr_b16 v[32:33], v22 offset:12288
    ds_read_b64_tr_b16 v[34:35], v22 offset:14336
    s_waitcnt lgkmcnt(10)
    v_mfma_f32_32x32x16_bf16 v[104:119], v[40:43], v[164:167], v[104:119]
    ds_read_b64_tr_b16 v[36:37], v23 offset:12288
    ds_read_b64_tr_b16 v[38:39], v23 offset:14336
    s_waitcnt lgkmcnt(10)
    v_mfma_f32_32x32x16_bf16 v[88:103], v[44:47], v[168:171], v[88:103]
    ds_read_b64_tr_b16 v[40:41], v22 offset:13312
    ds_read_b64_tr_b16 v[42:43], v22 offset:15360
    s_waitcnt lgkmcnt(10)
    v_mfma_f32_32x32x16_bf16 v[104:119], v[48:51], v[168:171], v[104:119]
    ds_read_b64_tr_b16 v[44:45], v23 offset:13312
    ds_read_b64_tr_b16 v[46:47], v23 offset:15360
    s_waitcnt lgkmcnt(10)
    v_mfma_f32_32x32x16_bf16 v[88:103], v[52:55], v[172:175], v[88:103]
    ds_read_b64_tr_b16 v[48:49], v22 offset:16384
    ds_read_b64_tr_b16 v[50:51], v22 offset:18432
    s_waitcnt lgkmcnt(10)
    v_mfma_f32_32x32x16_bf16 v[104:119], v[28:31], v[172:175], v[104:119]
    ds_read_b64_tr_b16 v[52:53], v23 offset:16384
    ds_read_b64_tr_b16 v[54:55], v23 offset:18432
    s_waitcnt lgkmcnt(10)
    v_mfma_f32_32x32x16_bf16 v[88:103], v[32:35], v[176:179], v[88:103]
    ds_read_b64_tr_b16 v[28:29], v22 offset:17408
    ds_read_b64_tr_b16 v[30:31], v22 offset:19456
    s_waitcnt lgkmcnt(10)
    v_mfma_f32_32x32x16_bf16 v[104:119], v[36:39], v[176:179], v[104:119]
    ds_read_b64_tr_b16 v[32:33], v23 offset:17408
    ds_read_b64_tr_b16 v[34:35], v23 offset:19456
    s_waitcnt lgkmcnt(10)
    v_mfma_f32_32x32x16_bf16 v[88:103], v[40:43], v[180:183], v[88:103]
    ds_read_b64_tr_b16 v[36:37], v22 offset:20480
    ds_read_b64_tr_b16 v[38:39], v22 offset:22528
    s_waitcnt lgkmcnt(10)
    v_mfma_f32_32x32x16_bf16 v[104:119], v[44:47], v[180:183], v[104:119]
    ds_read_b64_tr_b16 v[40:41], v23 offset:20480
    ds_read_b64_tr_b16 v[42:43], v23 offset:22528
    s_waitcnt lgkmcnt(10)
    v_mfma_f32_32x32x16_bf16 v[88:103], v[48:51], v[184:187], v[88:103]
    ds_read_b64_tr_b16 v[44:45], v22 offset:21504
    ds_read_b64_tr_b16 v[46:47], v22 offset:23552
    s_waitcnt lgkmcnt(10)
    v_mfma_f32_32x32x16_bf16 v[104:119], v[52:55], v[184:187], v[104:119]
    ds_read_b64_tr_b16 v[48:49], v23 offset:21504
    ds_read_b64_tr_b16 v[50:51], v23 offset:23552
    s_waitcnt lgkmcnt(10)
    v_mfma_f32_32x32x16_bf16 v[88:103], v[28:31], v[188:191], v[88:103]
    ds_read_b64_tr_b16 v[52:53], v22 offset:24576
    ds_read_b64_tr_b16 v[54:55], v22 offset:26624
    s_waitcnt lgkmcnt(10)
    v_mfma_f32_32x32x16_bf16 v[104:119], v[32:35], v[188:191], v[104:119]
    ds_read_b64_tr_b16 v[28:29], v23 offset:24576
    ds_read_b64_tr_b16 v[30:31], v23 offset:26624
    s_waitcnt lgkmcnt(10)
    v_mfma_f32_32x32x16_bf16 v[88:103], v[36:39], v[192:195], v[88:103]
    ds_read_b64_tr_b16 v[32:33], v22 offset:25600
    ds_read_b64_tr_b16 v[34:35], v22 offset:27648
    s_waitcnt lgkmcnt(10)
    v_mfma_f32_32x32x16_bf16 v[104:119], v[40:43], v[192:195], v[104:119]
    ds_read_b64_tr_b16 v[36:37], v23 offset:25600
    ds_read_b64_tr_b16 v[38:39], v23 offset:27648
    s_waitcnt lgkmcnt(10)
    v_mfma_f32_32x32x16_bf16 v[88:103], v[44:47], v[196:199], v[88:103]
    ds_read_b64_tr_b16 v[40:41], v22 offset:28672
    ds_read_b64_tr_b16 v[42:43], v22 offset:30720
    s_waitcnt lgkmcnt(10)
    v_mfma_f32_32x32x16_bf16 v[104:119], v[48:51], v[196:199], v[104:119]
    ds_read_b64_tr_b16 v[44:45], v23 offset:28672
    ds_read_b64_tr_b16 v[46:47], v23 offset:30720
    s_waitcnt lgkmcnt(10)
    v_mfma_f32_32x32x16_bf16 v[88:103], v[52:55], v[200:203], v[88:103]
    ds_read_b64_tr_b16 v[48:49], v22 offset:29696
    ds_read_b64_tr_b16 v[50:51], v22 offset:31744
    s_waitcnt lgkmcnt(10)
    v_mfma_f32_32x32x16_bf16 v[104:119], v[28:31], v[200:203], v[104:119]
    ds_read_b64_tr_b16 v[52:53], v23 offset:29696
    ds_read_b64_tr_b16 v[54:55], v23 offset:31744
    s_waitcnt lgkmcnt(10)
    v_mfma_f32_32x32x16_bf16 v[88:103], v[32:35], v[204:207], v[88:103]
    ds_read_b64_tr_b16 v[28:29], v24 offset:32768
    ds_read_b64_tr_b16 v[30:31], v24 offset:34816
    s_waitcnt lgkmcnt(10)
    v_mfma_f32_32x32x16_bf16 v[104:119], v[36:39], v[204:207], v[104:119]
    ds_read_b64_tr_b16 v[32:33], v25 offset:32768
    ds_read_b64_tr_b16 v[34:35], v25 offset:34816
    s_waitcnt lgkmcnt(10)
    v_mfma_f32_32x32x16_bf16 v[88:103], v[40:43], v[208:211], v[88:103]
    ds_read_b64_tr_b16 v[36:37], v24 offset:33792
    ds_read_b64_tr_b16 v[38:39], v24 offset:35840
    s_waitcnt lgkmcnt(10)
    v_mfma_f32_32x32x16_bf16 v[104:119], v[44:47], v[208:211], v[104:119]
    ds_read_b64_tr_b16 v[40:41], v25 offset:33792
    ds_read_b64_tr_b16 v[42:43], v25 offset:35840
    s_waitcnt lgkmcnt(10)
    v_mfma_f32_32x32x16_bf16 v[88:103], v[48:51], v[212:215], v[88:103]
    ds_read_b64_tr_b16 v[44:45], v24 offset:36864
    ds_read_b64_tr_b16 v[46:47], v24 offset:38912
    s_waitcnt lgkmcnt(10)
    v_mfma_f32_32x32x16_bf16 v[104:119], v[52:55], v[212:215], v[104:119]
    ds_read_b64_tr_b16 v[48:49], v25 offset:36864
    ds_read_b64_tr_b16 v[50:51], v25 offset:38912
    s_barrier
    s_waitcnt lgkmcnt(10)
    v_mfma_f32_32x32x16_bf16 v[120:135], v[28:31], v[216:219], v[120:135]
    ds_read_b64_tr_b16 v[52:53], v24 offset:37888
    ds_read_b64_tr_b16 v[54:55], v24 offset:39936
    s_waitcnt lgkmcnt(10)
    v_mfma_f32_32x32x16_bf16 v[136:151], v[32:35], v[216:219], v[136:151]
L_PAD4:
    s_cbranch_execz L_RET4
    v_cvt_pk_bf16_f32 v88, v88, v89
    v_cvt_pk_bf16_f32 v89, v90, v91
    ds_read_b64_tr_b16 v[28:29], v25 offset:37888
    ds_read_b64_tr_b16 v[30:31], v25 offset:39936
    s_waitcnt lgkmcnt(10)
    v_mfma_f32_32x32x16_bf16 v[120:135], v[36:39], v[220:223], v[120:135]
    v_cvt_pk_bf16_f32 v90, v92, v93
    v_cvt_pk_bf16_f32 v91, v94, v95
    ds_write_b128 v0, v[88:91]
    ds_read_b64_tr_b16 v[32:33], v24 offset:40960
    ds_read_b64_tr_b16 v[34:35], v24 offset:43008
    s_waitcnt lgkmcnt(11)
    v_mfma_f32_32x32x16_bf16 v[136:151], v[40:43], v[220:223], v[136:151]
    v_cvt_pk_bf16_f32 v92, v96, v97
    v_cvt_pk_bf16_f32 v93, v98, v99
    ds_read_b64_tr_b16 v[36:37], v25 offset:40960
    ds_read_b64_tr_b16 v[38:39], v25 offset:43008
    s_waitcnt lgkmcnt(11)
    v_mfma_f32_32x32x16_bf16 v[120:135], v[44:47], v[224:227], v[120:135]
    v_cvt_pk_bf16_f32 v94, v100, v101
    v_cvt_pk_bf16_f32 v95, v102, v103
    ds_write_b128 v0, v[92:95] offset:1024
    ds_read_b64_tr_b16 v[40:41], v24 offset:41984
    ds_read_b64_tr_b16 v[42:43], v24 offset:44032
    s_waitcnt lgkmcnt(12)
    v_mfma_f32_32x32x16_bf16 v[136:151], v[48:51], v[224:227], v[136:151]
    v_cvt_pk_bf16_f32 v104, v104, v105
    v_cvt_pk_bf16_f32 v105, v106, v107
    ds_read_b64_tr_b16 v[44:45], v25 offset:41984
    ds_read_b64_tr_b16 v[46:47], v25 offset:44032
    s_waitcnt lgkmcnt(12)
    v_mfma_f32_32x32x16_bf16 v[120:135], v[52:55], v[228:231], v[120:135]
    v_cvt_pk_bf16_f32 v106, v108, v109
    v_cvt_pk_bf16_f32 v107, v110, v111
    ds_write_b128 v0, v[104:107] offset:8192
    ds_read_b64_tr_b16 v[48:49], v24 offset:45056
    ds_read_b64_tr_b16 v[50:51], v24 offset:47104
    s_waitcnt lgkmcnt(13)
    v_mfma_f32_32x32x16_bf16 v[136:151], v[28:31], v[228:231], v[136:151]
    v_cvt_pk_bf16_f32 v108, v112, v113
    v_cvt_pk_bf16_f32 v109, v114, v115
    ds_read_b64_tr_b16 v[52:53], v25 offset:45056
    ds_read_b64_tr_b16 v[54:55], v25 offset:47104
    s_waitcnt lgkmcnt(12)
    v_mfma_f32_32x32x16_bf16 v[120:135], v[32:35], v[232:235], v[120:135]
    v_cvt_pk_bf16_f32 v110, v116, v117
    v_cvt_pk_bf16_f32 v111, v118, v119
    ds_write_b128 v0, v[108:111] offset:9216
    ds_read_b64_tr_b16 v[28:29], v24 offset:46080
    ds_read_b64_tr_b16 v[30:31], v24 offset:48128
    s_waitcnt lgkmcnt(13)
    v_mfma_f32_32x32x16_bf16 v[136:151], v[36:39], v[232:235], v[136:151]
    ds_read_b64_tr_b16 v[32:33], v25 offset:46080
    ds_read_b64_tr_b16 v[34:35], v25 offset:48128
    s_waitcnt lgkmcnt(12)
    v_mfma_f32_32x32x16_bf16 v[120:135], v[40:43], v[236:239], v[120:135]
    ds_read_b64_tr_b16 v[36:37], v24
    ds_read_b64_tr_b16 v[38:39], v24 offset:2048
    s_waitcnt lgkmcnt(12)
    v_mfma_f32_32x32x16_bf16 v[136:151], v[44:47], v[236:239], v[136:151]
    ds_read_b64_tr_b16 v[40:41], v25
    ds_read_b64_tr_b16 v[42:43], v25 offset:2048
    s_waitcnt lgkmcnt(11)
    v_mfma_f32_32x32x16_bf16 v[120:135], v[48:51], v[240:243], v[120:135]
    ds_read_b64_tr_b16 v[44:45], v24 offset:1024
    ds_read_b64_tr_b16 v[46:47], v24 offset:3072
    s_waitcnt lgkmcnt(11)
    v_mfma_f32_32x32x16_bf16 v[136:151], v[52:55], v[240:243], v[136:151]
    ds_read_b64_tr_b16 v[48:49], v25 offset:1024
    ds_read_b64_tr_b16 v[50:51], v25 offset:3072
    s_waitcnt lgkmcnt(10)
    v_mfma_f32_32x32x16_bf16 v[120:135], v[28:31], v[244:247], v[120:135]
    ds_read_b64_tr_b16 v[52:53], v24 offset:4096
    ds_read_b64_tr_b16 v[54:55], v24 offset:6144
    s_waitcnt lgkmcnt(10)
    v_mfma_f32_32x32x16_bf16 v[136:151], v[32:35], v[244:247], v[136:151]
    ds_read_b64_tr_b16 v[28:29], v25 offset:4096
    ds_read_b64_tr_b16 v[30:31], v25 offset:6144
    s_waitcnt lgkmcnt(10)
    v_mfma_f32_32x32x16_bf16 v[120:135], v[36:39], v[152:155], v[120:135]
    ds_read_b64_tr_b16 v[32:33], v24 offset:5120
    ds_read_b64_tr_b16 v[34:35], v24 offset:7168
    s_waitcnt lgkmcnt(10)
    v_mfma_f32_32x32x16_bf16 v[136:151], v[40:43], v[152:155], v[136:151]
    ds_read_b64_tr_b16 v[36:37], v25 offset:5120
    ds_read_b64_tr_b16 v[38:39], v25 offset:7168
    s_waitcnt lgkmcnt(10)
    v_mfma_f32_32x32x16_bf16 v[120:135], v[44:47], v[156:159], v[120:135]
    ds_read_b64_tr_b16 v[40:41], v24 offset:8192
    ds_read_b64_tr_b16 v[42:43], v24 offset:10240
    s_waitcnt lgkmcnt(10)
    v_mfma_f32_32x32x16_bf16 v[136:151], v[48:51], v[156:159], v[136:151]
    ds_read_b64_tr_b16 v[44:45], v25 offset:8192
    ds_read_b64_tr_b16 v[46:47], v25 offset:10240
    s_waitcnt lgkmcnt(10)
    v_mfma_f32_32x32x16_bf16 v[120:135], v[52:55], v[160:163], v[120:135]
    ds_read_b64_tr_b16 v[48:49], v24 offset:9216
    ds_read_b64_tr_b16 v[50:51], v24 offset:11264
    s_waitcnt lgkmcnt(10)
    v_mfma_f32_32x32x16_bf16 v[136:151], v[28:31], v[160:163], v[136:151]
    ds_read_b64_tr_b16 v[52:53], v25 offset:9216
    ds_read_b64_tr_b16 v[54:55], v25 offset:11264
    s_waitcnt lgkmcnt(10)
    v_mfma_f32_32x32x16_bf16 v[120:135], v[32:35], v[164:167], v[120:135]
    ds_read_b64_tr_b16 v[28:29], v24 offset:12288
    ds_read_b64_tr_b16 v[30:31], v24 offset:14336
    s_waitcnt lgkmcnt(10)
    v_mfma_f32_32x32x16_bf16 v[136:151], v[36:39], v[164:167], v[136:151]
    ds_read_b64_tr_b16 v[32:33], v25 offset:12288
    ds_read_b64_tr_b16 v[34:35], v25 offset:14336
    s_waitcnt lgkmcnt(10)
    v_mfma_f32_32x32x16_bf16 v[120:135], v[40:43], v[168:171], v[120:135]
    ds_read_b64_tr_b16 v[36:37], v24 offset:13312
    ds_read_b64_tr_b16 v[38:39], v24 offset:15360
    s_waitcnt lgkmcnt(10)
    v_mfma_f32_32x32x16_bf16 v[136:151], v[44:47], v[168:171], v[136:151]
    ds_read_b64_tr_b16 v[40:41], v25 offset:13312
    ds_read_b64_tr_b16 v[42:43], v25 offset:15360
    s_waitcnt lgkmcnt(10)
    v_mfma_f32_32x32x16_bf16 v[120:135], v[48:51], v[172:175], v[120:135]
    ds_read_b64_tr_b16 v[44:45], v24 offset:16384
    ds_read_b64_tr_b16 v[46:47], v24 offset:18432
    s_waitcnt lgkmcnt(10)
    v_mfma_f32_32x32x16_bf16 v[136:151], v[52:55], v[172:175], v[136:151]
    ds_read_b64_tr_b16 v[48:49], v25 offset:16384
    ds_read_b64_tr_b16 v[50:51], v25 offset:18432
    s_waitcnt lgkmcnt(10)
    v_mfma_f32_32x32x16_bf16 v[120:135], v[28:31], v[176:179], v[120:135]
    ds_read_b64_tr_b16 v[52:53], v24 offset:17408
    ds_read_b64_tr_b16 v[54:55], v24 offset:19456
    s_waitcnt lgkmcnt(10)
    v_mfma_f32_32x32x16_bf16 v[136:151], v[32:35], v[176:179], v[136:151]
    ds_read_b64_tr_b16 v[28:29], v25 offset:17408
    ds_read_b64_tr_b16 v[30:31], v25 offset:19456
    s_waitcnt lgkmcnt(10)
    v_mfma_f32_32x32x16_bf16 v[120:135], v[36:39], v[180:183], v[120:135]
    ds_read_b64_tr_b16 v[32:33], v24 offset:20480
    ds_read_b64_tr_b16 v[34:35], v24 offset:22528
    s_waitcnt lgkmcnt(10)
    v_mfma_f32_32x32x16_bf16 v[136:151], v[40:43], v[180:183], v[136:151]
    ds_read_b64_tr_b16 v[36:37], v25 offset:20480
    ds_read_b64_tr_b16 v[38:39], v25 offset:22528
    s_waitcnt lgkmcnt(10)
    v_mfma_f32_32x32x16_bf16 v[120:135], v[44:47], v[184:187], v[120:135]
    ds_read_b64_tr_b16 v[40:41], v24 offset:21504
    ds_read_b64_tr_b16 v[42:43], v24 offset:23552
    s_waitcnt lgkmcnt(10)
    v_mfma_f32_32x32x16_bf16 v[136:151], v[48:51], v[184:187], v[136:151]
    ds_read_b64_tr_b16 v[44:45], v25 offset:21504
    ds_read_b64_tr_b16 v[46:47], v25 offset:23552
    s_waitcnt lgkmcnt(10)
    v_mfma_f32_32x32x16_bf16 v[120:135], v[52:55], v[188:191], v[120:135]
    ds_read_b64_tr_b16 v[48:49], v24 offset:24576
    ds_read_b64_tr_b16 v[50:51], v24 offset:26624
    s_waitcnt lgkmcnt(10)
    v_mfma_f32_32x32x16_bf16 v[136:151], v[28:31], v[188:191], v[136:151]
    ds_read_b64_tr_b16 v[52:53], v25 offset:24576
    ds_read_b64_tr_b16 v[54:55], v25 offset:26624
    s_waitcnt lgkmcnt(10)
    v_mfma_f32_32x32x16_bf16 v[120:135], v[32:35], v[192:195], v[120:135]
    ds_read_b64_tr_b16 v[28:29], v24 offset:25600
    ds_read_b64_tr_b16 v[30:31], v24 offset:27648
    s_waitcnt lgkmcnt(10)
    v_mfma_f32_32x32x16_bf16 v[136:151], v[36:39], v[192:195], v[136:151]
    ds_read_b64_tr_b16 v[32:33], v25 offset:25600
    ds_read_b64_tr_b16 v[34:35], v25 offset:27648
    s_waitcnt lgkmcnt(10)
    v_mfma_f32_32x32x16_bf16 v[120:135], v[40:43], v[196:199], v[120:135]
    ds_read_b64_tr_b16 v[36:37], v24 offset:28672
    ds_read_b64_tr_b16 v[38:39], v24 offset:30720
    s_waitcnt lgkmcnt(10)
    v_mfma_f32_32x32x16_bf16 v[136:151], v[44:47], v[196:199], v[136:151]
    ds_read_b64_tr_b16 v[40:41], v25 offset:28672
    ds_read_b64_tr_b16 v[42:43], v25 offset:30720
    s_waitcnt lgkmcnt(10)
    v_mfma_f32_32x32x16_bf16 v[120:135], v[48:51], v[200:203], v[120:135]
    ds_read_b64_tr_b16 v[44:45], v25 offset:29696
    ds_read_b64_tr_b16 v[46:47], v25 offset:31744
    s_waitcnt lgkmcnt(10)
    v_mfma_f32_32x32x16_bf16 v[136:151], v[52:55], v[200:203], v[136:151]
    ds_read_b64_tr_b16 v[48:49], v24 offset:29696
    ds_read_b64_tr_b16 v[50:51], v24 offset:31744
    s_waitcnt lgkmcnt(10)
    v_mfma_f32_32x32x16_bf16 v[120:135], v[28:31], v[204:207], v[120:135]
    s_waitcnt lgkmcnt(8)
    v_mfma_f32_32x32x16_bf16 v[136:151], v[32:35], v[204:207], v[136:151]
    s_waitcnt lgkmcnt(6)
    v_mfma_f32_32x32x16_bf16 v[120:135], v[36:39], v[208:211], v[120:135]
    s_waitcnt lgkmcnt(4)
    v_mfma_f32_32x32x16_bf16 v[136:151], v[40:43], v[208:211], v[136:151]
    s_waitcnt lgkmcnt(2)
    v_mfma_f32_32x32x16_bf16 v[136:151], v[44:47], v[212:215], v[136:151]
    s_waitcnt lgkmcnt(0)
    v_mfma_f32_32x32x16_bf16 v[120:135], v[48:51], v[212:215], v[120:135]
    s_lshl_b32 s96, s77, 11
    s_add_u32 s14, s96, 151552
    v_add_u32 v0, s14, v2
    v_bfe_u32 v4, v1, 2, 2
    v_lshlrev_b32 v4, 6, v4
    v_bfe_u32 v9, v1, 4, 1
    v_lshl_add_u32 v4, v9, 5, v4
    v_and_b32 v9, 3, v1
    v_lshl_add_u32 v4, v9, 3, v4
    v_lshrrev_b32 v9, 5, v1
    v_lshl_add_u32 v4, v9, 8, v4
    v_add_u32 v4, 159744, v4
    ds_read_b64_tr_b16 v[176:177], v4
    ds_read_b64_tr_b16 v[178:179], v4 offset:512
    ds_read_b64_tr_b16 v[180:181], v4 offset:1024
    ds_read_b64_tr_b16 v[182:183], v4 offset:1536
    v_cvt_pk_bf16_f32 v152, v136, v137
    v_cvt_pk_bf16_f32 v153, v138, v139
    v_cvt_pk_bf16_f32 v154, v140, v141
    v_cvt_pk_bf16_f32 v155, v142, v143
    v_cvt_pk_bf16_f32 v156, v144, v145
    v_cvt_pk_bf16_f32 v157, v146, v147
    v_cvt_pk_bf16_f32 v158, v148, v149
    v_cvt_pk_bf16_f32 v159, v150, v151
    ds_write_b128 v0, v[152:155]
    ds_write_b128 v0, v[156:159] offset:1024
    v_cvt_pk_bf16_f32 v168, v120, v121
    v_cvt_pk_bf16_f32 v169, v122, v123
    v_cvt_pk_bf16_f32 v170, v124, v125
    v_cvt_pk_bf16_f32 v171, v126, v127
    v_cvt_pk_bf16_f32 v172, v128, v129
    v_cvt_pk_bf16_f32 v173, v130, v131
    v_cvt_pk_bf16_f32 v174, v132, v133
    v_cvt_pk_bf16_f32 v175, v134, v135
    s_setprio 0
    s_branch L_JOIN
L_HELP:
    s_waitcnt vmcnt(3)
    s_barrier
    s_add_u32 s96, s84, 5
    s_and_b32 s97, s96, 15
    s_mul_i32 s98, s97, 393216
    s_add_u32 s99, s98, s85
    s_add_u32 s82, s99, 4294772736
    s_add_u32 m0, s83, 36864
    s_nop 0
    buffer_load_dwordx4 v3, s[40:43], s82 offen lds
    s_add_u32 s96, s84, 5
    s_and_b32 s97, s96, 15
    s_mul_i32 s98, s97, 393216
    s_add_u32 s99, s98, s85
    s_add_u32 s82, s99, 2048
    s_add_u32 m0, s83, 40960
    s_nop 0
    buffer_load_dwordx4 v3, s[40:43], s82 offen lds
    s_add_u32 s96, s84, 5
    s_and_b32 s97, s96, 15
    s_mul_i32 s98, s97, 393216
    s_add_u32 s99, s98, s85
    s_add_u32 s82, s99, 4294774784
    s_add_u32 m0, s83, 86016
    s_nop 0
    buffer_load_dwordx4 v3, s[40:43], s82 offen lds
    s_add_u32 s96, s84, 5
    s_and_b32 s97, s96, 15
    s_mul_i32 s98, s97, 393216
    s_add_u32 s99, s98, s85
    s_add_u32 s82, s99, 4096
    s_add_u32 m0, s83, 90112
    s_nop 0
    buffer_load_dwordx4 v3, s[40:43], s82 offen lds
    s_add_u32 s96, s84, 5
    s_and_b32 s97, s96, 15
    s_mul_i32 s98, s97, 393216
    s_add_u32 s99, s98, s85
    s_add_u32 s82, s99, 4294770688
    s_add_u32 m0, s83, 135168
    s_nop 0
    buffer_load_dwordx4 v3, s[40:43], s82 offen lds
    s_add_u32 s96, s84, 5
    s_and_b32 s97, s96, 15
    s_mul_i32 s98, s97, 393216
    s_add_u32 s82, s98, s85
    s_add_u32 m0, s83, 139264
    s_nop 0
    buffer_load_dwordx4 v3, s[40:43], s82 offen lds
    v_bfe_u32 v4, v1, 2, 2
    v_lshlrev_b32 v4, 6, v4
    v_bfe_u32 v9, v1, 4, 1
    v_lshl_add_u32 v4, v9, 5, v4
    v_and_b32 v9, 3, v1
    v_lshl_add_u32 v4, v9, 3, v4
    v_lshrrev_b32 v9, 5, v1
    v_lshl_add_u32 v4, v9, 8, v4
    v_add_u32 v4, 159744, v4
    ds_read_b64_tr_b16 v[168:169], v4
    ds_read_b64_tr_b16 v[170:171], v4 offset:512
    ds_read_b64_tr_b16 v[172:173], v4 offset:1024
    ds_read_b64_tr_b16 v[174:175], v4 offset:1536
    ds_read_b64_tr_b16 v[176:177], v4 offset:2048
    ds_read_b64_tr_b16 v[178:179], v4 offset:2560
    ds_read_b64_tr_b16 v[180:181], v4 offset:3072
    ds_read_b64_tr_b16 v[182:183], v4 offset:3584
    s_lshl_b32 s14, s77, 10
    v_and_b32 v232, 7, v1
    v_lshl_add_u32 v232, v232, 4, s14
    v_bfe_u32 v9, v1, 3, 2
    v_lshl_add_u32 v232, v9, 8, v232
    v_lshrrev_b32 v9, 5, v1
    v_lshl_add_u32 v232, v9, 7, v232
    s_and_b32 s96, s9, 1
    s_lshl1_add_u32 s18, s96, 1
    s_and_b32 s96, s8, 3
    s_lshl2_add_u32 s97, s96, s3
    s_sub_u32 s98, s97, 4
    s_lshl_b32 s82, s98, 7
    v_lshrrev_b32 v136, 3, v1
    v_lshl_add_u32 v136, v136, 1, s82
    global_load_ushort v120, v136, s[86:87] offset:0
    global_load_ushort v121, v136, s[86:87] offset:16
    global_load_ushort v122, v136, s[86:87] offset:32
    global_load_ushort v123, v136, s[86:87] offset:48
    global_load_ushort v124, v136, s[86:87] offset:64
    global_load_ushort v125, v136, s[86:87] offset:80
    global_load_ushort v126, v136, s[86:87] offset:96
    global_load_ushort v127, v136, s[86:87] offset:112
    s_and_b32 s96, s8, 3
    s_lshl2_add_u32 s97, s96, s3
    s_sub_u32 s98, s97, 4
    s_mul_i32 s99, s98, 786432
    s_lshr_b32 s96, s8, 2
    s_lshl1_add_u32 s97, s9, s96
    s_lshl_b32 s98, s97, 7
    s_add_u32 s96, s99, s98
    s_add_u32 s19, s96, 4096
    s_waitcnt vmcnt(14)
    s_barrier
    s_add_u32 s96, s84, 6
    s_and_b32 s97, s96, 15
    s_mul_i32 s98, s97, 393216
    s_add_u32 s99, s98, s85
    s_add_u32 s82, s99, 4294772736
    s_add_u32 m0, s83, 4294963200
    s_nop 0
    buffer_load_dwordx4 v3, s[40:43], s82 offen lds
    s_add_u32 s96, s84, 6
    s_and_b32 s97, s96, 15
    s_mul_i32 s98, s97, 393216
    s_add_u32 s99, s98, s85
    s_add_u32 s82, s99, 2048
    s_mov_b32 m0, s83
    s_nop 0
    buffer_load_dwordx4 v3, s[40:43], s82 offen lds
    s_add_u32 s96, s84, 6
    s_and_b32 s97, s96, 15
    s_mul_i32 s98, s97, 393216
    s_add_u32 s99, s98, s85
    s_add_u32 s82, s99, 4294770688
    s_add_u32 m0, s83, 94208
    s_nop 0
    buffer_load_dwordx4 v3, s[40:43], s82 offen lds
    s_add_u32 s96, s84, 6
    s_and_b32 s97, s96, 15
    s_mul_i32 s98, s97, 393216
    s_add_u32 s82, s98, s85
    s_add_u32 m0, s83, 98304
    s_nop 0
    buffer_load_dwordx4 v3, s[40:43], s82 offen lds
    s_add_u32 s96, s84, 6
    s_and_b32 s97, s96, 15
    s_mul_i32 s98, s97, 393216
    s_add_u32 s99, s98, s85
    s_add_u32 s82, s99, 4294774784
    s_add_u32 m0, s83, 45056
    s_nop 0
    buffer_load_dwordx4 v3, s[40:43], s82 offen lds
    s_add_u32 s96, s84, 6
    s_and_b32 s97, s96, 15
    s_mul_i32 s98, s97, 393216
    s_add_u32 s99, s98, s85
    s_add_u32 s82, s99, 4096
    s_add_u32 m0, s83, 49152
    s_nop 0
    buffer_load_dwordx4 v3, s[40:43], s82 offen lds
    s_cmp_lg_u32 s18, 1
    s_cbranch_scc1 L_NM2_1
    s_mov_b32 s82, s19
    buffer_load_dwordx4 v[88:91], v248, s[48:51], s82 offen nt
    s_add_u32 s82, s19, 98304
    buffer_load_dwordx4 v[92:95], v248, s[48:51], s82 offen nt
    s_add_u32 s82, s19, 196608
    buffer_load_dwordx4 v[96:99], v248, s[48:51], s82 offen nt
    s_add_u32 s82, s19, 294912
    buffer_load_dwordx4 v[100:103], v248, s[48:51], s82 offen nt
    s_add_u32 s82, s19, 393216
    buffer_load_dwordx4 v[104:107], v248, s[48:51], s82 offen nt
    s_add_u32 s82, s19, 491520
    buffer_load_dwordx4 v[108:111], v248, s[48:51], s82 offen nt
    s_add_u32 s82, s19, 589824
    buffer_load_dwordx4 v[112:115], v248, s[48:51], s82 offen nt
    s_add_u32 s82, s19, 688128
    buffer_load_dwordx4 v[116:119], v248, s[48:51], s82 offen nt
L_NM2_1:
    s_waitcnt lgkmcnt(0)
    s_load_dword s24, s[32:33], s92 offset:512 glc
    s_load_dword s25, s[32:33], s92 offset:256 glc
    s_load_dword s26, s[32:33], s92 offset:3584 glc
    s_load_dword s27, s[32:33], s92 offset:3328 glc
    s_barrier
    s_add_u32 s96, s84, 7
    s_and_b32 s97, s96, 15
    s_mul_i32 s98, s97, 393216
    s_add_u32 s99, s98, s85
    s_add_u32 s82, s99, 4294772736
    s_add_u32 m0, s83, 4096
    s_nop 0
    buffer_load_dwordx4 v3, s[40:43], s82 offen lds
    s_add_u32 s96, s84, 7
    s_and_b32 s97, s96, 15
    s_mul_i32 s98, s97, 393216
    s_add_u32 s99, s98, s85
    s_add_u32 s82, s99, 2048
    s_add_u32 m0, s83, 8192
    s_nop 0
    buffer_load_dwordx4 v3, s[40:43], s82 offen lds
    s_add_u32 s96, s84, 7
    s_and_b32 s97, s96, 15
    s_mul_i32 s98, s97, 393216
    s_add_u32 s99, s98, s85
    s_add_u32 s82, s99, 4294770688
    s_add_u32 m0, s83, 102400
    s_nop 0
    buffer_load_dwordx4 v3, s[40:43], s82 offen lds
    s_add_u32 s96, s84, 7
    s_and_b32 s97, s96, 15
    s_mul_i32 s98, s97, 393216
    s_add_u32 s82, s98, s85
    s_add_u32 m0, s83, 106496
    s_nop 0
    buffer_load_dwordx4 v3, s[40:43], s82 offen lds
    s_add_u32 s96, s84, 7
    s_and_b32 s97, s96, 15
    s_mul_i32 s98, s97, 393216
    s_add_u32 s99, s98, s85
    s_add_u32 s82, s99, 4294774784
    s_add_u32 m0, s83, 53248
    s_nop 0
    buffer_load_dwordx4 v3, s[40:43], s82 offen lds
    s_add_u32 s96, s84, 7
    s_and_b32 s97, s96, 15
    s_mul_i32 s98, s97, 393216
    s_add_u32 s99, s98, s85
    s_add_u32 s82, s99, 4096
    s_add_u32 m0, s83, 57344
    s_nop 0
    buffer_load_dwordx4 v3, s[40:43], s82 offen lds
    s_cmp_lg_u32 s18, 2
    s_cbranch_scc1 L_NM2_2
    s_mov_b32 s82, s19
    buffer_load_dwordx4 v[88:91], v248, s[48:51], s82 offen nt
    s_add_u32 s82, s19, 98304
    buffer_load_dwordx4 v[92:95], v248, s[48:51], s82 offen nt
    s_add_u32 s82, s19, 196608
    buffer_load_dwordx4 v[96:99], v248, s[48:51], s82 offen nt
    s_add_u32 s82, s19, 294912
    buffer_load_dwordx4 v[100:103], v248, s[48:51], s82 offen nt
    s_add_u32 s82, s19, 393216
    buffer_load_dwordx4 v[104:107], v248, s[48:51], s82 offen nt
    s_add_u32 s82, s19, 491520
    buffer_load_dwordx4 v[108:111], v248, s[48:51], s82 offen nt
    s_add_u32 s82, s19, 589824
    buffer_load_dwordx4 v[112:115], v248, s[48:51], s82 offen nt
    s_add_u32 s82, s19, 688128
    buffer_load_dwordx4 v[116:119], v248, s[48:51], s82 offen nt
L_NM2_2:
    v_mov_b32 v4, -1
    v_mov_b32 v5, -1
    v_mov_b32 v6, -1
    v_mov_b32 v7, -1
    s_lshl3_add_u32 s96, s21, s3
    s_lshl4_add_u32 s97, s96, s12
    s_lshl_b32 s98, s97, 8
    s_add_u32 s14, s98, 12582912
    v_lshlrev_b32 v8, 2, v1
    buffer_store_dword v4, v8, s[32:35], s14 offen sc1
    s_lshl3_add_u32 s96, s21, s3
    s_sub_u32 s97, s96, 4
    s_lshl4_add_u32 s98, s97, s12
    s_lshl_b32 s99, s98, 8
    s_add_u32 s14, s99, 12582912
    v_lshlrev_b32 v8, 2, v1
    buffer_store_dword v4, v8, s[32:35], s14 offen sc1
    s_lshl_b32 s96, s21, 14
    s_lshl_b32 s97, s12, 9
    s_add_u32 s98, s96, s97
    s_add_u32 s14, s98, 13631488
    v_and_b32 v8, 31, v1
    v_lshlrev_b32 v8, 4, v8
    v_lshrrev_b32 v9, 5, v1
    v_lshl_add_u32 v8, v9, 13, v8
    s_cmp_lg_u32 s3, 5
    s_cbranch_scc1 L_NOPO
    buffer_store_dwordx4 v[4:7], v8, s[32:35], s14 offen sc1
L_NOPO:
    s_barrier
    s_add_u32 s96, s84, 8
    s_and_b32 s97, s96, 15
    s_mul_i32 s98, s97, 393216
    s_add_u32 s99, s98, s85
    s_add_u32 s82, s99, 4294772736
    s_add_u32 m0, s83, 12288
    s_nop 0
    buffer_load_dwordx4 v3, s[40:43], s82 offen lds
    s_add_u32 s96, s84, 8
    s_and_b32 s97, s96, 15
    s_mul_i32 s98, s97, 393216
    s_add_u32 s99, s98, s85
    s_add_u32 s82, s99, 2048
    s_add_u32 m0, s83, 16384
    s_nop 0
    buffer_load_dwordx4 v3, s[40:43], s82 offen lds
    s_add_u32 s96, s84, 8
    s_and_b32 s97, s96, 15
    s_mul_i32 s98, s97, 393216
    s_add_u32 s99, s98, s85
    s_add_u32 s82, s99, 4294770688
    s_add_u32 m0, s83, 110592
    s_nop 0
    buffer_load_dwordx4 v3, s[40:43], s82 offen lds
    s_add_u32 s96, s84, 8
    s_and_b32 s97, s96, 15
    s_mul_i32 s98, s97, 393216
    s_add_u32 s82, s98, s85
    s_add_u32 m0, s83, 114688
    s_nop 0
    buffer_load_dwordx4 v3, s[40:43], s82 offen lds
    s_add_u32 s96, s84, 8
    s_and_b32 s97, s96, 15
    s_mul_i32 s98, s97, 393216
    s_add_u32 s99, s98, s85
    s_add_u32 s82, s99, 4294774784
    s_add_u32 m0, s83, 61440
    s_nop 0
    buffer_load_dwordx4 v3, s[40:43], s82 offen lds
    s_add_u32 s96, s84, 8
    s_and_b32 s97, s96, 15
    s_mul_i32 s98, s97, 393216
    s_add_u32 s99, s98, s85
    s_add_u32 s82, s99, 4096
    s_add_u32 m0, s83, 65536
    s_nop 0
    buffer_load_dwordx4 v3, s[40:43], s82 offen lds
    s_cmp_lg_u32 s18, 3
    s_cbranch_scc1 L_NM2_3
    s_mov_b32 s82, s19
    buffer_load_dwordx4 v[88:91], v248, s[48:51], s82 offen nt
    s_add_u32 s82, s19, 98304
    buffer_load_dwordx4 v[92:95], v248, s[48:51], s82 offen nt
    s_add_u32 s82, s19, 196608
    buffer_load_dwordx4 v[96:99], v248, s[48:51], s82 offen nt
    s_add_u32 s82, s19, 294912
    buffer_load_dwordx4 v[100:103], v248, s[48:51], s82 offen nt
    s_add_u32 s82, s19, 393216
    buffer_load_dwordx4 v[104:107], v248, s[48:51], s82 offen nt
    s_add_u32 s82, s19, 491520
    buffer_load_dwordx4 v[108:111], v248, s[48:51], s82 offen nt
    s_add_u32 s82, s19, 589824
    buffer_load_dwordx4 v[112:115], v248, s[48:51], s82 offen nt
    s_add_u32 s82, s19, 688128
    buffer_load_dwordx4 v[116:119], v248, s[48:51], s82 offen nt
L_NM2_3:
    s_waitcnt vmcnt(20)
    v_lshlrev_b32 v120, 16, v120
    v_mul_f32 v136, s7, v120
    v_exp_f32 v136, -v136
    s_nop 0
    v_add_f32 v136, 1.0, v136
    v_rcp_f32 v136, v136
    s_nop 0
    v_mul_f32 v120, v120, v136
    v_cvt_pk_bf16_f32 v120, 0, v120
    v_lshlrev_b32 v121, 16, v121
    v_mul_f32 v137, s7, v121
    v_exp_f32 v137, -v137
    s_nop 0
    v_add_f32 v137, 1.0, v137
    v_rcp_f32 v137, v137
    s_nop 0
    v_mul_f32 v121, v121, v137
    v_cvt_pk_bf16_f32 v121, 0, v121
    v_lshlrev_b32 v122, 16, v122
    v_mul_f32 v136, s7, v122
    v_exp_f32 v136, -v136
    s_nop 0
    v_add_f32 v136, 1.0, v136
    v_rcp_f32 v136, v136
    s_nop 0
    v_mul_f32 v122, v122, v136
    v_cvt_pk_bf16_f32 v122, 0, v122
    v_lshlrev_b32 v123, 16, v123
    v_mul_f32 v137, s7, v123
    v_exp_f32 v137, -v137
    s_nop 0
    v_add_f32 v137, 1.0, v137
    v_rcp_f32 v137, v137
    s_nop 0
    v_mul_f32 v123, v123, v137
    v_cvt_pk_bf16_f32 v123, 0, v123
    v_lshlrev_b32 v124, 16, v124
    v_mul_f32 v136, s7, v124
    v_exp_f32 v136, -v136
    s_nop 0
    v_add_f32 v136, 1.0, v136
    v_rcp_f32 v136, v136
    s_nop 0
    v_mul_f32 v124, v124, v136
    v_cvt_pk_bf16_f32 v124, 0, v124
    v_lshlrev_b32 v125, 16, v125
    v_mul_f32 v137, s7, v125
    v_exp_f32 v137, -v137
    s_nop 0
    v_add_f32 v137, 1.0, v137
    v_rcp_f32 v137, v137
    s_nop 0
    v_mul_f32 v125, v125, v137
    v_cvt_pk_bf16_f32 v125, 0, v125
    v_lshlrev_b32 v126, 16, v126
    v_mul_f32 v136, s7, v126
    v_exp_f32 v136, -v136
    s_nop 0
    v_add_f32 v136, 1.0, v136
    v_rcp_f32 v136, v136
    s_nop 0
    v_mul_f32 v126, v126, v136
    v_cvt_pk_bf16_f32 v126, 0, v126
    v_lshlrev_b32 v127, 16, v127
    v_mul_f32 v137, s7, v127
    v_exp_f32 v137, -v137
    s_nop 0
    v_add_f32 v137, 1.0, v137
    v_rcp_f32 v137, v137
    s_nop 0
    v_mul_f32 v127, v127, v137
    v_cvt_pk_bf16_f32 v127, 0, v127
    s_waitcnt lgkmcnt(0)
    s_load_dword s24, s[32:33], s92 offset:1024 glc
    s_load_dword s25, s[32:33], s92 offset:768 glc
    s_load_dword s26, s[32:33], s92 offset:1536 glc
    s_load_dword s27, s[32:33], s92 offset:1280 glc
    s_barrier
    s_add_u32 s96, s84, 9
    s_and_b32 s97, s96, 15
    s_mul_i32 s98, s97, 393216
    s_add_u32 s99, s98, s85
    s_add_u32 s82, s99, 4294772736
    s_add_u32 m0, s83, 20480
    s_nop 0
    buffer_load_dwordx4 v3, s[40:43], s82 offen lds
L_PAD5:
    s_cbranch_execz L_RET5
    s_add_u32 s96, s84, 9
    s_and_b32 s97, s96, 15
    s_mul_i32 s98, s97, 393216
    s_add_u32 s99, s98, s85
    s_add_u32 s82, s99, 2048
    s_add_u32 m0, s83, 24576
    s_nop 0
    buffer_load_dwordx4 v3, s[40:43], s82 offen lds
    s_add_u32 s96, s84, 9
    s_and_b32 s97, s96, 15
    s_mul_i32 s98, s97, 393216
    s_add_u32 s99, s98, s85
    s_add_u32 s82, s99, 4294770688
    s_add_u32 m0, s83, 118784
    s_nop 0
    buffer_load_dwordx4 v3, s[40:43], s82 offen lds
    s_add_u32 s96, s84, 9
    s_and_b32 s97, s96, 15
    s_mul_i32 s98, s97, 393216
    s_add_u32 s82, s98, s85
    s_add_u32 m0, s83, 122880
    s_nop 0
    buffer_load_dwordx4 v3, s[40:43], s82 offen lds
    s_add_u32 s96, s84, 9
    s_and_b32 s97, s96, 15
    s_mul_i32 s98, s97, 393216
    s_add_u32 s99, s98, s85
    s_add_u32 s82, s99, 4294774784
    s_add_u32 m0, s83, 69632
    s_nop 0
    buffer_load_dwordx4 v3, s[40:43], s82 offen lds
    s_add_u32 s96, s84, 9
    s_and_b32 s97, s96, 15
    s_mul_i32 s98, s97, 393216
    s_add_u32 s99, s98, s85
    s_add_u32 s82, s99, 4096
    s_add_u32 m0, s83, 73728
    s_nop 0
    buffer_load_dwordx4 v3, s[40:43], s82 offen lds
    s_waitcnt vmcnt(24)
    s_waitcnt vmcnt(22)
    s_waitcnt vmcnt(20)
    s_barrier
    s_add_u32 s96, s84, 10
    s_and_b32 s97, s96, 15
    s_mul_i32 s98, s97, 393216
    s_add_u32 s99, s98, s85
    s_add_u32 s82, s99, 4294772736
    s_add_u32 m0, s83, 28672
    s_nop 0
    buffer_load_dwordx4 v3, s[40:43], s82 offen lds
    s_add_u32 s96, s84, 10
    s_and_b32 s97, s96, 15
    s_mul_i32 s98, s97, 393216
    s_add_u32 s99, s98, s85
    s_add_u32 s82, s99, 2048
    s_add_u32 m0, s83, 32768
    s_nop 0
    buffer_load_dwordx4 v3, s[40:43], s82 offen lds
    s_add_u32 s96, s84, 10
    s_and_b32 s97, s96, 15
    s_mul_i32 s98, s97, 393216
    s_add_u32 s99, s98, s85
    s_add_u32 s82, s99, 4294774784
    s_add_u32 m0, s83, 77824
    s_nop 0
    buffer_load_dwordx4 v3, s[40:43], s82 offen lds
    s_add_u32 s96, s84, 10
    s_and_b32 s97, s96, 15
    s_mul_i32 s98, s97, 393216
    s_add_u32 s99, s98, s85
    s_add_u32 s82, s99, 4096
    s_add_u32 m0, s83, 81920
    s_nop 0
    buffer_load_dwordx4 v3, s[40:43], s82 offen lds
    s_waitcnt vmcnt(8)
    v_lshlrev_b32 v136, 16, v88
    v_and_b32 v137, s6, v88
    v_mul_f32 v128, v136, v120
    v_mul_f32 v129, v137, v120
    v_lshlrev_b32 v138, 16, v89
    v_and_b32 v139, s6, v89
    v_mul_f32 v130, v138, v120
    v_mul_f32 v131, v139, v120
    v_lshlrev_b32 v136, 16, v90
    v_and_b32 v137, s6, v90
    v_mul_f32 v132, v136, v120
    v_mul_f32 v133, v137, v120
    v_lshlrev_b32 v138, 16, v91
    v_and_b32 v139, s6, v91
    v_mul_f32 v134, v138, v120
    v_mul_f32 v135, v139, v120
    v_lshlrev_b32 v136, 16, v92
    v_and_b32 v137, s6, v92
    v_fmac_f32 v128, v136, v121
    v_fmac_f32 v129, v137, v121
    v_lshlrev_b32 v138, 16, v93
    v_and_b32 v139, s6, v93
    v_fmac_f32 v130, v138, v121
    v_fmac_f32 v131, v139, v121
    v_lshlrev_b32 v136, 16, v94
    v_and_b32 v137, s6, v94
    v_fmac_f32 v132, v136, v121
    v_fmac_f32 v133, v137, v121
    v_lshlrev_b32 v138, 16, v95
    v_and_b32 v139, s6, v95
    v_fmac_f32 v134, v138, v121
    v_fmac_f32 v135, v139, v121
    v_lshlrev_b32 v136, 16, v96
    v_and_b32 v137, s6, v96
    v_fmac_f32 v128, v136, v122
    v_fmac_f32 v129, v137, v122
    v_lshlrev_b32 v138, 16, v97
    v_and_b32 v139, s6, v97
    v_fmac_f32 v130, v138, v122
    v_fmac_f32 v131, v139, v122
    v_lshlrev_b32 v136, 16, v98
    v_and_b32 v137, s6, v98
    v_fmac_f32 v132, v136, v122
    v_fmac_f32 v133, v137, v122
    v_lshlrev_b32 v138, 16, v99
    v_and_b32 v139, s6, v99
    v_fmac_f32 v134, v138, v122
    v_fmac_f32 v135, v139, v122
    s_waitcnt lgkmcnt(0)
    s_load_dword s24, s[32:33], s92 offset:2560 glc
    s_load_dword s25, s[32:33], s92 offset:2304 glc
    s_load_dword s26, s[32:33], s92 offset:3072 glc
    s_load_dword s27, s[32:33], s92 offset:2816 glc
    s_barrier
    s_add_u32 s96, s84, 11
    s_and_b32 s97, s96, 15
    s_mul_i32 s98, s97, 393216
    s_add_u32 s99, s98, s85
    s_add_u32 s82, s99, 4294772736
    s_add_u32 m0, s83, 36864
    s_nop 0
    buffer_load_dwordx4 v3, s[40:43], s82 offen lds
    s_add_u32 s96, s84, 11
    s_and_b32 s97, s96, 15
    s_mul_i32 s98, s97, 393216
    s_add_u32 s99, s98, s85
    s_add_u32 s82, s99, 2048
    s_add_u32 m0, s83, 40960
    s_nop 0
    buffer_load_dwordx4 v3, s[40:43], s82 offen lds
    s_add_u32 s96, s84, 11
    s_and_b32 s97, s96, 15
    s_mul_i32 s98, s97, 393216
    s_add_u32 s99, s98, s85
    s_add_u32 s82, s99, 4294774784
    s_add_u32 m0, s83, 86016
    s_nop 0
    buffer_load_dwordx4 v3, s[40:43], s82 offen lds
    s_add_u32 s96, s84, 11
    s_and_b32 s97, s96, 15
    s_mul_i32 s98, s97, 393216
    s_add_u32 s99, s98, s85
    s_add_u32 s82, s99, 4096
    s_add_u32 m0, s83, 90112
    s_nop 0
    buffer_load_dwordx4 v3, s[40:43], s82 offen lds
    v_lshlrev_b32 v136, 16, v100
    v_and_b32 v137, s6, v100
    v_fmac_f32 v128, v136, v123
    v_fmac_f32 v129, v137, v123
    v_lshlrev_b32 v138, 16, v101
    v_and_b32 v139, s6, v101
    v_fmac_f32 v130, v138, v123
    v_fmac_f32 v131, v139, v123
    v_lshlrev_b32 v136, 16, v102
    v_and_b32 v137, s6, v102
    v_fmac_f32 v132, v136, v123
    v_fmac_f32 v133, v137, v123
    v_lshlrev_b32 v138, 16, v103
    v_and_b32 v139, s6, v103
    v_fmac_f32 v134, v138, v123
    v_fmac_f32 v135, v139, v123
    v_lshlrev_b32 v136, 16, v104
    v_and_b32 v137, s6, v104
    v_fmac_f32 v128, v136, v124
    v_fmac_f32 v129, v137, v124
    v_lshlrev_b32 v138, 16, v105
    v_and_b32 v139, s6, v105
    v_fmac_f32 v130, v138, v124
    v_fmac_f32 v131, v139, v124
    v_lshlrev_b32 v136, 16, v106
    v_and_b32 v137, s6, v106
    v_fmac_f32 v132, v136, v124
    v_fmac_f32 v133, v137, v124
    v_lshlrev_b32 v138, 16, v107
    v_and_b32 v139, s6, v107
    v_fmac_f32 v134, v138, v124
    v_fmac_f32 v135, v139, v124
    v_lshlrev_b32 v136, 16, v108
    v_and_b32 v137, s6, v108
    v_fmac_f32 v128, v136, v125
    v_fmac_f32 v129, v137, v125
    v_lshlrev_b32 v138, 16, v109
    v_and_b32 v139, s6, v109
    v_fmac_f32 v130, v138, v125
    v_fmac_f32 v131, v139, v125
    v_lshlrev_b32 v136, 16, v110
    v_and_b32 v137, s6, v110
    v_fmac_f32 v132, v136, v125
    v_fmac_f32 v133, v137, v125
    v_lshlrev_b32 v138, 16, v111
    v_and_b32 v139, s6, v111
    v_fmac_f32 v134, v138, v125
    v_fmac_f32 v135, v139, v125
    s_barrier
    s_add_u32 s96, s84, 12
    s_and_b32 s97, s96, 15
    s_mul_i32 s98, s97, 393216
    s_add_u32 s99, s98, s85
    s_add_u32 s82, s99, 4294772736
    s_add_u32 m0, s83, 4294963200
    s_nop 0
    buffer_load_dwordx4 v3, s[40:43], s82 offen lds
    s_add_u32 s96, s84, 12
    s_and_b32 s97, s96, 15
    s_mul_i32 s98, s97, 393216
    s_add_u32 s99, s98, s85
    s_add_u32 s82, s99, 2048
    s_mov_b32 m0, s83
    s_nop 0
    buffer_load_dwordx4 v3, s[40:43], s82 offen lds
    s_add_u32 s96, s84, 12
    s_and_b32 s97, s96, 15
    s_mul_i32 s98, s97, 393216
    s_add_u32 s99, s98, s85
    s_add_u32 s82, s99, 4294774784
    s_add_u32 m0, s83, 45056
    s_nop 0
    buffer_load_dwordx4 v3, s[40:43], s82 offen lds
    s_add_u32 s96, s84, 12
    s_and_b32 s97, s96, 15
    s_mul_i32 s98, s97, 393216
    s_add_u32 s99, s98, s85
    s_add_u32 s82, s99, 4096
    s_add_u32 m0, s83, 49152
    s_nop 0
    buffer_load_dwordx4 v3, s[40:43], s82 offen lds
    v_lshlrev_b32 v136, 16, v112
    v_and_b32 v137, s6, v112
    v_fmac_f32 v128, v136, v126
    v_fmac_f32 v129, v137, v126
    v_lshlrev_b32 v138, 16, v113
    v_and_b32 v139, s6, v113
    v_fmac_f32 v130, v138, v126
    v_fmac_f32 v131, v139, v126
    v_lshlrev_b32 v136, 16, v114
    v_and_b32 v137, s6, v114
    v_fmac_f32 v132, v136, v126
    v_fmac_f32 v133, v137, v126
    v_lshlrev_b32 v138, 16, v115
    v_and_b32 v139, s6, v115
    v_fmac_f32 v134, v138, v126
    v_fmac_f32 v135, v139, v126
    v_lshlrev_b32 v136, 16, v116
    v_and_b32 v137, s6, v116
    v_fmac_f32 v128, v136, v127
    v_fmac_f32 v129, v137, v127
    v_lshlrev_b32 v138, 16, v117
    v_and_b32 v139, s6, v117
    v_fmac_f32 v130, v138, v127
    v_fmac_f32 v131, v139, v127
    v_lshlrev_b32 v136, 16, v118
    v_and_b32 v137, s6, v118
    v_fmac_f32 v132, v136, v127
    v_fmac_f32 v133, v137, v127
    v_lshlrev_b32 v138, 16, v119
    v_and_b32 v139, s6, v119
    v_fmac_f32 v134, v138, v127
    v_fmac_f32 v135, v139, v127
    v_permlane32_swap_b32 v128, v132
    v_permlane32_swap_b32 v129, v133
    v_permlane32_swap_b32 v130, v134
    v_permlane32_swap_b32 v131, v135
    v_add_f32 v128, v128, v132
    v_add_f32 v129, v129, v133
    v_add_f32 v130, v130, v134
    v_add_f32 v131, v131, v135
    s_nop 0
    v_permlane16_swap_b32 v128, v130
    v_permlane16_swap_b32 v129, v131
    v_add_f32 v128, v128, v130
    v_add_f32 v129, v129, v131
    s_nop 0
    v_add_f32_dpp v128, v128, v128 row_ror:8 row_mask:0xf bank_mask:0xf
    v_add_f32_dpp v129, v129, v129 row_ror:8 row_mask:0xf bank_mask:0xf
    s_nop 1
    v_mov_b32_dpp v128, v129 quad_perm:[0,1,2,3] row_mask:0xf bank_mask:0xc
    ds_write_b32 v252, v128 offset:9984
    s_waitcnt lgkmcnt(0)
    s_barrier
    s_add_u32 s96, s84, 13
    s_and_b32 s97, s96, 15
    s_mul_i32 s98, s97, 393216
    s_add_u32 s99, s98, s85
    s_add_u32 s82, s99, 4294772736
    s_add_u32 m0, s83, 4096
    s_nop 0
    buffer_load_dwordx4 v3, s[40:43], s82 offen lds
    s_add_u32 s96, s84, 13
    s_and_b32 s97, s96, 15
    s_mul_i32 s98, s97, 393216
    s_add_u32 s99, s98, s85
    s_add_u32 s82, s99, 2048
    s_add_u32 m0, s83, 8192
    s_nop 0
    buffer_load_dwordx4 v3, s[40:43], s82 offen lds
    s_add_u32 s96, s84, 13
    s_and_b32 s97, s96, 15
    s_mul_i32 s98, s97, 393216
    s_add_u32 s99, s98, s85
    s_add_u32 s82, s99, 4294774784
    s_add_u32 m0, s83, 53248
    s_nop 0
    buffer_load_dwordx4 v3, s[40:43], s82 offen lds
    s_add_u32 s96, s84, 13
    s_and_b32 s97, s96, 15
    s_mul_i32 s98, s97, 393216
    s_add_u32 s99, s98, s85
    s_add_u32 s82, s99, 4096
    s_add_u32 m0, s83, 57344
    s_nop 0
    buffer_load_dwordx4 v3, s[40:43], s82 offen lds
    s_cmp_lg_u32 s3, 4
    s_cbranch_scc1 L_M2F
    ds_read_b128 v[128:131], v251 offset:10000
    s_lshr_b32 s96, s8, 2
    s_lshl1_add_u32 s97, s9, s96
    s_and_b32 s98, s8, 3
    s_lshl2_add_u32 s99, s97, s98
    s_lshl_b32 s96, s99, 9
    s_add_u32 s13, s96, 131072
    s_waitcnt lgkmcnt(0)
    v_add_f32 v128, v128, v129
    v_add_f32 v130, v130, v131
    v_mov_b32 v129, s4
    v_add_f32 v128, v128, v130
    buffer_store_dwordx2 v[128:129], v250, s[32:35], s13 offen sc1
L_M2F:
    s_lshl_b32 s96, s74, 13
    s_sub_u32 s97, s3, 4
    s_lshl_b32 s98, s97, 8
    s_add_u32 s99, s96, s98
    s_add_u32 s13, s99, 20971520
    s_waitcnt lgkmcnt(0)
    s_load_dword s24, s[32:33], s13 offset:1276 glc
    s_load_dword s25, s[32:33], s13 offset:3324 glc
    s_load_dword s26, s[32:33], s13 offset:5372 glc
    s_load_dword s27, s[32:33], s13 offset:7420 glc
    s_waitcnt vmcnt(18)
    s_waitcnt vmcnt(16)
    s_barrier
    s_add_u32 s96, s84, 14
    s_and_b32 s97, s96, 15
    s_mul_i32 s98, s97, 393216
    s_add_u32 s99, s98, s85
    s_add_u32 s82, s99, 4294772736
    s_add_u32 m0, s83, 12288
    s_nop 0
    buffer_load_dwordx4 v3, s[40:43], s82 offen lds
    s_add_u32 s96, s84, 14
    s_and_b32 s97, s96, 15
    s_mul_i32 s98, s97, 393216
    s_add_u32 s99, s98, s85
    s_add_u32 s82, s99, 2048
    s_add_u32 m0, s83, 16384
    s_nop 0
    buffer_load_dwordx4 v3, s[40:43], s82 offen lds
    s_waitcnt vmcnt(16)
    s_waitcnt vmcnt(12)
    s_barrier
    s_add_u32 s96, s84, 15
    s_and_b32 s97, s96, 15
    s_mul_i32 s98, s97, 393216
    s_add_u32 s99, s98, s85
    s_add_u32 s82, s99, 4294772736
    s_add_u32 m0, s83, 20480
    s_nop 0
    buffer_load_dwordx4 v3, s[40:43], s82 offen lds
    s_add_u32 s96, s84, 15
    s_and_b32 s97, s96, 15
    s_mul_i32 s98, s97, 393216
    s_add_u32 s99, s98, s85
    s_add_u32 s82, s99, 2048
    s_add_u32 m0, s83, 24576
    s_nop 0
    buffer_load_dwordx4 v3, s[40:43], s82 offen lds
    s_waitcnt vmcnt(10)
    s_waitcnt vmcnt(6)
    s_waitcnt vmcnt(2)
    s_barrier
    s_add_u32 s96, s84, 14
    s_and_b32 s97, s96, 15
    s_mul_i32 s98, s97, 393216
    s_add_u32 s99, s98, s85
    s_add_u32 s82, s99, 4294774784
    s_add_u32 m0, s83, 61440
    s_nop 0
    buffer_load_dwordx4 v3, s[40:43], s82 offen lds
    s_add_u32 s96, s84, 14
    s_and_b32 s97, s96, 15
    s_mul_i32 s98, s97, 393216
    s_add_u32 s99, s98, s85
    s_add_u32 s82, s99, 4096
    s_add_u32 m0, s83, 65536
    s_nop 0
    buffer_load_dwordx4 v3, s[40:43], s82 offen lds
    s_add_u32 s96, s84, 15
    s_and_b32 s97, s96, 15
    s_mul_i32 s98, s97, 393216
    s_add_u32 s99, s98, s85
    s_add_u32 s82, s99, 4294774784
    s_add_u32 m0, s83, 69632
    s_nop 0
    buffer_load_dwordx4 v3, s[40:43], s82 offen lds
    s_add_u32 s96, s84, 15
    s_and_b32 s97, s96, 15
    s_mul_i32 s98, s97, 393216
    s_add_u32 s99, s98, s85
    s_add_u32 s82, s99, 4096
    s_add_u32 m0, s83, 73728
    s_nop 0
    buffer_load_dwordx4 v3, s[40:43], s82 offen lds
    s_waitcnt vmcnt(4)
    s_barrier
    s_add_u32 s96, s84, 10
    s_and_b32 s97, s96, 15
    s_mul_i32 s98, s97, 393216
    s_add_u32 s99, s98, s85
    s_add_u32 s82, s99, 4294770688
    s_add_u32 m0, s83, 126976
    s_nop 0
    buffer_load_dwordx4 v3, s[40:43], s82 offen lds
    s_add_u32 s96, s84, 10
    s_and_b32 s97, s96, 15
    s_mul_i32 s98, s97, 393216
    s_add_u32 s82, s98, s85
    s_add_u32 m0, s83, 131072
    s_nop 0
    buffer_load_dwordx4 v3, s[40:43], s82 offen lds
    s_add_u32 s96, s84, 11
    s_and_b32 s97, s96, 15
    s_mul_i32 s98, s97, 393216
    s_add_u32 s99, s98, s85
    s_add_u32 s82, s99, 4294770688
    s_add_u32 m0, s83, 135168
    s_nop 0
    buffer_load_dwordx4 v3, s[40:43], s82 offen lds
    s_add_u32 s96, s84, 11
    s_and_b32 s97, s96, 15
    s_mul_i32 s98, s97, 393216
    s_add_u32 s82, s98, s85
    s_add_u32 m0, s83, 139264
    s_nop 0
    buffer_load_dwordx4 v3, s[40:43], s82 offen lds
    s_waitcnt lgkmcnt(0)
    s_barrier
    s_add_u32 s96, s84, 12
    s_and_b32 s97, s96, 15
    s_mul_i32 s98, s97, 393216
    s_add_u32 s99, s98, s85
    s_add_u32 s82, s99, 4294770688
    s_add_u32 m0, s83, 94208
    s_nop 0
    buffer_load_dwordx4 v3, s[40:43], s82 offen lds
    s_add_u32 s96, s84, 12
    s_and_b32 s97, s96, 15
    s_mul_i32 s98, s97, 393216
    s_add_u32 s82, s98, s85
    s_add_u32 m0, s83, 98304
    s_nop 0
    buffer_load_dwordx4 v3, s[40:43], s82 offen lds
    s_add_u32 s96, s84, 13
    s_and_b32 s97, s96, 15
    s_mul_i32 s98, s97, 393216
    s_add_u32 s99, s98, s85
    s_add_u32 s82, s99, 4294770688
    s_add_u32 m0, s83, 102400
    s_nop 0
    buffer_load_dwordx4 v3, s[40:43], s82 offen lds
    s_add_u32 s96, s84, 13
    s_and_b32 s97, s96, 15
    s_mul_i32 s98, s97, 393216
    s_add_u32 s82, s98, s85
    s_add_u32 m0, s83, 106496
    s_nop 0
    buffer_load_dwordx4 v3, s[40:43], s82 offen lds
    s_setprio 3
    ds_read_b128 v[152:155], v0
    ds_read_b128 v[156:159], v0 offset:1024
    v_subrev_u32 v0, 118784, v0
    s_waitcnt lgkmcnt(1)
    v_mfma_f32_32x32x16_bf16 v[184:199], v[168:171], v[152:155], 0
    s_waitcnt lgkmcnt(0)
    v_mfma_f32_32x32x16_bf16 v[184:199], v[172:175], v[156:159], v[184:199]
    s_setprio 0
    s_nop 10
    v_cvt_pk_bf16_f32 v184, 0, v184
    v_cvt_pk_bf16_f32 v185, 0, v185
    v_cvt_pk_bf16_f32 v186, 0, v186
    v_cvt_pk_bf16_f32 v187, 0, v187
    v_cvt_pk_bf16_f32 v188, 0, v188
    v_cvt_pk_bf16_f32 v189, 0, v189
    v_cvt_pk_bf16_f32 v190, 0, v190
    v_cvt_pk_bf16_f32 v191, 0, v191
    v_cvt_pk_bf16_f32 v192, 0, v192
    v_cvt_pk_bf16_f32 v193, 0, v193
    v_cvt_pk_bf16_f32 v194, 0, v194
    v_cvt_pk_bf16_f32 v195, 0, v195
    v_cvt_pk_bf16_f32 v196, 0, v196
    v_cvt_pk_bf16_f32 v197, 0, v197
    v_cvt_pk_bf16_f32 v198, 0, v198
    v_cvt_pk_bf16_f32 v199, 0, v199
    v_max3_f32 v4, v184, v185, v186
    v_min3_f32 v5, v184, v185, v186
    v_max3_f32 v4, v4, v187, v188
    v_min3_f32 v5, v5, v187, v188
    v_max3_f32 v4, v4, v189, v190
    v_min3_f32 v5, v5, v189, v190
    v_max3_f32 v4, v4, v191, v192
    v_min3_f32 v5, v5, v191, v192
    v_max3_f32 v4, v4, v193, v194
    v_min3_f32 v5, v5, v193, v194
    v_max3_f32 v4, v4, v195, v196
    v_min3_f32 v5, v5, v195, v196
    v_max3_f32 v4, v4, v197, v198
    v_min3_f32 v5, v5, v197, v198
    v_max_f32 v6, v4, v199
    v_min_f32 v7, v5, v199
    v_max_f32 v4, v4, v199
    v_min_f32 v5, v5, v199
    s_nop 0
    v_permlane32_swap_b32 v4, v6
    v_permlane32_swap_b32 v5, v7
    v_max_f32 v4, v4, v6
    v_min_f32 v5, v5, v7
    v_mul_f32_e64 v4, v4, s7
    v_mul_f32_e64 v5, v5, s7
    v_fma_f32 v216, v184, s7, -v4
    v_fma_f32 v217, v185, s7, -v4
    v_fma_f32 v184, -v184, s7, v5
    v_fma_f32 v185, -v185, s7, v5
    v_fma_f32 v218, v186, s7, -v4
    v_fma_f32 v219, v187, s7, -v4
    v_fma_f32 v186, -v186, s7, v5
    v_fma_f32 v187, -v187, s7, v5
    s_waitcnt vmcnt(10)
    s_waitcnt vmcnt(8)
    s_waitcnt vmcnt(6)
    s_barrier
    s_add_u32 s96, s84, 14
    s_and_b32 s97, s96, 15
    s_mul_i32 s98, s97, 393216
    s_add_u32 s99, s98, s85
    s_add_u32 s82, s99, 4294770688
    s_add_u32 m0, s83, 110592
    s_nop 0
    buffer_load_dwordx4 v3, s[40:43], s82 offen lds
    s_add_u32 s96, s84, 14
    s_and_b32 s97, s96, 15
    s_mul_i32 s98, s97, 393216
    s_add_u32 s82, s98, s85
    s_add_u32 m0, s83, 114688
    s_nop 0
    buffer_load_dwordx4 v3, s[40:43], s82 offen lds
    s_add_u32 s96, s84, 15
    s_and_b32 s97, s96, 15
    s_mul_i32 s98, s97, 393216
    s_add_u32 s99, s98, s85
    s_add_u32 s82, s99, 4294770688
    s_add_u32 m0, s83, 118784
    s_nop 0
    buffer_load_dwordx4 v3, s[40:43], s82 offen lds
    s_add_u32 s96, s84, 15
    s_and_b32 s97, s96, 15
    s_mul_i32 s98, s97, 393216
    s_add_u32 s82, s98, s85
    s_add_u32 m0, s83, 122880
    s_nop 0
    buffer_load_dwordx4 v3, s[40:43], s82 offen lds
    s_setprio 3
    ds_read_b128 v[152:155], v0
    ds_read_b128 v[156:159], v0 offset:1024
    s_waitcnt lgkmcnt(1)
    v_mfma_f32_32x32x16_bf16 v[200:215], v[176:179], v[152:155], 0
    s_waitcnt lgkmcnt(0)
    v_mfma_f32_32x32x16_bf16 v[200:215], v[180:183], v[156:159], v[200:215]
    s_setprio 0
    v_fma_f32 v220, v188, s7, -v4
    v_fma_f32 v221, v189, s7, -v4
    v_fma_f32 v188, -v188, s7, v5
    v_fma_f32 v189, -v189, s7, v5
    v_fma_f32 v222, v190, s7, -v4
    s_mov_b32 s82, s80
    buffer_load_dwordx4 v[56:59], v27, s[52:55], s82 offen nt
    v_fma_f32 v223, v191, s7, -v4
    v_fma_f32 v190, -v190, s7, v5
    v_fma_f32 v191, -v191, s7, v5
    v_fma_f32 v224, v192, s7, -v4
    v_fma_f32 v225, v193, s7, -v4
    v_fma_f32 v192, -v192, s7, v5
    v_fma_f32 v193, -v193, s7, v5
    v_fma_f32 v226, v194, s7, -v4
    v_fma_f32 v227, v195, s7, -v4
    v_fma_f32 v194, -v194, s7, v5
    v_fma_f32 v195, -v195, s7, v5
    v_fma_f32 v228, v196, s7, -v4
    v_fma_f32 v229, v197, s7, -v4
    v_fma_f32 v196, -v196, s7, v5
    v_fma_f32 v197, -v197, s7, v5
    v_fma_f32 v230, v198, s7, -v4
    v_fma_f32 v231, v199, s7, -v4
    v_fma_f32 v198, -v198, s7, v5
    v_fma_f32 v199, -v199, s7, v5
    v_exp_f32 v216, v216
    v_exp_f32 v184, v184
    v_exp_f32 v217, v217
    v_exp_f32 v185, v185
    v_exp_f32 v218, v218
    v_exp_f32 v186, v186
    v_exp_f32 v219, v219
    v_exp_f32 v187, v187
    v_exp_f32 v220, v220
    v_exp_f32 v188, v188
    v_exp_f32 v221, v221
    v_exp_f32 v189, v189
    v_exp_f32 v222, v222
    v_exp_f32 v190, v190
    v_exp_f32 v223, v223
    v_exp_f32 v191, v191
    v_exp_f32 v224, v224
    v_exp_f32 v192, v192
    v_exp_f32 v225, v225
    v_exp_f32 v193, v193
    v_exp_f32 v226, v226
    s_add_u32 s82, s80, 4294049792
    buffer_load_dwordx4 v[60:63], v27, s[52:55], s82 offen nt
    v_exp_f32 v194, v194
    v_exp_f32 v227, v227
    v_exp_f32 v195, v195
    v_exp_f32 v228, v228
    v_exp_f32 v196, v196
    v_exp_f32 v229, v229
    v_exp_f32 v197, v197
    v_exp_f32 v230, v230
    v_exp_f32 v198, v198
    v_exp_f32 v231, v231
    v_exp_f32 v199, v199
    v_add_f32 v8, v216, v218
    v_add_f32 v9, v217, v219
    v_add_f32 v10, v184, v186
    v_add_f32 v11, v185, v187
    v_add_f32 v8, v8, v220
    v_add_f32 v9, v9, v221
    v_add_f32 v10, v10, v188
    v_add_f32 v11, v11, v189
    v_add_f32 v8, v8, v222
    v_add_f32 v9, v9, v223
    v_add_f32 v10, v10, v190
    v_add_f32 v11, v11, v191
    v_add_f32 v8, v8, v224
    v_add_f32 v9, v9, v225
    v_add_f32 v10, v10, v192
    v_add_f32 v11, v11, v193
    v_add_f32 v8, v8, v226
    v_add_f32 v9, v9, v227
    v_add_f32 v10, v10, v194
    v_add_f32 v11, v11, v195
    v_add_f32 v8, v8, v228
    v_add_f32 v9, v9, v229
    v_add_f32 v10, v10, v196
    v_add_f32 v11, v11, v197
    v_add_f32 v8, v8, v230
    v_add_f32 v9, v9, v231
    v_add_f32 v10, v10, v198
    v_add_f32 v11, v11, v199
    v_add_f32 v6, v8, v9
    s_add_u32 s82, s80, 57344
    buffer_load_dwordx4 v[64:67], v27, s[52:55], s82 offen nt
    v_add_f32 v7, v10, v11
    v_add_f32 v4, v8, v9
    v_add_f32 v5, v10, v11
    s_nop 0
    v_permlane32_swap_b32 v4, v6
    v_permlane32_swap_b32 v5, v7
    v_add_f32 v4, v4, v6
    v_add_f32 v5, v5, v7
    v_rcp_f32 v4, v4
    v_rcp_f32 v5, v5
    v_mul_f32 v216, v216, v4
    v_mul_f32 v217, v217, v4
    v_mul_f32 v184, v184, v5
    v_mul_f32 v185, v185, v5
    v_mul_f32 v218, v218, v4
    v_mul_f32 v219, v219, v4
    v_mul_f32 v186, v186, v5
    v_mul_f32 v187, v187, v5
    v_mul_f32 v220, v220, v4
    v_mul_f32 v221, v221, v4
    v_mul_f32 v188, v188, v5
    v_mul_f32 v189, v189, v5
    v_mul_f32 v222, v222, v4
    v_mul_f32 v223, v223, v4
    v_mul_f32 v190, v190, v5
    v_mul_f32 v191, v191, v5
    v_mul_f32 v224, v224, v4
    v_mul_f32 v225, v225, v4
    v_mul_f32 v192, v192, v5
    v_mul_f32 v193, v193, v5
    v_mul_f32 v226, v226, v4
    v_mul_f32 v227, v227, v4
    v_mul_f32 v194, v194, v5
    v_mul_f32 v195, v195, v5
    v_mul_f32 v228, v228, v4
    v_mul_f32 v229, v229, v4
    v_mul_f32 v196, v196, v5
    v_mul_f32 v197, v197, v5
    v_mul_f32 v230, v230, v4
    v_mul_f32 v231, v231, v4
    v_mul_f32 v198, v198, v5
    s_add_u32 s82, s80, 4294107136
    buffer_load_dwordx4 v[68:71], v27, s[52:55], s82 offen nt
    v_mul_f32 v199, v199, v5
    v_cvt_pk_bf16_f32 v216, v216, v217
    v_cvt_pk_bf16_f32 v217, v218, v219
    v_cvt_pk_bf16_f32 v218, v220, v221
    v_cvt_pk_bf16_f32 v219, v222, v223
    v_cvt_pk_bf16_f32 v220, v224, v225
    v_cvt_pk_bf16_f32 v221, v226, v227
    v_cvt_pk_bf16_f32 v222, v228, v229
    v_cvt_pk_bf16_f32 v223, v230, v231
    ds_write_b128 v232, v[216:219]
    v_cvt_pk_bf16_f32 v224, v184, v185
    v_cvt_pk_bf16_f32 v225, v186, v187
    v_cvt_pk_bf16_f32 v226, v188, v189
    v_cvt_pk_bf16_f32 v227, v190, v191
    ds_write_b128 v232, v[220:223] offset:4096
    ds_write_b128 v232, v[224:227] offset:8192
    v_cvt_pk_bf16_f32 v228, v192, v193
    v_cvt_pk_bf16_f32 v229, v194, v195
    v_cvt_pk_bf16_f32 v230, v196, v197
    v_cvt_pk_bf16_f32 v231, v198, v199
    ds_write_b128 v232, v[228:231] offset:12288
    s_waitcnt vmcnt(12)
    s_waitcnt vmcnt(10)
    s_waitcnt vmcnt(8)
L_PAD6:
    s_cbranch_execz L_RET6
    s_waitcnt vmcnt(6)
    s_waitcnt vmcnt(4)
    s_barrier
    v_cvt_pk_bf16_f32 v200, 0, v200
    v_cvt_pk_bf16_f32 v201, 0, v201
    v_cvt_pk_bf16_f32 v202, 0, v202
    v_cvt_pk_bf16_f32 v203, 0, v203
    s_xor_b32 s96, s95, 786432
    s_add_u32 s97, s96, s90
    s_sub_u32 s82, s97, 65536
    s_add_u32 m0, s83, 45056
    s_nop 0
    buffer_load_dwordx4 v26, s[44:47], s82 offen lds
    v_cvt_pk_bf16_f32 v204, 0, v204
    v_cvt_pk_bf16_f32 v205, 0, v205
    v_cvt_pk_bf16_f32 v206, 0, v206
    v_cvt_pk_bf16_f32 v207, 0, v207
    v_cvt_pk_bf16_f32 v208, 0, v208
    v_cvt_pk_bf16_f32 v209, 0, v209
    v_cvt_pk_bf16_f32 v210, 0, v210
    v_cvt_pk_bf16_f32 v211, 0, v211
    v_cvt_pk_bf16_f32 v212, 0, v212
    v_cvt_pk_bf16_f32 v213, 0, v213
    v_cvt_pk_bf16_f32 v214, 0, v214
    v_cvt_pk_bf16_f32 v215, 0, v215
    v_max3_f32 v4, v200, v201, v202
    v_min3_f32 v5, v200, v201, v202
    s_xor_b32 s96, s95, 786432
    s_add_u32 s82, s96, s90
    s_add_u32 m0, s83, 49152
    s_nop 0
    buffer_load_dwordx4 v26, s[44:47], s82 offen lds
    v_max3_f32 v4, v4, v203, v204
    v_min3_f32 v5, v5, v203, v204
    v_max3_f32 v4, v4, v205, v206
    v_min3_f32 v5, v5, v205, v206
    v_max3_f32 v4, v4, v207, v208
    v_min3_f32 v5, v5, v207, v208
    v_max3_f32 v4, v4, v209, v210
    v_min3_f32 v5, v5, v209, v210
    v_max3_f32 v4, v4, v211, v212
    v_min3_f32 v5, v5, v211, v212
    v_max3_f32 v4, v4, v213, v214
    v_min3_f32 v5, v5, v213, v214
    v_max_f32 v6, v4, v215
    v_min_f32 v7, v5, v215
    s_xor_b32 s96, s95, 917504
    s_add_u32 s97, s96, s90
    s_sub_u32 s82, s97, 65536
    s_add_u32 m0, s83, 53248
    s_nop 0
    buffer_load_dwordx4 v26, s[44:47], s82 offen lds
    v_max_f32 v4, v4, v215
    s_waitcnt lgkmcnt(0)
    v_min_f32 v5, v5, v215
    v_permlane32_swap_b32 v4, v6
    s_nop 0
    v_permlane32_swap_b32 v5, v7
    v_max_f32 v4, v4, v6
    v_min_f32 v5, v5, v7
    v_mul_f32_e64 v4, v4, s7
    v_mul_f32_e64 v5, v5, s7
    v_fma_f32 v216, v200, s7, -v4
    v_fma_f32 v217, v201, s7, -v4
    v_fma_f32 v200, -v200, s7, v5
    v_fma_f32 v201, -v201, s7, v5
    v_fma_f32 v218, v202, s7, -v4
    s_xor_b32 s96, s95, 917504
    s_add_u32 s82, s96, s90
    s_add_u32 m0, s83, 57344
    s_nop 0
    buffer_load_dwordx4 v26, s[44:47], s82 offen lds
    v_fma_f32 v219, v203, s7, -v4
    v_fma_f32 v202, -v202, s7, v5
    v_fma_f32 v203, -v203, s7, v5
    v_fma_f32 v220, v204, s7, -v4
    v_fma_f32 v221, v205, s7, -v4
    v_fma_f32 v204, -v204, s7, v5
    v_fma_f32 v205, -v205, s7, v5
    v_fma_f32 v222, v206, s7, -v4
    v_fma_f32 v223, v207, s7, -v4
    v_fma_f32 v206, -v206, s7, v5
    v_fma_f32 v207, -v207, s7, v5
    v_fma_f32 v224, v208, s7, -v4
    v_fma_f32 v225, v209, s7, -v4
    v_fma_f32 v208, -v208, s7, v5
    s_xor_b32 s96, s95, 1048576
    s_add_u32 s97, s96, s90
    s_sub_u32 s82, s97, 65536
    s_add_u32 m0, s83, 61440
    s_nop 0
    buffer_load_dwordx4 v26, s[44:47], s82 offen lds
    v_fma_f32 v209, -v209, s7, v5
    v_fma_f32 v226, v210, s7, -v4
    v_fma_f32 v227, v211, s7, -v4
    v_fma_f32 v210, -v210, s7, v5
    v_fma_f32 v211, -v211, s7, v5
    v_fma_f32 v228, v212, s7, -v4
    v_fma_f32 v229, v213, s7, -v4
    v_fma_f32 v212, -v212, s7, v5
    v_fma_f32 v213, -v213, s7, v5
    v_fma_f32 v230, v214, s7, -v4
    v_fma_f32 v231, v215, s7, -v4
    v_fma_f32 v214, -v214, s7, v5
    v_fma_f32 v215, -v215, s7, v5
    v_exp_f32 v216, v216
    s_xor_b32 s96, s95, 1048576
    s_add_u32 s82, s96, s90
    s_add_u32 m0, s83, 65536
    s_nop 0
    buffer_load_dwordx4 v26, s[44:47], s82 offen lds
    v_exp_f32 v200, v200
    v_exp_f32 v217, v217
    v_exp_f32 v201, v201
    v_exp_f32 v218, v218
    v_exp_f32 v202, v202
    v_exp_f32 v219, v219
    v_exp_f32 v203, v203
    v_exp_f32 v220, v220
    v_exp_f32 v204, v204
    v_exp_f32 v221, v221
    v_exp_f32 v205, v205
    v_exp_f32 v222, v222
    v_exp_f32 v206, v206
    v_exp_f32 v223, v223
    s_xor_b32 s96, s95, 1179648
    s_add_u32 s97, s96, s90
    s_sub_u32 s82, s97, 65536
    s_add_u32 m0, s83, 69632
    s_nop 0
    buffer_load_dwordx4 v26, s[44:47], s82 offen lds
    v_exp_f32 v207, v207
    v_exp_f32 v224, v224
    v_exp_f32 v208, v208
    v_exp_f32 v225, v225
    v_exp_f32 v209, v209
    v_exp_f32 v226, v226
    v_exp_f32 v210, v210
    v_exp_f32 v227, v227
    v_exp_f32 v211, v211
    v_exp_f32 v228, v228
    v_exp_f32 v212, v212
    v_exp_f32 v229, v229
    v_exp_f32 v213, v213
    v_exp_f32 v230, v230
    s_xor_b32 s96, s95, 1179648
    s_add_u32 s82, s96, s90
    s_add_u32 m0, s83, 73728
    s_nop 0
    buffer_load_dwordx4 v26, s[44:47], s82 offen lds
    v_exp_f32 v214, v214
    v_exp_f32 v231, v231
    v_exp_f32 v215, v215
    v_add_f32 v8, v216, v218
    v_add_f32 v9, v217, v219
    v_add_f32 v10, v200, v202
    v_add_f32 v11, v201, v203
    v_add_f32 v8, v8, v220
    v_add_f32 v9, v9, v221
    v_add_f32 v10, v10, v204
    v_add_f32 v11, v11, v205
    v_add_f32 v8, v8, v222
    v_add_f32 v9, v9, v223
    v_add_f32 v10, v10, v206
    s_add_u32 s82, s80, 114688
    buffer_load_dwordx4 v[72:75], v27, s[52:55], s82 offen nt
    v_add_f32 v11, v11, v207
    v_add_f32 v8, v8, v224
    v_add_f32 v9, v9, v225
    v_add_f32 v10, v10, v208
    v_add_f32 v11, v11, v209
    v_add_f32 v8, v8, v226
    v_add_f32 v9, v9, v227
    v_add_f32 v10, v10, v210
    v_add_f32 v11, v11, v211
    v_add_f32 v8, v8, v228
    v_add_f32 v9, v9, v229
    v_add_f32 v10, v10, v212
    v_add_f32 v11, v11, v213
    v_add_f32 v8, v8, v230
    s_add_u32 s82, s80, 4294164480
    buffer_load_dwordx4 v[76:79], v27, s[52:55], s82 offen nt
    v_add_f32 v9, v9, v231
    v_add_f32 v10, v10, v214
    v_add_f32 v11, v11, v215
    v_add_f32 v6, v8, v9
    v_add_f32 v7, v10, v11
    v_add_f32 v4, v8, v9
    v_add_f32 v5, v10, v11
    s_nop 0
    v_permlane32_swap_b32 v4, v6
    v_permlane32_swap_b32 v5, v7
    v_add_f32 v4, v4, v6
    v_add_f32 v5, v5, v7
    v_rcp_f32 v4, v4
    v_rcp_f32 v5, v5
    v_mul_f32 v216, v216, v4
    s_add_u32 s82, s80, 172032
    buffer_load_dwordx4 v[80:83], v27, s[52:55], s82 offen nt
    v_mul_f32 v217, v217, v4
    v_mul_f32 v200, v200, v5
    v_mul_f32 v201, v201, v5
    v_mul_f32 v218, v218, v4
    v_mul_f32 v219, v219, v4
    v_mul_f32 v202, v202, v5
    v_mul_f32 v203, v203, v5
    v_mul_f32 v220, v220, v4
    v_mul_f32 v221, v221, v4
    v_mul_f32 v204, v204, v5
    v_mul_f32 v205, v205, v5
    v_mul_f32 v222, v222, v4
    v_mul_f32 v223, v223, v4
    v_mul_f32 v206, v206, v5
    s_add_u32 s82, s80, 4294221824
    buffer_load_dwordx4 v[84:87], v27, s[52:55], s82 offen nt
    v_mul_f32 v207, v207, v5
    v_mul_f32 v224, v224, v4
    v_mul_f32 v225, v225, v4
    v_mul_f32 v208, v208, v5
    v_mul_f32 v209, v209, v5
    v_mul_f32 v226, v226, v4
    v_mul_f32 v227, v227, v4
    v_mul_f32 v210, v210, v5
    v_mul_f32 v211, v211, v5
    v_mul_f32 v228, v228, v4
    v_mul_f32 v229, v229, v4
    v_mul_f32 v212, v212, v5
    v_mul_f32 v213, v213, v5
    v_mul_f32 v230, v230, v4
    s_xor_b32 s96, s95, 1310720
    s_add_u32 s97, s96, s90
    s_sub_u32 s82, s97, 65536
    s_add_u32 m0, s83, 77824
    s_nop 0
    buffer_load_dwordx4 v26, s[44:47], s82 offen lds
    v_mul_f32 v231, v231, v4
    v_mul_f32 v214, v214, v5
    v_mul_f32 v215, v215, v5
    v_cvt_pk_bf16_f32 v216, v216, v217
    v_cvt_pk_bf16_f32 v217, v218, v219
    v_cvt_pk_bf16_f32 v218, v220, v221
    v_cvt_pk_bf16_f32 v219, v222, v223
    v_cvt_pk_bf16_f32 v220, v224, v225
    v_cvt_pk_bf16_f32 v221, v226, v227
    v_cvt_pk_bf16_f32 v222, v228, v229
    v_cvt_pk_bf16_f32 v223, v230, v231
    ds_write_b128 v232, v[216:219] offset:16384
    v_cvt_pk_bf16_f32 v224, v200, v201
    v_cvt_pk_bf16_f32 v225, v202, v203
    s_xor_b32 s96, s95, 1310720
    s_add_u32 s82, s96, s90
    s_add_u32 m0, s83, 81920
    s_nop 0
    buffer_load_dwordx4 v26, s[44:47], s82 offen lds
    v_cvt_pk_bf16_f32 v226, v204, v205
    v_cvt_pk_bf16_f32 v227, v206, v207
    ds_write_b128 v232, v[220:223] offset:20480
    ds_write_b128 v232, v[224:227] offset:24576
    v_cvt_pk_bf16_f32 v228, v208, v209
    v_cvt_pk_bf16_f32 v229, v210, v211
    v_cvt_pk_bf16_f32 v230, v212, v213
    v_cvt_pk_bf16_f32 v231, v214, v215
    ds_write_b128 v232, v[228:231] offset:28672
    s_xor_b32 s96, s95, 1441792
    s_add_u32 s97, s96, s90
    s_sub_u32 s82, s97, 65536
    s_add_u32 m0, s83, 86016
    s_nop 0
    buffer_load_dwordx4 v26, s[44:47], s82 offen lds
    s_xor_b32 s96, s95, 1441792
    s_add_u32 s82, s96, s90
    s_add_u32 m0, s83, 90112
    s_nop 0
    buffer_load_dwordx4 v26, s[44:47], s82 offen lds
    s_lshl_b32 s96, s77, 11
    s_add_u32 s14, s96, 151552
    v_add_u32 v0, s14, v2
    s_setprio 0
L_JOIN:
    v_and_b32 v45, 1, v1
    v_lshlrev_b32 v45, 3, v45
    v_bfe_u32 v9, v1, 2, 2
    v_lshl_add_u32 v45, v9, 4, v45
    v_bfe_u32 v9, v1, 4, 1
    v_lshl_add_u32 v45, v9, 6, v45
    v_bfe_u32 v9, v1, 1, 1
    v_lshl_add_u32 v45, v9, 7, v45
    v_lshrrev_b32 v9, 5, v1
    v_lshl_add_u32 v45, v9, 8, v45
    s_lshl_b32 s13, s3, 12
    v_add_u32 v44, s13, v45
    s_lshl_b32 s96, s76, 13
    s_add_u32 s13, s96, 32768
    v_add_u32 v45, s13, v45
    v_mov_b32 v244, 0x3f803f80
    v_mov_b32 v245, 0x3f803f80
    v_mov_b32 v246, 0x3f803f80
    v_mov_b32 v247, 0x3f803f80
    s_lshl3_add_u32 s96, s11, s3
    s_lshl_b32 s97, s96, 5
    s_add_u32 s98, s97, s10
    s_lshl_b32 s99, s98, 10
    s_add_u32 s13, s99, 25165824
    s_add_u32 s15, s13, 16384
    s_lshl3_add_u32 s96, s11, s3
    s_lshl_b32 s97, s96, 10
    s_add_u32 s16, s97, 21495808
    s_lshl_b32 s96, s10, 6
    s_add_u32 s14, s96, s16
    s_waitcnt lgkmcnt(0)
    s_barrier
    ds_read_b64_tr_b16 v[184:185], v44
    ds_read_b64_tr_b16 v[186:187], v44 offset:512
    ds_read_b64_tr_b16 v[200:201], v45
    ds_read_b64_tr_b16 v[202:203], v45 offset:512
    ds_read_b64_tr_b16 v[204:205], v45 offset:1024
    ds_read_b64_tr_b16 v[206:207], v45 offset:1536
    ds_read_b64_tr_b16 v[188:189], v44 offset:1024
    ds_read_b64_tr_b16 v[190:191], v44 offset:1536
    ds_read_b64_tr_b16 v[208:209], v45 offset:2048
    ds_read_b64_tr_b16 v[210:211], v45 offset:2560
    ds_read_b64_tr_b16 v[212:213], v45 offset:3072
    ds_read_b64_tr_b16 v[214:215], v45 offset:3584
    ds_read_b64_tr_b16 v[192:193], v44 offset:2048
    ds_read_b64_tr_b16 v[194:195], v44 offset:2560
    ds_read_b64_tr_b16 v[216:217], v45 offset:4096
    ds_read_b64_tr_b16 v[218:219], v45 offset:4608
    ds_read_b64_tr_b16 v[220:221], v45 offset:5120
    ds_read_b64_tr_b16 v[222:223], v45 offset:5632
    s_waitcnt lgkmcnt(12)
    v_mfma_f32_16x16x32_bf16 v[232:235], v[184:187], v[200:203], 0
    v_mfma_f32_16x16x32_bf16 v[236:239], v[184:187], v[204:207], 0
    v_mfma_f32_16x16x32_bf16 v[240:243], v[184:187], v[244:247], 0
    ds_read_b64_tr_b16 v[196:197], v44 offset:3072
    ds_read_b64_tr_b16 v[198:199], v44 offset:3584
    ds_read_b64_tr_b16 v[224:225], v45 offset:6144
    ds_read_b64_tr_b16 v[226:227], v45 offset:6656
    ds_read_b64_tr_b16 v[228:229], v45 offset:7168
    ds_read_b64_tr_b16 v[230:231], v45 offset:7680
    s_waitcnt lgkmcnt(12)
    v_mfma_f32_16x16x32_bf16 v[232:235], v[188:191], v[208:211], v[232:235]
    v_mfma_f32_16x16x32_bf16 v[236:239], v[188:191], v[212:215], v[236:239]
    v_mfma_f32_16x16x32_bf16 v[240:243], v[188:191], v[244:247], v[240:243]
    s_waitcnt lgkmcnt(6)
    v_mfma_f32_16x16x32_bf16 v[232:235], v[192:195], v[216:219], v[232:235]
    v_mfma_f32_16x16x32_bf16 v[236:239], v[192:195], v[220:223], v[236:239]
    v_mfma_f32_16x16x32_bf16 v[240:243], v[192:195], v[244:247], v[240:243]
    s_waitcnt lgkmcnt(0)
    v_mfma_f32_16x16x32_bf16 v[232:235], v[196:199], v[224:227], v[232:235]
    v_mfma_f32_16x16x32_bf16 v[236:239], v[196:199], v[228:231], v[236:239]
    v_mfma_f32_16x16x32_bf16 v[240:243], v[196:199], v[244:247], v[240:243]
    s_cmp_lt_u32 s3, 4
    s_cbranch_scc1 L_NOQX
    ds_read_b128 v[168:171], v0
    ds_read_b128 v[172:175], v0 offset:1024
L_NOQX:
    s_nop 3
    buffer_store_dwordx4 v[232:235], v2, s[32:35], s13 offen sc1
    buffer_store_dwordx4 v[236:239], v2, s[32:35], s15 offen sc1
    s_mov_b32 exec_lo, 0x00010001
    s_mov_b32 exec_hi, 0x00010001
    buffer_store_dwordx4 v[240:243], v1, s[32:35], s14 offen sc1
    s_mov_b64 exec, -1
    s_waitcnt lgkmcnt(0)
    v_mfma_f32_32x32x16_bf16 v[120:135], v[176:179], v[168:171], 0
    v_mfma_f32_32x32x16_bf16 v[120:135], v[180:183], v[172:175], v[120:135]
    v_and_b32 v46, 7, v1
    v_lshlrev_b32 v46, 17, v46
    v_bfe_u32 v9, v1, 3, 1
    v_lshl_add_u32 v46, v9, 14, v46
    s_and_b32 s96, s10, 1
    s_and_b32 s97, s2, 27
    s_lshl_b32 s98, s97, 12
    s_lshr_b32 s99, s10, 1
    s_lshl_b32 s97, s99, 6
    s_add_u32 s99, s98, s97
    s_lshl2_add_u32 s98, s96, s99
    s_add_u32 s97, s98, 1048576
    s_add_u32 s17, s97, 512
    v_lshrrev_b32 v47, 3, v1
    v_lshlrev_b32 v47, 10, v47
    v_and_b32 v9, 7, v1
    v_lshl_add_u32 v47, v9, 4, v47
    v_and_b32 v48, 7, v1
    v_lshlrev_b32 v48, 4, v48
    v_lshrrev_b32 v9, 5, v1
    v_lshl_add_u32 v48, v9, 3, v48
    v_cvt_pk_bf16_f32 v120, 0, v120
    v_cvt_pk_bf16_f32 v121, 0, v121
    v_cvt_pk_bf16_f32 v122, 0, v122
    v_cvt_pk_bf16_f32 v123, 0, v123
    v_cvt_pk_bf16_f32 v124, 0, v124
    v_cvt_pk_bf16_f32 v125, 0, v125
    v_cvt_pk_bf16_f32 v126, 0, v126
    v_cvt_pk_bf16_f32 v127, 0, v127
    v_cvt_pk_bf16_f32 v128, 0, v128
    v_cvt_pk_bf16_f32 v129, 0, v129
    v_cvt_pk_bf16_f32 v130, 0, v130
    v_cvt_pk_bf16_f32 v131, 0, v131
    v_cvt_pk_bf16_f32 v132, 0, v132
    v_cvt_pk_bf16_f32 v133, 0, v133
    v_cvt_pk_bf16_f32 v134, 0, v134
    v_cvt_pk_bf16_f32 v135, 0, v135
    v_max3_f32 v4, v120, v121, v122
    v_min3_f32 v5, v120, v121, v122
    v_max3_f32 v4, v4, v123, v124
    v_min3_f32 v5, v5, v123, v124
    v_max3_f32 v4, v4, v125, v126
    v_min3_f32 v5, v5, v125, v126
    v_max3_f32 v4, v4, v127, v128
    v_min3_f32 v5, v5, v127, v128
    v_max3_f32 v4, v4, v129, v130
    v_min3_f32 v5, v5, v129, v130
    v_max3_f32 v4, v4, v131, v132
    v_min3_f32 v5, v5, v131, v132
    v_max3_f32 v4, v4, v133, v134
    v_min3_f32 v5, v5, v133, v134
    v_max_f32 v6, v4, v135
    v_min_f32 v7, v5, v135
    v_max_f32 v4, v4, v135
    v_min_f32 v5, v5, v135
    s_nop 0
    v_permlane32_swap_b32 v4, v6
    v_permlane32_swap_b32 v5, v7
    v_max_f32 v4, v4, v6
    v_min_f32 v5, v5, v7
    v_pk_mul_f32 v[4:5], v[4:5], s[6:7] op_sel:[0,1]
    v_pk_fma_f32 v[136:137], v[120:121], s[6:7], v[4:5] op_sel:[0,1,0] op_sel_hi:[1,1,0] neg_lo:[0,0,1] neg_hi:[0,0,1]
    v_pk_fma_f32 v[120:121], v[120:121], s[6:7], v[4:5] op_sel:[0,1,1] neg_lo:[1,0,0] neg_hi:[1,0,0]
    v_pk_fma_f32 v[138:139], v[122:123], s[6:7], v[4:5] op_sel:[0,1,0] op_sel_hi:[1,1,0] neg_lo:[0,0,1] neg_hi:[0,0,1]
    v_pk_fma_f32 v[122:123], v[122:123], s[6:7], v[4:5] op_sel:[0,1,1] neg_lo:[1,0,0] neg_hi:[1,0,0]
    v_pk_fma_f32 v[140:141], v[124:125], s[6:7], v[4:5] op_sel:[0,1,0] op_sel_hi:[1,1,0] neg_lo:[0,0,1] neg_hi:[0,0,1]
    v_pk_fma_f32 v[124:125], v[124:125], s[6:7], v[4:5] op_sel:[0,1,1] neg_lo:[1,0,0] neg_hi:[1,0,0]
    v_pk_fma_f32 v[142:143], v[126:127], s[6:7], v[4:5] op_sel:[0,1,0] op_sel_hi:[1,1,0] neg_lo:[0,0,1] neg_hi:[0,0,1]
    v_pk_fma_f32 v[126:127], v[126:127], s[6:7], v[4:5] op_sel:[0,1,1] neg_lo:[1,0,0] neg_hi:[1,0,0]
    v_pk_fma_f32 v[144:145], v[128:129], s[6:7], v[4:5] op_sel:[0,1,0] op_sel_hi:[1,1,0] neg_lo:[0,0,1] neg_hi:[0,0,1]
    v_pk_fma_f32 v[128:129], v[128:129], s[6:7], v[4:5] op_sel:[0,1,1] neg_lo:[1,0,0] neg_hi:[1,0,0]
    v_pk_fma_f32 v[146:147], v[130:131], s[6:7], v[4:5] op_sel:[0,1,0] op_sel_hi:[1,1,0] neg_lo:[0,0,1] neg_hi:[0,0,1]
    v_pk_fma_f32 v[130:131], v[130:131], s[6:7], v[4:5] op_sel:[0,1,1] neg_lo:[1,0,0] neg_hi:[1,0,0]
    v_pk_fma_f32 v[148:149], v[132:133], s[6:7], v[4:5] op_sel:[0,1,0] op_sel_hi:[1,1,0] neg_lo:[0,0,1] neg_hi:[0,0,1]
    v_pk_fma_f32 v[132:133], v[132:133], s[6:7], v[4:5] op_sel:[0,1,1] neg_lo:[1,0,0] neg_hi:[1,0,0]
    v_pk_fma_f32 v[150:151], v[134:135], s[6:7], v[4:5] op_sel:[0,1,0] op_sel_hi:[1,1,0] neg_lo:[0,0,1] neg_hi:[0,0,1]
    v_pk_fma_f32 v[134:135], v[134:135], s[6:7], v[4:5] op_sel:[0,1,1] neg_lo:[1,0,0] neg_hi:[1,0,0]
    v_exp_f32 v136, v136
    v_exp_f32 v120, v120
    v_exp_f32 v137, v137
    v_exp_f32 v121, v121
    v_exp_f32 v138, v138
    v_exp_f32 v122, v122
    v_exp_f32 v139, v139
    v_exp_f32 v123, v123
    v_exp_f32 v140, v140
    v_exp_f32 v124, v124
    v_exp_f32 v141, v141
    v_exp_f32 v125, v125
    v_exp_f32 v142, v142
    v_exp_f32 v126, v126
    v_exp_f32 v143, v143
    v_exp_f32 v127, v127
    s_waitcnt vmcnt(0)
    s_barrier
    s_cmp_lg_u32 s3, 0
    s_cbranch_scc1 L_PC
    v_mov_b32 v45, s4
    s_mov_b32 exec_hi, 0
    s_mov_b32 exec_lo, 65535
    buffer_store_dword v45, v46, s[32:35], s17 offen sc1
    s_mov_b64 exec, -1
L_PC:
    s_xor_b32 s96, s95, 1572864
    s_add_u32 s82, s96, s90
    s_add_u32 m0, s83, 98304
    s_nop 0
    buffer_load_dwordx4 v26, s[44:47], s82 offen lds
    v_exp_f32 v144, v144
    v_exp_f32 v128, v128
    v_exp_f32 v145, v145
    v_exp_f32 v129, v129
    v_exp_f32 v146, v146
    v_exp_f32 v130, v130
    v_exp_f32 v147, v147
    v_exp_f32 v131, v131
    s_xor_b32 s96, s95, 1703936
    s_add_u32 s82, s96, s90
    s_add_u32 m0, s83, 106496
    s_nop 0
    buffer_load_dwordx4 v26, s[44:47], s82 offen lds
    v_exp_f32 v148, v148
    v_exp_f32 v132, v132
    v_exp_f32 v149, v149
    v_exp_f32 v133, v133
    v_exp_f32 v150, v150
    v_exp_f32 v134, v134
    v_exp_f32 v151, v151
    v_exp_f32 v135, v135
    s_lshl4_add_u32 s96, s11, s10
    s_lshl_b32 s97, s96, 14
    s_lshl_b32 s98, s3, 7
    s_add_u32 s99, s97, s98
    s_add_u32 s13, s99, 25165824
    s_add_u32 s14, s13, 8192
    s_lshl4_add_u32 s96, s11, s10
    s_lshl_b32 s97, s96, 10
    s_lshl_b32 s98, s3, 7
    s_add_u32 s99, s97, s98
    s_add_u32 s15, s99, 29360128
    s_add_u32 s17, s17, 3072
    s_load_dwordx2 s[24:25], s[32:33], s92 offset:512 glc
    s_xor_b32 s96, s95, 1835008
    s_add_u32 s82, s96, s90
    s_add_u32 m0, s83, 114688
    s_nop 0
    buffer_load_dwordx4 v26, s[44:47], s82 offen lds
    v_pk_add_f32 v[8:9], v[136:137], v[138:139]
    v_pk_add_f32 v[10:11], v[120:121], v[122:123]
    v_pk_add_f32 v[8:9], v[8:9], v[140:141]
    v_pk_add_f32 v[10:11], v[10:11], v[124:125]
    v_pk_add_f32 v[8:9], v[8:9], v[142:143]
    v_pk_add_f32 v[10:11], v[10:11], v[126:127]
    v_pk_add_f32 v[8:9], v[8:9], v[144:145]
    v_pk_add_f32 v[10:11], v[10:11], v[128:129]
    v_pk_add_f32 v[8:9], v[8:9], v[146:147]
    v_pk_add_f32 v[10:11], v[10:11], v[130:131]
    v_pk_add_f32 v[8:9], v[8:9], v[148:149]
    v_pk_add_f32 v[10:11], v[10:11], v[132:133]
    v_pk_add_f32 v[8:9], v[8:9], v[150:151]
    v_pk_add_f32 v[10:11], v[10:11], v[134:135]
    s_xor_b32 s96, s95, 1966080
    s_add_u32 s82, s96, s90
    s_add_u32 m0, s83, 122880
    s_nop 0
    buffer_load_dwordx4 v26, s[44:47], s82 offen lds
    v_add_f32 v6, v8, v9
    v_add_f32 v7, v10, v11
    v_add_f32 v4, v8, v9
    v_add_f32 v5, v10, v11
    s_nop 0
    v_permlane32_swap_b32 v4, v6
    v_permlane32_swap_b32 v5, v7
    v_pk_add_f32 v[4:5], v[4:5], v[6:7]
    v_rcp_f32 v4, v4
    v_rcp_f32 v5, v5
    s_nop 0
    v_pk_mul_f32 v[136:137], v[136:137], v[4:5] op_sel_hi:[1,0]
    v_pk_mul_f32 v[120:121], v[120:121], v[4:5] op_sel:[0,1]
    v_pk_mul_f32 v[138:139], v[138:139], v[4:5] op_sel_hi:[1,0]
    v_pk_mul_f32 v[122:123], v[122:123], v[4:5] op_sel:[0,1]
    v_pk_mul_f32 v[140:141], v[140:141], v[4:5] op_sel_hi:[1,0]
    s_add_u32 s82, s95, s90
    s_mov_b32 m0, s83
    s_nop 0
    buffer_load_dwordx4 v26, s[44:47], s82 offen lds
    v_pk_mul_f32 v[124:125], v[124:125], v[4:5] op_sel:[0,1]
    v_pk_mul_f32 v[142:143], v[142:143], v[4:5] op_sel_hi:[1,0]
    v_pk_mul_f32 v[126:127], v[126:127], v[4:5] op_sel:[0,1]
    v_pk_mul_f32 v[144:145], v[144:145], v[4:5] op_sel_hi:[1,0]
    v_pk_mul_f32 v[128:129], v[128:129], v[4:5] op_sel:[0,1]
    v_pk_mul_f32 v[146:147], v[146:147], v[4:5] op_sel_hi:[1,0]
    v_pk_mul_f32 v[130:131], v[130:131], v[4:5] op_sel:[0,1]
    v_pk_mul_f32 v[148:149], v[148:149], v[4:5] op_sel_hi:[1,0]
    v_pk_mul_f32 v[132:133], v[132:133], v[4:5] op_sel:[0,1]
    v_pk_mul_f32 v[150:151], v[150:151], v[4:5] op_sel_hi:[1,0]
    v_pk_mul_f32 v[134:135], v[134:135], v[4:5] op_sel:[0,1]
    v_cvt_pk_bf16_f32 v152, v136, v137
    v_cvt_pk_bf16_f32 v153, v138, v139
    v_cvt_pk_bf16_f32 v154, v140, v141
    s_xor_b32 s96, s95, 131072
    s_add_u32 s82, s96, s90
    s_add_u32 m0, s83, 8192
    s_nop 0
    buffer_load_dwordx4 v26, s[44:47], s82 offen lds
    v_cvt_pk_bf16_f32 v155, v142, v143
    v_cvt_pk_bf16_f32 v156, v144, v145
    v_cvt_pk_bf16_f32 v157, v146, v147
    v_cvt_pk_bf16_f32 v158, v148, v149
    v_cvt_pk_bf16_f32 v159, v150, v151
    v_cvt_pk_bf16_f32 v160, v120, v121
    v_cvt_pk_bf16_f32 v161, v122, v123
    v_cvt_pk_bf16_f32 v162, v124, v125
    v_cvt_pk_bf16_f32 v163, v126, v127
    v_cvt_pk_bf16_f32 v164, v128, v129
    v_cvt_pk_bf16_f32 v165, v130, v131
    v_cvt_pk_bf16_f32 v166, v132, v133
    v_cvt_pk_bf16_f32 v167, v134, v135
    s_branch SCHK_19
SPOLL_18:
    s_load_dwordx2 s[24:25], s[32:33], s92 offset:512 glc
SCHK_19:
    s_add_u32 s5, s5, 1
    s_cmp_ge_u32 s5, 200000
    s_waitcnt lgkmcnt(0)
    s_cbranch_scc1 SDONE_20
    s_cmp_lg_u32 s24, s4
    s_cbranch_scc1 SPOLL_18
    s_cmp_lg_u32 s25, s4
    s_cbranch_scc1 SPOLL_18
SDONE_20:
    s_barrier
    buffer_load_dwordx4 v[184:187], v47, s[32:35], s13 offen sc1
    buffer_load_dwordx4 v[188:191], v47, s[32:35], s14 offen sc1
    buffer_load_dwordx4 v[192:195], v2, s[32:35], s16 offen sc1
    s_lshl_b32 s96, s3, 5
    s_add_u32 s14, s96, 155648
    v_and_b32 v6, 3, v1
    v_lshl_add_u32 v6, v6, 3, s14
    v_lshrrev_b32 v9, 5, v1
    v_lshl_add_u32 v6, v9, 2, v6
    s_lshl_b32 s96, s3, 10
    s_add_u32 s14, s96, 147456
    v_and_b32 v5, 15, v1
    v_lshl_add_u32 v5, v5, 4, s14
    v_lshrrev_b32 v9, 5, v1
    v_lshl_add_u32 v5, v9, 9, v5
    v_bfe_u32 v9, v1, 4, 1
    v_lshl_add_u32 v5, v9, 3, v5
    s_lshl_b32 s96, s76, 7
    s_add_u32 s14, s96, 155648
    v_lshrrev_b32 v7, 5, v1
    v_lshl_add_u32 v7, v7, 4, s14
    s_lshl_b32 s96, s76, 12
    s_add_u32 s14, s96, 147456
    v_add_u32 v44, s14, v2
    s_waitcnt vmcnt(1)
    v_pk_add_f32 v[184:185], v[184:185], v[188:189]
    v_pk_add_f32 v[186:187], v[186:187], v[190:191]
    s_nop 1
    v_permlane32_swap_b32 v184, v186
    v_permlane32_swap_b32 v185, v187
    v_pk_add_f32 v[184:185], v[184:185], v[186:187]
    s_nop 1
    v_add_f32_dpp v184, v184, v184 row_ror:8 row_mask:0xf bank_mask:0xf
    v_add_f32_dpp v185, v185, v185 row_ror:8 row_mask:0xf bank_mask:0xf
    v_mov_b32 v186, v184
    v_mov_b32 v187, v185
    s_nop 0
    v_permlane16_swap_b32 v184, v186
    v_permlane16_swap_b32 v185, v187
    v_pk_add_f32 v[184:185], v[184:185], v[186:187]
    v_cvt_pk_bf16_f32 v184, v184, v185
    v_mov_b32 v185, s4
    s_mov_b32 exec_lo, 0xff
    s_mov_b32 exec_hi, 0xff
    buffer_store_dwordx2 v[184:185], v48, s[32:35], s15 offen sc1
    s_mov_b64 exec, -1
    s_barrier
    s_cmp_lg_u32 s3, 0
    s_cbranch_scc1 L_PC2
    v_mov_b32 v45, s4
    s_mov_b32 exec_hi, 0
    s_mov_b32 exec_lo, 65535
    buffer_store_dword v45, v46, s[32:35], s17 offen sc1
    s_mov_b64 exec, -1
L_PC2:
    s_waitcnt vmcnt(1)
    s_xor_b32 s96, s95, 262144
    s_add_u32 s82, s96, s90
    s_add_u32 m0, s83, 16384
    s_nop 0
    buffer_load_dwordx4 v26, s[44:47], s82 offen lds
    v_permlane32_swap_b32 v192, v194
    v_permlane32_swap_b32 v193, v195
    v_pk_add_f32 v[192:193], v[192:193], v[194:195]
    s_nop 1
    v_add_f32_dpp v192, v192, v192 row_ror:4 row_mask:0xf bank_mask:0xf
    s_xor_b32 s96, s95, 393216
    s_add_u32 s82, s96, s90
    s_add_u32 m0, s83, 24576
    s_nop 0
    buffer_load_dwordx4 v26, s[44:47], s82 offen lds
    v_add_f32_dpp v193, v193, v193 row_ror:4 row_mask:0xf bank_mask:0xf
    v_add_f32_dpp v192, v192, v192 row_ror:8 row_mask:0xf bank_mask:0xf
    s_nop 0
    v_add_f32_dpp v193, v193, v193 row_ror:8 row_mask:0xf bank_mask:0xf
L_PAD7:
    s_cbranch_execz L_RET7
    s_xor_b32 s96, s95, 524288
    s_add_u32 s82, s96, s90
    s_add_u32 m0, s83, 32768
    s_nop 0
    buffer_load_dwordx4 v26, s[44:47], s82 offen lds
    v_mov_b32 v194, v192
    v_mov_b32 v195, v193
    s_nop 0
    v_permlane16_swap_b32 v192, v194
    s_xor_b32 s96, s95, 655360
    s_add_u32 s82, s96, s90
    s_add_u32 m0, s83, 40960
    s_nop 0
    buffer_load_dwordx4 v26, s[44:47], s82 offen lds
    v_permlane16_swap_b32 v193, v195
    v_pk_add_f32 v[192:193], v[192:193], v[194:195]
    v_cvt_pk_bf16_f32 v192, v192, v193
    ds_write_b32 v6, v192
    s_waitcnt lgkmcnt(0)
    s_barrier
    ds_read_b128 v[196:199], v7
    ds_read_b128 v[200:203], v7 offset:32
    ds_read_b128 v[204:207], v7 offset:64
    ds_read_b128 v[208:211], v7 offset:96
    s_lshr_b32 s96, s8, 2
    s_lshl1_add_u32 s97, s9, s96
    s_and_b32 s98, s8, 3
    s_lshl2_add_u32 s99, s97, s98
    s_lshl_b32 s96, s99, 9
    s_add_u32 s18, s96, 131072
    s_waitcnt lgkmcnt(0)
    s_lshl3_add_u32 s96, s11, s3
    s_lshl_b32 s97, s96, 11
    s_add_u32 s13, s97, 29360128
    s_load_dwordx2 s[24:25], s[32:33], s92 offset:3584 glc
    v_mfma_f32_32x32x16_bf16 v[136:151], v[196:199], v[152:155], 0
    v_mfma_f32_32x32x16_bf16 v[136:151], v[200:203], v[156:159], v[136:151]
    v_mfma_f32_32x32x16_bf16 v[136:151], v[204:207], v[160:163], v[136:151]
    v_mfma_f32_32x32x16_bf16 v[136:151], v[208:211], v[164:167], v[136:151]
    s_nop 11
    v_cvt_pk_bf16_f32 v136, 0, v136
    v_add_f32 v136, 0x358637bd, v136
    v_cvt_pk_bf16_f32 v136, 0, v136
    v_rcp_f32 v136, v136
    s_branch SCHK_22
SPOLL_21:
    s_load_dwordx2 s[24:25], s[32:33], s92 offset:3584 glc
SCHK_22:
    s_add_u32 s5, s5, 1
    s_cmp_ge_u32 s5, 200000
    s_waitcnt lgkmcnt(0)
    s_cbranch_scc1 SDONE_23
    s_cmp_lg_u32 s24, s4
    s_cbranch_scc1 SPOLL_21
    s_cmp_lg_u32 s25, s4
    s_cbranch_scc1 SPOLL_21
SDONE_23:
    buffer_load_dwordx4 v[228:231], v2, s[32:35], s13 offen sc1
    buffer_load_dwordx4 v[232:235], v2, s[32:35], s13 offen offset:1024 sc1
    s_waitcnt vmcnt(0)
    v_bitop3_b32 v4, v229, v231, s4 bitop3:0x7e
    v_bitop3_b32 v4, v4, v233, s4 bitop3:0xf6
    v_bitop3_b32 v4, v4, v235, s4 bitop3:0xf6
    v_cmp_ne_u32 vcc, 0, v4
    s_cbranch_vccz TOK_25
POLL_26:
    buffer_load_dwordx4 v[228:231], v2, s[32:35], s13 offen sc1
    buffer_load_dwordx4 v[232:235], v2, s[32:35], s13 offen offset:1024 sc1
    s_waitcnt vmcnt(0)
    v_bitop3_b32 v4, v229, v231, s4 bitop3:0x7e
    v_bitop3_b32 v4, v4, v233, s4 bitop3:0xf6
    v_bitop3_b32 v4, v4, v235, s4 bitop3:0xf6
    v_cmp_ne_u32 vcc, 0, v4
    s_cbranch_vccz PDONE_27
    s_add_u32 s5, s5, 1
    s_cmp_lt_u32 s5, 200000
    s_cbranch_scc1 POLL_26
PDONE_27:
TOK_25:
    ds_write2_b32 v5, v228, v230 offset0:0 offset1:1
    ds_write2_b32 v5, v232, v234 offset0:64 offset1:65
    s_waitcnt lgkmcnt(0)
    s_barrier
    ds_read_b128 v[212:215], v44
    ds_read_b128 v[216:219], v44 offset:1024
    ds_read_b128 v[220:223], v44 offset:2048
    ds_read_b128 v[224:227], v44 offset:3072
    s_lshl_b32 s96, s77, 1
    s_lshl3_add_u32 s97, s10, s96
    s_lshl_b32 s98, s97, 5
    s_lshl1_add_u32 s99, s11, s98
    s_add_u32 s96, s99, s76
    s_lshl_b32 s97, s96, 10
    s_add_u32 s13, s97, 8388608
    v_and_b32 v47, 15, v1
    v_lshlrev_b32 v47, 4, v47
    v_bfe_u32 v9, v1, 4, 1
    v_lshl_add_u32 v47, v9, 15, v47
    v_lshrrev_b32 v9, 5, v1
    v_lshl_add_u32 v47, v9, 8, v47
    s_waitcnt lgkmcnt(3)
    v_mfma_f32_32x32x16_bf16 v[120:135], v[212:215], v[152:155], 0
    s_waitcnt lgkmcnt(2)
    v_mfma_f32_32x32x16_bf16 v[120:135], v[216:219], v[156:159], v[120:135]
    s_waitcnt lgkmcnt(1)
    v_mfma_f32_32x32x16_bf16 v[120:135], v[220:223], v[160:163], v[120:135]
    s_waitcnt lgkmcnt(0)
    v_mfma_f32_32x32x16_bf16 v[120:135], v[224:227], v[164:167], v[120:135]
    s_lshr_b32 s96, s3, 1
    s_lshl4_add_u32 s97, s96, s12
    s_lshl_b32 s98, s97, 11
    s_and_b32 s99, s3, 1
    s_lshl_b32 s96, s99, 10
    s_add_u32 s97, s98, s96
    s_add_u32 s18, s97, 131072
    s_lshl_b32 s19, s12, 7
    v_and_b32 v44, 3, v1
    v_lshl_add_u32 v44, v44, 1, s19
    v_lshrrev_b32 v9, 5, v1
    v_lshl_add_u32 v44, v9, 3, v44
    v_bfe_u32 v9, v1, 4, 1
    v_lshl_add_u32 v44, v9, 4, v44
    v_bfe_u32 v9, v1, 2, 2
    v_lshl_add_u32 v44, v9, 5, v44
    global_load_ushort v32, v44, s[78:79]
    buffer_load_dwordx4 v[28:31], v2, s[32:35], s18 offen sc1
    v_cvt_pk_bf16_f32 v120, 0, v120
    v_cvt_pk_bf16_f32 v121, 0, v121
    v_cvt_pk_bf16_f32 v122, 0, v122
    v_cvt_pk_bf16_f32 v123, 0, v123
    v_cvt_pk_bf16_f32 v124, 0, v124
    v_cvt_pk_bf16_f32 v125, 0, v125
    v_cvt_pk_bf16_f32 v126, 0, v126
    v_cvt_pk_bf16_f32 v127, 0, v127
    v_pk_mul_f32 v[120:121], v[120:121], v[136:137] op_sel_hi:[1,0]
    v_pk_mul_f32 v[122:123], v[122:123], v[136:137] op_sel_hi:[1,0]
    v_pk_mul_f32 v[124:125], v[124:125], v[136:137] op_sel_hi:[1,0]
    v_pk_mul_f32 v[126:127], v[126:127], v[136:137] op_sel_hi:[1,0]
    v_cvt_pk_bf16_f32 v168, v120, v121
    v_cvt_pk_bf16_f32 v169, v122, v123
    v_cvt_pk_bf16_f32 v170, v124, v125
    v_cvt_pk_bf16_f32 v171, v126, v127
    buffer_store_dwordx4 v[168:171], v47, s[32:35], s13 offen sc1
    v_cvt_pk_bf16_f32 v128, 0, v128
    v_cvt_pk_bf16_f32 v129, 0, v129
    v_cvt_pk_bf16_f32 v130, 0, v130
    v_cvt_pk_bf16_f32 v131, 0, v131
    v_cvt_pk_bf16_f32 v132, 0, v132
    v_cvt_pk_bf16_f32 v133, 0, v133
    v_cvt_pk_bf16_f32 v134, 0, v134
    v_cvt_pk_bf16_f32 v135, 0, v135
    v_pk_mul_f32 v[128:129], v[128:129], v[136:137] op_sel_hi:[1,0]
    v_pk_mul_f32 v[130:131], v[130:131], v[136:137] op_sel_hi:[1,0]
    v_pk_mul_f32 v[132:133], v[132:133], v[136:137] op_sel_hi:[1,0]
    v_pk_mul_f32 v[134:135], v[134:135], v[136:137] op_sel_hi:[1,0]
    v_cvt_pk_bf16_f32 v172, v128, v129
    v_cvt_pk_bf16_f32 v173, v130, v131
    v_cvt_pk_bf16_f32 v174, v132, v133
    v_cvt_pk_bf16_f32 v175, v134, v135
    buffer_store_dwordx4 v[172:175], v47, s[32:35], s13 offen offset:512 sc1
    v_bfe_u32 v36, v1, 2, 2
    v_lshlrev_b32 v36, 7, v36
    v_lshrrev_b32 v9, 4, v1
    v_lshl_add_u32 v36, v9, 10, v36
    v_and_b32 v9, 1, v1
    v_lshl_add_u32 v36, v9, 4, v36
    v_bfe_u32 v9, v1, 1, 1
    v_lshl_add_u32 v36, v9, 3, v36
    v_bfe_u32 v9, v1, 3, 2
    v_lshl_add_u32 v36, v9, 5, v36
    s_and_b32 s96, s9, 1
    s_lshl_b32 s97, s96, 2
    s_xor_b32 s98, s3, s97
    s_lshl_b32 s17, s98, 12
    s_lshl_b32 s96, s17, 2
    s_lshr_b32 s97, s95, 4
    s_xor_b32 s14, s96, s97
    v_add_u32 v36, s14, v36
    v_xor_b32 v37, 32, v36
    v_xor_b32 v38, 64, v36
    v_xor_b32 v39, 96, v36
    v_and_b32 v5, 7, v1
    v_lshlrev_b32 v5, 15, v5
    v_bfe_u32 v9, v1, 3, 1
    v_lshl_add_u32 v5, v9, 12, v5
    s_and_b32 s96, s11, 1
    s_lshr_b32 s97, s10, 2
    s_and_b32 s98, s10, 3
    s_lshl_b32 s99, s98, 6
    s_lshl1_add_u32 s98, s97, s99
    s_lshl_b32 s97, s98, 12
    s_lshr_b32 s99, s11, 1
    s_lshl_b32 s98, s99, 6
    s_add_u32 s99, s97, s98
    s_lshl2_add_u32 s97, s96, s99
    s_add_u32 s98, s97, 1048576
    s_add_u32 s15, s98, 1024
    v_lshlrev_b32 v152, 16, v12
    v_and_b32 v153, s6, v12
    v_lshlrev_b32 v154, 16, v13
    v_and_b32 v155, s6, v13
    v_lshlrev_b32 v156, 16, v14
    v_and_b32 v157, s6, v14
    v_lshlrev_b32 v158, 16, v15
    v_and_b32 v159, s6, v15
    v_lshlrev_b32 v160, 16, v16
    v_and_b32 v161, s6, v16
    v_lshlrev_b32 v162, 16, v17
    v_and_b32 v163, s6, v17
    v_lshlrev_b32 v164, 16, v18
    v_and_b32 v165, s6, v18
    v_lshlrev_b32 v166, 16, v19
    v_and_b32 v167, s6, v19
    s_lshl3_add_u32 s96, s21, s3
    s_lshl_b32 s97, s96, 15
    s_add_u32 s19, s97, 8388608
    s_waitcnt vmcnt(2)
    v_bitop3_b32 v4, v29, v31, s4 bitop3:0x7e
    v_cmp_ne_u32 vcc, 0, v4
    s_cbranch_vccz L_MGOK
POLL_28:
    buffer_load_dwordx4 v[28:31], v2, s[32:35], s18 offen sc1
    s_waitcnt vmcnt(0)
    v_bitop3_b32 v4, v29, v31, s4 bitop3:0x7e
    v_cmp_ne_u32 vcc, 0, v4
    s_cbranch_vccz PDONE_29
    s_add_u32 s5, s5, 1
    s_cmp_lt_u32 s5, 200000
    s_cbranch_scc1 POLL_28
PDONE_29:
L_MGOK:
    s_and_b32 s96, s3, 1
    s_lshr_b32 s97, s3, 1
    s_lshl_b32 s98, s97, 10
    s_lshl3_add_u32 s99, s96, s98
    s_add_u32 s14, s99, 159744
    v_and_b32 v4, 31, v1
    v_lshl_add_u32 v4, v4, 5, s14
    v_lshrrev_b32 v9, 5, v1
    v_lshl_add_u32 v4, v9, 2, v4
    ds_write2_b32 v4, v28, v30 offset0:0 offset1:4
    v_and_b32 v7, 3, v1
    v_lshlrev_b32 v7, 4, v7
    v_lshrrev_b32 v9, 5, v1
    v_lshl_add_u32 v7, v9, 6, v7
    v_bfe_u32 v9, v1, 4, 1
    v_lshl_add_u32 v7, v9, 7, v7
    v_bfe_u32 v9, v1, 2, 2
    v_lshl_add_u32 v7, v9, 8, v7
    v_add_u32 v7, 159744, v7
    s_lshl_b32 s96, s2, 12
    s_lshr_b32 s97, s17, 6
    s_add_u32 s98, s96, s97
    s_add_u32 s99, s98, 1048576
    s_add_u32 s18, s99, 1024
    s_waitcnt vmcnt(0)
    s_waitcnt lgkmcnt(0)
    s_barrier
    s_cmp_lg_u32 s3, 0
    s_cbranch_scc1 L_PD
    v_mov_b32 v6, s4
    s_mov_b32 exec_hi, 0
    s_mov_b32 exec_lo, 65535
    buffer_store_dword v6, v5, s[32:35], s15 offen sc1
    s_mov_b64 exec, -1
L_PD:
    ds_read_b128 v[192:195], v7
    ds_read_b128 v[196:199], v7 offset:1024
    ds_read_b128 v[200:203], v7 offset:2048
    ds_read_b128 v[204:207], v7 offset:3072
    v_and_b32 v8, 3, v1
    v_lshlrev_b32 v8, 2, v8
    v_lshrrev_b32 v9, 5, v1
    v_lshl_add_u32 v8, v9, 4, v8
    v_bfe_u32 v9, v1, 4, 1
    v_lshl_add_u32 v8, v9, 5, v8
    v_bfe_u32 v9, v1, 2, 2
    v_lshl_add_u32 v8, v9, 6, v8
    v_add_u32 v8, 157184, v8
    s_lshl4_add_u32 s96, s21, s12
    s_lshl_b32 s97, s96, 6
    s_add_u32 s13, s97, 14155776
    s_waitcnt lgkmcnt(0)
    s_load_dwordx2 s[24:25], s[32:33], s18 offset:0 glc
    v_pk_add_f32 v[192:193], v[192:193], v[194:195]
    v_add_f32 v28, v192, v193
    v_pk_add_f32 v[196:197], v[196:197], v[198:199]
    v_add_f32 v29, v196, v197
    v_pk_add_f32 v[200:201], v[200:201], v[202:203]
    v_add_f32 v30, v200, v201
    v_pk_add_f32 v[204:205], v[204:205], v[206:207]
    v_add_f32 v31, v204, v205
    v_cvt_pk_bf16_f32 v28, 0, v28
    v_cvt_pk_bf16_f32 v29, 0, v29
    v_cvt_pk_bf16_f32 v30, 0, v30
    v_cvt_pk_bf16_f32 v31, 0, v31
    v_add_f32 v30, 1.0, v30
    v_lshlrev_b32 v32, 16, v32
    v_cvt_pk_bf16_f32 v30, 0, v30
    ds_write_b32 v8, v31
    v_mul_f32 v192, v30, v32
    v_cvt_pk_bf16_f32 v193, 0, v192
    v_sub_f32 v194, v192, v193
    v_add_f32_dpp v192, v192, v192 quad_perm:[1,0,3,2] row_mask:0xf bank_mask:0xf
    s_nop 1
    v_add_f32_dpp v192, v192, v192 quad_perm:[2,3,0,1] row_mask:0xf bank_mask:0xf
    s_nop 1
    v_add_f32_dpp v192, v192, v192 row_half_mirror row_mask:0xf bank_mask:0xf
    s_nop 1
    v_add_f32_dpp v192, v192, v192 row_ror:8 row_mask:0xf bank_mask:0xf
    v_mov_b32 v199, v192
    s_nop 1
    v_permlane16_swap_b32 v192, v199
    v_add_f32 v192, v192, v199
    v_mov_b32 v199, v192
    s_nop 1
    v_permlane32_swap_b32 v192, v199
    v_add_f32 v192, v192, v199
    v_mov_b32_dpp v196, v193 row_shl:1 row_mask:0xf bank_mask:0xf
    v_mov_b32_dpp v197, v194 row_shl:1 row_mask:0xf bank_mask:0xf
    v_mov_b32_dpp v198, v32 row_shl:1 row_mask:0xf bank_mask:0xf
    v_cvt_pk_bf16_f32 v196, v193, v196
    v_cvt_pk_bf16_f32 v197, v194, v197
    v_cvt_pk_bf16_f32 v198, v32, v198
    v_mov_b32 v193, s4
    v_mov_b32 v194, 0
    s_cmp_lg_u32 s3, 2
    s_cbranch_scc1 L_NOUP
    s_mov_b64 exec, 1
    buffer_store_dwordx2 v[192:193], v194, s[32:35], s13 offen sc1
    s_mov_b64 exec, -1
L_NOUP:
    v_mov_b32 v184, 0x3f803f80
    s_nop 1
    v_mov_b32_dpp v184, v196 row_newbcast:0 row_mask:0xf bank_mask:0x2
    s_nop 1
    v_mov_b32_dpp v184, v197 row_newbcast:0 row_mask:0xf bank_mask:0x4
    s_nop 1
    v_mov_b32_dpp v184, v198 row_newbcast:0 row_mask:0xf bank_mask:0x8
    v_mov_b32 v185, 0x3f803f80
    s_nop 1
    v_mov_b32_dpp v185, v196 row_newbcast:2 row_mask:0xf bank_mask:0x2
    s_nop 1
    v_mov_b32_dpp v185, v197 row_newbcast:2 row_mask:0xf bank_mask:0x4
    s_nop 1
    v_mov_b32_dpp v185, v198 row_newbcast:2 row_mask:0xf bank_mask:0x8
    v_mov_b32 v186, 0x3f803f80
    s_nop 1
    v_mov_b32_dpp v186, v196 row_newbcast:4 row_mask:0xf bank_mask:0x2
    s_nop 1
    v_mov_b32_dpp v186, v197 row_newbcast:4 row_mask:0xf bank_mask:0x4
    s_nop 1
    v_mov_b32_dpp v186, v198 row_newbcast:4 row_mask:0xf bank_mask:0x8
    v_mov_b32 v187, 0x3f803f80
    s_nop 1
    v_mov_b32_dpp v187, v196 row_newbcast:6 row_mask:0xf bank_mask:0x2
    s_nop 1
    v_mov_b32_dpp v187, v197 row_newbcast:6 row_mask:0xf bank_mask:0x4
    s_nop 1
    v_mov_b32_dpp v187, v198 row_newbcast:6 row_mask:0xf bank_mask:0x8
    v_mov_b32 v188, 0x3f803f80
    s_nop 1
    v_mov_b32_dpp v188, v196 row_newbcast:8 row_mask:0xf bank_mask:0x2
    s_nop 1
    v_mov_b32_dpp v188, v197 row_newbcast:8 row_mask:0xf bank_mask:0x4
    s_nop 1
    v_mov_b32_dpp v188, v198 row_newbcast:8 row_mask:0xf bank_mask:0x8
    v_mov_b32 v189, 0x3f803f80
    s_nop 1
    v_mov_b32_dpp v189, v196 row_newbcast:10 row_mask:0xf bank_mask:0x2
    s_nop 1
    v_mov_b32_dpp v189, v197 row_newbcast:10 row_mask:0xf bank_mask:0x4
    s_nop 1
    v_mov_b32_dpp v189, v198 row_newbcast:10 row_mask:0xf bank_mask:0x8
    v_mov_b32 v190, 0x3f803f80
    s_nop 1
    v_mov_b32_dpp v190, v196 row_newbcast:12 row_mask:0xf bank_mask:0x2
    s_nop 1
    v_mov_b32_dpp v190, v197 row_newbcast:12 row_mask:0xf bank_mask:0x4
    s_nop 1
    v_mov_b32_dpp v190, v198 row_newbcast:12 row_mask:0xf bank_mask:0x8
    v_mov_b32 v191, 0x3f803f80
    s_nop 1
    v_mov_b32_dpp v191, v196 row_newbcast:14 row_mask:0xf bank_mask:0x2
    s_nop 1
    v_mov_b32_dpp v191, v197 row_newbcast:14 row_mask:0xf bank_mask:0x4
    s_nop 1
    v_mov_b32_dpp v191, v198 row_newbcast:14 row_mask:0xf bank_mask:0x8
    v_mov_b32_dpp v136, v28 row_newbcast:0 row_mask:0xf bank_mask:0xf
    v_mov_b32_dpp v137, v28 row_newbcast:1 row_mask:0xf bank_mask:0xf
    v_mov_b32_dpp v138, v28 row_newbcast:2 row_mask:0xf bank_mask:0xf
    v_mov_b32_dpp v139, v28 row_newbcast:3 row_mask:0xf bank_mask:0xf
    v_mov_b32_dpp v140, v28 row_newbcast:4 row_mask:0xf bank_mask:0xf
    v_mov_b32_dpp v141, v28 row_newbcast:5 row_mask:0xf bank_mask:0xf
    v_mov_b32_dpp v142, v28 row_newbcast:6 row_mask:0xf bank_mask:0xf
    v_mov_b32_dpp v143, v28 row_newbcast:7 row_mask:0xf bank_mask:0xf
    v_mov_b32_dpp v144, v28 row_newbcast:8 row_mask:0xf bank_mask:0xf
    v_mov_b32_dpp v145, v28 row_newbcast:9 row_mask:0xf bank_mask:0xf
    v_mov_b32_dpp v146, v28 row_newbcast:10 row_mask:0xf bank_mask:0xf
    v_mov_b32_dpp v147, v28 row_newbcast:11 row_mask:0xf bank_mask:0xf
    v_mov_b32_dpp v148, v28 row_newbcast:12 row_mask:0xf bank_mask:0xf
    v_mov_b32_dpp v149, v28 row_newbcast:13 row_mask:0xf bank_mask:0xf
    v_mov_b32_dpp v150, v28 row_newbcast:14 row_mask:0xf bank_mask:0xf
    v_mov_b32_dpp v151, v28 row_newbcast:15 row_mask:0xf bank_mask:0xf
    v_mov_b32_dpp v168, v30 row_newbcast:0 row_mask:0xf bank_mask:0xf
    v_mov_b32_dpp v169, v30 row_newbcast:1 row_mask:0xf bank_mask:0xf
    v_mov_b32_dpp v170, v30 row_newbcast:2 row_mask:0xf bank_mask:0xf
    v_mov_b32_dpp v171, v30 row_newbcast:3 row_mask:0xf bank_mask:0xf
    v_mov_b32_dpp v172, v30 row_newbcast:4 row_mask:0xf bank_mask:0xf
    v_mov_b32_dpp v173, v30 row_newbcast:5 row_mask:0xf bank_mask:0xf
    v_mov_b32_dpp v174, v30 row_newbcast:6 row_mask:0xf bank_mask:0xf
    v_mov_b32_dpp v175, v30 row_newbcast:7 row_mask:0xf bank_mask:0xf
    v_mov_b32_dpp v176, v30 row_newbcast:8 row_mask:0xf bank_mask:0xf
    v_mov_b32_dpp v177, v30 row_newbcast:9 row_mask:0xf bank_mask:0xf
    v_mov_b32_dpp v178, v30 row_newbcast:10 row_mask:0xf bank_mask:0xf
    v_mov_b32_dpp v179, v30 row_newbcast:11 row_mask:0xf bank_mask:0xf
    v_mov_b32_dpp v180, v30 row_newbcast:12 row_mask:0xf bank_mask:0xf
    v_mov_b32_dpp v181, v30 row_newbcast:13 row_mask:0xf bank_mask:0xf
    v_mov_b32_dpp v182, v30 row_newbcast:14 row_mask:0xf bank_mask:0xf
    v_mov_b32_dpp v183, v30 row_newbcast:15 row_mask:0xf bank_mask:0xf
    v_mov_b32_dpp v88, v29 row_newbcast:0 row_mask:0xf bank_mask:0xf
    v_mov_b32_dpp v89, v29 row_newbcast:1 row_mask:0xf bank_mask:0xf
    v_mov_b32_dpp v90, v29 row_newbcast:2 row_mask:0xf bank_mask:0xf
    v_mov_b32_dpp v91, v29 row_newbcast:3 row_mask:0xf bank_mask:0xf
    v_mov_b32_dpp v92, v29 row_newbcast:4 row_mask:0xf bank_mask:0xf
    v_mov_b32_dpp v93, v29 row_newbcast:5 row_mask:0xf bank_mask:0xf
    v_mov_b32_dpp v94, v29 row_newbcast:6 row_mask:0xf bank_mask:0xf
    v_mov_b32_dpp v95, v29 row_newbcast:7 row_mask:0xf bank_mask:0xf
    v_mov_b32_dpp v96, v29 row_newbcast:8 row_mask:0xf bank_mask:0xf
    v_mov_b32_dpp v97, v29 row_newbcast:9 row_mask:0xf bank_mask:0xf
    v_mov_b32_dpp v98, v29 row_newbcast:10 row_mask:0xf bank_mask:0xf
    v_mov_b32_dpp v99, v29 row_newbcast:11 row_mask:0xf bank_mask:0xf
    v_mov_b32_dpp v100, v29 row_newbcast:12 row_mask:0xf bank_mask:0xf
    v_mov_b32_dpp v101, v29 row_newbcast:13 row_mask:0xf bank_mask:0xf
    v_mov_b32_dpp v102, v29 row_newbcast:14 row_mask:0xf bank_mask:0xf
    v_mov_b32_dpp v103, v29 row_newbcast:15 row_mask:0xf bank_mask:0xf
    v_mov_b32_dpp v104, v31 row_newbcast:0 row_mask:0xf bank_mask:0xf
    v_mov_b32_dpp v105, v31 row_newbcast:1 row_mask:0xf bank_mask:0xf
    v_mov_b32_dpp v106, v31 row_newbcast:2 row_mask:0xf bank_mask:0xf
    v_mov_b32_dpp v107, v31 row_newbcast:3 row_mask:0xf bank_mask:0xf
    v_mov_b32_dpp v108, v31 row_newbcast:4 row_mask:0xf bank_mask:0xf
    v_mov_b32_dpp v109, v31 row_newbcast:5 row_mask:0xf bank_mask:0xf
    v_mov_b32_dpp v110, v31 row_newbcast:6 row_mask:0xf bank_mask:0xf
    v_mov_b32_dpp v111, v31 row_newbcast:7 row_mask:0xf bank_mask:0xf
    v_mov_b32_dpp v112, v31 row_newbcast:8 row_mask:0xf bank_mask:0xf
    v_mov_b32_dpp v113, v31 row_newbcast:9 row_mask:0xf bank_mask:0xf
    v_mov_b32_dpp v114, v31 row_newbcast:10 row_mask:0xf bank_mask:0xf
    v_mov_b32_dpp v115, v31 row_newbcast:11 row_mask:0xf bank_mask:0xf
    v_mov_b32_dpp v116, v31 row_newbcast:12 row_mask:0xf bank_mask:0xf
    v_mov_b32_dpp v117, v31 row_newbcast:13 row_mask:0xf bank_mask:0xf
    v_mov_b32_dpp v118, v31 row_newbcast:14 row_mask:0xf bank_mask:0xf
    v_mov_b32_dpp v119, v31 row_newbcast:15 row_mask:0xf bank_mask:0xf
    s_branch SCHK_31
SPOLL_30:
    s_load_dwordx2 s[24:25], s[32:33], s18 offset:0 glc
SCHK_31:
    s_add_u32 s5, s5, 1
    s_cmp_ge_u32 s5, 200000
    s_waitcnt lgkmcnt(0)
    s_cbranch_scc1 SDONE_32
    s_cmp_lg_u32 s24, s4
    s_cbranch_scc1 SPOLL_30
    s_cmp_lg_u32 s25, s4
    s_cbranch_scc1 SPOLL_30
SDONE_32:
    s_add_u32 s20, s17, s19
    buffer_load_dwordx4 v[224:227], v2, s[32:35], s20 offen sc1
    ds_read_b64_tr_b16 v[192:193], v36
    ds_read_b64_tr_b16 v[194:195], v36 offset:512
    ds_read_b64_tr_b16 v[196:197], v37
    ds_read_b64_tr_b16 v[198:199], v37 offset:512
    ds_read_b64_tr_b16 v[200:201], v38
    ds_read_b64_tr_b16 v[202:203], v38 offset:512
    ds_read_b64_tr_b16 v[204:205], v39
    ds_read_b64_tr_b16 v[206:207], v39 offset:512
    ds_read_b64_tr_b16 v[208:209], v36 offset:4096
    ds_read_b64_tr_b16 v[210:211], v36 offset:4608
    ds_read_b64_tr_b16 v[212:213], v37 offset:4096
    ds_read_b64_tr_b16 v[214:215], v37 offset:4608
    ds_read_b64_tr_b16 v[216:217], v38 offset:4096
    ds_read_b64_tr_b16 v[218:219], v38 offset:4608
    buffer_load_dwordx4 v[228:231], v2, s[32:35], s20 offen offset:1024 sc1
    buffer_load_dwordx4 v[232:235], v2, s[32:35], s20 offen offset:2048 sc1
    buffer_load_dwordx4 v[236:239], v2, s[32:35], s20 offen offset:3072 sc1
    s_barrier
    s_xor_b32 s96, s17, 4096
    s_add_u32 s20, s96, s19
    buffer_load_dwordx4 v[240:243], v2, s[32:35], s20 offen sc1
    buffer_load_dwordx4 v[244:247], v2, s[32:35], s20 offen offset:1024 sc1
    buffer_load_dwordx4 v[44:47], v2, s[32:35], s20 offen offset:2048 sc1
    buffer_load_dwordx4 v[48:51], v2, s[32:35], s20 offen offset:3072 sc1
    s_lshl_b32 s96, s21, 10
    s_add_u32 s13, s96, 14155776
    v_and_b32 v10, 15, v1
    v_lshlrev_b32 v10, 6, v10
    s_waitcnt vmcnt(7)
    s_waitcnt lgkmcnt(10)
    v_mfma_f32_16x16x32_bf16 v[120:123], v[192:195], v[224:227], 0
    ds_read_b64_tr_b16 v[220:221], v39 offset:4096
    ds_read_b64_tr_b16 v[222:223], v39 offset:4608
    v_mfma_f32_16x16x32_bf16 v[124:127], v[196:199], v[224:227], 0
    ds_read_b64_tr_b16 v[192:193], v36 offset:8192
    ds_read_b64_tr_b16 v[194:195], v36 offset:8704
    s_waitcnt lgkmcnt(10)
    v_mfma_f32_16x16x32_bf16 v[128:131], v[200:203], v[224:227], 0
    ds_read_b64_tr_b16 v[196:197], v37 offset:8192
    ds_read_b64_tr_b16 v[198:199], v37 offset:8704
    v_mfma_f32_16x16x32_bf16 v[132:135], v[204:207], v[224:227], 0
    ds_read_b64_tr_b16 v[200:201], v38 offset:8192
    ds_read_b64_tr_b16 v[202:203], v38 offset:8704
    s_xor_b32 s96, s17, 8192
    s_add_u32 s20, s96, s19
    buffer_load_dwordx4 v[224:227], v2, s[32:35], s20 offen sc1
    s_waitcnt vmcnt(7)
    s_waitcnt lgkmcnt(10)
    v_mfma_f32_16x16x32_bf16 v[120:123], v[208:211], v[228:231], v[120:123]
    ds_read_b64_tr_b16 v[204:205], v39 offset:8192
    ds_read_b64_tr_b16 v[206:207], v39 offset:8704
    v_mfma_f32_16x16x32_bf16 v[124:127], v[212:215], v[228:231], v[124:127]
    ds_read_b64_tr_b16 v[208:209], v36 offset:12288
    ds_read_b64_tr_b16 v[210:211], v36 offset:12800
    s_waitcnt lgkmcnt(10)
    v_mfma_f32_16x16x32_bf16 v[128:131], v[216:219], v[228:231], v[128:131]
    ds_read_b64_tr_b16 v[212:213], v37 offset:12288
    ds_read_b64_tr_b16 v[214:215], v37 offset:12800
    v_mfma_f32_16x16x32_bf16 v[132:135], v[220:223], v[228:231], v[132:135]
    ds_read_b64_tr_b16 v[216:217], v38 offset:12288
    ds_read_b64_tr_b16 v[218:219], v38 offset:12800
    buffer_load_dwordx4 v[228:231], v2, s[32:35], s20 offen offset:1024 sc1
    s_waitcnt vmcnt(7)
    s_waitcnt lgkmcnt(10)
    v_mfma_f32_16x16x32_bf16 v[120:123], v[192:195], v[232:235], v[120:123]
    ds_read_b64_tr_b16 v[220:221], v39 offset:12288
    ds_read_b64_tr_b16 v[222:223], v39 offset:12800
    v_mfma_f32_16x16x32_bf16 v[124:127], v[196:199], v[232:235], v[124:127]
    v_xor_b32 v36, 16384, v36
    ds_read_b64_tr_b16 v[192:193], v36
    ds_read_b64_tr_b16 v[194:195], v36 offset:512
    s_waitcnt lgkmcnt(10)
    v_mfma_f32_16x16x32_bf16 v[128:131], v[200:203], v[232:235], v[128:131]
    v_xor_b32 v37, 16384, v37
    ds_read_b64_tr_b16 v[196:197], v37
    ds_read_b64_tr_b16 v[198:199], v37 offset:512
    v_mfma_f32_16x16x32_bf16 v[132:135], v[204:207], v[232:235], v[132:135]
    v_xor_b32 v38, 16384, v38
    ds_read_b64_tr_b16 v[200:201], v38
    ds_read_b64_tr_b16 v[202:203], v38 offset:512
    buffer_load_dwordx4 v[232:235], v2, s[32:35], s20 offen offset:2048 sc1
    s_waitcnt vmcnt(7)
    s_waitcnt lgkmcnt(10)
    v_mfma_f32_16x16x32_bf16 v[120:123], v[208:211], v[236:239], v[120:123]
    v_xor_b32 v39, 16384, v39
    ds_read_b64_tr_b16 v[204:205], v39
    ds_read_b64_tr_b16 v[206:207], v39 offset:512
    v_mfma_f32_16x16x32_bf16 v[124:127], v[212:215], v[236:239], v[124:127]
    ds_read_b64_tr_b16 v[208:209], v36 offset:4096
    ds_read_b64_tr_b16 v[210:211], v36 offset:4608
    s_waitcnt lgkmcnt(10)
    v_mfma_f32_16x16x32_bf16 v[128:131], v[216:219], v[236:239], v[128:131]
    ds_read_b64_tr_b16 v[212:213], v37 offset:4096
    ds_read_b64_tr_b16 v[214:215], v37 offset:4608
    v_mfma_f32_16x16x32_bf16 v[132:135], v[220:223], v[236:239], v[132:135]
    ds_read_b64_tr_b16 v[216:217], v38 offset:4096
    ds_read_b64_tr_b16 v[218:219], v38 offset:4608
    buffer_load_dwordx4 v[236:239], v2, s[32:35], s20 offen offset:3072 sc1
    s_waitcnt vmcnt(7)
    s_waitcnt lgkmcnt(10)
    v_mfma_f32_16x16x32_bf16 v[120:123], v[192:195], v[240:243], v[120:123]
    ds_read_b64_tr_b16 v[220:221], v39 offset:4096
    ds_read_b64_tr_b16 v[222:223], v39 offset:4608
    v_mfma_f32_16x16x32_bf16 v[124:127], v[196:199], v[240:243], v[124:127]
    ds_read_b64_tr_b16 v[192:193], v36 offset:8192
    ds_read_b64_tr_b16 v[194:195], v36 offset:8704
    s_waitcnt lgkmcnt(10)
    v_mfma_f32_16x16x32_bf16 v[128:131], v[200:203], v[240:243], v[128:131]
    ds_read_b64_tr_b16 v[196:197], v37 offset:8192
    ds_read_b64_tr_b16 v[198:199], v37 offset:8704
    v_mfma_f32_16x16x32_bf16 v[132:135], v[204:207], v[240:243], v[132:135]
    ds_read_b64_tr_b16 v[200:201], v38 offset:8192
    ds_read_b64_tr_b16 v[202:203], v38 offset:8704
    s_xor_b32 s96, s17, 12288
    s_add_u32 s20, s96, s19
    buffer_load_dwordx4 v[240:243], v2, s[32:35], s20 offen sc1
    s_waitcnt vmcnt(7)
    s_waitcnt lgkmcnt(10)
    v_mfma_f32_16x16x32_bf16 v[120:123], v[208:211], v[244:247], v[120:123]
    ds_read_b64_tr_b16 v[204:205], v39 offset:8192
    ds_read_b64_tr_b16 v[206:207], v39 offset:8704
    v_mfma_f32_16x16x32_bf16 v[124:127], v[212:215], v[244:247], v[124:127]
    ds_read_b64_tr_b16 v[208:209], v36 offset:12288
    ds_read_b64_tr_b16 v[210:211], v36 offset:12800
    s_waitcnt lgkmcnt(10)
    v_mfma_f32_16x16x32_bf16 v[128:131], v[216:219], v[244:247], v[128:131]
    ds_read_b64_tr_b16 v[212:213], v37 offset:12288
    ds_read_b64_tr_b16 v[214:215], v37 offset:12800
    v_mfma_f32_16x16x32_bf16 v[132:135], v[220:223], v[244:247], v[132:135]
    ds_read_b64_tr_b16 v[216:217], v38 offset:12288
    ds_read_b64_tr_b16 v[218:219], v38 offset:12800
    buffer_load_dwordx4 v[244:247], v2, s[32:35], s20 offen offset:1024 sc1
    s_waitcnt vmcnt(7)
    s_waitcnt lgkmcnt(10)
    v_mfma_f32_16x16x32_bf16 v[120:123], v[192:195], v[44:47], v[120:123]
    ds_read_b64_tr_b16 v[220:221], v39 offset:12288
    ds_read_b64_tr_b16 v[222:223], v39 offset:12800
    v_mfma_f32_16x16x32_bf16 v[124:127], v[196:199], v[44:47], v[124:127]
    v_xor_b32 v36, 49152, v36
    ds_read_b64_tr_b16 v[192:193], v36
    ds_read_b64_tr_b16 v[194:195], v36 offset:512
    s_waitcnt lgkmcnt(10)
    v_mfma_f32_16x16x32_bf16 v[128:131], v[200:203], v[44:47], v[128:131]
    v_xor_b32 v37, 49152, v37
    ds_read_b64_tr_b16 v[196:197], v37
    ds_read_b64_tr_b16 v[198:199], v37 offset:512
    v_mfma_f32_16x16x32_bf16 v[132:135], v[204:207], v[44:47], v[132:135]
    v_xor_b32 v38, 49152, v38
    ds_read_b64_tr_b16 v[200:201], v38
    ds_read_b64_tr_b16 v[202:203], v38 offset:512
    buffer_load_dwordx4 v[44:47], v2, s[32:35], s20 offen offset:2048 sc1
    s_waitcnt vmcnt(7)
    s_waitcnt lgkmcnt(10)
    v_mfma_f32_16x16x32_bf16 v[120:123], v[208:211], v[48:51], v[120:123]
    v_xor_b32 v39, 49152, v39
    ds_read_b64_tr_b16 v[204:205], v39
    ds_read_b64_tr_b16 v[206:207], v39 offset:512
    v_mfma_f32_16x16x32_bf16 v[124:127], v[212:215], v[48:51], v[124:127]
    ds_read_b64_tr_b16 v[208:209], v36 offset:4096
    ds_read_b64_tr_b16 v[210:211], v36 offset:4608
    s_waitcnt lgkmcnt(10)
    v_mfma_f32_16x16x32_bf16 v[128:131], v[216:219], v[48:51], v[128:131]
    ds_read_b64_tr_b16 v[212:213], v37 offset:4096
    ds_read_b64_tr_b16 v[214:215], v37 offset:4608
    v_mfma_f32_16x16x32_bf16 v[132:135], v[220:223], v[48:51], v[132:135]
    ds_read_b64_tr_b16 v[216:217], v38 offset:4096
    ds_read_b64_tr_b16 v[218:219], v38 offset:4608
    buffer_load_dwordx4 v[48:51], v2, s[32:35], s20 offen offset:3072 sc1
    s_waitcnt vmcnt(7)
    s_waitcnt lgkmcnt(10)
    v_mfma_f32_16x16x32_bf16 v[120:123], v[192:195], v[224:227], v[120:123]
    ds_read_b64_tr_b16 v[220:221], v39 offset:4096
    ds_read_b64_tr_b16 v[222:223], v39 offset:4608
L_PAD8:
    s_cbranch_execz L_RET8
    v_mfma_f32_16x16x32_bf16 v[124:127], v[196:199], v[224:227], v[124:127]
    ds_read_b64_tr_b16 v[192:193], v36 offset:8192
    ds_read_b64_tr_b16 v[194:195], v36 offset:8704
    s_waitcnt lgkmcnt(10)
    v_mfma_f32_16x16x32_bf16 v[128:131], v[200:203], v[224:227], v[128:131]
    ds_read_b64_tr_b16 v[196:197], v37 offset:8192
    ds_read_b64_tr_b16 v[198:199], v37 offset:8704
    v_mfma_f32_16x16x32_bf16 v[132:135], v[204:207], v[224:227], v[132:135]
    ds_read_b64_tr_b16 v[200:201], v38 offset:8192
    ds_read_b64_tr_b16 v[202:203], v38 offset:8704
    s_xor_b32 s96, s17, 16384
    s_add_u32 s20, s96, s19
    buffer_load_dwordx4 v[224:227], v2, s[32:35], s20 offen sc1
    s_waitcnt vmcnt(7)
    s_waitcnt lgkmcnt(10)
    v_mfma_f32_16x16x32_bf16 v[120:123], v[208:211], v[228:231], v[120:123]
    ds_read_b64_tr_b16 v[204:205], v39 offset:8192
    ds_read_b64_tr_b16 v[206:207], v39 offset:8704
    v_mfma_f32_16x16x32_bf16 v[124:127], v[212:215], v[228:231], v[124:127]
    ds_read_b64_tr_b16 v[208:209], v36 offset:12288
    ds_read_b64_tr_b16 v[210:211], v36 offset:12800
    s_waitcnt lgkmcnt(10)
    v_mfma_f32_16x16x32_bf16 v[128:131], v[216:219], v[228:231], v[128:131]
    ds_read_b64_tr_b16 v[212:213], v37 offset:12288
    ds_read_b64_tr_b16 v[214:215], v37 offset:12800
    v_mfma_f32_16x16x32_bf16 v[132:135], v[220:223], v[228:231], v[132:135]
    ds_read_b64_tr_b16 v[216:217], v38 offset:12288
    ds_read_b64_tr_b16 v[218:219], v38 offset:12800
    buffer_load_dwordx4 v[228:231], v2, s[32:35], s20 offen offset:1024 sc1
    s_waitcnt vmcnt(7)
    s_waitcnt lgkmcnt(10)
    v_mfma_f32_16x16x32_bf16 v[120:123], v[192:195], v[232:235], v[120:123]
    ds_read_b64_tr_b16 v[220:221], v39 offset:12288
    ds_read_b64_tr_b16 v[222:223], v39 offset:12800
    v_mfma_f32_16x16x32_bf16 v[124:127], v[196:199], v[232:235], v[124:127]
    v_xor_b32 v36, 16384, v36
    ds_read_b64_tr_b16 v[192:193], v36
    ds_read_b64_tr_b16 v[194:195], v36 offset:512
    s_waitcnt lgkmcnt(10)
    v_mfma_f32_16x16x32_bf16 v[128:131], v[200:203], v[232:235], v[128:131]
    v_xor_b32 v37, 16384, v37
    ds_read_b64_tr_b16 v[196:197], v37
    ds_read_b64_tr_b16 v[198:199], v37 offset:512
    v_mfma_f32_16x16x32_bf16 v[132:135], v[204:207], v[232:235], v[132:135]
    v_xor_b32 v38, 16384, v38
    ds_read_b64_tr_b16 v[200:201], v38
    ds_read_b64_tr_b16 v[202:203], v38 offset:512
    buffer_load_dwordx4 v[232:235], v2, s[32:35], s20 offen offset:2048 sc1
    s_waitcnt vmcnt(7)
    s_waitcnt lgkmcnt(10)
    v_mfma_f32_16x16x32_bf16 v[120:123], v[208:211], v[236:239], v[120:123]
    v_xor_b32 v39, 16384, v39
    ds_read_b64_tr_b16 v[204:205], v39
    ds_read_b64_tr_b16 v[206:207], v39 offset:512
    v_mfma_f32_16x16x32_bf16 v[124:127], v[212:215], v[236:239], v[124:127]
    ds_read_b64_tr_b16 v[208:209], v36 offset:4096
    ds_read_b64_tr_b16 v[210:211], v36 offset:4608
    s_waitcnt lgkmcnt(10)
    v_mfma_f32_16x16x32_bf16 v[128:131], v[216:219], v[236:239], v[128:131]
    ds_read_b64_tr_b16 v[212:213], v37 offset:4096
    ds_read_b64_tr_b16 v[214:215], v37 offset:4608
    v_mfma_f32_16x16x32_bf16 v[132:135], v[220:223], v[236:239], v[132:135]
    ds_read_b64_tr_b16 v[216:217], v38 offset:4096
    ds_read_b64_tr_b16 v[218:219], v38 offset:4608
    buffer_load_dwordx4 v[236:239], v2, s[32:35], s20 offen offset:3072 sc1
    s_waitcnt vmcnt(7)
    s_waitcnt lgkmcnt(10)
    v_mfma_f32_16x16x32_bf16 v[120:123], v[192:195], v[240:243], v[120:123]
    ds_read_b64_tr_b16 v[220:221], v39 offset:4096
    ds_read_b64_tr_b16 v[222:223], v39 offset:4608
    v_mfma_f32_16x16x32_bf16 v[124:127], v[196:199], v[240:243], v[124:127]
    ds_read_b64_tr_b16 v[192:193], v36 offset:8192
    ds_read_b64_tr_b16 v[194:195], v36 offset:8704
    s_waitcnt lgkmcnt(10)
    v_mfma_f32_16x16x32_bf16 v[128:131], v[200:203], v[240:243], v[128:131]
    ds_read_b64_tr_b16 v[196:197], v37 offset:8192
    ds_read_b64_tr_b16 v[198:199], v37 offset:8704
    v_mfma_f32_16x16x32_bf16 v[132:135], v[204:207], v[240:243], v[132:135]
    ds_read_b64_tr_b16 v[200:201], v38 offset:8192
    ds_read_b64_tr_b16 v[202:203], v38 offset:8704
    s_xor_b32 s96, s17, 20480
    s_add_u32 s20, s96, s19
    buffer_load_dwordx4 v[240:243], v2, s[32:35], s20 offen sc1
    s_waitcnt vmcnt(7)
    s_waitcnt lgkmcnt(10)
    v_mfma_f32_16x16x32_bf16 v[120:123], v[208:211], v[244:247], v[120:123]
    ds_read_b64_tr_b16 v[204:205], v39 offset:8192
    ds_read_b64_tr_b16 v[206:207], v39 offset:8704
    v_mfma_f32_16x16x32_bf16 v[124:127], v[212:215], v[244:247], v[124:127]
    ds_read_b64_tr_b16 v[208:209], v36 offset:12288
    ds_read_b64_tr_b16 v[210:211], v36 offset:12800
    s_waitcnt lgkmcnt(10)
    v_mfma_f32_16x16x32_bf16 v[128:131], v[216:219], v[244:247], v[128:131]
    ds_read_b64_tr_b16 v[212:213], v37 offset:12288
    ds_read_b64_tr_b16 v[214:215], v37 offset:12800
    v_mfma_f32_16x16x32_bf16 v[132:135], v[220:223], v[244:247], v[132:135]
    ds_read_b64_tr_b16 v[216:217], v38 offset:12288
    ds_read_b64_tr_b16 v[218:219], v38 offset:12800
    buffer_load_dwordx4 v[244:247], v2, s[32:35], s20 offen offset:1024 sc1
    s_waitcnt vmcnt(7)
    s_waitcnt lgkmcnt(10)
    v_mfma_f32_16x16x32_bf16 v[120:123], v[192:195], v[44:47], v[120:123]
    ds_read_b64_tr_b16 v[220:221], v39 offset:12288
    ds_read_b64_tr_b16 v[222:223], v39 offset:12800
    v_mfma_f32_16x16x32_bf16 v[124:127], v[196:199], v[44:47], v[124:127]
    v_xor_b32 v36, 114688, v36
    ds_read_b64_tr_b16 v[192:193], v36
    ds_read_b64_tr_b16 v[194:195], v36 offset:512
    s_waitcnt lgkmcnt(10)
    v_mfma_f32_16x16x32_bf16 v[128:131], v[200:203], v[44:47], v[128:131]
    v_xor_b32 v37, 114688, v37
    ds_read_b64_tr_b16 v[196:197], v37
    ds_read_b64_tr_b16 v[198:199], v37 offset:512
    v_mfma_f32_16x16x32_bf16 v[132:135], v[204:207], v[44:47], v[132:135]
    v_xor_b32 v38, 114688, v38
    ds_read_b64_tr_b16 v[200:201], v38
    ds_read_b64_tr_b16 v[202:203], v38 offset:512
    buffer_load_dwordx4 v[44:47], v2, s[32:35], s20 offen offset:2048 sc1
    s_waitcnt vmcnt(7)
    s_waitcnt lgkmcnt(10)
    v_mfma_f32_16x16x32_bf16 v[120:123], v[208:211], v[48:51], v[120:123]
    v_xor_b32 v39, 114688, v39
    ds_read_b64_tr_b16 v[204:205], v39
    ds_read_b64_tr_b16 v[206:207], v39 offset:512
    v_mfma_f32_16x16x32_bf16 v[124:127], v[212:215], v[48:51], v[124:127]
    ds_read_b64_tr_b16 v[208:209], v36 offset:4096
    ds_read_b64_tr_b16 v[210:211], v36 offset:4608
    s_waitcnt lgkmcnt(10)
    v_mfma_f32_16x16x32_bf16 v[128:131], v[216:219], v[48:51], v[128:131]
    ds_read_b64_tr_b16 v[212:213], v37 offset:4096
    ds_read_b64_tr_b16 v[214:215], v37 offset:4608
    v_mfma_f32_16x16x32_bf16 v[132:135], v[220:223], v[48:51], v[132:135]
    ds_read_b64_tr_b16 v[216:217], v38 offset:4096
    ds_read_b64_tr_b16 v[218:219], v38 offset:4608
    buffer_load_dwordx4 v[48:51], v2, s[32:35], s20 offen offset:3072 sc1
    s_waitcnt vmcnt(7)
    s_waitcnt lgkmcnt(10)
    v_mfma_f32_16x16x32_bf16 v[120:123], v[192:195], v[224:227], v[120:123]
    ds_read_b64_tr_b16 v[220:221], v39 offset:4096
    ds_read_b64_tr_b16 v[222:223], v39 offset:4608
    v_mfma_f32_16x16x32_bf16 v[124:127], v[196:199], v[224:227], v[124:127]
    ds_read_b64_tr_b16 v[192:193], v36 offset:8192
    ds_read_b64_tr_b16 v[194:195], v36 offset:8704
    s_waitcnt lgkmcnt(10)
    v_mfma_f32_16x16x32_bf16 v[128:131], v[200:203], v[224:227], v[128:131]
    ds_read_b64_tr_b16 v[196:197], v37 offset:8192
    ds_read_b64_tr_b16 v[198:199], v37 offset:8704
    v_mfma_f32_16x16x32_bf16 v[132:135], v[204:207], v[224:227], v[132:135]
    ds_read_b64_tr_b16 v[200:201], v38 offset:8192
    ds_read_b64_tr_b16 v[202:203], v38 offset:8704
    s_xor_b32 s96, s17, 24576
    s_add_u32 s20, s96, s19
    buffer_load_dwordx4 v[224:227], v2, s[32:35], s20 offen sc1
    s_waitcnt vmcnt(7)
    s_waitcnt lgkmcnt(10)
    v_mfma_f32_16x16x32_bf16 v[120:123], v[208:211], v[228:231], v[120:123]
    ds_read_b64_tr_b16 v[204:205], v39 offset:8192
    ds_read_b64_tr_b16 v[206:207], v39 offset:8704
    v_mfma_f32_16x16x32_bf16 v[124:127], v[212:215], v[228:231], v[124:127]
    ds_read_b64_tr_b16 v[208:209], v36 offset:12288
    ds_read_b64_tr_b16 v[210:211], v36 offset:12800
    s_waitcnt lgkmcnt(10)
    v_mfma_f32_16x16x32_bf16 v[128:131], v[216:219], v[228:231], v[128:131]
    ds_read_b64_tr_b16 v[212:213], v37 offset:12288
    ds_read_b64_tr_b16 v[214:215], v37 offset:12800
    v_mfma_f32_16x16x32_bf16 v[132:135], v[220:223], v[228:231], v[132:135]
    ds_read_b64_tr_b16 v[216:217], v38 offset:12288
    ds_read_b64_tr_b16 v[218:219], v38 offset:12800
    buffer_load_dwordx4 v[228:231], v2, s[32:35], s20 offen offset:1024 sc1
    s_waitcnt vmcnt(7)
    s_waitcnt lgkmcnt(10)
    v_mfma_f32_16x16x32_bf16 v[120:123], v[192:195], v[232:235], v[120:123]
    ds_read_b64_tr_b16 v[220:221], v39 offset:12288
    ds_read_b64_tr_b16 v[222:223], v39 offset:12800
    v_mfma_f32_16x16x32_bf16 v[124:127], v[196:199], v[232:235], v[124:127]
    v_xor_b32 v36, 16384, v36
    ds_read_b64_tr_b16 v[192:193], v36
    ds_read_b64_tr_b16 v[194:195], v36 offset:512
    s_waitcnt lgkmcnt(10)
    v_mfma_f32_16x16x32_bf16 v[128:131], v[200:203], v[232:235], v[128:131]
    v_xor_b32 v37, 16384, v37
    ds_read_b64_tr_b16 v[196:197], v37
    ds_read_b64_tr_b16 v[198:199], v37 offset:512
    v_mfma_f32_16x16x32_bf16 v[132:135], v[204:207], v[232:235], v[132:135]
    v_xor_b32 v38, 16384, v38
    ds_read_b64_tr_b16 v[200:201], v38
    ds_read_b64_tr_b16 v[202:203], v38 offset:512
    buffer_load_dwordx4 v[232:235], v2, s[32:35], s20 offen offset:2048 sc1
    s_waitcnt vmcnt(7)
    s_waitcnt lgkmcnt(10)
    v_mfma_f32_16x16x32_bf16 v[120:123], v[208:211], v[236:239], v[120:123]
    v_xor_b32 v39, 16384, v39
    ds_read_b64_tr_b16 v[204:205], v39
    ds_read_b64_tr_b16 v[206:207], v39 offset:512
    v_mfma_f32_16x16x32_bf16 v[124:127], v[212:215], v[236:239], v[124:127]
    ds_read_b64_tr_b16 v[208:209], v36 offset:4096
    ds_read_b64_tr_b16 v[210:211], v36 offset:4608
    s_waitcnt lgkmcnt(10)
    v_mfma_f32_16x16x32_bf16 v[128:131], v[216:219], v[236:239], v[128:131]
    ds_read_b64_tr_b16 v[212:213], v37 offset:4096
    ds_read_b64_tr_b16 v[214:215], v37 offset:4608
    v_mfma_f32_16x16x32_bf16 v[132:135], v[220:223], v[236:239], v[132:135]
    ds_read_b64_tr_b16 v[216:217], v38 offset:4096
    ds_read_b64_tr_b16 v[218:219], v38 offset:4608
    buffer_load_dwordx4 v[236:239], v2, s[32:35], s20 offen offset:3072 sc1
    s_waitcnt vmcnt(7)
    s_waitcnt lgkmcnt(10)
    v_mfma_f32_16x16x32_bf16 v[120:123], v[192:195], v[240:243], v[120:123]
    ds_read_b64_tr_b16 v[220:221], v39 offset:4096
    ds_read_b64_tr_b16 v[222:223], v39 offset:4608
    v_mfma_f32_16x16x32_bf16 v[124:127], v[196:199], v[240:243], v[124:127]
    ds_read_b64_tr_b16 v[192:193], v36 offset:8192
    ds_read_b64_tr_b16 v[194:195], v36 offset:8704
    s_waitcnt lgkmcnt(10)
    v_mfma_f32_16x16x32_bf16 v[128:131], v[200:203], v[240:243], v[128:131]
    ds_read_b64_tr_b16 v[196:197], v37 offset:8192
    ds_read_b64_tr_b16 v[198:199], v37 offset:8704
    v_mfma_f32_16x16x32_bf16 v[132:135], v[204:207], v[240:243], v[132:135]
    ds_read_b64_tr_b16 v[200:201], v38 offset:8192
    ds_read_b64_tr_b16 v[202:203], v38 offset:8704
    s_xor_b32 s96, s17, 28672
    s_add_u32 s20, s96, s19
    buffer_load_dwordx4 v[240:243], v2, s[32:35], s20 offen sc1
    s_waitcnt vmcnt(7)
    s_waitcnt lgkmcnt(10)
    v_mfma_f32_16x16x32_bf16 v[120:123], v[208:211], v[244:247], v[120:123]
    ds_read_b64_tr_b16 v[204:205], v39 offset:8192
    ds_read_b64_tr_b16 v[206:207], v39 offset:8704
    v_mfma_f32_16x16x32_bf16 v[124:127], v[212:215], v[244:247], v[124:127]
    ds_read_b64_tr_b16 v[208:209], v36 offset:12288
    ds_read_b64_tr_b16 v[210:211], v36 offset:12800
    s_waitcnt lgkmcnt(10)
    v_mfma_f32_16x16x32_bf16 v[128:131], v[216:219], v[244:247], v[128:131]
    ds_read_b64_tr_b16 v[212:213], v37 offset:12288
    ds_read_b64_tr_b16 v[214:215], v37 offset:12800
    v_mfma_f32_16x16x32_bf16 v[132:135], v[220:223], v[244:247], v[132:135]
    ds_read_b64_tr_b16 v[216:217], v38 offset:12288
    ds_read_b64_tr_b16 v[218:219], v38 offset:12800
    buffer_load_dwordx4 v[244:247], v2, s[32:35], s20 offen offset:1024 sc1
    s_waitcnt vmcnt(7)
    s_waitcnt lgkmcnt(10)
    v_mfma_f32_16x16x32_bf16 v[120:123], v[192:195], v[44:47], v[120:123]
    ds_read_b64_tr_b16 v[220:221], v39 offset:12288
    ds_read_b64_tr_b16 v[222:223], v39 offset:12800
    v_mfma_f32_16x16x32_bf16 v[124:127], v[196:199], v[44:47], v[124:127]
    v_xor_b32 v36, 49152, v36
    ds_read_b64_tr_b16 v[192:193], v36
    ds_read_b64_tr_b16 v[194:195], v36 offset:512
    s_waitcnt lgkmcnt(10)
    v_mfma_f32_16x16x32_bf16 v[128:131], v[200:203], v[44:47], v[128:131]
    v_xor_b32 v37, 49152, v37
    ds_read_b64_tr_b16 v[196:197], v37
    ds_read_b64_tr_b16 v[198:199], v37 offset:512
    v_mfma_f32_16x16x32_bf16 v[132:135], v[204:207], v[44:47], v[132:135]
    v_xor_b32 v38, 49152, v38
    ds_read_b64_tr_b16 v[200:201], v38
    ds_read_b64_tr_b16 v[202:203], v38 offset:512
    buffer_load_dwordx4 v[44:47], v2, s[32:35], s20 offen offset:2048 sc1
    s_waitcnt vmcnt(7)
    s_waitcnt lgkmcnt(10)
    v_mfma_f32_16x16x32_bf16 v[120:123], v[208:211], v[48:51], v[120:123]
    v_xor_b32 v39, 49152, v39
    ds_read_b64_tr_b16 v[204:205], v39
    ds_read_b64_tr_b16 v[206:207], v39 offset:512
    v_mfma_f32_16x16x32_bf16 v[124:127], v[212:215], v[48:51], v[124:127]
    ds_read_b64_tr_b16 v[208:209], v36 offset:4096
    ds_read_b64_tr_b16 v[210:211], v36 offset:4608
    s_waitcnt lgkmcnt(10)
    v_mfma_f32_16x16x32_bf16 v[128:131], v[216:219], v[48:51], v[128:131]
    ds_read_b64_tr_b16 v[212:213], v37 offset:4096
    ds_read_b64_tr_b16 v[214:215], v37 offset:4608
    v_mfma_f32_16x16x32_bf16 v[132:135], v[220:223], v[48:51], v[132:135]
    ds_read_b64_tr_b16 v[216:217], v38 offset:4096
    ds_read_b64_tr_b16 v[218:219], v38 offset:4608
    buffer_load_dwordx4 v[48:51], v2, s[32:35], s20 offen offset:3072 sc1
    buffer_load_dwordx2 v[40:41], v10, s[32:35], s13 offen sc1
    s_cmp_ge_u32 s3, 4
    s_cbranch_scc1 L_FH_33
    s_mov_b32 s82, s80
    buffer_load_dwordx4 v[56:59], v27, s[56:59], s82 offen nt
    s_add_u32 s82, s80, 917504
    buffer_load_dwordx4 v[60:63], v27, s[56:59], s82 offen nt
    s_add_u32 s82, s80, 57344
    buffer_load_dwordx4 v[64:67], v27, s[56:59], s82 offen nt
    s_add_u32 s82, s80, 974848
    buffer_load_dwordx4 v[68:71], v27, s[56:59], s82 offen nt
L_FH_33:
    s_waitcnt vmcnt(8)
    s_waitcnt lgkmcnt(10)
    v_mfma_f32_16x16x32_bf16 v[120:123], v[192:195], v[224:227], v[120:123]
    ds_read_b64_tr_b16 v[220:221], v39 offset:4096
    ds_read_b64_tr_b16 v[222:223], v39 offset:4608
    v_mfma_f32_16x16x32_bf16 v[124:127], v[196:199], v[224:227], v[124:127]
    ds_read_b64_tr_b16 v[192:193], v36 offset:8192
    ds_read_b64_tr_b16 v[194:195], v36 offset:8704
    s_waitcnt lgkmcnt(10)
    v_mfma_f32_16x16x32_bf16 v[128:131], v[200:203], v[224:227], v[128:131]
    ds_read_b64_tr_b16 v[196:197], v37 offset:8192
    ds_read_b64_tr_b16 v[198:199], v37 offset:8704
    v_mfma_f32_16x16x32_bf16 v[132:135], v[204:207], v[224:227], v[132:135]
    ds_read_b64_tr_b16 v[200:201], v38 offset:8192
    ds_read_b64_tr_b16 v[202:203], v38 offset:8704
    s_waitcnt vmcnt(7)
    s_waitcnt lgkmcnt(10)
    v_mfma_f32_16x16x32_bf16 v[120:123], v[208:211], v[228:231], v[120:123]
    ds_read_b64_tr_b16 v[204:205], v39 offset:8192
    ds_read_b64_tr_b16 v[206:207], v39 offset:8704
    v_mfma_f32_16x16x32_bf16 v[124:127], v[212:215], v[228:231], v[124:127]
    ds_read_b64_tr_b16 v[208:209], v36 offset:12288
    ds_read_b64_tr_b16 v[210:211], v36 offset:12800
    s_waitcnt lgkmcnt(10)
    v_mfma_f32_16x16x32_bf16 v[128:131], v[216:219], v[228:231], v[128:131]
    ds_read_b64_tr_b16 v[212:213], v37 offset:12288
    ds_read_b64_tr_b16 v[214:215], v37 offset:12800
    v_mfma_f32_16x16x32_bf16 v[132:135], v[220:223], v[228:231], v[132:135]
    ds_read_b64_tr_b16 v[216:217], v38 offset:12288
    ds_read_b64_tr_b16 v[218:219], v38 offset:12800
    s_waitcnt vmcnt(6)
    s_waitcnt lgkmcnt(10)
    v_mfma_f32_16x16x32_bf16 v[120:123], v[192:195], v[232:235], v[120:123]
    ds_read_b64_tr_b16 v[220:221], v39 offset:12288
    ds_read_b64_tr_b16 v[222:223], v39 offset:12800
    v_mfma_f32_16x16x32_bf16 v[124:127], v[196:199], v[232:235], v[124:127]
    v_xor_b32 v36, 16384, v36
    ds_read_b64_tr_b16 v[192:193], v36
    ds_read_b64_tr_b16 v[194:195], v36 offset:512
    s_waitcnt lgkmcnt(10)
    v_mfma_f32_16x16x32_bf16 v[128:131], v[200:203], v[232:235], v[128:131]
    v_xor_b32 v37, 16384, v37
    ds_read_b64_tr_b16 v[196:197], v37
    ds_read_b64_tr_b16 v[198:199], v37 offset:512
    v_mfma_f32_16x16x32_bf16 v[132:135], v[204:207], v[232:235], v[132:135]
    v_xor_b32 v38, 16384, v38
    ds_read_b64_tr_b16 v[200:201], v38
    ds_read_b64_tr_b16 v[202:203], v38 offset:512
    s_waitcnt vmcnt(5)
    s_waitcnt lgkmcnt(10)
    v_mfma_f32_16x16x32_bf16 v[120:123], v[208:211], v[236:239], v[120:123]
    v_xor_b32 v39, 16384, v39
    ds_read_b64_tr_b16 v[204:205], v39
    ds_read_b64_tr_b16 v[206:207], v39 offset:512
    v_mfma_f32_16x16x32_bf16 v[124:127], v[212:215], v[236:239], v[124:127]
    ds_read_b64_tr_b16 v[208:209], v36 offset:4096
    ds_read_b64_tr_b16 v[210:211], v36 offset:4608
    s_waitcnt lgkmcnt(10)
    v_mfma_f32_16x16x32_bf16 v[128:131], v[216:219], v[236:239], v[128:131]
    ds_read_b64_tr_b16 v[212:213], v37 offset:4096
    ds_read_b64_tr_b16 v[214:215], v37 offset:4608
    v_mfma_f32_16x16x32_bf16 v[132:135], v[220:223], v[236:239], v[132:135]
    ds_read_b64_tr_b16 v[216:217], v38 offset:4096
    ds_read_b64_tr_b16 v[218:219], v38 offset:4608
    s_waitcnt vmcnt(4)
    s_waitcnt lgkmcnt(10)
    v_mfma_f32_16x16x32_bf16 v[120:123], v[192:195], v[240:243], v[120:123]
    ds_read_b64_tr_b16 v[220:221], v39 offset:4096
    ds_read_b64_tr_b16 v[222:223], v39 offset:4608
    v_mfma_f32_16x16x32_bf16 v[124:127], v[196:199], v[240:243], v[124:127]
    ds_read_b64_tr_b16 v[192:193], v36 offset:8192
    ds_read_b64_tr_b16 v[194:195], v36 offset:8704
    s_waitcnt lgkmcnt(10)
    v_mfma_f32_16x16x32_bf16 v[128:131], v[200:203], v[240:243], v[128:131]
    ds_read_b64_tr_b16 v[196:197], v37 offset:8192
    ds_read_b64_tr_b16 v[198:199], v37 offset:8704
    v_mfma_f32_16x16x32_bf16 v[132:135], v[204:207], v[240:243], v[132:135]
    ds_read_b64_tr_b16 v[200:201], v38 offset:8192
    ds_read_b64_tr_b16 v[202:203], v38 offset:8704
    s_waitcnt vmcnt(3)
    s_waitcnt lgkmcnt(10)
    v_mfma_f32_16x16x32_bf16 v[120:123], v[208:211], v[244:247], v[120:123]
    ds_read_b64_tr_b16 v[204:205], v39 offset:8192
    ds_read_b64_tr_b16 v[206:207], v39 offset:8704
    v_mfma_f32_16x16x32_bf16 v[124:127], v[212:215], v[244:247], v[124:127]
    ds_read_b64_tr_b16 v[208:209], v36 offset:12288
    ds_read_b64_tr_b16 v[210:211], v36 offset:12800
    s_waitcnt lgkmcnt(10)
    v_mfma_f32_16x16x32_bf16 v[128:131], v[216:219], v[244:247], v[128:131]
    ds_read_b64_tr_b16 v[212:213], v37 offset:12288
    ds_read_b64_tr_b16 v[214:215], v37 offset:12800
    v_mfma_f32_16x16x32_bf16 v[132:135], v[220:223], v[244:247], v[132:135]
    ds_read_b64_tr_b16 v[216:217], v38 offset:12288
    ds_read_b64_tr_b16 v[218:219], v38 offset:12800
    s_waitcnt vmcnt(2)
    s_waitcnt lgkmcnt(10)
    v_mfma_f32_16x16x32_bf16 v[120:123], v[192:195], v[44:47], v[120:123]
    ds_read_b64_tr_b16 v[220:221], v39 offset:12288
    ds_read_b64_tr_b16 v[222:223], v39 offset:12800
    v_mfma_f32_16x16x32_bf16 v[124:127], v[196:199], v[44:47], v[124:127]
    s_waitcnt lgkmcnt(8)
    v_mfma_f32_16x16x32_bf16 v[128:131], v[200:203], v[44:47], v[128:131]
    v_mfma_f32_16x16x32_bf16 v[132:135], v[204:207], v[44:47], v[132:135]
    s_waitcnt vmcnt(1)
    s_waitcnt lgkmcnt(4)
    v_mfma_f32_16x16x32_bf16 v[120:123], v[208:211], v[48:51], v[120:123]
    v_mfma_f32_16x16x32_bf16 v[124:127], v[212:215], v[48:51], v[124:127]
    s_waitcnt lgkmcnt(0)
    v_mfma_f32_16x16x32_bf16 v[128:131], v[216:219], v[48:51], v[128:131]
    v_mfma_f32_16x16x32_bf16 v[132:135], v[220:223], v[48:51], v[132:135]
    s_lshl3_add_u32 s96, s21, s3
    s_lshl4_add_u32 s97, s96, s12
    s_lshl_b32 s98, s97, 8
    s_add_u32 s14, s98, 12582912
    v_and_b32 v28, 15, v1
    v_lshlrev_b32 v28, 4, v28
    v_lshrrev_b32 v9, 4, v1
    v_lshl_add_u32 v28, v9, 2, v28
    v_cvt_pk_bf16_f32 v120, 0, v120
    v_cvt_pk_bf16_f32 v121, 0, v121
    v_cvt_pk_bf16_f32 v122, 0, v122
    v_cvt_pk_bf16_f32 v123, 0, v123
    v_cvt_pk_bf16_f32 v124, 0, v124
    v_cvt_pk_bf16_f32 v125, 0, v125
    v_cvt_pk_bf16_f32 v126, 0, v126
    v_cvt_pk_bf16_f32 v127, 0, v127
    v_pk_mul_f32 v[120:121], v[120:121], v[136:137]
    v_pk_mul_f32 v[122:123], v[122:123], v[138:139]
    v_pk_mul_f32 v[124:125], v[124:125], v[140:141]
    v_pk_mul_f32 v[126:127], v[126:127], v[142:143]
    v_cvt_pk_bf16_f32 v120, 0, v120
    v_cvt_pk_bf16_f32 v121, 0, v121
    v_cvt_pk_bf16_f32 v122, 0, v122
    v_cvt_pk_bf16_f32 v123, 0, v123
    v_cvt_pk_bf16_f32 v124, 0, v124
    v_cvt_pk_bf16_f32 v125, 0, v125
    v_cvt_pk_bf16_f32 v126, 0, v126
    v_cvt_pk_bf16_f32 v127, 0, v127
    v_pk_add_f32 v[120:121], v[120:121], v[152:153]
    v_pk_add_f32 v[122:123], v[122:123], v[154:155]
    v_pk_add_f32 v[124:125], v[124:125], v[156:157]
    v_pk_add_f32 v[126:127], v[126:127], v[158:159]
    v_cvt_pk_bf16_f32 v12, v120, v121
    v_cvt_pk_bf16_f32 v13, v122, v123
    v_cvt_pk_bf16_f32 v14, v124, v125
    v_cvt_pk_bf16_f32 v15, v126, v127
    v_dot2_f32_bf16 v4, v12, v12, 0
    v_dot2_f32_bf16 v5, v13, v13, 0
    v_dot2_f32_bf16 v4, v14, v14, v4
    v_dot2_f32_bf16 v5, v15, v15, v5
    v_mfma_f32_16x16x32_bf16 v[240:243], v[184:187], v[12:15], 0
    v_cvt_pk_bf16_f32 v128, 0, v128
    v_cvt_pk_bf16_f32 v129, 0, v129
    v_cvt_pk_bf16_f32 v130, 0, v130
    v_cvt_pk_bf16_f32 v131, 0, v131
    v_cvt_pk_bf16_f32 v132, 0, v132
    v_cvt_pk_bf16_f32 v133, 0, v133
    v_cvt_pk_bf16_f32 v134, 0, v134
    v_cvt_pk_bf16_f32 v135, 0, v135
    v_pk_mul_f32 v[128:129], v[128:129], v[144:145]
    v_pk_mul_f32 v[130:131], v[130:131], v[146:147]
    v_pk_mul_f32 v[132:133], v[132:133], v[148:149]
    v_pk_mul_f32 v[134:135], v[134:135], v[150:151]
    v_cvt_pk_bf16_f32 v128, 0, v128
    v_cvt_pk_bf16_f32 v129, 0, v129
    v_cvt_pk_bf16_f32 v130, 0, v130
    v_cvt_pk_bf16_f32 v131, 0, v131
    v_cvt_pk_bf16_f32 v132, 0, v132
    v_cvt_pk_bf16_f32 v133, 0, v133
    v_cvt_pk_bf16_f32 v134, 0, v134
    v_cvt_pk_bf16_f32 v135, 0, v135
    v_pk_add_f32 v[128:129], v[128:129], v[160:161]
    v_pk_add_f32 v[130:131], v[130:131], v[162:163]
    v_pk_add_f32 v[132:133], v[132:133], v[164:165]
    v_pk_add_f32 v[134:135], v[134:135], v[166:167]
    v_cvt_pk_bf16_f32 v16, v128, v129
    v_cvt_pk_bf16_f32 v17, v130, v131
    v_cvt_pk_bf16_f32 v18, v132, v133
    v_cvt_pk_bf16_f32 v19, v134, v135
    v_dot2_f32_bf16 v4, v16, v16, v4
    v_dot2_f32_bf16 v5, v17, v17, v5
    v_dot2_f32_bf16 v4, v18, v18, v4
    v_dot2_f32_bf16 v5, v19, v19, v5
    v_mfma_f32_16x16x32_bf16 v[240:243], v[188:191], v[16:19], v[240:243]
    v_and_b32 v7, 7, v1
    v_lshlrev_b32 v7, 15, v7
    v_bfe_u32 v9, v1, 3, 1
    v_lshl_add_u32 v7, v9, 12, v7
    v_add_f32 v4, v4, v5
    v_mov_b32 v5, v4
    s_nop 1
    v_permlane32_swap_b32 v4, v5
    v_add_f32 v4, v4, v5
    v_mov_b32 v5, v4
    s_nop 1
    v_permlane16_swap_b32 v4, v5
    v_add_f32 v4, v4, v5
    s_nop 1
    v_mov_b32_dpp v240, v4 quad_perm:[0,1,2,3] row_mask:0x8 bank_mask:0xf
    buffer_store_dword v240, v28, s[32:35], s14 offen sc1
    s_and_b32 s96, s12, 1
    s_lshr_b32 s97, s21, 2
    s_and_b32 s98, s21, 3
    s_lshl_b32 s99, s98, 6
    s_lshl1_add_u32 s98, s97, s99
    s_lshl_b32 s97, s98, 12
    s_lshr_b32 s99, s12, 1
    s_lshl_b32 s98, s99, 6
    s_add_u32 s99, s97, s98
    s_lshl2_add_u32 s97, s96, s99
    s_add_u32 s98, s97, 1048576
    s_add_u32 s16, s98, 1536
    s_barrier
    s_cmp_lg_u32 s3, 0
    s_cbranch_scc1 L_PE
    v_mov_b32 v6, s4
    s_mov_b32 exec_hi, 0
    s_mov_b32 exec_lo, 65535
    buffer_store_dword v6, v7, s[32:35], s16 offen sc1
    s_mov_b64 exec, -1
L_PE:
    s_add_u32 s82, s80, 114688
    s_lshl2_add_u32 m0, s83, 34816
    s_nop 0
    buffer_load_dwordx4 v27, s[56:59], s82 offen nt lds
    s_add_u32 s82, s80, 172032
    s_lshl2_add_u32 m0, s83, 35840
    s_nop 0
    buffer_load_dwordx4 v27, s[56:59], s82 offen nt lds
    s_lshl_b32 s15, s3, 12
    v_add_u32 v4, s15, v2
    v_add_u32 v7, 65536, v4
    s_waitcnt vmcnt(3)
    v_cmp_ne_u32 vcc, s4, v41
    s_cbranch_vccz L_UPOK
POLL_34:
    buffer_load_dwordx2 v[40:41], v10, s[32:35], s13 offen sc1
    s_waitcnt vmcnt(0)
    v_cmp_ne_u32 vcc, s4, v41
    s_cbranch_vccz PDONE_35
    s_add_u32 s5, s5, 1
    s_cmp_lt_u32 s5, 200000
    s_cbranch_scc1 POLL_34
PDONE_35:
L_UPOK:
    s_lshl3_add_u32 s96, s21, s3
    s_lshl_b32 s97, s96, 12
    s_add_u32 s14, s97, 12582912
    s_load_dwordx2 s[24:25], s[32:33], s92 offset:1536 glc
    v_add_f32_dpp v40, v40, v40 quad_perm:[1,0,3,2] row_mask:0xf bank_mask:0xf
    s_nop 1
    v_add_f32_dpp v40, v40, v40 quad_perm:[2,3,0,1] row_mask:0xf bank_mask:0xf
    s_nop 1
    v_add_f32_dpp v40, v40, v40 row_half_mirror row_mask:0xf bank_mask:0xf
    s_nop 1
    v_add_f32_dpp v40, v40, v40 row_mirror row_mask:0xf bank_mask:0xf
    v_lshlrev_b32 v152, 16, v12
    v_and_b32 v153, s6, v12
    v_lshlrev_b32 v154, 16, v13
    v_and_b32 v155, s6, v13
    v_lshlrev_b32 v156, 16, v14
    v_and_b32 v157, s6, v14
    v_lshlrev_b32 v158, 16, v15
    v_and_b32 v159, s6, v15
    v_lshlrev_b32 v160, 16, v16
    v_and_b32 v161, s6, v16
    v_lshlrev_b32 v162, 16, v17
    v_and_b32 v163, s6, v17
    v_lshlrev_b32 v164, 16, v18
    v_and_b32 v165, s6, v18
    v_lshlrev_b32 v166, 16, v19
    v_and_b32 v167, s6, v19
    s_lshl_b32 s96, s3, 9
    s_lshl1_add_u32 s15, s21, s96
    v_and_b32 v29, 15, v1
    v_lshl_add_u32 v29, v29, 5, s15
    v_xor_b32 v5, 0x4000, v4
    v_xor_b32 v8, 0x4000, v7
    s_waitcnt vmcnt(2)
    s_cmp_ge_u32 s3, 4
    s_cbranch_scc1 L_FW0
    ds_write_b128 v4, v[56:59] offset:32768
    ds_write_b128 v5, v[60:63] offset:32768
    ds_write_b128 v4, v[64:67] offset:33792
    ds_write_b128 v5, v[68:71] offset:33792
L_FW0:
    s_cmp_lt_u32 s3, 4
    s_cbranch_scc1 L_FW1
    ds_write_b128 v4, v[56:59] offset:0
    ds_write_b128 v5, v[60:63] offset:0
    ds_write_b128 v4, v[64:67] offset:1024
    ds_write_b128 v5, v[68:71] offset:1024
    ds_write_b128 v4, v[72:75] offset:2048
    ds_write_b128 v5, v[76:79] offset:2048
    ds_write_b128 v4, v[80:83] offset:3072
    ds_write_b128 v5, v[84:87] offset:3072
L_FW1:
    s_branch SCHK_37
SPOLL_36:
    s_load_dwordx2 s[24:25], s[32:33], s92 offset:1536 glc
SCHK_37:
    s_add_u32 s5, s5, 1
    s_cmp_ge_u32 s5, 200000
    s_waitcnt lgkmcnt(0)
    s_cbranch_scc1 SDONE_38
    s_cmp_lg_u32 s24, s4
    s_cbranch_scc1 SPOLL_36
    s_cmp_lg_u32 s25, s4
    s_cbranch_scc1 SPOLL_36
SDONE_38:
    s_barrier
    buffer_load_dwordx4 v[192:195], v2, s[32:35], s14 offen sc1
    buffer_load_dwordx4 v[196:199], v2, s[32:35], s14 offen offset:1024 sc1
    buffer_load_dwordx4 v[200:203], v2, s[32:35], s14 offen offset:2048 sc1
    buffer_load_dwordx4 v[204:207], v2, s[32:35], s14 offen offset:3072 sc1
L_PAD9:
    s_cbranch_execz L_RET9
    s_mov_b32 s82, s81
    s_lshl2_add_u32 m0, s83, 65536
    s_nop 0
    buffer_load_dwordx4 v253, s[60:63], s82 offen nt lds
    s_add_u32 s82, s81, 4096
    s_lshl2_add_u32 m0, s83, 66560
    s_nop 0
    buffer_load_dwordx4 v253, s[60:63], s82 offen nt lds
    s_add_u32 s82, s81, 8192
    s_lshl2_add_u32 m0, s83, 67584
    s_nop 0
    buffer_load_dwordx4 v253, s[60:63], s82 offen nt lds
    s_add_u32 s82, s81, 12288
    s_lshl2_add_u32 m0, s83, 68608
    s_nop 0
    buffer_load_dwordx4 v253, s[60:63], s82 offen nt lds
    s_lshl3_add_u32 s15, s3, 156160
    v_mov_b32 v4, s15
    v_and_b32 v5, 7, v1
    v_lshlrev_b32 v5, 3, v5
    v_add_u32 v5, 156160, v5
    v_and_b32 v6, 3, v1
    v_lshlrev_b32 v6, 18, v6
    v_bfe_u32 v9, v1, 2, 2
    v_lshl_add_u32 v6, v9, 13, v6
    s_and_b32 s96, s21, 1
    s_and_b32 s97, s12, 7
    s_lshr_b32 s98, s12, 3
    s_lshl3_add_u32 s99, s97, s98
    s_lshl_b32 s97, s99, 12
    s_lshr_b32 s98, s21, 1
    s_lshl_b32 s99, s98, 6
    s_add_u32 s98, s97, s99
    s_lshl4_add_u32 s97, s96, s98
    s_add_u32 s99, s97, 1048576
    s_add_u32 s16, s99, 2560
    s_waitcnt vmcnt(4)
    v_pk_add_f32 v[192:193], v[192:193], v[196:197]
    v_pk_add_f32 v[200:201], v[200:201], v[204:205]
    v_pk_add_f32 v[194:195], v[194:195], v[198:199]
    v_pk_add_f32 v[202:203], v[202:203], v[206:207]
    v_pk_add_f32 v[192:193], v[192:193], v[200:201]
    v_pk_add_f32 v[194:195], v[194:195], v[202:203]
    v_add_f32 v193, v193, v194
    v_add_f32 v197, v192, v195
    v_cmp_u_f32 vcc, v193, v197
    s_cbranch_vccz POK_40
PRE_41:
    buffer_load_dwordx4 v[192:195], v2, s[32:35], s14 offen sc1
    buffer_load_dwordx4 v[196:199], v2, s[32:35], s14 offen offset:1024 sc1
    buffer_load_dwordx4 v[200:203], v2, s[32:35], s14 offen offset:2048 sc1
    buffer_load_dwordx4 v[204:207], v2, s[32:35], s14 offen offset:3072 sc1
    s_waitcnt vmcnt(0)
    v_pk_add_f32 v[192:193], v[192:193], v[196:197]
    v_pk_add_f32 v[200:201], v[200:201], v[204:205]
    v_pk_add_f32 v[194:195], v[194:195], v[198:199]
    v_pk_add_f32 v[202:203], v[202:203], v[206:207]
    v_pk_add_f32 v[192:193], v[192:193], v[200:201]
    v_pk_add_f32 v[194:195], v[194:195], v[202:203]
    v_add_f32 v193, v193, v194
    v_add_f32 v197, v192, v195
    v_cmp_u_f32 vcc, v193, v197
    s_cbranch_vccz POK_40
    s_add_u32 s5, s5, 1
    s_cmp_lt_u32 s5, 200000
    s_cbranch_scc1 PRE_41
POK_40:
    v_mov_b32 v196, v195
    s_nop 1
    v_permlane32_swap_b32 v195, v196
    v_permlane32_swap_b32 v192, v193
    v_add_f32 v195, v195, v196
    v_add_f32 v192, v192, v193
    s_nop 1
    v_permlane16_swap_b32 v192, v195
    v_add_f32 v193, v192, v195
    v_add_f32 v195, v192, v195
    s_nop 1
    v_permlane16_swap_b32 v193, v195
    v_mov_b32 v192, v193
    v_mul_f32 v195, 0x3a800000, v195
    s_nop 0
    v_permlane32_swap_b32 v192, v193
    v_mul_f32 v192, 0x3a800000, v192
    v_fma_f32 v31, -v192, v192, v195
    v_cvt_pk_bf16_f32 v30, 0, v192
    v_max_f32 v31, 0, v31
    v_cvt_pk_bf16_f32 v31, 0, v31
    v_fma_f32 v193, -v30, v40, v193
    v_add_f32 v31, 0x3727c5ac, v31
    v_cvt_pk_bf16_f32 v31, 0, v31
    v_sqrt_f32 v31, v31
    s_nop 0
    v_cvt_pk_bf16_f32 v31, 0, v31
    v_rcp_f32 v31, v31
    s_nop 0
    v_mul_f32 v32, v193, v31
    v_ashrrev_i32 v196, 31, v32
    v_or_b32 v196, 0x80000000, v196
    v_xor_b32 v32, v32, v196
    s_mov_b32 s15, 0xfffff000
    v_and_or_b32 v32, v32, s15, v29
    s_nop 1
    v_max_u32_dpp v244, v32, v32 quad_perm:[1,0,3,2] row_mask:0xf bank_mask:0xf
    v_min_u32_dpp v245, v32, v32 quad_perm:[1,0,3,2] row_mask:0xf bank_mask:0xf
    s_nop 0
    v_min_u32_dpp v196, v244, v244 quad_perm:[2,3,0,1] row_mask:0xf bank_mask:0xf
    v_max_u32_dpp v245, v245, v245 quad_perm:[2,3,0,1] row_mask:0xf bank_mask:0xf
    v_max_u32_dpp v244, v244, v244 quad_perm:[2,3,0,1] row_mask:0xf bank_mask:0xf
    v_max_u32 v245, v245, v196
    s_nop 0
    v_min_u32_dpp v196, v244, v244 row_half_mirror row_mask:0xf bank_mask:0xf
    v_max_u32_dpp v245, v245, v245 row_half_mirror row_mask:0xf bank_mask:0xf
    v_max_u32_dpp v244, v244, v244 row_half_mirror row_mask:0xf bank_mask:0xf
    v_max_u32 v245, v245, v196
    s_nop 0
    v_min_u32_dpp v196, v244, v244 row_mirror row_mask:0xf bank_mask:0xf
    v_max_u32_dpp v245, v245, v245 row_mirror row_mask:0xf bank_mask:0xf
    v_max_u32_dpp v244, v244, v244 row_mirror row_mask:0xf bank_mask:0xf
    v_max_u32 v245, v245, v196
    ds_write_b64 v4, v[244:245]
    s_waitcnt lgkmcnt(0)
    s_barrier
    ds_read_b64 v[244:245], v5
    v_pk_add_f32 v[208:209], v[152:153], v[30:31] op_sel_hi:[1,0] neg_lo:[0,1] neg_hi:[0,1]
    v_pk_add_f32 v[210:211], v[154:155], v[30:31] op_sel_hi:[1,0] neg_lo:[0,1] neg_hi:[0,1]
    v_pk_add_f32 v[212:213], v[156:157], v[30:31] op_sel_hi:[1,0] neg_lo:[0,1] neg_hi:[0,1]
    v_pk_add_f32 v[214:215], v[158:159], v[30:31] op_sel_hi:[1,0] neg_lo:[0,1] neg_hi:[0,1]
    v_pk_add_f32 v[216:217], v[160:161], v[30:31] op_sel_hi:[1,0] neg_lo:[0,1] neg_hi:[0,1]
    v_pk_add_f32 v[218:219], v[162:163], v[30:31] op_sel_hi:[1,0] neg_lo:[0,1] neg_hi:[0,1]
    v_pk_add_f32 v[220:221], v[164:165], v[30:31] op_sel_hi:[1,0] neg_lo:[0,1] neg_hi:[0,1]
    v_pk_add_f32 v[222:223], v[166:167], v[30:31] op_sel_hi:[1,0] neg_lo:[0,1] neg_hi:[0,1]
    s_waitcnt lgkmcnt(0)
    v_min_u32_dpp v196, v244, v244 quad_perm:[1,0,3,2] row_mask:0xf bank_mask:0xf
    v_max_u32_dpp v245, v245, v245 quad_perm:[1,0,3,2] row_mask:0xf bank_mask:0xf
    v_max_u32_dpp v244, v244, v244 quad_perm:[1,0,3,2] row_mask:0xf bank_mask:0xf
    v_max_u32 v245, v245, v196
    s_nop 0
    v_min_u32_dpp v196, v244, v244 quad_perm:[2,3,0,1] row_mask:0xf bank_mask:0xf
    v_max_u32_dpp v245, v245, v245 quad_perm:[2,3,0,1] row_mask:0xf bank_mask:0xf
    v_max_u32_dpp v244, v244, v244 quad_perm:[2,3,0,1] row_mask:0xf bank_mask:0xf
    v_max_u32 v245, v245, v196
    s_nop 0
    v_min_u32_dpp v196, v244, v244 row_half_mirror row_mask:0xf bank_mask:0xf
    v_max_u32_dpp v245, v245, v245 row_half_mirror row_mask:0xf bank_mask:0xf
    v_max_u32_dpp v244, v244, v244 row_half_mirror row_mask:0xf bank_mask:0xf
    v_max_u32 v245, v245, v196
    v_cmp_eq_u32 s[88:89], v32, v245
    v_cmp_eq_u32 vcc, v32, v244
    v_or_b32 v246, 1, v245
    v_mov_b32 v245, s4
    v_mov_b32 v247, s4
    s_or_b64 s[84:85], vcc, s[88:89]
    s_cmp_lg_u32 s3, 0
    s_cbranch_scc1 L_NOF
    s_mov_b64 exec, 0xffff
    buffer_store_dwordx4 v[244:247], v6, s[32:35], s16 offen sc1
    s_mov_b64 exec, -1
L_NOF:
    s_lshl4_add_u32 s13, s3, 156288
    v_mov_b32 v4, s13
    v_and_b32 v5, 7, v1
    v_lshlrev_b32 v5, 4, v5
    v_add_u32 v5, 156288, v5
    s_load_dwordx8 s[24:31], s[32:33], s92 offset:2560 glc
    v_cvt_pk_bf16_f32 v208, 0, v208
    v_cvt_pk_bf16_f32 v209, 0, v209
    v_cvt_pk_bf16_f32 v210, 0, v210
    v_cvt_pk_bf16_f32 v211, 0, v211
    v_cvt_pk_bf16_f32 v212, 0, v212
    v_cvt_pk_bf16_f32 v213, 0, v213
    v_cvt_pk_bf16_f32 v214, 0, v214
    v_cvt_pk_bf16_f32 v215, 0, v215
    v_cvt_pk_bf16_f32 v216, 0, v216
    v_cvt_pk_bf16_f32 v217, 0, v217
    v_cvt_pk_bf16_f32 v218, 0, v218
    v_cvt_pk_bf16_f32 v219, 0, v219
    v_cvt_pk_bf16_f32 v220, 0, v220
    v_cvt_pk_bf16_f32 v221, 0, v221
    v_cvt_pk_bf16_f32 v222, 0, v222
    v_cvt_pk_bf16_f32 v223, 0, v223
    v_pk_mul_f32 v[208:209], v[208:209], v[30:31] op_sel:[0,1]
    v_pk_mul_f32 v[210:211], v[210:211], v[30:31] op_sel:[0,1]
    v_pk_mul_f32 v[212:213], v[212:213], v[30:31] op_sel:[0,1]
    v_pk_mul_f32 v[214:215], v[214:215], v[30:31] op_sel:[0,1]
    v_pk_mul_f32 v[216:217], v[216:217], v[30:31] op_sel:[0,1]
    v_pk_mul_f32 v[218:219], v[218:219], v[30:31] op_sel:[0,1]
    v_pk_mul_f32 v[220:221], v[220:221], v[30:31] op_sel:[0,1]
    v_pk_mul_f32 v[222:223], v[222:223], v[30:31] op_sel:[0,1]
    v_cvt_pk_bf16_f32 v208, 0, v208
    v_cvt_pk_bf16_f32 v209, 0, v209
    v_cvt_pk_bf16_f32 v210, 0, v210
    v_cvt_pk_bf16_f32 v211, 0, v211
    v_cvt_pk_bf16_f32 v212, 0, v212
    v_cvt_pk_bf16_f32 v213, 0, v213
    v_cvt_pk_bf16_f32 v214, 0, v214
    v_cvt_pk_bf16_f32 v215, 0, v215
    v_cvt_pk_bf16_f32 v216, 0, v216
    v_cvt_pk_bf16_f32 v217, 0, v217
    v_cvt_pk_bf16_f32 v218, 0, v218
    v_cvt_pk_bf16_f32 v219, 0, v219
    v_cvt_pk_bf16_f32 v220, 0, v220
    v_cvt_pk_bf16_f32 v221, 0, v221
    v_cvt_pk_bf16_f32 v222, 0, v222
    v_cvt_pk_bf16_f32 v223, 0, v223
    v_pk_mul_f32 v[208:209], v[208:209], v[168:169]
    v_pk_mul_f32 v[210:211], v[210:211], v[170:171]
    v_pk_mul_f32 v[212:213], v[212:213], v[172:173]
    v_pk_mul_f32 v[214:215], v[214:215], v[174:175]
    v_pk_mul_f32 v[216:217], v[216:217], v[176:177]
    v_pk_mul_f32 v[218:219], v[218:219], v[178:179]
    v_pk_mul_f32 v[220:221], v[220:221], v[180:181]
    v_pk_mul_f32 v[222:223], v[222:223], v[182:183]
    v_cvt_pk_bf16_f32 v208, 0, v208
    v_cvt_pk_bf16_f32 v209, 0, v209
    v_cvt_pk_bf16_f32 v210, 0, v210
    v_cvt_pk_bf16_f32 v211, 0, v211
    v_cvt_pk_bf16_f32 v212, 0, v212
    v_cvt_pk_bf16_f32 v213, 0, v213
    v_cvt_pk_bf16_f32 v214, 0, v214
    v_cvt_pk_bf16_f32 v215, 0, v215
    v_cvt_pk_bf16_f32 v216, 0, v216
    v_cvt_pk_bf16_f32 v217, 0, v217
    v_cvt_pk_bf16_f32 v218, 0, v218
    v_cvt_pk_bf16_f32 v219, 0, v219
    v_cvt_pk_bf16_f32 v220, 0, v220
    v_cvt_pk_bf16_f32 v221, 0, v221
    v_cvt_pk_bf16_f32 v222, 0, v222
    v_cvt_pk_bf16_f32 v223, 0, v223
    v_pk_add_f32 v[208:209], v[208:209], v[88:89]
    v_pk_add_f32 v[210:211], v[210:211], v[90:91]
    v_pk_add_f32 v[212:213], v[212:213], v[92:93]
    v_pk_add_f32 v[214:215], v[214:215], v[94:95]
    v_pk_add_f32 v[216:217], v[216:217], v[96:97]
    v_pk_add_f32 v[218:219], v[218:219], v[98:99]
    v_pk_add_f32 v[220:221], v[220:221], v[100:101]
    v_pk_add_f32 v[222:223], v[222:223], v[102:103]
    v_cvt_pk_bf16_f32 v224, v208, v209
    v_cvt_pk_bf16_f32 v225, v210, v211
    v_cvt_pk_bf16_f32 v226, v212, v213
    v_cvt_pk_bf16_f32 v227, v214, v215
    v_cvt_pk_bf16_f32 v228, v216, v217
    v_cvt_pk_bf16_f32 v229, v218, v219
    v_cvt_pk_bf16_f32 v230, v220, v221
    v_cvt_pk_bf16_f32 v231, v222, v223
    s_cmp_eq_u64 s[84:85], 0
    s_cbranch_scc1 L_NOCAND
    v_mfma_f32_16x16x32_bf16 v[240:243], v[184:187], v[224:227], 0
    v_mfma_f32_16x16x32_bf16 v[240:243], v[188:191], v[228:231], v[240:243]
    v_mov_b32 v232, v224
    v_mov_b32 v233, v225
    v_mov_b32 v234, v226
    v_mov_b32 v235, v227
    v_mov_b32 v236, v228
    v_mov_b32 v237, v229
    v_mov_b32 v238, v230
    v_mov_b32 v239, v231
    s_lshl_b32 s96, s21, 14
    s_lshl_b32 s97, s12, 9
    s_add_u32 s98, s96, s97
    s_add_u32 s15, s98, 13631488
    v_lshrrev_b32 v7, 4, v1
    v_lshlrev_b32 v7, 4, v7
    v_add_u32 v8, 8192, v7
    v_permlane32_swap_b32 v232, v234
    v_permlane32_swap_b32 v233, v235
    v_permlane32_swap_b32 v236, v238
    v_permlane32_swap_b32 v237, v239
    v_permlane32_swap_b32 v12, v14
    v_permlane32_swap_b32 v13, v15
    v_permlane32_swap_b32 v16, v18
    v_permlane32_swap_b32 v17, v19
    v_cndmask_b32 v7, v7, v8, s[88:89]
    s_mov_b64 exec, s[84:85]
    buffer_store_dwordx4 v[232:235], v7, s[32:35], s15 offen sc1
    buffer_store_dwordx4 v[236:239], v7, s[32:35], s15 offen offset:64 sc1
    s_mov_b32 exec_lo, 0
    s_and_b32 exec_hi, s85, 0xffff0000
    buffer_store_dword v240, v7, s[32:35], s15 offen offset:208 sc1
    s_mov_b64 exec, s[84:85]
    buffer_store_dwordx4 v[12:15], v7, s[32:35], s15 offen offset:128 sc1
    buffer_store_dwordx4 v[16:19], v7, s[32:35], s15 offen offset:192 sc1
    s_mov_b64 exec, -1
L_NOCAND:
    v_lshlrev_b32 v208, 16, v224
    v_and_b32 v209, s6, v224
    v_lshlrev_b32 v210, 16, v225
    v_and_b32 v211, s6, v225
    v_lshlrev_b32 v212, 16, v226
    v_and_b32 v213, s6, v226
    v_lshlrev_b32 v214, 16, v227
    v_and_b32 v215, s6, v227
    v_lshlrev_b32 v216, 16, v228
    v_and_b32 v217, s6, v228
    v_lshlrev_b32 v218, 16, v229
    v_and_b32 v219, s6, v229
    v_lshlrev_b32 v220, 16, v230
    v_and_b32 v221, s6, v230
    v_lshlrev_b32 v222, 16, v231
    v_and_b32 v223, s6, v231
    v_pk_mul_f32 v[208:209], v[208:209], v[104:105]
    v_pk_mul_f32 v[210:211], v[210:211], v[106:107]
    v_pk_mul_f32 v[212:213], v[212:213], v[108:109]
    v_pk_mul_f32 v[214:215], v[214:215], v[110:111]
    v_pk_mul_f32 v[216:217], v[216:217], v[112:113]
    v_pk_mul_f32 v[218:219], v[218:219], v[114:115]
    v_pk_mul_f32 v[220:221], v[220:221], v[116:117]
    v_pk_mul_f32 v[222:223], v[222:223], v[118:119]
    v_cvt_pk_bf16_f32 v208, 0, v208
    v_cvt_pk_bf16_f32 v209, 0, v209
    v_cvt_pk_bf16_f32 v210, 0, v210
    v_cvt_pk_bf16_f32 v211, 0, v211
    v_cvt_pk_bf16_f32 v212, 0, v212
    v_cvt_pk_bf16_f32 v213, 0, v213
    v_cvt_pk_bf16_f32 v214, 0, v214
    v_cvt_pk_bf16_f32 v215, 0, v215
    v_cvt_pk_bf16_f32 v216, 0, v216
    v_cvt_pk_bf16_f32 v217, 0, v217
    v_cvt_pk_bf16_f32 v218, 0, v218
    v_cvt_pk_bf16_f32 v219, 0, v219
    v_cvt_pk_bf16_f32 v220, 0, v220
    v_cvt_pk_bf16_f32 v221, 0, v221
    v_cvt_pk_bf16_f32 v222, 0, v222
    v_cvt_pk_bf16_f32 v223, 0, v223
    s_lshl_b32 s96, s3, 11
    s_add_u32 s13, s96, 98304
    v_lshrrev_b32 v202, 4, v1
    v_lshlrev_b32 v202, 4, v202
    v_and_b32 v203, 7, v1
    v_lshlrev_b32 v203, 4, v203
    v_xor_b32 v202, v202, v203
    v_and_b32 v204, 15, v1
    v_lshl_add_u32 v204, v204, 7, s13
    v_add_u32 v202, v202, v204
    v_xor_b32 v204, 64, v202
    v_lshrrev_b32 v205, 3, v1
    v_lshlrev_b32 v205, 4, v205
    v_xor_b32 v203, v205, v203
    v_lshrrev_b32 v205, 3, v1
    v_lshl_add_u32 v205, v205, 7, s13
    v_add_u32 v203, v203, v205
    s_lshl_b32 s96, s21, 7
    s_sub_u32 s97, 2047, s96
    s_lshl_b32 s98, s3, 4
    s_sub_u32 s13, s97, s98
    v_lshrrev_b32 v43, 3, v1
    v_sub_u32 v42, s13, v43
    v_subrev_u32 v43, 8, v42
    v_lshrrev_b32 v33, 3, v1
    v_lshlrev_b32 v33, 11, v33
    v_and_b32 v9, 7, v1
    v_lshl_add_u32 v33, v9, 4, v33
    s_branch SCHK_43
SPOLL_42:
    s_load_dwordx8 s[24:31], s[32:33], s92 offset:2560 glc
SCHK_43:
    s_add_u32 s5, s5, 1
    s_cmp_ge_u32 s5, 200000
    s_waitcnt lgkmcnt(0)
    s_cbranch_scc1 SDONE_44
    s_cmp_lg_u32 s25, s4
    s_cbranch_scc1 SPOLL_42
    s_cmp_lg_u32 s27, s4
    s_cbranch_scc1 SPOLL_42
    s_cmp_lg_u32 s29, s4
    s_cbranch_scc1 SPOLL_42
    s_cmp_lg_u32 s31, s4
    s_cbranch_scc1 SPOLL_42
SDONE_44:
    s_min_u32 s25, s24, s28
    s_min_u32 s27, s26, s28
    s_min_u32 s29, s24, s30
    s_max_u32 s24, s24, s28
    s_max_u32 s26, s26, s30
    s_max_u32 s27, s27, s29
    s_max_u32 s25, s25, s26
    v_mov_b32 v244, s24
    v_mov_b32 v246, s27
    v_mov_b32 v245, s25
    ds_write_b128 v4, v[244:247]
    v_pk_add_f32 v[208:209], v[208:209], v[152:153]
    v_pk_add_f32 v[210:211], v[210:211], v[154:155]
    v_pk_add_f32 v[212:213], v[212:213], v[156:157]
    v_pk_add_f32 v[214:215], v[214:215], v[158:159]
    v_pk_add_f32 v[216:217], v[216:217], v[160:161]
    v_pk_add_f32 v[218:219], v[218:219], v[162:163]
    v_pk_add_f32 v[220:221], v[220:221], v[164:165]
    v_pk_add_f32 v[222:223], v[222:223], v[166:167]
    v_cvt_pk_bf16_f32 v232, v208, v209
    v_cvt_pk_bf16_f32 v233, v210, v211
    v_cvt_pk_bf16_f32 v234, v212, v213
    v_cvt_pk_bf16_f32 v235, v214, v215
    v_cvt_pk_bf16_f32 v236, v216, v217
    v_cvt_pk_bf16_f32 v237, v218, v219
    v_cvt_pk_bf16_f32 v238, v220, v221
    v_cvt_pk_bf16_f32 v239, v222, v223
    v_permlane32_swap_b32 v232, v234
    v_permlane32_swap_b32 v233, v235
    v_permlane32_swap_b32 v236, v238
    v_permlane32_swap_b32 v237, v239
    ds_write_b128 v202, v[232:235]
    ds_write_b128 v204, v[236:239]
    ds_read_b128 v[232:235], v203
    ds_read_b128 v[236:239], v203 offset:1024
    s_lshl3_add_u32 s96, s21, s3
    s_lshl_b32 s97, s96, 15
    s_lshl_b32 s98, s12, 7
    s_add_u32 s16, s97, s98
    s_add_u32 s15, s16, 16384
    s_lshr_b32 s96, s3, 2
    s_lshl_b32 s97, s96, 15
    s_and_b32 s98, s3, 3
    s_lshl_b32 s99, s98, 5
    s_add_u32 s13, s97, s99
    v_lshrrev_b32 v34, 4, v1
    v_lshlrev_b32 v34, 13, v34
    v_bfe_u32 v9, v1, 2, 2
    v_lshl_add_u32 v34, v9, 7, v34
    v_bfe_u32 v9, v1, 3, 2
    v_lshl_add_u32 v34, v9, 5, v34
    v_and_b32 v9, 3, v1
    v_lshl_add_u32 v34, v9, 3, v34
    v_xor_b32 v34, s13, v34
    s_lshl_b32 s96, s75, 11
    s_add_u32 s13, s96, 13631488
    v_and_b32 v36, 7, v1
    v_lshl_add_u32 v36, v36, 4, s13
    v_lshrrev_b32 v9, 4, v1
    v_lshl_add_u32 v36, v9, 9, v36
    v_and_b32 v10, 15, v1
    v_lshlrev_b32 v10, 9, v10
    v_add_u32 v10, 13631744, v10
    s_waitcnt vmcnt(0)
    s_waitcnt lgkmcnt(0)
    s_barrier
    ds_read_b128 v[244:247], v5
    v_and_b32 v8, 8, v1
    v_cmp_eq_u32 s[22:23], 0, v8
    v_cmp_gt_u32 s[24:25], 16, v1
    v_cmp_gt_u32 s[26:27], 32, v1
    s_waitcnt lgkmcnt(0)
    v_min_u32_dpp v192, v244, v244 quad_perm:[1,0,3,2] row_mask:0xf bank_mask:0xf
    v_min_u32_dpp v193, v245, v244 quad_perm:[1,0,3,2] row_mask:0xf bank_mask:0xf
    v_min_u32_dpp v194, v244, v245 quad_perm:[1,0,3,2] row_mask:0xf bank_mask:0xf
    v_max_u32_dpp v246, v246, v246 quad_perm:[1,0,3,2] row_mask:0xf bank_mask:0xf
    v_max_u32_dpp v245, v245, v245 quad_perm:[1,0,3,2] row_mask:0xf bank_mask:0xf
    v_max_u32_dpp v244, v244, v244 quad_perm:[1,0,3,2] row_mask:0xf bank_mask:0xf
    v_max3_u32 v246, v246, v193, v194
    v_max_u32 v245, v245, v192
    v_min_u32_dpp v192, v244, v244 quad_perm:[2,3,0,1] row_mask:0xf bank_mask:0xf
    s_nop 0
    v_min_u32_dpp v193, v245, v244 quad_perm:[2,3,0,1] row_mask:0xf bank_mask:0xf
    v_min_u32_dpp v194, v244, v245 quad_perm:[2,3,0,1] row_mask:0xf bank_mask:0xf
    v_max_u32_dpp v246, v246, v246 quad_perm:[2,3,0,1] row_mask:0xf bank_mask:0xf
    v_max_u32_dpp v245, v245, v245 quad_perm:[2,3,0,1] row_mask:0xf bank_mask:0xf
    v_max_u32_dpp v244, v244, v244 quad_perm:[2,3,0,1] row_mask:0xf bank_mask:0xf
    v_max3_u32 v246, v246, v193, v194
    v_max_u32 v245, v245, v192
    v_min_u32_dpp v192, v244, v244 row_half_mirror row_mask:0xf bank_mask:0xf
    s_nop 0
    v_min_u32_dpp v193, v245, v244 row_half_mirror row_mask:0xf bank_mask:0xf
    v_min_u32_dpp v194, v244, v245 row_half_mirror row_mask:0xf bank_mask:0xf
    v_max_u32_dpp v246, v246, v246 row_half_mirror row_mask:0xf bank_mask:0xf
    v_max_u32_dpp v245, v245, v245 row_half_mirror row_mask:0xf bank_mask:0xf
    v_max_u32_dpp v244, v244, v244 row_half_mirror row_mask:0xf bank_mask:0xf
    v_max3_u32 v246, v246, v193, v194
    v_max_u32 v245, v245, v192
    v_cndmask_b32 v192, v245, v244, s[22:23]
    v_cndmask_b32 v201, v246, v245, s[26:27]
    v_and_b32 v193, 31, v246
    v_and_b32 v192, 31, v192
    v_cndmask_b32 v201, v201, v244, s[24:25]
    v_lshl_add_u32 v4, v192, 13, v36
    v_lshl_add_u32 v5, v193, 13, v36
    v_and_b32 v194, 31, v201
    v_lshl_add_u32 v6, v194, 13, v10
    buffer_load_dwordx4 v[192:195], v4, s[32:35], 0 offen sc1
    buffer_load_dwordx4 v[196:199], v5, s[32:35], 0 offen sc1
    buffer_load_dword v200, v6, s[32:35], 0 offen sc1
    v_readfirstlane_b32 s91, v244
    v_readfirstlane_b32 s94, v245
    v_readfirstlane_b32 s95, v246
    ds_read_b64_tr_b16 v[56:57], v34
    ds_read_b64_tr_b16 v[58:59], v34 offset:512
    ds_read_b64_tr_b16 v[60:61], v34 offset:1024
    ds_read_b64_tr_b16 v[62:63], v34 offset:1536
    ds_read_b64_tr_b16 v[64:65], v34 offset:2048
    ds_read_b64_tr_b16 v[66:67], v34 offset:2560
    ds_read_b64_tr_b16 v[68:69], v34 offset:3072
    ds_read_b64_tr_b16 v[70:71], v34 offset:3584
    ds_read_b64_tr_b16 v[72:73], v34 offset:4096
    ds_read_b64_tr_b16 v[74:75], v34 offset:4608
    ds_read_b64_tr_b16 v[76:77], v34 offset:5120
    ds_read_b64_tr_b16 v[78:79], v34 offset:5632
    ds_read_b64_tr_b16 v[80:81], v34 offset:6144
    ds_read_b64_tr_b16 v[82:83], v34 offset:6656
    ds_read_b64_tr_b16 v[84:85], v34 offset:7168
    ds_read_b64_tr_b16 v[86:87], v34 offset:7680
    s_bfe_u32 s96, s91, 262145
    s_lshl_b32 s97, s96, 7
    s_bfe_u32 s98, s91, 458757
    s_add_u32 s99, s97, s98
    s_xor_b32 s17, s99, 2047
    s_bfe_u32 s96, s94, 262145
    s_lshl_b32 s97, s96, 7
    s_bfe_u32 s98, s94, 458757
    s_add_u32 s99, s97, s98
    s_xor_b32 s18, s99, 2047
    s_bfe_u32 s96, s95, 262145
    s_lshl_b32 s97, s96, 7
    s_bfe_u32 s98, s95, 458757
    s_add_u32 s99, s97, s98
    s_xor_b32 s19, s99, 2047
    s_waitcnt lgkmcnt(0)
    v_cmp_ne_u32 s[24:25], s17, v42
    v_cmp_ne_u32 s[26:27], s18, v42
    v_cmp_ne_u32 s[28:29], s19, v42
    s_and_b64 vcc, s[24:25], s[26:27]
    s_and_b64 exec, vcc, s[28:29]
    buffer_store_dwordx4 v[232:235], v33, s[64:67], s16 offen sc1
    s_mov_b64 exec, -1
    v_cmp_ne_u32 s[24:25], s17, v43
    v_cmp_ne_u32 s[26:27], s18, v43
    v_cmp_ne_u32 s[28:29], s19, v43
    s_and_b64 vcc, s[24:25], s[26:27]
    s_and_b64 exec, vcc, s[28:29]
    buffer_store_dwordx4 v[236:239], v33, s[64:67], s15 offen sc1
    s_mov_b64 exec, -1
    s_lshl_b32 s13, s3, 6
    v_bfe_u32 v35, v1, 2, 1
    v_lshlrev_b32 v35, 9, v35
    v_bfe_u32 v9, v1, 3, 1
    v_lshl_add_u32 v35, v9, 12, v35
    v_lshrrev_b32 v9, 5, v1
    v_lshl_add_u32 v35, v9, 11, v35
    v_bfe_u32 v9, v1, 2, 2
    v_lshl_add_u32 v35, v9, 6, v35
    v_bfe_u32 v9, v1, 4, 1
    v_lshl_add_u32 v35, v9, 5, v35
    v_and_b32 v9, 3, v1
    v_lshl_add_u32 v35, v9, 3, v35
    v_xor_b32 v35, s13, v35
    v_add_u32 v35, 65536, v35
    v_and_b32 v8, 15, v1
    v_lshlrev_b32 v8, 4, v8
    v_lshrrev_b32 v9, 5, v1
    v_lshl_add_u32 v8, v9, 3, v8
    s_lshl_b32 s96, s74, 13
    s_add_u32 s14, s96, 20971520
    s_lshl3_add_u32 s96, s75, s3
    s_lshl_b32 s97, s96, 8
    s_add_u32 s20, s97, s14
    v_bfe_u32 v7, v201, 1, 4
    v_bfe_u32 v201, v201, 5, 7
    v_lshl_or_b32 v201, v7, 7, v201
    v_xor_b32 v201, 0x7ff, v201
    s_waitcnt vmcnt(2)
    v_max3_u32 v7, v192, v196, v200
    v_cmp_eq_u32 vcc, -1, v7
    s_cbranch_vccz POK_46
PRE_47:
    buffer_load_dwordx4 v[192:195], v4, s[32:35], 0 offen sc1
    buffer_load_dwordx4 v[196:199], v5, s[32:35], 0 offen sc1
    buffer_load_dword v200, v6, s[32:35], 0 offen sc1
    s_waitcnt vmcnt(0)
    v_max3_u32 v7, v192, v196, v200
    v_cmp_eq_u32 vcc, -1, v7
    s_cbranch_vccz POK_46
    s_add_u32 s5, s5, 1
    s_cmp_lt_u32 s5, 200000
    s_cbranch_scc1 PRE_47
POK_46:
    v_add_f32_dpp v200, v200, v200 quad_perm:[1,0,3,2] row_mask:0xf bank_mask:0xf
    s_nop 1
    v_add_f32_dpp v200, v200, v200 quad_perm:[2,3,0,1] row_mask:0xf bank_mask:0xf
    s_nop 1
    v_add_f32_dpp v200, v200, v200 row_half_mirror row_mask:0xf bank_mask:0xf
    s_nop 1
    v_add_f32_dpp v200, v200, v200 row_mirror row_mask:0xf bank_mask:0xf
    v_cvt_pk_bf16_f32 v200, 0, v200
    v_ashrrev_i32 v7, 31, v200
    v_or_b32 v7, 0x80000000, v7
    v_xor_b32 v200, v200, v7
    v_lshrrev_b32 v200, 16, v200
    v_lshl_or_b32 v200, v200, 11, v201
    s_nop 0
    v_readlane_b32 s24, v200, 0
    v_readlane_b32 s25, v200, 16
    v_readlane_b32 s26, v200, 32
    s_not_b64 s[28:29], s[22:23]
    s_cmp_lt_u32 s24, s25
    s_cselect_b64 s[28:29], s[22:23], s[28:29]
    s_cselect_b32 s27, s24, s25
    s_cmp_gt_u32 s26, s27
    s_cselect_b64 vcc, s[28:29], 0
    v_cndmask_b32 v192, v192, v196, vcc
    v_cndmask_b32 v193, v193, v197, vcc
    v_cndmask_b32 v194, v194, v198, vcc
    v_cndmask_b32 v195, v195, v199, vcc
    s_bitcmp1_b32 vcc_lo, 0
    s_cselect_b32 s24, s26, s24
    s_cselect_b32 s19, s17, s19
    s_cselect_b32 s17, s95, s91
    s_bitcmp1_b32 vcc_lo, 8
    s_cselect_b32 s25, s26, s25
    s_cselect_b32 s19, s18, s19
    s_cselect_b32 s18, s95, s94
    s_waitcnt lgkmcnt(0)
    v_mfma_f32_16x16x32_bf16 v[136:139], v[192:195], v[56:59], 0
    v_mfma_f32_16x16x32_bf16 v[140:143], v[192:195], v[60:63], 0
    v_mfma_f32_16x16x32_bf16 v[144:147], v[192:195], v[64:67], 0
    v_mfma_f32_16x16x32_bf16 v[148:151], v[192:195], v[68:71], 0
    v_mfma_f32_16x16x32_bf16 v[168:171], v[192:195], v[72:75], 0
    v_mfma_f32_16x16x32_bf16 v[172:175], v[192:195], v[76:79], 0
    v_mfma_f32_16x16x32_bf16 v[176:179], v[192:195], v[80:83], 0
    v_mfma_f32_16x16x32_bf16 v[180:183], v[192:195], v[84:87], 0
    s_andn2_b32 s70, 2047, s24
    s_andn2_b32 s71, 2047, s25
    v_add_f32 v196, v136, v141
    s_nop 0
    v_add_f32 v197, v146, v151
    s_nop 0
    v_add_f32 v198, v168, v173
    s_nop 0
    v_add_f32 v199, v178, v183
    v_add_f32 v196, v196, v197
    v_add_f32 v198, v198, v199
    v_mov_b32 v197, s4
    s_nop 0
    v_permlane16_swap_b32 v198, v199
    s_cmp_ge_u32 s9, 28
    s_cbranch_scc1 L_NOHP
    v_add_f32 v196, v196, v199
    s_mov_b32 exec_lo, 0xffff
    s_mov_b32 exec_hi, 0xffff
    buffer_store_dwordx2 v[196:197], v8, s[32:35], s20 offen sc1
    s_mov_b64 exec, -1
L_NOHP:
    ds_read_b64_tr_b16 v[120:121], v35
    ds_read_b64_tr_b16 v[122:123], v35 offset:1024
    ds_read_b64_tr_b16 v[124:125], v35 offset:8192
    ds_read_b64_tr_b16 v[126:127], v35 offset:9216
    ds_read_b64_tr_b16 v[128:129], v35 offset:16384
    ds_read_b64_tr_b16 v[130:131], v35 offset:17408
    ds_read_b64_tr_b16 v[132:133], v35 offset:24576
    ds_read_b64_tr_b16 v[134:135], v35 offset:25600
    v_cmp_eq_u32 vcc, s19, v42
    s_nop 0
    s_and_b64 exec, vcc, -1
    s_cbranch_execz L_NOLO0
    buffer_store_dwordx4 v[232:235], v33, s[64:67], s16 offen sc1
L_NOLO0:
    s_mov_b64 exec, -1
    v_cmp_eq_u32 vcc, s19, v43
    s_nop 0
    s_and_b64 exec, vcc, -1
    s_cbranch_execz L_NOLO1
    buffer_store_dwordx4 v[236:239], v33, s[64:67], s15 offen sc1
L_NOLO1:
    s_mov_b64 exec, -1
    s_cmp_lg_u32 s93, 7
    s_cbranch_scc1 L_NONON
    v_mov_b32 v6, s4
    v_mov_b32 v7, 0
    s_mov_b64 exec, 1
    buffer_store_dword v6, v7, s[32:35], 0 offen sc1
    s_mov_b64 exec, -1
L_NONON:
    s_cmp_ge_u32 s9, 28
    s_cbranch_scc1 L_FIN
    s_cmp_lg_u32 s3, 7
    s_cbranch_scc1 L_NOFZ
    s_bitcmp1_b32 s9, 3
    s_cselect_b32 s15, s25, s24
    s_cselect_b32 s17, s18, s17
    s_andn2_b32 s18, 2047, s15
    s_lshr_b32 s96, s8, 1
L_PAD10:
    s_cbranch_execz L_RET10
    s_lshl2_add_u32 s19, s12, s96
    s_lshr_b32 s96, s19, 1
    s_lshr_b32 s97, s9, 3
    s_lshl_b32 s98, s97, 1
    s_lshl2_add_u32 s99, s96, s98
    s_and_b32 s97, s19, 1
    s_add_u32 s96, s99, s97
    s_mul_i32 s98, s96, 7168
    s_add_u32 s20, s98, 22020096
    s_lshl_b32 s96, s18, 11
    s_lshl_b32 s97, s19, 5
    s_add_u32 s82, s96, s97
    v_and_b32 v10, 7, v1
    v_lshlrev_b32 v10, 2, v10
    s_lshr_b32 s96, s8, 1
    s_lshl_b32 s97, s96, 6
    s_add_u32 s13, s97, 157184
    v_and_b32 v5, 7, v1
    v_lshl_add_u32 v5, v5, 3, s13
    ds_read_b64 v[206:207], v5
    s_and_b32 s96, s17, 31
    s_lshl_b32 s97, s96, 13
    s_lshl_b32 s98, s12, 9
    s_add_u32 s99, s97, s98
    s_lshr_b32 s96, s8, 1
    s_lshl_b32 s97, s96, 5
    s_add_u32 s98, s99, s97
    s_add_u32 s68, s98, 13631488
    s_lshr_b32 s13, s15, 11
    s_lshl_b32 s13, s13, 16
    s_ashr_i32 s15, s13, 31
    s_andn2_b32 s15, 0x7fff0000, s15
    s_or_b32 s15, s15, 0x80000000
    s_xor_b32 s13, s13, s15
    v_mov_b32 v204, s13
    v_mul_f32 v204, s7, v204
    v_exp_f32 v204, -v204
    s_nop 0
    v_add_f32 v204, 1.0, v204
    v_rcp_f32 v204, v204
    s_nop 0
    v_cvt_pk_bf16_f32 v204, 0, v204
L_NOFZ:
    s_cmp_ge_u32 s3, 4
    s_cbranch_scc1 L_NOH
    s_lshl_b32 s96, s3, 8
    s_add_u32 s13, s96, s14
    v_lshrrev_b32 v4, 4, v1
    v_lshlrev_b32 v4, 11, v4
    v_and_b32 v9, 15, v1
    v_lshl_add_u32 v4, v9, 4, v4
    s_lshl_b32 s96, s3, 5
    s_add_u32 s15, s96, 156672
    v_lshrrev_b32 v5, 5, v1
    v_lshl_add_u32 v5, v5, 7, s15
    v_bfe_u32 v9, v1, 2, 1
    v_lshl_add_u32 v5, v9, 4, v5
    v_bfe_u32 v9, v1, 1, 1
    v_lshl_add_u32 v5, v9, 3, v5
    v_bfe_u32 v9, v1, 3, 1
    v_lshl_add_u32 v5, v9, 2, v5
    v_and_b32 v9, 1, v1
    v_lshl_add_u32 v5, v9, 1, v5
SPOLL_48:
    s_load_dword s24, s[32:33], s13 offset:1276 glc
    s_load_dword s25, s[32:33], s13 offset:3324 glc
    s_load_dword s26, s[32:33], s13 offset:5372 glc
    s_load_dword s27, s[32:33], s13 offset:7420 glc
SCHK_49:
    s_add_u32 s5, s5, 1
    s_cmp_ge_u32 s5, 200000
    s_waitcnt lgkmcnt(0)
    s_cbranch_scc1 SDONE_50
    s_cmp_lg_u32 s24, s4
    s_cbranch_scc1 SPOLL_48
    s_cmp_lg_u32 s25, s4
    s_cbranch_scc1 SPOLL_48
    s_cmp_lg_u32 s26, s4
    s_cbranch_scc1 SPOLL_48
    s_cmp_lg_u32 s27, s4
    s_cbranch_scc1 SPOLL_48
SDONE_50:
POLL_51:
    buffer_load_dwordx4 v[88:91], v4, s[32:35], s13 offen sc1
    buffer_load_dwordx4 v[92:95], v4, s[32:35], s13 offen offset:1024 sc1
    s_waitcnt vmcnt(0)
    v_bitop3_b32 v6, v89, v91, s4 bitop3:0x7e
    v_bitop3_b32 v6, v6, v93, s4 bitop3:0xf6
    v_bitop3_b32 v6, v6, v95, s4 bitop3:0xf6
    v_cmp_ne_u32 vcc, 0, v6
    s_cbranch_vccz PDONE_52
    s_add_u32 s5, s5, 1
    s_cmp_lt_u32 s5, 200000
    s_cbranch_scc1 POLL_51
PDONE_52:
    v_permlane32_swap_b32 v88, v90
    v_permlane32_swap_b32 v92, v94
    v_add_f32 v88, v88, v90
    v_add_f32 v92, v92, v94
    v_mov_b32 v90, v88
    v_mov_b32 v94, v92
    s_nop 0
    v_permlane16_swap_b32 v88, v90
    v_permlane16_swap_b32 v92, v94
    v_add_f32 v88, v88, v90
    v_add_f32 v92, v92, v94
    v_cvt_pk_bf16_f32 v88, 0, v88
    v_cvt_pk_bf16_f32 v92, 0, v92
    v_mul_f32 v6, s7, v88
    v_exp_f32 v6, -v6
    s_nop 0
    v_add_f32 v6, 1.0, v6
    v_rcp_f32 v6, v6
    s_nop 0
    v_mul_f32 v88, v88, v6
    v_cvt_pk_bf16_f32 v88, 0, v88
    v_mul_f32 v88, v88, v92
    v_cvt_pk_bf16_f32 v88, v88, v88
    ds_write_b16 v5, v88
L_NOH:
    v_bfe_u32 v4, v1, 2, 1
    v_lshlrev_b32 v4, 7, v4
    v_lshrrev_b32 v9, 5, v1
    v_lshl_add_u32 v4, v9, 4, v4
    v_add_u32 v4, 156672, v4
    v_lshrrev_b32 v5, 4, v1
    v_mul_u32_u24 v5, 7168, v5
    v_and_b32 v9, 15, v1
    v_lshl_add_u32 v5, v9, 3, v5
    s_lshl3_add_u32 s96, s75, s3
    s_mul_i32 s97, s96, 28672
    s_lshl_b32 s98, s74, 7
    s_add_u32 s99, s97, s98
    s_add_u32 s13, s99, 22020096
    v_and_b32 v6, 1, v1
    v_lshlrev_b32 v6, 13, v6
    v_bfe_u32 v9, v1, 1, 1
    v_lshl_add_u32 v6, v9, 18, v6
    s_lshr_b32 s96, s9, 2
    s_and_b32 s97, s75, 1
    s_lshr_b32 s98, s3, 1
    s_lshl2_add_u32 s99, s97, s98
    s_and_b32 s97, s3, 1
    s_lshr_b32 s98, s75, 1
    s_lshl2_add_u32 s97, s97, s98
    s_lshl3_add_u32 s98, s99, s97
    s_lshl_b32 s99, s98, 12
    s_lshl_b32 s97, s8, 6
    s_add_u32 s98, s99, s97
    s_lshl2_add_u32 s99, s96, s98
    s_add_u32 s97, s99, 1048576
    s_add_u32 s14, s97, 3072
    s_waitcnt lgkmcnt(0)
    s_barrier
    ds_read_b128 v[88:91], v4
    ds_read_b128 v[92:95], v4 offset:32
    ds_read_b128 v[96:99], v4 offset:64
    ds_read_b128 v[100:103], v4 offset:96
    s_waitcnt lgkmcnt(3)
    v_mfma_f32_32x32x16_bf16 v[208:223], v[88:91], v[120:123], 0
    s_waitcnt lgkmcnt(2)
    v_mfma_f32_32x32x16_bf16 v[208:223], v[92:95], v[124:127], v[208:223]
    s_waitcnt lgkmcnt(1)
    v_mfma_f32_32x32x16_bf16 v[208:223], v[96:99], v[128:131], v[208:223]
    s_waitcnt lgkmcnt(0)
    v_mfma_f32_32x32x16_bf16 v[208:223], v[100:103], v[132:135], v[208:223]
    s_nop 11
    v_mov_b32 v209, s4
    buffer_store_dwordx2 v[208:209], v5, s[32:35], s13 offen sc1
    s_mov_b64 exec, 15
    buffer_store_dword v209, v6, s[32:35], s14 offen sc1
    s_mov_b64 exec, -1
    s_cmp_ge_u32 s9, 16
    s_cbranch_scc1 L_FIN
SPOLL_53:
    s_load_dwordx8 s[24:31], s[32:33], s92 offset:3072 glc
SCHK_54:
    s_add_u32 s5, s5, 1
    s_cmp_ge_u32 s5, 200000
    s_waitcnt lgkmcnt(0)
    s_cbranch_scc1 SDONE_55
    s_cmp_lg_u32 s24, s4
    s_cbranch_scc1 SPOLL_53
    s_cmp_lg_u32 s25, s4
    s_cbranch_scc1 SPOLL_53
    s_cmp_lg_u32 s26, s4
    s_cbranch_scc1 SPOLL_53
    s_cmp_lg_u32 s27, s4
    s_cbranch_scc1 SPOLL_53
    s_cmp_lg_u32 s28, s4
    s_cbranch_scc1 SPOLL_53
    s_cmp_lg_u32 s29, s4
    s_cbranch_scc1 SPOLL_53
    s_cmp_lg_u32 s30, s4
    s_cbranch_scc1 SPOLL_53
SDONE_55:
    s_barrier
    s_cmp_lg_u32 s3, 7
    s_cbranch_scc1 L_FIN
    s_add_u32 s13, s20, 4096
    v_mov_b32 v5, s4
    v_not_b32 v6, v5
POLL_56:
    buffer_load_dwordx4 v[88:91], v2, s[32:35], s20 offen sc1
    buffer_load_dwordx4 v[92:95], v2, s[32:35], s20 offen offset:1024 sc1
    buffer_load_dwordx4 v[96:99], v2, s[32:35], s20 offen offset:2048 sc1
    buffer_load_dwordx4 v[100:103], v2, s[32:35], s20 offen offset:3072 sc1
    buffer_load_dwordx4 v[104:107], v2, s[32:35], s13 offen sc1
    buffer_load_dwordx4 v[108:111], v2, s[32:35], s13 offen offset:1024 sc1
    buffer_load_dwordx4 v[112:115], v2, s[32:35], s13 offen offset:2048 sc1
    buffer_load_dword v244, v10, s[32:35], s68 offen sc1
    buffer_load_dword v245, v10, s[32:35], s68 offen offset:128 sc1
    s_waitcnt vmcnt(0)
    v_max_u32 v246, v244, v245
    v_cmp_ne_u32 vcc, -1, v246
    s_nop 1
    v_cndmask_b32 v246, v6, v5, vcc
    v_bitop3_b32 v4, v89, v91, s4 bitop3:0x7e
    v_bitop3_b32 v4, v4, v93, s4 bitop3:0xf6
    v_bitop3_b32 v4, v4, v95, s4 bitop3:0xf6
    v_bitop3_b32 v4, v4, v97, s4 bitop3:0xf6
    v_bitop3_b32 v4, v4, v99, s4 bitop3:0xf6
    v_bitop3_b32 v4, v4, v101, s4 bitop3:0xf6
    v_bitop3_b32 v4, v4, v103, s4 bitop3:0xf6
    v_bitop3_b32 v4, v4, v105, s4 bitop3:0xf6
    v_bitop3_b32 v4, v4, v107, s4 bitop3:0xf6
    v_bitop3_b32 v4, v4, v109, s4 bitop3:0xf6
    v_bitop3_b32 v4, v4, v111, s4 bitop3:0xf6
    v_bitop3_b32 v4, v4, v113, s4 bitop3:0xf6
    v_bitop3_b32 v4, v4, v115, s4 bitop3:0xf6
    v_bitop3_b32 v4, v4, v246, s4 bitop3:0xf6
    v_cmp_ne_u32 vcc, 0, v4
    s_cbranch_vccz PDONE_57
    s_add_u32 s5, s5, 1
    s_cmp_lt_u32 s5, 200000
    s_cbranch_scc1 POLL_56
PDONE_57:
    v_add_f32 v88, v88, v92
    v_add_f32 v90, v90, v94
    v_add_f32 v88, v88, v96
    v_add_f32 v90, v90, v98
    v_add_f32 v88, v88, v100
    v_add_f32 v90, v90, v102
    v_add_f32 v88, v88, v104
    v_add_f32 v90, v90, v106
    v_add_f32 v88, v88, v108
    v_add_f32 v90, v90, v110
    v_add_f32 v88, v88, v112
    v_add_f32 v90, v90, v114
    v_mov_b32 v89, v90
    v_add_f32_dpp v88, v88, v88 row_ror:8 row_mask:0xf bank_mask:0xf
    s_nop 0
    v_add_f32_dpp v89, v89, v89 row_ror:8 row_mask:0xf bank_mask:0xf
    v_mov_b32 v90, v88
    v_mov_b32 v91, v89
    s_nop 0
    v_permlane16_swap_b32 v88, v90
    v_permlane16_swap_b32 v89, v91
    v_pk_add_f32 v[88:89], v[88:89], v[90:91]
    v_mov_b32 v90, v88
    v_mov_b32 v91, v89
    s_nop 0
    v_permlane32_swap_b32 v88, v90
    v_permlane32_swap_b32 v89, v91
    v_pk_add_f32 v[88:89], v[88:89], v[90:91]
    v_cvt_pk_bf16_f32 v88, 0, v88
    v_cvt_pk_bf16_f32 v89, 0, v89
    v_pk_mul_f32 v[88:89], v[88:89], v[204:205] op_sel_hi:[1,0]
    v_lshlrev_b32 v4, 16, v244
    v_and_b32 v5, s6, v244
    v_cvt_pk_bf16_f32 v88, 0, v88
    v_cvt_pk_bf16_f32 v89, 0, v89
    v_pk_add_f32 v[88:89], v[88:89], v[4:5]
    v_cvt_pk_bf16_f32 v88, 0, v88
    v_cvt_pk_bf16_f32 v89, 0, v89
    v_pk_mul_f32 v[88:89], v[88:89], v[206:207]
    v_lshlrev_b32 v4, 16, v245
    v_and_b32 v5, s6, v245
    v_cvt_pk_bf16_f32 v88, 0, v88
    v_cvt_pk_bf16_f32 v89, 0, v89
    v_pk_add_f32 v[88:89], v[88:89], v[4:5]
    v_cvt_pk_bf16_f32 v88, v88, v89
    s_mov_b64 exec, 0xff
    buffer_store_dword v88, v10, s[64:67], s82 offen sc1
    s_mov_b64 exec, -1
L_FIN:
L_END:
    s_endpgm
.p2align 10
.fill 768, 4, 0xbf800000
.section .rodata,"a"
.p2align 6
.amdhsa_kernel adaLN_cond__linear_kernel_hedgehog__moe_arch_mod__prompt_kernel
  .amdhsa_next_free_vgpr 256
  .amdhsa_next_free_sgpr 102
  .amdhsa_accum_offset 256
  .amdhsa_group_segment_fixed_size 0
  .amdhsa_kernarg_size 112
  .amdhsa_user_sgpr_count 2
  .amdhsa_user_sgpr_kernarg_segment_ptr 1
  .amdhsa_system_sgpr_workgroup_id_x 1
  .amdhsa_float_denorm_mode_32 3
  .amdhsa_float_denorm_mode_16_64 3
.end_amdhsa_kernel
```

```asm
; @launch grid=(256,1,1) block=(512,1,1) lds=163840
.amdgcn_target "amdgcn-amd-amdhsa--gfx950"
.text
.globl adaLN_cond__linear_kernel_hedgehog__moe_arch_mod__prompt_kernel
.p2align 12
.type adaLN_cond__linear_kernel_hedgehog__moe_arch_mod__prompt_kernel,@function
adaLN_cond__linear_kernel_hedgehog__moe_arch_mod__prompt_kernel:
    s_load_dwordx16 s[68:83], s[0:1], 0
    s_load_dwordx8 s[84:91], s[0:1], 64
    s_load_dwordx2 s[32:33], s[0:1], 104
    s_cmp_ge_u32 s2, 256
    s_cbranch_scc1 L_END
    v_lshrrev_b32 v4, 6, v0
    v_and_b32 v1, 63, v0
    s_nop 0
    v_readfirstlane_b32 s3, v4
    v_lshlrev_b32 v2, 4, v1
    s_mov_b32 s38, 4194304
    s_mov_b32 s39, 0x20000
    s_mov_b32 s50, 12582912
    s_mov_b32 s51, 0x20000
    s_mov_b32 s34, 268435456
    s_mov_b32 s35, 0x20000
    s_mov_b32 s42, 6291456
    s_mov_b32 s43, 0x20000
    s_mov_b32 s46, 2097152
    s_mov_b32 s47, 0x20000
    s_mov_b32 s54, 7340032
    s_mov_b32 s55, 0x20000
    s_mov_b32 s58, 7340032
    s_mov_b32 s59, 0x20000
    s_mov_b32 s62, 7340032
    s_mov_b32 s63, 0x20000
    s_mov_b32 s66, 4194304
    s_mov_b32 s67, 0x20000
    s_mov_b32 s5, 0
    s_mov_b32 s6, 0xffff0000
    s_mov_b32 s7, 0x3fb8aa3b
    s_and_b32 s8, s2, 7
    s_lshr_b32 s9, s2, 3
    s_lshl_b32 s96, s8, 5
    s_add_u32 s97, s96, s9
    s_lshl3_add_u32 s93, s97, s3
    s_and_b32 s96, s8, 4
    s_lshr_b32 s97, s9, 2
    s_lshl1_add_u32 s10, s96, s97
    s_and_b32 s96, s8, 3
    s_and_b32 s97, s9, 3
    s_xor_b32 s98, s97, 2
    s_lshl2_add_u32 s11, s96, s98
    s_and_b32 s96, s8, 1
    s_and_b32 s97, s9, 7
    s_lshl3_add_u32 s12, s96, s97
    s_lshr_b32 s96, s8, 1
    s_lshr_b32 s97, s9, 3
    s_lshl2_add_u32 s21, s96, s97
    s_lshl_b32 s96, s2, 6
    s_add_u32 s97, s96, s3
    s_lshl_b32 s98, s97, 6
    s_add_u32 s92, s98, 1048576
    s_lshl_b32 s16, s93, 11
    s_lshl3_add_u32 s96, s8, s3
    s_lshl_b32 s15, s96, 5
    s_mul_i32 s96, s15, 6144
    s_xor_b32 s97, s9, 1
    s_lshl_b32 s98, s97, 7
    s_add_u32 s13, s96, s98
    s_add_u32 s14, s13, 98304
    s_lshl3_add_u32 s96, s21, s3
    s_lshl_b32 s97, s96, 15
    s_lshl_b32 s98, s12, 7
    s_add_u32 s18, s97, s98
    s_lshr_b32 s96, s8, 1
    s_lshl4_add_u32 s97, s96, s12
    s_lshl4_add_u32 s98, s97, s3
    s_lshl_b32 s99, s98, 9
    s_add_u32 s17, s99, 524288
    v_lshrrev_b32 v248, 3, v1
    v_mul_u32_u24 v248, 12288, v248
    v_and_b32 v9, 7, v1
    v_lshl_add_u32 v248, v9, 4, v248
    v_lshrrev_b32 v249, 3, v1
    v_lshl_add_u32 v249, v249, 1, s15
    v_and_b32 v10, 15, v1
    v_lshlrev_b32 v10, 11, v10
    v_lshrrev_b32 v9, 4, v1
    v_lshl_add_u32 v10, v9, 4, v10
    s_waitcnt lgkmcnt(0)
    s_mov_b64 s[36:37], s[68:69]
    buffer_load_dwordx4 v[152:155], v2, s[36:39], s16 offen
    buffer_load_dwordx4 v[156:159], v2, s[36:39], s16 offen offset:1024
    s_load_dword s4, s[32:33], 0
    s_mov_b64 s[48:49], s[88:89]
    s_load_dword s24, s[32:33], s92 offset:0 glc
    s_load_dword s25, s[32:33], s17 offset:508 glc
    s_load_dword s26, s[32:33], s17 offset:4604 glc
    global_load_ushort v168, v249, s[86:87]
    global_load_ushort v169, v249, s[86:87] offset:16
    s_barrier
    buffer_load_dwordx4 v[160:163], v248, s[48:51], s13 offen nt
    buffer_load_dwordx4 v[164:167], v248, s[48:51], s14 offen nt
    s_mov_b64 s[40:41], s[70:71]
    s_mov_b64 s[44:45], s[74:75]
    s_mov_b64 s[52:53], s[80:81]
    s_mov_b64 s[56:57], s[82:83]
    s_mov_b64 s[60:61], s[84:85]
    s_mov_b64 s[64:65], s[90:91]
    s_getpc_b64 s[22:23]
    s_and_b32 s22, s22, 0xfffffc00
    s_lshl3_add_u32 s96, s9, s3
    s_lshl_b32 s19, s96, 7
    v_lshrrev_b32 v4, 5, v1
    v_lshl_add_u32 v4, v4, 15, s19
    v_min_u32 v4, 41984, v4
    global_load_dword v11, v4, s[22:23]
    s_lshr_b32 s76, s3, 2
    s_and_b32 s77, s3, 3
    s_lshl_b32 s83, s3, 10
    s_mul_i32 s96, s8, 7
    s_lshr_b32 s97, s9, 2
    s_add_u32 s74, s96, s97
    s_and_b32 s75, s9, 3
    v_bfe_u32 v6, v1, 4, 1
    v_lshlrev_b32 v6, 6, v6
    v_and_b32 v3, 7, v1
    v_lshlrev_b32 v3, 4, v3
    v_xor_b32 v3, v3, v6
    v_lshrrev_b32 v6, 3, v1
    v_mul_u32_u24 v6, 6144, v6
    v_add_u32 v3, v3, v6
    s_and_b32 s84, s9, 12
    s_mul_i32 s96, s3, 49152
    s_lshl_b32 s97, s11, 7
    s_add_u32 s85, s96, s97
    v_lshlrev_b32 v250, 3, v1
    v_lshlrev_b32 v251, 5, v1
    v_add_u32 v251, 147456, v251
    s_lshl2_add_u32 s13, s3, 147456
    v_lshrrev_b32 v252, 4, v1
    v_lshl_add_u32 v252, v252, 6, s13
    v_and_b32 v9, 7, v1
    v_lshl_add_u32 v252, v9, 8, v252
    v_bfe_u32 v9, v1, 3, 1
    v_lshl_add_u32 v252, v9, 5, v252
    s_waitcnt vmcnt(5)
    v_mov_b32 v8, 0x3f803f80
    v_dot2_f32_bf16 v4, v152, v8, 0
    v_dot2_f32_bf16 v5, v152, v152, 0
    v_dot2_f32_bf16 v6, v153, v8, 0
    v_dot2_f32_bf16 v7, v153, v153, 0
    v_dot2_f32_bf16 v4, v154, v8, v4
    v_dot2_f32_bf16 v5, v154, v154, v5
    v_dot2_f32_bf16 v6, v155, v8, v6
    v_dot2_f32_bf16 v7, v155, v155, v7
    v_dot2_f32_bf16 v4, v156, v8, v4
    v_dot2_f32_bf16 v5, v156, v156, v5
    v_dot2_f32_bf16 v6, v157, v8, v6
    v_dot2_f32_bf16 v7, v157, v157, v7
    v_dot2_f32_bf16 v4, v158, v8, v4
    v_dot2_f32_bf16 v5, v158, v158, v5
    v_dot2_f32_bf16 v6, v159, v8, v6
    v_dot2_f32_bf16 v7, v159, v159, v7
    s_nop 2
    v_pk_add_f32 v[4:5], v[4:5], v[6:7]
    s_nop 1
    v_add_f32_dpp v4, v4, v4 quad_perm:[1,0,3,2] row_mask:0xf bank_mask:0xf
    v_add_f32_dpp v5, v5, v5 quad_perm:[1,0,3,2] row_mask:0xf bank_mask:0xf
    s_nop 0
    v_add_f32_dpp v4, v4, v4 quad_perm:[2,3,0,1] row_mask:0xf bank_mask:0xf
    v_add_f32_dpp v5, v5, v5 quad_perm:[2,3,0,1] row_mask:0xf bank_mask:0xf
    s_nop 0
    v_add_f32_dpp v4, v4, v4 row_half_mirror row_mask:0xf bank_mask:0xf
    v_add_f32_dpp v5, v5, v5 row_half_mirror row_mask:0xf bank_mask:0xf
    s_nop 0
    v_add_f32_dpp v4, v4, v4 row_ror:8 row_mask:0xf bank_mask:0xf
    v_add_f32_dpp v5, v5, v5 row_ror:8 row_mask:0xf bank_mask:0xf
    s_nop 1
    v_permlane16_swap_b32 v4, v5
    v_add_f32 v8, v4, v5
    v_add_f32 v4, v4, v5
    s_nop 1
    v_permlane32_swap_b32 v4, v8
    v_add_f32 v4, v4, v8
    v_mul_f32 v8, 0x3a800000, v4
    v_mul_f32 v4, 0x3a800000, v4
    s_nop 1
    v_permlane16_swap_b32 v4, v8
    v_fma_f32 v173, -v4, v4, v8
    v_cvt_pk_bf16_f32 v172, 0, v4
    v_max_f32 v173, 0, v173
    v_cvt_pk_bf16_f32 v173, 0, v173
    v_add_f32 v173, 0x3727c5ac, v173
    v_cvt_pk_bf16_f32 v173, 0, v173
    v_sqrt_f32 v173, v173
    s_nop 0
    v_cvt_pk_bf16_f32 v173, 0, v173
    s_lshl3_add_u32 s13, s3, 153600
    s_waitcnt lgkmcnt(0)
    s_mul_i32 s4, s4, 0x9e3779b1
    s_add_u32 s4, s4, 0x7f4a7c15
    v_lshrrev_b32 v172, 16, v172
    v_or_b32 v172, v172, v173
    v_mov_b32 v173, s4
    v_mov_b32 v4, s13
    ds_write_b64 v4, v[172:173]
    v_and_b32 v5, 3, v1
    v_lshlrev_b32 v5, 4, v5
    v_add_u32 v5, 153600, v5
    v_and_b32 v4, 3, v1
    v_lshlrev_b32 v4, 4, v4
    v_bfe_u32 v9, v1, 2, 1
    v_lshl_add_u32 v4, v9, 10, v4
    s_and_b32 s96, s8, 6
    s_and_b32 s97, s8, 1
    s_lshr_b32 s98, s9, 4
    s_lshl1_add_u32 s99, s97, s98
    s_lshl_b32 s97, s99, 6
    s_add_u32 s98, s96, s97
    s_lshl3_add_u32 s99, s3, s98
    s_lshl_b32 s96, s99, 10
    s_and_b32 s97, s9, 15
    s_lshl_b32 s98, s97, 6
    s_add_u32 s99, s96, s98
    s_add_u32 s13, s99, 262144
    s_waitcnt lgkmcnt(0)
    s_barrier
    ds_read_b128 v[172:175], v5
    s_waitcnt lgkmcnt(0)
    s_mov_b64 exec, 0xff
    buffer_store_dwordx4 v[172:175], v4, s[32:35], s13 offen sc1
    s_mov_b64 exec, -1
    buffer_load_dwordx4 v[12:15], v10, s[36:39], s18 offen
    buffer_load_dwordx4 v[16:19], v10, s[36:39], s18 offen offset:64
    s_lshl_b32 s96, s11, 12
    s_lshl_b32 s97, s3, 9
    s_add_u32 s13, s96, s97
    v_add_u32 v4, s13, v2
    s_lshl_b32 s96, s3, 9
    s_add_u32 m0, s96, 159744
    s_mov_b32 exec_hi, 0
    global_load_lds_dwordx4 v4, s[72:73]
    s_mov_b32 exec_hi, -1
    s_lshr_b32 s96, s9, 4
    s_lshl_b32 s94, s96, 1
    s_add_u32 s96, s94, s84
    s_and_b32 s97, s96, 15
    s_mul_i32 s98, s97, 393216
    s_add_u32 s91, s98, s85
    s_lshl_b32 s96, s94, 13
    s_add_u32 s94, s96, s83
    s_add_u32 s82, s91, 2048
    s_mov_b32 m0, s94
    s_nop 0
    buffer_load_dwordx4 v3, s[40:43], s82 offen lds
    s_add_u32 s82, s91, 4096
    s_add_u32 m0, s94, 49152
    s_nop 0
    buffer_load_dwordx4 v3, s[40:43], s82 offen lds
    s_waitcnt vmcnt(9)
    v_lshlrev_b32 v168, 16, v168
    v_mul_f32 v4, s7, v168
    v_exp_f32 v4, -v4
    s_nop 0
    v_add_f32 v4, 1.0, v4
    v_rcp_f32 v4, v4
    s_nop 0
    v_mul_f32 v168, v168, v4
    v_cvt_pk_bf16_f32 v168, 0, v168
    v_lshlrev_b32 v169, 16, v169
    v_mul_f32 v5, s7, v169
    v_exp_f32 v5, -v5
    s_nop 0
    v_add_f32 v5, 1.0, v5
    v_rcp_f32 v5, v5
    s_nop 0
    v_mul_f32 v169, v169, v5
    v_cvt_pk_bf16_f32 v169, 0, v169
    s_lshr_b32 s96, s3, 1
    s_xor_b32 s97, s9, 1
    s_and_b32 s98, s97, 15
    s_lshl4_add_u32 s99, s96, s98
    s_lshr_b32 s97, s9, 4
    s_lshl1_add_u32 s96, s99, s97
    s_lshl3_add_u32 s98, s96, s8
    s_lshl_b32 s99, s98, 9
    s_add_u32 s13, s99, 524288
    s_lshl3_add_u32 s96, s2, s3
    s_lshl_b32 s97, s96, 7
    s_add_u32 s14, s97, 262144
    v_and_b32 v8, 15, v1
    v_lshlrev_b32 v8, 3, v8
    s_waitcnt vmcnt(7)
    v_lshlrev_b32 v4, 16, v160
    v_and_b32 v5, s6, v160
    v_pk_mul_f32 v[176:177], v[4:5], v[168:169] op_sel:[0,0] op_sel_hi:[1,0]
    v_lshlrev_b32 v6, 16, v161
    v_and_b32 v7, s6, v161
    v_pk_mul_f32 v[178:179], v[6:7], v[168:169] op_sel:[0,0] op_sel_hi:[1,0]
    v_lshlrev_b32 v4, 16, v162
    v_and_b32 v5, s6, v162
    v_pk_mul_f32 v[180:181], v[4:5], v[168:169] op_sel:[0,0] op_sel_hi:[1,0]
    v_lshlrev_b32 v6, 16, v163
    v_and_b32 v7, s6, v163
    v_pk_mul_f32 v[182:183], v[6:7], v[168:169] op_sel:[0,0] op_sel_hi:[1,0]
    v_lshlrev_b32 v4, 16, v164
    v_and_b32 v5, s6, v164
    v_pk_fma_f32 v[176:177], v[4:5], v[168:169], v[176:177] op_sel:[0,1,0] op_sel_hi:[1,1,1]
    v_lshlrev_b32 v6, 16, v165
    v_and_b32 v7, s6, v165
    v_pk_fma_f32 v[178:179], v[6:7], v[168:169], v[178:179] op_sel:[0,1,0] op_sel_hi:[1,1,1]
    v_lshlrev_b32 v4, 16, v166
    v_and_b32 v5, s6, v166
    v_pk_fma_f32 v[180:181], v[4:5], v[168:169], v[180:181] op_sel:[0,1,0] op_sel_hi:[1,1,1]
    v_lshlrev_b32 v6, 16, v167
    v_and_b32 v7, s6, v167
    v_pk_fma_f32 v[182:183], v[6:7], v[168:169], v[182:183] op_sel:[0,1,0] op_sel_hi:[1,1,1]
    v_permlane32_swap_b32 v176, v180
    v_permlane32_swap_b32 v177, v181
    v_permlane32_swap_b32 v178, v182
    v_permlane32_swap_b32 v179, v183
    v_add_f32 v176, v176, v180
    v_add_f32 v177, v177, v181
    v_add_f32 v178, v178, v182
    v_add_f32 v179, v179, v183
    s_nop 0
    v_permlane16_swap_b32 v176, v178
    v_permlane16_swap_b32 v177, v179
    v_add_f32 v176, v176, v178
    v_add_f32 v177, v177, v179
    s_nop 0
    v_add_f32_dpp v176, v176, v176 row_ror:8 row_mask:0xf bank_mask:0xf
    v_add_f32_dpp v177, v177, v177 row_ror:8 row_mask:0xf bank_mask:0xf
    s_nop 1
    v_mov_b32_dpp v176, v177 quad_perm:[0,1,2,3] row_mask:0xf bank_mask:0xc
    ds_write_b32 v252, v176
    s_waitcnt lgkmcnt(0)
    s_barrier
    buffer_load_dwordx2 v[172:173], v8, s[32:35], s14 offen sc1
    ds_read_b128 v[176:179], v251 offset:0
    ds_read_b128 v[180:183], v251 offset:16
    s_waitcnt lgkmcnt(0)
    v_pk_add_f32 v[176:177], v[176:177], v[178:179]
    v_pk_add_f32 v[180:181], v[180:181], v[182:183]
    v_pk_add_f32 v[176:177], v[176:177], v[180:181]
    v_add_f32 v176, v176, v177
    v_mov_b32 v177, s4
    s_bitcmp1_b32 s3, 0
    s_cselect_b32 exec_lo, 0, -1
    s_cselect_b32 exec_hi, -1, 0
    buffer_store_dwordx2 v[176:177], v250, s[32:35], s13 offen sc1
    s_mov_b64 exec, -1
    s_mov_b32 s82, s91
    s_add_u32 m0, s94, 98304
    s_nop 0
    buffer_load_dwordx4 v3, s[40:43], s82 offen lds
    s_waitcnt vmcnt(2)
    v_cmp_ne_u32 vcc, s4, v173
    s_cbranch_vccz TOK_2
SPOLL_3:
    s_load_dword s24, s[32:33], s14 offset:60 glc
    s_load_dword s25, s[32:33], s14 offset:124 glc
SCHK_4:
    s_add_u32 s5, s5, 1
    s_cmp_ge_u32 s5, 200000
    s_waitcnt lgkmcnt(0)
    s_cbranch_scc1 SDONE_5
    s_cmp_lg_u32 s24, s4
    s_cbranch_scc1 SPOLL_3
    s_cmp_lg_u32 s25, s4
    s_cbranch_scc1 SPOLL_3
SDONE_5:
POLL_6:
    buffer_load_dwordx2 v[172:173], v8, s[32:35], s14 offen sc1
    s_waitcnt vmcnt(0)
    v_cmp_ne_u32 vcc, s4, v173
    s_cbranch_vccz PDONE_7
    s_add_u32 s5, s5, 1
    s_cmp_lt_u32 s5, 200000
    s_cbranch_scc1 POLL_6
PDONE_7:
TOK_2:
    v_and_b32 v4, 31, v1
    v_lshlrev_b32 v4, 4, v4
    v_lshrrev_b32 v9, 5, v1
    v_lshl_add_u32 v4, v9, 12, v4
    s_mov_b32 s13, s17
    s_lshl2_add_u32 s14, s3, 155648
    v_lshl_add_u32 v5, v1, 6, s14
    v_and_b32 v6, 3, v1
    v_lshlrev_b32 v6, 5, v6
    v_lshrrev_b32 v9, 5, v1
    v_lshl_add_u32 v6, v9, 7, v6
    v_bfe_u32 v9, v1, 4, 1
    v_lshl_add_u32 v6, v9, 8, v6
    v_bfe_u32 v9, v1, 2, 2
    v_lshl_add_u32 v6, v9, 9, v6
    v_add_u32 v6, 155648, v6
    s_load_dword s24, s[32:33], s13 offset:508 glc
    s_load_dword s25, s[32:33], s13 offset:4604 glc
    v_permlane32_swap_b32 v12, v14
    v_permlane32_swap_b32 v13, v15
    v_permlane32_swap_b32 v16, v18
    v_permlane32_swap_b32 v17, v19
    v_lshlrev_b32 v173, 16, v172
    v_and_b32 v172, s6, v172
    v_rcp_f32 v172, v172
    v_lshlrev_b32 v184, 16, v12
    v_and_b32 v185, s6, v12
    v_lshlrev_b32 v186, 16, v13
    v_and_b32 v187, s6, v13
    v_lshlrev_b32 v188, 16, v14
    v_and_b32 v189, s6, v14
    v_lshlrev_b32 v190, 16, v15
    v_and_b32 v191, s6, v15
    v_lshlrev_b32 v192, 16, v16
    v_and_b32 v193, s6, v16
    v_lshlrev_b32 v194, 16, v17
    v_and_b32 v195, s6, v17
    v_lshlrev_b32 v196, 16, v18
    v_and_b32 v197, s6, v18
    v_lshlrev_b32 v198, 16, v19
    v_and_b32 v199, s6, v19
    v_pk_add_f32 v[184:185], v[184:185], v[172:173] op_sel:[0,1] neg_lo:[0,1] neg_hi:[0,1]
    v_pk_add_f32 v[186:187], v[186:187], v[172:173] op_sel:[0,1] neg_lo:[0,1] neg_hi:[0,1]
    v_pk_add_f32 v[188:189], v[188:189], v[172:173] op_sel:[0,1] neg_lo:[0,1] neg_hi:[0,1]
    v_pk_add_f32 v[190:191], v[190:191], v[172:173] op_sel:[0,1] neg_lo:[0,1] neg_hi:[0,1]
    v_pk_add_f32 v[192:193], v[192:193], v[172:173] op_sel:[0,1] neg_lo:[0,1] neg_hi:[0,1]
    v_pk_add_f32 v[194:195], v[194:195], v[172:173] op_sel:[0,1] neg_lo:[0,1] neg_hi:[0,1]
    v_pk_add_f32 v[196:197], v[196:197], v[172:173] op_sel:[0,1] neg_lo:[0,1] neg_hi:[0,1]
    v_pk_add_f32 v[198:199], v[198:199], v[172:173] op_sel:[0,1] neg_lo:[0,1] neg_hi:[0,1]
    v_cvt_pk_bf16_f32 v184, 0, v184
    v_cvt_pk_bf16_f32 v185, 0, v185
    v_cvt_pk_bf16_f32 v186, 0, v186
    v_cvt_pk_bf16_f32 v187, 0, v187
    v_cvt_pk_bf16_f32 v188, 0, v188
    v_cvt_pk_bf16_f32 v189, 0, v189
    v_cvt_pk_bf16_f32 v190, 0, v190
    v_cvt_pk_bf16_f32 v191, 0, v191
    v_cvt_pk_bf16_f32 v192, 0, v192
    v_cvt_pk_bf16_f32 v193, 0, v193
    v_cvt_pk_bf16_f32 v194, 0, v194
    v_cvt_pk_bf16_f32 v195, 0, v195
    v_cvt_pk_bf16_f32 v196, 0, v196
    v_cvt_pk_bf16_f32 v197, 0, v197
    v_cvt_pk_bf16_f32 v198, 0, v198
    v_cvt_pk_bf16_f32 v199, 0, v199
    v_pk_mul_f32 v[184:185], v[184:185], v[172:173] op_sel_hi:[1,0]
    v_pk_mul_f32 v[186:187], v[186:187], v[172:173] op_sel_hi:[1,0]
    v_pk_mul_f32 v[188:189], v[188:189], v[172:173] op_sel_hi:[1,0]
    v_pk_mul_f32 v[190:191], v[190:191], v[172:173] op_sel_hi:[1,0]
    v_pk_mul_f32 v[192:193], v[192:193], v[172:173] op_sel_hi:[1,0]
    v_pk_mul_f32 v[194:195], v[194:195], v[172:173] op_sel_hi:[1,0]
    v_pk_mul_f32 v[196:197], v[196:197], v[172:173] op_sel_hi:[1,0]
    v_pk_mul_f32 v[198:199], v[198:199], v[172:173] op_sel_hi:[1,0]
    v_cvt_pk_bf16_f32 v184, 0, v184
    v_cvt_pk_bf16_f32 v185, 0, v185
    v_cvt_pk_bf16_f32 v186, 0, v186
    v_cvt_pk_bf16_f32 v187, 0, v187
    v_cvt_pk_bf16_f32 v188, 0, v188
    v_cvt_pk_bf16_f32 v189, 0, v189
    v_cvt_pk_bf16_f32 v190, 0, v190
    v_cvt_pk_bf16_f32 v191, 0, v191
    v_cvt_pk_bf16_f32 v192, 0, v192
    v_cvt_pk_bf16_f32 v193, 0, v193
    v_cvt_pk_bf16_f32 v194, 0, v194
    v_cvt_pk_bf16_f32 v195, 0, v195
    v_cvt_pk_bf16_f32 v196, 0, v196
    v_cvt_pk_bf16_f32 v197, 0, v197
    v_cvt_pk_bf16_f32 v198, 0, v198
    v_cvt_pk_bf16_f32 v199, 0, v199
    s_branch SCHK_9
SPOLL_8:
    s_load_dword s24, s[32:33], s13 offset:508 glc
    s_load_dword s25, s[32:33], s13 offset:4604 glc
SCHK_9:
    s_add_u32 s5, s5, 1
    s_cmp_ge_u32 s5, 200000
    s_waitcnt lgkmcnt(0)
    s_cbranch_scc1 SDONE_10
    s_cmp_lg_u32 s24, s4
    s_cbranch_scc1 SPOLL_8
    s_cmp_lg_u32 s25, s4
    s_cbranch_scc1 SPOLL_8
SDONE_10:
    s_barrier
    buffer_load_dwordx4 v[172:175], v4, s[32:35], s13 offen sc1
    s_lshr_b32 s96, s9, 4
    s_lshl_b32 s97, s96, 1
    s_xor_b32 s94, s97, 1
    s_add_u32 s96, s94, s84
    s_and_b32 s97, s96, 15
    s_mul_i32 s98, s97, 393216
    s_add_u32 s91, s98, s85
    s_lshl_b32 s96, s94, 13
    s_add_u32 s94, s96, s83
    s_add_u32 s82, s91, 2048
    s_mov_b32 m0, s94
    s_nop 0
    buffer_load_dwordx4 v3, s[40:43], s82 offen lds
    s_add_u32 s82, s91, 4096
    s_add_u32 m0, s94, 49152
    s_nop 0
    buffer_load_dwordx4 v3, s[40:43], s82 offen lds
    s_mov_b32 s82, s91
    s_add_u32 m0, s94, 98304
    s_nop 0
    buffer_load_dwordx4 v3, s[40:43], s82 offen lds
    s_waitcnt vmcnt(3)
    v_bitop3_b32 v7, v173, v175, s4 bitop3:0x7e
    v_cmp_ne_u32 vcc, 0, v7
    s_cbranch_vccz TOK_12
POLL_13:
    buffer_load_dwordx4 v[172:175], v4, s[32:35], s13 offen sc1
    s_waitcnt vmcnt(0)
    v_bitop3_b32 v7, v173, v175, s4 bitop3:0x7e
    v_cmp_ne_u32 vcc, 0, v7
    s_cbranch_vccz PDONE_14
    s_add_u32 s5, s5, 1
    s_cmp_lt_u32 s5, 200000
    s_cbranch_scc1 POLL_13
PDONE_14:
TOK_12:
    ds_write2_b32 v5, v172, v174 offset0:0 offset1:8
    s_waitcnt lgkmcnt(0)
    s_barrier
    ds_read_b128 v[208:211], v6 offset:2048
    ds_read_b128 v[212:215], v6 offset:2064
    ds_read_b128 v[200:203], v6
    ds_read_b128 v[204:207], v6 offset:16
    s_lshl4_add_u32 s96, s21, s12
    s_lshr_b32 s97, s3, 1
    s_lshl2_add_u32 s98, s96, s97
    s_lshl_b32 s99, s98, 12
    s_and_b32 s96, s3, 1
    s_lshl_b32 s97, s96, 8
    s_add_u32 s98, s99, s97
    s_add_u32 s13, s98, 4194304
    v_and_b32 v4, 15, v1
    v_lshlrev_b32 v4, 4, v4
    v_bfe_u32 v9, v1, 4, 1
    v_lshl_add_u32 v4, v9, 10, v4
    v_lshrrev_b32 v9, 5, v1
    v_lshl_add_u32 v4, v9, 9, v4
    s_waitcnt lgkmcnt(2)
    v_pk_add_f32 v[208:209], v[208:209], v[210:211]
    v_pk_add_f32 v[212:213], v[212:213], v[214:215]
    v_pk_add_f32 v[208:209], v[208:209], v[212:213]
    v_add_f32 v208, v208, v209
    v_cvt_pk_bf16_f32 v208, 0, v208
    s_waitcnt lgkmcnt(0)
    v_pk_add_f32 v[200:201], v[200:201], v[202:203]
    v_pk_add_f32 v[204:205], v[204:205], v[206:207]
    v_pk_add_f32 v[200:201], v[200:201], v[204:205]
    v_add_f32 v200, v200, v201
    v_add_f32 v208, 1.0, v208
    v_cvt_pk_bf16_f32 v208, 0, v208
    v_cvt_pk_bf16_f32 v200, 0, v200
    s_nop 0
    v_mul_f32_dpp v184, v208, v184 row_newbcast:0 row_mask:0xf bank_mask:0xf
    v_mul_f32_dpp v185, v208, v185 row_newbcast:1 row_mask:0xf bank_mask:0xf
    v_mul_f32_dpp v186, v208, v186 row_newbcast:2 row_mask:0xf bank_mask:0xf
    v_mul_f32_dpp v187, v208, v187 row_newbcast:3 row_mask:0xf bank_mask:0xf
    v_mul_f32_dpp v188, v208, v188 row_newbcast:4 row_mask:0xf bank_mask:0xf
    v_mul_f32_dpp v189, v208, v189 row_newbcast:5 row_mask:0xf bank_mask:0xf
    v_mul_f32_dpp v190, v208, v190 row_newbcast:6 row_mask:0xf bank_mask:0xf
    v_mul_f32_dpp v191, v208, v191 row_newbcast:7 row_mask:0xf bank_mask:0xf
    v_cvt_pk_bf16_f32 v184, 0, v184
    v_cvt_pk_bf16_f32 v185, 0, v185
    v_cvt_pk_bf16_f32 v186, 0, v186
    v_cvt_pk_bf16_f32 v187, 0, v187
    v_cvt_pk_bf16_f32 v188, 0, v188
    v_cvt_pk_bf16_f32 v189, 0, v189
    v_cvt_pk_bf16_f32 v190, 0, v190
    v_cvt_pk_bf16_f32 v191, 0, v191
    v_add_f32_dpp v184, v200, v184 row_newbcast:0 row_mask:0xf bank_mask:0xf
    v_add_f32_dpp v185, v200, v185 row_newbcast:1 row_mask:0xf bank_mask:0xf
    v_add_f32_dpp v186, v200, v186 row_newbcast:2 row_mask:0xf bank_mask:0xf
    v_add_f32_dpp v187, v200, v187 row_newbcast:3 row_mask:0xf bank_mask:0xf
    v_add_f32_dpp v188, v200, v188 row_newbcast:4 row_mask:0xf bank_mask:0xf
    v_add_f32_dpp v189, v200, v189 row_newbcast:5 row_mask:0xf bank_mask:0xf
    v_add_f32_dpp v190, v200, v190 row_newbcast:6 row_mask:0xf bank_mask:0xf
    v_add_f32_dpp v191, v200, v191 row_newbcast:7 row_mask:0xf bank_mask:0xf
    v_cvt_pk_bf16_f32 v216, v184, v185
    v_cvt_pk_bf16_f32 v217, v186, v187
    v_cvt_pk_bf16_f32 v218, v188, v189
    v_cvt_pk_bf16_f32 v219, v190, v191
    buffer_store_dwordx4 v[216:219], v4, s[32:35], s13 offen sc1
    v_mul_f32_dpp v192, v208, v192 row_newbcast:8 row_mask:0xf bank_mask:0xf
    v_mul_f32_dpp v193, v208, v193 row_newbcast:9 row_mask:0xf bank_mask:0xf
    v_mul_f32_dpp v194, v208, v194 row_newbcast:10 row_mask:0xf bank_mask:0xf
    v_mul_f32_dpp v195, v208, v195 row_newbcast:11 row_mask:0xf bank_mask:0xf
    v_mul_f32_dpp v196, v208, v196 row_newbcast:12 row_mask:0xf bank_mask:0xf
    v_mul_f32_dpp v197, v208, v197 row_newbcast:13 row_mask:0xf bank_mask:0xf
    v_mul_f32_dpp v198, v208, v198 row_newbcast:14 row_mask:0xf bank_mask:0xf
    v_mul_f32_dpp v199, v208, v199 row_newbcast:15 row_mask:0xf bank_mask:0xf
    v_cvt_pk_bf16_f32 v192, 0, v192
    v_cvt_pk_bf16_f32 v193, 0, v193
    v_cvt_pk_bf16_f32 v194, 0, v194
    v_cvt_pk_bf16_f32 v195, 0, v195
    v_cvt_pk_bf16_f32 v196, 0, v196
    v_cvt_pk_bf16_f32 v197, 0, v197
    v_cvt_pk_bf16_f32 v198, 0, v198
    v_cvt_pk_bf16_f32 v199, 0, v199
    v_add_f32_dpp v192, v200, v192 row_newbcast:8 row_mask:0xf bank_mask:0xf
    v_add_f32_dpp v193, v200, v193 row_newbcast:9 row_mask:0xf bank_mask:0xf
    v_add_f32_dpp v194, v200, v194 row_newbcast:10 row_mask:0xf bank_mask:0xf
    v_add_f32_dpp v195, v200, v195 row_newbcast:11 row_mask:0xf bank_mask:0xf
    v_add_f32_dpp v196, v200, v196 row_newbcast:12 row_mask:0xf bank_mask:0xf
    v_add_f32_dpp v197, v200, v197 row_newbcast:13 row_mask:0xf bank_mask:0xf
    v_add_f32_dpp v198, v200, v198 row_newbcast:14 row_mask:0xf bank_mask:0xf
    v_add_f32_dpp v199, v200, v199 row_newbcast:15 row_mask:0xf bank_mask:0xf
    v_cvt_pk_bf16_f32 v220, v192, v193
    v_cvt_pk_bf16_f32 v221, v194, v195
    v_cvt_pk_bf16_f32 v222, v196, v197
    v_cvt_pk_bf16_f32 v223, v198, v199
    buffer_store_dwordx4 v[220:223], v4, s[32:35], s13 offen offset:2048 sc1
    v_bfe_u32 v20, v1, 2, 2
    v_lshlrev_b32 v20, 7, v20
    v_bfe_u32 v9, v1, 3, 1
    v_lshl_add_u32 v20, v9, 6, v20
    v_bfe_u32 v9, v1, 4, 1
    v_lshl_add_u32 v20, v9, 5, v20
    v_and_b32 v9, 3, v1
    v_lshl_add_u32 v20, v9, 3, v20
    v_lshrrev_b32 v9, 5, v1
    v_lshl_add_u32 v20, v9, 9, v20
    v_xor_b32 v21, 64, v20
    v_add_u32 v22, 49152, v20
    v_add_u32 v23, 49152, v21
    v_add_u32 v24, 98304, v20
    v_add_u32 v25, 98304, v21
    v_and_b32 v5, 3, v1
    v_lshlrev_b32 v5, 15, v5
    v_bfe_u32 v9, v1, 2, 2
    v_lshl_add_u32 v5, v9, 12, v5
    s_and_b32 s96, s12, 1
    s_lshr_b32 s97, s21, 3
    s_and_b32 s98, s21, 7
    s_lshl_b32 s99, s98, 5
    s_lshl2_add_u32 s98, s97, s99
    s_lshl_b32 s97, s98, 12
    s_lshr_b32 s99, s12, 1
    s_lshl_b32 s98, s99, 6
    s_add_u32 s99, s97, s98
    s_lshl2_add_u32 s97, s96, s99
    s_add_u32 s13, s97, 1048576
    s_lshl_b32 s96, s10, 18
    s_lshl_b32 s97, s77, 12
    s_add_u32 s98, s96, s97
    s_add_u32 s88, s98, 4194304
    s_cmp_ge_u32 s9, 28
    s_cselect_b32 s54, 0, s54
    s_cselect_b32 s58, 0, s58
    s_cselect_b32 s62, 0, s62
    s_waitcnt vmcnt(0)
    s_barrier
    s_cmp_lg_u32 s3, 0
    s_cbranch_scc1 L_PB
    v_mov_b32 v6, s4
    s_mov_b32 exec_hi, 0
    s_mov_b32 exec_lo, 65535
    buffer_store_dword v6, v5, s[32:35], s13 offen sc1
    s_mov_b64 exec, -1
L_PB:
    s_lshr_b32 s96, s9, 4
    s_lshl_b32 s97, s96, 1
    s_xor_b32 s94, s97, 2
    s_add_u32 s96, s94, s84
    s_and_b32 s97, s96, 15
    s_mul_i32 s98, s97, 393216
    s_add_u32 s91, s98, s85
    s_lshl_b32 s96, s94, 13
    s_add_u32 s94, s96, s83
    s_add_u32 s82, s91, 2048
    s_mov_b32 m0, s94
    s_nop 0
    buffer_load_dwordx4 v3, s[40:43], s82 offen lds
    s_add_u32 s82, s91, 4096
    s_add_u32 m0, s94, 49152
    s_nop 0
    buffer_load_dwordx4 v3, s[40:43], s82 offen lds
    s_mov_b32 s82, s91
    s_add_u32 m0, s94, 98304
    s_nop 0
    buffer_load_dwordx4 v3, s[40:43], s82 offen lds
    s_lshr_b32 s96, s9, 4
    s_lshl_b32 s97, s96, 1
    s_xor_b32 s94, s97, 3
    s_add_u32 s96, s94, s84
    s_and_b32 s97, s96, 15
    s_mul_i32 s98, s97, 393216
    s_add_u32 s91, s98, s85
    s_lshl_b32 s96, s94, 13
    s_add_u32 s94, s96, s83
    s_add_u32 s82, s91, 2048
    s_mov_b32 m0, s94
    s_nop 0
    buffer_load_dwordx4 v3, s[40:43], s82 offen lds
    s_add_u32 s82, s91, 4096
    s_add_u32 m0, s94, 49152
    s_nop 0
    buffer_load_dwordx4 v3, s[40:43], s82 offen lds
    s_mov_b32 s82, s91
    s_add_u32 m0, s94, 98304
    s_nop 0
    buffer_load_dwordx4 v3, s[40:43], s82 offen lds
    s_lshl_b32 s96, s2, 12
    s_add_u32 s19, s96, 1048576
    s_and_b32 s96, s3, 3
    s_lshl_b32 s97, s96, 7
    s_add_u32 s20, s97, s19
    s_lshl_b32 s96, s84, 5
    s_add_u32 s19, s96, s19
    s_cmp_ge_u32 s3, 4
    s_cselect_b32 s19, s20, s19
    s_load_dwordx2 s[24:25], s[32:33], s19 offset:0 glc
    s_load_dwordx2 s[26:27], s[32:33], s19 offset:64 glc
    s_add_u32 s96, s84, 4
    s_and_b32 s97, s96, 15
    s_mul_i32 s98, s97, 393216
    s_add_u32 s91, s98, s85
    s_add_u32 s94, s83, 32768
    s_add_u32 s82, s91, 2048
    s_mov_b32 m0, s94
    s_nop 0
    buffer_load_dwordx4 v3, s[40:43], s82 offen lds
    s_add_u32 s82, s91, 4096
    s_add_u32 m0, s94, 49152
    s_nop 0
    buffer_load_dwordx4 v3, s[40:43], s82 offen lds
    s_mov_b32 s82, s91
    s_add_u32 m0, s94, 98304
    s_nop 0
    buffer_load_dwordx4 v3, s[40:43], s82 offen lds
    s_lshl_b32 s96, s3, 14
    s_lshl_b32 s97, s12, 7
    s_add_u32 s90, s96, s97
    s_and_b32 s96, s9, 1
    s_lshr_b32 s97, s9, 3
    s_lshl_b32 s98, s97, 1
    s_lshl3_add_u32 s99, s96, s98
    s_lshl_b32 s95, s99, 17
    s_lshl3_add_u32 s96, s75, s3
    s_mul_i32 s97, s96, 229376
    s_lshl_b32 s98, s74, 7
    s_add_u32 s80, s97, s98
    s_lshl3_add_u32 s96, s74, s3
    s_lshl_b32 s97, s96, 14
    s_lshl_b32 s98, s75, 9
    s_add_u32 s81, s97, s98
    s_and_b32 s96, s8, 3
    s_lshl3_add_u32 s97, s96, s3
    s_mul_i32 s98, s97, 393216
    s_lshr_b32 s99, s8, 2
    s_lshl1_add_u32 s96, s9, s99
    s_lshl_b32 s97, s96, 7
    s_add_u32 s99, s98, s97
    s_add_u32 s89, s99, 4096
    s_and_b32 s96, s3, 1
    s_lshl_b32 s14, s96, 6
    v_bfe_u32 v6, v1, 4, 1
    v_lshl_add_u32 v6, v6, 5, s14
    v_and_b32 v26, 7, v1
    v_lshlrev_b32 v26, 4, v26
    v_xor_b32 v26, v26, v6
    v_lshrrev_b32 v6, 3, v1
    v_lshlrev_b32 v6, 11, v6
    v_add_u32 v26, v26, v6
    s_and_b32 s96, s3, 2
    s_lshl_b32 s14, s96, 5
    v_bfe_u32 v6, v1, 4, 1
    v_lshl_add_u32 v6, v6, 5, s14
    v_and_b32 v27, 7, v1
    v_lshlrev_b32 v27, 4, v27
    v_xor_b32 v27, v27, v6
    v_lshrrev_b32 v6, 3, v1
    v_mul_u32_u24 v6, 7168, v6
    v_add_u32 v27, v27, v6
    s_and_b32 s96, s3, 1
    s_lshl_b32 s14, s96, 7
    v_lshrrev_b32 v6, 5, v1
    v_lshl_add_u32 v6, v6, 6, s14
    v_and_b32 v253, 31, v1
    v_lshlrev_b32 v253, 4, v253
    v_lshrrev_b32 v9, 5, v1
    v_lshl_add_u32 v253, v9, 11, v253
    v_xor_b32 v253, v253, v6
    s_lshl_b32 s16, s84, 14
    v_add_u32 v249, s88, v2
    s_lshl_b32 s96, s77, 11
    s_add_u32 s14, s96, 151552
    v_add_u32 v0, s14, v2
    s_mov_b64 exec, 0
    s_cmp_eq_u32 s3, 4
    s_cbranch_scc1 L_PAD2
    s_cmp_eq_u32 s3, 5
    s_cbranch_scc1 L_PAD3
    s_cmp_eq_u32 s3, 6
    s_cbranch_scc1 L_PAD4
    s_cmp_eq_u32 s3, 7
    s_cbranch_scc1 L_PAD5
    s_branch L_TEND
L_RET2:
    s_branch L_PAD6
L_RET6:
    s_branch L_PAD10
L_RET10:
    s_branch L_TEND
L_RET3:
    s_branch L_PAD7
L_RET7:
    s_branch L_TEND
L_RET4:
    s_branch L_PAD8
L_RET8:
    s_branch L_TEND
L_RET5:
    s_branch L_PAD9
L_RET9:
    s_branch L_TEND
    s_nop 0
    s_nop 0
    s_nop 0
    s_nop 0
    s_nop 0
    s_nop 0
    s_nop 0
    s_nop 0
    s_nop 0
    s_nop 0
    s_nop 0
    s_nop 0
    s_nop 0
    s_nop 0
    s_nop 0
    s_nop 0
    s_nop 0
    s_nop 0
    s_nop 0
    s_nop 0
    s_nop 0
    s_nop 0
    s_nop 0
    s_nop 0
    s_nop 0
    s_nop 0
    s_nop 0
    s_nop 0
L_TEND:
    s_mov_b64 exec, -1
    s_branch SCHK_16
SPOLL_15:
    s_load_dwordx2 s[24:25], s[32:33], s19 offset:0 glc
    s_load_dwordx2 s[26:27], s[32:33], s19 offset:64 glc
SCHK_16:
    s_add_u32 s5, s5, 1
    s_cmp_ge_u32 s5, 200000
    s_waitcnt lgkmcnt(0)
    s_cbranch_scc1 SDONE_17
    s_cmp_lg_u32 s24, s4
    s_cbranch_scc1 SPOLL_15
    s_cmp_lg_u32 s25, s4
    s_cbranch_scc1 SPOLL_15
    s_cmp_lg_u32 s26, s4
    s_cbranch_scc1 SPOLL_15
    s_cmp_lg_u32 s27, s4
    s_cbranch_scc1 SPOLL_15
SDONE_17:
    s_cmp_ge_u32 s3, 4
    s_cbranch_scc1 L_HELP
    s_setprio 2
    buffer_load_dwordx4 v[152:155], v249, s[32:35], s16 offen sc1
    buffer_load_dwordx4 v[156:159], v249, s[32:35], s16 offen offset:1024 sc1
    buffer_load_dwordx4 v[160:163], v249, s[32:35], s16 offen offset:2048 sc1
    buffer_load_dwordx4 v[164:167], v249, s[32:35], s16 offen offset:3072 sc1
    s_add_u32 s16, s16, 16384
    s_and_b32 s16, s16, 0x3ffff
    buffer_load_dwordx4 v[168:171], v249, s[32:35], s16 offen sc1
    buffer_load_dwordx4 v[172:175], v249, s[32:35], s16 offen offset:1024 sc1
    s_waitcnt vmcnt(9)
    s_barrier
    ds_read_b64_tr_b16 v[28:29], v20
    ds_read_b64_tr_b16 v[30:31], v20 offset:2048
    ds_read_b64_tr_b16 v[32:33], v21
    ds_read_b64_tr_b16 v[34:35], v21 offset:2048
    ds_read_b64_tr_b16 v[36:37], v24
    ds_read_b64_tr_b16 v[38:39], v24 offset:2048
    ds_read_b64_tr_b16 v[40:41], v25
    ds_read_b64_tr_b16 v[42:43], v25 offset:2048
    ds_read_b64_tr_b16 v[44:45], v22
    ds_read_b64_tr_b16 v[46:47], v22 offset:2048
    ds_read_b64_tr_b16 v[48:49], v23
    ds_read_b64_tr_b16 v[50:51], v23 offset:2048
    s_waitcnt vmcnt(5)
    s_waitcnt lgkmcnt(10)
    v_mfma_f32_32x32x16_bf16 v[56:71], v[28:31], v[152:155], 0
    ds_read_b64_tr_b16 v[52:53], v20 offset:1024
    ds_read_b64_tr_b16 v[54:55], v20 offset:3072
    s_waitcnt lgkmcnt(10)
    v_mfma_f32_32x32x16_bf16 v[72:87], v[32:35], v[152:155], 0
    ds_read_b64_tr_b16 v[28:29], v21 offset:1024
    ds_read_b64_tr_b16 v[30:31], v21 offset:3072
    s_waitcnt lgkmcnt(10)
    v_mfma_f32_32x32x16_bf16 v[120:135], v[36:39], v[152:155], 0
    ds_read_b64_tr_b16 v[32:33], v24 offset:1024
    ds_read_b64_tr_b16 v[34:35], v24 offset:3072
    s_waitcnt lgkmcnt(10)
    v_mfma_f32_32x32x16_bf16 v[136:151], v[40:43], v[152:155], 0
    ds_read_b64_tr_b16 v[36:37], v25 offset:1024
    ds_read_b64_tr_b16 v[38:39], v25 offset:3072
    s_waitcnt lgkmcnt(10)
    v_mfma_f32_32x32x16_bf16 v[88:103], v[44:47], v[152:155], 0
    buffer_load_dwordx4 v[176:179], v249, s[32:35], s16 offen offset:2048 sc1
    ds_read_b64_tr_b16 v[40:41], v22 offset:1024
    ds_read_b64_tr_b16 v[42:43], v22 offset:3072
    s_waitcnt lgkmcnt(10)
    v_mfma_f32_32x32x16_bf16 v[104:119], v[48:51], v[152:155], 0
    ds_read_b64_tr_b16 v[44:45], v23 offset:1024
    ds_read_b64_tr_b16 v[46:47], v23 offset:3072
    s_waitcnt vmcnt(5)
    s_waitcnt lgkmcnt(10)
    v_mfma_f32_32x32x16_bf16 v[56:71], v[52:55], v[156:159], v[56:71]
    ds_read_b64_tr_b16 v[48:49], v20 offset:4096
    ds_read_b64_tr_b16 v[50:51], v20 offset:6144
    s_waitcnt lgkmcnt(10)
    v_mfma_f32_32x32x16_bf16 v[72:87], v[28:31], v[156:159], v[72:87]
    ds_read_b64_tr_b16 v[52:53], v21 offset:4096
    ds_read_b64_tr_b16 v[54:55], v21 offset:6144
    s_waitcnt lgkmcnt(10)
    v_mfma_f32_32x32x16_bf16 v[120:135], v[32:35], v[156:159], v[120:135]
    ds_read_b64_tr_b16 v[28:29], v24 offset:4096
    ds_read_b64_tr_b16 v[30:31], v24 offset:6144
    s_waitcnt lgkmcnt(10)
    v_mfma_f32_32x32x16_bf16 v[136:151], v[36:39], v[156:159], v[136:151]
    buffer_load_dwordx4 v[180:183], v249, s[32:35], s16 offen offset:3072 sc1
    ds_read_b64_tr_b16 v[32:33], v25 offset:4096
    ds_read_b64_tr_b16 v[34:35], v25 offset:6144
    s_waitcnt lgkmcnt(10)
    v_mfma_f32_32x32x16_bf16 v[88:103], v[40:43], v[156:159], v[88:103]
    s_add_u32 s16, s16, 16384
    ds_read_b64_tr_b16 v[36:37], v22 offset:4096
    ds_read_b64_tr_b16 v[38:39], v22 offset:6144
    s_waitcnt lgkmcnt(10)
    v_mfma_f32_32x32x16_bf16 v[104:119], v[44:47], v[156:159], v[104:119]
    s_and_b32 s16, s16, 0x3ffff
    ds_read_b64_tr_b16 v[40:41], v23 offset:4096
    ds_read_b64_tr_b16 v[42:43], v23 offset:6144
    s_waitcnt vmcnt(5)
    s_waitcnt lgkmcnt(10)
    v_mfma_f32_32x32x16_bf16 v[56:71], v[48:51], v[160:163], v[56:71]
    ds_read_b64_tr_b16 v[44:45], v20 offset:5120
    ds_read_b64_tr_b16 v[46:47], v20 offset:7168
    s_waitcnt lgkmcnt(10)
    v_mfma_f32_32x32x16_bf16 v[72:87], v[52:55], v[160:163], v[72:87]
    ds_read_b64_tr_b16 v[48:49], v21 offset:5120
    ds_read_b64_tr_b16 v[50:51], v21 offset:7168
    s_waitcnt lgkmcnt(10)
    v_mfma_f32_32x32x16_bf16 v[120:135], v[28:31], v[160:163], v[120:135]
    buffer_load_dwordx4 v[184:187], v249, s[32:35], s16 offen sc1
    ds_read_b64_tr_b16 v[52:53], v24 offset:5120
    ds_read_b64_tr_b16 v[54:55], v24 offset:7168
    s_waitcnt lgkmcnt(10)
    v_mfma_f32_32x32x16_bf16 v[136:151], v[32:35], v[160:163], v[136:151]
    ds_read_b64_tr_b16 v[28:29], v25 offset:5120
    ds_read_b64_tr_b16 v[30:31], v25 offset:7168
    s_waitcnt lgkmcnt(10)
    v_mfma_f32_32x32x16_bf16 v[88:103], v[36:39], v[160:163], v[88:103]
    ds_read_b64_tr_b16 v[32:33], v22 offset:5120
    ds_read_b64_tr_b16 v[34:35], v22 offset:7168
    s_waitcnt lgkmcnt(10)
    v_mfma_f32_32x32x16_bf16 v[104:119], v[40:43], v[160:163], v[104:119]
    ds_read_b64_tr_b16 v[36:37], v23 offset:5120
    ds_read_b64_tr_b16 v[38:39], v23 offset:7168
    s_waitcnt vmcnt(5)
    s_waitcnt lgkmcnt(10)
    v_mfma_f32_32x32x16_bf16 v[56:71], v[44:47], v[164:167], v[56:71]
    ds_read_b64_tr_b16 v[40:41], v20 offset:8192
    ds_read_b64_tr_b16 v[42:43], v20 offset:10240
    s_waitcnt lgkmcnt(10)
    v_mfma_f32_32x32x16_bf16 v[72:87], v[48:51], v[164:167], v[72:87]
    buffer_load_dwordx4 v[188:191], v249, s[32:35], s16 offen offset:1024 sc1
    ds_read_b64_tr_b16 v[44:45], v21 offset:8192
    ds_read_b64_tr_b16 v[46:47], v21 offset:10240
    s_waitcnt lgkmcnt(10)
    v_mfma_f32_32x32x16_bf16 v[120:135], v[52:55], v[164:167], v[120:135]
    ds_read_b64_tr_b16 v[48:49], v24 offset:8192
    ds_read_b64_tr_b16 v[50:51], v24 offset:10240
    s_waitcnt lgkmcnt(10)
    v_mfma_f32_32x32x16_bf16 v[136:151], v[28:31], v[164:167], v[136:151]
    ds_read_b64_tr_b16 v[52:53], v25 offset:8192
    ds_read_b64_tr_b16 v[54:55], v25 offset:10240
    s_waitcnt lgkmcnt(10)
    v_mfma_f32_32x32x16_bf16 v[88:103], v[32:35], v[164:167], v[88:103]
    ds_read_b64_tr_b16 v[28:29], v22 offset:8192
    ds_read_b64_tr_b16 v[30:31], v22 offset:10240
    s_waitcnt lgkmcnt(10)
    v_mfma_f32_32x32x16_bf16 v[104:119], v[36:39], v[164:167], v[104:119]
    buffer_load_dwordx4 v[192:195], v249, s[32:35], s16 offen offset:2048 sc1
    ds_read_b64_tr_b16 v[32:33], v23 offset:8192
    ds_read_b64_tr_b16 v[34:35], v23 offset:10240
    s_barrier
    s_waitcnt vmcnt(6)
    s_waitcnt lgkmcnt(10)
    v_mfma_f32_32x32x16_bf16 v[56:71], v[40:43], v[168:171], v[56:71]
    ds_read_b64_tr_b16 v[36:37], v20 offset:9216
    ds_read_b64_tr_b16 v[38:39], v20 offset:11264
    s_waitcnt lgkmcnt(10)
    v_mfma_f32_32x32x16_bf16 v[72:87], v[44:47], v[168:171], v[72:87]
    ds_read_b64_tr_b16 v[40:41], v21 offset:9216
    ds_read_b64_tr_b16 v[42:43], v21 offset:11264
    s_waitcnt lgkmcnt(10)
    v_mfma_f32_32x32x16_bf16 v[120:135], v[48:51], v[168:171], v[120:135]
    ds_read_b64_tr_b16 v[44:45], v24 offset:9216
    ds_read_b64_tr_b16 v[46:47], v24 offset:11264
    s_waitcnt lgkmcnt(10)
    v_mfma_f32_32x32x16_bf16 v[136:151], v[52:55], v[168:171], v[136:151]
    ds_read_b64_tr_b16 v[48:49], v25 offset:9216
    ds_read_b64_tr_b16 v[50:51], v25 offset:11264
    s_waitcnt lgkmcnt(10)
    v_mfma_f32_32x32x16_bf16 v[88:103], v[28:31], v[168:171], v[88:103]
    buffer_load_dwordx4 v[196:199], v249, s[32:35], s16 offen offset:3072 sc1
    ds_read_b64_tr_b16 v[52:53], v22 offset:9216
    ds_read_b64_tr_b16 v[54:55], v22 offset:11264
    s_waitcnt lgkmcnt(10)
    v_mfma_f32_32x32x16_bf16 v[104:119], v[32:35], v[168:171], v[104:119]
    s_add_u32 s16, s16, 16384
    ds_read_b64_tr_b16 v[28:29], v23 offset:9216
    ds_read_b64_tr_b16 v[30:31], v23 offset:11264
    s_waitcnt vmcnt(6)
    s_waitcnt lgkmcnt(10)
    v_mfma_f32_32x32x16_bf16 v[56:71], v[36:39], v[172:175], v[56:71]
    s_and_b32 s16, s16, 0x3ffff
    ds_read_b64_tr_b16 v[32:33], v20 offset:12288
    ds_read_b64_tr_b16 v[34:35], v20 offset:14336
    s_waitcnt lgkmcnt(10)
    v_mfma_f32_32x32x16_bf16 v[72:87], v[40:43], v[172:175], v[72:87]
    ds_read_b64_tr_b16 v[36:37], v21 offset:12288
    ds_read_b64_tr_b16 v[38:39], v21 offset:14336
    s_waitcnt lgkmcnt(10)
    v_mfma_f32_32x32x16_bf16 v[120:135], v[44:47], v[172:175], v[120:135]
    ds_read_b64_tr_b16 v[40:41], v24 offset:12288
    ds_read_b64_tr_b16 v[42:43], v24 offset:14336
    s_waitcnt lgkmcnt(10)
    v_mfma_f32_32x32x16_bf16 v[136:151], v[48:51], v[172:175], v[136:151]
    buffer_load_dwordx4 v[200:203], v249, s[32:35], s16 offen sc1
    ds_read_b64_tr_b16 v[44:45], v25 offset:12288
    ds_read_b64_tr_b16 v[46:47], v25 offset:14336
    s_waitcnt lgkmcnt(10)
    v_mfma_f32_32x32x16_bf16 v[88:103], v[52:55], v[172:175], v[88:103]
    ds_read_b64_tr_b16 v[48:49], v22 offset:12288
    ds_read_b64_tr_b16 v[50:51], v22 offset:14336
    s_waitcnt lgkmcnt(10)
    v_mfma_f32_32x32x16_bf16 v[104:119], v[28:31], v[172:175], v[104:119]
    ds_read_b64_tr_b16 v[52:53], v23 offset:12288
    ds_read_b64_tr_b16 v[54:55], v23 offset:14336
    s_waitcnt vmcnt(6)
    s_waitcnt lgkmcnt(10)
    v_mfma_f32_32x32x16_bf16 v[56:71], v[32:35], v[176:179], v[56:71]
    ds_read_b64_tr_b16 v[28:29], v20 offset:13312
    ds_read_b64_tr_b16 v[30:31], v20 offset:15360
    s_waitcnt lgkmcnt(10)
    v_mfma_f32_32x32x16_bf16 v[72:87], v[36:39], v[176:179], v[72:87]
    ds_read_b64_tr_b16 v[32:33], v21 offset:13312
    ds_read_b64_tr_b16 v[34:35], v21 offset:15360
    s_waitcnt lgkmcnt(10)
    v_mfma_f32_32x32x16_bf16 v[120:135], v[40:43], v[176:179], v[120:135]
    buffer_load_dwordx4 v[204:207], v249, s[32:35], s16 offen offset:1024 sc1
    ds_read_b64_tr_b16 v[36:37], v24 offset:13312
    ds_read_b64_tr_b16 v[38:39], v24 offset:15360
    s_waitcnt lgkmcnt(10)
    v_mfma_f32_32x32x16_bf16 v[136:151], v[44:47], v[176:179], v[136:151]
    ds_read_b64_tr_b16 v[40:41], v25 offset:13312
    ds_read_b64_tr_b16 v[42:43], v25 offset:15360
    s_waitcnt lgkmcnt(10)
    v_mfma_f32_32x32x16_bf16 v[88:103], v[48:51], v[176:179], v[88:103]
    ds_read_b64_tr_b16 v[44:45], v22 offset:13312
    ds_read_b64_tr_b16 v[46:47], v22 offset:15360
    s_waitcnt lgkmcnt(10)
    v_mfma_f32_32x32x16_bf16 v[104:119], v[52:55], v[176:179], v[104:119]
    ds_read_b64_tr_b16 v[48:49], v23 offset:13312
    ds_read_b64_tr_b16 v[50:51], v23 offset:15360
    s_waitcnt vmcnt(6)
    s_waitcnt lgkmcnt(10)
    v_mfma_f32_32x32x16_bf16 v[56:71], v[28:31], v[180:183], v[56:71]
    ds_read_b64_tr_b16 v[52:53], v20 offset:16384
    ds_read_b64_tr_b16 v[54:55], v20 offset:18432
    s_waitcnt lgkmcnt(10)
    v_mfma_f32_32x32x16_bf16 v[72:87], v[32:35], v[180:183], v[72:87]
    buffer_load_dwordx4 v[208:211], v249, s[32:35], s16 offen offset:2048 sc1
    ds_read_b64_tr_b16 v[28:29], v21 offset:16384
    ds_read_b64_tr_b16 v[30:31], v21 offset:18432
    s_waitcnt lgkmcnt(10)
    v_mfma_f32_32x32x16_bf16 v[120:135], v[36:39], v[180:183], v[120:135]
    ds_read_b64_tr_b16 v[32:33], v24 offset:16384
    ds_read_b64_tr_b16 v[34:35], v24 offset:18432
    s_waitcnt lgkmcnt(10)
    v_mfma_f32_32x32x16_bf16 v[136:151], v[40:43], v[180:183], v[136:151]
    ds_read_b64_tr_b16 v[36:37], v25 offset:16384
    ds_read_b64_tr_b16 v[38:39], v25 offset:18432
    s_waitcnt lgkmcnt(10)
    v_mfma_f32_32x32x16_bf16 v[88:103], v[44:47], v[180:183], v[88:103]
    ds_read_b64_tr_b16 v[40:41], v22 offset:16384
    ds_read_b64_tr_b16 v[42:43], v22 offset:18432
    s_waitcnt lgkmcnt(10)
    v_mfma_f32_32x32x16_bf16 v[104:119], v[48:51], v[180:183], v[104:119]
    buffer_load_dwordx4 v[212:215], v249, s[32:35], s16 offen offset:3072 sc1
    ds_read_b64_tr_b16 v[44:45], v23 offset:16384
    ds_read_b64_tr_b16 v[46:47], v23 offset:18432
    s_barrier
    s_waitcnt vmcnt(7)
    s_waitcnt lgkmcnt(10)
    v_mfma_f32_32x32x16_bf16 v[56:71], v[52:55], v[184:187], v[56:71]
    s_add_u32 s16, s16, 16384
    ds_read_b64_tr_b16 v[48:49], v20 offset:17408
    ds_read_b64_tr_b16 v[50:51], v20 offset:19456
    s_waitcnt lgkmcnt(10)
    v_mfma_f32_32x32x16_bf16 v[72:87], v[28:31], v[184:187], v[72:87]
    s_and_b32 s16, s16, 0x3ffff
    ds_read_b64_tr_b16 v[52:53], v21 offset:17408
    ds_read_b64_tr_b16 v[54:55], v21 offset:19456
    s_waitcnt lgkmcnt(10)
    v_mfma_f32_32x32x16_bf16 v[120:135], v[32:35], v[184:187], v[120:135]
    ds_read_b64_tr_b16 v[28:29], v24 offset:17408
    ds_read_b64_tr_b16 v[30:31], v24 offset:19456
    s_waitcnt lgkmcnt(10)
    v_mfma_f32_32x32x16_bf16 v[136:151], v[36:39], v[184:187], v[136:151]
    ds_read_b64_tr_b16 v[32:33], v25 offset:17408
    ds_read_b64_tr_b16 v[34:35], v25 offset:19456
    s_waitcnt lgkmcnt(10)
    v_mfma_f32_32x32x16_bf16 v[88:103], v[40:43], v[184:187], v[88:103]
    buffer_load_dwordx4 v[216:219], v249, s[32:35], s16 offen sc1
    ds_read_b64_tr_b16 v[36:37], v22 offset:17408
    ds_read_b64_tr_b16 v[38:39], v22 offset:19456
    s_waitcnt lgkmcnt(10)
    v_mfma_f32_32x32x16_bf16 v[104:119], v[44:47], v[184:187], v[104:119]
    ds_read_b64_tr_b16 v[40:41], v23 offset:17408
    ds_read_b64_tr_b16 v[42:43], v23 offset:19456
    s_waitcnt vmcnt(7)
    s_waitcnt lgkmcnt(10)
    v_mfma_f32_32x32x16_bf16 v[56:71], v[48:51], v[188:191], v[56:71]
    ds_read_b64_tr_b16 v[44:45], v20 offset:20480
    ds_read_b64_tr_b16 v[46:47], v20 offset:22528
    s_waitcnt lgkmcnt(10)
    v_mfma_f32_32x32x16_bf16 v[72:87], v[52:55], v[188:191], v[72:87]
    ds_read_b64_tr_b16 v[48:49], v21 offset:20480
    ds_read_b64_tr_b16 v[50:51], v21 offset:22528
    s_waitcnt lgkmcnt(10)
    v_mfma_f32_32x32x16_bf16 v[120:135], v[28:31], v[188:191], v[120:135]
    ds_read_b64_tr_b16 v[52:53], v24 offset:20480
    ds_read_b64_tr_b16 v[54:55], v24 offset:22528
    s_waitcnt lgkmcnt(10)
    v_mfma_f32_32x32x16_bf16 v[136:151], v[32:35], v[188:191], v[136:151]
    buffer_load_dwordx4 v[220:223], v249, s[32:35], s16 offen offset:1024 sc1
    ds_read_b64_tr_b16 v[28:29], v25 offset:20480
    ds_read_b64_tr_b16 v[30:31], v25 offset:22528
    s_waitcnt lgkmcnt(10)
    v_mfma_f32_32x32x16_bf16 v[88:103], v[36:39], v[188:191], v[88:103]
    ds_read_b64_tr_b16 v[32:33], v22 offset:20480
    ds_read_b64_tr_b16 v[34:35], v22 offset:22528
    s_waitcnt lgkmcnt(10)
    v_mfma_f32_32x32x16_bf16 v[104:119], v[40:43], v[188:191], v[104:119]
    ds_read_b64_tr_b16 v[36:37], v23 offset:20480
    ds_read_b64_tr_b16 v[38:39], v23 offset:22528
    s_waitcnt vmcnt(7)
    s_waitcnt lgkmcnt(10)
    v_mfma_f32_32x32x16_bf16 v[56:71], v[44:47], v[192:195], v[56:71]
    ds_read_b64_tr_b16 v[40:41], v20 offset:21504
    ds_read_b64_tr_b16 v[42:43], v20 offset:23552
    s_waitcnt lgkmcnt(10)
    v_mfma_f32_32x32x16_bf16 v[72:87], v[48:51], v[192:195], v[72:87]
    ds_read_b64_tr_b16 v[44:45], v21 offset:21504
    ds_read_b64_tr_b16 v[46:47], v21 offset:23552
    s_waitcnt lgkmcnt(10)
    v_mfma_f32_32x32x16_bf16 v[120:135], v[52:55], v[192:195], v[120:135]
    buffer_load_dwordx4 v[224:227], v249, s[32:35], s16 offen offset:2048 sc1
    ds_read_b64_tr_b16 v[48:49], v24 offset:21504
    ds_read_b64_tr_b16 v[50:51], v24 offset:23552
    s_waitcnt lgkmcnt(10)
    v_mfma_f32_32x32x16_bf16 v[136:151], v[28:31], v[192:195], v[136:151]
    ds_read_b64_tr_b16 v[52:53], v25 offset:21504
    ds_read_b64_tr_b16 v[54:55], v25 offset:23552
    s_waitcnt lgkmcnt(10)
    v_mfma_f32_32x32x16_bf16 v[88:103], v[32:35], v[192:195], v[88:103]
    ds_read_b64_tr_b16 v[28:29], v22 offset:21504
    ds_read_b64_tr_b16 v[30:31], v22 offset:23552
    s_waitcnt lgkmcnt(10)
    v_mfma_f32_32x32x16_bf16 v[104:119], v[36:39], v[192:195], v[104:119]
    ds_read_b64_tr_b16 v[32:33], v23 offset:21504
    ds_read_b64_tr_b16 v[34:35], v23 offset:23552
    s_waitcnt vmcnt(7)
    s_waitcnt lgkmcnt(10)
    v_mfma_f32_32x32x16_bf16 v[56:71], v[40:43], v[196:199], v[56:71]
    ds_read_b64_tr_b16 v[36:37], v20 offset:24576
    ds_read_b64_tr_b16 v[38:39], v20 offset:26624
    s_waitcnt lgkmcnt(10)
    v_mfma_f32_32x32x16_bf16 v[72:87], v[44:47], v[196:199], v[72:87]
    buffer_load_dwordx4 v[228:231], v249, s[32:35], s16 offen offset:3072 sc1
    ds_read_b64_tr_b16 v[40:41], v21 offset:24576
    ds_read_b64_tr_b16 v[42:43], v21 offset:26624
    s_waitcnt lgkmcnt(10)
    v_mfma_f32_32x32x16_bf16 v[120:135], v[48:51], v[196:199], v[120:135]
    s_add_u32 s16, s16, 16384
    ds_read_b64_tr_b16 v[44:45], v24 offset:24576
    ds_read_b64_tr_b16 v[46:47], v24 offset:26624
    s_waitcnt lgkmcnt(10)
    v_mfma_f32_32x32x16_bf16 v[136:151], v[52:55], v[196:199], v[136:151]
    s_and_b32 s16, s16, 0x3ffff
    ds_read_b64_tr_b16 v[48:49], v25 offset:24576
    ds_read_b64_tr_b16 v[50:51], v25 offset:26624
    s_waitcnt lgkmcnt(10)
    v_mfma_f32_32x32x16_bf16 v[88:103], v[28:31], v[196:199], v[88:103]
    ds_read_b64_tr_b16 v[52:53], v22 offset:24576
    ds_read_b64_tr_b16 v[54:55], v22 offset:26624
    s_waitcnt lgkmcnt(10)
    v_mfma_f32_32x32x16_bf16 v[104:119], v[32:35], v[196:199], v[104:119]
    buffer_load_dwordx4 v[232:235], v249, s[32:35], s16 offen sc1
    ds_read_b64_tr_b16 v[28:29], v23 offset:24576
    ds_read_b64_tr_b16 v[30:31], v23 offset:26624
    s_barrier
    s_waitcnt vmcnt(8)
    s_waitcnt lgkmcnt(10)
    v_mfma_f32_32x32x16_bf16 v[56:71], v[36:39], v[200:203], v[56:71]
    ds_read_b64_tr_b16 v[32:33], v20 offset:25600
    ds_read_b64_tr_b16 v[34:35], v20 offset:27648
    s_waitcnt lgkmcnt(10)
    v_mfma_f32_32x32x16_bf16 v[72:87], v[40:43], v[200:203], v[72:87]
    ds_read_b64_tr_b16 v[36:37], v21 offset:25600
    ds_read_b64_tr_b16 v[38:39], v21 offset:27648
    s_waitcnt lgkmcnt(10)
    v_mfma_f32_32x32x16_bf16 v[120:135], v[44:47], v[200:203], v[120:135]
    ds_read_b64_tr_b16 v[40:41], v24 offset:25600
    ds_read_b64_tr_b16 v[42:43], v24 offset:27648
    s_waitcnt lgkmcnt(10)
    v_mfma_f32_32x32x16_bf16 v[136:151], v[48:51], v[200:203], v[136:151]
    ds_read_b64_tr_b16 v[44:45], v25 offset:25600
    ds_read_b64_tr_b16 v[46:47], v25 offset:27648
    s_waitcnt lgkmcnt(10)
    v_mfma_f32_32x32x16_bf16 v[88:103], v[52:55], v[200:203], v[88:103]
    buffer_load_dwordx4 v[236:239], v249, s[32:35], s16 offen offset:1024 sc1
    ds_read_b64_tr_b16 v[48:49], v22 offset:25600
    ds_read_b64_tr_b16 v[50:51], v22 offset:27648
    s_waitcnt lgkmcnt(10)
    v_mfma_f32_32x32x16_bf16 v[104:119], v[28:31], v[200:203], v[104:119]
    ds_read_b64_tr_b16 v[52:53], v23 offset:25600
    ds_read_b64_tr_b16 v[54:55], v23 offset:27648
    s_waitcnt vmcnt(8)
    s_waitcnt lgkmcnt(10)
    v_mfma_f32_32x32x16_bf16 v[56:71], v[32:35], v[204:207], v[56:71]
    ds_read_b64_tr_b16 v[28:29], v20 offset:28672
    ds_read_b64_tr_b16 v[30:31], v20 offset:30720
    s_waitcnt lgkmcnt(10)
    v_mfma_f32_32x32x16_bf16 v[72:87], v[36:39], v[204:207], v[72:87]
    ds_read_b64_tr_b16 v[32:33], v21 offset:28672
    ds_read_b64_tr_b16 v[34:35], v21 offset:30720
L_PAD2:
    s_cbranch_execz L_RET2
    s_waitcnt lgkmcnt(10)
    v_mfma_f32_32x32x16_bf16 v[120:135], v[40:43], v[204:207], v[120:135]
    ds_read_b64_tr_b16 v[36:37], v24 offset:28672
    ds_read_b64_tr_b16 v[38:39], v24 offset:30720
    s_waitcnt lgkmcnt(10)
    v_mfma_f32_32x32x16_bf16 v[136:151], v[44:47], v[204:207], v[136:151]
    buffer_load_dwordx4 v[240:243], v249, s[32:35], s16 offen offset:2048 sc1
    ds_read_b64_tr_b16 v[40:41], v25 offset:28672
    ds_read_b64_tr_b16 v[42:43], v25 offset:30720
    s_waitcnt lgkmcnt(10)
    v_mfma_f32_32x32x16_bf16 v[88:103], v[48:51], v[204:207], v[88:103]
    ds_read_b64_tr_b16 v[44:45], v22 offset:28672
    ds_read_b64_tr_b16 v[46:47], v22 offset:30720
    s_waitcnt lgkmcnt(10)
    v_mfma_f32_32x32x16_bf16 v[104:119], v[52:55], v[204:207], v[104:119]
    ds_read_b64_tr_b16 v[48:49], v23 offset:28672
    ds_read_b64_tr_b16 v[50:51], v23 offset:30720
    s_waitcnt vmcnt(8)
    s_waitcnt lgkmcnt(10)
    v_mfma_f32_32x32x16_bf16 v[56:71], v[28:31], v[208:211], v[56:71]
    ds_read_b64_tr_b16 v[52:53], v20 offset:29696
    ds_read_b64_tr_b16 v[54:55], v20 offset:31744
    s_waitcnt lgkmcnt(10)
    v_mfma_f32_32x32x16_bf16 v[72:87], v[32:35], v[208:211], v[72:87]
    ds_read_b64_tr_b16 v[28:29], v21 offset:29696
    ds_read_b64_tr_b16 v[30:31], v21 offset:31744
    s_waitcnt lgkmcnt(10)
    v_mfma_f32_32x32x16_bf16 v[120:135], v[36:39], v[208:211], v[120:135]
    buffer_load_dwordx4 v[244:247], v249, s[32:35], s16 offen offset:3072 sc1
    ds_read_b64_tr_b16 v[32:33], v24 offset:29696
    ds_read_b64_tr_b16 v[34:35], v24 offset:31744
    s_waitcnt lgkmcnt(10)
    v_mfma_f32_32x32x16_bf16 v[136:151], v[40:43], v[208:211], v[136:151]
    s_add_u32 s16, s16, 16384
    ds_read_b64_tr_b16 v[36:37], v25 offset:29696
    ds_read_b64_tr_b16 v[38:39], v25 offset:31744
    s_waitcnt lgkmcnt(10)
    v_mfma_f32_32x32x16_bf16 v[88:103], v[44:47], v[208:211], v[88:103]
    s_and_b32 s16, s16, 0x3ffff
    ds_read_b64_tr_b16 v[40:41], v22 offset:29696
    ds_read_b64_tr_b16 v[42:43], v22 offset:31744
    s_waitcnt lgkmcnt(10)
    v_mfma_f32_32x32x16_bf16 v[104:119], v[48:51], v[208:211], v[104:119]
    ds_read_b64_tr_b16 v[44:45], v23 offset:29696
    ds_read_b64_tr_b16 v[46:47], v23 offset:31744
    s_waitcnt vmcnt(8)
    s_waitcnt lgkmcnt(10)
    v_mfma_f32_32x32x16_bf16 v[56:71], v[52:55], v[212:215], v[56:71]
    ds_read_b64_tr_b16 v[48:49], v20 offset:32768
    ds_read_b64_tr_b16 v[50:51], v20 offset:34816
    s_waitcnt lgkmcnt(10)
    v_mfma_f32_32x32x16_bf16 v[72:87], v[28:31], v[212:215], v[72:87]
    buffer_load_dwordx4 v[152:155], v249, s[32:35], s16 offen sc1
    ds_read_b64_tr_b16 v[52:53], v21 offset:32768
    ds_read_b64_tr_b16 v[54:55], v21 offset:34816
    s_waitcnt lgkmcnt(10)
    v_mfma_f32_32x32x16_bf16 v[120:135], v[32:35], v[212:215], v[120:135]
    ds_read_b64_tr_b16 v[28:29], v24 offset:32768
    ds_read_b64_tr_b16 v[30:31], v24 offset:34816
    s_waitcnt lgkmcnt(10)
    v_mfma_f32_32x32x16_bf16 v[136:151], v[36:39], v[212:215], v[136:151]
    ds_read_b64_tr_b16 v[32:33], v25 offset:32768
    ds_read_b64_tr_b16 v[34:35], v25 offset:34816
    s_waitcnt lgkmcnt(10)
    v_mfma_f32_32x32x16_bf16 v[88:103], v[40:43], v[212:215], v[88:103]
    ds_read_b64_tr_b16 v[36:37], v22 offset:32768
    ds_read_b64_tr_b16 v[38:39], v22 offset:34816
    s_waitcnt lgkmcnt(10)
    v_mfma_f32_32x32x16_bf16 v[104:119], v[44:47], v[212:215], v[104:119]
    buffer_load_dwordx4 v[156:159], v249, s[32:35], s16 offen offset:1024 sc1
    ds_read_b64_tr_b16 v[40:41], v23 offset:32768
    ds_read_b64_tr_b16 v[42:43], v23 offset:34816
    s_barrier
    s_waitcnt vmcnt(9)
    s_waitcnt lgkmcnt(10)
    v_mfma_f32_32x32x16_bf16 v[56:71], v[48:51], v[216:219], v[56:71]
    ds_read_b64_tr_b16 v[44:45], v20 offset:33792
    ds_read_b64_tr_b16 v[46:47], v20 offset:35840
    s_waitcnt lgkmcnt(10)
    v_mfma_f32_32x32x16_bf16 v[72:87], v[52:55], v[216:219], v[72:87]
    ds_read_b64_tr_b16 v[48:49], v21 offset:33792
    ds_read_b64_tr_b16 v[50:51], v21 offset:35840
    s_waitcnt lgkmcnt(10)
    v_mfma_f32_32x32x16_bf16 v[120:135], v[28:31], v[216:219], v[120:135]
    ds_read_b64_tr_b16 v[52:53], v24 offset:33792
    ds_read_b64_tr_b16 v[54:55], v24 offset:35840
    s_waitcnt lgkmcnt(10)
    v_mfma_f32_32x32x16_bf16 v[136:151], v[32:35], v[216:219], v[136:151]
    ds_read_b64_tr_b16 v[28:29], v25 offset:33792
    ds_read_b64_tr_b16 v[30:31], v25 offset:35840
    s_waitcnt lgkmcnt(10)
    v_mfma_f32_32x32x16_bf16 v[88:103], v[36:39], v[216:219], v[88:103]
    buffer_load_dwordx4 v[160:163], v249, s[32:35], s16 offen offset:2048 sc1
    ds_read_b64_tr_b16 v[32:33], v22 offset:33792
    ds_read_b64_tr_b16 v[34:35], v22 offset:35840
    s_waitcnt lgkmcnt(10)
    v_mfma_f32_32x32x16_bf16 v[104:119], v[40:43], v[216:219], v[104:119]
    ds_read_b64_tr_b16 v[36:37], v23 offset:33792
    ds_read_b64_tr_b16 v[38:39], v23 offset:35840
    s_waitcnt vmcnt(9)
    s_waitcnt lgkmcnt(10)
    v_mfma_f32_32x32x16_bf16 v[56:71], v[44:47], v[220:223], v[56:71]
    ds_read_b64_tr_b16 v[40:41], v20 offset:36864
    ds_read_b64_tr_b16 v[42:43], v20 offset:38912
    s_waitcnt lgkmcnt(10)
    v_mfma_f32_32x32x16_bf16 v[72:87], v[48:51], v[220:223], v[72:87]
    ds_read_b64_tr_b16 v[44:45], v21 offset:36864
    ds_read_b64_tr_b16 v[46:47], v21 offset:38912
    s_waitcnt lgkmcnt(10)
    v_mfma_f32_32x32x16_bf16 v[120:135], v[52:55], v[220:223], v[120:135]
    ds_read_b64_tr_b16 v[48:49], v24 offset:36864
    ds_read_b64_tr_b16 v[50:51], v24 offset:38912
    s_waitcnt lgkmcnt(10)
    v_mfma_f32_32x32x16_bf16 v[136:151], v[28:31], v[220:223], v[136:151]
    buffer_load_dwordx4 v[164:167], v249, s[32:35], s16 offen offset:3072 sc1
    ds_read_b64_tr_b16 v[52:53], v25 offset:36864
    ds_read_b64_tr_b16 v[54:55], v25 offset:38912
    s_waitcnt lgkmcnt(10)
    v_mfma_f32_32x32x16_bf16 v[88:103], v[32:35], v[220:223], v[88:103]
    s_add_u32 s16, s16, 16384
    ds_read_b64_tr_b16 v[28:29], v22 offset:36864
    ds_read_b64_tr_b16 v[30:31], v22 offset:38912
    s_waitcnt lgkmcnt(10)
    v_mfma_f32_32x32x16_bf16 v[104:119], v[36:39], v[220:223], v[104:119]
    s_and_b32 s16, s16, 0x3ffff
    ds_read_b64_tr_b16 v[32:33], v23 offset:36864
    ds_read_b64_tr_b16 v[34:35], v23 offset:38912
    s_waitcnt vmcnt(9)
    s_waitcnt lgkmcnt(10)
    v_mfma_f32_32x32x16_bf16 v[56:71], v[40:43], v[224:227], v[56:71]
    ds_read_b64_tr_b16 v[36:37], v20 offset:37888
    ds_read_b64_tr_b16 v[38:39], v20 offset:39936
    s_waitcnt lgkmcnt(10)
    v_mfma_f32_32x32x16_bf16 v[72:87], v[44:47], v[224:227], v[72:87]
    ds_read_b64_tr_b16 v[40:41], v21 offset:37888
    ds_read_b64_tr_b16 v[42:43], v21 offset:39936
    s_waitcnt lgkmcnt(10)
    v_mfma_f32_32x32x16_bf16 v[120:135], v[48:51], v[224:227], v[120:135]
    buffer_load_dwordx4 v[168:171], v249, s[32:35], s16 offen sc1
    ds_read_b64_tr_b16 v[44:45], v24 offset:37888
    ds_read_b64_tr_b16 v[46:47], v24 offset:39936
    s_waitcnt lgkmcnt(10)
    v_mfma_f32_32x32x16_bf16 v[136:151], v[52:55], v[224:227], v[136:151]
    ds_read_b64_tr_b16 v[48:49], v25 offset:37888
    ds_read_b64_tr_b16 v[50:51], v25 offset:39936
    s_waitcnt lgkmcnt(10)
    v_mfma_f32_32x32x16_bf16 v[88:103], v[28:31], v[224:227], v[88:103]
    ds_read_b64_tr_b16 v[52:53], v22 offset:37888
    ds_read_b64_tr_b16 v[54:55], v22 offset:39936
    s_waitcnt lgkmcnt(10)
    v_mfma_f32_32x32x16_bf16 v[104:119], v[32:35], v[224:227], v[104:119]
    ds_read_b64_tr_b16 v[28:29], v23 offset:37888
    ds_read_b64_tr_b16 v[30:31], v23 offset:39936
    s_waitcnt vmcnt(9)
    s_waitcnt lgkmcnt(10)
    v_mfma_f32_32x32x16_bf16 v[56:71], v[36:39], v[228:231], v[56:71]
    ds_read_b64_tr_b16 v[32:33], v20 offset:40960
    ds_read_b64_tr_b16 v[34:35], v20 offset:43008
    s_waitcnt lgkmcnt(10)
    v_mfma_f32_32x32x16_bf16 v[72:87], v[40:43], v[228:231], v[72:87]
    buffer_load_dwordx4 v[172:175], v249, s[32:35], s16 offen offset:1024 sc1
    ds_read_b64_tr_b16 v[36:37], v21 offset:40960
    ds_read_b64_tr_b16 v[38:39], v21 offset:43008
    s_waitcnt lgkmcnt(10)
    v_mfma_f32_32x32x16_bf16 v[120:135], v[44:47], v[228:231], v[120:135]
    ds_read_b64_tr_b16 v[40:41], v24 offset:40960
    ds_read_b64_tr_b16 v[42:43], v24 offset:43008
    s_waitcnt lgkmcnt(10)
    v_mfma_f32_32x32x16_bf16 v[136:151], v[48:51], v[228:231], v[136:151]
    ds_read_b64_tr_b16 v[44:45], v25 offset:40960
    ds_read_b64_tr_b16 v[46:47], v25 offset:43008
    s_waitcnt lgkmcnt(10)
    v_mfma_f32_32x32x16_bf16 v[88:103], v[52:55], v[228:231], v[88:103]
    ds_read_b64_tr_b16 v[48:49], v22 offset:40960
    ds_read_b64_tr_b16 v[50:51], v22 offset:43008
    s_waitcnt lgkmcnt(10)
    v_mfma_f32_32x32x16_bf16 v[104:119], v[28:31], v[228:231], v[104:119]
    buffer_load_dwordx4 v[176:179], v249, s[32:35], s16 offen offset:2048 sc1
    ds_read_b64_tr_b16 v[52:53], v23 offset:40960
    ds_read_b64_tr_b16 v[54:55], v23 offset:43008
    s_barrier
    s_waitcnt vmcnt(10)
    s_waitcnt lgkmcnt(10)
    v_mfma_f32_32x32x16_bf16 v[56:71], v[32:35], v[232:235], v[56:71]
    ds_read_b64_tr_b16 v[28:29], v20 offset:41984
    ds_read_b64_tr_b16 v[30:31], v20 offset:44032
    s_waitcnt lgkmcnt(10)
    v_mfma_f32_32x32x16_bf16 v[72:87], v[36:39], v[232:235], v[72:87]
    ds_read_b64_tr_b16 v[32:33], v21 offset:41984
    ds_read_b64_tr_b16 v[34:35], v21 offset:44032
    s_waitcnt lgkmcnt(10)
    v_mfma_f32_32x32x16_bf16 v[120:135], v[40:43], v[232:235], v[120:135]
    ds_read_b64_tr_b16 v[36:37], v24 offset:41984
    ds_read_b64_tr_b16 v[38:39], v24 offset:44032
    s_waitcnt lgkmcnt(10)
    v_mfma_f32_32x32x16_bf16 v[136:151], v[44:47], v[232:235], v[136:151]
    buffer_load_dwordx4 v[180:183], v249, s[32:35], s16 offen offset:3072 sc1
    ds_read_b64_tr_b16 v[40:41], v25 offset:41984
    ds_read_b64_tr_b16 v[42:43], v25 offset:44032
    s_waitcnt lgkmcnt(10)
    v_mfma_f32_32x32x16_bf16 v[88:103], v[48:51], v[232:235], v[88:103]
    s_add_u32 s16, s16, 16384
    ds_read_b64_tr_b16 v[44:45], v22 offset:41984
    ds_read_b64_tr_b16 v[46:47], v22 offset:44032
    s_waitcnt lgkmcnt(10)
    v_mfma_f32_32x32x16_bf16 v[104:119], v[52:55], v[232:235], v[104:119]
    s_and_b32 s16, s16, 0x3ffff
    ds_read_b64_tr_b16 v[48:49], v23 offset:41984
    ds_read_b64_tr_b16 v[50:51], v23 offset:44032
    s_waitcnt vmcnt(10)
    s_waitcnt lgkmcnt(10)
    v_mfma_f32_32x32x16_bf16 v[56:71], v[28:31], v[236:239], v[56:71]
    buffer_load_dwordx4 v[184:187], v249, s[32:35], s16 offen sc1
    ds_read_b64_tr_b16 v[52:53], v20 offset:45056
    ds_read_b64_tr_b16 v[54:55], v20 offset:47104
    s_waitcnt lgkmcnt(10)
    v_mfma_f32_32x32x16_bf16 v[72:87], v[32:35], v[236:239], v[72:87]
    ds_read_b64_tr_b16 v[28:29], v21 offset:45056
    ds_read_b64_tr_b16 v[30:31], v21 offset:47104
    s_waitcnt lgkmcnt(10)
    v_mfma_f32_32x32x16_bf16 v[120:135], v[36:39], v[236:239], v[120:135]
    ds_read_b64_tr_b16 v[32:33], v24 offset:45056
    ds_read_b64_tr_b16 v[34:35], v24 offset:47104
    s_waitcnt lgkmcnt(10)
    v_mfma_f32_32x32x16_bf16 v[136:151], v[40:43], v[236:239], v[136:151]
    ds_read_b64_tr_b16 v[36:37], v25 offset:45056
    ds_read_b64_tr_b16 v[38:39], v25 offset:47104
    s_waitcnt lgkmcnt(10)
    v_mfma_f32_32x32x16_bf16 v[88:103], v[44:47], v[236:239], v[88:103]
    buffer_load_dwordx4 v[188:191], v249, s[32:35], s16 offen offset:1024 sc1
    ds_read_b64_tr_b16 v[40:41], v22 offset:45056
    ds_read_b64_tr_b16 v[42:43], v22 offset:47104
    s_waitcnt lgkmcnt(10)
    v_mfma_f32_32x32x16_bf16 v[104:119], v[48:51], v[236:239], v[104:119]
    ds_read_b64_tr_b16 v[44:45], v23 offset:45056
    ds_read_b64_tr_b16 v[46:47], v23 offset:47104
    s_waitcnt vmcnt(11)
    s_waitcnt lgkmcnt(10)
    v_mfma_f32_32x32x16_bf16 v[56:71], v[52:55], v[240:243], v[56:71]
    ds_read_b64_tr_b16 v[48:49], v20 offset:46080
    ds_read_b64_tr_b16 v[50:51], v20 offset:48128
    s_waitcnt lgkmcnt(10)
    v_mfma_f32_32x32x16_bf16 v[72:87], v[28:31], v[240:243], v[72:87]
    buffer_load_dwordx4 v[192:195], v249, s[32:35], s16 offen offset:2048 sc1
    ds_read_b64_tr_b16 v[52:53], v21 offset:46080
    ds_read_b64_tr_b16 v[54:55], v21 offset:48128
    s_waitcnt lgkmcnt(10)
    v_mfma_f32_32x32x16_bf16 v[120:135], v[32:35], v[240:243], v[120:135]
    ds_read_b64_tr_b16 v[28:29], v24 offset:46080
    ds_read_b64_tr_b16 v[30:31], v24 offset:48128
    s_waitcnt lgkmcnt(10)
    v_mfma_f32_32x32x16_bf16 v[136:151], v[36:39], v[240:243], v[136:151]
    ds_read_b64_tr_b16 v[32:33], v25 offset:46080
    ds_read_b64_tr_b16 v[34:35], v25 offset:48128
    s_waitcnt lgkmcnt(10)
    v_mfma_f32_32x32x16_bf16 v[88:103], v[40:43], v[240:243], v[88:103]
    ds_read_b64_tr_b16 v[36:37], v22 offset:46080
    ds_read_b64_tr_b16 v[38:39], v22 offset:48128
    s_waitcnt lgkmcnt(10)
    v_mfma_f32_32x32x16_bf16 v[104:119], v[44:47], v[240:243], v[104:119]
    buffer_load_dwordx4 v[196:199], v249, s[32:35], s16 offen offset:3072 sc1
    ds_read_b64_tr_b16 v[40:41], v23 offset:46080
    ds_read_b64_tr_b16 v[42:43], v23 offset:48128
    s_waitcnt vmcnt(12)
    s_waitcnt lgkmcnt(10)
    v_mfma_f32_32x32x16_bf16 v[56:71], v[48:51], v[244:247], v[56:71]
    s_add_u32 s16, s16, 16384
    ds_read_b64_tr_b16 v[44:45], v20
    ds_read_b64_tr_b16 v[46:47], v20 offset:2048
    s_waitcnt lgkmcnt(10)
    v_mfma_f32_32x32x16_bf16 v[72:87], v[52:55], v[244:247], v[72:87]
    s_and_b32 s16, s16, 0x3ffff
    ds_read_b64_tr_b16 v[48:49], v21
    ds_read_b64_tr_b16 v[50:51], v21 offset:2048
    s_waitcnt lgkmcnt(10)
    v_mfma_f32_32x32x16_bf16 v[120:135], v[28:31], v[244:247], v[120:135]
    buffer_load_dwordx4 v[200:203], v249, s[32:35], s16 offen sc1
    ds_read_b64_tr_b16 v[52:53], v24
    ds_read_b64_tr_b16 v[54:55], v24 offset:2048
    s_waitcnt lgkmcnt(10)
    v_mfma_f32_32x32x16_bf16 v[136:151], v[32:35], v[244:247], v[136:151]
    ds_read_b64_tr_b16 v[28:29], v25
    ds_read_b64_tr_b16 v[30:31], v25 offset:2048
    s_waitcnt lgkmcnt(10)
    v_mfma_f32_32x32x16_bf16 v[88:103], v[36:39], v[244:247], v[88:103]
    ds_read_b64_tr_b16 v[32:33], v22
    ds_read_b64_tr_b16 v[34:35], v22 offset:2048
    s_waitcnt lgkmcnt(10)
    v_mfma_f32_32x32x16_bf16 v[104:119], v[40:43], v[244:247], v[104:119]
    buffer_load_dwordx4 v[204:207], v249, s[32:35], s16 offen offset:1024 sc1
    ds_read_b64_tr_b16 v[36:37], v23
    ds_read_b64_tr_b16 v[38:39], v23 offset:2048
    s_barrier
    s_waitcnt vmcnt(13)
    s_waitcnt lgkmcnt(10)
    v_mfma_f32_32x32x16_bf16 v[56:71], v[44:47], v[152:155], v[56:71]
    ds_read_b64_tr_b16 v[40:41], v20 offset:1024
    ds_read_b64_tr_b16 v[42:43], v20 offset:3072
    s_waitcnt lgkmcnt(10)
    v_mfma_f32_32x32x16_bf16 v[72:87], v[48:51], v[152:155], v[72:87]
    ds_read_b64_tr_b16 v[44:45], v21 offset:1024
    ds_read_b64_tr_b16 v[46:47], v21 offset:3072
    s_waitcnt lgkmcnt(10)
    v_mfma_f32_32x32x16_bf16 v[120:135], v[52:55], v[152:155], v[120:135]
    ds_read_b64_tr_b16 v[48:49], v24 offset:1024
    ds_read_b64_tr_b16 v[50:51], v24 offset:3072
    s_waitcnt lgkmcnt(10)
    v_mfma_f32_32x32x16_bf16 v[136:151], v[28:31], v[152:155], v[136:151]
    buffer_load_dwordx4 v[208:211], v249, s[32:35], s16 offen offset:2048 sc1
    ds_read_b64_tr_b16 v[52:53], v25 offset:1024
    ds_read_b64_tr_b16 v[54:55], v25 offset:3072
    s_waitcnt lgkmcnt(10)
    v_mfma_f32_32x32x16_bf16 v[88:103], v[32:35], v[152:155], v[88:103]
    ds_read_b64_tr_b16 v[28:29], v22 offset:1024
    ds_read_b64_tr_b16 v[30:31], v22 offset:3072
    s_waitcnt lgkmcnt(10)
    v_mfma_f32_32x32x16_bf16 v[104:119], v[36:39], v[152:155], v[104:119]
    ds_read_b64_tr_b16 v[32:33], v23 offset:1024
    ds_read_b64_tr_b16 v[34:35], v23 offset:3072
    s_waitcnt vmcnt(13)
    s_waitcnt lgkmcnt(10)
    v_mfma_f32_32x32x16_bf16 v[56:71], v[40:43], v[156:159], v[56:71]
    buffer_load_dwordx4 v[212:215], v249, s[32:35], s16 offen offset:3072 sc1
    ds_read_b64_tr_b16 v[36:37], v20 offset:4096
    ds_read_b64_tr_b16 v[38:39], v20 offset:6144
    s_waitcnt lgkmcnt(10)
    v_mfma_f32_32x32x16_bf16 v[72:87], v[44:47], v[156:159], v[72:87]
    s_add_u32 s16, s16, 16384
    ds_read_b64_tr_b16 v[40:41], v21 offset:4096
    ds_read_b64_tr_b16 v[42:43], v21 offset:6144
    s_waitcnt lgkmcnt(10)
    v_mfma_f32_32x32x16_bf16 v[120:135], v[48:51], v[156:159], v[120:135]
    s_and_b32 s16, s16, 0x3ffff
    ds_read_b64_tr_b16 v[44:45], v24 offset:4096
    ds_read_b64_tr_b16 v[46:47], v24 offset:6144
    s_waitcnt lgkmcnt(10)
    v_mfma_f32_32x32x16_bf16 v[136:151], v[52:55], v[156:159], v[136:151]
    ds_read_b64_tr_b16 v[48:49], v25 offset:4096
    ds_read_b64_tr_b16 v[50:51], v25 offset:6144
    s_waitcnt lgkmcnt(10)
    v_mfma_f32_32x32x16_bf16 v[88:103], v[28:31], v[156:159], v[88:103]
    buffer_load_dwordx4 v[216:219], v249, s[32:35], s16 offen sc1
    ds_read_b64_tr_b16 v[52:53], v22 offset:4096
    ds_read_b64_tr_b16 v[54:55], v22 offset:6144
    s_waitcnt lgkmcnt(10)
    v_mfma_f32_32x32x16_bf16 v[104:119], v[32:35], v[156:159], v[104:119]
    ds_read_b64_tr_b16 v[28:29], v23 offset:4096
    ds_read_b64_tr_b16 v[30:31], v23 offset:6144
    s_waitcnt vmcnt(14)
    s_waitcnt lgkmcnt(10)
    v_mfma_f32_32x32x16_bf16 v[56:71], v[36:39], v[160:163], v[56:71]
    ds_read_b64_tr_b16 v[32:33], v20 offset:5120
    ds_read_b64_tr_b16 v[34:35], v20 offset:7168
    s_waitcnt lgkmcnt(10)
    v_mfma_f32_32x32x16_bf16 v[72:87], v[40:43], v[160:163], v[72:87]
    buffer_load_dwordx4 v[220:223], v249, s[32:35], s16 offen offset:1024 sc1
    ds_read_b64_tr_b16 v[36:37], v21 offset:5120
    ds_read_b64_tr_b16 v[38:39], v21 offset:7168
    s_waitcnt lgkmcnt(10)
    v_mfma_f32_32x32x16_bf16 v[120:135], v[44:47], v[160:163], v[120:135]
    ds_read_b64_tr_b16 v[40:41], v24 offset:5120
    ds_read_b64_tr_b16 v[42:43], v24 offset:7168
    s_waitcnt lgkmcnt(10)
    v_mfma_f32_32x32x16_bf16 v[136:151], v[48:51], v[160:163], v[136:151]
    ds_read_b64_tr_b16 v[44:45], v25 offset:5120
    ds_read_b64_tr_b16 v[46:47], v25 offset:7168
    s_waitcnt lgkmcnt(10)
    v_mfma_f32_32x32x16_bf16 v[88:103], v[52:55], v[160:163], v[88:103]
    ds_read_b64_tr_b16 v[48:49], v22 offset:5120
    ds_read_b64_tr_b16 v[50:51], v22 offset:7168
    s_waitcnt lgkmcnt(10)
    v_mfma_f32_32x32x16_bf16 v[104:119], v[28:31], v[160:163], v[104:119]
    buffer_load_dwordx4 v[224:227], v249, s[32:35], s16 offen offset:2048 sc1
    ds_read_b64_tr_b16 v[52:53], v23 offset:5120
    ds_read_b64_tr_b16 v[54:55], v23 offset:7168
    s_waitcnt vmcnt(15)
    s_waitcnt lgkmcnt(10)
    v_mfma_f32_32x32x16_bf16 v[56:71], v[32:35], v[164:167], v[56:71]
    ds_read_b64_tr_b16 v[28:29], v20 offset:8192
    ds_read_b64_tr_b16 v[30:31], v20 offset:10240
    s_waitcnt lgkmcnt(10)
    v_mfma_f32_32x32x16_bf16 v[72:87], v[36:39], v[164:167], v[72:87]
    ds_read_b64_tr_b16 v[32:33], v21 offset:8192
    ds_read_b64_tr_b16 v[34:35], v21 offset:10240
    s_waitcnt lgkmcnt(10)
    v_mfma_f32_32x32x16_bf16 v[120:135], v[40:43], v[164:167], v[120:135]
    buffer_load_dwordx4 v[228:231], v249, s[32:35], s16 offen offset:3072 sc1
    ds_read_b64_tr_b16 v[36:37], v24 offset:8192
    ds_read_b64_tr_b16 v[38:39], v24 offset:10240
    s_waitcnt lgkmcnt(10)
    v_mfma_f32_32x32x16_bf16 v[136:151], v[44:47], v[164:167], v[136:151]
    s_add_u32 s16, s16, 16384
    ds_read_b64_tr_b16 v[40:41], v25 offset:8192
    ds_read_b64_tr_b16 v[42:43], v25 offset:10240
    s_waitcnt lgkmcnt(10)
    v_mfma_f32_32x32x16_bf16 v[88:103], v[48:51], v[164:167], v[88:103]
    s_and_b32 s16, s16, 0x3ffff
    ds_read_b64_tr_b16 v[44:45], v22 offset:8192
    ds_read_b64_tr_b16 v[46:47], v22 offset:10240
    s_waitcnt lgkmcnt(10)
    v_mfma_f32_32x32x16_bf16 v[104:119], v[52:55], v[164:167], v[104:119]
    buffer_load_dwordx4 v[232:235], v249, s[32:35], s16 offen sc1
    ds_read_b64_tr_b16 v[48:49], v23 offset:8192
    ds_read_b64_tr_b16 v[50:51], v23 offset:10240
    s_barrier
    s_waitcnt vmcnt(16)
    s_waitcnt lgkmcnt(10)
    v_mfma_f32_32x32x16_bf16 v[56:71], v[28:31], v[168:171], v[56:71]
    ds_read_b64_tr_b16 v[52:53], v20 offset:9216
    ds_read_b64_tr_b16 v[54:55], v20 offset:11264
    s_waitcnt lgkmcnt(10)
    v_mfma_f32_32x32x16_bf16 v[72:87], v[32:35], v[168:171], v[72:87]
    ds_read_b64_tr_b16 v[28:29], v21 offset:9216
    ds_read_b64_tr_b16 v[30:31], v21 offset:11264
    s_waitcnt lgkmcnt(10)
    v_mfma_f32_32x32x16_bf16 v[120:135], v[36:39], v[168:171], v[120:135]
    ds_read_b64_tr_b16 v[32:33], v24 offset:9216
    ds_read_b64_tr_b16 v[34:35], v24 offset:11264
    s_waitcnt lgkmcnt(10)
    v_mfma_f32_32x32x16_bf16 v[136:151], v[40:43], v[168:171], v[136:151]
    buffer_load_dwordx4 v[236:239], v249, s[32:35], s16 offen offset:1024 sc1
    ds_read_b64_tr_b16 v[36:37], v25 offset:9216
    ds_read_b64_tr_b16 v[38:39], v25 offset:11264
    s_waitcnt lgkmcnt(10)
    v_mfma_f32_32x32x16_bf16 v[88:103], v[44:47], v[168:171], v[88:103]
    ds_read_b64_tr_b16 v[40:41], v22 offset:9216
    ds_read_b64_tr_b16 v[42:43], v22 offset:11264
    s_waitcnt lgkmcnt(10)
    v_mfma_f32_32x32x16_bf16 v[104:119], v[48:51], v[168:171], v[104:119]
    ds_read_b64_tr_b16 v[44:45], v23 offset:9216
    ds_read_b64_tr_b16 v[46:47], v23 offset:11264
    s_waitcnt vmcnt(16)
    s_waitcnt lgkmcnt(10)
    v_mfma_f32_32x32x16_bf16 v[56:71], v[52:55], v[172:175], v[56:71]
    buffer_load_dwordx4 v[240:243], v249, s[32:35], s16 offen offset:2048 sc1
    ds_read_b64_tr_b16 v[48:49], v20 offset:12288
    ds_read_b64_tr_b16 v[50:51], v20 offset:14336
    s_waitcnt lgkmcnt(10)
    v_mfma_f32_32x32x16_bf16 v[72:87], v[28:31], v[172:175], v[72:87]
    ds_read_b64_tr_b16 v[52:53], v21 offset:12288
    ds_read_b64_tr_b16 v[54:55], v21 offset:14336
    s_waitcnt lgkmcnt(10)
    v_mfma_f32_32x32x16_bf16 v[120:135], v[32:35], v[172:175], v[120:135]
    ds_read_b64_tr_b16 v[28:29], v24 offset:12288
    ds_read_b64_tr_b16 v[30:31], v24 offset:14336
    s_waitcnt lgkmcnt(10)
    v_mfma_f32_32x32x16_bf16 v[136:151], v[36:39], v[172:175], v[136:151]
    ds_read_b64_tr_b16 v[32:33], v25 offset:12288
    ds_read_b64_tr_b16 v[34:35], v25 offset:14336
    s_waitcnt lgkmcnt(10)
    v_mfma_f32_32x32x16_bf16 v[88:103], v[40:43], v[172:175], v[88:103]
    buffer_load_dwordx4 v[244:247], v249, s[32:35], s16 offen offset:3072 sc1
    ds_read_b64_tr_b16 v[36:37], v22 offset:12288
    ds_read_b64_tr_b16 v[38:39], v22 offset:14336
    s_waitcnt lgkmcnt(10)
    v_mfma_f32_32x32x16_bf16 v[104:119], v[44:47], v[172:175], v[104:119]
    s_add_u32 s16, s16, 16384
    ds_read_b64_tr_b16 v[40:41], v23 offset:12288
    ds_read_b64_tr_b16 v[42:43], v23 offset:14336
    s_waitcnt vmcnt(17)
    s_waitcnt lgkmcnt(10)
    v_mfma_f32_32x32x16_bf16 v[56:71], v[48:51], v[176:179], v[56:71]
    s_and_b32 s16, s16, 0x3ffff
    ds_read_b64_tr_b16 v[44:45], v20 offset:13312
    ds_read_b64_tr_b16 v[46:47], v20 offset:15360
    s_waitcnt lgkmcnt(10)
    v_mfma_f32_32x32x16_bf16 v[72:87], v[52:55], v[176:179], v[72:87]
    buffer_load_dwordx4 v[152:155], v249, s[32:35], s16 offen sc1
    ds_read_b64_tr_b16 v[48:49], v21 offset:13312
    ds_read_b64_tr_b16 v[50:51], v21 offset:15360
    s_waitcnt lgkmcnt(10)
    v_mfma_f32_32x32x16_bf16 v[120:135], v[28:31], v[176:179], v[120:135]
    ds_read_b64_tr_b16 v[52:53], v24 offset:13312
    ds_read_b64_tr_b16 v[54:55], v24 offset:15360
    s_waitcnt lgkmcnt(10)
    v_mfma_f32_32x32x16_bf16 v[136:151], v[32:35], v[176:179], v[136:151]
    ds_read_b64_tr_b16 v[28:29], v25 offset:13312
    ds_read_b64_tr_b16 v[30:31], v25 offset:15360
    s_waitcnt lgkmcnt(10)
    v_mfma_f32_32x32x16_bf16 v[88:103], v[36:39], v[176:179], v[88:103]
    ds_read_b64_tr_b16 v[32:33], v22 offset:13312
    ds_read_b64_tr_b16 v[34:35], v22 offset:15360
    s_waitcnt lgkmcnt(10)
    v_mfma_f32_32x32x16_bf16 v[104:119], v[40:43], v[176:179], v[104:119]
    buffer_load_dwordx4 v[156:159], v249, s[32:35], s16 offen offset:1024 sc1
    ds_read_b64_tr_b16 v[36:37], v23 offset:13312
    ds_read_b64_tr_b16 v[38:39], v23 offset:15360
    s_waitcnt vmcnt(18)
    s_waitcnt lgkmcnt(10)
    v_mfma_f32_32x32x16_bf16 v[56:71], v[44:47], v[180:183], v[56:71]
    ds_read_b64_tr_b16 v[40:41], v20 offset:16384
    ds_read_b64_tr_b16 v[42:43], v20 offset:18432
    s_waitcnt lgkmcnt(10)
    v_mfma_f32_32x32x16_bf16 v[72:87], v[48:51], v[180:183], v[72:87]
    ds_read_b64_tr_b16 v[44:45], v21 offset:16384
    ds_read_b64_tr_b16 v[46:47], v21 offset:18432
    s_waitcnt lgkmcnt(10)
    v_mfma_f32_32x32x16_bf16 v[120:135], v[52:55], v[180:183], v[120:135]
    buffer_load_dwordx4 v[160:163], v249, s[32:35], s16 offen offset:2048 sc1
    ds_read_b64_tr_b16 v[48:49], v24 offset:16384
    ds_read_b64_tr_b16 v[50:51], v24 offset:18432
    s_waitcnt lgkmcnt(10)
    v_mfma_f32_32x32x16_bf16 v[136:151], v[28:31], v[180:183], v[136:151]
    ds_read_b64_tr_b16 v[52:53], v25 offset:16384
    ds_read_b64_tr_b16 v[54:55], v25 offset:18432
    s_waitcnt lgkmcnt(10)
    v_mfma_f32_32x32x16_bf16 v[88:103], v[32:35], v[180:183], v[88:103]
    ds_read_b64_tr_b16 v[28:29], v22 offset:16384
    ds_read_b64_tr_b16 v[30:31], v22 offset:18432
    s_waitcnt lgkmcnt(10)
    v_mfma_f32_32x32x16_bf16 v[104:119], v[36:39], v[180:183], v[104:119]
    buffer_load_dwordx4 v[164:167], v249, s[32:35], s16 offen offset:3072 sc1
    ds_read_b64_tr_b16 v[32:33], v23 offset:16384
    ds_read_b64_tr_b16 v[34:35], v23 offset:18432
    s_barrier
    s_waitcnt vmcnt(19)
    s_waitcnt lgkmcnt(10)
    v_mfma_f32_32x32x16_bf16 v[56:71], v[40:43], v[184:187], v[56:71]
    s_add_u32 s16, s16, 16384
    ds_read_b64_tr_b16 v[36:37], v20 offset:17408
    ds_read_b64_tr_b16 v[38:39], v20 offset:19456
    s_waitcnt lgkmcnt(10)
    v_mfma_f32_32x32x16_bf16 v[72:87], v[44:47], v[184:187], v[72:87]
    s_and_b32 s16, s16, 0x3ffff
    ds_read_b64_tr_b16 v[40:41], v21 offset:17408
    ds_read_b64_tr_b16 v[42:43], v21 offset:19456
    s_waitcnt lgkmcnt(10)
    v_mfma_f32_32x32x16_bf16 v[120:135], v[48:51], v[184:187], v[120:135]
    ds_read_b64_tr_b16 v[44:45], v24 offset:17408
    ds_read_b64_tr_b16 v[46:47], v24 offset:19456
    s_waitcnt lgkmcnt(10)
    v_mfma_f32_32x32x16_bf16 v[136:151], v[52:55], v[184:187], v[136:151]
    buffer_load_dwordx4 v[168:171], v249, s[32:35], s16 offen sc1
    ds_read_b64_tr_b16 v[48:49], v25 offset:17408
    ds_read_b64_tr_b16 v[50:51], v25 offset:19456
    s_waitcnt lgkmcnt(10)
    v_mfma_f32_32x32x16_bf16 v[88:103], v[28:31], v[184:187], v[88:103]
    ds_read_b64_tr_b16 v[52:53], v22 offset:17408
    ds_read_b64_tr_b16 v[54:55], v22 offset:19456
    s_waitcnt lgkmcnt(10)
    v_mfma_f32_32x32x16_bf16 v[104:119], v[32:35], v[184:187], v[104:119]
    ds_read_b64_tr_b16 v[28:29], v23 offset:17408
    ds_read_b64_tr_b16 v[30:31], v23 offset:19456
    s_waitcnt vmcnt(19)
    s_waitcnt lgkmcnt(10)
    v_mfma_f32_32x32x16_bf16 v[56:71], v[36:39], v[188:191], v[56:71]
    ds_read_b64_tr_b16 v[32:33], v20 offset:20480
    ds_read_b64_tr_b16 v[34:35], v20 offset:22528
    s_waitcnt lgkmcnt(10)
    v_mfma_f32_32x32x16_bf16 v[72:87], v[40:43], v[188:191], v[72:87]
    buffer_load_dwordx4 v[172:175], v249, s[32:35], s16 offen offset:1024 sc1
    ds_read_b64_tr_b16 v[36:37], v21 offset:20480
    ds_read_b64_tr_b16 v[38:39], v21 offset:22528
    s_waitcnt lgkmcnt(10)
    v_mfma_f32_32x32x16_bf16 v[120:135], v[44:47], v[188:191], v[120:135]
    ds_read_b64_tr_b16 v[40:41], v24 offset:20480
    ds_read_b64_tr_b16 v[42:43], v24 offset:22528
    s_waitcnt lgkmcnt(10)
    v_mfma_f32_32x32x16_bf16 v[136:151], v[48:51], v[188:191], v[136:151]
    ds_read_b64_tr_b16 v[44:45], v25 offset:20480
    ds_read_b64_tr_b16 v[46:47], v25 offset:22528
    s_waitcnt lgkmcnt(10)
    v_mfma_f32_32x32x16_bf16 v[88:103], v[52:55], v[188:191], v[88:103]
    ds_read_b64_tr_b16 v[48:49], v22 offset:20480
    ds_read_b64_tr_b16 v[50:51], v22 offset:22528
    s_waitcnt lgkmcnt(10)
    v_mfma_f32_32x32x16_bf16 v[104:119], v[28:31], v[188:191], v[104:119]
    buffer_load_dwordx4 v[176:179], v249, s[32:35], s16 offen offset:2048 sc1
    ds_read_b64_tr_b16 v[52:53], v23 offset:20480
    ds_read_b64_tr_b16 v[54:55], v23 offset:22528
    s_waitcnt vmcnt(20)
    s_waitcnt lgkmcnt(10)
    v_mfma_f32_32x32x16_bf16 v[56:71], v[32:35], v[192:195], v[56:71]
    ds_read_b64_tr_b16 v[28:29], v20 offset:21504
    ds_read_b64_tr_b16 v[30:31], v20 offset:23552
    s_waitcnt lgkmcnt(10)
    v_mfma_f32_32x32x16_bf16 v[72:87], v[36:39], v[192:195], v[72:87]
    ds_read_b64_tr_b16 v[32:33], v21 offset:21504
    ds_read_b64_tr_b16 v[34:35], v21 offset:23552
    s_waitcnt lgkmcnt(10)
    v_mfma_f32_32x32x16_bf16 v[120:135], v[40:43], v[192:195], v[120:135]
    ds_read_b64_tr_b16 v[36:37], v24 offset:21504
    ds_read_b64_tr_b16 v[38:39], v24 offset:23552
    s_waitcnt lgkmcnt(10)
    v_mfma_f32_32x32x16_bf16 v[136:151], v[44:47], v[192:195], v[136:151]
    buffer_load_dwordx4 v[180:183], v249, s[32:35], s16 offen offset:3072 sc1
    ds_read_b64_tr_b16 v[40:41], v25 offset:21504
    ds_read_b64_tr_b16 v[42:43], v25 offset:23552
L_PAD3:
    s_cbranch_execz L_RET3
    s_waitcnt lgkmcnt(10)
    v_mfma_f32_32x32x16_bf16 v[88:103], v[48:51], v[192:195], v[88:103]
    s_add_u32 s16, s16, 16384
    ds_read_b64_tr_b16 v[44:45], v22 offset:21504
    ds_read_b64_tr_b16 v[46:47], v22 offset:23552
    s_waitcnt lgkmcnt(10)
    v_mfma_f32_32x32x16_bf16 v[104:119], v[52:55], v[192:195], v[104:119]
    s_and_b32 s16, s16, 0x3ffff
    ds_read_b64_tr_b16 v[48:49], v23 offset:21504
    ds_read_b64_tr_b16 v[50:51], v23 offset:23552
    s_waitcnt vmcnt(20)
    s_waitcnt lgkmcnt(10)
    v_mfma_f32_32x32x16_bf16 v[56:71], v[28:31], v[196:199], v[56:71]
    ds_read_b64_tr_b16 v[52:53], v20 offset:24576
    ds_read_b64_tr_b16 v[54:55], v20 offset:26624
    s_waitcnt lgkmcnt(10)
    v_mfma_f32_32x32x16_bf16 v[72:87], v[32:35], v[196:199], v[72:87]
    buffer_load_dwordx4 v[184:187], v249, s[32:35], s16 offen sc1
    ds_read_b64_tr_b16 v[28:29], v21 offset:24576
    ds_read_b64_tr_b16 v[30:31], v21 offset:26624
    s_waitcnt lgkmcnt(10)
    v_mfma_f32_32x32x16_bf16 v[120:135], v[36:39], v[196:199], v[120:135]
    ds_read_b64_tr_b16 v[32:33], v20 offset:25600
    ds_read_b64_tr_b16 v[34:35], v20 offset:27648
    s_waitcnt lgkmcnt(10)
    v_mfma_f32_32x32x16_bf16 v[136:151], v[40:43], v[196:199], v[136:151]
    ds_read_b64_tr_b16 v[36:37], v21 offset:25600
    ds_read_b64_tr_b16 v[38:39], v21 offset:27648
    s_waitcnt lgkmcnt(10)
    v_mfma_f32_32x32x16_bf16 v[88:103], v[44:47], v[196:199], v[88:103]
    ds_read_b64_tr_b16 v[40:41], v20 offset:28672
    ds_read_b64_tr_b16 v[42:43], v20 offset:30720
    s_waitcnt lgkmcnt(10)
    v_mfma_f32_32x32x16_bf16 v[104:119], v[48:51], v[196:199], v[104:119]
    buffer_load_dwordx4 v[188:191], v249, s[32:35], s16 offen offset:1024 sc1
    ds_read_b64_tr_b16 v[44:45], v21 offset:28672
    ds_read_b64_tr_b16 v[46:47], v21 offset:30720
    s_barrier
    s_waitcnt vmcnt(21)
    s_waitcnt lgkmcnt(10)
    v_mfma_f32_32x32x16_bf16 v[56:71], v[52:55], v[200:203], v[56:71]
    ds_read_b64_tr_b16 v[48:49], v20 offset:29696
    ds_read_b64_tr_b16 v[50:51], v20 offset:31744
    s_waitcnt lgkmcnt(10)
    v_mfma_f32_32x32x16_bf16 v[72:87], v[28:31], v[200:203], v[72:87]
    ds_read_b64_tr_b16 v[52:53], v21 offset:29696
    ds_read_b64_tr_b16 v[54:55], v21 offset:31744
    s_waitcnt vmcnt(20)
    s_waitcnt lgkmcnt(10)
    v_mfma_f32_32x32x16_bf16 v[56:71], v[32:35], v[204:207], v[56:71]
    ds_read_b64_tr_b16 v[28:29], v24 offset:24576
    ds_read_b64_tr_b16 v[30:31], v24 offset:26624
    s_waitcnt lgkmcnt(10)
    v_mfma_f32_32x32x16_bf16 v[72:87], v[36:39], v[204:207], v[72:87]
    buffer_load_dwordx4 v[192:195], v249, s[32:35], s16 offen offset:2048 sc1
    ds_read_b64_tr_b16 v[32:33], v25 offset:24576
    ds_read_b64_tr_b16 v[34:35], v25 offset:26624
    s_waitcnt vmcnt(20)
    s_waitcnt lgkmcnt(10)
    v_mfma_f32_32x32x16_bf16 v[56:71], v[40:43], v[208:211], v[56:71]
    ds_read_b64_tr_b16 v[36:37], v22 offset:24576
    ds_read_b64_tr_b16 v[38:39], v22 offset:26624
    s_waitcnt lgkmcnt(10)
    v_mfma_f32_32x32x16_bf16 v[72:87], v[44:47], v[208:211], v[72:87]
    ds_read_b64_tr_b16 v[40:41], v23 offset:24576
    ds_read_b64_tr_b16 v[42:43], v23 offset:26624
    s_waitcnt vmcnt(19)
    s_waitcnt lgkmcnt(10)
    v_mfma_f32_32x32x16_bf16 v[56:71], v[48:51], v[212:215], v[56:71]
    ds_read_b64_tr_b16 v[44:45], v24 offset:25600
    ds_read_b64_tr_b16 v[46:47], v24 offset:27648
    s_waitcnt lgkmcnt(10)
    v_mfma_f32_32x32x16_bf16 v[72:87], v[52:55], v[212:215], v[72:87]
    buffer_load_dwordx4 v[196:199], v249, s[32:35], s16 offen offset:3072 sc1
    ds_read_b64_tr_b16 v[48:49], v25 offset:25600
    ds_read_b64_tr_b16 v[50:51], v25 offset:27648
    s_barrier
    s_waitcnt lgkmcnt(10)
    v_mfma_f32_32x32x16_bf16 v[120:135], v[28:31], v[200:203], v[120:135]
    s_add_u32 s16, s16, 16384
    ds_read_b64_tr_b16 v[52:53], v22 offset:25600
    ds_read_b64_tr_b16 v[54:55], v22 offset:27648
    s_waitcnt lgkmcnt(10)
    v_mfma_f32_32x32x16_bf16 v[136:151], v[32:35], v[200:203], v[136:151]
    s_and_b32 s16, s16, 0x3ffff
    ds_read_b64_tr_b16 v[28:29], v23 offset:25600
    ds_read_b64_tr_b16 v[30:31], v23 offset:27648
    s_waitcnt lgkmcnt(10)
    v_mfma_f32_32x32x16_bf16 v[88:103], v[36:39], v[200:203], v[88:103]
    ds_read_b64_tr_b16 v[32:33], v24 offset:28672
    ds_read_b64_tr_b16 v[34:35], v24 offset:30720
    s_waitcnt lgkmcnt(10)
    v_mfma_f32_32x32x16_bf16 v[104:119], v[40:43], v[200:203], v[104:119]
    buffer_load_dwordx4 v[200:203], v249, s[32:35], s16 offen sc1
    ds_read_b64_tr_b16 v[36:37], v25 offset:28672
    ds_read_b64_tr_b16 v[38:39], v25 offset:30720
    s_waitcnt lgkmcnt(10)
    v_mfma_f32_32x32x16_bf16 v[120:135], v[44:47], v[204:207], v[120:135]
    ds_read_b64_tr_b16 v[40:41], v22 offset:28672
    ds_read_b64_tr_b16 v[42:43], v22 offset:30720
    s_waitcnt lgkmcnt(10)
    v_mfma_f32_32x32x16_bf16 v[136:151], v[48:51], v[204:207], v[136:151]
    ds_read_b64_tr_b16 v[44:45], v23 offset:28672
    ds_read_b64_tr_b16 v[46:47], v23 offset:30720
    s_waitcnt lgkmcnt(10)
    v_mfma_f32_32x32x16_bf16 v[88:103], v[52:55], v[204:207], v[88:103]
    ds_read_b64_tr_b16 v[48:49], v24 offset:29696
    ds_read_b64_tr_b16 v[50:51], v24 offset:31744
    s_waitcnt lgkmcnt(10)
    v_mfma_f32_32x32x16_bf16 v[104:119], v[28:31], v[204:207], v[104:119]
    buffer_load_dwordx4 v[204:207], v249, s[32:35], s16 offen offset:1024 sc1
    ds_read_b64_tr_b16 v[52:53], v25 offset:29696
    ds_read_b64_tr_b16 v[54:55], v25 offset:31744
    s_waitcnt lgkmcnt(10)
    v_mfma_f32_32x32x16_bf16 v[120:135], v[32:35], v[208:211], v[120:135]
    ds_read_b64_tr_b16 v[28:29], v22 offset:29696
    ds_read_b64_tr_b16 v[30:31], v22 offset:31744
    s_waitcnt lgkmcnt(10)
    v_mfma_f32_32x32x16_bf16 v[136:151], v[36:39], v[208:211], v[136:151]
    ds_read_b64_tr_b16 v[32:33], v23 offset:29696
    ds_read_b64_tr_b16 v[34:35], v23 offset:31744
    s_waitcnt lgkmcnt(10)
    v_mfma_f32_32x32x16_bf16 v[88:103], v[40:43], v[208:211], v[88:103]
    ds_read_b64_tr_b16 v[36:37], v20 offset:32768
    ds_read_b64_tr_b16 v[38:39], v20 offset:34816
    s_waitcnt lgkmcnt(10)
    v_mfma_f32_32x32x16_bf16 v[104:119], v[44:47], v[208:211], v[104:119]
    buffer_load_dwordx4 v[208:211], v249, s[32:35], s16 offen offset:2048 sc1
    ds_read_b64_tr_b16 v[40:41], v20 offset:33792
    ds_read_b64_tr_b16 v[42:43], v20 offset:35840
    s_waitcnt lgkmcnt(10)
    v_mfma_f32_32x32x16_bf16 v[120:135], v[48:51], v[212:215], v[120:135]
    ds_read_b64_tr_b16 v[44:45], v20 offset:36864
    ds_read_b64_tr_b16 v[46:47], v20 offset:38912
    s_waitcnt lgkmcnt(10)
    v_mfma_f32_32x32x16_bf16 v[136:151], v[52:55], v[212:215], v[136:151]
    ds_read_b64_tr_b16 v[48:49], v20 offset:37888
    ds_read_b64_tr_b16 v[50:51], v20 offset:39936
    s_waitcnt lgkmcnt(10)
    v_mfma_f32_32x32x16_bf16 v[88:103], v[28:31], v[212:215], v[88:103]
    ds_read_b64_tr_b16 v[52:53], v20 offset:40960
    ds_read_b64_tr_b16 v[54:55], v20 offset:43008
    s_waitcnt lgkmcnt(10)
    v_mfma_f32_32x32x16_bf16 v[104:119], v[32:35], v[212:215], v[104:119]
    buffer_load_dwordx4 v[212:215], v249, s[32:35], s16 offen offset:3072 sc1
    ds_read_b64_tr_b16 v[28:29], v20 offset:41984
    ds_read_b64_tr_b16 v[30:31], v20 offset:44032
    s_barrier
    s_waitcnt vmcnt(23)
    s_waitcnt lgkmcnt(10)
    v_mfma_f32_32x32x16_bf16 v[56:71], v[36:39], v[216:219], v[56:71]
    s_add_u32 s16, s16, 16384
    ds_read_b64_tr_b16 v[32:33], v20 offset:45056
    ds_read_b64_tr_b16 v[34:35], v20 offset:47104
    s_waitcnt vmcnt(22)
    s_waitcnt lgkmcnt(10)
    v_mfma_f32_32x32x16_bf16 v[56:71], v[40:43], v[220:223], v[56:71]
    s_and_b32 s16, s16, 0x3ffff
    ds_read_b64_tr_b16 v[36:37], v20 offset:46080
    ds_read_b64_tr_b16 v[38:39], v20 offset:48128
    s_waitcnt vmcnt(21)
    s_waitcnt lgkmcnt(10)
    v_mfma_f32_32x32x16_bf16 v[56:71], v[44:47], v[224:227], v[56:71]
    ds_read_b64_tr_b16 v[40:41], v20
    ds_read_b64_tr_b16 v[42:43], v20 offset:2048
    s_waitcnt vmcnt(20)
    s_waitcnt lgkmcnt(10)
    v_mfma_f32_32x32x16_bf16 v[56:71], v[48:51], v[228:231], v[56:71]
    ds_read_b64_tr_b16 v[44:45], v20 offset:1024
    ds_read_b64_tr_b16 v[46:47], v20 offset:3072
    s_waitcnt vmcnt(19)
    s_waitcnt lgkmcnt(10)
    v_mfma_f32_32x32x16_bf16 v[56:71], v[52:55], v[232:235], v[56:71]
    ds_read_b64_tr_b16 v[48:49], v20 offset:4096
    ds_read_b64_tr_b16 v[50:51], v20 offset:6144
    s_waitcnt vmcnt(18)
    s_waitcnt lgkmcnt(10)
    v_mfma_f32_32x32x16_bf16 v[56:71], v[28:31], v[236:239], v[56:71]
    ds_read_b64_tr_b16 v[52:53], v20 offset:5120
    ds_read_b64_tr_b16 v[54:55], v20 offset:7168
    s_waitcnt vmcnt(17)
    s_waitcnt lgkmcnt(10)
    v_mfma_f32_32x32x16_bf16 v[56:71], v[32:35], v[240:243], v[56:71]
    ds_read_b64_tr_b16 v[28:29], v20 offset:8192
    ds_read_b64_tr_b16 v[30:31], v20 offset:10240
    s_waitcnt vmcnt(16)
    s_waitcnt lgkmcnt(10)
    v_mfma_f32_32x32x16_bf16 v[56:71], v[36:39], v[244:247], v[56:71]
    ds_read_b64_tr_b16 v[32:33], v20 offset:9216
    ds_read_b64_tr_b16 v[34:35], v20 offset:11264
    s_waitcnt vmcnt(15)
    s_waitcnt lgkmcnt(10)
    v_mfma_f32_32x32x16_bf16 v[56:71], v[40:43], v[152:155], v[56:71]
    ds_read_b64_tr_b16 v[36:37], v20 offset:12288
    ds_read_b64_tr_b16 v[38:39], v20 offset:14336
    s_waitcnt vmcnt(14)
    s_waitcnt lgkmcnt(10)
    v_mfma_f32_32x32x16_bf16 v[56:71], v[44:47], v[156:159], v[56:71]
    ds_read_b64_tr_b16 v[40:41], v20 offset:13312
    ds_read_b64_tr_b16 v[42:43], v20 offset:15360
    s_waitcnt vmcnt(13)
    s_waitcnt lgkmcnt(10)
    v_mfma_f32_32x32x16_bf16 v[56:71], v[48:51], v[160:163], v[56:71]
    ds_read_b64_tr_b16 v[44:45], v20 offset:16384
    ds_read_b64_tr_b16 v[46:47], v20 offset:18432
    s_waitcnt vmcnt(12)
    s_waitcnt lgkmcnt(10)
    v_mfma_f32_32x32x16_bf16 v[56:71], v[52:55], v[164:167], v[56:71]
    ds_read_b64_tr_b16 v[48:49], v20 offset:17408
    ds_read_b64_tr_b16 v[50:51], v20 offset:19456
    s_waitcnt vmcnt(11)
    s_waitcnt lgkmcnt(10)
    v_mfma_f32_32x32x16_bf16 v[56:71], v[28:31], v[168:171], v[56:71]
    ds_read_b64_tr_b16 v[52:53], v20 offset:20480
    ds_read_b64_tr_b16 v[54:55], v20 offset:22528
    s_waitcnt vmcnt(10)
    s_waitcnt lgkmcnt(10)
    v_mfma_f32_32x32x16_bf16 v[56:71], v[32:35], v[172:175], v[56:71]
    ds_read_b64_tr_b16 v[28:29], v20 offset:21504
    ds_read_b64_tr_b16 v[30:31], v20 offset:23552
    s_barrier
    s_waitcnt vmcnt(9)
    s_waitcnt lgkmcnt(10)
    v_mfma_f32_32x32x16_bf16 v[56:71], v[36:39], v[176:179], v[56:71]
    ds_read_b64_tr_b16 v[32:33], v20 offset:24576
    ds_read_b64_tr_b16 v[34:35], v20 offset:26624
    s_waitcnt vmcnt(8)
    s_waitcnt lgkmcnt(10)
    v_mfma_f32_32x32x16_bf16 v[56:71], v[40:43], v[180:183], v[56:71]
    ds_read_b64_tr_b16 v[36:37], v20 offset:25600
    ds_read_b64_tr_b16 v[38:39], v20 offset:27648
    s_waitcnt vmcnt(7)
    s_waitcnt lgkmcnt(10)
    v_mfma_f32_32x32x16_bf16 v[56:71], v[44:47], v[184:187], v[56:71]
    ds_read_b64_tr_b16 v[40:41], v20 offset:28672
    ds_read_b64_tr_b16 v[42:43], v20 offset:30720
    s_waitcnt vmcnt(6)
    s_waitcnt lgkmcnt(10)
    v_mfma_f32_32x32x16_bf16 v[56:71], v[48:51], v[188:191], v[56:71]
    ds_read_b64_tr_b16 v[44:45], v20 offset:29696
    ds_read_b64_tr_b16 v[46:47], v20 offset:31744
    s_waitcnt vmcnt(5)
    s_waitcnt lgkmcnt(10)
    v_mfma_f32_32x32x16_bf16 v[56:71], v[52:55], v[192:195], v[56:71]
    ds_read_b64_tr_b16 v[48:49], v21 offset:32768
    ds_read_b64_tr_b16 v[50:51], v21 offset:34816
    s_waitcnt vmcnt(4)
    s_waitcnt lgkmcnt(10)
    v_mfma_f32_32x32x16_bf16 v[56:71], v[28:31], v[196:199], v[56:71]
    ds_read_b64_tr_b16 v[52:53], v21 offset:33792
    ds_read_b64_tr_b16 v[54:55], v21 offset:35840
    s_waitcnt vmcnt(3)
    s_waitcnt lgkmcnt(10)
    v_mfma_f32_32x32x16_bf16 v[56:71], v[32:35], v[200:203], v[56:71]
    ds_read_b64_tr_b16 v[28:29], v21 offset:36864
    ds_read_b64_tr_b16 v[30:31], v21 offset:38912
    s_waitcnt vmcnt(2)
    s_waitcnt lgkmcnt(10)
    v_mfma_f32_32x32x16_bf16 v[56:71], v[36:39], v[204:207], v[56:71]
    ds_read_b64_tr_b16 v[32:33], v21 offset:37888
    ds_read_b64_tr_b16 v[34:35], v21 offset:39936
    s_waitcnt vmcnt(1)
    s_waitcnt lgkmcnt(10)
    v_mfma_f32_32x32x16_bf16 v[56:71], v[40:43], v[208:211], v[56:71]
    ds_read_b64_tr_b16 v[36:37], v21 offset:40960
    ds_read_b64_tr_b16 v[38:39], v21 offset:43008
    s_waitcnt vmcnt(0)
    s_waitcnt lgkmcnt(10)
    v_mfma_f32_32x32x16_bf16 v[56:71], v[44:47], v[212:215], v[56:71]
    ds_read_b64_tr_b16 v[40:41], v21 offset:41984
    ds_read_b64_tr_b16 v[42:43], v21 offset:44032
    s_waitcnt lgkmcnt(10)
    v_mfma_f32_32x32x16_bf16 v[72:87], v[48:51], v[216:219], v[72:87]
    ds_read_b64_tr_b16 v[44:45], v21 offset:45056
    ds_read_b64_tr_b16 v[46:47], v21 offset:47104
    s_waitcnt lgkmcnt(10)
    v_mfma_f32_32x32x16_bf16 v[72:87], v[52:55], v[220:223], v[72:87]
    s_nop 3
    v_cvt_pk_bf16_f32 v56, v56, v57
    v_cvt_pk_bf16_f32 v57, v58, v59
    ds_read_b64_tr_b16 v[48:49], v21 offset:46080
    ds_read_b64_tr_b16 v[50:51], v21 offset:48128
    s_waitcnt lgkmcnt(10)
    v_mfma_f32_32x32x16_bf16 v[72:87], v[28:31], v[224:227], v[72:87]
    v_cvt_pk_bf16_f32 v58, v60, v61
    v_cvt_pk_bf16_f32 v59, v62, v63
    ds_write_b128 v0, v[56:59]
    ds_read_b64_tr_b16 v[52:53], v21
    ds_read_b64_tr_b16 v[54:55], v21 offset:2048
    s_waitcnt lgkmcnt(11)
    v_mfma_f32_32x32x16_bf16 v[72:87], v[32:35], v[228:231], v[72:87]
    v_cvt_pk_bf16_f32 v60, v64, v65
    v_cvt_pk_bf16_f32 v61, v66, v67
    ds_read_b64_tr_b16 v[28:29], v21 offset:1024
    ds_read_b64_tr_b16 v[30:31], v21 offset:3072
    s_waitcnt lgkmcnt(11)
    v_mfma_f32_32x32x16_bf16 v[72:87], v[36:39], v[232:235], v[72:87]
    v_cvt_pk_bf16_f32 v62, v68, v69
    v_cvt_pk_bf16_f32 v63, v70, v71
    ds_write_b128 v0, v[60:63] offset:1024
    ds_read_b64_tr_b16 v[32:33], v21 offset:4096
    ds_read_b64_tr_b16 v[34:35], v21 offset:6144
    s_waitcnt lgkmcnt(12)
    v_mfma_f32_32x32x16_bf16 v[72:87], v[40:43], v[236:239], v[72:87]
    v_subrev_u32 v0, 118784, v0
    ds_read_b64_tr_b16 v[36:37], v21 offset:5120
    ds_read_b64_tr_b16 v[38:39], v21 offset:7168
    s_waitcnt lgkmcnt(12)
    v_mfma_f32_32x32x16_bf16 v[72:87], v[44:47], v[240:243], v[72:87]
    ds_read_b64_tr_b16 v[40:41], v21 offset:8192
    ds_read_b64_tr_b16 v[42:43], v21 offset:10240
    s_waitcnt lgkmcnt(12)
    v_mfma_f32_32x32x16_bf16 v[72:87], v[48:51], v[244:247], v[72:87]
    ds_read_b64_tr_b16 v[44:45], v21 offset:9216
    ds_read_b64_tr_b16 v[46:47], v21 offset:11264
    s_waitcnt lgkmcnt(8)
    s_barrier
    v_mfma_f32_32x32x16_bf16 v[72:87], v[52:55], v[152:155], v[72:87]
    ds_read_b64_tr_b16 v[48:49], v21 offset:12288
    ds_read_b64_tr_b16 v[50:51], v21 offset:14336
    v_mfma_f32_32x32x16_bf16 v[72:87], v[28:31], v[156:159], v[72:87]
    ds_read_b64_tr_b16 v[52:53], v21 offset:13312
    ds_read_b64_tr_b16 v[54:55], v21 offset:15360
    s_waitcnt lgkmcnt(10)
    v_mfma_f32_32x32x16_bf16 v[72:87], v[32:35], v[160:163], v[72:87]
    ds_read_b64_tr_b16 v[28:29], v21 offset:16384
    ds_read_b64_tr_b16 v[30:31], v21 offset:18432
    s_waitcnt lgkmcnt(10)
    v_mfma_f32_32x32x16_bf16 v[72:87], v[36:39], v[164:167], v[72:87]
    ds_read_b64_tr_b16 v[32:33], v21 offset:17408
    ds_read_b64_tr_b16 v[34:35], v21 offset:19456
    s_waitcnt lgkmcnt(10)
    v_mfma_f32_32x32x16_bf16 v[72:87], v[40:43], v[168:171], v[72:87]
    ds_read_b64_tr_b16 v[36:37], v21 offset:20480
    ds_read_b64_tr_b16 v[38:39], v21 offset:22528
    s_waitcnt lgkmcnt(10)
    v_mfma_f32_32x32x16_bf16 v[72:87], v[44:47], v[172:175], v[72:87]
    ds_read_b64_tr_b16 v[40:41], v21 offset:21504
    ds_read_b64_tr_b16 v[42:43], v21 offset:23552
    s_waitcnt lgkmcnt(10)
    v_mfma_f32_32x32x16_bf16 v[72:87], v[48:51], v[176:179], v[72:87]
    ds_read_b64_tr_b16 v[44:45], v21 offset:24576
    ds_read_b64_tr_b16 v[46:47], v21 offset:26624
    s_waitcnt lgkmcnt(10)
    v_mfma_f32_32x32x16_bf16 v[72:87], v[52:55], v[180:183], v[72:87]
    ds_read_b64_tr_b16 v[48:49], v21 offset:25600
    ds_read_b64_tr_b16 v[50:51], v21 offset:27648
    s_waitcnt lgkmcnt(10)
    v_mfma_f32_32x32x16_bf16 v[72:87], v[28:31], v[184:187], v[72:87]
    ds_read_b64_tr_b16 v[52:53], v21 offset:28672
    ds_read_b64_tr_b16 v[54:55], v21 offset:30720
    s_waitcnt lgkmcnt(10)
    v_mfma_f32_32x32x16_bf16 v[72:87], v[32:35], v[188:191], v[72:87]
    ds_read_b64_tr_b16 v[28:29], v21 offset:29696
    ds_read_b64_tr_b16 v[30:31], v21 offset:31744
    s_waitcnt lgkmcnt(10)
    v_mfma_f32_32x32x16_bf16 v[72:87], v[36:39], v[192:195], v[72:87]
    ds_read_b64_tr_b16 v[32:33], v22 offset:32768
    ds_read_b64_tr_b16 v[34:35], v22 offset:34816
    s_waitcnt lgkmcnt(10)
    v_mfma_f32_32x32x16_bf16 v[72:87], v[40:43], v[196:199], v[72:87]
    ds_read_b64_tr_b16 v[36:37], v23 offset:32768
    ds_read_b64_tr_b16 v[38:39], v23 offset:34816
    s_waitcnt lgkmcnt(10)
    v_mfma_f32_32x32x16_bf16 v[72:87], v[44:47], v[200:203], v[72:87]
    ds_read_b64_tr_b16 v[40:41], v22 offset:33792
    ds_read_b64_tr_b16 v[42:43], v22 offset:35840
    s_waitcnt lgkmcnt(10)
    v_mfma_f32_32x32x16_bf16 v[72:87], v[48:51], v[204:207], v[72:87]
    ds_read_b64_tr_b16 v[44:45], v23 offset:33792
    ds_read_b64_tr_b16 v[46:47], v23 offset:35840
    s_waitcnt lgkmcnt(10)
    v_mfma_f32_32x32x16_bf16 v[72:87], v[52:55], v[208:211], v[72:87]
    ds_read_b64_tr_b16 v[48:49], v22 offset:36864
    ds_read_b64_tr_b16 v[50:51], v22 offset:38912
    s_waitcnt lgkmcnt(10)
    v_mfma_f32_32x32x16_bf16 v[72:87], v[28:31], v[212:215], v[72:87]
    ds_read_b64_tr_b16 v[52:53], v23 offset:36864
    ds_read_b64_tr_b16 v[54:55], v23 offset:38912
    s_waitcnt lgkmcnt(10)
    v_mfma_f32_32x32x16_bf16 v[88:103], v[32:35], v[216:219], v[88:103]
    ds_read_b64_tr_b16 v[28:29], v22 offset:37888
    ds_read_b64_tr_b16 v[30:31], v22 offset:39936
    s_waitcnt lgkmcnt(10)
    v_mfma_f32_32x32x16_bf16 v[104:119], v[36:39], v[216:219], v[104:119]
    s_nop 3
    v_cvt_pk_bf16_f32 v72, v72, v73
    v_cvt_pk_bf16_f32 v73, v74, v75
    ds_read_b64_tr_b16 v[32:33], v23 offset:37888
    ds_read_b64_tr_b16 v[34:35], v23 offset:39936
    s_waitcnt lgkmcnt(10)
    v_mfma_f32_32x32x16_bf16 v[88:103], v[40:43], v[220:223], v[88:103]
    v_cvt_pk_bf16_f32 v74, v76, v77
    v_cvt_pk_bf16_f32 v75, v78, v79
    ds_write_b128 v0, v[72:75]
    ds_read_b64_tr_b16 v[36:37], v22 offset:40960
    ds_read_b64_tr_b16 v[38:39], v22 offset:43008
    s_waitcnt lgkmcnt(11)
    v_mfma_f32_32x32x16_bf16 v[104:119], v[44:47], v[220:223], v[104:119]
    v_cvt_pk_bf16_f32 v76, v80, v81
    v_cvt_pk_bf16_f32 v77, v82, v83
    ds_read_b64_tr_b16 v[40:41], v23 offset:40960
    ds_read_b64_tr_b16 v[42:43], v23 offset:43008
    s_waitcnt lgkmcnt(11)
    v_mfma_f32_32x32x16_bf16 v[88:103], v[48:51], v[224:227], v[88:103]
    v_cvt_pk_bf16_f32 v78, v84, v85
    v_cvt_pk_bf16_f32 v79, v86, v87
    ds_write_b128 v0, v[76:79] offset:1024
    ds_read_b64_tr_b16 v[44:45], v22 offset:41984
    ds_read_b64_tr_b16 v[46:47], v22 offset:44032
    s_waitcnt lgkmcnt(12)
    v_mfma_f32_32x32x16_bf16 v[104:119], v[52:55], v[224:227], v[104:119]
    ds_read_b64_tr_b16 v[48:49], v23 offset:41984
    ds_read_b64_tr_b16 v[50:51], v23 offset:44032
    s_waitcnt lgkmcnt(4)
    s_barrier
    v_mfma_f32_32x32x16_bf16 v[88:103], v[28:31], v[228:231], v[88:103]
    s_lshl_b32 s96, s77, 11
    s_add_u32 s14, s96, 32768
    v_and_b32 v0, 7, v1
    ds_read_b64_tr_b16 v[52:53], v22 offset:45056
    ds_read_b64_tr_b16 v[54:55], v22 offset:47104
    v_mfma_f32_32x32x16_bf16 v[104:119], v[32:35], v[228:231], v[104:119]
    v_lshl_add_u32 v0, v0, 4, s14
    ds_read_b64_tr_b16 v[28:29], v23 offset:45056
    ds_read_b64_tr_b16 v[30:31], v23 offset:47104
    v_mfma_f32_32x32x16_bf16 v[88:103], v[36:39], v[232:235], v[88:103]
    v_bfe_u32 v4, v1, 3, 2
    ds_read_b64_tr_b16 v[32:33], v22 offset:46080
    ds_read_b64_tr_b16 v[34:35], v22 offset:48128
    v_mfma_f32_32x32x16_bf16 v[104:119], v[40:43], v[232:235], v[104:119]
    v_lshl_add_u32 v0, v4, 8, v0
    v_lshrrev_b32 v4, 5, v1
    ds_read_b64_tr_b16 v[36:37], v23 offset:46080
    ds_read_b64_tr_b16 v[38:39], v23 offset:48128
    s_waitcnt lgkmcnt(10)
    v_mfma_f32_32x32x16_bf16 v[88:103], v[44:47], v[236:239], v[88:103]
    v_lshl_add_u32 v0, v4, 7, v0
    ds_read_b64_tr_b16 v[40:41], v22
    ds_read_b64_tr_b16 v[42:43], v22 offset:2048
    s_waitcnt lgkmcnt(10)
    v_mfma_f32_32x32x16_bf16 v[104:119], v[48:51], v[236:239], v[104:119]
    ds_read_b64_tr_b16 v[44:45], v23
    ds_read_b64_tr_b16 v[46:47], v23 offset:2048
    s_waitcnt lgkmcnt(10)
    v_mfma_f32_32x32x16_bf16 v[88:103], v[52:55], v[240:243], v[88:103]
    ds_read_b64_tr_b16 v[48:49], v22 offset:1024
    ds_read_b64_tr_b16 v[50:51], v22 offset:3072
    s_waitcnt lgkmcnt(10)
    v_mfma_f32_32x32x16_bf16 v[104:119], v[28:31], v[240:243], v[104:119]
    ds_read_b64_tr_b16 v[52:53], v23 offset:1024
    ds_read_b64_tr_b16 v[54:55], v23 offset:3072
    s_waitcnt lgkmcnt(10)
    v_mfma_f32_32x32x16_bf16 v[88:103], v[32:35], v[244:247], v[88:103]
    ds_read_b64_tr_b16 v[28:29], v22 offset:4096
    ds_read_b64_tr_b16 v[30:31], v22 offset:6144
    s_waitcnt lgkmcnt(10)
    v_mfma_f32_32x32x16_bf16 v[104:119], v[36:39], v[244:247], v[104:119]
    ds_read_b64_tr_b16 v[32:33], v23 offset:4096
    ds_read_b64_tr_b16 v[34:35], v23 offset:6144
    s_waitcnt lgkmcnt(10)
    v_mfma_f32_32x32x16_bf16 v[88:103], v[40:43], v[152:155], v[88:103]
    ds_read_b64_tr_b16 v[36:37], v22 offset:5120
    ds_read_b64_tr_b16 v[38:39], v22 offset:7168
    s_waitcnt lgkmcnt(10)
    v_mfma_f32_32x32x16_bf16 v[104:119], v[44:47], v[152:155], v[104:119]
    ds_read_b64_tr_b16 v[40:41], v23 offset:5120
    ds_read_b64_tr_b16 v[42:43], v23 offset:7168
    s_waitcnt lgkmcnt(10)
    v_mfma_f32_32x32x16_bf16 v[88:103], v[48:51], v[156:159], v[88:103]
    ds_read_b64_tr_b16 v[44:45], v22 offset:8192
    ds_read_b64_tr_b16 v[46:47], v22 offset:10240
    s_waitcnt lgkmcnt(10)
    v_mfma_f32_32x32x16_bf16 v[104:119], v[52:55], v[156:159], v[104:119]
    ds_read_b64_tr_b16 v[48:49], v23 offset:8192
    ds_read_b64_tr_b16 v[50:51], v23 offset:10240
    s_waitcnt lgkmcnt(10)
    v_mfma_f32_32x32x16_bf16 v[88:103], v[28:31], v[160:163], v[88:103]
    ds_read_b64_tr_b16 v[52:53], v22 offset:9216
    ds_read_b64_tr_b16 v[54:55], v22 offset:11264
    s_waitcnt lgkmcnt(10)
    v_mfma_f32_32x32x16_bf16 v[104:119], v[32:35], v[160:163], v[104:119]
    ds_read_b64_tr_b16 v[28:29], v23 offset:9216
    ds_read_b64_tr_b16 v[30:31], v23 offset:11264
    s_waitcnt lgkmcnt(10)
    v_mfma_f32_32x32x16_bf16 v[88:103], v[36:39], v[164:167], v[88:103]
    ds_read_b64_tr_b16 v[32:33], v22 offset:12288
    ds_read_b64_tr_b16 v[34:35], v22 offset:14336
    s_waitcnt lgkmcnt(10)
    v_mfma_f32_32x32x16_bf16 v[104:119], v[40:43], v[164:167], v[104:119]
    ds_read_b64_tr_b16 v[36:37], v23 offset:12288
    ds_read_b64_tr_b16 v[38:39], v23 offset:14336
    s_waitcnt lgkmcnt(10)
    v_mfma_f32_32x32x16_bf16 v[88:103], v[44:47], v[168:171], v[88:103]
    ds_read_b64_tr_b16 v[40:41], v22 offset:13312
    ds_read_b64_tr_b16 v[42:43], v22 offset:15360
    s_waitcnt lgkmcnt(10)
    v_mfma_f32_32x32x16_bf16 v[104:119], v[48:51], v[168:171], v[104:119]
    ds_read_b64_tr_b16 v[44:45], v23 offset:13312
    ds_read_b64_tr_b16 v[46:47], v23 offset:15360
    s_waitcnt lgkmcnt(10)
    v_mfma_f32_32x32x16_bf16 v[88:103], v[52:55], v[172:175], v[88:103]
    ds_read_b64_tr_b16 v[48:49], v22 offset:16384
    ds_read_b64_tr_b16 v[50:51], v22 offset:18432
    s_waitcnt lgkmcnt(10)
    v_mfma_f32_32x32x16_bf16 v[104:119], v[28:31], v[172:175], v[104:119]
    ds_read_b64_tr_b16 v[52:53], v23 offset:16384
    ds_read_b64_tr_b16 v[54:55], v23 offset:18432
    s_waitcnt lgkmcnt(10)
    v_mfma_f32_32x32x16_bf16 v[88:103], v[32:35], v[176:179], v[88:103]
    ds_read_b64_tr_b16 v[28:29], v22 offset:17408
    ds_read_b64_tr_b16 v[30:31], v22 offset:19456
    s_waitcnt lgkmcnt(10)
    v_mfma_f32_32x32x16_bf16 v[104:119], v[36:39], v[176:179], v[104:119]
    ds_read_b64_tr_b16 v[32:33], v23 offset:17408
    ds_read_b64_tr_b16 v[34:35], v23 offset:19456
    s_waitcnt lgkmcnt(10)
    v_mfma_f32_32x32x16_bf16 v[88:103], v[40:43], v[180:183], v[88:103]
    ds_read_b64_tr_b16 v[36:37], v22 offset:20480
    ds_read_b64_tr_b16 v[38:39], v22 offset:22528
    s_waitcnt lgkmcnt(10)
    v_mfma_f32_32x32x16_bf16 v[104:119], v[44:47], v[180:183], v[104:119]
    ds_read_b64_tr_b16 v[40:41], v23 offset:20480
    ds_read_b64_tr_b16 v[42:43], v23 offset:22528
    s_waitcnt lgkmcnt(10)
    v_mfma_f32_32x32x16_bf16 v[88:103], v[48:51], v[184:187], v[88:103]
    ds_read_b64_tr_b16 v[44:45], v22 offset:21504
    ds_read_b64_tr_b16 v[46:47], v22 offset:23552
    s_waitcnt lgkmcnt(10)
    v_mfma_f32_32x32x16_bf16 v[104:119], v[52:55], v[184:187], v[104:119]
    ds_read_b64_tr_b16 v[48:49], v23 offset:21504
    ds_read_b64_tr_b16 v[50:51], v23 offset:23552
    s_waitcnt lgkmcnt(10)
    v_mfma_f32_32x32x16_bf16 v[88:103], v[28:31], v[188:191], v[88:103]
    ds_read_b64_tr_b16 v[52:53], v22 offset:24576
    ds_read_b64_tr_b16 v[54:55], v22 offset:26624
    s_waitcnt lgkmcnt(10)
    v_mfma_f32_32x32x16_bf16 v[104:119], v[32:35], v[188:191], v[104:119]
    ds_read_b64_tr_b16 v[28:29], v23 offset:24576
    ds_read_b64_tr_b16 v[30:31], v23 offset:26624
    s_waitcnt lgkmcnt(10)
    v_mfma_f32_32x32x16_bf16 v[88:103], v[36:39], v[192:195], v[88:103]
    ds_read_b64_tr_b16 v[32:33], v22 offset:25600
    ds_read_b64_tr_b16 v[34:35], v22 offset:27648
    s_waitcnt lgkmcnt(10)
    v_mfma_f32_32x32x16_bf16 v[104:119], v[40:43], v[192:195], v[104:119]
    ds_read_b64_tr_b16 v[36:37], v23 offset:25600
    ds_read_b64_tr_b16 v[38:39], v23 offset:27648
    s_waitcnt lgkmcnt(10)
    v_mfma_f32_32x32x16_bf16 v[88:103], v[44:47], v[196:199], v[88:103]
    ds_read_b64_tr_b16 v[40:41], v22 offset:28672
    ds_read_b64_tr_b16 v[42:43], v22 offset:30720
    s_waitcnt lgkmcnt(10)
    v_mfma_f32_32x32x16_bf16 v[104:119], v[48:51], v[196:199], v[104:119]
    ds_read_b64_tr_b16 v[44:45], v23 offset:28672
    ds_read_b64_tr_b16 v[46:47], v23 offset:30720
    s_waitcnt lgkmcnt(10)
    v_mfma_f32_32x32x16_bf16 v[88:103], v[52:55], v[200:203], v[88:103]
    ds_read_b64_tr_b16 v[48:49], v22 offset:29696
    ds_read_b64_tr_b16 v[50:51], v22 offset:31744
    s_waitcnt lgkmcnt(10)
    v_mfma_f32_32x32x16_bf16 v[104:119], v[28:31], v[200:203], v[104:119]
    ds_read_b64_tr_b16 v[52:53], v23 offset:29696
    ds_read_b64_tr_b16 v[54:55], v23 offset:31744
    s_waitcnt lgkmcnt(10)
    v_mfma_f32_32x32x16_bf16 v[88:103], v[32:35], v[204:207], v[88:103]
    ds_read_b64_tr_b16 v[28:29], v24 offset:32768
    ds_read_b64_tr_b16 v[30:31], v24 offset:34816
    s_waitcnt lgkmcnt(10)
    v_mfma_f32_32x32x16_bf16 v[104:119], v[36:39], v[204:207], v[104:119]
    ds_read_b64_tr_b16 v[32:33], v25 offset:32768
    ds_read_b64_tr_b16 v[34:35], v25 offset:34816
    s_waitcnt lgkmcnt(10)
    v_mfma_f32_32x32x16_bf16 v[88:103], v[40:43], v[208:211], v[88:103]
    ds_read_b64_tr_b16 v[36:37], v24 offset:33792
    ds_read_b64_tr_b16 v[38:39], v24 offset:35840
    s_waitcnt lgkmcnt(10)
    v_mfma_f32_32x32x16_bf16 v[104:119], v[44:47], v[208:211], v[104:119]
    ds_read_b64_tr_b16 v[40:41], v25 offset:33792
    ds_read_b64_tr_b16 v[42:43], v25 offset:35840
    s_waitcnt lgkmcnt(10)
    v_mfma_f32_32x32x16_bf16 v[88:103], v[48:51], v[212:215], v[88:103]
    ds_read_b64_tr_b16 v[44:45], v24 offset:36864
    ds_read_b64_tr_b16 v[46:47], v24 offset:38912
    s_waitcnt lgkmcnt(10)
    v_mfma_f32_32x32x16_bf16 v[104:119], v[52:55], v[212:215], v[104:119]
    ds_read_b64_tr_b16 v[48:49], v25 offset:36864
    ds_read_b64_tr_b16 v[50:51], v25 offset:38912
    s_barrier
    s_waitcnt lgkmcnt(10)
    v_mfma_f32_32x32x16_bf16 v[120:135], v[28:31], v[216:219], v[120:135]
    ds_read_b64_tr_b16 v[52:53], v24 offset:37888
    ds_read_b64_tr_b16 v[54:55], v24 offset:39936
    s_waitcnt lgkmcnt(10)
    v_mfma_f32_32x32x16_bf16 v[136:151], v[32:35], v[216:219], v[136:151]
L_PAD4:
    s_cbranch_execz L_RET4
    v_cvt_pk_bf16_f32 v88, v88, v89
    v_cvt_pk_bf16_f32 v89, v90, v91
    ds_read_b64_tr_b16 v[28:29], v25 offset:37888
    ds_read_b64_tr_b16 v[30:31], v25 offset:39936
    s_waitcnt lgkmcnt(10)
    v_mfma_f32_32x32x16_bf16 v[120:135], v[36:39], v[220:223], v[120:135]
    v_cvt_pk_bf16_f32 v90, v92, v93
    v_cvt_pk_bf16_f32 v91, v94, v95
    ds_write_b128 v0, v[88:91]
    ds_read_b64_tr_b16 v[32:33], v24 offset:40960
    ds_read_b64_tr_b16 v[34:35], v24 offset:43008
    s_waitcnt lgkmcnt(11)
    v_mfma_f32_32x32x16_bf16 v[136:151], v[40:43], v[220:223], v[136:151]
    v_cvt_pk_bf16_f32 v92, v96, v97
    v_cvt_pk_bf16_f32 v93, v98, v99
    ds_read_b64_tr_b16 v[36:37], v25 offset:40960
    ds_read_b64_tr_b16 v[38:39], v25 offset:43008
    s_waitcnt lgkmcnt(11)
    v_mfma_f32_32x32x16_bf16 v[120:135], v[44:47], v[224:227], v[120:135]
    v_cvt_pk_bf16_f32 v94, v100, v101
    v_cvt_pk_bf16_f32 v95, v102, v103
    ds_write_b128 v0, v[92:95] offset:1024
    ds_read_b64_tr_b16 v[40:41], v24 offset:41984
    ds_read_b64_tr_b16 v[42:43], v24 offset:44032
    s_waitcnt lgkmcnt(12)
    v_mfma_f32_32x32x16_bf16 v[136:151], v[48:51], v[224:227], v[136:151]
    v_cvt_pk_bf16_f32 v104, v104, v105
    v_cvt_pk_bf16_f32 v105, v106, v107
    ds_read_b64_tr_b16 v[44:45], v25 offset:41984
    ds_read_b64_tr_b16 v[46:47], v25 offset:44032
    s_waitcnt lgkmcnt(12)
    v_mfma_f32_32x32x16_bf16 v[120:135], v[52:55], v[228:231], v[120:135]
    v_cvt_pk_bf16_f32 v106, v108, v109
    v_cvt_pk_bf16_f32 v107, v110, v111
    ds_write_b128 v0, v[104:107] offset:8192
    ds_read_b64_tr_b16 v[48:49], v24 offset:45056
    ds_read_b64_tr_b16 v[50:51], v24 offset:47104
    s_waitcnt lgkmcnt(13)
    v_mfma_f32_32x32x16_bf16 v[136:151], v[28:31], v[228:231], v[136:151]
    v_cvt_pk_bf16_f32 v108, v112, v113
    v_cvt_pk_bf16_f32 v109, v114, v115
    ds_read_b64_tr_b16 v[52:53], v25 offset:45056
    ds_read_b64_tr_b16 v[54:55], v25 offset:47104
    s_waitcnt lgkmcnt(12)
    v_mfma_f32_32x32x16_bf16 v[120:135], v[32:35], v[232:235], v[120:135]
    v_cvt_pk_bf16_f32 v110, v116, v117
    v_cvt_pk_bf16_f32 v111, v118, v119
    ds_write_b128 v0, v[108:111] offset:9216
    ds_read_b64_tr_b16 v[28:29], v24 offset:46080
    ds_read_b64_tr_b16 v[30:31], v24 offset:48128
    s_waitcnt lgkmcnt(13)
    v_mfma_f32_32x32x16_bf16 v[136:151], v[36:39], v[232:235], v[136:151]
    ds_read_b64_tr_b16 v[32:33], v25 offset:46080
    ds_read_b64_tr_b16 v[34:35], v25 offset:48128
    s_waitcnt lgkmcnt(12)
    v_mfma_f32_32x32x16_bf16 v[120:135], v[40:43], v[236:239], v[120:135]
    ds_read_b64_tr_b16 v[36:37], v24
    ds_read_b64_tr_b16 v[38:39], v24 offset:2048
    s_waitcnt lgkmcnt(12)
    v_mfma_f32_32x32x16_bf16 v[136:151], v[44:47], v[236:239], v[136:151]
    ds_read_b64_tr_b16 v[40:41], v25
    ds_read_b64_tr_b16 v[42:43], v25 offset:2048
    s_waitcnt lgkmcnt(11)
    v_mfma_f32_32x32x16_bf16 v[120:135], v[48:51], v[240:243], v[120:135]
    ds_read_b64_tr_b16 v[44:45], v24 offset:1024
    ds_read_b64_tr_b16 v[46:47], v24 offset:3072
    s_waitcnt lgkmcnt(11)
    v_mfma_f32_32x32x16_bf16 v[136:151], v[52:55], v[240:243], v[136:151]
    ds_read_b64_tr_b16 v[48:49], v25 offset:1024
    ds_read_b64_tr_b16 v[50:51], v25 offset:3072
    s_waitcnt lgkmcnt(10)
    v_mfma_f32_32x32x16_bf16 v[120:135], v[28:31], v[244:247], v[120:135]
    ds_read_b64_tr_b16 v[52:53], v24 offset:4096
    ds_read_b64_tr_b16 v[54:55], v24 offset:6144
    s_waitcnt lgkmcnt(10)
    v_mfma_f32_32x32x16_bf16 v[136:151], v[32:35], v[244:247], v[136:151]
    ds_read_b64_tr_b16 v[28:29], v25 offset:4096
    ds_read_b64_tr_b16 v[30:31], v25 offset:6144
    s_waitcnt lgkmcnt(10)
    v_mfma_f32_32x32x16_bf16 v[120:135], v[36:39], v[152:155], v[120:135]
    ds_read_b64_tr_b16 v[32:33], v24 offset:5120
    ds_read_b64_tr_b16 v[34:35], v24 offset:7168
    s_waitcnt lgkmcnt(10)
    v_mfma_f32_32x32x16_bf16 v[136:151], v[40:43], v[152:155], v[136:151]
    ds_read_b64_tr_b16 v[36:37], v25 offset:5120
    ds_read_b64_tr_b16 v[38:39], v25 offset:7168
    s_waitcnt lgkmcnt(10)
    v_mfma_f32_32x32x16_bf16 v[120:135], v[44:47], v[156:159], v[120:135]
    ds_read_b64_tr_b16 v[40:41], v24 offset:8192
    ds_read_b64_tr_b16 v[42:43], v24 offset:10240
    s_waitcnt lgkmcnt(10)
    v_mfma_f32_32x32x16_bf16 v[136:151], v[48:51], v[156:159], v[136:151]
    ds_read_b64_tr_b16 v[44:45], v25 offset:8192
    ds_read_b64_tr_b16 v[46:47], v25 offset:10240
    s_waitcnt lgkmcnt(10)
    v_mfma_f32_32x32x16_bf16 v[120:135], v[52:55], v[160:163], v[120:135]
    ds_read_b64_tr_b16 v[48:49], v24 offset:9216
    ds_read_b64_tr_b16 v[50:51], v24 offset:11264
    s_waitcnt lgkmcnt(10)
    v_mfma_f32_32x32x16_bf16 v[136:151], v[28:31], v[160:163], v[136:151]
    ds_read_b64_tr_b16 v[52:53], v25 offset:9216
    ds_read_b64_tr_b16 v[54:55], v25 offset:11264
    s_waitcnt lgkmcnt(10)
    v_mfma_f32_32x32x16_bf16 v[120:135], v[32:35], v[164:167], v[120:135]
    ds_read_b64_tr_b16 v[28:29], v24 offset:12288
    ds_read_b64_tr_b16 v[30:31], v24 offset:14336
    s_waitcnt lgkmcnt(10)
    v_mfma_f32_32x32x16_bf16 v[136:151], v[36:39], v[164:167], v[136:151]
    ds_read_b64_tr_b16 v[32:33], v25 offset:12288
    ds_read_b64_tr_b16 v[34:35], v25 offset:14336
    s_waitcnt lgkmcnt(10)
    v_mfma_f32_32x32x16_bf16 v[120:135], v[40:43], v[168:171], v[120:135]
    ds_read_b64_tr_b16 v[36:37], v24 offset:13312
    ds_read_b64_tr_b16 v[38:39], v24 offset:15360
    s_waitcnt lgkmcnt(10)
    v_mfma_f32_32x32x16_bf16 v[136:151], v[44:47], v[168:171], v[136:151]
    ds_read_b64_tr_b16 v[40:41], v25 offset:13312
    ds_read_b64_tr_b16 v[42:43], v25 offset:15360
    s_waitcnt lgkmcnt(10)
    v_mfma_f32_32x32x16_bf16 v[120:135], v[48:51], v[172:175], v[120:135]
    ds_read_b64_tr_b16 v[44:45], v24 offset:16384
    ds_read_b64_tr_b16 v[46:47], v24 offset:18432
    s_waitcnt lgkmcnt(10)
    v_mfma_f32_32x32x16_bf16 v[136:151], v[52:55], v[172:175], v[136:151]
    ds_read_b64_tr_b16 v[48:49], v25 offset:16384
    ds_read_b64_tr_b16 v[50:51], v25 offset:18432
    s_waitcnt lgkmcnt(10)
    v_mfma_f32_32x32x16_bf16 v[120:135], v[28:31], v[176:179], v[120:135]
    ds_read_b64_tr_b16 v[52:53], v24 offset:17408
    ds_read_b64_tr_b16 v[54:55], v24 offset:19456
    s_waitcnt lgkmcnt(10)
    v_mfma_f32_32x32x16_bf16 v[136:151], v[32:35], v[176:179], v[136:151]
    ds_read_b64_tr_b16 v[28:29], v25 offset:17408
    ds_read_b64_tr_b16 v[30:31], v25 offset:19456
    s_waitcnt lgkmcnt(10)
    v_mfma_f32_32x32x16_bf16 v[120:135], v[36:39], v[180:183], v[120:135]
    ds_read_b64_tr_b16 v[32:33], v24 offset:20480
    ds_read_b64_tr_b16 v[34:35], v24 offset:22528
    s_waitcnt lgkmcnt(10)
    v_mfma_f32_32x32x16_bf16 v[136:151], v[40:43], v[180:183], v[136:151]
    ds_read_b64_tr_b16 v[36:37], v25 offset:20480
    ds_read_b64_tr_b16 v[38:39], v25 offset:22528
    s_waitcnt lgkmcnt(10)
    v_mfma_f32_32x32x16_bf16 v[120:135], v[44:47], v[184:187], v[120:135]
    ds_read_b64_tr_b16 v[40:41], v24 offset:21504
    ds_read_b64_tr_b16 v[42:43], v24 offset:23552
    s_waitcnt lgkmcnt(10)
    v_mfma_f32_32x32x16_bf16 v[136:151], v[48:51], v[184:187], v[136:151]
    ds_read_b64_tr_b16 v[44:45], v25 offset:21504
    ds_read_b64_tr_b16 v[46:47], v25 offset:23552
    s_waitcnt lgkmcnt(10)
    v_mfma_f32_32x32x16_bf16 v[120:135], v[52:55], v[188:191], v[120:135]
    ds_read_b64_tr_b16 v[48:49], v24 offset:24576
    ds_read_b64_tr_b16 v[50:51], v24 offset:26624
    s_waitcnt lgkmcnt(10)
    v_mfma_f32_32x32x16_bf16 v[136:151], v[28:31], v[188:191], v[136:151]
    ds_read_b64_tr_b16 v[52:53], v25 offset:24576
    ds_read_b64_tr_b16 v[54:55], v25 offset:26624
    s_waitcnt lgkmcnt(10)
    v_mfma_f32_32x32x16_bf16 v[120:135], v[32:35], v[192:195], v[120:135]
    ds_read_b64_tr_b16 v[28:29], v24 offset:25600
    ds_read_b64_tr_b16 v[30:31], v24 offset:27648
    s_waitcnt lgkmcnt(10)
    v_mfma_f32_32x32x16_bf16 v[136:151], v[36:39], v[192:195], v[136:151]
    ds_read_b64_tr_b16 v[32:33], v25 offset:25600
    ds_read_b64_tr_b16 v[34:35], v25 offset:27648
    s_waitcnt lgkmcnt(10)
    v_mfma_f32_32x32x16_bf16 v[120:135], v[40:43], v[196:199], v[120:135]
    ds_read_b64_tr_b16 v[36:37], v24 offset:28672
    ds_read_b64_tr_b16 v[38:39], v24 offset:30720
    s_waitcnt lgkmcnt(10)
    v_mfma_f32_32x32x16_bf16 v[136:151], v[44:47], v[196:199], v[136:151]
    ds_read_b64_tr_b16 v[40:41], v25 offset:28672
    ds_read_b64_tr_b16 v[42:43], v25 offset:30720
    s_waitcnt lgkmcnt(10)
    v_mfma_f32_32x32x16_bf16 v[120:135], v[48:51], v[200:203], v[120:135]
    ds_read_b64_tr_b16 v[44:45], v25 offset:29696
    ds_read_b64_tr_b16 v[46:47], v25 offset:31744
    s_waitcnt lgkmcnt(10)
    v_mfma_f32_32x32x16_bf16 v[136:151], v[52:55], v[200:203], v[136:151]
    ds_read_b64_tr_b16 v[48:49], v24 offset:29696
    ds_read_b64_tr_b16 v[50:51], v24 offset:31744
    s_waitcnt lgkmcnt(10)
    v_mfma_f32_32x32x16_bf16 v[120:135], v[28:31], v[204:207], v[120:135]
    s_waitcnt lgkmcnt(8)
    v_mfma_f32_32x32x16_bf16 v[136:151], v[32:35], v[204:207], v[136:151]
    s_waitcnt lgkmcnt(6)
    v_mfma_f32_32x32x16_bf16 v[120:135], v[36:39], v[208:211], v[120:135]
    s_waitcnt lgkmcnt(4)
    v_mfma_f32_32x32x16_bf16 v[136:151], v[40:43], v[208:211], v[136:151]
    s_waitcnt lgkmcnt(2)
    v_mfma_f32_32x32x16_bf16 v[136:151], v[44:47], v[212:215], v[136:151]
    s_waitcnt lgkmcnt(0)
    v_mfma_f32_32x32x16_bf16 v[120:135], v[48:51], v[212:215], v[120:135]
    s_lshl_b32 s96, s77, 11
    s_add_u32 s14, s96, 151552
    v_add_u32 v0, s14, v2
    v_bfe_u32 v4, v1, 2, 2
    v_lshlrev_b32 v4, 6, v4
    v_bfe_u32 v9, v1, 4, 1
    v_lshl_add_u32 v4, v9, 5, v4
    v_and_b32 v9, 3, v1
    v_lshl_add_u32 v4, v9, 3, v4
    v_lshrrev_b32 v9, 5, v1
    v_lshl_add_u32 v4, v9, 8, v4
    v_add_u32 v4, 159744, v4
    ds_read_b64_tr_b16 v[176:177], v4
    ds_read_b64_tr_b16 v[178:179], v4 offset:512
    ds_read_b64_tr_b16 v[180:181], v4 offset:1024
    ds_read_b64_tr_b16 v[182:183], v4 offset:1536
    v_cvt_pk_bf16_f32 v152, v136, v137
    v_cvt_pk_bf16_f32 v153, v138, v139
    v_cvt_pk_bf16_f32 v154, v140, v141
    v_cvt_pk_bf16_f32 v155, v142, v143
    v_cvt_pk_bf16_f32 v156, v144, v145
    v_cvt_pk_bf16_f32 v157, v146, v147
    v_cvt_pk_bf16_f32 v158, v148, v149
    v_cvt_pk_bf16_f32 v159, v150, v151
    ds_write_b128 v0, v[152:155]
    ds_write_b128 v0, v[156:159] offset:1024
    v_cvt_pk_bf16_f32 v168, v120, v121
    v_cvt_pk_bf16_f32 v169, v122, v123
    v_cvt_pk_bf16_f32 v170, v124, v125
    v_cvt_pk_bf16_f32 v171, v126, v127
    v_cvt_pk_bf16_f32 v172, v128, v129
    v_cvt_pk_bf16_f32 v173, v130, v131
    v_cvt_pk_bf16_f32 v174, v132, v133
    v_cvt_pk_bf16_f32 v175, v134, v135
    s_setprio 0
    s_branch L_JOIN
L_HELP:
    s_waitcnt vmcnt(3)
    s_barrier
    s_add_u32 s96, s84, 5
    s_and_b32 s97, s96, 15
    s_mul_i32 s98, s97, 393216
    s_add_u32 s99, s98, s85
    s_add_u32 s82, s99, 4294772736
    s_add_u32 m0, s83, 36864
    s_nop 0
    buffer_load_dwordx4 v3, s[40:43], s82 offen lds
    s_add_u32 s96, s84, 5
    s_and_b32 s97, s96, 15
    s_mul_i32 s98, s97, 393216
    s_add_u32 s99, s98, s85
    s_add_u32 s82, s99, 2048
    s_add_u32 m0, s83, 40960
    s_nop 0
    buffer_load_dwordx4 v3, s[40:43], s82 offen lds
    s_add_u32 s96, s84, 5
    s_and_b32 s97, s96, 15
    s_mul_i32 s98, s97, 393216
    s_add_u32 s99, s98, s85
    s_add_u32 s82, s99, 4294774784
    s_add_u32 m0, s83, 86016
    s_nop 0
    buffer_load_dwordx4 v3, s[40:43], s82 offen lds
    s_add_u32 s96, s84, 5
    s_and_b32 s97, s96, 15
    s_mul_i32 s98, s97, 393216
    s_add_u32 s99, s98, s85
    s_add_u32 s82, s99, 4096
    s_add_u32 m0, s83, 90112
    s_nop 0
    buffer_load_dwordx4 v3, s[40:43], s82 offen lds
    s_add_u32 s96, s84, 5
    s_and_b32 s97, s96, 15
    s_mul_i32 s98, s97, 393216
    s_add_u32 s99, s98, s85
    s_add_u32 s82, s99, 4294770688
    s_add_u32 m0, s83, 135168
    s_nop 0
    buffer_load_dwordx4 v3, s[40:43], s82 offen lds
    s_add_u32 s96, s84, 5
    s_and_b32 s97, s96, 15
    s_mul_i32 s98, s97, 393216
    s_add_u32 s82, s98, s85
    s_add_u32 m0, s83, 139264
    s_nop 0
    buffer_load_dwordx4 v3, s[40:43], s82 offen lds
    v_bfe_u32 v4, v1, 2, 2
    v_lshlrev_b32 v4, 6, v4
    v_bfe_u32 v9, v1, 4, 1
    v_lshl_add_u32 v4, v9, 5, v4
    v_and_b32 v9, 3, v1
    v_lshl_add_u32 v4, v9, 3, v4
    v_lshrrev_b32 v9, 5, v1
    v_lshl_add_u32 v4, v9, 8, v4
    v_add_u32 v4, 159744, v4
    ds_read_b64_tr_b16 v[168:169], v4
    ds_read_b64_tr_b16 v[170:171], v4 offset:512
    ds_read_b64_tr_b16 v[172:173], v4 offset:1024
    ds_read_b64_tr_b16 v[174:175], v4 offset:1536
    ds_read_b64_tr_b16 v[176:177], v4 offset:2048
    ds_read_b64_tr_b16 v[178:179], v4 offset:2560
    ds_read_b64_tr_b16 v[180:181], v4 offset:3072
    ds_read_b64_tr_b16 v[182:183], v4 offset:3584
    s_lshl_b32 s14, s77, 10
    v_and_b32 v232, 7, v1
    v_lshl_add_u32 v232, v232, 4, s14
    v_bfe_u32 v9, v1, 3, 2
    v_lshl_add_u32 v232, v9, 8, v232
    v_lshrrev_b32 v9, 5, v1
    v_lshl_add_u32 v232, v9, 7, v232
    s_and_b32 s96, s9, 1
    s_lshl1_add_u32 s18, s96, 1
    s_and_b32 s96, s8, 3
    s_lshl2_add_u32 s97, s96, s3
    s_sub_u32 s98, s97, 4
    s_lshl_b32 s82, s98, 7
    v_lshrrev_b32 v136, 3, v1
    v_lshl_add_u32 v136, v136, 1, s82
    global_load_ushort v120, v136, s[86:87] offset:0
    global_load_ushort v121, v136, s[86:87] offset:16
    global_load_ushort v122, v136, s[86:87] offset:32
    global_load_ushort v123, v136, s[86:87] offset:48
    global_load_ushort v124, v136, s[86:87] offset:64
    global_load_ushort v125, v136, s[86:87] offset:80
    global_load_ushort v126, v136, s[86:87] offset:96
    global_load_ushort v127, v136, s[86:87] offset:112
    s_and_b32 s96, s8, 3
    s_lshl2_add_u32 s97, s96, s3
    s_sub_u32 s98, s97, 4
    s_mul_i32 s99, s98, 786432
    s_lshr_b32 s96, s8, 2
    s_lshl1_add_u32 s97, s9, s96
    s_lshl_b32 s98, s97, 7
    s_add_u32 s96, s99, s98
    s_add_u32 s19, s96, 4096
    s_waitcnt vmcnt(14)
    s_barrier
    s_add_u32 s96, s84, 6
    s_and_b32 s97, s96, 15
    s_mul_i32 s98, s97, 393216
    s_add_u32 s99, s98, s85
    s_add_u32 s82, s99, 4294772736
    s_add_u32 m0, s83, 4294963200
    s_nop 0
    buffer_load_dwordx4 v3, s[40:43], s82 offen lds
    s_add_u32 s96, s84, 6
    s_and_b32 s97, s96, 15
    s_mul_i32 s98, s97, 393216
    s_add_u32 s99, s98, s85
    s_add_u32 s82, s99, 2048
    s_mov_b32 m0, s83
    s_nop 0
    buffer_load_dwordx4 v3, s[40:43], s82 offen lds
    s_add_u32 s96, s84, 6
    s_and_b32 s97, s96, 15
    s_mul_i32 s98, s97, 393216
    s_add_u32 s99, s98, s85
    s_add_u32 s82, s99, 4294770688
    s_add_u32 m0, s83, 94208
    s_nop 0
    buffer_load_dwordx4 v3, s[40:43], s82 offen lds
    s_add_u32 s96, s84, 6
    s_and_b32 s97, s96, 15
    s_mul_i32 s98, s97, 393216
    s_add_u32 s82, s98, s85
    s_add_u32 m0, s83, 98304
    s_nop 0
    buffer_load_dwordx4 v3, s[40:43], s82 offen lds
    s_add_u32 s96, s84, 6
    s_and_b32 s97, s96, 15
    s_mul_i32 s98, s97, 393216
    s_add_u32 s99, s98, s85
    s_add_u32 s82, s99, 4294774784
    s_add_u32 m0, s83, 45056
    s_nop 0
    buffer_load_dwordx4 v3, s[40:43], s82 offen lds
    s_add_u32 s96, s84, 6
    s_and_b32 s97, s96, 15
    s_mul_i32 s98, s97, 393216
    s_add_u32 s99, s98, s85
    s_add_u32 s82, s99, 4096
    s_add_u32 m0, s83, 49152
    s_nop 0
    buffer_load_dwordx4 v3, s[40:43], s82 offen lds
    s_cmp_lg_u32 s18, 1
    s_cbranch_scc1 L_NM2_1
    s_mov_b32 s82, s19
    buffer_load_dwordx4 v[88:91], v248, s[48:51], s82 offen nt
    s_add_u32 s82, s19, 98304
    buffer_load_dwordx4 v[92:95], v248, s[48:51], s82 offen nt
    s_add_u32 s82, s19, 196608
    buffer_load_dwordx4 v[96:99], v248, s[48:51], s82 offen nt
    s_add_u32 s82, s19, 294912
    buffer_load_dwordx4 v[100:103], v248, s[48:51], s82 offen nt
    s_add_u32 s82, s19, 393216
    buffer_load_dwordx4 v[104:107], v248, s[48:51], s82 offen nt
    s_add_u32 s82, s19, 491520
    buffer_load_dwordx4 v[108:111], v248, s[48:51], s82 offen nt
    s_add_u32 s82, s19, 589824
    buffer_load_dwordx4 v[112:115], v248, s[48:51], s82 offen nt
    s_add_u32 s82, s19, 688128
    buffer_load_dwordx4 v[116:119], v248, s[48:51], s82 offen nt
L_NM2_1:
    s_waitcnt lgkmcnt(0)
    s_load_dword s24, s[32:33], s92 offset:512 glc
    s_load_dword s25, s[32:33], s92 offset:256 glc
    s_load_dword s26, s[32:33], s92 offset:3584 glc
    s_load_dword s27, s[32:33], s92 offset:3328 glc
    s_barrier
    s_add_u32 s96, s84, 7
    s_and_b32 s97, s96, 15
    s_mul_i32 s98, s97, 393216
    s_add_u32 s99, s98, s85
    s_add_u32 s82, s99, 4294772736
    s_add_u32 m0, s83, 4096
    s_nop 0
    buffer_load_dwordx4 v3, s[40:43], s82 offen lds
    s_add_u32 s96, s84, 7
    s_and_b32 s97, s96, 15
    s_mul_i32 s98, s97, 393216
    s_add_u32 s99, s98, s85
    s_add_u32 s82, s99, 2048
    s_add_u32 m0, s83, 8192
    s_nop 0
    buffer_load_dwordx4 v3, s[40:43], s82 offen lds
    s_add_u32 s96, s84, 7
    s_and_b32 s97, s96, 15
    s_mul_i32 s98, s97, 393216
    s_add_u32 s99, s98, s85
    s_add_u32 s82, s99, 4294770688
    s_add_u32 m0, s83, 102400
    s_nop 0
    buffer_load_dwordx4 v3, s[40:43], s82 offen lds
    s_add_u32 s96, s84, 7
    s_and_b32 s97, s96, 15
    s_mul_i32 s98, s97, 393216
    s_add_u32 s82, s98, s85
    s_add_u32 m0, s83, 106496
    s_nop 0
    buffer_load_dwordx4 v3, s[40:43], s82 offen lds
    s_add_u32 s96, s84, 7
    s_and_b32 s97, s96, 15
    s_mul_i32 s98, s97, 393216
    s_add_u32 s99, s98, s85
    s_add_u32 s82, s99, 4294774784
    s_add_u32 m0, s83, 53248
    s_nop 0
    buffer_load_dwordx4 v3, s[40:43], s82 offen lds
    s_add_u32 s96, s84, 7
    s_and_b32 s97, s96, 15
    s_mul_i32 s98, s97, 393216
    s_add_u32 s99, s98, s85
    s_add_u32 s82, s99, 4096
    s_add_u32 m0, s83, 57344
    s_nop 0
    buffer_load_dwordx4 v3, s[40:43], s82 offen lds
    s_cmp_lg_u32 s18, 2
    s_cbranch_scc1 L_NM2_2
    s_mov_b32 s82, s19
    buffer_load_dwordx4 v[88:91], v248, s[48:51], s82 offen nt
    s_add_u32 s82, s19, 98304
    buffer_load_dwordx4 v[92:95], v248, s[48:51], s82 offen nt
    s_add_u32 s82, s19, 196608
    buffer_load_dwordx4 v[96:99], v248, s[48:51], s82 offen nt
    s_add_u32 s82, s19, 294912
    buffer_load_dwordx4 v[100:103], v248, s[48:51], s82 offen nt
    s_add_u32 s82, s19, 393216
    buffer_load_dwordx4 v[104:107], v248, s[48:51], s82 offen nt
    s_add_u32 s82, s19, 491520
    buffer_load_dwordx4 v[108:111], v248, s[48:51], s82 offen nt
    s_add_u32 s82, s19, 589824
    buffer_load_dwordx4 v[112:115], v248, s[48:51], s82 offen nt
    s_add_u32 s82, s19, 688128
    buffer_load_dwordx4 v[116:119], v248, s[48:51], s82 offen nt
L_NM2_2:
    s_barrier
    s_add_u32 s96, s84, 8
    s_and_b32 s97, s96, 15
    s_mul_i32 s98, s97, 393216
    s_add_u32 s99, s98, s85
    s_add_u32 s82, s99, 4294772736
    s_add_u32 m0, s83, 12288
    s_nop 0
    buffer_load_dwordx4 v3, s[40:43], s82 offen lds
    s_add_u32 s96, s84, 8
    s_and_b32 s97, s96, 15
    s_mul_i32 s98, s97, 393216
    s_add_u32 s99, s98, s85
    s_add_u32 s82, s99, 2048
    s_add_u32 m0, s83, 16384
    s_nop 0
    buffer_load_dwordx4 v3, s[40:43], s82 offen lds
    s_add_u32 s96, s84, 8
    s_and_b32 s97, s96, 15
    s_mul_i32 s98, s97, 393216
    s_add_u32 s99, s98, s85
    s_add_u32 s82, s99, 4294770688
    s_add_u32 m0, s83, 110592
    s_nop 0
    buffer_load_dwordx4 v3, s[40:43], s82 offen lds
    s_add_u32 s96, s84, 8
    s_and_b32 s97, s96, 15
    s_mul_i32 s98, s97, 393216
    s_add_u32 s82, s98, s85
    s_add_u32 m0, s83, 114688
    s_nop 0
    buffer_load_dwordx4 v3, s[40:43], s82 offen lds
    s_add_u32 s96, s84, 8
    s_and_b32 s97, s96, 15
    s_mul_i32 s98, s97, 393216
    s_add_u32 s99, s98, s85
    s_add_u32 s82, s99, 4294774784
    s_add_u32 m0, s83, 61440
    s_nop 0
    buffer_load_dwordx4 v3, s[40:43], s82 offen lds
    s_add_u32 s96, s84, 8
    s_and_b32 s97, s96, 15
    s_mul_i32 s98, s97, 393216
    s_add_u32 s99, s98, s85
    s_add_u32 s82, s99, 4096
    s_add_u32 m0, s83, 65536
    s_nop 0
    buffer_load_dwordx4 v3, s[40:43], s82 offen lds
    s_cmp_lg_u32 s18, 3
    s_cbranch_scc1 L_NM2_3
    s_mov_b32 s82, s19
    buffer_load_dwordx4 v[88:91], v248, s[48:51], s82 offen nt
    s_add_u32 s82, s19, 98304
    buffer_load_dwordx4 v[92:95], v248, s[48:51], s82 offen nt
    s_add_u32 s82, s19, 196608
    buffer_load_dwordx4 v[96:99], v248, s[48:51], s82 offen nt
    s_add_u32 s82, s19, 294912
    buffer_load_dwordx4 v[100:103], v248, s[48:51], s82 offen nt
    s_add_u32 s82, s19, 393216
    buffer_load_dwordx4 v[104:107], v248, s[48:51], s82 offen nt
    s_add_u32 s82, s19, 491520
    buffer_load_dwordx4 v[108:111], v248, s[48:51], s82 offen nt
    s_add_u32 s82, s19, 589824
    buffer_load_dwordx4 v[112:115], v248, s[48:51], s82 offen nt
    s_add_u32 s82, s19, 688128
    buffer_load_dwordx4 v[116:119], v248, s[48:51], s82 offen nt
L_NM2_3:
    s_waitcnt vmcnt(18)
    v_lshlrev_b32 v120, 16, v120
    v_mul_f32 v136, s7, v120
    v_exp_f32 v136, -v136
    s_nop 0
    v_add_f32 v136, 1.0, v136
    v_rcp_f32 v136, v136
    s_nop 0
    v_mul_f32 v120, v120, v136
    v_cvt_pk_bf16_f32 v120, 0, v120
    v_lshlrev_b32 v121, 16, v121
    v_mul_f32 v137, s7, v121
    v_exp_f32 v137, -v137
    s_nop 0
    v_add_f32 v137, 1.0, v137
    v_rcp_f32 v137, v137
    s_nop 0
    v_mul_f32 v121, v121, v137
    v_cvt_pk_bf16_f32 v121, 0, v121
    v_lshlrev_b32 v122, 16, v122
    v_mul_f32 v136, s7, v122
    v_exp_f32 v136, -v136
    s_nop 0
    v_add_f32 v136, 1.0, v136
    v_rcp_f32 v136, v136
    s_nop 0
    v_mul_f32 v122, v122, v136
    v_cvt_pk_bf16_f32 v122, 0, v122
    v_lshlrev_b32 v123, 16, v123
    v_mul_f32 v137, s7, v123
    v_exp_f32 v137, -v137
    s_nop 0
    v_add_f32 v137, 1.0, v137
    v_rcp_f32 v137, v137
    s_nop 0
    v_mul_f32 v123, v123, v137
    v_cvt_pk_bf16_f32 v123, 0, v123
    v_lshlrev_b32 v124, 16, v124
    v_mul_f32 v136, s7, v124
    v_exp_f32 v136, -v136
    s_nop 0
    v_add_f32 v136, 1.0, v136
    v_rcp_f32 v136, v136
    s_nop 0
    v_mul_f32 v124, v124, v136
    v_cvt_pk_bf16_f32 v124, 0, v124
    v_lshlrev_b32 v125, 16, v125
    v_mul_f32 v137, s7, v125
    v_exp_f32 v137, -v137
    s_nop 0
    v_add_f32 v137, 1.0, v137
    v_rcp_f32 v137, v137
    s_nop 0
    v_mul_f32 v125, v125, v137
    v_cvt_pk_bf16_f32 v125, 0, v125
    v_lshlrev_b32 v126, 16, v126
    v_mul_f32 v136, s7, v126
    v_exp_f32 v136, -v136
    s_nop 0
    v_add_f32 v136, 1.0, v136
    v_rcp_f32 v136, v136
    s_nop 0
    v_mul_f32 v126, v126, v136
    v_cvt_pk_bf16_f32 v126, 0, v126
    v_lshlrev_b32 v127, 16, v127
    v_mul_f32 v137, s7, v127
    v_exp_f32 v137, -v137
    s_nop 0
    v_add_f32 v137, 1.0, v137
    v_rcp_f32 v137, v137
    s_nop 0
    v_mul_f32 v127, v127, v137
    v_cvt_pk_bf16_f32 v127, 0, v127
    s_waitcnt lgkmcnt(0)
    s_load_dword s24, s[32:33], s92 offset:1024 glc
    s_load_dword s25, s[32:33], s92 offset:768 glc
    s_load_dword s26, s[32:33], s92 offset:1536 glc
    s_load_dword s27, s[32:33], s92 offset:1280 glc
    s_barrier
    s_add_u32 s96, s84, 9
    s_and_b32 s97, s96, 15
    s_mul_i32 s98, s97, 393216
    s_add_u32 s99, s98, s85
    s_add_u32 s82, s99, 4294772736
    s_add_u32 m0, s83, 20480
    s_nop 0
    buffer_load_dwordx4 v3, s[40:43], s82 offen lds
    s_add_u32 s96, s84, 9
    s_and_b32 s97, s96, 15
    s_mul_i32 s98, s97, 393216
    s_add_u32 s99, s98, s85
    s_add_u32 s82, s99, 2048
    s_add_u32 m0, s83, 24576
    s_nop 0
    buffer_load_dwordx4 v3, s[40:43], s82 offen lds
    s_add_u32 s96, s84, 9
    s_and_b32 s97, s96, 15
    s_mul_i32 s98, s97, 393216
    s_add_u32 s99, s98, s85
    s_add_u32 s82, s99, 4294770688
    s_add_u32 m0, s83, 118784
    s_nop 0
    buffer_load_dwordx4 v3, s[40:43], s82 offen lds
    s_add_u32 s96, s84, 9
    s_and_b32 s97, s96, 15
    s_mul_i32 s98, s97, 393216
    s_add_u32 s82, s98, s85
    s_add_u32 m0, s83, 122880
    s_nop 0
    buffer_load_dwordx4 v3, s[40:43], s82 offen lds
L_PAD5:
    s_cbranch_execz L_RET5
    s_add_u32 s96, s84, 9
    s_and_b32 s97, s96, 15
    s_mul_i32 s98, s97, 393216
    s_add_u32 s99, s98, s85
    s_add_u32 s82, s99, 4294774784
    s_add_u32 m0, s83, 69632
    s_nop 0
    buffer_load_dwordx4 v3, s[40:43], s82 offen lds
    s_add_u32 s96, s84, 9
    s_and_b32 s97, s96, 15
    s_mul_i32 s98, s97, 393216
    s_add_u32 s99, s98, s85
    s_add_u32 s82, s99, 4096
    s_add_u32 m0, s83, 73728
    s_nop 0
    buffer_load_dwordx4 v3, s[40:43], s82 offen lds
    s_waitcnt vmcnt(22)
    s_waitcnt vmcnt(20)
    s_waitcnt vmcnt(18)
    s_barrier
    s_add_u32 s96, s84, 10
    s_and_b32 s97, s96, 15
    s_mul_i32 s98, s97, 393216
    s_add_u32 s99, s98, s85
    s_add_u32 s82, s99, 4294772736
    s_add_u32 m0, s83, 28672
    s_nop 0
    buffer_load_dwordx4 v3, s[40:43], s82 offen lds
    s_add_u32 s96, s84, 10
    s_and_b32 s97, s96, 15
    s_mul_i32 s98, s97, 393216
    s_add_u32 s99, s98, s85
    s_add_u32 s82, s99, 2048
    s_add_u32 m0, s83, 32768
    s_nop 0
    buffer_load_dwordx4 v3, s[40:43], s82 offen lds
    s_add_u32 s96, s84, 10
    s_and_b32 s97, s96, 15
    s_mul_i32 s98, s97, 393216
    s_add_u32 s99, s98, s85
    s_add_u32 s82, s99, 4294774784
    s_add_u32 m0, s83, 77824
    s_nop 0
    buffer_load_dwordx4 v3, s[40:43], s82 offen lds
    s_add_u32 s96, s84, 10
    s_and_b32 s97, s96, 15
    s_mul_i32 s98, s97, 393216
    s_add_u32 s99, s98, s85
    s_add_u32 s82, s99, 4096
    s_add_u32 m0, s83, 81920
    s_nop 0
    buffer_load_dwordx4 v3, s[40:43], s82 offen lds
    s_waitcnt vmcnt(8)
    v_lshlrev_b32 v136, 16, v88
    v_and_b32 v137, s6, v88
    v_mul_f32 v128, v136, v120
    v_mul_f32 v129, v137, v120
    v_lshlrev_b32 v138, 16, v89
    v_and_b32 v139, s6, v89
    v_mul_f32 v130, v138, v120
    v_mul_f32 v131, v139, v120
    v_lshlrev_b32 v136, 16, v90
    v_and_b32 v137, s6, v90
    v_mul_f32 v132, v136, v120
    v_mul_f32 v133, v137, v120
    v_lshlrev_b32 v138, 16, v91
    v_and_b32 v139, s6, v91
    v_mul_f32 v134, v138, v120
    v_mul_f32 v135, v139, v120
    v_lshlrev_b32 v136, 16, v92
    v_and_b32 v137, s6, v92
    v_fmac_f32 v128, v136, v121
    v_fmac_f32 v129, v137, v121
    v_lshlrev_b32 v138, 16, v93
    v_and_b32 v139, s6, v93
    v_fmac_f32 v130, v138, v121
    v_fmac_f32 v131, v139, v121
    v_lshlrev_b32 v136, 16, v94
    v_and_b32 v137, s6, v94
    v_fmac_f32 v132, v136, v121
    v_fmac_f32 v133, v137, v121
    v_lshlrev_b32 v138, 16, v95
    v_and_b32 v139, s6, v95
    v_fmac_f32 v134, v138, v121
    v_fmac_f32 v135, v139, v121
    v_lshlrev_b32 v136, 16, v96
    v_and_b32 v137, s6, v96
    v_fmac_f32 v128, v136, v122
    v_fmac_f32 v129, v137, v122
    v_lshlrev_b32 v138, 16, v97
    v_and_b32 v139, s6, v97
    v_fmac_f32 v130, v138, v122
    v_fmac_f32 v131, v139, v122
    v_lshlrev_b32 v136, 16, v98
    v_and_b32 v137, s6, v98
    v_fmac_f32 v132, v136, v122
    v_fmac_f32 v133, v137, v122
    v_lshlrev_b32 v138, 16, v99
    v_and_b32 v139, s6, v99
    v_fmac_f32 v134, v138, v122
    v_fmac_f32 v135, v139, v122
    s_waitcnt lgkmcnt(0)
    s_load_dword s24, s[32:33], s92 offset:2560 glc
    s_load_dword s25, s[32:33], s92 offset:2304 glc
    s_load_dword s26, s[32:33], s92 offset:3072 glc
    s_load_dword s27, s[32:33], s92 offset:2816 glc
    s_barrier
    s_add_u32 s96, s84, 11
    s_and_b32 s97, s96, 15
    s_mul_i32 s98, s97, 393216
    s_add_u32 s99, s98, s85
    s_add_u32 s82, s99, 4294772736
    s_add_u32 m0, s83, 36864
    s_nop 0
    buffer_load_dwordx4 v3, s[40:43], s82 offen lds
    s_add_u32 s96, s84, 11
    s_and_b32 s97, s96, 15
    s_mul_i32 s98, s97, 393216
    s_add_u32 s99, s98, s85
    s_add_u32 s82, s99, 2048
    s_add_u32 m0, s83, 40960
    s_nop 0
    buffer_load_dwordx4 v3, s[40:43], s82 offen lds
    s_add_u32 s96, s84, 11
    s_and_b32 s97, s96, 15
    s_mul_i32 s98, s97, 393216
    s_add_u32 s99, s98, s85
    s_add_u32 s82, s99, 4294774784
    s_add_u32 m0, s83, 86016
    s_nop 0
    buffer_load_dwordx4 v3, s[40:43], s82 offen lds
    s_add_u32 s96, s84, 11
    s_and_b32 s97, s96, 15
    s_mul_i32 s98, s97, 393216
    s_add_u32 s99, s98, s85
    s_add_u32 s82, s99, 4096
    s_add_u32 m0, s83, 90112
    s_nop 0
    buffer_load_dwordx4 v3, s[40:43], s82 offen lds
    v_lshlrev_b32 v136, 16, v100
    v_and_b32 v137, s6, v100
    v_fmac_f32 v128, v136, v123
    v_fmac_f32 v129, v137, v123
    v_lshlrev_b32 v138, 16, v101
    v_and_b32 v139, s6, v101
    v_fmac_f32 v130, v138, v123
    v_fmac_f32 v131, v139, v123
    v_lshlrev_b32 v136, 16, v102
    v_and_b32 v137, s6, v102
    v_fmac_f32 v132, v136, v123
    v_fmac_f32 v133, v137, v123
    v_lshlrev_b32 v138, 16, v103
    v_and_b32 v139, s6, v103
    v_fmac_f32 v134, v138, v123
    v_fmac_f32 v135, v139, v123
    v_lshlrev_b32 v136, 16, v104
    v_and_b32 v137, s6, v104
    v_fmac_f32 v128, v136, v124
    v_fmac_f32 v129, v137, v124
    v_lshlrev_b32 v138, 16, v105
    v_and_b32 v139, s6, v105
    v_fmac_f32 v130, v138, v124
    v_fmac_f32 v131, v139, v124
    v_lshlrev_b32 v136, 16, v106
    v_and_b32 v137, s6, v106
    v_fmac_f32 v132, v136, v124
    v_fmac_f32 v133, v137, v124
    v_lshlrev_b32 v138, 16, v107
    v_and_b32 v139, s6, v107
    v_fmac_f32 v134, v138, v124
    v_fmac_f32 v135, v139, v124
    v_lshlrev_b32 v136, 16, v108
    v_and_b32 v137, s6, v108
    v_fmac_f32 v128, v136, v125
    v_fmac_f32 v129, v137, v125
    v_lshlrev_b32 v138, 16, v109
    v_and_b32 v139, s6, v109
    v_fmac_f32 v130, v138, v125
    v_fmac_f32 v131, v139, v125
    v_lshlrev_b32 v136, 16, v110
    v_and_b32 v137, s6, v110
    v_fmac_f32 v132, v136, v125
    v_fmac_f32 v133, v137, v125
    v_lshlrev_b32 v138, 16, v111
    v_and_b32 v139, s6, v111
    v_fmac_f32 v134, v138, v125
    v_fmac_f32 v135, v139, v125
    s_barrier
    s_add_u32 s96, s84, 12
    s_and_b32 s97, s96, 15
    s_mul_i32 s98, s97, 393216
    s_add_u32 s99, s98, s85
    s_add_u32 s82, s99, 4294772736
    s_add_u32 m0, s83, 4294963200
    s_nop 0
    buffer_load_dwordx4 v3, s[40:43], s82 offen lds
    s_add_u32 s96, s84, 12
    s_and_b32 s97, s96, 15
    s_mul_i32 s98, s97, 393216
    s_add_u32 s99, s98, s85
    s_add_u32 s82, s99, 2048
    s_mov_b32 m0, s83
    s_nop 0
    buffer_load_dwordx4 v3, s[40:43], s82 offen lds
    s_add_u32 s96, s84, 12
    s_and_b32 s97, s96, 15
    s_mul_i32 s98, s97, 393216
    s_add_u32 s99, s98, s85
    s_add_u32 s82, s99, 4294774784
    s_add_u32 m0, s83, 45056
    s_nop 0
    buffer_load_dwordx4 v3, s[40:43], s82 offen lds
    s_add_u32 s96, s84, 12
    s_and_b32 s97, s96, 15
    s_mul_i32 s98, s97, 393216
    s_add_u32 s99, s98, s85
    s_add_u32 s82, s99, 4096
    s_add_u32 m0, s83, 49152
    s_nop 0
    buffer_load_dwordx4 v3, s[40:43], s82 offen lds
    v_lshlrev_b32 v136, 16, v112
    v_and_b32 v137, s6, v112
    v_fmac_f32 v128, v136, v126
    v_fmac_f32 v129, v137, v126
    v_lshlrev_b32 v138, 16, v113
    v_and_b32 v139, s6, v113
    v_fmac_f32 v130, v138, v126
    v_fmac_f32 v131, v139, v126
    v_lshlrev_b32 v136, 16, v114
    v_and_b32 v137, s6, v114
    v_fmac_f32 v132, v136, v126
    v_fmac_f32 v133, v137, v126
    v_lshlrev_b32 v138, 16, v115
    v_and_b32 v139, s6, v115
    v_fmac_f32 v134, v138, v126
    v_fmac_f32 v135, v139, v126
    v_lshlrev_b32 v136, 16, v116
    v_and_b32 v137, s6, v116
    v_fmac_f32 v128, v136, v127
    v_fmac_f32 v129, v137, v127
    v_lshlrev_b32 v138, 16, v117
    v_and_b32 v139, s6, v117
    v_fmac_f32 v130, v138, v127
    v_fmac_f32 v131, v139, v127
    v_lshlrev_b32 v136, 16, v118
    v_and_b32 v137, s6, v118
    v_fmac_f32 v132, v136, v127
    v_fmac_f32 v133, v137, v127
    v_lshlrev_b32 v138, 16, v119
    v_and_b32 v139, s6, v119
    v_fmac_f32 v134, v138, v127
    v_fmac_f32 v135, v139, v127
    v_permlane32_swap_b32 v128, v132
    v_permlane32_swap_b32 v129, v133
    v_permlane32_swap_b32 v130, v134
    v_permlane32_swap_b32 v131, v135
    v_add_f32 v128, v128, v132
    v_add_f32 v129, v129, v133
    v_add_f32 v130, v130, v134
    v_add_f32 v131, v131, v135
    s_nop 0
    v_permlane16_swap_b32 v128, v130
    v_permlane16_swap_b32 v129, v131
    v_add_f32 v128, v128, v130
    v_add_f32 v129, v129, v131
    s_nop 0
    v_add_f32_dpp v128, v128, v128 row_ror:8 row_mask:0xf bank_mask:0xf
    v_add_f32_dpp v129, v129, v129 row_ror:8 row_mask:0xf bank_mask:0xf
    s_nop 1
    v_mov_b32_dpp v128, v129 quad_perm:[0,1,2,3] row_mask:0xf bank_mask:0xc
    ds_write_b32 v252, v128 offset:9984
    s_waitcnt lgkmcnt(0)
    s_barrier
    s_add_u32 s96, s84, 13
    s_and_b32 s97, s96, 15
    s_mul_i32 s98, s97, 393216
    s_add_u32 s99, s98, s85
    s_add_u32 s82, s99, 4294772736
    s_add_u32 m0, s83, 4096
    s_nop 0
    buffer_load_dwordx4 v3, s[40:43], s82 offen lds
    s_add_u32 s96, s84, 13
    s_and_b32 s97, s96, 15
    s_mul_i32 s98, s97, 393216
    s_add_u32 s99, s98, s85
    s_add_u32 s82, s99, 2048
    s_add_u32 m0, s83, 8192
    s_nop 0
    buffer_load_dwordx4 v3, s[40:43], s82 offen lds
    s_add_u32 s96, s84, 13
    s_and_b32 s97, s96, 15
    s_mul_i32 s98, s97, 393216
    s_add_u32 s99, s98, s85
    s_add_u32 s82, s99, 4294774784
    s_add_u32 m0, s83, 53248
    s_nop 0
    buffer_load_dwordx4 v3, s[40:43], s82 offen lds
    s_add_u32 s96, s84, 13
    s_and_b32 s97, s96, 15
    s_mul_i32 s98, s97, 393216
    s_add_u32 s99, s98, s85
    s_add_u32 s82, s99, 4096
    s_add_u32 m0, s83, 57344
    s_nop 0
    buffer_load_dwordx4 v3, s[40:43], s82 offen lds
    s_cmp_lg_u32 s3, 4
    s_cbranch_scc1 L_M2F
    ds_read_b128 v[128:131], v251 offset:10000
    s_lshr_b32 s96, s8, 2
    s_lshl1_add_u32 s97, s9, s96
    s_and_b32 s98, s8, 3
    s_lshl2_add_u32 s99, s97, s98
    s_lshl_b32 s96, s99, 9
    s_add_u32 s13, s96, 131072
    s_waitcnt lgkmcnt(0)
    v_add_f32 v128, v128, v129
    v_add_f32 v130, v130, v131
    v_mov_b32 v129, s4
    v_add_f32 v128, v128, v130
    buffer_store_dwordx2 v[128:129], v250, s[32:35], s13 offen sc1
L_M2F:
    s_lshl_b32 s96, s74, 13
    s_sub_u32 s97, s3, 4
    s_lshl_b32 s98, s97, 8
    s_add_u32 s99, s96, s98
    s_add_u32 s13, s99, 20971520
    s_waitcnt lgkmcnt(0)
    s_load_dword s24, s[32:33], s13 offset:1276 glc
    s_load_dword s25, s[32:33], s13 offset:3324 glc
    s_load_dword s26, s[32:33], s13 offset:5372 glc
    s_load_dword s27, s[32:33], s13 offset:7420 glc
    s_waitcnt vmcnt(18)
    s_waitcnt vmcnt(16)
    s_barrier
    s_add_u32 s96, s84, 14
    s_and_b32 s97, s96, 15
    s_mul_i32 s98, s97, 393216
    s_add_u32 s99, s98, s85
    s_add_u32 s82, s99, 4294772736
    s_add_u32 m0, s83, 12288
    s_nop 0
    buffer_load_dwordx4 v3, s[40:43], s82 offen lds
    s_add_u32 s96, s84, 14
    s_and_b32 s97, s96, 15
    s_mul_i32 s98, s97, 393216
    s_add_u32 s99, s98, s85
    s_add_u32 s82, s99, 2048
    s_add_u32 m0, s83, 16384
    s_nop 0
    buffer_load_dwordx4 v3, s[40:43], s82 offen lds
    s_waitcnt vmcnt(16)
    s_waitcnt vmcnt(12)
    s_barrier
    s_add_u32 s96, s84, 15
    s_and_b32 s97, s96, 15
    s_mul_i32 s98, s97, 393216
    s_add_u32 s99, s98, s85
    s_add_u32 s82, s99, 4294772736
    s_add_u32 m0, s83, 20480
    s_nop 0
    buffer_load_dwordx4 v3, s[40:43], s82 offen lds
    s_add_u32 s96, s84, 15
    s_and_b32 s97, s96, 15
    s_mul_i32 s98, s97, 393216
    s_add_u32 s99, s98, s85
    s_add_u32 s82, s99, 2048
    s_add_u32 m0, s83, 24576
    s_nop 0
    buffer_load_dwordx4 v3, s[40:43], s82 offen lds
    s_waitcnt vmcnt(10)
    s_waitcnt vmcnt(6)
    s_waitcnt vmcnt(2)
    s_barrier
    s_add_u32 s96, s84, 14
    s_and_b32 s97, s96, 15
    s_mul_i32 s98, s97, 393216
    s_add_u32 s99, s98, s85
    s_add_u32 s82, s99, 4294774784
    s_add_u32 m0, s83, 61440
    s_nop 0
    buffer_load_dwordx4 v3, s[40:43], s82 offen lds
    s_add_u32 s96, s84, 14
    s_and_b32 s97, s96, 15
    s_mul_i32 s98, s97, 393216
    s_add_u32 s99, s98, s85
    s_add_u32 s82, s99, 4096
    s_add_u32 m0, s83, 65536
    s_nop 0
    buffer_load_dwordx4 v3, s[40:43], s82 offen lds
    s_add_u32 s96, s84, 15
    s_and_b32 s97, s96, 15
    s_mul_i32 s98, s97, 393216
    s_add_u32 s99, s98, s85
    s_add_u32 s82, s99, 4294774784
    s_add_u32 m0, s83, 69632
    s_nop 0
    buffer_load_dwordx4 v3, s[40:43], s82 offen lds
    s_add_u32 s96, s84, 15
    s_and_b32 s97, s96, 15
    s_mul_i32 s98, s97, 393216
    s_add_u32 s99, s98, s85
    s_add_u32 s82, s99, 4096
    s_add_u32 m0, s83, 73728
    s_nop 0
    buffer_load_dwordx4 v3, s[40:43], s82 offen lds
    s_waitcnt vmcnt(4)
    s_barrier
    s_add_u32 s96, s84, 10
    s_and_b32 s97, s96, 15
    s_mul_i32 s98, s97, 393216
    s_add_u32 s99, s98, s85
    s_add_u32 s82, s99, 4294770688
    s_add_u32 m0, s83, 126976
    s_nop 0
    buffer_load_dwordx4 v3, s[40:43], s82 offen lds
    s_add_u32 s96, s84, 10
    s_and_b32 s97, s96, 15
    s_mul_i32 s98, s97, 393216
    s_add_u32 s82, s98, s85
    s_add_u32 m0, s83, 131072
    s_nop 0
    buffer_load_dwordx4 v3, s[40:43], s82 offen lds
    s_add_u32 s96, s84, 11
    s_and_b32 s97, s96, 15
    s_mul_i32 s98, s97, 393216
    s_add_u32 s99, s98, s85
    s_add_u32 s82, s99, 4294770688
    s_add_u32 m0, s83, 135168
    s_nop 0
    buffer_load_dwordx4 v3, s[40:43], s82 offen lds
    s_add_u32 s96, s84, 11
    s_and_b32 s97, s96, 15
    s_mul_i32 s98, s97, 393216
    s_add_u32 s82, s98, s85
    s_add_u32 m0, s83, 139264
    s_nop 0
    buffer_load_dwordx4 v3, s[40:43], s82 offen lds
    s_waitcnt lgkmcnt(0)
    s_barrier
    s_add_u32 s96, s84, 12
    s_and_b32 s97, s96, 15
    s_mul_i32 s98, s97, 393216
    s_add_u32 s99, s98, s85
    s_add_u32 s82, s99, 4294770688
    s_add_u32 m0, s83, 94208
    s_nop 0
    buffer_load_dwordx4 v3, s[40:43], s82 offen lds
    s_add_u32 s96, s84, 12
    s_and_b32 s97, s96, 15
    s_mul_i32 s98, s97, 393216
    s_add_u32 s82, s98, s85
    s_add_u32 m0, s83, 98304
    s_nop 0
    buffer_load_dwordx4 v3, s[40:43], s82 offen lds
    s_add_u32 s96, s84, 13
    s_and_b32 s97, s96, 15
    s_mul_i32 s98, s97, 393216
    s_add_u32 s99, s98, s85
    s_add_u32 s82, s99, 4294770688
    s_add_u32 m0, s83, 102400
    s_nop 0
    buffer_load_dwordx4 v3, s[40:43], s82 offen lds
    s_add_u32 s96, s84, 13
    s_and_b32 s97, s96, 15
    s_mul_i32 s98, s97, 393216
    s_add_u32 s82, s98, s85
    s_add_u32 m0, s83, 106496
    s_nop 0
    buffer_load_dwordx4 v3, s[40:43], s82 offen lds
    s_setprio 3
    ds_read_b128 v[152:155], v0
    ds_read_b128 v[156:159], v0 offset:1024
    v_subrev_u32 v0, 118784, v0
    s_waitcnt lgkmcnt(1)
    v_mfma_f32_32x32x16_bf16 v[184:199], v[168:171], v[152:155], 0
    s_waitcnt lgkmcnt(0)
    v_mfma_f32_32x32x16_bf16 v[184:199], v[172:175], v[156:159], v[184:199]
    s_setprio 0
    s_nop 10
    v_cvt_pk_bf16_f32 v184, 0, v184
    v_cvt_pk_bf16_f32 v185, 0, v185
    v_cvt_pk_bf16_f32 v186, 0, v186
    v_cvt_pk_bf16_f32 v187, 0, v187
    v_cvt_pk_bf16_f32 v188, 0, v188
    v_cvt_pk_bf16_f32 v189, 0, v189
    v_cvt_pk_bf16_f32 v190, 0, v190
    v_cvt_pk_bf16_f32 v191, 0, v191
    v_cvt_pk_bf16_f32 v192, 0, v192
    v_cvt_pk_bf16_f32 v193, 0, v193
    v_cvt_pk_bf16_f32 v194, 0, v194
    v_cvt_pk_bf16_f32 v195, 0, v195
    v_cvt_pk_bf16_f32 v196, 0, v196
    v_cvt_pk_bf16_f32 v197, 0, v197
    v_cvt_pk_bf16_f32 v198, 0, v198
    v_cvt_pk_bf16_f32 v199, 0, v199
    v_max3_f32 v4, v184, v185, v186
    v_min3_f32 v5, v184, v185, v186
    v_max3_f32 v4, v4, v187, v188
    v_min3_f32 v5, v5, v187, v188
    v_max3_f32 v4, v4, v189, v190
    v_min3_f32 v5, v5, v189, v190
    v_max3_f32 v4, v4, v191, v192
    v_min3_f32 v5, v5, v191, v192
    v_max3_f32 v4, v4, v193, v194
    v_min3_f32 v5, v5, v193, v194
    v_max3_f32 v4, v4, v195, v196
    v_min3_f32 v5, v5, v195, v196
    v_max3_f32 v4, v4, v197, v198
    v_min3_f32 v5, v5, v197, v198
    v_max_f32 v6, v4, v199
    v_min_f32 v7, v5, v199
    v_max_f32 v4, v4, v199
    v_min_f32 v5, v5, v199
    s_nop 0
    v_permlane32_swap_b32 v4, v6
    v_permlane32_swap_b32 v5, v7
    v_max_f32 v4, v4, v6
    v_min_f32 v5, v5, v7
    v_mul_f32_e64 v4, v4, s7
    v_mul_f32_e64 v5, v5, s7
    v_fma_f32 v216, v184, s7, -v4
    v_fma_f32 v217, v185, s7, -v4
    v_fma_f32 v184, -v184, s7, v5
    v_fma_f32 v185, -v185, s7, v5
    v_fma_f32 v218, v186, s7, -v4
    v_fma_f32 v219, v187, s7, -v4
    v_fma_f32 v186, -v186, s7, v5
    v_fma_f32 v187, -v187, s7, v5
    s_waitcnt vmcnt(10)
    s_waitcnt vmcnt(8)
    s_waitcnt vmcnt(6)
    s_barrier
    s_add_u32 s96, s84, 14
    s_and_b32 s97, s96, 15
    s_mul_i32 s98, s97, 393216
    s_add_u32 s99, s98, s85
    s_add_u32 s82, s99, 4294770688
    s_add_u32 m0, s83, 110592
    s_nop 0
    buffer_load_dwordx4 v3, s[40:43], s82 offen lds
    s_add_u32 s96, s84, 14
    s_and_b32 s97, s96, 15
    s_mul_i32 s98, s97, 393216
    s_add_u32 s82, s98, s85
    s_add_u32 m0, s83, 114688
    s_nop 0
    buffer_load_dwordx4 v3, s[40:43], s82 offen lds
    s_add_u32 s96, s84, 15
    s_and_b32 s97, s96, 15
    s_mul_i32 s98, s97, 393216
    s_add_u32 s99, s98, s85
    s_add_u32 s82, s99, 4294770688
    s_add_u32 m0, s83, 118784
    s_nop 0
    buffer_load_dwordx4 v3, s[40:43], s82 offen lds
    s_add_u32 s96, s84, 15
    s_and_b32 s97, s96, 15
    s_mul_i32 s98, s97, 393216
    s_add_u32 s82, s98, s85
    s_add_u32 m0, s83, 122880
    s_nop 0
    buffer_load_dwordx4 v3, s[40:43], s82 offen lds
    s_setprio 3
    ds_read_b128 v[152:155], v0
    ds_read_b128 v[156:159], v0 offset:1024
    s_waitcnt lgkmcnt(1)
    v_mfma_f32_32x32x16_bf16 v[200:215], v[176:179], v[152:155], 0
    s_waitcnt lgkmcnt(0)
    v_mfma_f32_32x32x16_bf16 v[200:215], v[180:183], v[156:159], v[200:215]
    s_setprio 0
    v_fma_f32 v220, v188, s7, -v4
    v_fma_f32 v221, v189, s7, -v4
    v_fma_f32 v188, -v188, s7, v5
    v_fma_f32 v189, -v189, s7, v5
    v_fma_f32 v222, v190, s7, -v4
    s_mov_b32 s82, s80
    buffer_load_dwordx4 v[56:59], v27, s[52:55], s82 offen nt
    v_fma_f32 v223, v191, s7, -v4
    v_fma_f32 v190, -v190, s7, v5
    v_fma_f32 v191, -v191, s7, v5
    v_fma_f32 v224, v192, s7, -v4
    v_fma_f32 v225, v193, s7, -v4
    v_fma_f32 v192, -v192, s7, v5
    v_fma_f32 v193, -v193, s7, v5
    v_fma_f32 v226, v194, s7, -v4
    v_fma_f32 v227, v195, s7, -v4
    v_fma_f32 v194, -v194, s7, v5
    v_fma_f32 v195, -v195, s7, v5
    v_fma_f32 v228, v196, s7, -v4
    v_fma_f32 v229, v197, s7, -v4
    v_fma_f32 v196, -v196, s7, v5
    v_fma_f32 v197, -v197, s7, v5
    v_fma_f32 v230, v198, s7, -v4
    v_fma_f32 v231, v199, s7, -v4
    v_fma_f32 v198, -v198, s7, v5
    v_fma_f32 v199, -v199, s7, v5
    v_exp_f32 v216, v216
    v_exp_f32 v184, v184
    v_exp_f32 v217, v217
    v_exp_f32 v185, v185
    v_exp_f32 v218, v218
    v_exp_f32 v186, v186
    v_exp_f32 v219, v219
    v_exp_f32 v187, v187
    v_exp_f32 v220, v220
    v_exp_f32 v188, v188
    v_exp_f32 v221, v221
    v_exp_f32 v189, v189
    v_exp_f32 v222, v222
    v_exp_f32 v190, v190
    v_exp_f32 v223, v223
    v_exp_f32 v191, v191
    v_exp_f32 v224, v224
    v_exp_f32 v192, v192
    v_exp_f32 v225, v225
    v_exp_f32 v193, v193
    v_exp_f32 v226, v226
    s_add_u32 s82, s80, 4294049792
    buffer_load_dwordx4 v[60:63], v27, s[52:55], s82 offen nt
    v_exp_f32 v194, v194
    v_exp_f32 v227, v227
    v_exp_f32 v195, v195
    v_exp_f32 v228, v228
    v_exp_f32 v196, v196
    v_exp_f32 v229, v229
    v_exp_f32 v197, v197
    v_exp_f32 v230, v230
    v_exp_f32 v198, v198
    v_exp_f32 v231, v231
    v_exp_f32 v199, v199
    v_add_f32 v8, v216, v218
    v_add_f32 v9, v217, v219
    v_add_f32 v10, v184, v186
    v_add_f32 v11, v185, v187
    v_add_f32 v8, v8, v220
    v_add_f32 v9, v9, v221
    v_add_f32 v10, v10, v188
    v_add_f32 v11, v11, v189
    v_add_f32 v8, v8, v222
    v_add_f32 v9, v9, v223
    v_add_f32 v10, v10, v190
    v_add_f32 v11, v11, v191
    v_add_f32 v8, v8, v224
    v_add_f32 v9, v9, v225
    v_add_f32 v10, v10, v192
    v_add_f32 v11, v11, v193
    v_add_f32 v8, v8, v226
    v_add_f32 v9, v9, v227
    v_add_f32 v10, v10, v194
    v_add_f32 v11, v11, v195
    v_add_f32 v8, v8, v228
    v_add_f32 v9, v9, v229
    v_add_f32 v10, v10, v196
    v_add_f32 v11, v11, v197
    v_add_f32 v8, v8, v230
    v_add_f32 v9, v9, v231
    v_add_f32 v10, v10, v198
    v_add_f32 v11, v11, v199
    v_add_f32 v6, v8, v9
    s_add_u32 s82, s80, 57344
    buffer_load_dwordx4 v[64:67], v27, s[52:55], s82 offen nt
    v_add_f32 v7, v10, v11
    v_add_f32 v4, v8, v9
    v_add_f32 v5, v10, v11
    s_nop 0
    v_permlane32_swap_b32 v4, v6
    v_permlane32_swap_b32 v5, v7
    v_add_f32 v4, v4, v6
    v_add_f32 v5, v5, v7
    v_rcp_f32 v4, v4
    v_rcp_f32 v5, v5
    v_mul_f32 v216, v216, v4
    v_mul_f32 v217, v217, v4
    v_mul_f32 v184, v184, v5
    v_mul_f32 v185, v185, v5
    v_mul_f32 v218, v218, v4
    v_mul_f32 v219, v219, v4
    v_mul_f32 v186, v186, v5
    v_mul_f32 v187, v187, v5
    v_mul_f32 v220, v220, v4
    v_mul_f32 v221, v221, v4
    v_mul_f32 v188, v188, v5
    v_mul_f32 v189, v189, v5
    v_mul_f32 v222, v222, v4
    v_mul_f32 v223, v223, v4
    v_mul_f32 v190, v190, v5
    v_mul_f32 v191, v191, v5
    v_mul_f32 v224, v224, v4
    v_mul_f32 v225, v225, v4
    v_mul_f32 v192, v192, v5
    v_mul_f32 v193, v193, v5
    v_mul_f32 v226, v226, v4
    v_mul_f32 v227, v227, v4
    v_mul_f32 v194, v194, v5
    v_mul_f32 v195, v195, v5
    v_mul_f32 v228, v228, v4
    v_mul_f32 v229, v229, v4
    v_mul_f32 v196, v196, v5
    v_mul_f32 v197, v197, v5
    v_mul_f32 v230, v230, v4
    v_mul_f32 v231, v231, v4
    v_mul_f32 v198, v198, v5
    s_add_u32 s82, s80, 4294107136
    buffer_load_dwordx4 v[68:71], v27, s[52:55], s82 offen nt
    v_mul_f32 v199, v199, v5
    v_cvt_pk_bf16_f32 v216, v216, v217
    v_cvt_pk_bf16_f32 v217, v218, v219
    v_cvt_pk_bf16_f32 v218, v220, v221
    v_cvt_pk_bf16_f32 v219, v222, v223
    v_cvt_pk_bf16_f32 v220, v224, v225
    v_cvt_pk_bf16_f32 v221, v226, v227
    v_cvt_pk_bf16_f32 v222, v228, v229
    v_cvt_pk_bf16_f32 v223, v230, v231
    ds_write_b128 v232, v[216:219]
    v_cvt_pk_bf16_f32 v224, v184, v185
    v_cvt_pk_bf16_f32 v225, v186, v187
    v_cvt_pk_bf16_f32 v226, v188, v189
    v_cvt_pk_bf16_f32 v227, v190, v191
    ds_write_b128 v232, v[220:223] offset:4096
    ds_write_b128 v232, v[224:227] offset:8192
    v_cvt_pk_bf16_f32 v228, v192, v193
    v_cvt_pk_bf16_f32 v229, v194, v195
    v_cvt_pk_bf16_f32 v230, v196, v197
    v_cvt_pk_bf16_f32 v231, v198, v199
    ds_write_b128 v232, v[228:231] offset:12288
    s_waitcnt vmcnt(12)
    s_waitcnt vmcnt(10)
    s_waitcnt vmcnt(8)
    s_waitcnt vmcnt(6)
    s_waitcnt vmcnt(4)
    s_barrier
    v_cvt_pk_bf16_f32 v200, 0, v200
    v_cvt_pk_bf16_f32 v201, 0, v201
    v_cvt_pk_bf16_f32 v202, 0, v202
    v_cvt_pk_bf16_f32 v203, 0, v203
    s_xor_b32 s96, s95, 786432
    s_add_u32 s97, s96, s90
    s_sub_u32 s82, s97, 65536
    s_add_u32 m0, s83, 45056
    s_nop 0
    buffer_load_dwordx4 v26, s[44:47], s82 offen lds
    v_cvt_pk_bf16_f32 v204, 0, v204
    v_cvt_pk_bf16_f32 v205, 0, v205
    v_cvt_pk_bf16_f32 v206, 0, v206
    v_cvt_pk_bf16_f32 v207, 0, v207
    v_cvt_pk_bf16_f32 v208, 0, v208
    v_cvt_pk_bf16_f32 v209, 0, v209
    v_cvt_pk_bf16_f32 v210, 0, v210
L_PAD6:
    s_cbranch_execz L_RET6
    v_cvt_pk_bf16_f32 v211, 0, v211
    v_cvt_pk_bf16_f32 v212, 0, v212
    v_cvt_pk_bf16_f32 v213, 0, v213
    v_cvt_pk_bf16_f32 v214, 0, v214
    v_cvt_pk_bf16_f32 v215, 0, v215
    v_max3_f32 v4, v200, v201, v202
    v_min3_f32 v5, v200, v201, v202
    s_xor_b32 s96, s95, 786432
    s_add_u32 s82, s96, s90
    s_add_u32 m0, s83, 49152
    s_nop 0
    buffer_load_dwordx4 v26, s[44:47], s82 offen lds
    v_max3_f32 v4, v4, v203, v204
    v_min3_f32 v5, v5, v203, v204
    v_max3_f32 v4, v4, v205, v206
    v_min3_f32 v5, v5, v205, v206
    v_max3_f32 v4, v4, v207, v208
    v_min3_f32 v5, v5, v207, v208
    v_max3_f32 v4, v4, v209, v210
    v_min3_f32 v5, v5, v209, v210
    v_max3_f32 v4, v4, v211, v212
    v_min3_f32 v5, v5, v211, v212
    v_max3_f32 v4, v4, v213, v214
    v_min3_f32 v5, v5, v213, v214
    v_max_f32 v6, v4, v215
    v_min_f32 v7, v5, v215
    s_xor_b32 s96, s95, 917504
    s_add_u32 s97, s96, s90
    s_sub_u32 s82, s97, 65536
    s_add_u32 m0, s83, 53248
    s_nop 0
    buffer_load_dwordx4 v26, s[44:47], s82 offen lds
    v_max_f32 v4, v4, v215
    s_waitcnt lgkmcnt(0)
    v_min_f32 v5, v5, v215
    v_permlane32_swap_b32 v4, v6
    s_nop 0
    v_permlane32_swap_b32 v5, v7
    v_max_f32 v4, v4, v6
    v_min_f32 v5, v5, v7
    v_mul_f32_e64 v4, v4, s7
    v_mul_f32_e64 v5, v5, s7
    v_fma_f32 v216, v200, s7, -v4
    v_fma_f32 v217, v201, s7, -v4
    v_fma_f32 v200, -v200, s7, v5
    v_fma_f32 v201, -v201, s7, v5
    v_fma_f32 v218, v202, s7, -v4
    s_xor_b32 s96, s95, 917504
    s_add_u32 s82, s96, s90
    s_add_u32 m0, s83, 57344
    s_nop 0
    buffer_load_dwordx4 v26, s[44:47], s82 offen lds
    v_fma_f32 v219, v203, s7, -v4
    v_fma_f32 v202, -v202, s7, v5
    v_fma_f32 v203, -v203, s7, v5
    v_fma_f32 v220, v204, s7, -v4
    v_fma_f32 v221, v205, s7, -v4
    v_fma_f32 v204, -v204, s7, v5
    v_fma_f32 v205, -v205, s7, v5
    v_fma_f32 v222, v206, s7, -v4
    v_fma_f32 v223, v207, s7, -v4
    v_fma_f32 v206, -v206, s7, v5
    v_fma_f32 v207, -v207, s7, v5
    v_fma_f32 v224, v208, s7, -v4
    v_fma_f32 v225, v209, s7, -v4
    v_fma_f32 v208, -v208, s7, v5
    s_xor_b32 s96, s95, 1048576
    s_add_u32 s97, s96, s90
    s_sub_u32 s82, s97, 65536
    s_add_u32 m0, s83, 61440
    s_nop 0
    buffer_load_dwordx4 v26, s[44:47], s82 offen lds
    v_fma_f32 v209, -v209, s7, v5
    v_fma_f32 v226, v210, s7, -v4
    v_fma_f32 v227, v211, s7, -v4
    v_fma_f32 v210, -v210, s7, v5
    v_fma_f32 v211, -v211, s7, v5
    v_fma_f32 v228, v212, s7, -v4
    v_fma_f32 v229, v213, s7, -v4
    v_fma_f32 v212, -v212, s7, v5
    v_fma_f32 v213, -v213, s7, v5
    v_fma_f32 v230, v214, s7, -v4
    v_fma_f32 v231, v215, s7, -v4
    v_fma_f32 v214, -v214, s7, v5
    v_fma_f32 v215, -v215, s7, v5
    v_exp_f32 v216, v216
    s_xor_b32 s96, s95, 1048576
    s_add_u32 s82, s96, s90
    s_add_u32 m0, s83, 65536
    s_nop 0
    buffer_load_dwordx4 v26, s[44:47], s82 offen lds
    v_exp_f32 v200, v200
    v_exp_f32 v217, v217
    v_exp_f32 v201, v201
    v_exp_f32 v218, v218
    v_exp_f32 v202, v202
    v_exp_f32 v219, v219
    v_exp_f32 v203, v203
    v_exp_f32 v220, v220
    v_exp_f32 v204, v204
    v_exp_f32 v221, v221
    v_exp_f32 v205, v205
    v_exp_f32 v222, v222
    v_exp_f32 v206, v206
    v_exp_f32 v223, v223
    s_xor_b32 s96, s95, 1179648
    s_add_u32 s97, s96, s90
    s_sub_u32 s82, s97, 65536
    s_add_u32 m0, s83, 69632
    s_nop 0
    buffer_load_dwordx4 v26, s[44:47], s82 offen lds
    v_exp_f32 v207, v207
    v_exp_f32 v224, v224
    v_exp_f32 v208, v208
    v_exp_f32 v225, v225
    v_exp_f32 v209, v209
    v_exp_f32 v226, v226
    v_exp_f32 v210, v210
    v_exp_f32 v227, v227
    v_exp_f32 v211, v211
    v_exp_f32 v228, v228
    v_exp_f32 v212, v212
    v_exp_f32 v229, v229
    v_exp_f32 v213, v213
    v_exp_f32 v230, v230
    s_xor_b32 s96, s95, 1179648
    s_add_u32 s82, s96, s90
    s_add_u32 m0, s83, 73728
    s_nop 0
    buffer_load_dwordx4 v26, s[44:47], s82 offen lds
    v_exp_f32 v214, v214
    v_exp_f32 v231, v231
    v_exp_f32 v215, v215
    v_add_f32 v8, v216, v218
    v_add_f32 v9, v217, v219
    v_add_f32 v10, v200, v202
    v_add_f32 v11, v201, v203
    v_add_f32 v8, v8, v220
    v_add_f32 v9, v9, v221
    v_add_f32 v10, v10, v204
    v_add_f32 v11, v11, v205
    v_add_f32 v8, v8, v222
    v_add_f32 v9, v9, v223
    v_add_f32 v10, v10, v206
    s_add_u32 s82, s80, 114688
    buffer_load_dwordx4 v[72:75], v27, s[52:55], s82 offen nt
    v_add_f32 v11, v11, v207
    v_add_f32 v8, v8, v224
    v_add_f32 v9, v9, v225
    v_add_f32 v10, v10, v208
    v_add_f32 v11, v11, v209
    v_add_f32 v8, v8, v226
    v_add_f32 v9, v9, v227
    v_add_f32 v10, v10, v210
    v_add_f32 v11, v11, v211
    v_add_f32 v8, v8, v228
    v_add_f32 v9, v9, v229
    v_add_f32 v10, v10, v212
    v_add_f32 v11, v11, v213
    v_add_f32 v8, v8, v230
    s_add_u32 s82, s80, 4294164480
    buffer_load_dwordx4 v[76:79], v27, s[52:55], s82 offen nt
    v_add_f32 v9, v9, v231
    v_add_f32 v10, v10, v214
    v_add_f32 v11, v11, v215
    v_add_f32 v6, v8, v9
    v_add_f32 v7, v10, v11
    v_add_f32 v4, v8, v9
    v_add_f32 v5, v10, v11
    s_nop 0
    v_permlane32_swap_b32 v4, v6
    v_permlane32_swap_b32 v5, v7
    v_add_f32 v4, v4, v6
    v_add_f32 v5, v5, v7
    v_rcp_f32 v4, v4
    v_rcp_f32 v5, v5
    v_mul_f32 v216, v216, v4
    s_add_u32 s82, s80, 172032
    buffer_load_dwordx4 v[80:83], v27, s[52:55], s82 offen nt
    v_mul_f32 v217, v217, v4
    v_mul_f32 v200, v200, v5
    v_mul_f32 v201, v201, v5
    v_mul_f32 v218, v218, v4
    v_mul_f32 v219, v219, v4
    v_mul_f32 v202, v202, v5
    v_mul_f32 v203, v203, v5
    v_mul_f32 v220, v220, v4
    v_mul_f32 v221, v221, v4
    v_mul_f32 v204, v204, v5
    v_mul_f32 v205, v205, v5
    v_mul_f32 v222, v222, v4
    v_mul_f32 v223, v223, v4
    v_mul_f32 v206, v206, v5
    s_add_u32 s82, s80, 4294221824
    buffer_load_dwordx4 v[84:87], v27, s[52:55], s82 offen nt
    v_mul_f32 v207, v207, v5
    v_mul_f32 v224, v224, v4
    v_mul_f32 v225, v225, v4
    v_mul_f32 v208, v208, v5
    v_mul_f32 v209, v209, v5
    v_mul_f32 v226, v226, v4
    v_mul_f32 v227, v227, v4
    v_mul_f32 v210, v210, v5
    v_mul_f32 v211, v211, v5
    v_mul_f32 v228, v228, v4
    v_mul_f32 v229, v229, v4
    v_mul_f32 v212, v212, v5
    v_mul_f32 v213, v213, v5
    v_mul_f32 v230, v230, v4
    s_xor_b32 s96, s95, 1310720
    s_add_u32 s97, s96, s90
    s_sub_u32 s82, s97, 65536
    s_add_u32 m0, s83, 77824
    s_nop 0
    buffer_load_dwordx4 v26, s[44:47], s82 offen lds
    v_mul_f32 v231, v231, v4
    v_mul_f32 v214, v214, v5
    v_mul_f32 v215, v215, v5
    v_cvt_pk_bf16_f32 v216, v216, v217
    v_cvt_pk_bf16_f32 v217, v218, v219
    v_cvt_pk_bf16_f32 v218, v220, v221
    v_cvt_pk_bf16_f32 v219, v222, v223
    v_cvt_pk_bf16_f32 v220, v224, v225
    v_cvt_pk_bf16_f32 v221, v226, v227
    v_cvt_pk_bf16_f32 v222, v228, v229
    v_cvt_pk_bf16_f32 v223, v230, v231
    ds_write_b128 v232, v[216:219] offset:16384
    v_cvt_pk_bf16_f32 v224, v200, v201
    v_cvt_pk_bf16_f32 v225, v202, v203
    s_xor_b32 s96, s95, 1310720
    s_add_u32 s82, s96, s90
    s_add_u32 m0, s83, 81920
    s_nop 0
    buffer_load_dwordx4 v26, s[44:47], s82 offen lds
    v_cvt_pk_bf16_f32 v226, v204, v205
    v_cvt_pk_bf16_f32 v227, v206, v207
    ds_write_b128 v232, v[220:223] offset:20480
    ds_write_b128 v232, v[224:227] offset:24576
    v_cvt_pk_bf16_f32 v228, v208, v209
    v_cvt_pk_bf16_f32 v229, v210, v211
    v_cvt_pk_bf16_f32 v230, v212, v213
    v_cvt_pk_bf16_f32 v231, v214, v215
    ds_write_b128 v232, v[228:231] offset:28672
    s_xor_b32 s96, s95, 1441792
    s_add_u32 s97, s96, s90
    s_sub_u32 s82, s97, 65536
    s_add_u32 m0, s83, 86016
    s_nop 0
    buffer_load_dwordx4 v26, s[44:47], s82 offen lds
    s_xor_b32 s96, s95, 1441792
    s_add_u32 s82, s96, s90
    s_add_u32 m0, s83, 90112
    s_nop 0
    buffer_load_dwordx4 v26, s[44:47], s82 offen lds
    s_lshl_b32 s96, s77, 11
    s_add_u32 s14, s96, 151552
    v_add_u32 v0, s14, v2
    s_setprio 0
L_JOIN:
    v_and_b32 v45, 1, v1
    v_lshlrev_b32 v45, 3, v45
    v_bfe_u32 v9, v1, 2, 2
    v_lshl_add_u32 v45, v9, 4, v45
    v_bfe_u32 v9, v1, 4, 1
    v_lshl_add_u32 v45, v9, 6, v45
    v_bfe_u32 v9, v1, 1, 1
    v_lshl_add_u32 v45, v9, 7, v45
    v_lshrrev_b32 v9, 5, v1
    v_lshl_add_u32 v45, v9, 8, v45
    s_lshl_b32 s13, s3, 12
    v_add_u32 v44, s13, v45
    s_lshl_b32 s96, s76, 13
    s_add_u32 s13, s96, 32768
    v_add_u32 v45, s13, v45
    v_mov_b32 v244, 0x3f803f80
    v_mov_b32 v245, 0x3f803f80
    v_mov_b32 v246, 0x3f803f80
    v_mov_b32 v247, 0x3f803f80
    s_lshl3_add_u32 s96, s11, s3
    s_lshl_b32 s97, s96, 5
    s_add_u32 s98, s97, s10
    s_lshl_b32 s99, s98, 10
    s_add_u32 s13, s99, 25165824
    s_add_u32 s15, s13, 16384
    s_lshl3_add_u32 s96, s11, s3
    s_lshl_b32 s97, s96, 10
    s_add_u32 s16, s97, 21495808
    s_lshl_b32 s96, s10, 6
    s_add_u32 s14, s96, s16
    s_waitcnt lgkmcnt(0)
    s_barrier
    ds_read_b64_tr_b16 v[184:185], v44
    ds_read_b64_tr_b16 v[186:187], v44 offset:512
    ds_read_b64_tr_b16 v[200:201], v45
    ds_read_b64_tr_b16 v[202:203], v45 offset:512
    ds_read_b64_tr_b16 v[204:205], v45 offset:1024
    ds_read_b64_tr_b16 v[206:207], v45 offset:1536
    ds_read_b64_tr_b16 v[188:189], v44 offset:1024
    ds_read_b64_tr_b16 v[190:191], v44 offset:1536
    ds_read_b64_tr_b16 v[208:209], v45 offset:2048
    ds_read_b64_tr_b16 v[210:211], v45 offset:2560
    ds_read_b64_tr_b16 v[212:213], v45 offset:3072
    ds_read_b64_tr_b16 v[214:215], v45 offset:3584
    ds_read_b64_tr_b16 v[192:193], v44 offset:2048
    ds_read_b64_tr_b16 v[194:195], v44 offset:2560
    ds_read_b64_tr_b16 v[216:217], v45 offset:4096
    ds_read_b64_tr_b16 v[218:219], v45 offset:4608
    ds_read_b64_tr_b16 v[220:221], v45 offset:5120
    ds_read_b64_tr_b16 v[222:223], v45 offset:5632
    s_waitcnt lgkmcnt(12)
    v_mfma_f32_16x16x32_bf16 v[232:235], v[184:187], v[200:203], 0
    v_mfma_f32_16x16x32_bf16 v[236:239], v[184:187], v[204:207], 0
    v_mfma_f32_16x16x32_bf16 v[240:243], v[184:187], v[244:247], 0
    ds_read_b64_tr_b16 v[196:197], v44 offset:3072
    ds_read_b64_tr_b16 v[198:199], v44 offset:3584
    ds_read_b64_tr_b16 v[224:225], v45 offset:6144
    ds_read_b64_tr_b16 v[226:227], v45 offset:6656
    ds_read_b64_tr_b16 v[228:229], v45 offset:7168
    ds_read_b64_tr_b16 v[230:231], v45 offset:7680
    s_waitcnt lgkmcnt(12)
    v_mfma_f32_16x16x32_bf16 v[232:235], v[188:191], v[208:211], v[232:235]
    v_mfma_f32_16x16x32_bf16 v[236:239], v[188:191], v[212:215], v[236:239]
    v_mfma_f32_16x16x32_bf16 v[240:243], v[188:191], v[244:247], v[240:243]
    s_waitcnt lgkmcnt(6)
    v_mfma_f32_16x16x32_bf16 v[232:235], v[192:195], v[216:219], v[232:235]
    v_mfma_f32_16x16x32_bf16 v[236:239], v[192:195], v[220:223], v[236:239]
    v_mfma_f32_16x16x32_bf16 v[240:243], v[192:195], v[244:247], v[240:243]
    s_waitcnt lgkmcnt(0)
    v_mfma_f32_16x16x32_bf16 v[232:235], v[196:199], v[224:227], v[232:235]
    v_mfma_f32_16x16x32_bf16 v[236:239], v[196:199], v[228:231], v[236:239]
    v_mfma_f32_16x16x32_bf16 v[240:243], v[196:199], v[244:247], v[240:243]
    s_cmp_lt_u32 s3, 4
    s_cbranch_scc1 L_NOQX
    ds_read_b128 v[168:171], v0
    ds_read_b128 v[172:175], v0 offset:1024
L_NOQX:
    s_nop 3
    buffer_store_dwordx4 v[232:235], v2, s[32:35], s13 offen sc1
    buffer_store_dwordx4 v[236:239], v2, s[32:35], s15 offen sc1
    s_mov_b32 exec_lo, 0x00010001
    s_mov_b32 exec_hi, 0x00010001
    buffer_store_dwordx4 v[240:243], v1, s[32:35], s14 offen sc1
    s_mov_b64 exec, -1
    s_waitcnt lgkmcnt(0)
    v_mfma_f32_32x32x16_bf16 v[120:135], v[176:179], v[168:171], 0
    v_mfma_f32_32x32x16_bf16 v[120:135], v[180:183], v[172:175], v[120:135]
    v_and_b32 v46, 7, v1
    v_lshlrev_b32 v46, 17, v46
    v_bfe_u32 v9, v1, 3, 1
    v_lshl_add_u32 v46, v9, 14, v46
    s_and_b32 s96, s10, 1
    s_and_b32 s97, s2, 27
    s_lshl_b32 s98, s97, 12
    s_lshr_b32 s99, s10, 1
    s_lshl_b32 s97, s99, 6
    s_add_u32 s99, s98, s97
    s_lshl2_add_u32 s98, s96, s99
    s_add_u32 s97, s98, 1048576
    s_add_u32 s17, s97, 512
    v_lshrrev_b32 v47, 3, v1
    v_lshlrev_b32 v47, 10, v47
    v_and_b32 v9, 7, v1
    v_lshl_add_u32 v47, v9, 4, v47
    v_and_b32 v48, 7, v1
    v_lshlrev_b32 v48, 4, v48
    v_lshrrev_b32 v9, 5, v1
    v_lshl_add_u32 v48, v9, 3, v48
    v_cvt_pk_bf16_f32 v120, 0, v120
    v_cvt_pk_bf16_f32 v121, 0, v121
    v_cvt_pk_bf16_f32 v122, 0, v122
    v_cvt_pk_bf16_f32 v123, 0, v123
    v_cvt_pk_bf16_f32 v124, 0, v124
    v_cvt_pk_bf16_f32 v125, 0, v125
    v_cvt_pk_bf16_f32 v126, 0, v126
    v_cvt_pk_bf16_f32 v127, 0, v127
    v_cvt_pk_bf16_f32 v128, 0, v128
    v_cvt_pk_bf16_f32 v129, 0, v129
    v_cvt_pk_bf16_f32 v130, 0, v130
    v_cvt_pk_bf16_f32 v131, 0, v131
    v_cvt_pk_bf16_f32 v132, 0, v132
    v_cvt_pk_bf16_f32 v133, 0, v133
    v_cvt_pk_bf16_f32 v134, 0, v134
    v_cvt_pk_bf16_f32 v135, 0, v135
    v_max3_f32 v4, v120, v121, v122
    v_min3_f32 v5, v120, v121, v122
    v_max3_f32 v4, v4, v123, v124
    v_min3_f32 v5, v5, v123, v124
    v_max3_f32 v4, v4, v125, v126
    v_min3_f32 v5, v5, v125, v126
    v_max3_f32 v4, v4, v127, v128
    v_min3_f32 v5, v5, v127, v128
    v_max3_f32 v4, v4, v129, v130
    v_min3_f32 v5, v5, v129, v130
    v_max3_f32 v4, v4, v131, v132
    v_min3_f32 v5, v5, v131, v132
    v_max3_f32 v4, v4, v133, v134
    v_min3_f32 v5, v5, v133, v134
    v_max_f32 v6, v4, v135
    v_min_f32 v7, v5, v135
    v_max_f32 v4, v4, v135
    v_min_f32 v5, v5, v135
    s_nop 0
    v_permlane32_swap_b32 v4, v6
    v_permlane32_swap_b32 v5, v7
    v_max_f32 v4, v4, v6
    v_min_f32 v5, v5, v7
    v_pk_mul_f32 v[4:5], v[4:5], s[6:7] op_sel:[0,1]
    v_pk_fma_f32 v[136:137], v[120:121], s[6:7], v[4:5] op_sel:[0,1,0] op_sel_hi:[1,1,0] neg_lo:[0,0,1] neg_hi:[0,0,1]
    v_pk_fma_f32 v[120:121], v[120:121], s[6:7], v[4:5] op_sel:[0,1,1] neg_lo:[1,0,0] neg_hi:[1,0,0]
    v_pk_fma_f32 v[138:139], v[122:123], s[6:7], v[4:5] op_sel:[0,1,0] op_sel_hi:[1,1,0] neg_lo:[0,0,1] neg_hi:[0,0,1]
    v_pk_fma_f32 v[122:123], v[122:123], s[6:7], v[4:5] op_sel:[0,1,1] neg_lo:[1,0,0] neg_hi:[1,0,0]
    v_pk_fma_f32 v[140:141], v[124:125], s[6:7], v[4:5] op_sel:[0,1,0] op_sel_hi:[1,1,0] neg_lo:[0,0,1] neg_hi:[0,0,1]
    v_pk_fma_f32 v[124:125], v[124:125], s[6:7], v[4:5] op_sel:[0,1,1] neg_lo:[1,0,0] neg_hi:[1,0,0]
    v_pk_fma_f32 v[142:143], v[126:127], s[6:7], v[4:5] op_sel:[0,1,0] op_sel_hi:[1,1,0] neg_lo:[0,0,1] neg_hi:[0,0,1]
    v_pk_fma_f32 v[126:127], v[126:127], s[6:7], v[4:5] op_sel:[0,1,1] neg_lo:[1,0,0] neg_hi:[1,0,0]
    v_pk_fma_f32 v[144:145], v[128:129], s[6:7], v[4:5] op_sel:[0,1,0] op_sel_hi:[1,1,0] neg_lo:[0,0,1] neg_hi:[0,0,1]
    v_pk_fma_f32 v[128:129], v[128:129], s[6:7], v[4:5] op_sel:[0,1,1] neg_lo:[1,0,0] neg_hi:[1,0,0]
    v_pk_fma_f32 v[146:147], v[130:131], s[6:7], v[4:5] op_sel:[0,1,0] op_sel_hi:[1,1,0] neg_lo:[0,0,1] neg_hi:[0,0,1]
    v_pk_fma_f32 v[130:131], v[130:131], s[6:7], v[4:5] op_sel:[0,1,1] neg_lo:[1,0,0] neg_hi:[1,0,0]
    v_pk_fma_f32 v[148:149], v[132:133], s[6:7], v[4:5] op_sel:[0,1,0] op_sel_hi:[1,1,0] neg_lo:[0,0,1] neg_hi:[0,0,1]
    v_pk_fma_f32 v[132:133], v[132:133], s[6:7], v[4:5] op_sel:[0,1,1] neg_lo:[1,0,0] neg_hi:[1,0,0]
    v_pk_fma_f32 v[150:151], v[134:135], s[6:7], v[4:5] op_sel:[0,1,0] op_sel_hi:[1,1,0] neg_lo:[0,0,1] neg_hi:[0,0,1]
    v_pk_fma_f32 v[134:135], v[134:135], s[6:7], v[4:5] op_sel:[0,1,1] neg_lo:[1,0,0] neg_hi:[1,0,0]
    v_exp_f32 v136, v136
    v_exp_f32 v120, v120
    v_exp_f32 v137, v137
    v_exp_f32 v121, v121
    v_exp_f32 v138, v138
    v_exp_f32 v122, v122
    v_exp_f32 v139, v139
    v_exp_f32 v123, v123
    v_exp_f32 v140, v140
    v_exp_f32 v124, v124
    v_exp_f32 v141, v141
    v_exp_f32 v125, v125
    v_exp_f32 v142, v142
    v_exp_f32 v126, v126
    v_exp_f32 v143, v143
    v_exp_f32 v127, v127
    s_waitcnt vmcnt(0)
    s_barrier
    s_cmp_lg_u32 s3, 0
    s_cbranch_scc1 L_PC
    v_mov_b32 v45, s4
    s_mov_b32 exec_hi, 0
    s_mov_b32 exec_lo, 65535
    buffer_store_dword v45, v46, s[32:35], s17 offen sc1
    s_mov_b64 exec, -1
L_PC:
    s_xor_b32 s96, s95, 1572864
    s_add_u32 s82, s96, s90
    s_add_u32 m0, s83, 98304
    s_nop 0
    buffer_load_dwordx4 v26, s[44:47], s82 offen lds
    v_exp_f32 v144, v144
    v_exp_f32 v128, v128
    v_exp_f32 v145, v145
    v_exp_f32 v129, v129
    v_exp_f32 v146, v146
    v_exp_f32 v130, v130
    v_exp_f32 v147, v147
    v_exp_f32 v131, v131
    s_xor_b32 s96, s95, 1703936
    s_add_u32 s82, s96, s90
    s_add_u32 m0, s83, 106496
    s_nop 0
    buffer_load_dwordx4 v26, s[44:47], s82 offen lds
    v_exp_f32 v148, v148
    v_exp_f32 v132, v132
    v_exp_f32 v149, v149
    v_exp_f32 v133, v133
    v_exp_f32 v150, v150
    v_exp_f32 v134, v134
    v_exp_f32 v151, v151
    v_exp_f32 v135, v135
    s_lshl4_add_u32 s96, s11, s10
    s_lshl_b32 s97, s96, 14
    s_lshl_b32 s98, s3, 7
    s_add_u32 s99, s97, s98
    s_add_u32 s13, s99, 25165824
    s_add_u32 s14, s13, 8192
    s_lshl4_add_u32 s96, s11, s10
    s_lshl_b32 s97, s96, 10
    s_lshl_b32 s98, s3, 7
    s_add_u32 s99, s97, s98
    s_add_u32 s15, s99, 29360128
    s_add_u32 s17, s17, 3072
    s_load_dwordx2 s[24:25], s[32:33], s92 offset:512 glc
    s_xor_b32 s96, s95, 1835008
    s_add_u32 s82, s96, s90
    s_add_u32 m0, s83, 114688
    s_nop 0
    buffer_load_dwordx4 v26, s[44:47], s82 offen lds
    v_pk_add_f32 v[8:9], v[136:137], v[138:139]
    v_pk_add_f32 v[10:11], v[120:121], v[122:123]
    v_pk_add_f32 v[8:9], v[8:9], v[140:141]
    v_pk_add_f32 v[10:11], v[10:11], v[124:125]
    v_pk_add_f32 v[8:9], v[8:9], v[142:143]
    v_pk_add_f32 v[10:11], v[10:11], v[126:127]
    v_pk_add_f32 v[8:9], v[8:9], v[144:145]
    v_pk_add_f32 v[10:11], v[10:11], v[128:129]
    v_pk_add_f32 v[8:9], v[8:9], v[146:147]
    v_pk_add_f32 v[10:11], v[10:11], v[130:131]
    v_pk_add_f32 v[8:9], v[8:9], v[148:149]
    v_pk_add_f32 v[10:11], v[10:11], v[132:133]
    v_pk_add_f32 v[8:9], v[8:9], v[150:151]
    v_pk_add_f32 v[10:11], v[10:11], v[134:135]
    s_xor_b32 s96, s95, 1966080
    s_add_u32 s82, s96, s90
    s_add_u32 m0, s83, 122880
    s_nop 0
    buffer_load_dwordx4 v26, s[44:47], s82 offen lds
    v_add_f32 v6, v8, v9
    v_add_f32 v7, v10, v11
    v_add_f32 v4, v8, v9
    v_add_f32 v5, v10, v11
    s_nop 0
    v_permlane32_swap_b32 v4, v6
    v_permlane32_swap_b32 v5, v7
    v_pk_add_f32 v[4:5], v[4:5], v[6:7]
    v_rcp_f32 v4, v4
    v_rcp_f32 v5, v5
    s_nop 0
    v_pk_mul_f32 v[136:137], v[136:137], v[4:5] op_sel_hi:[1,0]
    v_pk_mul_f32 v[120:121], v[120:121], v[4:5] op_sel:[0,1]
    v_pk_mul_f32 v[138:139], v[138:139], v[4:5] op_sel_hi:[1,0]
    v_pk_mul_f32 v[122:123], v[122:123], v[4:5] op_sel:[0,1]
    v_pk_mul_f32 v[140:141], v[140:141], v[4:5] op_sel_hi:[1,0]
    s_add_u32 s82, s95, s90
    s_mov_b32 m0, s83
    s_nop 0
    buffer_load_dwordx4 v26, s[44:47], s82 offen lds
    v_pk_mul_f32 v[124:125], v[124:125], v[4:5] op_sel:[0,1]
    v_pk_mul_f32 v[142:143], v[142:143], v[4:5] op_sel_hi:[1,0]
    v_pk_mul_f32 v[126:127], v[126:127], v[4:5] op_sel:[0,1]
    v_pk_mul_f32 v[144:145], v[144:145], v[4:5] op_sel_hi:[1,0]
    v_pk_mul_f32 v[128:129], v[128:129], v[4:5] op_sel:[0,1]
    v_pk_mul_f32 v[146:147], v[146:147], v[4:5] op_sel_hi:[1,0]
    v_pk_mul_f32 v[130:131], v[130:131], v[4:5] op_sel:[0,1]
    v_pk_mul_f32 v[148:149], v[148:149], v[4:5] op_sel_hi:[1,0]
    v_pk_mul_f32 v[132:133], v[132:133], v[4:5] op_sel:[0,1]
    v_pk_mul_f32 v[150:151], v[150:151], v[4:5] op_sel_hi:[1,0]
    v_pk_mul_f32 v[134:135], v[134:135], v[4:5] op_sel:[0,1]
    v_cvt_pk_bf16_f32 v152, v136, v137
    v_cvt_pk_bf16_f32 v153, v138, v139
    v_cvt_pk_bf16_f32 v154, v140, v141
    s_xor_b32 s96, s95, 131072
    s_add_u32 s82, s96, s90
    s_add_u32 m0, s83, 8192
    s_nop 0
    buffer_load_dwordx4 v26, s[44:47], s82 offen lds
    v_cvt_pk_bf16_f32 v155, v142, v143
    v_cvt_pk_bf16_f32 v156, v144, v145
    v_cvt_pk_bf16_f32 v157, v146, v147
    v_cvt_pk_bf16_f32 v158, v148, v149
    v_cvt_pk_bf16_f32 v159, v150, v151
    v_cvt_pk_bf16_f32 v160, v120, v121
    v_cvt_pk_bf16_f32 v161, v122, v123
    v_cvt_pk_bf16_f32 v162, v124, v125
    v_cvt_pk_bf16_f32 v163, v126, v127
    v_cvt_pk_bf16_f32 v164, v128, v129
    v_cvt_pk_bf16_f32 v165, v130, v131
    v_cvt_pk_bf16_f32 v166, v132, v133
    v_cvt_pk_bf16_f32 v167, v134, v135
    s_branch SCHK_19
SPOLL_18:
    s_load_dwordx2 s[24:25], s[32:33], s92 offset:512 glc
SCHK_19:
    s_add_u32 s5, s5, 1
    s_cmp_ge_u32 s5, 200000
    s_waitcnt lgkmcnt(0)
    s_cbranch_scc1 SDONE_20
    s_cmp_lg_u32 s24, s4
    s_cbranch_scc1 SPOLL_18
    s_cmp_lg_u32 s25, s4
    s_cbranch_scc1 SPOLL_18
SDONE_20:
    s_barrier
    buffer_load_dwordx4 v[184:187], v47, s[32:35], s13 offen sc1
    buffer_load_dwordx4 v[188:191], v47, s[32:35], s14 offen sc1
    buffer_load_dwordx4 v[192:195], v2, s[32:35], s16 offen sc1
    s_lshl_b32 s96, s3, 5
    s_add_u32 s14, s96, 155648
    v_and_b32 v6, 3, v1
    v_lshl_add_u32 v6, v6, 3, s14
    v_lshrrev_b32 v9, 5, v1
    v_lshl_add_u32 v6, v9, 2, v6
    s_lshl_b32 s96, s3, 10
    s_add_u32 s14, s96, 147456
    v_and_b32 v5, 15, v1
    v_lshl_add_u32 v5, v5, 4, s14
    v_lshrrev_b32 v9, 5, v1
    v_lshl_add_u32 v5, v9, 9, v5
    v_bfe_u32 v9, v1, 4, 1
    v_lshl_add_u32 v5, v9, 3, v5
    s_lshl_b32 s96, s76, 7
    s_add_u32 s14, s96, 155648
    v_lshrrev_b32 v7, 5, v1
    v_lshl_add_u32 v7, v7, 4, s14
    s_lshl_b32 s96, s76, 12
    s_add_u32 s14, s96, 147456
    v_add_u32 v44, s14, v2
    s_waitcnt vmcnt(1)
    v_pk_add_f32 v[184:185], v[184:185], v[188:189]
    v_pk_add_f32 v[186:187], v[186:187], v[190:191]
    s_nop 1
    v_permlane32_swap_b32 v184, v186
    v_permlane32_swap_b32 v185, v187
    v_pk_add_f32 v[184:185], v[184:185], v[186:187]
    s_nop 1
    v_add_f32_dpp v184, v184, v184 row_ror:8 row_mask:0xf bank_mask:0xf
    v_add_f32_dpp v185, v185, v185 row_ror:8 row_mask:0xf bank_mask:0xf
    v_mov_b32 v186, v184
    v_mov_b32 v187, v185
    s_nop 0
    v_permlane16_swap_b32 v184, v186
    v_permlane16_swap_b32 v185, v187
    v_pk_add_f32 v[184:185], v[184:185], v[186:187]
    v_cvt_pk_bf16_f32 v184, v184, v185
    v_mov_b32 v185, s4
    s_mov_b32 exec_lo, 0xff
    s_mov_b32 exec_hi, 0xff
    buffer_store_dwordx2 v[184:185], v48, s[32:35], s15 offen sc1
    s_mov_b64 exec, -1
    s_barrier
    s_cmp_lg_u32 s3, 0
    s_cbranch_scc1 L_PC2
    v_mov_b32 v45, s4
    s_mov_b32 exec_hi, 0
    s_mov_b32 exec_lo, 65535
    buffer_store_dword v45, v46, s[32:35], s17 offen sc1
    s_mov_b64 exec, -1
L_PC2:
    s_waitcnt vmcnt(1)
    s_xor_b32 s96, s95, 262144
    s_add_u32 s82, s96, s90
    s_add_u32 m0, s83, 16384
    s_nop 0
    buffer_load_dwordx4 v26, s[44:47], s82 offen lds
    v_permlane32_swap_b32 v192, v194
    v_permlane32_swap_b32 v193, v195
    v_pk_add_f32 v[192:193], v[192:193], v[194:195]
    s_nop 1
    v_add_f32_dpp v192, v192, v192 row_ror:4 row_mask:0xf bank_mask:0xf
    s_xor_b32 s96, s95, 393216
    s_add_u32 s82, s96, s90
    s_add_u32 m0, s83, 24576
    s_nop 0
    buffer_load_dwordx4 v26, s[44:47], s82 offen lds
    v_add_f32_dpp v193, v193, v193 row_ror:4 row_mask:0xf bank_mask:0xf
    v_add_f32_dpp v192, v192, v192 row_ror:8 row_mask:0xf bank_mask:0xf
    s_nop 0
    v_add_f32_dpp v193, v193, v193 row_ror:8 row_mask:0xf bank_mask:0xf
    s_xor_b32 s96, s95, 524288
    s_add_u32 s82, s96, s90
    s_add_u32 m0, s83, 32768
    s_nop 0
    buffer_load_dwordx4 v26, s[44:47], s82 offen lds
    v_mov_b32 v194, v192
    v_mov_b32 v195, v193
    s_nop 0
    v_permlane16_swap_b32 v192, v194
    s_xor_b32 s96, s95, 655360
    s_add_u32 s82, s96, s90
    s_add_u32 m0, s83, 40960
    s_nop 0
    buffer_load_dwordx4 v26, s[44:47], s82 offen lds
    v_permlane16_swap_b32 v193, v195
    v_pk_add_f32 v[192:193], v[192:193], v[194:195]
    v_cvt_pk_bf16_f32 v192, v192, v193
    ds_write_b32 v6, v192
    s_waitcnt lgkmcnt(0)
    s_barrier
    ds_read_b128 v[196:199], v7
    ds_read_b128 v[200:203], v7 offset:32
    ds_read_b128 v[204:207], v7 offset:64
L_PAD7:
    s_cbranch_execz L_RET7
    ds_read_b128 v[208:211], v7 offset:96
    s_lshr_b32 s96, s8, 2
    s_lshl1_add_u32 s97, s9, s96
    s_and_b32 s98, s8, 3
    s_lshl2_add_u32 s99, s97, s98
    s_lshl_b32 s96, s99, 9
    s_add_u32 s18, s96, 131072
    s_waitcnt lgkmcnt(0)
    s_lshl3_add_u32 s96, s11, s3
    s_lshl_b32 s97, s96, 11
    s_add_u32 s13, s97, 29360128
    s_load_dwordx2 s[24:25], s[32:33], s92 offset:3584 glc
    v_mfma_f32_32x32x16_bf16 v[136:151], v[196:199], v[152:155], 0
    v_mfma_f32_32x32x16_bf16 v[136:151], v[200:203], v[156:159], v[136:151]
    v_mfma_f32_32x32x16_bf16 v[136:151], v[204:207], v[160:163], v[136:151]
    v_mfma_f32_32x32x16_bf16 v[136:151], v[208:211], v[164:167], v[136:151]
    s_nop 11
    v_cvt_pk_bf16_f32 v136, 0, v136
    v_add_f32 v136, 0x358637bd, v136
    v_cvt_pk_bf16_f32 v136, 0, v136
    v_rcp_f32 v136, v136
    s_branch SCHK_22
SPOLL_21:
    s_load_dwordx2 s[24:25], s[32:33], s92 offset:3584 glc
SCHK_22:
    s_add_u32 s5, s5, 1
    s_cmp_ge_u32 s5, 200000
    s_waitcnt lgkmcnt(0)
    s_cbranch_scc1 SDONE_23
    s_cmp_lg_u32 s24, s4
    s_cbranch_scc1 SPOLL_21
    s_cmp_lg_u32 s25, s4
    s_cbranch_scc1 SPOLL_21
SDONE_23:
    buffer_load_dwordx4 v[228:231], v2, s[32:35], s13 offen sc1
    buffer_load_dwordx4 v[232:235], v2, s[32:35], s13 offen offset:1024 sc1
    s_waitcnt vmcnt(0)
    v_bitop3_b32 v4, v229, v231, s4 bitop3:0x7e
    v_bitop3_b32 v4, v4, v233, s4 bitop3:0xf6
    v_bitop3_b32 v4, v4, v235, s4 bitop3:0xf6
    v_cmp_ne_u32 vcc, 0, v4
    s_cbranch_vccz TOK_25
POLL_26:
    buffer_load_dwordx4 v[228:231], v2, s[32:35], s13 offen sc1
    buffer_load_dwordx4 v[232:235], v2, s[32:35], s13 offen offset:1024 sc1
    s_waitcnt vmcnt(0)
    v_bitop3_b32 v4, v229, v231, s4 bitop3:0x7e
    v_bitop3_b32 v4, v4, v233, s4 bitop3:0xf6
    v_bitop3_b32 v4, v4, v235, s4 bitop3:0xf6
    v_cmp_ne_u32 vcc, 0, v4
    s_cbranch_vccz PDONE_27
    s_add_u32 s5, s5, 1
    s_cmp_lt_u32 s5, 200000
    s_cbranch_scc1 POLL_26
PDONE_27:
TOK_25:
    ds_write2_b32 v5, v228, v230 offset0:0 offset1:1
    ds_write2_b32 v5, v232, v234 offset0:64 offset1:65
    s_waitcnt lgkmcnt(0)
    s_barrier
    ds_read_b128 v[212:215], v44
    ds_read_b128 v[216:219], v44 offset:1024
    ds_read_b128 v[220:223], v44 offset:2048
    ds_read_b128 v[224:227], v44 offset:3072
    s_lshl_b32 s96, s77, 1
    s_lshl3_add_u32 s97, s10, s96
    s_lshl_b32 s98, s97, 5
    s_lshl1_add_u32 s99, s11, s98
    s_add_u32 s96, s99, s76
    s_lshl_b32 s97, s96, 10
    s_add_u32 s13, s97, 8388608
    v_and_b32 v47, 15, v1
    v_lshlrev_b32 v47, 4, v47
    v_bfe_u32 v9, v1, 4, 1
    v_lshl_add_u32 v47, v9, 15, v47
    v_lshrrev_b32 v9, 5, v1
    v_lshl_add_u32 v47, v9, 8, v47
    s_waitcnt lgkmcnt(3)
    v_mfma_f32_32x32x16_bf16 v[120:135], v[212:215], v[152:155], 0
    s_waitcnt lgkmcnt(2)
    v_mfma_f32_32x32x16_bf16 v[120:135], v[216:219], v[156:159], v[120:135]
    s_waitcnt lgkmcnt(1)
    v_mfma_f32_32x32x16_bf16 v[120:135], v[220:223], v[160:163], v[120:135]
    s_waitcnt lgkmcnt(0)
    v_mfma_f32_32x32x16_bf16 v[120:135], v[224:227], v[164:167], v[120:135]
    s_lshr_b32 s96, s3, 1
    s_lshl4_add_u32 s97, s96, s12
    s_lshl_b32 s98, s97, 11
    s_and_b32 s99, s3, 1
    s_lshl_b32 s96, s99, 10
    s_add_u32 s97, s98, s96
    s_add_u32 s18, s97, 131072
    s_lshl_b32 s19, s12, 7
    v_and_b32 v44, 3, v1
    v_lshl_add_u32 v44, v44, 1, s19
    v_lshrrev_b32 v9, 5, v1
    v_lshl_add_u32 v44, v9, 3, v44
    v_bfe_u32 v9, v1, 4, 1
    v_lshl_add_u32 v44, v9, 4, v44
    v_bfe_u32 v9, v1, 2, 2
    v_lshl_add_u32 v44, v9, 5, v44
    global_load_ushort v32, v44, s[78:79]
    buffer_load_dwordx4 v[28:31], v2, s[32:35], s18 offen sc1
    v_cvt_pk_bf16_f32 v120, 0, v120
    v_cvt_pk_bf16_f32 v121, 0, v121
    v_cvt_pk_bf16_f32 v122, 0, v122
    v_cvt_pk_bf16_f32 v123, 0, v123
    v_cvt_pk_bf16_f32 v124, 0, v124
    v_cvt_pk_bf16_f32 v125, 0, v125
    v_cvt_pk_bf16_f32 v126, 0, v126
    v_cvt_pk_bf16_f32 v127, 0, v127
    v_pk_mul_f32 v[120:121], v[120:121], v[136:137] op_sel_hi:[1,0]
    v_pk_mul_f32 v[122:123], v[122:123], v[136:137] op_sel_hi:[1,0]
    v_pk_mul_f32 v[124:125], v[124:125], v[136:137] op_sel_hi:[1,0]
    v_pk_mul_f32 v[126:127], v[126:127], v[136:137] op_sel_hi:[1,0]
    v_cvt_pk_bf16_f32 v168, v120, v121
    v_cvt_pk_bf16_f32 v169, v122, v123
    v_cvt_pk_bf16_f32 v170, v124, v125
    v_cvt_pk_bf16_f32 v171, v126, v127
    buffer_store_dwordx4 v[168:171], v47, s[32:35], s13 offen sc1
    v_cvt_pk_bf16_f32 v128, 0, v128
    v_cvt_pk_bf16_f32 v129, 0, v129
    v_cvt_pk_bf16_f32 v130, 0, v130
    v_cvt_pk_bf16_f32 v131, 0, v131
    v_cvt_pk_bf16_f32 v132, 0, v132
    v_cvt_pk_bf16_f32 v133, 0, v133
    v_cvt_pk_bf16_f32 v134, 0, v134
    v_cvt_pk_bf16_f32 v135, 0, v135
    v_pk_mul_f32 v[128:129], v[128:129], v[136:137] op_sel_hi:[1,0]
    v_pk_mul_f32 v[130:131], v[130:131], v[136:137] op_sel_hi:[1,0]
    v_pk_mul_f32 v[132:133], v[132:133], v[136:137] op_sel_hi:[1,0]
    v_pk_mul_f32 v[134:135], v[134:135], v[136:137] op_sel_hi:[1,0]
    v_cvt_pk_bf16_f32 v172, v128, v129
    v_cvt_pk_bf16_f32 v173, v130, v131
    v_cvt_pk_bf16_f32 v174, v132, v133
    v_cvt_pk_bf16_f32 v175, v134, v135
    buffer_store_dwordx4 v[172:175], v47, s[32:35], s13 offen offset:512 sc1
    v_mov_b32 v50, -1
    v_mov_b32 v51, -1
    v_mov_b32 v52, -1
    v_mov_b32 v53, -1
    s_lshl3_add_u32 s96, s21, s3
    s_lshl4_add_u32 s97, s96, s12
    s_lshl_b32 s98, s97, 8
    s_add_u32 s19, s98, 12582912
    v_lshlrev_b32 v54, 2, v1
    buffer_store_dword v50, v54, s[32:35], s19 offen sc1
    s_lshl_b32 s96, s21, 14
    s_lshl_b32 s97, s12, 9
    s_add_u32 s98, s96, s97
    s_add_u32 s19, s98, 13631488
    v_and_b32 v54, 31, v1
    v_lshlrev_b32 v54, 4, v54
    v_lshrrev_b32 v55, 5, v1
    v_lshl_add_u32 v54, v55, 13, v54
    s_cmp_lg_u32 s3, 5
    s_cbranch_scc1 L_NOPO
    buffer_store_dwordx4 v[50:53], v54, s[32:35], s19 offen sc1
L_NOPO:
    v_bfe_u32 v36, v1, 2, 2
    v_lshlrev_b32 v36, 7, v36
    v_lshrrev_b32 v9, 4, v1
    v_lshl_add_u32 v36, v9, 10, v36
    v_and_b32 v9, 1, v1
    v_lshl_add_u32 v36, v9, 4, v36
    v_bfe_u32 v9, v1, 1, 1
    v_lshl_add_u32 v36, v9, 3, v36
    v_bfe_u32 v9, v1, 3, 2
    v_lshl_add_u32 v36, v9, 5, v36
    s_and_b32 s96, s9, 1
    s_lshl_b32 s97, s96, 2
    s_xor_b32 s98, s3, s97
    s_lshl_b32 s17, s98, 12
    s_lshl_b32 s96, s17, 2
    s_lshr_b32 s97, s95, 4
    s_xor_b32 s14, s96, s97
    v_add_u32 v36, s14, v36
    v_xor_b32 v37, 32, v36
    v_xor_b32 v38, 64, v36
    v_xor_b32 v39, 96, v36
    v_and_b32 v5, 7, v1
    v_lshlrev_b32 v5, 15, v5
    v_bfe_u32 v9, v1, 3, 1
    v_lshl_add_u32 v5, v9, 12, v5
    s_and_b32 s96, s11, 1
    s_lshr_b32 s97, s10, 2
    s_and_b32 s98, s10, 3
    s_lshl_b32 s99, s98, 6
    s_lshl1_add_u32 s98, s97, s99
    s_lshl_b32 s97, s98, 12
    s_lshr_b32 s99, s11, 1
    s_lshl_b32 s98, s99, 6
    s_add_u32 s99, s97, s98
    s_lshl2_add_u32 s97, s96, s99
    s_add_u32 s98, s97, 1048576
    s_add_u32 s15, s98, 1024
    v_lshlrev_b32 v152, 16, v12
    v_and_b32 v153, s6, v12
    v_lshlrev_b32 v154, 16, v13
    v_and_b32 v155, s6, v13
    v_lshlrev_b32 v156, 16, v14
    v_and_b32 v157, s6, v14
    v_lshlrev_b32 v158, 16, v15
    v_and_b32 v159, s6, v15
    v_lshlrev_b32 v160, 16, v16
    v_and_b32 v161, s6, v16
    v_lshlrev_b32 v162, 16, v17
    v_and_b32 v163, s6, v17
    v_lshlrev_b32 v164, 16, v18
    v_and_b32 v165, s6, v18
    v_lshlrev_b32 v166, 16, v19
    v_and_b32 v167, s6, v19
    s_lshl3_add_u32 s96, s21, s3
    s_lshl_b32 s97, s96, 15
    s_add_u32 s19, s97, 8388608
    s_waitcnt vmcnt(3)
    v_bitop3_b32 v4, v29, v31, s4 bitop3:0x7e
    v_cmp_ne_u32 vcc, 0, v4
    s_cbranch_vccz L_MGOK
POLL_28:
    buffer_load_dwordx4 v[28:31], v2, s[32:35], s18 offen sc1
    s_waitcnt vmcnt(0)
    v_bitop3_b32 v4, v29, v31, s4 bitop3:0x7e
    v_cmp_ne_u32 vcc, 0, v4
    s_cbranch_vccz PDONE_29
    s_add_u32 s5, s5, 1
    s_cmp_lt_u32 s5, 200000
    s_cbranch_scc1 POLL_28
PDONE_29:
L_MGOK:
    s_and_b32 s96, s3, 1
    s_lshr_b32 s97, s3, 1
    s_lshl_b32 s98, s97, 10
    s_lshl3_add_u32 s99, s96, s98
    s_add_u32 s14, s99, 159744
    v_and_b32 v4, 31, v1
    v_lshl_add_u32 v4, v4, 5, s14
    v_lshrrev_b32 v9, 5, v1
    v_lshl_add_u32 v4, v9, 2, v4
    ds_write2_b32 v4, v28, v30 offset0:0 offset1:4
    v_and_b32 v7, 3, v1
    v_lshlrev_b32 v7, 4, v7
    v_lshrrev_b32 v9, 5, v1
    v_lshl_add_u32 v7, v9, 6, v7
    v_bfe_u32 v9, v1, 4, 1
    v_lshl_add_u32 v7, v9, 7, v7
    v_bfe_u32 v9, v1, 2, 2
    v_lshl_add_u32 v7, v9, 8, v7
    v_add_u32 v7, 159744, v7
    s_lshl_b32 s96, s2, 12
    s_lshr_b32 s97, s17, 6
    s_add_u32 s98, s96, s97
    s_add_u32 s99, s98, 1048576
    s_add_u32 s18, s99, 1024
    s_waitcnt vmcnt(1)
    s_waitcnt lgkmcnt(0)
    s_barrier
    s_cmp_lg_u32 s3, 0
    s_cbranch_scc1 L_PD
    v_mov_b32 v6, s4
    s_mov_b32 exec_hi, 0
    s_mov_b32 exec_lo, 65535
    buffer_store_dword v6, v5, s[32:35], s15 offen sc1
    s_mov_b64 exec, -1
L_PD:
    ds_read_b128 v[192:195], v7
    ds_read_b128 v[196:199], v7 offset:1024
    ds_read_b128 v[200:203], v7 offset:2048
    ds_read_b128 v[204:207], v7 offset:3072
    v_and_b32 v8, 3, v1
    v_lshlrev_b32 v8, 2, v8
    v_lshrrev_b32 v9, 5, v1
    v_lshl_add_u32 v8, v9, 4, v8
    v_bfe_u32 v9, v1, 4, 1
    v_lshl_add_u32 v8, v9, 5, v8
    v_bfe_u32 v9, v1, 2, 2
    v_lshl_add_u32 v8, v9, 6, v8
    v_add_u32 v8, 157184, v8
    s_lshl4_add_u32 s96, s21, s12
    s_lshl_b32 s97, s96, 6
    s_add_u32 s13, s97, 14155776
    s_waitcnt lgkmcnt(0)
    s_load_dwordx2 s[24:25], s[32:33], s18 offset:0 glc
    v_pk_add_f32 v[192:193], v[192:193], v[194:195]
    v_add_f32 v28, v192, v193
    v_pk_add_f32 v[196:197], v[196:197], v[198:199]
    v_add_f32 v29, v196, v197
    v_pk_add_f32 v[200:201], v[200:201], v[202:203]
    v_add_f32 v30, v200, v201
    v_pk_add_f32 v[204:205], v[204:205], v[206:207]
    v_add_f32 v31, v204, v205
    v_cvt_pk_bf16_f32 v28, 0, v28
    v_cvt_pk_bf16_f32 v29, 0, v29
    v_cvt_pk_bf16_f32 v30, 0, v30
    v_cvt_pk_bf16_f32 v31, 0, v31
    v_add_f32 v30, 1.0, v30
    v_lshlrev_b32 v32, 16, v32
    v_cvt_pk_bf16_f32 v30, 0, v30
    ds_write_b32 v8, v31
    v_mul_f32 v192, v30, v32
    v_cvt_pk_bf16_f32 v193, 0, v192
    v_sub_f32 v194, v192, v193
    v_add_f32_dpp v192, v192, v192 quad_perm:[1,0,3,2] row_mask:0xf bank_mask:0xf
    s_nop 1
    v_add_f32_dpp v192, v192, v192 quad_perm:[2,3,0,1] row_mask:0xf bank_mask:0xf
    s_nop 1
    v_add_f32_dpp v192, v192, v192 row_half_mirror row_mask:0xf bank_mask:0xf
    s_nop 1
    v_add_f32_dpp v192, v192, v192 row_ror:8 row_mask:0xf bank_mask:0xf
    v_mov_b32 v199, v192
    s_nop 1
    v_permlane16_swap_b32 v192, v199
    v_add_f32 v192, v192, v199
    v_mov_b32 v199, v192
    s_nop 1
    v_permlane32_swap_b32 v192, v199
    v_add_f32 v192, v192, v199
    v_mov_b32_dpp v196, v193 row_shl:1 row_mask:0xf bank_mask:0xf
    v_mov_b32_dpp v197, v194 row_shl:1 row_mask:0xf bank_mask:0xf
    v_mov_b32_dpp v198, v32 row_shl:1 row_mask:0xf bank_mask:0xf
    v_cvt_pk_bf16_f32 v196, v193, v196
    v_cvt_pk_bf16_f32 v197, v194, v197
    v_cvt_pk_bf16_f32 v198, v32, v198
    v_mov_b32 v193, s4
    v_mov_b32 v194, 0
    s_cmp_lg_u32 s3, 2
    s_cbranch_scc1 L_NOUP
    s_mov_b64 exec, 1
    buffer_store_dwordx2 v[192:193], v194, s[32:35], s13 offen sc1
    s_mov_b64 exec, -1
L_NOUP:
    v_mov_b32 v184, 0x3f803f80
    s_nop 1
    v_mov_b32_dpp v184, v196 row_newbcast:0 row_mask:0xf bank_mask:0x2
    s_nop 1
    v_mov_b32_dpp v184, v197 row_newbcast:0 row_mask:0xf bank_mask:0x4
    s_nop 1
    v_mov_b32_dpp v184, v198 row_newbcast:0 row_mask:0xf bank_mask:0x8
    v_mov_b32 v185, 0x3f803f80
    s_nop 1
    v_mov_b32_dpp v185, v196 row_newbcast:2 row_mask:0xf bank_mask:0x2
    s_nop 1
    v_mov_b32_dpp v185, v197 row_newbcast:2 row_mask:0xf bank_mask:0x4
    s_nop 1
    v_mov_b32_dpp v185, v198 row_newbcast:2 row_mask:0xf bank_mask:0x8
    v_mov_b32 v186, 0x3f803f80
    s_nop 1
    v_mov_b32_dpp v186, v196 row_newbcast:4 row_mask:0xf bank_mask:0x2
    s_nop 1
    v_mov_b32_dpp v186, v197 row_newbcast:4 row_mask:0xf bank_mask:0x4
    s_nop 1
    v_mov_b32_dpp v186, v198 row_newbcast:4 row_mask:0xf bank_mask:0x8
    v_mov_b32 v187, 0x3f803f80
    s_nop 1
    v_mov_b32_dpp v187, v196 row_newbcast:6 row_mask:0xf bank_mask:0x2
    s_nop 1
    v_mov_b32_dpp v187, v197 row_newbcast:6 row_mask:0xf bank_mask:0x4
    s_nop 1
    v_mov_b32_dpp v187, v198 row_newbcast:6 row_mask:0xf bank_mask:0x8
    v_mov_b32 v188, 0x3f803f80
    s_nop 1
    v_mov_b32_dpp v188, v196 row_newbcast:8 row_mask:0xf bank_mask:0x2
    s_nop 1
    v_mov_b32_dpp v188, v197 row_newbcast:8 row_mask:0xf bank_mask:0x4
    s_nop 1
    v_mov_b32_dpp v188, v198 row_newbcast:8 row_mask:0xf bank_mask:0x8
    v_mov_b32 v189, 0x3f803f80
    s_nop 1
    v_mov_b32_dpp v189, v196 row_newbcast:10 row_mask:0xf bank_mask:0x2
    s_nop 1
    v_mov_b32_dpp v189, v197 row_newbcast:10 row_mask:0xf bank_mask:0x4
    s_nop 1
    v_mov_b32_dpp v189, v198 row_newbcast:10 row_mask:0xf bank_mask:0x8
    v_mov_b32 v190, 0x3f803f80
    s_nop 1
    v_mov_b32_dpp v190, v196 row_newbcast:12 row_mask:0xf bank_mask:0x2
    s_nop 1
    v_mov_b32_dpp v190, v197 row_newbcast:12 row_mask:0xf bank_mask:0x4
    s_nop 1
    v_mov_b32_dpp v190, v198 row_newbcast:12 row_mask:0xf bank_mask:0x8
    v_mov_b32 v191, 0x3f803f80
    s_nop 1
    v_mov_b32_dpp v191, v196 row_newbcast:14 row_mask:0xf bank_mask:0x2
    s_nop 1
    v_mov_b32_dpp v191, v197 row_newbcast:14 row_mask:0xf bank_mask:0x4
    s_nop 1
    v_mov_b32_dpp v191, v198 row_newbcast:14 row_mask:0xf bank_mask:0x8
    v_mov_b32_dpp v136, v28 row_newbcast:0 row_mask:0xf bank_mask:0xf
    v_mov_b32_dpp v137, v28 row_newbcast:1 row_mask:0xf bank_mask:0xf
    v_mov_b32_dpp v138, v28 row_newbcast:2 row_mask:0xf bank_mask:0xf
    v_mov_b32_dpp v139, v28 row_newbcast:3 row_mask:0xf bank_mask:0xf
    v_mov_b32_dpp v140, v28 row_newbcast:4 row_mask:0xf bank_mask:0xf
    v_mov_b32_dpp v141, v28 row_newbcast:5 row_mask:0xf bank_mask:0xf
    v_mov_b32_dpp v142, v28 row_newbcast:6 row_mask:0xf bank_mask:0xf
    v_mov_b32_dpp v143, v28 row_newbcast:7 row_mask:0xf bank_mask:0xf
    v_mov_b32_dpp v144, v28 row_newbcast:8 row_mask:0xf bank_mask:0xf
    v_mov_b32_dpp v145, v28 row_newbcast:9 row_mask:0xf bank_mask:0xf
    v_mov_b32_dpp v146, v28 row_newbcast:10 row_mask:0xf bank_mask:0xf
    v_mov_b32_dpp v147, v28 row_newbcast:11 row_mask:0xf bank_mask:0xf
    v_mov_b32_dpp v148, v28 row_newbcast:12 row_mask:0xf bank_mask:0xf
    v_mov_b32_dpp v149, v28 row_newbcast:13 row_mask:0xf bank_mask:0xf
    v_mov_b32_dpp v150, v28 row_newbcast:14 row_mask:0xf bank_mask:0xf
    v_mov_b32_dpp v151, v28 row_newbcast:15 row_mask:0xf bank_mask:0xf
    v_mov_b32_dpp v168, v30 row_newbcast:0 row_mask:0xf bank_mask:0xf
    v_mov_b32_dpp v169, v30 row_newbcast:1 row_mask:0xf bank_mask:0xf
    v_mov_b32_dpp v170, v30 row_newbcast:2 row_mask:0xf bank_mask:0xf
    v_mov_b32_dpp v171, v30 row_newbcast:3 row_mask:0xf bank_mask:0xf
    v_mov_b32_dpp v172, v30 row_newbcast:4 row_mask:0xf bank_mask:0xf
    v_mov_b32_dpp v173, v30 row_newbcast:5 row_mask:0xf bank_mask:0xf
    v_mov_b32_dpp v174, v30 row_newbcast:6 row_mask:0xf bank_mask:0xf
    v_mov_b32_dpp v175, v30 row_newbcast:7 row_mask:0xf bank_mask:0xf
    v_mov_b32_dpp v176, v30 row_newbcast:8 row_mask:0xf bank_mask:0xf
    v_mov_b32_dpp v177, v30 row_newbcast:9 row_mask:0xf bank_mask:0xf
    v_mov_b32_dpp v178, v30 row_newbcast:10 row_mask:0xf bank_mask:0xf
    v_mov_b32_dpp v179, v30 row_newbcast:11 row_mask:0xf bank_mask:0xf
    v_mov_b32_dpp v180, v30 row_newbcast:12 row_mask:0xf bank_mask:0xf
    v_mov_b32_dpp v181, v30 row_newbcast:13 row_mask:0xf bank_mask:0xf
    v_mov_b32_dpp v182, v30 row_newbcast:14 row_mask:0xf bank_mask:0xf
    v_mov_b32_dpp v183, v30 row_newbcast:15 row_mask:0xf bank_mask:0xf
    v_mov_b32_dpp v88, v29 row_newbcast:0 row_mask:0xf bank_mask:0xf
    v_mov_b32_dpp v89, v29 row_newbcast:1 row_mask:0xf bank_mask:0xf
    v_mov_b32_dpp v90, v29 row_newbcast:2 row_mask:0xf bank_mask:0xf
    v_mov_b32_dpp v91, v29 row_newbcast:3 row_mask:0xf bank_mask:0xf
    v_mov_b32_dpp v92, v29 row_newbcast:4 row_mask:0xf bank_mask:0xf
    v_mov_b32_dpp v93, v29 row_newbcast:5 row_mask:0xf bank_mask:0xf
    v_mov_b32_dpp v94, v29 row_newbcast:6 row_mask:0xf bank_mask:0xf
    v_mov_b32_dpp v95, v29 row_newbcast:7 row_mask:0xf bank_mask:0xf
    v_mov_b32_dpp v96, v29 row_newbcast:8 row_mask:0xf bank_mask:0xf
    v_mov_b32_dpp v97, v29 row_newbcast:9 row_mask:0xf bank_mask:0xf
    v_mov_b32_dpp v98, v29 row_newbcast:10 row_mask:0xf bank_mask:0xf
    v_mov_b32_dpp v99, v29 row_newbcast:11 row_mask:0xf bank_mask:0xf
    v_mov_b32_dpp v100, v29 row_newbcast:12 row_mask:0xf bank_mask:0xf
    v_mov_b32_dpp v101, v29 row_newbcast:13 row_mask:0xf bank_mask:0xf
    v_mov_b32_dpp v102, v29 row_newbcast:14 row_mask:0xf bank_mask:0xf
    v_mov_b32_dpp v103, v29 row_newbcast:15 row_mask:0xf bank_mask:0xf
    v_mov_b32_dpp v104, v31 row_newbcast:0 row_mask:0xf bank_mask:0xf
    v_mov_b32_dpp v105, v31 row_newbcast:1 row_mask:0xf bank_mask:0xf
    v_mov_b32_dpp v106, v31 row_newbcast:2 row_mask:0xf bank_mask:0xf
    v_mov_b32_dpp v107, v31 row_newbcast:3 row_mask:0xf bank_mask:0xf
    v_mov_b32_dpp v108, v31 row_newbcast:4 row_mask:0xf bank_mask:0xf
    v_mov_b32_dpp v109, v31 row_newbcast:5 row_mask:0xf bank_mask:0xf
    v_mov_b32_dpp v110, v31 row_newbcast:6 row_mask:0xf bank_mask:0xf
    v_mov_b32_dpp v111, v31 row_newbcast:7 row_mask:0xf bank_mask:0xf
    v_mov_b32_dpp v112, v31 row_newbcast:8 row_mask:0xf bank_mask:0xf
    v_mov_b32_dpp v113, v31 row_newbcast:9 row_mask:0xf bank_mask:0xf
    v_mov_b32_dpp v114, v31 row_newbcast:10 row_mask:0xf bank_mask:0xf
    v_mov_b32_dpp v115, v31 row_newbcast:11 row_mask:0xf bank_mask:0xf
    v_mov_b32_dpp v116, v31 row_newbcast:12 row_mask:0xf bank_mask:0xf
    v_mov_b32_dpp v117, v31 row_newbcast:13 row_mask:0xf bank_mask:0xf
    v_mov_b32_dpp v118, v31 row_newbcast:14 row_mask:0xf bank_mask:0xf
    v_mov_b32_dpp v119, v31 row_newbcast:15 row_mask:0xf bank_mask:0xf
    s_branch SCHK_31
SPOLL_30:
    s_load_dwordx2 s[24:25], s[32:33], s18 offset:0 glc
SCHK_31:
    s_add_u32 s5, s5, 1
    s_cmp_ge_u32 s5, 200000
    s_waitcnt lgkmcnt(0)
    s_cbranch_scc1 SDONE_32
    s_cmp_lg_u32 s24, s4
    s_cbranch_scc1 SPOLL_30
    s_cmp_lg_u32 s25, s4
    s_cbranch_scc1 SPOLL_30
SDONE_32:
    s_add_u32 s20, s17, s19
    buffer_load_dwordx4 v[224:227], v2, s[32:35], s20 offen sc1
    ds_read_b64_tr_b16 v[192:193], v36
    ds_read_b64_tr_b16 v[194:195], v36 offset:512
    ds_read_b64_tr_b16 v[196:197], v37
    ds_read_b64_tr_b16 v[198:199], v37 offset:512
    ds_read_b64_tr_b16 v[200:201], v38
    ds_read_b64_tr_b16 v[202:203], v38 offset:512
    ds_read_b64_tr_b16 v[204:205], v39
    ds_read_b64_tr_b16 v[206:207], v39 offset:512
    ds_read_b64_tr_b16 v[208:209], v36 offset:4096
    ds_read_b64_tr_b16 v[210:211], v36 offset:4608
    ds_read_b64_tr_b16 v[212:213], v37 offset:4096
    ds_read_b64_tr_b16 v[214:215], v37 offset:4608
    ds_read_b64_tr_b16 v[216:217], v38 offset:4096
    ds_read_b64_tr_b16 v[218:219], v38 offset:4608
    buffer_load_dwordx4 v[228:231], v2, s[32:35], s20 offen offset:1024 sc1
    buffer_load_dwordx4 v[232:235], v2, s[32:35], s20 offen offset:2048 sc1
    buffer_load_dwordx4 v[236:239], v2, s[32:35], s20 offen offset:3072 sc1
    s_barrier
    s_xor_b32 s96, s17, 4096
    s_add_u32 s20, s96, s19
    buffer_load_dwordx4 v[240:243], v2, s[32:35], s20 offen sc1
    buffer_load_dwordx4 v[244:247], v2, s[32:35], s20 offen offset:1024 sc1
    buffer_load_dwordx4 v[44:47], v2, s[32:35], s20 offen offset:2048 sc1
    buffer_load_dwordx4 v[48:51], v2, s[32:35], s20 offen offset:3072 sc1
    s_lshl_b32 s96, s21, 10
    s_add_u32 s13, s96, 14155776
    v_and_b32 v10, 15, v1
    v_lshlrev_b32 v10, 6, v10
    s_waitcnt vmcnt(7)
    s_waitcnt lgkmcnt(10)
    v_mfma_f32_16x16x32_bf16 v[120:123], v[192:195], v[224:227], 0
    ds_read_b64_tr_b16 v[220:221], v39 offset:4096
    ds_read_b64_tr_b16 v[222:223], v39 offset:4608
    v_mfma_f32_16x16x32_bf16 v[124:127], v[196:199], v[224:227], 0
    ds_read_b64_tr_b16 v[192:193], v36 offset:8192
    ds_read_b64_tr_b16 v[194:195], v36 offset:8704
    s_waitcnt lgkmcnt(10)
    v_mfma_f32_16x16x32_bf16 v[128:131], v[200:203], v[224:227], 0
    ds_read_b64_tr_b16 v[196:197], v37 offset:8192
    ds_read_b64_tr_b16 v[198:199], v37 offset:8704
    v_mfma_f32_16x16x32_bf16 v[132:135], v[204:207], v[224:227], 0
    ds_read_b64_tr_b16 v[200:201], v38 offset:8192
    ds_read_b64_tr_b16 v[202:203], v38 offset:8704
    s_xor_b32 s96, s17, 8192
    s_add_u32 s20, s96, s19
    buffer_load_dwordx4 v[224:227], v2, s[32:35], s20 offen sc1
    s_waitcnt vmcnt(7)
    s_waitcnt lgkmcnt(10)
    v_mfma_f32_16x16x32_bf16 v[120:123], v[208:211], v[228:231], v[120:123]
    ds_read_b64_tr_b16 v[204:205], v39 offset:8192
    ds_read_b64_tr_b16 v[206:207], v39 offset:8704
    v_mfma_f32_16x16x32_bf16 v[124:127], v[212:215], v[228:231], v[124:127]
    ds_read_b64_tr_b16 v[208:209], v36 offset:12288
    ds_read_b64_tr_b16 v[210:211], v36 offset:12800
    s_waitcnt lgkmcnt(10)
    v_mfma_f32_16x16x32_bf16 v[128:131], v[216:219], v[228:231], v[128:131]
    ds_read_b64_tr_b16 v[212:213], v37 offset:12288
    ds_read_b64_tr_b16 v[214:215], v37 offset:12800
    v_mfma_f32_16x16x32_bf16 v[132:135], v[220:223], v[228:231], v[132:135]
    ds_read_b64_tr_b16 v[216:217], v38 offset:12288
    ds_read_b64_tr_b16 v[218:219], v38 offset:12800
    buffer_load_dwordx4 v[228:231], v2, s[32:35], s20 offen offset:1024 sc1
    s_waitcnt vmcnt(7)
    s_waitcnt lgkmcnt(10)
    v_mfma_f32_16x16x32_bf16 v[120:123], v[192:195], v[232:235], v[120:123]
    ds_read_b64_tr_b16 v[220:221], v39 offset:12288
    ds_read_b64_tr_b16 v[222:223], v39 offset:12800
    v_mfma_f32_16x16x32_bf16 v[124:127], v[196:199], v[232:235], v[124:127]
    v_xor_b32 v36, 16384, v36
    ds_read_b64_tr_b16 v[192:193], v36
    ds_read_b64_tr_b16 v[194:195], v36 offset:512
    s_waitcnt lgkmcnt(10)
    v_mfma_f32_16x16x32_bf16 v[128:131], v[200:203], v[232:235], v[128:131]
    v_xor_b32 v37, 16384, v37
    ds_read_b64_tr_b16 v[196:197], v37
    ds_read_b64_tr_b16 v[198:199], v37 offset:512
    v_mfma_f32_16x16x32_bf16 v[132:135], v[204:207], v[232:235], v[132:135]
    v_xor_b32 v38, 16384, v38
    ds_read_b64_tr_b16 v[200:201], v38
    ds_read_b64_tr_b16 v[202:203], v38 offset:512
    buffer_load_dwordx4 v[232:235], v2, s[32:35], s20 offen offset:2048 sc1
    s_waitcnt vmcnt(7)
    s_waitcnt lgkmcnt(10)
    v_mfma_f32_16x16x32_bf16 v[120:123], v[208:211], v[236:239], v[120:123]
    v_xor_b32 v39, 16384, v39
    ds_read_b64_tr_b16 v[204:205], v39
    ds_read_b64_tr_b16 v[206:207], v39 offset:512
    v_mfma_f32_16x16x32_bf16 v[124:127], v[212:215], v[236:239], v[124:127]
    ds_read_b64_tr_b16 v[208:209], v36 offset:4096
    ds_read_b64_tr_b16 v[210:211], v36 offset:4608
    s_waitcnt lgkmcnt(10)
    v_mfma_f32_16x16x32_bf16 v[128:131], v[216:219], v[236:239], v[128:131]
    ds_read_b64_tr_b16 v[212:213], v37 offset:4096
    ds_read_b64_tr_b16 v[214:215], v37 offset:4608
    v_mfma_f32_16x16x32_bf16 v[132:135], v[220:223], v[236:239], v[132:135]
    ds_read_b64_tr_b16 v[216:217], v38 offset:4096
    ds_read_b64_tr_b16 v[218:219], v38 offset:4608
    buffer_load_dwordx4 v[236:239], v2, s[32:35], s20 offen offset:3072 sc1
    s_waitcnt vmcnt(7)
    s_waitcnt lgkmcnt(10)
    v_mfma_f32_16x16x32_bf16 v[120:123], v[192:195], v[240:243], v[120:123]
    ds_read_b64_tr_b16 v[220:221], v39 offset:4096
    ds_read_b64_tr_b16 v[222:223], v39 offset:4608
    v_mfma_f32_16x16x32_bf16 v[124:127], v[196:199], v[240:243], v[124:127]
    ds_read_b64_tr_b16 v[192:193], v36 offset:8192
    ds_read_b64_tr_b16 v[194:195], v36 offset:8704
    s_waitcnt lgkmcnt(10)
    v_mfma_f32_16x16x32_bf16 v[128:131], v[200:203], v[240:243], v[128:131]
    ds_read_b64_tr_b16 v[196:197], v37 offset:8192
    ds_read_b64_tr_b16 v[198:199], v37 offset:8704
    v_mfma_f32_16x16x32_bf16 v[132:135], v[204:207], v[240:243], v[132:135]
    ds_read_b64_tr_b16 v[200:201], v38 offset:8192
    ds_read_b64_tr_b16 v[202:203], v38 offset:8704
    s_xor_b32 s96, s17, 12288
    s_add_u32 s20, s96, s19
    buffer_load_dwordx4 v[240:243], v2, s[32:35], s20 offen sc1
    s_waitcnt vmcnt(7)
    s_waitcnt lgkmcnt(10)
    v_mfma_f32_16x16x32_bf16 v[120:123], v[208:211], v[244:247], v[120:123]
    ds_read_b64_tr_b16 v[204:205], v39 offset:8192
    ds_read_b64_tr_b16 v[206:207], v39 offset:8704
    v_mfma_f32_16x16x32_bf16 v[124:127], v[212:215], v[244:247], v[124:127]
    ds_read_b64_tr_b16 v[208:209], v36 offset:12288
    ds_read_b64_tr_b16 v[210:211], v36 offset:12800
    s_waitcnt lgkmcnt(10)
    v_mfma_f32_16x16x32_bf16 v[128:131], v[216:219], v[244:247], v[128:131]
    ds_read_b64_tr_b16 v[212:213], v37 offset:12288
    ds_read_b64_tr_b16 v[214:215], v37 offset:12800
    v_mfma_f32_16x16x32_bf16 v[132:135], v[220:223], v[244:247], v[132:135]
    ds_read_b64_tr_b16 v[216:217], v38 offset:12288
    ds_read_b64_tr_b16 v[218:219], v38 offset:12800
    buffer_load_dwordx4 v[244:247], v2, s[32:35], s20 offen offset:1024 sc1
    s_waitcnt vmcnt(7)
    s_waitcnt lgkmcnt(10)
    v_mfma_f32_16x16x32_bf16 v[120:123], v[192:195], v[44:47], v[120:123]
    ds_read_b64_tr_b16 v[220:221], v39 offset:12288
    ds_read_b64_tr_b16 v[222:223], v39 offset:12800
    v_mfma_f32_16x16x32_bf16 v[124:127], v[196:199], v[44:47], v[124:127]
    v_xor_b32 v36, 49152, v36
    ds_read_b64_tr_b16 v[192:193], v36
    ds_read_b64_tr_b16 v[194:195], v36 offset:512
    s_waitcnt lgkmcnt(10)
    v_mfma_f32_16x16x32_bf16 v[128:131], v[200:203], v[44:47], v[128:131]
    v_xor_b32 v37, 49152, v37
    ds_read_b64_tr_b16 v[196:197], v37
    ds_read_b64_tr_b16 v[198:199], v37 offset:512
    v_mfma_f32_16x16x32_bf16 v[132:135], v[204:207], v[44:47], v[132:135]
    v_xor_b32 v38, 49152, v38
    ds_read_b64_tr_b16 v[200:201], v38
    ds_read_b64_tr_b16 v[202:203], v38 offset:512
    buffer_load_dwordx4 v[44:47], v2, s[32:35], s20 offen offset:2048 sc1
    s_waitcnt vmcnt(7)
    s_waitcnt lgkmcnt(10)
    v_mfma_f32_16x16x32_bf16 v[120:123], v[208:211], v[48:51], v[120:123]
    v_xor_b32 v39, 49152, v39
    ds_read_b64_tr_b16 v[204:205], v39
    ds_read_b64_tr_b16 v[206:207], v39 offset:512
    v_mfma_f32_16x16x32_bf16 v[124:127], v[212:215], v[48:51], v[124:127]
    ds_read_b64_tr_b16 v[208:209], v36 offset:4096
    ds_read_b64_tr_b16 v[210:211], v36 offset:4608
    s_waitcnt lgkmcnt(10)
    v_mfma_f32_16x16x32_bf16 v[128:131], v[216:219], v[48:51], v[128:131]
    ds_read_b64_tr_b16 v[212:213], v37 offset:4096
    ds_read_b64_tr_b16 v[214:215], v37 offset:4608
    v_mfma_f32_16x16x32_bf16 v[132:135], v[220:223], v[48:51], v[132:135]
    ds_read_b64_tr_b16 v[216:217], v38 offset:4096
    ds_read_b64_tr_b16 v[218:219], v38 offset:4608
    buffer_load_dwordx4 v[48:51], v2, s[32:35], s20 offen offset:3072 sc1
    s_waitcnt vmcnt(7)
    s_waitcnt lgkmcnt(10)
    v_mfma_f32_16x16x32_bf16 v[120:123], v[192:195], v[224:227], v[120:123]
    ds_read_b64_tr_b16 v[220:221], v39 offset:4096
    ds_read_b64_tr_b16 v[222:223], v39 offset:4608
    v_mfma_f32_16x16x32_bf16 v[124:127], v[196:199], v[224:227], v[124:127]
    ds_read_b64_tr_b16 v[192:193], v36 offset:8192
    ds_read_b64_tr_b16 v[194:195], v36 offset:8704
    s_waitcnt lgkmcnt(10)
    v_mfma_f32_16x16x32_bf16 v[128:131], v[200:203], v[224:227], v[128:131]
L_PAD8:
    s_cbranch_execz L_RET8
    ds_read_b64_tr_b16 v[196:197], v37 offset:8192
    ds_read_b64_tr_b16 v[198:199], v37 offset:8704
    v_mfma_f32_16x16x32_bf16 v[132:135], v[204:207], v[224:227], v[132:135]
    ds_read_b64_tr_b16 v[200:201], v38 offset:8192
    ds_read_b64_tr_b16 v[202:203], v38 offset:8704
    s_xor_b32 s96, s17, 16384
    s_add_u32 s20, s96, s19
    buffer_load_dwordx4 v[224:227], v2, s[32:35], s20 offen sc1
    s_waitcnt vmcnt(7)
    s_waitcnt lgkmcnt(10)
    v_mfma_f32_16x16x32_bf16 v[120:123], v[208:211], v[228:231], v[120:123]
    ds_read_b64_tr_b16 v[204:205], v39 offset:8192
    ds_read_b64_tr_b16 v[206:207], v39 offset:8704
    v_mfma_f32_16x16x32_bf16 v[124:127], v[212:215], v[228:231], v[124:127]
    ds_read_b64_tr_b16 v[208:209], v36 offset:12288
    ds_read_b64_tr_b16 v[210:211], v36 offset:12800
    s_waitcnt lgkmcnt(10)
    v_mfma_f32_16x16x32_bf16 v[128:131], v[216:219], v[228:231], v[128:131]
    ds_read_b64_tr_b16 v[212:213], v37 offset:12288
    ds_read_b64_tr_b16 v[214:215], v37 offset:12800
    v_mfma_f32_16x16x32_bf16 v[132:135], v[220:223], v[228:231], v[132:135]
    ds_read_b64_tr_b16 v[216:217], v38 offset:12288
    ds_read_b64_tr_b16 v[218:219], v38 offset:12800
    buffer_load_dwordx4 v[228:231], v2, s[32:35], s20 offen offset:1024 sc1
    s_waitcnt vmcnt(7)
    s_waitcnt lgkmcnt(10)
    v_mfma_f32_16x16x32_bf16 v[120:123], v[192:195], v[232:235], v[120:123]
    ds_read_b64_tr_b16 v[220:221], v39 offset:12288
    ds_read_b64_tr_b16 v[222:223], v39 offset:12800
    v_mfma_f32_16x16x32_bf16 v[124:127], v[196:199], v[232:235], v[124:127]
    v_xor_b32 v36, 16384, v36
    ds_read_b64_tr_b16 v[192:193], v36
    ds_read_b64_tr_b16 v[194:195], v36 offset:512
    s_waitcnt lgkmcnt(10)
    v_mfma_f32_16x16x32_bf16 v[128:131], v[200:203], v[232:235], v[128:131]
    v_xor_b32 v37, 16384, v37
    ds_read_b64_tr_b16 v[196:197], v37
    ds_read_b64_tr_b16 v[198:199], v37 offset:512
    v_mfma_f32_16x16x32_bf16 v[132:135], v[204:207], v[232:235], v[132:135]
    v_xor_b32 v38, 16384, v38
    ds_read_b64_tr_b16 v[200:201], v38
    ds_read_b64_tr_b16 v[202:203], v38 offset:512
    buffer_load_dwordx4 v[232:235], v2, s[32:35], s20 offen offset:2048 sc1
    s_waitcnt vmcnt(7)
    s_waitcnt lgkmcnt(10)
    v_mfma_f32_16x16x32_bf16 v[120:123], v[208:211], v[236:239], v[120:123]
    v_xor_b32 v39, 16384, v39
    ds_read_b64_tr_b16 v[204:205], v39
    ds_read_b64_tr_b16 v[206:207], v39 offset:512
    v_mfma_f32_16x16x32_bf16 v[124:127], v[212:215], v[236:239], v[124:127]
    ds_read_b64_tr_b16 v[208:209], v36 offset:4096
    ds_read_b64_tr_b16 v[210:211], v36 offset:4608
    s_waitcnt lgkmcnt(10)
    v_mfma_f32_16x16x32_bf16 v[128:131], v[216:219], v[236:239], v[128:131]
    ds_read_b64_tr_b16 v[212:213], v37 offset:4096
    ds_read_b64_tr_b16 v[214:215], v37 offset:4608
    v_mfma_f32_16x16x32_bf16 v[132:135], v[220:223], v[236:239], v[132:135]
    ds_read_b64_tr_b16 v[216:217], v38 offset:4096
    ds_read_b64_tr_b16 v[218:219], v38 offset:4608
    buffer_load_dwordx4 v[236:239], v2, s[32:35], s20 offen offset:3072 sc1
    s_waitcnt vmcnt(7)
    s_waitcnt lgkmcnt(10)
    v_mfma_f32_16x16x32_bf16 v[120:123], v[192:195], v[240:243], v[120:123]
    ds_read_b64_tr_b16 v[220:221], v39 offset:4096
    ds_read_b64_tr_b16 v[222:223], v39 offset:4608
    v_mfma_f32_16x16x32_bf16 v[124:127], v[196:199], v[240:243], v[124:127]
    ds_read_b64_tr_b16 v[192:193], v36 offset:8192
    ds_read_b64_tr_b16 v[194:195], v36 offset:8704
    s_waitcnt lgkmcnt(10)
    v_mfma_f32_16x16x32_bf16 v[128:131], v[200:203], v[240:243], v[128:131]
    ds_read_b64_tr_b16 v[196:197], v37 offset:8192
    ds_read_b64_tr_b16 v[198:199], v37 offset:8704
    v_mfma_f32_16x16x32_bf16 v[132:135], v[204:207], v[240:243], v[132:135]
    ds_read_b64_tr_b16 v[200:201], v38 offset:8192
    ds_read_b64_tr_b16 v[202:203], v38 offset:8704
    s_xor_b32 s96, s17, 20480
    s_add_u32 s20, s96, s19
    buffer_load_dwordx4 v[240:243], v2, s[32:35], s20 offen sc1
    s_waitcnt vmcnt(7)
    s_waitcnt lgkmcnt(10)
    v_mfma_f32_16x16x32_bf16 v[120:123], v[208:211], v[244:247], v[120:123]
    ds_read_b64_tr_b16 v[204:205], v39 offset:8192
    ds_read_b64_tr_b16 v[206:207], v39 offset:8704
    v_mfma_f32_16x16x32_bf16 v[124:127], v[212:215], v[244:247], v[124:127]
    ds_read_b64_tr_b16 v[208:209], v36 offset:12288
    ds_read_b64_tr_b16 v[210:211], v36 offset:12800
    s_waitcnt lgkmcnt(10)
    v_mfma_f32_16x16x32_bf16 v[128:131], v[216:219], v[244:247], v[128:131]
    ds_read_b64_tr_b16 v[212:213], v37 offset:12288
    ds_read_b64_tr_b16 v[214:215], v37 offset:12800
    v_mfma_f32_16x16x32_bf16 v[132:135], v[220:223], v[244:247], v[132:135]
    ds_read_b64_tr_b16 v[216:217], v38 offset:12288
    ds_read_b64_tr_b16 v[218:219], v38 offset:12800
    buffer_load_dwordx4 v[244:247], v2, s[32:35], s20 offen offset:1024 sc1
    s_waitcnt vmcnt(7)
    s_waitcnt lgkmcnt(10)
    v_mfma_f32_16x16x32_bf16 v[120:123], v[192:195], v[44:47], v[120:123]
    ds_read_b64_tr_b16 v[220:221], v39 offset:12288
    ds_read_b64_tr_b16 v[222:223], v39 offset:12800
    v_mfma_f32_16x16x32_bf16 v[124:127], v[196:199], v[44:47], v[124:127]
    v_xor_b32 v36, 114688, v36
    ds_read_b64_tr_b16 v[192:193], v36
    ds_read_b64_tr_b16 v[194:195], v36 offset:512
    s_waitcnt lgkmcnt(10)
    v_mfma_f32_16x16x32_bf16 v[128:131], v[200:203], v[44:47], v[128:131]
    v_xor_b32 v37, 114688, v37
    ds_read_b64_tr_b16 v[196:197], v37
    ds_read_b64_tr_b16 v[198:199], v37 offset:512
    v_mfma_f32_16x16x32_bf16 v[132:135], v[204:207], v[44:47], v[132:135]
    v_xor_b32 v38, 114688, v38
    ds_read_b64_tr_b16 v[200:201], v38
    ds_read_b64_tr_b16 v[202:203], v38 offset:512
    buffer_load_dwordx4 v[44:47], v2, s[32:35], s20 offen offset:2048 sc1
    s_waitcnt vmcnt(7)
    s_waitcnt lgkmcnt(10)
    v_mfma_f32_16x16x32_bf16 v[120:123], v[208:211], v[48:51], v[120:123]
    v_xor_b32 v39, 114688, v39
    ds_read_b64_tr_b16 v[204:205], v39
    ds_read_b64_tr_b16 v[206:207], v39 offset:512
    v_mfma_f32_16x16x32_bf16 v[124:127], v[212:215], v[48:51], v[124:127]
    ds_read_b64_tr_b16 v[208:209], v36 offset:4096
    ds_read_b64_tr_b16 v[210:211], v36 offset:4608
    s_waitcnt lgkmcnt(10)
    v_mfma_f32_16x16x32_bf16 v[128:131], v[216:219], v[48:51], v[128:131]
    ds_read_b64_tr_b16 v[212:213], v37 offset:4096
    ds_read_b64_tr_b16 v[214:215], v37 offset:4608
    v_mfma_f32_16x16x32_bf16 v[132:135], v[220:223], v[48:51], v[132:135]
    ds_read_b64_tr_b16 v[216:217], v38 offset:4096
    ds_read_b64_tr_b16 v[218:219], v38 offset:4608
    buffer_load_dwordx4 v[48:51], v2, s[32:35], s20 offen offset:3072 sc1
    s_waitcnt vmcnt(7)
    s_waitcnt lgkmcnt(10)
    v_mfma_f32_16x16x32_bf16 v[120:123], v[192:195], v[224:227], v[120:123]
    ds_read_b64_tr_b16 v[220:221], v39 offset:4096
    ds_read_b64_tr_b16 v[222:223], v39 offset:4608
    v_mfma_f32_16x16x32_bf16 v[124:127], v[196:199], v[224:227], v[124:127]
    ds_read_b64_tr_b16 v[192:193], v36 offset:8192
    ds_read_b64_tr_b16 v[194:195], v36 offset:8704
    s_waitcnt lgkmcnt(10)
    v_mfma_f32_16x16x32_bf16 v[128:131], v[200:203], v[224:227], v[128:131]
    ds_read_b64_tr_b16 v[196:197], v37 offset:8192
    ds_read_b64_tr_b16 v[198:199], v37 offset:8704
    v_mfma_f32_16x16x32_bf16 v[132:135], v[204:207], v[224:227], v[132:135]
    ds_read_b64_tr_b16 v[200:201], v38 offset:8192
    ds_read_b64_tr_b16 v[202:203], v38 offset:8704
    s_xor_b32 s96, s17, 24576
    s_add_u32 s20, s96, s19
    buffer_load_dwordx4 v[224:227], v2, s[32:35], s20 offen sc1
    s_waitcnt vmcnt(7)
    s_waitcnt lgkmcnt(10)
    v_mfma_f32_16x16x32_bf16 v[120:123], v[208:211], v[228:231], v[120:123]
    ds_read_b64_tr_b16 v[204:205], v39 offset:8192
    ds_read_b64_tr_b16 v[206:207], v39 offset:8704
    v_mfma_f32_16x16x32_bf16 v[124:127], v[212:215], v[228:231], v[124:127]
    ds_read_b64_tr_b16 v[208:209], v36 offset:12288
    ds_read_b64_tr_b16 v[210:211], v36 offset:12800
    s_waitcnt lgkmcnt(10)
    v_mfma_f32_16x16x32_bf16 v[128:131], v[216:219], v[228:231], v[128:131]
    ds_read_b64_tr_b16 v[212:213], v37 offset:12288
    ds_read_b64_tr_b16 v[214:215], v37 offset:12800
    v_mfma_f32_16x16x32_bf16 v[132:135], v[220:223], v[228:231], v[132:135]
    ds_read_b64_tr_b16 v[216:217], v38 offset:12288
    ds_read_b64_tr_b16 v[218:219], v38 offset:12800
    buffer_load_dwordx4 v[228:231], v2, s[32:35], s20 offen offset:1024 sc1
    s_waitcnt vmcnt(7)
    s_waitcnt lgkmcnt(10)
    v_mfma_f32_16x16x32_bf16 v[120:123], v[192:195], v[232:235], v[120:123]
    ds_read_b64_tr_b16 v[220:221], v39 offset:12288
    ds_read_b64_tr_b16 v[222:223], v39 offset:12800
    v_mfma_f32_16x16x32_bf16 v[124:127], v[196:199], v[232:235], v[124:127]
    v_xor_b32 v36, 16384, v36
    ds_read_b64_tr_b16 v[192:193], v36
    ds_read_b64_tr_b16 v[194:195], v36 offset:512
    s_waitcnt lgkmcnt(10)
    v_mfma_f32_16x16x32_bf16 v[128:131], v[200:203], v[232:235], v[128:131]
    v_xor_b32 v37, 16384, v37
    ds_read_b64_tr_b16 v[196:197], v37
    ds_read_b64_tr_b16 v[198:199], v37 offset:512
    v_mfma_f32_16x16x32_bf16 v[132:135], v[204:207], v[232:235], v[132:135]
    v_xor_b32 v38, 16384, v38
    ds_read_b64_tr_b16 v[200:201], v38
    ds_read_b64_tr_b16 v[202:203], v38 offset:512
    buffer_load_dwordx4 v[232:235], v2, s[32:35], s20 offen offset:2048 sc1
    s_waitcnt vmcnt(7)
    s_waitcnt lgkmcnt(10)
    v_mfma_f32_16x16x32_bf16 v[120:123], v[208:211], v[236:239], v[120:123]
    v_xor_b32 v39, 16384, v39
    ds_read_b64_tr_b16 v[204:205], v39
    ds_read_b64_tr_b16 v[206:207], v39 offset:512
    v_mfma_f32_16x16x32_bf16 v[124:127], v[212:215], v[236:239], v[124:127]
    ds_read_b64_tr_b16 v[208:209], v36 offset:4096
    ds_read_b64_tr_b16 v[210:211], v36 offset:4608
    s_waitcnt lgkmcnt(10)
    v_mfma_f32_16x16x32_bf16 v[128:131], v[216:219], v[236:239], v[128:131]
    ds_read_b64_tr_b16 v[212:213], v37 offset:4096
    ds_read_b64_tr_b16 v[214:215], v37 offset:4608
    v_mfma_f32_16x16x32_bf16 v[132:135], v[220:223], v[236:239], v[132:135]
    ds_read_b64_tr_b16 v[216:217], v38 offset:4096
    ds_read_b64_tr_b16 v[218:219], v38 offset:4608
    buffer_load_dwordx4 v[236:239], v2, s[32:35], s20 offen offset:3072 sc1
    s_waitcnt vmcnt(7)
    s_waitcnt lgkmcnt(10)
    v_mfma_f32_16x16x32_bf16 v[120:123], v[192:195], v[240:243], v[120:123]
    ds_read_b64_tr_b16 v[220:221], v39 offset:4096
    ds_read_b64_tr_b16 v[222:223], v39 offset:4608
    v_mfma_f32_16x16x32_bf16 v[124:127], v[196:199], v[240:243], v[124:127]
    ds_read_b64_tr_b16 v[192:193], v36 offset:8192
    ds_read_b64_tr_b16 v[194:195], v36 offset:8704
    s_waitcnt lgkmcnt(10)
    v_mfma_f32_16x16x32_bf16 v[128:131], v[200:203], v[240:243], v[128:131]
    ds_read_b64_tr_b16 v[196:197], v37 offset:8192
    ds_read_b64_tr_b16 v[198:199], v37 offset:8704
    v_mfma_f32_16x16x32_bf16 v[132:135], v[204:207], v[240:243], v[132:135]
    ds_read_b64_tr_b16 v[200:201], v38 offset:8192
    ds_read_b64_tr_b16 v[202:203], v38 offset:8704
    s_xor_b32 s96, s17, 28672
    s_add_u32 s20, s96, s19
    buffer_load_dwordx4 v[240:243], v2, s[32:35], s20 offen sc1
    s_waitcnt vmcnt(7)
    s_waitcnt lgkmcnt(10)
    v_mfma_f32_16x16x32_bf16 v[120:123], v[208:211], v[244:247], v[120:123]
    ds_read_b64_tr_b16 v[204:205], v39 offset:8192
    ds_read_b64_tr_b16 v[206:207], v39 offset:8704
    v_mfma_f32_16x16x32_bf16 v[124:127], v[212:215], v[244:247], v[124:127]
    ds_read_b64_tr_b16 v[208:209], v36 offset:12288
    ds_read_b64_tr_b16 v[210:211], v36 offset:12800
    s_waitcnt lgkmcnt(10)
    v_mfma_f32_16x16x32_bf16 v[128:131], v[216:219], v[244:247], v[128:131]
    ds_read_b64_tr_b16 v[212:213], v37 offset:12288
    ds_read_b64_tr_b16 v[214:215], v37 offset:12800
    v_mfma_f32_16x16x32_bf16 v[132:135], v[220:223], v[244:247], v[132:135]
    ds_read_b64_tr_b16 v[216:217], v38 offset:12288
    ds_read_b64_tr_b16 v[218:219], v38 offset:12800
    buffer_load_dwordx4 v[244:247], v2, s[32:35], s20 offen offset:1024 sc1
    s_waitcnt vmcnt(7)
    s_waitcnt lgkmcnt(10)
    v_mfma_f32_16x16x32_bf16 v[120:123], v[192:195], v[44:47], v[120:123]
    ds_read_b64_tr_b16 v[220:221], v39 offset:12288
    ds_read_b64_tr_b16 v[222:223], v39 offset:12800
    v_mfma_f32_16x16x32_bf16 v[124:127], v[196:199], v[44:47], v[124:127]
    v_xor_b32 v36, 49152, v36
    ds_read_b64_tr_b16 v[192:193], v36
    ds_read_b64_tr_b16 v[194:195], v36 offset:512
    s_waitcnt lgkmcnt(10)
    v_mfma_f32_16x16x32_bf16 v[128:131], v[200:203], v[44:47], v[128:131]
    v_xor_b32 v37, 49152, v37
    ds_read_b64_tr_b16 v[196:197], v37
    ds_read_b64_tr_b16 v[198:199], v37 offset:512
    v_mfma_f32_16x16x32_bf16 v[132:135], v[204:207], v[44:47], v[132:135]
    v_xor_b32 v38, 49152, v38
    ds_read_b64_tr_b16 v[200:201], v38
    ds_read_b64_tr_b16 v[202:203], v38 offset:512
    buffer_load_dwordx4 v[44:47], v2, s[32:35], s20 offen offset:2048 sc1
    s_waitcnt vmcnt(7)
    s_waitcnt lgkmcnt(10)
    v_mfma_f32_16x16x32_bf16 v[120:123], v[208:211], v[48:51], v[120:123]
    v_xor_b32 v39, 49152, v39
    ds_read_b64_tr_b16 v[204:205], v39
    ds_read_b64_tr_b16 v[206:207], v39 offset:512
    v_mfma_f32_16x16x32_bf16 v[124:127], v[212:215], v[48:51], v[124:127]
    ds_read_b64_tr_b16 v[208:209], v36 offset:4096
    ds_read_b64_tr_b16 v[210:211], v36 offset:4608
    s_waitcnt lgkmcnt(10)
    v_mfma_f32_16x16x32_bf16 v[128:131], v[216:219], v[48:51], v[128:131]
    ds_read_b64_tr_b16 v[212:213], v37 offset:4096
    ds_read_b64_tr_b16 v[214:215], v37 offset:4608
    v_mfma_f32_16x16x32_bf16 v[132:135], v[220:223], v[48:51], v[132:135]
    ds_read_b64_tr_b16 v[216:217], v38 offset:4096
    ds_read_b64_tr_b16 v[218:219], v38 offset:4608
    buffer_load_dwordx4 v[48:51], v2, s[32:35], s20 offen offset:3072 sc1
    buffer_load_dwordx2 v[40:41], v10, s[32:35], s13 offen sc1
    s_cmp_ge_u32 s3, 4
    s_cbranch_scc1 L_FH_33
    s_mov_b32 s82, s80
    buffer_load_dwordx4 v[56:59], v27, s[56:59], s82 offen nt
    s_add_u32 s82, s80, 917504
    buffer_load_dwordx4 v[60:63], v27, s[56:59], s82 offen nt
    s_add_u32 s82, s80, 57344
    buffer_load_dwordx4 v[64:67], v27, s[56:59], s82 offen nt
    s_add_u32 s82, s80, 974848
    buffer_load_dwordx4 v[68:71], v27, s[56:59], s82 offen nt
L_FH_33:
    s_waitcnt vmcnt(8)
    s_waitcnt lgkmcnt(10)
    v_mfma_f32_16x16x32_bf16 v[120:123], v[192:195], v[224:227], v[120:123]
    ds_read_b64_tr_b16 v[220:221], v39 offset:4096
    ds_read_b64_tr_b16 v[222:223], v39 offset:4608
    v_mfma_f32_16x16x32_bf16 v[124:127], v[196:199], v[224:227], v[124:127]
    ds_read_b64_tr_b16 v[192:193], v36 offset:8192
    ds_read_b64_tr_b16 v[194:195], v36 offset:8704
    s_waitcnt lgkmcnt(10)
    v_mfma_f32_16x16x32_bf16 v[128:131], v[200:203], v[224:227], v[128:131]
    ds_read_b64_tr_b16 v[196:197], v37 offset:8192
    ds_read_b64_tr_b16 v[198:199], v37 offset:8704
    v_mfma_f32_16x16x32_bf16 v[132:135], v[204:207], v[224:227], v[132:135]
    ds_read_b64_tr_b16 v[200:201], v38 offset:8192
    ds_read_b64_tr_b16 v[202:203], v38 offset:8704
    s_waitcnt vmcnt(7)
    s_waitcnt lgkmcnt(10)
    v_mfma_f32_16x16x32_bf16 v[120:123], v[208:211], v[228:231], v[120:123]
    ds_read_b64_tr_b16 v[204:205], v39 offset:8192
    ds_read_b64_tr_b16 v[206:207], v39 offset:8704
    v_mfma_f32_16x16x32_bf16 v[124:127], v[212:215], v[228:231], v[124:127]
    ds_read_b64_tr_b16 v[208:209], v36 offset:12288
    ds_read_b64_tr_b16 v[210:211], v36 offset:12800
    s_waitcnt lgkmcnt(10)
    v_mfma_f32_16x16x32_bf16 v[128:131], v[216:219], v[228:231], v[128:131]
    ds_read_b64_tr_b16 v[212:213], v37 offset:12288
    ds_read_b64_tr_b16 v[214:215], v37 offset:12800
    v_mfma_f32_16x16x32_bf16 v[132:135], v[220:223], v[228:231], v[132:135]
    ds_read_b64_tr_b16 v[216:217], v38 offset:12288
    ds_read_b64_tr_b16 v[218:219], v38 offset:12800
    s_waitcnt vmcnt(6)
    s_waitcnt lgkmcnt(10)
    v_mfma_f32_16x16x32_bf16 v[120:123], v[192:195], v[232:235], v[120:123]
    ds_read_b64_tr_b16 v[220:221], v39 offset:12288
    ds_read_b64_tr_b16 v[222:223], v39 offset:12800
    v_mfma_f32_16x16x32_bf16 v[124:127], v[196:199], v[232:235], v[124:127]
    v_xor_b32 v36, 16384, v36
    ds_read_b64_tr_b16 v[192:193], v36
    ds_read_b64_tr_b16 v[194:195], v36 offset:512
    s_waitcnt lgkmcnt(10)
    v_mfma_f32_16x16x32_bf16 v[128:131], v[200:203], v[232:235], v[128:131]
    v_xor_b32 v37, 16384, v37
    ds_read_b64_tr_b16 v[196:197], v37
    ds_read_b64_tr_b16 v[198:199], v37 offset:512
    v_mfma_f32_16x16x32_bf16 v[132:135], v[204:207], v[232:235], v[132:135]
    v_xor_b32 v38, 16384, v38
    ds_read_b64_tr_b16 v[200:201], v38
    ds_read_b64_tr_b16 v[202:203], v38 offset:512
    s_waitcnt vmcnt(5)
    s_waitcnt lgkmcnt(10)
    v_mfma_f32_16x16x32_bf16 v[120:123], v[208:211], v[236:239], v[120:123]
    v_xor_b32 v39, 16384, v39
    ds_read_b64_tr_b16 v[204:205], v39
    ds_read_b64_tr_b16 v[206:207], v39 offset:512
    v_mfma_f32_16x16x32_bf16 v[124:127], v[212:215], v[236:239], v[124:127]
    ds_read_b64_tr_b16 v[208:209], v36 offset:4096
    ds_read_b64_tr_b16 v[210:211], v36 offset:4608
    s_waitcnt lgkmcnt(10)
    v_mfma_f32_16x16x32_bf16 v[128:131], v[216:219], v[236:239], v[128:131]
    ds_read_b64_tr_b16 v[212:213], v37 offset:4096
    ds_read_b64_tr_b16 v[214:215], v37 offset:4608
    v_mfma_f32_16x16x32_bf16 v[132:135], v[220:223], v[236:239], v[132:135]
    ds_read_b64_tr_b16 v[216:217], v38 offset:4096
    ds_read_b64_tr_b16 v[218:219], v38 offset:4608
    s_waitcnt vmcnt(4)
    s_waitcnt lgkmcnt(10)
    v_mfma_f32_16x16x32_bf16 v[120:123], v[192:195], v[240:243], v[120:123]
    ds_read_b64_tr_b16 v[220:221], v39 offset:4096
    ds_read_b64_tr_b16 v[222:223], v39 offset:4608
    v_mfma_f32_16x16x32_bf16 v[124:127], v[196:199], v[240:243], v[124:127]
    ds_read_b64_tr_b16 v[192:193], v36 offset:8192
    ds_read_b64_tr_b16 v[194:195], v36 offset:8704
    s_waitcnt lgkmcnt(10)
    v_mfma_f32_16x16x32_bf16 v[128:131], v[200:203], v[240:243], v[128:131]
    ds_read_b64_tr_b16 v[196:197], v37 offset:8192
    ds_read_b64_tr_b16 v[198:199], v37 offset:8704
    v_mfma_f32_16x16x32_bf16 v[132:135], v[204:207], v[240:243], v[132:135]
    ds_read_b64_tr_b16 v[200:201], v38 offset:8192
    ds_read_b64_tr_b16 v[202:203], v38 offset:8704
    s_waitcnt vmcnt(3)
    s_waitcnt lgkmcnt(10)
    v_mfma_f32_16x16x32_bf16 v[120:123], v[208:211], v[244:247], v[120:123]
    ds_read_b64_tr_b16 v[204:205], v39 offset:8192
    ds_read_b64_tr_b16 v[206:207], v39 offset:8704
    v_mfma_f32_16x16x32_bf16 v[124:127], v[212:215], v[244:247], v[124:127]
    ds_read_b64_tr_b16 v[208:209], v36 offset:12288
    ds_read_b64_tr_b16 v[210:211], v36 offset:12800
    s_waitcnt lgkmcnt(10)
    v_mfma_f32_16x16x32_bf16 v[128:131], v[216:219], v[244:247], v[128:131]
    ds_read_b64_tr_b16 v[212:213], v37 offset:12288
    ds_read_b64_tr_b16 v[214:215], v37 offset:12800
    v_mfma_f32_16x16x32_bf16 v[132:135], v[220:223], v[244:247], v[132:135]
    ds_read_b64_tr_b16 v[216:217], v38 offset:12288
    ds_read_b64_tr_b16 v[218:219], v38 offset:12800
    s_waitcnt vmcnt(2)
    s_waitcnt lgkmcnt(10)
    v_mfma_f32_16x16x32_bf16 v[120:123], v[192:195], v[44:47], v[120:123]
    ds_read_b64_tr_b16 v[220:221], v39 offset:12288
    ds_read_b64_tr_b16 v[222:223], v39 offset:12800
    v_mfma_f32_16x16x32_bf16 v[124:127], v[196:199], v[44:47], v[124:127]
    s_waitcnt lgkmcnt(8)
    v_mfma_f32_16x16x32_bf16 v[128:131], v[200:203], v[44:47], v[128:131]
    v_mfma_f32_16x16x32_bf16 v[132:135], v[204:207], v[44:47], v[132:135]
    s_waitcnt vmcnt(1)
    s_waitcnt lgkmcnt(4)
    v_mfma_f32_16x16x32_bf16 v[120:123], v[208:211], v[48:51], v[120:123]
    v_mfma_f32_16x16x32_bf16 v[124:127], v[212:215], v[48:51], v[124:127]
    s_waitcnt lgkmcnt(0)
    v_mfma_f32_16x16x32_bf16 v[128:131], v[216:219], v[48:51], v[128:131]
    v_mfma_f32_16x16x32_bf16 v[132:135], v[220:223], v[48:51], v[132:135]
    s_lshl3_add_u32 s96, s21, s3
    s_lshl4_add_u32 s97, s96, s12
    s_lshl_b32 s98, s97, 8
    s_add_u32 s14, s98, 12582912
    v_and_b32 v28, 15, v1
    v_lshlrev_b32 v28, 4, v28
    v_lshrrev_b32 v9, 4, v1
    v_lshl_add_u32 v28, v9, 2, v28
    v_cvt_pk_bf16_f32 v120, 0, v120
    v_cvt_pk_bf16_f32 v121, 0, v121
    v_cvt_pk_bf16_f32 v122, 0, v122
    v_cvt_pk_bf16_f32 v123, 0, v123
    v_cvt_pk_bf16_f32 v124, 0, v124
    v_cvt_pk_bf16_f32 v125, 0, v125
    v_cvt_pk_bf16_f32 v126, 0, v126
    v_cvt_pk_bf16_f32 v127, 0, v127
    v_pk_mul_f32 v[120:121], v[120:121], v[136:137]
    v_pk_mul_f32 v[122:123], v[122:123], v[138:139]
    v_pk_mul_f32 v[124:125], v[124:125], v[140:141]
    v_pk_mul_f32 v[126:127], v[126:127], v[142:143]
    v_cvt_pk_bf16_f32 v120, 0, v120
    v_cvt_pk_bf16_f32 v121, 0, v121
    v_cvt_pk_bf16_f32 v122, 0, v122
    v_cvt_pk_bf16_f32 v123, 0, v123
    v_cvt_pk_bf16_f32 v124, 0, v124
    v_cvt_pk_bf16_f32 v125, 0, v125
    v_cvt_pk_bf16_f32 v126, 0, v126
    v_cvt_pk_bf16_f32 v127, 0, v127
    v_pk_add_f32 v[120:121], v[120:121], v[152:153]
    v_pk_add_f32 v[122:123], v[122:123], v[154:155]
    v_pk_add_f32 v[124:125], v[124:125], v[156:157]
    v_pk_add_f32 v[126:127], v[126:127], v[158:159]
    v_cvt_pk_bf16_f32 v12, v120, v121
    v_cvt_pk_bf16_f32 v13, v122, v123
    v_cvt_pk_bf16_f32 v14, v124, v125
    v_cvt_pk_bf16_f32 v15, v126, v127
    v_dot2_f32_bf16 v4, v12, v12, 0
    v_dot2_f32_bf16 v5, v13, v13, 0
    v_dot2_f32_bf16 v4, v14, v14, v4
    v_dot2_f32_bf16 v5, v15, v15, v5
    v_mfma_f32_16x16x32_bf16 v[240:243], v[184:187], v[12:15], 0
    v_cvt_pk_bf16_f32 v128, 0, v128
    v_cvt_pk_bf16_f32 v129, 0, v129
    v_cvt_pk_bf16_f32 v130, 0, v130
    v_cvt_pk_bf16_f32 v131, 0, v131
    v_cvt_pk_bf16_f32 v132, 0, v132
    v_cvt_pk_bf16_f32 v133, 0, v133
    v_cvt_pk_bf16_f32 v134, 0, v134
    v_cvt_pk_bf16_f32 v135, 0, v135
    v_pk_mul_f32 v[128:129], v[128:129], v[144:145]
    v_pk_mul_f32 v[130:131], v[130:131], v[146:147]
    v_pk_mul_f32 v[132:133], v[132:133], v[148:149]
    v_pk_mul_f32 v[134:135], v[134:135], v[150:151]
    v_cvt_pk_bf16_f32 v128, 0, v128
    v_cvt_pk_bf16_f32 v129, 0, v129
    v_cvt_pk_bf16_f32 v130, 0, v130
    v_cvt_pk_bf16_f32 v131, 0, v131
    v_cvt_pk_bf16_f32 v132, 0, v132
    v_cvt_pk_bf16_f32 v133, 0, v133
    v_cvt_pk_bf16_f32 v134, 0, v134
    v_cvt_pk_bf16_f32 v135, 0, v135
    v_pk_add_f32 v[128:129], v[128:129], v[160:161]
    v_pk_add_f32 v[130:131], v[130:131], v[162:163]
    v_pk_add_f32 v[132:133], v[132:133], v[164:165]
    v_pk_add_f32 v[134:135], v[134:135], v[166:167]
    v_cvt_pk_bf16_f32 v16, v128, v129
    v_cvt_pk_bf16_f32 v17, v130, v131
    v_cvt_pk_bf16_f32 v18, v132, v133
    v_cvt_pk_bf16_f32 v19, v134, v135
    v_dot2_f32_bf16 v4, v16, v16, v4
    v_dot2_f32_bf16 v5, v17, v17, v5
    v_dot2_f32_bf16 v4, v18, v18, v4
    v_dot2_f32_bf16 v5, v19, v19, v5
    v_mfma_f32_16x16x32_bf16 v[240:243], v[188:191], v[16:19], v[240:243]
    v_and_b32 v7, 7, v1
    v_lshlrev_b32 v7, 15, v7
    v_bfe_u32 v9, v1, 3, 1
    v_lshl_add_u32 v7, v9, 12, v7
    v_add_f32 v4, v4, v5
    v_mov_b32 v5, v4
    s_nop 1
    v_permlane32_swap_b32 v4, v5
    v_add_f32 v4, v4, v5
    v_mov_b32 v5, v4
    s_nop 1
    v_permlane16_swap_b32 v4, v5
    v_add_f32 v4, v4, v5
    s_nop 1
    v_mov_b32_dpp v240, v4 quad_perm:[0,1,2,3] row_mask:0x8 bank_mask:0xf
    buffer_store_dword v240, v28, s[32:35], s14 offen sc1
    s_and_b32 s96, s12, 1
    s_lshr_b32 s97, s21, 2
    s_and_b32 s98, s21, 3
    s_lshl_b32 s99, s98, 6
    s_lshl1_add_u32 s98, s97, s99
    s_lshl_b32 s97, s98, 12
    s_lshr_b32 s99, s12, 1
    s_lshl_b32 s98, s99, 6
    s_add_u32 s99, s97, s98
    s_lshl2_add_u32 s97, s96, s99
    s_add_u32 s98, s97, 1048576
    s_add_u32 s16, s98, 1536
    s_barrier
    s_cmp_lg_u32 s3, 0
    s_cbranch_scc1 L_PE
    v_mov_b32 v6, s4
    s_mov_b32 exec_hi, 0
    s_mov_b32 exec_lo, 65535
    buffer_store_dword v6, v7, s[32:35], s16 offen sc1
    s_mov_b64 exec, -1
L_PE:
    s_add_u32 s82, s80, 114688
    s_lshl2_add_u32 m0, s83, 34816
    s_nop 0
    buffer_load_dwordx4 v27, s[56:59], s82 offen nt lds
    s_add_u32 s82, s80, 172032
    s_lshl2_add_u32 m0, s83, 35840
    s_nop 0
    buffer_load_dwordx4 v27, s[56:59], s82 offen nt lds
    s_lshl_b32 s15, s3, 12
    v_add_u32 v4, s15, v2
    v_add_u32 v7, 65536, v4
    s_waitcnt vmcnt(3)
    v_cmp_ne_u32 vcc, s4, v41
    s_cbranch_vccz L_UPOK
POLL_34:
    buffer_load_dwordx2 v[40:41], v10, s[32:35], s13 offen sc1
    s_waitcnt vmcnt(0)
    v_cmp_ne_u32 vcc, s4, v41
    s_cbranch_vccz PDONE_35
    s_add_u32 s5, s5, 1
    s_cmp_lt_u32 s5, 200000
    s_cbranch_scc1 POLL_34
PDONE_35:
L_UPOK:
    s_lshl3_add_u32 s96, s21, s3
    s_lshl_b32 s97, s96, 12
    s_add_u32 s14, s97, 12582912
    s_load_dwordx2 s[24:25], s[32:33], s92 offset:1536 glc
    v_add_f32_dpp v40, v40, v40 quad_perm:[1,0,3,2] row_mask:0xf bank_mask:0xf
    s_nop 1
    v_add_f32_dpp v40, v40, v40 quad_perm:[2,3,0,1] row_mask:0xf bank_mask:0xf
    s_nop 1
    v_add_f32_dpp v40, v40, v40 row_half_mirror row_mask:0xf bank_mask:0xf
    s_nop 1
    v_add_f32_dpp v40, v40, v40 row_mirror row_mask:0xf bank_mask:0xf
    v_lshlrev_b32 v152, 16, v12
    v_and_b32 v153, s6, v12
    v_lshlrev_b32 v154, 16, v13
    v_and_b32 v155, s6, v13
    v_lshlrev_b32 v156, 16, v14
    v_and_b32 v157, s6, v14
    v_lshlrev_b32 v158, 16, v15
    v_and_b32 v159, s6, v15
    v_lshlrev_b32 v160, 16, v16
    v_and_b32 v161, s6, v16
    v_lshlrev_b32 v162, 16, v17
    v_and_b32 v163, s6, v17
    v_lshlrev_b32 v164, 16, v18
    v_and_b32 v165, s6, v18
    v_lshlrev_b32 v166, 16, v19
    v_and_b32 v167, s6, v19
    s_lshl_b32 s96, s3, 9
    s_lshl1_add_u32 s15, s21, s96
    v_and_b32 v29, 15, v1
    v_lshl_add_u32 v29, v29, 5, s15
    v_xor_b32 v5, 0x4000, v4
    v_xor_b32 v8, 0x4000, v7
    s_waitcnt vmcnt(2)
    s_cmp_ge_u32 s3, 4
    s_cbranch_scc1 L_FW0
    ds_write_b128 v4, v[56:59] offset:32768
    ds_write_b128 v5, v[60:63] offset:32768
    ds_write_b128 v4, v[64:67] offset:33792
    ds_write_b128 v5, v[68:71] offset:33792
L_FW0:
    s_cmp_lt_u32 s3, 4
    s_cbranch_scc1 L_FW1
    ds_write_b128 v4, v[56:59] offset:0
    ds_write_b128 v5, v[60:63] offset:0
    ds_write_b128 v4, v[64:67] offset:1024
    ds_write_b128 v5, v[68:71] offset:1024
    ds_write_b128 v4, v[72:75] offset:2048
    ds_write_b128 v5, v[76:79] offset:2048
    ds_write_b128 v4, v[80:83] offset:3072
    ds_write_b128 v5, v[84:87] offset:3072
L_FW1:
    s_branch SCHK_37
SPOLL_36:
    s_load_dwordx2 s[24:25], s[32:33], s92 offset:1536 glc
SCHK_37:
    s_add_u32 s5, s5, 1
    s_cmp_ge_u32 s5, 200000
    s_waitcnt lgkmcnt(0)
    s_cbranch_scc1 SDONE_38
    s_cmp_lg_u32 s24, s4
    s_cbranch_scc1 SPOLL_36
    s_cmp_lg_u32 s25, s4
    s_cbranch_scc1 SPOLL_36
SDONE_38:
    s_barrier
    buffer_load_dwordx4 v[192:195], v2, s[32:35], s14 offen sc1
    buffer_load_dwordx4 v[196:199], v2, s[32:35], s14 offen offset:1024 sc1
    buffer_load_dwordx4 v[200:203], v2, s[32:35], s14 offen offset:2048 sc1
    buffer_load_dwordx4 v[204:207], v2, s[32:35], s14 offen offset:3072 sc1
    s_mov_b32 s82, s81
    s_lshl2_add_u32 m0, s83, 65536
    s_nop 0
    buffer_load_dwordx4 v253, s[60:63], s82 offen nt lds
    s_add_u32 s82, s81, 4096
    s_lshl2_add_u32 m0, s83, 66560
L_PAD9:
    s_cbranch_execz L_RET9
    s_nop 0
    buffer_load_dwordx4 v253, s[60:63], s82 offen nt lds
    s_add_u32 s82, s81, 8192
    s_lshl2_add_u32 m0, s83, 67584
    s_nop 0
    buffer_load_dwordx4 v253, s[60:63], s82 offen nt lds
    s_add_u32 s82, s81, 12288
    s_lshl2_add_u32 m0, s83, 68608
    s_nop 0
    buffer_load_dwordx4 v253, s[60:63], s82 offen nt lds
    s_lshl3_add_u32 s15, s3, 156160
    v_mov_b32 v4, s15
    v_and_b32 v5, 7, v1
    v_lshlrev_b32 v5, 3, v5
    v_add_u32 v5, 156160, v5
    v_and_b32 v6, 3, v1
    v_lshlrev_b32 v6, 18, v6
    v_bfe_u32 v9, v1, 2, 2
    v_lshl_add_u32 v6, v9, 13, v6
    s_and_b32 s96, s21, 1
    s_and_b32 s97, s12, 7
    s_lshr_b32 s98, s12, 3
    s_lshl3_add_u32 s99, s97, s98
    s_lshl_b32 s97, s99, 12
    s_lshr_b32 s98, s21, 1
    s_lshl_b32 s99, s98, 6
    s_add_u32 s98, s97, s99
    s_lshl4_add_u32 s97, s96, s98
    s_add_u32 s99, s97, 1048576
    s_add_u32 s16, s99, 2560
    s_waitcnt vmcnt(4)
    v_pk_add_f32 v[192:193], v[192:193], v[196:197]
    v_pk_add_f32 v[200:201], v[200:201], v[204:205]
    v_pk_add_f32 v[194:195], v[194:195], v[198:199]
    v_pk_add_f32 v[202:203], v[202:203], v[206:207]
    v_pk_add_f32 v[192:193], v[192:193], v[200:201]
    v_pk_add_f32 v[194:195], v[194:195], v[202:203]
    v_add_f32 v193, v193, v194
    v_add_f32 v197, v192, v195
    v_cmp_u_f32 vcc, v193, v197
    s_cbranch_vccz POK_40
PRE_41:
    buffer_load_dwordx4 v[192:195], v2, s[32:35], s14 offen sc1
    buffer_load_dwordx4 v[196:199], v2, s[32:35], s14 offen offset:1024 sc1
    buffer_load_dwordx4 v[200:203], v2, s[32:35], s14 offen offset:2048 sc1
    buffer_load_dwordx4 v[204:207], v2, s[32:35], s14 offen offset:3072 sc1
    s_waitcnt vmcnt(0)
    v_pk_add_f32 v[192:193], v[192:193], v[196:197]
    v_pk_add_f32 v[200:201], v[200:201], v[204:205]
    v_pk_add_f32 v[194:195], v[194:195], v[198:199]
    v_pk_add_f32 v[202:203], v[202:203], v[206:207]
    v_pk_add_f32 v[192:193], v[192:193], v[200:201]
    v_pk_add_f32 v[194:195], v[194:195], v[202:203]
    v_add_f32 v193, v193, v194
    v_add_f32 v197, v192, v195
    v_cmp_u_f32 vcc, v193, v197
    s_cbranch_vccz POK_40
    s_add_u32 s5, s5, 1
    s_cmp_lt_u32 s5, 200000
    s_cbranch_scc1 PRE_41
POK_40:
    v_mov_b32 v196, v195
    s_nop 1
    v_permlane32_swap_b32 v195, v196
    v_permlane32_swap_b32 v192, v193
    v_add_f32 v195, v195, v196
    v_add_f32 v192, v192, v193
    s_nop 1
    v_permlane16_swap_b32 v192, v195
    v_add_f32 v193, v192, v195
    v_add_f32 v195, v192, v195
    s_nop 1
    v_permlane16_swap_b32 v193, v195
    v_mov_b32 v192, v193
    v_mul_f32 v195, 0x3a800000, v195
    s_nop 0
    v_permlane32_swap_b32 v192, v193
    v_mul_f32 v192, 0x3a800000, v192
    v_fma_f32 v31, -v192, v192, v195
    v_cvt_pk_bf16_f32 v30, 0, v192
    v_max_f32 v31, 0, v31
    v_cvt_pk_bf16_f32 v31, 0, v31
    v_fma_f32 v193, -v30, v40, v193
    v_add_f32 v31, 0x3727c5ac, v31
    v_cvt_pk_bf16_f32 v31, 0, v31
    v_sqrt_f32 v31, v31
    s_nop 0
    v_cvt_pk_bf16_f32 v31, 0, v31
    v_rcp_f32 v31, v31
    s_nop 0
    v_mul_f32 v32, v193, v31
    v_ashrrev_i32 v196, 31, v32
    v_or_b32 v196, 0x80000000, v196
    v_xor_b32 v32, v32, v196
    s_mov_b32 s15, 0xfffff000
    v_and_or_b32 v32, v32, s15, v29
    s_nop 1
    v_max_u32_dpp v244, v32, v32 quad_perm:[1,0,3,2] row_mask:0xf bank_mask:0xf
    v_min_u32_dpp v245, v32, v32 quad_perm:[1,0,3,2] row_mask:0xf bank_mask:0xf
    s_nop 0
    v_min_u32_dpp v196, v244, v244 quad_perm:[2,3,0,1] row_mask:0xf bank_mask:0xf
    v_max_u32_dpp v245, v245, v245 quad_perm:[2,3,0,1] row_mask:0xf bank_mask:0xf
    v_max_u32_dpp v244, v244, v244 quad_perm:[2,3,0,1] row_mask:0xf bank_mask:0xf
    v_max_u32 v245, v245, v196
    s_nop 0
    v_min_u32_dpp v196, v244, v244 row_half_mirror row_mask:0xf bank_mask:0xf
    v_max_u32_dpp v245, v245, v245 row_half_mirror row_mask:0xf bank_mask:0xf
    v_max_u32_dpp v244, v244, v244 row_half_mirror row_mask:0xf bank_mask:0xf
    v_max_u32 v245, v245, v196
    s_nop 0
    v_min_u32_dpp v196, v244, v244 row_mirror row_mask:0xf bank_mask:0xf
    v_max_u32_dpp v245, v245, v245 row_mirror row_mask:0xf bank_mask:0xf
    v_max_u32_dpp v244, v244, v244 row_mirror row_mask:0xf bank_mask:0xf
    v_max_u32 v245, v245, v196
    ds_write_b64 v4, v[244:245]
    s_waitcnt lgkmcnt(0)
    s_barrier
    ds_read_b64 v[244:245], v5
    v_pk_add_f32 v[208:209], v[152:153], v[30:31] op_sel_hi:[1,0] neg_lo:[0,1] neg_hi:[0,1]
    v_pk_add_f32 v[210:211], v[154:155], v[30:31] op_sel_hi:[1,0] neg_lo:[0,1] neg_hi:[0,1]
    v_pk_add_f32 v[212:213], v[156:157], v[30:31] op_sel_hi:[1,0] neg_lo:[0,1] neg_hi:[0,1]
    v_pk_add_f32 v[214:215], v[158:159], v[30:31] op_sel_hi:[1,0] neg_lo:[0,1] neg_hi:[0,1]
    v_pk_add_f32 v[216:217], v[160:161], v[30:31] op_sel_hi:[1,0] neg_lo:[0,1] neg_hi:[0,1]
    v_pk_add_f32 v[218:219], v[162:163], v[30:31] op_sel_hi:[1,0] neg_lo:[0,1] neg_hi:[0,1]
    v_pk_add_f32 v[220:221], v[164:165], v[30:31] op_sel_hi:[1,0] neg_lo:[0,1] neg_hi:[0,1]
    v_pk_add_f32 v[222:223], v[166:167], v[30:31] op_sel_hi:[1,0] neg_lo:[0,1] neg_hi:[0,1]
    s_waitcnt lgkmcnt(0)
    v_min_u32_dpp v196, v244, v244 quad_perm:[1,0,3,2] row_mask:0xf bank_mask:0xf
    v_max_u32_dpp v245, v245, v245 quad_perm:[1,0,3,2] row_mask:0xf bank_mask:0xf
    v_max_u32_dpp v244, v244, v244 quad_perm:[1,0,3,2] row_mask:0xf bank_mask:0xf
    v_max_u32 v245, v245, v196
    s_nop 0
    v_min_u32_dpp v196, v244, v244 quad_perm:[2,3,0,1] row_mask:0xf bank_mask:0xf
    v_max_u32_dpp v245, v245, v245 quad_perm:[2,3,0,1] row_mask:0xf bank_mask:0xf
    v_max_u32_dpp v244, v244, v244 quad_perm:[2,3,0,1] row_mask:0xf bank_mask:0xf
    v_max_u32 v245, v245, v196
    s_nop 0
    v_min_u32_dpp v196, v244, v244 row_half_mirror row_mask:0xf bank_mask:0xf
    v_max_u32_dpp v245, v245, v245 row_half_mirror row_mask:0xf bank_mask:0xf
    v_max_u32_dpp v244, v244, v244 row_half_mirror row_mask:0xf bank_mask:0xf
    v_max_u32 v245, v245, v196
    v_cmp_eq_u32 s[88:89], v32, v245
    v_cmp_eq_u32 vcc, v32, v244
    v_or_b32 v246, 1, v245
    v_mov_b32 v245, s4
    v_mov_b32 v247, s4
    s_or_b64 s[84:85], vcc, s[88:89]
    s_cmp_lg_u32 s3, 0
    s_cbranch_scc1 L_NOF
    s_mov_b64 exec, 0xffff
    buffer_store_dwordx4 v[244:247], v6, s[32:35], s16 offen sc1
    s_mov_b64 exec, -1
L_NOF:
    s_lshl4_add_u32 s13, s3, 156288
    v_mov_b32 v4, s13
    v_and_b32 v5, 7, v1
    v_lshlrev_b32 v5, 4, v5
    v_add_u32 v5, 156288, v5
    s_load_dwordx8 s[24:31], s[32:33], s92 offset:2560 glc
    v_cvt_pk_bf16_f32 v208, 0, v208
    v_cvt_pk_bf16_f32 v209, 0, v209
    v_cvt_pk_bf16_f32 v210, 0, v210
    v_cvt_pk_bf16_f32 v211, 0, v211
    v_cvt_pk_bf16_f32 v212, 0, v212
    v_cvt_pk_bf16_f32 v213, 0, v213
    v_cvt_pk_bf16_f32 v214, 0, v214
    v_cvt_pk_bf16_f32 v215, 0, v215
    v_cvt_pk_bf16_f32 v216, 0, v216
    v_cvt_pk_bf16_f32 v217, 0, v217
    v_cvt_pk_bf16_f32 v218, 0, v218
    v_cvt_pk_bf16_f32 v219, 0, v219
    v_cvt_pk_bf16_f32 v220, 0, v220
    v_cvt_pk_bf16_f32 v221, 0, v221
    v_cvt_pk_bf16_f32 v222, 0, v222
    v_cvt_pk_bf16_f32 v223, 0, v223
    v_pk_mul_f32 v[208:209], v[208:209], v[30:31] op_sel:[0,1]
    v_pk_mul_f32 v[210:211], v[210:211], v[30:31] op_sel:[0,1]
    v_pk_mul_f32 v[212:213], v[212:213], v[30:31] op_sel:[0,1]
    v_pk_mul_f32 v[214:215], v[214:215], v[30:31] op_sel:[0,1]
    v_pk_mul_f32 v[216:217], v[216:217], v[30:31] op_sel:[0,1]
    v_pk_mul_f32 v[218:219], v[218:219], v[30:31] op_sel:[0,1]
    v_pk_mul_f32 v[220:221], v[220:221], v[30:31] op_sel:[0,1]
    v_pk_mul_f32 v[222:223], v[222:223], v[30:31] op_sel:[0,1]
    v_cvt_pk_bf16_f32 v208, 0, v208
    v_cvt_pk_bf16_f32 v209, 0, v209
    v_cvt_pk_bf16_f32 v210, 0, v210
    v_cvt_pk_bf16_f32 v211, 0, v211
    v_cvt_pk_bf16_f32 v212, 0, v212
    v_cvt_pk_bf16_f32 v213, 0, v213
    v_cvt_pk_bf16_f32 v214, 0, v214
    v_cvt_pk_bf16_f32 v215, 0, v215
    v_cvt_pk_bf16_f32 v216, 0, v216
    v_cvt_pk_bf16_f32 v217, 0, v217
    v_cvt_pk_bf16_f32 v218, 0, v218
    v_cvt_pk_bf16_f32 v219, 0, v219
    v_cvt_pk_bf16_f32 v220, 0, v220
    v_cvt_pk_bf16_f32 v221, 0, v221
    v_cvt_pk_bf16_f32 v222, 0, v222
    v_cvt_pk_bf16_f32 v223, 0, v223
    v_pk_mul_f32 v[208:209], v[208:209], v[168:169]
    v_pk_mul_f32 v[210:211], v[210:211], v[170:171]
    v_pk_mul_f32 v[212:213], v[212:213], v[172:173]
    v_pk_mul_f32 v[214:215], v[214:215], v[174:175]
    v_pk_mul_f32 v[216:217], v[216:217], v[176:177]
    v_pk_mul_f32 v[218:219], v[218:219], v[178:179]
    v_pk_mul_f32 v[220:221], v[220:221], v[180:181]
    v_pk_mul_f32 v[222:223], v[222:223], v[182:183]
    v_cvt_pk_bf16_f32 v208, 0, v208
    v_cvt_pk_bf16_f32 v209, 0, v209
    v_cvt_pk_bf16_f32 v210, 0, v210
    v_cvt_pk_bf16_f32 v211, 0, v211
    v_cvt_pk_bf16_f32 v212, 0, v212
    v_cvt_pk_bf16_f32 v213, 0, v213
    v_cvt_pk_bf16_f32 v214, 0, v214
    v_cvt_pk_bf16_f32 v215, 0, v215
    v_cvt_pk_bf16_f32 v216, 0, v216
    v_cvt_pk_bf16_f32 v217, 0, v217
    v_cvt_pk_bf16_f32 v218, 0, v218
    v_cvt_pk_bf16_f32 v219, 0, v219
    v_cvt_pk_bf16_f32 v220, 0, v220
    v_cvt_pk_bf16_f32 v221, 0, v221
    v_cvt_pk_bf16_f32 v222, 0, v222
    v_cvt_pk_bf16_f32 v223, 0, v223
    v_pk_add_f32 v[208:209], v[208:209], v[88:89]
    v_pk_add_f32 v[210:211], v[210:211], v[90:91]
    v_pk_add_f32 v[212:213], v[212:213], v[92:93]
    v_pk_add_f32 v[214:215], v[214:215], v[94:95]
    v_pk_add_f32 v[216:217], v[216:217], v[96:97]
    v_pk_add_f32 v[218:219], v[218:219], v[98:99]
    v_pk_add_f32 v[220:221], v[220:221], v[100:101]
    v_pk_add_f32 v[222:223], v[222:223], v[102:103]
    v_cvt_pk_bf16_f32 v224, v208, v209
    v_cvt_pk_bf16_f32 v225, v210, v211
    v_cvt_pk_bf16_f32 v226, v212, v213
    v_cvt_pk_bf16_f32 v227, v214, v215
    v_cvt_pk_bf16_f32 v228, v216, v217
    v_cvt_pk_bf16_f32 v229, v218, v219
    v_cvt_pk_bf16_f32 v230, v220, v221
    v_cvt_pk_bf16_f32 v231, v222, v223
    s_cmp_eq_u64 s[84:85], 0
    s_cbranch_scc1 L_NOCAND
    v_mfma_f32_16x16x32_bf16 v[240:243], v[184:187], v[224:227], 0
    v_mfma_f32_16x16x32_bf16 v[240:243], v[188:191], v[228:231], v[240:243]
    v_mov_b32 v232, v224
    v_mov_b32 v233, v225
    v_mov_b32 v234, v226
    v_mov_b32 v235, v227
    v_mov_b32 v236, v228
    v_mov_b32 v237, v229
    v_mov_b32 v238, v230
    v_mov_b32 v239, v231
    s_lshl_b32 s96, s21, 14
    s_lshl_b32 s97, s12, 9
    s_add_u32 s98, s96, s97
    s_add_u32 s15, s98, 13631488
    v_lshrrev_b32 v7, 4, v1
    v_lshlrev_b32 v7, 4, v7
    v_add_u32 v8, 8192, v7
    v_permlane32_swap_b32 v232, v234
    v_permlane32_swap_b32 v233, v235
    v_permlane32_swap_b32 v236, v238
    v_permlane32_swap_b32 v237, v239
    v_permlane32_swap_b32 v12, v14
    v_permlane32_swap_b32 v13, v15
    v_permlane32_swap_b32 v16, v18
    v_permlane32_swap_b32 v17, v19
    v_cndmask_b32 v7, v7, v8, s[88:89]
    s_mov_b64 exec, s[84:85]
    buffer_store_dwordx4 v[232:235], v7, s[32:35], s15 offen sc1
    buffer_store_dwordx4 v[236:239], v7, s[32:35], s15 offen offset:64 sc1
    s_mov_b32 exec_lo, 0
    s_and_b32 exec_hi, s85, 0xffff0000
    buffer_store_dword v240, v7, s[32:35], s15 offen offset:208 sc1
    s_mov_b64 exec, s[84:85]
    buffer_store_dwordx4 v[12:15], v7, s[32:35], s15 offen offset:128 sc1
    buffer_store_dwordx4 v[16:19], v7, s[32:35], s15 offen offset:192 sc1
    s_mov_b64 exec, -1
L_NOCAND:
    v_lshlrev_b32 v208, 16, v224
    v_and_b32 v209, s6, v224
    v_lshlrev_b32 v210, 16, v225
    v_and_b32 v211, s6, v225
    v_lshlrev_b32 v212, 16, v226
    v_and_b32 v213, s6, v226
    v_lshlrev_b32 v214, 16, v227
    v_and_b32 v215, s6, v227
    v_lshlrev_b32 v216, 16, v228
    v_and_b32 v217, s6, v228
    v_lshlrev_b32 v218, 16, v229
    v_and_b32 v219, s6, v229
    v_lshlrev_b32 v220, 16, v230
    v_and_b32 v221, s6, v230
    v_lshlrev_b32 v222, 16, v231
    v_and_b32 v223, s6, v231
    v_pk_mul_f32 v[208:209], v[208:209], v[104:105]
    v_pk_mul_f32 v[210:211], v[210:211], v[106:107]
    v_pk_mul_f32 v[212:213], v[212:213], v[108:109]
    v_pk_mul_f32 v[214:215], v[214:215], v[110:111]
    v_pk_mul_f32 v[216:217], v[216:217], v[112:113]
    v_pk_mul_f32 v[218:219], v[218:219], v[114:115]
    v_pk_mul_f32 v[220:221], v[220:221], v[116:117]
    v_pk_mul_f32 v[222:223], v[222:223], v[118:119]
    v_cvt_pk_bf16_f32 v208, 0, v208
    v_cvt_pk_bf16_f32 v209, 0, v209
    v_cvt_pk_bf16_f32 v210, 0, v210
    v_cvt_pk_bf16_f32 v211, 0, v211
    v_cvt_pk_bf16_f32 v212, 0, v212
    v_cvt_pk_bf16_f32 v213, 0, v213
    v_cvt_pk_bf16_f32 v214, 0, v214
    v_cvt_pk_bf16_f32 v215, 0, v215
    v_cvt_pk_bf16_f32 v216, 0, v216
    v_cvt_pk_bf16_f32 v217, 0, v217
    v_cvt_pk_bf16_f32 v218, 0, v218
    v_cvt_pk_bf16_f32 v219, 0, v219
    v_cvt_pk_bf16_f32 v220, 0, v220
    v_cvt_pk_bf16_f32 v221, 0, v221
    v_cvt_pk_bf16_f32 v222, 0, v222
    v_cvt_pk_bf16_f32 v223, 0, v223
    s_lshl_b32 s96, s3, 11
    s_add_u32 s13, s96, 98304
    v_lshrrev_b32 v202, 4, v1
    v_lshlrev_b32 v202, 4, v202
    v_and_b32 v203, 7, v1
    v_lshlrev_b32 v203, 4, v203
    v_xor_b32 v202, v202, v203
    v_and_b32 v204, 15, v1
    v_lshl_add_u32 v204, v204, 7, s13
    v_add_u32 v202, v202, v204
    v_xor_b32 v204, 64, v202
    v_lshrrev_b32 v205, 3, v1
    v_lshlrev_b32 v205, 4, v205
    v_xor_b32 v203, v205, v203
    v_lshrrev_b32 v205, 3, v1
    v_lshl_add_u32 v205, v205, 7, s13
    v_add_u32 v203, v203, v205
    s_lshl_b32 s96, s21, 7
    s_sub_u32 s97, 2047, s96
    s_lshl_b32 s98, s3, 4
    s_sub_u32 s13, s97, s98
    v_lshrrev_b32 v43, 3, v1
    v_sub_u32 v42, s13, v43
    v_subrev_u32 v43, 8, v42
    v_lshrrev_b32 v33, 3, v1
    v_lshlrev_b32 v33, 11, v33
    v_and_b32 v9, 7, v1
    v_lshl_add_u32 v33, v9, 4, v33
    s_branch SCHK_43
SPOLL_42:
    s_load_dwordx8 s[24:31], s[32:33], s92 offset:2560 glc
SCHK_43:
    s_add_u32 s5, s5, 1
    s_cmp_ge_u32 s5, 200000
    s_waitcnt lgkmcnt(0)
    s_cbranch_scc1 SDONE_44
    s_cmp_lg_u32 s25, s4
    s_cbranch_scc1 SPOLL_42
    s_cmp_lg_u32 s27, s4
    s_cbranch_scc1 SPOLL_42
    s_cmp_lg_u32 s29, s4
    s_cbranch_scc1 SPOLL_42
    s_cmp_lg_u32 s31, s4
    s_cbranch_scc1 SPOLL_42
SDONE_44:
    s_min_u32 s25, s24, s28
    s_min_u32 s27, s26, s28
    s_min_u32 s29, s24, s30
    s_max_u32 s24, s24, s28
    s_max_u32 s26, s26, s30
    s_max_u32 s27, s27, s29
    s_max_u32 s25, s25, s26
    v_mov_b32 v244, s24
    v_mov_b32 v246, s27
    v_mov_b32 v245, s25
    ds_write_b128 v4, v[244:247]
    v_pk_add_f32 v[208:209], v[208:209], v[152:153]
    v_pk_add_f32 v[210:211], v[210:211], v[154:155]
    v_pk_add_f32 v[212:213], v[212:213], v[156:157]
    v_pk_add_f32 v[214:215], v[214:215], v[158:159]
    v_pk_add_f32 v[216:217], v[216:217], v[160:161]
    v_pk_add_f32 v[218:219], v[218:219], v[162:163]
    v_pk_add_f32 v[220:221], v[220:221], v[164:165]
    v_pk_add_f32 v[222:223], v[222:223], v[166:167]
    v_cvt_pk_bf16_f32 v232, v208, v209
    v_cvt_pk_bf16_f32 v233, v210, v211
    v_cvt_pk_bf16_f32 v234, v212, v213
    v_cvt_pk_bf16_f32 v235, v214, v215
    v_cvt_pk_bf16_f32 v236, v216, v217
    v_cvt_pk_bf16_f32 v237, v218, v219
    v_cvt_pk_bf16_f32 v238, v220, v221
    v_cvt_pk_bf16_f32 v239, v222, v223
    v_permlane32_swap_b32 v232, v234
    v_permlane32_swap_b32 v233, v235
    v_permlane32_swap_b32 v236, v238
    v_permlane32_swap_b32 v237, v239
    ds_write_b128 v202, v[232:235]
    ds_write_b128 v204, v[236:239]
    ds_read_b128 v[232:235], v203
    ds_read_b128 v[236:239], v203 offset:1024
    s_lshl3_add_u32 s96, s21, s3
    s_lshl_b32 s97, s96, 15
    s_lshl_b32 s98, s12, 7
    s_add_u32 s16, s97, s98
    s_add_u32 s15, s16, 16384
    s_lshr_b32 s96, s3, 2
    s_lshl_b32 s97, s96, 15
    s_and_b32 s98, s3, 3
    s_lshl_b32 s99, s98, 5
    s_add_u32 s13, s97, s99
    v_lshrrev_b32 v34, 4, v1
    v_lshlrev_b32 v34, 13, v34
    v_bfe_u32 v9, v1, 2, 2
    v_lshl_add_u32 v34, v9, 7, v34
    v_bfe_u32 v9, v1, 3, 2
    v_lshl_add_u32 v34, v9, 5, v34
    v_and_b32 v9, 3, v1
    v_lshl_add_u32 v34, v9, 3, v34
    v_xor_b32 v34, s13, v34
    s_lshl_b32 s96, s75, 11
    s_add_u32 s13, s96, 13631488
    v_and_b32 v36, 7, v1
    v_lshl_add_u32 v36, v36, 4, s13
    v_lshrrev_b32 v9, 4, v1
    v_lshl_add_u32 v36, v9, 9, v36
    v_and_b32 v10, 15, v1
    v_lshlrev_b32 v10, 9, v10
    v_add_u32 v10, 13631744, v10
    s_waitcnt vmcnt(0)
    s_waitcnt lgkmcnt(0)
    s_barrier
    ds_read_b128 v[244:247], v5
    v_and_b32 v8, 8, v1
    v_cmp_eq_u32 s[22:23], 0, v8
    v_cmp_gt_u32 s[24:25], 16, v1
    v_cmp_gt_u32 s[26:27], 32, v1
    s_waitcnt lgkmcnt(0)
    v_min_u32_dpp v192, v244, v244 quad_perm:[1,0,3,2] row_mask:0xf bank_mask:0xf
    v_min_u32_dpp v193, v245, v244 quad_perm:[1,0,3,2] row_mask:0xf bank_mask:0xf
    v_min_u32_dpp v194, v244, v245 quad_perm:[1,0,3,2] row_mask:0xf bank_mask:0xf
    v_max_u32_dpp v246, v246, v246 quad_perm:[1,0,3,2] row_mask:0xf bank_mask:0xf
    v_max_u32_dpp v245, v245, v245 quad_perm:[1,0,3,2] row_mask:0xf bank_mask:0xf
    v_max_u32_dpp v244, v244, v244 quad_perm:[1,0,3,2] row_mask:0xf bank_mask:0xf
    v_max3_u32 v246, v246, v193, v194
    v_max_u32 v245, v245, v192
    v_min_u32_dpp v192, v244, v244 quad_perm:[2,3,0,1] row_mask:0xf bank_mask:0xf
    s_nop 0
    v_min_u32_dpp v193, v245, v244 quad_perm:[2,3,0,1] row_mask:0xf bank_mask:0xf
    v_min_u32_dpp v194, v244, v245 quad_perm:[2,3,0,1] row_mask:0xf bank_mask:0xf
    v_max_u32_dpp v246, v246, v246 quad_perm:[2,3,0,1] row_mask:0xf bank_mask:0xf
    v_max_u32_dpp v245, v245, v245 quad_perm:[2,3,0,1] row_mask:0xf bank_mask:0xf
    v_max_u32_dpp v244, v244, v244 quad_perm:[2,3,0,1] row_mask:0xf bank_mask:0xf
    v_max3_u32 v246, v246, v193, v194
    v_max_u32 v245, v245, v192
    v_min_u32_dpp v192, v244, v244 row_half_mirror row_mask:0xf bank_mask:0xf
    s_nop 0
    v_min_u32_dpp v193, v245, v244 row_half_mirror row_mask:0xf bank_mask:0xf
    v_min_u32_dpp v194, v244, v245 row_half_mirror row_mask:0xf bank_mask:0xf
    v_max_u32_dpp v246, v246, v246 row_half_mirror row_mask:0xf bank_mask:0xf
    v_max_u32_dpp v245, v245, v245 row_half_mirror row_mask:0xf bank_mask:0xf
    v_max_u32_dpp v244, v244, v244 row_half_mirror row_mask:0xf bank_mask:0xf
    v_max3_u32 v246, v246, v193, v194
    v_max_u32 v245, v245, v192
    v_cndmask_b32 v192, v245, v244, s[22:23]
    v_cndmask_b32 v201, v246, v245, s[26:27]
    v_and_b32 v193, 31, v246
    v_and_b32 v192, 31, v192
    v_cndmask_b32 v201, v201, v244, s[24:25]
    v_lshl_add_u32 v4, v192, 13, v36
    v_lshl_add_u32 v5, v193, 13, v36
    v_and_b32 v194, 31, v201
    v_lshl_add_u32 v6, v194, 13, v10
    buffer_load_dwordx4 v[192:195], v4, s[32:35], 0 offen sc1
    buffer_load_dwordx4 v[196:199], v5, s[32:35], 0 offen sc1
    buffer_load_dword v200, v6, s[32:35], 0 offen sc1
    v_readfirstlane_b32 s91, v244
    v_readfirstlane_b32 s94, v245
    v_readfirstlane_b32 s95, v246
    ds_read_b64_tr_b16 v[56:57], v34
    ds_read_b64_tr_b16 v[58:59], v34 offset:512
    ds_read_b64_tr_b16 v[60:61], v34 offset:1024
    ds_read_b64_tr_b16 v[62:63], v34 offset:1536
    ds_read_b64_tr_b16 v[64:65], v34 offset:2048
    ds_read_b64_tr_b16 v[66:67], v34 offset:2560
    ds_read_b64_tr_b16 v[68:69], v34 offset:3072
    ds_read_b64_tr_b16 v[70:71], v34 offset:3584
    ds_read_b64_tr_b16 v[72:73], v34 offset:4096
    ds_read_b64_tr_b16 v[74:75], v34 offset:4608
    ds_read_b64_tr_b16 v[76:77], v34 offset:5120
    ds_read_b64_tr_b16 v[78:79], v34 offset:5632
    ds_read_b64_tr_b16 v[80:81], v34 offset:6144
    ds_read_b64_tr_b16 v[82:83], v34 offset:6656
    ds_read_b64_tr_b16 v[84:85], v34 offset:7168
    ds_read_b64_tr_b16 v[86:87], v34 offset:7680
    s_bfe_u32 s96, s91, 262145
    s_lshl_b32 s97, s96, 7
    s_bfe_u32 s98, s91, 458757
    s_add_u32 s99, s97, s98
    s_xor_b32 s17, s99, 2047
    s_bfe_u32 s96, s94, 262145
    s_lshl_b32 s97, s96, 7
    s_bfe_u32 s98, s94, 458757
    s_add_u32 s99, s97, s98
    s_xor_b32 s18, s99, 2047
    s_bfe_u32 s96, s95, 262145
    s_lshl_b32 s97, s96, 7
    s_bfe_u32 s98, s95, 458757
    s_add_u32 s99, s97, s98
    s_xor_b32 s19, s99, 2047
    s_waitcnt lgkmcnt(0)
    v_cmp_ne_u32 s[24:25], s17, v42
    v_cmp_ne_u32 s[26:27], s18, v42
    v_cmp_ne_u32 s[28:29], s19, v42
    s_and_b64 vcc, s[24:25], s[26:27]
    s_and_b64 exec, vcc, s[28:29]
    buffer_store_dwordx4 v[232:235], v33, s[64:67], s16 offen sc1
    s_mov_b64 exec, -1
    v_cmp_ne_u32 s[24:25], s17, v43
    v_cmp_ne_u32 s[26:27], s18, v43
    v_cmp_ne_u32 s[28:29], s19, v43
    s_and_b64 vcc, s[24:25], s[26:27]
    s_and_b64 exec, vcc, s[28:29]
    buffer_store_dwordx4 v[236:239], v33, s[64:67], s15 offen sc1
    s_mov_b64 exec, -1
    s_lshl_b32 s13, s3, 6
    v_bfe_u32 v35, v1, 2, 1
    v_lshlrev_b32 v35, 9, v35
    v_bfe_u32 v9, v1, 3, 1
    v_lshl_add_u32 v35, v9, 12, v35
    v_lshrrev_b32 v9, 5, v1
    v_lshl_add_u32 v35, v9, 11, v35
    v_bfe_u32 v9, v1, 2, 2
    v_lshl_add_u32 v35, v9, 6, v35
    v_bfe_u32 v9, v1, 4, 1
    v_lshl_add_u32 v35, v9, 5, v35
    v_and_b32 v9, 3, v1
    v_lshl_add_u32 v35, v9, 3, v35
    v_xor_b32 v35, s13, v35
    v_add_u32 v35, 65536, v35
    v_and_b32 v8, 15, v1
    v_lshlrev_b32 v8, 4, v8
    v_lshrrev_b32 v9, 5, v1
    v_lshl_add_u32 v8, v9, 3, v8
    s_lshl_b32 s96, s74, 13
    s_add_u32 s14, s96, 20971520
    s_lshl3_add_u32 s96, s75, s3
    s_lshl_b32 s97, s96, 8
    s_add_u32 s20, s97, s14
    v_bfe_u32 v7, v201, 1, 4
    v_bfe_u32 v201, v201, 5, 7
    v_lshl_or_b32 v201, v7, 7, v201
    v_xor_b32 v201, 0x7ff, v201
    s_waitcnt vmcnt(2)
    v_max3_u32 v7, v192, v196, v200
    v_cmp_eq_u32 vcc, -1, v7
    s_cbranch_vccz POK_46
PRE_47:
    buffer_load_dwordx4 v[192:195], v4, s[32:35], 0 offen sc1
    buffer_load_dwordx4 v[196:199], v5, s[32:35], 0 offen sc1
    buffer_load_dword v200, v6, s[32:35], 0 offen sc1
    s_waitcnt vmcnt(0)
    v_max3_u32 v7, v192, v196, v200
    v_cmp_eq_u32 vcc, -1, v7
    s_cbranch_vccz POK_46
    s_add_u32 s5, s5, 1
    s_cmp_lt_u32 s5, 200000
    s_cbranch_scc1 PRE_47
POK_46:
    v_add_f32_dpp v200, v200, v200 quad_perm:[1,0,3,2] row_mask:0xf bank_mask:0xf
    s_nop 1
    v_add_f32_dpp v200, v200, v200 quad_perm:[2,3,0,1] row_mask:0xf bank_mask:0xf
    s_nop 1
    v_add_f32_dpp v200, v200, v200 row_half_mirror row_mask:0xf bank_mask:0xf
    s_nop 1
    v_add_f32_dpp v200, v200, v200 row_mirror row_mask:0xf bank_mask:0xf
    v_cvt_pk_bf16_f32 v200, 0, v200
    v_ashrrev_i32 v7, 31, v200
    v_or_b32 v7, 0x80000000, v7
    v_xor_b32 v200, v200, v7
    v_lshrrev_b32 v200, 16, v200
    v_lshl_or_b32 v200, v200, 11, v201
    s_nop 0
    v_readlane_b32 s24, v200, 0
    v_readlane_b32 s25, v200, 16
    v_readlane_b32 s26, v200, 32
    s_not_b64 s[28:29], s[22:23]
    s_cmp_lt_u32 s24, s25
    s_cselect_b64 s[28:29], s[22:23], s[28:29]
    s_cselect_b32 s27, s24, s25
    s_cmp_gt_u32 s26, s27
    s_cselect_b64 vcc, s[28:29], 0
    v_cndmask_b32 v192, v192, v196, vcc
    v_cndmask_b32 v193, v193, v197, vcc
    v_cndmask_b32 v194, v194, v198, vcc
    v_cndmask_b32 v195, v195, v199, vcc
    s_bitcmp1_b32 vcc_lo, 0
    s_cselect_b32 s24, s26, s24
    s_cselect_b32 s19, s17, s19
    s_cselect_b32 s17, s95, s91
    s_bitcmp1_b32 vcc_lo, 8
    s_cselect_b32 s25, s26, s25
    s_cselect_b32 s19, s18, s19
    s_cselect_b32 s18, s95, s94
    s_waitcnt lgkmcnt(0)
    v_mfma_f32_16x16x32_bf16 v[136:139], v[192:195], v[56:59], 0
    v_mfma_f32_16x16x32_bf16 v[140:143], v[192:195], v[60:63], 0
    v_mfma_f32_16x16x32_bf16 v[144:147], v[192:195], v[64:67], 0
    v_mfma_f32_16x16x32_bf16 v[148:151], v[192:195], v[68:71], 0
    v_mfma_f32_16x16x32_bf16 v[168:171], v[192:195], v[72:75], 0
    v_mfma_f32_16x16x32_bf16 v[172:175], v[192:195], v[76:79], 0
    v_mfma_f32_16x16x32_bf16 v[176:179], v[192:195], v[80:83], 0
    v_mfma_f32_16x16x32_bf16 v[180:183], v[192:195], v[84:87], 0
    s_andn2_b32 s70, 2047, s24
    s_andn2_b32 s71, 2047, s25
    v_add_f32 v196, v136, v141
    s_nop 0
    v_add_f32 v197, v146, v151
    s_nop 0
    v_add_f32 v198, v168, v173
    s_nop 0
    v_add_f32 v199, v178, v183
    v_add_f32 v196, v196, v197
    v_add_f32 v198, v198, v199
    v_mov_b32 v197, s4
    s_nop 0
    v_permlane16_swap_b32 v198, v199
    s_cmp_ge_u32 s9, 28
    s_cbranch_scc1 L_NOHP
    v_add_f32 v196, v196, v199
    s_mov_b32 exec_lo, 0xffff
    s_mov_b32 exec_hi, 0xffff
    buffer_store_dwordx2 v[196:197], v8, s[32:35], s20 offen sc1
    s_mov_b64 exec, -1
L_NOHP:
    ds_read_b64_tr_b16 v[120:121], v35
    ds_read_b64_tr_b16 v[122:123], v35 offset:1024
    ds_read_b64_tr_b16 v[124:125], v35 offset:8192
    ds_read_b64_tr_b16 v[126:127], v35 offset:9216
    ds_read_b64_tr_b16 v[128:129], v35 offset:16384
    ds_read_b64_tr_b16 v[130:131], v35 offset:17408
    ds_read_b64_tr_b16 v[132:133], v35 offset:24576
    ds_read_b64_tr_b16 v[134:135], v35 offset:25600
    v_cmp_eq_u32 vcc, s19, v42
    s_nop 0
    s_and_b64 exec, vcc, -1
    s_cbranch_execz L_NOLO0
    buffer_store_dwordx4 v[232:235], v33, s[64:67], s16 offen sc1
L_NOLO0:
    s_mov_b64 exec, -1
    v_cmp_eq_u32 vcc, s19, v43
    s_nop 0
    s_and_b64 exec, vcc, -1
    s_cbranch_execz L_NOLO1
    buffer_store_dwordx4 v[236:239], v33, s[64:67], s15 offen sc1
L_NOLO1:
    s_mov_b64 exec, -1
    s_cmp_lg_u32 s93, 7
    s_cbranch_scc1 L_NONON
    v_mov_b32 v6, s4
    v_mov_b32 v7, 0
    s_mov_b64 exec, 1
    buffer_store_dword v6, v7, s[32:35], 0 offen sc1
    s_mov_b64 exec, -1
L_NONON:
    s_cmp_ge_u32 s9, 28
    s_cbranch_scc1 L_FIN
    s_cmp_lg_u32 s3, 7
    s_cbranch_scc1 L_NOFZ
    s_bitcmp1_b32 s9, 3
    s_cselect_b32 s15, s25, s24
    s_cselect_b32 s17, s18, s17
    s_andn2_b32 s18, 2047, s15
    s_lshr_b32 s96, s8, 1
    s_lshl2_add_u32 s19, s12, s96
    s_lshr_b32 s96, s19, 1
    s_lshr_b32 s97, s9, 3
    s_lshl_b32 s98, s97, 1
    s_lshl2_add_u32 s99, s96, s98
    s_and_b32 s97, s19, 1
    s_add_u32 s96, s99, s97
    s_mul_i32 s98, s96, 7168
L_PAD10:
    s_cbranch_execz L_RET10
    s_add_u32 s20, s98, 22020096
    s_lshl_b32 s96, s18, 11
    s_lshl_b32 s97, s19, 5
    s_add_u32 s82, s96, s97
    v_and_b32 v10, 7, v1
    v_lshlrev_b32 v10, 2, v10
    s_lshr_b32 s96, s8, 1
    s_lshl_b32 s97, s96, 6
    s_add_u32 s13, s97, 157184
    v_and_b32 v5, 7, v1
    v_lshl_add_u32 v5, v5, 3, s13
    ds_read_b64 v[206:207], v5
    s_and_b32 s96, s17, 31
    s_lshl_b32 s97, s96, 13
    s_lshl_b32 s98, s12, 9
    s_add_u32 s99, s97, s98
    s_lshr_b32 s96, s8, 1
    s_lshl_b32 s97, s96, 5
    s_add_u32 s98, s99, s97
    s_add_u32 s68, s98, 13631488
    s_lshr_b32 s13, s15, 11
    s_lshl_b32 s13, s13, 16
    s_ashr_i32 s15, s13, 31
    s_andn2_b32 s15, 0x7fff0000, s15
    s_or_b32 s15, s15, 0x80000000
    s_xor_b32 s13, s13, s15
    v_mov_b32 v204, s13
    v_mul_f32 v204, s7, v204
    v_exp_f32 v204, -v204
    s_nop 0
    v_add_f32 v204, 1.0, v204
    v_rcp_f32 v204, v204
    s_nop 0
    v_cvt_pk_bf16_f32 v204, 0, v204
L_NOFZ:
    s_cmp_ge_u32 s3, 4
    s_cbranch_scc1 L_NOH
    s_lshl_b32 s96, s3, 8
    s_add_u32 s13, s96, s14
    v_lshrrev_b32 v4, 4, v1
    v_lshlrev_b32 v4, 11, v4
    v_and_b32 v9, 15, v1
    v_lshl_add_u32 v4, v9, 4, v4
    s_lshl_b32 s96, s3, 5
    s_add_u32 s15, s96, 156672
    v_lshrrev_b32 v5, 5, v1
    v_lshl_add_u32 v5, v5, 7, s15
    v_bfe_u32 v9, v1, 2, 1
    v_lshl_add_u32 v5, v9, 4, v5
    v_bfe_u32 v9, v1, 1, 1
    v_lshl_add_u32 v5, v9, 3, v5
    v_bfe_u32 v9, v1, 3, 1
    v_lshl_add_u32 v5, v9, 2, v5
    v_and_b32 v9, 1, v1
    v_lshl_add_u32 v5, v9, 1, v5
SPOLL_48:
    s_load_dword s24, s[32:33], s13 offset:1276 glc
    s_load_dword s25, s[32:33], s13 offset:3324 glc
    s_load_dword s26, s[32:33], s13 offset:5372 glc
    s_load_dword s27, s[32:33], s13 offset:7420 glc
SCHK_49:
    s_add_u32 s5, s5, 1
    s_cmp_ge_u32 s5, 200000
    s_waitcnt lgkmcnt(0)
    s_cbranch_scc1 SDONE_50
    s_cmp_lg_u32 s24, s4
    s_cbranch_scc1 SPOLL_48
    s_cmp_lg_u32 s25, s4
    s_cbranch_scc1 SPOLL_48
    s_cmp_lg_u32 s26, s4
    s_cbranch_scc1 SPOLL_48
    s_cmp_lg_u32 s27, s4
    s_cbranch_scc1 SPOLL_48
SDONE_50:
POLL_51:
    buffer_load_dwordx4 v[88:91], v4, s[32:35], s13 offen sc1
    buffer_load_dwordx4 v[92:95], v4, s[32:35], s13 offen offset:1024 sc1
    s_waitcnt vmcnt(0)
    v_bitop3_b32 v6, v89, v91, s4 bitop3:0x7e
    v_bitop3_b32 v6, v6, v93, s4 bitop3:0xf6
    v_bitop3_b32 v6, v6, v95, s4 bitop3:0xf6
    v_cmp_ne_u32 vcc, 0, v6
    s_cbranch_vccz PDONE_52
    s_add_u32 s5, s5, 1
    s_cmp_lt_u32 s5, 200000
    s_cbranch_scc1 POLL_51
PDONE_52:
    v_permlane32_swap_b32 v88, v90
    v_permlane32_swap_b32 v92, v94
    v_add_f32 v88, v88, v90
    v_add_f32 v92, v92, v94
    v_mov_b32 v90, v88
    v_mov_b32 v94, v92
    s_nop 0
    v_permlane16_swap_b32 v88, v90
    v_permlane16_swap_b32 v92, v94
    v_add_f32 v88, v88, v90
    v_add_f32 v92, v92, v94
    v_cvt_pk_bf16_f32 v88, 0, v88
    v_cvt_pk_bf16_f32 v92, 0, v92
    v_mul_f32 v6, s7, v88
    v_exp_f32 v6, -v6
    s_nop 0
    v_add_f32 v6, 1.0, v6
    v_rcp_f32 v6, v6
    s_nop 0
    v_mul_f32 v88, v88, v6
    v_cvt_pk_bf16_f32 v88, 0, v88
    v_mul_f32 v88, v88, v92
    v_cvt_pk_bf16_f32 v88, v88, v88
    ds_write_b16 v5, v88
L_NOH:
    v_bfe_u32 v4, v1, 2, 1
    v_lshlrev_b32 v4, 7, v4
    v_lshrrev_b32 v9, 5, v1
    v_lshl_add_u32 v4, v9, 4, v4
    v_add_u32 v4, 156672, v4
    v_lshrrev_b32 v5, 4, v1
    v_mul_u32_u24 v5, 7168, v5
    v_and_b32 v9, 15, v1
    v_lshl_add_u32 v5, v9, 3, v5
    s_lshl3_add_u32 s96, s75, s3
    s_mul_i32 s97, s96, 28672
    s_lshl_b32 s98, s74, 7
    s_add_u32 s99, s97, s98
    s_add_u32 s13, s99, 22020096
    v_and_b32 v6, 1, v1
    v_lshlrev_b32 v6, 13, v6
    v_bfe_u32 v9, v1, 1, 1
    v_lshl_add_u32 v6, v9, 18, v6
    s_lshr_b32 s96, s9, 2
    s_and_b32 s97, s75, 1
    s_lshr_b32 s98, s3, 1
    s_lshl2_add_u32 s99, s97, s98
    s_and_b32 s97, s3, 1
    s_lshr_b32 s98, s75, 1
    s_lshl2_add_u32 s97, s97, s98
    s_lshl3_add_u32 s98, s99, s97
    s_lshl_b32 s99, s98, 12
    s_lshl_b32 s97, s8, 6
    s_add_u32 s98, s99, s97
    s_lshl2_add_u32 s99, s96, s98
    s_add_u32 s97, s99, 1048576
    s_add_u32 s14, s97, 3072
    s_waitcnt lgkmcnt(0)
    s_barrier
    ds_read_b128 v[88:91], v4
    ds_read_b128 v[92:95], v4 offset:32
    ds_read_b128 v[96:99], v4 offset:64
    ds_read_b128 v[100:103], v4 offset:96
    s_waitcnt lgkmcnt(3)
    v_mfma_f32_32x32x16_bf16 v[208:223], v[88:91], v[120:123], 0
    s_waitcnt lgkmcnt(2)
    v_mfma_f32_32x32x16_bf16 v[208:223], v[92:95], v[124:127], v[208:223]
    s_waitcnt lgkmcnt(1)
    v_mfma_f32_32x32x16_bf16 v[208:223], v[96:99], v[128:131], v[208:223]
    s_waitcnt lgkmcnt(0)
    v_mfma_f32_32x32x16_bf16 v[208:223], v[100:103], v[132:135], v[208:223]
    s_nop 11
    v_mov_b32 v209, s4
    buffer_store_dwordx2 v[208:209], v5, s[32:35], s13 offen sc1
    s_mov_b64 exec, 15
    buffer_store_dword v209, v6, s[32:35], s14 offen sc1
    s_mov_b64 exec, -1
    s_cmp_ge_u32 s9, 16
    s_cbranch_scc1 L_FIN
SPOLL_53:
    s_load_dwordx8 s[24:31], s[32:33], s92 offset:3072 glc
SCHK_54:
    s_add_u32 s5, s5, 1
    s_cmp_ge_u32 s5, 200000
    s_waitcnt lgkmcnt(0)
    s_cbranch_scc1 SDONE_55
    s_cmp_lg_u32 s24, s4
    s_cbranch_scc1 SPOLL_53
    s_cmp_lg_u32 s25, s4
    s_cbranch_scc1 SPOLL_53
    s_cmp_lg_u32 s26, s4
    s_cbranch_scc1 SPOLL_53
    s_cmp_lg_u32 s27, s4
    s_cbranch_scc1 SPOLL_53
    s_cmp_lg_u32 s28, s4
    s_cbranch_scc1 SPOLL_53
    s_cmp_lg_u32 s29, s4
    s_cbranch_scc1 SPOLL_53
    s_cmp_lg_u32 s30, s4
    s_cbranch_scc1 SPOLL_53
SDONE_55:
    s_barrier
    s_cmp_lg_u32 s3, 7
    s_cbranch_scc1 L_FIN
    s_add_u32 s13, s20, 4096
    v_mov_b32 v5, s4
    v_not_b32 v6, v5
POLL_56:
    buffer_load_dwordx4 v[88:91], v2, s[32:35], s20 offen sc1
    buffer_load_dwordx4 v[92:95], v2, s[32:35], s20 offen offset:1024 sc1
    buffer_load_dwordx4 v[96:99], v2, s[32:35], s20 offen offset:2048 sc1
    buffer_load_dwordx4 v[100:103], v2, s[32:35], s20 offen offset:3072 sc1
    buffer_load_dwordx4 v[104:107], v2, s[32:35], s13 offen sc1
    buffer_load_dwordx4 v[108:111], v2, s[32:35], s13 offen offset:1024 sc1
    buffer_load_dwordx4 v[112:115], v2, s[32:35], s13 offen offset:2048 sc1
    buffer_load_dword v244, v10, s[32:35], s68 offen sc1
    buffer_load_dword v245, v10, s[32:35], s68 offen offset:128 sc1
    s_waitcnt vmcnt(0)
    v_max_u32 v246, v244, v245
    v_cmp_ne_u32 vcc, -1, v246
    s_nop 1
    v_cndmask_b32 v246, v6, v5, vcc
    v_bitop3_b32 v4, v89, v91, s4 bitop3:0x7e
    v_bitop3_b32 v4, v4, v93, s4 bitop3:0xf6
    v_bitop3_b32 v4, v4, v95, s4 bitop3:0xf6
    v_bitop3_b32 v4, v4, v97, s4 bitop3:0xf6
    v_bitop3_b32 v4, v4, v99, s4 bitop3:0xf6
    v_bitop3_b32 v4, v4, v101, s4 bitop3:0xf6
    v_bitop3_b32 v4, v4, v103, s4 bitop3:0xf6
    v_bitop3_b32 v4, v4, v105, s4 bitop3:0xf6
    v_bitop3_b32 v4, v4, v107, s4 bitop3:0xf6
    v_bitop3_b32 v4, v4, v109, s4 bitop3:0xf6
    v_bitop3_b32 v4, v4, v111, s4 bitop3:0xf6
    v_bitop3_b32 v4, v4, v113, s4 bitop3:0xf6
    v_bitop3_b32 v4, v4, v115, s4 bitop3:0xf6
    v_bitop3_b32 v4, v4, v246, s4 bitop3:0xf6
    v_cmp_ne_u32 vcc, 0, v4
    s_cbranch_vccz PDONE_57
    s_add_u32 s5, s5, 1
    s_cmp_lt_u32 s5, 200000
    s_cbranch_scc1 POLL_56
PDONE_57:
    v_add_f32 v88, v88, v92
    v_add_f32 v90, v90, v94
    v_add_f32 v88, v88, v96
    v_add_f32 v90, v90, v98
    v_add_f32 v88, v88, v100
    v_add_f32 v90, v90, v102
    v_add_f32 v88, v88, v104
    v_add_f32 v90, v90, v106
    v_add_f32 v88, v88, v108
    v_add_f32 v90, v90, v110
    v_add_f32 v88, v88, v112
    v_add_f32 v90, v90, v114
    v_mov_b32 v89, v90
    v_add_f32_dpp v88, v88, v88 row_ror:8 row_mask:0xf bank_mask:0xf
    s_nop 0
    v_add_f32_dpp v89, v89, v89 row_ror:8 row_mask:0xf bank_mask:0xf
    v_mov_b32 v90, v88
    v_mov_b32 v91, v89
    s_nop 0
    v_permlane16_swap_b32 v88, v90
    v_permlane16_swap_b32 v89, v91
    v_pk_add_f32 v[88:89], v[88:89], v[90:91]
    v_mov_b32 v90, v88
    v_mov_b32 v91, v89
    s_nop 0
    v_permlane32_swap_b32 v88, v90
    v_permlane32_swap_b32 v89, v91
    v_pk_add_f32 v[88:89], v[88:89], v[90:91]
    v_cvt_pk_bf16_f32 v88, 0, v88
    v_cvt_pk_bf16_f32 v89, 0, v89
    v_pk_mul_f32 v[88:89], v[88:89], v[204:205] op_sel_hi:[1,0]
    v_lshlrev_b32 v4, 16, v244
    v_and_b32 v5, s6, v244
    v_cvt_pk_bf16_f32 v88, 0, v88
    v_cvt_pk_bf16_f32 v89, 0, v89
    v_pk_add_f32 v[88:89], v[88:89], v[4:5]
    v_cvt_pk_bf16_f32 v88, 0, v88
    v_cvt_pk_bf16_f32 v89, 0, v89
    v_pk_mul_f32 v[88:89], v[88:89], v[206:207]
    v_lshlrev_b32 v4, 16, v245
    v_and_b32 v5, s6, v245
    v_cvt_pk_bf16_f32 v88, 0, v88
    v_cvt_pk_bf16_f32 v89, 0, v89
    v_pk_add_f32 v[88:89], v[88:89], v[4:5]
    v_cvt_pk_bf16_f32 v88, v88, v89
    s_mov_b64 exec, 0xff
    buffer_store_dword v88, v10, s[64:67], s82 offen sc1
    s_mov_b64 exec, -1
L_FIN:
L_END:
    s_endpgm
.p2align 10
.fill 768, 4, 0xbf800000
.section .rodata,"a"
.p2align 6
.amdhsa_kernel adaLN_cond__linear_kernel_hedgehog__moe_arch_mod__prompt_kernel
  .amdhsa_next_free_vgpr 256
  .amdhsa_next_free_sgpr 102
  .amdhsa_accum_offset 256
  .amdhsa_group_segment_fixed_size 0
  .amdhsa_kernarg_size 112
  .amdhsa_user_sgpr_count 2
  .amdhsa_user_sgpr_kernarg_segment_ptr 1
  .amdhsa_system_sgpr_workgroup_id_x 1
  .amdhsa_float_denorm_mode_32 3
  .amdhsa_float_denorm_mode_16_64 3
.end_amdhsa_kernel
```

```asm
; @launch grid=(256,1,1) block=(512,1,1) lds=163840
.amdgcn_target "amdgcn-amd-amdhsa--gfx950"
.text
.globl adaLN_cond__linear_kernel_hedgehog__moe_arch_mod__prompt_kernel
.p2align 12
.type adaLN_cond__linear_kernel_hedgehog__moe_arch_mod__prompt_kernel,@function
adaLN_cond__linear_kernel_hedgehog__moe_arch_mod__prompt_kernel:
    s_load_dwordx16 s[68:83], s[0:1], 0
    s_load_dwordx8 s[84:91], s[0:1], 64
    s_load_dwordx2 s[32:33], s[0:1], 104
    s_cmp_ge_u32 s2, 256
    s_cbranch_scc1 L_END
    v_lshrrev_b32 v4, 6, v0
    v_and_b32 v1, 63, v0
    s_nop 0
    v_readfirstlane_b32 s3, v4
    v_lshlrev_b32 v2, 4, v1
    s_mov_b32 s38, 4194304
    s_mov_b32 s39, 0x20000
    s_mov_b32 s50, 12582912
    s_mov_b32 s51, 0x20000
    s_mov_b32 s34, 268435456
    s_mov_b32 s35, 0x20000
    s_mov_b32 s42, 6291456
    s_mov_b32 s43, 0x20000
    s_mov_b32 s46, 2097152
    s_mov_b32 s47, 0x20000
    s_mov_b32 s54, 7340032
    s_mov_b32 s55, 0x20000
    s_mov_b32 s58, 7340032
    s_mov_b32 s59, 0x20000
    s_mov_b32 s62, 7340032
    s_mov_b32 s63, 0x20000
    s_mov_b32 s66, 4194304
    s_mov_b32 s67, 0x20000
    s_mov_b32 s5, 0
    s_mov_b32 s6, 0xffff0000
    s_mov_b32 s7, 0x3fb8aa3b
    s_and_b32 s8, s2, 7
    s_lshr_b32 s9, s2, 3
    s_lshl_b32 s96, s8, 5
    s_add_u32 s97, s96, s9
    s_lshl3_add_u32 s93, s97, s3
    s_and_b32 s96, s8, 4
    s_lshr_b32 s97, s9, 2
    s_lshl1_add_u32 s10, s96, s97
    s_and_b32 s96, s8, 3
    s_and_b32 s97, s9, 3
    s_xor_b32 s98, s97, 2
    s_lshl2_add_u32 s11, s96, s98
    s_and_b32 s96, s8, 1
    s_and_b32 s97, s9, 7
    s_lshl3_add_u32 s12, s96, s97
    s_lshr_b32 s96, s8, 1
    s_lshr_b32 s97, s9, 3
    s_lshl2_add_u32 s21, s96, s97
    s_lshl_b32 s96, s2, 6
    s_add_u32 s97, s96, s3
    s_lshl_b32 s98, s97, 6
    s_add_u32 s92, s98, 1048576
    s_lshl_b32 s16, s93, 11
    s_lshl3_add_u32 s96, s8, s3
    s_lshl_b32 s15, s96, 5
    s_mul_i32 s96, s15, 6144
    s_xor_b32 s97, s9, 1
    s_lshl_b32 s98, s97, 7
    s_add_u32 s13, s96, s98
    s_add_u32 s14, s13, 98304
    s_lshl3_add_u32 s96, s21, s3
    s_lshl_b32 s97, s96, 15
    s_lshl_b32 s98, s12, 7
    s_add_u32 s18, s97, s98
    s_lshr_b32 s96, s8, 1
    s_lshl4_add_u32 s97, s96, s12
    s_lshl4_add_u32 s98, s97, s3
    s_lshl_b32 s99, s98, 9
    s_add_u32 s17, s99, 524288
    v_lshrrev_b32 v248, 3, v1
    v_mul_u32_u24 v248, 12288, v248
    v_and_b32 v9, 7, v1
    v_lshl_add_u32 v248, v9, 4, v248
    v_lshrrev_b32 v249, 3, v1
    v_lshl_add_u32 v249, v249, 1, s15
    v_and_b32 v10, 15, v1
    v_lshlrev_b32 v10, 11, v10
    v_lshrrev_b32 v9, 4, v1
    v_lshl_add_u32 v10, v9, 4, v10
    s_waitcnt lgkmcnt(0)
    s_mov_b64 s[48:49], s[88:89]
    buffer_load_dwordx4 v[160:163], v248, s[48:51], s13 offen nt
    buffer_load_dwordx4 v[164:167], v248, s[48:51], s14 offen nt
    s_load_dword s4, s[32:33], 0
    global_load_ushort v168, v249, s[86:87]
    global_load_ushort v169, v249, s[86:87] offset:16
    s_mov_b64 s[36:37], s[68:69]
    s_load_dword s24, s[32:33], s92 offset:0 glc
    s_load_dword s25, s[32:33], s17 offset:508 glc
    s_load_dword s26, s[32:33], s17 offset:4604 glc
    s_barrier
    buffer_load_dwordx4 v[152:155], v2, s[36:39], s16 offen
    buffer_load_dwordx4 v[156:159], v2, s[36:39], s16 offen offset:1024
    s_mov_b64 s[40:41], s[70:71]
    s_mov_b64 s[44:45], s[74:75]
    s_mov_b64 s[52:53], s[80:81]
    s_mov_b64 s[56:57], s[82:83]
    s_mov_b64 s[60:61], s[84:85]
    s_mov_b64 s[64:65], s[90:91]
    s_getpc_b64 s[22:23]
    s_and_b32 s22, s22, 0xfffffc00
    s_lshl3_add_u32 s96, s9, s3
    s_lshl_b32 s19, s96, 7
    v_lshrrev_b32 v4, 5, v1
    v_lshl_add_u32 v4, v4, 15, s19
    v_min_u32 v4, 41984, v4
    global_load_dword v11, v4, s[22:23]
    s_lshr_b32 s76, s3, 2
    s_and_b32 s77, s3, 3
    s_lshl_b32 s83, s3, 10
    s_mul_i32 s96, s8, 7
    s_lshr_b32 s97, s9, 2
    s_add_u32 s74, s96, s97
    s_and_b32 s75, s9, 3
    v_bfe_u32 v6, v1, 4, 1
    v_lshlrev_b32 v6, 6, v6
    v_and_b32 v3, 7, v1
    v_lshlrev_b32 v3, 4, v3
    v_xor_b32 v3, v3, v6
    v_lshrrev_b32 v6, 3, v1
    v_mul_u32_u24 v6, 6144, v6
    v_add_u32 v3, v3, v6
    s_and_b32 s84, s9, 12
    s_mul_i32 s96, s3, 49152
    s_lshl_b32 s97, s11, 7
    s_add_u32 s85, s96, s97
    v_lshlrev_b32 v250, 3, v1
    v_lshlrev_b32 v251, 5, v1
    v_add_u32 v251, 147456, v251
    s_lshl2_add_u32 s13, s3, 147456
    v_lshrrev_b32 v252, 4, v1
    v_lshl_add_u32 v252, v252, 6, s13
    v_and_b32 v9, 7, v1
    v_lshl_add_u32 v252, v9, 8, v252
    v_bfe_u32 v9, v1, 3, 1
    v_lshl_add_u32 v252, v9, 5, v252
    buffer_load_dwordx4 v[12:15], v10, s[36:39], s18 offen
    buffer_load_dwordx4 v[16:19], v10, s[36:39], s18 offen offset:64
    s_lshr_b32 s96, s3, 1
    s_xor_b32 s97, s9, 1
    s_and_b32 s98, s97, 15
    s_lshl4_add_u32 s99, s96, s98
    s_lshr_b32 s97, s9, 4
    s_lshl1_add_u32 s96, s99, s97
    s_lshl3_add_u32 s98, s96, s8
    s_lshl_b32 s99, s98, 9
    s_add_u32 s13, s99, 524288
    s_waitcnt vmcnt(5)
    v_lshlrev_b32 v168, 16, v168
    v_mul_f32 v4, s7, v168
    v_exp_f32 v4, -v4
    s_nop 0
    v_add_f32 v4, 1.0, v4
    v_rcp_f32 v4, v4
    s_nop 0
    v_mul_f32 v168, v168, v4
    v_cvt_pk_bf16_f32 v168, 0, v168
    v_lshlrev_b32 v169, 16, v169
    v_mul_f32 v5, s7, v169
    v_exp_f32 v5, -v5
    s_nop 0
    v_add_f32 v5, 1.0, v5
    v_rcp_f32 v5, v5
    s_nop 0
    v_mul_f32 v169, v169, v5
    v_cvt_pk_bf16_f32 v169, 0, v169
    v_lshlrev_b32 v4, 16, v160
    v_and_b32 v5, s6, v160
    v_pk_mul_f32 v[176:177], v[4:5], v[168:169] op_sel:[0,0] op_sel_hi:[1,0]
    v_lshlrev_b32 v6, 16, v161
    v_and_b32 v7, s6, v161
    v_pk_mul_f32 v[178:179], v[6:7], v[168:169] op_sel:[0,0] op_sel_hi:[1,0]
    v_lshlrev_b32 v4, 16, v162
    v_and_b32 v5, s6, v162
    v_pk_mul_f32 v[180:181], v[4:5], v[168:169] op_sel:[0,0] op_sel_hi:[1,0]
    v_lshlrev_b32 v6, 16, v163
    v_and_b32 v7, s6, v163
    v_pk_mul_f32 v[182:183], v[6:7], v[168:169] op_sel:[0,0] op_sel_hi:[1,0]
    v_lshlrev_b32 v4, 16, v164
    v_and_b32 v5, s6, v164
    v_pk_fma_f32 v[176:177], v[4:5], v[168:169], v[176:177] op_sel:[0,1,0] op_sel_hi:[1,1,1]
    v_lshlrev_b32 v6, 16, v165
    v_and_b32 v7, s6, v165
    v_pk_fma_f32 v[178:179], v[6:7], v[168:169], v[178:179] op_sel:[0,1,0] op_sel_hi:[1,1,1]
    v_lshlrev_b32 v4, 16, v166
    v_and_b32 v5, s6, v166
    v_pk_fma_f32 v[180:181], v[4:5], v[168:169], v[180:181] op_sel:[0,1,0] op_sel_hi:[1,1,1]
    v_lshlrev_b32 v6, 16, v167
    v_and_b32 v7, s6, v167
    v_pk_fma_f32 v[182:183], v[6:7], v[168:169], v[182:183] op_sel:[0,1,0] op_sel_hi:[1,1,1]
    v_permlane32_swap_b32 v176, v180
    v_permlane32_swap_b32 v177, v181
    v_permlane32_swap_b32 v178, v182
    v_permlane32_swap_b32 v179, v183
    v_add_f32 v176, v176, v180
    v_add_f32 v177, v177, v181
    v_add_f32 v178, v178, v182
    v_add_f32 v179, v179, v183
    s_nop 0
    v_permlane16_swap_b32 v176, v178
    v_permlane16_swap_b32 v177, v179
    v_add_f32 v176, v176, v178
    v_add_f32 v177, v177, v179
    s_nop 0
    v_add_f32_dpp v176, v176, v176 row_ror:8 row_mask:0xf bank_mask:0xf
    v_add_f32_dpp v177, v177, v177 row_ror:8 row_mask:0xf bank_mask:0xf
    s_nop 1
    v_mov_b32_dpp v176, v177 quad_perm:[0,1,2,3] row_mask:0xf bank_mask:0xc
    s_waitcnt lgkmcnt(0)
    s_mul_i32 s4, s4, 0x9e3779b1
    s_add_u32 s4, s4, 0x7f4a7c15
    ds_write_b32 v252, v176
    s_waitcnt lgkmcnt(0)
    s_barrier
    ds_read_b128 v[176:179], v251
    ds_read_b128 v[180:183], v251 offset:16
    s_waitcnt lgkmcnt(0)
    v_pk_add_f32 v[176:177], v[176:177], v[178:179]
    v_pk_add_f32 v[180:181], v[180:181], v[182:183]
    v_pk_add_f32 v[176:177], v[176:177], v[180:181]
    v_add_f32 v176, v176, v177
    v_mov_b32 v177, s4
    s_bitcmp1_b32 s3, 0
    s_cselect_b32 exec_lo, 0, -1
    s_cselect_b32 exec_hi, -1, 0
    buffer_store_dwordx2 v[176:177], v250, s[32:35], s13 offen sc1
    s_mov_b64 exec, -1
    s_lshr_b32 s96, s9, 4
    s_lshl_b32 s94, s96, 1
    s_add_u32 s96, s94, s84
    s_and_b32 s97, s96, 15
    s_mul_i32 s98, s97, 393216
    s_add_u32 s91, s98, s85
    s_lshl_b32 s96, s94, 13
    s_add_u32 s94, s96, s83
    s_add_u32 s82, s91, 2048
    s_mov_b32 m0, s94
    s_nop 0
    buffer_load_dwordx4 v3, s[40:43], s82 offen lds
    s_add_u32 s82, s91, 4096
    s_add_u32 m0, s94, 49152
    s_nop 0
    buffer_load_dwordx4 v3, s[40:43], s82 offen lds
    s_waitcnt vmcnt(6)
    v_mov_b32 v8, 0x3f803f80
    v_dot2_f32_bf16 v4, v152, v8, 0
    v_dot2_f32_bf16 v5, v152, v152, 0
    v_dot2_f32_bf16 v6, v153, v8, 0
    v_dot2_f32_bf16 v7, v153, v153, 0
    v_dot2_f32_bf16 v4, v154, v8, v4
    v_dot2_f32_bf16 v5, v154, v154, v5
    v_dot2_f32_bf16 v6, v155, v8, v6
    v_dot2_f32_bf16 v7, v155, v155, v7
    v_dot2_f32_bf16 v4, v156, v8, v4
    v_dot2_f32_bf16 v5, v156, v156, v5
    v_dot2_f32_bf16 v6, v157, v8, v6
    v_dot2_f32_bf16 v7, v157, v157, v7
    v_dot2_f32_bf16 v4, v158, v8, v4
    v_dot2_f32_bf16 v5, v158, v158, v5
    v_dot2_f32_bf16 v6, v159, v8, v6
    v_dot2_f32_bf16 v7, v159, v159, v7
    s_nop 2
    v_pk_add_f32 v[4:5], v[4:5], v[6:7]
    s_nop 1
    v_add_f32_dpp v4, v4, v4 quad_perm:[1,0,3,2] row_mask:0xf bank_mask:0xf
    v_add_f32_dpp v5, v5, v5 quad_perm:[1,0,3,2] row_mask:0xf bank_mask:0xf
    s_nop 0
    v_add_f32_dpp v4, v4, v4 quad_perm:[2,3,0,1] row_mask:0xf bank_mask:0xf
    v_add_f32_dpp v5, v5, v5 quad_perm:[2,3,0,1] row_mask:0xf bank_mask:0xf
    s_nop 0
    v_add_f32_dpp v4, v4, v4 row_half_mirror row_mask:0xf bank_mask:0xf
    v_add_f32_dpp v5, v5, v5 row_half_mirror row_mask:0xf bank_mask:0xf
    s_nop 0
    v_add_f32_dpp v4, v4, v4 row_ror:8 row_mask:0xf bank_mask:0xf
    v_add_f32_dpp v5, v5, v5 row_ror:8 row_mask:0xf bank_mask:0xf
    s_nop 1
    v_permlane16_swap_b32 v4, v5
    v_add_f32 v8, v4, v5
    v_add_f32 v4, v4, v5
    s_nop 1
    v_permlane32_swap_b32 v4, v8
    v_add_f32 v4, v4, v8
    v_mul_f32 v8, 0x3a800000, v4
    v_mul_f32 v4, 0x3a800000, v4
    s_nop 1
    v_permlane16_swap_b32 v4, v8
    v_fma_f32 v173, -v4, v4, v8
    v_cvt_pk_bf16_f32 v172, 0, v4
    v_max_f32 v173, 0, v173
    v_cvt_pk_bf16_f32 v173, 0, v173
    v_add_f32 v173, 0x3727c5ac, v173
    v_cvt_pk_bf16_f32 v173, 0, v173
    v_sqrt_f32 v173, v173
    s_nop 0
    v_cvt_pk_bf16_f32 v173, 0, v173
    s_lshl3_add_u32 s13, s3, 153600
    v_lshrrev_b32 v172, 16, v172
    v_or_b32 v172, v172, v173
    v_mov_b32 v173, s4
    v_mov_b32 v4, s13
    ds_write_b64 v4, v[172:173]
    v_and_b32 v5, 3, v1
    v_lshlrev_b32 v5, 4, v5
    v_add_u32 v5, 153600, v5
    v_and_b32 v4, 3, v1
    v_lshlrev_b32 v4, 4, v4
    v_bfe_u32 v9, v1, 2, 1
    v_lshl_add_u32 v4, v9, 10, v4
    s_and_b32 s96, s8, 6
    s_and_b32 s97, s8, 1
    s_lshr_b32 s98, s9, 4
    s_lshl1_add_u32 s99, s97, s98
    s_lshl_b32 s97, s99, 6
    s_add_u32 s98, s96, s97
    s_lshl3_add_u32 s99, s3, s98
    s_lshl_b32 s96, s99, 10
    s_and_b32 s97, s9, 15
    s_lshl_b32 s98, s97, 6
    s_add_u32 s99, s96, s98
    s_add_u32 s13, s99, 262144
    s_waitcnt lgkmcnt(0)
    s_barrier
    ds_read_b128 v[172:175], v5
    s_waitcnt lgkmcnt(0)
    s_mov_b64 exec, 0xff
    buffer_store_dwordx4 v[172:175], v4, s[32:35], s13 offen sc1
    s_mov_b64 exec, -1
    s_mov_b32 s82, s91
    s_add_u32 m0, s94, 98304
    s_nop 0
    buffer_load_dwordx4 v3, s[40:43], s82 offen lds
    s_load_dword s24, s[32:33], s17 offset:508 glc
    s_load_dword s25, s[32:33], s17 offset:4604 glc
    v_and_b32 v4, 31, v1
    v_lshlrev_b32 v4, 4, v4
    v_lshrrev_b32 v9, 5, v1
    v_lshl_add_u32 v4, v9, 12, v4
    s_lshl2_add_u32 s14, s3, 155648
    v_lshl_add_u32 v5, v1, 6, s14
    v_and_b32 v6, 3, v1
    v_lshlrev_b32 v6, 5, v6
    v_lshrrev_b32 v9, 5, v1
    v_lshl_add_u32 v6, v9, 7, v6
    v_bfe_u32 v9, v1, 4, 1
    v_lshl_add_u32 v6, v9, 8, v6
    v_bfe_u32 v9, v1, 2, 2
    v_lshl_add_u32 v6, v9, 9, v6
    v_add_u32 v6, 155648, v6
    s_lshl3_add_u32 s96, s2, s3
    s_lshl_b32 s97, s96, 7
    s_add_u32 s14, s97, 262144
    v_and_b32 v8, 15, v1
    v_lshlrev_b32 v8, 3, v8
    s_branch SCHK_2
SPOLL_1:
    s_load_dword s24, s[32:33], s17 offset:508 glc
    s_load_dword s25, s[32:33], s17 offset:4604 glc
SCHK_2:
    s_add_u32 s5, s5, 1
    s_cmp_ge_u32 s5, 200000
    s_waitcnt lgkmcnt(0)
    s_cbranch_scc1 SDONE_3
    s_cmp_lg_u32 s24, s4
    s_cbranch_scc1 SPOLL_1
    s_cmp_lg_u32 s25, s4
    s_cbranch_scc1 SPOLL_1
SDONE_3:
    buffer_load_dwordx4 v[176:179], v4, s[32:35], s17 offen sc1
    s_load_dword s24, s[32:33], s14 offset:60 glc
    s_load_dword s25, s[32:33], s14 offset:124 glc
    s_waitcnt vmcnt(6)
    v_permlane32_swap_b32 v12, v14
    v_permlane32_swap_b32 v13, v15
    v_permlane32_swap_b32 v16, v18
    v_permlane32_swap_b32 v17, v19
    v_lshlrev_b32 v184, 16, v12
    v_and_b32 v185, s6, v12
    v_lshlrev_b32 v186, 16, v13
    v_and_b32 v187, s6, v13
    v_lshlrev_b32 v188, 16, v14
    v_and_b32 v189, s6, v14
    v_lshlrev_b32 v190, 16, v15
    v_and_b32 v191, s6, v15
    v_lshlrev_b32 v192, 16, v16
    v_and_b32 v193, s6, v16
    v_lshlrev_b32 v194, 16, v17
    v_and_b32 v195, s6, v17
    v_lshlrev_b32 v196, 16, v18
    v_and_b32 v197, s6, v18
    v_lshlrev_b32 v198, 16, v19
    v_and_b32 v199, s6, v19
    s_branch SCHK_6
SPOLL_5:
    s_load_dword s24, s[32:33], s14 offset:60 glc
    s_load_dword s25, s[32:33], s14 offset:124 glc
SCHK_6:
    s_add_u32 s5, s5, 1
    s_cmp_ge_u32 s5, 200000
    s_waitcnt lgkmcnt(0)
    s_cbranch_scc1 SDONE_7
    s_cmp_lg_u32 s24, s4
    s_cbranch_scc1 SPOLL_5
    s_cmp_lg_u32 s25, s4
    s_cbranch_scc1 SPOLL_5
SDONE_7:
    buffer_load_dwordx2 v[172:173], v8, s[32:35], s14 offen sc1
    s_lshr_b32 s96, s9, 4
    s_lshl_b32 s97, s96, 1
    s_xor_b32 s94, s97, 1
    s_add_u32 s96, s94, s84
    s_and_b32 s97, s96, 15
    s_mul_i32 s98, s97, 393216
    s_add_u32 s91, s98, s85
    s_lshl_b32 s96, s94, 13
    s_add_u32 s94, s96, s83
    s_add_u32 s82, s91, 2048
    s_mov_b32 m0, s94
    s_nop 0
    buffer_load_dwordx4 v3, s[40:43], s82 offen lds
    s_add_u32 s82, s91, 4096
    s_add_u32 m0, s94, 49152
    s_nop 0
    buffer_load_dwordx4 v3, s[40:43], s82 offen lds
    s_mov_b32 s82, s91
    s_add_u32 m0, s94, 98304
    s_nop 0
    buffer_load_dwordx4 v3, s[40:43], s82 offen lds
    s_waitcnt vmcnt(4)
    v_bitop3_b32 v7, v177, v179, s4 bitop3:0x7e
    v_cmp_ne_u32 vcc, 0, v7
    s_cbranch_vccz TOK_8
POLL_9:
    buffer_load_dwordx4 v[176:179], v4, s[32:35], s17 offen sc1
    s_waitcnt vmcnt(0)
    v_bitop3_b32 v7, v177, v179, s4 bitop3:0x7e
    v_cmp_ne_u32 vcc, 0, v7
    s_cbranch_vccz PDONE_10
    s_add_u32 s5, s5, 1
    s_cmp_lt_u32 s5, 200000
    s_cbranch_scc1 POLL_9
PDONE_10:
TOK_8:
    ds_write2_b32 v5, v176, v178 offset0:0 offset1:8
    s_waitcnt lgkmcnt(0)
    s_barrier
    ds_read_b128 v[208:211], v6 offset:2048
    ds_read_b128 v[212:215], v6 offset:2064
    ds_read_b128 v[200:203], v6
    ds_read_b128 v[204:207], v6 offset:16
    s_lshl_b32 s96, s11, 12
    s_lshl_b32 s97, s3, 9
    s_add_u32 s13, s96, s97
    v_add_u32 v4, s13, v2
    s_lshl_b32 s96, s3, 9
    s_add_u32 m0, s96, 159744
    s_mov_b32 exec_hi, 0
    global_load_lds_dwordx4 v4, s[72:73]
    s_mov_b32 exec_hi, -1
    s_lshl4_add_u32 s96, s21, s12
    s_lshr_b32 s97, s3, 1
    s_lshl2_add_u32 s98, s96, s97
    s_lshl_b32 s99, s98, 12
    s_and_b32 s96, s3, 1
    s_lshl_b32 s97, s96, 8
    s_add_u32 s98, s99, s97
    s_add_u32 s13, s98, 4194304
    v_and_b32 v4, 15, v1
    v_lshlrev_b32 v4, 4, v4
    v_bfe_u32 v9, v1, 4, 1
    v_lshl_add_u32 v4, v9, 10, v4
    v_lshrrev_b32 v9, 5, v1
    v_lshl_add_u32 v4, v9, 9, v4
    s_waitcnt lgkmcnt(2)
    v_pk_add_f32 v[208:209], v[208:209], v[210:211]
    v_pk_add_f32 v[212:213], v[212:213], v[214:215]
    v_pk_add_f32 v[208:209], v[208:209], v[212:213]
    v_add_f32 v208, v208, v209
    v_cvt_pk_bf16_f32 v208, 0, v208
    s_waitcnt lgkmcnt(0)
    v_pk_add_f32 v[200:201], v[200:201], v[202:203]
    v_pk_add_f32 v[204:205], v[204:205], v[206:207]
    v_pk_add_f32 v[200:201], v[200:201], v[204:205]
    v_add_f32 v200, v200, v201
    v_add_f32 v208, 1.0, v208
    v_cvt_pk_bf16_f32 v208, 0, v208
    v_cvt_pk_bf16_f32 v200, 0, v200
    s_waitcnt vmcnt(4)
    v_cmp_ne_u32 vcc, s4, v173
    s_cbranch_vccz L_STOK
POLL_11:
    buffer_load_dwordx2 v[172:173], v8, s[32:35], s14 offen sc1
    s_waitcnt vmcnt(0)
    v_cmp_ne_u32 vcc, s4, v173
    s_cbranch_vccz PDONE_12
    s_add_u32 s5, s5, 1
    s_cmp_lt_u32 s5, 200000
    s_cbranch_scc1 POLL_11
PDONE_12:
L_STOK:
    v_lshlrev_b32 v173, 16, v172
    v_and_b32 v172, s6, v172
    v_rcp_f32 v172, v172
    s_nop 0
    v_pk_add_f32 v[184:185], v[184:185], v[172:173] op_sel:[0,1] neg_lo:[0,1] neg_hi:[0,1]
    v_pk_add_f32 v[186:187], v[186:187], v[172:173] op_sel:[0,1] neg_lo:[0,1] neg_hi:[0,1]
    v_pk_add_f32 v[188:189], v[188:189], v[172:173] op_sel:[0,1] neg_lo:[0,1] neg_hi:[0,1]
    v_pk_add_f32 v[190:191], v[190:191], v[172:173] op_sel:[0,1] neg_lo:[0,1] neg_hi:[0,1]
    v_pk_add_f32 v[192:193], v[192:193], v[172:173] op_sel:[0,1] neg_lo:[0,1] neg_hi:[0,1]
    v_pk_add_f32 v[194:195], v[194:195], v[172:173] op_sel:[0,1] neg_lo:[0,1] neg_hi:[0,1]
    v_pk_add_f32 v[196:197], v[196:197], v[172:173] op_sel:[0,1] neg_lo:[0,1] neg_hi:[0,1]
    v_pk_add_f32 v[198:199], v[198:199], v[172:173] op_sel:[0,1] neg_lo:[0,1] neg_hi:[0,1]
    v_cvt_pk_bf16_f32 v184, 0, v184
    v_cvt_pk_bf16_f32 v185, 0, v185
    v_cvt_pk_bf16_f32 v186, 0, v186
    v_cvt_pk_bf16_f32 v187, 0, v187
    v_cvt_pk_bf16_f32 v188, 0, v188
    v_cvt_pk_bf16_f32 v189, 0, v189
    v_cvt_pk_bf16_f32 v190, 0, v190
    v_cvt_pk_bf16_f32 v191, 0, v191
    v_cvt_pk_bf16_f32 v192, 0, v192
    v_cvt_pk_bf16_f32 v193, 0, v193
    v_cvt_pk_bf16_f32 v194, 0, v194
    v_cvt_pk_bf16_f32 v195, 0, v195
    v_cvt_pk_bf16_f32 v196, 0, v196
    v_cvt_pk_bf16_f32 v197, 0, v197
    v_cvt_pk_bf16_f32 v198, 0, v198
    v_cvt_pk_bf16_f32 v199, 0, v199
    v_pk_mul_f32 v[184:185], v[184:185], v[172:173] op_sel_hi:[1,0]
    v_pk_mul_f32 v[186:187], v[186:187], v[172:173] op_sel_hi:[1,0]
    v_pk_mul_f32 v[188:189], v[188:189], v[172:173] op_sel_hi:[1,0]
    v_pk_mul_f32 v[190:191], v[190:191], v[172:173] op_sel_hi:[1,0]
    v_pk_mul_f32 v[192:193], v[192:193], v[172:173] op_sel_hi:[1,0]
    v_pk_mul_f32 v[194:195], v[194:195], v[172:173] op_sel_hi:[1,0]
    v_pk_mul_f32 v[196:197], v[196:197], v[172:173] op_sel_hi:[1,0]
    v_pk_mul_f32 v[198:199], v[198:199], v[172:173] op_sel_hi:[1,0]
    v_cvt_pk_bf16_f32 v184, 0, v184
    v_cvt_pk_bf16_f32 v185, 0, v185
    v_cvt_pk_bf16_f32 v186, 0, v186
    v_cvt_pk_bf16_f32 v187, 0, v187
    v_cvt_pk_bf16_f32 v188, 0, v188
    v_cvt_pk_bf16_f32 v189, 0, v189
    v_cvt_pk_bf16_f32 v190, 0, v190
    v_cvt_pk_bf16_f32 v191, 0, v191
    v_cvt_pk_bf16_f32 v192, 0, v192
    v_cvt_pk_bf16_f32 v193, 0, v193
    v_cvt_pk_bf16_f32 v194, 0, v194
    v_cvt_pk_bf16_f32 v195, 0, v195
    v_cvt_pk_bf16_f32 v196, 0, v196
    v_cvt_pk_bf16_f32 v197, 0, v197
    v_cvt_pk_bf16_f32 v198, 0, v198
    v_cvt_pk_bf16_f32 v199, 0, v199
    v_mul_f32_dpp v184, v208, v184 row_newbcast:0 row_mask:0xf bank_mask:0xf
    v_mul_f32_dpp v185, v208, v185 row_newbcast:1 row_mask:0xf bank_mask:0xf
    v_mul_f32_dpp v186, v208, v186 row_newbcast:2 row_mask:0xf bank_mask:0xf
    v_mul_f32_dpp v187, v208, v187 row_newbcast:3 row_mask:0xf bank_mask:0xf
    v_mul_f32_dpp v188, v208, v188 row_newbcast:4 row_mask:0xf bank_mask:0xf
    v_mul_f32_dpp v189, v208, v189 row_newbcast:5 row_mask:0xf bank_mask:0xf
    v_mul_f32_dpp v190, v208, v190 row_newbcast:6 row_mask:0xf bank_mask:0xf
    v_mul_f32_dpp v191, v208, v191 row_newbcast:7 row_mask:0xf bank_mask:0xf
    v_cvt_pk_bf16_f32 v184, 0, v184
    v_cvt_pk_bf16_f32 v185, 0, v185
    v_cvt_pk_bf16_f32 v186, 0, v186
    v_cvt_pk_bf16_f32 v187, 0, v187
    v_cvt_pk_bf16_f32 v188, 0, v188
    v_cvt_pk_bf16_f32 v189, 0, v189
    v_cvt_pk_bf16_f32 v190, 0, v190
    v_cvt_pk_bf16_f32 v191, 0, v191
    v_add_f32_dpp v184, v200, v184 row_newbcast:0 row_mask:0xf bank_mask:0xf
    v_add_f32_dpp v185, v200, v185 row_newbcast:1 row_mask:0xf bank_mask:0xf
    v_add_f32_dpp v186, v200, v186 row_newbcast:2 row_mask:0xf bank_mask:0xf
    v_add_f32_dpp v187, v200, v187 row_newbcast:3 row_mask:0xf bank_mask:0xf
    v_add_f32_dpp v188, v200, v188 row_newbcast:4 row_mask:0xf bank_mask:0xf
    v_add_f32_dpp v189, v200, v189 row_newbcast:5 row_mask:0xf bank_mask:0xf
    v_add_f32_dpp v190, v200, v190 row_newbcast:6 row_mask:0xf bank_mask:0xf
    v_add_f32_dpp v191, v200, v191 row_newbcast:7 row_mask:0xf bank_mask:0xf
    v_cvt_pk_bf16_f32 v216, v184, v185
    v_cvt_pk_bf16_f32 v217, v186, v187
    v_cvt_pk_bf16_f32 v218, v188, v189
    v_cvt_pk_bf16_f32 v219, v190, v191
    buffer_store_dwordx4 v[216:219], v4, s[32:35], s13 offen sc1
    v_mul_f32_dpp v192, v208, v192 row_newbcast:8 row_mask:0xf bank_mask:0xf
    v_mul_f32_dpp v193, v208, v193 row_newbcast:9 row_mask:0xf bank_mask:0xf
    v_mul_f32_dpp v194, v208, v194 row_newbcast:10 row_mask:0xf bank_mask:0xf
    v_mul_f32_dpp v195, v208, v195 row_newbcast:11 row_mask:0xf bank_mask:0xf
    v_mul_f32_dpp v196, v208, v196 row_newbcast:12 row_mask:0xf bank_mask:0xf
    v_mul_f32_dpp v197, v208, v197 row_newbcast:13 row_mask:0xf bank_mask:0xf
    v_mul_f32_dpp v198, v208, v198 row_newbcast:14 row_mask:0xf bank_mask:0xf
    v_mul_f32_dpp v199, v208, v199 row_newbcast:15 row_mask:0xf bank_mask:0xf
    v_cvt_pk_bf16_f32 v192, 0, v192
    v_cvt_pk_bf16_f32 v193, 0, v193
    v_cvt_pk_bf16_f32 v194, 0, v194
    v_cvt_pk_bf16_f32 v195, 0, v195
    v_cvt_pk_bf16_f32 v196, 0, v196
    v_cvt_pk_bf16_f32 v197, 0, v197
    v_cvt_pk_bf16_f32 v198, 0, v198
    v_cvt_pk_bf16_f32 v199, 0, v199
    v_add_f32_dpp v192, v200, v192 row_newbcast:8 row_mask:0xf bank_mask:0xf
    v_add_f32_dpp v193, v200, v193 row_newbcast:9 row_mask:0xf bank_mask:0xf
    v_add_f32_dpp v194, v200, v194 row_newbcast:10 row_mask:0xf bank_mask:0xf
    v_add_f32_dpp v195, v200, v195 row_newbcast:11 row_mask:0xf bank_mask:0xf
    v_add_f32_dpp v196, v200, v196 row_newbcast:12 row_mask:0xf bank_mask:0xf
    v_add_f32_dpp v197, v200, v197 row_newbcast:13 row_mask:0xf bank_mask:0xf
    v_add_f32_dpp v198, v200, v198 row_newbcast:14 row_mask:0xf bank_mask:0xf
    v_add_f32_dpp v199, v200, v199 row_newbcast:15 row_mask:0xf bank_mask:0xf
    v_cvt_pk_bf16_f32 v220, v192, v193
    v_cvt_pk_bf16_f32 v221, v194, v195
    v_cvt_pk_bf16_f32 v222, v196, v197
    v_cvt_pk_bf16_f32 v223, v198, v199
    buffer_store_dwordx4 v[220:223], v4, s[32:35], s13 offen offset:2048 sc1
    v_bfe_u32 v20, v1, 2, 2
    v_lshlrev_b32 v20, 7, v20
    v_bfe_u32 v9, v1, 3, 1
    v_lshl_add_u32 v20, v9, 6, v20
    v_bfe_u32 v9, v1, 4, 1
    v_lshl_add_u32 v20, v9, 5, v20
    v_and_b32 v9, 3, v1
    v_lshl_add_u32 v20, v9, 3, v20
    v_lshrrev_b32 v9, 5, v1
    v_lshl_add_u32 v20, v9, 9, v20
    v_xor_b32 v21, 64, v20
    v_add_u32 v22, 49152, v20
    v_add_u32 v23, 49152, v21
    v_add_u32 v24, 98304, v20
    v_add_u32 v25, 98304, v21
    v_and_b32 v5, 3, v1
    v_lshlrev_b32 v5, 15, v5
    v_bfe_u32 v9, v1, 2, 2
    v_lshl_add_u32 v5, v9, 12, v5
    s_and_b32 s96, s12, 1
    s_lshr_b32 s97, s21, 3
    s_and_b32 s98, s21, 7
    s_lshl_b32 s99, s98, 5
    s_lshl2_add_u32 s98, s97, s99
    s_lshl_b32 s97, s98, 12
    s_lshr_b32 s99, s12, 1
    s_lshl_b32 s98, s99, 6
    s_add_u32 s99, s97, s98
    s_lshl2_add_u32 s97, s96, s99
    s_add_u32 s13, s97, 1048576
    s_lshl_b32 s96, s10, 18
    s_lshl_b32 s97, s77, 12
    s_add_u32 s98, s96, s97
    s_add_u32 s88, s98, 4194304
    s_cmp_ge_u32 s9, 28
    s_cselect_b32 s54, 0, s54
    s_cselect_b32 s58, 0, s58
    s_cselect_b32 s62, 0, s62
    s_waitcnt vmcnt(0)
    s_barrier
    s_cmp_lg_u32 s3, 0
    s_cbranch_scc1 L_PB
    v_mov_b32 v6, s4
    s_mov_b32 exec_hi, 0
    s_mov_b32 exec_lo, 65535
    buffer_store_dword v6, v5, s[32:35], s13 offen sc1
    s_mov_b64 exec, -1
L_PB:
    s_lshr_b32 s96, s9, 4
    s_lshl_b32 s97, s96, 1
    s_xor_b32 s94, s97, 2
    s_add_u32 s96, s94, s84
    s_and_b32 s97, s96, 15
    s_mul_i32 s98, s97, 393216
    s_add_u32 s91, s98, s85
    s_lshl_b32 s96, s94, 13
    s_add_u32 s94, s96, s83
    s_add_u32 s82, s91, 2048
    s_mov_b32 m0, s94
    s_nop 0
    buffer_load_dwordx4 v3, s[40:43], s82 offen lds
    s_add_u32 s82, s91, 4096
    s_add_u32 m0, s94, 49152
    s_nop 0
    buffer_load_dwordx4 v3, s[40:43], s82 offen lds
    s_mov_b32 s82, s91
    s_add_u32 m0, s94, 98304
    s_nop 0
    buffer_load_dwordx4 v3, s[40:43], s82 offen lds
    s_lshr_b32 s96, s9, 4
    s_lshl_b32 s97, s96, 1
    s_xor_b32 s94, s97, 3
    s_add_u32 s96, s94, s84
    s_and_b32 s97, s96, 15
    s_mul_i32 s98, s97, 393216
    s_add_u32 s91, s98, s85
    s_lshl_b32 s96, s94, 13
    s_add_u32 s94, s96, s83
    s_add_u32 s82, s91, 2048
    s_mov_b32 m0, s94
    s_nop 0
    buffer_load_dwordx4 v3, s[40:43], s82 offen lds
    s_add_u32 s82, s91, 4096
    s_add_u32 m0, s94, 49152
    s_nop 0
    buffer_load_dwordx4 v3, s[40:43], s82 offen lds
    s_mov_b32 s82, s91
    s_add_u32 m0, s94, 98304
    s_nop 0
    buffer_load_dwordx4 v3, s[40:43], s82 offen lds
    s_lshl_b32 s96, s2, 12
    s_add_u32 s19, s96, 1048576
    s_and_b32 s96, s3, 3
    s_lshl_b32 s97, s96, 7
    s_add_u32 s20, s97, s19
    s_lshl_b32 s96, s84, 5
    s_add_u32 s19, s96, s19
    s_cmp_ge_u32 s3, 4
    s_cselect_b32 s19, s20, s19
    s_load_dwordx2 s[24:25], s[32:33], s19 offset:0 glc
    s_load_dwordx2 s[26:27], s[32:33], s19 offset:64 glc
    s_add_u32 s96, s84, 4
    s_and_b32 s97, s96, 15
    s_mul_i32 s98, s97, 393216
    s_add_u32 s91, s98, s85
    s_add_u32 s94, s83, 32768
    s_add_u32 s82, s91, 2048
    s_mov_b32 m0, s94
    s_nop 0
    buffer_load_dwordx4 v3, s[40:43], s82 offen lds
    s_add_u32 s82, s91, 4096
    s_add_u32 m0, s94, 49152
    s_nop 0
    buffer_load_dwordx4 v3, s[40:43], s82 offen lds
    s_mov_b32 s82, s91
    s_add_u32 m0, s94, 98304
    s_nop 0
    buffer_load_dwordx4 v3, s[40:43], s82 offen lds
    s_lshl_b32 s96, s3, 14
    s_lshl_b32 s97, s12, 7
    s_add_u32 s90, s96, s97
    s_and_b32 s96, s9, 1
    s_lshr_b32 s97, s9, 3
    s_lshl_b32 s98, s97, 1
    s_lshl3_add_u32 s99, s96, s98
    s_lshl_b32 s95, s99, 17
    s_lshl3_add_u32 s96, s75, s3
    s_mul_i32 s97, s96, 229376
    s_lshl_b32 s98, s74, 7
    s_add_u32 s80, s97, s98
    s_lshl3_add_u32 s96, s74, s3
    s_lshl_b32 s97, s96, 14
    s_lshl_b32 s98, s75, 9
    s_add_u32 s81, s97, s98
    s_and_b32 s96, s8, 3
    s_lshl3_add_u32 s97, s96, s3
    s_mul_i32 s98, s97, 393216
    s_lshr_b32 s99, s8, 2
    s_lshl1_add_u32 s96, s9, s99
    s_lshl_b32 s97, s96, 7
    s_add_u32 s99, s98, s97
    s_add_u32 s89, s99, 4096
    s_and_b32 s96, s3, 1
    s_lshl_b32 s14, s96, 6
    v_bfe_u32 v6, v1, 4, 1
    v_lshl_add_u32 v6, v6, 5, s14
    v_and_b32 v26, 7, v1
    v_lshlrev_b32 v26, 4, v26
    v_xor_b32 v26, v26, v6
    v_lshrrev_b32 v6, 3, v1
    v_lshlrev_b32 v6, 11, v6
    v_add_u32 v26, v26, v6
    s_and_b32 s96, s3, 2
    s_lshl_b32 s14, s96, 5
    v_bfe_u32 v6, v1, 4, 1
    v_lshl_add_u32 v6, v6, 5, s14
    v_and_b32 v27, 7, v1
    v_lshlrev_b32 v27, 4, v27
    v_xor_b32 v27, v27, v6
    v_lshrrev_b32 v6, 3, v1
    v_mul_u32_u24 v6, 7168, v6
    v_add_u32 v27, v27, v6
    s_and_b32 s96, s3, 1
    s_lshl_b32 s14, s96, 7
    v_lshrrev_b32 v6, 5, v1
    v_lshl_add_u32 v6, v6, 6, s14
    v_and_b32 v253, 31, v1
    v_lshlrev_b32 v253, 4, v253
    v_lshrrev_b32 v9, 5, v1
    v_lshl_add_u32 v253, v9, 11, v253
    v_xor_b32 v253, v253, v6
    s_lshl_b32 s16, s84, 14
    v_add_u32 v249, s88, v2
    s_lshl_b32 s96, s77, 11
    s_add_u32 s14, s96, 151552
    v_add_u32 v0, s14, v2
    s_mov_b64 exec, 0
    s_cmp_eq_u32 s3, 4
    s_cbranch_scc1 L_PAD2
    s_cmp_eq_u32 s3, 5
    s_cbranch_scc1 L_PAD3
    s_cmp_eq_u32 s3, 6
    s_cbranch_scc1 L_PAD4
    s_cmp_eq_u32 s3, 7
    s_cbranch_scc1 L_PAD5
    s_branch L_TEND
L_RET2:
    s_branch L_PAD6
L_RET6:
    s_branch L_PAD10
L_RET10:
    s_branch L_TEND
L_RET3:
    s_branch L_PAD7
L_RET7:
    s_branch L_TEND
L_RET4:
    s_branch L_PAD8
L_RET8:
    s_branch L_TEND
L_RET5:
    s_branch L_PAD9
L_RET9:
    s_branch L_TEND
    s_nop 0
    s_nop 0
    s_nop 0
    s_nop 0
    s_nop 0
    s_nop 0
    s_nop 0
    s_nop 0
    s_nop 0
    s_nop 0
    s_nop 0
    s_nop 0
    s_nop 0
    s_nop 0
    s_nop 0
    s_nop 0
    s_nop 0
    s_nop 0
    s_nop 0
    s_nop 0
    s_nop 0
    s_nop 0
    s_nop 0
    s_nop 0
    s_nop 0
    s_nop 0
    s_nop 0
    s_nop 0
L_TEND:
    s_mov_b64 exec, -1
    s_branch SCHK_14
SPOLL_13:
    s_load_dwordx2 s[24:25], s[32:33], s19 offset:0 glc
    s_load_dwordx2 s[26:27], s[32:33], s19 offset:64 glc
SCHK_14:
    s_add_u32 s5, s5, 1
    s_cmp_ge_u32 s5, 200000
    s_waitcnt lgkmcnt(0)
    s_cbranch_scc1 SDONE_15
    s_cmp_lg_u32 s24, s4
    s_cbranch_scc1 SPOLL_13
    s_cmp_lg_u32 s25, s4
    s_cbranch_scc1 SPOLL_13
    s_cmp_lg_u32 s26, s4
    s_cbranch_scc1 SPOLL_13
    s_cmp_lg_u32 s27, s4
    s_cbranch_scc1 SPOLL_13
SDONE_15:
    s_cmp_ge_u32 s3, 4
    s_cbranch_scc1 L_HELP
    s_setprio 2
    buffer_load_dwordx4 v[152:155], v249, s[32:35], s16 offen sc1
    buffer_load_dwordx4 v[156:159], v249, s[32:35], s16 offen offset:1024 sc1
    buffer_load_dwordx4 v[160:163], v249, s[32:35], s16 offen offset:2048 sc1
    buffer_load_dwordx4 v[164:167], v249, s[32:35], s16 offen offset:3072 sc1
    s_add_u32 s16, s16, 16384
    s_and_b32 s16, s16, 0x3ffff
    buffer_load_dwordx4 v[168:171], v249, s[32:35], s16 offen sc1
    buffer_load_dwordx4 v[172:175], v249, s[32:35], s16 offen offset:1024 sc1
    s_waitcnt vmcnt(9)
    s_barrier
    ds_read_b64_tr_b16 v[28:29], v20
    ds_read_b64_tr_b16 v[30:31], v20 offset:2048
    ds_read_b64_tr_b16 v[32:33], v21
    ds_read_b64_tr_b16 v[34:35], v21 offset:2048
    ds_read_b64_tr_b16 v[36:37], v24
    ds_read_b64_tr_b16 v[38:39], v24 offset:2048
    ds_read_b64_tr_b16 v[40:41], v25
    ds_read_b64_tr_b16 v[42:43], v25 offset:2048
    ds_read_b64_tr_b16 v[44:45], v22
    ds_read_b64_tr_b16 v[46:47], v22 offset:2048
    ds_read_b64_tr_b16 v[48:49], v23
    ds_read_b64_tr_b16 v[50:51], v23 offset:2048
    s_waitcnt vmcnt(5)
    s_waitcnt lgkmcnt(10)
    v_mfma_f32_32x32x16_bf16 v[56:71], v[28:31], v[152:155], 0
    ds_read_b64_tr_b16 v[52:53], v20 offset:1024
    ds_read_b64_tr_b16 v[54:55], v20 offset:3072
    s_waitcnt lgkmcnt(10)
    v_mfma_f32_32x32x16_bf16 v[72:87], v[32:35], v[152:155], 0
    ds_read_b64_tr_b16 v[28:29], v21 offset:1024
    ds_read_b64_tr_b16 v[30:31], v21 offset:3072
    s_waitcnt lgkmcnt(10)
    v_mfma_f32_32x32x16_bf16 v[120:135], v[36:39], v[152:155], 0
    ds_read_b64_tr_b16 v[32:33], v24 offset:1024
    ds_read_b64_tr_b16 v[34:35], v24 offset:3072
    s_waitcnt lgkmcnt(10)
    v_mfma_f32_32x32x16_bf16 v[136:151], v[40:43], v[152:155], 0
    ds_read_b64_tr_b16 v[36:37], v25 offset:1024
    ds_read_b64_tr_b16 v[38:39], v25 offset:3072
    s_waitcnt lgkmcnt(10)
    v_mfma_f32_32x32x16_bf16 v[88:103], v[44:47], v[152:155], 0
    buffer_load_dwordx4 v[176:179], v249, s[32:35], s16 offen offset:2048 sc1
    ds_read_b64_tr_b16 v[40:41], v22 offset:1024
    ds_read_b64_tr_b16 v[42:43], v22 offset:3072
    s_waitcnt lgkmcnt(10)
    v_mfma_f32_32x32x16_bf16 v[104:119], v[48:51], v[152:155], 0
    ds_read_b64_tr_b16 v[44:45], v23 offset:1024
    ds_read_b64_tr_b16 v[46:47], v23 offset:3072
    s_waitcnt vmcnt(5)
    s_waitcnt lgkmcnt(10)
    v_mfma_f32_32x32x16_bf16 v[56:71], v[52:55], v[156:159], v[56:71]
    ds_read_b64_tr_b16 v[48:49], v20 offset:4096
    ds_read_b64_tr_b16 v[50:51], v20 offset:6144
    s_waitcnt lgkmcnt(10)
    v_mfma_f32_32x32x16_bf16 v[72:87], v[28:31], v[156:159], v[72:87]
    ds_read_b64_tr_b16 v[52:53], v21 offset:4096
    ds_read_b64_tr_b16 v[54:55], v21 offset:6144
    s_waitcnt lgkmcnt(10)
    v_mfma_f32_32x32x16_bf16 v[120:135], v[32:35], v[156:159], v[120:135]
    ds_read_b64_tr_b16 v[28:29], v24 offset:4096
    ds_read_b64_tr_b16 v[30:31], v24 offset:6144
    s_waitcnt lgkmcnt(10)
    v_mfma_f32_32x32x16_bf16 v[136:151], v[36:39], v[156:159], v[136:151]
    buffer_load_dwordx4 v[180:183], v249, s[32:35], s16 offen offset:3072 sc1
    ds_read_b64_tr_b16 v[32:33], v25 offset:4096
    ds_read_b64_tr_b16 v[34:35], v25 offset:6144
    s_waitcnt lgkmcnt(10)
    v_mfma_f32_32x32x16_bf16 v[88:103], v[40:43], v[156:159], v[88:103]
    s_add_u32 s16, s16, 16384
    ds_read_b64_tr_b16 v[36:37], v22 offset:4096
    ds_read_b64_tr_b16 v[38:39], v22 offset:6144
    s_waitcnt lgkmcnt(10)
    v_mfma_f32_32x32x16_bf16 v[104:119], v[44:47], v[156:159], v[104:119]
    s_and_b32 s16, s16, 0x3ffff
    ds_read_b64_tr_b16 v[40:41], v23 offset:4096
    ds_read_b64_tr_b16 v[42:43], v23 offset:6144
    s_waitcnt vmcnt(5)
    s_waitcnt lgkmcnt(10)
    v_mfma_f32_32x32x16_bf16 v[56:71], v[48:51], v[160:163], v[56:71]
    ds_read_b64_tr_b16 v[44:45], v20 offset:5120
    ds_read_b64_tr_b16 v[46:47], v20 offset:7168
    s_waitcnt lgkmcnt(10)
    v_mfma_f32_32x32x16_bf16 v[72:87], v[52:55], v[160:163], v[72:87]
    ds_read_b64_tr_b16 v[48:49], v21 offset:5120
    ds_read_b64_tr_b16 v[50:51], v21 offset:7168
    s_waitcnt lgkmcnt(10)
    v_mfma_f32_32x32x16_bf16 v[120:135], v[28:31], v[160:163], v[120:135]
    buffer_load_dwordx4 v[184:187], v249, s[32:35], s16 offen sc1
    ds_read_b64_tr_b16 v[52:53], v24 offset:5120
    ds_read_b64_tr_b16 v[54:55], v24 offset:7168
    s_waitcnt lgkmcnt(10)
    v_mfma_f32_32x32x16_bf16 v[136:151], v[32:35], v[160:163], v[136:151]
    ds_read_b64_tr_b16 v[28:29], v25 offset:5120
    ds_read_b64_tr_b16 v[30:31], v25 offset:7168
    s_waitcnt lgkmcnt(10)
    v_mfma_f32_32x32x16_bf16 v[88:103], v[36:39], v[160:163], v[88:103]
    ds_read_b64_tr_b16 v[32:33], v22 offset:5120
    ds_read_b64_tr_b16 v[34:35], v22 offset:7168
    s_waitcnt lgkmcnt(10)
    v_mfma_f32_32x32x16_bf16 v[104:119], v[40:43], v[160:163], v[104:119]
    ds_read_b64_tr_b16 v[36:37], v23 offset:5120
    ds_read_b64_tr_b16 v[38:39], v23 offset:7168
    s_waitcnt vmcnt(5)
    s_waitcnt lgkmcnt(10)
    v_mfma_f32_32x32x16_bf16 v[56:71], v[44:47], v[164:167], v[56:71]
    ds_read_b64_tr_b16 v[40:41], v20 offset:8192
    ds_read_b64_tr_b16 v[42:43], v20 offset:10240
    s_waitcnt lgkmcnt(10)
    v_mfma_f32_32x32x16_bf16 v[72:87], v[48:51], v[164:167], v[72:87]
    buffer_load_dwordx4 v[188:191], v249, s[32:35], s16 offen offset:1024 sc1
    ds_read_b64_tr_b16 v[44:45], v21 offset:8192
    ds_read_b64_tr_b16 v[46:47], v21 offset:10240
    s_waitcnt lgkmcnt(10)
    v_mfma_f32_32x32x16_bf16 v[120:135], v[52:55], v[164:167], v[120:135]
    ds_read_b64_tr_b16 v[48:49], v24 offset:8192
    ds_read_b64_tr_b16 v[50:51], v24 offset:10240
    s_waitcnt lgkmcnt(10)
    v_mfma_f32_32x32x16_bf16 v[136:151], v[28:31], v[164:167], v[136:151]
    ds_read_b64_tr_b16 v[52:53], v25 offset:8192
    ds_read_b64_tr_b16 v[54:55], v25 offset:10240
    s_waitcnt lgkmcnt(10)
    v_mfma_f32_32x32x16_bf16 v[88:103], v[32:35], v[164:167], v[88:103]
    ds_read_b64_tr_b16 v[28:29], v22 offset:8192
    ds_read_b64_tr_b16 v[30:31], v22 offset:10240
    s_waitcnt lgkmcnt(10)
    v_mfma_f32_32x32x16_bf16 v[104:119], v[36:39], v[164:167], v[104:119]
    buffer_load_dwordx4 v[192:195], v249, s[32:35], s16 offen offset:2048 sc1
    ds_read_b64_tr_b16 v[32:33], v23 offset:8192
    ds_read_b64_tr_b16 v[34:35], v23 offset:10240
    s_barrier
    s_waitcnt vmcnt(6)
    s_waitcnt lgkmcnt(10)
    v_mfma_f32_32x32x16_bf16 v[56:71], v[40:43], v[168:171], v[56:71]
    ds_read_b64_tr_b16 v[36:37], v20 offset:9216
    ds_read_b64_tr_b16 v[38:39], v20 offset:11264
    s_waitcnt lgkmcnt(10)
    v_mfma_f32_32x32x16_bf16 v[72:87], v[44:47], v[168:171], v[72:87]
    ds_read_b64_tr_b16 v[40:41], v21 offset:9216
    ds_read_b64_tr_b16 v[42:43], v21 offset:11264
    s_waitcnt lgkmcnt(10)
    v_mfma_f32_32x32x16_bf16 v[120:135], v[48:51], v[168:171], v[120:135]
    ds_read_b64_tr_b16 v[44:45], v24 offset:9216
    ds_read_b64_tr_b16 v[46:47], v24 offset:11264
    s_waitcnt lgkmcnt(10)
    v_mfma_f32_32x32x16_bf16 v[136:151], v[52:55], v[168:171], v[136:151]
    ds_read_b64_tr_b16 v[48:49], v25 offset:9216
    ds_read_b64_tr_b16 v[50:51], v25 offset:11264
    s_waitcnt lgkmcnt(10)
    v_mfma_f32_32x32x16_bf16 v[88:103], v[28:31], v[168:171], v[88:103]
    buffer_load_dwordx4 v[196:199], v249, s[32:35], s16 offen offset:3072 sc1
    ds_read_b64_tr_b16 v[52:53], v22 offset:9216
    ds_read_b64_tr_b16 v[54:55], v22 offset:11264
    s_waitcnt lgkmcnt(10)
    v_mfma_f32_32x32x16_bf16 v[104:119], v[32:35], v[168:171], v[104:119]
    s_add_u32 s16, s16, 16384
    ds_read_b64_tr_b16 v[28:29], v23 offset:9216
    ds_read_b64_tr_b16 v[30:31], v23 offset:11264
    s_waitcnt vmcnt(6)
    s_waitcnt lgkmcnt(10)
    v_mfma_f32_32x32x16_bf16 v[56:71], v[36:39], v[172:175], v[56:71]
    s_and_b32 s16, s16, 0x3ffff
    ds_read_b64_tr_b16 v[32:33], v20 offset:12288
    ds_read_b64_tr_b16 v[34:35], v20 offset:14336
    s_waitcnt lgkmcnt(10)
    v_mfma_f32_32x32x16_bf16 v[72:87], v[40:43], v[172:175], v[72:87]
    ds_read_b64_tr_b16 v[36:37], v21 offset:12288
    ds_read_b64_tr_b16 v[38:39], v21 offset:14336
    s_waitcnt lgkmcnt(10)
    v_mfma_f32_32x32x16_bf16 v[120:135], v[44:47], v[172:175], v[120:135]
    ds_read_b64_tr_b16 v[40:41], v24 offset:12288
    ds_read_b64_tr_b16 v[42:43], v24 offset:14336
    s_waitcnt lgkmcnt(10)
    v_mfma_f32_32x32x16_bf16 v[136:151], v[48:51], v[172:175], v[136:151]
    buffer_load_dwordx4 v[200:203], v249, s[32:35], s16 offen sc1
    ds_read_b64_tr_b16 v[44:45], v25 offset:12288
    ds_read_b64_tr_b16 v[46:47], v25 offset:14336
    s_waitcnt lgkmcnt(10)
    v_mfma_f32_32x32x16_bf16 v[88:103], v[52:55], v[172:175], v[88:103]
    ds_read_b64_tr_b16 v[48:49], v22 offset:12288
    ds_read_b64_tr_b16 v[50:51], v22 offset:14336
    s_waitcnt lgkmcnt(10)
    v_mfma_f32_32x32x16_bf16 v[104:119], v[28:31], v[172:175], v[104:119]
    ds_read_b64_tr_b16 v[52:53], v23 offset:12288
    ds_read_b64_tr_b16 v[54:55], v23 offset:14336
    s_waitcnt vmcnt(6)
    s_waitcnt lgkmcnt(10)
    v_mfma_f32_32x32x16_bf16 v[56:71], v[32:35], v[176:179], v[56:71]
    ds_read_b64_tr_b16 v[28:29], v20 offset:13312
    ds_read_b64_tr_b16 v[30:31], v20 offset:15360
    s_waitcnt lgkmcnt(10)
    v_mfma_f32_32x32x16_bf16 v[72:87], v[36:39], v[176:179], v[72:87]
    ds_read_b64_tr_b16 v[32:33], v21 offset:13312
    ds_read_b64_tr_b16 v[34:35], v21 offset:15360
    s_waitcnt lgkmcnt(10)
    v_mfma_f32_32x32x16_bf16 v[120:135], v[40:43], v[176:179], v[120:135]
    buffer_load_dwordx4 v[204:207], v249, s[32:35], s16 offen offset:1024 sc1
    ds_read_b64_tr_b16 v[36:37], v24 offset:13312
    ds_read_b64_tr_b16 v[38:39], v24 offset:15360
    s_waitcnt lgkmcnt(10)
    v_mfma_f32_32x32x16_bf16 v[136:151], v[44:47], v[176:179], v[136:151]
    ds_read_b64_tr_b16 v[40:41], v25 offset:13312
    ds_read_b64_tr_b16 v[42:43], v25 offset:15360
    s_waitcnt lgkmcnt(10)
    v_mfma_f32_32x32x16_bf16 v[88:103], v[48:51], v[176:179], v[88:103]
    ds_read_b64_tr_b16 v[44:45], v22 offset:13312
    ds_read_b64_tr_b16 v[46:47], v22 offset:15360
    s_waitcnt lgkmcnt(10)
    v_mfma_f32_32x32x16_bf16 v[104:119], v[52:55], v[176:179], v[104:119]
    ds_read_b64_tr_b16 v[48:49], v23 offset:13312
    ds_read_b64_tr_b16 v[50:51], v23 offset:15360
    s_waitcnt vmcnt(6)
    s_waitcnt lgkmcnt(10)
    v_mfma_f32_32x32x16_bf16 v[56:71], v[28:31], v[180:183], v[56:71]
    ds_read_b64_tr_b16 v[52:53], v20 offset:16384
    ds_read_b64_tr_b16 v[54:55], v20 offset:18432
    s_waitcnt lgkmcnt(10)
    v_mfma_f32_32x32x16_bf16 v[72:87], v[32:35], v[180:183], v[72:87]
    buffer_load_dwordx4 v[208:211], v249, s[32:35], s16 offen offset:2048 sc1
    ds_read_b64_tr_b16 v[28:29], v21 offset:16384
    ds_read_b64_tr_b16 v[30:31], v21 offset:18432
    s_waitcnt lgkmcnt(10)
    v_mfma_f32_32x32x16_bf16 v[120:135], v[36:39], v[180:183], v[120:135]
    ds_read_b64_tr_b16 v[32:33], v24 offset:16384
    ds_read_b64_tr_b16 v[34:35], v24 offset:18432
    s_waitcnt lgkmcnt(10)
    v_mfma_f32_32x32x16_bf16 v[136:151], v[40:43], v[180:183], v[136:151]
    ds_read_b64_tr_b16 v[36:37], v25 offset:16384
    ds_read_b64_tr_b16 v[38:39], v25 offset:18432
    s_waitcnt lgkmcnt(10)
    v_mfma_f32_32x32x16_bf16 v[88:103], v[44:47], v[180:183], v[88:103]
    ds_read_b64_tr_b16 v[40:41], v22 offset:16384
    ds_read_b64_tr_b16 v[42:43], v22 offset:18432
    s_waitcnt lgkmcnt(10)
    v_mfma_f32_32x32x16_bf16 v[104:119], v[48:51], v[180:183], v[104:119]
    buffer_load_dwordx4 v[212:215], v249, s[32:35], s16 offen offset:3072 sc1
    ds_read_b64_tr_b16 v[44:45], v23 offset:16384
    ds_read_b64_tr_b16 v[46:47], v23 offset:18432
    s_barrier
    s_waitcnt vmcnt(7)
    s_waitcnt lgkmcnt(10)
    v_mfma_f32_32x32x16_bf16 v[56:71], v[52:55], v[184:187], v[56:71]
    s_add_u32 s16, s16, 16384
    ds_read_b64_tr_b16 v[48:49], v20 offset:17408
    ds_read_b64_tr_b16 v[50:51], v20 offset:19456
    s_waitcnt lgkmcnt(10)
    v_mfma_f32_32x32x16_bf16 v[72:87], v[28:31], v[184:187], v[72:87]
    s_and_b32 s16, s16, 0x3ffff
    ds_read_b64_tr_b16 v[52:53], v21 offset:17408
    ds_read_b64_tr_b16 v[54:55], v21 offset:19456
    s_waitcnt lgkmcnt(10)
    v_mfma_f32_32x32x16_bf16 v[120:135], v[32:35], v[184:187], v[120:135]
    ds_read_b64_tr_b16 v[28:29], v24 offset:17408
    ds_read_b64_tr_b16 v[30:31], v24 offset:19456
    s_waitcnt lgkmcnt(10)
    v_mfma_f32_32x32x16_bf16 v[136:151], v[36:39], v[184:187], v[136:151]
    ds_read_b64_tr_b16 v[32:33], v25 offset:17408
    ds_read_b64_tr_b16 v[34:35], v25 offset:19456
    s_waitcnt lgkmcnt(10)
    v_mfma_f32_32x32x16_bf16 v[88:103], v[40:43], v[184:187], v[88:103]
    buffer_load_dwordx4 v[216:219], v249, s[32:35], s16 offen sc1
    ds_read_b64_tr_b16 v[36:37], v22 offset:17408
    ds_read_b64_tr_b16 v[38:39], v22 offset:19456
    s_waitcnt lgkmcnt(10)
    v_mfma_f32_32x32x16_bf16 v[104:119], v[44:47], v[184:187], v[104:119]
    ds_read_b64_tr_b16 v[40:41], v23 offset:17408
    ds_read_b64_tr_b16 v[42:43], v23 offset:19456
    s_waitcnt vmcnt(7)
    s_waitcnt lgkmcnt(10)
    v_mfma_f32_32x32x16_bf16 v[56:71], v[48:51], v[188:191], v[56:71]
    ds_read_b64_tr_b16 v[44:45], v20 offset:20480
    ds_read_b64_tr_b16 v[46:47], v20 offset:22528
    s_waitcnt lgkmcnt(10)
    v_mfma_f32_32x32x16_bf16 v[72:87], v[52:55], v[188:191], v[72:87]
    ds_read_b64_tr_b16 v[48:49], v21 offset:20480
    ds_read_b64_tr_b16 v[50:51], v21 offset:22528
    s_waitcnt lgkmcnt(10)
    v_mfma_f32_32x32x16_bf16 v[120:135], v[28:31], v[188:191], v[120:135]
    ds_read_b64_tr_b16 v[52:53], v24 offset:20480
    ds_read_b64_tr_b16 v[54:55], v24 offset:22528
    s_waitcnt lgkmcnt(10)
    v_mfma_f32_32x32x16_bf16 v[136:151], v[32:35], v[188:191], v[136:151]
    buffer_load_dwordx4 v[220:223], v249, s[32:35], s16 offen offset:1024 sc1
    ds_read_b64_tr_b16 v[28:29], v25 offset:20480
    ds_read_b64_tr_b16 v[30:31], v25 offset:22528
    s_waitcnt lgkmcnt(10)
    v_mfma_f32_32x32x16_bf16 v[88:103], v[36:39], v[188:191], v[88:103]
    ds_read_b64_tr_b16 v[32:33], v22 offset:20480
    ds_read_b64_tr_b16 v[34:35], v22 offset:22528
    s_waitcnt lgkmcnt(10)
    v_mfma_f32_32x32x16_bf16 v[104:119], v[40:43], v[188:191], v[104:119]
    ds_read_b64_tr_b16 v[36:37], v23 offset:20480
    ds_read_b64_tr_b16 v[38:39], v23 offset:22528
    s_waitcnt vmcnt(7)
    s_waitcnt lgkmcnt(10)
    v_mfma_f32_32x32x16_bf16 v[56:71], v[44:47], v[192:195], v[56:71]
    ds_read_b64_tr_b16 v[40:41], v20 offset:21504
    ds_read_b64_tr_b16 v[42:43], v20 offset:23552
    s_waitcnt lgkmcnt(10)
    v_mfma_f32_32x32x16_bf16 v[72:87], v[48:51], v[192:195], v[72:87]
    ds_read_b64_tr_b16 v[44:45], v21 offset:21504
    ds_read_b64_tr_b16 v[46:47], v21 offset:23552
    s_waitcnt lgkmcnt(10)
    v_mfma_f32_32x32x16_bf16 v[120:135], v[52:55], v[192:195], v[120:135]
    buffer_load_dwordx4 v[224:227], v249, s[32:35], s16 offen offset:2048 sc1
    ds_read_b64_tr_b16 v[48:49], v24 offset:21504
    ds_read_b64_tr_b16 v[50:51], v24 offset:23552
    s_waitcnt lgkmcnt(10)
    v_mfma_f32_32x32x16_bf16 v[136:151], v[28:31], v[192:195], v[136:151]
    ds_read_b64_tr_b16 v[52:53], v25 offset:21504
    ds_read_b64_tr_b16 v[54:55], v25 offset:23552
    s_waitcnt lgkmcnt(10)
    v_mfma_f32_32x32x16_bf16 v[88:103], v[32:35], v[192:195], v[88:103]
    ds_read_b64_tr_b16 v[28:29], v22 offset:21504
    ds_read_b64_tr_b16 v[30:31], v22 offset:23552
    s_waitcnt lgkmcnt(10)
    v_mfma_f32_32x32x16_bf16 v[104:119], v[36:39], v[192:195], v[104:119]
    ds_read_b64_tr_b16 v[32:33], v23 offset:21504
    ds_read_b64_tr_b16 v[34:35], v23 offset:23552
    s_waitcnt vmcnt(7)
    s_waitcnt lgkmcnt(10)
    v_mfma_f32_32x32x16_bf16 v[56:71], v[40:43], v[196:199], v[56:71]
    ds_read_b64_tr_b16 v[36:37], v20 offset:24576
    ds_read_b64_tr_b16 v[38:39], v20 offset:26624
    s_waitcnt lgkmcnt(10)
    v_mfma_f32_32x32x16_bf16 v[72:87], v[44:47], v[196:199], v[72:87]
    buffer_load_dwordx4 v[228:231], v249, s[32:35], s16 offen offset:3072 sc1
    ds_read_b64_tr_b16 v[40:41], v21 offset:24576
    ds_read_b64_tr_b16 v[42:43], v21 offset:26624
    s_waitcnt lgkmcnt(10)
    v_mfma_f32_32x32x16_bf16 v[120:135], v[48:51], v[196:199], v[120:135]
    s_add_u32 s16, s16, 16384
    ds_read_b64_tr_b16 v[44:45], v24 offset:24576
    ds_read_b64_tr_b16 v[46:47], v24 offset:26624
    s_waitcnt lgkmcnt(10)
    v_mfma_f32_32x32x16_bf16 v[136:151], v[52:55], v[196:199], v[136:151]
    s_and_b32 s16, s16, 0x3ffff
    ds_read_b64_tr_b16 v[48:49], v25 offset:24576
    ds_read_b64_tr_b16 v[50:51], v25 offset:26624
    s_waitcnt lgkmcnt(10)
    v_mfma_f32_32x32x16_bf16 v[88:103], v[28:31], v[196:199], v[88:103]
    ds_read_b64_tr_b16 v[52:53], v22 offset:24576
    ds_read_b64_tr_b16 v[54:55], v22 offset:26624
    s_waitcnt lgkmcnt(10)
    v_mfma_f32_32x32x16_bf16 v[104:119], v[32:35], v[196:199], v[104:119]
    buffer_load_dwordx4 v[232:235], v249, s[32:35], s16 offen sc1
    ds_read_b64_tr_b16 v[28:29], v23 offset:24576
    ds_read_b64_tr_b16 v[30:31], v23 offset:26624
    s_barrier
    s_waitcnt vmcnt(8)
    s_waitcnt lgkmcnt(10)
    v_mfma_f32_32x32x16_bf16 v[56:71], v[36:39], v[200:203], v[56:71]
    ds_read_b64_tr_b16 v[32:33], v20 offset:25600
    ds_read_b64_tr_b16 v[34:35], v20 offset:27648
    s_waitcnt lgkmcnt(10)
    v_mfma_f32_32x32x16_bf16 v[72:87], v[40:43], v[200:203], v[72:87]
    ds_read_b64_tr_b16 v[36:37], v21 offset:25600
    ds_read_b64_tr_b16 v[38:39], v21 offset:27648
    s_waitcnt lgkmcnt(10)
    v_mfma_f32_32x32x16_bf16 v[120:135], v[44:47], v[200:203], v[120:135]
    ds_read_b64_tr_b16 v[40:41], v24 offset:25600
    ds_read_b64_tr_b16 v[42:43], v24 offset:27648
    s_waitcnt lgkmcnt(10)
    v_mfma_f32_32x32x16_bf16 v[136:151], v[48:51], v[200:203], v[136:151]
    ds_read_b64_tr_b16 v[44:45], v25 offset:25600
    ds_read_b64_tr_b16 v[46:47], v25 offset:27648
    s_waitcnt lgkmcnt(10)
    v_mfma_f32_32x32x16_bf16 v[88:103], v[52:55], v[200:203], v[88:103]
    buffer_load_dwordx4 v[236:239], v249, s[32:35], s16 offen offset:1024 sc1
    ds_read_b64_tr_b16 v[48:49], v22 offset:25600
    ds_read_b64_tr_b16 v[50:51], v22 offset:27648
    s_waitcnt lgkmcnt(10)
    v_mfma_f32_32x32x16_bf16 v[104:119], v[28:31], v[200:203], v[104:119]
    ds_read_b64_tr_b16 v[52:53], v23 offset:25600
    ds_read_b64_tr_b16 v[54:55], v23 offset:27648
    s_waitcnt vmcnt(8)
    s_waitcnt lgkmcnt(10)
    v_mfma_f32_32x32x16_bf16 v[56:71], v[32:35], v[204:207], v[56:71]
    ds_read_b64_tr_b16 v[28:29], v20 offset:28672
    ds_read_b64_tr_b16 v[30:31], v20 offset:30720
    s_waitcnt lgkmcnt(10)
    v_mfma_f32_32x32x16_bf16 v[72:87], v[36:39], v[204:207], v[72:87]
L_PAD2:
    s_cbranch_execz L_RET2
    ds_read_b64_tr_b16 v[32:33], v21 offset:28672
    ds_read_b64_tr_b16 v[34:35], v21 offset:30720
    s_waitcnt lgkmcnt(10)
    v_mfma_f32_32x32x16_bf16 v[120:135], v[40:43], v[204:207], v[120:135]
    ds_read_b64_tr_b16 v[36:37], v24 offset:28672
    ds_read_b64_tr_b16 v[38:39], v24 offset:30720
    s_waitcnt lgkmcnt(10)
    v_mfma_f32_32x32x16_bf16 v[136:151], v[44:47], v[204:207], v[136:151]
    buffer_load_dwordx4 v[240:243], v249, s[32:35], s16 offen offset:2048 sc1
    ds_read_b64_tr_b16 v[40:41], v25 offset:28672
    ds_read_b64_tr_b16 v[42:43], v25 offset:30720
    s_waitcnt lgkmcnt(10)
    v_mfma_f32_32x32x16_bf16 v[88:103], v[48:51], v[204:207], v[88:103]
    ds_read_b64_tr_b16 v[44:45], v22 offset:28672
    ds_read_b64_tr_b16 v[46:47], v22 offset:30720
    s_waitcnt lgkmcnt(10)
    v_mfma_f32_32x32x16_bf16 v[104:119], v[52:55], v[204:207], v[104:119]
    ds_read_b64_tr_b16 v[48:49], v23 offset:28672
    ds_read_b64_tr_b16 v[50:51], v23 offset:30720
    s_waitcnt vmcnt(8)
    s_waitcnt lgkmcnt(10)
    v_mfma_f32_32x32x16_bf16 v[56:71], v[28:31], v[208:211], v[56:71]
    ds_read_b64_tr_b16 v[52:53], v20 offset:29696
    ds_read_b64_tr_b16 v[54:55], v20 offset:31744
    s_waitcnt lgkmcnt(10)
    v_mfma_f32_32x32x16_bf16 v[72:87], v[32:35], v[208:211], v[72:87]
    ds_read_b64_tr_b16 v[28:29], v21 offset:29696
    ds_read_b64_tr_b16 v[30:31], v21 offset:31744
    s_waitcnt lgkmcnt(10)
    v_mfma_f32_32x32x16_bf16 v[120:135], v[36:39], v[208:211], v[120:135]
    buffer_load_dwordx4 v[244:247], v249, s[32:35], s16 offen offset:3072 sc1
    ds_read_b64_tr_b16 v[32:33], v24 offset:29696
    ds_read_b64_tr_b16 v[34:35], v24 offset:31744
    s_waitcnt lgkmcnt(10)
    v_mfma_f32_32x32x16_bf16 v[136:151], v[40:43], v[208:211], v[136:151]
    s_add_u32 s16, s16, 16384
    ds_read_b64_tr_b16 v[36:37], v25 offset:29696
    ds_read_b64_tr_b16 v[38:39], v25 offset:31744
    s_waitcnt lgkmcnt(10)
    v_mfma_f32_32x32x16_bf16 v[88:103], v[44:47], v[208:211], v[88:103]
    s_and_b32 s16, s16, 0x3ffff
    ds_read_b64_tr_b16 v[40:41], v22 offset:29696
    ds_read_b64_tr_b16 v[42:43], v22 offset:31744
    s_waitcnt lgkmcnt(10)
    v_mfma_f32_32x32x16_bf16 v[104:119], v[48:51], v[208:211], v[104:119]
    ds_read_b64_tr_b16 v[44:45], v23 offset:29696
    ds_read_b64_tr_b16 v[46:47], v23 offset:31744
    s_waitcnt vmcnt(8)
    s_waitcnt lgkmcnt(10)
    v_mfma_f32_32x32x16_bf16 v[56:71], v[52:55], v[212:215], v[56:71]
    ds_read_b64_tr_b16 v[48:49], v20 offset:32768
    ds_read_b64_tr_b16 v[50:51], v20 offset:34816
    s_waitcnt lgkmcnt(10)
    v_mfma_f32_32x32x16_bf16 v[72:87], v[28:31], v[212:215], v[72:87]
    buffer_load_dwordx4 v[152:155], v249, s[32:35], s16 offen sc1
    ds_read_b64_tr_b16 v[52:53], v21 offset:32768
    ds_read_b64_tr_b16 v[54:55], v21 offset:34816
    s_waitcnt lgkmcnt(10)
    v_mfma_f32_32x32x16_bf16 v[120:135], v[32:35], v[212:215], v[120:135]
    ds_read_b64_tr_b16 v[28:29], v24 offset:32768
    ds_read_b64_tr_b16 v[30:31], v24 offset:34816
    s_waitcnt lgkmcnt(10)
    v_mfma_f32_32x32x16_bf16 v[136:151], v[36:39], v[212:215], v[136:151]
    ds_read_b64_tr_b16 v[32:33], v25 offset:32768
    ds_read_b64_tr_b16 v[34:35], v25 offset:34816
    s_waitcnt lgkmcnt(10)
    v_mfma_f32_32x32x16_bf16 v[88:103], v[40:43], v[212:215], v[88:103]
    ds_read_b64_tr_b16 v[36:37], v22 offset:32768
    ds_read_b64_tr_b16 v[38:39], v22 offset:34816
    s_waitcnt lgkmcnt(10)
    v_mfma_f32_32x32x16_bf16 v[104:119], v[44:47], v[212:215], v[104:119]
    buffer_load_dwordx4 v[156:159], v249, s[32:35], s16 offen offset:1024 sc1
    ds_read_b64_tr_b16 v[40:41], v23 offset:32768
    ds_read_b64_tr_b16 v[42:43], v23 offset:34816
    s_barrier
    s_waitcnt vmcnt(9)
    s_waitcnt lgkmcnt(10)
    v_mfma_f32_32x32x16_bf16 v[56:71], v[48:51], v[216:219], v[56:71]
    ds_read_b64_tr_b16 v[44:45], v20 offset:33792
    ds_read_b64_tr_b16 v[46:47], v20 offset:35840
    s_waitcnt lgkmcnt(10)
    v_mfma_f32_32x32x16_bf16 v[72:87], v[52:55], v[216:219], v[72:87]
    ds_read_b64_tr_b16 v[48:49], v21 offset:33792
    ds_read_b64_tr_b16 v[50:51], v21 offset:35840
    s_waitcnt lgkmcnt(10)
    v_mfma_f32_32x32x16_bf16 v[120:135], v[28:31], v[216:219], v[120:135]
    ds_read_b64_tr_b16 v[52:53], v24 offset:33792
    ds_read_b64_tr_b16 v[54:55], v24 offset:35840
    s_waitcnt lgkmcnt(10)
    v_mfma_f32_32x32x16_bf16 v[136:151], v[32:35], v[216:219], v[136:151]
    ds_read_b64_tr_b16 v[28:29], v25 offset:33792
    ds_read_b64_tr_b16 v[30:31], v25 offset:35840
    s_waitcnt lgkmcnt(10)
    v_mfma_f32_32x32x16_bf16 v[88:103], v[36:39], v[216:219], v[88:103]
    buffer_load_dwordx4 v[160:163], v249, s[32:35], s16 offen offset:2048 sc1
    ds_read_b64_tr_b16 v[32:33], v22 offset:33792
    ds_read_b64_tr_b16 v[34:35], v22 offset:35840
    s_waitcnt lgkmcnt(10)
    v_mfma_f32_32x32x16_bf16 v[104:119], v[40:43], v[216:219], v[104:119]
    ds_read_b64_tr_b16 v[36:37], v23 offset:33792
    ds_read_b64_tr_b16 v[38:39], v23 offset:35840
    s_waitcnt vmcnt(9)
    s_waitcnt lgkmcnt(10)
    v_mfma_f32_32x32x16_bf16 v[56:71], v[44:47], v[220:223], v[56:71]
    ds_read_b64_tr_b16 v[40:41], v20 offset:36864
    ds_read_b64_tr_b16 v[42:43], v20 offset:38912
    s_waitcnt lgkmcnt(10)
    v_mfma_f32_32x32x16_bf16 v[72:87], v[48:51], v[220:223], v[72:87]
    ds_read_b64_tr_b16 v[44:45], v21 offset:36864
    ds_read_b64_tr_b16 v[46:47], v21 offset:38912
    s_waitcnt lgkmcnt(10)
    v_mfma_f32_32x32x16_bf16 v[120:135], v[52:55], v[220:223], v[120:135]
    ds_read_b64_tr_b16 v[48:49], v24 offset:36864
    ds_read_b64_tr_b16 v[50:51], v24 offset:38912
    s_waitcnt lgkmcnt(10)
    v_mfma_f32_32x32x16_bf16 v[136:151], v[28:31], v[220:223], v[136:151]
    buffer_load_dwordx4 v[164:167], v249, s[32:35], s16 offen offset:3072 sc1
    ds_read_b64_tr_b16 v[52:53], v25 offset:36864
    ds_read_b64_tr_b16 v[54:55], v25 offset:38912
    s_waitcnt lgkmcnt(10)
    v_mfma_f32_32x32x16_bf16 v[88:103], v[32:35], v[220:223], v[88:103]
    s_add_u32 s16, s16, 16384
    ds_read_b64_tr_b16 v[28:29], v22 offset:36864
    ds_read_b64_tr_b16 v[30:31], v22 offset:38912
    s_waitcnt lgkmcnt(10)
    v_mfma_f32_32x32x16_bf16 v[104:119], v[36:39], v[220:223], v[104:119]
    s_and_b32 s16, s16, 0x3ffff
    ds_read_b64_tr_b16 v[32:33], v23 offset:36864
    ds_read_b64_tr_b16 v[34:35], v23 offset:38912
    s_waitcnt vmcnt(9)
    s_waitcnt lgkmcnt(10)
    v_mfma_f32_32x32x16_bf16 v[56:71], v[40:43], v[224:227], v[56:71]
    ds_read_b64_tr_b16 v[36:37], v20 offset:37888
    ds_read_b64_tr_b16 v[38:39], v20 offset:39936
    s_waitcnt lgkmcnt(10)
    v_mfma_f32_32x32x16_bf16 v[72:87], v[44:47], v[224:227], v[72:87]
    ds_read_b64_tr_b16 v[40:41], v21 offset:37888
    ds_read_b64_tr_b16 v[42:43], v21 offset:39936
    s_waitcnt lgkmcnt(10)
    v_mfma_f32_32x32x16_bf16 v[120:135], v[48:51], v[224:227], v[120:135]
    buffer_load_dwordx4 v[168:171], v249, s[32:35], s16 offen sc1
    ds_read_b64_tr_b16 v[44:45], v24 offset:37888
    ds_read_b64_tr_b16 v[46:47], v24 offset:39936
    s_waitcnt lgkmcnt(10)
    v_mfma_f32_32x32x16_bf16 v[136:151], v[52:55], v[224:227], v[136:151]
    ds_read_b64_tr_b16 v[48:49], v25 offset:37888
    ds_read_b64_tr_b16 v[50:51], v25 offset:39936
    s_waitcnt lgkmcnt(10)
    v_mfma_f32_32x32x16_bf16 v[88:103], v[28:31], v[224:227], v[88:103]
    ds_read_b64_tr_b16 v[52:53], v22 offset:37888
    ds_read_b64_tr_b16 v[54:55], v22 offset:39936
    s_waitcnt lgkmcnt(10)
    v_mfma_f32_32x32x16_bf16 v[104:119], v[32:35], v[224:227], v[104:119]
    ds_read_b64_tr_b16 v[28:29], v23 offset:37888
    ds_read_b64_tr_b16 v[30:31], v23 offset:39936
    s_waitcnt vmcnt(9)
    s_waitcnt lgkmcnt(10)
    v_mfma_f32_32x32x16_bf16 v[56:71], v[36:39], v[228:231], v[56:71]
    ds_read_b64_tr_b16 v[32:33], v20 offset:40960
    ds_read_b64_tr_b16 v[34:35], v20 offset:43008
    s_waitcnt lgkmcnt(10)
    v_mfma_f32_32x32x16_bf16 v[72:87], v[40:43], v[228:231], v[72:87]
    buffer_load_dwordx4 v[172:175], v249, s[32:35], s16 offen offset:1024 sc1
    ds_read_b64_tr_b16 v[36:37], v21 offset:40960
    ds_read_b64_tr_b16 v[38:39], v21 offset:43008
    s_waitcnt lgkmcnt(10)
    v_mfma_f32_32x32x16_bf16 v[120:135], v[44:47], v[228:231], v[120:135]
    ds_read_b64_tr_b16 v[40:41], v24 offset:40960
    ds_read_b64_tr_b16 v[42:43], v24 offset:43008
    s_waitcnt lgkmcnt(10)
    v_mfma_f32_32x32x16_bf16 v[136:151], v[48:51], v[228:231], v[136:151]
    ds_read_b64_tr_b16 v[44:45], v25 offset:40960
    ds_read_b64_tr_b16 v[46:47], v25 offset:43008
    s_waitcnt lgkmcnt(10)
    v_mfma_f32_32x32x16_bf16 v[88:103], v[52:55], v[228:231], v[88:103]
    ds_read_b64_tr_b16 v[48:49], v22 offset:40960
    ds_read_b64_tr_b16 v[50:51], v22 offset:43008
    s_waitcnt lgkmcnt(10)
    v_mfma_f32_32x32x16_bf16 v[104:119], v[28:31], v[228:231], v[104:119]
    buffer_load_dwordx4 v[176:179], v249, s[32:35], s16 offen offset:2048 sc1
    ds_read_b64_tr_b16 v[52:53], v23 offset:40960
    ds_read_b64_tr_b16 v[54:55], v23 offset:43008
    s_barrier
    s_waitcnt vmcnt(10)
    s_waitcnt lgkmcnt(10)
    v_mfma_f32_32x32x16_bf16 v[56:71], v[32:35], v[232:235], v[56:71]
    ds_read_b64_tr_b16 v[28:29], v20 offset:41984
    ds_read_b64_tr_b16 v[30:31], v20 offset:44032
    s_waitcnt lgkmcnt(10)
    v_mfma_f32_32x32x16_bf16 v[72:87], v[36:39], v[232:235], v[72:87]
    ds_read_b64_tr_b16 v[32:33], v21 offset:41984
    ds_read_b64_tr_b16 v[34:35], v21 offset:44032
    s_waitcnt lgkmcnt(10)
    v_mfma_f32_32x32x16_bf16 v[120:135], v[40:43], v[232:235], v[120:135]
    ds_read_b64_tr_b16 v[36:37], v24 offset:41984
    ds_read_b64_tr_b16 v[38:39], v24 offset:44032
    s_waitcnt lgkmcnt(10)
    v_mfma_f32_32x32x16_bf16 v[136:151], v[44:47], v[232:235], v[136:151]
    buffer_load_dwordx4 v[180:183], v249, s[32:35], s16 offen offset:3072 sc1
    ds_read_b64_tr_b16 v[40:41], v25 offset:41984
    ds_read_b64_tr_b16 v[42:43], v25 offset:44032
    s_waitcnt lgkmcnt(10)
    v_mfma_f32_32x32x16_bf16 v[88:103], v[48:51], v[232:235], v[88:103]
    s_add_u32 s16, s16, 16384
    ds_read_b64_tr_b16 v[44:45], v22 offset:41984
    ds_read_b64_tr_b16 v[46:47], v22 offset:44032
    s_waitcnt lgkmcnt(10)
    v_mfma_f32_32x32x16_bf16 v[104:119], v[52:55], v[232:235], v[104:119]
    s_and_b32 s16, s16, 0x3ffff
    ds_read_b64_tr_b16 v[48:49], v23 offset:41984
    ds_read_b64_tr_b16 v[50:51], v23 offset:44032
    s_waitcnt vmcnt(10)
    s_waitcnt lgkmcnt(10)
    v_mfma_f32_32x32x16_bf16 v[56:71], v[28:31], v[236:239], v[56:71]
    buffer_load_dwordx4 v[184:187], v249, s[32:35], s16 offen sc1
    ds_read_b64_tr_b16 v[52:53], v20 offset:45056
    ds_read_b64_tr_b16 v[54:55], v20 offset:47104
    s_waitcnt lgkmcnt(10)
    v_mfma_f32_32x32x16_bf16 v[72:87], v[32:35], v[236:239], v[72:87]
    ds_read_b64_tr_b16 v[28:29], v21 offset:45056
    ds_read_b64_tr_b16 v[30:31], v21 offset:47104
    s_waitcnt lgkmcnt(10)
    v_mfma_f32_32x32x16_bf16 v[120:135], v[36:39], v[236:239], v[120:135]
    ds_read_b64_tr_b16 v[32:33], v24 offset:45056
    ds_read_b64_tr_b16 v[34:35], v24 offset:47104
    s_waitcnt lgkmcnt(10)
    v_mfma_f32_32x32x16_bf16 v[136:151], v[40:43], v[236:239], v[136:151]
    ds_read_b64_tr_b16 v[36:37], v25 offset:45056
    ds_read_b64_tr_b16 v[38:39], v25 offset:47104
    s_waitcnt lgkmcnt(10)
    v_mfma_f32_32x32x16_bf16 v[88:103], v[44:47], v[236:239], v[88:103]
    buffer_load_dwordx4 v[188:191], v249, s[32:35], s16 offen offset:1024 sc1
    ds_read_b64_tr_b16 v[40:41], v22 offset:45056
    ds_read_b64_tr_b16 v[42:43], v22 offset:47104
    s_waitcnt lgkmcnt(10)
    v_mfma_f32_32x32x16_bf16 v[104:119], v[48:51], v[236:239], v[104:119]
    ds_read_b64_tr_b16 v[44:45], v23 offset:45056
    ds_read_b64_tr_b16 v[46:47], v23 offset:47104
    s_waitcnt vmcnt(11)
    s_waitcnt lgkmcnt(10)
    v_mfma_f32_32x32x16_bf16 v[56:71], v[52:55], v[240:243], v[56:71]
    ds_read_b64_tr_b16 v[48:49], v20 offset:46080
    ds_read_b64_tr_b16 v[50:51], v20 offset:48128
    s_waitcnt lgkmcnt(10)
    v_mfma_f32_32x32x16_bf16 v[72:87], v[28:31], v[240:243], v[72:87]
    buffer_load_dwordx4 v[192:195], v249, s[32:35], s16 offen offset:2048 sc1
    ds_read_b64_tr_b16 v[52:53], v21 offset:46080
    ds_read_b64_tr_b16 v[54:55], v21 offset:48128
    s_waitcnt lgkmcnt(10)
    v_mfma_f32_32x32x16_bf16 v[120:135], v[32:35], v[240:243], v[120:135]
    ds_read_b64_tr_b16 v[28:29], v24 offset:46080
    ds_read_b64_tr_b16 v[30:31], v24 offset:48128
    s_waitcnt lgkmcnt(10)
    v_mfma_f32_32x32x16_bf16 v[136:151], v[36:39], v[240:243], v[136:151]
    ds_read_b64_tr_b16 v[32:33], v25 offset:46080
    ds_read_b64_tr_b16 v[34:35], v25 offset:48128
    s_waitcnt lgkmcnt(10)
    v_mfma_f32_32x32x16_bf16 v[88:103], v[40:43], v[240:243], v[88:103]
    ds_read_b64_tr_b16 v[36:37], v22 offset:46080
    ds_read_b64_tr_b16 v[38:39], v22 offset:48128
    s_waitcnt lgkmcnt(10)
    v_mfma_f32_32x32x16_bf16 v[104:119], v[44:47], v[240:243], v[104:119]
    buffer_load_dwordx4 v[196:199], v249, s[32:35], s16 offen offset:3072 sc1
    ds_read_b64_tr_b16 v[40:41], v23 offset:46080
    ds_read_b64_tr_b16 v[42:43], v23 offset:48128
    s_waitcnt vmcnt(12)
    s_waitcnt lgkmcnt(10)
    v_mfma_f32_32x32x16_bf16 v[56:71], v[48:51], v[244:247], v[56:71]
    s_add_u32 s16, s16, 16384
    ds_read_b64_tr_b16 v[44:45], v20
    ds_read_b64_tr_b16 v[46:47], v20 offset:2048
    s_waitcnt lgkmcnt(10)
    v_mfma_f32_32x32x16_bf16 v[72:87], v[52:55], v[244:247], v[72:87]
    s_and_b32 s16, s16, 0x3ffff
    ds_read_b64_tr_b16 v[48:49], v21
    ds_read_b64_tr_b16 v[50:51], v21 offset:2048
    s_waitcnt lgkmcnt(10)
    v_mfma_f32_32x32x16_bf16 v[120:135], v[28:31], v[244:247], v[120:135]
    buffer_load_dwordx4 v[200:203], v249, s[32:35], s16 offen sc1
    ds_read_b64_tr_b16 v[52:53], v24
    ds_read_b64_tr_b16 v[54:55], v24 offset:2048
    s_waitcnt lgkmcnt(10)
    v_mfma_f32_32x32x16_bf16 v[136:151], v[32:35], v[244:247], v[136:151]
    ds_read_b64_tr_b16 v[28:29], v25
    ds_read_b64_tr_b16 v[30:31], v25 offset:2048
    s_waitcnt lgkmcnt(10)
    v_mfma_f32_32x32x16_bf16 v[88:103], v[36:39], v[244:247], v[88:103]
    ds_read_b64_tr_b16 v[32:33], v22
    ds_read_b64_tr_b16 v[34:35], v22 offset:2048
    s_waitcnt lgkmcnt(10)
    v_mfma_f32_32x32x16_bf16 v[104:119], v[40:43], v[244:247], v[104:119]
    buffer_load_dwordx4 v[204:207], v249, s[32:35], s16 offen offset:1024 sc1
    ds_read_b64_tr_b16 v[36:37], v23
    ds_read_b64_tr_b16 v[38:39], v23 offset:2048
    s_barrier
    s_waitcnt vmcnt(13)
    s_waitcnt lgkmcnt(10)
    v_mfma_f32_32x32x16_bf16 v[56:71], v[44:47], v[152:155], v[56:71]
    ds_read_b64_tr_b16 v[40:41], v20 offset:1024
    ds_read_b64_tr_b16 v[42:43], v20 offset:3072
    s_waitcnt lgkmcnt(10)
    v_mfma_f32_32x32x16_bf16 v[72:87], v[48:51], v[152:155], v[72:87]
    ds_read_b64_tr_b16 v[44:45], v21 offset:1024
    ds_read_b64_tr_b16 v[46:47], v21 offset:3072
    s_waitcnt lgkmcnt(10)
    v_mfma_f32_32x32x16_bf16 v[120:135], v[52:55], v[152:155], v[120:135]
    ds_read_b64_tr_b16 v[48:49], v24 offset:1024
    ds_read_b64_tr_b16 v[50:51], v24 offset:3072
    s_waitcnt lgkmcnt(10)
    v_mfma_f32_32x32x16_bf16 v[136:151], v[28:31], v[152:155], v[136:151]
    buffer_load_dwordx4 v[208:211], v249, s[32:35], s16 offen offset:2048 sc1
    ds_read_b64_tr_b16 v[52:53], v25 offset:1024
    ds_read_b64_tr_b16 v[54:55], v25 offset:3072
    s_waitcnt lgkmcnt(10)
    v_mfma_f32_32x32x16_bf16 v[88:103], v[32:35], v[152:155], v[88:103]
    ds_read_b64_tr_b16 v[28:29], v22 offset:1024
    ds_read_b64_tr_b16 v[30:31], v22 offset:3072
    s_waitcnt lgkmcnt(10)
    v_mfma_f32_32x32x16_bf16 v[104:119], v[36:39], v[152:155], v[104:119]
    ds_read_b64_tr_b16 v[32:33], v23 offset:1024
    ds_read_b64_tr_b16 v[34:35], v23 offset:3072
    s_waitcnt vmcnt(13)
    s_waitcnt lgkmcnt(10)
    v_mfma_f32_32x32x16_bf16 v[56:71], v[40:43], v[156:159], v[56:71]
    buffer_load_dwordx4 v[212:215], v249, s[32:35], s16 offen offset:3072 sc1
    ds_read_b64_tr_b16 v[36:37], v20 offset:4096
    ds_read_b64_tr_b16 v[38:39], v20 offset:6144
    s_waitcnt lgkmcnt(10)
    v_mfma_f32_32x32x16_bf16 v[72:87], v[44:47], v[156:159], v[72:87]
    s_add_u32 s16, s16, 16384
    ds_read_b64_tr_b16 v[40:41], v21 offset:4096
    ds_read_b64_tr_b16 v[42:43], v21 offset:6144
    s_waitcnt lgkmcnt(10)
    v_mfma_f32_32x32x16_bf16 v[120:135], v[48:51], v[156:159], v[120:135]
    s_and_b32 s16, s16, 0x3ffff
    ds_read_b64_tr_b16 v[44:45], v24 offset:4096
    ds_read_b64_tr_b16 v[46:47], v24 offset:6144
    s_waitcnt lgkmcnt(10)
    v_mfma_f32_32x32x16_bf16 v[136:151], v[52:55], v[156:159], v[136:151]
    ds_read_b64_tr_b16 v[48:49], v25 offset:4096
    ds_read_b64_tr_b16 v[50:51], v25 offset:6144
    s_waitcnt lgkmcnt(10)
    v_mfma_f32_32x32x16_bf16 v[88:103], v[28:31], v[156:159], v[88:103]
    buffer_load_dwordx4 v[216:219], v249, s[32:35], s16 offen sc1
    ds_read_b64_tr_b16 v[52:53], v22 offset:4096
    ds_read_b64_tr_b16 v[54:55], v22 offset:6144
    s_waitcnt lgkmcnt(10)
    v_mfma_f32_32x32x16_bf16 v[104:119], v[32:35], v[156:159], v[104:119]
    ds_read_b64_tr_b16 v[28:29], v23 offset:4096
    ds_read_b64_tr_b16 v[30:31], v23 offset:6144
    s_waitcnt vmcnt(14)
    s_waitcnt lgkmcnt(10)
    v_mfma_f32_32x32x16_bf16 v[56:71], v[36:39], v[160:163], v[56:71]
    ds_read_b64_tr_b16 v[32:33], v20 offset:5120
    ds_read_b64_tr_b16 v[34:35], v20 offset:7168
    s_waitcnt lgkmcnt(10)
    v_mfma_f32_32x32x16_bf16 v[72:87], v[40:43], v[160:163], v[72:87]
    buffer_load_dwordx4 v[220:223], v249, s[32:35], s16 offen offset:1024 sc1
    ds_read_b64_tr_b16 v[36:37], v21 offset:5120
    ds_read_b64_tr_b16 v[38:39], v21 offset:7168
    s_waitcnt lgkmcnt(10)
    v_mfma_f32_32x32x16_bf16 v[120:135], v[44:47], v[160:163], v[120:135]
    ds_read_b64_tr_b16 v[40:41], v24 offset:5120
    ds_read_b64_tr_b16 v[42:43], v24 offset:7168
    s_waitcnt lgkmcnt(10)
    v_mfma_f32_32x32x16_bf16 v[136:151], v[48:51], v[160:163], v[136:151]
    ds_read_b64_tr_b16 v[44:45], v25 offset:5120
    ds_read_b64_tr_b16 v[46:47], v25 offset:7168
    s_waitcnt lgkmcnt(10)
    v_mfma_f32_32x32x16_bf16 v[88:103], v[52:55], v[160:163], v[88:103]
    ds_read_b64_tr_b16 v[48:49], v22 offset:5120
    ds_read_b64_tr_b16 v[50:51], v22 offset:7168
    s_waitcnt lgkmcnt(10)
    v_mfma_f32_32x32x16_bf16 v[104:119], v[28:31], v[160:163], v[104:119]
    buffer_load_dwordx4 v[224:227], v249, s[32:35], s16 offen offset:2048 sc1
    ds_read_b64_tr_b16 v[52:53], v23 offset:5120
    ds_read_b64_tr_b16 v[54:55], v23 offset:7168
    s_waitcnt vmcnt(15)
    s_waitcnt lgkmcnt(10)
    v_mfma_f32_32x32x16_bf16 v[56:71], v[32:35], v[164:167], v[56:71]
    ds_read_b64_tr_b16 v[28:29], v20 offset:8192
    ds_read_b64_tr_b16 v[30:31], v20 offset:10240
    s_waitcnt lgkmcnt(10)
    v_mfma_f32_32x32x16_bf16 v[72:87], v[36:39], v[164:167], v[72:87]
    ds_read_b64_tr_b16 v[32:33], v21 offset:8192
    ds_read_b64_tr_b16 v[34:35], v21 offset:10240
    s_waitcnt lgkmcnt(10)
    v_mfma_f32_32x32x16_bf16 v[120:135], v[40:43], v[164:167], v[120:135]
    buffer_load_dwordx4 v[228:231], v249, s[32:35], s16 offen offset:3072 sc1
    ds_read_b64_tr_b16 v[36:37], v24 offset:8192
    ds_read_b64_tr_b16 v[38:39], v24 offset:10240
    s_waitcnt lgkmcnt(10)
    v_mfma_f32_32x32x16_bf16 v[136:151], v[44:47], v[164:167], v[136:151]
    s_add_u32 s16, s16, 16384
    ds_read_b64_tr_b16 v[40:41], v25 offset:8192
    ds_read_b64_tr_b16 v[42:43], v25 offset:10240
    s_waitcnt lgkmcnt(10)
    v_mfma_f32_32x32x16_bf16 v[88:103], v[48:51], v[164:167], v[88:103]
    s_and_b32 s16, s16, 0x3ffff
    ds_read_b64_tr_b16 v[44:45], v22 offset:8192
    ds_read_b64_tr_b16 v[46:47], v22 offset:10240
    s_waitcnt lgkmcnt(10)
    v_mfma_f32_32x32x16_bf16 v[104:119], v[52:55], v[164:167], v[104:119]
    buffer_load_dwordx4 v[232:235], v249, s[32:35], s16 offen sc1
    ds_read_b64_tr_b16 v[48:49], v23 offset:8192
    ds_read_b64_tr_b16 v[50:51], v23 offset:10240
    s_barrier
    s_waitcnt vmcnt(16)
    s_waitcnt lgkmcnt(10)
    v_mfma_f32_32x32x16_bf16 v[56:71], v[28:31], v[168:171], v[56:71]
    ds_read_b64_tr_b16 v[52:53], v20 offset:9216
    ds_read_b64_tr_b16 v[54:55], v20 offset:11264
    s_waitcnt lgkmcnt(10)
    v_mfma_f32_32x32x16_bf16 v[72:87], v[32:35], v[168:171], v[72:87]
    ds_read_b64_tr_b16 v[28:29], v21 offset:9216
    ds_read_b64_tr_b16 v[30:31], v21 offset:11264
    s_waitcnt lgkmcnt(10)
    v_mfma_f32_32x32x16_bf16 v[120:135], v[36:39], v[168:171], v[120:135]
    ds_read_b64_tr_b16 v[32:33], v24 offset:9216
    ds_read_b64_tr_b16 v[34:35], v24 offset:11264
    s_waitcnt lgkmcnt(10)
    v_mfma_f32_32x32x16_bf16 v[136:151], v[40:43], v[168:171], v[136:151]
    buffer_load_dwordx4 v[236:239], v249, s[32:35], s16 offen offset:1024 sc1
    ds_read_b64_tr_b16 v[36:37], v25 offset:9216
    ds_read_b64_tr_b16 v[38:39], v25 offset:11264
    s_waitcnt lgkmcnt(10)
    v_mfma_f32_32x32x16_bf16 v[88:103], v[44:47], v[168:171], v[88:103]
    ds_read_b64_tr_b16 v[40:41], v22 offset:9216
    ds_read_b64_tr_b16 v[42:43], v22 offset:11264
    s_waitcnt lgkmcnt(10)
    v_mfma_f32_32x32x16_bf16 v[104:119], v[48:51], v[168:171], v[104:119]
    ds_read_b64_tr_b16 v[44:45], v23 offset:9216
    ds_read_b64_tr_b16 v[46:47], v23 offset:11264
    s_waitcnt vmcnt(16)
    s_waitcnt lgkmcnt(10)
    v_mfma_f32_32x32x16_bf16 v[56:71], v[52:55], v[172:175], v[56:71]
    buffer_load_dwordx4 v[240:243], v249, s[32:35], s16 offen offset:2048 sc1
    ds_read_b64_tr_b16 v[48:49], v20 offset:12288
    ds_read_b64_tr_b16 v[50:51], v20 offset:14336
    s_waitcnt lgkmcnt(10)
    v_mfma_f32_32x32x16_bf16 v[72:87], v[28:31], v[172:175], v[72:87]
    ds_read_b64_tr_b16 v[52:53], v21 offset:12288
    ds_read_b64_tr_b16 v[54:55], v21 offset:14336
    s_waitcnt lgkmcnt(10)
    v_mfma_f32_32x32x16_bf16 v[120:135], v[32:35], v[172:175], v[120:135]
    ds_read_b64_tr_b16 v[28:29], v24 offset:12288
    ds_read_b64_tr_b16 v[30:31], v24 offset:14336
    s_waitcnt lgkmcnt(10)
    v_mfma_f32_32x32x16_bf16 v[136:151], v[36:39], v[172:175], v[136:151]
    ds_read_b64_tr_b16 v[32:33], v25 offset:12288
    ds_read_b64_tr_b16 v[34:35], v25 offset:14336
    s_waitcnt lgkmcnt(10)
    v_mfma_f32_32x32x16_bf16 v[88:103], v[40:43], v[172:175], v[88:103]
    buffer_load_dwordx4 v[244:247], v249, s[32:35], s16 offen offset:3072 sc1
    ds_read_b64_tr_b16 v[36:37], v22 offset:12288
    ds_read_b64_tr_b16 v[38:39], v22 offset:14336
    s_waitcnt lgkmcnt(10)
    v_mfma_f32_32x32x16_bf16 v[104:119], v[44:47], v[172:175], v[104:119]
    s_add_u32 s16, s16, 16384
    ds_read_b64_tr_b16 v[40:41], v23 offset:12288
    ds_read_b64_tr_b16 v[42:43], v23 offset:14336
    s_waitcnt vmcnt(17)
    s_waitcnt lgkmcnt(10)
    v_mfma_f32_32x32x16_bf16 v[56:71], v[48:51], v[176:179], v[56:71]
    s_and_b32 s16, s16, 0x3ffff
    ds_read_b64_tr_b16 v[44:45], v20 offset:13312
    ds_read_b64_tr_b16 v[46:47], v20 offset:15360
    s_waitcnt lgkmcnt(10)
    v_mfma_f32_32x32x16_bf16 v[72:87], v[52:55], v[176:179], v[72:87]
    buffer_load_dwordx4 v[152:155], v249, s[32:35], s16 offen sc1
    ds_read_b64_tr_b16 v[48:49], v21 offset:13312
    ds_read_b64_tr_b16 v[50:51], v21 offset:15360
    s_waitcnt lgkmcnt(10)
    v_mfma_f32_32x32x16_bf16 v[120:135], v[28:31], v[176:179], v[120:135]
    ds_read_b64_tr_b16 v[52:53], v24 offset:13312
    ds_read_b64_tr_b16 v[54:55], v24 offset:15360
    s_waitcnt lgkmcnt(10)
    v_mfma_f32_32x32x16_bf16 v[136:151], v[32:35], v[176:179], v[136:151]
    ds_read_b64_tr_b16 v[28:29], v25 offset:13312
    ds_read_b64_tr_b16 v[30:31], v25 offset:15360
    s_waitcnt lgkmcnt(10)
    v_mfma_f32_32x32x16_bf16 v[88:103], v[36:39], v[176:179], v[88:103]
    ds_read_b64_tr_b16 v[32:33], v22 offset:13312
    ds_read_b64_tr_b16 v[34:35], v22 offset:15360
    s_waitcnt lgkmcnt(10)
    v_mfma_f32_32x32x16_bf16 v[104:119], v[40:43], v[176:179], v[104:119]
    buffer_load_dwordx4 v[156:159], v249, s[32:35], s16 offen offset:1024 sc1
    ds_read_b64_tr_b16 v[36:37], v23 offset:13312
    ds_read_b64_tr_b16 v[38:39], v23 offset:15360
    s_waitcnt vmcnt(18)
    s_waitcnt lgkmcnt(10)
    v_mfma_f32_32x32x16_bf16 v[56:71], v[44:47], v[180:183], v[56:71]
    ds_read_b64_tr_b16 v[40:41], v20 offset:16384
    ds_read_b64_tr_b16 v[42:43], v20 offset:18432
    s_waitcnt lgkmcnt(10)
    v_mfma_f32_32x32x16_bf16 v[72:87], v[48:51], v[180:183], v[72:87]
    ds_read_b64_tr_b16 v[44:45], v21 offset:16384
    ds_read_b64_tr_b16 v[46:47], v21 offset:18432
    s_waitcnt lgkmcnt(10)
    v_mfma_f32_32x32x16_bf16 v[120:135], v[52:55], v[180:183], v[120:135]
    buffer_load_dwordx4 v[160:163], v249, s[32:35], s16 offen offset:2048 sc1
    ds_read_b64_tr_b16 v[48:49], v24 offset:16384
    ds_read_b64_tr_b16 v[50:51], v24 offset:18432
    s_waitcnt lgkmcnt(10)
    v_mfma_f32_32x32x16_bf16 v[136:151], v[28:31], v[180:183], v[136:151]
    ds_read_b64_tr_b16 v[52:53], v25 offset:16384
    ds_read_b64_tr_b16 v[54:55], v25 offset:18432
    s_waitcnt lgkmcnt(10)
    v_mfma_f32_32x32x16_bf16 v[88:103], v[32:35], v[180:183], v[88:103]
    ds_read_b64_tr_b16 v[28:29], v22 offset:16384
    ds_read_b64_tr_b16 v[30:31], v22 offset:18432
    s_waitcnt lgkmcnt(10)
    v_mfma_f32_32x32x16_bf16 v[104:119], v[36:39], v[180:183], v[104:119]
    buffer_load_dwordx4 v[164:167], v249, s[32:35], s16 offen offset:3072 sc1
    ds_read_b64_tr_b16 v[32:33], v23 offset:16384
    ds_read_b64_tr_b16 v[34:35], v23 offset:18432
    s_barrier
    s_waitcnt vmcnt(19)
    s_waitcnt lgkmcnt(10)
    v_mfma_f32_32x32x16_bf16 v[56:71], v[40:43], v[184:187], v[56:71]
    s_add_u32 s16, s16, 16384
    ds_read_b64_tr_b16 v[36:37], v20 offset:17408
    ds_read_b64_tr_b16 v[38:39], v20 offset:19456
    s_waitcnt lgkmcnt(10)
    v_mfma_f32_32x32x16_bf16 v[72:87], v[44:47], v[184:187], v[72:87]
    s_and_b32 s16, s16, 0x3ffff
    ds_read_b64_tr_b16 v[40:41], v21 offset:17408
    ds_read_b64_tr_b16 v[42:43], v21 offset:19456
    s_waitcnt lgkmcnt(10)
    v_mfma_f32_32x32x16_bf16 v[120:135], v[48:51], v[184:187], v[120:135]
    ds_read_b64_tr_b16 v[44:45], v24 offset:17408
    ds_read_b64_tr_b16 v[46:47], v24 offset:19456
    s_waitcnt lgkmcnt(10)
    v_mfma_f32_32x32x16_bf16 v[136:151], v[52:55], v[184:187], v[136:151]
    buffer_load_dwordx4 v[168:171], v249, s[32:35], s16 offen sc1
    ds_read_b64_tr_b16 v[48:49], v25 offset:17408
    ds_read_b64_tr_b16 v[50:51], v25 offset:19456
    s_waitcnt lgkmcnt(10)
    v_mfma_f32_32x32x16_bf16 v[88:103], v[28:31], v[184:187], v[88:103]
    ds_read_b64_tr_b16 v[52:53], v22 offset:17408
    ds_read_b64_tr_b16 v[54:55], v22 offset:19456
    s_waitcnt lgkmcnt(10)
    v_mfma_f32_32x32x16_bf16 v[104:119], v[32:35], v[184:187], v[104:119]
    ds_read_b64_tr_b16 v[28:29], v23 offset:17408
    ds_read_b64_tr_b16 v[30:31], v23 offset:19456
    s_waitcnt vmcnt(19)
    s_waitcnt lgkmcnt(10)
    v_mfma_f32_32x32x16_bf16 v[56:71], v[36:39], v[188:191], v[56:71]
    ds_read_b64_tr_b16 v[32:33], v20 offset:20480
    ds_read_b64_tr_b16 v[34:35], v20 offset:22528
    s_waitcnt lgkmcnt(10)
    v_mfma_f32_32x32x16_bf16 v[72:87], v[40:43], v[188:191], v[72:87]
    buffer_load_dwordx4 v[172:175], v249, s[32:35], s16 offen offset:1024 sc1
    ds_read_b64_tr_b16 v[36:37], v21 offset:20480
    ds_read_b64_tr_b16 v[38:39], v21 offset:22528
    s_waitcnt lgkmcnt(10)
    v_mfma_f32_32x32x16_bf16 v[120:135], v[44:47], v[188:191], v[120:135]
    ds_read_b64_tr_b16 v[40:41], v24 offset:20480
    ds_read_b64_tr_b16 v[42:43], v24 offset:22528
    s_waitcnt lgkmcnt(10)
    v_mfma_f32_32x32x16_bf16 v[136:151], v[48:51], v[188:191], v[136:151]
    ds_read_b64_tr_b16 v[44:45], v25 offset:20480
    ds_read_b64_tr_b16 v[46:47], v25 offset:22528
    s_waitcnt lgkmcnt(10)
    v_mfma_f32_32x32x16_bf16 v[88:103], v[52:55], v[188:191], v[88:103]
    ds_read_b64_tr_b16 v[48:49], v22 offset:20480
    ds_read_b64_tr_b16 v[50:51], v22 offset:22528
    s_waitcnt lgkmcnt(10)
    v_mfma_f32_32x32x16_bf16 v[104:119], v[28:31], v[188:191], v[104:119]
    buffer_load_dwordx4 v[176:179], v249, s[32:35], s16 offen offset:2048 sc1
    ds_read_b64_tr_b16 v[52:53], v23 offset:20480
    ds_read_b64_tr_b16 v[54:55], v23 offset:22528
    s_waitcnt vmcnt(20)
    s_waitcnt lgkmcnt(10)
    v_mfma_f32_32x32x16_bf16 v[56:71], v[32:35], v[192:195], v[56:71]
    ds_read_b64_tr_b16 v[28:29], v20 offset:21504
    ds_read_b64_tr_b16 v[30:31], v20 offset:23552
    s_waitcnt lgkmcnt(10)
    v_mfma_f32_32x32x16_bf16 v[72:87], v[36:39], v[192:195], v[72:87]
    ds_read_b64_tr_b16 v[32:33], v21 offset:21504
    ds_read_b64_tr_b16 v[34:35], v21 offset:23552
    s_waitcnt lgkmcnt(10)
    v_mfma_f32_32x32x16_bf16 v[120:135], v[40:43], v[192:195], v[120:135]
    ds_read_b64_tr_b16 v[36:37], v24 offset:21504
    ds_read_b64_tr_b16 v[38:39], v24 offset:23552
    s_waitcnt lgkmcnt(10)
    v_mfma_f32_32x32x16_bf16 v[136:151], v[44:47], v[192:195], v[136:151]
    buffer_load_dwordx4 v[180:183], v249, s[32:35], s16 offen offset:3072 sc1
    ds_read_b64_tr_b16 v[40:41], v25 offset:21504
L_PAD3:
    s_cbranch_execz L_RET3
    ds_read_b64_tr_b16 v[42:43], v25 offset:23552
    s_waitcnt lgkmcnt(10)
    v_mfma_f32_32x32x16_bf16 v[88:103], v[48:51], v[192:195], v[88:103]
    s_add_u32 s16, s16, 16384
    ds_read_b64_tr_b16 v[44:45], v22 offset:21504
    ds_read_b64_tr_b16 v[46:47], v22 offset:23552
    s_waitcnt lgkmcnt(10)
    v_mfma_f32_32x32x16_bf16 v[104:119], v[52:55], v[192:195], v[104:119]
    s_and_b32 s16, s16, 0x3ffff
    ds_read_b64_tr_b16 v[48:49], v23 offset:21504
    ds_read_b64_tr_b16 v[50:51], v23 offset:23552
    s_waitcnt vmcnt(20)
    s_waitcnt lgkmcnt(10)
    v_mfma_f32_32x32x16_bf16 v[56:71], v[28:31], v[196:199], v[56:71]
    ds_read_b64_tr_b16 v[52:53], v20 offset:24576
    ds_read_b64_tr_b16 v[54:55], v20 offset:26624
    s_waitcnt lgkmcnt(10)
    v_mfma_f32_32x32x16_bf16 v[72:87], v[32:35], v[196:199], v[72:87]
    buffer_load_dwordx4 v[184:187], v249, s[32:35], s16 offen sc1
    ds_read_b64_tr_b16 v[28:29], v21 offset:24576
    ds_read_b64_tr_b16 v[30:31], v21 offset:26624
    s_waitcnt lgkmcnt(10)
    v_mfma_f32_32x32x16_bf16 v[120:135], v[36:39], v[196:199], v[120:135]
    ds_read_b64_tr_b16 v[32:33], v20 offset:25600
    ds_read_b64_tr_b16 v[34:35], v20 offset:27648
    s_waitcnt lgkmcnt(10)
    v_mfma_f32_32x32x16_bf16 v[136:151], v[40:43], v[196:199], v[136:151]
    ds_read_b64_tr_b16 v[36:37], v21 offset:25600
    ds_read_b64_tr_b16 v[38:39], v21 offset:27648
    s_waitcnt lgkmcnt(10)
    v_mfma_f32_32x32x16_bf16 v[88:103], v[44:47], v[196:199], v[88:103]
    ds_read_b64_tr_b16 v[40:41], v20 offset:28672
    ds_read_b64_tr_b16 v[42:43], v20 offset:30720
    s_waitcnt lgkmcnt(10)
    v_mfma_f32_32x32x16_bf16 v[104:119], v[48:51], v[196:199], v[104:119]
    buffer_load_dwordx4 v[188:191], v249, s[32:35], s16 offen offset:1024 sc1
    ds_read_b64_tr_b16 v[44:45], v21 offset:28672
    ds_read_b64_tr_b16 v[46:47], v21 offset:30720
    s_barrier
    s_waitcnt vmcnt(21)
    s_waitcnt lgkmcnt(10)
    v_mfma_f32_32x32x16_bf16 v[56:71], v[52:55], v[200:203], v[56:71]
    ds_read_b64_tr_b16 v[48:49], v20 offset:29696
    ds_read_b64_tr_b16 v[50:51], v20 offset:31744
    s_waitcnt lgkmcnt(10)
    v_mfma_f32_32x32x16_bf16 v[72:87], v[28:31], v[200:203], v[72:87]
    ds_read_b64_tr_b16 v[52:53], v21 offset:29696
    ds_read_b64_tr_b16 v[54:55], v21 offset:31744
    s_waitcnt vmcnt(20)
    s_waitcnt lgkmcnt(10)
    v_mfma_f32_32x32x16_bf16 v[56:71], v[32:35], v[204:207], v[56:71]
    ds_read_b64_tr_b16 v[28:29], v24 offset:24576
    ds_read_b64_tr_b16 v[30:31], v24 offset:26624
    s_waitcnt lgkmcnt(10)
    v_mfma_f32_32x32x16_bf16 v[72:87], v[36:39], v[204:207], v[72:87]
    buffer_load_dwordx4 v[192:195], v249, s[32:35], s16 offen offset:2048 sc1
    ds_read_b64_tr_b16 v[32:33], v25 offset:24576
    ds_read_b64_tr_b16 v[34:35], v25 offset:26624
    s_waitcnt vmcnt(20)
    s_waitcnt lgkmcnt(10)
    v_mfma_f32_32x32x16_bf16 v[56:71], v[40:43], v[208:211], v[56:71]
    ds_read_b64_tr_b16 v[36:37], v22 offset:24576
    ds_read_b64_tr_b16 v[38:39], v22 offset:26624
    s_waitcnt lgkmcnt(10)
    v_mfma_f32_32x32x16_bf16 v[72:87], v[44:47], v[208:211], v[72:87]
    ds_read_b64_tr_b16 v[40:41], v23 offset:24576
    ds_read_b64_tr_b16 v[42:43], v23 offset:26624
    s_waitcnt vmcnt(19)
    s_waitcnt lgkmcnt(10)
    v_mfma_f32_32x32x16_bf16 v[56:71], v[48:51], v[212:215], v[56:71]
    ds_read_b64_tr_b16 v[44:45], v24 offset:25600
    ds_read_b64_tr_b16 v[46:47], v24 offset:27648
    s_waitcnt lgkmcnt(10)
    v_mfma_f32_32x32x16_bf16 v[72:87], v[52:55], v[212:215], v[72:87]
    buffer_load_dwordx4 v[196:199], v249, s[32:35], s16 offen offset:3072 sc1
    ds_read_b64_tr_b16 v[48:49], v25 offset:25600
    ds_read_b64_tr_b16 v[50:51], v25 offset:27648
    s_barrier
    s_waitcnt lgkmcnt(10)
    v_mfma_f32_32x32x16_bf16 v[120:135], v[28:31], v[200:203], v[120:135]
    s_add_u32 s16, s16, 16384
    ds_read_b64_tr_b16 v[52:53], v22 offset:25600
    ds_read_b64_tr_b16 v[54:55], v22 offset:27648
    s_waitcnt lgkmcnt(10)
    v_mfma_f32_32x32x16_bf16 v[136:151], v[32:35], v[200:203], v[136:151]
    s_and_b32 s16, s16, 0x3ffff
    ds_read_b64_tr_b16 v[28:29], v23 offset:25600
    ds_read_b64_tr_b16 v[30:31], v23 offset:27648
    s_waitcnt lgkmcnt(10)
    v_mfma_f32_32x32x16_bf16 v[88:103], v[36:39], v[200:203], v[88:103]
    ds_read_b64_tr_b16 v[32:33], v24 offset:28672
    ds_read_b64_tr_b16 v[34:35], v24 offset:30720
    s_waitcnt lgkmcnt(10)
    v_mfma_f32_32x32x16_bf16 v[104:119], v[40:43], v[200:203], v[104:119]
    buffer_load_dwordx4 v[200:203], v249, s[32:35], s16 offen sc1
    ds_read_b64_tr_b16 v[36:37], v25 offset:28672
    ds_read_b64_tr_b16 v[38:39], v25 offset:30720
    s_waitcnt lgkmcnt(10)
    v_mfma_f32_32x32x16_bf16 v[120:135], v[44:47], v[204:207], v[120:135]
    ds_read_b64_tr_b16 v[40:41], v22 offset:28672
    ds_read_b64_tr_b16 v[42:43], v22 offset:30720
    s_waitcnt lgkmcnt(10)
    v_mfma_f32_32x32x16_bf16 v[136:151], v[48:51], v[204:207], v[136:151]
    ds_read_b64_tr_b16 v[44:45], v23 offset:28672
    ds_read_b64_tr_b16 v[46:47], v23 offset:30720
    s_waitcnt lgkmcnt(10)
    v_mfma_f32_32x32x16_bf16 v[88:103], v[52:55], v[204:207], v[88:103]
    ds_read_b64_tr_b16 v[48:49], v24 offset:29696
    ds_read_b64_tr_b16 v[50:51], v24 offset:31744
    s_waitcnt lgkmcnt(10)
    v_mfma_f32_32x32x16_bf16 v[104:119], v[28:31], v[204:207], v[104:119]
    buffer_load_dwordx4 v[204:207], v249, s[32:35], s16 offen offset:1024 sc1
    ds_read_b64_tr_b16 v[52:53], v25 offset:29696
    ds_read_b64_tr_b16 v[54:55], v25 offset:31744
    s_waitcnt lgkmcnt(10)
    v_mfma_f32_32x32x16_bf16 v[120:135], v[32:35], v[208:211], v[120:135]
    ds_read_b64_tr_b16 v[28:29], v22 offset:29696
    ds_read_b64_tr_b16 v[30:31], v22 offset:31744
    s_waitcnt lgkmcnt(10)
    v_mfma_f32_32x32x16_bf16 v[136:151], v[36:39], v[208:211], v[136:151]
    ds_read_b64_tr_b16 v[32:33], v23 offset:29696
    ds_read_b64_tr_b16 v[34:35], v23 offset:31744
    s_waitcnt lgkmcnt(10)
    v_mfma_f32_32x32x16_bf16 v[88:103], v[40:43], v[208:211], v[88:103]
    ds_read_b64_tr_b16 v[36:37], v20 offset:32768
    ds_read_b64_tr_b16 v[38:39], v20 offset:34816
    s_waitcnt lgkmcnt(10)
    v_mfma_f32_32x32x16_bf16 v[104:119], v[44:47], v[208:211], v[104:119]
    buffer_load_dwordx4 v[208:211], v249, s[32:35], s16 offen offset:2048 sc1
    ds_read_b64_tr_b16 v[40:41], v20 offset:33792
    ds_read_b64_tr_b16 v[42:43], v20 offset:35840
    s_waitcnt lgkmcnt(10)
    v_mfma_f32_32x32x16_bf16 v[120:135], v[48:51], v[212:215], v[120:135]
    ds_read_b64_tr_b16 v[44:45], v20 offset:36864
    ds_read_b64_tr_b16 v[46:47], v20 offset:38912
    s_waitcnt lgkmcnt(10)
    v_mfma_f32_32x32x16_bf16 v[136:151], v[52:55], v[212:215], v[136:151]
    ds_read_b64_tr_b16 v[48:49], v20 offset:37888
    ds_read_b64_tr_b16 v[50:51], v20 offset:39936
    s_waitcnt lgkmcnt(10)
    v_mfma_f32_32x32x16_bf16 v[88:103], v[28:31], v[212:215], v[88:103]
    ds_read_b64_tr_b16 v[52:53], v20 offset:40960
    ds_read_b64_tr_b16 v[54:55], v20 offset:43008
    s_waitcnt lgkmcnt(10)
    v_mfma_f32_32x32x16_bf16 v[104:119], v[32:35], v[212:215], v[104:119]
    buffer_load_dwordx4 v[212:215], v249, s[32:35], s16 offen offset:3072 sc1
    ds_read_b64_tr_b16 v[28:29], v20 offset:41984
    ds_read_b64_tr_b16 v[30:31], v20 offset:44032
    s_barrier
    s_waitcnt vmcnt(23)
    s_waitcnt lgkmcnt(10)
    v_mfma_f32_32x32x16_bf16 v[56:71], v[36:39], v[216:219], v[56:71]
    s_add_u32 s16, s16, 16384
    ds_read_b64_tr_b16 v[32:33], v20 offset:45056
    ds_read_b64_tr_b16 v[34:35], v20 offset:47104
    s_waitcnt vmcnt(22)
    s_waitcnt lgkmcnt(10)
    v_mfma_f32_32x32x16_bf16 v[56:71], v[40:43], v[220:223], v[56:71]
    s_and_b32 s16, s16, 0x3ffff
    ds_read_b64_tr_b16 v[36:37], v20 offset:46080
    ds_read_b64_tr_b16 v[38:39], v20 offset:48128
    s_waitcnt vmcnt(21)
    s_waitcnt lgkmcnt(10)
    v_mfma_f32_32x32x16_bf16 v[56:71], v[44:47], v[224:227], v[56:71]
    ds_read_b64_tr_b16 v[40:41], v20
    ds_read_b64_tr_b16 v[42:43], v20 offset:2048
    s_waitcnt vmcnt(20)
    s_waitcnt lgkmcnt(10)
    v_mfma_f32_32x32x16_bf16 v[56:71], v[48:51], v[228:231], v[56:71]
    ds_read_b64_tr_b16 v[44:45], v20 offset:1024
    ds_read_b64_tr_b16 v[46:47], v20 offset:3072
    s_waitcnt vmcnt(19)
    s_waitcnt lgkmcnt(10)
    v_mfma_f32_32x32x16_bf16 v[56:71], v[52:55], v[232:235], v[56:71]
    ds_read_b64_tr_b16 v[48:49], v20 offset:4096
    ds_read_b64_tr_b16 v[50:51], v20 offset:6144
    s_waitcnt vmcnt(18)
    s_waitcnt lgkmcnt(10)
    v_mfma_f32_32x32x16_bf16 v[56:71], v[28:31], v[236:239], v[56:71]
    ds_read_b64_tr_b16 v[52:53], v20 offset:5120
    ds_read_b64_tr_b16 v[54:55], v20 offset:7168
    s_waitcnt vmcnt(17)
    s_waitcnt lgkmcnt(10)
    v_mfma_f32_32x32x16_bf16 v[56:71], v[32:35], v[240:243], v[56:71]
    ds_read_b64_tr_b16 v[28:29], v20 offset:8192
    ds_read_b64_tr_b16 v[30:31], v20 offset:10240
    s_waitcnt vmcnt(16)
    s_waitcnt lgkmcnt(10)
    v_mfma_f32_32x32x16_bf16 v[56:71], v[36:39], v[244:247], v[56:71]
    ds_read_b64_tr_b16 v[32:33], v20 offset:9216
    ds_read_b64_tr_b16 v[34:35], v20 offset:11264
    s_waitcnt vmcnt(15)
    s_waitcnt lgkmcnt(10)
    v_mfma_f32_32x32x16_bf16 v[56:71], v[40:43], v[152:155], v[56:71]
    ds_read_b64_tr_b16 v[36:37], v20 offset:12288
    ds_read_b64_tr_b16 v[38:39], v20 offset:14336
    s_waitcnt vmcnt(14)
    s_waitcnt lgkmcnt(10)
    v_mfma_f32_32x32x16_bf16 v[56:71], v[44:47], v[156:159], v[56:71]
    ds_read_b64_tr_b16 v[40:41], v20 offset:13312
    ds_read_b64_tr_b16 v[42:43], v20 offset:15360
    s_waitcnt vmcnt(13)
    s_waitcnt lgkmcnt(10)
    v_mfma_f32_32x32x16_bf16 v[56:71], v[48:51], v[160:163], v[56:71]
    ds_read_b64_tr_b16 v[44:45], v20 offset:16384
    ds_read_b64_tr_b16 v[46:47], v20 offset:18432
    s_waitcnt vmcnt(12)
    s_waitcnt lgkmcnt(10)
    v_mfma_f32_32x32x16_bf16 v[56:71], v[52:55], v[164:167], v[56:71]
    ds_read_b64_tr_b16 v[48:49], v20 offset:17408
    ds_read_b64_tr_b16 v[50:51], v20 offset:19456
    s_waitcnt vmcnt(11)
    s_waitcnt lgkmcnt(10)
    v_mfma_f32_32x32x16_bf16 v[56:71], v[28:31], v[168:171], v[56:71]
    ds_read_b64_tr_b16 v[52:53], v20 offset:20480
    ds_read_b64_tr_b16 v[54:55], v20 offset:22528
    s_waitcnt vmcnt(10)
    s_waitcnt lgkmcnt(10)
    v_mfma_f32_32x32x16_bf16 v[56:71], v[32:35], v[172:175], v[56:71]
    ds_read_b64_tr_b16 v[28:29], v20 offset:21504
    ds_read_b64_tr_b16 v[30:31], v20 offset:23552
    s_barrier
    s_waitcnt vmcnt(9)
    s_waitcnt lgkmcnt(10)
    v_mfma_f32_32x32x16_bf16 v[56:71], v[36:39], v[176:179], v[56:71]
    ds_read_b64_tr_b16 v[32:33], v20 offset:24576
    ds_read_b64_tr_b16 v[34:35], v20 offset:26624
    s_waitcnt vmcnt(8)
    s_waitcnt lgkmcnt(10)
    v_mfma_f32_32x32x16_bf16 v[56:71], v[40:43], v[180:183], v[56:71]
    ds_read_b64_tr_b16 v[36:37], v20 offset:25600
    ds_read_b64_tr_b16 v[38:39], v20 offset:27648
    s_waitcnt vmcnt(7)
    s_waitcnt lgkmcnt(10)
    v_mfma_f32_32x32x16_bf16 v[56:71], v[44:47], v[184:187], v[56:71]
    ds_read_b64_tr_b16 v[40:41], v20 offset:28672
    ds_read_b64_tr_b16 v[42:43], v20 offset:30720
    s_waitcnt vmcnt(6)
    s_waitcnt lgkmcnt(10)
    v_mfma_f32_32x32x16_bf16 v[56:71], v[48:51], v[188:191], v[56:71]
    ds_read_b64_tr_b16 v[44:45], v20 offset:29696
    ds_read_b64_tr_b16 v[46:47], v20 offset:31744
    s_waitcnt vmcnt(5)
    s_waitcnt lgkmcnt(10)
    v_mfma_f32_32x32x16_bf16 v[56:71], v[52:55], v[192:195], v[56:71]
    ds_read_b64_tr_b16 v[48:49], v21 offset:32768
    ds_read_b64_tr_b16 v[50:51], v21 offset:34816
    s_waitcnt vmcnt(4)
    s_waitcnt lgkmcnt(10)
    v_mfma_f32_32x32x16_bf16 v[56:71], v[28:31], v[196:199], v[56:71]
    ds_read_b64_tr_b16 v[52:53], v21 offset:33792
    ds_read_b64_tr_b16 v[54:55], v21 offset:35840
    s_waitcnt vmcnt(3)
    s_waitcnt lgkmcnt(10)
    v_mfma_f32_32x32x16_bf16 v[56:71], v[32:35], v[200:203], v[56:71]
    ds_read_b64_tr_b16 v[28:29], v21 offset:36864
    ds_read_b64_tr_b16 v[30:31], v21 offset:38912
    s_waitcnt vmcnt(2)
    s_waitcnt lgkmcnt(10)
    v_mfma_f32_32x32x16_bf16 v[56:71], v[36:39], v[204:207], v[56:71]
    ds_read_b64_tr_b16 v[32:33], v21 offset:37888
    ds_read_b64_tr_b16 v[34:35], v21 offset:39936
    s_waitcnt vmcnt(1)
    s_waitcnt lgkmcnt(10)
    v_mfma_f32_32x32x16_bf16 v[56:71], v[40:43], v[208:211], v[56:71]
    ds_read_b64_tr_b16 v[36:37], v21 offset:40960
    ds_read_b64_tr_b16 v[38:39], v21 offset:43008
    s_waitcnt vmcnt(0)
    s_waitcnt lgkmcnt(10)
    v_mfma_f32_32x32x16_bf16 v[56:71], v[44:47], v[212:215], v[56:71]
    ds_read_b64_tr_b16 v[40:41], v21 offset:41984
    ds_read_b64_tr_b16 v[42:43], v21 offset:44032
    s_waitcnt lgkmcnt(10)
    v_mfma_f32_32x32x16_bf16 v[72:87], v[48:51], v[216:219], v[72:87]
    ds_read_b64_tr_b16 v[44:45], v21 offset:45056
    ds_read_b64_tr_b16 v[46:47], v21 offset:47104
    s_waitcnt lgkmcnt(10)
    v_mfma_f32_32x32x16_bf16 v[72:87], v[52:55], v[220:223], v[72:87]
    s_nop 3
    v_cvt_pk_bf16_f32 v56, v56, v57
    v_cvt_pk_bf16_f32 v57, v58, v59
    ds_read_b64_tr_b16 v[48:49], v21 offset:46080
    ds_read_b64_tr_b16 v[50:51], v21 offset:48128
    s_waitcnt lgkmcnt(10)
    v_mfma_f32_32x32x16_bf16 v[72:87], v[28:31], v[224:227], v[72:87]
    v_cvt_pk_bf16_f32 v58, v60, v61
    v_cvt_pk_bf16_f32 v59, v62, v63
    ds_write_b128 v0, v[56:59]
    ds_read_b64_tr_b16 v[52:53], v21
    ds_read_b64_tr_b16 v[54:55], v21 offset:2048
    s_waitcnt lgkmcnt(11)
    v_mfma_f32_32x32x16_bf16 v[72:87], v[32:35], v[228:231], v[72:87]
    v_cvt_pk_bf16_f32 v60, v64, v65
    v_cvt_pk_bf16_f32 v61, v66, v67
    ds_read_b64_tr_b16 v[28:29], v21 offset:1024
    ds_read_b64_tr_b16 v[30:31], v21 offset:3072
    s_waitcnt lgkmcnt(11)
    v_mfma_f32_32x32x16_bf16 v[72:87], v[36:39], v[232:235], v[72:87]
    v_cvt_pk_bf16_f32 v62, v68, v69
    v_cvt_pk_bf16_f32 v63, v70, v71
    ds_write_b128 v0, v[60:63] offset:1024
    ds_read_b64_tr_b16 v[32:33], v21 offset:4096
    ds_read_b64_tr_b16 v[34:35], v21 offset:6144
    s_waitcnt lgkmcnt(12)
    v_mfma_f32_32x32x16_bf16 v[72:87], v[40:43], v[236:239], v[72:87]
    v_subrev_u32 v0, 118784, v0
    ds_read_b64_tr_b16 v[36:37], v21 offset:5120
    ds_read_b64_tr_b16 v[38:39], v21 offset:7168
    s_waitcnt lgkmcnt(12)
    v_mfma_f32_32x32x16_bf16 v[72:87], v[44:47], v[240:243], v[72:87]
    ds_read_b64_tr_b16 v[40:41], v21 offset:8192
    ds_read_b64_tr_b16 v[42:43], v21 offset:10240
    s_waitcnt lgkmcnt(12)
    v_mfma_f32_32x32x16_bf16 v[72:87], v[48:51], v[244:247], v[72:87]
    ds_read_b64_tr_b16 v[44:45], v21 offset:9216
    ds_read_b64_tr_b16 v[46:47], v21 offset:11264
    s_waitcnt lgkmcnt(8)
    s_barrier
    v_mfma_f32_32x32x16_bf16 v[72:87], v[52:55], v[152:155], v[72:87]
    ds_read_b64_tr_b16 v[48:49], v21 offset:12288
    ds_read_b64_tr_b16 v[50:51], v21 offset:14336
    v_mfma_f32_32x32x16_bf16 v[72:87], v[28:31], v[156:159], v[72:87]
    ds_read_b64_tr_b16 v[52:53], v21 offset:13312
    ds_read_b64_tr_b16 v[54:55], v21 offset:15360
    s_waitcnt lgkmcnt(10)
    v_mfma_f32_32x32x16_bf16 v[72:87], v[32:35], v[160:163], v[72:87]
    ds_read_b64_tr_b16 v[28:29], v21 offset:16384
    ds_read_b64_tr_b16 v[30:31], v21 offset:18432
    s_waitcnt lgkmcnt(10)
    v_mfma_f32_32x32x16_bf16 v[72:87], v[36:39], v[164:167], v[72:87]
    ds_read_b64_tr_b16 v[32:33], v21 offset:17408
    ds_read_b64_tr_b16 v[34:35], v21 offset:19456
    s_waitcnt lgkmcnt(10)
    v_mfma_f32_32x32x16_bf16 v[72:87], v[40:43], v[168:171], v[72:87]
    ds_read_b64_tr_b16 v[36:37], v21 offset:20480
    ds_read_b64_tr_b16 v[38:39], v21 offset:22528
    s_waitcnt lgkmcnt(10)
    v_mfma_f32_32x32x16_bf16 v[72:87], v[44:47], v[172:175], v[72:87]
    ds_read_b64_tr_b16 v[40:41], v21 offset:21504
    ds_read_b64_tr_b16 v[42:43], v21 offset:23552
    s_waitcnt lgkmcnt(10)
    v_mfma_f32_32x32x16_bf16 v[72:87], v[48:51], v[176:179], v[72:87]
    ds_read_b64_tr_b16 v[44:45], v21 offset:24576
    ds_read_b64_tr_b16 v[46:47], v21 offset:26624
    s_waitcnt lgkmcnt(10)
    v_mfma_f32_32x32x16_bf16 v[72:87], v[52:55], v[180:183], v[72:87]
    ds_read_b64_tr_b16 v[48:49], v21 offset:25600
    ds_read_b64_tr_b16 v[50:51], v21 offset:27648
    s_waitcnt lgkmcnt(10)
    v_mfma_f32_32x32x16_bf16 v[72:87], v[28:31], v[184:187], v[72:87]
    ds_read_b64_tr_b16 v[52:53], v21 offset:28672
    ds_read_b64_tr_b16 v[54:55], v21 offset:30720
    s_waitcnt lgkmcnt(10)
    v_mfma_f32_32x32x16_bf16 v[72:87], v[32:35], v[188:191], v[72:87]
    ds_read_b64_tr_b16 v[28:29], v21 offset:29696
    ds_read_b64_tr_b16 v[30:31], v21 offset:31744
    s_waitcnt lgkmcnt(10)
    v_mfma_f32_32x32x16_bf16 v[72:87], v[36:39], v[192:195], v[72:87]
    ds_read_b64_tr_b16 v[32:33], v22 offset:32768
    ds_read_b64_tr_b16 v[34:35], v22 offset:34816
    s_waitcnt lgkmcnt(10)
    v_mfma_f32_32x32x16_bf16 v[72:87], v[40:43], v[196:199], v[72:87]
    ds_read_b64_tr_b16 v[36:37], v23 offset:32768
    ds_read_b64_tr_b16 v[38:39], v23 offset:34816
    s_waitcnt lgkmcnt(10)
    v_mfma_f32_32x32x16_bf16 v[72:87], v[44:47], v[200:203], v[72:87]
    ds_read_b64_tr_b16 v[40:41], v22 offset:33792
    ds_read_b64_tr_b16 v[42:43], v22 offset:35840
    s_waitcnt lgkmcnt(10)
    v_mfma_f32_32x32x16_bf16 v[72:87], v[48:51], v[204:207], v[72:87]
    ds_read_b64_tr_b16 v[44:45], v23 offset:33792
    ds_read_b64_tr_b16 v[46:47], v23 offset:35840
    s_waitcnt lgkmcnt(10)
    v_mfma_f32_32x32x16_bf16 v[72:87], v[52:55], v[208:211], v[72:87]
    ds_read_b64_tr_b16 v[48:49], v22 offset:36864
    ds_read_b64_tr_b16 v[50:51], v22 offset:38912
    s_waitcnt lgkmcnt(10)
    v_mfma_f32_32x32x16_bf16 v[72:87], v[28:31], v[212:215], v[72:87]
    ds_read_b64_tr_b16 v[52:53], v23 offset:36864
    ds_read_b64_tr_b16 v[54:55], v23 offset:38912
    s_waitcnt lgkmcnt(10)
    v_mfma_f32_32x32x16_bf16 v[88:103], v[32:35], v[216:219], v[88:103]
    ds_read_b64_tr_b16 v[28:29], v22 offset:37888
    ds_read_b64_tr_b16 v[30:31], v22 offset:39936
    s_waitcnt lgkmcnt(10)
    v_mfma_f32_32x32x16_bf16 v[104:119], v[36:39], v[216:219], v[104:119]
    s_nop 3
    v_cvt_pk_bf16_f32 v72, v72, v73
    v_cvt_pk_bf16_f32 v73, v74, v75
    ds_read_b64_tr_b16 v[32:33], v23 offset:37888
    ds_read_b64_tr_b16 v[34:35], v23 offset:39936
    s_waitcnt lgkmcnt(10)
    v_mfma_f32_32x32x16_bf16 v[88:103], v[40:43], v[220:223], v[88:103]
    v_cvt_pk_bf16_f32 v74, v76, v77
    v_cvt_pk_bf16_f32 v75, v78, v79
    ds_write_b128 v0, v[72:75]
    ds_read_b64_tr_b16 v[36:37], v22 offset:40960
    ds_read_b64_tr_b16 v[38:39], v22 offset:43008
    s_waitcnt lgkmcnt(11)
    v_mfma_f32_32x32x16_bf16 v[104:119], v[44:47], v[220:223], v[104:119]
    v_cvt_pk_bf16_f32 v76, v80, v81
    v_cvt_pk_bf16_f32 v77, v82, v83
    ds_read_b64_tr_b16 v[40:41], v23 offset:40960
    ds_read_b64_tr_b16 v[42:43], v23 offset:43008
    s_waitcnt lgkmcnt(11)
    v_mfma_f32_32x32x16_bf16 v[88:103], v[48:51], v[224:227], v[88:103]
    v_cvt_pk_bf16_f32 v78, v84, v85
    v_cvt_pk_bf16_f32 v79, v86, v87
    ds_write_b128 v0, v[76:79] offset:1024
    ds_read_b64_tr_b16 v[44:45], v22 offset:41984
    ds_read_b64_tr_b16 v[46:47], v22 offset:44032
    s_waitcnt lgkmcnt(12)
    v_mfma_f32_32x32x16_bf16 v[104:119], v[52:55], v[224:227], v[104:119]
    ds_read_b64_tr_b16 v[48:49], v23 offset:41984
    ds_read_b64_tr_b16 v[50:51], v23 offset:44032
    s_waitcnt lgkmcnt(4)
    s_barrier
    v_mfma_f32_32x32x16_bf16 v[88:103], v[28:31], v[228:231], v[88:103]
    s_lshl_b32 s96, s77, 11
    s_add_u32 s14, s96, 32768
    v_and_b32 v0, 7, v1
    ds_read_b64_tr_b16 v[52:53], v22 offset:45056
    ds_read_b64_tr_b16 v[54:55], v22 offset:47104
    v_mfma_f32_32x32x16_bf16 v[104:119], v[32:35], v[228:231], v[104:119]
    v_lshl_add_u32 v0, v0, 4, s14
    ds_read_b64_tr_b16 v[28:29], v23 offset:45056
    ds_read_b64_tr_b16 v[30:31], v23 offset:47104
    v_mfma_f32_32x32x16_bf16 v[88:103], v[36:39], v[232:235], v[88:103]
    v_bfe_u32 v4, v1, 3, 2
    ds_read_b64_tr_b16 v[32:33], v22 offset:46080
    ds_read_b64_tr_b16 v[34:35], v22 offset:48128
    v_mfma_f32_32x32x16_bf16 v[104:119], v[40:43], v[232:235], v[104:119]
    v_lshl_add_u32 v0, v4, 8, v0
    v_lshrrev_b32 v4, 5, v1
    ds_read_b64_tr_b16 v[36:37], v23 offset:46080
    ds_read_b64_tr_b16 v[38:39], v23 offset:48128
    s_waitcnt lgkmcnt(10)
    v_mfma_f32_32x32x16_bf16 v[88:103], v[44:47], v[236:239], v[88:103]
    v_lshl_add_u32 v0, v4, 7, v0
    ds_read_b64_tr_b16 v[40:41], v22
    ds_read_b64_tr_b16 v[42:43], v22 offset:2048
    s_waitcnt lgkmcnt(10)
    v_mfma_f32_32x32x16_bf16 v[104:119], v[48:51], v[236:239], v[104:119]
    ds_read_b64_tr_b16 v[44:45], v23
    ds_read_b64_tr_b16 v[46:47], v23 offset:2048
    s_waitcnt lgkmcnt(10)
    v_mfma_f32_32x32x16_bf16 v[88:103], v[52:55], v[240:243], v[88:103]
    ds_read_b64_tr_b16 v[48:49], v22 offset:1024
    ds_read_b64_tr_b16 v[50:51], v22 offset:3072
    s_waitcnt lgkmcnt(10)
    v_mfma_f32_32x32x16_bf16 v[104:119], v[28:31], v[240:243], v[104:119]
    ds_read_b64_tr_b16 v[52:53], v23 offset:1024
    ds_read_b64_tr_b16 v[54:55], v23 offset:3072
    s_waitcnt lgkmcnt(10)
    v_mfma_f32_32x32x16_bf16 v[88:103], v[32:35], v[244:247], v[88:103]
    ds_read_b64_tr_b16 v[28:29], v22 offset:4096
    ds_read_b64_tr_b16 v[30:31], v22 offset:6144
    s_waitcnt lgkmcnt(10)
    v_mfma_f32_32x32x16_bf16 v[104:119], v[36:39], v[244:247], v[104:119]
    ds_read_b64_tr_b16 v[32:33], v23 offset:4096
    ds_read_b64_tr_b16 v[34:35], v23 offset:6144
    s_waitcnt lgkmcnt(10)
    v_mfma_f32_32x32x16_bf16 v[88:103], v[40:43], v[152:155], v[88:103]
    ds_read_b64_tr_b16 v[36:37], v22 offset:5120
    ds_read_b64_tr_b16 v[38:39], v22 offset:7168
    s_waitcnt lgkmcnt(10)
    v_mfma_f32_32x32x16_bf16 v[104:119], v[44:47], v[152:155], v[104:119]
    ds_read_b64_tr_b16 v[40:41], v23 offset:5120
    ds_read_b64_tr_b16 v[42:43], v23 offset:7168
    s_waitcnt lgkmcnt(10)
    v_mfma_f32_32x32x16_bf16 v[88:103], v[48:51], v[156:159], v[88:103]
    ds_read_b64_tr_b16 v[44:45], v22 offset:8192
    ds_read_b64_tr_b16 v[46:47], v22 offset:10240
    s_waitcnt lgkmcnt(10)
    v_mfma_f32_32x32x16_bf16 v[104:119], v[52:55], v[156:159], v[104:119]
    ds_read_b64_tr_b16 v[48:49], v23 offset:8192
    ds_read_b64_tr_b16 v[50:51], v23 offset:10240
    s_waitcnt lgkmcnt(10)
    v_mfma_f32_32x32x16_bf16 v[88:103], v[28:31], v[160:163], v[88:103]
    ds_read_b64_tr_b16 v[52:53], v22 offset:9216
    ds_read_b64_tr_b16 v[54:55], v22 offset:11264
    s_waitcnt lgkmcnt(10)
    v_mfma_f32_32x32x16_bf16 v[104:119], v[32:35], v[160:163], v[104:119]
    ds_read_b64_tr_b16 v[28:29], v23 offset:9216
    ds_read_b64_tr_b16 v[30:31], v23 offset:11264
    s_waitcnt lgkmcnt(10)
    v_mfma_f32_32x32x16_bf16 v[88:103], v[36:39], v[164:167], v[88:103]
    ds_read_b64_tr_b16 v[32:33], v22 offset:12288
    ds_read_b64_tr_b16 v[34:35], v22 offset:14336
    s_waitcnt lgkmcnt(10)
    v_mfma_f32_32x32x16_bf16 v[104:119], v[40:43], v[164:167], v[104:119]
    ds_read_b64_tr_b16 v[36:37], v23 offset:12288
    ds_read_b64_tr_b16 v[38:39], v23 offset:14336
    s_waitcnt lgkmcnt(10)
    v_mfma_f32_32x32x16_bf16 v[88:103], v[44:47], v[168:171], v[88:103]
    ds_read_b64_tr_b16 v[40:41], v22 offset:13312
    ds_read_b64_tr_b16 v[42:43], v22 offset:15360
    s_waitcnt lgkmcnt(10)
    v_mfma_f32_32x32x16_bf16 v[104:119], v[48:51], v[168:171], v[104:119]
    ds_read_b64_tr_b16 v[44:45], v23 offset:13312
    ds_read_b64_tr_b16 v[46:47], v23 offset:15360
    s_waitcnt lgkmcnt(10)
    v_mfma_f32_32x32x16_bf16 v[88:103], v[52:55], v[172:175], v[88:103]
    ds_read_b64_tr_b16 v[48:49], v22 offset:16384
    ds_read_b64_tr_b16 v[50:51], v22 offset:18432
    s_waitcnt lgkmcnt(10)
    v_mfma_f32_32x32x16_bf16 v[104:119], v[28:31], v[172:175], v[104:119]
    ds_read_b64_tr_b16 v[52:53], v23 offset:16384
    ds_read_b64_tr_b16 v[54:55], v23 offset:18432
    s_waitcnt lgkmcnt(10)
    v_mfma_f32_32x32x16_bf16 v[88:103], v[32:35], v[176:179], v[88:103]
    ds_read_b64_tr_b16 v[28:29], v22 offset:17408
    ds_read_b64_tr_b16 v[30:31], v22 offset:19456
    s_waitcnt lgkmcnt(10)
    v_mfma_f32_32x32x16_bf16 v[104:119], v[36:39], v[176:179], v[104:119]
    ds_read_b64_tr_b16 v[32:33], v23 offset:17408
    ds_read_b64_tr_b16 v[34:35], v23 offset:19456
    s_waitcnt lgkmcnt(10)
    v_mfma_f32_32x32x16_bf16 v[88:103], v[40:43], v[180:183], v[88:103]
    ds_read_b64_tr_b16 v[36:37], v22 offset:20480
    ds_read_b64_tr_b16 v[38:39], v22 offset:22528
    s_waitcnt lgkmcnt(10)
    v_mfma_f32_32x32x16_bf16 v[104:119], v[44:47], v[180:183], v[104:119]
    ds_read_b64_tr_b16 v[40:41], v23 offset:20480
    ds_read_b64_tr_b16 v[42:43], v23 offset:22528
    s_waitcnt lgkmcnt(10)
    v_mfma_f32_32x32x16_bf16 v[88:103], v[48:51], v[184:187], v[88:103]
    ds_read_b64_tr_b16 v[44:45], v22 offset:21504
    ds_read_b64_tr_b16 v[46:47], v22 offset:23552
    s_waitcnt lgkmcnt(10)
    v_mfma_f32_32x32x16_bf16 v[104:119], v[52:55], v[184:187], v[104:119]
    ds_read_b64_tr_b16 v[48:49], v23 offset:21504
    ds_read_b64_tr_b16 v[50:51], v23 offset:23552
    s_waitcnt lgkmcnt(10)
    v_mfma_f32_32x32x16_bf16 v[88:103], v[28:31], v[188:191], v[88:103]
    ds_read_b64_tr_b16 v[52:53], v22 offset:24576
    ds_read_b64_tr_b16 v[54:55], v22 offset:26624
    s_waitcnt lgkmcnt(10)
    v_mfma_f32_32x32x16_bf16 v[104:119], v[32:35], v[188:191], v[104:119]
    ds_read_b64_tr_b16 v[28:29], v23 offset:24576
    ds_read_b64_tr_b16 v[30:31], v23 offset:26624
    s_waitcnt lgkmcnt(10)
    v_mfma_f32_32x32x16_bf16 v[88:103], v[36:39], v[192:195], v[88:103]
    ds_read_b64_tr_b16 v[32:33], v22 offset:25600
    ds_read_b64_tr_b16 v[34:35], v22 offset:27648
    s_waitcnt lgkmcnt(10)
    v_mfma_f32_32x32x16_bf16 v[104:119], v[40:43], v[192:195], v[104:119]
    ds_read_b64_tr_b16 v[36:37], v23 offset:25600
    ds_read_b64_tr_b16 v[38:39], v23 offset:27648
    s_waitcnt lgkmcnt(10)
    v_mfma_f32_32x32x16_bf16 v[88:103], v[44:47], v[196:199], v[88:103]
    ds_read_b64_tr_b16 v[40:41], v22 offset:28672
    ds_read_b64_tr_b16 v[42:43], v22 offset:30720
    s_waitcnt lgkmcnt(10)
    v_mfma_f32_32x32x16_bf16 v[104:119], v[48:51], v[196:199], v[104:119]
    ds_read_b64_tr_b16 v[44:45], v23 offset:28672
    ds_read_b64_tr_b16 v[46:47], v23 offset:30720
    s_waitcnt lgkmcnt(10)
    v_mfma_f32_32x32x16_bf16 v[88:103], v[52:55], v[200:203], v[88:103]
    ds_read_b64_tr_b16 v[48:49], v22 offset:29696
    ds_read_b64_tr_b16 v[50:51], v22 offset:31744
    s_waitcnt lgkmcnt(10)
    v_mfma_f32_32x32x16_bf16 v[104:119], v[28:31], v[200:203], v[104:119]
    ds_read_b64_tr_b16 v[52:53], v23 offset:29696
    ds_read_b64_tr_b16 v[54:55], v23 offset:31744
    s_waitcnt lgkmcnt(10)
    v_mfma_f32_32x32x16_bf16 v[88:103], v[32:35], v[204:207], v[88:103]
    ds_read_b64_tr_b16 v[28:29], v24 offset:32768
    ds_read_b64_tr_b16 v[30:31], v24 offset:34816
    s_waitcnt lgkmcnt(10)
    v_mfma_f32_32x32x16_bf16 v[104:119], v[36:39], v[204:207], v[104:119]
    ds_read_b64_tr_b16 v[32:33], v25 offset:32768
    ds_read_b64_tr_b16 v[34:35], v25 offset:34816
    s_waitcnt lgkmcnt(10)
    v_mfma_f32_32x32x16_bf16 v[88:103], v[40:43], v[208:211], v[88:103]
    ds_read_b64_tr_b16 v[36:37], v24 offset:33792
    ds_read_b64_tr_b16 v[38:39], v24 offset:35840
    s_waitcnt lgkmcnt(10)
    v_mfma_f32_32x32x16_bf16 v[104:119], v[44:47], v[208:211], v[104:119]
    ds_read_b64_tr_b16 v[40:41], v25 offset:33792
    ds_read_b64_tr_b16 v[42:43], v25 offset:35840
    s_waitcnt lgkmcnt(10)
    v_mfma_f32_32x32x16_bf16 v[88:103], v[48:51], v[212:215], v[88:103]
    ds_read_b64_tr_b16 v[44:45], v24 offset:36864
    ds_read_b64_tr_b16 v[46:47], v24 offset:38912
    s_waitcnt lgkmcnt(10)
    v_mfma_f32_32x32x16_bf16 v[104:119], v[52:55], v[212:215], v[104:119]
    ds_read_b64_tr_b16 v[48:49], v25 offset:36864
    ds_read_b64_tr_b16 v[50:51], v25 offset:38912
    s_barrier
    s_waitcnt lgkmcnt(10)
    v_mfma_f32_32x32x16_bf16 v[120:135], v[28:31], v[216:219], v[120:135]
    ds_read_b64_tr_b16 v[52:53], v24 offset:37888
    ds_read_b64_tr_b16 v[54:55], v24 offset:39936
L_PAD4:
    s_cbranch_execz L_RET4
    s_waitcnt lgkmcnt(10)
    v_mfma_f32_32x32x16_bf16 v[136:151], v[32:35], v[216:219], v[136:151]
    v_cvt_pk_bf16_f32 v88, v88, v89
    v_cvt_pk_bf16_f32 v89, v90, v91
    ds_read_b64_tr_b16 v[28:29], v25 offset:37888
    ds_read_b64_tr_b16 v[30:31], v25 offset:39936
    s_waitcnt lgkmcnt(10)
    v_mfma_f32_32x32x16_bf16 v[120:135], v[36:39], v[220:223], v[120:135]
    v_cvt_pk_bf16_f32 v90, v92, v93
    v_cvt_pk_bf16_f32 v91, v94, v95
    ds_write_b128 v0, v[88:91]
    ds_read_b64_tr_b16 v[32:33], v24 offset:40960
    ds_read_b64_tr_b16 v[34:35], v24 offset:43008
    s_waitcnt lgkmcnt(11)
    v_mfma_f32_32x32x16_bf16 v[136:151], v[40:43], v[220:223], v[136:151]
    v_cvt_pk_bf16_f32 v92, v96, v97
    v_cvt_pk_bf16_f32 v93, v98, v99
    ds_read_b64_tr_b16 v[36:37], v25 offset:40960
    ds_read_b64_tr_b16 v[38:39], v25 offset:43008
    s_waitcnt lgkmcnt(11)
    v_mfma_f32_32x32x16_bf16 v[120:135], v[44:47], v[224:227], v[120:135]
    v_cvt_pk_bf16_f32 v94, v100, v101
    v_cvt_pk_bf16_f32 v95, v102, v103
    ds_write_b128 v0, v[92:95] offset:1024
    ds_read_b64_tr_b16 v[40:41], v24 offset:41984
    ds_read_b64_tr_b16 v[42:43], v24 offset:44032
    s_waitcnt lgkmcnt(12)
    v_mfma_f32_32x32x16_bf16 v[136:151], v[48:51], v[224:227], v[136:151]
    v_cvt_pk_bf16_f32 v104, v104, v105
    v_cvt_pk_bf16_f32 v105, v106, v107
    ds_read_b64_tr_b16 v[44:45], v25 offset:41984
    ds_read_b64_tr_b16 v[46:47], v25 offset:44032
    s_waitcnt lgkmcnt(12)
    v_mfma_f32_32x32x16_bf16 v[120:135], v[52:55], v[228:231], v[120:135]
    v_cvt_pk_bf16_f32 v106, v108, v109
    v_cvt_pk_bf16_f32 v107, v110, v111
    ds_write_b128 v0, v[104:107] offset:8192
    ds_read_b64_tr_b16 v[48:49], v24 offset:45056
    ds_read_b64_tr_b16 v[50:51], v24 offset:47104
    s_waitcnt lgkmcnt(13)
    v_mfma_f32_32x32x16_bf16 v[136:151], v[28:31], v[228:231], v[136:151]
    v_cvt_pk_bf16_f32 v108, v112, v113
    v_cvt_pk_bf16_f32 v109, v114, v115
    ds_read_b64_tr_b16 v[52:53], v25 offset:45056
    ds_read_b64_tr_b16 v[54:55], v25 offset:47104
    s_waitcnt lgkmcnt(12)
    v_mfma_f32_32x32x16_bf16 v[120:135], v[32:35], v[232:235], v[120:135]
    v_cvt_pk_bf16_f32 v110, v116, v117
    v_cvt_pk_bf16_f32 v111, v118, v119
    ds_write_b128 v0, v[108:111] offset:9216
    ds_read_b64_tr_b16 v[28:29], v24 offset:46080
    ds_read_b64_tr_b16 v[30:31], v24 offset:48128
    s_waitcnt lgkmcnt(13)
    v_mfma_f32_32x32x16_bf16 v[136:151], v[36:39], v[232:235], v[136:151]
    ds_read_b64_tr_b16 v[32:33], v25 offset:46080
    ds_read_b64_tr_b16 v[34:35], v25 offset:48128
    s_waitcnt lgkmcnt(12)
    v_mfma_f32_32x32x16_bf16 v[120:135], v[40:43], v[236:239], v[120:135]
    ds_read_b64_tr_b16 v[36:37], v24
    ds_read_b64_tr_b16 v[38:39], v24 offset:2048
    s_waitcnt lgkmcnt(12)
    v_mfma_f32_32x32x16_bf16 v[136:151], v[44:47], v[236:239], v[136:151]
    ds_read_b64_tr_b16 v[40:41], v25
    ds_read_b64_tr_b16 v[42:43], v25 offset:2048
    s_waitcnt lgkmcnt(11)
    v_mfma_f32_32x32x16_bf16 v[120:135], v[48:51], v[240:243], v[120:135]
    ds_read_b64_tr_b16 v[44:45], v24 offset:1024
    ds_read_b64_tr_b16 v[46:47], v24 offset:3072
    s_waitcnt lgkmcnt(11)
    v_mfma_f32_32x32x16_bf16 v[136:151], v[52:55], v[240:243], v[136:151]
    ds_read_b64_tr_b16 v[48:49], v25 offset:1024
    ds_read_b64_tr_b16 v[50:51], v25 offset:3072
    s_waitcnt lgkmcnt(10)
    v_mfma_f32_32x32x16_bf16 v[120:135], v[28:31], v[244:247], v[120:135]
    ds_read_b64_tr_b16 v[52:53], v24 offset:4096
    ds_read_b64_tr_b16 v[54:55], v24 offset:6144
    s_waitcnt lgkmcnt(10)
    v_mfma_f32_32x32x16_bf16 v[136:151], v[32:35], v[244:247], v[136:151]
    ds_read_b64_tr_b16 v[28:29], v25 offset:4096
    ds_read_b64_tr_b16 v[30:31], v25 offset:6144
    s_waitcnt lgkmcnt(10)
    v_mfma_f32_32x32x16_bf16 v[120:135], v[36:39], v[152:155], v[120:135]
    ds_read_b64_tr_b16 v[32:33], v24 offset:5120
    ds_read_b64_tr_b16 v[34:35], v24 offset:7168
    s_waitcnt lgkmcnt(10)
    v_mfma_f32_32x32x16_bf16 v[136:151], v[40:43], v[152:155], v[136:151]
    ds_read_b64_tr_b16 v[36:37], v25 offset:5120
    ds_read_b64_tr_b16 v[38:39], v25 offset:7168
    s_waitcnt lgkmcnt(10)
    v_mfma_f32_32x32x16_bf16 v[120:135], v[44:47], v[156:159], v[120:135]
    ds_read_b64_tr_b16 v[40:41], v24 offset:8192
    ds_read_b64_tr_b16 v[42:43], v24 offset:10240
    s_waitcnt lgkmcnt(10)
    v_mfma_f32_32x32x16_bf16 v[136:151], v[48:51], v[156:159], v[136:151]
    ds_read_b64_tr_b16 v[44:45], v25 offset:8192
    ds_read_b64_tr_b16 v[46:47], v25 offset:10240
    s_waitcnt lgkmcnt(10)
    v_mfma_f32_32x32x16_bf16 v[120:135], v[52:55], v[160:163], v[120:135]
    ds_read_b64_tr_b16 v[48:49], v24 offset:9216
    ds_read_b64_tr_b16 v[50:51], v24 offset:11264
    s_waitcnt lgkmcnt(10)
    v_mfma_f32_32x32x16_bf16 v[136:151], v[28:31], v[160:163], v[136:151]
    ds_read_b64_tr_b16 v[52:53], v25 offset:9216
    ds_read_b64_tr_b16 v[54:55], v25 offset:11264
    s_waitcnt lgkmcnt(10)
    v_mfma_f32_32x32x16_bf16 v[120:135], v[32:35], v[164:167], v[120:135]
    ds_read_b64_tr_b16 v[28:29], v24 offset:12288
    ds_read_b64_tr_b16 v[30:31], v24 offset:14336
    s_waitcnt lgkmcnt(10)
    v_mfma_f32_32x32x16_bf16 v[136:151], v[36:39], v[164:167], v[136:151]
    ds_read_b64_tr_b16 v[32:33], v25 offset:12288
    ds_read_b64_tr_b16 v[34:35], v25 offset:14336
    s_waitcnt lgkmcnt(10)
    v_mfma_f32_32x32x16_bf16 v[120:135], v[40:43], v[168:171], v[120:135]
    ds_read_b64_tr_b16 v[36:37], v24 offset:13312
    ds_read_b64_tr_b16 v[38:39], v24 offset:15360
    s_waitcnt lgkmcnt(10)
    v_mfma_f32_32x32x16_bf16 v[136:151], v[44:47], v[168:171], v[136:151]
    ds_read_b64_tr_b16 v[40:41], v25 offset:13312
    ds_read_b64_tr_b16 v[42:43], v25 offset:15360
    s_waitcnt lgkmcnt(10)
    v_mfma_f32_32x32x16_bf16 v[120:135], v[48:51], v[172:175], v[120:135]
    ds_read_b64_tr_b16 v[44:45], v24 offset:16384
    ds_read_b64_tr_b16 v[46:47], v24 offset:18432
    s_waitcnt lgkmcnt(10)
    v_mfma_f32_32x32x16_bf16 v[136:151], v[52:55], v[172:175], v[136:151]
    ds_read_b64_tr_b16 v[48:49], v25 offset:16384
    ds_read_b64_tr_b16 v[50:51], v25 offset:18432
    s_waitcnt lgkmcnt(10)
    v_mfma_f32_32x32x16_bf16 v[120:135], v[28:31], v[176:179], v[120:135]
    ds_read_b64_tr_b16 v[52:53], v24 offset:17408
    ds_read_b64_tr_b16 v[54:55], v24 offset:19456
    s_waitcnt lgkmcnt(10)
    v_mfma_f32_32x32x16_bf16 v[136:151], v[32:35], v[176:179], v[136:151]
    ds_read_b64_tr_b16 v[28:29], v25 offset:17408
    ds_read_b64_tr_b16 v[30:31], v25 offset:19456
    s_waitcnt lgkmcnt(10)
    v_mfma_f32_32x32x16_bf16 v[120:135], v[36:39], v[180:183], v[120:135]
    ds_read_b64_tr_b16 v[32:33], v24 offset:20480
    ds_read_b64_tr_b16 v[34:35], v24 offset:22528
    s_waitcnt lgkmcnt(10)
    v_mfma_f32_32x32x16_bf16 v[136:151], v[40:43], v[180:183], v[136:151]
    ds_read_b64_tr_b16 v[36:37], v25 offset:20480
    ds_read_b64_tr_b16 v[38:39], v25 offset:22528
    s_waitcnt lgkmcnt(10)
    v_mfma_f32_32x32x16_bf16 v[120:135], v[44:47], v[184:187], v[120:135]
    ds_read_b64_tr_b16 v[40:41], v24 offset:21504
    ds_read_b64_tr_b16 v[42:43], v24 offset:23552
    s_waitcnt lgkmcnt(10)
    v_mfma_f32_32x32x16_bf16 v[136:151], v[48:51], v[184:187], v[136:151]
    ds_read_b64_tr_b16 v[44:45], v25 offset:21504
    ds_read_b64_tr_b16 v[46:47], v25 offset:23552
    s_waitcnt lgkmcnt(10)
    v_mfma_f32_32x32x16_bf16 v[120:135], v[52:55], v[188:191], v[120:135]
    ds_read_b64_tr_b16 v[48:49], v24 offset:24576
    ds_read_b64_tr_b16 v[50:51], v24 offset:26624
    s_waitcnt lgkmcnt(10)
    v_mfma_f32_32x32x16_bf16 v[136:151], v[28:31], v[188:191], v[136:151]
    ds_read_b64_tr_b16 v[52:53], v25 offset:24576
    ds_read_b64_tr_b16 v[54:55], v25 offset:26624
    s_waitcnt lgkmcnt(10)
    v_mfma_f32_32x32x16_bf16 v[120:135], v[32:35], v[192:195], v[120:135]
    ds_read_b64_tr_b16 v[28:29], v24 offset:25600
    ds_read_b64_tr_b16 v[30:31], v24 offset:27648
    s_waitcnt lgkmcnt(10)
    v_mfma_f32_32x32x16_bf16 v[136:151], v[36:39], v[192:195], v[136:151]
    ds_read_b64_tr_b16 v[32:33], v25 offset:25600
    ds_read_b64_tr_b16 v[34:35], v25 offset:27648
    s_waitcnt lgkmcnt(10)
    v_mfma_f32_32x32x16_bf16 v[120:135], v[40:43], v[196:199], v[120:135]
    ds_read_b64_tr_b16 v[36:37], v24 offset:28672
    ds_read_b64_tr_b16 v[38:39], v24 offset:30720
    s_waitcnt lgkmcnt(10)
    v_mfma_f32_32x32x16_bf16 v[136:151], v[44:47], v[196:199], v[136:151]
    ds_read_b64_tr_b16 v[40:41], v25 offset:28672
    ds_read_b64_tr_b16 v[42:43], v25 offset:30720
    s_waitcnt lgkmcnt(10)
    v_mfma_f32_32x32x16_bf16 v[120:135], v[48:51], v[200:203], v[120:135]
    ds_read_b64_tr_b16 v[44:45], v25 offset:29696
    ds_read_b64_tr_b16 v[46:47], v25 offset:31744
    s_waitcnt lgkmcnt(10)
    v_mfma_f32_32x32x16_bf16 v[136:151], v[52:55], v[200:203], v[136:151]
    ds_read_b64_tr_b16 v[48:49], v24 offset:29696
    ds_read_b64_tr_b16 v[50:51], v24 offset:31744
    s_waitcnt lgkmcnt(10)
    v_mfma_f32_32x32x16_bf16 v[120:135], v[28:31], v[204:207], v[120:135]
    s_waitcnt lgkmcnt(8)
    v_mfma_f32_32x32x16_bf16 v[136:151], v[32:35], v[204:207], v[136:151]
    s_waitcnt lgkmcnt(6)
    v_mfma_f32_32x32x16_bf16 v[120:135], v[36:39], v[208:211], v[120:135]
    s_waitcnt lgkmcnt(4)
    v_mfma_f32_32x32x16_bf16 v[136:151], v[40:43], v[208:211], v[136:151]
    s_waitcnt lgkmcnt(2)
    v_mfma_f32_32x32x16_bf16 v[136:151], v[44:47], v[212:215], v[136:151]
    s_waitcnt lgkmcnt(0)
    v_mfma_f32_32x32x16_bf16 v[120:135], v[48:51], v[212:215], v[120:135]
    s_lshl_b32 s96, s77, 11
    s_add_u32 s14, s96, 151552
    v_add_u32 v0, s14, v2
    v_bfe_u32 v4, v1, 2, 2
    v_lshlrev_b32 v4, 6, v4
    v_bfe_u32 v9, v1, 4, 1
    v_lshl_add_u32 v4, v9, 5, v4
    v_and_b32 v9, 3, v1
    v_lshl_add_u32 v4, v9, 3, v4
    v_lshrrev_b32 v9, 5, v1
    v_lshl_add_u32 v4, v9, 8, v4
    v_add_u32 v4, 159744, v4
    ds_read_b64_tr_b16 v[176:177], v4
    ds_read_b64_tr_b16 v[178:179], v4 offset:512
    ds_read_b64_tr_b16 v[180:181], v4 offset:1024
    ds_read_b64_tr_b16 v[182:183], v4 offset:1536
    v_cvt_pk_bf16_f32 v152, v136, v137
    v_cvt_pk_bf16_f32 v153, v138, v139
    v_cvt_pk_bf16_f32 v154, v140, v141
    v_cvt_pk_bf16_f32 v155, v142, v143
    v_cvt_pk_bf16_f32 v156, v144, v145
    v_cvt_pk_bf16_f32 v157, v146, v147
    v_cvt_pk_bf16_f32 v158, v148, v149
    v_cvt_pk_bf16_f32 v159, v150, v151
    ds_write_b128 v0, v[152:155]
    ds_write_b128 v0, v[156:159] offset:1024
    v_cvt_pk_bf16_f32 v168, v120, v121
    v_cvt_pk_bf16_f32 v169, v122, v123
    v_cvt_pk_bf16_f32 v170, v124, v125
    v_cvt_pk_bf16_f32 v171, v126, v127
    v_cvt_pk_bf16_f32 v172, v128, v129
    v_cvt_pk_bf16_f32 v173, v130, v131
    v_cvt_pk_bf16_f32 v174, v132, v133
    v_cvt_pk_bf16_f32 v175, v134, v135
    s_setprio 0
    s_branch L_JOIN
L_HELP:
    s_waitcnt vmcnt(3)
    s_barrier
    s_add_u32 s96, s84, 5
    s_and_b32 s97, s96, 15
    s_mul_i32 s98, s97, 393216
    s_add_u32 s99, s98, s85
    s_add_u32 s82, s99, 4294772736
    s_add_u32 m0, s83, 36864
    s_nop 0
    buffer_load_dwordx4 v3, s[40:43], s82 offen lds
    s_add_u32 s96, s84, 5
    s_and_b32 s97, s96, 15
    s_mul_i32 s98, s97, 393216
    s_add_u32 s99, s98, s85
    s_add_u32 s82, s99, 2048
    s_add_u32 m0, s83, 40960
    s_nop 0
    buffer_load_dwordx4 v3, s[40:43], s82 offen lds
    s_add_u32 s96, s84, 5
    s_and_b32 s97, s96, 15
    s_mul_i32 s98, s97, 393216
    s_add_u32 s99, s98, s85
    s_add_u32 s82, s99, 4294774784
    s_add_u32 m0, s83, 86016
    s_nop 0
    buffer_load_dwordx4 v3, s[40:43], s82 offen lds
    s_add_u32 s96, s84, 5
    s_and_b32 s97, s96, 15
    s_mul_i32 s98, s97, 393216
    s_add_u32 s99, s98, s85
    s_add_u32 s82, s99, 4096
    s_add_u32 m0, s83, 90112
    s_nop 0
    buffer_load_dwordx4 v3, s[40:43], s82 offen lds
    s_add_u32 s96, s84, 5
    s_and_b32 s97, s96, 15
    s_mul_i32 s98, s97, 393216
    s_add_u32 s99, s98, s85
    s_add_u32 s82, s99, 4294770688
    s_add_u32 m0, s83, 135168
    s_nop 0
    buffer_load_dwordx4 v3, s[40:43], s82 offen lds
    s_add_u32 s96, s84, 5
    s_and_b32 s97, s96, 15
    s_mul_i32 s98, s97, 393216
    s_add_u32 s82, s98, s85
    s_add_u32 m0, s83, 139264
    s_nop 0
    buffer_load_dwordx4 v3, s[40:43], s82 offen lds
    v_bfe_u32 v4, v1, 2, 2
    v_lshlrev_b32 v4, 6, v4
    v_bfe_u32 v9, v1, 4, 1
    v_lshl_add_u32 v4, v9, 5, v4
    v_and_b32 v9, 3, v1
    v_lshl_add_u32 v4, v9, 3, v4
    v_lshrrev_b32 v9, 5, v1
    v_lshl_add_u32 v4, v9, 8, v4
    v_add_u32 v4, 159744, v4
    ds_read_b64_tr_b16 v[168:169], v4
    ds_read_b64_tr_b16 v[170:171], v4 offset:512
    ds_read_b64_tr_b16 v[172:173], v4 offset:1024
    ds_read_b64_tr_b16 v[174:175], v4 offset:1536
    ds_read_b64_tr_b16 v[176:177], v4 offset:2048
    ds_read_b64_tr_b16 v[178:179], v4 offset:2560
    ds_read_b64_tr_b16 v[180:181], v4 offset:3072
    ds_read_b64_tr_b16 v[182:183], v4 offset:3584
    s_lshl_b32 s14, s77, 10
    v_and_b32 v232, 7, v1
    v_lshl_add_u32 v232, v232, 4, s14
    v_bfe_u32 v9, v1, 3, 2
    v_lshl_add_u32 v232, v9, 8, v232
    v_lshrrev_b32 v9, 5, v1
    v_lshl_add_u32 v232, v9, 7, v232
    s_and_b32 s96, s9, 1
    s_lshl1_add_u32 s18, s96, 1
    s_and_b32 s96, s8, 3
    s_lshl2_add_u32 s97, s96, s3
    s_sub_u32 s98, s97, 4
    s_lshl_b32 s82, s98, 7
    v_lshrrev_b32 v136, 3, v1
    v_lshl_add_u32 v136, v136, 1, s82
    global_load_ushort v120, v136, s[86:87] offset:0
    global_load_ushort v121, v136, s[86:87] offset:16
    global_load_ushort v122, v136, s[86:87] offset:32
    global_load_ushort v123, v136, s[86:87] offset:48
    global_load_ushort v124, v136, s[86:87] offset:64
    global_load_ushort v125, v136, s[86:87] offset:80
    global_load_ushort v126, v136, s[86:87] offset:96
    global_load_ushort v127, v136, s[86:87] offset:112
    s_and_b32 s96, s8, 3
    s_lshl2_add_u32 s97, s96, s3
    s_sub_u32 s98, s97, 4
    s_mul_i32 s99, s98, 786432
    s_lshr_b32 s96, s8, 2
    s_lshl1_add_u32 s97, s9, s96
    s_lshl_b32 s98, s97, 7
    s_add_u32 s96, s99, s98
    s_add_u32 s19, s96, 4096
    s_barrier
    s_add_u32 s96, s84, 6
    s_and_b32 s97, s96, 15
    s_mul_i32 s98, s97, 393216
    s_add_u32 s99, s98, s85
    s_add_u32 s82, s99, 4294772736
    s_add_u32 m0, s83, 4294963200
    s_nop 0
    buffer_load_dwordx4 v3, s[40:43], s82 offen lds
    s_add_u32 s96, s84, 6
    s_and_b32 s97, s96, 15
    s_mul_i32 s98, s97, 393216
    s_add_u32 s99, s98, s85
    s_add_u32 s82, s99, 2048
    s_mov_b32 m0, s83
    s_nop 0
    buffer_load_dwordx4 v3, s[40:43], s82 offen lds
    s_add_u32 s96, s84, 6
    s_and_b32 s97, s96, 15
    s_mul_i32 s98, s97, 393216
    s_add_u32 s99, s98, s85
    s_add_u32 s82, s99, 4294770688
    s_add_u32 m0, s83, 94208
    s_nop 0
    buffer_load_dwordx4 v3, s[40:43], s82 offen lds
    s_add_u32 s96, s84, 6
    s_and_b32 s97, s96, 15
    s_mul_i32 s98, s97, 393216
    s_add_u32 s82, s98, s85
    s_add_u32 m0, s83, 98304
    s_nop 0
    buffer_load_dwordx4 v3, s[40:43], s82 offen lds
    s_add_u32 s96, s84, 6
    s_and_b32 s97, s96, 15
    s_mul_i32 s98, s97, 393216
    s_add_u32 s99, s98, s85
    s_add_u32 s82, s99, 4294774784
    s_add_u32 m0, s83, 45056
    s_nop 0
    buffer_load_dwordx4 v3, s[40:43], s82 offen lds
    s_add_u32 s96, s84, 6
    s_and_b32 s97, s96, 15
    s_mul_i32 s98, s97, 393216
    s_add_u32 s99, s98, s85
    s_add_u32 s82, s99, 4096
    s_add_u32 m0, s83, 49152
    s_nop 0
    buffer_load_dwordx4 v3, s[40:43], s82 offen lds
    s_cmp_lg_u32 s18, 1
    s_cbranch_scc1 L_NM2_1_0
    s_mov_b32 s82, s19
    buffer_load_dwordx4 v[88:91], v248, s[48:51], s82 offen nt
    s_add_u32 s82, s19, 98304
    buffer_load_dwordx4 v[92:95], v248, s[48:51], s82 offen nt
    s_add_u32 s82, s19, 196608
    buffer_load_dwordx4 v[96:99], v248, s[48:51], s82 offen nt
    s_add_u32 s82, s19, 294912
    buffer_load_dwordx4 v[100:103], v248, s[48:51], s82 offen nt
    s_add_u32 s82, s19, 393216
    buffer_load_dwordx4 v[104:107], v248, s[48:51], s82 offen nt
    s_add_u32 s82, s19, 491520
    buffer_load_dwordx4 v[108:111], v248, s[48:51], s82 offen nt
    s_add_u32 s82, s19, 589824
    buffer_load_dwordx4 v[112:115], v248, s[48:51], s82 offen nt
    s_add_u32 s82, s19, 688128
    buffer_load_dwordx4 v[116:119], v248, s[48:51], s82 offen nt
L_NM2_1_0:
    s_waitcnt lgkmcnt(0)
    s_load_dword s24, s[32:33], s92 offset:512 glc
    s_load_dword s25, s[32:33], s92 offset:256 glc
    s_load_dword s26, s[32:33], s92 offset:3584 glc
    s_load_dword s27, s[32:33], s92 offset:3328 glc
    s_barrier
    s_add_u32 s96, s84, 7
    s_and_b32 s97, s96, 15
    s_mul_i32 s98, s97, 393216
    s_add_u32 s99, s98, s85
    s_add_u32 s82, s99, 4294772736
    s_add_u32 m0, s83, 4096
    s_nop 0
    buffer_load_dwordx4 v3, s[40:43], s82 offen lds
    s_add_u32 s96, s84, 7
    s_and_b32 s97, s96, 15
    s_mul_i32 s98, s97, 393216
    s_add_u32 s99, s98, s85
    s_add_u32 s82, s99, 2048
    s_add_u32 m0, s83, 8192
    s_nop 0
    buffer_load_dwordx4 v3, s[40:43], s82 offen lds
    s_add_u32 s96, s84, 7
    s_and_b32 s97, s96, 15
    s_mul_i32 s98, s97, 393216
    s_add_u32 s99, s98, s85
    s_add_u32 s82, s99, 4294770688
    s_add_u32 m0, s83, 102400
    s_nop 0
    buffer_load_dwordx4 v3, s[40:43], s82 offen lds
    s_add_u32 s96, s84, 7
    s_and_b32 s97, s96, 15
    s_mul_i32 s98, s97, 393216
    s_add_u32 s82, s98, s85
    s_add_u32 m0, s83, 106496
    s_nop 0
    buffer_load_dwordx4 v3, s[40:43], s82 offen lds
    s_add_u32 s96, s84, 7
    s_and_b32 s97, s96, 15
    s_mul_i32 s98, s97, 393216
    s_add_u32 s99, s98, s85
    s_add_u32 s82, s99, 4294774784
    s_add_u32 m0, s83, 53248
    s_nop 0
    buffer_load_dwordx4 v3, s[40:43], s82 offen lds
    s_add_u32 s96, s84, 7
    s_and_b32 s97, s96, 15
    s_mul_i32 s98, s97, 393216
    s_add_u32 s99, s98, s85
    s_add_u32 s82, s99, 4096
    s_add_u32 m0, s83, 57344
    s_nop 0
    buffer_load_dwordx4 v3, s[40:43], s82 offen lds
    s_cmp_lg_u32 s18, 2
    s_cbranch_scc1 L_NM2_2_0
    s_mov_b32 s82, s19
    buffer_load_dwordx4 v[88:91], v248, s[48:51], s82 offen nt
    s_add_u32 s82, s19, 98304
    buffer_load_dwordx4 v[92:95], v248, s[48:51], s82 offen nt
    s_add_u32 s82, s19, 196608
    buffer_load_dwordx4 v[96:99], v248, s[48:51], s82 offen nt
    s_add_u32 s82, s19, 294912
    buffer_load_dwordx4 v[100:103], v248, s[48:51], s82 offen nt
    s_add_u32 s82, s19, 393216
    buffer_load_dwordx4 v[104:107], v248, s[48:51], s82 offen nt
    s_add_u32 s82, s19, 491520
    buffer_load_dwordx4 v[108:111], v248, s[48:51], s82 offen nt
    s_add_u32 s82, s19, 589824
    buffer_load_dwordx4 v[112:115], v248, s[48:51], s82 offen nt
    s_add_u32 s82, s19, 688128
    buffer_load_dwordx4 v[116:119], v248, s[48:51], s82 offen nt
L_NM2_2_0:
    s_waitcnt vmcnt(26)
    s_barrier
    s_add_u32 s96, s84, 8
    s_and_b32 s97, s96, 15
    s_mul_i32 s98, s97, 393216
    s_add_u32 s99, s98, s85
    s_add_u32 s82, s99, 4294772736
    s_add_u32 m0, s83, 12288
    s_nop 0
    buffer_load_dwordx4 v3, s[40:43], s82 offen lds
    s_add_u32 s96, s84, 8
    s_and_b32 s97, s96, 15
    s_mul_i32 s98, s97, 393216
    s_add_u32 s99, s98, s85
    s_add_u32 s82, s99, 2048
    s_add_u32 m0, s83, 16384
    s_nop 0
    buffer_load_dwordx4 v3, s[40:43], s82 offen lds
    s_add_u32 s96, s84, 8
    s_and_b32 s97, s96, 15
    s_mul_i32 s98, s97, 393216
    s_add_u32 s99, s98, s85
    s_add_u32 s82, s99, 4294770688
    s_add_u32 m0, s83, 110592
    s_nop 0
    buffer_load_dwordx4 v3, s[40:43], s82 offen lds
    s_add_u32 s96, s84, 8
    s_and_b32 s97, s96, 15
    s_mul_i32 s98, s97, 393216
    s_add_u32 s82, s98, s85
    s_add_u32 m0, s83, 114688
    s_nop 0
    buffer_load_dwordx4 v3, s[40:43], s82 offen lds
    s_add_u32 s96, s84, 8
    s_and_b32 s97, s96, 15
    s_mul_i32 s98, s97, 393216
    s_add_u32 s99, s98, s85
    s_add_u32 s82, s99, 4294774784
    s_add_u32 m0, s83, 61440
    s_nop 0
    buffer_load_dwordx4 v3, s[40:43], s82 offen lds
    s_add_u32 s96, s84, 8
    s_and_b32 s97, s96, 15
    s_mul_i32 s98, s97, 393216
    s_add_u32 s99, s98, s85
    s_add_u32 s82, s99, 4096
    s_add_u32 m0, s83, 65536
    s_nop 0
    buffer_load_dwordx4 v3, s[40:43], s82 offen lds
    s_cmp_lg_u32 s18, 3
    s_cbranch_scc1 L_NM2_3_0
    s_mov_b32 s82, s19
    buffer_load_dwordx4 v[88:91], v248, s[48:51], s82 offen nt
    s_add_u32 s82, s19, 98304
    buffer_load_dwordx4 v[92:95], v248, s[48:51], s82 offen nt
    s_add_u32 s82, s19, 196608
    buffer_load_dwordx4 v[96:99], v248, s[48:51], s82 offen nt
    s_add_u32 s82, s19, 294912
    buffer_load_dwordx4 v[100:103], v248, s[48:51], s82 offen nt
    s_add_u32 s82, s19, 393216
    buffer_load_dwordx4 v[104:107], v248, s[48:51], s82 offen nt
    s_add_u32 s82, s19, 491520
    buffer_load_dwordx4 v[108:111], v248, s[48:51], s82 offen nt
    s_add_u32 s82, s19, 589824
    buffer_load_dwordx4 v[112:115], v248, s[48:51], s82 offen nt
    s_add_u32 s82, s19, 688128
    buffer_load_dwordx4 v[116:119], v248, s[48:51], s82 offen nt
L_NM2_3_0:
    s_waitcnt vmcnt(18)
    v_lshlrev_b32 v120, 16, v120
    v_mul_f32 v136, s7, v120
    v_exp_f32 v136, -v136
    s_nop 0
    v_add_f32 v136, 1.0, v136
    v_rcp_f32 v136, v136
    s_nop 0
    v_mul_f32 v120, v120, v136
    v_cvt_pk_bf16_f32 v120, 0, v120
    v_lshlrev_b32 v121, 16, v121
    v_mul_f32 v137, s7, v121
    v_exp_f32 v137, -v137
    s_nop 0
    v_add_f32 v137, 1.0, v137
    v_rcp_f32 v137, v137
    s_nop 0
    v_mul_f32 v121, v121, v137
    v_cvt_pk_bf16_f32 v121, 0, v121
    v_lshlrev_b32 v122, 16, v122
    v_mul_f32 v136, s7, v122
    v_exp_f32 v136, -v136
    s_nop 0
    v_add_f32 v136, 1.0, v136
    v_rcp_f32 v136, v136
    s_nop 0
    v_mul_f32 v122, v122, v136
    v_cvt_pk_bf16_f32 v122, 0, v122
    v_lshlrev_b32 v123, 16, v123
    v_mul_f32 v137, s7, v123
    v_exp_f32 v137, -v137
    s_nop 0
    v_add_f32 v137, 1.0, v137
    v_rcp_f32 v137, v137
    s_nop 0
    v_mul_f32 v123, v123, v137
    v_cvt_pk_bf16_f32 v123, 0, v123
    v_lshlrev_b32 v124, 16, v124
    v_mul_f32 v136, s7, v124
    v_exp_f32 v136, -v136
    s_nop 0
    v_add_f32 v136, 1.0, v136
    v_rcp_f32 v136, v136
    s_nop 0
    v_mul_f32 v124, v124, v136
    v_cvt_pk_bf16_f32 v124, 0, v124
    v_lshlrev_b32 v125, 16, v125
    v_mul_f32 v137, s7, v125
    v_exp_f32 v137, -v137
    s_nop 0
    v_add_f32 v137, 1.0, v137
    v_rcp_f32 v137, v137
    s_nop 0
    v_mul_f32 v125, v125, v137
    v_cvt_pk_bf16_f32 v125, 0, v125
    v_lshlrev_b32 v126, 16, v126
    v_mul_f32 v136, s7, v126
    v_exp_f32 v136, -v136
    s_nop 0
    v_add_f32 v136, 1.0, v136
    v_rcp_f32 v136, v136
    s_nop 0
    v_mul_f32 v126, v126, v136
    v_cvt_pk_bf16_f32 v126, 0, v126
    v_lshlrev_b32 v127, 16, v127
    v_mul_f32 v137, s7, v127
    v_exp_f32 v137, -v137
    s_nop 0
    v_add_f32 v137, 1.0, v137
    v_rcp_f32 v137, v137
    s_nop 0
    v_mul_f32 v127, v127, v137
    v_cvt_pk_bf16_f32 v127, 0, v127
    s_waitcnt lgkmcnt(0)
    s_load_dword s24, s[32:33], s92 offset:1024 glc
    s_load_dword s25, s[32:33], s92 offset:768 glc
    s_load_dword s26, s[32:33], s92 offset:1536 glc
    s_load_dword s27, s[32:33], s92 offset:1280 glc
    s_barrier
    s_add_u32 s96, s84, 9
    s_and_b32 s97, s96, 15
    s_mul_i32 s98, s97, 393216
    s_add_u32 s99, s98, s85
    s_add_u32 s82, s99, 4294772736
    s_add_u32 m0, s83, 20480
    s_nop 0
    buffer_load_dwordx4 v3, s[40:43], s82 offen lds
    s_add_u32 s96, s84, 9
    s_and_b32 s97, s96, 15
    s_mul_i32 s98, s97, 393216
    s_add_u32 s99, s98, s85
    s_add_u32 s82, s99, 2048
    s_add_u32 m0, s83, 24576
    s_nop 0
    buffer_load_dwordx4 v3, s[40:43], s82 offen lds
    s_add_u32 s96, s84, 9
    s_and_b32 s97, s96, 15
    s_mul_i32 s98, s97, 393216
    s_add_u32 s99, s98, s85
    s_add_u32 s82, s99, 4294770688
    s_add_u32 m0, s83, 118784
    s_nop 0
    buffer_load_dwordx4 v3, s[40:43], s82 offen lds
    s_add_u32 s96, s84, 9
    s_and_b32 s97, s96, 15
    s_mul_i32 s98, s97, 393216
    s_add_u32 s82, s98, s85
    s_add_u32 m0, s83, 122880
L_PAD5:
    s_cbranch_execz L_RET5
    s_nop 0
    buffer_load_dwordx4 v3, s[40:43], s82 offen lds
    s_add_u32 s96, s84, 9
    s_and_b32 s97, s96, 15
    s_mul_i32 s98, s97, 393216
    s_add_u32 s99, s98, s85
    s_add_u32 s82, s99, 4294774784
    s_add_u32 m0, s83, 69632
    s_nop 0
    buffer_load_dwordx4 v3, s[40:43], s82 offen lds
    s_add_u32 s96, s84, 9
    s_and_b32 s97, s96, 15
    s_mul_i32 s98, s97, 393216
    s_add_u32 s99, s98, s85
    s_add_u32 s82, s99, 4096
    s_add_u32 m0, s83, 73728
    s_nop 0
    buffer_load_dwordx4 v3, s[40:43], s82 offen lds
    s_waitcnt vmcnt(22)
    s_waitcnt vmcnt(20)
    s_waitcnt vmcnt(18)
    s_barrier
    s_add_u32 s96, s84, 10
    s_and_b32 s97, s96, 15
    s_mul_i32 s98, s97, 393216
    s_add_u32 s99, s98, s85
    s_add_u32 s82, s99, 4294772736
    s_add_u32 m0, s83, 28672
    s_nop 0
    buffer_load_dwordx4 v3, s[40:43], s82 offen lds
    s_add_u32 s96, s84, 10
    s_and_b32 s97, s96, 15
    s_mul_i32 s98, s97, 393216
    s_add_u32 s99, s98, s85
    s_add_u32 s82, s99, 2048
    s_add_u32 m0, s83, 32768
    s_nop 0
    buffer_load_dwordx4 v3, s[40:43], s82 offen lds
    s_add_u32 s96, s84, 10
    s_and_b32 s97, s96, 15
    s_mul_i32 s98, s97, 393216
    s_add_u32 s99, s98, s85
    s_add_u32 s82, s99, 4294774784
    s_add_u32 m0, s83, 77824
    s_nop 0
    buffer_load_dwordx4 v3, s[40:43], s82 offen lds
    s_add_u32 s96, s84, 10
    s_and_b32 s97, s96, 15
    s_mul_i32 s98, s97, 393216
    s_add_u32 s99, s98, s85
    s_add_u32 s82, s99, 4096
    s_add_u32 m0, s83, 81920
    s_nop 0
    buffer_load_dwordx4 v3, s[40:43], s82 offen lds
    s_waitcnt vmcnt(8)
    v_lshlrev_b32 v136, 16, v88
    v_and_b32 v137, s6, v88
    v_mul_f32 v128, v136, v120
    v_mul_f32 v129, v137, v120
    v_lshlrev_b32 v138, 16, v89
    v_and_b32 v139, s6, v89
    v_mul_f32 v130, v138, v120
    v_mul_f32 v131, v139, v120
    v_lshlrev_b32 v136, 16, v90
    v_and_b32 v137, s6, v90
    v_mul_f32 v132, v136, v120
    v_mul_f32 v133, v137, v120
    v_lshlrev_b32 v138, 16, v91
    v_and_b32 v139, s6, v91
    v_mul_f32 v134, v138, v120
    v_mul_f32 v135, v139, v120
    v_lshlrev_b32 v136, 16, v92
    v_and_b32 v137, s6, v92
    v_fmac_f32 v128, v136, v121
    v_fmac_f32 v129, v137, v121
    v_lshlrev_b32 v138, 16, v93
    v_and_b32 v139, s6, v93
    v_fmac_f32 v130, v138, v121
    v_fmac_f32 v131, v139, v121
    v_lshlrev_b32 v136, 16, v94
    v_and_b32 v137, s6, v94
    v_fmac_f32 v132, v136, v121
    v_fmac_f32 v133, v137, v121
    v_lshlrev_b32 v138, 16, v95
    v_and_b32 v139, s6, v95
    v_fmac_f32 v134, v138, v121
    v_fmac_f32 v135, v139, v121
    v_lshlrev_b32 v136, 16, v96
    v_and_b32 v137, s6, v96
    v_fmac_f32 v128, v136, v122
    v_fmac_f32 v129, v137, v122
    v_lshlrev_b32 v138, 16, v97
    v_and_b32 v139, s6, v97
    v_fmac_f32 v130, v138, v122
    v_fmac_f32 v131, v139, v122
    v_lshlrev_b32 v136, 16, v98
    v_and_b32 v137, s6, v98
    v_fmac_f32 v132, v136, v122
    v_fmac_f32 v133, v137, v122
    v_lshlrev_b32 v138, 16, v99
    v_and_b32 v139, s6, v99
    v_fmac_f32 v134, v138, v122
    v_fmac_f32 v135, v139, v122
    s_waitcnt lgkmcnt(0)
    s_load_dword s24, s[32:33], s92 offset:2560 glc
    s_load_dword s25, s[32:33], s92 offset:2304 glc
    s_load_dword s26, s[32:33], s92 offset:3072 glc
    s_load_dword s27, s[32:33], s92 offset:2816 glc
    s_barrier
    s_add_u32 s96, s84, 11
    s_and_b32 s97, s96, 15
    s_mul_i32 s98, s97, 393216
    s_add_u32 s99, s98, s85
    s_add_u32 s82, s99, 4294772736
    s_add_u32 m0, s83, 36864
    s_nop 0
    buffer_load_dwordx4 v3, s[40:43], s82 offen lds
    s_add_u32 s96, s84, 11
    s_and_b32 s97, s96, 15
    s_mul_i32 s98, s97, 393216
    s_add_u32 s99, s98, s85
    s_add_u32 s82, s99, 2048
    s_add_u32 m0, s83, 40960
    s_nop 0
    buffer_load_dwordx4 v3, s[40:43], s82 offen lds
    s_add_u32 s96, s84, 11
    s_and_b32 s97, s96, 15
    s_mul_i32 s98, s97, 393216
    s_add_u32 s99, s98, s85
    s_add_u32 s82, s99, 4294774784
    s_add_u32 m0, s83, 86016
    s_nop 0
    buffer_load_dwordx4 v3, s[40:43], s82 offen lds
    s_add_u32 s96, s84, 11
    s_and_b32 s97, s96, 15
    s_mul_i32 s98, s97, 393216
    s_add_u32 s99, s98, s85
    s_add_u32 s82, s99, 4096
    s_add_u32 m0, s83, 90112
    s_nop 0
    buffer_load_dwordx4 v3, s[40:43], s82 offen lds
    v_lshlrev_b32 v136, 16, v100
    v_and_b32 v137, s6, v100
    v_fmac_f32 v128, v136, v123
    v_fmac_f32 v129, v137, v123
    v_lshlrev_b32 v138, 16, v101
    v_and_b32 v139, s6, v101
    v_fmac_f32 v130, v138, v123
    v_fmac_f32 v131, v139, v123
    v_lshlrev_b32 v136, 16, v102
    v_and_b32 v137, s6, v102
    v_fmac_f32 v132, v136, v123
    v_fmac_f32 v133, v137, v123
    v_lshlrev_b32 v138, 16, v103
    v_and_b32 v139, s6, v103
    v_fmac_f32 v134, v138, v123
    v_fmac_f32 v135, v139, v123
    v_lshlrev_b32 v136, 16, v104
    v_and_b32 v137, s6, v104
    v_fmac_f32 v128, v136, v124
    v_fmac_f32 v129, v137, v124
    v_lshlrev_b32 v138, 16, v105
    v_and_b32 v139, s6, v105
    v_fmac_f32 v130, v138, v124
    v_fmac_f32 v131, v139, v124
    v_lshlrev_b32 v136, 16, v106
    v_and_b32 v137, s6, v106
    v_fmac_f32 v132, v136, v124
    v_fmac_f32 v133, v137, v124
    v_lshlrev_b32 v138, 16, v107
    v_and_b32 v139, s6, v107
    v_fmac_f32 v134, v138, v124
    v_fmac_f32 v135, v139, v124
    v_lshlrev_b32 v136, 16, v108
    v_and_b32 v137, s6, v108
    v_fmac_f32 v128, v136, v125
    v_fmac_f32 v129, v137, v125
    v_lshlrev_b32 v138, 16, v109
    v_and_b32 v139, s6, v109
    v_fmac_f32 v130, v138, v125
    v_fmac_f32 v131, v139, v125
    v_lshlrev_b32 v136, 16, v110
    v_and_b32 v137, s6, v110
    v_fmac_f32 v132, v136, v125
    v_fmac_f32 v133, v137, v125
    v_lshlrev_b32 v138, 16, v111
    v_and_b32 v139, s6, v111
    v_fmac_f32 v134, v138, v125
    v_fmac_f32 v135, v139, v125
    s_barrier
    s_add_u32 s96, s84, 12
    s_and_b32 s97, s96, 15
    s_mul_i32 s98, s97, 393216
    s_add_u32 s99, s98, s85
    s_add_u32 s82, s99, 4294772736
    s_add_u32 m0, s83, 4294963200
    s_nop 0
    buffer_load_dwordx4 v3, s[40:43], s82 offen lds
    s_add_u32 s96, s84, 12
    s_and_b32 s97, s96, 15
    s_mul_i32 s98, s97, 393216
    s_add_u32 s99, s98, s85
    s_add_u32 s82, s99, 2048
    s_mov_b32 m0, s83
    s_nop 0
    buffer_load_dwordx4 v3, s[40:43], s82 offen lds
    s_add_u32 s96, s84, 12
    s_and_b32 s97, s96, 15
    s_mul_i32 s98, s97, 393216
    s_add_u32 s99, s98, s85
    s_add_u32 s82, s99, 4294774784
    s_add_u32 m0, s83, 45056
    s_nop 0
    buffer_load_dwordx4 v3, s[40:43], s82 offen lds
    s_add_u32 s96, s84, 12
    s_and_b32 s97, s96, 15
    s_mul_i32 s98, s97, 393216
    s_add_u32 s99, s98, s85
    s_add_u32 s82, s99, 4096
    s_add_u32 m0, s83, 49152
    s_nop 0
    buffer_load_dwordx4 v3, s[40:43], s82 offen lds
    v_lshlrev_b32 v136, 16, v112
    v_and_b32 v137, s6, v112
    v_fmac_f32 v128, v136, v126
    v_fmac_f32 v129, v137, v126
    v_lshlrev_b32 v138, 16, v113
    v_and_b32 v139, s6, v113
    v_fmac_f32 v130, v138, v126
    v_fmac_f32 v131, v139, v126
    v_lshlrev_b32 v136, 16, v114
    v_and_b32 v137, s6, v114
    v_fmac_f32 v132, v136, v126
    v_fmac_f32 v133, v137, v126
    v_lshlrev_b32 v138, 16, v115
    v_and_b32 v139, s6, v115
    v_fmac_f32 v134, v138, v126
    v_fmac_f32 v135, v139, v126
    v_lshlrev_b32 v136, 16, v116
    v_and_b32 v137, s6, v116
    v_fmac_f32 v128, v136, v127
    v_fmac_f32 v129, v137, v127
    v_lshlrev_b32 v138, 16, v117
    v_and_b32 v139, s6, v117
    v_fmac_f32 v130, v138, v127
    v_fmac_f32 v131, v139, v127
    v_lshlrev_b32 v136, 16, v118
    v_and_b32 v137, s6, v118
    v_fmac_f32 v132, v136, v127
    v_fmac_f32 v133, v137, v127
    v_lshlrev_b32 v138, 16, v119
    v_and_b32 v139, s6, v119
    v_fmac_f32 v134, v138, v127
    v_fmac_f32 v135, v139, v127
    v_permlane32_swap_b32 v128, v132
    v_permlane32_swap_b32 v129, v133
    v_permlane32_swap_b32 v130, v134
    v_permlane32_swap_b32 v131, v135
    v_add_f32 v128, v128, v132
    v_add_f32 v129, v129, v133
    v_add_f32 v130, v130, v134
    v_add_f32 v131, v131, v135
    s_nop 0
    v_permlane16_swap_b32 v128, v130
    v_permlane16_swap_b32 v129, v131
    v_add_f32 v128, v128, v130
    v_add_f32 v129, v129, v131
    s_nop 0
    v_add_f32_dpp v128, v128, v128 row_ror:8 row_mask:0xf bank_mask:0xf
    v_add_f32_dpp v129, v129, v129 row_ror:8 row_mask:0xf bank_mask:0xf
    s_nop 1
    v_mov_b32_dpp v128, v129 quad_perm:[0,1,2,3] row_mask:0xf bank_mask:0xc
    ds_write_b32 v252, v128 offset:9984
    s_waitcnt lgkmcnt(0)
    s_barrier
    s_add_u32 s96, s84, 13
    s_and_b32 s97, s96, 15
    s_mul_i32 s98, s97, 393216
    s_add_u32 s99, s98, s85
    s_add_u32 s82, s99, 4294772736
    s_add_u32 m0, s83, 4096
    s_nop 0
    buffer_load_dwordx4 v3, s[40:43], s82 offen lds
    s_add_u32 s96, s84, 13
    s_and_b32 s97, s96, 15
    s_mul_i32 s98, s97, 393216
    s_add_u32 s99, s98, s85
    s_add_u32 s82, s99, 2048
    s_add_u32 m0, s83, 8192
    s_nop 0
    buffer_load_dwordx4 v3, s[40:43], s82 offen lds
    s_add_u32 s96, s84, 13
    s_and_b32 s97, s96, 15
    s_mul_i32 s98, s97, 393216
    s_add_u32 s99, s98, s85
    s_add_u32 s82, s99, 4294774784
    s_add_u32 m0, s83, 53248
    s_nop 0
    buffer_load_dwordx4 v3, s[40:43], s82 offen lds
    s_add_u32 s96, s84, 13
    s_and_b32 s97, s96, 15
    s_mul_i32 s98, s97, 393216
    s_add_u32 s99, s98, s85
    s_add_u32 s82, s99, 4096
    s_add_u32 m0, s83, 57344
    s_nop 0
    buffer_load_dwordx4 v3, s[40:43], s82 offen lds
    s_cmp_lg_u32 s3, 4
    s_cbranch_scc1 L_M2F
    ds_read_b128 v[128:131], v251 offset:10000
    s_lshr_b32 s96, s8, 2
    s_lshl1_add_u32 s97, s9, s96
    s_and_b32 s98, s8, 3
    s_lshl2_add_u32 s99, s97, s98
    s_lshl_b32 s96, s99, 9
    s_add_u32 s13, s96, 131072
    s_waitcnt lgkmcnt(0)
    v_add_f32 v128, v128, v129
    v_add_f32 v130, v130, v131
    v_mov_b32 v129, s4
    v_add_f32 v128, v128, v130
    buffer_store_dwordx2 v[128:129], v250, s[32:35], s13 offen sc1
L_M2F:
    s_lshl_b32 s96, s74, 13
    s_sub_u32 s97, s3, 4
    s_lshl_b32 s98, s97, 8
    s_add_u32 s99, s96, s98
    s_add_u32 s13, s99, 20971520
    s_waitcnt lgkmcnt(0)
    s_load_dword s24, s[32:33], s13 offset:1276 glc
    s_load_dword s25, s[32:33], s13 offset:3324 glc
    s_load_dword s26, s[32:33], s13 offset:5372 glc
    s_load_dword s27, s[32:33], s13 offset:7420 glc
    s_waitcnt vmcnt(18)
    s_waitcnt vmcnt(16)
    s_barrier
    s_add_u32 s96, s84, 14
    s_and_b32 s97, s96, 15
    s_mul_i32 s98, s97, 393216
    s_add_u32 s99, s98, s85
    s_add_u32 s82, s99, 4294772736
    s_add_u32 m0, s83, 12288
    s_nop 0
    buffer_load_dwordx4 v3, s[40:43], s82 offen lds
    s_add_u32 s96, s84, 14
    s_and_b32 s97, s96, 15
    s_mul_i32 s98, s97, 393216
    s_add_u32 s99, s98, s85
    s_add_u32 s82, s99, 2048
    s_add_u32 m0, s83, 16384
    s_nop 0
    buffer_load_dwordx4 v3, s[40:43], s82 offen lds
    s_waitcnt vmcnt(16)
    s_waitcnt vmcnt(12)
    s_barrier
    s_add_u32 s96, s84, 15
    s_and_b32 s97, s96, 15
    s_mul_i32 s98, s97, 393216
    s_add_u32 s99, s98, s85
    s_add_u32 s82, s99, 4294772736
    s_add_u32 m0, s83, 20480
    s_nop 0
    buffer_load_dwordx4 v3, s[40:43], s82 offen lds
    s_add_u32 s96, s84, 15
    s_and_b32 s97, s96, 15
    s_mul_i32 s98, s97, 393216
    s_add_u32 s99, s98, s85
    s_add_u32 s82, s99, 2048
    s_add_u32 m0, s83, 24576
    s_nop 0
    buffer_load_dwordx4 v3, s[40:43], s82 offen lds
    s_waitcnt vmcnt(10)
    s_waitcnt vmcnt(6)
    s_waitcnt vmcnt(2)
    s_barrier
    s_add_u32 s96, s84, 14
    s_and_b32 s97, s96, 15
    s_mul_i32 s98, s97, 393216
    s_add_u32 s99, s98, s85
    s_add_u32 s82, s99, 4294774784
    s_add_u32 m0, s83, 61440
    s_nop 0
    buffer_load_dwordx4 v3, s[40:43], s82 offen lds
    s_add_u32 s96, s84, 14
    s_and_b32 s97, s96, 15
    s_mul_i32 s98, s97, 393216
    s_add_u32 s99, s98, s85
    s_add_u32 s82, s99, 4096
    s_add_u32 m0, s83, 65536
    s_nop 0
    buffer_load_dwordx4 v3, s[40:43], s82 offen lds
    s_add_u32 s96, s84, 15
    s_and_b32 s97, s96, 15
    s_mul_i32 s98, s97, 393216
    s_add_u32 s99, s98, s85
    s_add_u32 s82, s99, 4294774784
    s_add_u32 m0, s83, 69632
    s_nop 0
    buffer_load_dwordx4 v3, s[40:43], s82 offen lds
    s_add_u32 s96, s84, 15
    s_and_b32 s97, s96, 15
    s_mul_i32 s98, s97, 393216
    s_add_u32 s99, s98, s85
    s_add_u32 s82, s99, 4096
    s_add_u32 m0, s83, 73728
    s_nop 0
    buffer_load_dwordx4 v3, s[40:43], s82 offen lds
    s_waitcnt vmcnt(4)
    s_barrier
    s_add_u32 s96, s84, 10
    s_and_b32 s97, s96, 15
    s_mul_i32 s98, s97, 393216
    s_add_u32 s99, s98, s85
    s_add_u32 s82, s99, 4294770688
    s_add_u32 m0, s83, 126976
    s_nop 0
    buffer_load_dwordx4 v3, s[40:43], s82 offen lds
    s_add_u32 s96, s84, 10
    s_and_b32 s97, s96, 15
    s_mul_i32 s98, s97, 393216
    s_add_u32 s82, s98, s85
    s_add_u32 m0, s83, 131072
    s_nop 0
    buffer_load_dwordx4 v3, s[40:43], s82 offen lds
    s_add_u32 s96, s84, 11
    s_and_b32 s97, s96, 15
    s_mul_i32 s98, s97, 393216
    s_add_u32 s99, s98, s85
    s_add_u32 s82, s99, 4294770688
    s_add_u32 m0, s83, 135168
    s_nop 0
    buffer_load_dwordx4 v3, s[40:43], s82 offen lds
    s_add_u32 s96, s84, 11
    s_and_b32 s97, s96, 15
    s_mul_i32 s98, s97, 393216
    s_add_u32 s82, s98, s85
    s_add_u32 m0, s83, 139264
    s_nop 0
    buffer_load_dwordx4 v3, s[40:43], s82 offen lds
    s_waitcnt lgkmcnt(0)
    s_barrier
    s_add_u32 s96, s84, 12
    s_and_b32 s97, s96, 15
    s_mul_i32 s98, s97, 393216
    s_add_u32 s99, s98, s85
    s_add_u32 s82, s99, 4294770688
    s_add_u32 m0, s83, 94208
    s_nop 0
    buffer_load_dwordx4 v3, s[40:43], s82 offen lds
    s_add_u32 s96, s84, 12
    s_and_b32 s97, s96, 15
    s_mul_i32 s98, s97, 393216
    s_add_u32 s82, s98, s85
    s_add_u32 m0, s83, 98304
    s_nop 0
    buffer_load_dwordx4 v3, s[40:43], s82 offen lds
    s_add_u32 s96, s84, 13
    s_and_b32 s97, s96, 15
    s_mul_i32 s98, s97, 393216
    s_add_u32 s99, s98, s85
    s_add_u32 s82, s99, 4294770688
    s_add_u32 m0, s83, 102400
    s_nop 0
    buffer_load_dwordx4 v3, s[40:43], s82 offen lds
    s_add_u32 s96, s84, 13
    s_and_b32 s97, s96, 15
    s_mul_i32 s98, s97, 393216
    s_add_u32 s82, s98, s85
    s_add_u32 m0, s83, 106496
    s_nop 0
    buffer_load_dwordx4 v3, s[40:43], s82 offen lds
    s_setprio 3
    ds_read_b128 v[152:155], v0
    ds_read_b128 v[156:159], v0 offset:1024
    v_subrev_u32 v0, 118784, v0
    s_waitcnt lgkmcnt(1)
    v_mfma_f32_32x32x16_bf16 v[184:199], v[168:171], v[152:155], 0
    s_waitcnt lgkmcnt(0)
    v_mfma_f32_32x32x16_bf16 v[184:199], v[172:175], v[156:159], v[184:199]
    s_setprio 0
    s_nop 10
    v_cvt_pk_bf16_f32 v184, 0, v184
    v_cvt_pk_bf16_f32 v185, 0, v185
    v_cvt_pk_bf16_f32 v186, 0, v186
    v_cvt_pk_bf16_f32 v187, 0, v187
    v_cvt_pk_bf16_f32 v188, 0, v188
    v_cvt_pk_bf16_f32 v189, 0, v189
    v_cvt_pk_bf16_f32 v190, 0, v190
    v_cvt_pk_bf16_f32 v191, 0, v191
    v_cvt_pk_bf16_f32 v192, 0, v192
    v_cvt_pk_bf16_f32 v193, 0, v193
    v_cvt_pk_bf16_f32 v194, 0, v194
    v_cvt_pk_bf16_f32 v195, 0, v195
    v_cvt_pk_bf16_f32 v196, 0, v196
    v_cvt_pk_bf16_f32 v197, 0, v197
    v_cvt_pk_bf16_f32 v198, 0, v198
    v_cvt_pk_bf16_f32 v199, 0, v199
    v_max3_f32 v4, v184, v185, v186
    v_min3_f32 v5, v184, v185, v186
    v_max3_f32 v4, v4, v187, v188
    v_min3_f32 v5, v5, v187, v188
    v_max3_f32 v4, v4, v189, v190
    v_min3_f32 v5, v5, v189, v190
    v_max3_f32 v4, v4, v191, v192
    v_min3_f32 v5, v5, v191, v192
    v_max3_f32 v4, v4, v193, v194
    v_min3_f32 v5, v5, v193, v194
    v_max3_f32 v4, v4, v195, v196
    v_min3_f32 v5, v5, v195, v196
    v_max3_f32 v4, v4, v197, v198
    v_min3_f32 v5, v5, v197, v198
    v_max_f32 v6, v4, v199
    v_min_f32 v7, v5, v199
    v_max_f32 v4, v4, v199
    v_min_f32 v5, v5, v199
    s_nop 0
    v_permlane32_swap_b32 v4, v6
    v_permlane32_swap_b32 v5, v7
    v_max_f32 v4, v4, v6
    v_min_f32 v5, v5, v7
    v_mul_f32_e64 v4, v4, s7
    v_mul_f32_e64 v5, v5, s7
    v_fma_f32 v216, v184, s7, -v4
    v_fma_f32 v217, v185, s7, -v4
    v_fma_f32 v184, -v184, s7, v5
    v_fma_f32 v185, -v185, s7, v5
    v_fma_f32 v218, v186, s7, -v4
    v_fma_f32 v219, v187, s7, -v4
    v_fma_f32 v186, -v186, s7, v5
    v_fma_f32 v187, -v187, s7, v5
    s_waitcnt vmcnt(10)
    s_waitcnt vmcnt(8)
    s_waitcnt vmcnt(6)
    s_barrier
    s_add_u32 s96, s84, 14
    s_and_b32 s97, s96, 15
    s_mul_i32 s98, s97, 393216
    s_add_u32 s99, s98, s85
    s_add_u32 s82, s99, 4294770688
    s_add_u32 m0, s83, 110592
    s_nop 0
    buffer_load_dwordx4 v3, s[40:43], s82 offen lds
    s_add_u32 s96, s84, 14
    s_and_b32 s97, s96, 15
    s_mul_i32 s98, s97, 393216
    s_add_u32 s82, s98, s85
    s_add_u32 m0, s83, 114688
    s_nop 0
    buffer_load_dwordx4 v3, s[40:43], s82 offen lds
    s_add_u32 s96, s84, 15
    s_and_b32 s97, s96, 15
    s_mul_i32 s98, s97, 393216
    s_add_u32 s99, s98, s85
    s_add_u32 s82, s99, 4294770688
    s_add_u32 m0, s83, 118784
    s_nop 0
    buffer_load_dwordx4 v3, s[40:43], s82 offen lds
    s_add_u32 s96, s84, 15
    s_and_b32 s97, s96, 15
    s_mul_i32 s98, s97, 393216
    s_add_u32 s82, s98, s85
    s_add_u32 m0, s83, 122880
    s_nop 0
    buffer_load_dwordx4 v3, s[40:43], s82 offen lds
    s_setprio 3
    ds_read_b128 v[152:155], v0
    ds_read_b128 v[156:159], v0 offset:1024
    s_waitcnt lgkmcnt(1)
    v_mfma_f32_32x32x16_bf16 v[200:215], v[176:179], v[152:155], 0
    s_waitcnt lgkmcnt(0)
    v_mfma_f32_32x32x16_bf16 v[200:215], v[180:183], v[156:159], v[200:215]
    s_setprio 0
    v_fma_f32 v220, v188, s7, -v4
    v_fma_f32 v221, v189, s7, -v4
    v_fma_f32 v188, -v188, s7, v5
    v_fma_f32 v189, -v189, s7, v5
    v_fma_f32 v222, v190, s7, -v4
    s_mov_b32 s82, s80
    buffer_load_dwordx4 v[56:59], v27, s[52:55], s82 offen nt
    v_fma_f32 v223, v191, s7, -v4
    v_fma_f32 v190, -v190, s7, v5
    v_fma_f32 v191, -v191, s7, v5
    v_fma_f32 v224, v192, s7, -v4
    v_fma_f32 v225, v193, s7, -v4
    v_fma_f32 v192, -v192, s7, v5
    v_fma_f32 v193, -v193, s7, v5
    v_fma_f32 v226, v194, s7, -v4
    v_fma_f32 v227, v195, s7, -v4
    v_fma_f32 v194, -v194, s7, v5
    v_fma_f32 v195, -v195, s7, v5
    v_fma_f32 v228, v196, s7, -v4
    v_fma_f32 v229, v197, s7, -v4
    v_fma_f32 v196, -v196, s7, v5
    v_fma_f32 v197, -v197, s7, v5
    v_fma_f32 v230, v198, s7, -v4
    v_fma_f32 v231, v199, s7, -v4
    v_fma_f32 v198, -v198, s7, v5
    v_fma_f32 v199, -v199, s7, v5
    v_exp_f32 v216, v216
    v_exp_f32 v184, v184
    v_exp_f32 v217, v217
    v_exp_f32 v185, v185
    v_exp_f32 v218, v218
    v_exp_f32 v186, v186
    v_exp_f32 v219, v219
    v_exp_f32 v187, v187
    v_exp_f32 v220, v220
    v_exp_f32 v188, v188
    v_exp_f32 v221, v221
    v_exp_f32 v189, v189
    v_exp_f32 v222, v222
    v_exp_f32 v190, v190
    v_exp_f32 v223, v223
    v_exp_f32 v191, v191
    v_exp_f32 v224, v224
    v_exp_f32 v192, v192
    v_exp_f32 v225, v225
    v_exp_f32 v193, v193
    v_exp_f32 v226, v226
    s_add_u32 s82, s80, 4294049792
    buffer_load_dwordx4 v[60:63], v27, s[52:55], s82 offen nt
    v_exp_f32 v194, v194
    v_exp_f32 v227, v227
    v_exp_f32 v195, v195
    v_exp_f32 v228, v228
    v_exp_f32 v196, v196
    v_exp_f32 v229, v229
    v_exp_f32 v197, v197
    v_exp_f32 v230, v230
    v_exp_f32 v198, v198
    v_exp_f32 v231, v231
    v_exp_f32 v199, v199
    v_add_f32 v8, v216, v218
    v_add_f32 v9, v217, v219
    v_add_f32 v10, v184, v186
    v_add_f32 v11, v185, v187
    v_add_f32 v8, v8, v220
    v_add_f32 v9, v9, v221
    v_add_f32 v10, v10, v188
    v_add_f32 v11, v11, v189
    v_add_f32 v8, v8, v222
    v_add_f32 v9, v9, v223
    v_add_f32 v10, v10, v190
    v_add_f32 v11, v11, v191
    v_add_f32 v8, v8, v224
    v_add_f32 v9, v9, v225
    v_add_f32 v10, v10, v192
    v_add_f32 v11, v11, v193
    v_add_f32 v8, v8, v226
    v_add_f32 v9, v9, v227
    v_add_f32 v10, v10, v194
    v_add_f32 v11, v11, v195
    v_add_f32 v8, v8, v228
    v_add_f32 v9, v9, v229
    v_add_f32 v10, v10, v196
    v_add_f32 v11, v11, v197
    v_add_f32 v8, v8, v230
    v_add_f32 v9, v9, v231
    v_add_f32 v10, v10, v198
    v_add_f32 v11, v11, v199
    v_add_f32 v6, v8, v9
    s_add_u32 s82, s80, 57344
    buffer_load_dwordx4 v[64:67], v27, s[52:55], s82 offen nt
    v_add_f32 v7, v10, v11
    v_add_f32 v4, v8, v9
    v_add_f32 v5, v10, v11
    s_nop 0
    v_permlane32_swap_b32 v4, v6
    v_permlane32_swap_b32 v5, v7
    v_add_f32 v4, v4, v6
    v_add_f32 v5, v5, v7
    v_rcp_f32 v4, v4
    v_rcp_f32 v5, v5
    v_mul_f32 v216, v216, v4
    v_mul_f32 v217, v217, v4
    v_mul_f32 v184, v184, v5
    v_mul_f32 v185, v185, v5
    v_mul_f32 v218, v218, v4
    v_mul_f32 v219, v219, v4
    v_mul_f32 v186, v186, v5
    v_mul_f32 v187, v187, v5
    v_mul_f32 v220, v220, v4
    v_mul_f32 v221, v221, v4
    v_mul_f32 v188, v188, v5
    v_mul_f32 v189, v189, v5
    v_mul_f32 v222, v222, v4
    v_mul_f32 v223, v223, v4
    v_mul_f32 v190, v190, v5
    v_mul_f32 v191, v191, v5
    v_mul_f32 v224, v224, v4
    v_mul_f32 v225, v225, v4
    v_mul_f32 v192, v192, v5
    v_mul_f32 v193, v193, v5
    v_mul_f32 v226, v226, v4
    v_mul_f32 v227, v227, v4
    v_mul_f32 v194, v194, v5
    v_mul_f32 v195, v195, v5
    v_mul_f32 v228, v228, v4
    v_mul_f32 v229, v229, v4
    v_mul_f32 v196, v196, v5
    v_mul_f32 v197, v197, v5
    v_mul_f32 v230, v230, v4
    v_mul_f32 v231, v231, v4
    v_mul_f32 v198, v198, v5
    s_add_u32 s82, s80, 4294107136
    buffer_load_dwordx4 v[68:71], v27, s[52:55], s82 offen nt
    v_mul_f32 v199, v199, v5
    v_cvt_pk_bf16_f32 v216, v216, v217
    v_cvt_pk_bf16_f32 v217, v218, v219
    v_cvt_pk_bf16_f32 v218, v220, v221
    v_cvt_pk_bf16_f32 v219, v222, v223
    v_cvt_pk_bf16_f32 v220, v224, v225
    v_cvt_pk_bf16_f32 v221, v226, v227
    v_cvt_pk_bf16_f32 v222, v228, v229
    v_cvt_pk_bf16_f32 v223, v230, v231
    ds_write_b128 v232, v[216:219]
    v_cvt_pk_bf16_f32 v224, v184, v185
    v_cvt_pk_bf16_f32 v225, v186, v187
    v_cvt_pk_bf16_f32 v226, v188, v189
    v_cvt_pk_bf16_f32 v227, v190, v191
    ds_write_b128 v232, v[220:223] offset:4096
    ds_write_b128 v232, v[224:227] offset:8192
    v_cvt_pk_bf16_f32 v228, v192, v193
    v_cvt_pk_bf16_f32 v229, v194, v195
    v_cvt_pk_bf16_f32 v230, v196, v197
    v_cvt_pk_bf16_f32 v231, v198, v199
    ds_write_b128 v232, v[228:231] offset:12288
    s_waitcnt vmcnt(12)
    s_waitcnt vmcnt(10)
    s_waitcnt vmcnt(8)
    s_waitcnt vmcnt(6)
    s_waitcnt vmcnt(4)
    s_barrier
    v_cvt_pk_bf16_f32 v200, 0, v200
    v_cvt_pk_bf16_f32 v201, 0, v201
    v_cvt_pk_bf16_f32 v202, 0, v202
    v_cvt_pk_bf16_f32 v203, 0, v203
    s_xor_b32 s96, s95, 786432
    s_add_u32 s97, s96, s90
    s_sub_u32 s82, s97, 65536
    s_add_u32 m0, s83, 45056
    s_nop 0
    buffer_load_dwordx4 v26, s[44:47], s82 offen lds
    v_cvt_pk_bf16_f32 v204, 0, v204
    v_cvt_pk_bf16_f32 v205, 0, v205
    v_cvt_pk_bf16_f32 v206, 0, v206
    v_cvt_pk_bf16_f32 v207, 0, v207
    v_cvt_pk_bf16_f32 v208, 0, v208
    v_cvt_pk_bf16_f32 v209, 0, v209
L_PAD6:
    s_cbranch_execz L_RET6
    v_cvt_pk_bf16_f32 v210, 0, v210
    v_cvt_pk_bf16_f32 v211, 0, v211
    v_cvt_pk_bf16_f32 v212, 0, v212
    v_cvt_pk_bf16_f32 v213, 0, v213
    v_cvt_pk_bf16_f32 v214, 0, v214
    v_cvt_pk_bf16_f32 v215, 0, v215
    v_max3_f32 v4, v200, v201, v202
    v_min3_f32 v5, v200, v201, v202
    s_xor_b32 s96, s95, 786432
    s_add_u32 s82, s96, s90
    s_add_u32 m0, s83, 49152
    s_nop 0
    buffer_load_dwordx4 v26, s[44:47], s82 offen lds
    v_max3_f32 v4, v4, v203, v204
    v_min3_f32 v5, v5, v203, v204
    v_max3_f32 v4, v4, v205, v206
    v_min3_f32 v5, v5, v205, v206
    v_max3_f32 v4, v4, v207, v208
    v_min3_f32 v5, v5, v207, v208
    v_max3_f32 v4, v4, v209, v210
    v_min3_f32 v5, v5, v209, v210
    v_max3_f32 v4, v4, v211, v212
    v_min3_f32 v5, v5, v211, v212
    v_max3_f32 v4, v4, v213, v214
    v_min3_f32 v5, v5, v213, v214
    v_max_f32 v6, v4, v215
    v_min_f32 v7, v5, v215
    s_xor_b32 s96, s95, 917504
    s_add_u32 s97, s96, s90
    s_sub_u32 s82, s97, 65536
    s_add_u32 m0, s83, 53248
    s_nop 0
    buffer_load_dwordx4 v26, s[44:47], s82 offen lds
    v_max_f32 v4, v4, v215
    s_waitcnt lgkmcnt(0)
    v_min_f32 v5, v5, v215
    v_permlane32_swap_b32 v4, v6
    s_nop 0
    v_permlane32_swap_b32 v5, v7
    v_max_f32 v4, v4, v6
    v_min_f32 v5, v5, v7
    v_mul_f32_e64 v4, v4, s7
    v_mul_f32_e64 v5, v5, s7
    v_fma_f32 v216, v200, s7, -v4
    v_fma_f32 v217, v201, s7, -v4
    v_fma_f32 v200, -v200, s7, v5
    v_fma_f32 v201, -v201, s7, v5
    v_fma_f32 v218, v202, s7, -v4
    s_xor_b32 s96, s95, 917504
    s_add_u32 s82, s96, s90
    s_add_u32 m0, s83, 57344
    s_nop 0
    buffer_load_dwordx4 v26, s[44:47], s82 offen lds
    v_fma_f32 v219, v203, s7, -v4
    v_fma_f32 v202, -v202, s7, v5
    v_fma_f32 v203, -v203, s7, v5
    v_fma_f32 v220, v204, s7, -v4
    v_fma_f32 v221, v205, s7, -v4
    v_fma_f32 v204, -v204, s7, v5
    v_fma_f32 v205, -v205, s7, v5
    v_fma_f32 v222, v206, s7, -v4
    v_fma_f32 v223, v207, s7, -v4
    v_fma_f32 v206, -v206, s7, v5
    v_fma_f32 v207, -v207, s7, v5
    v_fma_f32 v224, v208, s7, -v4
    v_fma_f32 v225, v209, s7, -v4
    v_fma_f32 v208, -v208, s7, v5
    s_xor_b32 s96, s95, 1048576
    s_add_u32 s97, s96, s90
    s_sub_u32 s82, s97, 65536
    s_add_u32 m0, s83, 61440
    s_nop 0
    buffer_load_dwordx4 v26, s[44:47], s82 offen lds
    v_fma_f32 v209, -v209, s7, v5
    v_fma_f32 v226, v210, s7, -v4
    v_fma_f32 v227, v211, s7, -v4
    v_fma_f32 v210, -v210, s7, v5
    v_fma_f32 v211, -v211, s7, v5
    v_fma_f32 v228, v212, s7, -v4
    v_fma_f32 v229, v213, s7, -v4
    v_fma_f32 v212, -v212, s7, v5
    v_fma_f32 v213, -v213, s7, v5
    v_fma_f32 v230, v214, s7, -v4
    v_fma_f32 v231, v215, s7, -v4
    v_fma_f32 v214, -v214, s7, v5
    v_fma_f32 v215, -v215, s7, v5
    v_exp_f32 v216, v216
    s_xor_b32 s96, s95, 1048576
    s_add_u32 s82, s96, s90
    s_add_u32 m0, s83, 65536
    s_nop 0
    buffer_load_dwordx4 v26, s[44:47], s82 offen lds
    v_exp_f32 v200, v200
    v_exp_f32 v217, v217
    v_exp_f32 v201, v201
    v_exp_f32 v218, v218
    v_exp_f32 v202, v202
    v_exp_f32 v219, v219
    v_exp_f32 v203, v203
    v_exp_f32 v220, v220
    v_exp_f32 v204, v204
    v_exp_f32 v221, v221
    v_exp_f32 v205, v205
    v_exp_f32 v222, v222
    v_exp_f32 v206, v206
    v_exp_f32 v223, v223
    s_xor_b32 s96, s95, 1179648
    s_add_u32 s97, s96, s90
    s_sub_u32 s82, s97, 65536
    s_add_u32 m0, s83, 69632
    s_nop 0
    buffer_load_dwordx4 v26, s[44:47], s82 offen lds
    v_exp_f32 v207, v207
    v_exp_f32 v224, v224
    v_exp_f32 v208, v208
    v_exp_f32 v225, v225
    v_exp_f32 v209, v209
    v_exp_f32 v226, v226
    v_exp_f32 v210, v210
    v_exp_f32 v227, v227
    v_exp_f32 v211, v211
    v_exp_f32 v228, v228
    v_exp_f32 v212, v212
    v_exp_f32 v229, v229
    v_exp_f32 v213, v213
    v_exp_f32 v230, v230
    s_xor_b32 s96, s95, 1179648
    s_add_u32 s82, s96, s90
    s_add_u32 m0, s83, 73728
    s_nop 0
    buffer_load_dwordx4 v26, s[44:47], s82 offen lds
    v_exp_f32 v214, v214
    v_exp_f32 v231, v231
    v_exp_f32 v215, v215
    v_add_f32 v8, v216, v218
    v_add_f32 v9, v217, v219
    v_add_f32 v10, v200, v202
    v_add_f32 v11, v201, v203
    v_add_f32 v8, v8, v220
    v_add_f32 v9, v9, v221
    v_add_f32 v10, v10, v204
    v_add_f32 v11, v11, v205
    v_add_f32 v8, v8, v222
    v_add_f32 v9, v9, v223
    v_add_f32 v10, v10, v206
    s_add_u32 s82, s80, 114688
    buffer_load_dwordx4 v[72:75], v27, s[52:55], s82 offen nt
    v_add_f32 v11, v11, v207
    v_add_f32 v8, v8, v224
    v_add_f32 v9, v9, v225
    v_add_f32 v10, v10, v208
    v_add_f32 v11, v11, v209
    v_add_f32 v8, v8, v226
    v_add_f32 v9, v9, v227
    v_add_f32 v10, v10, v210
    v_add_f32 v11, v11, v211
    v_add_f32 v8, v8, v228
    v_add_f32 v9, v9, v229
    v_add_f32 v10, v10, v212
    v_add_f32 v11, v11, v213
    v_add_f32 v8, v8, v230
    s_add_u32 s82, s80, 4294164480
    buffer_load_dwordx4 v[76:79], v27, s[52:55], s82 offen nt
    v_add_f32 v9, v9, v231
    v_add_f32 v10, v10, v214
    v_add_f32 v11, v11, v215
    v_add_f32 v6, v8, v9
    v_add_f32 v7, v10, v11
    v_add_f32 v4, v8, v9
    v_add_f32 v5, v10, v11
    s_nop 0
    v_permlane32_swap_b32 v4, v6
    v_permlane32_swap_b32 v5, v7
    v_add_f32 v4, v4, v6
    v_add_f32 v5, v5, v7
    v_rcp_f32 v4, v4
    v_rcp_f32 v5, v5
    v_mul_f32 v216, v216, v4
    s_add_u32 s82, s80, 172032
    buffer_load_dwordx4 v[80:83], v27, s[52:55], s82 offen nt
    v_mul_f32 v217, v217, v4
    v_mul_f32 v200, v200, v5
    v_mul_f32 v201, v201, v5
    v_mul_f32 v218, v218, v4
    v_mul_f32 v219, v219, v4
    v_mul_f32 v202, v202, v5
    v_mul_f32 v203, v203, v5
    v_mul_f32 v220, v220, v4
    v_mul_f32 v221, v221, v4
    v_mul_f32 v204, v204, v5
    v_mul_f32 v205, v205, v5
    v_mul_f32 v222, v222, v4
    v_mul_f32 v223, v223, v4
    v_mul_f32 v206, v206, v5
    s_add_u32 s82, s80, 4294221824
    buffer_load_dwordx4 v[84:87], v27, s[52:55], s82 offen nt
    v_mul_f32 v207, v207, v5
    v_mul_f32 v224, v224, v4
    v_mul_f32 v225, v225, v4
    v_mul_f32 v208, v208, v5
    v_mul_f32 v209, v209, v5
    v_mul_f32 v226, v226, v4
    v_mul_f32 v227, v227, v4
    v_mul_f32 v210, v210, v5
    v_mul_f32 v211, v211, v5
    v_mul_f32 v228, v228, v4
    v_mul_f32 v229, v229, v4
    v_mul_f32 v212, v212, v5
    v_mul_f32 v213, v213, v5
    v_mul_f32 v230, v230, v4
    s_xor_b32 s96, s95, 1310720
    s_add_u32 s97, s96, s90
    s_sub_u32 s82, s97, 65536
    s_add_u32 m0, s83, 77824
    s_nop 0
    buffer_load_dwordx4 v26, s[44:47], s82 offen lds
    v_mul_f32 v231, v231, v4
    v_mul_f32 v214, v214, v5
    v_mul_f32 v215, v215, v5
    v_cvt_pk_bf16_f32 v216, v216, v217
    v_cvt_pk_bf16_f32 v217, v218, v219
    v_cvt_pk_bf16_f32 v218, v220, v221
    v_cvt_pk_bf16_f32 v219, v222, v223
    v_cvt_pk_bf16_f32 v220, v224, v225
    v_cvt_pk_bf16_f32 v221, v226, v227
    v_cvt_pk_bf16_f32 v222, v228, v229
    v_cvt_pk_bf16_f32 v223, v230, v231
    ds_write_b128 v232, v[216:219] offset:16384
    v_cvt_pk_bf16_f32 v224, v200, v201
    v_cvt_pk_bf16_f32 v225, v202, v203
    s_xor_b32 s96, s95, 1310720
    s_add_u32 s82, s96, s90
    s_add_u32 m0, s83, 81920
    s_nop 0
    buffer_load_dwordx4 v26, s[44:47], s82 offen lds
    v_cvt_pk_bf16_f32 v226, v204, v205
    v_cvt_pk_bf16_f32 v227, v206, v207
    ds_write_b128 v232, v[220:223] offset:20480
    ds_write_b128 v232, v[224:227] offset:24576
    v_cvt_pk_bf16_f32 v228, v208, v209
    v_cvt_pk_bf16_f32 v229, v210, v211
    v_cvt_pk_bf16_f32 v230, v212, v213
    v_cvt_pk_bf16_f32 v231, v214, v215
    ds_write_b128 v232, v[228:231] offset:28672
    s_xor_b32 s96, s95, 1441792
    s_add_u32 s97, s96, s90
    s_sub_u32 s82, s97, 65536
    s_add_u32 m0, s83, 86016
    s_nop 0
    buffer_load_dwordx4 v26, s[44:47], s82 offen lds
    s_xor_b32 s96, s95, 1441792
    s_add_u32 s82, s96, s90
    s_add_u32 m0, s83, 90112
    s_nop 0
    buffer_load_dwordx4 v26, s[44:47], s82 offen lds
    s_lshl_b32 s96, s77, 11
    s_add_u32 s14, s96, 151552
    v_add_u32 v0, s14, v2
    s_setprio 0
L_JOIN:
    v_and_b32 v45, 1, v1
    v_lshlrev_b32 v45, 3, v45
    v_bfe_u32 v9, v1, 2, 2
    v_lshl_add_u32 v45, v9, 4, v45
    v_bfe_u32 v9, v1, 4, 1
    v_lshl_add_u32 v45, v9, 6, v45
    v_bfe_u32 v9, v1, 1, 1
    v_lshl_add_u32 v45, v9, 7, v45
    v_lshrrev_b32 v9, 5, v1
    v_lshl_add_u32 v45, v9, 8, v45
    s_lshl_b32 s13, s3, 12
    v_add_u32 v44, s13, v45
    s_lshl_b32 s96, s76, 13
    s_add_u32 s13, s96, 32768
    v_add_u32 v45, s13, v45
    v_mov_b32 v244, 0x3f803f80
    v_mov_b32 v245, 0x3f803f80
    v_mov_b32 v246, 0x3f803f80
    v_mov_b32 v247, 0x3f803f80
    s_lshl3_add_u32 s96, s11, s3
    s_lshl_b32 s97, s96, 5
    s_add_u32 s98, s97, s10
    s_lshl_b32 s99, s98, 10
    s_add_u32 s13, s99, 25165824
    s_add_u32 s15, s13, 16384
    s_lshl3_add_u32 s96, s11, s3
    s_lshl_b32 s97, s96, 10
    s_add_u32 s16, s97, 21495808
    s_lshl_b32 s96, s10, 6
    s_add_u32 s14, s96, s16
    s_waitcnt lgkmcnt(0)
    s_barrier
    ds_read_b64_tr_b16 v[184:185], v44
    ds_read_b64_tr_b16 v[186:187], v44 offset:512
    ds_read_b64_tr_b16 v[200:201], v45
    ds_read_b64_tr_b16 v[202:203], v45 offset:512
    ds_read_b64_tr_b16 v[204:205], v45 offset:1024
    ds_read_b64_tr_b16 v[206:207], v45 offset:1536
    ds_read_b64_tr_b16 v[188:189], v44 offset:1024
    ds_read_b64_tr_b16 v[190:191], v44 offset:1536
    ds_read_b64_tr_b16 v[208:209], v45 offset:2048
    ds_read_b64_tr_b16 v[210:211], v45 offset:2560
    ds_read_b64_tr_b16 v[212:213], v45 offset:3072
    ds_read_b64_tr_b16 v[214:215], v45 offset:3584
    ds_read_b64_tr_b16 v[192:193], v44 offset:2048
    ds_read_b64_tr_b16 v[194:195], v44 offset:2560
    ds_read_b64_tr_b16 v[216:217], v45 offset:4096
    ds_read_b64_tr_b16 v[218:219], v45 offset:4608
    ds_read_b64_tr_b16 v[220:221], v45 offset:5120
    ds_read_b64_tr_b16 v[222:223], v45 offset:5632
    s_waitcnt lgkmcnt(12)
    v_mfma_f32_16x16x32_bf16 v[232:235], v[184:187], v[200:203], 0
    v_mfma_f32_16x16x32_bf16 v[236:239], v[184:187], v[204:207], 0
    v_mfma_f32_16x16x32_bf16 v[240:243], v[184:187], v[244:247], 0
    ds_read_b64_tr_b16 v[196:197], v44 offset:3072
    ds_read_b64_tr_b16 v[198:199], v44 offset:3584
    ds_read_b64_tr_b16 v[224:225], v45 offset:6144
    ds_read_b64_tr_b16 v[226:227], v45 offset:6656
    ds_read_b64_tr_b16 v[228:229], v45 offset:7168
    ds_read_b64_tr_b16 v[230:231], v45 offset:7680
    s_waitcnt lgkmcnt(12)
    v_mfma_f32_16x16x32_bf16 v[232:235], v[188:191], v[208:211], v[232:235]
    v_mfma_f32_16x16x32_bf16 v[236:239], v[188:191], v[212:215], v[236:239]
    v_mfma_f32_16x16x32_bf16 v[240:243], v[188:191], v[244:247], v[240:243]
    s_waitcnt lgkmcnt(6)
    v_mfma_f32_16x16x32_bf16 v[232:235], v[192:195], v[216:219], v[232:235]
    v_mfma_f32_16x16x32_bf16 v[236:239], v[192:195], v[220:223], v[236:239]
    v_mfma_f32_16x16x32_bf16 v[240:243], v[192:195], v[244:247], v[240:243]
    s_waitcnt lgkmcnt(0)
    v_mfma_f32_16x16x32_bf16 v[232:235], v[196:199], v[224:227], v[232:235]
    v_mfma_f32_16x16x32_bf16 v[236:239], v[196:199], v[228:231], v[236:239]
    v_mfma_f32_16x16x32_bf16 v[240:243], v[196:199], v[244:247], v[240:243]
    s_cmp_lt_u32 s3, 4
    s_cbranch_scc1 L_NOQX
    ds_read_b128 v[168:171], v0
    ds_read_b128 v[172:175], v0 offset:1024
L_NOQX:
    s_nop 3
    buffer_store_dwordx4 v[232:235], v2, s[32:35], s13 offen sc1
    buffer_store_dwordx4 v[236:239], v2, s[32:35], s15 offen sc1
    s_mov_b32 exec_lo, 0x00010001
    s_mov_b32 exec_hi, 0x00010001
    buffer_store_dwordx4 v[240:243], v1, s[32:35], s14 offen sc1
    s_mov_b64 exec, -1
    s_waitcnt lgkmcnt(0)
    v_mfma_f32_32x32x16_bf16 v[120:135], v[176:179], v[168:171], 0
    v_mfma_f32_32x32x16_bf16 v[120:135], v[180:183], v[172:175], v[120:135]
    v_and_b32 v46, 7, v1
    v_lshlrev_b32 v46, 17, v46
    v_bfe_u32 v9, v1, 3, 1
    v_lshl_add_u32 v46, v9, 14, v46
    s_and_b32 s96, s10, 1
    s_and_b32 s97, s2, 27
    s_lshl_b32 s98, s97, 12
    s_lshr_b32 s99, s10, 1
    s_lshl_b32 s97, s99, 6
    s_add_u32 s99, s98, s97
    s_lshl2_add_u32 s98, s96, s99
    s_add_u32 s97, s98, 1048576
    s_add_u32 s17, s97, 512
    v_lshrrev_b32 v47, 3, v1
    v_lshlrev_b32 v47, 10, v47
    v_and_b32 v9, 7, v1
    v_lshl_add_u32 v47, v9, 4, v47
    v_and_b32 v48, 7, v1
    v_lshlrev_b32 v48, 4, v48
    v_lshrrev_b32 v9, 5, v1
    v_lshl_add_u32 v48, v9, 3, v48
    v_cvt_pk_bf16_f32 v120, 0, v120
    v_cvt_pk_bf16_f32 v121, 0, v121
    v_cvt_pk_bf16_f32 v122, 0, v122
    v_cvt_pk_bf16_f32 v123, 0, v123
    v_cvt_pk_bf16_f32 v124, 0, v124
    v_cvt_pk_bf16_f32 v125, 0, v125
    v_cvt_pk_bf16_f32 v126, 0, v126
    v_cvt_pk_bf16_f32 v127, 0, v127
    v_cvt_pk_bf16_f32 v128, 0, v128
    v_cvt_pk_bf16_f32 v129, 0, v129
    v_cvt_pk_bf16_f32 v130, 0, v130
    v_cvt_pk_bf16_f32 v131, 0, v131
    v_cvt_pk_bf16_f32 v132, 0, v132
    v_cvt_pk_bf16_f32 v133, 0, v133
    v_cvt_pk_bf16_f32 v134, 0, v134
    v_cvt_pk_bf16_f32 v135, 0, v135
    v_max3_f32 v4, v120, v121, v122
    v_min3_f32 v5, v120, v121, v122
    v_max3_f32 v4, v4, v123, v124
    v_min3_f32 v5, v5, v123, v124
    v_max3_f32 v4, v4, v125, v126
    v_min3_f32 v5, v5, v125, v126
    v_max3_f32 v4, v4, v127, v128
    v_min3_f32 v5, v5, v127, v128
    v_max3_f32 v4, v4, v129, v130
    v_min3_f32 v5, v5, v129, v130
    v_max3_f32 v4, v4, v131, v132
    v_min3_f32 v5, v5, v131, v132
    v_max3_f32 v4, v4, v133, v134
    v_min3_f32 v5, v5, v133, v134
    v_max_f32 v6, v4, v135
    v_min_f32 v7, v5, v135
    v_max_f32 v4, v4, v135
    v_min_f32 v5, v5, v135
    s_nop 0
    v_permlane32_swap_b32 v4, v6
    v_permlane32_swap_b32 v5, v7
    v_max_f32 v4, v4, v6
    v_min_f32 v5, v5, v7
    v_pk_mul_f32 v[4:5], v[4:5], s[6:7] op_sel:[0,1]
    v_pk_fma_f32 v[136:137], v[120:121], s[6:7], v[4:5] op_sel:[0,1,0] op_sel_hi:[1,1,0] neg_lo:[0,0,1] neg_hi:[0,0,1]
    v_pk_fma_f32 v[120:121], v[120:121], s[6:7], v[4:5] op_sel:[0,1,1] neg_lo:[1,0,0] neg_hi:[1,0,0]
    v_pk_fma_f32 v[138:139], v[122:123], s[6:7], v[4:5] op_sel:[0,1,0] op_sel_hi:[1,1,0] neg_lo:[0,0,1] neg_hi:[0,0,1]
    v_pk_fma_f32 v[122:123], v[122:123], s[6:7], v[4:5] op_sel:[0,1,1] neg_lo:[1,0,0] neg_hi:[1,0,0]
    v_pk_fma_f32 v[140:141], v[124:125], s[6:7], v[4:5] op_sel:[0,1,0] op_sel_hi:[1,1,0] neg_lo:[0,0,1] neg_hi:[0,0,1]
    v_pk_fma_f32 v[124:125], v[124:125], s[6:7], v[4:5] op_sel:[0,1,1] neg_lo:[1,0,0] neg_hi:[1,0,0]
    v_pk_fma_f32 v[142:143], v[126:127], s[6:7], v[4:5] op_sel:[0,1,0] op_sel_hi:[1,1,0] neg_lo:[0,0,1] neg_hi:[0,0,1]
    v_pk_fma_f32 v[126:127], v[126:127], s[6:7], v[4:5] op_sel:[0,1,1] neg_lo:[1,0,0] neg_hi:[1,0,0]
    v_pk_fma_f32 v[144:145], v[128:129], s[6:7], v[4:5] op_sel:[0,1,0] op_sel_hi:[1,1,0] neg_lo:[0,0,1] neg_hi:[0,0,1]
    v_pk_fma_f32 v[128:129], v[128:129], s[6:7], v[4:5] op_sel:[0,1,1] neg_lo:[1,0,0] neg_hi:[1,0,0]
    v_pk_fma_f32 v[146:147], v[130:131], s[6:7], v[4:5] op_sel:[0,1,0] op_sel_hi:[1,1,0] neg_lo:[0,0,1] neg_hi:[0,0,1]
    v_pk_fma_f32 v[130:131], v[130:131], s[6:7], v[4:5] op_sel:[0,1,1] neg_lo:[1,0,0] neg_hi:[1,0,0]
    v_pk_fma_f32 v[148:149], v[132:133], s[6:7], v[4:5] op_sel:[0,1,0] op_sel_hi:[1,1,0] neg_lo:[0,0,1] neg_hi:[0,0,1]
    v_pk_fma_f32 v[132:133], v[132:133], s[6:7], v[4:5] op_sel:[0,1,1] neg_lo:[1,0,0] neg_hi:[1,0,0]
    v_pk_fma_f32 v[150:151], v[134:135], s[6:7], v[4:5] op_sel:[0,1,0] op_sel_hi:[1,1,0] neg_lo:[0,0,1] neg_hi:[0,0,1]
    v_pk_fma_f32 v[134:135], v[134:135], s[6:7], v[4:5] op_sel:[0,1,1] neg_lo:[1,0,0] neg_hi:[1,0,0]
    v_exp_f32 v136, v136
    v_exp_f32 v120, v120
    v_exp_f32 v137, v137
    v_exp_f32 v121, v121
    v_exp_f32 v138, v138
    v_exp_f32 v122, v122
    v_exp_f32 v139, v139
    v_exp_f32 v123, v123
    v_exp_f32 v140, v140
    v_exp_f32 v124, v124
    v_exp_f32 v141, v141
    v_exp_f32 v125, v125
    v_exp_f32 v142, v142
    v_exp_f32 v126, v126
    v_exp_f32 v143, v143
    v_exp_f32 v127, v127
    s_waitcnt vmcnt(0)
    s_barrier
    s_cmp_lg_u32 s3, 0
    s_cbranch_scc1 L_PC
    v_mov_b32 v45, s4
    s_mov_b32 exec_hi, 0
    s_mov_b32 exec_lo, 65535
    buffer_store_dword v45, v46, s[32:35], s17 offen sc1
    s_mov_b64 exec, -1
L_PC:
    s_xor_b32 s96, s95, 1572864
    s_add_u32 s82, s96, s90
    s_add_u32 m0, s83, 98304
    s_nop 0
    buffer_load_dwordx4 v26, s[44:47], s82 offen lds
    v_exp_f32 v144, v144
    v_exp_f32 v128, v128
    v_exp_f32 v145, v145
    v_exp_f32 v129, v129
    v_exp_f32 v146, v146
    v_exp_f32 v130, v130
    v_exp_f32 v147, v147
    v_exp_f32 v131, v131
    s_xor_b32 s96, s95, 1703936
    s_add_u32 s82, s96, s90
    s_add_u32 m0, s83, 106496
    s_nop 0
    buffer_load_dwordx4 v26, s[44:47], s82 offen lds
    v_exp_f32 v148, v148
    v_exp_f32 v132, v132
    v_exp_f32 v149, v149
    v_exp_f32 v133, v133
    v_exp_f32 v150, v150
    v_exp_f32 v134, v134
    v_exp_f32 v151, v151
    v_exp_f32 v135, v135
    s_lshl4_add_u32 s96, s11, s10
    s_lshl_b32 s97, s96, 14
    s_lshl_b32 s98, s3, 7
    s_add_u32 s99, s97, s98
    s_add_u32 s13, s99, 25165824
    s_add_u32 s14, s13, 8192
    s_lshl4_add_u32 s96, s11, s10
    s_lshl_b32 s97, s96, 10
    s_lshl_b32 s98, s3, 7
    s_add_u32 s99, s97, s98
    s_add_u32 s15, s99, 29360128
    s_add_u32 s17, s17, 3072
    s_load_dwordx2 s[24:25], s[32:33], s92 offset:512 glc
    s_xor_b32 s96, s95, 1835008
    s_add_u32 s82, s96, s90
    s_add_u32 m0, s83, 114688
    s_nop 0
    buffer_load_dwordx4 v26, s[44:47], s82 offen lds
    v_pk_add_f32 v[8:9], v[136:137], v[138:139]
    v_pk_add_f32 v[10:11], v[120:121], v[122:123]
    v_pk_add_f32 v[8:9], v[8:9], v[140:141]
    v_pk_add_f32 v[10:11], v[10:11], v[124:125]
    v_pk_add_f32 v[8:9], v[8:9], v[142:143]
    v_pk_add_f32 v[10:11], v[10:11], v[126:127]
    v_pk_add_f32 v[8:9], v[8:9], v[144:145]
    v_pk_add_f32 v[10:11], v[10:11], v[128:129]
    v_pk_add_f32 v[8:9], v[8:9], v[146:147]
    v_pk_add_f32 v[10:11], v[10:11], v[130:131]
    v_pk_add_f32 v[8:9], v[8:9], v[148:149]
    v_pk_add_f32 v[10:11], v[10:11], v[132:133]
    v_pk_add_f32 v[8:9], v[8:9], v[150:151]
    v_pk_add_f32 v[10:11], v[10:11], v[134:135]
    s_xor_b32 s96, s95, 1966080
    s_add_u32 s82, s96, s90
    s_add_u32 m0, s83, 122880
    s_nop 0
    buffer_load_dwordx4 v26, s[44:47], s82 offen lds
    v_add_f32 v6, v8, v9
    v_add_f32 v7, v10, v11
    v_add_f32 v4, v8, v9
    v_add_f32 v5, v10, v11
    s_nop 0
    v_permlane32_swap_b32 v4, v6
    v_permlane32_swap_b32 v5, v7
    v_pk_add_f32 v[4:5], v[4:5], v[6:7]
    v_rcp_f32 v4, v4
    v_rcp_f32 v5, v5
    s_nop 0
    v_pk_mul_f32 v[136:137], v[136:137], v[4:5] op_sel_hi:[1,0]
    v_pk_mul_f32 v[120:121], v[120:121], v[4:5] op_sel:[0,1]
    v_pk_mul_f32 v[138:139], v[138:139], v[4:5] op_sel_hi:[1,0]
    v_pk_mul_f32 v[122:123], v[122:123], v[4:5] op_sel:[0,1]
    v_pk_mul_f32 v[140:141], v[140:141], v[4:5] op_sel_hi:[1,0]
    s_add_u32 s82, s95, s90
    s_mov_b32 m0, s83
    s_nop 0
    buffer_load_dwordx4 v26, s[44:47], s82 offen lds
    v_pk_mul_f32 v[124:125], v[124:125], v[4:5] op_sel:[0,1]
    v_pk_mul_f32 v[142:143], v[142:143], v[4:5] op_sel_hi:[1,0]
    v_pk_mul_f32 v[126:127], v[126:127], v[4:5] op_sel:[0,1]
    v_pk_mul_f32 v[144:145], v[144:145], v[4:5] op_sel_hi:[1,0]
    v_pk_mul_f32 v[128:129], v[128:129], v[4:5] op_sel:[0,1]
    v_pk_mul_f32 v[146:147], v[146:147], v[4:5] op_sel_hi:[1,0]
    v_pk_mul_f32 v[130:131], v[130:131], v[4:5] op_sel:[0,1]
    v_pk_mul_f32 v[148:149], v[148:149], v[4:5] op_sel_hi:[1,0]
    v_pk_mul_f32 v[132:133], v[132:133], v[4:5] op_sel:[0,1]
    v_pk_mul_f32 v[150:151], v[150:151], v[4:5] op_sel_hi:[1,0]
    v_pk_mul_f32 v[134:135], v[134:135], v[4:5] op_sel:[0,1]
    v_cvt_pk_bf16_f32 v152, v136, v137
    v_cvt_pk_bf16_f32 v153, v138, v139
    v_cvt_pk_bf16_f32 v154, v140, v141
    s_xor_b32 s96, s95, 131072
    s_add_u32 s82, s96, s90
    s_add_u32 m0, s83, 8192
    s_nop 0
    buffer_load_dwordx4 v26, s[44:47], s82 offen lds
    v_cvt_pk_bf16_f32 v155, v142, v143
    v_cvt_pk_bf16_f32 v156, v144, v145
    v_cvt_pk_bf16_f32 v157, v146, v147
    v_cvt_pk_bf16_f32 v158, v148, v149
    v_cvt_pk_bf16_f32 v159, v150, v151
    v_cvt_pk_bf16_f32 v160, v120, v121
    v_cvt_pk_bf16_f32 v161, v122, v123
    v_cvt_pk_bf16_f32 v162, v124, v125
    v_cvt_pk_bf16_f32 v163, v126, v127
    v_cvt_pk_bf16_f32 v164, v128, v129
    v_cvt_pk_bf16_f32 v165, v130, v131
    v_cvt_pk_bf16_f32 v166, v132, v133
    v_cvt_pk_bf16_f32 v167, v134, v135
    s_branch SCHK_17
SPOLL_16:
    s_load_dwordx2 s[24:25], s[32:33], s92 offset:512 glc
SCHK_17:
    s_add_u32 s5, s5, 1
    s_cmp_ge_u32 s5, 200000
    s_waitcnt lgkmcnt(0)
    s_cbranch_scc1 SDONE_18
    s_cmp_lg_u32 s24, s4
    s_cbranch_scc1 SPOLL_16
    s_cmp_lg_u32 s25, s4
    s_cbranch_scc1 SPOLL_16
SDONE_18:
    s_barrier
    buffer_load_dwordx4 v[184:187], v47, s[32:35], s13 offen sc1
    buffer_load_dwordx4 v[188:191], v47, s[32:35], s14 offen sc1
    buffer_load_dwordx4 v[192:195], v2, s[32:35], s16 offen sc1
    s_lshl_b32 s96, s3, 5
    s_add_u32 s14, s96, 155648
    v_and_b32 v6, 3, v1
    v_lshl_add_u32 v6, v6, 3, s14
    v_lshrrev_b32 v9, 5, v1
    v_lshl_add_u32 v6, v9, 2, v6
    s_lshl_b32 s96, s3, 10
    s_add_u32 s14, s96, 147456
    v_and_b32 v5, 15, v1
    v_lshl_add_u32 v5, v5, 4, s14
    v_lshrrev_b32 v9, 5, v1
    v_lshl_add_u32 v5, v9, 9, v5
    v_bfe_u32 v9, v1, 4, 1
    v_lshl_add_u32 v5, v9, 3, v5
    s_lshl_b32 s96, s76, 7
    s_add_u32 s14, s96, 155648
    v_lshrrev_b32 v7, 5, v1
    v_lshl_add_u32 v7, v7, 4, s14
    s_lshl_b32 s96, s76, 12
    s_add_u32 s14, s96, 147456
    v_add_u32 v44, s14, v2
    s_waitcnt vmcnt(1)
    v_pk_add_f32 v[184:185], v[184:185], v[188:189]
    v_pk_add_f32 v[186:187], v[186:187], v[190:191]
    s_nop 1
    v_permlane32_swap_b32 v184, v186
    v_permlane32_swap_b32 v185, v187
    v_pk_add_f32 v[184:185], v[184:185], v[186:187]
    s_nop 1
    v_add_f32_dpp v184, v184, v184 row_ror:8 row_mask:0xf bank_mask:0xf
    v_add_f32_dpp v185, v185, v185 row_ror:8 row_mask:0xf bank_mask:0xf
    v_mov_b32 v186, v184
    v_mov_b32 v187, v185
    s_nop 0
    v_permlane16_swap_b32 v184, v186
    v_permlane16_swap_b32 v185, v187
    v_pk_add_f32 v[184:185], v[184:185], v[186:187]
    v_cvt_pk_bf16_f32 v184, v184, v185
    v_mov_b32 v185, s4
    s_mov_b32 exec_lo, 0xff
    s_mov_b32 exec_hi, 0xff
    buffer_store_dwordx2 v[184:185], v48, s[32:35], s15 offen sc1
    s_mov_b64 exec, -1
    s_barrier
    s_cmp_lg_u32 s3, 0
    s_cbranch_scc1 L_PC2
    v_mov_b32 v45, s4
    s_mov_b32 exec_hi, 0
    s_mov_b32 exec_lo, 65535
    buffer_store_dword v45, v46, s[32:35], s17 offen sc1
    s_mov_b64 exec, -1
L_PC2:
    s_waitcnt vmcnt(1)
    s_xor_b32 s96, s95, 262144
    s_add_u32 s82, s96, s90
    s_add_u32 m0, s83, 16384
    s_nop 0
    buffer_load_dwordx4 v26, s[44:47], s82 offen lds
    v_permlane32_swap_b32 v192, v194
    v_permlane32_swap_b32 v193, v195
    v_pk_add_f32 v[192:193], v[192:193], v[194:195]
    s_nop 1
    v_add_f32_dpp v192, v192, v192 row_ror:4 row_mask:0xf bank_mask:0xf
    s_xor_b32 s96, s95, 393216
    s_add_u32 s82, s96, s90
    s_add_u32 m0, s83, 24576
    s_nop 0
    buffer_load_dwordx4 v26, s[44:47], s82 offen lds
    v_add_f32_dpp v193, v193, v193 row_ror:4 row_mask:0xf bank_mask:0xf
    v_add_f32_dpp v192, v192, v192 row_ror:8 row_mask:0xf bank_mask:0xf
    s_nop 0
    v_add_f32_dpp v193, v193, v193 row_ror:8 row_mask:0xf bank_mask:0xf
    s_xor_b32 s96, s95, 524288
    s_add_u32 s82, s96, s90
    s_add_u32 m0, s83, 32768
    s_nop 0
    buffer_load_dwordx4 v26, s[44:47], s82 offen lds
    v_mov_b32 v194, v192
    v_mov_b32 v195, v193
    s_nop 0
    v_permlane16_swap_b32 v192, v194
    s_xor_b32 s96, s95, 655360
    s_add_u32 s82, s96, s90
    s_add_u32 m0, s83, 40960
    s_nop 0
    buffer_load_dwordx4 v26, s[44:47], s82 offen lds
    v_permlane16_swap_b32 v193, v195
    v_pk_add_f32 v[192:193], v[192:193], v[194:195]
    v_cvt_pk_bf16_f32 v192, v192, v193
    ds_write_b32 v6, v192
    s_waitcnt lgkmcnt(0)
    s_barrier
    ds_read_b128 v[196:199], v7
    ds_read_b128 v[200:203], v7 offset:32
L_PAD7:
    s_cbranch_execz L_RET7
    ds_read_b128 v[204:207], v7 offset:64
    ds_read_b128 v[208:211], v7 offset:96
    s_lshr_b32 s96, s8, 2
    s_lshl1_add_u32 s97, s9, s96
    s_and_b32 s98, s8, 3
    s_lshl2_add_u32 s99, s97, s98
    s_lshl_b32 s96, s99, 9
    s_add_u32 s18, s96, 131072
    s_waitcnt lgkmcnt(0)
    s_lshl3_add_u32 s96, s11, s3
    s_lshl_b32 s97, s96, 11
    s_add_u32 s13, s97, 29360128
    s_load_dwordx2 s[24:25], s[32:33], s92 offset:3584 glc
    v_mfma_f32_32x32x16_bf16 v[136:151], v[196:199], v[152:155], 0
    v_mfma_f32_32x32x16_bf16 v[136:151], v[200:203], v[156:159], v[136:151]
    v_mfma_f32_32x32x16_bf16 v[136:151], v[204:207], v[160:163], v[136:151]
    v_mfma_f32_32x32x16_bf16 v[136:151], v[208:211], v[164:167], v[136:151]
    s_nop 11
    v_cvt_pk_bf16_f32 v136, 0, v136
    v_add_f32 v136, 0x358637bd, v136
    v_cvt_pk_bf16_f32 v136, 0, v136
    v_rcp_f32 v136, v136
    s_branch SCHK_20
SPOLL_19:
    s_load_dwordx2 s[24:25], s[32:33], s92 offset:3584 glc
SCHK_20:
    s_add_u32 s5, s5, 1
    s_cmp_ge_u32 s5, 200000
    s_waitcnt lgkmcnt(0)
    s_cbranch_scc1 SDONE_21
    s_cmp_lg_u32 s24, s4
    s_cbranch_scc1 SPOLL_19
    s_cmp_lg_u32 s25, s4
    s_cbranch_scc1 SPOLL_19
SDONE_21:
    buffer_load_dwordx4 v[228:231], v2, s[32:35], s13 offen sc1
    buffer_load_dwordx4 v[232:235], v2, s[32:35], s13 offen offset:1024 sc1
    s_waitcnt vmcnt(0)
    v_bitop3_b32 v4, v229, v231, s4 bitop3:0x7e
    v_bitop3_b32 v4, v4, v233, s4 bitop3:0xf6
    v_bitop3_b32 v4, v4, v235, s4 bitop3:0xf6
    v_cmp_ne_u32 vcc, 0, v4
    s_cbranch_vccz TOK_23
POLL_24:
    buffer_load_dwordx4 v[228:231], v2, s[32:35], s13 offen sc1
    buffer_load_dwordx4 v[232:235], v2, s[32:35], s13 offen offset:1024 sc1
    s_waitcnt vmcnt(0)
    v_bitop3_b32 v4, v229, v231, s4 bitop3:0x7e
    v_bitop3_b32 v4, v4, v233, s4 bitop3:0xf6
    v_bitop3_b32 v4, v4, v235, s4 bitop3:0xf6
    v_cmp_ne_u32 vcc, 0, v4
    s_cbranch_vccz PDONE_25
    s_add_u32 s5, s5, 1
    s_cmp_lt_u32 s5, 200000
    s_cbranch_scc1 POLL_24
PDONE_25:
TOK_23:
    ds_write2_b32 v5, v228, v230 offset0:0 offset1:1
    ds_write2_b32 v5, v232, v234 offset0:64 offset1:65
    s_waitcnt lgkmcnt(0)
    s_barrier
    ds_read_b128 v[212:215], v44
    ds_read_b128 v[216:219], v44 offset:1024
    ds_read_b128 v[220:223], v44 offset:2048
    ds_read_b128 v[224:227], v44 offset:3072
    s_lshl_b32 s96, s77, 1
    s_lshl3_add_u32 s97, s10, s96
    s_lshl_b32 s98, s97, 5
    s_lshl1_add_u32 s99, s11, s98
    s_add_u32 s96, s99, s76
    s_lshl_b32 s97, s96, 10
    s_add_u32 s13, s97, 8388608
    v_and_b32 v47, 15, v1
    v_lshlrev_b32 v47, 4, v47
    v_bfe_u32 v9, v1, 4, 1
    v_lshl_add_u32 v47, v9, 15, v47
    v_lshrrev_b32 v9, 5, v1
    v_lshl_add_u32 v47, v9, 8, v47
    s_waitcnt lgkmcnt(3)
    v_mfma_f32_32x32x16_bf16 v[120:135], v[212:215], v[152:155], 0
    s_waitcnt lgkmcnt(2)
    v_mfma_f32_32x32x16_bf16 v[120:135], v[216:219], v[156:159], v[120:135]
    s_waitcnt lgkmcnt(1)
    v_mfma_f32_32x32x16_bf16 v[120:135], v[220:223], v[160:163], v[120:135]
    s_waitcnt lgkmcnt(0)
    v_mfma_f32_32x32x16_bf16 v[120:135], v[224:227], v[164:167], v[120:135]
    s_lshr_b32 s96, s3, 1
    s_lshl4_add_u32 s97, s96, s12
    s_lshl_b32 s98, s97, 11
    s_and_b32 s99, s3, 1
    s_lshl_b32 s96, s99, 10
    s_add_u32 s97, s98, s96
    s_add_u32 s18, s97, 131072
    s_lshl_b32 s19, s12, 7
    v_and_b32 v44, 3, v1
    v_lshl_add_u32 v44, v44, 1, s19
    v_lshrrev_b32 v9, 5, v1
    v_lshl_add_u32 v44, v9, 3, v44
    v_bfe_u32 v9, v1, 4, 1
    v_lshl_add_u32 v44, v9, 4, v44
    v_bfe_u32 v9, v1, 2, 2
    v_lshl_add_u32 v44, v9, 5, v44
    global_load_ushort v32, v44, s[78:79]
    buffer_load_dwordx4 v[28:31], v2, s[32:35], s18 offen sc1
    v_cvt_pk_bf16_f32 v120, 0, v120
    v_cvt_pk_bf16_f32 v121, 0, v121
    v_cvt_pk_bf16_f32 v122, 0, v122
    v_cvt_pk_bf16_f32 v123, 0, v123
    v_cvt_pk_bf16_f32 v124, 0, v124
    v_cvt_pk_bf16_f32 v125, 0, v125
    v_cvt_pk_bf16_f32 v126, 0, v126
    v_cvt_pk_bf16_f32 v127, 0, v127
    v_pk_mul_f32 v[120:121], v[120:121], v[136:137] op_sel_hi:[1,0]
    v_pk_mul_f32 v[122:123], v[122:123], v[136:137] op_sel_hi:[1,0]
    v_pk_mul_f32 v[124:125], v[124:125], v[136:137] op_sel_hi:[1,0]
    v_pk_mul_f32 v[126:127], v[126:127], v[136:137] op_sel_hi:[1,0]
    v_cvt_pk_bf16_f32 v168, v120, v121
    v_cvt_pk_bf16_f32 v169, v122, v123
    v_cvt_pk_bf16_f32 v170, v124, v125
    v_cvt_pk_bf16_f32 v171, v126, v127
    buffer_store_dwordx4 v[168:171], v47, s[32:35], s13 offen sc1
    v_cvt_pk_bf16_f32 v128, 0, v128
    v_cvt_pk_bf16_f32 v129, 0, v129
    v_cvt_pk_bf16_f32 v130, 0, v130
    v_cvt_pk_bf16_f32 v131, 0, v131
    v_cvt_pk_bf16_f32 v132, 0, v132
    v_cvt_pk_bf16_f32 v133, 0, v133
    v_cvt_pk_bf16_f32 v134, 0, v134
    v_cvt_pk_bf16_f32 v135, 0, v135
    v_pk_mul_f32 v[128:129], v[128:129], v[136:137] op_sel_hi:[1,0]
    v_pk_mul_f32 v[130:131], v[130:131], v[136:137] op_sel_hi:[1,0]
    v_pk_mul_f32 v[132:133], v[132:133], v[136:137] op_sel_hi:[1,0]
    v_pk_mul_f32 v[134:135], v[134:135], v[136:137] op_sel_hi:[1,0]
    v_cvt_pk_bf16_f32 v172, v128, v129
    v_cvt_pk_bf16_f32 v173, v130, v131
    v_cvt_pk_bf16_f32 v174, v132, v133
    v_cvt_pk_bf16_f32 v175, v134, v135
    buffer_store_dwordx4 v[172:175], v47, s[32:35], s13 offen offset:512 sc1
    v_mov_b32 v50, -1
    v_mov_b32 v51, -1
    v_mov_b32 v52, -1
    v_mov_b32 v53, -1
    s_lshl3_add_u32 s96, s21, s3
    s_lshl4_add_u32 s97, s96, s12
    s_lshl_b32 s98, s97, 8
    s_add_u32 s19, s98, 12582912
    v_lshlrev_b32 v54, 2, v1
    buffer_store_dword v50, v54, s[32:35], s19 offen sc1
    s_lshl_b32 s96, s21, 14
    s_lshl_b32 s97, s12, 9
    s_add_u32 s98, s96, s97
    s_add_u32 s19, s98, 13631488
    v_and_b32 v54, 31, v1
    v_lshlrev_b32 v54, 4, v54
    v_lshrrev_b32 v55, 5, v1
    v_lshl_add_u32 v54, v55, 13, v54
    s_cmp_lg_u32 s3, 5
    s_cbranch_scc1 L_NOPO
    buffer_store_dwordx4 v[50:53], v54, s[32:35], s19 offen sc1
L_NOPO:
    v_bfe_u32 v36, v1, 2, 2
    v_lshlrev_b32 v36, 7, v36
    v_lshrrev_b32 v9, 4, v1
    v_lshl_add_u32 v36, v9, 10, v36
    v_and_b32 v9, 1, v1
    v_lshl_add_u32 v36, v9, 4, v36
    v_bfe_u32 v9, v1, 1, 1
    v_lshl_add_u32 v36, v9, 3, v36
    v_bfe_u32 v9, v1, 3, 2
    v_lshl_add_u32 v36, v9, 5, v36
    s_and_b32 s96, s9, 1
    s_lshl_b32 s97, s96, 2
    s_xor_b32 s98, s3, s97
    s_lshl_b32 s17, s98, 12
    s_lshl_b32 s96, s17, 2
    s_lshr_b32 s97, s95, 4
    s_xor_b32 s14, s96, s97
    v_add_u32 v36, s14, v36
    v_xor_b32 v37, 32, v36
    v_xor_b32 v38, 64, v36
    v_xor_b32 v39, 96, v36
    v_and_b32 v5, 7, v1
    v_lshlrev_b32 v5, 15, v5
    v_bfe_u32 v9, v1, 3, 1
    v_lshl_add_u32 v5, v9, 12, v5
    s_and_b32 s96, s11, 1
    s_lshr_b32 s97, s10, 2
    s_and_b32 s98, s10, 3
    s_lshl_b32 s99, s98, 6
    s_lshl1_add_u32 s98, s97, s99
    s_lshl_b32 s97, s98, 12
    s_lshr_b32 s99, s11, 1
    s_lshl_b32 s98, s99, 6
    s_add_u32 s99, s97, s98
    s_lshl2_add_u32 s97, s96, s99
    s_add_u32 s98, s97, 1048576
    s_add_u32 s15, s98, 1024
    v_lshlrev_b32 v152, 16, v12
    v_and_b32 v153, s6, v12
    v_lshlrev_b32 v154, 16, v13
    v_and_b32 v155, s6, v13
    v_lshlrev_b32 v156, 16, v14
    v_and_b32 v157, s6, v14
    v_lshlrev_b32 v158, 16, v15
    v_and_b32 v159, s6, v15
    v_lshlrev_b32 v160, 16, v16
    v_and_b32 v161, s6, v16
    v_lshlrev_b32 v162, 16, v17
    v_and_b32 v163, s6, v17
    v_lshlrev_b32 v164, 16, v18
    v_and_b32 v165, s6, v18
    v_lshlrev_b32 v166, 16, v19
    v_and_b32 v167, s6, v19
    s_lshl3_add_u32 s96, s21, s3
    s_lshl_b32 s97, s96, 15
    s_add_u32 s19, s97, 8388608
    s_waitcnt vmcnt(3)
    v_bitop3_b32 v4, v29, v31, s4 bitop3:0x7e
    v_cmp_ne_u32 vcc, 0, v4
    s_cbranch_vccz L_MGOK
POLL_26:
    buffer_load_dwordx4 v[28:31], v2, s[32:35], s18 offen sc1
    s_waitcnt vmcnt(0)
    v_bitop3_b32 v4, v29, v31, s4 bitop3:0x7e
    v_cmp_ne_u32 vcc, 0, v4
    s_cbranch_vccz PDONE_27
    s_add_u32 s5, s5, 1
    s_cmp_lt_u32 s5, 200000
    s_cbranch_scc1 POLL_26
PDONE_27:
L_MGOK:
    s_and_b32 s96, s3, 1
    s_lshr_b32 s97, s3, 1
    s_lshl_b32 s98, s97, 10
    s_lshl3_add_u32 s99, s96, s98
    s_add_u32 s14, s99, 159744
    v_and_b32 v4, 31, v1
    v_lshl_add_u32 v4, v4, 5, s14
    v_lshrrev_b32 v9, 5, v1
    v_lshl_add_u32 v4, v9, 2, v4
    ds_write2_b32 v4, v28, v30 offset0:0 offset1:4
    v_and_b32 v7, 3, v1
    v_lshlrev_b32 v7, 4, v7
    v_lshrrev_b32 v9, 5, v1
    v_lshl_add_u32 v7, v9, 6, v7
    v_bfe_u32 v9, v1, 4, 1
    v_lshl_add_u32 v7, v9, 7, v7
    v_bfe_u32 v9, v1, 2, 2
    v_lshl_add_u32 v7, v9, 8, v7
    v_add_u32 v7, 159744, v7
    s_lshl_b32 s96, s2, 12
    s_lshr_b32 s97, s17, 6
    s_add_u32 s98, s96, s97
    s_add_u32 s99, s98, 1048576
    s_add_u32 s18, s99, 1024
    s_waitcnt vmcnt(1)
    s_waitcnt lgkmcnt(0)
    s_barrier
    s_cmp_lg_u32 s3, 0
    s_cbranch_scc1 L_PD
    v_mov_b32 v6, s4
    s_mov_b32 exec_hi, 0
    s_mov_b32 exec_lo, 65535
    buffer_store_dword v6, v5, s[32:35], s15 offen sc1
    s_mov_b64 exec, -1
L_PD:
    ds_read_b128 v[192:195], v7
    ds_read_b128 v[196:199], v7 offset:1024
    ds_read_b128 v[200:203], v7 offset:2048
    ds_read_b128 v[204:207], v7 offset:3072
    v_and_b32 v8, 3, v1
    v_lshlrev_b32 v8, 2, v8
    v_lshrrev_b32 v9, 5, v1
    v_lshl_add_u32 v8, v9, 4, v8
    v_bfe_u32 v9, v1, 4, 1
    v_lshl_add_u32 v8, v9, 5, v8
    v_bfe_u32 v9, v1, 2, 2
    v_lshl_add_u32 v8, v9, 6, v8
    v_add_u32 v8, 157184, v8
    s_lshl4_add_u32 s96, s21, s12
    s_lshl_b32 s97, s96, 6
    s_add_u32 s13, s97, 14155776
    s_waitcnt lgkmcnt(0)
    s_load_dwordx2 s[24:25], s[32:33], s18 offset:0 glc
    v_pk_add_f32 v[192:193], v[192:193], v[194:195]
    v_add_f32 v28, v192, v193
    v_pk_add_f32 v[196:197], v[196:197], v[198:199]
    v_add_f32 v29, v196, v197
    v_pk_add_f32 v[200:201], v[200:201], v[202:203]
    v_add_f32 v30, v200, v201
    v_pk_add_f32 v[204:205], v[204:205], v[206:207]
    v_add_f32 v31, v204, v205
    v_cvt_pk_bf16_f32 v28, 0, v28
    v_cvt_pk_bf16_f32 v29, 0, v29
    v_cvt_pk_bf16_f32 v30, 0, v30
    v_cvt_pk_bf16_f32 v31, 0, v31
    v_add_f32 v30, 1.0, v30
    v_lshlrev_b32 v32, 16, v32
    v_cvt_pk_bf16_f32 v30, 0, v30
    ds_write_b32 v8, v31
    v_mul_f32 v192, v30, v32
    v_cvt_pk_bf16_f32 v193, 0, v192
    v_sub_f32 v194, v192, v193
    v_add_f32_dpp v192, v192, v192 quad_perm:[1,0,3,2] row_mask:0xf bank_mask:0xf
    s_nop 1
    v_add_f32_dpp v192, v192, v192 quad_perm:[2,3,0,1] row_mask:0xf bank_mask:0xf
    s_nop 1
    v_add_f32_dpp v192, v192, v192 row_half_mirror row_mask:0xf bank_mask:0xf
    s_nop 1
    v_add_f32_dpp v192, v192, v192 row_ror:8 row_mask:0xf bank_mask:0xf
    v_mov_b32 v199, v192
    s_nop 1
    v_permlane16_swap_b32 v192, v199
    v_add_f32 v192, v192, v199
    v_mov_b32 v199, v192
    s_nop 1
    v_permlane32_swap_b32 v192, v199
    v_add_f32 v192, v192, v199
    v_mov_b32_dpp v196, v193 row_shl:1 row_mask:0xf bank_mask:0xf
    v_mov_b32_dpp v197, v194 row_shl:1 row_mask:0xf bank_mask:0xf
    v_mov_b32_dpp v198, v32 row_shl:1 row_mask:0xf bank_mask:0xf
    v_cvt_pk_bf16_f32 v196, v193, v196
    v_cvt_pk_bf16_f32 v197, v194, v197
    v_cvt_pk_bf16_f32 v198, v32, v198
    v_mov_b32 v193, s4
    v_mov_b32 v194, 0
    s_cmp_lg_u32 s3, 2
    s_cbranch_scc1 L_NOUP
    s_mov_b64 exec, 1
    buffer_store_dwordx2 v[192:193], v194, s[32:35], s13 offen sc1
    s_mov_b64 exec, -1
L_NOUP:
    v_mov_b32 v184, 0x3f803f80
    s_nop 1
    v_mov_b32_dpp v184, v196 row_newbcast:0 row_mask:0xf bank_mask:0x2
    s_nop 1
    v_mov_b32_dpp v184, v197 row_newbcast:0 row_mask:0xf bank_mask:0x4
    s_nop 1
    v_mov_b32_dpp v184, v198 row_newbcast:0 row_mask:0xf bank_mask:0x8
    v_mov_b32 v185, 0x3f803f80
    s_nop 1
    v_mov_b32_dpp v185, v196 row_newbcast:2 row_mask:0xf bank_mask:0x2
    s_nop 1
    v_mov_b32_dpp v185, v197 row_newbcast:2 row_mask:0xf bank_mask:0x4
    s_nop 1
    v_mov_b32_dpp v185, v198 row_newbcast:2 row_mask:0xf bank_mask:0x8
    v_mov_b32 v186, 0x3f803f80
    s_nop 1
    v_mov_b32_dpp v186, v196 row_newbcast:4 row_mask:0xf bank_mask:0x2
    s_nop 1
    v_mov_b32_dpp v186, v197 row_newbcast:4 row_mask:0xf bank_mask:0x4
    s_nop 1
    v_mov_b32_dpp v186, v198 row_newbcast:4 row_mask:0xf bank_mask:0x8
    v_mov_b32 v187, 0x3f803f80
    s_nop 1
    v_mov_b32_dpp v187, v196 row_newbcast:6 row_mask:0xf bank_mask:0x2
    s_nop 1
    v_mov_b32_dpp v187, v197 row_newbcast:6 row_mask:0xf bank_mask:0x4
    s_nop 1
    v_mov_b32_dpp v187, v198 row_newbcast:6 row_mask:0xf bank_mask:0x8
    v_mov_b32 v188, 0x3f803f80
    s_nop 1
    v_mov_b32_dpp v188, v196 row_newbcast:8 row_mask:0xf bank_mask:0x2
    s_nop 1
    v_mov_b32_dpp v188, v197 row_newbcast:8 row_mask:0xf bank_mask:0x4
    s_nop 1
    v_mov_b32_dpp v188, v198 row_newbcast:8 row_mask:0xf bank_mask:0x8
    v_mov_b32 v189, 0x3f803f80
    s_nop 1
    v_mov_b32_dpp v189, v196 row_newbcast:10 row_mask:0xf bank_mask:0x2
    s_nop 1
    v_mov_b32_dpp v189, v197 row_newbcast:10 row_mask:0xf bank_mask:0x4
    s_nop 1
    v_mov_b32_dpp v189, v198 row_newbcast:10 row_mask:0xf bank_mask:0x8
    v_mov_b32 v190, 0x3f803f80
    s_nop 1
    v_mov_b32_dpp v190, v196 row_newbcast:12 row_mask:0xf bank_mask:0x2
    s_nop 1
    v_mov_b32_dpp v190, v197 row_newbcast:12 row_mask:0xf bank_mask:0x4
    s_nop 1
    v_mov_b32_dpp v190, v198 row_newbcast:12 row_mask:0xf bank_mask:0x8
    v_mov_b32 v191, 0x3f803f80
    s_nop 1
    v_mov_b32_dpp v191, v196 row_newbcast:14 row_mask:0xf bank_mask:0x2
    s_nop 1
    v_mov_b32_dpp v191, v197 row_newbcast:14 row_mask:0xf bank_mask:0x4
    s_nop 1
    v_mov_b32_dpp v191, v198 row_newbcast:14 row_mask:0xf bank_mask:0x8
    v_mov_b32_dpp v136, v28 row_newbcast:0 row_mask:0xf bank_mask:0xf
    v_mov_b32_dpp v137, v28 row_newbcast:1 row_mask:0xf bank_mask:0xf
    v_mov_b32_dpp v138, v28 row_newbcast:2 row_mask:0xf bank_mask:0xf
    v_mov_b32_dpp v139, v28 row_newbcast:3 row_mask:0xf bank_mask:0xf
    v_mov_b32_dpp v140, v28 row_newbcast:4 row_mask:0xf bank_mask:0xf
    v_mov_b32_dpp v141, v28 row_newbcast:5 row_mask:0xf bank_mask:0xf
    v_mov_b32_dpp v142, v28 row_newbcast:6 row_mask:0xf bank_mask:0xf
    v_mov_b32_dpp v143, v28 row_newbcast:7 row_mask:0xf bank_mask:0xf
    v_mov_b32_dpp v144, v28 row_newbcast:8 row_mask:0xf bank_mask:0xf
    v_mov_b32_dpp v145, v28 row_newbcast:9 row_mask:0xf bank_mask:0xf
    v_mov_b32_dpp v146, v28 row_newbcast:10 row_mask:0xf bank_mask:0xf
    v_mov_b32_dpp v147, v28 row_newbcast:11 row_mask:0xf bank_mask:0xf
    v_mov_b32_dpp v148, v28 row_newbcast:12 row_mask:0xf bank_mask:0xf
    v_mov_b32_dpp v149, v28 row_newbcast:13 row_mask:0xf bank_mask:0xf
    v_mov_b32_dpp v150, v28 row_newbcast:14 row_mask:0xf bank_mask:0xf
    v_mov_b32_dpp v151, v28 row_newbcast:15 row_mask:0xf bank_mask:0xf
    v_mov_b32_dpp v168, v30 row_newbcast:0 row_mask:0xf bank_mask:0xf
    v_mov_b32_dpp v169, v30 row_newbcast:1 row_mask:0xf bank_mask:0xf
    v_mov_b32_dpp v170, v30 row_newbcast:2 row_mask:0xf bank_mask:0xf
    v_mov_b32_dpp v171, v30 row_newbcast:3 row_mask:0xf bank_mask:0xf
    v_mov_b32_dpp v172, v30 row_newbcast:4 row_mask:0xf bank_mask:0xf
    v_mov_b32_dpp v173, v30 row_newbcast:5 row_mask:0xf bank_mask:0xf
    v_mov_b32_dpp v174, v30 row_newbcast:6 row_mask:0xf bank_mask:0xf
    v_mov_b32_dpp v175, v30 row_newbcast:7 row_mask:0xf bank_mask:0xf
    v_mov_b32_dpp v176, v30 row_newbcast:8 row_mask:0xf bank_mask:0xf
    v_mov_b32_dpp v177, v30 row_newbcast:9 row_mask:0xf bank_mask:0xf
    v_mov_b32_dpp v178, v30 row_newbcast:10 row_mask:0xf bank_mask:0xf
    v_mov_b32_dpp v179, v30 row_newbcast:11 row_mask:0xf bank_mask:0xf
    v_mov_b32_dpp v180, v30 row_newbcast:12 row_mask:0xf bank_mask:0xf
    v_mov_b32_dpp v181, v30 row_newbcast:13 row_mask:0xf bank_mask:0xf
    v_mov_b32_dpp v182, v30 row_newbcast:14 row_mask:0xf bank_mask:0xf
    v_mov_b32_dpp v183, v30 row_newbcast:15 row_mask:0xf bank_mask:0xf
    v_mov_b32_dpp v88, v29 row_newbcast:0 row_mask:0xf bank_mask:0xf
    v_mov_b32_dpp v89, v29 row_newbcast:1 row_mask:0xf bank_mask:0xf
    v_mov_b32_dpp v90, v29 row_newbcast:2 row_mask:0xf bank_mask:0xf
    v_mov_b32_dpp v91, v29 row_newbcast:3 row_mask:0xf bank_mask:0xf
    v_mov_b32_dpp v92, v29 row_newbcast:4 row_mask:0xf bank_mask:0xf
    v_mov_b32_dpp v93, v29 row_newbcast:5 row_mask:0xf bank_mask:0xf
    v_mov_b32_dpp v94, v29 row_newbcast:6 row_mask:0xf bank_mask:0xf
    v_mov_b32_dpp v95, v29 row_newbcast:7 row_mask:0xf bank_mask:0xf
    v_mov_b32_dpp v96, v29 row_newbcast:8 row_mask:0xf bank_mask:0xf
    v_mov_b32_dpp v97, v29 row_newbcast:9 row_mask:0xf bank_mask:0xf
    v_mov_b32_dpp v98, v29 row_newbcast:10 row_mask:0xf bank_mask:0xf
    v_mov_b32_dpp v99, v29 row_newbcast:11 row_mask:0xf bank_mask:0xf
    v_mov_b32_dpp v100, v29 row_newbcast:12 row_mask:0xf bank_mask:0xf
    v_mov_b32_dpp v101, v29 row_newbcast:13 row_mask:0xf bank_mask:0xf
    v_mov_b32_dpp v102, v29 row_newbcast:14 row_mask:0xf bank_mask:0xf
    v_mov_b32_dpp v103, v29 row_newbcast:15 row_mask:0xf bank_mask:0xf
    v_mov_b32_dpp v104, v31 row_newbcast:0 row_mask:0xf bank_mask:0xf
    v_mov_b32_dpp v105, v31 row_newbcast:1 row_mask:0xf bank_mask:0xf
    v_mov_b32_dpp v106, v31 row_newbcast:2 row_mask:0xf bank_mask:0xf
    v_mov_b32_dpp v107, v31 row_newbcast:3 row_mask:0xf bank_mask:0xf
    v_mov_b32_dpp v108, v31 row_newbcast:4 row_mask:0xf bank_mask:0xf
    v_mov_b32_dpp v109, v31 row_newbcast:5 row_mask:0xf bank_mask:0xf
    v_mov_b32_dpp v110, v31 row_newbcast:6 row_mask:0xf bank_mask:0xf
    v_mov_b32_dpp v111, v31 row_newbcast:7 row_mask:0xf bank_mask:0xf
    v_mov_b32_dpp v112, v31 row_newbcast:8 row_mask:0xf bank_mask:0xf
    v_mov_b32_dpp v113, v31 row_newbcast:9 row_mask:0xf bank_mask:0xf
    v_mov_b32_dpp v114, v31 row_newbcast:10 row_mask:0xf bank_mask:0xf
    v_mov_b32_dpp v115, v31 row_newbcast:11 row_mask:0xf bank_mask:0xf
    v_mov_b32_dpp v116, v31 row_newbcast:12 row_mask:0xf bank_mask:0xf
    v_mov_b32_dpp v117, v31 row_newbcast:13 row_mask:0xf bank_mask:0xf
    v_mov_b32_dpp v118, v31 row_newbcast:14 row_mask:0xf bank_mask:0xf
    v_mov_b32_dpp v119, v31 row_newbcast:15 row_mask:0xf bank_mask:0xf
    s_branch SCHK_29
SPOLL_28:
    s_load_dwordx2 s[24:25], s[32:33], s18 offset:0 glc
SCHK_29:
    s_add_u32 s5, s5, 1
    s_cmp_ge_u32 s5, 200000
    s_waitcnt lgkmcnt(0)
    s_cbranch_scc1 SDONE_30
    s_cmp_lg_u32 s24, s4
    s_cbranch_scc1 SPOLL_28
    s_cmp_lg_u32 s25, s4
    s_cbranch_scc1 SPOLL_28
SDONE_30:
    s_add_u32 s20, s17, s19
    buffer_load_dwordx4 v[224:227], v2, s[32:35], s20 offen sc1
    ds_read_b64_tr_b16 v[192:193], v36
    ds_read_b64_tr_b16 v[194:195], v36 offset:512
    ds_read_b64_tr_b16 v[196:197], v37
    ds_read_b64_tr_b16 v[198:199], v37 offset:512
    ds_read_b64_tr_b16 v[200:201], v38
    ds_read_b64_tr_b16 v[202:203], v38 offset:512
    ds_read_b64_tr_b16 v[204:205], v39
    ds_read_b64_tr_b16 v[206:207], v39 offset:512
    ds_read_b64_tr_b16 v[208:209], v36 offset:4096
    ds_read_b64_tr_b16 v[210:211], v36 offset:4608
    ds_read_b64_tr_b16 v[212:213], v37 offset:4096
    ds_read_b64_tr_b16 v[214:215], v37 offset:4608
    ds_read_b64_tr_b16 v[216:217], v38 offset:4096
    ds_read_b64_tr_b16 v[218:219], v38 offset:4608
    buffer_load_dwordx4 v[228:231], v2, s[32:35], s20 offen offset:1024 sc1
    buffer_load_dwordx4 v[232:235], v2, s[32:35], s20 offen offset:2048 sc1
    buffer_load_dwordx4 v[236:239], v2, s[32:35], s20 offen offset:3072 sc1
    s_barrier
    s_xor_b32 s96, s17, 4096
    s_add_u32 s20, s96, s19
    buffer_load_dwordx4 v[240:243], v2, s[32:35], s20 offen sc1
    buffer_load_dwordx4 v[244:247], v2, s[32:35], s20 offen offset:1024 sc1
    buffer_load_dwordx4 v[44:47], v2, s[32:35], s20 offen offset:2048 sc1
    buffer_load_dwordx4 v[48:51], v2, s[32:35], s20 offen offset:3072 sc1
    s_lshl_b32 s96, s21, 10
    s_add_u32 s13, s96, 14155776
    v_and_b32 v10, 15, v1
    v_lshlrev_b32 v10, 6, v10
    s_waitcnt vmcnt(7)
    s_waitcnt lgkmcnt(10)
    v_mfma_f32_16x16x32_bf16 v[120:123], v[192:195], v[224:227], 0
    ds_read_b64_tr_b16 v[220:221], v39 offset:4096
    ds_read_b64_tr_b16 v[222:223], v39 offset:4608
    v_mfma_f32_16x16x32_bf16 v[124:127], v[196:199], v[224:227], 0
    ds_read_b64_tr_b16 v[192:193], v36 offset:8192
    ds_read_b64_tr_b16 v[194:195], v36 offset:8704
    s_waitcnt lgkmcnt(10)
    v_mfma_f32_16x16x32_bf16 v[128:131], v[200:203], v[224:227], 0
    ds_read_b64_tr_b16 v[196:197], v37 offset:8192
    ds_read_b64_tr_b16 v[198:199], v37 offset:8704
    v_mfma_f32_16x16x32_bf16 v[132:135], v[204:207], v[224:227], 0
    ds_read_b64_tr_b16 v[200:201], v38 offset:8192
    ds_read_b64_tr_b16 v[202:203], v38 offset:8704
    s_xor_b32 s96, s17, 8192
    s_add_u32 s20, s96, s19
    buffer_load_dwordx4 v[224:227], v2, s[32:35], s20 offen sc1
    s_waitcnt vmcnt(7)
    s_waitcnt lgkmcnt(10)
    v_mfma_f32_16x16x32_bf16 v[120:123], v[208:211], v[228:231], v[120:123]
    ds_read_b64_tr_b16 v[204:205], v39 offset:8192
    ds_read_b64_tr_b16 v[206:207], v39 offset:8704
    v_mfma_f32_16x16x32_bf16 v[124:127], v[212:215], v[228:231], v[124:127]
    ds_read_b64_tr_b16 v[208:209], v36 offset:12288
    ds_read_b64_tr_b16 v[210:211], v36 offset:12800
    s_waitcnt lgkmcnt(10)
    v_mfma_f32_16x16x32_bf16 v[128:131], v[216:219], v[228:231], v[128:131]
    ds_read_b64_tr_b16 v[212:213], v37 offset:12288
    ds_read_b64_tr_b16 v[214:215], v37 offset:12800
    v_mfma_f32_16x16x32_bf16 v[132:135], v[220:223], v[228:231], v[132:135]
    ds_read_b64_tr_b16 v[216:217], v38 offset:12288
    ds_read_b64_tr_b16 v[218:219], v38 offset:12800
    buffer_load_dwordx4 v[228:231], v2, s[32:35], s20 offen offset:1024 sc1
    s_waitcnt vmcnt(7)
    s_waitcnt lgkmcnt(10)
    v_mfma_f32_16x16x32_bf16 v[120:123], v[192:195], v[232:235], v[120:123]
    ds_read_b64_tr_b16 v[220:221], v39 offset:12288
    ds_read_b64_tr_b16 v[222:223], v39 offset:12800
    v_mfma_f32_16x16x32_bf16 v[124:127], v[196:199], v[232:235], v[124:127]
    v_xor_b32 v36, 16384, v36
    ds_read_b64_tr_b16 v[192:193], v36
    ds_read_b64_tr_b16 v[194:195], v36 offset:512
    s_waitcnt lgkmcnt(10)
    v_mfma_f32_16x16x32_bf16 v[128:131], v[200:203], v[232:235], v[128:131]
    v_xor_b32 v37, 16384, v37
    ds_read_b64_tr_b16 v[196:197], v37
    ds_read_b64_tr_b16 v[198:199], v37 offset:512
    v_mfma_f32_16x16x32_bf16 v[132:135], v[204:207], v[232:235], v[132:135]
    v_xor_b32 v38, 16384, v38
    ds_read_b64_tr_b16 v[200:201], v38
    ds_read_b64_tr_b16 v[202:203], v38 offset:512
    buffer_load_dwordx4 v[232:235], v2, s[32:35], s20 offen offset:2048 sc1
    s_waitcnt vmcnt(7)
    s_waitcnt lgkmcnt(10)
    v_mfma_f32_16x16x32_bf16 v[120:123], v[208:211], v[236:239], v[120:123]
    v_xor_b32 v39, 16384, v39
    ds_read_b64_tr_b16 v[204:205], v39
    ds_read_b64_tr_b16 v[206:207], v39 offset:512
    v_mfma_f32_16x16x32_bf16 v[124:127], v[212:215], v[236:239], v[124:127]
    ds_read_b64_tr_b16 v[208:209], v36 offset:4096
    ds_read_b64_tr_b16 v[210:211], v36 offset:4608
    s_waitcnt lgkmcnt(10)
    v_mfma_f32_16x16x32_bf16 v[128:131], v[216:219], v[236:239], v[128:131]
    ds_read_b64_tr_b16 v[212:213], v37 offset:4096
    ds_read_b64_tr_b16 v[214:215], v37 offset:4608
    v_mfma_f32_16x16x32_bf16 v[132:135], v[220:223], v[236:239], v[132:135]
    ds_read_b64_tr_b16 v[216:217], v38 offset:4096
    ds_read_b64_tr_b16 v[218:219], v38 offset:4608
    buffer_load_dwordx4 v[236:239], v2, s[32:35], s20 offen offset:3072 sc1
    s_waitcnt vmcnt(7)
    s_waitcnt lgkmcnt(10)
    v_mfma_f32_16x16x32_bf16 v[120:123], v[192:195], v[240:243], v[120:123]
    ds_read_b64_tr_b16 v[220:221], v39 offset:4096
    ds_read_b64_tr_b16 v[222:223], v39 offset:4608
    v_mfma_f32_16x16x32_bf16 v[124:127], v[196:199], v[240:243], v[124:127]
    ds_read_b64_tr_b16 v[192:193], v36 offset:8192
    ds_read_b64_tr_b16 v[194:195], v36 offset:8704
    s_waitcnt lgkmcnt(10)
    v_mfma_f32_16x16x32_bf16 v[128:131], v[200:203], v[240:243], v[128:131]
    ds_read_b64_tr_b16 v[196:197], v37 offset:8192
    ds_read_b64_tr_b16 v[198:199], v37 offset:8704
    v_mfma_f32_16x16x32_bf16 v[132:135], v[204:207], v[240:243], v[132:135]
    ds_read_b64_tr_b16 v[200:201], v38 offset:8192
    ds_read_b64_tr_b16 v[202:203], v38 offset:8704
    s_xor_b32 s96, s17, 12288
    s_add_u32 s20, s96, s19
    buffer_load_dwordx4 v[240:243], v2, s[32:35], s20 offen sc1
    s_waitcnt vmcnt(7)
    s_waitcnt lgkmcnt(10)
    v_mfma_f32_16x16x32_bf16 v[120:123], v[208:211], v[244:247], v[120:123]
    ds_read_b64_tr_b16 v[204:205], v39 offset:8192
    ds_read_b64_tr_b16 v[206:207], v39 offset:8704
    v_mfma_f32_16x16x32_bf16 v[124:127], v[212:215], v[244:247], v[124:127]
    ds_read_b64_tr_b16 v[208:209], v36 offset:12288
    ds_read_b64_tr_b16 v[210:211], v36 offset:12800
    s_waitcnt lgkmcnt(10)
    v_mfma_f32_16x16x32_bf16 v[128:131], v[216:219], v[244:247], v[128:131]
    ds_read_b64_tr_b16 v[212:213], v37 offset:12288
    ds_read_b64_tr_b16 v[214:215], v37 offset:12800
    v_mfma_f32_16x16x32_bf16 v[132:135], v[220:223], v[244:247], v[132:135]
    ds_read_b64_tr_b16 v[216:217], v38 offset:12288
    ds_read_b64_tr_b16 v[218:219], v38 offset:12800
    buffer_load_dwordx4 v[244:247], v2, s[32:35], s20 offen offset:1024 sc1
    s_waitcnt vmcnt(7)
    s_waitcnt lgkmcnt(10)
    v_mfma_f32_16x16x32_bf16 v[120:123], v[192:195], v[44:47], v[120:123]
    ds_read_b64_tr_b16 v[220:221], v39 offset:12288
    ds_read_b64_tr_b16 v[222:223], v39 offset:12800
    v_mfma_f32_16x16x32_bf16 v[124:127], v[196:199], v[44:47], v[124:127]
    v_xor_b32 v36, 49152, v36
    ds_read_b64_tr_b16 v[192:193], v36
    ds_read_b64_tr_b16 v[194:195], v36 offset:512
    s_waitcnt lgkmcnt(10)
    v_mfma_f32_16x16x32_bf16 v[128:131], v[200:203], v[44:47], v[128:131]
    v_xor_b32 v37, 49152, v37
    ds_read_b64_tr_b16 v[196:197], v37
    ds_read_b64_tr_b16 v[198:199], v37 offset:512
    v_mfma_f32_16x16x32_bf16 v[132:135], v[204:207], v[44:47], v[132:135]
    v_xor_b32 v38, 49152, v38
    ds_read_b64_tr_b16 v[200:201], v38
    ds_read_b64_tr_b16 v[202:203], v38 offset:512
    buffer_load_dwordx4 v[44:47], v2, s[32:35], s20 offen offset:2048 sc1
    s_waitcnt vmcnt(7)
    s_waitcnt lgkmcnt(10)
    v_mfma_f32_16x16x32_bf16 v[120:123], v[208:211], v[48:51], v[120:123]
    v_xor_b32 v39, 49152, v39
    ds_read_b64_tr_b16 v[204:205], v39
    ds_read_b64_tr_b16 v[206:207], v39 offset:512
    v_mfma_f32_16x16x32_bf16 v[124:127], v[212:215], v[48:51], v[124:127]
    ds_read_b64_tr_b16 v[208:209], v36 offset:4096
    ds_read_b64_tr_b16 v[210:211], v36 offset:4608
    s_waitcnt lgkmcnt(10)
    v_mfma_f32_16x16x32_bf16 v[128:131], v[216:219], v[48:51], v[128:131]
    ds_read_b64_tr_b16 v[212:213], v37 offset:4096
    ds_read_b64_tr_b16 v[214:215], v37 offset:4608
    v_mfma_f32_16x16x32_bf16 v[132:135], v[220:223], v[48:51], v[132:135]
    ds_read_b64_tr_b16 v[216:217], v38 offset:4096
    ds_read_b64_tr_b16 v[218:219], v38 offset:4608
    buffer_load_dwordx4 v[48:51], v2, s[32:35], s20 offen offset:3072 sc1
    s_waitcnt vmcnt(7)
    s_waitcnt lgkmcnt(10)
    v_mfma_f32_16x16x32_bf16 v[120:123], v[192:195], v[224:227], v[120:123]
    ds_read_b64_tr_b16 v[220:221], v39 offset:4096
    ds_read_b64_tr_b16 v[222:223], v39 offset:4608
    v_mfma_f32_16x16x32_bf16 v[124:127], v[196:199], v[224:227], v[124:127]
    ds_read_b64_tr_b16 v[192:193], v36 offset:8192
    ds_read_b64_tr_b16 v[194:195], v36 offset:8704
L_PAD8:
    s_cbranch_execz L_RET8
    s_waitcnt lgkmcnt(10)
    v_mfma_f32_16x16x32_bf16 v[128:131], v[200:203], v[224:227], v[128:131]
    ds_read_b64_tr_b16 v[196:197], v37 offset:8192
    ds_read_b64_tr_b16 v[198:199], v37 offset:8704
    v_mfma_f32_16x16x32_bf16 v[132:135], v[204:207], v[224:227], v[132:135]
    ds_read_b64_tr_b16 v[200:201], v38 offset:8192
    ds_read_b64_tr_b16 v[202:203], v38 offset:8704
    s_xor_b32 s96, s17, 16384
    s_add_u32 s20, s96, s19
    buffer_load_dwordx4 v[224:227], v2, s[32:35], s20 offen sc1
    s_waitcnt vmcnt(7)
    s_waitcnt lgkmcnt(10)
    v_mfma_f32_16x16x32_bf16 v[120:123], v[208:211], v[228:231], v[120:123]
    ds_read_b64_tr_b16 v[204:205], v39 offset:8192
    ds_read_b64_tr_b16 v[206:207], v39 offset:8704
    v_mfma_f32_16x16x32_bf16 v[124:127], v[212:215], v[228:231], v[124:127]
    ds_read_b64_tr_b16 v[208:209], v36 offset:12288
    ds_read_b64_tr_b16 v[210:211], v36 offset:12800
    s_waitcnt lgkmcnt(10)
    v_mfma_f32_16x16x32_bf16 v[128:131], v[216:219], v[228:231], v[128:131]
    ds_read_b64_tr_b16 v[212:213], v37 offset:12288
    ds_read_b64_tr_b16 v[214:215], v37 offset:12800
    v_mfma_f32_16x16x32_bf16 v[132:135], v[220:223], v[228:231], v[132:135]
    ds_read_b64_tr_b16 v[216:217], v38 offset:12288
    ds_read_b64_tr_b16 v[218:219], v38 offset:12800
    buffer_load_dwordx4 v[228:231], v2, s[32:35], s20 offen offset:1024 sc1
    s_waitcnt vmcnt(7)
    s_waitcnt lgkmcnt(10)
    v_mfma_f32_16x16x32_bf16 v[120:123], v[192:195], v[232:235], v[120:123]
    ds_read_b64_tr_b16 v[220:221], v39 offset:12288
    ds_read_b64_tr_b16 v[222:223], v39 offset:12800
    v_mfma_f32_16x16x32_bf16 v[124:127], v[196:199], v[232:235], v[124:127]
    v_xor_b32 v36, 16384, v36
    ds_read_b64_tr_b16 v[192:193], v36
    ds_read_b64_tr_b16 v[194:195], v36 offset:512
    s_waitcnt lgkmcnt(10)
    v_mfma_f32_16x16x32_bf16 v[128:131], v[200:203], v[232:235], v[128:131]
    v_xor_b32 v37, 16384, v37
    ds_read_b64_tr_b16 v[196:197], v37
    ds_read_b64_tr_b16 v[198:199], v37 offset:512
    v_mfma_f32_16x16x32_bf16 v[132:135], v[204:207], v[232:235], v[132:135]
    v_xor_b32 v38, 16384, v38
    ds_read_b64_tr_b16 v[200:201], v38
    ds_read_b64_tr_b16 v[202:203], v38 offset:512
    buffer_load_dwordx4 v[232:235], v2, s[32:35], s20 offen offset:2048 sc1
    s_waitcnt vmcnt(7)
    s_waitcnt lgkmcnt(10)
    v_mfma_f32_16x16x32_bf16 v[120:123], v[208:211], v[236:239], v[120:123]
    v_xor_b32 v39, 16384, v39
    ds_read_b64_tr_b16 v[204:205], v39
    ds_read_b64_tr_b16 v[206:207], v39 offset:512
    v_mfma_f32_16x16x32_bf16 v[124:127], v[212:215], v[236:239], v[124:127]
    ds_read_b64_tr_b16 v[208:209], v36 offset:4096
    ds_read_b64_tr_b16 v[210:211], v36 offset:4608
    s_waitcnt lgkmcnt(10)
    v_mfma_f32_16x16x32_bf16 v[128:131], v[216:219], v[236:239], v[128:131]
    ds_read_b64_tr_b16 v[212:213], v37 offset:4096
    ds_read_b64_tr_b16 v[214:215], v37 offset:4608
    v_mfma_f32_16x16x32_bf16 v[132:135], v[220:223], v[236:239], v[132:135]
    ds_read_b64_tr_b16 v[216:217], v38 offset:4096
    ds_read_b64_tr_b16 v[218:219], v38 offset:4608
    buffer_load_dwordx4 v[236:239], v2, s[32:35], s20 offen offset:3072 sc1
    s_waitcnt vmcnt(7)
    s_waitcnt lgkmcnt(10)
    v_mfma_f32_16x16x32_bf16 v[120:123], v[192:195], v[240:243], v[120:123]
    ds_read_b64_tr_b16 v[220:221], v39 offset:4096
    ds_read_b64_tr_b16 v[222:223], v39 offset:4608
    v_mfma_f32_16x16x32_bf16 v[124:127], v[196:199], v[240:243], v[124:127]
    ds_read_b64_tr_b16 v[192:193], v36 offset:8192
    ds_read_b64_tr_b16 v[194:195], v36 offset:8704
    s_waitcnt lgkmcnt(10)
    v_mfma_f32_16x16x32_bf16 v[128:131], v[200:203], v[240:243], v[128:131]
    ds_read_b64_tr_b16 v[196:197], v37 offset:8192
    ds_read_b64_tr_b16 v[198:199], v37 offset:8704
    v_mfma_f32_16x16x32_bf16 v[132:135], v[204:207], v[240:243], v[132:135]
    ds_read_b64_tr_b16 v[200:201], v38 offset:8192
    ds_read_b64_tr_b16 v[202:203], v38 offset:8704
    s_xor_b32 s96, s17, 20480
    s_add_u32 s20, s96, s19
    buffer_load_dwordx4 v[240:243], v2, s[32:35], s20 offen sc1
    s_waitcnt vmcnt(7)
    s_waitcnt lgkmcnt(10)
    v_mfma_f32_16x16x32_bf16 v[120:123], v[208:211], v[244:247], v[120:123]
    ds_read_b64_tr_b16 v[204:205], v39 offset:8192
    ds_read_b64_tr_b16 v[206:207], v39 offset:8704
    v_mfma_f32_16x16x32_bf16 v[124:127], v[212:215], v[244:247], v[124:127]
    ds_read_b64_tr_b16 v[208:209], v36 offset:12288
    ds_read_b64_tr_b16 v[210:211], v36 offset:12800
    s_waitcnt lgkmcnt(10)
    v_mfma_f32_16x16x32_bf16 v[128:131], v[216:219], v[244:247], v[128:131]
    ds_read_b64_tr_b16 v[212:213], v37 offset:12288
    ds_read_b64_tr_b16 v[214:215], v37 offset:12800
    v_mfma_f32_16x16x32_bf16 v[132:135], v[220:223], v[244:247], v[132:135]
    ds_read_b64_tr_b16 v[216:217], v38 offset:12288
    ds_read_b64_tr_b16 v[218:219], v38 offset:12800
    buffer_load_dwordx4 v[244:247], v2, s[32:35], s20 offen offset:1024 sc1
    s_waitcnt vmcnt(7)
    s_waitcnt lgkmcnt(10)
    v_mfma_f32_16x16x32_bf16 v[120:123], v[192:195], v[44:47], v[120:123]
    ds_read_b64_tr_b16 v[220:221], v39 offset:12288
    ds_read_b64_tr_b16 v[222:223], v39 offset:12800
    v_mfma_f32_16x16x32_bf16 v[124:127], v[196:199], v[44:47], v[124:127]
    v_xor_b32 v36, 114688, v36
    ds_read_b64_tr_b16 v[192:193], v36
    ds_read_b64_tr_b16 v[194:195], v36 offset:512
    s_waitcnt lgkmcnt(10)
    v_mfma_f32_16x16x32_bf16 v[128:131], v[200:203], v[44:47], v[128:131]
    v_xor_b32 v37, 114688, v37
    ds_read_b64_tr_b16 v[196:197], v37
    ds_read_b64_tr_b16 v[198:199], v37 offset:512
    v_mfma_f32_16x16x32_bf16 v[132:135], v[204:207], v[44:47], v[132:135]
    v_xor_b32 v38, 114688, v38
    ds_read_b64_tr_b16 v[200:201], v38
    ds_read_b64_tr_b16 v[202:203], v38 offset:512
    buffer_load_dwordx4 v[44:47], v2, s[32:35], s20 offen offset:2048 sc1
    s_waitcnt vmcnt(7)
    s_waitcnt lgkmcnt(10)
    v_mfma_f32_16x16x32_bf16 v[120:123], v[208:211], v[48:51], v[120:123]
    v_xor_b32 v39, 114688, v39
    ds_read_b64_tr_b16 v[204:205], v39
    ds_read_b64_tr_b16 v[206:207], v39 offset:512
    v_mfma_f32_16x16x32_bf16 v[124:127], v[212:215], v[48:51], v[124:127]
    ds_read_b64_tr_b16 v[208:209], v36 offset:4096
    ds_read_b64_tr_b16 v[210:211], v36 offset:4608
    s_waitcnt lgkmcnt(10)
    v_mfma_f32_16x16x32_bf16 v[128:131], v[216:219], v[48:51], v[128:131]
    ds_read_b64_tr_b16 v[212:213], v37 offset:4096
    ds_read_b64_tr_b16 v[214:215], v37 offset:4608
    v_mfma_f32_16x16x32_bf16 v[132:135], v[220:223], v[48:51], v[132:135]
    ds_read_b64_tr_b16 v[216:217], v38 offset:4096
    ds_read_b64_tr_b16 v[218:219], v38 offset:4608
    buffer_load_dwordx4 v[48:51], v2, s[32:35], s20 offen offset:3072 sc1
    s_waitcnt vmcnt(7)
    s_waitcnt lgkmcnt(10)
    v_mfma_f32_16x16x32_bf16 v[120:123], v[192:195], v[224:227], v[120:123]
    ds_read_b64_tr_b16 v[220:221], v39 offset:4096
    ds_read_b64_tr_b16 v[222:223], v39 offset:4608
    v_mfma_f32_16x16x32_bf16 v[124:127], v[196:199], v[224:227], v[124:127]
    ds_read_b64_tr_b16 v[192:193], v36 offset:8192
    ds_read_b64_tr_b16 v[194:195], v36 offset:8704
    s_waitcnt lgkmcnt(10)
    v_mfma_f32_16x16x32_bf16 v[128:131], v[200:203], v[224:227], v[128:131]
    ds_read_b64_tr_b16 v[196:197], v37 offset:8192
    ds_read_b64_tr_b16 v[198:199], v37 offset:8704
    v_mfma_f32_16x16x32_bf16 v[132:135], v[204:207], v[224:227], v[132:135]
    ds_read_b64_tr_b16 v[200:201], v38 offset:8192
    ds_read_b64_tr_b16 v[202:203], v38 offset:8704
    s_xor_b32 s96, s17, 24576
    s_add_u32 s20, s96, s19
    buffer_load_dwordx4 v[224:227], v2, s[32:35], s20 offen sc1
    s_waitcnt vmcnt(7)
    s_waitcnt lgkmcnt(10)
    v_mfma_f32_16x16x32_bf16 v[120:123], v[208:211], v[228:231], v[120:123]
    ds_read_b64_tr_b16 v[204:205], v39 offset:8192
    ds_read_b64_tr_b16 v[206:207], v39 offset:8704
    v_mfma_f32_16x16x32_bf16 v[124:127], v[212:215], v[228:231], v[124:127]
    ds_read_b64_tr_b16 v[208:209], v36 offset:12288
    ds_read_b64_tr_b16 v[210:211], v36 offset:12800
    s_waitcnt lgkmcnt(10)
    v_mfma_f32_16x16x32_bf16 v[128:131], v[216:219], v[228:231], v[128:131]
    ds_read_b64_tr_b16 v[212:213], v37 offset:12288
    ds_read_b64_tr_b16 v[214:215], v37 offset:12800
    v_mfma_f32_16x16x32_bf16 v[132:135], v[220:223], v[228:231], v[132:135]
    ds_read_b64_tr_b16 v[216:217], v38 offset:12288
    ds_read_b64_tr_b16 v[218:219], v38 offset:12800
    buffer_load_dwordx4 v[228:231], v2, s[32:35], s20 offen offset:1024 sc1
    s_waitcnt vmcnt(7)
    s_waitcnt lgkmcnt(10)
    v_mfma_f32_16x16x32_bf16 v[120:123], v[192:195], v[232:235], v[120:123]
    ds_read_b64_tr_b16 v[220:221], v39 offset:12288
    ds_read_b64_tr_b16 v[222:223], v39 offset:12800
    v_mfma_f32_16x16x32_bf16 v[124:127], v[196:199], v[232:235], v[124:127]
    v_xor_b32 v36, 16384, v36
    ds_read_b64_tr_b16 v[192:193], v36
    ds_read_b64_tr_b16 v[194:195], v36 offset:512
    s_waitcnt lgkmcnt(10)
    v_mfma_f32_16x16x32_bf16 v[128:131], v[200:203], v[232:235], v[128:131]
    v_xor_b32 v37, 16384, v37
    ds_read_b64_tr_b16 v[196:197], v37
    ds_read_b64_tr_b16 v[198:199], v37 offset:512
    v_mfma_f32_16x16x32_bf16 v[132:135], v[204:207], v[232:235], v[132:135]
    v_xor_b32 v38, 16384, v38
    ds_read_b64_tr_b16 v[200:201], v38
    ds_read_b64_tr_b16 v[202:203], v38 offset:512
    buffer_load_dwordx4 v[232:235], v2, s[32:35], s20 offen offset:2048 sc1
    s_waitcnt vmcnt(7)
    s_waitcnt lgkmcnt(10)
    v_mfma_f32_16x16x32_bf16 v[120:123], v[208:211], v[236:239], v[120:123]
    v_xor_b32 v39, 16384, v39
    ds_read_b64_tr_b16 v[204:205], v39
    ds_read_b64_tr_b16 v[206:207], v39 offset:512
    v_mfma_f32_16x16x32_bf16 v[124:127], v[212:215], v[236:239], v[124:127]
    ds_read_b64_tr_b16 v[208:209], v36 offset:4096
    ds_read_b64_tr_b16 v[210:211], v36 offset:4608
    s_waitcnt lgkmcnt(10)
    v_mfma_f32_16x16x32_bf16 v[128:131], v[216:219], v[236:239], v[128:131]
    ds_read_b64_tr_b16 v[212:213], v37 offset:4096
    ds_read_b64_tr_b16 v[214:215], v37 offset:4608
    v_mfma_f32_16x16x32_bf16 v[132:135], v[220:223], v[236:239], v[132:135]
    ds_read_b64_tr_b16 v[216:217], v38 offset:4096
    ds_read_b64_tr_b16 v[218:219], v38 offset:4608
    buffer_load_dwordx4 v[236:239], v2, s[32:35], s20 offen offset:3072 sc1
    s_waitcnt vmcnt(7)
    s_waitcnt lgkmcnt(10)
    v_mfma_f32_16x16x32_bf16 v[120:123], v[192:195], v[240:243], v[120:123]
    ds_read_b64_tr_b16 v[220:221], v39 offset:4096
    ds_read_b64_tr_b16 v[222:223], v39 offset:4608
    v_mfma_f32_16x16x32_bf16 v[124:127], v[196:199], v[240:243], v[124:127]
    ds_read_b64_tr_b16 v[192:193], v36 offset:8192
    ds_read_b64_tr_b16 v[194:195], v36 offset:8704
    s_waitcnt lgkmcnt(10)
    v_mfma_f32_16x16x32_bf16 v[128:131], v[200:203], v[240:243], v[128:131]
    ds_read_b64_tr_b16 v[196:197], v37 offset:8192
    ds_read_b64_tr_b16 v[198:199], v37 offset:8704
    v_mfma_f32_16x16x32_bf16 v[132:135], v[204:207], v[240:243], v[132:135]
    ds_read_b64_tr_b16 v[200:201], v38 offset:8192
    ds_read_b64_tr_b16 v[202:203], v38 offset:8704
    s_xor_b32 s96, s17, 28672
    s_add_u32 s20, s96, s19
    buffer_load_dwordx4 v[240:243], v2, s[32:35], s20 offen sc1
    s_waitcnt vmcnt(7)
    s_waitcnt lgkmcnt(10)
    v_mfma_f32_16x16x32_bf16 v[120:123], v[208:211], v[244:247], v[120:123]
    ds_read_b64_tr_b16 v[204:205], v39 offset:8192
    ds_read_b64_tr_b16 v[206:207], v39 offset:8704
    v_mfma_f32_16x16x32_bf16 v[124:127], v[212:215], v[244:247], v[124:127]
    ds_read_b64_tr_b16 v[208:209], v36 offset:12288
    ds_read_b64_tr_b16 v[210:211], v36 offset:12800
    s_waitcnt lgkmcnt(10)
    v_mfma_f32_16x16x32_bf16 v[128:131], v[216:219], v[244:247], v[128:131]
    ds_read_b64_tr_b16 v[212:213], v37 offset:12288
    ds_read_b64_tr_b16 v[214:215], v37 offset:12800
    v_mfma_f32_16x16x32_bf16 v[132:135], v[220:223], v[244:247], v[132:135]
    ds_read_b64_tr_b16 v[216:217], v38 offset:12288
    ds_read_b64_tr_b16 v[218:219], v38 offset:12800
    buffer_load_dwordx4 v[244:247], v2, s[32:35], s20 offen offset:1024 sc1
    s_waitcnt vmcnt(7)
    s_waitcnt lgkmcnt(10)
    v_mfma_f32_16x16x32_bf16 v[120:123], v[192:195], v[44:47], v[120:123]
    ds_read_b64_tr_b16 v[220:221], v39 offset:12288
    ds_read_b64_tr_b16 v[222:223], v39 offset:12800
    v_mfma_f32_16x16x32_bf16 v[124:127], v[196:199], v[44:47], v[124:127]
    v_xor_b32 v36, 49152, v36
    ds_read_b64_tr_b16 v[192:193], v36
    ds_read_b64_tr_b16 v[194:195], v36 offset:512
    s_waitcnt lgkmcnt(10)
    v_mfma_f32_16x16x32_bf16 v[128:131], v[200:203], v[44:47], v[128:131]
    v_xor_b32 v37, 49152, v37
    ds_read_b64_tr_b16 v[196:197], v37
    ds_read_b64_tr_b16 v[198:199], v37 offset:512
    v_mfma_f32_16x16x32_bf16 v[132:135], v[204:207], v[44:47], v[132:135]
    v_xor_b32 v38, 49152, v38
    ds_read_b64_tr_b16 v[200:201], v38
    ds_read_b64_tr_b16 v[202:203], v38 offset:512
    buffer_load_dwordx4 v[44:47], v2, s[32:35], s20 offen offset:2048 sc1
    s_waitcnt vmcnt(7)
    s_waitcnt lgkmcnt(10)
    v_mfma_f32_16x16x32_bf16 v[120:123], v[208:211], v[48:51], v[120:123]
    v_xor_b32 v39, 49152, v39
    ds_read_b64_tr_b16 v[204:205], v39
    ds_read_b64_tr_b16 v[206:207], v39 offset:512
    v_mfma_f32_16x16x32_bf16 v[124:127], v[212:215], v[48:51], v[124:127]
    ds_read_b64_tr_b16 v[208:209], v36 offset:4096
    ds_read_b64_tr_b16 v[210:211], v36 offset:4608
    s_waitcnt lgkmcnt(10)
    v_mfma_f32_16x16x32_bf16 v[128:131], v[216:219], v[48:51], v[128:131]
    ds_read_b64_tr_b16 v[212:213], v37 offset:4096
    ds_read_b64_tr_b16 v[214:215], v37 offset:4608
    v_mfma_f32_16x16x32_bf16 v[132:135], v[220:223], v[48:51], v[132:135]
    ds_read_b64_tr_b16 v[216:217], v38 offset:4096
    ds_read_b64_tr_b16 v[218:219], v38 offset:4608
    buffer_load_dwordx4 v[48:51], v2, s[32:35], s20 offen offset:3072 sc1
    buffer_load_dwordx2 v[40:41], v10, s[32:35], s13 offen sc1
    s_cmp_ge_u32 s3, 4
    s_cbranch_scc1 L_FH_31
    s_mov_b32 s82, s80
    buffer_load_dwordx4 v[56:59], v27, s[56:59], s82 offen nt
    s_add_u32 s82, s80, 917504
    buffer_load_dwordx4 v[60:63], v27, s[56:59], s82 offen nt
L_FH_31:
    s_waitcnt vmcnt(8)
    s_waitcnt lgkmcnt(10)
    v_mfma_f32_16x16x32_bf16 v[120:123], v[192:195], v[224:227], v[120:123]
    ds_read_b64_tr_b16 v[220:221], v39 offset:4096
    ds_read_b64_tr_b16 v[222:223], v39 offset:4608
    v_mfma_f32_16x16x32_bf16 v[124:127], v[196:199], v[224:227], v[124:127]
    ds_read_b64_tr_b16 v[192:193], v36 offset:8192
    ds_read_b64_tr_b16 v[194:195], v36 offset:8704
    s_waitcnt lgkmcnt(10)
    v_mfma_f32_16x16x32_bf16 v[128:131], v[200:203], v[224:227], v[128:131]
    ds_read_b64_tr_b16 v[196:197], v37 offset:8192
    ds_read_b64_tr_b16 v[198:199], v37 offset:8704
    v_mfma_f32_16x16x32_bf16 v[132:135], v[204:207], v[224:227], v[132:135]
    ds_read_b64_tr_b16 v[200:201], v38 offset:8192
    ds_read_b64_tr_b16 v[202:203], v38 offset:8704
    s_waitcnt vmcnt(7)
    s_waitcnt lgkmcnt(10)
    v_mfma_f32_16x16x32_bf16 v[120:123], v[208:211], v[228:231], v[120:123]
    ds_read_b64_tr_b16 v[204:205], v39 offset:8192
    ds_read_b64_tr_b16 v[206:207], v39 offset:8704
    v_mfma_f32_16x16x32_bf16 v[124:127], v[212:215], v[228:231], v[124:127]
    ds_read_b64_tr_b16 v[208:209], v36 offset:12288
    ds_read_b64_tr_b16 v[210:211], v36 offset:12800
    s_waitcnt lgkmcnt(10)
    v_mfma_f32_16x16x32_bf16 v[128:131], v[216:219], v[228:231], v[128:131]
    ds_read_b64_tr_b16 v[212:213], v37 offset:12288
    ds_read_b64_tr_b16 v[214:215], v37 offset:12800
    v_mfma_f32_16x16x32_bf16 v[132:135], v[220:223], v[228:231], v[132:135]
    ds_read_b64_tr_b16 v[216:217], v38 offset:12288
    ds_read_b64_tr_b16 v[218:219], v38 offset:12800
    s_waitcnt vmcnt(6)
    s_waitcnt lgkmcnt(10)
    v_mfma_f32_16x16x32_bf16 v[120:123], v[192:195], v[232:235], v[120:123]
    ds_read_b64_tr_b16 v[220:221], v39 offset:12288
    ds_read_b64_tr_b16 v[222:223], v39 offset:12800
    v_mfma_f32_16x16x32_bf16 v[124:127], v[196:199], v[232:235], v[124:127]
    v_xor_b32 v36, 16384, v36
    ds_read_b64_tr_b16 v[192:193], v36
    ds_read_b64_tr_b16 v[194:195], v36 offset:512
    s_waitcnt lgkmcnt(10)
    v_mfma_f32_16x16x32_bf16 v[128:131], v[200:203], v[232:235], v[128:131]
    v_xor_b32 v37, 16384, v37
    ds_read_b64_tr_b16 v[196:197], v37
    ds_read_b64_tr_b16 v[198:199], v37 offset:512
    v_mfma_f32_16x16x32_bf16 v[132:135], v[204:207], v[232:235], v[132:135]
    v_xor_b32 v38, 16384, v38
    ds_read_b64_tr_b16 v[200:201], v38
    ds_read_b64_tr_b16 v[202:203], v38 offset:512
    s_waitcnt vmcnt(5)
    s_waitcnt lgkmcnt(10)
    v_mfma_f32_16x16x32_bf16 v[120:123], v[208:211], v[236:239], v[120:123]
    v_xor_b32 v39, 16384, v39
    ds_read_b64_tr_b16 v[204:205], v39
    ds_read_b64_tr_b16 v[206:207], v39 offset:512
    v_mfma_f32_16x16x32_bf16 v[124:127], v[212:215], v[236:239], v[124:127]
    ds_read_b64_tr_b16 v[208:209], v36 offset:4096
    ds_read_b64_tr_b16 v[210:211], v36 offset:4608
    s_waitcnt lgkmcnt(10)
    v_mfma_f32_16x16x32_bf16 v[128:131], v[216:219], v[236:239], v[128:131]
    ds_read_b64_tr_b16 v[212:213], v37 offset:4096
    ds_read_b64_tr_b16 v[214:215], v37 offset:4608
    v_mfma_f32_16x16x32_bf16 v[132:135], v[220:223], v[236:239], v[132:135]
    ds_read_b64_tr_b16 v[216:217], v38 offset:4096
    ds_read_b64_tr_b16 v[218:219], v38 offset:4608
    s_waitcnt vmcnt(4)
    s_waitcnt lgkmcnt(10)
    v_mfma_f32_16x16x32_bf16 v[120:123], v[192:195], v[240:243], v[120:123]
    ds_read_b64_tr_b16 v[220:221], v39 offset:4096
    ds_read_b64_tr_b16 v[222:223], v39 offset:4608
    v_mfma_f32_16x16x32_bf16 v[124:127], v[196:199], v[240:243], v[124:127]
    ds_read_b64_tr_b16 v[192:193], v36 offset:8192
    ds_read_b64_tr_b16 v[194:195], v36 offset:8704
    s_waitcnt lgkmcnt(10)
    v_mfma_f32_16x16x32_bf16 v[128:131], v[200:203], v[240:243], v[128:131]
    ds_read_b64_tr_b16 v[196:197], v37 offset:8192
    ds_read_b64_tr_b16 v[198:199], v37 offset:8704
    v_mfma_f32_16x16x32_bf16 v[132:135], v[204:207], v[240:243], v[132:135]
    ds_read_b64_tr_b16 v[200:201], v38 offset:8192
    ds_read_b64_tr_b16 v[202:203], v38 offset:8704
    s_waitcnt vmcnt(3)
    s_waitcnt lgkmcnt(10)
    v_mfma_f32_16x16x32_bf16 v[120:123], v[208:211], v[244:247], v[120:123]
    ds_read_b64_tr_b16 v[204:205], v39 offset:8192
    ds_read_b64_tr_b16 v[206:207], v39 offset:8704
    v_mfma_f32_16x16x32_bf16 v[124:127], v[212:215], v[244:247], v[124:127]
    ds_read_b64_tr_b16 v[208:209], v36 offset:12288
    ds_read_b64_tr_b16 v[210:211], v36 offset:12800
    s_waitcnt lgkmcnt(10)
    v_mfma_f32_16x16x32_bf16 v[128:131], v[216:219], v[244:247], v[128:131]
    ds_read_b64_tr_b16 v[212:213], v37 offset:12288
    ds_read_b64_tr_b16 v[214:215], v37 offset:12800
    v_mfma_f32_16x16x32_bf16 v[132:135], v[220:223], v[244:247], v[132:135]
    ds_read_b64_tr_b16 v[216:217], v38 offset:12288
    ds_read_b64_tr_b16 v[218:219], v38 offset:12800
    s_waitcnt vmcnt(2)
    s_waitcnt lgkmcnt(10)
    v_mfma_f32_16x16x32_bf16 v[120:123], v[192:195], v[44:47], v[120:123]
    ds_read_b64_tr_b16 v[220:221], v39 offset:12288
    ds_read_b64_tr_b16 v[222:223], v39 offset:12800
    v_mfma_f32_16x16x32_bf16 v[124:127], v[196:199], v[44:47], v[124:127]
    s_waitcnt lgkmcnt(8)
    v_mfma_f32_16x16x32_bf16 v[128:131], v[200:203], v[44:47], v[128:131]
    v_mfma_f32_16x16x32_bf16 v[132:135], v[204:207], v[44:47], v[132:135]
    s_waitcnt vmcnt(1)
    s_waitcnt lgkmcnt(4)
    v_mfma_f32_16x16x32_bf16 v[120:123], v[208:211], v[48:51], v[120:123]
    v_mfma_f32_16x16x32_bf16 v[124:127], v[212:215], v[48:51], v[124:127]
    s_waitcnt lgkmcnt(0)
    v_mfma_f32_16x16x32_bf16 v[128:131], v[216:219], v[48:51], v[128:131]
    v_mfma_f32_16x16x32_bf16 v[132:135], v[220:223], v[48:51], v[132:135]
    s_lshl3_add_u32 s96, s21, s3
    s_lshl4_add_u32 s97, s96, s12
    s_lshl_b32 s98, s97, 8
    s_add_u32 s14, s98, 12582912
    v_and_b32 v28, 15, v1
    v_lshlrev_b32 v28, 4, v28
    v_lshrrev_b32 v9, 4, v1
    v_lshl_add_u32 v28, v9, 2, v28
    v_cvt_pk_bf16_f32 v120, 0, v120
    v_cvt_pk_bf16_f32 v121, 0, v121
    v_cvt_pk_bf16_f32 v122, 0, v122
    v_cvt_pk_bf16_f32 v123, 0, v123
    v_cvt_pk_bf16_f32 v124, 0, v124
    v_cvt_pk_bf16_f32 v125, 0, v125
    v_cvt_pk_bf16_f32 v126, 0, v126
    v_cvt_pk_bf16_f32 v127, 0, v127
    v_pk_mul_f32 v[120:121], v[120:121], v[136:137]
    v_pk_mul_f32 v[122:123], v[122:123], v[138:139]
    v_pk_mul_f32 v[124:125], v[124:125], v[140:141]
    v_pk_mul_f32 v[126:127], v[126:127], v[142:143]
    v_cvt_pk_bf16_f32 v120, 0, v120
    v_cvt_pk_bf16_f32 v121, 0, v121
    v_cvt_pk_bf16_f32 v122, 0, v122
    v_cvt_pk_bf16_f32 v123, 0, v123
    v_cvt_pk_bf16_f32 v124, 0, v124
    v_cvt_pk_bf16_f32 v125, 0, v125
    v_cvt_pk_bf16_f32 v126, 0, v126
    v_cvt_pk_bf16_f32 v127, 0, v127
    v_pk_add_f32 v[120:121], v[120:121], v[152:153]
    v_pk_add_f32 v[122:123], v[122:123], v[154:155]
    v_pk_add_f32 v[124:125], v[124:125], v[156:157]
    v_pk_add_f32 v[126:127], v[126:127], v[158:159]
    v_cvt_pk_bf16_f32 v12, v120, v121
    v_cvt_pk_bf16_f32 v13, v122, v123
    v_cvt_pk_bf16_f32 v14, v124, v125
    v_cvt_pk_bf16_f32 v15, v126, v127
    v_dot2_f32_bf16 v4, v12, v12, 0
    v_dot2_f32_bf16 v5, v13, v13, 0
    v_dot2_f32_bf16 v4, v14, v14, v4
    v_dot2_f32_bf16 v5, v15, v15, v5
    v_mfma_f32_16x16x32_bf16 v[240:243], v[184:187], v[12:15], 0
    v_cvt_pk_bf16_f32 v128, 0, v128
    v_cvt_pk_bf16_f32 v129, 0, v129
    v_cvt_pk_bf16_f32 v130, 0, v130
    v_cvt_pk_bf16_f32 v131, 0, v131
    v_cvt_pk_bf16_f32 v132, 0, v132
    v_cvt_pk_bf16_f32 v133, 0, v133
    v_cvt_pk_bf16_f32 v134, 0, v134
    v_cvt_pk_bf16_f32 v135, 0, v135
    v_pk_mul_f32 v[128:129], v[128:129], v[144:145]
    v_pk_mul_f32 v[130:131], v[130:131], v[146:147]
    v_pk_mul_f32 v[132:133], v[132:133], v[148:149]
    v_pk_mul_f32 v[134:135], v[134:135], v[150:151]
    v_cvt_pk_bf16_f32 v128, 0, v128
    v_cvt_pk_bf16_f32 v129, 0, v129
    v_cvt_pk_bf16_f32 v130, 0, v130
    v_cvt_pk_bf16_f32 v131, 0, v131
    v_cvt_pk_bf16_f32 v132, 0, v132
    v_cvt_pk_bf16_f32 v133, 0, v133
    v_cvt_pk_bf16_f32 v134, 0, v134
    v_cvt_pk_bf16_f32 v135, 0, v135
    v_pk_add_f32 v[128:129], v[128:129], v[160:161]
    v_pk_add_f32 v[130:131], v[130:131], v[162:163]
    v_pk_add_f32 v[132:133], v[132:133], v[164:165]
    v_pk_add_f32 v[134:135], v[134:135], v[166:167]
    v_cvt_pk_bf16_f32 v16, v128, v129
    v_cvt_pk_bf16_f32 v17, v130, v131
    v_cvt_pk_bf16_f32 v18, v132, v133
    v_cvt_pk_bf16_f32 v19, v134, v135
    v_dot2_f32_bf16 v4, v16, v16, v4
    v_dot2_f32_bf16 v5, v17, v17, v5
    v_dot2_f32_bf16 v4, v18, v18, v4
    v_dot2_f32_bf16 v5, v19, v19, v5
    v_mfma_f32_16x16x32_bf16 v[240:243], v[188:191], v[16:19], v[240:243]
    v_and_b32 v7, 7, v1
    v_lshlrev_b32 v7, 15, v7
    v_bfe_u32 v9, v1, 3, 1
    v_lshl_add_u32 v7, v9, 12, v7
    v_add_f32 v4, v4, v5
    v_mov_b32 v5, v4
    s_nop 1
    v_permlane32_swap_b32 v4, v5
    v_add_f32 v4, v4, v5
    v_mov_b32 v5, v4
    s_nop 1
    v_permlane16_swap_b32 v4, v5
    v_add_f32 v4, v4, v5
    s_nop 1
    v_mov_b32_dpp v240, v4 quad_perm:[0,1,2,3] row_mask:0x8 bank_mask:0xf
    buffer_store_dword v240, v28, s[32:35], s14 offen sc1
    s_and_b32 s96, s12, 1
    s_lshr_b32 s97, s21, 2
    s_and_b32 s98, s21, 3
    s_lshl_b32 s99, s98, 6
    s_lshl1_add_u32 s98, s97, s99
    s_lshl_b32 s97, s98, 12
    s_lshr_b32 s99, s12, 1
    s_lshl_b32 s98, s99, 6
    s_add_u32 s99, s97, s98
    s_lshl2_add_u32 s97, s96, s99
    s_add_u32 s98, s97, 1048576
    s_add_u32 s16, s98, 1536
    s_barrier
    s_cmp_lg_u32 s3, 0
    s_cbranch_scc1 L_PE
    v_mov_b32 v6, s4
    s_mov_b32 exec_hi, 0
    s_mov_b32 exec_lo, 65535
    buffer_store_dword v6, v7, s[32:35], s16 offen sc1
    s_mov_b64 exec, -1
L_PE:
    s_add_u32 s82, s80, 57344
    s_lshl2_add_u32 m0, s83, 33792
    s_nop 0
    buffer_load_dwordx4 v27, s[56:59], s82 offen nt lds
    s_add_u32 s82, s80, 114688
    s_lshl2_add_u32 m0, s83, 34816
    s_nop 0
    buffer_load_dwordx4 v27, s[56:59], s82 offen nt lds
    s_lshl_b32 s15, s3, 12
    v_add_u32 v4, s15, v2
    v_add_u32 v7, 65536, v4
    s_waitcnt vmcnt(3)
    v_cmp_ne_u32 vcc, s4, v41
    s_cbranch_vccz L_UPOK
POLL_32:
    buffer_load_dwordx2 v[40:41], v10, s[32:35], s13 offen sc1
    s_waitcnt vmcnt(0)
    v_cmp_ne_u32 vcc, s4, v41
    s_cbranch_vccz PDONE_33
    s_add_u32 s5, s5, 1
    s_cmp_lt_u32 s5, 200000
    s_cbranch_scc1 POLL_32
PDONE_33:
L_UPOK:
    s_lshl3_add_u32 s96, s21, s3
    s_lshl_b32 s97, s96, 12
    s_add_u32 s14, s97, 12582912
    s_load_dwordx2 s[24:25], s[32:33], s92 offset:1536 glc
    v_add_f32_dpp v40, v40, v40 quad_perm:[1,0,3,2] row_mask:0xf bank_mask:0xf
    s_nop 1
    v_add_f32_dpp v40, v40, v40 quad_perm:[2,3,0,1] row_mask:0xf bank_mask:0xf
    s_nop 1
    v_add_f32_dpp v40, v40, v40 row_half_mirror row_mask:0xf bank_mask:0xf
    s_nop 1
    v_add_f32_dpp v40, v40, v40 row_mirror row_mask:0xf bank_mask:0xf
    v_lshlrev_b32 v152, 16, v12
    v_and_b32 v153, s6, v12
    v_lshlrev_b32 v154, 16, v13
    v_and_b32 v155, s6, v13
    v_lshlrev_b32 v156, 16, v14
    v_and_b32 v157, s6, v14
    v_lshlrev_b32 v158, 16, v15
    v_and_b32 v159, s6, v15
    v_lshlrev_b32 v160, 16, v16
    v_and_b32 v161, s6, v16
    v_lshlrev_b32 v162, 16, v17
    v_and_b32 v163, s6, v17
    v_lshlrev_b32 v164, 16, v18
    v_and_b32 v165, s6, v18
    v_lshlrev_b32 v166, 16, v19
    v_and_b32 v167, s6, v19
    s_lshl_b32 s96, s3, 9
    s_lshl1_add_u32 s15, s21, s96
    v_and_b32 v29, 15, v1
    v_lshl_add_u32 v29, v29, 5, s15
    v_xor_b32 v5, 0x4000, v4
    v_xor_b32 v8, 0x4000, v7
    s_waitcnt vmcnt(2)
    s_cmp_ge_u32 s3, 4
    s_cbranch_scc1 L_FW0
    ds_write_b128 v4, v[56:59] offset:32768
    ds_write_b128 v5, v[60:63] offset:32768
L_FW0:
    s_cmp_lt_u32 s3, 4
    s_cbranch_scc1 L_FW1
    ds_write_b128 v4, v[56:59] offset:0
    ds_write_b128 v5, v[60:63] offset:0
    ds_write_b128 v4, v[64:67] offset:1024
    ds_write_b128 v5, v[68:71] offset:1024
    ds_write_b128 v4, v[72:75] offset:2048
    ds_write_b128 v5, v[76:79] offset:2048
    ds_write_b128 v4, v[80:83] offset:3072
    ds_write_b128 v5, v[84:87] offset:3072
L_FW1:
    s_branch SCHK_35
SPOLL_34:
    s_load_dwordx2 s[24:25], s[32:33], s92 offset:1536 glc
SCHK_35:
    s_add_u32 s5, s5, 1
    s_cmp_ge_u32 s5, 200000
    s_waitcnt lgkmcnt(0)
    s_cbranch_scc1 SDONE_36
    s_cmp_lg_u32 s24, s4
    s_cbranch_scc1 SPOLL_34
    s_cmp_lg_u32 s25, s4
    s_cbranch_scc1 SPOLL_34
SDONE_36:
    s_barrier
    buffer_load_dwordx4 v[192:195], v2, s[32:35], s14 offen sc1
    buffer_load_dwordx4 v[196:199], v2, s[32:35], s14 offen offset:1024 sc1
    buffer_load_dwordx4 v[200:203], v2, s[32:35], s14 offen offset:2048 sc1
    buffer_load_dwordx4 v[204:207], v2, s[32:35], s14 offen offset:3072 sc1
    s_barrier
    s_add_u32 s82, s80, 172032
    s_lshl2_add_u32 m0, s83, 35840
    s_nop 0
    buffer_load_dwordx4 v27, s[56:59], s82 offen nt lds
    s_mov_b32 s82, s81
    s_lshl2_add_u32 m0, s83, 65536
    s_nop 0
    buffer_load_dwordx4 v253, s[60:63], s82 offen nt lds
    s_add_u32 s82, s81, 4096
    s_lshl2_add_u32 m0, s83, 66560
L_PAD9:
    s_cbranch_execz L_RET9
    s_nop 0
    buffer_load_dwordx4 v253, s[60:63], s82 offen nt lds
    s_add_u32 s82, s81, 8192
    s_lshl2_add_u32 m0, s83, 67584
    s_nop 0
    buffer_load_dwordx4 v253, s[60:63], s82 offen nt lds
    s_lshl3_add_u32 s15, s3, 156160
    v_mov_b32 v4, s15
    v_and_b32 v5, 7, v1
    v_lshlrev_b32 v5, 3, v5
    v_add_u32 v5, 156160, v5
    v_and_b32 v6, 3, v1
    v_lshlrev_b32 v6, 18, v6
    v_bfe_u32 v9, v1, 2, 2
    v_lshl_add_u32 v6, v9, 13, v6
    s_and_b32 s96, s21, 1
    s_and_b32 s97, s12, 7
    s_lshr_b32 s98, s12, 3
    s_lshl3_add_u32 s99, s97, s98
    s_lshl_b32 s97, s99, 12
    s_lshr_b32 s98, s21, 1
    s_lshl_b32 s99, s98, 6
    s_add_u32 s98, s97, s99
    s_lshl4_add_u32 s97, s96, s98
    s_add_u32 s99, s97, 1048576
    s_add_u32 s16, s99, 2560
    s_waitcnt vmcnt(4)
    v_pk_add_f32 v[192:193], v[192:193], v[196:197]
    v_pk_add_f32 v[200:201], v[200:201], v[204:205]
    v_pk_add_f32 v[194:195], v[194:195], v[198:199]
    v_pk_add_f32 v[202:203], v[202:203], v[206:207]
    v_pk_add_f32 v[192:193], v[192:193], v[200:201]
    v_pk_add_f32 v[194:195], v[194:195], v[202:203]
    v_add_f32 v193, v193, v194
    v_add_f32 v197, v192, v195
    v_cmp_u_f32 vcc, v193, v197
    s_cbranch_vccz POK_38
PRE_39:
    buffer_load_dwordx4 v[192:195], v2, s[32:35], s14 offen sc1
    buffer_load_dwordx4 v[196:199], v2, s[32:35], s14 offen offset:1024 sc1
    buffer_load_dwordx4 v[200:203], v2, s[32:35], s14 offen offset:2048 sc1
    buffer_load_dwordx4 v[204:207], v2, s[32:35], s14 offen offset:3072 sc1
    s_waitcnt vmcnt(0)
    v_pk_add_f32 v[192:193], v[192:193], v[196:197]
    v_pk_add_f32 v[200:201], v[200:201], v[204:205]
    v_pk_add_f32 v[194:195], v[194:195], v[198:199]
    v_pk_add_f32 v[202:203], v[202:203], v[206:207]
    v_pk_add_f32 v[192:193], v[192:193], v[200:201]
    v_pk_add_f32 v[194:195], v[194:195], v[202:203]
    v_add_f32 v193, v193, v194
    v_add_f32 v197, v192, v195
    v_cmp_u_f32 vcc, v193, v197
    s_cbranch_vccz POK_38
    s_add_u32 s5, s5, 1
    s_cmp_lt_u32 s5, 200000
    s_cbranch_scc1 PRE_39
POK_38:
    v_mov_b32 v196, v195
    s_nop 1
    v_permlane32_swap_b32 v195, v196
    v_permlane32_swap_b32 v192, v193
    v_add_f32 v195, v195, v196
    v_add_f32 v192, v192, v193
    s_nop 1
    v_permlane16_swap_b32 v192, v195
    v_add_f32 v193, v192, v195
    v_add_f32 v195, v192, v195
    s_nop 1
    v_permlane16_swap_b32 v193, v195
    v_mov_b32 v192, v193
    v_mul_f32 v195, 0x3a800000, v195
    s_nop 0
    v_permlane32_swap_b32 v192, v193
    v_mul_f32 v192, 0x3a800000, v192
    v_fma_f32 v31, -v192, v192, v195
    v_cvt_pk_bf16_f32 v30, 0, v192
    v_max_f32 v31, 0, v31
    v_cvt_pk_bf16_f32 v31, 0, v31
    v_fma_f32 v193, -v30, v40, v193
    v_add_f32 v31, 0x3727c5ac, v31
    v_cvt_pk_bf16_f32 v31, 0, v31
    v_sqrt_f32 v31, v31
    s_nop 0
    v_cvt_pk_bf16_f32 v31, 0, v31
    v_rcp_f32 v31, v31
    s_nop 0
    v_mul_f32 v32, v193, v31
    v_ashrrev_i32 v196, 31, v32
    v_or_b32 v196, 0x80000000, v196
    v_xor_b32 v32, v32, v196
    s_mov_b32 s15, 0xfffff000
    v_and_or_b32 v32, v32, s15, v29
    s_nop 1
    v_max_u32_dpp v244, v32, v32 quad_perm:[1,0,3,2] row_mask:0xf bank_mask:0xf
    v_min_u32_dpp v245, v32, v32 quad_perm:[1,0,3,2] row_mask:0xf bank_mask:0xf
    s_nop 0
    v_min_u32_dpp v196, v244, v244 quad_perm:[2,3,0,1] row_mask:0xf bank_mask:0xf
    v_max_u32_dpp v245, v245, v245 quad_perm:[2,3,0,1] row_mask:0xf bank_mask:0xf
    v_max_u32_dpp v244, v244, v244 quad_perm:[2,3,0,1] row_mask:0xf bank_mask:0xf
    v_max_u32 v245, v245, v196
    s_nop 0
    v_min_u32_dpp v196, v244, v244 row_half_mirror row_mask:0xf bank_mask:0xf
    v_max_u32_dpp v245, v245, v245 row_half_mirror row_mask:0xf bank_mask:0xf
    v_max_u32_dpp v244, v244, v244 row_half_mirror row_mask:0xf bank_mask:0xf
    v_max_u32 v245, v245, v196
    s_nop 0
    v_min_u32_dpp v196, v244, v244 row_mirror row_mask:0xf bank_mask:0xf
    v_max_u32_dpp v245, v245, v245 row_mirror row_mask:0xf bank_mask:0xf
    v_max_u32_dpp v244, v244, v244 row_mirror row_mask:0xf bank_mask:0xf
    v_max_u32 v245, v245, v196
    ds_write_b64 v4, v[244:245]
    s_waitcnt lgkmcnt(0)
    s_barrier
    ds_read_b64 v[244:245], v5
    v_pk_add_f32 v[208:209], v[152:153], v[30:31] op_sel_hi:[1,0] neg_lo:[0,1] neg_hi:[0,1]
    v_pk_add_f32 v[210:211], v[154:155], v[30:31] op_sel_hi:[1,0] neg_lo:[0,1] neg_hi:[0,1]
    v_pk_add_f32 v[212:213], v[156:157], v[30:31] op_sel_hi:[1,0] neg_lo:[0,1] neg_hi:[0,1]
    v_pk_add_f32 v[214:215], v[158:159], v[30:31] op_sel_hi:[1,0] neg_lo:[0,1] neg_hi:[0,1]
    v_pk_add_f32 v[216:217], v[160:161], v[30:31] op_sel_hi:[1,0] neg_lo:[0,1] neg_hi:[0,1]
    v_pk_add_f32 v[218:219], v[162:163], v[30:31] op_sel_hi:[1,0] neg_lo:[0,1] neg_hi:[0,1]
    v_pk_add_f32 v[220:221], v[164:165], v[30:31] op_sel_hi:[1,0] neg_lo:[0,1] neg_hi:[0,1]
    v_pk_add_f32 v[222:223], v[166:167], v[30:31] op_sel_hi:[1,0] neg_lo:[0,1] neg_hi:[0,1]
    s_waitcnt lgkmcnt(0)
    v_min_u32_dpp v196, v244, v244 quad_perm:[1,0,3,2] row_mask:0xf bank_mask:0xf
    v_max_u32_dpp v245, v245, v245 quad_perm:[1,0,3,2] row_mask:0xf bank_mask:0xf
    v_max_u32_dpp v244, v244, v244 quad_perm:[1,0,3,2] row_mask:0xf bank_mask:0xf
    v_max_u32 v245, v245, v196
    s_nop 0
    v_min_u32_dpp v196, v244, v244 quad_perm:[2,3,0,1] row_mask:0xf bank_mask:0xf
    v_max_u32_dpp v245, v245, v245 quad_perm:[2,3,0,1] row_mask:0xf bank_mask:0xf
    v_max_u32_dpp v244, v244, v244 quad_perm:[2,3,0,1] row_mask:0xf bank_mask:0xf
    v_max_u32 v245, v245, v196
    s_nop 0
    v_min_u32_dpp v196, v244, v244 row_half_mirror row_mask:0xf bank_mask:0xf
    v_max_u32_dpp v245, v245, v245 row_half_mirror row_mask:0xf bank_mask:0xf
    v_max_u32_dpp v244, v244, v244 row_half_mirror row_mask:0xf bank_mask:0xf
    v_max_u32 v245, v245, v196
    v_cmp_eq_u32 s[88:89], v32, v245
    v_cmp_eq_u32 vcc, v32, v244
    v_or_b32 v246, 1, v245
    v_mov_b32 v245, s4
    v_mov_b32 v247, s4
    s_or_b64 s[84:85], vcc, s[88:89]
    s_cmp_lg_u32 s3, 0
    s_cbranch_scc1 L_NOF
    s_mov_b64 exec, 0xffff
    buffer_store_dwordx4 v[244:247], v6, s[32:35], s16 offen sc1
    s_mov_b64 exec, -1
L_NOF:
    s_lshl4_add_u32 s13, s3, 156288
    v_mov_b32 v4, s13
    v_and_b32 v5, 7, v1
    v_lshlrev_b32 v5, 4, v5
    v_add_u32 v5, 156288, v5
    s_load_dwordx8 s[24:31], s[32:33], s92 offset:2560 glc
    v_cvt_pk_bf16_f32 v208, 0, v208
    v_cvt_pk_bf16_f32 v209, 0, v209
    v_cvt_pk_bf16_f32 v210, 0, v210
    v_cvt_pk_bf16_f32 v211, 0, v211
    v_cvt_pk_bf16_f32 v212, 0, v212
    v_cvt_pk_bf16_f32 v213, 0, v213
    v_cvt_pk_bf16_f32 v214, 0, v214
    v_cvt_pk_bf16_f32 v215, 0, v215
    v_cvt_pk_bf16_f32 v216, 0, v216
    v_cvt_pk_bf16_f32 v217, 0, v217
    v_cvt_pk_bf16_f32 v218, 0, v218
    v_cvt_pk_bf16_f32 v219, 0, v219
    v_cvt_pk_bf16_f32 v220, 0, v220
    v_cvt_pk_bf16_f32 v221, 0, v221
    v_cvt_pk_bf16_f32 v222, 0, v222
    v_cvt_pk_bf16_f32 v223, 0, v223
    v_pk_mul_f32 v[208:209], v[208:209], v[30:31] op_sel:[0,1]
    v_pk_mul_f32 v[210:211], v[210:211], v[30:31] op_sel:[0,1]
    v_pk_mul_f32 v[212:213], v[212:213], v[30:31] op_sel:[0,1]
    v_pk_mul_f32 v[214:215], v[214:215], v[30:31] op_sel:[0,1]
    v_pk_mul_f32 v[216:217], v[216:217], v[30:31] op_sel:[0,1]
    v_pk_mul_f32 v[218:219], v[218:219], v[30:31] op_sel:[0,1]
    v_pk_mul_f32 v[220:221], v[220:221], v[30:31] op_sel:[0,1]
    v_pk_mul_f32 v[222:223], v[222:223], v[30:31] op_sel:[0,1]
    v_cvt_pk_bf16_f32 v208, 0, v208
    v_cvt_pk_bf16_f32 v209, 0, v209
    v_cvt_pk_bf16_f32 v210, 0, v210
    v_cvt_pk_bf16_f32 v211, 0, v211
    v_cvt_pk_bf16_f32 v212, 0, v212
    v_cvt_pk_bf16_f32 v213, 0, v213
    v_cvt_pk_bf16_f32 v214, 0, v214
    v_cvt_pk_bf16_f32 v215, 0, v215
    v_cvt_pk_bf16_f32 v216, 0, v216
    v_cvt_pk_bf16_f32 v217, 0, v217
    v_cvt_pk_bf16_f32 v218, 0, v218
    v_cvt_pk_bf16_f32 v219, 0, v219
    v_cvt_pk_bf16_f32 v220, 0, v220
    v_cvt_pk_bf16_f32 v221, 0, v221
    v_cvt_pk_bf16_f32 v222, 0, v222
    v_cvt_pk_bf16_f32 v223, 0, v223
    v_pk_mul_f32 v[208:209], v[208:209], v[168:169]
    v_pk_mul_f32 v[210:211], v[210:211], v[170:171]
    v_pk_mul_f32 v[212:213], v[212:213], v[172:173]
    v_pk_mul_f32 v[214:215], v[214:215], v[174:175]
    v_pk_mul_f32 v[216:217], v[216:217], v[176:177]
    v_pk_mul_f32 v[218:219], v[218:219], v[178:179]
    v_pk_mul_f32 v[220:221], v[220:221], v[180:181]
    v_pk_mul_f32 v[222:223], v[222:223], v[182:183]
    v_cvt_pk_bf16_f32 v208, 0, v208
    v_cvt_pk_bf16_f32 v209, 0, v209
    v_cvt_pk_bf16_f32 v210, 0, v210
    v_cvt_pk_bf16_f32 v211, 0, v211
    v_cvt_pk_bf16_f32 v212, 0, v212
    v_cvt_pk_bf16_f32 v213, 0, v213
    v_cvt_pk_bf16_f32 v214, 0, v214
    v_cvt_pk_bf16_f32 v215, 0, v215
    v_cvt_pk_bf16_f32 v216, 0, v216
    v_cvt_pk_bf16_f32 v217, 0, v217
    v_cvt_pk_bf16_f32 v218, 0, v218
    v_cvt_pk_bf16_f32 v219, 0, v219
    v_cvt_pk_bf16_f32 v220, 0, v220
    v_cvt_pk_bf16_f32 v221, 0, v221
    v_cvt_pk_bf16_f32 v222, 0, v222
    v_cvt_pk_bf16_f32 v223, 0, v223
    v_pk_add_f32 v[208:209], v[208:209], v[88:89]
    v_pk_add_f32 v[210:211], v[210:211], v[90:91]
    v_pk_add_f32 v[212:213], v[212:213], v[92:93]
    v_pk_add_f32 v[214:215], v[214:215], v[94:95]
    v_pk_add_f32 v[216:217], v[216:217], v[96:97]
    v_pk_add_f32 v[218:219], v[218:219], v[98:99]
    v_pk_add_f32 v[220:221], v[220:221], v[100:101]
    v_pk_add_f32 v[222:223], v[222:223], v[102:103]
    v_cvt_pk_bf16_f32 v224, v208, v209
    v_cvt_pk_bf16_f32 v225, v210, v211
    v_cvt_pk_bf16_f32 v226, v212, v213
    v_cvt_pk_bf16_f32 v227, v214, v215
    v_cvt_pk_bf16_f32 v228, v216, v217
    v_cvt_pk_bf16_f32 v229, v218, v219
    v_cvt_pk_bf16_f32 v230, v220, v221
    v_cvt_pk_bf16_f32 v231, v222, v223
    s_cmp_eq_u64 s[84:85], 0
    s_cbranch_scc1 L_NOCAND
    v_mfma_f32_16x16x32_bf16 v[240:243], v[184:187], v[224:227], 0
    v_mfma_f32_16x16x32_bf16 v[240:243], v[188:191], v[228:231], v[240:243]
    v_mov_b32 v232, v224
    v_mov_b32 v233, v225
    v_mov_b32 v234, v226
    v_mov_b32 v235, v227
    v_mov_b32 v236, v228
    v_mov_b32 v237, v229
    v_mov_b32 v238, v230
    v_mov_b32 v239, v231
    s_lshl_b32 s96, s21, 14
    s_lshl_b32 s97, s12, 9
    s_add_u32 s98, s96, s97
    s_add_u32 s15, s98, 13631488
    v_lshrrev_b32 v7, 4, v1
    v_lshlrev_b32 v7, 4, v7
    v_add_u32 v8, 8192, v7
    v_permlane32_swap_b32 v232, v234
    v_permlane32_swap_b32 v233, v235
    v_permlane32_swap_b32 v236, v238
    v_permlane32_swap_b32 v237, v239
    v_permlane32_swap_b32 v12, v14
    v_permlane32_swap_b32 v13, v15
    v_permlane32_swap_b32 v16, v18
    v_permlane32_swap_b32 v17, v19
    v_cndmask_b32 v7, v7, v8, s[88:89]
    s_mov_b64 exec, s[84:85]
    buffer_store_dwordx4 v[232:235], v7, s[32:35], s15 offen sc1
    buffer_store_dwordx4 v[236:239], v7, s[32:35], s15 offen offset:64 sc1
    s_mov_b32 exec_lo, 0
    s_and_b32 exec_hi, s85, 0xffff0000
    buffer_store_dword v240, v7, s[32:35], s15 offen offset:208 sc1
    s_mov_b64 exec, s[84:85]
    buffer_store_dwordx4 v[12:15], v7, s[32:35], s15 offen offset:128 sc1
    buffer_store_dwordx4 v[16:19], v7, s[32:35], s15 offen offset:192 sc1
    s_mov_b64 exec, -1
L_NOCAND:
    s_add_u32 s82, s81, 12288
    s_lshl2_add_u32 m0, s83, 68608
    s_nop 0
    buffer_load_dwordx4 v253, s[60:63], s82 offen nt lds
    v_lshlrev_b32 v208, 16, v224
    v_and_b32 v209, s6, v224
    v_lshlrev_b32 v210, 16, v225
    v_and_b32 v211, s6, v225
    v_lshlrev_b32 v212, 16, v226
    v_and_b32 v213, s6, v226
    v_lshlrev_b32 v214, 16, v227
    v_and_b32 v215, s6, v227
    v_lshlrev_b32 v216, 16, v228
    v_and_b32 v217, s6, v228
    v_lshlrev_b32 v218, 16, v229
    v_and_b32 v219, s6, v229
    v_lshlrev_b32 v220, 16, v230
    v_and_b32 v221, s6, v230
    v_lshlrev_b32 v222, 16, v231
    v_and_b32 v223, s6, v231
    v_pk_mul_f32 v[208:209], v[208:209], v[104:105]
    v_pk_mul_f32 v[210:211], v[210:211], v[106:107]
    v_pk_mul_f32 v[212:213], v[212:213], v[108:109]
    v_pk_mul_f32 v[214:215], v[214:215], v[110:111]
    v_pk_mul_f32 v[216:217], v[216:217], v[112:113]
    v_pk_mul_f32 v[218:219], v[218:219], v[114:115]
    v_pk_mul_f32 v[220:221], v[220:221], v[116:117]
    v_pk_mul_f32 v[222:223], v[222:223], v[118:119]
    v_cvt_pk_bf16_f32 v208, 0, v208
    v_cvt_pk_bf16_f32 v209, 0, v209
    v_cvt_pk_bf16_f32 v210, 0, v210
    v_cvt_pk_bf16_f32 v211, 0, v211
    v_cvt_pk_bf16_f32 v212, 0, v212
    v_cvt_pk_bf16_f32 v213, 0, v213
    v_cvt_pk_bf16_f32 v214, 0, v214
    v_cvt_pk_bf16_f32 v215, 0, v215
    v_cvt_pk_bf16_f32 v216, 0, v216
    v_cvt_pk_bf16_f32 v217, 0, v217
    v_cvt_pk_bf16_f32 v218, 0, v218
    v_cvt_pk_bf16_f32 v219, 0, v219
    v_cvt_pk_bf16_f32 v220, 0, v220
    v_cvt_pk_bf16_f32 v221, 0, v221
    v_cvt_pk_bf16_f32 v222, 0, v222
    v_cvt_pk_bf16_f32 v223, 0, v223
    s_lshl_b32 s96, s3, 11
    s_add_u32 s13, s96, 98304
    v_lshrrev_b32 v202, 4, v1
    v_lshlrev_b32 v202, 4, v202
    v_and_b32 v203, 7, v1
    v_lshlrev_b32 v203, 4, v203
    v_xor_b32 v202, v202, v203
    v_and_b32 v204, 15, v1
    v_lshl_add_u32 v204, v204, 7, s13
    v_add_u32 v202, v202, v204
    v_xor_b32 v204, 64, v202
    v_lshrrev_b32 v205, 3, v1
    v_lshlrev_b32 v205, 4, v205
    v_xor_b32 v203, v205, v203
    v_lshrrev_b32 v205, 3, v1
    v_lshl_add_u32 v205, v205, 7, s13
    v_add_u32 v203, v203, v205
    s_lshl_b32 s96, s21, 7
    s_sub_u32 s97, 2047, s96
    s_lshl_b32 s98, s3, 4
    s_sub_u32 s13, s97, s98
    v_lshrrev_b32 v43, 3, v1
    v_sub_u32 v42, s13, v43
    v_subrev_u32 v43, 8, v42
    v_lshrrev_b32 v33, 3, v1
    v_lshlrev_b32 v33, 11, v33
    v_and_b32 v9, 7, v1
    v_lshl_add_u32 v33, v9, 4, v33
    s_lshl3_add_u32 s96, s21, s3
    s_lshl_b32 s97, s96, 15
    s_lshl_b32 s98, s12, 7
    s_add_u32 s16, s97, s98
    s_add_u32 s15, s16, 16384
    s_branch SCHK_41
SPOLL_40:
    s_load_dwordx8 s[24:31], s[32:33], s92 offset:2560 glc
SCHK_41:
    s_add_u32 s5, s5, 1
    s_cmp_ge_u32 s5, 200000
    s_waitcnt lgkmcnt(0)
    s_cbranch_scc1 SDONE_42
    s_cmp_lg_u32 s25, s4
    s_cbranch_scc1 SPOLL_40
    s_cmp_lg_u32 s27, s4
    s_cbranch_scc1 SPOLL_40
    s_cmp_lg_u32 s29, s4
    s_cbranch_scc1 SPOLL_40
    s_cmp_lg_u32 s31, s4
    s_cbranch_scc1 SPOLL_40
SDONE_42:
    s_min_u32 s25, s24, s28
    s_min_u32 s27, s26, s28
    s_min_u32 s29, s24, s30
    s_max_u32 s24, s24, s28
    s_max_u32 s26, s26, s30
    s_max_u32 s27, s27, s29
    s_max_u32 s25, s25, s26
    v_mov_b32 v244, s24
    v_mov_b32 v246, s27
    v_mov_b32 v245, s25
    ds_write_b128 v4, v[244:247]
    s_lshr_b32 s96, s3, 2
    s_lshl_b32 s97, s96, 15
    s_and_b32 s98, s3, 3
    s_lshl_b32 s99, s98, 5
    s_add_u32 s13, s97, s99
    v_lshrrev_b32 v34, 4, v1
    v_lshlrev_b32 v34, 13, v34
    v_bfe_u32 v9, v1, 2, 2
    v_lshl_add_u32 v34, v9, 7, v34
    v_bfe_u32 v9, v1, 3, 2
    v_lshl_add_u32 v34, v9, 5, v34
    v_and_b32 v9, 3, v1
    v_lshl_add_u32 v34, v9, 3, v34
    v_xor_b32 v34, s13, v34
    s_lshl_b32 s96, s75, 11
    s_add_u32 s13, s96, 13631488
    v_and_b32 v36, 7, v1
    v_lshl_add_u32 v36, v36, 4, s13
    v_lshrrev_b32 v9, 4, v1
    v_lshl_add_u32 v36, v9, 9, v36
    v_and_b32 v10, 15, v1
    v_lshlrev_b32 v10, 9, v10
    v_add_u32 v10, 13631744, v10
    s_waitcnt vmcnt(0)
    s_waitcnt lgkmcnt(0)
    s_barrier
    ds_read_b128 v[244:247], v5
    v_and_b32 v8, 8, v1
    v_cmp_eq_u32 s[22:23], 0, v8
    v_cmp_gt_u32 s[24:25], 16, v1
    v_cmp_gt_u32 s[26:27], 32, v1
    s_waitcnt lgkmcnt(0)
    v_min_u32_dpp v192, v244, v244 quad_perm:[1,0,3,2] row_mask:0xf bank_mask:0xf
    v_min_u32_dpp v193, v245, v244 quad_perm:[1,0,3,2] row_mask:0xf bank_mask:0xf
    v_min_u32_dpp v194, v244, v245 quad_perm:[1,0,3,2] row_mask:0xf bank_mask:0xf
    v_max_u32_dpp v246, v246, v246 quad_perm:[1,0,3,2] row_mask:0xf bank_mask:0xf
    v_max_u32_dpp v245, v245, v245 quad_perm:[1,0,3,2] row_mask:0xf bank_mask:0xf
    v_max_u32_dpp v244, v244, v244 quad_perm:[1,0,3,2] row_mask:0xf bank_mask:0xf
    v_max3_u32 v246, v246, v193, v194
    v_max_u32 v245, v245, v192
    v_min_u32_dpp v192, v244, v244 quad_perm:[2,3,0,1] row_mask:0xf bank_mask:0xf
    s_nop 0
    v_min_u32_dpp v193, v245, v244 quad_perm:[2,3,0,1] row_mask:0xf bank_mask:0xf
    v_min_u32_dpp v194, v244, v245 quad_perm:[2,3,0,1] row_mask:0xf bank_mask:0xf
    v_max_u32_dpp v246, v246, v246 quad_perm:[2,3,0,1] row_mask:0xf bank_mask:0xf
    v_max_u32_dpp v245, v245, v245 quad_perm:[2,3,0,1] row_mask:0xf bank_mask:0xf
    v_max_u32_dpp v244, v244, v244 quad_perm:[2,3,0,1] row_mask:0xf bank_mask:0xf
    v_max3_u32 v246, v246, v193, v194
    v_max_u32 v245, v245, v192
    v_min_u32_dpp v192, v244, v244 row_half_mirror row_mask:0xf bank_mask:0xf
    s_nop 0
    v_min_u32_dpp v193, v245, v244 row_half_mirror row_mask:0xf bank_mask:0xf
    v_min_u32_dpp v194, v244, v245 row_half_mirror row_mask:0xf bank_mask:0xf
    v_max_u32_dpp v246, v246, v246 row_half_mirror row_mask:0xf bank_mask:0xf
    v_max_u32_dpp v245, v245, v245 row_half_mirror row_mask:0xf bank_mask:0xf
    v_max_u32_dpp v244, v244, v244 row_half_mirror row_mask:0xf bank_mask:0xf
    v_max3_u32 v246, v246, v193, v194
    v_max_u32 v245, v245, v192
    v_cndmask_b32 v192, v245, v244, s[22:23]
    v_cndmask_b32 v201, v246, v245, s[26:27]
    v_and_b32 v193, 31, v246
    v_and_b32 v192, 31, v192
    v_cndmask_b32 v201, v201, v244, s[24:25]
    v_lshl_add_u32 v4, v192, 13, v36
    v_lshl_add_u32 v5, v193, 13, v36
    v_and_b32 v194, 31, v201
    v_lshl_add_u32 v6, v194, 13, v10
    buffer_load_dwordx4 v[192:195], v4, s[32:35], 0 offen sc1
    buffer_load_dwordx4 v[196:199], v5, s[32:35], 0 offen sc1
    buffer_load_dword v200, v6, s[32:35], 0 offen sc1
    s_barrier
    v_readfirstlane_b32 s91, v244
    v_readfirstlane_b32 s94, v245
    v_readfirstlane_b32 s95, v246
    ds_read_b64_tr_b16 v[56:57], v34
    ds_read_b64_tr_b16 v[58:59], v34 offset:512
    ds_read_b64_tr_b16 v[60:61], v34 offset:1024
    ds_read_b64_tr_b16 v[62:63], v34 offset:1536
    ds_read_b64_tr_b16 v[64:65], v34 offset:2048
    ds_read_b64_tr_b16 v[66:67], v34 offset:2560
    ds_read_b64_tr_b16 v[68:69], v34 offset:3072
    ds_read_b64_tr_b16 v[70:71], v34 offset:3584
    ds_read_b64_tr_b16 v[72:73], v34 offset:4096
    ds_read_b64_tr_b16 v[74:75], v34 offset:4608
    ds_read_b64_tr_b16 v[76:77], v34 offset:5120
    ds_read_b64_tr_b16 v[78:79], v34 offset:5632
    ds_read_b64_tr_b16 v[80:81], v34 offset:6144
    ds_read_b64_tr_b16 v[82:83], v34 offset:6656
    ds_read_b64_tr_b16 v[84:85], v34 offset:7168
    ds_read_b64_tr_b16 v[86:87], v34 offset:7680
    s_bfe_u32 s96, s91, 262145
    s_lshl_b32 s97, s96, 7
    s_bfe_u32 s98, s91, 458757
    s_add_u32 s99, s97, s98
    s_xor_b32 s17, s99, 2047
    s_bfe_u32 s96, s94, 262145
    s_lshl_b32 s97, s96, 7
    s_bfe_u32 s98, s94, 458757
    s_add_u32 s99, s97, s98
    s_xor_b32 s18, s99, 2047
    s_bfe_u32 s96, s95, 262145
    s_lshl_b32 s97, s96, 7
    s_bfe_u32 s98, s95, 458757
    s_add_u32 s99, s97, s98
    s_xor_b32 s19, s99, 2047
    s_waitcnt lgkmcnt(0)
    s_lshl_b32 s13, s3, 6
    v_bfe_u32 v35, v1, 2, 1
    v_lshlrev_b32 v35, 9, v35
    v_bfe_u32 v9, v1, 3, 1
    v_lshl_add_u32 v35, v9, 12, v35
    v_lshrrev_b32 v9, 5, v1
    v_lshl_add_u32 v35, v9, 11, v35
    v_bfe_u32 v9, v1, 2, 2
    v_lshl_add_u32 v35, v9, 6, v35
    v_bfe_u32 v9, v1, 4, 1
    v_lshl_add_u32 v35, v9, 5, v35
    v_and_b32 v9, 3, v1
    v_lshl_add_u32 v35, v9, 3, v35
    v_xor_b32 v35, s13, v35
    v_add_u32 v35, 65536, v35
    v_and_b32 v8, 15, v1
    v_lshlrev_b32 v8, 4, v8
    v_lshrrev_b32 v9, 5, v1
    v_lshl_add_u32 v8, v9, 3, v8
    s_lshl_b32 s96, s74, 13
    s_add_u32 s14, s96, 20971520
    s_lshl3_add_u32 s96, s75, s3
    s_lshl_b32 s97, s96, 8
    s_add_u32 s20, s97, s14
    v_bfe_u32 v7, v201, 1, 4
    v_bfe_u32 v201, v201, 5, 7
    v_lshl_or_b32 v201, v7, 7, v201
    v_xor_b32 v201, 0x7ff, v201
    s_waitcnt vmcnt(0)
    v_max3_u32 v7, v192, v196, v200
    v_cmp_eq_u32 vcc, -1, v7
    s_cbranch_vccz POK_44
PRE_45:
    buffer_load_dwordx4 v[192:195], v4, s[32:35], 0 offen sc1
    buffer_load_dwordx4 v[196:199], v5, s[32:35], 0 offen sc1
    buffer_load_dword v200, v6, s[32:35], 0 offen sc1
    s_waitcnt vmcnt(0)
    v_max3_u32 v7, v192, v196, v200
    v_cmp_eq_u32 vcc, -1, v7
    s_cbranch_vccz POK_44
    s_add_u32 s5, s5, 1
    s_cmp_lt_u32 s5, 200000
    s_cbranch_scc1 PRE_45
POK_44:
    v_add_f32_dpp v200, v200, v200 quad_perm:[1,0,3,2] row_mask:0xf bank_mask:0xf
    s_nop 1
    v_add_f32_dpp v200, v200, v200 quad_perm:[2,3,0,1] row_mask:0xf bank_mask:0xf
    s_nop 1
    v_add_f32_dpp v200, v200, v200 row_half_mirror row_mask:0xf bank_mask:0xf
    s_nop 1
    v_add_f32_dpp v200, v200, v200 row_mirror row_mask:0xf bank_mask:0xf
    v_cvt_pk_bf16_f32 v200, 0, v200
    v_ashrrev_i32 v7, 31, v200
    v_or_b32 v7, 0x80000000, v7
    v_xor_b32 v200, v200, v7
    v_lshrrev_b32 v200, 16, v200
    v_lshl_or_b32 v200, v200, 11, v201
    s_nop 0
    v_readlane_b32 s24, v200, 0
    v_readlane_b32 s25, v200, 16
    v_readlane_b32 s26, v200, 32
    s_not_b64 s[28:29], s[22:23]
    s_cmp_lt_u32 s24, s25
    s_cselect_b64 s[28:29], s[22:23], s[28:29]
    s_cselect_b32 s27, s24, s25
    s_cmp_gt_u32 s26, s27
    s_cselect_b64 vcc, s[28:29], 0
    v_cndmask_b32 v192, v192, v196, vcc
    v_cndmask_b32 v193, v193, v197, vcc
    v_cndmask_b32 v194, v194, v198, vcc
    v_cndmask_b32 v195, v195, v199, vcc
    s_bitcmp1_b32 vcc_lo, 0
    s_cselect_b32 s24, s26, s24
    s_cselect_b32 s19, s17, s19
    s_cselect_b32 s17, s95, s91
    s_bitcmp1_b32 vcc_lo, 8
    s_cselect_b32 s25, s26, s25
    s_cselect_b32 s19, s18, s19
    s_cselect_b32 s18, s95, s94
    s_waitcnt lgkmcnt(0)
    v_mfma_f32_16x16x32_bf16 v[136:139], v[192:195], v[56:59], 0
    v_mfma_f32_16x16x32_bf16 v[140:143], v[192:195], v[60:63], 0
    v_mfma_f32_16x16x32_bf16 v[144:147], v[192:195], v[64:67], 0
    v_mfma_f32_16x16x32_bf16 v[148:151], v[192:195], v[68:71], 0
    v_mfma_f32_16x16x32_bf16 v[168:171], v[192:195], v[72:75], 0
    v_mfma_f32_16x16x32_bf16 v[172:175], v[192:195], v[76:79], 0
    v_mfma_f32_16x16x32_bf16 v[176:179], v[192:195], v[80:83], 0
    v_mfma_f32_16x16x32_bf16 v[180:183], v[192:195], v[84:87], 0
    s_nop 1
    v_add_f32 v196, v136, v141
    s_nop 0
    v_add_f32 v197, v146, v151
    s_nop 0
    v_add_f32 v198, v168, v173
    s_nop 0
    v_add_f32 v199, v178, v183
    v_add_f32 v196, v196, v197
    v_add_f32 v198, v198, v199
    v_mov_b32 v197, s4
    s_nop 0
    v_permlane16_swap_b32 v198, v199
    s_cmp_ge_u32 s9, 28
    s_cbranch_scc1 L_NOHP
    v_add_f32 v196, v196, v199
    s_mov_b32 exec_lo, 0xffff
    s_mov_b32 exec_hi, 0xffff
    buffer_store_dwordx2 v[196:197], v8, s[32:35], s20 offen sc1
    s_mov_b64 exec, -1
L_NOHP:
    ds_read_b64_tr_b16 v[120:121], v35
    ds_read_b64_tr_b16 v[122:123], v35 offset:1024
    ds_read_b64_tr_b16 v[124:125], v35 offset:8192
    ds_read_b64_tr_b16 v[126:127], v35 offset:9216
    ds_read_b64_tr_b16 v[128:129], v35 offset:16384
    ds_read_b64_tr_b16 v[130:131], v35 offset:17408
    ds_read_b64_tr_b16 v[132:133], v35 offset:24576
    ds_read_b64_tr_b16 v[134:135], v35 offset:25600
    s_and_b32 s68, s24, 2047
    s_and_b32 s69, s25, 2047
    s_mov_b32 s70, s16
    s_mov_b32 s71, s15
    v_pk_add_f32 v[208:209], v[208:209], v[152:153]
    v_pk_add_f32 v[210:211], v[210:211], v[154:155]
    v_pk_add_f32 v[212:213], v[212:213], v[156:157]
    v_pk_add_f32 v[214:215], v[214:215], v[158:159]
    v_pk_add_f32 v[216:217], v[216:217], v[160:161]
    v_pk_add_f32 v[218:219], v[218:219], v[162:163]
    v_pk_add_f32 v[220:221], v[220:221], v[164:165]
    v_pk_add_f32 v[222:223], v[222:223], v[166:167]
    v_cvt_pk_bf16_f32 v232, v208, v209
    v_cvt_pk_bf16_f32 v233, v210, v211
    v_cvt_pk_bf16_f32 v234, v212, v213
    v_cvt_pk_bf16_f32 v235, v214, v215
    v_cvt_pk_bf16_f32 v236, v216, v217
    v_cvt_pk_bf16_f32 v237, v218, v219
    v_cvt_pk_bf16_f32 v238, v220, v221
    v_cvt_pk_bf16_f32 v239, v222, v223
    v_permlane32_swap_b32 v232, v234
    v_permlane32_swap_b32 v233, v235
    v_permlane32_swap_b32 v236, v238
    v_permlane32_swap_b32 v237, v239
    ds_write_b128 v202, v[232:235]
    ds_write_b128 v204, v[236:239]
    ds_read_b128 v[232:235], v203
    ds_read_b128 v[236:239], v203 offset:1024
    s_waitcnt lgkmcnt(0)
    s_cmp_lg_u32 s93, 7
    s_cbranch_scc1 L_NONON
    v_mov_b32 v6, s4
    v_mov_b32 v7, 0
    s_mov_b64 exec, 1
    buffer_store_dword v6, v7, s[32:35], 0 offen sc1
    s_mov_b64 exec, -1
L_NONON:
    s_cmp_ge_u32 s9, 28
    s_cbranch_scc1 L_FIN2
    s_cmp_lg_u32 s3, 7
    s_cbranch_scc1 L_NOFZ
    s_bitcmp1_b32 s9, 3
    s_cselect_b32 s15, s25, s24
    s_cselect_b32 s17, s18, s17
    s_andn2_b32 s18, 2047, s15
    s_lshr_b32 s96, s8, 1
    s_lshl2_add_u32 s19, s12, s96
    s_lshr_b32 s96, s19, 1
    s_lshr_b32 s97, s9, 3
    s_lshl_b32 s98, s97, 1
    s_lshl2_add_u32 s99, s96, s98
    s_and_b32 s97, s19, 1
    s_add_u32 s96, s99, s97
    s_mul_i32 s98, s96, 7168
    s_add_u32 s20, s98, 22020096
    s_lshl_b32 s96, s18, 11
    s_lshl_b32 s97, s19, 5
    s_add_u32 s82, s96, s97
    v_and_b32 v10, 7, v1
    v_lshlrev_b32 v10, 2, v10
    s_lshr_b32 s96, s8, 1
    s_lshl_b32 s97, s96, 6
    s_add_u32 s13, s97, 157184
    v_and_b32 v5, 7, v1
    v_lshl_add_u32 v5, v5, 3, s13
    ds_read_b64 v[206:207], v5
    s_and_b32 s96, s17, 31
    s_lshl_b32 s97, s96, 13
    s_lshl_b32 s98, s12, 9
    s_add_u32 s99, s97, s98
    s_lshr_b32 s96, s8, 1
    s_lshl_b32 s97, s96, 5
    s_add_u32 s98, s99, s97
    s_add_u32 s91, s98, 13631488
    s_lshr_b32 s13, s15, 11
    s_lshl_b32 s13, s13, 16
    s_ashr_i32 s15, s13, 31
    s_andn2_b32 s15, 0x7fff0000, s15
    s_or_b32 s15, s15, 0x80000000
L_PAD10:
    s_cbranch_execz L_RET10
    s_xor_b32 s13, s13, s15
    v_mov_b32 v204, s13
    v_mul_f32 v204, s7, v204
    v_exp_f32 v204, -v204
    s_nop 0
    v_add_f32 v204, 1.0, v204
    v_rcp_f32 v204, v204
    s_nop 0
    v_cvt_pk_bf16_f32 v204, 0, v204
L_NOFZ:
    s_cmp_ge_u32 s3, 4
    s_cbranch_scc1 L_NOH
    s_lshl_b32 s96, s3, 8
    s_add_u32 s13, s96, s14
    v_lshrrev_b32 v4, 4, v1
    v_lshlrev_b32 v4, 11, v4
    v_and_b32 v9, 15, v1
    v_lshl_add_u32 v4, v9, 4, v4
    s_lshl_b32 s96, s3, 5
    s_add_u32 s15, s96, 156672
    v_lshrrev_b32 v5, 5, v1
    v_lshl_add_u32 v5, v5, 7, s15
    v_bfe_u32 v9, v1, 2, 1
    v_lshl_add_u32 v5, v9, 4, v5
    v_bfe_u32 v9, v1, 1, 1
    v_lshl_add_u32 v5, v9, 3, v5
    v_bfe_u32 v9, v1, 3, 1
    v_lshl_add_u32 v5, v9, 2, v5
    v_and_b32 v9, 1, v1
    v_lshl_add_u32 v5, v9, 1, v5
SPOLL_46:
    s_load_dword s24, s[32:33], s13 offset:1276 glc
    s_load_dword s25, s[32:33], s13 offset:3324 glc
    s_load_dword s26, s[32:33], s13 offset:5372 glc
    s_load_dword s27, s[32:33], s13 offset:7420 glc
SCHK_47:
    s_add_u32 s5, s5, 1
    s_cmp_ge_u32 s5, 200000
    s_waitcnt lgkmcnt(0)
    s_cbranch_scc1 SDONE_48
    s_cmp_lg_u32 s24, s4
    s_cbranch_scc1 SPOLL_46
    s_cmp_lg_u32 s25, s4
    s_cbranch_scc1 SPOLL_46
    s_cmp_lg_u32 s26, s4
    s_cbranch_scc1 SPOLL_46
    s_cmp_lg_u32 s27, s4
    s_cbranch_scc1 SPOLL_46
SDONE_48:
POLL_49:
    buffer_load_dwordx4 v[88:91], v4, s[32:35], s13 offen sc1
    buffer_load_dwordx4 v[92:95], v4, s[32:35], s13 offen offset:1024 sc1
    s_waitcnt vmcnt(0)
    v_bitop3_b32 v6, v89, v91, s4 bitop3:0x7e
    v_bitop3_b32 v6, v6, v93, s4 bitop3:0xf6
    v_bitop3_b32 v6, v6, v95, s4 bitop3:0xf6
    v_cmp_ne_u32 vcc, 0, v6
    s_cbranch_vccz PDONE_50
    s_add_u32 s5, s5, 1
    s_cmp_lt_u32 s5, 200000
    s_cbranch_scc1 POLL_49
PDONE_50:
    v_permlane32_swap_b32 v88, v90
    v_permlane32_swap_b32 v92, v94
    v_add_f32 v88, v88, v90
    v_add_f32 v92, v92, v94
    v_mov_b32 v90, v88
    v_mov_b32 v94, v92
    s_nop 0
    v_permlane16_swap_b32 v88, v90
    v_permlane16_swap_b32 v92, v94
    v_add_f32 v88, v88, v90
    v_add_f32 v92, v92, v94
    v_cvt_pk_bf16_f32 v88, 0, v88
    v_cvt_pk_bf16_f32 v92, 0, v92
    v_mul_f32 v6, s7, v88
    v_exp_f32 v6, -v6
    s_nop 0
    v_add_f32 v6, 1.0, v6
    v_rcp_f32 v6, v6
    s_nop 0
    v_mul_f32 v88, v88, v6
    v_cvt_pk_bf16_f32 v88, 0, v88
    v_mul_f32 v88, v88, v92
    v_cvt_pk_bf16_f32 v88, v88, v88
    ds_write_b16 v5, v88
L_NOH:
    v_bfe_u32 v4, v1, 2, 1
    v_lshlrev_b32 v4, 7, v4
    v_lshrrev_b32 v9, 5, v1
    v_lshl_add_u32 v4, v9, 4, v4
    v_add_u32 v4, 156672, v4
    v_lshrrev_b32 v5, 4, v1
    v_mul_u32_u24 v5, 7168, v5
    v_and_b32 v9, 15, v1
    v_lshl_add_u32 v5, v9, 3, v5
    s_lshl3_add_u32 s96, s75, s3
    s_mul_i32 s97, s96, 28672
    s_lshl_b32 s98, s74, 7
    s_add_u32 s99, s97, s98
    s_add_u32 s13, s99, 22020096
    v_and_b32 v6, 1, v1
    v_lshlrev_b32 v6, 13, v6
    v_bfe_u32 v9, v1, 1, 1
    v_lshl_add_u32 v6, v9, 18, v6
    s_lshr_b32 s96, s9, 2
    s_and_b32 s97, s75, 1
    s_lshr_b32 s98, s3, 1
    s_lshl2_add_u32 s99, s97, s98
    s_and_b32 s97, s3, 1
    s_lshr_b32 s98, s75, 1
    s_lshl2_add_u32 s97, s97, s98
    s_lshl3_add_u32 s98, s99, s97
    s_lshl_b32 s99, s98, 12
    s_lshl_b32 s97, s8, 6
    s_add_u32 s98, s99, s97
    s_lshl2_add_u32 s99, s96, s98
    s_add_u32 s97, s99, 1048576
    s_add_u32 s14, s97, 3072
    s_waitcnt lgkmcnt(0)
    s_barrier
    ds_read_b128 v[88:91], v4
    ds_read_b128 v[92:95], v4 offset:32
    ds_read_b128 v[96:99], v4 offset:64
    ds_read_b128 v[100:103], v4 offset:96
    s_waitcnt lgkmcnt(3)
    v_mfma_f32_32x32x16_bf16 v[208:223], v[88:91], v[120:123], 0
    s_waitcnt lgkmcnt(2)
    v_mfma_f32_32x32x16_bf16 v[208:223], v[92:95], v[124:127], v[208:223]
    s_waitcnt lgkmcnt(1)
    v_mfma_f32_32x32x16_bf16 v[208:223], v[96:99], v[128:131], v[208:223]
    s_waitcnt lgkmcnt(0)
    v_mfma_f32_32x32x16_bf16 v[208:223], v[100:103], v[132:135], v[208:223]
    s_nop 11
    v_mov_b32 v209, s4
    buffer_store_dwordx2 v[208:209], v5, s[32:35], s13 offen sc1
    s_mov_b64 exec, 15
    buffer_store_dword v209, v6, s[32:35], s14 offen sc1
    s_mov_b64 exec, -1
    s_barrier
L_FIN2:
    v_cmp_ne_u32 vcc, s68, v42
    v_cmp_ne_u32 s[22:23], s69, v42
    s_nop 0
    s_and_b64 exec, vcc, s[22:23]
    buffer_store_dwordx4 v[232:235], v33, s[64:67], s70 offen sc1
    s_mov_b64 exec, -1
    v_cmp_ne_u32 vcc, s68, v43
    v_cmp_ne_u32 s[22:23], s69, v43
    s_nop 0
    s_and_b64 exec, vcc, s[22:23]
    buffer_store_dwordx4 v[236:239], v33, s[64:67], s71 offen sc1
    s_mov_b64 exec, -1
    s_cmp_ge_u32 s9, 16
    s_cbranch_scc1 L_FIN
SPOLL_51:
    s_load_dwordx8 s[24:31], s[32:33], s92 offset:3072 glc
SCHK_52:
    s_add_u32 s5, s5, 1
    s_cmp_ge_u32 s5, 200000
    s_waitcnt lgkmcnt(0)
    s_cbranch_scc1 SDONE_53
    s_cmp_lg_u32 s24, s4
    s_cbranch_scc1 SPOLL_51
    s_cmp_lg_u32 s25, s4
    s_cbranch_scc1 SPOLL_51
    s_cmp_lg_u32 s26, s4
    s_cbranch_scc1 SPOLL_51
    s_cmp_lg_u32 s27, s4
    s_cbranch_scc1 SPOLL_51
    s_cmp_lg_u32 s28, s4
    s_cbranch_scc1 SPOLL_51
    s_cmp_lg_u32 s29, s4
    s_cbranch_scc1 SPOLL_51
    s_cmp_lg_u32 s30, s4
    s_cbranch_scc1 SPOLL_51
SDONE_53:
    s_barrier
    s_cmp_lg_u32 s3, 7
    s_cbranch_scc1 L_FIN
    s_add_u32 s13, s20, 4096
    v_mov_b32 v5, s4
    v_not_b32 v6, v5
POLL_54:
    buffer_load_dwordx4 v[88:91], v2, s[32:35], s20 offen sc1
    buffer_load_dwordx4 v[92:95], v2, s[32:35], s20 offen offset:1024 sc1
    buffer_load_dwordx4 v[96:99], v2, s[32:35], s20 offen offset:2048 sc1
    buffer_load_dwordx4 v[100:103], v2, s[32:35], s20 offen offset:3072 sc1
    buffer_load_dwordx4 v[104:107], v2, s[32:35], s13 offen sc1
    buffer_load_dwordx4 v[108:111], v2, s[32:35], s13 offen offset:1024 sc1
    buffer_load_dwordx4 v[112:115], v2, s[32:35], s13 offen offset:2048 sc1
    buffer_load_dword v244, v10, s[32:35], s91 offen sc1
    buffer_load_dword v245, v10, s[32:35], s91 offen offset:128 sc1
    s_waitcnt vmcnt(0)
    v_max_u32 v246, v244, v245
    v_cmp_ne_u32 vcc, -1, v246
    s_nop 1
    v_cndmask_b32 v246, v6, v5, vcc
    v_bitop3_b32 v4, v89, v91, s4 bitop3:0x7e
    v_bitop3_b32 v4, v4, v93, s4 bitop3:0xf6
    v_bitop3_b32 v4, v4, v95, s4 bitop3:0xf6
    v_bitop3_b32 v4, v4, v97, s4 bitop3:0xf6
    v_bitop3_b32 v4, v4, v99, s4 bitop3:0xf6
    v_bitop3_b32 v4, v4, v101, s4 bitop3:0xf6
    v_bitop3_b32 v4, v4, v103, s4 bitop3:0xf6
    v_bitop3_b32 v4, v4, v105, s4 bitop3:0xf6
    v_bitop3_b32 v4, v4, v107, s4 bitop3:0xf6
    v_bitop3_b32 v4, v4, v109, s4 bitop3:0xf6
    v_bitop3_b32 v4, v4, v111, s4 bitop3:0xf6
    v_bitop3_b32 v4, v4, v113, s4 bitop3:0xf6
    v_bitop3_b32 v4, v4, v115, s4 bitop3:0xf6
    v_bitop3_b32 v4, v4, v246, s4 bitop3:0xf6
    v_cmp_ne_u32 vcc, 0, v4
    s_cbranch_vccz PDONE_55
    s_add_u32 s5, s5, 1
    s_cmp_lt_u32 s5, 200000
    s_cbranch_scc1 POLL_54
PDONE_55:
    v_add_f32 v88, v88, v92
    v_add_f32 v90, v90, v94
    v_add_f32 v88, v88, v96
    v_add_f32 v90, v90, v98
    v_add_f32 v88, v88, v100
    v_add_f32 v90, v90, v102
    v_add_f32 v88, v88, v104
    v_add_f32 v90, v90, v106
    v_add_f32 v88, v88, v108
    v_add_f32 v90, v90, v110
    v_add_f32 v88, v88, v112
    v_add_f32 v90, v90, v114
    v_mov_b32 v89, v90
    v_add_f32_dpp v88, v88, v88 row_ror:8 row_mask:0xf bank_mask:0xf
    s_nop 0
    v_add_f32_dpp v89, v89, v89 row_ror:8 row_mask:0xf bank_mask:0xf
    v_mov_b32 v90, v88
    v_mov_b32 v91, v89
    s_nop 0
    v_permlane16_swap_b32 v88, v90
    v_permlane16_swap_b32 v89, v91
    v_pk_add_f32 v[88:89], v[88:89], v[90:91]
    v_mov_b32 v90, v88
    v_mov_b32 v91, v89
    s_nop 0
    v_permlane32_swap_b32 v88, v90
    v_permlane32_swap_b32 v89, v91
    v_pk_add_f32 v[88:89], v[88:89], v[90:91]
    v_cvt_pk_bf16_f32 v88, 0, v88
    v_cvt_pk_bf16_f32 v89, 0, v89
    v_pk_mul_f32 v[88:89], v[88:89], v[204:205] op_sel_hi:[1,0]
    v_lshlrev_b32 v4, 16, v244
    v_and_b32 v5, s6, v244
    v_cvt_pk_bf16_f32 v88, 0, v88
    v_cvt_pk_bf16_f32 v89, 0, v89
    v_pk_add_f32 v[88:89], v[88:89], v[4:5]
    v_cvt_pk_bf16_f32 v88, 0, v88
    v_cvt_pk_bf16_f32 v89, 0, v89
    v_pk_mul_f32 v[88:89], v[88:89], v[206:207]
    v_lshlrev_b32 v4, 16, v245
    v_and_b32 v5, s6, v245
    v_cvt_pk_bf16_f32 v88, 0, v88
    v_cvt_pk_bf16_f32 v89, 0, v89
    v_pk_add_f32 v[88:89], v[88:89], v[4:5]
    v_cvt_pk_bf16_f32 v88, v88, v89
    s_mov_b64 exec, 0xff
    buffer_store_dword v88, v10, s[64:67], s82 offen sc1
    s_mov_b64 exec, -1
L_FIN:
L_END:
    s_endpgm
.p2align 10
.fill 768, 4, 0xbf800000
.section .rodata,"a"
.p2align 6
.amdhsa_kernel adaLN_cond__linear_kernel_hedgehog__moe_arch_mod__prompt_kernel
  .amdhsa_next_free_vgpr 256
  .amdhsa_next_free_sgpr 102
  .amdhsa_accum_offset 256
  .amdhsa_group_segment_fixed_size 0
  .amdhsa_kernarg_size 112
  .amdhsa_user_sgpr_count 2
  .amdhsa_user_sgpr_kernarg_segment_ptr 1
  .amdhsa_system_sgpr_workgroup_id_x 1
  .amdhsa_float_denorm_mode_32 3
  .amdhsa_float_denorm_mode_16_64 3
.end_amdhsa_kernel
```

```asm
; @launch grid=(256,1,1) block=(512,1,1) lds=163840
.amdgcn_target "amdgcn-amd-amdhsa--gfx950"
.text
.globl adaLN_cond__linear_kernel_hedgehog__moe_arch_mod__prompt_kernel
.p2align 12
.type adaLN_cond__linear_kernel_hedgehog__moe_arch_mod__prompt_kernel,@function
adaLN_cond__linear_kernel_hedgehog__moe_arch_mod__prompt_kernel:
    s_load_dwordx16 s[68:83], s[0:1], 0
    s_load_dwordx8 s[84:91], s[0:1], 64
    s_load_dwordx2 s[32:33], s[0:1], 104
    s_cmp_ge_u32 s2, 256
    s_cbranch_scc1 L_END
    v_lshrrev_b32 v4, 6, v0
    v_and_b32 v1, 63, v0
    s_nop 0
    v_readfirstlane_b32 s3, v4
    v_lshlrev_b32 v2, 4, v1
    s_mov_b32 s38, 4194304
    s_mov_b32 s39, 0x20000
    s_mov_b32 s50, 12582912
    s_mov_b32 s51, 0x20000
    s_mov_b32 s34, 268435456
    s_mov_b32 s35, 0x20000
    s_mov_b32 s42, 6291456
    s_mov_b32 s43, 0x20000
    s_mov_b32 s46, 2097152
    s_mov_b32 s47, 0x20000
    s_mov_b32 s54, 7340032
    s_mov_b32 s55, 0x20000
    s_mov_b32 s58, 7340032
    s_mov_b32 s59, 0x20000
    s_mov_b32 s62, 7340032
    s_mov_b32 s63, 0x20000
    s_mov_b32 s66, 4194304
    s_mov_b32 s67, 0x20000
    s_mov_b32 s5, 0
    s_mov_b32 s6, 0xffff0000
    s_mov_b32 s7, 0x3fb8aa3b
    s_and_b32 s8, s2, 7
    s_lshr_b32 s9, s2, 3
    s_lshl_b32 s96, s8, 5
    s_add_u32 s97, s96, s9
    s_lshl3_add_u32 s93, s97, s3
    s_and_b32 s96, s8, 4
    s_lshr_b32 s97, s9, 2
    s_lshl1_add_u32 s10, s96, s97
    s_and_b32 s96, s8, 3
    s_and_b32 s97, s9, 3
    s_xor_b32 s98, s97, 2
    s_lshl2_add_u32 s11, s96, s98
    s_and_b32 s96, s8, 1
    s_and_b32 s97, s9, 7
    s_lshl3_add_u32 s12, s96, s97
    s_lshr_b32 s96, s8, 1
    s_lshr_b32 s97, s9, 3
    s_lshl2_add_u32 s21, s96, s97
    s_lshl_b32 s96, s2, 6
    s_add_u32 s97, s96, s3
    s_lshl_b32 s98, s97, 6
    s_add_u32 s92, s98, 1048576
    s_lshl_b32 s16, s93, 11
    s_lshl3_add_u32 s96, s8, s3
    s_lshl_b32 s15, s96, 5
    s_mul_i32 s96, s15, 6144
    s_xor_b32 s97, s9, 1
    s_lshl_b32 s98, s97, 7
    s_add_u32 s13, s96, s98
    s_add_u32 s14, s13, 98304
    s_lshl3_add_u32 s96, s21, s3
    s_lshl_b32 s97, s96, 15
    s_lshl_b32 s98, s12, 7
    s_add_u32 s18, s97, s98
    s_lshr_b32 s96, s8, 1
    s_lshl4_add_u32 s97, s96, s12
    s_lshl4_add_u32 s98, s97, s3
    s_lshl_b32 s99, s98, 9
    s_add_u32 s17, s99, 524288
    v_lshrrev_b32 v248, 3, v1
    v_mul_u32_u24 v248, 12288, v248
    v_and_b32 v9, 7, v1
    v_lshl_add_u32 v248, v9, 4, v248
    v_lshrrev_b32 v249, 3, v1
    v_lshl_add_u32 v249, v249, 1, s15
    v_and_b32 v10, 15, v1
    v_lshlrev_b32 v10, 11, v10
    v_lshrrev_b32 v9, 4, v1
    v_lshl_add_u32 v10, v9, 4, v10
    s_waitcnt lgkmcnt(0)
    s_mov_b64 s[48:49], s[88:89]
    buffer_load_dwordx4 v[160:163], v248, s[48:51], s13 offen nt
    buffer_load_dwordx4 v[164:167], v248, s[48:51], s14 offen nt
    s_load_dword s4, s[32:33], 0
    global_load_ushort v168, v249, s[86:87]
    global_load_ushort v169, v249, s[86:87] offset:16
    s_mov_b64 s[36:37], s[68:69]
    s_load_dword s24, s[32:33], s92 offset:0 glc
    s_load_dword s25, s[32:33], s17 offset:508 glc
    s_load_dword s26, s[32:33], s17 offset:4604 glc
    s_barrier
    buffer_load_dwordx4 v[152:155], v2, s[36:39], s16 offen
    buffer_load_dwordx4 v[156:159], v2, s[36:39], s16 offen offset:1024
    s_mov_b64 s[40:41], s[70:71]
    s_mov_b64 s[44:45], s[74:75]
    s_mov_b64 s[52:53], s[80:81]
    s_mov_b64 s[56:57], s[82:83]
    s_mov_b64 s[60:61], s[84:85]
    s_mov_b64 s[64:65], s[90:91]
    s_getpc_b64 s[22:23]
    s_and_b32 s22, s22, 0xfffffc00
    s_lshl3_add_u32 s96, s9, s3
    s_lshl_b32 s19, s96, 7
    v_lshrrev_b32 v4, 5, v1
    v_lshl_add_u32 v4, v4, 15, s19
    v_min_u32 v4, 41984, v4
    global_load_dword v11, v4, s[22:23]
    s_lshr_b32 s76, s3, 2
    s_and_b32 s77, s3, 3
    s_lshl_b32 s83, s3, 10
    s_mul_i32 s96, s8, 7
    s_lshr_b32 s97, s9, 2
    s_add_u32 s74, s96, s97
    s_and_b32 s75, s9, 3
    v_bfe_u32 v6, v1, 4, 1
    v_lshlrev_b32 v6, 6, v6
    v_and_b32 v3, 7, v1
    v_lshlrev_b32 v3, 4, v3
    v_xor_b32 v3, v3, v6
    v_lshrrev_b32 v6, 3, v1
    v_mul_u32_u24 v6, 6144, v6
    v_add_u32 v3, v3, v6
    s_and_b32 s84, s9, 12
    s_mul_i32 s96, s3, 49152
    s_lshl_b32 s97, s11, 7
    s_add_u32 s85, s96, s97
    v_lshlrev_b32 v250, 3, v1
    v_lshlrev_b32 v251, 5, v1
    v_add_u32 v251, 147456, v251
    s_lshl2_add_u32 s13, s3, 147456
    v_lshrrev_b32 v252, 4, v1
    v_lshl_add_u32 v252, v252, 6, s13
    v_and_b32 v9, 7, v1
    v_lshl_add_u32 v252, v9, 8, v252
    v_bfe_u32 v9, v1, 3, 1
    v_lshl_add_u32 v252, v9, 5, v252
    buffer_load_dwordx4 v[12:15], v10, s[36:39], s18 offen
    buffer_load_dwordx4 v[16:19], v10, s[36:39], s18 offen offset:64
    s_lshr_b32 s96, s3, 1
    s_xor_b32 s97, s9, 1
    s_and_b32 s98, s97, 15
    s_lshl4_add_u32 s99, s96, s98
    s_lshr_b32 s97, s9, 4
    s_lshl1_add_u32 s96, s99, s97
    s_lshl3_add_u32 s98, s96, s8
    s_lshl_b32 s99, s98, 9
    s_add_u32 s13, s99, 524288
    s_waitcnt vmcnt(5)
    v_lshlrev_b32 v168, 16, v168
    v_mul_f32 v4, s7, v168
    v_exp_f32 v4, -v4
    s_nop 0
    v_add_f32 v4, 1.0, v4
    v_rcp_f32 v4, v4
    s_nop 0
    v_mul_f32 v168, v168, v4
    v_cvt_pk_bf16_f32 v168, 0, v168
    v_lshlrev_b32 v169, 16, v169
    v_mul_f32 v5, s7, v169
    v_exp_f32 v5, -v5
    s_nop 0
    v_add_f32 v5, 1.0, v5
    v_rcp_f32 v5, v5
    s_nop 0
    v_mul_f32 v169, v169, v5
    v_cvt_pk_bf16_f32 v169, 0, v169
    v_lshlrev_b32 v4, 16, v160
    v_and_b32 v5, s6, v160
    v_pk_mul_f32 v[176:177], v[4:5], v[168:169] op_sel:[0,0] op_sel_hi:[1,0]
    v_lshlrev_b32 v6, 16, v161
    v_and_b32 v7, s6, v161
    v_pk_mul_f32 v[178:179], v[6:7], v[168:169] op_sel:[0,0] op_sel_hi:[1,0]
    v_lshlrev_b32 v4, 16, v162
    v_and_b32 v5, s6, v162
    v_pk_mul_f32 v[180:181], v[4:5], v[168:169] op_sel:[0,0] op_sel_hi:[1,0]
    v_lshlrev_b32 v6, 16, v163
    v_and_b32 v7, s6, v163
    v_pk_mul_f32 v[182:183], v[6:7], v[168:169] op_sel:[0,0] op_sel_hi:[1,0]
    v_lshlrev_b32 v4, 16, v164
    v_and_b32 v5, s6, v164
    v_pk_fma_f32 v[176:177], v[4:5], v[168:169], v[176:177] op_sel:[0,1,0] op_sel_hi:[1,1,1]
    v_lshlrev_b32 v6, 16, v165
    v_and_b32 v7, s6, v165
    v_pk_fma_f32 v[178:179], v[6:7], v[168:169], v[178:179] op_sel:[0,1,0] op_sel_hi:[1,1,1]
    v_lshlrev_b32 v4, 16, v166
    v_and_b32 v5, s6, v166
    v_pk_fma_f32 v[180:181], v[4:5], v[168:169], v[180:181] op_sel:[0,1,0] op_sel_hi:[1,1,1]
    v_lshlrev_b32 v6, 16, v167
    v_and_b32 v7, s6, v167
    v_pk_fma_f32 v[182:183], v[6:7], v[168:169], v[182:183] op_sel:[0,1,0] op_sel_hi:[1,1,1]
    v_permlane32_swap_b32 v176, v180
    v_permlane32_swap_b32 v177, v181
    v_permlane32_swap_b32 v178, v182
    v_permlane32_swap_b32 v179, v183
    v_add_f32 v176, v176, v180
    v_add_f32 v177, v177, v181
    v_add_f32 v178, v178, v182
    v_add_f32 v179, v179, v183
    s_nop 0
    v_permlane16_swap_b32 v176, v178
    v_permlane16_swap_b32 v177, v179
    v_add_f32 v176, v176, v178
    v_add_f32 v177, v177, v179
    s_nop 0
    v_add_f32_dpp v176, v176, v176 row_ror:8 row_mask:0xf bank_mask:0xf
    v_add_f32_dpp v177, v177, v177 row_ror:8 row_mask:0xf bank_mask:0xf
    s_nop 1
    v_mov_b32_dpp v176, v177 quad_perm:[0,1,2,3] row_mask:0xf bank_mask:0xc
    s_waitcnt lgkmcnt(0)
    s_mul_i32 s4, s4, 0x9e3779b1
    s_add_u32 s4, s4, 0x7f4a7c15
    ds_write_b32 v252, v176
    s_waitcnt lgkmcnt(0)
    s_barrier
    ds_read_b128 v[176:179], v251
    ds_read_b128 v[180:183], v251 offset:16
    s_waitcnt lgkmcnt(0)
    v_pk_add_f32 v[176:177], v[176:177], v[178:179]
    v_pk_add_f32 v[180:181], v[180:181], v[182:183]
    v_pk_add_f32 v[176:177], v[176:177], v[180:181]
    v_add_f32 v176, v176, v177
    v_mov_b32 v177, s4
    s_bitcmp1_b32 s3, 0
    s_cselect_b32 exec_lo, 0, -1
    s_cselect_b32 exec_hi, -1, 0
    buffer_store_dwordx2 v[176:177], v250, s[32:35], s13 offen sc1
    s_mov_b64 exec, -1
    s_lshr_b32 s96, s9, 4
    s_lshl_b32 s94, s96, 1
    s_add_u32 s96, s94, s84
    s_and_b32 s97, s96, 15
    s_mul_i32 s98, s97, 393216
    s_add_u32 s91, s98, s85
    s_lshl_b32 s96, s94, 13
    s_add_u32 s94, s96, s83
    s_add_u32 s82, s91, 2048
    s_mov_b32 m0, s94
    s_nop 0
    buffer_load_dwordx4 v3, s[40:43], s82 offen lds
    s_add_u32 s82, s91, 4096
    s_add_u32 m0, s94, 49152
    s_nop 0
    buffer_load_dwordx4 v3, s[40:43], s82 offen lds
    s_waitcnt vmcnt(6)
    v_mov_b32 v8, 0x3f803f80
    v_dot2_f32_bf16 v4, v152, v8, 0
    v_dot2_f32_bf16 v5, v152, v152, 0
    v_dot2_f32_bf16 v6, v153, v8, 0
    v_dot2_f32_bf16 v7, v153, v153, 0
    v_dot2_f32_bf16 v4, v154, v8, v4
    v_dot2_f32_bf16 v5, v154, v154, v5
    v_dot2_f32_bf16 v6, v155, v8, v6
    v_dot2_f32_bf16 v7, v155, v155, v7
    v_dot2_f32_bf16 v4, v156, v8, v4
    v_dot2_f32_bf16 v5, v156, v156, v5
    v_dot2_f32_bf16 v6, v157, v8, v6
    v_dot2_f32_bf16 v7, v157, v157, v7
    v_dot2_f32_bf16 v4, v158, v8, v4
    v_dot2_f32_bf16 v5, v158, v158, v5
    v_dot2_f32_bf16 v6, v159, v8, v6
    v_dot2_f32_bf16 v7, v159, v159, v7
    s_nop 2
    v_pk_add_f32 v[4:5], v[4:5], v[6:7]
    s_nop 1
    v_add_f32_dpp v4, v4, v4 quad_perm:[1,0,3,2] row_mask:0xf bank_mask:0xf
    v_add_f32_dpp v5, v5, v5 quad_perm:[1,0,3,2] row_mask:0xf bank_mask:0xf
    s_nop 0
    v_add_f32_dpp v4, v4, v4 quad_perm:[2,3,0,1] row_mask:0xf bank_mask:0xf
    v_add_f32_dpp v5, v5, v5 quad_perm:[2,3,0,1] row_mask:0xf bank_mask:0xf
    s_nop 0
    v_add_f32_dpp v4, v4, v4 row_half_mirror row_mask:0xf bank_mask:0xf
    v_add_f32_dpp v5, v5, v5 row_half_mirror row_mask:0xf bank_mask:0xf
    s_nop 0
    v_add_f32_dpp v4, v4, v4 row_ror:8 row_mask:0xf bank_mask:0xf
    v_add_f32_dpp v5, v5, v5 row_ror:8 row_mask:0xf bank_mask:0xf
    s_nop 1
    v_permlane16_swap_b32 v4, v5
    v_add_f32 v8, v4, v5
    v_add_f32 v4, v4, v5
    s_nop 1
    v_permlane32_swap_b32 v4, v8
    v_add_f32 v4, v4, v8
    v_mul_f32 v8, 0x3a800000, v4
    v_mul_f32 v4, 0x3a800000, v4
    s_nop 1
    v_permlane16_swap_b32 v4, v8
    v_fma_f32 v173, -v4, v4, v8
    v_cvt_pk_bf16_f32 v172, 0, v4
    v_max_f32 v173, 0, v173
    v_cvt_pk_bf16_f32 v173, 0, v173
    v_add_f32 v173, 0x3727c5ac, v173
    v_cvt_pk_bf16_f32 v173, 0, v173
    v_sqrt_f32 v173, v173
    s_nop 0
    v_cvt_pk_bf16_f32 v173, 0, v173
    s_lshl3_add_u32 s13, s3, 153600
    v_lshrrev_b32 v172, 16, v172
    v_or_b32 v172, v172, v173
    v_mov_b32 v173, s4
    v_mov_b32 v4, s13
    ds_write_b64 v4, v[172:173]
    v_and_b32 v5, 3, v1
    v_lshlrev_b32 v5, 4, v5
    v_add_u32 v5, 153600, v5
    v_and_b32 v4, 3, v1
    v_lshlrev_b32 v4, 4, v4
    v_bfe_u32 v9, v1, 2, 1
    v_lshl_add_u32 v4, v9, 10, v4
    s_and_b32 s96, s8, 6
    s_and_b32 s97, s8, 1
    s_lshr_b32 s98, s9, 4
    s_lshl1_add_u32 s99, s97, s98
    s_lshl_b32 s97, s99, 6
    s_add_u32 s98, s96, s97
    s_lshl3_add_u32 s99, s3, s98
    s_lshl_b32 s96, s99, 10
    s_and_b32 s97, s9, 15
    s_lshl_b32 s98, s97, 6
    s_add_u32 s99, s96, s98
    s_add_u32 s13, s99, 262144
    s_waitcnt lgkmcnt(0)
    s_barrier
    ds_read_b128 v[172:175], v5
    s_waitcnt lgkmcnt(0)
    s_mov_b64 exec, 0xff
    buffer_store_dwordx4 v[172:175], v4, s[32:35], s13 offen sc1
    s_mov_b64 exec, -1
    s_mov_b32 s82, s91
    s_add_u32 m0, s94, 98304
    s_nop 0
    buffer_load_dwordx4 v3, s[40:43], s82 offen lds
    s_load_dword s24, s[32:33], s17 offset:508 glc
    s_load_dword s25, s[32:33], s17 offset:4604 glc
    v_and_b32 v4, 31, v1
    v_lshlrev_b32 v4, 4, v4
    v_lshrrev_b32 v9, 5, v1
    v_lshl_add_u32 v4, v9, 12, v4
    s_lshl2_add_u32 s14, s3, 155648
    v_lshl_add_u32 v5, v1, 6, s14
    v_and_b32 v6, 3, v1
    v_lshlrev_b32 v6, 5, v6
    v_lshrrev_b32 v9, 5, v1
    v_lshl_add_u32 v6, v9, 7, v6
    v_bfe_u32 v9, v1, 4, 1
    v_lshl_add_u32 v6, v9, 8, v6
    v_bfe_u32 v9, v1, 2, 2
    v_lshl_add_u32 v6, v9, 9, v6
    v_add_u32 v6, 155648, v6
    s_lshl3_add_u32 s96, s2, s3
    s_lshl_b32 s97, s96, 7
    s_add_u32 s14, s97, 262144
    v_and_b32 v8, 15, v1
    v_lshlrev_b32 v8, 3, v8
    s_branch SCHK_2
SPOLL_1:
    s_load_dword s24, s[32:33], s17 offset:508 glc
    s_load_dword s25, s[32:33], s17 offset:4604 glc
SCHK_2:
    s_add_u32 s5, s5, 1
    s_cmp_ge_u32 s5, 200000
    s_waitcnt lgkmcnt(0)
    s_cbranch_scc1 SDONE_3
    s_cmp_lg_u32 s24, s4
    s_cbranch_scc1 SPOLL_1
    s_cmp_lg_u32 s25, s4
    s_cbranch_scc1 SPOLL_1
SDONE_3:
    buffer_load_dwordx4 v[176:179], v4, s[32:35], s17 offen sc1
    s_load_dword s24, s[32:33], s14 offset:60 glc
    s_load_dword s25, s[32:33], s14 offset:124 glc
    s_waitcnt vmcnt(6)
    v_permlane32_swap_b32 v12, v14
    v_permlane32_swap_b32 v13, v15
    v_permlane32_swap_b32 v16, v18
    v_permlane32_swap_b32 v17, v19
    v_lshlrev_b32 v184, 16, v12
    v_and_b32 v185, s6, v12
    v_lshlrev_b32 v186, 16, v13
    v_and_b32 v187, s6, v13
    v_lshlrev_b32 v188, 16, v14
    v_and_b32 v189, s6, v14
    v_lshlrev_b32 v190, 16, v15
    v_and_b32 v191, s6, v15
    v_lshlrev_b32 v192, 16, v16
    v_and_b32 v193, s6, v16
    v_lshlrev_b32 v194, 16, v17
    v_and_b32 v195, s6, v17
    v_lshlrev_b32 v196, 16, v18
    v_and_b32 v197, s6, v18
    v_lshlrev_b32 v198, 16, v19
    v_and_b32 v199, s6, v19
    s_branch SCHK_6
SPOLL_5:
    s_load_dword s24, s[32:33], s14 offset:60 glc
    s_load_dword s25, s[32:33], s14 offset:124 glc
SCHK_6:
    s_add_u32 s5, s5, 1
    s_cmp_ge_u32 s5, 200000
    s_waitcnt lgkmcnt(0)
    s_cbranch_scc1 SDONE_7
    s_cmp_lg_u32 s24, s4
    s_cbranch_scc1 SPOLL_5
    s_cmp_lg_u32 s25, s4
    s_cbranch_scc1 SPOLL_5
SDONE_7:
    buffer_load_dwordx2 v[172:173], v8, s[32:35], s14 offen sc1
    s_lshr_b32 s96, s9, 4
    s_lshl_b32 s97, s96, 1
    s_xor_b32 s94, s97, 1
    s_add_u32 s96, s94, s84
    s_and_b32 s97, s96, 15
    s_mul_i32 s98, s97, 393216
    s_add_u32 s91, s98, s85
    s_lshl_b32 s96, s94, 13
    s_add_u32 s94, s96, s83
    s_add_u32 s82, s91, 2048
    s_mov_b32 m0, s94
    s_nop 0
    buffer_load_dwordx4 v3, s[40:43], s82 offen lds
    s_add_u32 s82, s91, 4096
    s_add_u32 m0, s94, 49152
    s_nop 0
    buffer_load_dwordx4 v3, s[40:43], s82 offen lds
    s_mov_b32 s82, s91
    s_add_u32 m0, s94, 98304
    s_nop 0
    buffer_load_dwordx4 v3, s[40:43], s82 offen lds
    s_waitcnt vmcnt(4)
    v_bitop3_b32 v7, v177, v179, s4 bitop3:0x7e
    v_cmp_ne_u32 vcc, 0, v7
    s_cbranch_vccz TOK_8
POLL_9:
    buffer_load_dwordx4 v[176:179], v4, s[32:35], s17 offen sc1
    s_waitcnt vmcnt(0)
    v_bitop3_b32 v7, v177, v179, s4 bitop3:0x7e
    v_cmp_ne_u32 vcc, 0, v7
    s_cbranch_vccz PDONE_10
    s_add_u32 s5, s5, 1
    s_cmp_lt_u32 s5, 200000
    s_cbranch_scc1 POLL_9
PDONE_10:
TOK_8:
    ds_write2_b32 v5, v176, v178 offset0:0 offset1:8
    s_waitcnt lgkmcnt(0)
    s_barrier
    ds_read_b128 v[208:211], v6 offset:2048
    ds_read_b128 v[212:215], v6 offset:2064
    ds_read_b128 v[200:203], v6
    ds_read_b128 v[204:207], v6 offset:16
    s_lshl_b32 s96, s11, 12
    s_lshl_b32 s97, s3, 9
    s_add_u32 s13, s96, s97
    v_add_u32 v4, s13, v2
    s_lshl_b32 s96, s3, 9
    s_add_u32 m0, s96, 159744
    s_mov_b32 exec_hi, 0
    global_load_lds_dwordx4 v4, s[72:73]
    s_mov_b32 exec_hi, -1
    s_lshl4_add_u32 s96, s21, s12
    s_lshr_b32 s97, s3, 1
    s_lshl2_add_u32 s98, s96, s97
    s_lshl_b32 s99, s98, 12
    s_and_b32 s96, s3, 1
    s_lshl_b32 s97, s96, 8
    s_add_u32 s98, s99, s97
    s_add_u32 s13, s98, 4194304
    v_and_b32 v4, 15, v1
    v_lshlrev_b32 v4, 4, v4
    v_bfe_u32 v9, v1, 4, 1
    v_lshl_add_u32 v4, v9, 10, v4
    v_lshrrev_b32 v9, 5, v1
    v_lshl_add_u32 v4, v9, 9, v4
    s_waitcnt lgkmcnt(2)
    v_pk_add_f32 v[208:209], v[208:209], v[210:211]
    v_pk_add_f32 v[212:213], v[212:213], v[214:215]
    v_pk_add_f32 v[208:209], v[208:209], v[212:213]
    v_add_f32 v208, v208, v209
    v_cvt_pk_bf16_f32 v208, 0, v208
    s_waitcnt lgkmcnt(0)
    v_pk_add_f32 v[200:201], v[200:201], v[202:203]
    v_pk_add_f32 v[204:205], v[204:205], v[206:207]
    v_pk_add_f32 v[200:201], v[200:201], v[204:205]
    v_add_f32 v200, v200, v201
    v_add_f32 v208, 1.0, v208
    v_cvt_pk_bf16_f32 v208, 0, v208
    v_cvt_pk_bf16_f32 v200, 0, v200
    s_waitcnt vmcnt(4)
    v_cmp_ne_u32 vcc, s4, v173
    s_cbranch_vccz L_STOK
POLL_11:
    buffer_load_dwordx2 v[172:173], v8, s[32:35], s14 offen sc1
    s_waitcnt vmcnt(0)
    v_cmp_ne_u32 vcc, s4, v173
    s_cbranch_vccz PDONE_12
    s_add_u32 s5, s5, 1
    s_cmp_lt_u32 s5, 200000
    s_cbranch_scc1 POLL_11
PDONE_12:
L_STOK:
    v_lshlrev_b32 v173, 16, v172
    v_and_b32 v172, s6, v172
    v_rcp_f32 v172, v172
    s_nop 0
    v_pk_add_f32 v[184:185], v[184:185], v[172:173] op_sel:[0,1] neg_lo:[0,1] neg_hi:[0,1]
    v_pk_add_f32 v[186:187], v[186:187], v[172:173] op_sel:[0,1] neg_lo:[0,1] neg_hi:[0,1]
    v_pk_add_f32 v[188:189], v[188:189], v[172:173] op_sel:[0,1] neg_lo:[0,1] neg_hi:[0,1]
    v_pk_add_f32 v[190:191], v[190:191], v[172:173] op_sel:[0,1] neg_lo:[0,1] neg_hi:[0,1]
    v_pk_add_f32 v[192:193], v[192:193], v[172:173] op_sel:[0,1] neg_lo:[0,1] neg_hi:[0,1]
    v_pk_add_f32 v[194:195], v[194:195], v[172:173] op_sel:[0,1] neg_lo:[0,1] neg_hi:[0,1]
    v_pk_add_f32 v[196:197], v[196:197], v[172:173] op_sel:[0,1] neg_lo:[0,1] neg_hi:[0,1]
    v_pk_add_f32 v[198:199], v[198:199], v[172:173] op_sel:[0,1] neg_lo:[0,1] neg_hi:[0,1]
    v_cvt_pk_bf16_f32 v184, 0, v184
    v_cvt_pk_bf16_f32 v185, 0, v185
    v_cvt_pk_bf16_f32 v186, 0, v186
    v_cvt_pk_bf16_f32 v187, 0, v187
    v_cvt_pk_bf16_f32 v188, 0, v188
    v_cvt_pk_bf16_f32 v189, 0, v189
    v_cvt_pk_bf16_f32 v190, 0, v190
    v_cvt_pk_bf16_f32 v191, 0, v191
    v_cvt_pk_bf16_f32 v192, 0, v192
    v_cvt_pk_bf16_f32 v193, 0, v193
    v_cvt_pk_bf16_f32 v194, 0, v194
    v_cvt_pk_bf16_f32 v195, 0, v195
    v_cvt_pk_bf16_f32 v196, 0, v196
    v_cvt_pk_bf16_f32 v197, 0, v197
    v_cvt_pk_bf16_f32 v198, 0, v198
    v_cvt_pk_bf16_f32 v199, 0, v199
    v_pk_mul_f32 v[184:185], v[184:185], v[172:173] op_sel_hi:[1,0]
    v_pk_mul_f32 v[186:187], v[186:187], v[172:173] op_sel_hi:[1,0]
    v_pk_mul_f32 v[188:189], v[188:189], v[172:173] op_sel_hi:[1,0]
    v_pk_mul_f32 v[190:191], v[190:191], v[172:173] op_sel_hi:[1,0]
    v_pk_mul_f32 v[192:193], v[192:193], v[172:173] op_sel_hi:[1,0]
    v_pk_mul_f32 v[194:195], v[194:195], v[172:173] op_sel_hi:[1,0]
    v_pk_mul_f32 v[196:197], v[196:197], v[172:173] op_sel_hi:[1,0]
    v_pk_mul_f32 v[198:199], v[198:199], v[172:173] op_sel_hi:[1,0]
    v_cvt_pk_bf16_f32 v184, 0, v184
    v_cvt_pk_bf16_f32 v185, 0, v185
    v_cvt_pk_bf16_f32 v186, 0, v186
    v_cvt_pk_bf16_f32 v187, 0, v187
    v_cvt_pk_bf16_f32 v188, 0, v188
    v_cvt_pk_bf16_f32 v189, 0, v189
    v_cvt_pk_bf16_f32 v190, 0, v190
    v_cvt_pk_bf16_f32 v191, 0, v191
    v_cvt_pk_bf16_f32 v192, 0, v192
    v_cvt_pk_bf16_f32 v193, 0, v193
    v_cvt_pk_bf16_f32 v194, 0, v194
    v_cvt_pk_bf16_f32 v195, 0, v195
    v_cvt_pk_bf16_f32 v196, 0, v196
    v_cvt_pk_bf16_f32 v197, 0, v197
    v_cvt_pk_bf16_f32 v198, 0, v198
    v_cvt_pk_bf16_f32 v199, 0, v199
    v_mul_f32_dpp v184, v208, v184 row_newbcast:0 row_mask:0xf bank_mask:0xf
    v_mul_f32_dpp v185, v208, v185 row_newbcast:1 row_mask:0xf bank_mask:0xf
    v_mul_f32_dpp v186, v208, v186 row_newbcast:2 row_mask:0xf bank_mask:0xf
    v_mul_f32_dpp v187, v208, v187 row_newbcast:3 row_mask:0xf bank_mask:0xf
    v_mul_f32_dpp v188, v208, v188 row_newbcast:4 row_mask:0xf bank_mask:0xf
    v_mul_f32_dpp v189, v208, v189 row_newbcast:5 row_mask:0xf bank_mask:0xf
    v_mul_f32_dpp v190, v208, v190 row_newbcast:6 row_mask:0xf bank_mask:0xf
    v_mul_f32_dpp v191, v208, v191 row_newbcast:7 row_mask:0xf bank_mask:0xf
    v_cvt_pk_bf16_f32 v184, 0, v184
    v_cvt_pk_bf16_f32 v185, 0, v185
    v_cvt_pk_bf16_f32 v186, 0, v186
    v_cvt_pk_bf16_f32 v187, 0, v187
    v_cvt_pk_bf16_f32 v188, 0, v188
    v_cvt_pk_bf16_f32 v189, 0, v189
    v_cvt_pk_bf16_f32 v190, 0, v190
    v_cvt_pk_bf16_f32 v191, 0, v191
    v_add_f32_dpp v184, v200, v184 row_newbcast:0 row_mask:0xf bank_mask:0xf
    v_add_f32_dpp v185, v200, v185 row_newbcast:1 row_mask:0xf bank_mask:0xf
    v_add_f32_dpp v186, v200, v186 row_newbcast:2 row_mask:0xf bank_mask:0xf
    v_add_f32_dpp v187, v200, v187 row_newbcast:3 row_mask:0xf bank_mask:0xf
    v_add_f32_dpp v188, v200, v188 row_newbcast:4 row_mask:0xf bank_mask:0xf
    v_add_f32_dpp v189, v200, v189 row_newbcast:5 row_mask:0xf bank_mask:0xf
    v_add_f32_dpp v190, v200, v190 row_newbcast:6 row_mask:0xf bank_mask:0xf
    v_add_f32_dpp v191, v200, v191 row_newbcast:7 row_mask:0xf bank_mask:0xf
    v_cvt_pk_bf16_f32 v216, v184, v185
    v_cvt_pk_bf16_f32 v217, v186, v187
    v_cvt_pk_bf16_f32 v218, v188, v189
    v_cvt_pk_bf16_f32 v219, v190, v191
    buffer_store_dwordx4 v[216:219], v4, s[32:35], s13 offen sc1
    v_mul_f32_dpp v192, v208, v192 row_newbcast:8 row_mask:0xf bank_mask:0xf
    v_mul_f32_dpp v193, v208, v193 row_newbcast:9 row_mask:0xf bank_mask:0xf
    v_mul_f32_dpp v194, v208, v194 row_newbcast:10 row_mask:0xf bank_mask:0xf
    v_mul_f32_dpp v195, v208, v195 row_newbcast:11 row_mask:0xf bank_mask:0xf
    v_mul_f32_dpp v196, v208, v196 row_newbcast:12 row_mask:0xf bank_mask:0xf
    v_mul_f32_dpp v197, v208, v197 row_newbcast:13 row_mask:0xf bank_mask:0xf
    v_mul_f32_dpp v198, v208, v198 row_newbcast:14 row_mask:0xf bank_mask:0xf
    v_mul_f32_dpp v199, v208, v199 row_newbcast:15 row_mask:0xf bank_mask:0xf
    v_cvt_pk_bf16_f32 v192, 0, v192
    v_cvt_pk_bf16_f32 v193, 0, v193
    v_cvt_pk_bf16_f32 v194, 0, v194
    v_cvt_pk_bf16_f32 v195, 0, v195
    v_cvt_pk_bf16_f32 v196, 0, v196
    v_cvt_pk_bf16_f32 v197, 0, v197
    v_cvt_pk_bf16_f32 v198, 0, v198
    v_cvt_pk_bf16_f32 v199, 0, v199
    v_add_f32_dpp v192, v200, v192 row_newbcast:8 row_mask:0xf bank_mask:0xf
    v_add_f32_dpp v193, v200, v193 row_newbcast:9 row_mask:0xf bank_mask:0xf
    v_add_f32_dpp v194, v200, v194 row_newbcast:10 row_mask:0xf bank_mask:0xf
    v_add_f32_dpp v195, v200, v195 row_newbcast:11 row_mask:0xf bank_mask:0xf
    v_add_f32_dpp v196, v200, v196 row_newbcast:12 row_mask:0xf bank_mask:0xf
    v_add_f32_dpp v197, v200, v197 row_newbcast:13 row_mask:0xf bank_mask:0xf
    v_add_f32_dpp v198, v200, v198 row_newbcast:14 row_mask:0xf bank_mask:0xf
    v_add_f32_dpp v199, v200, v199 row_newbcast:15 row_mask:0xf bank_mask:0xf
    v_cvt_pk_bf16_f32 v220, v192, v193
    v_cvt_pk_bf16_f32 v221, v194, v195
    v_cvt_pk_bf16_f32 v222, v196, v197
    v_cvt_pk_bf16_f32 v223, v198, v199
    buffer_store_dwordx4 v[220:223], v4, s[32:35], s13 offen offset:2048 sc1
    v_bfe_u32 v20, v1, 2, 2
    v_lshlrev_b32 v20, 7, v20
    v_bfe_u32 v9, v1, 3, 1
    v_lshl_add_u32 v20, v9, 6, v20
    v_bfe_u32 v9, v1, 4, 1
    v_lshl_add_u32 v20, v9, 5, v20
    v_and_b32 v9, 3, v1
    v_lshl_add_u32 v20, v9, 3, v20
    v_lshrrev_b32 v9, 5, v1
    v_lshl_add_u32 v20, v9, 9, v20
    v_xor_b32 v21, 64, v20
    v_add_u32 v22, 49152, v20
    v_add_u32 v23, 49152, v21
    v_add_u32 v24, 98304, v20
    v_add_u32 v25, 98304, v21
    v_and_b32 v5, 3, v1
    v_lshlrev_b32 v5, 15, v5
    v_bfe_u32 v9, v1, 2, 2
    v_lshl_add_u32 v5, v9, 12, v5
    s_and_b32 s96, s12, 1
    s_lshr_b32 s97, s21, 3
    s_and_b32 s98, s21, 7
    s_lshl_b32 s99, s98, 5
    s_lshl2_add_u32 s98, s97, s99
    s_lshl_b32 s97, s98, 12
    s_lshr_b32 s99, s12, 1
    s_lshl_b32 s98, s99, 6
    s_add_u32 s99, s97, s98
    s_lshl2_add_u32 s97, s96, s99
    s_add_u32 s13, s97, 1048576
    s_lshl_b32 s96, s10, 18
    s_lshl_b32 s97, s77, 12
    s_add_u32 s98, s96, s97
    s_add_u32 s88, s98, 4194304
    s_cmp_ge_u32 s9, 28
    s_cselect_b32 s54, 0, s54
    s_cselect_b32 s58, 0, s58
    s_cselect_b32 s62, 0, s62
    s_waitcnt vmcnt(0)
    s_barrier
    s_cmp_lg_u32 s3, 0
    s_cbranch_scc1 L_PB
    v_mov_b32 v6, s4
    s_mov_b32 exec_hi, 0
    s_mov_b32 exec_lo, 65535
    buffer_store_dword v6, v5, s[32:35], s13 offen sc1
    s_mov_b64 exec, -1
L_PB:
    s_lshr_b32 s96, s9, 4
    s_lshl_b32 s97, s96, 1
    s_xor_b32 s94, s97, 2
    s_add_u32 s96, s94, s84
    s_and_b32 s97, s96, 15
    s_mul_i32 s98, s97, 393216
    s_add_u32 s91, s98, s85
    s_lshl_b32 s96, s94, 13
    s_add_u32 s94, s96, s83
    s_add_u32 s82, s91, 2048
    s_mov_b32 m0, s94
    s_nop 0
    buffer_load_dwordx4 v3, s[40:43], s82 offen lds
    s_add_u32 s82, s91, 4096
    s_add_u32 m0, s94, 49152
    s_nop 0
    buffer_load_dwordx4 v3, s[40:43], s82 offen lds
    s_mov_b32 s82, s91
    s_add_u32 m0, s94, 98304
    s_nop 0
    buffer_load_dwordx4 v3, s[40:43], s82 offen lds
    s_lshr_b32 s96, s9, 4
    s_lshl_b32 s97, s96, 1
    s_xor_b32 s94, s97, 3
    s_add_u32 s96, s94, s84
    s_and_b32 s97, s96, 15
    s_mul_i32 s98, s97, 393216
    s_add_u32 s91, s98, s85
    s_lshl_b32 s96, s94, 13
    s_add_u32 s94, s96, s83
    s_add_u32 s82, s91, 2048
    s_mov_b32 m0, s94
    s_nop 0
    buffer_load_dwordx4 v3, s[40:43], s82 offen lds
    s_add_u32 s82, s91, 4096
    s_add_u32 m0, s94, 49152
    s_nop 0
    buffer_load_dwordx4 v3, s[40:43], s82 offen lds
    s_mov_b32 s82, s91
    s_add_u32 m0, s94, 98304
    s_nop 0
    buffer_load_dwordx4 v3, s[40:43], s82 offen lds
    s_lshl_b32 s96, s2, 12
    s_add_u32 s19, s96, 1048576
    s_and_b32 s96, s3, 3
    s_lshl_b32 s97, s96, 7
    s_add_u32 s20, s97, s19
    s_lshl_b32 s96, s84, 5
    s_add_u32 s19, s96, s19
    s_cmp_ge_u32 s3, 4
    s_cselect_b32 s19, s20, s19
    s_load_dwordx2 s[24:25], s[32:33], s19 offset:0 glc
    s_load_dwordx2 s[26:27], s[32:33], s19 offset:64 glc
    s_add_u32 s96, s84, 4
    s_and_b32 s97, s96, 15
    s_mul_i32 s98, s97, 393216
    s_add_u32 s91, s98, s85
    s_add_u32 s94, s83, 32768
    s_add_u32 s82, s91, 2048
    s_mov_b32 m0, s94
    s_nop 0
    buffer_load_dwordx4 v3, s[40:43], s82 offen lds
    s_add_u32 s82, s91, 4096
    s_add_u32 m0, s94, 49152
    s_nop 0
    buffer_load_dwordx4 v3, s[40:43], s82 offen lds
    s_mov_b32 s82, s91
    s_add_u32 m0, s94, 98304
    s_nop 0
    buffer_load_dwordx4 v3, s[40:43], s82 offen lds
    s_lshl_b32 s96, s3, 14
    s_lshl_b32 s97, s12, 7
    s_add_u32 s90, s96, s97
    s_and_b32 s96, s9, 1
    s_lshr_b32 s97, s9, 3
    s_lshl_b32 s98, s97, 1
    s_lshl3_add_u32 s99, s96, s98
    s_lshl_b32 s95, s99, 17
    s_lshl3_add_u32 s96, s75, s3
    s_mul_i32 s97, s96, 229376
    s_lshl_b32 s98, s74, 7
    s_add_u32 s80, s97, s98
    s_lshl3_add_u32 s96, s74, s3
    s_lshl_b32 s97, s96, 14
    s_lshl_b32 s98, s75, 9
    s_add_u32 s81, s97, s98
    s_and_b32 s96, s8, 3
    s_lshl3_add_u32 s97, s96, s3
    s_mul_i32 s98, s97, 393216
    s_lshr_b32 s99, s8, 2
    s_lshl1_add_u32 s96, s9, s99
    s_lshl_b32 s97, s96, 7
    s_add_u32 s99, s98, s97
    s_add_u32 s89, s99, 4096
    s_and_b32 s96, s3, 1
    s_lshl_b32 s14, s96, 6
    v_bfe_u32 v6, v1, 4, 1
    v_lshl_add_u32 v6, v6, 5, s14
    v_and_b32 v26, 7, v1
    v_lshlrev_b32 v26, 4, v26
    v_xor_b32 v26, v26, v6
    v_lshrrev_b32 v6, 3, v1
    v_lshlrev_b32 v6, 11, v6
    v_add_u32 v26, v26, v6
    s_and_b32 s96, s3, 2
    s_lshl_b32 s14, s96, 5
    v_bfe_u32 v6, v1, 4, 1
    v_lshl_add_u32 v6, v6, 5, s14
    v_and_b32 v27, 7, v1
    v_lshlrev_b32 v27, 4, v27
    v_xor_b32 v27, v27, v6
    v_lshrrev_b32 v6, 3, v1
    v_mul_u32_u24 v6, 7168, v6
    v_add_u32 v27, v27, v6
    s_and_b32 s96, s3, 1
    s_lshl_b32 s14, s96, 7
    v_lshrrev_b32 v6, 5, v1
    v_lshl_add_u32 v6, v6, 6, s14
    v_and_b32 v253, 31, v1
    v_lshlrev_b32 v253, 4, v253
    v_lshrrev_b32 v9, 5, v1
    v_lshl_add_u32 v253, v9, 11, v253
    v_xor_b32 v253, v253, v6
    s_lshl_b32 s16, s84, 14
    v_add_u32 v249, s88, v2
    s_lshl_b32 s96, s77, 11
    s_add_u32 s14, s96, 151552
    v_add_u32 v0, s14, v2
    s_mov_b64 exec, 0
    s_cmp_eq_u32 s3, 4
    s_cbranch_scc1 L_PAD2
    s_cmp_eq_u32 s3, 5
    s_cbranch_scc1 L_PAD3
    s_cmp_eq_u32 s3, 6
    s_cbranch_scc1 L_PAD4
    s_cmp_eq_u32 s3, 7
    s_cbranch_scc1 L_PAD5
    s_branch L_TEND
L_RET2:
    s_branch L_PAD6
L_RET6:
    s_branch L_PAD10
L_RET10:
    s_branch L_TEND
L_RET3:
    s_branch L_PAD7
L_RET7:
    s_branch L_TEND
L_RET4:
    s_branch L_PAD8
L_RET8:
    s_branch L_TEND
L_RET5:
    s_branch L_PAD9
L_RET9:
    s_branch L_TEND
    s_nop 0
    s_nop 0
    s_nop 0
    s_nop 0
    s_nop 0
    s_nop 0
    s_nop 0
    s_nop 0
    s_nop 0
    s_nop 0
    s_nop 0
    s_nop 0
    s_nop 0
    s_nop 0
    s_nop 0
    s_nop 0
    s_nop 0
    s_nop 0
    s_nop 0
    s_nop 0
    s_nop 0
    s_nop 0
    s_nop 0
    s_nop 0
    s_nop 0
    s_nop 0
    s_nop 0
    s_nop 0
L_TEND:
    s_mov_b64 exec, -1
    s_branch SCHK_14
SPOLL_13:
    s_load_dwordx2 s[24:25], s[32:33], s19 offset:0 glc
    s_load_dwordx2 s[26:27], s[32:33], s19 offset:64 glc
SCHK_14:
    s_add_u32 s5, s5, 1
    s_cmp_ge_u32 s5, 200000
    s_waitcnt lgkmcnt(0)
    s_cbranch_scc1 SDONE_15
    s_cmp_lg_u32 s24, s4
    s_cbranch_scc1 SPOLL_13
    s_cmp_lg_u32 s25, s4
    s_cbranch_scc1 SPOLL_13
    s_cmp_lg_u32 s26, s4
    s_cbranch_scc1 SPOLL_13
    s_cmp_lg_u32 s27, s4
    s_cbranch_scc1 SPOLL_13
SDONE_15:
    s_cmp_ge_u32 s3, 4
    s_cbranch_scc1 L_HELP
    s_setprio 2
    buffer_load_dwordx4 v[152:155], v249, s[32:35], s16 offen sc1
    buffer_load_dwordx4 v[156:159], v249, s[32:35], s16 offen offset:1024 sc1
    buffer_load_dwordx4 v[160:163], v249, s[32:35], s16 offen offset:2048 sc1
    buffer_load_dwordx4 v[164:167], v249, s[32:35], s16 offen offset:3072 sc1
    s_add_u32 s16, s16, 16384
    s_and_b32 s16, s16, 0x3ffff
    buffer_load_dwordx4 v[168:171], v249, s[32:35], s16 offen sc1
    buffer_load_dwordx4 v[172:175], v249, s[32:35], s16 offen offset:1024 sc1
    s_waitcnt vmcnt(9)
    s_barrier
    ds_read_b64_tr_b16 v[28:29], v20
    ds_read_b64_tr_b16 v[30:31], v20 offset:2048
    ds_read_b64_tr_b16 v[32:33], v21
    ds_read_b64_tr_b16 v[34:35], v21 offset:2048
    ds_read_b64_tr_b16 v[36:37], v24
    ds_read_b64_tr_b16 v[38:39], v24 offset:2048
    ds_read_b64_tr_b16 v[40:41], v25
    ds_read_b64_tr_b16 v[42:43], v25 offset:2048
    ds_read_b64_tr_b16 v[44:45], v22
    ds_read_b64_tr_b16 v[46:47], v22 offset:2048
    ds_read_b64_tr_b16 v[48:49], v23
    ds_read_b64_tr_b16 v[50:51], v23 offset:2048
    s_waitcnt vmcnt(5)
    s_waitcnt lgkmcnt(10)
    v_mfma_f32_32x32x16_bf16 v[56:71], v[28:31], v[152:155], 0
    ds_read_b64_tr_b16 v[52:53], v20 offset:1024
    ds_read_b64_tr_b16 v[54:55], v20 offset:3072
    s_waitcnt lgkmcnt(10)
    v_mfma_f32_32x32x16_bf16 v[72:87], v[32:35], v[152:155], 0
    ds_read_b64_tr_b16 v[28:29], v21 offset:1024
    ds_read_b64_tr_b16 v[30:31], v21 offset:3072
    s_waitcnt lgkmcnt(10)
    v_mfma_f32_32x32x16_bf16 v[120:135], v[36:39], v[152:155], 0
    ds_read_b64_tr_b16 v[32:33], v24 offset:1024
    ds_read_b64_tr_b16 v[34:35], v24 offset:3072
    s_waitcnt lgkmcnt(10)
    v_mfma_f32_32x32x16_bf16 v[136:151], v[40:43], v[152:155], 0
    ds_read_b64_tr_b16 v[36:37], v25 offset:1024
    ds_read_b64_tr_b16 v[38:39], v25 offset:3072
    s_waitcnt lgkmcnt(10)
    v_mfma_f32_32x32x16_bf16 v[88:103], v[44:47], v[152:155], 0
    buffer_load_dwordx4 v[176:179], v249, s[32:35], s16 offen offset:2048 sc1
    ds_read_b64_tr_b16 v[40:41], v22 offset:1024
    ds_read_b64_tr_b16 v[42:43], v22 offset:3072
    s_waitcnt lgkmcnt(10)
    v_mfma_f32_32x32x16_bf16 v[104:119], v[48:51], v[152:155], 0
    ds_read_b64_tr_b16 v[44:45], v23 offset:1024
    ds_read_b64_tr_b16 v[46:47], v23 offset:3072
    s_waitcnt vmcnt(5)
    s_waitcnt lgkmcnt(10)
    v_mfma_f32_32x32x16_bf16 v[56:71], v[52:55], v[156:159], v[56:71]
    ds_read_b64_tr_b16 v[48:49], v20 offset:4096
    ds_read_b64_tr_b16 v[50:51], v20 offset:6144
    s_waitcnt lgkmcnt(10)
    v_mfma_f32_32x32x16_bf16 v[72:87], v[28:31], v[156:159], v[72:87]
    ds_read_b64_tr_b16 v[52:53], v21 offset:4096
    ds_read_b64_tr_b16 v[54:55], v21 offset:6144
    s_waitcnt lgkmcnt(10)
    v_mfma_f32_32x32x16_bf16 v[120:135], v[32:35], v[156:159], v[120:135]
    ds_read_b64_tr_b16 v[28:29], v24 offset:4096
    ds_read_b64_tr_b16 v[30:31], v24 offset:6144
    s_waitcnt lgkmcnt(10)
    v_mfma_f32_32x32x16_bf16 v[136:151], v[36:39], v[156:159], v[136:151]
    buffer_load_dwordx4 v[180:183], v249, s[32:35], s16 offen offset:3072 sc1
    ds_read_b64_tr_b16 v[32:33], v25 offset:4096
    ds_read_b64_tr_b16 v[34:35], v25 offset:6144
    s_waitcnt lgkmcnt(10)
    v_mfma_f32_32x32x16_bf16 v[88:103], v[40:43], v[156:159], v[88:103]
    s_add_u32 s16, s16, 16384
    ds_read_b64_tr_b16 v[36:37], v22 offset:4096
    ds_read_b64_tr_b16 v[38:39], v22 offset:6144
    s_waitcnt lgkmcnt(10)
    v_mfma_f32_32x32x16_bf16 v[104:119], v[44:47], v[156:159], v[104:119]
    s_and_b32 s16, s16, 0x3ffff
    ds_read_b64_tr_b16 v[40:41], v23 offset:4096
    ds_read_b64_tr_b16 v[42:43], v23 offset:6144
    s_waitcnt vmcnt(5)
    s_waitcnt lgkmcnt(10)
    v_mfma_f32_32x32x16_bf16 v[56:71], v[48:51], v[160:163], v[56:71]
    ds_read_b64_tr_b16 v[44:45], v20 offset:5120
    ds_read_b64_tr_b16 v[46:47], v20 offset:7168
    s_waitcnt lgkmcnt(10)
    v_mfma_f32_32x32x16_bf16 v[72:87], v[52:55], v[160:163], v[72:87]
    ds_read_b64_tr_b16 v[48:49], v21 offset:5120
    ds_read_b64_tr_b16 v[50:51], v21 offset:7168
    s_waitcnt lgkmcnt(10)
    v_mfma_f32_32x32x16_bf16 v[120:135], v[28:31], v[160:163], v[120:135]
    buffer_load_dwordx4 v[184:187], v249, s[32:35], s16 offen sc1
    ds_read_b64_tr_b16 v[52:53], v24 offset:5120
    ds_read_b64_tr_b16 v[54:55], v24 offset:7168
    s_waitcnt lgkmcnt(10)
    v_mfma_f32_32x32x16_bf16 v[136:151], v[32:35], v[160:163], v[136:151]
    ds_read_b64_tr_b16 v[28:29], v25 offset:5120
    ds_read_b64_tr_b16 v[30:31], v25 offset:7168
    s_waitcnt lgkmcnt(10)
    v_mfma_f32_32x32x16_bf16 v[88:103], v[36:39], v[160:163], v[88:103]
    ds_read_b64_tr_b16 v[32:33], v22 offset:5120
    ds_read_b64_tr_b16 v[34:35], v22 offset:7168
    s_waitcnt lgkmcnt(10)
    v_mfma_f32_32x32x16_bf16 v[104:119], v[40:43], v[160:163], v[104:119]
    ds_read_b64_tr_b16 v[36:37], v23 offset:5120
    ds_read_b64_tr_b16 v[38:39], v23 offset:7168
    s_waitcnt vmcnt(5)
    s_waitcnt lgkmcnt(10)
    v_mfma_f32_32x32x16_bf16 v[56:71], v[44:47], v[164:167], v[56:71]
    ds_read_b64_tr_b16 v[40:41], v20 offset:8192
    ds_read_b64_tr_b16 v[42:43], v20 offset:10240
    s_waitcnt lgkmcnt(10)
    v_mfma_f32_32x32x16_bf16 v[72:87], v[48:51], v[164:167], v[72:87]
    buffer_load_dwordx4 v[188:191], v249, s[32:35], s16 offen offset:1024 sc1
    ds_read_b64_tr_b16 v[44:45], v21 offset:8192
    ds_read_b64_tr_b16 v[46:47], v21 offset:10240
    s_waitcnt lgkmcnt(10)
    v_mfma_f32_32x32x16_bf16 v[120:135], v[52:55], v[164:167], v[120:135]
    ds_read_b64_tr_b16 v[48:49], v24 offset:8192
    ds_read_b64_tr_b16 v[50:51], v24 offset:10240
    s_waitcnt lgkmcnt(10)
    v_mfma_f32_32x32x16_bf16 v[136:151], v[28:31], v[164:167], v[136:151]
    ds_read_b64_tr_b16 v[52:53], v25 offset:8192
    ds_read_b64_tr_b16 v[54:55], v25 offset:10240
    s_waitcnt lgkmcnt(10)
    v_mfma_f32_32x32x16_bf16 v[88:103], v[32:35], v[164:167], v[88:103]
    ds_read_b64_tr_b16 v[28:29], v22 offset:8192
    ds_read_b64_tr_b16 v[30:31], v22 offset:10240
    s_waitcnt lgkmcnt(10)
    v_mfma_f32_32x32x16_bf16 v[104:119], v[36:39], v[164:167], v[104:119]
    buffer_load_dwordx4 v[192:195], v249, s[32:35], s16 offen offset:2048 sc1
    ds_read_b64_tr_b16 v[32:33], v23 offset:8192
    ds_read_b64_tr_b16 v[34:35], v23 offset:10240
    s_barrier
    s_waitcnt vmcnt(6)
    s_waitcnt lgkmcnt(10)
    v_mfma_f32_32x32x16_bf16 v[56:71], v[40:43], v[168:171], v[56:71]
    ds_read_b64_tr_b16 v[36:37], v20 offset:9216
    ds_read_b64_tr_b16 v[38:39], v20 offset:11264
    s_waitcnt lgkmcnt(10)
    v_mfma_f32_32x32x16_bf16 v[72:87], v[44:47], v[168:171], v[72:87]
    ds_read_b64_tr_b16 v[40:41], v21 offset:9216
    ds_read_b64_tr_b16 v[42:43], v21 offset:11264
    s_waitcnt lgkmcnt(10)
    v_mfma_f32_32x32x16_bf16 v[120:135], v[48:51], v[168:171], v[120:135]
    ds_read_b64_tr_b16 v[44:45], v24 offset:9216
    ds_read_b64_tr_b16 v[46:47], v24 offset:11264
    s_waitcnt lgkmcnt(10)
    v_mfma_f32_32x32x16_bf16 v[136:151], v[52:55], v[168:171], v[136:151]
    ds_read_b64_tr_b16 v[48:49], v25 offset:9216
    ds_read_b64_tr_b16 v[50:51], v25 offset:11264
    s_waitcnt lgkmcnt(10)
    v_mfma_f32_32x32x16_bf16 v[88:103], v[28:31], v[168:171], v[88:103]
    buffer_load_dwordx4 v[196:199], v249, s[32:35], s16 offen offset:3072 sc1
    ds_read_b64_tr_b16 v[52:53], v22 offset:9216
    ds_read_b64_tr_b16 v[54:55], v22 offset:11264
    s_waitcnt lgkmcnt(10)
    v_mfma_f32_32x32x16_bf16 v[104:119], v[32:35], v[168:171], v[104:119]
    s_add_u32 s16, s16, 16384
    ds_read_b64_tr_b16 v[28:29], v23 offset:9216
    ds_read_b64_tr_b16 v[30:31], v23 offset:11264
    s_waitcnt vmcnt(6)
    s_waitcnt lgkmcnt(10)
    v_mfma_f32_32x32x16_bf16 v[56:71], v[36:39], v[172:175], v[56:71]
    s_and_b32 s16, s16, 0x3ffff
    ds_read_b64_tr_b16 v[32:33], v20 offset:12288
    ds_read_b64_tr_b16 v[34:35], v20 offset:14336
    s_waitcnt lgkmcnt(10)
    v_mfma_f32_32x32x16_bf16 v[72:87], v[40:43], v[172:175], v[72:87]
    ds_read_b64_tr_b16 v[36:37], v21 offset:12288
    ds_read_b64_tr_b16 v[38:39], v21 offset:14336
    s_waitcnt lgkmcnt(10)
    v_mfma_f32_32x32x16_bf16 v[120:135], v[44:47], v[172:175], v[120:135]
    ds_read_b64_tr_b16 v[40:41], v24 offset:12288
    ds_read_b64_tr_b16 v[42:43], v24 offset:14336
    s_waitcnt lgkmcnt(10)
    v_mfma_f32_32x32x16_bf16 v[136:151], v[48:51], v[172:175], v[136:151]
    buffer_load_dwordx4 v[200:203], v249, s[32:35], s16 offen sc1
    ds_read_b64_tr_b16 v[44:45], v25 offset:12288
    ds_read_b64_tr_b16 v[46:47], v25 offset:14336
    s_waitcnt lgkmcnt(10)
    v_mfma_f32_32x32x16_bf16 v[88:103], v[52:55], v[172:175], v[88:103]
    ds_read_b64_tr_b16 v[48:49], v22 offset:12288
    ds_read_b64_tr_b16 v[50:51], v22 offset:14336
    s_waitcnt lgkmcnt(10)
    v_mfma_f32_32x32x16_bf16 v[104:119], v[28:31], v[172:175], v[104:119]
    ds_read_b64_tr_b16 v[52:53], v23 offset:12288
    ds_read_b64_tr_b16 v[54:55], v23 offset:14336
    s_waitcnt vmcnt(6)
    s_waitcnt lgkmcnt(10)
    v_mfma_f32_32x32x16_bf16 v[56:71], v[32:35], v[176:179], v[56:71]
    ds_read_b64_tr_b16 v[28:29], v20 offset:13312
    ds_read_b64_tr_b16 v[30:31], v20 offset:15360
    s_waitcnt lgkmcnt(10)
    v_mfma_f32_32x32x16_bf16 v[72:87], v[36:39], v[176:179], v[72:87]
    ds_read_b64_tr_b16 v[32:33], v21 offset:13312
    ds_read_b64_tr_b16 v[34:35], v21 offset:15360
    s_waitcnt lgkmcnt(10)
    v_mfma_f32_32x32x16_bf16 v[120:135], v[40:43], v[176:179], v[120:135]
    buffer_load_dwordx4 v[204:207], v249, s[32:35], s16 offen offset:1024 sc1
    ds_read_b64_tr_b16 v[36:37], v24 offset:13312
    ds_read_b64_tr_b16 v[38:39], v24 offset:15360
    s_waitcnt lgkmcnt(10)
    v_mfma_f32_32x32x16_bf16 v[136:151], v[44:47], v[176:179], v[136:151]
    ds_read_b64_tr_b16 v[40:41], v25 offset:13312
    ds_read_b64_tr_b16 v[42:43], v25 offset:15360
    s_waitcnt lgkmcnt(10)
    v_mfma_f32_32x32x16_bf16 v[88:103], v[48:51], v[176:179], v[88:103]
    ds_read_b64_tr_b16 v[44:45], v22 offset:13312
    ds_read_b64_tr_b16 v[46:47], v22 offset:15360
    s_waitcnt lgkmcnt(10)
    v_mfma_f32_32x32x16_bf16 v[104:119], v[52:55], v[176:179], v[104:119]
    ds_read_b64_tr_b16 v[48:49], v23 offset:13312
    ds_read_b64_tr_b16 v[50:51], v23 offset:15360
    s_waitcnt vmcnt(6)
    s_waitcnt lgkmcnt(10)
    v_mfma_f32_32x32x16_bf16 v[56:71], v[28:31], v[180:183], v[56:71]
    ds_read_b64_tr_b16 v[52:53], v20 offset:16384
    ds_read_b64_tr_b16 v[54:55], v20 offset:18432
    s_waitcnt lgkmcnt(10)
    v_mfma_f32_32x32x16_bf16 v[72:87], v[32:35], v[180:183], v[72:87]
    buffer_load_dwordx4 v[208:211], v249, s[32:35], s16 offen offset:2048 sc1
    ds_read_b64_tr_b16 v[28:29], v21 offset:16384
    ds_read_b64_tr_b16 v[30:31], v21 offset:18432
    s_waitcnt lgkmcnt(10)
    v_mfma_f32_32x32x16_bf16 v[120:135], v[36:39], v[180:183], v[120:135]
    ds_read_b64_tr_b16 v[32:33], v24 offset:16384
    ds_read_b64_tr_b16 v[34:35], v24 offset:18432
    s_waitcnt lgkmcnt(10)
    v_mfma_f32_32x32x16_bf16 v[136:151], v[40:43], v[180:183], v[136:151]
    ds_read_b64_tr_b16 v[36:37], v25 offset:16384
    ds_read_b64_tr_b16 v[38:39], v25 offset:18432
    s_waitcnt lgkmcnt(10)
    v_mfma_f32_32x32x16_bf16 v[88:103], v[44:47], v[180:183], v[88:103]
    ds_read_b64_tr_b16 v[40:41], v22 offset:16384
    ds_read_b64_tr_b16 v[42:43], v22 offset:18432
    s_waitcnt lgkmcnt(10)
    v_mfma_f32_32x32x16_bf16 v[104:119], v[48:51], v[180:183], v[104:119]
    buffer_load_dwordx4 v[212:215], v249, s[32:35], s16 offen offset:3072 sc1
    ds_read_b64_tr_b16 v[44:45], v23 offset:16384
    ds_read_b64_tr_b16 v[46:47], v23 offset:18432
    s_barrier
    s_waitcnt vmcnt(7)
    s_waitcnt lgkmcnt(10)
    v_mfma_f32_32x32x16_bf16 v[56:71], v[52:55], v[184:187], v[56:71]
    s_add_u32 s16, s16, 16384
    ds_read_b64_tr_b16 v[48:49], v20 offset:17408
    ds_read_b64_tr_b16 v[50:51], v20 offset:19456
    s_waitcnt lgkmcnt(10)
    v_mfma_f32_32x32x16_bf16 v[72:87], v[28:31], v[184:187], v[72:87]
    s_and_b32 s16, s16, 0x3ffff
    ds_read_b64_tr_b16 v[52:53], v21 offset:17408
    ds_read_b64_tr_b16 v[54:55], v21 offset:19456
    s_waitcnt lgkmcnt(10)
    v_mfma_f32_32x32x16_bf16 v[120:135], v[32:35], v[184:187], v[120:135]
    ds_read_b64_tr_b16 v[28:29], v24 offset:17408
    ds_read_b64_tr_b16 v[30:31], v24 offset:19456
    s_waitcnt lgkmcnt(10)
    v_mfma_f32_32x32x16_bf16 v[136:151], v[36:39], v[184:187], v[136:151]
    ds_read_b64_tr_b16 v[32:33], v25 offset:17408
    ds_read_b64_tr_b16 v[34:35], v25 offset:19456
    s_waitcnt lgkmcnt(10)
    v_mfma_f32_32x32x16_bf16 v[88:103], v[40:43], v[184:187], v[88:103]
    buffer_load_dwordx4 v[216:219], v249, s[32:35], s16 offen sc1
    ds_read_b64_tr_b16 v[36:37], v22 offset:17408
    ds_read_b64_tr_b16 v[38:39], v22 offset:19456
    s_waitcnt lgkmcnt(10)
    v_mfma_f32_32x32x16_bf16 v[104:119], v[44:47], v[184:187], v[104:119]
    ds_read_b64_tr_b16 v[40:41], v23 offset:17408
    ds_read_b64_tr_b16 v[42:43], v23 offset:19456
    s_waitcnt vmcnt(7)
    s_waitcnt lgkmcnt(10)
    v_mfma_f32_32x32x16_bf16 v[56:71], v[48:51], v[188:191], v[56:71]
    ds_read_b64_tr_b16 v[44:45], v20 offset:20480
    ds_read_b64_tr_b16 v[46:47], v20 offset:22528
    s_waitcnt lgkmcnt(10)
    v_mfma_f32_32x32x16_bf16 v[72:87], v[52:55], v[188:191], v[72:87]
    ds_read_b64_tr_b16 v[48:49], v21 offset:20480
    ds_read_b64_tr_b16 v[50:51], v21 offset:22528
    s_waitcnt lgkmcnt(10)
    v_mfma_f32_32x32x16_bf16 v[120:135], v[28:31], v[188:191], v[120:135]
    ds_read_b64_tr_b16 v[52:53], v24 offset:20480
    ds_read_b64_tr_b16 v[54:55], v24 offset:22528
    s_waitcnt lgkmcnt(10)
    v_mfma_f32_32x32x16_bf16 v[136:151], v[32:35], v[188:191], v[136:151]
    buffer_load_dwordx4 v[220:223], v249, s[32:35], s16 offen offset:1024 sc1
    ds_read_b64_tr_b16 v[28:29], v25 offset:20480
    ds_read_b64_tr_b16 v[30:31], v25 offset:22528
    s_waitcnt lgkmcnt(10)
    v_mfma_f32_32x32x16_bf16 v[88:103], v[36:39], v[188:191], v[88:103]
    ds_read_b64_tr_b16 v[32:33], v22 offset:20480
    ds_read_b64_tr_b16 v[34:35], v22 offset:22528
    s_waitcnt lgkmcnt(10)
    v_mfma_f32_32x32x16_bf16 v[104:119], v[40:43], v[188:191], v[104:119]
    ds_read_b64_tr_b16 v[36:37], v23 offset:20480
    ds_read_b64_tr_b16 v[38:39], v23 offset:22528
    s_waitcnt vmcnt(7)
    s_waitcnt lgkmcnt(10)
    v_mfma_f32_32x32x16_bf16 v[56:71], v[44:47], v[192:195], v[56:71]
    ds_read_b64_tr_b16 v[40:41], v20 offset:21504
    ds_read_b64_tr_b16 v[42:43], v20 offset:23552
    s_waitcnt lgkmcnt(10)
    v_mfma_f32_32x32x16_bf16 v[72:87], v[48:51], v[192:195], v[72:87]
    ds_read_b64_tr_b16 v[44:45], v21 offset:21504
    ds_read_b64_tr_b16 v[46:47], v21 offset:23552
    s_waitcnt lgkmcnt(10)
    v_mfma_f32_32x32x16_bf16 v[120:135], v[52:55], v[192:195], v[120:135]
    buffer_load_dwordx4 v[224:227], v249, s[32:35], s16 offen offset:2048 sc1
    ds_read_b64_tr_b16 v[48:49], v24 offset:21504
    ds_read_b64_tr_b16 v[50:51], v24 offset:23552
    s_waitcnt lgkmcnt(10)
    v_mfma_f32_32x32x16_bf16 v[136:151], v[28:31], v[192:195], v[136:151]
    ds_read_b64_tr_b16 v[52:53], v25 offset:21504
    ds_read_b64_tr_b16 v[54:55], v25 offset:23552
    s_waitcnt lgkmcnt(10)
    v_mfma_f32_32x32x16_bf16 v[88:103], v[32:35], v[192:195], v[88:103]
    ds_read_b64_tr_b16 v[28:29], v22 offset:21504
    ds_read_b64_tr_b16 v[30:31], v22 offset:23552
    s_waitcnt lgkmcnt(10)
    v_mfma_f32_32x32x16_bf16 v[104:119], v[36:39], v[192:195], v[104:119]
    ds_read_b64_tr_b16 v[32:33], v23 offset:21504
    ds_read_b64_tr_b16 v[34:35], v23 offset:23552
    s_waitcnt vmcnt(7)
    s_waitcnt lgkmcnt(10)
    v_mfma_f32_32x32x16_bf16 v[56:71], v[40:43], v[196:199], v[56:71]
    ds_read_b64_tr_b16 v[36:37], v20 offset:24576
    ds_read_b64_tr_b16 v[38:39], v20 offset:26624
    s_waitcnt lgkmcnt(10)
    v_mfma_f32_32x32x16_bf16 v[72:87], v[44:47], v[196:199], v[72:87]
    buffer_load_dwordx4 v[228:231], v249, s[32:35], s16 offen offset:3072 sc1
    ds_read_b64_tr_b16 v[40:41], v21 offset:24576
    ds_read_b64_tr_b16 v[42:43], v21 offset:26624
    s_waitcnt lgkmcnt(10)
    v_mfma_f32_32x32x16_bf16 v[120:135], v[48:51], v[196:199], v[120:135]
    s_add_u32 s16, s16, 16384
    ds_read_b64_tr_b16 v[44:45], v24 offset:24576
    ds_read_b64_tr_b16 v[46:47], v24 offset:26624
    s_waitcnt lgkmcnt(10)
    v_mfma_f32_32x32x16_bf16 v[136:151], v[52:55], v[196:199], v[136:151]
    s_and_b32 s16, s16, 0x3ffff
    ds_read_b64_tr_b16 v[48:49], v25 offset:24576
    ds_read_b64_tr_b16 v[50:51], v25 offset:26624
    s_waitcnt lgkmcnt(10)
    v_mfma_f32_32x32x16_bf16 v[88:103], v[28:31], v[196:199], v[88:103]
    ds_read_b64_tr_b16 v[52:53], v22 offset:24576
    ds_read_b64_tr_b16 v[54:55], v22 offset:26624
    s_waitcnt lgkmcnt(10)
    v_mfma_f32_32x32x16_bf16 v[104:119], v[32:35], v[196:199], v[104:119]
    buffer_load_dwordx4 v[232:235], v249, s[32:35], s16 offen sc1
    ds_read_b64_tr_b16 v[28:29], v23 offset:24576
    ds_read_b64_tr_b16 v[30:31], v23 offset:26624
    s_barrier
    s_waitcnt vmcnt(8)
    s_waitcnt lgkmcnt(10)
    v_mfma_f32_32x32x16_bf16 v[56:71], v[36:39], v[200:203], v[56:71]
    ds_read_b64_tr_b16 v[32:33], v20 offset:25600
    ds_read_b64_tr_b16 v[34:35], v20 offset:27648
    s_waitcnt lgkmcnt(10)
    v_mfma_f32_32x32x16_bf16 v[72:87], v[40:43], v[200:203], v[72:87]
    ds_read_b64_tr_b16 v[36:37], v21 offset:25600
    ds_read_b64_tr_b16 v[38:39], v21 offset:27648
    s_waitcnt lgkmcnt(10)
    v_mfma_f32_32x32x16_bf16 v[120:135], v[44:47], v[200:203], v[120:135]
    ds_read_b64_tr_b16 v[40:41], v24 offset:25600
    ds_read_b64_tr_b16 v[42:43], v24 offset:27648
    s_waitcnt lgkmcnt(10)
    v_mfma_f32_32x32x16_bf16 v[136:151], v[48:51], v[200:203], v[136:151]
    ds_read_b64_tr_b16 v[44:45], v25 offset:25600
    ds_read_b64_tr_b16 v[46:47], v25 offset:27648
    s_waitcnt lgkmcnt(10)
    v_mfma_f32_32x32x16_bf16 v[88:103], v[52:55], v[200:203], v[88:103]
    buffer_load_dwordx4 v[236:239], v249, s[32:35], s16 offen offset:1024 sc1
    ds_read_b64_tr_b16 v[48:49], v22 offset:25600
    ds_read_b64_tr_b16 v[50:51], v22 offset:27648
    s_waitcnt lgkmcnt(10)
    v_mfma_f32_32x32x16_bf16 v[104:119], v[28:31], v[200:203], v[104:119]
    ds_read_b64_tr_b16 v[52:53], v23 offset:25600
    ds_read_b64_tr_b16 v[54:55], v23 offset:27648
    s_waitcnt vmcnt(8)
    s_waitcnt lgkmcnt(10)
    v_mfma_f32_32x32x16_bf16 v[56:71], v[32:35], v[204:207], v[56:71]
    ds_read_b64_tr_b16 v[28:29], v20 offset:28672
    ds_read_b64_tr_b16 v[30:31], v20 offset:30720
    s_waitcnt lgkmcnt(10)
    v_mfma_f32_32x32x16_bf16 v[72:87], v[36:39], v[204:207], v[72:87]
L_PAD2:
    s_cbranch_execz L_RET2
    ds_read_b64_tr_b16 v[32:33], v21 offset:28672
    ds_read_b64_tr_b16 v[34:35], v21 offset:30720
    s_waitcnt lgkmcnt(10)
    v_mfma_f32_32x32x16_bf16 v[120:135], v[40:43], v[204:207], v[120:135]
    ds_read_b64_tr_b16 v[36:37], v24 offset:28672
    ds_read_b64_tr_b16 v[38:39], v24 offset:30720
    s_waitcnt lgkmcnt(10)
    v_mfma_f32_32x32x16_bf16 v[136:151], v[44:47], v[204:207], v[136:151]
    buffer_load_dwordx4 v[240:243], v249, s[32:35], s16 offen offset:2048 sc1
    ds_read_b64_tr_b16 v[40:41], v25 offset:28672
    ds_read_b64_tr_b16 v[42:43], v25 offset:30720
    s_waitcnt lgkmcnt(10)
    v_mfma_f32_32x32x16_bf16 v[88:103], v[48:51], v[204:207], v[88:103]
    ds_read_b64_tr_b16 v[44:45], v22 offset:28672
    ds_read_b64_tr_b16 v[46:47], v22 offset:30720
    s_waitcnt lgkmcnt(10)
    v_mfma_f32_32x32x16_bf16 v[104:119], v[52:55], v[204:207], v[104:119]
    ds_read_b64_tr_b16 v[48:49], v23 offset:28672
    ds_read_b64_tr_b16 v[50:51], v23 offset:30720
    s_waitcnt vmcnt(8)
    s_waitcnt lgkmcnt(10)
    v_mfma_f32_32x32x16_bf16 v[56:71], v[28:31], v[208:211], v[56:71]
    ds_read_b64_tr_b16 v[52:53], v20 offset:29696
    ds_read_b64_tr_b16 v[54:55], v20 offset:31744
    s_waitcnt lgkmcnt(10)
    v_mfma_f32_32x32x16_bf16 v[72:87], v[32:35], v[208:211], v[72:87]
    ds_read_b64_tr_b16 v[28:29], v21 offset:29696
    ds_read_b64_tr_b16 v[30:31], v21 offset:31744
    s_waitcnt lgkmcnt(10)
    v_mfma_f32_32x32x16_bf16 v[120:135], v[36:39], v[208:211], v[120:135]
    buffer_load_dwordx4 v[244:247], v249, s[32:35], s16 offen offset:3072 sc1
    ds_read_b64_tr_b16 v[32:33], v24 offset:29696
    ds_read_b64_tr_b16 v[34:35], v24 offset:31744
    s_waitcnt lgkmcnt(10)
    v_mfma_f32_32x32x16_bf16 v[136:151], v[40:43], v[208:211], v[136:151]
    s_add_u32 s16, s16, 16384
    ds_read_b64_tr_b16 v[36:37], v25 offset:29696
    ds_read_b64_tr_b16 v[38:39], v25 offset:31744
    s_waitcnt lgkmcnt(10)
    v_mfma_f32_32x32x16_bf16 v[88:103], v[44:47], v[208:211], v[88:103]
    s_and_b32 s16, s16, 0x3ffff
    ds_read_b64_tr_b16 v[40:41], v22 offset:29696
    ds_read_b64_tr_b16 v[42:43], v22 offset:31744
    s_waitcnt lgkmcnt(10)
    v_mfma_f32_32x32x16_bf16 v[104:119], v[48:51], v[208:211], v[104:119]
    ds_read_b64_tr_b16 v[44:45], v23 offset:29696
    ds_read_b64_tr_b16 v[46:47], v23 offset:31744
    s_waitcnt vmcnt(8)
    s_waitcnt lgkmcnt(10)
    v_mfma_f32_32x32x16_bf16 v[56:71], v[52:55], v[212:215], v[56:71]
    ds_read_b64_tr_b16 v[48:49], v20 offset:32768
    ds_read_b64_tr_b16 v[50:51], v20 offset:34816
    s_waitcnt lgkmcnt(10)
    v_mfma_f32_32x32x16_bf16 v[72:87], v[28:31], v[212:215], v[72:87]
    buffer_load_dwordx4 v[152:155], v249, s[32:35], s16 offen sc1
    ds_read_b64_tr_b16 v[52:53], v21 offset:32768
    ds_read_b64_tr_b16 v[54:55], v21 offset:34816
    s_waitcnt lgkmcnt(10)
    v_mfma_f32_32x32x16_bf16 v[120:135], v[32:35], v[212:215], v[120:135]
    ds_read_b64_tr_b16 v[28:29], v24 offset:32768
    ds_read_b64_tr_b16 v[30:31], v24 offset:34816
    s_waitcnt lgkmcnt(10)
    v_mfma_f32_32x32x16_bf16 v[136:151], v[36:39], v[212:215], v[136:151]
    ds_read_b64_tr_b16 v[32:33], v25 offset:32768
    ds_read_b64_tr_b16 v[34:35], v25 offset:34816
    s_waitcnt lgkmcnt(10)
    v_mfma_f32_32x32x16_bf16 v[88:103], v[40:43], v[212:215], v[88:103]
    ds_read_b64_tr_b16 v[36:37], v22 offset:32768
    ds_read_b64_tr_b16 v[38:39], v22 offset:34816
    s_waitcnt lgkmcnt(10)
    v_mfma_f32_32x32x16_bf16 v[104:119], v[44:47], v[212:215], v[104:119]
    buffer_load_dwordx4 v[156:159], v249, s[32:35], s16 offen offset:1024 sc1
    ds_read_b64_tr_b16 v[40:41], v23 offset:32768
    ds_read_b64_tr_b16 v[42:43], v23 offset:34816
    s_barrier
    s_waitcnt vmcnt(9)
    s_waitcnt lgkmcnt(10)
    v_mfma_f32_32x32x16_bf16 v[56:71], v[48:51], v[216:219], v[56:71]
    ds_read_b64_tr_b16 v[44:45], v20 offset:33792
    ds_read_b64_tr_b16 v[46:47], v20 offset:35840
    s_waitcnt lgkmcnt(10)
    v_mfma_f32_32x32x16_bf16 v[72:87], v[52:55], v[216:219], v[72:87]
    ds_read_b64_tr_b16 v[48:49], v21 offset:33792
    ds_read_b64_tr_b16 v[50:51], v21 offset:35840
    s_waitcnt lgkmcnt(10)
    v_mfma_f32_32x32x16_bf16 v[120:135], v[28:31], v[216:219], v[120:135]
    ds_read_b64_tr_b16 v[52:53], v24 offset:33792
    ds_read_b64_tr_b16 v[54:55], v24 offset:35840
    s_waitcnt lgkmcnt(10)
    v_mfma_f32_32x32x16_bf16 v[136:151], v[32:35], v[216:219], v[136:151]
    ds_read_b64_tr_b16 v[28:29], v25 offset:33792
    ds_read_b64_tr_b16 v[30:31], v25 offset:35840
    s_waitcnt lgkmcnt(10)
    v_mfma_f32_32x32x16_bf16 v[88:103], v[36:39], v[216:219], v[88:103]
    buffer_load_dwordx4 v[160:163], v249, s[32:35], s16 offen offset:2048 sc1
    ds_read_b64_tr_b16 v[32:33], v22 offset:33792
    ds_read_b64_tr_b16 v[34:35], v22 offset:35840
    s_waitcnt lgkmcnt(10)
    v_mfma_f32_32x32x16_bf16 v[104:119], v[40:43], v[216:219], v[104:119]
    ds_read_b64_tr_b16 v[36:37], v23 offset:33792
    ds_read_b64_tr_b16 v[38:39], v23 offset:35840
    s_waitcnt vmcnt(9)
    s_waitcnt lgkmcnt(10)
    v_mfma_f32_32x32x16_bf16 v[56:71], v[44:47], v[220:223], v[56:71]
    ds_read_b64_tr_b16 v[40:41], v20 offset:36864
    ds_read_b64_tr_b16 v[42:43], v20 offset:38912
    s_waitcnt lgkmcnt(10)
    v_mfma_f32_32x32x16_bf16 v[72:87], v[48:51], v[220:223], v[72:87]
    ds_read_b64_tr_b16 v[44:45], v21 offset:36864
    ds_read_b64_tr_b16 v[46:47], v21 offset:38912
    s_waitcnt lgkmcnt(10)
    v_mfma_f32_32x32x16_bf16 v[120:135], v[52:55], v[220:223], v[120:135]
    ds_read_b64_tr_b16 v[48:49], v24 offset:36864
    ds_read_b64_tr_b16 v[50:51], v24 offset:38912
    s_waitcnt lgkmcnt(10)
    v_mfma_f32_32x32x16_bf16 v[136:151], v[28:31], v[220:223], v[136:151]
    buffer_load_dwordx4 v[164:167], v249, s[32:35], s16 offen offset:3072 sc1
    ds_read_b64_tr_b16 v[52:53], v25 offset:36864
    ds_read_b64_tr_b16 v[54:55], v25 offset:38912
    s_waitcnt lgkmcnt(10)
    v_mfma_f32_32x32x16_bf16 v[88:103], v[32:35], v[220:223], v[88:103]
    s_add_u32 s16, s16, 16384
    ds_read_b64_tr_b16 v[28:29], v22 offset:36864
    ds_read_b64_tr_b16 v[30:31], v22 offset:38912
    s_waitcnt lgkmcnt(10)
    v_mfma_f32_32x32x16_bf16 v[104:119], v[36:39], v[220:223], v[104:119]
    s_and_b32 s16, s16, 0x3ffff
    ds_read_b64_tr_b16 v[32:33], v23 offset:36864
    ds_read_b64_tr_b16 v[34:35], v23 offset:38912
    s_waitcnt vmcnt(9)
    s_waitcnt lgkmcnt(10)
    v_mfma_f32_32x32x16_bf16 v[56:71], v[40:43], v[224:227], v[56:71]
    ds_read_b64_tr_b16 v[36:37], v20 offset:37888
    ds_read_b64_tr_b16 v[38:39], v20 offset:39936
    s_waitcnt lgkmcnt(10)
    v_mfma_f32_32x32x16_bf16 v[72:87], v[44:47], v[224:227], v[72:87]
    ds_read_b64_tr_b16 v[40:41], v21 offset:37888
    ds_read_b64_tr_b16 v[42:43], v21 offset:39936
    s_waitcnt lgkmcnt(10)
    v_mfma_f32_32x32x16_bf16 v[120:135], v[48:51], v[224:227], v[120:135]
    buffer_load_dwordx4 v[168:171], v249, s[32:35], s16 offen sc1
    ds_read_b64_tr_b16 v[44:45], v24 offset:37888
    ds_read_b64_tr_b16 v[46:47], v24 offset:39936
    s_waitcnt lgkmcnt(10)
    v_mfma_f32_32x32x16_bf16 v[136:151], v[52:55], v[224:227], v[136:151]
    ds_read_b64_tr_b16 v[48:49], v25 offset:37888
    ds_read_b64_tr_b16 v[50:51], v25 offset:39936
    s_waitcnt lgkmcnt(10)
    v_mfma_f32_32x32x16_bf16 v[88:103], v[28:31], v[224:227], v[88:103]
    ds_read_b64_tr_b16 v[52:53], v22 offset:37888
    ds_read_b64_tr_b16 v[54:55], v22 offset:39936
    s_waitcnt lgkmcnt(10)
    v_mfma_f32_32x32x16_bf16 v[104:119], v[32:35], v[224:227], v[104:119]
    ds_read_b64_tr_b16 v[28:29], v23 offset:37888
    ds_read_b64_tr_b16 v[30:31], v23 offset:39936
    s_waitcnt vmcnt(9)
    s_waitcnt lgkmcnt(10)
    v_mfma_f32_32x32x16_bf16 v[56:71], v[36:39], v[228:231], v[56:71]
    ds_read_b64_tr_b16 v[32:33], v20 offset:40960
    ds_read_b64_tr_b16 v[34:35], v20 offset:43008
    s_waitcnt lgkmcnt(10)
    v_mfma_f32_32x32x16_bf16 v[72:87], v[40:43], v[228:231], v[72:87]
    buffer_load_dwordx4 v[172:175], v249, s[32:35], s16 offen offset:1024 sc1
    ds_read_b64_tr_b16 v[36:37], v21 offset:40960
    ds_read_b64_tr_b16 v[38:39], v21 offset:43008
    s_waitcnt lgkmcnt(10)
    v_mfma_f32_32x32x16_bf16 v[120:135], v[44:47], v[228:231], v[120:135]
    ds_read_b64_tr_b16 v[40:41], v24 offset:40960
    ds_read_b64_tr_b16 v[42:43], v24 offset:43008
    s_waitcnt lgkmcnt(10)
    v_mfma_f32_32x32x16_bf16 v[136:151], v[48:51], v[228:231], v[136:151]
    ds_read_b64_tr_b16 v[44:45], v25 offset:40960
    ds_read_b64_tr_b16 v[46:47], v25 offset:43008
    s_waitcnt lgkmcnt(10)
    v_mfma_f32_32x32x16_bf16 v[88:103], v[52:55], v[228:231], v[88:103]
    ds_read_b64_tr_b16 v[48:49], v22 offset:40960
    ds_read_b64_tr_b16 v[50:51], v22 offset:43008
    s_waitcnt lgkmcnt(10)
    v_mfma_f32_32x32x16_bf16 v[104:119], v[28:31], v[228:231], v[104:119]
    buffer_load_dwordx4 v[176:179], v249, s[32:35], s16 offen offset:2048 sc1
    ds_read_b64_tr_b16 v[52:53], v23 offset:40960
    ds_read_b64_tr_b16 v[54:55], v23 offset:43008
    s_barrier
    s_waitcnt vmcnt(10)
    s_waitcnt lgkmcnt(10)
    v_mfma_f32_32x32x16_bf16 v[56:71], v[32:35], v[232:235], v[56:71]
    ds_read_b64_tr_b16 v[28:29], v20 offset:41984
    ds_read_b64_tr_b16 v[30:31], v20 offset:44032
    s_waitcnt lgkmcnt(10)
    v_mfma_f32_32x32x16_bf16 v[72:87], v[36:39], v[232:235], v[72:87]
    ds_read_b64_tr_b16 v[32:33], v21 offset:41984
    ds_read_b64_tr_b16 v[34:35], v21 offset:44032
    s_waitcnt lgkmcnt(10)
    v_mfma_f32_32x32x16_bf16 v[120:135], v[40:43], v[232:235], v[120:135]
    ds_read_b64_tr_b16 v[36:37], v24 offset:41984
    ds_read_b64_tr_b16 v[38:39], v24 offset:44032
    s_waitcnt lgkmcnt(10)
    v_mfma_f32_32x32x16_bf16 v[136:151], v[44:47], v[232:235], v[136:151]
    buffer_load_dwordx4 v[180:183], v249, s[32:35], s16 offen offset:3072 sc1
    ds_read_b64_tr_b16 v[40:41], v25 offset:41984
    ds_read_b64_tr_b16 v[42:43], v25 offset:44032
    s_waitcnt lgkmcnt(10)
    v_mfma_f32_32x32x16_bf16 v[88:103], v[48:51], v[232:235], v[88:103]
    s_add_u32 s16, s16, 16384
    ds_read_b64_tr_b16 v[44:45], v22 offset:41984
    ds_read_b64_tr_b16 v[46:47], v22 offset:44032
    s_waitcnt lgkmcnt(10)
    v_mfma_f32_32x32x16_bf16 v[104:119], v[52:55], v[232:235], v[104:119]
    s_and_b32 s16, s16, 0x3ffff
    ds_read_b64_tr_b16 v[48:49], v23 offset:41984
    ds_read_b64_tr_b16 v[50:51], v23 offset:44032
    s_waitcnt vmcnt(10)
    s_waitcnt lgkmcnt(10)
    v_mfma_f32_32x32x16_bf16 v[56:71], v[28:31], v[236:239], v[56:71]
    buffer_load_dwordx4 v[184:187], v249, s[32:35], s16 offen sc1
    ds_read_b64_tr_b16 v[52:53], v20 offset:45056
    ds_read_b64_tr_b16 v[54:55], v20 offset:47104
    s_waitcnt lgkmcnt(10)
    v_mfma_f32_32x32x16_bf16 v[72:87], v[32:35], v[236:239], v[72:87]
    ds_read_b64_tr_b16 v[28:29], v21 offset:45056
    ds_read_b64_tr_b16 v[30:31], v21 offset:47104
    s_waitcnt lgkmcnt(10)
    v_mfma_f32_32x32x16_bf16 v[120:135], v[36:39], v[236:239], v[120:135]
    ds_read_b64_tr_b16 v[32:33], v24 offset:45056
    ds_read_b64_tr_b16 v[34:35], v24 offset:47104
    s_waitcnt lgkmcnt(10)
    v_mfma_f32_32x32x16_bf16 v[136:151], v[40:43], v[236:239], v[136:151]
    ds_read_b64_tr_b16 v[36:37], v25 offset:45056
    ds_read_b64_tr_b16 v[38:39], v25 offset:47104
    s_waitcnt lgkmcnt(10)
    v_mfma_f32_32x32x16_bf16 v[88:103], v[44:47], v[236:239], v[88:103]
    buffer_load_dwordx4 v[188:191], v249, s[32:35], s16 offen offset:1024 sc1
    ds_read_b64_tr_b16 v[40:41], v22 offset:45056
    ds_read_b64_tr_b16 v[42:43], v22 offset:47104
    s_waitcnt lgkmcnt(10)
    v_mfma_f32_32x32x16_bf16 v[104:119], v[48:51], v[236:239], v[104:119]
    ds_read_b64_tr_b16 v[44:45], v23 offset:45056
    ds_read_b64_tr_b16 v[46:47], v23 offset:47104
    s_waitcnt vmcnt(11)
    s_waitcnt lgkmcnt(10)
    v_mfma_f32_32x32x16_bf16 v[56:71], v[52:55], v[240:243], v[56:71]
    ds_read_b64_tr_b16 v[48:49], v20 offset:46080
    ds_read_b64_tr_b16 v[50:51], v20 offset:48128
    s_waitcnt lgkmcnt(10)
    v_mfma_f32_32x32x16_bf16 v[72:87], v[28:31], v[240:243], v[72:87]
    buffer_load_dwordx4 v[192:195], v249, s[32:35], s16 offen offset:2048 sc1
    ds_read_b64_tr_b16 v[52:53], v21 offset:46080
    ds_read_b64_tr_b16 v[54:55], v21 offset:48128
    s_waitcnt lgkmcnt(10)
    v_mfma_f32_32x32x16_bf16 v[120:135], v[32:35], v[240:243], v[120:135]
    ds_read_b64_tr_b16 v[28:29], v24 offset:46080
    ds_read_b64_tr_b16 v[30:31], v24 offset:48128
    s_waitcnt lgkmcnt(10)
    v_mfma_f32_32x32x16_bf16 v[136:151], v[36:39], v[240:243], v[136:151]
    ds_read_b64_tr_b16 v[32:33], v25 offset:46080
    ds_read_b64_tr_b16 v[34:35], v25 offset:48128
    s_waitcnt lgkmcnt(10)
    v_mfma_f32_32x32x16_bf16 v[88:103], v[40:43], v[240:243], v[88:103]
    ds_read_b64_tr_b16 v[36:37], v22 offset:46080
    ds_read_b64_tr_b16 v[38:39], v22 offset:48128
    s_waitcnt lgkmcnt(10)
    v_mfma_f32_32x32x16_bf16 v[104:119], v[44:47], v[240:243], v[104:119]
    buffer_load_dwordx4 v[196:199], v249, s[32:35], s16 offen offset:3072 sc1
    ds_read_b64_tr_b16 v[40:41], v23 offset:46080
    ds_read_b64_tr_b16 v[42:43], v23 offset:48128
    s_waitcnt vmcnt(12)
    s_waitcnt lgkmcnt(10)
    v_mfma_f32_32x32x16_bf16 v[56:71], v[48:51], v[244:247], v[56:71]
    s_add_u32 s16, s16, 16384
    ds_read_b64_tr_b16 v[44:45], v20
    ds_read_b64_tr_b16 v[46:47], v20 offset:2048
    s_waitcnt lgkmcnt(10)
    v_mfma_f32_32x32x16_bf16 v[72:87], v[52:55], v[244:247], v[72:87]
    s_and_b32 s16, s16, 0x3ffff
    ds_read_b64_tr_b16 v[48:49], v21
    ds_read_b64_tr_b16 v[50:51], v21 offset:2048
    s_waitcnt lgkmcnt(10)
    v_mfma_f32_32x32x16_bf16 v[120:135], v[28:31], v[244:247], v[120:135]
    buffer_load_dwordx4 v[200:203], v249, s[32:35], s16 offen sc1
    ds_read_b64_tr_b16 v[52:53], v24
    ds_read_b64_tr_b16 v[54:55], v24 offset:2048
    s_waitcnt lgkmcnt(10)
    v_mfma_f32_32x32x16_bf16 v[136:151], v[32:35], v[244:247], v[136:151]
    ds_read_b64_tr_b16 v[28:29], v25
    ds_read_b64_tr_b16 v[30:31], v25 offset:2048
    s_waitcnt lgkmcnt(10)
    v_mfma_f32_32x32x16_bf16 v[88:103], v[36:39], v[244:247], v[88:103]
    ds_read_b64_tr_b16 v[32:33], v22
    ds_read_b64_tr_b16 v[34:35], v22 offset:2048
    s_waitcnt lgkmcnt(10)
    v_mfma_f32_32x32x16_bf16 v[104:119], v[40:43], v[244:247], v[104:119]
    buffer_load_dwordx4 v[204:207], v249, s[32:35], s16 offen offset:1024 sc1
    ds_read_b64_tr_b16 v[36:37], v23
    ds_read_b64_tr_b16 v[38:39], v23 offset:2048
    s_barrier
    s_waitcnt vmcnt(13)
    s_waitcnt lgkmcnt(10)
    v_mfma_f32_32x32x16_bf16 v[56:71], v[44:47], v[152:155], v[56:71]
    ds_read_b64_tr_b16 v[40:41], v20 offset:1024
    ds_read_b64_tr_b16 v[42:43], v20 offset:3072
    s_waitcnt lgkmcnt(10)
    v_mfma_f32_32x32x16_bf16 v[72:87], v[48:51], v[152:155], v[72:87]
    ds_read_b64_tr_b16 v[44:45], v21 offset:1024
    ds_read_b64_tr_b16 v[46:47], v21 offset:3072
    s_waitcnt lgkmcnt(10)
    v_mfma_f32_32x32x16_bf16 v[120:135], v[52:55], v[152:155], v[120:135]
    ds_read_b64_tr_b16 v[48:49], v24 offset:1024
    ds_read_b64_tr_b16 v[50:51], v24 offset:3072
    s_waitcnt lgkmcnt(10)
    v_mfma_f32_32x32x16_bf16 v[136:151], v[28:31], v[152:155], v[136:151]
    buffer_load_dwordx4 v[208:211], v249, s[32:35], s16 offen offset:2048 sc1
    ds_read_b64_tr_b16 v[52:53], v25 offset:1024
    ds_read_b64_tr_b16 v[54:55], v25 offset:3072
    s_waitcnt lgkmcnt(10)
    v_mfma_f32_32x32x16_bf16 v[88:103], v[32:35], v[152:155], v[88:103]
    ds_read_b64_tr_b16 v[28:29], v22 offset:1024
    ds_read_b64_tr_b16 v[30:31], v22 offset:3072
    s_waitcnt lgkmcnt(10)
    v_mfma_f32_32x32x16_bf16 v[104:119], v[36:39], v[152:155], v[104:119]
    ds_read_b64_tr_b16 v[32:33], v23 offset:1024
    ds_read_b64_tr_b16 v[34:35], v23 offset:3072
    s_waitcnt vmcnt(13)
    s_waitcnt lgkmcnt(10)
    v_mfma_f32_32x32x16_bf16 v[56:71], v[40:43], v[156:159], v[56:71]
    buffer_load_dwordx4 v[212:215], v249, s[32:35], s16 offen offset:3072 sc1
    ds_read_b64_tr_b16 v[36:37], v20 offset:4096
    ds_read_b64_tr_b16 v[38:39], v20 offset:6144
    s_waitcnt lgkmcnt(10)
    v_mfma_f32_32x32x16_bf16 v[72:87], v[44:47], v[156:159], v[72:87]
    s_add_u32 s16, s16, 16384
    ds_read_b64_tr_b16 v[40:41], v21 offset:4096
    ds_read_b64_tr_b16 v[42:43], v21 offset:6144
    s_waitcnt lgkmcnt(10)
    v_mfma_f32_32x32x16_bf16 v[120:135], v[48:51], v[156:159], v[120:135]
    s_and_b32 s16, s16, 0x3ffff
    ds_read_b64_tr_b16 v[44:45], v24 offset:4096
    ds_read_b64_tr_b16 v[46:47], v24 offset:6144
    s_waitcnt lgkmcnt(10)
    v_mfma_f32_32x32x16_bf16 v[136:151], v[52:55], v[156:159], v[136:151]
    ds_read_b64_tr_b16 v[48:49], v25 offset:4096
    ds_read_b64_tr_b16 v[50:51], v25 offset:6144
    s_waitcnt lgkmcnt(10)
    v_mfma_f32_32x32x16_bf16 v[88:103], v[28:31], v[156:159], v[88:103]
    buffer_load_dwordx4 v[216:219], v249, s[32:35], s16 offen sc1
    ds_read_b64_tr_b16 v[52:53], v22 offset:4096
    ds_read_b64_tr_b16 v[54:55], v22 offset:6144
    s_waitcnt lgkmcnt(10)
    v_mfma_f32_32x32x16_bf16 v[104:119], v[32:35], v[156:159], v[104:119]
    ds_read_b64_tr_b16 v[28:29], v23 offset:4096
    ds_read_b64_tr_b16 v[30:31], v23 offset:6144
    s_waitcnt vmcnt(14)
    s_waitcnt lgkmcnt(10)
    v_mfma_f32_32x32x16_bf16 v[56:71], v[36:39], v[160:163], v[56:71]
    ds_read_b64_tr_b16 v[32:33], v20 offset:5120
    ds_read_b64_tr_b16 v[34:35], v20 offset:7168
    s_waitcnt lgkmcnt(10)
    v_mfma_f32_32x32x16_bf16 v[72:87], v[40:43], v[160:163], v[72:87]
    buffer_load_dwordx4 v[220:223], v249, s[32:35], s16 offen offset:1024 sc1
    ds_read_b64_tr_b16 v[36:37], v21 offset:5120
    ds_read_b64_tr_b16 v[38:39], v21 offset:7168
    s_waitcnt lgkmcnt(10)
    v_mfma_f32_32x32x16_bf16 v[120:135], v[44:47], v[160:163], v[120:135]
    ds_read_b64_tr_b16 v[40:41], v24 offset:5120
    ds_read_b64_tr_b16 v[42:43], v24 offset:7168
    s_waitcnt lgkmcnt(10)
    v_mfma_f32_32x32x16_bf16 v[136:151], v[48:51], v[160:163], v[136:151]
    ds_read_b64_tr_b16 v[44:45], v25 offset:5120
    ds_read_b64_tr_b16 v[46:47], v25 offset:7168
    s_waitcnt lgkmcnt(10)
    v_mfma_f32_32x32x16_bf16 v[88:103], v[52:55], v[160:163], v[88:103]
    ds_read_b64_tr_b16 v[48:49], v22 offset:5120
    ds_read_b64_tr_b16 v[50:51], v22 offset:7168
    s_waitcnt lgkmcnt(10)
    v_mfma_f32_32x32x16_bf16 v[104:119], v[28:31], v[160:163], v[104:119]
    buffer_load_dwordx4 v[224:227], v249, s[32:35], s16 offen offset:2048 sc1
    ds_read_b64_tr_b16 v[52:53], v23 offset:5120
    ds_read_b64_tr_b16 v[54:55], v23 offset:7168
    s_waitcnt vmcnt(15)
    s_waitcnt lgkmcnt(10)
    v_mfma_f32_32x32x16_bf16 v[56:71], v[32:35], v[164:167], v[56:71]
    ds_read_b64_tr_b16 v[28:29], v20 offset:8192
    ds_read_b64_tr_b16 v[30:31], v20 offset:10240
    s_waitcnt lgkmcnt(10)
    v_mfma_f32_32x32x16_bf16 v[72:87], v[36:39], v[164:167], v[72:87]
    ds_read_b64_tr_b16 v[32:33], v21 offset:8192
    ds_read_b64_tr_b16 v[34:35], v21 offset:10240
    s_waitcnt lgkmcnt(10)
    v_mfma_f32_32x32x16_bf16 v[120:135], v[40:43], v[164:167], v[120:135]
    buffer_load_dwordx4 v[228:231], v249, s[32:35], s16 offen offset:3072 sc1
    ds_read_b64_tr_b16 v[36:37], v24 offset:8192
    ds_read_b64_tr_b16 v[38:39], v24 offset:10240
    s_waitcnt lgkmcnt(10)
    v_mfma_f32_32x32x16_bf16 v[136:151], v[44:47], v[164:167], v[136:151]
    s_add_u32 s16, s16, 16384
    ds_read_b64_tr_b16 v[40:41], v25 offset:8192
    ds_read_b64_tr_b16 v[42:43], v25 offset:10240
    s_waitcnt lgkmcnt(10)
    v_mfma_f32_32x32x16_bf16 v[88:103], v[48:51], v[164:167], v[88:103]
    s_and_b32 s16, s16, 0x3ffff
    ds_read_b64_tr_b16 v[44:45], v22 offset:8192
    ds_read_b64_tr_b16 v[46:47], v22 offset:10240
    s_waitcnt lgkmcnt(10)
    v_mfma_f32_32x32x16_bf16 v[104:119], v[52:55], v[164:167], v[104:119]
    buffer_load_dwordx4 v[232:235], v249, s[32:35], s16 offen sc1
    ds_read_b64_tr_b16 v[48:49], v23 offset:8192
    ds_read_b64_tr_b16 v[50:51], v23 offset:10240
    s_barrier
    s_waitcnt vmcnt(16)
    s_waitcnt lgkmcnt(10)
    v_mfma_f32_32x32x16_bf16 v[56:71], v[28:31], v[168:171], v[56:71]
    ds_read_b64_tr_b16 v[52:53], v20 offset:9216
    ds_read_b64_tr_b16 v[54:55], v20 offset:11264
    s_waitcnt lgkmcnt(10)
    v_mfma_f32_32x32x16_bf16 v[72:87], v[32:35], v[168:171], v[72:87]
    ds_read_b64_tr_b16 v[28:29], v21 offset:9216
    ds_read_b64_tr_b16 v[30:31], v21 offset:11264
    s_waitcnt lgkmcnt(10)
    v_mfma_f32_32x32x16_bf16 v[120:135], v[36:39], v[168:171], v[120:135]
    ds_read_b64_tr_b16 v[32:33], v24 offset:9216
    ds_read_b64_tr_b16 v[34:35], v24 offset:11264
    s_waitcnt lgkmcnt(10)
    v_mfma_f32_32x32x16_bf16 v[136:151], v[40:43], v[168:171], v[136:151]
    buffer_load_dwordx4 v[236:239], v249, s[32:35], s16 offen offset:1024 sc1
    ds_read_b64_tr_b16 v[36:37], v25 offset:9216
    ds_read_b64_tr_b16 v[38:39], v25 offset:11264
    s_waitcnt lgkmcnt(10)
    v_mfma_f32_32x32x16_bf16 v[88:103], v[44:47], v[168:171], v[88:103]
    ds_read_b64_tr_b16 v[40:41], v22 offset:9216
    ds_read_b64_tr_b16 v[42:43], v22 offset:11264
    s_waitcnt lgkmcnt(10)
    v_mfma_f32_32x32x16_bf16 v[104:119], v[48:51], v[168:171], v[104:119]
    ds_read_b64_tr_b16 v[44:45], v23 offset:9216
    ds_read_b64_tr_b16 v[46:47], v23 offset:11264
    s_waitcnt vmcnt(16)
    s_waitcnt lgkmcnt(10)
    v_mfma_f32_32x32x16_bf16 v[56:71], v[52:55], v[172:175], v[56:71]
    buffer_load_dwordx4 v[240:243], v249, s[32:35], s16 offen offset:2048 sc1
    ds_read_b64_tr_b16 v[48:49], v20 offset:12288
    ds_read_b64_tr_b16 v[50:51], v20 offset:14336
    s_waitcnt lgkmcnt(10)
    v_mfma_f32_32x32x16_bf16 v[72:87], v[28:31], v[172:175], v[72:87]
    ds_read_b64_tr_b16 v[52:53], v21 offset:12288
    ds_read_b64_tr_b16 v[54:55], v21 offset:14336
    s_waitcnt lgkmcnt(10)
    v_mfma_f32_32x32x16_bf16 v[120:135], v[32:35], v[172:175], v[120:135]
    ds_read_b64_tr_b16 v[28:29], v24 offset:12288
    ds_read_b64_tr_b16 v[30:31], v24 offset:14336
    s_waitcnt lgkmcnt(10)
    v_mfma_f32_32x32x16_bf16 v[136:151], v[36:39], v[172:175], v[136:151]
    ds_read_b64_tr_b16 v[32:33], v25 offset:12288
    ds_read_b64_tr_b16 v[34:35], v25 offset:14336
    s_waitcnt lgkmcnt(10)
    v_mfma_f32_32x32x16_bf16 v[88:103], v[40:43], v[172:175], v[88:103]
    buffer_load_dwordx4 v[244:247], v249, s[32:35], s16 offen offset:3072 sc1
    ds_read_b64_tr_b16 v[36:37], v22 offset:12288
    ds_read_b64_tr_b16 v[38:39], v22 offset:14336
    s_waitcnt lgkmcnt(10)
    v_mfma_f32_32x32x16_bf16 v[104:119], v[44:47], v[172:175], v[104:119]
    s_add_u32 s16, s16, 16384
    ds_read_b64_tr_b16 v[40:41], v23 offset:12288
    ds_read_b64_tr_b16 v[42:43], v23 offset:14336
    s_waitcnt vmcnt(17)
    s_waitcnt lgkmcnt(10)
    v_mfma_f32_32x32x16_bf16 v[56:71], v[48:51], v[176:179], v[56:71]
    s_and_b32 s16, s16, 0x3ffff
    ds_read_b64_tr_b16 v[44:45], v20 offset:13312
    ds_read_b64_tr_b16 v[46:47], v20 offset:15360
    s_waitcnt lgkmcnt(10)
    v_mfma_f32_32x32x16_bf16 v[72:87], v[52:55], v[176:179], v[72:87]
    buffer_load_dwordx4 v[152:155], v249, s[32:35], s16 offen sc1
    ds_read_b64_tr_b16 v[48:49], v21 offset:13312
    ds_read_b64_tr_b16 v[50:51], v21 offset:15360
    s_waitcnt lgkmcnt(10)
    v_mfma_f32_32x32x16_bf16 v[120:135], v[28:31], v[176:179], v[120:135]
    ds_read_b64_tr_b16 v[52:53], v24 offset:13312
    ds_read_b64_tr_b16 v[54:55], v24 offset:15360
    s_waitcnt lgkmcnt(10)
    v_mfma_f32_32x32x16_bf16 v[136:151], v[32:35], v[176:179], v[136:151]
    ds_read_b64_tr_b16 v[28:29], v25 offset:13312
    ds_read_b64_tr_b16 v[30:31], v25 offset:15360
    s_waitcnt lgkmcnt(10)
    v_mfma_f32_32x32x16_bf16 v[88:103], v[36:39], v[176:179], v[88:103]
    ds_read_b64_tr_b16 v[32:33], v22 offset:13312
    ds_read_b64_tr_b16 v[34:35], v22 offset:15360
    s_waitcnt lgkmcnt(10)
    v_mfma_f32_32x32x16_bf16 v[104:119], v[40:43], v[176:179], v[104:119]
    buffer_load_dwordx4 v[156:159], v249, s[32:35], s16 offen offset:1024 sc1
    ds_read_b64_tr_b16 v[36:37], v23 offset:13312
    ds_read_b64_tr_b16 v[38:39], v23 offset:15360
    s_waitcnt vmcnt(18)
    s_waitcnt lgkmcnt(10)
    v_mfma_f32_32x32x16_bf16 v[56:71], v[44:47], v[180:183], v[56:71]
    ds_read_b64_tr_b16 v[40:41], v20 offset:16384
    ds_read_b64_tr_b16 v[42:43], v20 offset:18432
    s_waitcnt lgkmcnt(10)
    v_mfma_f32_32x32x16_bf16 v[72:87], v[48:51], v[180:183], v[72:87]
    ds_read_b64_tr_b16 v[44:45], v21 offset:16384
    ds_read_b64_tr_b16 v[46:47], v21 offset:18432
    s_waitcnt lgkmcnt(10)
    v_mfma_f32_32x32x16_bf16 v[120:135], v[52:55], v[180:183], v[120:135]
    buffer_load_dwordx4 v[160:163], v249, s[32:35], s16 offen offset:2048 sc1
    ds_read_b64_tr_b16 v[48:49], v24 offset:16384
    ds_read_b64_tr_b16 v[50:51], v24 offset:18432
    s_waitcnt lgkmcnt(10)
    v_mfma_f32_32x32x16_bf16 v[136:151], v[28:31], v[180:183], v[136:151]
    ds_read_b64_tr_b16 v[52:53], v25 offset:16384
    ds_read_b64_tr_b16 v[54:55], v25 offset:18432
    s_waitcnt lgkmcnt(10)
    v_mfma_f32_32x32x16_bf16 v[88:103], v[32:35], v[180:183], v[88:103]
    ds_read_b64_tr_b16 v[28:29], v22 offset:16384
    ds_read_b64_tr_b16 v[30:31], v22 offset:18432
    s_waitcnt lgkmcnt(10)
    v_mfma_f32_32x32x16_bf16 v[104:119], v[36:39], v[180:183], v[104:119]
    buffer_load_dwordx4 v[164:167], v249, s[32:35], s16 offen offset:3072 sc1
    ds_read_b64_tr_b16 v[32:33], v23 offset:16384
    ds_read_b64_tr_b16 v[34:35], v23 offset:18432
    s_barrier
    s_waitcnt vmcnt(19)
    s_waitcnt lgkmcnt(10)
    v_mfma_f32_32x32x16_bf16 v[56:71], v[40:43], v[184:187], v[56:71]
    s_add_u32 s16, s16, 16384
    ds_read_b64_tr_b16 v[36:37], v20 offset:17408
    ds_read_b64_tr_b16 v[38:39], v20 offset:19456
    s_waitcnt lgkmcnt(10)
    v_mfma_f32_32x32x16_bf16 v[72:87], v[44:47], v[184:187], v[72:87]
    s_and_b32 s16, s16, 0x3ffff
    ds_read_b64_tr_b16 v[40:41], v21 offset:17408
    ds_read_b64_tr_b16 v[42:43], v21 offset:19456
    s_waitcnt lgkmcnt(10)
    v_mfma_f32_32x32x16_bf16 v[120:135], v[48:51], v[184:187], v[120:135]
    ds_read_b64_tr_b16 v[44:45], v24 offset:17408
    ds_read_b64_tr_b16 v[46:47], v24 offset:19456
    s_waitcnt lgkmcnt(10)
    v_mfma_f32_32x32x16_bf16 v[136:151], v[52:55], v[184:187], v[136:151]
    buffer_load_dwordx4 v[168:171], v249, s[32:35], s16 offen sc1
    ds_read_b64_tr_b16 v[48:49], v25 offset:17408
    ds_read_b64_tr_b16 v[50:51], v25 offset:19456
    s_waitcnt lgkmcnt(10)
    v_mfma_f32_32x32x16_bf16 v[88:103], v[28:31], v[184:187], v[88:103]
    ds_read_b64_tr_b16 v[52:53], v22 offset:17408
    ds_read_b64_tr_b16 v[54:55], v22 offset:19456
    s_waitcnt lgkmcnt(10)
    v_mfma_f32_32x32x16_bf16 v[104:119], v[32:35], v[184:187], v[104:119]
    ds_read_b64_tr_b16 v[28:29], v23 offset:17408
    ds_read_b64_tr_b16 v[30:31], v23 offset:19456
    s_waitcnt vmcnt(19)
    s_waitcnt lgkmcnt(10)
    v_mfma_f32_32x32x16_bf16 v[56:71], v[36:39], v[188:191], v[56:71]
    ds_read_b64_tr_b16 v[32:33], v20 offset:20480
    ds_read_b64_tr_b16 v[34:35], v20 offset:22528
    s_waitcnt lgkmcnt(10)
    v_mfma_f32_32x32x16_bf16 v[72:87], v[40:43], v[188:191], v[72:87]
    buffer_load_dwordx4 v[172:175], v249, s[32:35], s16 offen offset:1024 sc1
    ds_read_b64_tr_b16 v[36:37], v21 offset:20480
    ds_read_b64_tr_b16 v[38:39], v21 offset:22528
    s_waitcnt lgkmcnt(10)
    v_mfma_f32_32x32x16_bf16 v[120:135], v[44:47], v[188:191], v[120:135]
    ds_read_b64_tr_b16 v[40:41], v24 offset:20480
    ds_read_b64_tr_b16 v[42:43], v24 offset:22528
    s_waitcnt lgkmcnt(10)
    v_mfma_f32_32x32x16_bf16 v[136:151], v[48:51], v[188:191], v[136:151]
    ds_read_b64_tr_b16 v[44:45], v25 offset:20480
    ds_read_b64_tr_b16 v[46:47], v25 offset:22528
    s_waitcnt lgkmcnt(10)
    v_mfma_f32_32x32x16_bf16 v[88:103], v[52:55], v[188:191], v[88:103]
    ds_read_b64_tr_b16 v[48:49], v22 offset:20480
    ds_read_b64_tr_b16 v[50:51], v22 offset:22528
    s_waitcnt lgkmcnt(10)
    v_mfma_f32_32x32x16_bf16 v[104:119], v[28:31], v[188:191], v[104:119]
    buffer_load_dwordx4 v[176:179], v249, s[32:35], s16 offen offset:2048 sc1
    ds_read_b64_tr_b16 v[52:53], v23 offset:20480
    ds_read_b64_tr_b16 v[54:55], v23 offset:22528
    s_waitcnt vmcnt(20)
    s_waitcnt lgkmcnt(10)
    v_mfma_f32_32x32x16_bf16 v[56:71], v[32:35], v[192:195], v[56:71]
    ds_read_b64_tr_b16 v[28:29], v20 offset:21504
    ds_read_b64_tr_b16 v[30:31], v20 offset:23552
    s_waitcnt lgkmcnt(10)
    v_mfma_f32_32x32x16_bf16 v[72:87], v[36:39], v[192:195], v[72:87]
    ds_read_b64_tr_b16 v[32:33], v21 offset:21504
    ds_read_b64_tr_b16 v[34:35], v21 offset:23552
    s_waitcnt lgkmcnt(10)
    v_mfma_f32_32x32x16_bf16 v[120:135], v[40:43], v[192:195], v[120:135]
    ds_read_b64_tr_b16 v[36:37], v24 offset:21504
    ds_read_b64_tr_b16 v[38:39], v24 offset:23552
    s_waitcnt lgkmcnt(10)
    v_mfma_f32_32x32x16_bf16 v[136:151], v[44:47], v[192:195], v[136:151]
    buffer_load_dwordx4 v[180:183], v249, s[32:35], s16 offen offset:3072 sc1
    ds_read_b64_tr_b16 v[40:41], v25 offset:21504
L_PAD3:
    s_cbranch_execz L_RET3
    ds_read_b64_tr_b16 v[42:43], v25 offset:23552
    s_waitcnt lgkmcnt(10)
    v_mfma_f32_32x32x16_bf16 v[88:103], v[48:51], v[192:195], v[88:103]
    s_add_u32 s16, s16, 16384
    ds_read_b64_tr_b16 v[44:45], v22 offset:21504
    ds_read_b64_tr_b16 v[46:47], v22 offset:23552
    s_waitcnt lgkmcnt(10)
    v_mfma_f32_32x32x16_bf16 v[104:119], v[52:55], v[192:195], v[104:119]
    s_and_b32 s16, s16, 0x3ffff
    ds_read_b64_tr_b16 v[48:49], v23 offset:21504
    ds_read_b64_tr_b16 v[50:51], v23 offset:23552
    s_waitcnt vmcnt(20)
    s_waitcnt lgkmcnt(10)
    v_mfma_f32_32x32x16_bf16 v[56:71], v[28:31], v[196:199], v[56:71]
    ds_read_b64_tr_b16 v[52:53], v20 offset:24576
    ds_read_b64_tr_b16 v[54:55], v20 offset:26624
    s_waitcnt lgkmcnt(10)
    v_mfma_f32_32x32x16_bf16 v[72:87], v[32:35], v[196:199], v[72:87]
    buffer_load_dwordx4 v[184:187], v249, s[32:35], s16 offen sc1
    ds_read_b64_tr_b16 v[28:29], v21 offset:24576
    ds_read_b64_tr_b16 v[30:31], v21 offset:26624
    s_waitcnt lgkmcnt(10)
    v_mfma_f32_32x32x16_bf16 v[120:135], v[36:39], v[196:199], v[120:135]
    ds_read_b64_tr_b16 v[32:33], v20 offset:25600
    ds_read_b64_tr_b16 v[34:35], v20 offset:27648
    s_waitcnt lgkmcnt(10)
    v_mfma_f32_32x32x16_bf16 v[136:151], v[40:43], v[196:199], v[136:151]
    ds_read_b64_tr_b16 v[36:37], v21 offset:25600
    ds_read_b64_tr_b16 v[38:39], v21 offset:27648
    s_waitcnt lgkmcnt(10)
    v_mfma_f32_32x32x16_bf16 v[88:103], v[44:47], v[196:199], v[88:103]
    ds_read_b64_tr_b16 v[40:41], v20 offset:28672
    ds_read_b64_tr_b16 v[42:43], v20 offset:30720
    s_waitcnt lgkmcnt(10)
    v_mfma_f32_32x32x16_bf16 v[104:119], v[48:51], v[196:199], v[104:119]
    buffer_load_dwordx4 v[188:191], v249, s[32:35], s16 offen offset:1024 sc1
    ds_read_b64_tr_b16 v[44:45], v21 offset:28672
    ds_read_b64_tr_b16 v[46:47], v21 offset:30720
    s_barrier
    s_waitcnt vmcnt(21)
    s_waitcnt lgkmcnt(10)
    v_mfma_f32_32x32x16_bf16 v[56:71], v[52:55], v[200:203], v[56:71]
    ds_read_b64_tr_b16 v[48:49], v20 offset:29696
    ds_read_b64_tr_b16 v[50:51], v20 offset:31744
    s_waitcnt lgkmcnt(10)
    v_mfma_f32_32x32x16_bf16 v[72:87], v[28:31], v[200:203], v[72:87]
    ds_read_b64_tr_b16 v[52:53], v21 offset:29696
    ds_read_b64_tr_b16 v[54:55], v21 offset:31744
    s_waitcnt vmcnt(20)
    s_waitcnt lgkmcnt(10)
    v_mfma_f32_32x32x16_bf16 v[56:71], v[32:35], v[204:207], v[56:71]
    ds_read_b64_tr_b16 v[28:29], v24 offset:24576
    ds_read_b64_tr_b16 v[30:31], v24 offset:26624
    s_waitcnt lgkmcnt(10)
    v_mfma_f32_32x32x16_bf16 v[72:87], v[36:39], v[204:207], v[72:87]
    buffer_load_dwordx4 v[192:195], v249, s[32:35], s16 offen offset:2048 sc1
    ds_read_b64_tr_b16 v[32:33], v25 offset:24576
    ds_read_b64_tr_b16 v[34:35], v25 offset:26624
    s_waitcnt vmcnt(20)
    s_waitcnt lgkmcnt(10)
    v_mfma_f32_32x32x16_bf16 v[56:71], v[40:43], v[208:211], v[56:71]
    ds_read_b64_tr_b16 v[36:37], v22 offset:24576
    ds_read_b64_tr_b16 v[38:39], v22 offset:26624
    s_waitcnt lgkmcnt(10)
    v_mfma_f32_32x32x16_bf16 v[72:87], v[44:47], v[208:211], v[72:87]
    ds_read_b64_tr_b16 v[40:41], v23 offset:24576
    ds_read_b64_tr_b16 v[42:43], v23 offset:26624
    s_waitcnt vmcnt(19)
    s_waitcnt lgkmcnt(10)
    v_mfma_f32_32x32x16_bf16 v[56:71], v[48:51], v[212:215], v[56:71]
    ds_read_b64_tr_b16 v[44:45], v24 offset:25600
    ds_read_b64_tr_b16 v[46:47], v24 offset:27648
    s_waitcnt lgkmcnt(10)
    v_mfma_f32_32x32x16_bf16 v[72:87], v[52:55], v[212:215], v[72:87]
    buffer_load_dwordx4 v[196:199], v249, s[32:35], s16 offen offset:3072 sc1
    ds_read_b64_tr_b16 v[48:49], v25 offset:25600
    ds_read_b64_tr_b16 v[50:51], v25 offset:27648
    s_barrier
    s_waitcnt lgkmcnt(10)
    v_mfma_f32_32x32x16_bf16 v[120:135], v[28:31], v[200:203], v[120:135]
    s_add_u32 s16, s16, 16384
    ds_read_b64_tr_b16 v[52:53], v22 offset:25600
    ds_read_b64_tr_b16 v[54:55], v22 offset:27648
    s_waitcnt lgkmcnt(10)
    v_mfma_f32_32x32x16_bf16 v[136:151], v[32:35], v[200:203], v[136:151]
    s_and_b32 s16, s16, 0x3ffff
    ds_read_b64_tr_b16 v[28:29], v23 offset:25600
    ds_read_b64_tr_b16 v[30:31], v23 offset:27648
    s_waitcnt lgkmcnt(10)
    v_mfma_f32_32x32x16_bf16 v[88:103], v[36:39], v[200:203], v[88:103]
    ds_read_b64_tr_b16 v[32:33], v24 offset:28672
    ds_read_b64_tr_b16 v[34:35], v24 offset:30720
    s_waitcnt lgkmcnt(10)
    v_mfma_f32_32x32x16_bf16 v[104:119], v[40:43], v[200:203], v[104:119]
    buffer_load_dwordx4 v[200:203], v249, s[32:35], s16 offen sc1
    ds_read_b64_tr_b16 v[36:37], v25 offset:28672
    ds_read_b64_tr_b16 v[38:39], v25 offset:30720
    s_waitcnt lgkmcnt(10)
    v_mfma_f32_32x32x16_bf16 v[120:135], v[44:47], v[204:207], v[120:135]
    ds_read_b64_tr_b16 v[40:41], v22 offset:28672
    ds_read_b64_tr_b16 v[42:43], v22 offset:30720
    s_waitcnt lgkmcnt(10)
    v_mfma_f32_32x32x16_bf16 v[136:151], v[48:51], v[204:207], v[136:151]
    ds_read_b64_tr_b16 v[44:45], v23 offset:28672
    ds_read_b64_tr_b16 v[46:47], v23 offset:30720
    s_waitcnt lgkmcnt(10)
    v_mfma_f32_32x32x16_bf16 v[88:103], v[52:55], v[204:207], v[88:103]
    ds_read_b64_tr_b16 v[48:49], v24 offset:29696
    ds_read_b64_tr_b16 v[50:51], v24 offset:31744
    s_waitcnt lgkmcnt(10)
    v_mfma_f32_32x32x16_bf16 v[104:119], v[28:31], v[204:207], v[104:119]
    buffer_load_dwordx4 v[204:207], v249, s[32:35], s16 offen offset:1024 sc1
    ds_read_b64_tr_b16 v[52:53], v25 offset:29696
    ds_read_b64_tr_b16 v[54:55], v25 offset:31744
    s_waitcnt lgkmcnt(10)
    v_mfma_f32_32x32x16_bf16 v[120:135], v[32:35], v[208:211], v[120:135]
    ds_read_b64_tr_b16 v[28:29], v22 offset:29696
    ds_read_b64_tr_b16 v[30:31], v22 offset:31744
    s_waitcnt lgkmcnt(10)
    v_mfma_f32_32x32x16_bf16 v[136:151], v[36:39], v[208:211], v[136:151]
    ds_read_b64_tr_b16 v[32:33], v23 offset:29696
    ds_read_b64_tr_b16 v[34:35], v23 offset:31744
    s_waitcnt lgkmcnt(10)
    v_mfma_f32_32x32x16_bf16 v[88:103], v[40:43], v[208:211], v[88:103]
    ds_read_b64_tr_b16 v[36:37], v20 offset:32768
    ds_read_b64_tr_b16 v[38:39], v20 offset:34816
    s_waitcnt lgkmcnt(10)
    v_mfma_f32_32x32x16_bf16 v[104:119], v[44:47], v[208:211], v[104:119]
    buffer_load_dwordx4 v[208:211], v249, s[32:35], s16 offen offset:2048 sc1
    ds_read_b64_tr_b16 v[40:41], v20 offset:33792
    ds_read_b64_tr_b16 v[42:43], v20 offset:35840
    s_waitcnt lgkmcnt(10)
    v_mfma_f32_32x32x16_bf16 v[120:135], v[48:51], v[212:215], v[120:135]
    ds_read_b64_tr_b16 v[44:45], v20 offset:36864
    ds_read_b64_tr_b16 v[46:47], v20 offset:38912
    s_waitcnt lgkmcnt(10)
    v_mfma_f32_32x32x16_bf16 v[136:151], v[52:55], v[212:215], v[136:151]
    ds_read_b64_tr_b16 v[48:49], v20 offset:37888
    ds_read_b64_tr_b16 v[50:51], v20 offset:39936
    s_waitcnt lgkmcnt(10)
    v_mfma_f32_32x32x16_bf16 v[88:103], v[28:31], v[212:215], v[88:103]
    ds_read_b64_tr_b16 v[52:53], v20 offset:40960
    ds_read_b64_tr_b16 v[54:55], v20 offset:43008
    s_waitcnt lgkmcnt(10)
    v_mfma_f32_32x32x16_bf16 v[104:119], v[32:35], v[212:215], v[104:119]
    buffer_load_dwordx4 v[212:215], v249, s[32:35], s16 offen offset:3072 sc1
    ds_read_b64_tr_b16 v[28:29], v20 offset:41984
    ds_read_b64_tr_b16 v[30:31], v20 offset:44032
    s_barrier
    s_waitcnt vmcnt(23)
    s_waitcnt lgkmcnt(10)
    v_mfma_f32_32x32x16_bf16 v[56:71], v[36:39], v[216:219], v[56:71]
    s_add_u32 s16, s16, 16384
    ds_read_b64_tr_b16 v[32:33], v20 offset:45056
    ds_read_b64_tr_b16 v[34:35], v20 offset:47104
    s_waitcnt vmcnt(22)
    s_waitcnt lgkmcnt(10)
    v_mfma_f32_32x32x16_bf16 v[56:71], v[40:43], v[220:223], v[56:71]
    s_and_b32 s16, s16, 0x3ffff
    ds_read_b64_tr_b16 v[36:37], v20 offset:46080
    ds_read_b64_tr_b16 v[38:39], v20 offset:48128
    s_waitcnt vmcnt(21)
    s_waitcnt lgkmcnt(10)
    v_mfma_f32_32x32x16_bf16 v[56:71], v[44:47], v[224:227], v[56:71]
    ds_read_b64_tr_b16 v[40:41], v20
    ds_read_b64_tr_b16 v[42:43], v20 offset:2048
    s_waitcnt vmcnt(20)
    s_waitcnt lgkmcnt(10)
    v_mfma_f32_32x32x16_bf16 v[56:71], v[48:51], v[228:231], v[56:71]
    ds_read_b64_tr_b16 v[44:45], v20 offset:1024
    ds_read_b64_tr_b16 v[46:47], v20 offset:3072
    s_waitcnt vmcnt(19)
    s_waitcnt lgkmcnt(10)
    v_mfma_f32_32x32x16_bf16 v[56:71], v[52:55], v[232:235], v[56:71]
    ds_read_b64_tr_b16 v[48:49], v20 offset:4096
    ds_read_b64_tr_b16 v[50:51], v20 offset:6144
    s_waitcnt vmcnt(18)
    s_waitcnt lgkmcnt(10)
    v_mfma_f32_32x32x16_bf16 v[56:71], v[28:31], v[236:239], v[56:71]
    ds_read_b64_tr_b16 v[52:53], v20 offset:5120
    ds_read_b64_tr_b16 v[54:55], v20 offset:7168
    s_waitcnt vmcnt(17)
    s_waitcnt lgkmcnt(10)
    v_mfma_f32_32x32x16_bf16 v[56:71], v[32:35], v[240:243], v[56:71]
    ds_read_b64_tr_b16 v[28:29], v20 offset:8192
    ds_read_b64_tr_b16 v[30:31], v20 offset:10240
    s_waitcnt vmcnt(16)
    s_waitcnt lgkmcnt(10)
    v_mfma_f32_32x32x16_bf16 v[56:71], v[36:39], v[244:247], v[56:71]
    ds_read_b64_tr_b16 v[32:33], v20 offset:9216
    ds_read_b64_tr_b16 v[34:35], v20 offset:11264
    s_waitcnt vmcnt(15)
    s_waitcnt lgkmcnt(10)
    v_mfma_f32_32x32x16_bf16 v[56:71], v[40:43], v[152:155], v[56:71]
    ds_read_b64_tr_b16 v[36:37], v20 offset:12288
    ds_read_b64_tr_b16 v[38:39], v20 offset:14336
    s_waitcnt vmcnt(14)
    s_waitcnt lgkmcnt(10)
    v_mfma_f32_32x32x16_bf16 v[56:71], v[44:47], v[156:159], v[56:71]
    ds_read_b64_tr_b16 v[40:41], v20 offset:13312
    ds_read_b64_tr_b16 v[42:43], v20 offset:15360
    s_waitcnt vmcnt(13)
    s_waitcnt lgkmcnt(10)
    v_mfma_f32_32x32x16_bf16 v[56:71], v[48:51], v[160:163], v[56:71]
    ds_read_b64_tr_b16 v[44:45], v20 offset:16384
    ds_read_b64_tr_b16 v[46:47], v20 offset:18432
    s_waitcnt vmcnt(12)
    s_waitcnt lgkmcnt(10)
    v_mfma_f32_32x32x16_bf16 v[56:71], v[52:55], v[164:167], v[56:71]
    ds_read_b64_tr_b16 v[48:49], v20 offset:17408
    ds_read_b64_tr_b16 v[50:51], v20 offset:19456
    s_waitcnt vmcnt(11)
    s_waitcnt lgkmcnt(10)
    v_mfma_f32_32x32x16_bf16 v[56:71], v[28:31], v[168:171], v[56:71]
    ds_read_b64_tr_b16 v[52:53], v20 offset:20480
    ds_read_b64_tr_b16 v[54:55], v20 offset:22528
    s_waitcnt vmcnt(10)
    s_waitcnt lgkmcnt(10)
    v_mfma_f32_32x32x16_bf16 v[56:71], v[32:35], v[172:175], v[56:71]
    ds_read_b64_tr_b16 v[28:29], v20 offset:21504
    ds_read_b64_tr_b16 v[30:31], v20 offset:23552
    s_barrier
    s_waitcnt vmcnt(9)
    s_waitcnt lgkmcnt(10)
    v_mfma_f32_32x32x16_bf16 v[56:71], v[36:39], v[176:179], v[56:71]
    ds_read_b64_tr_b16 v[32:33], v20 offset:24576
    ds_read_b64_tr_b16 v[34:35], v20 offset:26624
    s_waitcnt vmcnt(8)
    s_waitcnt lgkmcnt(10)
    v_mfma_f32_32x32x16_bf16 v[56:71], v[40:43], v[180:183], v[56:71]
    ds_read_b64_tr_b16 v[36:37], v20 offset:25600
    ds_read_b64_tr_b16 v[38:39], v20 offset:27648
    s_waitcnt vmcnt(7)
    s_waitcnt lgkmcnt(10)
    v_mfma_f32_32x32x16_bf16 v[56:71], v[44:47], v[184:187], v[56:71]
    ds_read_b64_tr_b16 v[40:41], v20 offset:28672
    ds_read_b64_tr_b16 v[42:43], v20 offset:30720
    s_waitcnt vmcnt(6)
    s_waitcnt lgkmcnt(10)
    v_mfma_f32_32x32x16_bf16 v[56:71], v[48:51], v[188:191], v[56:71]
    ds_read_b64_tr_b16 v[44:45], v20 offset:29696
    ds_read_b64_tr_b16 v[46:47], v20 offset:31744
    s_waitcnt vmcnt(5)
    s_waitcnt lgkmcnt(10)
    v_mfma_f32_32x32x16_bf16 v[56:71], v[52:55], v[192:195], v[56:71]
    ds_read_b64_tr_b16 v[48:49], v21 offset:32768
    ds_read_b64_tr_b16 v[50:51], v21 offset:34816
    s_waitcnt vmcnt(4)
    s_waitcnt lgkmcnt(10)
    v_mfma_f32_32x32x16_bf16 v[56:71], v[28:31], v[196:199], v[56:71]
    ds_read_b64_tr_b16 v[52:53], v21 offset:33792
    ds_read_b64_tr_b16 v[54:55], v21 offset:35840
    s_waitcnt vmcnt(3)
    s_waitcnt lgkmcnt(10)
    v_mfma_f32_32x32x16_bf16 v[56:71], v[32:35], v[200:203], v[56:71]
    ds_read_b64_tr_b16 v[28:29], v21 offset:36864
    ds_read_b64_tr_b16 v[30:31], v21 offset:38912
    s_waitcnt vmcnt(2)
    s_waitcnt lgkmcnt(10)
    v_mfma_f32_32x32x16_bf16 v[56:71], v[36:39], v[204:207], v[56:71]
    ds_read_b64_tr_b16 v[32:33], v21 offset:37888
    ds_read_b64_tr_b16 v[34:35], v21 offset:39936
    s_waitcnt vmcnt(1)
    s_waitcnt lgkmcnt(10)
    v_mfma_f32_32x32x16_bf16 v[56:71], v[40:43], v[208:211], v[56:71]
    ds_read_b64_tr_b16 v[36:37], v21 offset:40960
    ds_read_b64_tr_b16 v[38:39], v21 offset:43008
    s_waitcnt vmcnt(0)
    s_waitcnt lgkmcnt(10)
    v_mfma_f32_32x32x16_bf16 v[56:71], v[44:47], v[212:215], v[56:71]
    ds_read_b64_tr_b16 v[40:41], v21 offset:41984
    ds_read_b64_tr_b16 v[42:43], v21 offset:44032
    s_waitcnt lgkmcnt(10)
    v_mfma_f32_32x32x16_bf16 v[72:87], v[48:51], v[216:219], v[72:87]
    ds_read_b64_tr_b16 v[44:45], v21 offset:45056
    ds_read_b64_tr_b16 v[46:47], v21 offset:47104
    s_waitcnt lgkmcnt(10)
    v_mfma_f32_32x32x16_bf16 v[72:87], v[52:55], v[220:223], v[72:87]
    s_nop 3
    v_cvt_pk_bf16_f32 v56, v56, v57
    v_cvt_pk_bf16_f32 v57, v58, v59
    ds_read_b64_tr_b16 v[48:49], v21 offset:46080
    ds_read_b64_tr_b16 v[50:51], v21 offset:48128
    s_waitcnt lgkmcnt(10)
    v_mfma_f32_32x32x16_bf16 v[72:87], v[28:31], v[224:227], v[72:87]
    v_cvt_pk_bf16_f32 v58, v60, v61
    v_cvt_pk_bf16_f32 v59, v62, v63
    ds_write_b128 v0, v[56:59]
    ds_read_b64_tr_b16 v[52:53], v21
    ds_read_b64_tr_b16 v[54:55], v21 offset:2048
    s_waitcnt lgkmcnt(11)
    v_mfma_f32_32x32x16_bf16 v[72:87], v[32:35], v[228:231], v[72:87]
    v_cvt_pk_bf16_f32 v60, v64, v65
    v_cvt_pk_bf16_f32 v61, v66, v67
    ds_read_b64_tr_b16 v[28:29], v21 offset:1024
    ds_read_b64_tr_b16 v[30:31], v21 offset:3072
    s_waitcnt lgkmcnt(11)
    v_mfma_f32_32x32x16_bf16 v[72:87], v[36:39], v[232:235], v[72:87]
    v_cvt_pk_bf16_f32 v62, v68, v69
    v_cvt_pk_bf16_f32 v63, v70, v71
    ds_write_b128 v0, v[60:63] offset:1024
    ds_read_b64_tr_b16 v[32:33], v21 offset:4096
    ds_read_b64_tr_b16 v[34:35], v21 offset:6144
    s_waitcnt lgkmcnt(12)
    v_mfma_f32_32x32x16_bf16 v[72:87], v[40:43], v[236:239], v[72:87]
    v_subrev_u32 v0, 118784, v0
    ds_read_b64_tr_b16 v[36:37], v21 offset:5120
    ds_read_b64_tr_b16 v[38:39], v21 offset:7168
    s_waitcnt lgkmcnt(12)
    v_mfma_f32_32x32x16_bf16 v[72:87], v[44:47], v[240:243], v[72:87]
    ds_read_b64_tr_b16 v[40:41], v21 offset:8192
    ds_read_b64_tr_b16 v[42:43], v21 offset:10240
    s_waitcnt lgkmcnt(12)
    v_mfma_f32_32x32x16_bf16 v[72:87], v[48:51], v[244:247], v[72:87]
    ds_read_b64_tr_b16 v[44:45], v21 offset:9216
    ds_read_b64_tr_b16 v[46:47], v21 offset:11264
    s_waitcnt lgkmcnt(8)
    s_barrier
    v_mfma_f32_32x32x16_bf16 v[72:87], v[52:55], v[152:155], v[72:87]
    ds_read_b64_tr_b16 v[48:49], v21 offset:12288
    ds_read_b64_tr_b16 v[50:51], v21 offset:14336
    v_mfma_f32_32x32x16_bf16 v[72:87], v[28:31], v[156:159], v[72:87]
    ds_read_b64_tr_b16 v[52:53], v21 offset:13312
    ds_read_b64_tr_b16 v[54:55], v21 offset:15360
    s_waitcnt lgkmcnt(10)
    v_mfma_f32_32x32x16_bf16 v[72:87], v[32:35], v[160:163], v[72:87]
    ds_read_b64_tr_b16 v[28:29], v21 offset:16384
    ds_read_b64_tr_b16 v[30:31], v21 offset:18432
    s_waitcnt lgkmcnt(10)
    v_mfma_f32_32x32x16_bf16 v[72:87], v[36:39], v[164:167], v[72:87]
    ds_read_b64_tr_b16 v[32:33], v21 offset:17408
    ds_read_b64_tr_b16 v[34:35], v21 offset:19456
    s_waitcnt lgkmcnt(10)
    v_mfma_f32_32x32x16_bf16 v[72:87], v[40:43], v[168:171], v[72:87]
    ds_read_b64_tr_b16 v[36:37], v21 offset:20480
    ds_read_b64_tr_b16 v[38:39], v21 offset:22528
    s_waitcnt lgkmcnt(10)
    v_mfma_f32_32x32x16_bf16 v[72:87], v[44:47], v[172:175], v[72:87]
    ds_read_b64_tr_b16 v[40:41], v21 offset:21504
    ds_read_b64_tr_b16 v[42:43], v21 offset:23552
    s_waitcnt lgkmcnt(10)
    v_mfma_f32_32x32x16_bf16 v[72:87], v[48:51], v[176:179], v[72:87]
    ds_read_b64_tr_b16 v[44:45], v21 offset:24576
    ds_read_b64_tr_b16 v[46:47], v21 offset:26624
    s_waitcnt lgkmcnt(10)
    v_mfma_f32_32x32x16_bf16 v[72:87], v[52:55], v[180:183], v[72:87]
    ds_read_b64_tr_b16 v[48:49], v21 offset:25600
    ds_read_b64_tr_b16 v[50:51], v21 offset:27648
    s_waitcnt lgkmcnt(10)
    v_mfma_f32_32x32x16_bf16 v[72:87], v[28:31], v[184:187], v[72:87]
    ds_read_b64_tr_b16 v[52:53], v21 offset:28672
    ds_read_b64_tr_b16 v[54:55], v21 offset:30720
    s_waitcnt lgkmcnt(10)
    v_mfma_f32_32x32x16_bf16 v[72:87], v[32:35], v[188:191], v[72:87]
    ds_read_b64_tr_b16 v[28:29], v21 offset:29696
    ds_read_b64_tr_b16 v[30:31], v21 offset:31744
    s_waitcnt lgkmcnt(10)
    v_mfma_f32_32x32x16_bf16 v[72:87], v[36:39], v[192:195], v[72:87]
    ds_read_b64_tr_b16 v[32:33], v22 offset:32768
    ds_read_b64_tr_b16 v[34:35], v22 offset:34816
    s_waitcnt lgkmcnt(10)
    v_mfma_f32_32x32x16_bf16 v[72:87], v[40:43], v[196:199], v[72:87]
    ds_read_b64_tr_b16 v[36:37], v23 offset:32768
    ds_read_b64_tr_b16 v[38:39], v23 offset:34816
    s_waitcnt lgkmcnt(10)
    v_mfma_f32_32x32x16_bf16 v[72:87], v[44:47], v[200:203], v[72:87]
    ds_read_b64_tr_b16 v[40:41], v22 offset:33792
    ds_read_b64_tr_b16 v[42:43], v22 offset:35840
    s_waitcnt lgkmcnt(10)
    v_mfma_f32_32x32x16_bf16 v[72:87], v[48:51], v[204:207], v[72:87]
    ds_read_b64_tr_b16 v[44:45], v23 offset:33792
    ds_read_b64_tr_b16 v[46:47], v23 offset:35840
    s_waitcnt lgkmcnt(10)
    v_mfma_f32_32x32x16_bf16 v[72:87], v[52:55], v[208:211], v[72:87]
    ds_read_b64_tr_b16 v[48:49], v22 offset:36864
    ds_read_b64_tr_b16 v[50:51], v22 offset:38912
    s_waitcnt lgkmcnt(10)
    v_mfma_f32_32x32x16_bf16 v[72:87], v[28:31], v[212:215], v[72:87]
    ds_read_b64_tr_b16 v[52:53], v23 offset:36864
    ds_read_b64_tr_b16 v[54:55], v23 offset:38912
    s_waitcnt lgkmcnt(10)
    v_mfma_f32_32x32x16_bf16 v[88:103], v[32:35], v[216:219], v[88:103]
    ds_read_b64_tr_b16 v[28:29], v22 offset:37888
    ds_read_b64_tr_b16 v[30:31], v22 offset:39936
    s_waitcnt lgkmcnt(10)
    v_mfma_f32_32x32x16_bf16 v[104:119], v[36:39], v[216:219], v[104:119]
    s_nop 3
    v_cvt_pk_bf16_f32 v72, v72, v73
    v_cvt_pk_bf16_f32 v73, v74, v75
    ds_read_b64_tr_b16 v[32:33], v23 offset:37888
    ds_read_b64_tr_b16 v[34:35], v23 offset:39936
    s_waitcnt lgkmcnt(10)
    v_mfma_f32_32x32x16_bf16 v[88:103], v[40:43], v[220:223], v[88:103]
    v_cvt_pk_bf16_f32 v74, v76, v77
    v_cvt_pk_bf16_f32 v75, v78, v79
    ds_write_b128 v0, v[72:75]
    ds_read_b64_tr_b16 v[36:37], v22 offset:40960
    ds_read_b64_tr_b16 v[38:39], v22 offset:43008
    s_waitcnt lgkmcnt(11)
    v_mfma_f32_32x32x16_bf16 v[104:119], v[44:47], v[220:223], v[104:119]
    v_cvt_pk_bf16_f32 v76, v80, v81
    v_cvt_pk_bf16_f32 v77, v82, v83
    ds_read_b64_tr_b16 v[40:41], v23 offset:40960
    ds_read_b64_tr_b16 v[42:43], v23 offset:43008
    s_waitcnt lgkmcnt(11)
    v_mfma_f32_32x32x16_bf16 v[88:103], v[48:51], v[224:227], v[88:103]
    v_cvt_pk_bf16_f32 v78, v84, v85
    v_cvt_pk_bf16_f32 v79, v86, v87
    ds_write_b128 v0, v[76:79] offset:1024
    ds_read_b64_tr_b16 v[44:45], v22 offset:41984
    ds_read_b64_tr_b16 v[46:47], v22 offset:44032
    s_waitcnt lgkmcnt(12)
    v_mfma_f32_32x32x16_bf16 v[104:119], v[52:55], v[224:227], v[104:119]
    ds_read_b64_tr_b16 v[48:49], v23 offset:41984
    ds_read_b64_tr_b16 v[50:51], v23 offset:44032
    s_waitcnt lgkmcnt(4)
    s_barrier
    v_mfma_f32_32x32x16_bf16 v[88:103], v[28:31], v[228:231], v[88:103]
    s_lshl_b32 s96, s77, 11
    s_add_u32 s14, s96, 32768
    v_and_b32 v0, 7, v1
    ds_read_b64_tr_b16 v[52:53], v22 offset:45056
    ds_read_b64_tr_b16 v[54:55], v22 offset:47104
    v_mfma_f32_32x32x16_bf16 v[104:119], v[32:35], v[228:231], v[104:119]
    v_lshl_add_u32 v0, v0, 4, s14
    ds_read_b64_tr_b16 v[28:29], v23 offset:45056
    ds_read_b64_tr_b16 v[30:31], v23 offset:47104
    v_mfma_f32_32x32x16_bf16 v[88:103], v[36:39], v[232:235], v[88:103]
    v_bfe_u32 v4, v1, 3, 2
    ds_read_b64_tr_b16 v[32:33], v22 offset:46080
    ds_read_b64_tr_b16 v[34:35], v22 offset:48128
    v_mfma_f32_32x32x16_bf16 v[104:119], v[40:43], v[232:235], v[104:119]
    v_lshl_add_u32 v0, v4, 8, v0
    v_lshrrev_b32 v4, 5, v1
    ds_read_b64_tr_b16 v[36:37], v23 offset:46080
    ds_read_b64_tr_b16 v[38:39], v23 offset:48128
    s_waitcnt lgkmcnt(10)
    v_mfma_f32_32x32x16_bf16 v[88:103], v[44:47], v[236:239], v[88:103]
    v_lshl_add_u32 v0, v4, 7, v0
    ds_read_b64_tr_b16 v[40:41], v22
    ds_read_b64_tr_b16 v[42:43], v22 offset:2048
    s_waitcnt lgkmcnt(10)
    v_mfma_f32_32x32x16_bf16 v[104:119], v[48:51], v[236:239], v[104:119]
    ds_read_b64_tr_b16 v[44:45], v23
    ds_read_b64_tr_b16 v[46:47], v23 offset:2048
    s_waitcnt lgkmcnt(10)
    v_mfma_f32_32x32x16_bf16 v[88:103], v[52:55], v[240:243], v[88:103]
    ds_read_b64_tr_b16 v[48:49], v22 offset:1024
    ds_read_b64_tr_b16 v[50:51], v22 offset:3072
    s_waitcnt lgkmcnt(10)
    v_mfma_f32_32x32x16_bf16 v[104:119], v[28:31], v[240:243], v[104:119]
    ds_read_b64_tr_b16 v[52:53], v23 offset:1024
    ds_read_b64_tr_b16 v[54:55], v23 offset:3072
    s_waitcnt lgkmcnt(10)
    v_mfma_f32_32x32x16_bf16 v[88:103], v[32:35], v[244:247], v[88:103]
    ds_read_b64_tr_b16 v[28:29], v22 offset:4096
    ds_read_b64_tr_b16 v[30:31], v22 offset:6144
    s_waitcnt lgkmcnt(10)
    v_mfma_f32_32x32x16_bf16 v[104:119], v[36:39], v[244:247], v[104:119]
    ds_read_b64_tr_b16 v[32:33], v23 offset:4096
    ds_read_b64_tr_b16 v[34:35], v23 offset:6144
    s_waitcnt lgkmcnt(10)
    v_mfma_f32_32x32x16_bf16 v[88:103], v[40:43], v[152:155], v[88:103]
    ds_read_b64_tr_b16 v[36:37], v22 offset:5120
    ds_read_b64_tr_b16 v[38:39], v22 offset:7168
    s_waitcnt lgkmcnt(10)
    v_mfma_f32_32x32x16_bf16 v[104:119], v[44:47], v[152:155], v[104:119]
    ds_read_b64_tr_b16 v[40:41], v23 offset:5120
    ds_read_b64_tr_b16 v[42:43], v23 offset:7168
    s_waitcnt lgkmcnt(10)
    v_mfma_f32_32x32x16_bf16 v[88:103], v[48:51], v[156:159], v[88:103]
    ds_read_b64_tr_b16 v[44:45], v22 offset:8192
    ds_read_b64_tr_b16 v[46:47], v22 offset:10240
    s_waitcnt lgkmcnt(10)
    v_mfma_f32_32x32x16_bf16 v[104:119], v[52:55], v[156:159], v[104:119]
    ds_read_b64_tr_b16 v[48:49], v23 offset:8192
    ds_read_b64_tr_b16 v[50:51], v23 offset:10240
    s_waitcnt lgkmcnt(10)
    v_mfma_f32_32x32x16_bf16 v[88:103], v[28:31], v[160:163], v[88:103]
    ds_read_b64_tr_b16 v[52:53], v22 offset:9216
    ds_read_b64_tr_b16 v[54:55], v22 offset:11264
    s_waitcnt lgkmcnt(10)
    v_mfma_f32_32x32x16_bf16 v[104:119], v[32:35], v[160:163], v[104:119]
    ds_read_b64_tr_b16 v[28:29], v23 offset:9216
    ds_read_b64_tr_b16 v[30:31], v23 offset:11264
    s_waitcnt lgkmcnt(10)
    v_mfma_f32_32x32x16_bf16 v[88:103], v[36:39], v[164:167], v[88:103]
    ds_read_b64_tr_b16 v[32:33], v22 offset:12288
    ds_read_b64_tr_b16 v[34:35], v22 offset:14336
    s_waitcnt lgkmcnt(10)
    v_mfma_f32_32x32x16_bf16 v[104:119], v[40:43], v[164:167], v[104:119]
    ds_read_b64_tr_b16 v[36:37], v23 offset:12288
    ds_read_b64_tr_b16 v[38:39], v23 offset:14336
    s_waitcnt lgkmcnt(10)
    v_mfma_f32_32x32x16_bf16 v[88:103], v[44:47], v[168:171], v[88:103]
    ds_read_b64_tr_b16 v[40:41], v22 offset:13312
    ds_read_b64_tr_b16 v[42:43], v22 offset:15360
    s_waitcnt lgkmcnt(10)
    v_mfma_f32_32x32x16_bf16 v[104:119], v[48:51], v[168:171], v[104:119]
    ds_read_b64_tr_b16 v[44:45], v23 offset:13312
    ds_read_b64_tr_b16 v[46:47], v23 offset:15360
    s_waitcnt lgkmcnt(10)
    v_mfma_f32_32x32x16_bf16 v[88:103], v[52:55], v[172:175], v[88:103]
    ds_read_b64_tr_b16 v[48:49], v22 offset:16384
    ds_read_b64_tr_b16 v[50:51], v22 offset:18432
    s_waitcnt lgkmcnt(10)
    v_mfma_f32_32x32x16_bf16 v[104:119], v[28:31], v[172:175], v[104:119]
    ds_read_b64_tr_b16 v[52:53], v23 offset:16384
    ds_read_b64_tr_b16 v[54:55], v23 offset:18432
    s_waitcnt lgkmcnt(10)
    v_mfma_f32_32x32x16_bf16 v[88:103], v[32:35], v[176:179], v[88:103]
    ds_read_b64_tr_b16 v[28:29], v22 offset:17408
    ds_read_b64_tr_b16 v[30:31], v22 offset:19456
    s_waitcnt lgkmcnt(10)
    v_mfma_f32_32x32x16_bf16 v[104:119], v[36:39], v[176:179], v[104:119]
    ds_read_b64_tr_b16 v[32:33], v23 offset:17408
    ds_read_b64_tr_b16 v[34:35], v23 offset:19456
    s_waitcnt lgkmcnt(10)
    v_mfma_f32_32x32x16_bf16 v[88:103], v[40:43], v[180:183], v[88:103]
    ds_read_b64_tr_b16 v[36:37], v22 offset:20480
    ds_read_b64_tr_b16 v[38:39], v22 offset:22528
    s_waitcnt lgkmcnt(10)
    v_mfma_f32_32x32x16_bf16 v[104:119], v[44:47], v[180:183], v[104:119]
    ds_read_b64_tr_b16 v[40:41], v23 offset:20480
    ds_read_b64_tr_b16 v[42:43], v23 offset:22528
    s_waitcnt lgkmcnt(10)
    v_mfma_f32_32x32x16_bf16 v[88:103], v[48:51], v[184:187], v[88:103]
    ds_read_b64_tr_b16 v[44:45], v22 offset:21504
    ds_read_b64_tr_b16 v[46:47], v22 offset:23552
    s_waitcnt lgkmcnt(10)
    v_mfma_f32_32x32x16_bf16 v[104:119], v[52:55], v[184:187], v[104:119]
    ds_read_b64_tr_b16 v[48:49], v23 offset:21504
    ds_read_b64_tr_b16 v[50:51], v23 offset:23552
    s_waitcnt lgkmcnt(10)
    v_mfma_f32_32x32x16_bf16 v[88:103], v[28:31], v[188:191], v[88:103]
    ds_read_b64_tr_b16 v[52:53], v22 offset:24576
    ds_read_b64_tr_b16 v[54:55], v22 offset:26624
    s_waitcnt lgkmcnt(10)
    v_mfma_f32_32x32x16_bf16 v[104:119], v[32:35], v[188:191], v[104:119]
    ds_read_b64_tr_b16 v[28:29], v23 offset:24576
    ds_read_b64_tr_b16 v[30:31], v23 offset:26624
    s_waitcnt lgkmcnt(10)
    v_mfma_f32_32x32x16_bf16 v[88:103], v[36:39], v[192:195], v[88:103]
    ds_read_b64_tr_b16 v[32:33], v22 offset:25600
    ds_read_b64_tr_b16 v[34:35], v22 offset:27648
    s_waitcnt lgkmcnt(10)
    v_mfma_f32_32x32x16_bf16 v[104:119], v[40:43], v[192:195], v[104:119]
    ds_read_b64_tr_b16 v[36:37], v23 offset:25600
    ds_read_b64_tr_b16 v[38:39], v23 offset:27648
    s_waitcnt lgkmcnt(10)
    v_mfma_f32_32x32x16_bf16 v[88:103], v[44:47], v[196:199], v[88:103]
    ds_read_b64_tr_b16 v[40:41], v22 offset:28672
    ds_read_b64_tr_b16 v[42:43], v22 offset:30720
    s_waitcnt lgkmcnt(10)
    v_mfma_f32_32x32x16_bf16 v[104:119], v[48:51], v[196:199], v[104:119]
    ds_read_b64_tr_b16 v[44:45], v23 offset:28672
    ds_read_b64_tr_b16 v[46:47], v23 offset:30720
    s_waitcnt lgkmcnt(10)
    v_mfma_f32_32x32x16_bf16 v[88:103], v[52:55], v[200:203], v[88:103]
    ds_read_b64_tr_b16 v[48:49], v22 offset:29696
    ds_read_b64_tr_b16 v[50:51], v22 offset:31744
    s_waitcnt lgkmcnt(10)
    v_mfma_f32_32x32x16_bf16 v[104:119], v[28:31], v[200:203], v[104:119]
    ds_read_b64_tr_b16 v[52:53], v23 offset:29696
    ds_read_b64_tr_b16 v[54:55], v23 offset:31744
    s_waitcnt lgkmcnt(10)
    v_mfma_f32_32x32x16_bf16 v[88:103], v[32:35], v[204:207], v[88:103]
    ds_read_b64_tr_b16 v[28:29], v24 offset:32768
    ds_read_b64_tr_b16 v[30:31], v24 offset:34816
    s_waitcnt lgkmcnt(10)
    v_mfma_f32_32x32x16_bf16 v[104:119], v[36:39], v[204:207], v[104:119]
    ds_read_b64_tr_b16 v[32:33], v25 offset:32768
    ds_read_b64_tr_b16 v[34:35], v25 offset:34816
    s_waitcnt lgkmcnt(10)
    v_mfma_f32_32x32x16_bf16 v[88:103], v[40:43], v[208:211], v[88:103]
    ds_read_b64_tr_b16 v[36:37], v24 offset:33792
    ds_read_b64_tr_b16 v[38:39], v24 offset:35840
    s_waitcnt lgkmcnt(10)
    v_mfma_f32_32x32x16_bf16 v[104:119], v[44:47], v[208:211], v[104:119]
    ds_read_b64_tr_b16 v[40:41], v25 offset:33792
    ds_read_b64_tr_b16 v[42:43], v25 offset:35840
    s_waitcnt lgkmcnt(10)
    v_mfma_f32_32x32x16_bf16 v[88:103], v[48:51], v[212:215], v[88:103]
    ds_read_b64_tr_b16 v[44:45], v24 offset:36864
    ds_read_b64_tr_b16 v[46:47], v24 offset:38912
    s_waitcnt lgkmcnt(10)
    v_mfma_f32_32x32x16_bf16 v[104:119], v[52:55], v[212:215], v[104:119]
    ds_read_b64_tr_b16 v[48:49], v25 offset:36864
    ds_read_b64_tr_b16 v[50:51], v25 offset:38912
    s_barrier
    s_waitcnt lgkmcnt(10)
    v_mfma_f32_32x32x16_bf16 v[120:135], v[28:31], v[216:219], v[120:135]
    ds_read_b64_tr_b16 v[52:53], v24 offset:37888
    ds_read_b64_tr_b16 v[54:55], v24 offset:39936
L_PAD4:
    s_cbranch_execz L_RET4
    s_waitcnt lgkmcnt(10)
    v_mfma_f32_32x32x16_bf16 v[136:151], v[32:35], v[216:219], v[136:151]
    v_cvt_pk_bf16_f32 v88, v88, v89
    v_cvt_pk_bf16_f32 v89, v90, v91
    ds_read_b64_tr_b16 v[28:29], v25 offset:37888
    ds_read_b64_tr_b16 v[30:31], v25 offset:39936
    s_waitcnt lgkmcnt(10)
    v_mfma_f32_32x32x16_bf16 v[120:135], v[36:39], v[220:223], v[120:135]
    v_cvt_pk_bf16_f32 v90, v92, v93
    v_cvt_pk_bf16_f32 v91, v94, v95
    ds_write_b128 v0, v[88:91]
    ds_read_b64_tr_b16 v[32:33], v24 offset:40960
    ds_read_b64_tr_b16 v[34:35], v24 offset:43008
    s_waitcnt lgkmcnt(11)
    v_mfma_f32_32x32x16_bf16 v[136:151], v[40:43], v[220:223], v[136:151]
    v_cvt_pk_bf16_f32 v92, v96, v97
    v_cvt_pk_bf16_f32 v93, v98, v99
    ds_read_b64_tr_b16 v[36:37], v25 offset:40960
    ds_read_b64_tr_b16 v[38:39], v25 offset:43008
    s_waitcnt lgkmcnt(11)
    v_mfma_f32_32x32x16_bf16 v[120:135], v[44:47], v[224:227], v[120:135]
    v_cvt_pk_bf16_f32 v94, v100, v101
    v_cvt_pk_bf16_f32 v95, v102, v103
    ds_write_b128 v0, v[92:95] offset:1024
    ds_read_b64_tr_b16 v[40:41], v24 offset:41984
    ds_read_b64_tr_b16 v[42:43], v24 offset:44032
    s_waitcnt lgkmcnt(12)
    v_mfma_f32_32x32x16_bf16 v[136:151], v[48:51], v[224:227], v[136:151]
    v_cvt_pk_bf16_f32 v104, v104, v105
    v_cvt_pk_bf16_f32 v105, v106, v107
    ds_read_b64_tr_b16 v[44:45], v25 offset:41984
    ds_read_b64_tr_b16 v[46:47], v25 offset:44032
    s_waitcnt lgkmcnt(12)
    v_mfma_f32_32x32x16_bf16 v[120:135], v[52:55], v[228:231], v[120:135]
    v_cvt_pk_bf16_f32 v106, v108, v109
    v_cvt_pk_bf16_f32 v107, v110, v111
    ds_write_b128 v0, v[104:107] offset:8192
    ds_read_b64_tr_b16 v[48:49], v24 offset:45056
    ds_read_b64_tr_b16 v[50:51], v24 offset:47104
    s_waitcnt lgkmcnt(13)
    v_mfma_f32_32x32x16_bf16 v[136:151], v[28:31], v[228:231], v[136:151]
    v_cvt_pk_bf16_f32 v108, v112, v113
    v_cvt_pk_bf16_f32 v109, v114, v115
    ds_read_b64_tr_b16 v[52:53], v25 offset:45056
    ds_read_b64_tr_b16 v[54:55], v25 offset:47104
    s_waitcnt lgkmcnt(12)
    v_mfma_f32_32x32x16_bf16 v[120:135], v[32:35], v[232:235], v[120:135]
    v_cvt_pk_bf16_f32 v110, v116, v117
    v_cvt_pk_bf16_f32 v111, v118, v119
    ds_write_b128 v0, v[108:111] offset:9216
    ds_read_b64_tr_b16 v[28:29], v24 offset:46080
    ds_read_b64_tr_b16 v[30:31], v24 offset:48128
    s_waitcnt lgkmcnt(13)
    v_mfma_f32_32x32x16_bf16 v[136:151], v[36:39], v[232:235], v[136:151]
    ds_read_b64_tr_b16 v[32:33], v25 offset:46080
    ds_read_b64_tr_b16 v[34:35], v25 offset:48128
    s_waitcnt lgkmcnt(12)
    v_mfma_f32_32x32x16_bf16 v[120:135], v[40:43], v[236:239], v[120:135]
    ds_read_b64_tr_b16 v[36:37], v24
    ds_read_b64_tr_b16 v[38:39], v24 offset:2048
    s_waitcnt lgkmcnt(12)
    v_mfma_f32_32x32x16_bf16 v[136:151], v[44:47], v[236:239], v[136:151]
    ds_read_b64_tr_b16 v[40:41], v25
    ds_read_b64_tr_b16 v[42:43], v25 offset:2048
    s_waitcnt lgkmcnt(11)
    v_mfma_f32_32x32x16_bf16 v[120:135], v[48:51], v[240:243], v[120:135]
    ds_read_b64_tr_b16 v[44:45], v24 offset:1024
    ds_read_b64_tr_b16 v[46:47], v24 offset:3072
    s_waitcnt lgkmcnt(11)
    v_mfma_f32_32x32x16_bf16 v[136:151], v[52:55], v[240:243], v[136:151]
    ds_read_b64_tr_b16 v[48:49], v25 offset:1024
    ds_read_b64_tr_b16 v[50:51], v25 offset:3072
    s_waitcnt lgkmcnt(10)
    v_mfma_f32_32x32x16_bf16 v[120:135], v[28:31], v[244:247], v[120:135]
    ds_read_b64_tr_b16 v[52:53], v24 offset:4096
    ds_read_b64_tr_b16 v[54:55], v24 offset:6144
    s_waitcnt lgkmcnt(10)
    v_mfma_f32_32x32x16_bf16 v[136:151], v[32:35], v[244:247], v[136:151]
    ds_read_b64_tr_b16 v[28:29], v25 offset:4096
    ds_read_b64_tr_b16 v[30:31], v25 offset:6144
    s_waitcnt lgkmcnt(10)
    v_mfma_f32_32x32x16_bf16 v[120:135], v[36:39], v[152:155], v[120:135]
    ds_read_b64_tr_b16 v[32:33], v24 offset:5120
    ds_read_b64_tr_b16 v[34:35], v24 offset:7168
    s_waitcnt lgkmcnt(10)
    v_mfma_f32_32x32x16_bf16 v[136:151], v[40:43], v[152:155], v[136:151]
    ds_read_b64_tr_b16 v[36:37], v25 offset:5120
    ds_read_b64_tr_b16 v[38:39], v25 offset:7168
    s_waitcnt lgkmcnt(10)
    v_mfma_f32_32x32x16_bf16 v[120:135], v[44:47], v[156:159], v[120:135]
    ds_read_b64_tr_b16 v[40:41], v24 offset:8192
    ds_read_b64_tr_b16 v[42:43], v24 offset:10240
    s_waitcnt lgkmcnt(10)
    v_mfma_f32_32x32x16_bf16 v[136:151], v[48:51], v[156:159], v[136:151]
    ds_read_b64_tr_b16 v[44:45], v25 offset:8192
    ds_read_b64_tr_b16 v[46:47], v25 offset:10240
    s_waitcnt lgkmcnt(10)
    v_mfma_f32_32x32x16_bf16 v[120:135], v[52:55], v[160:163], v[120:135]
    ds_read_b64_tr_b16 v[48:49], v24 offset:9216
    ds_read_b64_tr_b16 v[50:51], v24 offset:11264
    s_waitcnt lgkmcnt(10)
    v_mfma_f32_32x32x16_bf16 v[136:151], v[28:31], v[160:163], v[136:151]
    ds_read_b64_tr_b16 v[52:53], v25 offset:9216
    ds_read_b64_tr_b16 v[54:55], v25 offset:11264
    s_waitcnt lgkmcnt(10)
    v_mfma_f32_32x32x16_bf16 v[120:135], v[32:35], v[164:167], v[120:135]
    ds_read_b64_tr_b16 v[28:29], v24 offset:12288
    ds_read_b64_tr_b16 v[30:31], v24 offset:14336
    s_waitcnt lgkmcnt(10)
    v_mfma_f32_32x32x16_bf16 v[136:151], v[36:39], v[164:167], v[136:151]
    ds_read_b64_tr_b16 v[32:33], v25 offset:12288
    ds_read_b64_tr_b16 v[34:35], v25 offset:14336
    s_waitcnt lgkmcnt(10)
    v_mfma_f32_32x32x16_bf16 v[120:135], v[40:43], v[168:171], v[120:135]
    ds_read_b64_tr_b16 v[36:37], v24 offset:13312
    ds_read_b64_tr_b16 v[38:39], v24 offset:15360
    s_waitcnt lgkmcnt(10)
    v_mfma_f32_32x32x16_bf16 v[136:151], v[44:47], v[168:171], v[136:151]
    ds_read_b64_tr_b16 v[40:41], v25 offset:13312
    ds_read_b64_tr_b16 v[42:43], v25 offset:15360
    s_waitcnt lgkmcnt(10)
    v_mfma_f32_32x32x16_bf16 v[120:135], v[48:51], v[172:175], v[120:135]
    ds_read_b64_tr_b16 v[44:45], v24 offset:16384
    ds_read_b64_tr_b16 v[46:47], v24 offset:18432
    s_waitcnt lgkmcnt(10)
    v_mfma_f32_32x32x16_bf16 v[136:151], v[52:55], v[172:175], v[136:151]
    ds_read_b64_tr_b16 v[48:49], v25 offset:16384
    ds_read_b64_tr_b16 v[50:51], v25 offset:18432
    s_waitcnt lgkmcnt(10)
    v_mfma_f32_32x32x16_bf16 v[120:135], v[28:31], v[176:179], v[120:135]
    ds_read_b64_tr_b16 v[52:53], v24 offset:17408
    ds_read_b64_tr_b16 v[54:55], v24 offset:19456
    s_waitcnt lgkmcnt(10)
    v_mfma_f32_32x32x16_bf16 v[136:151], v[32:35], v[176:179], v[136:151]
    ds_read_b64_tr_b16 v[28:29], v25 offset:17408
    ds_read_b64_tr_b16 v[30:31], v25 offset:19456
    s_waitcnt lgkmcnt(10)
    v_mfma_f32_32x32x16_bf16 v[120:135], v[36:39], v[180:183], v[120:135]
    ds_read_b64_tr_b16 v[32:33], v24 offset:20480
    ds_read_b64_tr_b16 v[34:35], v24 offset:22528
    s_waitcnt lgkmcnt(10)
    v_mfma_f32_32x32x16_bf16 v[136:151], v[40:43], v[180:183], v[136:151]
    ds_read_b64_tr_b16 v[36:37], v25 offset:20480
    ds_read_b64_tr_b16 v[38:39], v25 offset:22528
    s_waitcnt lgkmcnt(10)
    v_mfma_f32_32x32x16_bf16 v[120:135], v[44:47], v[184:187], v[120:135]
    ds_read_b64_tr_b16 v[40:41], v24 offset:21504
    ds_read_b64_tr_b16 v[42:43], v24 offset:23552
    s_waitcnt lgkmcnt(10)
    v_mfma_f32_32x32x16_bf16 v[136:151], v[48:51], v[184:187], v[136:151]
    ds_read_b64_tr_b16 v[44:45], v25 offset:21504
    ds_read_b64_tr_b16 v[46:47], v25 offset:23552
    s_waitcnt lgkmcnt(10)
    v_mfma_f32_32x32x16_bf16 v[120:135], v[52:55], v[188:191], v[120:135]
    ds_read_b64_tr_b16 v[48:49], v24 offset:24576
    ds_read_b64_tr_b16 v[50:51], v24 offset:26624
    s_waitcnt lgkmcnt(10)
    v_mfma_f32_32x32x16_bf16 v[136:151], v[28:31], v[188:191], v[136:151]
    ds_read_b64_tr_b16 v[52:53], v25 offset:24576
    ds_read_b64_tr_b16 v[54:55], v25 offset:26624
    s_waitcnt lgkmcnt(10)
    v_mfma_f32_32x32x16_bf16 v[120:135], v[32:35], v[192:195], v[120:135]
    ds_read_b64_tr_b16 v[28:29], v24 offset:25600
    ds_read_b64_tr_b16 v[30:31], v24 offset:27648
    s_waitcnt lgkmcnt(10)
    v_mfma_f32_32x32x16_bf16 v[136:151], v[36:39], v[192:195], v[136:151]
    ds_read_b64_tr_b16 v[32:33], v25 offset:25600
    ds_read_b64_tr_b16 v[34:35], v25 offset:27648
    s_waitcnt lgkmcnt(10)
    v_mfma_f32_32x32x16_bf16 v[120:135], v[40:43], v[196:199], v[120:135]
    ds_read_b64_tr_b16 v[36:37], v24 offset:28672
    ds_read_b64_tr_b16 v[38:39], v24 offset:30720
    s_waitcnt lgkmcnt(10)
    v_mfma_f32_32x32x16_bf16 v[136:151], v[44:47], v[196:199], v[136:151]
    ds_read_b64_tr_b16 v[40:41], v25 offset:28672
    ds_read_b64_tr_b16 v[42:43], v25 offset:30720
    s_waitcnt lgkmcnt(10)
    v_mfma_f32_32x32x16_bf16 v[120:135], v[48:51], v[200:203], v[120:135]
    ds_read_b64_tr_b16 v[44:45], v25 offset:29696
    ds_read_b64_tr_b16 v[46:47], v25 offset:31744
    s_waitcnt lgkmcnt(10)
    v_mfma_f32_32x32x16_bf16 v[136:151], v[52:55], v[200:203], v[136:151]
    ds_read_b64_tr_b16 v[48:49], v24 offset:29696
    ds_read_b64_tr_b16 v[50:51], v24 offset:31744
    s_waitcnt lgkmcnt(10)
    v_mfma_f32_32x32x16_bf16 v[120:135], v[28:31], v[204:207], v[120:135]
    s_waitcnt lgkmcnt(8)
    v_mfma_f32_32x32x16_bf16 v[136:151], v[32:35], v[204:207], v[136:151]
    s_waitcnt lgkmcnt(6)
    v_mfma_f32_32x32x16_bf16 v[120:135], v[36:39], v[208:211], v[120:135]
    s_waitcnt lgkmcnt(4)
    v_mfma_f32_32x32x16_bf16 v[136:151], v[40:43], v[208:211], v[136:151]
    s_waitcnt lgkmcnt(2)
    v_mfma_f32_32x32x16_bf16 v[136:151], v[44:47], v[212:215], v[136:151]
    s_waitcnt lgkmcnt(0)
    v_mfma_f32_32x32x16_bf16 v[120:135], v[48:51], v[212:215], v[120:135]
    s_lshl_b32 s96, s77, 11
    s_add_u32 s14, s96, 151552
    v_add_u32 v0, s14, v2
    v_bfe_u32 v4, v1, 2, 2
    v_lshlrev_b32 v4, 6, v4
    v_bfe_u32 v9, v1, 4, 1
    v_lshl_add_u32 v4, v9, 5, v4
    v_and_b32 v9, 3, v1
    v_lshl_add_u32 v4, v9, 3, v4
    v_lshrrev_b32 v9, 5, v1
    v_lshl_add_u32 v4, v9, 8, v4
    v_add_u32 v4, 159744, v4
    ds_read_b64_tr_b16 v[176:177], v4
    ds_read_b64_tr_b16 v[178:179], v4 offset:512
    ds_read_b64_tr_b16 v[180:181], v4 offset:1024
    ds_read_b64_tr_b16 v[182:183], v4 offset:1536
    v_cvt_pk_bf16_f32 v152, v136, v137
    v_cvt_pk_bf16_f32 v153, v138, v139
    v_cvt_pk_bf16_f32 v154, v140, v141
    v_cvt_pk_bf16_f32 v155, v142, v143
    v_cvt_pk_bf16_f32 v156, v144, v145
    v_cvt_pk_bf16_f32 v157, v146, v147
    v_cvt_pk_bf16_f32 v158, v148, v149
    v_cvt_pk_bf16_f32 v159, v150, v151
    ds_write_b128 v0, v[152:155]
    ds_write_b128 v0, v[156:159] offset:1024
    v_cvt_pk_bf16_f32 v168, v120, v121
    v_cvt_pk_bf16_f32 v169, v122, v123
    v_cvt_pk_bf16_f32 v170, v124, v125
    v_cvt_pk_bf16_f32 v171, v126, v127
    v_cvt_pk_bf16_f32 v172, v128, v129
    v_cvt_pk_bf16_f32 v173, v130, v131
    v_cvt_pk_bf16_f32 v174, v132, v133
    v_cvt_pk_bf16_f32 v175, v134, v135
    s_setprio 0
    s_branch L_JOIN
L_HELP:
    s_waitcnt vmcnt(3)
    s_barrier
    s_add_u32 s96, s84, 5
    s_and_b32 s97, s96, 15
    s_mul_i32 s98, s97, 393216
    s_add_u32 s99, s98, s85
    s_add_u32 s82, s99, 4294772736
    s_add_u32 m0, s83, 36864
    s_nop 0
    buffer_load_dwordx4 v3, s[40:43], s82 offen lds
    s_add_u32 s96, s84, 5
    s_and_b32 s97, s96, 15
    s_mul_i32 s98, s97, 393216
    s_add_u32 s99, s98, s85
    s_add_u32 s82, s99, 2048
    s_add_u32 m0, s83, 40960
    s_nop 0
    buffer_load_dwordx4 v3, s[40:43], s82 offen lds
    s_add_u32 s96, s84, 5
    s_and_b32 s97, s96, 15
    s_mul_i32 s98, s97, 393216
    s_add_u32 s99, s98, s85
    s_add_u32 s82, s99, 4294774784
    s_add_u32 m0, s83, 86016
    s_nop 0
    buffer_load_dwordx4 v3, s[40:43], s82 offen lds
    s_add_u32 s96, s84, 5
    s_and_b32 s97, s96, 15
    s_mul_i32 s98, s97, 393216
    s_add_u32 s99, s98, s85
    s_add_u32 s82, s99, 4096
    s_add_u32 m0, s83, 90112
    s_nop 0
    buffer_load_dwordx4 v3, s[40:43], s82 offen lds
    s_add_u32 s96, s84, 5
    s_and_b32 s97, s96, 15
    s_mul_i32 s98, s97, 393216
    s_add_u32 s99, s98, s85
    s_add_u32 s82, s99, 4294770688
    s_add_u32 m0, s83, 135168
    s_nop 0
    buffer_load_dwordx4 v3, s[40:43], s82 offen lds
    s_add_u32 s96, s84, 5
    s_and_b32 s97, s96, 15
    s_mul_i32 s98, s97, 393216
    s_add_u32 s82, s98, s85
    s_add_u32 m0, s83, 139264
    s_nop 0
    buffer_load_dwordx4 v3, s[40:43], s82 offen lds
    v_bfe_u32 v4, v1, 2, 2
    v_lshlrev_b32 v4, 6, v4
    v_bfe_u32 v9, v1, 4, 1
    v_lshl_add_u32 v4, v9, 5, v4
    v_and_b32 v9, 3, v1
    v_lshl_add_u32 v4, v9, 3, v4
    v_lshrrev_b32 v9, 5, v1
    v_lshl_add_u32 v4, v9, 8, v4
    v_add_u32 v4, 159744, v4
    ds_read_b64_tr_b16 v[168:169], v4
    ds_read_b64_tr_b16 v[170:171], v4 offset:512
    ds_read_b64_tr_b16 v[172:173], v4 offset:1024
    ds_read_b64_tr_b16 v[174:175], v4 offset:1536
    ds_read_b64_tr_b16 v[176:177], v4 offset:2048
    ds_read_b64_tr_b16 v[178:179], v4 offset:2560
    ds_read_b64_tr_b16 v[180:181], v4 offset:3072
    ds_read_b64_tr_b16 v[182:183], v4 offset:3584
    s_lshl_b32 s14, s77, 10
    v_and_b32 v232, 7, v1
    v_lshl_add_u32 v232, v232, 4, s14
    v_bfe_u32 v9, v1, 3, 2
    v_lshl_add_u32 v232, v9, 8, v232
    v_lshrrev_b32 v9, 5, v1
    v_lshl_add_u32 v232, v9, 7, v232
    s_and_b32 s96, s9, 1
    s_lshl1_add_u32 s18, s96, 1
    s_and_b32 s96, s8, 3
    s_lshl2_add_u32 s97, s96, s3
    s_sub_u32 s98, s97, 4
    s_lshl_b32 s82, s98, 7
    v_lshrrev_b32 v136, 3, v1
    v_lshl_add_u32 v136, v136, 1, s82
    global_load_ushort v120, v136, s[86:87] offset:0
    global_load_ushort v121, v136, s[86:87] offset:16
    global_load_ushort v122, v136, s[86:87] offset:32
    global_load_ushort v123, v136, s[86:87] offset:48
    global_load_ushort v124, v136, s[86:87] offset:64
    global_load_ushort v125, v136, s[86:87] offset:80
    global_load_ushort v126, v136, s[86:87] offset:96
    global_load_ushort v127, v136, s[86:87] offset:112
    s_and_b32 s96, s8, 3
    s_lshl2_add_u32 s97, s96, s3
    s_sub_u32 s98, s97, 4
    s_mul_i32 s99, s98, 786432
    s_lshr_b32 s96, s8, 2
    s_lshl1_add_u32 s97, s9, s96
    s_lshl_b32 s98, s97, 7
    s_add_u32 s96, s99, s98
    s_add_u32 s19, s96, 4096
    s_barrier
    s_add_u32 s96, s84, 6
    s_and_b32 s97, s96, 15
    s_mul_i32 s98, s97, 393216
    s_add_u32 s99, s98, s85
    s_add_u32 s82, s99, 4294772736
    s_add_u32 m0, s83, 4294963200
    s_nop 0
    buffer_load_dwordx4 v3, s[40:43], s82 offen lds
    s_add_u32 s96, s84, 6
    s_and_b32 s97, s96, 15
    s_mul_i32 s98, s97, 393216
    s_add_u32 s99, s98, s85
    s_add_u32 s82, s99, 2048
    s_mov_b32 m0, s83
    s_nop 0
    buffer_load_dwordx4 v3, s[40:43], s82 offen lds
    s_add_u32 s96, s84, 6
    s_and_b32 s97, s96, 15
    s_mul_i32 s98, s97, 393216
    s_add_u32 s99, s98, s85
    s_add_u32 s82, s99, 4294770688
    s_add_u32 m0, s83, 94208
    s_nop 0
    buffer_load_dwordx4 v3, s[40:43], s82 offen lds
    s_add_u32 s96, s84, 6
    s_and_b32 s97, s96, 15
    s_mul_i32 s98, s97, 393216
    s_add_u32 s82, s98, s85
    s_add_u32 m0, s83, 98304
    s_nop 0
    buffer_load_dwordx4 v3, s[40:43], s82 offen lds
    s_add_u32 s96, s84, 6
    s_and_b32 s97, s96, 15
    s_mul_i32 s98, s97, 393216
    s_add_u32 s99, s98, s85
    s_add_u32 s82, s99, 4294774784
    s_add_u32 m0, s83, 45056
    s_nop 0
    buffer_load_dwordx4 v3, s[40:43], s82 offen lds
    s_add_u32 s96, s84, 6
    s_and_b32 s97, s96, 15
    s_mul_i32 s98, s97, 393216
    s_add_u32 s99, s98, s85
    s_add_u32 s82, s99, 4096
    s_add_u32 m0, s83, 49152
    s_nop 0
    buffer_load_dwordx4 v3, s[40:43], s82 offen lds
    s_cmp_lg_u32 s18, 1
    s_cbranch_scc1 L_NM2_1_0
    s_mov_b32 s82, s19
    buffer_load_dwordx4 v[88:91], v248, s[48:51], s82 offen nt
    s_add_u32 s82, s19, 98304
    buffer_load_dwordx4 v[92:95], v248, s[48:51], s82 offen nt
    s_add_u32 s82, s19, 196608
    buffer_load_dwordx4 v[96:99], v248, s[48:51], s82 offen nt
    s_add_u32 s82, s19, 294912
    buffer_load_dwordx4 v[100:103], v248, s[48:51], s82 offen nt
    s_add_u32 s82, s19, 393216
    buffer_load_dwordx4 v[104:107], v248, s[48:51], s82 offen nt
    s_add_u32 s82, s19, 491520
    buffer_load_dwordx4 v[108:111], v248, s[48:51], s82 offen nt
    s_add_u32 s82, s19, 589824
    buffer_load_dwordx4 v[112:115], v248, s[48:51], s82 offen nt
    s_add_u32 s82, s19, 688128
    buffer_load_dwordx4 v[116:119], v248, s[48:51], s82 offen nt
L_NM2_1_0:
    s_waitcnt lgkmcnt(0)
    s_load_dword s24, s[32:33], s92 offset:512 glc
    s_load_dword s25, s[32:33], s92 offset:256 glc
    s_load_dword s26, s[32:33], s92 offset:3584 glc
    s_load_dword s27, s[32:33], s92 offset:3328 glc
    s_barrier
    s_add_u32 s96, s84, 7
    s_and_b32 s97, s96, 15
    s_mul_i32 s98, s97, 393216
    s_add_u32 s99, s98, s85
    s_add_u32 s82, s99, 4294772736
    s_add_u32 m0, s83, 4096
    s_nop 0
    buffer_load_dwordx4 v3, s[40:43], s82 offen lds
    s_add_u32 s96, s84, 7
    s_and_b32 s97, s96, 15
    s_mul_i32 s98, s97, 393216
    s_add_u32 s99, s98, s85
    s_add_u32 s82, s99, 2048
    s_add_u32 m0, s83, 8192
    s_nop 0
    buffer_load_dwordx4 v3, s[40:43], s82 offen lds
    s_add_u32 s96, s84, 7
    s_and_b32 s97, s96, 15
    s_mul_i32 s98, s97, 393216
    s_add_u32 s99, s98, s85
    s_add_u32 s82, s99, 4294770688
    s_add_u32 m0, s83, 102400
    s_nop 0
    buffer_load_dwordx4 v3, s[40:43], s82 offen lds
    s_add_u32 s96, s84, 7
    s_and_b32 s97, s96, 15
    s_mul_i32 s98, s97, 393216
    s_add_u32 s82, s98, s85
    s_add_u32 m0, s83, 106496
    s_nop 0
    buffer_load_dwordx4 v3, s[40:43], s82 offen lds
    s_add_u32 s96, s84, 7
    s_and_b32 s97, s96, 15
    s_mul_i32 s98, s97, 393216
    s_add_u32 s99, s98, s85
    s_add_u32 s82, s99, 4294774784
    s_add_u32 m0, s83, 53248
    s_nop 0
    buffer_load_dwordx4 v3, s[40:43], s82 offen lds
    s_add_u32 s96, s84, 7
    s_and_b32 s97, s96, 15
    s_mul_i32 s98, s97, 393216
    s_add_u32 s99, s98, s85
    s_add_u32 s82, s99, 4096
    s_add_u32 m0, s83, 57344
    s_nop 0
    buffer_load_dwordx4 v3, s[40:43], s82 offen lds
    s_cmp_lg_u32 s18, 2
    s_cbranch_scc1 L_NM2_2_0
    s_mov_b32 s82, s19
    buffer_load_dwordx4 v[88:91], v248, s[48:51], s82 offen nt
    s_add_u32 s82, s19, 98304
    buffer_load_dwordx4 v[92:95], v248, s[48:51], s82 offen nt
    s_add_u32 s82, s19, 196608
    buffer_load_dwordx4 v[96:99], v248, s[48:51], s82 offen nt
    s_add_u32 s82, s19, 294912
    buffer_load_dwordx4 v[100:103], v248, s[48:51], s82 offen nt
    s_add_u32 s82, s19, 393216
    buffer_load_dwordx4 v[104:107], v248, s[48:51], s82 offen nt
    s_add_u32 s82, s19, 491520
    buffer_load_dwordx4 v[108:111], v248, s[48:51], s82 offen nt
    s_add_u32 s82, s19, 589824
    buffer_load_dwordx4 v[112:115], v248, s[48:51], s82 offen nt
    s_add_u32 s82, s19, 688128
    buffer_load_dwordx4 v[116:119], v248, s[48:51], s82 offen nt
L_NM2_2_0:
    s_waitcnt vmcnt(26)
    s_barrier
    s_add_u32 s96, s84, 8
    s_and_b32 s97, s96, 15
    s_mul_i32 s98, s97, 393216
    s_add_u32 s99, s98, s85
    s_add_u32 s82, s99, 4294772736
    s_add_u32 m0, s83, 12288
    s_nop 0
    buffer_load_dwordx4 v3, s[40:43], s82 offen lds
    s_add_u32 s96, s84, 8
    s_and_b32 s97, s96, 15
    s_mul_i32 s98, s97, 393216
    s_add_u32 s99, s98, s85
    s_add_u32 s82, s99, 2048
    s_add_u32 m0, s83, 16384
    s_nop 0
    buffer_load_dwordx4 v3, s[40:43], s82 offen lds
    s_add_u32 s96, s84, 8
    s_and_b32 s97, s96, 15
    s_mul_i32 s98, s97, 393216
    s_add_u32 s99, s98, s85
    s_add_u32 s82, s99, 4294770688
    s_add_u32 m0, s83, 110592
    s_nop 0
    buffer_load_dwordx4 v3, s[40:43], s82 offen lds
    s_add_u32 s96, s84, 8
    s_and_b32 s97, s96, 15
    s_mul_i32 s98, s97, 393216
    s_add_u32 s82, s98, s85
    s_add_u32 m0, s83, 114688
    s_nop 0
    buffer_load_dwordx4 v3, s[40:43], s82 offen lds
    s_add_u32 s96, s84, 8
    s_and_b32 s97, s96, 15
    s_mul_i32 s98, s97, 393216
    s_add_u32 s99, s98, s85
    s_add_u32 s82, s99, 4294774784
    s_add_u32 m0, s83, 61440
    s_nop 0
    buffer_load_dwordx4 v3, s[40:43], s82 offen lds
    s_add_u32 s96, s84, 8
    s_and_b32 s97, s96, 15
    s_mul_i32 s98, s97, 393216
    s_add_u32 s99, s98, s85
    s_add_u32 s82, s99, 4096
    s_add_u32 m0, s83, 65536
    s_nop 0
    buffer_load_dwordx4 v3, s[40:43], s82 offen lds
    s_cmp_lg_u32 s18, 3
    s_cbranch_scc1 L_NM2_3_0
    s_mov_b32 s82, s19
    buffer_load_dwordx4 v[88:91], v248, s[48:51], s82 offen nt
    s_add_u32 s82, s19, 98304
    buffer_load_dwordx4 v[92:95], v248, s[48:51], s82 offen nt
    s_add_u32 s82, s19, 196608
    buffer_load_dwordx4 v[96:99], v248, s[48:51], s82 offen nt
    s_add_u32 s82, s19, 294912
    buffer_load_dwordx4 v[100:103], v248, s[48:51], s82 offen nt
    s_add_u32 s82, s19, 393216
    buffer_load_dwordx4 v[104:107], v248, s[48:51], s82 offen nt
    s_add_u32 s82, s19, 491520
    buffer_load_dwordx4 v[108:111], v248, s[48:51], s82 offen nt
    s_add_u32 s82, s19, 589824
    buffer_load_dwordx4 v[112:115], v248, s[48:51], s82 offen nt
    s_add_u32 s82, s19, 688128
    buffer_load_dwordx4 v[116:119], v248, s[48:51], s82 offen nt
L_NM2_3_0:
    s_waitcnt vmcnt(18)
    v_lshlrev_b32 v120, 16, v120
    v_mul_f32 v136, s7, v120
    v_exp_f32 v136, -v136
    s_nop 0
    v_add_f32 v136, 1.0, v136
    v_rcp_f32 v136, v136
    s_nop 0
    v_mul_f32 v120, v120, v136
    v_cvt_pk_bf16_f32 v120, 0, v120
    v_lshlrev_b32 v121, 16, v121
    v_mul_f32 v137, s7, v121
    v_exp_f32 v137, -v137
    s_nop 0
    v_add_f32 v137, 1.0, v137
    v_rcp_f32 v137, v137
    s_nop 0
    v_mul_f32 v121, v121, v137
    v_cvt_pk_bf16_f32 v121, 0, v121
    v_lshlrev_b32 v122, 16, v122
    v_mul_f32 v136, s7, v122
    v_exp_f32 v136, -v136
    s_nop 0
    v_add_f32 v136, 1.0, v136
    v_rcp_f32 v136, v136
    s_nop 0
    v_mul_f32 v122, v122, v136
    v_cvt_pk_bf16_f32 v122, 0, v122
    v_lshlrev_b32 v123, 16, v123
    v_mul_f32 v137, s7, v123
    v_exp_f32 v137, -v137
    s_nop 0
    v_add_f32 v137, 1.0, v137
    v_rcp_f32 v137, v137
    s_nop 0
    v_mul_f32 v123, v123, v137
    v_cvt_pk_bf16_f32 v123, 0, v123
    v_lshlrev_b32 v124, 16, v124
    v_mul_f32 v136, s7, v124
    v_exp_f32 v136, -v136
    s_nop 0
    v_add_f32 v136, 1.0, v136
    v_rcp_f32 v136, v136
    s_nop 0
    v_mul_f32 v124, v124, v136
    v_cvt_pk_bf16_f32 v124, 0, v124
    v_lshlrev_b32 v125, 16, v125
    v_mul_f32 v137, s7, v125
    v_exp_f32 v137, -v137
    s_nop 0
    v_add_f32 v137, 1.0, v137
    v_rcp_f32 v137, v137
    s_nop 0
    v_mul_f32 v125, v125, v137
    v_cvt_pk_bf16_f32 v125, 0, v125
    v_lshlrev_b32 v126, 16, v126
    v_mul_f32 v136, s7, v126
    v_exp_f32 v136, -v136
    s_nop 0
    v_add_f32 v136, 1.0, v136
    v_rcp_f32 v136, v136
    s_nop 0
    v_mul_f32 v126, v126, v136
    v_cvt_pk_bf16_f32 v126, 0, v126
    v_lshlrev_b32 v127, 16, v127
    v_mul_f32 v137, s7, v127
    v_exp_f32 v137, -v137
    s_nop 0
    v_add_f32 v137, 1.0, v137
    v_rcp_f32 v137, v137
    s_nop 0
    v_mul_f32 v127, v127, v137
    v_cvt_pk_bf16_f32 v127, 0, v127
    s_waitcnt lgkmcnt(0)
    s_load_dword s24, s[32:33], s92 offset:1024 glc
    s_load_dword s25, s[32:33], s92 offset:768 glc
    s_load_dword s26, s[32:33], s92 offset:1536 glc
    s_load_dword s27, s[32:33], s92 offset:1280 glc
    s_barrier
    s_add_u32 s96, s84, 9
    s_and_b32 s97, s96, 15
    s_mul_i32 s98, s97, 393216
    s_add_u32 s99, s98, s85
    s_add_u32 s82, s99, 4294772736
    s_add_u32 m0, s83, 20480
    s_nop 0
    buffer_load_dwordx4 v3, s[40:43], s82 offen lds
    s_add_u32 s96, s84, 9
    s_and_b32 s97, s96, 15
    s_mul_i32 s98, s97, 393216
    s_add_u32 s99, s98, s85
    s_add_u32 s82, s99, 2048
    s_add_u32 m0, s83, 24576
    s_nop 0
    buffer_load_dwordx4 v3, s[40:43], s82 offen lds
    s_add_u32 s96, s84, 9
    s_and_b32 s97, s96, 15
    s_mul_i32 s98, s97, 393216
    s_add_u32 s99, s98, s85
    s_add_u32 s82, s99, 4294770688
    s_add_u32 m0, s83, 118784
    s_nop 0
    buffer_load_dwordx4 v3, s[40:43], s82 offen lds
    s_add_u32 s96, s84, 9
    s_and_b32 s97, s96, 15
    s_mul_i32 s98, s97, 393216
    s_add_u32 s82, s98, s85
    s_add_u32 m0, s83, 122880
L_PAD5:
    s_cbranch_execz L_RET5
    s_nop 0
    buffer_load_dwordx4 v3, s[40:43], s82 offen lds
    s_add_u32 s96, s84, 9
    s_and_b32 s97, s96, 15
    s_mul_i32 s98, s97, 393216
    s_add_u32 s99, s98, s85
    s_add_u32 s82, s99, 4294774784
    s_add_u32 m0, s83, 69632
    s_nop 0
    buffer_load_dwordx4 v3, s[40:43], s82 offen lds
    s_add_u32 s96, s84, 9
    s_and_b32 s97, s96, 15
    s_mul_i32 s98, s97, 393216
    s_add_u32 s99, s98, s85
    s_add_u32 s82, s99, 4096
    s_add_u32 m0, s83, 73728
    s_nop 0
    buffer_load_dwordx4 v3, s[40:43], s82 offen lds
    s_waitcnt vmcnt(22)
    s_waitcnt vmcnt(20)
    s_waitcnt vmcnt(18)
    s_barrier
    s_add_u32 s96, s84, 10
    s_and_b32 s97, s96, 15
    s_mul_i32 s98, s97, 393216
    s_add_u32 s99, s98, s85
    s_add_u32 s82, s99, 4294772736
    s_add_u32 m0, s83, 28672
    s_nop 0
    buffer_load_dwordx4 v3, s[40:43], s82 offen lds
    s_add_u32 s96, s84, 10
    s_and_b32 s97, s96, 15
    s_mul_i32 s98, s97, 393216
    s_add_u32 s99, s98, s85
    s_add_u32 s82, s99, 2048
    s_add_u32 m0, s83, 32768
    s_nop 0
    buffer_load_dwordx4 v3, s[40:43], s82 offen lds
    s_add_u32 s96, s84, 10
    s_and_b32 s97, s96, 15
    s_mul_i32 s98, s97, 393216
    s_add_u32 s99, s98, s85
    s_add_u32 s82, s99, 4294774784
    s_add_u32 m0, s83, 77824
    s_nop 0
    buffer_load_dwordx4 v3, s[40:43], s82 offen lds
    s_add_u32 s96, s84, 10
    s_and_b32 s97, s96, 15
    s_mul_i32 s98, s97, 393216
    s_add_u32 s99, s98, s85
    s_add_u32 s82, s99, 4096
    s_add_u32 m0, s83, 81920
    s_nop 0
    buffer_load_dwordx4 v3, s[40:43], s82 offen lds
    s_waitcnt vmcnt(8)
    v_lshlrev_b32 v136, 16, v88
    v_and_b32 v137, s6, v88
    v_mul_f32 v128, v136, v120
    v_mul_f32 v129, v137, v120
    v_lshlrev_b32 v138, 16, v89
    v_and_b32 v139, s6, v89
    v_mul_f32 v130, v138, v120
    v_mul_f32 v131, v139, v120
    v_lshlrev_b32 v136, 16, v90
    v_and_b32 v137, s6, v90
    v_mul_f32 v132, v136, v120
    v_mul_f32 v133, v137, v120
    v_lshlrev_b32 v138, 16, v91
    v_and_b32 v139, s6, v91
    v_mul_f32 v134, v138, v120
    v_mul_f32 v135, v139, v120
    v_lshlrev_b32 v136, 16, v92
    v_and_b32 v137, s6, v92
    v_fmac_f32 v128, v136, v121
    v_fmac_f32 v129, v137, v121
    v_lshlrev_b32 v138, 16, v93
    v_and_b32 v139, s6, v93
    v_fmac_f32 v130, v138, v121
    v_fmac_f32 v131, v139, v121
    v_lshlrev_b32 v136, 16, v94
    v_and_b32 v137, s6, v94
    v_fmac_f32 v132, v136, v121
    v_fmac_f32 v133, v137, v121
    v_lshlrev_b32 v138, 16, v95
    v_and_b32 v139, s6, v95
    v_fmac_f32 v134, v138, v121
    v_fmac_f32 v135, v139, v121
    v_lshlrev_b32 v136, 16, v96
    v_and_b32 v137, s6, v96
    v_fmac_f32 v128, v136, v122
    v_fmac_f32 v129, v137, v122
    v_lshlrev_b32 v138, 16, v97
    v_and_b32 v139, s6, v97
    v_fmac_f32 v130, v138, v122
    v_fmac_f32 v131, v139, v122
    v_lshlrev_b32 v136, 16, v98
    v_and_b32 v137, s6, v98
    v_fmac_f32 v132, v136, v122
    v_fmac_f32 v133, v137, v122
    v_lshlrev_b32 v138, 16, v99
    v_and_b32 v139, s6, v99
    v_fmac_f32 v134, v138, v122
    v_fmac_f32 v135, v139, v122
    s_waitcnt lgkmcnt(0)
    s_load_dword s24, s[32:33], s92 offset:2560 glc
    s_load_dword s25, s[32:33], s92 offset:2304 glc
    s_load_dword s26, s[32:33], s92 offset:3072 glc
    s_load_dword s27, s[32:33], s92 offset:2816 glc
    s_barrier
    s_add_u32 s96, s84, 11
    s_and_b32 s97, s96, 15
    s_mul_i32 s98, s97, 393216
    s_add_u32 s99, s98, s85
    s_add_u32 s82, s99, 4294772736
    s_add_u32 m0, s83, 36864
    s_nop 0
    buffer_load_dwordx4 v3, s[40:43], s82 offen lds
    s_add_u32 s96, s84, 11
    s_and_b32 s97, s96, 15
    s_mul_i32 s98, s97, 393216
    s_add_u32 s99, s98, s85
    s_add_u32 s82, s99, 2048
    s_add_u32 m0, s83, 40960
    s_nop 0
    buffer_load_dwordx4 v3, s[40:43], s82 offen lds
    s_add_u32 s96, s84, 11
    s_and_b32 s97, s96, 15
    s_mul_i32 s98, s97, 393216
    s_add_u32 s99, s98, s85
    s_add_u32 s82, s99, 4294774784
    s_add_u32 m0, s83, 86016
    s_nop 0
    buffer_load_dwordx4 v3, s[40:43], s82 offen lds
    s_add_u32 s96, s84, 11
    s_and_b32 s97, s96, 15
    s_mul_i32 s98, s97, 393216
    s_add_u32 s99, s98, s85
    s_add_u32 s82, s99, 4096
    s_add_u32 m0, s83, 90112
    s_nop 0
    buffer_load_dwordx4 v3, s[40:43], s82 offen lds
    v_lshlrev_b32 v136, 16, v100
    v_and_b32 v137, s6, v100
    v_fmac_f32 v128, v136, v123
    v_fmac_f32 v129, v137, v123
    v_lshlrev_b32 v138, 16, v101
    v_and_b32 v139, s6, v101
    v_fmac_f32 v130, v138, v123
    v_fmac_f32 v131, v139, v123
    v_lshlrev_b32 v136, 16, v102
    v_and_b32 v137, s6, v102
    v_fmac_f32 v132, v136, v123
    v_fmac_f32 v133, v137, v123
    v_lshlrev_b32 v138, 16, v103
    v_and_b32 v139, s6, v103
    v_fmac_f32 v134, v138, v123
    v_fmac_f32 v135, v139, v123
    v_lshlrev_b32 v136, 16, v104
    v_and_b32 v137, s6, v104
    v_fmac_f32 v128, v136, v124
    v_fmac_f32 v129, v137, v124
    v_lshlrev_b32 v138, 16, v105
    v_and_b32 v139, s6, v105
    v_fmac_f32 v130, v138, v124
    v_fmac_f32 v131, v139, v124
    v_lshlrev_b32 v136, 16, v106
    v_and_b32 v137, s6, v106
    v_fmac_f32 v132, v136, v124
    v_fmac_f32 v133, v137, v124
    v_lshlrev_b32 v138, 16, v107
    v_and_b32 v139, s6, v107
    v_fmac_f32 v134, v138, v124
    v_fmac_f32 v135, v139, v124
    v_lshlrev_b32 v136, 16, v108
    v_and_b32 v137, s6, v108
    v_fmac_f32 v128, v136, v125
    v_fmac_f32 v129, v137, v125
    v_lshlrev_b32 v138, 16, v109
    v_and_b32 v139, s6, v109
    v_fmac_f32 v130, v138, v125
    v_fmac_f32 v131, v139, v125
    v_lshlrev_b32 v136, 16, v110
    v_and_b32 v137, s6, v110
    v_fmac_f32 v132, v136, v125
    v_fmac_f32 v133, v137, v125
    v_lshlrev_b32 v138, 16, v111
    v_and_b32 v139, s6, v111
    v_fmac_f32 v134, v138, v125
    v_fmac_f32 v135, v139, v125
    s_barrier
    s_add_u32 s96, s84, 12
    s_and_b32 s97, s96, 15
    s_mul_i32 s98, s97, 393216
    s_add_u32 s99, s98, s85
    s_add_u32 s82, s99, 4294772736
    s_add_u32 m0, s83, 4294963200
    s_nop 0
    buffer_load_dwordx4 v3, s[40:43], s82 offen lds
    s_add_u32 s96, s84, 12
    s_and_b32 s97, s96, 15
    s_mul_i32 s98, s97, 393216
    s_add_u32 s99, s98, s85
    s_add_u32 s82, s99, 2048
    s_mov_b32 m0, s83
    s_nop 0
    buffer_load_dwordx4 v3, s[40:43], s82 offen lds
    s_add_u32 s96, s84, 12
    s_and_b32 s97, s96, 15
    s_mul_i32 s98, s97, 393216
    s_add_u32 s99, s98, s85
    s_add_u32 s82, s99, 4294774784
    s_add_u32 m0, s83, 45056
    s_nop 0
    buffer_load_dwordx4 v3, s[40:43], s82 offen lds
    s_add_u32 s96, s84, 12
    s_and_b32 s97, s96, 15
    s_mul_i32 s98, s97, 393216
    s_add_u32 s99, s98, s85
    s_add_u32 s82, s99, 4096
    s_add_u32 m0, s83, 49152
    s_nop 0
    buffer_load_dwordx4 v3, s[40:43], s82 offen lds
    v_lshlrev_b32 v136, 16, v112
    v_and_b32 v137, s6, v112
    v_fmac_f32 v128, v136, v126
    v_fmac_f32 v129, v137, v126
    v_lshlrev_b32 v138, 16, v113
    v_and_b32 v139, s6, v113
    v_fmac_f32 v130, v138, v126
    v_fmac_f32 v131, v139, v126
    v_lshlrev_b32 v136, 16, v114
    v_and_b32 v137, s6, v114
    v_fmac_f32 v132, v136, v126
    v_fmac_f32 v133, v137, v126
    v_lshlrev_b32 v138, 16, v115
    v_and_b32 v139, s6, v115
    v_fmac_f32 v134, v138, v126
    v_fmac_f32 v135, v139, v126
    v_lshlrev_b32 v136, 16, v116
    v_and_b32 v137, s6, v116
    v_fmac_f32 v128, v136, v127
    v_fmac_f32 v129, v137, v127
    v_lshlrev_b32 v138, 16, v117
    v_and_b32 v139, s6, v117
    v_fmac_f32 v130, v138, v127
    v_fmac_f32 v131, v139, v127
    v_lshlrev_b32 v136, 16, v118
    v_and_b32 v137, s6, v118
    v_fmac_f32 v132, v136, v127
    v_fmac_f32 v133, v137, v127
    v_lshlrev_b32 v138, 16, v119
    v_and_b32 v139, s6, v119
    v_fmac_f32 v134, v138, v127
    v_fmac_f32 v135, v139, v127
    v_permlane32_swap_b32 v128, v132
    v_permlane32_swap_b32 v129, v133
    v_permlane32_swap_b32 v130, v134
    v_permlane32_swap_b32 v131, v135
    v_add_f32 v128, v128, v132
    v_add_f32 v129, v129, v133
    v_add_f32 v130, v130, v134
    v_add_f32 v131, v131, v135
    s_nop 0
    v_permlane16_swap_b32 v128, v130
    v_permlane16_swap_b32 v129, v131
    v_add_f32 v128, v128, v130
    v_add_f32 v129, v129, v131
    s_nop 0
    v_add_f32_dpp v128, v128, v128 row_ror:8 row_mask:0xf bank_mask:0xf
    v_add_f32_dpp v129, v129, v129 row_ror:8 row_mask:0xf bank_mask:0xf
    s_nop 1
    v_mov_b32_dpp v128, v129 quad_perm:[0,1,2,3] row_mask:0xf bank_mask:0xc
    ds_write_b32 v252, v128 offset:9984
    s_waitcnt lgkmcnt(0)
    s_barrier
    s_add_u32 s96, s84, 13
    s_and_b32 s97, s96, 15
    s_mul_i32 s98, s97, 393216
    s_add_u32 s99, s98, s85
    s_add_u32 s82, s99, 4294772736
    s_add_u32 m0, s83, 4096
    s_nop 0
    buffer_load_dwordx4 v3, s[40:43], s82 offen lds
    s_add_u32 s96, s84, 13
    s_and_b32 s97, s96, 15
    s_mul_i32 s98, s97, 393216
    s_add_u32 s99, s98, s85
    s_add_u32 s82, s99, 2048
    s_add_u32 m0, s83, 8192
    s_nop 0
    buffer_load_dwordx4 v3, s[40:43], s82 offen lds
    s_add_u32 s96, s84, 13
    s_and_b32 s97, s96, 15
    s_mul_i32 s98, s97, 393216
    s_add_u32 s99, s98, s85
    s_add_u32 s82, s99, 4294774784
    s_add_u32 m0, s83, 53248
    s_nop 0
    buffer_load_dwordx4 v3, s[40:43], s82 offen lds
    s_add_u32 s96, s84, 13
    s_and_b32 s97, s96, 15
    s_mul_i32 s98, s97, 393216
    s_add_u32 s99, s98, s85
    s_add_u32 s82, s99, 4096
    s_add_u32 m0, s83, 57344
    s_nop 0
    buffer_load_dwordx4 v3, s[40:43], s82 offen lds
    s_cmp_lg_u32 s3, 4
    s_cbranch_scc1 L_M2F
    ds_read_b128 v[128:131], v251 offset:10000
    s_lshr_b32 s96, s8, 2
    s_lshl1_add_u32 s97, s9, s96
    s_and_b32 s98, s8, 3
    s_lshl2_add_u32 s99, s97, s98
    s_lshl_b32 s96, s99, 9
    s_add_u32 s13, s96, 131072
    s_waitcnt lgkmcnt(0)
    v_add_f32 v128, v128, v129
    v_add_f32 v130, v130, v131
    v_mov_b32 v129, s4
    v_add_f32 v128, v128, v130
    buffer_store_dwordx2 v[128:129], v250, s[32:35], s13 offen sc1
L_M2F:
    s_lshl_b32 s96, s74, 13
    s_sub_u32 s97, s3, 4
    s_lshl_b32 s98, s97, 8
    s_add_u32 s99, s96, s98
    s_add_u32 s13, s99, 20971520
    s_waitcnt lgkmcnt(0)
    s_load_dword s24, s[32:33], s13 offset:1276 glc
    s_load_dword s25, s[32:33], s13 offset:3324 glc
    s_load_dword s26, s[32:33], s13 offset:5372 glc
    s_load_dword s27, s[32:33], s13 offset:7420 glc
    s_waitcnt vmcnt(18)
    s_waitcnt vmcnt(16)
    s_barrier
    s_add_u32 s96, s84, 14
    s_and_b32 s97, s96, 15
    s_mul_i32 s98, s97, 393216
    s_add_u32 s99, s98, s85
    s_add_u32 s82, s99, 4294772736
    s_add_u32 m0, s83, 12288
    s_nop 0
    buffer_load_dwordx4 v3, s[40:43], s82 offen lds
    s_add_u32 s96, s84, 14
    s_and_b32 s97, s96, 15
    s_mul_i32 s98, s97, 393216
    s_add_u32 s99, s98, s85
    s_add_u32 s82, s99, 2048
    s_add_u32 m0, s83, 16384
    s_nop 0
    buffer_load_dwordx4 v3, s[40:43], s82 offen lds
    s_waitcnt vmcnt(16)
    s_waitcnt vmcnt(12)
    s_barrier
    s_add_u32 s96, s84, 15
    s_and_b32 s97, s96, 15
    s_mul_i32 s98, s97, 393216
    s_add_u32 s99, s98, s85
    s_add_u32 s82, s99, 4294772736
    s_add_u32 m0, s83, 20480
    s_nop 0
    buffer_load_dwordx4 v3, s[40:43], s82 offen lds
    s_add_u32 s96, s84, 15
    s_and_b32 s97, s96, 15
    s_mul_i32 s98, s97, 393216
    s_add_u32 s99, s98, s85
    s_add_u32 s82, s99, 2048
    s_add_u32 m0, s83, 24576
    s_nop 0
    buffer_load_dwordx4 v3, s[40:43], s82 offen lds
    s_waitcnt vmcnt(10)
    s_waitcnt vmcnt(6)
    s_waitcnt vmcnt(2)
    s_barrier
    s_add_u32 s96, s84, 14
    s_and_b32 s97, s96, 15
    s_mul_i32 s98, s97, 393216
    s_add_u32 s99, s98, s85
    s_add_u32 s82, s99, 4294774784
    s_add_u32 m0, s83, 61440
    s_nop 0
    buffer_load_dwordx4 v3, s[40:43], s82 offen lds
    s_add_u32 s96, s84, 14
    s_and_b32 s97, s96, 15
    s_mul_i32 s98, s97, 393216
    s_add_u32 s99, s98, s85
    s_add_u32 s82, s99, 4096
    s_add_u32 m0, s83, 65536
    s_nop 0
    buffer_load_dwordx4 v3, s[40:43], s82 offen lds
    s_add_u32 s96, s84, 15
    s_and_b32 s97, s96, 15
    s_mul_i32 s98, s97, 393216
    s_add_u32 s99, s98, s85
    s_add_u32 s82, s99, 4294774784
    s_add_u32 m0, s83, 69632
    s_nop 0
    buffer_load_dwordx4 v3, s[40:43], s82 offen lds
    s_add_u32 s96, s84, 15
    s_and_b32 s97, s96, 15
    s_mul_i32 s98, s97, 393216
    s_add_u32 s99, s98, s85
    s_add_u32 s82, s99, 4096
    s_add_u32 m0, s83, 73728
    s_nop 0
    buffer_load_dwordx4 v3, s[40:43], s82 offen lds
    s_waitcnt vmcnt(4)
    s_barrier
    s_add_u32 s96, s84, 10
    s_and_b32 s97, s96, 15
    s_mul_i32 s98, s97, 393216
    s_add_u32 s99, s98, s85
    s_add_u32 s82, s99, 4294770688
    s_add_u32 m0, s83, 126976
    s_nop 0
    buffer_load_dwordx4 v3, s[40:43], s82 offen lds
    s_add_u32 s96, s84, 10
    s_and_b32 s97, s96, 15
    s_mul_i32 s98, s97, 393216
    s_add_u32 s82, s98, s85
    s_add_u32 m0, s83, 131072
    s_nop 0
    buffer_load_dwordx4 v3, s[40:43], s82 offen lds
    s_add_u32 s96, s84, 11
    s_and_b32 s97, s96, 15
    s_mul_i32 s98, s97, 393216
    s_add_u32 s99, s98, s85
    s_add_u32 s82, s99, 4294770688
    s_add_u32 m0, s83, 135168
    s_nop 0
    buffer_load_dwordx4 v3, s[40:43], s82 offen lds
    s_add_u32 s96, s84, 11
    s_and_b32 s97, s96, 15
    s_mul_i32 s98, s97, 393216
    s_add_u32 s82, s98, s85
    s_add_u32 m0, s83, 139264
    s_nop 0
    buffer_load_dwordx4 v3, s[40:43], s82 offen lds
    s_waitcnt lgkmcnt(0)
    s_barrier
    s_add_u32 s96, s84, 12
    s_and_b32 s97, s96, 15
    s_mul_i32 s98, s97, 393216
    s_add_u32 s99, s98, s85
    s_add_u32 s82, s99, 4294770688
    s_add_u32 m0, s83, 94208
    s_nop 0
    buffer_load_dwordx4 v3, s[40:43], s82 offen lds
    s_add_u32 s96, s84, 12
    s_and_b32 s97, s96, 15
    s_mul_i32 s98, s97, 393216
    s_add_u32 s82, s98, s85
    s_add_u32 m0, s83, 98304
    s_nop 0
    buffer_load_dwordx4 v3, s[40:43], s82 offen lds
    s_add_u32 s96, s84, 13
    s_and_b32 s97, s96, 15
    s_mul_i32 s98, s97, 393216
    s_add_u32 s99, s98, s85
    s_add_u32 s82, s99, 4294770688
    s_add_u32 m0, s83, 102400
    s_nop 0
    buffer_load_dwordx4 v3, s[40:43], s82 offen lds
    s_add_u32 s96, s84, 13
    s_and_b32 s97, s96, 15
    s_mul_i32 s98, s97, 393216
    s_add_u32 s82, s98, s85
    s_add_u32 m0, s83, 106496
    s_nop 0
    buffer_load_dwordx4 v3, s[40:43], s82 offen lds
    s_setprio 3
    ds_read_b128 v[152:155], v0
    ds_read_b128 v[156:159], v0 offset:1024
    v_subrev_u32 v0, 118784, v0
    s_waitcnt lgkmcnt(1)
    v_mfma_f32_32x32x16_bf16 v[184:199], v[168:171], v[152:155], 0
    s_waitcnt lgkmcnt(0)
    v_mfma_f32_32x32x16_bf16 v[184:199], v[172:175], v[156:159], v[184:199]
    s_setprio 0
    s_nop 10
    v_cvt_pk_bf16_f32 v184, 0, v184
    v_cvt_pk_bf16_f32 v185, 0, v185
    v_cvt_pk_bf16_f32 v186, 0, v186
    v_cvt_pk_bf16_f32 v187, 0, v187
    v_cvt_pk_bf16_f32 v188, 0, v188
    v_cvt_pk_bf16_f32 v189, 0, v189
    v_cvt_pk_bf16_f32 v190, 0, v190
    v_cvt_pk_bf16_f32 v191, 0, v191
    v_cvt_pk_bf16_f32 v192, 0, v192
    v_cvt_pk_bf16_f32 v193, 0, v193
    v_cvt_pk_bf16_f32 v194, 0, v194
    v_cvt_pk_bf16_f32 v195, 0, v195
    v_cvt_pk_bf16_f32 v196, 0, v196
    v_cvt_pk_bf16_f32 v197, 0, v197
    v_cvt_pk_bf16_f32 v198, 0, v198
    v_cvt_pk_bf16_f32 v199, 0, v199
    v_max3_f32 v4, v184, v185, v186
    v_min3_f32 v5, v184, v185, v186
    v_max3_f32 v4, v4, v187, v188
    v_min3_f32 v5, v5, v187, v188
    v_max3_f32 v4, v4, v189, v190
    v_min3_f32 v5, v5, v189, v190
    v_max3_f32 v4, v4, v191, v192
    v_min3_f32 v5, v5, v191, v192
    v_max3_f32 v4, v4, v193, v194
    v_min3_f32 v5, v5, v193, v194
    v_max3_f32 v4, v4, v195, v196
    v_min3_f32 v5, v5, v195, v196
    v_max3_f32 v4, v4, v197, v198
    v_min3_f32 v5, v5, v197, v198
    v_max_f32 v6, v4, v199
    v_min_f32 v7, v5, v199
    v_max_f32 v4, v4, v199
    v_min_f32 v5, v5, v199
    s_nop 0
    v_permlane32_swap_b32 v4, v6
    v_permlane32_swap_b32 v5, v7
    v_max_f32 v4, v4, v6
    v_min_f32 v5, v5, v7
    v_mul_f32_e64 v4, v4, s7
    v_mul_f32_e64 v5, v5, s7
    v_fma_f32 v216, v184, s7, -v4
    v_fma_f32 v217, v185, s7, -v4
    v_fma_f32 v184, -v184, s7, v5
    v_fma_f32 v185, -v185, s7, v5
    v_fma_f32 v218, v186, s7, -v4
    v_fma_f32 v219, v187, s7, -v4
    v_fma_f32 v186, -v186, s7, v5
    v_fma_f32 v187, -v187, s7, v5
    s_waitcnt vmcnt(10)
    s_waitcnt vmcnt(8)
    s_waitcnt vmcnt(6)
    s_barrier
    s_add_u32 s96, s84, 14
    s_and_b32 s97, s96, 15
    s_mul_i32 s98, s97, 393216
    s_add_u32 s99, s98, s85
    s_add_u32 s82, s99, 4294770688
    s_add_u32 m0, s83, 110592
    s_nop 0
    buffer_load_dwordx4 v3, s[40:43], s82 offen lds
    s_add_u32 s96, s84, 14
    s_and_b32 s97, s96, 15
    s_mul_i32 s98, s97, 393216
    s_add_u32 s82, s98, s85
    s_add_u32 m0, s83, 114688
    s_nop 0
    buffer_load_dwordx4 v3, s[40:43], s82 offen lds
    s_add_u32 s96, s84, 15
    s_and_b32 s97, s96, 15
    s_mul_i32 s98, s97, 393216
    s_add_u32 s99, s98, s85
    s_add_u32 s82, s99, 4294770688
    s_add_u32 m0, s83, 118784
    s_nop 0
    buffer_load_dwordx4 v3, s[40:43], s82 offen lds
    s_add_u32 s96, s84, 15
    s_and_b32 s97, s96, 15
    s_mul_i32 s98, s97, 393216
    s_add_u32 s82, s98, s85
    s_add_u32 m0, s83, 122880
    s_nop 0
    buffer_load_dwordx4 v3, s[40:43], s82 offen lds
    s_setprio 3
    ds_read_b128 v[152:155], v0
    ds_read_b128 v[156:159], v0 offset:1024
    s_waitcnt lgkmcnt(1)
    v_mfma_f32_32x32x16_bf16 v[200:215], v[176:179], v[152:155], 0
    s_waitcnt lgkmcnt(0)
    v_mfma_f32_32x32x16_bf16 v[200:215], v[180:183], v[156:159], v[200:215]
    s_setprio 0
    v_fma_f32 v220, v188, s7, -v4
    v_fma_f32 v221, v189, s7, -v4
    v_fma_f32 v188, -v188, s7, v5
    v_fma_f32 v189, -v189, s7, v5
    v_fma_f32 v222, v190, s7, -v4
    s_mov_b32 s82, s80
    buffer_load_dwordx4 v[56:59], v27, s[52:55], s82 offen nt
    v_fma_f32 v223, v191, s7, -v4
    v_fma_f32 v190, -v190, s7, v5
    v_fma_f32 v191, -v191, s7, v5
    v_fma_f32 v224, v192, s7, -v4
    v_fma_f32 v225, v193, s7, -v4
    v_fma_f32 v192, -v192, s7, v5
    v_fma_f32 v193, -v193, s7, v5
    v_fma_f32 v226, v194, s7, -v4
    v_fma_f32 v227, v195, s7, -v4
    v_fma_f32 v194, -v194, s7, v5
    v_fma_f32 v195, -v195, s7, v5
    v_fma_f32 v228, v196, s7, -v4
    v_fma_f32 v229, v197, s7, -v4
    v_fma_f32 v196, -v196, s7, v5
    v_fma_f32 v197, -v197, s7, v5
    v_fma_f32 v230, v198, s7, -v4
    v_fma_f32 v231, v199, s7, -v4
    v_fma_f32 v198, -v198, s7, v5
    v_fma_f32 v199, -v199, s7, v5
    v_exp_f32 v216, v216
    s_add_u32 s82, s80, 4294049792
    buffer_load_dwordx4 v[60:63], v27, s[52:55], s82 offen nt
    v_exp_f32 v184, v184
    v_exp_f32 v217, v217
    v_exp_f32 v185, v185
    v_exp_f32 v218, v218
    v_exp_f32 v186, v186
    v_exp_f32 v219, v219
    v_exp_f32 v187, v187
    v_exp_f32 v220, v220
    v_exp_f32 v188, v188
    v_exp_f32 v221, v221
    v_exp_f32 v189, v189
    v_exp_f32 v222, v222
    v_exp_f32 v190, v190
    v_exp_f32 v223, v223
    v_exp_f32 v191, v191
    v_exp_f32 v224, v224
    v_exp_f32 v192, v192
    v_exp_f32 v225, v225
    v_exp_f32 v193, v193
    v_exp_f32 v226, v226
    s_add_u32 s82, s80, 57344
    buffer_load_dwordx4 v[64:67], v27, s[52:55], s82 offen nt
    v_exp_f32 v194, v194
    v_exp_f32 v227, v227
    v_exp_f32 v195, v195
    v_exp_f32 v228, v228
    v_exp_f32 v196, v196
    v_exp_f32 v229, v229
    v_exp_f32 v197, v197
    v_exp_f32 v230, v230
    v_exp_f32 v198, v198
    v_exp_f32 v231, v231
    v_exp_f32 v199, v199
    v_add_f32 v8, v216, v218
    v_add_f32 v9, v217, v219
    v_add_f32 v10, v184, v186
    v_add_f32 v11, v185, v187
    v_add_f32 v8, v8, v220
    v_add_f32 v9, v9, v221
    v_add_f32 v10, v10, v188
    v_add_f32 v11, v11, v189
    v_add_f32 v8, v8, v222
    s_add_u32 s82, s80, 4294107136
    buffer_load_dwordx4 v[68:71], v27, s[52:55], s82 offen nt
    v_add_f32 v9, v9, v223
    v_add_f32 v10, v10, v190
    v_add_f32 v11, v11, v191
    v_add_f32 v8, v8, v224
    v_add_f32 v9, v9, v225
    v_add_f32 v10, v10, v192
    v_add_f32 v11, v11, v193
    v_add_f32 v8, v8, v226
    v_add_f32 v9, v9, v227
    v_add_f32 v10, v10, v194
    v_add_f32 v11, v11, v195
    v_add_f32 v8, v8, v228
    v_add_f32 v9, v9, v229
    v_add_f32 v10, v10, v196
    v_add_f32 v11, v11, v197
    v_add_f32 v8, v8, v230
    v_add_f32 v9, v9, v231
    v_add_f32 v10, v10, v198
    v_add_f32 v11, v11, v199
    v_add_f32 v6, v8, v9
    s_add_u32 s82, s80, 114688
    buffer_load_dwordx4 v[72:75], v27, s[52:55], s82 offen nt
    v_add_f32 v7, v10, v11
    v_add_f32 v4, v8, v9
    v_add_f32 v5, v10, v11
    s_nop 0
    v_permlane32_swap_b32 v4, v6
    v_permlane32_swap_b32 v5, v7
    v_add_f32 v4, v4, v6
    v_add_f32 v5, v5, v7
    v_rcp_f32 v4, v4
    v_rcp_f32 v5, v5
    v_mul_f32 v216, v216, v4
    v_mul_f32 v217, v217, v4
    v_mul_f32 v184, v184, v5
    v_mul_f32 v185, v185, v5
    v_mul_f32 v218, v218, v4
    v_mul_f32 v219, v219, v4
    v_mul_f32 v186, v186, v5
    v_mul_f32 v187, v187, v5
    v_mul_f32 v220, v220, v4
    v_mul_f32 v221, v221, v4
    v_mul_f32 v188, v188, v5
    s_add_u32 s82, s80, 4294164480
    buffer_load_dwordx4 v[76:79], v27, s[52:55], s82 offen nt
    v_mul_f32 v189, v189, v5
    v_mul_f32 v222, v222, v4
    v_mul_f32 v223, v223, v4
    v_mul_f32 v190, v190, v5
    v_mul_f32 v191, v191, v5
    v_mul_f32 v224, v224, v4
    v_mul_f32 v225, v225, v4
    v_mul_f32 v192, v192, v5
    v_mul_f32 v193, v193, v5
    v_mul_f32 v226, v226, v4
    v_mul_f32 v227, v227, v4
    v_mul_f32 v194, v194, v5
    v_mul_f32 v195, v195, v5
    v_mul_f32 v228, v228, v4
    v_mul_f32 v229, v229, v4
    v_mul_f32 v196, v196, v5
    v_mul_f32 v197, v197, v5
    v_mul_f32 v230, v230, v4
    v_mul_f32 v231, v231, v4
    v_mul_f32 v198, v198, v5
    s_add_u32 s82, s80, 172032
    buffer_load_dwordx4 v[80:83], v27, s[52:55], s82 offen nt
    v_mul_f32 v199, v199, v5
    v_cvt_pk_bf16_f32 v216, v216, v217
    v_cvt_pk_bf16_f32 v217, v218, v219
    v_cvt_pk_bf16_f32 v218, v220, v221
    v_cvt_pk_bf16_f32 v219, v222, v223
    v_cvt_pk_bf16_f32 v220, v224, v225
    v_cvt_pk_bf16_f32 v221, v226, v227
    v_cvt_pk_bf16_f32 v222, v228, v229
    v_cvt_pk_bf16_f32 v223, v230, v231
    ds_write_b128 v232, v[216:219]
    v_cvt_pk_bf16_f32 v224, v184, v185
    v_cvt_pk_bf16_f32 v225, v186, v187
    v_cvt_pk_bf16_f32 v226, v188, v189
    v_cvt_pk_bf16_f32 v227, v190, v191
    ds_write_b128 v232, v[220:223] offset:4096
    ds_write_b128 v232, v[224:227] offset:8192
    v_cvt_pk_bf16_f32 v228, v192, v193
    v_cvt_pk_bf16_f32 v229, v194, v195
    v_cvt_pk_bf16_f32 v230, v196, v197
    v_cvt_pk_bf16_f32 v231, v198, v199
    s_add_u32 s82, s80, 4294221824
    buffer_load_dwordx4 v[84:87], v27, s[52:55], s82 offen nt
    ds_write_b128 v232, v[228:231] offset:12288
    s_waitcnt vmcnt(16)
    s_waitcnt vmcnt(14)
    s_waitcnt vmcnt(12)
    s_waitcnt vmcnt(10)
    s_waitcnt vmcnt(8)
    s_barrier
    v_cvt_pk_bf16_f32 v200, 0, v200
    v_cvt_pk_bf16_f32 v201, 0, v201
    v_cvt_pk_bf16_f32 v202, 0, v202
    v_cvt_pk_bf16_f32 v203, 0, v203
    s_xor_b32 s96, s95, 786432
    s_add_u32 s97, s96, s90
    s_sub_u32 s82, s97, 65536
L_PAD6:
    s_cbranch_execz L_RET6
    s_add_u32 m0, s83, 45056
    s_nop 0
    buffer_load_dwordx4 v26, s[44:47], s82 offen lds
    v_cvt_pk_bf16_f32 v204, 0, v204
    v_cvt_pk_bf16_f32 v205, 0, v205
    v_cvt_pk_bf16_f32 v206, 0, v206
    v_cvt_pk_bf16_f32 v207, 0, v207
    v_cvt_pk_bf16_f32 v208, 0, v208
    v_cvt_pk_bf16_f32 v209, 0, v209
    v_cvt_pk_bf16_f32 v210, 0, v210
    v_cvt_pk_bf16_f32 v211, 0, v211
    v_cvt_pk_bf16_f32 v212, 0, v212
    v_cvt_pk_bf16_f32 v213, 0, v213
    v_cvt_pk_bf16_f32 v214, 0, v214
    v_cvt_pk_bf16_f32 v215, 0, v215
    v_max3_f32 v4, v200, v201, v202
    v_min3_f32 v5, v200, v201, v202
    s_xor_b32 s96, s95, 786432
    s_add_u32 s82, s96, s90
    s_add_u32 m0, s83, 49152
    s_nop 0
    buffer_load_dwordx4 v26, s[44:47], s82 offen lds
    v_max3_f32 v4, v4, v203, v204
    v_min3_f32 v5, v5, v203, v204
    v_max3_f32 v4, v4, v205, v206
    v_min3_f32 v5, v5, v205, v206
    v_max3_f32 v4, v4, v207, v208
    v_min3_f32 v5, v5, v207, v208
    v_max3_f32 v4, v4, v209, v210
    v_min3_f32 v5, v5, v209, v210
    v_max3_f32 v4, v4, v211, v212
    v_min3_f32 v5, v5, v211, v212
    v_max3_f32 v4, v4, v213, v214
    v_min3_f32 v5, v5, v213, v214
    v_max_f32 v6, v4, v215
    v_min_f32 v7, v5, v215
    s_xor_b32 s96, s95, 917504
    s_add_u32 s97, s96, s90
    s_sub_u32 s82, s97, 65536
    s_add_u32 m0, s83, 53248
    s_nop 0
    buffer_load_dwordx4 v26, s[44:47], s82 offen lds
    v_max_f32 v4, v4, v215
    s_waitcnt lgkmcnt(0)
    v_min_f32 v5, v5, v215
    v_permlane32_swap_b32 v4, v6
    s_nop 0
    v_permlane32_swap_b32 v5, v7
    v_max_f32 v4, v4, v6
    v_min_f32 v5, v5, v7
    v_mul_f32_e64 v4, v4, s7
    v_mul_f32_e64 v5, v5, s7
    v_fma_f32 v216, v200, s7, -v4
    v_fma_f32 v217, v201, s7, -v4
    v_fma_f32 v200, -v200, s7, v5
    v_fma_f32 v201, -v201, s7, v5
    v_fma_f32 v218, v202, s7, -v4
    s_xor_b32 s96, s95, 917504
    s_add_u32 s82, s96, s90
    s_add_u32 m0, s83, 57344
    s_nop 0
    buffer_load_dwordx4 v26, s[44:47], s82 offen lds
    v_fma_f32 v219, v203, s7, -v4
    v_fma_f32 v202, -v202, s7, v5
    v_fma_f32 v203, -v203, s7, v5
    v_fma_f32 v220, v204, s7, -v4
    v_fma_f32 v221, v205, s7, -v4
    v_fma_f32 v204, -v204, s7, v5
    v_fma_f32 v205, -v205, s7, v5
    v_fma_f32 v222, v206, s7, -v4
    v_fma_f32 v223, v207, s7, -v4
    v_fma_f32 v206, -v206, s7, v5
    v_fma_f32 v207, -v207, s7, v5
    v_fma_f32 v224, v208, s7, -v4
    v_fma_f32 v225, v209, s7, -v4
    v_fma_f32 v208, -v208, s7, v5
    s_xor_b32 s96, s95, 1048576
    s_add_u32 s97, s96, s90
    s_sub_u32 s82, s97, 65536
    s_add_u32 m0, s83, 61440
    s_nop 0
    buffer_load_dwordx4 v26, s[44:47], s82 offen lds
    v_fma_f32 v209, -v209, s7, v5
    v_fma_f32 v226, v210, s7, -v4
    v_fma_f32 v227, v211, s7, -v4
    v_fma_f32 v210, -v210, s7, v5
    v_fma_f32 v211, -v211, s7, v5
    v_fma_f32 v228, v212, s7, -v4
    v_fma_f32 v229, v213, s7, -v4
    v_fma_f32 v212, -v212, s7, v5
    v_fma_f32 v213, -v213, s7, v5
    v_fma_f32 v230, v214, s7, -v4
    v_fma_f32 v231, v215, s7, -v4
    v_fma_f32 v214, -v214, s7, v5
    v_fma_f32 v215, -v215, s7, v5
    v_exp_f32 v216, v216
    s_xor_b32 s96, s95, 1048576
    s_add_u32 s82, s96, s90
    s_add_u32 m0, s83, 65536
    s_nop 0
    buffer_load_dwordx4 v26, s[44:47], s82 offen lds
    v_exp_f32 v200, v200
    v_exp_f32 v217, v217
    v_exp_f32 v201, v201
    v_exp_f32 v218, v218
    v_exp_f32 v202, v202
    v_exp_f32 v219, v219
    v_exp_f32 v203, v203
    v_exp_f32 v220, v220
    v_exp_f32 v204, v204
    v_exp_f32 v221, v221
    v_exp_f32 v205, v205
    v_exp_f32 v222, v222
    v_exp_f32 v206, v206
    v_exp_f32 v223, v223
    s_xor_b32 s96, s95, 1179648
    s_add_u32 s97, s96, s90
    s_sub_u32 s82, s97, 65536
    s_add_u32 m0, s83, 69632
    s_nop 0
    buffer_load_dwordx4 v26, s[44:47], s82 offen lds
    v_exp_f32 v207, v207
    v_exp_f32 v224, v224
    v_exp_f32 v208, v208
    v_exp_f32 v225, v225
    v_exp_f32 v209, v209
    v_exp_f32 v226, v226
    v_exp_f32 v210, v210
    v_exp_f32 v227, v227
    v_exp_f32 v211, v211
    v_exp_f32 v228, v228
    v_exp_f32 v212, v212
    v_exp_f32 v229, v229
    v_exp_f32 v213, v213
    v_exp_f32 v230, v230
    s_xor_b32 s96, s95, 1179648
    s_add_u32 s82, s96, s90
    s_add_u32 m0, s83, 73728
    s_nop 0
    buffer_load_dwordx4 v26, s[44:47], s82 offen lds
    v_exp_f32 v214, v214
    v_exp_f32 v231, v231
    v_exp_f32 v215, v215
    v_add_f32 v8, v216, v218
    v_add_f32 v9, v217, v219
    v_add_f32 v10, v200, v202
    v_add_f32 v11, v201, v203
    v_add_f32 v8, v8, v220
    v_add_f32 v9, v9, v221
    v_add_f32 v10, v10, v204
    v_add_f32 v11, v11, v205
    v_add_f32 v8, v8, v222
    v_add_f32 v9, v9, v223
    v_add_f32 v10, v10, v206
    s_xor_b32 s96, s95, 1310720
    s_add_u32 s97, s96, s90
    s_sub_u32 s82, s97, 65536
    s_add_u32 m0, s83, 77824
    s_nop 0
    buffer_load_dwordx4 v26, s[44:47], s82 offen lds
    v_add_f32 v11, v11, v207
    v_add_f32 v8, v8, v224
    v_add_f32 v9, v9, v225
    v_add_f32 v10, v10, v208
    v_add_f32 v11, v11, v209
    v_add_f32 v8, v8, v226
    v_add_f32 v9, v9, v227
    v_add_f32 v10, v10, v210
    v_add_f32 v11, v11, v211
    v_add_f32 v8, v8, v228
    v_add_f32 v9, v9, v229
    v_add_f32 v10, v10, v212
    v_add_f32 v11, v11, v213
    v_add_f32 v8, v8, v230
    s_xor_b32 s96, s95, 1310720
    s_add_u32 s82, s96, s90
    s_add_u32 m0, s83, 81920
    s_nop 0
    buffer_load_dwordx4 v26, s[44:47], s82 offen lds
    v_add_f32 v9, v9, v231
    v_add_f32 v10, v10, v214
    v_add_f32 v11, v11, v215
    v_add_f32 v6, v8, v9
    v_add_f32 v7, v10, v11
    v_add_f32 v4, v8, v9
    v_add_f32 v5, v10, v11
    s_nop 0
    v_permlane32_swap_b32 v4, v6
    v_permlane32_swap_b32 v5, v7
    v_add_f32 v4, v4, v6
    v_add_f32 v5, v5, v7
    v_rcp_f32 v4, v4
    v_rcp_f32 v5, v5
    v_mul_f32 v216, v216, v4
    s_xor_b32 s96, s95, 1441792
    s_add_u32 s97, s96, s90
    s_sub_u32 s82, s97, 65536
    s_add_u32 m0, s83, 86016
    s_nop 0
    buffer_load_dwordx4 v26, s[44:47], s82 offen lds
    v_mul_f32 v217, v217, v4
    v_mul_f32 v200, v200, v5
    v_mul_f32 v201, v201, v5
    v_mul_f32 v218, v218, v4
    v_mul_f32 v219, v219, v4
    v_mul_f32 v202, v202, v5
    v_mul_f32 v203, v203, v5
    v_mul_f32 v220, v220, v4
    v_mul_f32 v221, v221, v4
    v_mul_f32 v204, v204, v5
    v_mul_f32 v205, v205, v5
    v_mul_f32 v222, v222, v4
    v_mul_f32 v223, v223, v4
    v_mul_f32 v206, v206, v5
    s_xor_b32 s96, s95, 1441792
    s_add_u32 s82, s96, s90
    s_add_u32 m0, s83, 90112
    s_nop 0
    buffer_load_dwordx4 v26, s[44:47], s82 offen lds
    v_mul_f32 v207, v207, v5
    v_mul_f32 v224, v224, v4
    v_mul_f32 v225, v225, v4
    v_mul_f32 v208, v208, v5
    v_mul_f32 v209, v209, v5
    v_mul_f32 v226, v226, v4
    v_mul_f32 v227, v227, v4
    v_mul_f32 v210, v210, v5
    v_mul_f32 v211, v211, v5
    v_mul_f32 v228, v228, v4
    v_mul_f32 v229, v229, v4
    v_mul_f32 v212, v212, v5
    v_mul_f32 v213, v213, v5
    v_mul_f32 v230, v230, v4
    v_mul_f32 v231, v231, v4
    v_mul_f32 v214, v214, v5
    v_mul_f32 v215, v215, v5
    v_cvt_pk_bf16_f32 v216, v216, v217
    v_cvt_pk_bf16_f32 v217, v218, v219
    v_cvt_pk_bf16_f32 v218, v220, v221
    v_cvt_pk_bf16_f32 v219, v222, v223
    v_cvt_pk_bf16_f32 v220, v224, v225
    v_cvt_pk_bf16_f32 v221, v226, v227
    v_cvt_pk_bf16_f32 v222, v228, v229
    v_cvt_pk_bf16_f32 v223, v230, v231
    ds_write_b128 v232, v[216:219] offset:16384
    v_cvt_pk_bf16_f32 v224, v200, v201
    v_cvt_pk_bf16_f32 v225, v202, v203
    v_cvt_pk_bf16_f32 v226, v204, v205
    v_cvt_pk_bf16_f32 v227, v206, v207
    ds_write_b128 v232, v[220:223] offset:20480
    ds_write_b128 v232, v[224:227] offset:24576
    v_cvt_pk_bf16_f32 v228, v208, v209
    v_cvt_pk_bf16_f32 v229, v210, v211
    v_cvt_pk_bf16_f32 v230, v212, v213
    v_cvt_pk_bf16_f32 v231, v214, v215
    ds_write_b128 v232, v[228:231] offset:28672
    s_lshl_b32 s96, s77, 11
    s_add_u32 s14, s96, 151552
    v_add_u32 v0, s14, v2
    s_setprio 0
L_JOIN:
    v_and_b32 v45, 1, v1
    v_lshlrev_b32 v45, 3, v45
    v_bfe_u32 v9, v1, 2, 2
    v_lshl_add_u32 v45, v9, 4, v45
    v_bfe_u32 v9, v1, 4, 1
    v_lshl_add_u32 v45, v9, 6, v45
    v_bfe_u32 v9, v1, 1, 1
    v_lshl_add_u32 v45, v9, 7, v45
    v_lshrrev_b32 v9, 5, v1
    v_lshl_add_u32 v45, v9, 8, v45
    s_lshl_b32 s13, s3, 12
    v_add_u32 v44, s13, v45
    s_lshl_b32 s96, s76, 13
    s_add_u32 s13, s96, 32768
    v_add_u32 v45, s13, v45
    v_mov_b32 v244, 0x3f803f80
    v_mov_b32 v245, 0x3f803f80
    v_mov_b32 v246, 0x3f803f80
    v_mov_b32 v247, 0x3f803f80
    s_lshl3_add_u32 s96, s11, s3
    s_lshl_b32 s97, s96, 5
    s_add_u32 s98, s97, s10
    s_lshl_b32 s99, s98, 10
    s_add_u32 s13, s99, 25165824
    s_add_u32 s15, s13, 16384
    s_lshl3_add_u32 s96, s11, s3
    s_lshl_b32 s97, s96, 10
    s_add_u32 s16, s97, 21495808
    s_lshl_b32 s96, s10, 6
    s_add_u32 s14, s96, s16
    s_waitcnt lgkmcnt(0)
    s_barrier
    ds_read_b64_tr_b16 v[184:185], v44
    ds_read_b64_tr_b16 v[186:187], v44 offset:512
    ds_read_b64_tr_b16 v[200:201], v45
    ds_read_b64_tr_b16 v[202:203], v45 offset:512
    ds_read_b64_tr_b16 v[204:205], v45 offset:1024
    ds_read_b64_tr_b16 v[206:207], v45 offset:1536
    ds_read_b64_tr_b16 v[188:189], v44 offset:1024
    ds_read_b64_tr_b16 v[190:191], v44 offset:1536
    ds_read_b64_tr_b16 v[208:209], v45 offset:2048
    ds_read_b64_tr_b16 v[210:211], v45 offset:2560
    ds_read_b64_tr_b16 v[212:213], v45 offset:3072
    ds_read_b64_tr_b16 v[214:215], v45 offset:3584
    ds_read_b64_tr_b16 v[192:193], v44 offset:2048
    ds_read_b64_tr_b16 v[194:195], v44 offset:2560
    ds_read_b64_tr_b16 v[216:217], v45 offset:4096
    ds_read_b64_tr_b16 v[218:219], v45 offset:4608
    ds_read_b64_tr_b16 v[220:221], v45 offset:5120
    ds_read_b64_tr_b16 v[222:223], v45 offset:5632
    s_waitcnt lgkmcnt(12)
    v_mfma_f32_16x16x32_bf16 v[232:235], v[184:187], v[200:203], 0
    v_mfma_f32_16x16x32_bf16 v[236:239], v[184:187], v[204:207], 0
    v_mfma_f32_16x16x32_bf16 v[240:243], v[184:187], v[244:247], 0
    ds_read_b64_tr_b16 v[196:197], v44 offset:3072
    ds_read_b64_tr_b16 v[198:199], v44 offset:3584
    ds_read_b64_tr_b16 v[224:225], v45 offset:6144
    ds_read_b64_tr_b16 v[226:227], v45 offset:6656
    ds_read_b64_tr_b16 v[228:229], v45 offset:7168
    ds_read_b64_tr_b16 v[230:231], v45 offset:7680
    s_waitcnt lgkmcnt(12)
    v_mfma_f32_16x16x32_bf16 v[232:235], v[188:191], v[208:211], v[232:235]
    v_mfma_f32_16x16x32_bf16 v[236:239], v[188:191], v[212:215], v[236:239]
    v_mfma_f32_16x16x32_bf16 v[240:243], v[188:191], v[244:247], v[240:243]
    s_waitcnt lgkmcnt(6)
    v_mfma_f32_16x16x32_bf16 v[232:235], v[192:195], v[216:219], v[232:235]
    v_mfma_f32_16x16x32_bf16 v[236:239], v[192:195], v[220:223], v[236:239]
    v_mfma_f32_16x16x32_bf16 v[240:243], v[192:195], v[244:247], v[240:243]
    s_waitcnt lgkmcnt(0)
    v_mfma_f32_16x16x32_bf16 v[232:235], v[196:199], v[224:227], v[232:235]
    v_mfma_f32_16x16x32_bf16 v[236:239], v[196:199], v[228:231], v[236:239]
    v_mfma_f32_16x16x32_bf16 v[240:243], v[196:199], v[244:247], v[240:243]
    s_cmp_lt_u32 s3, 4
    s_cbranch_scc1 L_NOQX
    ds_read_b128 v[168:171], v0
    ds_read_b128 v[172:175], v0 offset:1024
L_NOQX:
    s_nop 3
    buffer_store_dwordx4 v[232:235], v2, s[32:35], s13 offen sc1
    buffer_store_dwordx4 v[236:239], v2, s[32:35], s15 offen sc1
    s_mov_b32 exec_lo, 0x00010001
    s_mov_b32 exec_hi, 0x00010001
    buffer_store_dwordx4 v[240:243], v1, s[32:35], s14 offen sc1
    s_mov_b64 exec, -1
    s_waitcnt lgkmcnt(0)
    v_mfma_f32_32x32x16_bf16 v[120:135], v[176:179], v[168:171], 0
    v_mfma_f32_32x32x16_bf16 v[120:135], v[180:183], v[172:175], v[120:135]
    v_and_b32 v46, 7, v1
    v_lshlrev_b32 v46, 17, v46
    v_bfe_u32 v9, v1, 3, 1
    v_lshl_add_u32 v46, v9, 14, v46
    s_and_b32 s96, s10, 1
    s_and_b32 s97, s2, 27
    s_lshl_b32 s98, s97, 12
    s_lshr_b32 s99, s10, 1
    s_lshl_b32 s97, s99, 6
    s_add_u32 s99, s98, s97
    s_lshl2_add_u32 s98, s96, s99
    s_add_u32 s97, s98, 1048576
    s_add_u32 s17, s97, 512
    v_lshrrev_b32 v47, 3, v1
    v_lshlrev_b32 v47, 10, v47
    v_and_b32 v9, 7, v1
    v_lshl_add_u32 v47, v9, 4, v47
    v_and_b32 v48, 7, v1
    v_lshlrev_b32 v48, 4, v48
    v_lshrrev_b32 v9, 5, v1
    v_lshl_add_u32 v48, v9, 3, v48
    v_cvt_pk_bf16_f32 v120, 0, v120
    v_cvt_pk_bf16_f32 v121, 0, v121
    v_cvt_pk_bf16_f32 v122, 0, v122
    v_cvt_pk_bf16_f32 v123, 0, v123
    v_cvt_pk_bf16_f32 v124, 0, v124
    v_cvt_pk_bf16_f32 v125, 0, v125
    v_cvt_pk_bf16_f32 v126, 0, v126
    v_cvt_pk_bf16_f32 v127, 0, v127
    v_cvt_pk_bf16_f32 v128, 0, v128
    v_cvt_pk_bf16_f32 v129, 0, v129
    v_cvt_pk_bf16_f32 v130, 0, v130
    v_cvt_pk_bf16_f32 v131, 0, v131
    v_cvt_pk_bf16_f32 v132, 0, v132
    v_cvt_pk_bf16_f32 v133, 0, v133
    v_cvt_pk_bf16_f32 v134, 0, v134
    v_cvt_pk_bf16_f32 v135, 0, v135
    v_max3_f32 v4, v120, v121, v122
    v_min3_f32 v5, v120, v121, v122
    v_max3_f32 v4, v4, v123, v124
    v_min3_f32 v5, v5, v123, v124
    v_max3_f32 v4, v4, v125, v126
    v_min3_f32 v5, v5, v125, v126
    v_max3_f32 v4, v4, v127, v128
    v_min3_f32 v5, v5, v127, v128
    v_max3_f32 v4, v4, v129, v130
    v_min3_f32 v5, v5, v129, v130
    v_max3_f32 v4, v4, v131, v132
    v_min3_f32 v5, v5, v131, v132
    v_max3_f32 v4, v4, v133, v134
    v_min3_f32 v5, v5, v133, v134
    v_max_f32 v6, v4, v135
    v_min_f32 v7, v5, v135
    v_max_f32 v4, v4, v135
    v_min_f32 v5, v5, v135
    s_nop 0
    v_permlane32_swap_b32 v4, v6
    v_permlane32_swap_b32 v5, v7
    v_max_f32 v4, v4, v6
    v_min_f32 v5, v5, v7
    v_pk_mul_f32 v[4:5], v[4:5], s[6:7] op_sel:[0,1]
    v_pk_fma_f32 v[136:137], v[120:121], s[6:7], v[4:5] op_sel:[0,1,0] op_sel_hi:[1,1,0] neg_lo:[0,0,1] neg_hi:[0,0,1]
    v_pk_fma_f32 v[120:121], v[120:121], s[6:7], v[4:5] op_sel:[0,1,1] neg_lo:[1,0,0] neg_hi:[1,0,0]
    v_pk_fma_f32 v[138:139], v[122:123], s[6:7], v[4:5] op_sel:[0,1,0] op_sel_hi:[1,1,0] neg_lo:[0,0,1] neg_hi:[0,0,1]
    v_pk_fma_f32 v[122:123], v[122:123], s[6:7], v[4:5] op_sel:[0,1,1] neg_lo:[1,0,0] neg_hi:[1,0,0]
    v_pk_fma_f32 v[140:141], v[124:125], s[6:7], v[4:5] op_sel:[0,1,0] op_sel_hi:[1,1,0] neg_lo:[0,0,1] neg_hi:[0,0,1]
    v_pk_fma_f32 v[124:125], v[124:125], s[6:7], v[4:5] op_sel:[0,1,1] neg_lo:[1,0,0] neg_hi:[1,0,0]
    v_pk_fma_f32 v[142:143], v[126:127], s[6:7], v[4:5] op_sel:[0,1,0] op_sel_hi:[1,1,0] neg_lo:[0,0,1] neg_hi:[0,0,1]
    v_pk_fma_f32 v[126:127], v[126:127], s[6:7], v[4:5] op_sel:[0,1,1] neg_lo:[1,0,0] neg_hi:[1,0,0]
    v_pk_fma_f32 v[144:145], v[128:129], s[6:7], v[4:5] op_sel:[0,1,0] op_sel_hi:[1,1,0] neg_lo:[0,0,1] neg_hi:[0,0,1]
    v_pk_fma_f32 v[128:129], v[128:129], s[6:7], v[4:5] op_sel:[0,1,1] neg_lo:[1,0,0] neg_hi:[1,0,0]
    v_pk_fma_f32 v[146:147], v[130:131], s[6:7], v[4:5] op_sel:[0,1,0] op_sel_hi:[1,1,0] neg_lo:[0,0,1] neg_hi:[0,0,1]
    v_pk_fma_f32 v[130:131], v[130:131], s[6:7], v[4:5] op_sel:[0,1,1] neg_lo:[1,0,0] neg_hi:[1,0,0]
    v_pk_fma_f32 v[148:149], v[132:133], s[6:7], v[4:5] op_sel:[0,1,0] op_sel_hi:[1,1,0] neg_lo:[0,0,1] neg_hi:[0,0,1]
    v_pk_fma_f32 v[132:133], v[132:133], s[6:7], v[4:5] op_sel:[0,1,1] neg_lo:[1,0,0] neg_hi:[1,0,0]
    v_pk_fma_f32 v[150:151], v[134:135], s[6:7], v[4:5] op_sel:[0,1,0] op_sel_hi:[1,1,0] neg_lo:[0,0,1] neg_hi:[0,0,1]
    v_pk_fma_f32 v[134:135], v[134:135], s[6:7], v[4:5] op_sel:[0,1,1] neg_lo:[1,0,0] neg_hi:[1,0,0]
    v_exp_f32 v136, v136
    v_exp_f32 v120, v120
    v_exp_f32 v137, v137
    v_exp_f32 v121, v121
    v_exp_f32 v138, v138
    v_exp_f32 v122, v122
    v_exp_f32 v139, v139
    v_exp_f32 v123, v123
    v_exp_f32 v140, v140
    v_exp_f32 v124, v124
    v_exp_f32 v141, v141
    v_exp_f32 v125, v125
    v_exp_f32 v142, v142
    v_exp_f32 v126, v126
    v_exp_f32 v143, v143
    v_exp_f32 v127, v127
    s_waitcnt vmcnt(0)
    s_barrier
    s_cmp_lg_u32 s3, 0
    s_cbranch_scc1 L_PC
    v_mov_b32 v45, s4
    s_mov_b32 exec_hi, 0
    s_mov_b32 exec_lo, 65535
    buffer_store_dword v45, v46, s[32:35], s17 offen sc1
    s_mov_b64 exec, -1
L_PC:
    s_xor_b32 s96, s95, 1572864
    s_add_u32 s82, s96, s90
    s_add_u32 m0, s83, 98304
    s_nop 0
    buffer_load_dwordx4 v26, s[44:47], s82 offen lds
    v_exp_f32 v144, v144
    v_exp_f32 v128, v128
    v_exp_f32 v145, v145
    v_exp_f32 v129, v129
    v_exp_f32 v146, v146
    v_exp_f32 v130, v130
    v_exp_f32 v147, v147
    v_exp_f32 v131, v131
    s_xor_b32 s96, s95, 1703936
    s_add_u32 s82, s96, s90
    s_add_u32 m0, s83, 106496
    s_nop 0
    buffer_load_dwordx4 v26, s[44:47], s82 offen lds
    v_exp_f32 v148, v148
    v_exp_f32 v132, v132
    v_exp_f32 v149, v149
    v_exp_f32 v133, v133
    v_exp_f32 v150, v150
    v_exp_f32 v134, v134
    v_exp_f32 v151, v151
    v_exp_f32 v135, v135
    s_lshl4_add_u32 s96, s11, s10
    s_lshl_b32 s97, s96, 14
    s_lshl_b32 s98, s3, 7
    s_add_u32 s99, s97, s98
    s_add_u32 s13, s99, 25165824
    s_add_u32 s14, s13, 8192
    s_lshl4_add_u32 s96, s11, s10
    s_lshl_b32 s97, s96, 10
    s_lshl_b32 s98, s3, 7
    s_add_u32 s99, s97, s98
    s_add_u32 s15, s99, 29360128
    s_add_u32 s17, s17, 3072
    s_load_dwordx2 s[24:25], s[32:33], s92 offset:512 glc
    s_xor_b32 s96, s95, 1835008
    s_add_u32 s82, s96, s90
    s_add_u32 m0, s83, 114688
    s_nop 0
    buffer_load_dwordx4 v26, s[44:47], s82 offen lds
    v_pk_add_f32 v[8:9], v[136:137], v[138:139]
    v_pk_add_f32 v[10:11], v[120:121], v[122:123]
    v_pk_add_f32 v[8:9], v[8:9], v[140:141]
    v_pk_add_f32 v[10:11], v[10:11], v[124:125]
    v_pk_add_f32 v[8:9], v[8:9], v[142:143]
    v_pk_add_f32 v[10:11], v[10:11], v[126:127]
    v_pk_add_f32 v[8:9], v[8:9], v[144:145]
    v_pk_add_f32 v[10:11], v[10:11], v[128:129]
    v_pk_add_f32 v[8:9], v[8:9], v[146:147]
    v_pk_add_f32 v[10:11], v[10:11], v[130:131]
    v_pk_add_f32 v[8:9], v[8:9], v[148:149]
    v_pk_add_f32 v[10:11], v[10:11], v[132:133]
    v_pk_add_f32 v[8:9], v[8:9], v[150:151]
    v_pk_add_f32 v[10:11], v[10:11], v[134:135]
    s_xor_b32 s96, s95, 1966080
    s_add_u32 s82, s96, s90
    s_add_u32 m0, s83, 122880
    s_nop 0
    buffer_load_dwordx4 v26, s[44:47], s82 offen lds
    v_add_f32 v6, v8, v9
    v_add_f32 v7, v10, v11
    v_add_f32 v4, v8, v9
    v_add_f32 v5, v10, v11
    s_nop 0
    v_permlane32_swap_b32 v4, v6
    v_permlane32_swap_b32 v5, v7
    v_pk_add_f32 v[4:5], v[4:5], v[6:7]
    v_rcp_f32 v4, v4
    v_rcp_f32 v5, v5
    s_nop 0
    v_pk_mul_f32 v[136:137], v[136:137], v[4:5] op_sel_hi:[1,0]
    v_pk_mul_f32 v[120:121], v[120:121], v[4:5] op_sel:[0,1]
    v_pk_mul_f32 v[138:139], v[138:139], v[4:5] op_sel_hi:[1,0]
    v_pk_mul_f32 v[122:123], v[122:123], v[4:5] op_sel:[0,1]
    v_pk_mul_f32 v[140:141], v[140:141], v[4:5] op_sel_hi:[1,0]
    s_add_u32 s82, s95, s90
    s_mov_b32 m0, s83
    s_nop 0
    buffer_load_dwordx4 v26, s[44:47], s82 offen lds
    v_pk_mul_f32 v[124:125], v[124:125], v[4:5] op_sel:[0,1]
    v_pk_mul_f32 v[142:143], v[142:143], v[4:5] op_sel_hi:[1,0]
    v_pk_mul_f32 v[126:127], v[126:127], v[4:5] op_sel:[0,1]
    v_pk_mul_f32 v[144:145], v[144:145], v[4:5] op_sel_hi:[1,0]
    v_pk_mul_f32 v[128:129], v[128:129], v[4:5] op_sel:[0,1]
    v_pk_mul_f32 v[146:147], v[146:147], v[4:5] op_sel_hi:[1,0]
    v_pk_mul_f32 v[130:131], v[130:131], v[4:5] op_sel:[0,1]
    v_pk_mul_f32 v[148:149], v[148:149], v[4:5] op_sel_hi:[1,0]
    v_pk_mul_f32 v[132:133], v[132:133], v[4:5] op_sel:[0,1]
    v_pk_mul_f32 v[150:151], v[150:151], v[4:5] op_sel_hi:[1,0]
    v_pk_mul_f32 v[134:135], v[134:135], v[4:5] op_sel:[0,1]
    v_cvt_pk_bf16_f32 v152, v136, v137
    v_cvt_pk_bf16_f32 v153, v138, v139
    v_cvt_pk_bf16_f32 v154, v140, v141
    s_xor_b32 s96, s95, 131072
    s_add_u32 s82, s96, s90
    s_add_u32 m0, s83, 8192
    s_nop 0
    buffer_load_dwordx4 v26, s[44:47], s82 offen lds
    v_cvt_pk_bf16_f32 v155, v142, v143
    v_cvt_pk_bf16_f32 v156, v144, v145
    v_cvt_pk_bf16_f32 v157, v146, v147
    v_cvt_pk_bf16_f32 v158, v148, v149
    v_cvt_pk_bf16_f32 v159, v150, v151
    v_cvt_pk_bf16_f32 v160, v120, v121
    v_cvt_pk_bf16_f32 v161, v122, v123
    v_cvt_pk_bf16_f32 v162, v124, v125
    v_cvt_pk_bf16_f32 v163, v126, v127
    v_cvt_pk_bf16_f32 v164, v128, v129
    v_cvt_pk_bf16_f32 v165, v130, v131
    v_cvt_pk_bf16_f32 v166, v132, v133
    v_cvt_pk_bf16_f32 v167, v134, v135
    s_branch SCHK_17
SPOLL_16:
    s_load_dwordx2 s[24:25], s[32:33], s92 offset:512 glc
SCHK_17:
    s_add_u32 s5, s5, 1
    s_cmp_ge_u32 s5, 200000
    s_waitcnt lgkmcnt(0)
    s_cbranch_scc1 SDONE_18
    s_cmp_lg_u32 s24, s4
    s_cbranch_scc1 SPOLL_16
    s_cmp_lg_u32 s25, s4
    s_cbranch_scc1 SPOLL_16
SDONE_18:
    s_barrier
    buffer_load_dwordx4 v[184:187], v47, s[32:35], s13 offen sc1
    buffer_load_dwordx4 v[188:191], v47, s[32:35], s14 offen sc1
    buffer_load_dwordx4 v[192:195], v2, s[32:35], s16 offen sc1
    s_lshl_b32 s96, s3, 5
    s_add_u32 s14, s96, 155648
    v_and_b32 v6, 3, v1
    v_lshl_add_u32 v6, v6, 3, s14
    v_lshrrev_b32 v9, 5, v1
    v_lshl_add_u32 v6, v9, 2, v6
    s_lshl_b32 s96, s3, 10
    s_add_u32 s14, s96, 147456
    v_and_b32 v5, 15, v1
    v_lshl_add_u32 v5, v5, 4, s14
    v_lshrrev_b32 v9, 5, v1
    v_lshl_add_u32 v5, v9, 9, v5
    v_bfe_u32 v9, v1, 4, 1
    v_lshl_add_u32 v5, v9, 3, v5
    s_lshl_b32 s96, s76, 7
    s_add_u32 s14, s96, 155648
    v_lshrrev_b32 v7, 5, v1
    v_lshl_add_u32 v7, v7, 4, s14
    s_lshl_b32 s96, s76, 12
    s_add_u32 s14, s96, 147456
    v_add_u32 v44, s14, v2
    s_waitcnt vmcnt(1)
    v_pk_add_f32 v[184:185], v[184:185], v[188:189]
    v_pk_add_f32 v[186:187], v[186:187], v[190:191]
    s_nop 1
    v_permlane32_swap_b32 v184, v186
    v_permlane32_swap_b32 v185, v187
    v_pk_add_f32 v[184:185], v[184:185], v[186:187]
    s_nop 1
    v_add_f32_dpp v184, v184, v184 row_ror:8 row_mask:0xf bank_mask:0xf
    v_add_f32_dpp v185, v185, v185 row_ror:8 row_mask:0xf bank_mask:0xf
    v_mov_b32 v186, v184
    v_mov_b32 v187, v185
    s_nop 0
    v_permlane16_swap_b32 v184, v186
    v_permlane16_swap_b32 v185, v187
    v_pk_add_f32 v[184:185], v[184:185], v[186:187]
    v_cvt_pk_bf16_f32 v184, v184, v185
    v_mov_b32 v185, s4
    s_mov_b32 exec_lo, 0xff
    s_mov_b32 exec_hi, 0xff
    buffer_store_dwordx2 v[184:185], v48, s[32:35], s15 offen sc1
    s_mov_b64 exec, -1
    s_barrier
    s_cmp_lg_u32 s3, 0
    s_cbranch_scc1 L_PC2
    v_mov_b32 v45, s4
    s_mov_b32 exec_hi, 0
    s_mov_b32 exec_lo, 65535
    buffer_store_dword v45, v46, s[32:35], s17 offen sc1
    s_mov_b64 exec, -1
L_PC2:
    s_waitcnt vmcnt(1)
    s_xor_b32 s96, s95, 262144
    s_add_u32 s82, s96, s90
    s_add_u32 m0, s83, 16384
    s_nop 0
    buffer_load_dwordx4 v26, s[44:47], s82 offen lds
    v_permlane32_swap_b32 v192, v194
    v_permlane32_swap_b32 v193, v195
    v_pk_add_f32 v[192:193], v[192:193], v[194:195]
    s_nop 1
    v_add_f32_dpp v192, v192, v192 row_ror:4 row_mask:0xf bank_mask:0xf
    s_xor_b32 s96, s95, 393216
    s_add_u32 s82, s96, s90
    s_add_u32 m0, s83, 24576
    s_nop 0
    buffer_load_dwordx4 v26, s[44:47], s82 offen lds
    v_add_f32_dpp v193, v193, v193 row_ror:4 row_mask:0xf bank_mask:0xf
    v_add_f32_dpp v192, v192, v192 row_ror:8 row_mask:0xf bank_mask:0xf
    s_nop 0
    v_add_f32_dpp v193, v193, v193 row_ror:8 row_mask:0xf bank_mask:0xf
    s_xor_b32 s96, s95, 524288
    s_add_u32 s82, s96, s90
    s_add_u32 m0, s83, 32768
    s_nop 0
    buffer_load_dwordx4 v26, s[44:47], s82 offen lds
    v_mov_b32 v194, v192
    v_mov_b32 v195, v193
    s_nop 0
    v_permlane16_swap_b32 v192, v194
    s_xor_b32 s96, s95, 655360
    s_add_u32 s82, s96, s90
    s_add_u32 m0, s83, 40960
    s_nop 0
    buffer_load_dwordx4 v26, s[44:47], s82 offen lds
    v_permlane16_swap_b32 v193, v195
    v_pk_add_f32 v[192:193], v[192:193], v[194:195]
    v_cvt_pk_bf16_f32 v192, v192, v193
    ds_write_b32 v6, v192
    s_waitcnt lgkmcnt(0)
    s_barrier
    ds_read_b128 v[196:199], v7
    ds_read_b128 v[200:203], v7 offset:32
L_PAD7:
    s_cbranch_execz L_RET7
    ds_read_b128 v[204:207], v7 offset:64
    ds_read_b128 v[208:211], v7 offset:96
    s_lshr_b32 s96, s8, 2
    s_lshl1_add_u32 s97, s9, s96
    s_and_b32 s98, s8, 3
    s_lshl2_add_u32 s99, s97, s98
    s_lshl_b32 s96, s99, 9
    s_add_u32 s18, s96, 131072
    s_waitcnt lgkmcnt(0)
    s_lshl3_add_u32 s96, s11, s3
    s_lshl_b32 s97, s96, 11
    s_add_u32 s13, s97, 29360128
    s_load_dwordx2 s[24:25], s[32:33], s92 offset:3584 glc
    v_mfma_f32_32x32x16_bf16 v[136:151], v[196:199], v[152:155], 0
    v_mfma_f32_32x32x16_bf16 v[136:151], v[200:203], v[156:159], v[136:151]
    v_mfma_f32_32x32x16_bf16 v[136:151], v[204:207], v[160:163], v[136:151]
    v_mfma_f32_32x32x16_bf16 v[136:151], v[208:211], v[164:167], v[136:151]
    s_nop 11
    v_cvt_pk_bf16_f32 v136, 0, v136
    v_add_f32 v136, 0x358637bd, v136
    v_cvt_pk_bf16_f32 v136, 0, v136
    v_rcp_f32 v136, v136
    s_branch SCHK_20
SPOLL_19:
    s_load_dwordx2 s[24:25], s[32:33], s92 offset:3584 glc
SCHK_20:
    s_add_u32 s5, s5, 1
    s_cmp_ge_u32 s5, 200000
    s_waitcnt lgkmcnt(0)
    s_cbranch_scc1 SDONE_21
    s_cmp_lg_u32 s24, s4
    s_cbranch_scc1 SPOLL_19
    s_cmp_lg_u32 s25, s4
    s_cbranch_scc1 SPOLL_19
SDONE_21:
    buffer_load_dwordx4 v[228:231], v2, s[32:35], s13 offen sc1
    buffer_load_dwordx4 v[232:235], v2, s[32:35], s13 offen offset:1024 sc1
    s_waitcnt vmcnt(0)
    v_bitop3_b32 v4, v229, v231, s4 bitop3:0x7e
    v_bitop3_b32 v4, v4, v233, s4 bitop3:0xf6
    v_bitop3_b32 v4, v4, v235, s4 bitop3:0xf6
    v_cmp_ne_u32 vcc, 0, v4
    s_cbranch_vccz TOK_23
POLL_24:
    buffer_load_dwordx4 v[228:231], v2, s[32:35], s13 offen sc1
    buffer_load_dwordx4 v[232:235], v2, s[32:35], s13 offen offset:1024 sc1
    s_waitcnt vmcnt(0)
    v_bitop3_b32 v4, v229, v231, s4 bitop3:0x7e
    v_bitop3_b32 v4, v4, v233, s4 bitop3:0xf6
    v_bitop3_b32 v4, v4, v235, s4 bitop3:0xf6
    v_cmp_ne_u32 vcc, 0, v4
    s_cbranch_vccz PDONE_25
    s_add_u32 s5, s5, 1
    s_cmp_lt_u32 s5, 200000
    s_cbranch_scc1 POLL_24
PDONE_25:
TOK_23:
    ds_write2_b32 v5, v228, v230 offset0:0 offset1:1
    ds_write2_b32 v5, v232, v234 offset0:64 offset1:65
    s_waitcnt lgkmcnt(0)
    s_barrier
    ds_read_b128 v[212:215], v44
    ds_read_b128 v[216:219], v44 offset:1024
    ds_read_b128 v[220:223], v44 offset:2048
    ds_read_b128 v[224:227], v44 offset:3072
    s_lshl_b32 s96, s77, 1
    s_lshl3_add_u32 s97, s10, s96
    s_lshl_b32 s98, s97, 5
    s_lshl1_add_u32 s99, s11, s98
    s_add_u32 s96, s99, s76
    s_lshl_b32 s97, s96, 10
    s_add_u32 s13, s97, 8388608
    v_and_b32 v47, 15, v1
    v_lshlrev_b32 v47, 4, v47
    v_bfe_u32 v9, v1, 4, 1
    v_lshl_add_u32 v47, v9, 15, v47
    v_lshrrev_b32 v9, 5, v1
    v_lshl_add_u32 v47, v9, 8, v47
    s_waitcnt lgkmcnt(3)
    v_mfma_f32_32x32x16_bf16 v[120:135], v[212:215], v[152:155], 0
    s_waitcnt lgkmcnt(2)
    v_mfma_f32_32x32x16_bf16 v[120:135], v[216:219], v[156:159], v[120:135]
    s_waitcnt lgkmcnt(1)
    v_mfma_f32_32x32x16_bf16 v[120:135], v[220:223], v[160:163], v[120:135]
    s_waitcnt lgkmcnt(0)
    v_mfma_f32_32x32x16_bf16 v[120:135], v[224:227], v[164:167], v[120:135]
    s_lshr_b32 s96, s3, 1
    s_lshl4_add_u32 s97, s96, s12
    s_lshl_b32 s98, s97, 11
    s_and_b32 s99, s3, 1
    s_lshl_b32 s96, s99, 10
    s_add_u32 s97, s98, s96
    s_add_u32 s18, s97, 131072
    s_lshl_b32 s19, s12, 7
    v_and_b32 v44, 3, v1
    v_lshl_add_u32 v44, v44, 1, s19
    v_lshrrev_b32 v9, 5, v1
    v_lshl_add_u32 v44, v9, 3, v44
    v_bfe_u32 v9, v1, 4, 1
    v_lshl_add_u32 v44, v9, 4, v44
    v_bfe_u32 v9, v1, 2, 2
    v_lshl_add_u32 v44, v9, 5, v44
    global_load_ushort v32, v44, s[78:79]
    buffer_load_dwordx4 v[28:31], v2, s[32:35], s18 offen sc1
    v_cvt_pk_bf16_f32 v120, 0, v120
    v_cvt_pk_bf16_f32 v121, 0, v121
    v_cvt_pk_bf16_f32 v122, 0, v122
    v_cvt_pk_bf16_f32 v123, 0, v123
    v_cvt_pk_bf16_f32 v124, 0, v124
    v_cvt_pk_bf16_f32 v125, 0, v125
    v_cvt_pk_bf16_f32 v126, 0, v126
    v_cvt_pk_bf16_f32 v127, 0, v127
    v_pk_mul_f32 v[120:121], v[120:121], v[136:137] op_sel_hi:[1,0]
    v_pk_mul_f32 v[122:123], v[122:123], v[136:137] op_sel_hi:[1,0]
    v_pk_mul_f32 v[124:125], v[124:125], v[136:137] op_sel_hi:[1,0]
    v_pk_mul_f32 v[126:127], v[126:127], v[136:137] op_sel_hi:[1,0]
    v_cvt_pk_bf16_f32 v168, v120, v121
    v_cvt_pk_bf16_f32 v169, v122, v123
    v_cvt_pk_bf16_f32 v170, v124, v125
    v_cvt_pk_bf16_f32 v171, v126, v127
    buffer_store_dwordx4 v[168:171], v47, s[32:35], s13 offen sc1
    v_cvt_pk_bf16_f32 v128, 0, v128
    v_cvt_pk_bf16_f32 v129, 0, v129
    v_cvt_pk_bf16_f32 v130, 0, v130
    v_cvt_pk_bf16_f32 v131, 0, v131
    v_cvt_pk_bf16_f32 v132, 0, v132
    v_cvt_pk_bf16_f32 v133, 0, v133
    v_cvt_pk_bf16_f32 v134, 0, v134
    v_cvt_pk_bf16_f32 v135, 0, v135
    v_pk_mul_f32 v[128:129], v[128:129], v[136:137] op_sel_hi:[1,0]
    v_pk_mul_f32 v[130:131], v[130:131], v[136:137] op_sel_hi:[1,0]
    v_pk_mul_f32 v[132:133], v[132:133], v[136:137] op_sel_hi:[1,0]
    v_pk_mul_f32 v[134:135], v[134:135], v[136:137] op_sel_hi:[1,0]
    v_cvt_pk_bf16_f32 v172, v128, v129
    v_cvt_pk_bf16_f32 v173, v130, v131
    v_cvt_pk_bf16_f32 v174, v132, v133
    v_cvt_pk_bf16_f32 v175, v134, v135
    buffer_store_dwordx4 v[172:175], v47, s[32:35], s13 offen offset:512 sc1
    v_mov_b32 v50, -1
    v_mov_b32 v51, -1
    v_mov_b32 v52, -1
    v_mov_b32 v53, -1
    s_lshl3_add_u32 s96, s21, s3
    s_lshl4_add_u32 s97, s96, s12
    s_lshl_b32 s98, s97, 8
    s_add_u32 s19, s98, 12582912
    v_lshlrev_b32 v54, 2, v1
    buffer_store_dword v50, v54, s[32:35], s19 offen sc1
    s_lshl_b32 s96, s21, 14
    s_lshl_b32 s97, s12, 9
    s_add_u32 s98, s96, s97
    s_add_u32 s19, s98, 13631488
    v_and_b32 v54, 31, v1
    v_lshlrev_b32 v54, 4, v54
    v_lshrrev_b32 v55, 5, v1
    v_lshl_add_u32 v54, v55, 13, v54
    s_cmp_lg_u32 s3, 5
    s_cbranch_scc1 L_NOPO
    buffer_store_dwordx4 v[50:53], v54, s[32:35], s19 offen sc1
L_NOPO:
    v_bfe_u32 v36, v1, 2, 2
    v_lshlrev_b32 v36, 7, v36
    v_lshrrev_b32 v9, 4, v1
    v_lshl_add_u32 v36, v9, 10, v36
    v_and_b32 v9, 1, v1
    v_lshl_add_u32 v36, v9, 4, v36
    v_bfe_u32 v9, v1, 1, 1
    v_lshl_add_u32 v36, v9, 3, v36
    v_bfe_u32 v9, v1, 3, 2
    v_lshl_add_u32 v36, v9, 5, v36
    s_and_b32 s96, s9, 1
    s_lshl_b32 s97, s96, 2
    s_xor_b32 s98, s3, s97
    s_lshl_b32 s17, s98, 12
    s_lshl_b32 s96, s17, 2
    s_lshr_b32 s97, s95, 4
    s_xor_b32 s14, s96, s97
    v_add_u32 v36, s14, v36
    v_xor_b32 v37, 32, v36
    v_xor_b32 v38, 64, v36
    v_xor_b32 v39, 96, v36
    v_and_b32 v5, 7, v1
    v_lshlrev_b32 v5, 15, v5
    v_bfe_u32 v9, v1, 3, 1
    v_lshl_add_u32 v5, v9, 12, v5
    s_and_b32 s96, s11, 1
    s_lshr_b32 s97, s10, 2
    s_and_b32 s98, s10, 3
    s_lshl_b32 s99, s98, 6
    s_lshl1_add_u32 s98, s97, s99
    s_lshl_b32 s97, s98, 12
    s_lshr_b32 s99, s11, 1
    s_lshl_b32 s98, s99, 6
    s_add_u32 s99, s97, s98
    s_lshl2_add_u32 s97, s96, s99
    s_add_u32 s98, s97, 1048576
    s_add_u32 s15, s98, 1024
    v_lshlrev_b32 v152, 16, v12
    v_and_b32 v153, s6, v12
    v_lshlrev_b32 v154, 16, v13
    v_and_b32 v155, s6, v13
    v_lshlrev_b32 v156, 16, v14
    v_and_b32 v157, s6, v14
    v_lshlrev_b32 v158, 16, v15
    v_and_b32 v159, s6, v15
    v_lshlrev_b32 v160, 16, v16
    v_and_b32 v161, s6, v16
    v_lshlrev_b32 v162, 16, v17
    v_and_b32 v163, s6, v17
    v_lshlrev_b32 v164, 16, v18
    v_and_b32 v165, s6, v18
    v_lshlrev_b32 v166, 16, v19
    v_and_b32 v167, s6, v19
    s_lshl3_add_u32 s96, s21, s3
    s_lshl_b32 s97, s96, 15
    s_add_u32 s19, s97, 8388608
    s_waitcnt vmcnt(3)
    v_bitop3_b32 v4, v29, v31, s4 bitop3:0x7e
    v_cmp_ne_u32 vcc, 0, v4
    s_cbranch_vccz L_MGOK
POLL_26:
    buffer_load_dwordx4 v[28:31], v2, s[32:35], s18 offen sc1
    s_waitcnt vmcnt(0)
    v_bitop3_b32 v4, v29, v31, s4 bitop3:0x7e
    v_cmp_ne_u32 vcc, 0, v4
    s_cbranch_vccz PDONE_27
    s_add_u32 s5, s5, 1
    s_cmp_lt_u32 s5, 200000
    s_cbranch_scc1 POLL_26
PDONE_27:
L_MGOK:
    s_and_b32 s96, s3, 1
    s_lshr_b32 s97, s3, 1
    s_lshl_b32 s98, s97, 10
    s_lshl3_add_u32 s99, s96, s98
    s_add_u32 s14, s99, 159744
    v_and_b32 v4, 31, v1
    v_lshl_add_u32 v4, v4, 5, s14
    v_lshrrev_b32 v9, 5, v1
    v_lshl_add_u32 v4, v9, 2, v4
    ds_write2_b32 v4, v28, v30 offset0:0 offset1:4
    v_and_b32 v7, 3, v1
    v_lshlrev_b32 v7, 4, v7
    v_lshrrev_b32 v9, 5, v1
    v_lshl_add_u32 v7, v9, 6, v7
    v_bfe_u32 v9, v1, 4, 1
    v_lshl_add_u32 v7, v9, 7, v7
    v_bfe_u32 v9, v1, 2, 2
    v_lshl_add_u32 v7, v9, 8, v7
    v_add_u32 v7, 159744, v7
    s_lshl_b32 s96, s2, 12
    s_lshr_b32 s97, s17, 6
    s_add_u32 s98, s96, s97
    s_add_u32 s99, s98, 1048576
    s_add_u32 s18, s99, 1024
    s_waitcnt vmcnt(1)
    s_waitcnt lgkmcnt(0)
    s_barrier
    s_cmp_lg_u32 s3, 0
    s_cbranch_scc1 L_PD
    v_mov_b32 v6, s4
    s_mov_b32 exec_hi, 0
    s_mov_b32 exec_lo, 65535
    buffer_store_dword v6, v5, s[32:35], s15 offen sc1
    s_mov_b64 exec, -1
L_PD:
    ds_read_b128 v[192:195], v7
    ds_read_b128 v[196:199], v7 offset:1024
    ds_read_b128 v[200:203], v7 offset:2048
    ds_read_b128 v[204:207], v7 offset:3072
    v_and_b32 v8, 3, v1
    v_lshlrev_b32 v8, 2, v8
    v_lshrrev_b32 v9, 5, v1
    v_lshl_add_u32 v8, v9, 4, v8
    v_bfe_u32 v9, v1, 4, 1
    v_lshl_add_u32 v8, v9, 5, v8
    v_bfe_u32 v9, v1, 2, 2
    v_lshl_add_u32 v8, v9, 6, v8
    v_add_u32 v8, 157184, v8
    s_lshl4_add_u32 s96, s21, s12
    s_lshl_b32 s97, s96, 6
    s_add_u32 s13, s97, 14155776
    s_waitcnt lgkmcnt(0)
    s_load_dwordx2 s[24:25], s[32:33], s18 offset:0 glc
    v_pk_add_f32 v[192:193], v[192:193], v[194:195]
    v_add_f32 v28, v192, v193
    v_pk_add_f32 v[196:197], v[196:197], v[198:199]
    v_add_f32 v29, v196, v197
    v_pk_add_f32 v[200:201], v[200:201], v[202:203]
    v_add_f32 v30, v200, v201
    v_pk_add_f32 v[204:205], v[204:205], v[206:207]
    v_add_f32 v31, v204, v205
    v_cvt_pk_bf16_f32 v28, 0, v28
    v_cvt_pk_bf16_f32 v29, 0, v29
    v_cvt_pk_bf16_f32 v30, 0, v30
    v_cvt_pk_bf16_f32 v31, 0, v31
    v_add_f32 v30, 1.0, v30
    v_lshlrev_b32 v32, 16, v32
    v_cvt_pk_bf16_f32 v30, 0, v30
    ds_write_b32 v8, v31
    v_mul_f32 v192, v30, v32
    v_cvt_pk_bf16_f32 v193, 0, v192
    v_sub_f32 v194, v192, v193
    v_add_f32_dpp v192, v192, v192 quad_perm:[1,0,3,2] row_mask:0xf bank_mask:0xf
    s_nop 1
    v_add_f32_dpp v192, v192, v192 quad_perm:[2,3,0,1] row_mask:0xf bank_mask:0xf
    s_nop 1
    v_add_f32_dpp v192, v192, v192 row_half_mirror row_mask:0xf bank_mask:0xf
    s_nop 1
    v_add_f32_dpp v192, v192, v192 row_ror:8 row_mask:0xf bank_mask:0xf
    v_mov_b32 v199, v192
    s_nop 1
    v_permlane16_swap_b32 v192, v199
    v_add_f32 v192, v192, v199
    v_mov_b32 v199, v192
    s_nop 1
    v_permlane32_swap_b32 v192, v199
    v_add_f32 v192, v192, v199
    v_mov_b32_dpp v196, v193 row_shl:1 row_mask:0xf bank_mask:0xf
    v_mov_b32_dpp v197, v194 row_shl:1 row_mask:0xf bank_mask:0xf
    v_mov_b32_dpp v198, v32 row_shl:1 row_mask:0xf bank_mask:0xf
    v_cvt_pk_bf16_f32 v196, v193, v196
    v_cvt_pk_bf16_f32 v197, v194, v197
    v_cvt_pk_bf16_f32 v198, v32, v198
    v_mov_b32 v193, s4
    v_mov_b32 v194, 0
    s_cmp_lg_u32 s3, 2
    s_cbranch_scc1 L_NOUP
    s_mov_b64 exec, 1
    buffer_store_dwordx2 v[192:193], v194, s[32:35], s13 offen sc1
    s_mov_b64 exec, -1
L_NOUP:
    v_mov_b32 v184, 0x3f803f80
    s_nop 1
    v_mov_b32_dpp v184, v196 row_newbcast:0 row_mask:0xf bank_mask:0x2
    s_nop 1
    v_mov_b32_dpp v184, v197 row_newbcast:0 row_mask:0xf bank_mask:0x4
    s_nop 1
    v_mov_b32_dpp v184, v198 row_newbcast:0 row_mask:0xf bank_mask:0x8
    v_mov_b32 v185, 0x3f803f80
    s_nop 1
    v_mov_b32_dpp v185, v196 row_newbcast:2 row_mask:0xf bank_mask:0x2
    s_nop 1
    v_mov_b32_dpp v185, v197 row_newbcast:2 row_mask:0xf bank_mask:0x4
    s_nop 1
    v_mov_b32_dpp v185, v198 row_newbcast:2 row_mask:0xf bank_mask:0x8
    v_mov_b32 v186, 0x3f803f80
    s_nop 1
    v_mov_b32_dpp v186, v196 row_newbcast:4 row_mask:0xf bank_mask:0x2
    s_nop 1
    v_mov_b32_dpp v186, v197 row_newbcast:4 row_mask:0xf bank_mask:0x4
    s_nop 1
    v_mov_b32_dpp v186, v198 row_newbcast:4 row_mask:0xf bank_mask:0x8
    v_mov_b32 v187, 0x3f803f80
    s_nop 1
    v_mov_b32_dpp v187, v196 row_newbcast:6 row_mask:0xf bank_mask:0x2
    s_nop 1
    v_mov_b32_dpp v187, v197 row_newbcast:6 row_mask:0xf bank_mask:0x4
    s_nop 1
    v_mov_b32_dpp v187, v198 row_newbcast:6 row_mask:0xf bank_mask:0x8
    v_mov_b32 v188, 0x3f803f80
    s_nop 1
    v_mov_b32_dpp v188, v196 row_newbcast:8 row_mask:0xf bank_mask:0x2
    s_nop 1
    v_mov_b32_dpp v188, v197 row_newbcast:8 row_mask:0xf bank_mask:0x4
    s_nop 1
    v_mov_b32_dpp v188, v198 row_newbcast:8 row_mask:0xf bank_mask:0x8
    v_mov_b32 v189, 0x3f803f80
    s_nop 1
    v_mov_b32_dpp v189, v196 row_newbcast:10 row_mask:0xf bank_mask:0x2
    s_nop 1
    v_mov_b32_dpp v189, v197 row_newbcast:10 row_mask:0xf bank_mask:0x4
    s_nop 1
    v_mov_b32_dpp v189, v198 row_newbcast:10 row_mask:0xf bank_mask:0x8
    v_mov_b32 v190, 0x3f803f80
    s_nop 1
    v_mov_b32_dpp v190, v196 row_newbcast:12 row_mask:0xf bank_mask:0x2
    s_nop 1
    v_mov_b32_dpp v190, v197 row_newbcast:12 row_mask:0xf bank_mask:0x4
    s_nop 1
    v_mov_b32_dpp v190, v198 row_newbcast:12 row_mask:0xf bank_mask:0x8
    v_mov_b32 v191, 0x3f803f80
    s_nop 1
    v_mov_b32_dpp v191, v196 row_newbcast:14 row_mask:0xf bank_mask:0x2
    s_nop 1
    v_mov_b32_dpp v191, v197 row_newbcast:14 row_mask:0xf bank_mask:0x4
    s_nop 1
    v_mov_b32_dpp v191, v198 row_newbcast:14 row_mask:0xf bank_mask:0x8
    v_mov_b32_dpp v136, v28 row_newbcast:0 row_mask:0xf bank_mask:0xf
    v_mov_b32_dpp v137, v28 row_newbcast:1 row_mask:0xf bank_mask:0xf
    v_mov_b32_dpp v138, v28 row_newbcast:2 row_mask:0xf bank_mask:0xf
    v_mov_b32_dpp v139, v28 row_newbcast:3 row_mask:0xf bank_mask:0xf
    v_mov_b32_dpp v140, v28 row_newbcast:4 row_mask:0xf bank_mask:0xf
    v_mov_b32_dpp v141, v28 row_newbcast:5 row_mask:0xf bank_mask:0xf
    v_mov_b32_dpp v142, v28 row_newbcast:6 row_mask:0xf bank_mask:0xf
    v_mov_b32_dpp v143, v28 row_newbcast:7 row_mask:0xf bank_mask:0xf
    v_mov_b32_dpp v144, v28 row_newbcast:8 row_mask:0xf bank_mask:0xf
    v_mov_b32_dpp v145, v28 row_newbcast:9 row_mask:0xf bank_mask:0xf
    v_mov_b32_dpp v146, v28 row_newbcast:10 row_mask:0xf bank_mask:0xf
    v_mov_b32_dpp v147, v28 row_newbcast:11 row_mask:0xf bank_mask:0xf
    v_mov_b32_dpp v148, v28 row_newbcast:12 row_mask:0xf bank_mask:0xf
    v_mov_b32_dpp v149, v28 row_newbcast:13 row_mask:0xf bank_mask:0xf
    v_mov_b32_dpp v150, v28 row_newbcast:14 row_mask:0xf bank_mask:0xf
    v_mov_b32_dpp v151, v28 row_newbcast:15 row_mask:0xf bank_mask:0xf
    v_mov_b32_dpp v168, v30 row_newbcast:0 row_mask:0xf bank_mask:0xf
    v_mov_b32_dpp v169, v30 row_newbcast:1 row_mask:0xf bank_mask:0xf
    v_mov_b32_dpp v170, v30 row_newbcast:2 row_mask:0xf bank_mask:0xf
    v_mov_b32_dpp v171, v30 row_newbcast:3 row_mask:0xf bank_mask:0xf
    v_mov_b32_dpp v172, v30 row_newbcast:4 row_mask:0xf bank_mask:0xf
    v_mov_b32_dpp v173, v30 row_newbcast:5 row_mask:0xf bank_mask:0xf
    v_mov_b32_dpp v174, v30 row_newbcast:6 row_mask:0xf bank_mask:0xf
    v_mov_b32_dpp v175, v30 row_newbcast:7 row_mask:0xf bank_mask:0xf
    v_mov_b32_dpp v176, v30 row_newbcast:8 row_mask:0xf bank_mask:0xf
    v_mov_b32_dpp v177, v30 row_newbcast:9 row_mask:0xf bank_mask:0xf
    v_mov_b32_dpp v178, v30 row_newbcast:10 row_mask:0xf bank_mask:0xf
    v_mov_b32_dpp v179, v30 row_newbcast:11 row_mask:0xf bank_mask:0xf
    v_mov_b32_dpp v180, v30 row_newbcast:12 row_mask:0xf bank_mask:0xf
    v_mov_b32_dpp v181, v30 row_newbcast:13 row_mask:0xf bank_mask:0xf
    v_mov_b32_dpp v182, v30 row_newbcast:14 row_mask:0xf bank_mask:0xf
    v_mov_b32_dpp v183, v30 row_newbcast:15 row_mask:0xf bank_mask:0xf
    v_mov_b32_dpp v88, v29 row_newbcast:0 row_mask:0xf bank_mask:0xf
    v_mov_b32_dpp v89, v29 row_newbcast:1 row_mask:0xf bank_mask:0xf
    v_mov_b32_dpp v90, v29 row_newbcast:2 row_mask:0xf bank_mask:0xf
    v_mov_b32_dpp v91, v29 row_newbcast:3 row_mask:0xf bank_mask:0xf
    v_mov_b32_dpp v92, v29 row_newbcast:4 row_mask:0xf bank_mask:0xf
    v_mov_b32_dpp v93, v29 row_newbcast:5 row_mask:0xf bank_mask:0xf
    v_mov_b32_dpp v94, v29 row_newbcast:6 row_mask:0xf bank_mask:0xf
    v_mov_b32_dpp v95, v29 row_newbcast:7 row_mask:0xf bank_mask:0xf
    v_mov_b32_dpp v96, v29 row_newbcast:8 row_mask:0xf bank_mask:0xf
    v_mov_b32_dpp v97, v29 row_newbcast:9 row_mask:0xf bank_mask:0xf
    v_mov_b32_dpp v98, v29 row_newbcast:10 row_mask:0xf bank_mask:0xf
    v_mov_b32_dpp v99, v29 row_newbcast:11 row_mask:0xf bank_mask:0xf
    v_mov_b32_dpp v100, v29 row_newbcast:12 row_mask:0xf bank_mask:0xf
    v_mov_b32_dpp v101, v29 row_newbcast:13 row_mask:0xf bank_mask:0xf
    v_mov_b32_dpp v102, v29 row_newbcast:14 row_mask:0xf bank_mask:0xf
    v_mov_b32_dpp v103, v29 row_newbcast:15 row_mask:0xf bank_mask:0xf
    v_mov_b32_dpp v104, v31 row_newbcast:0 row_mask:0xf bank_mask:0xf
    v_mov_b32_dpp v105, v31 row_newbcast:1 row_mask:0xf bank_mask:0xf
    v_mov_b32_dpp v106, v31 row_newbcast:2 row_mask:0xf bank_mask:0xf
    v_mov_b32_dpp v107, v31 row_newbcast:3 row_mask:0xf bank_mask:0xf
    v_mov_b32_dpp v108, v31 row_newbcast:4 row_mask:0xf bank_mask:0xf
    v_mov_b32_dpp v109, v31 row_newbcast:5 row_mask:0xf bank_mask:0xf
    v_mov_b32_dpp v110, v31 row_newbcast:6 row_mask:0xf bank_mask:0xf
    v_mov_b32_dpp v111, v31 row_newbcast:7 row_mask:0xf bank_mask:0xf
    v_mov_b32_dpp v112, v31 row_newbcast:8 row_mask:0xf bank_mask:0xf
    v_mov_b32_dpp v113, v31 row_newbcast:9 row_mask:0xf bank_mask:0xf
    v_mov_b32_dpp v114, v31 row_newbcast:10 row_mask:0xf bank_mask:0xf
    v_mov_b32_dpp v115, v31 row_newbcast:11 row_mask:0xf bank_mask:0xf
    v_mov_b32_dpp v116, v31 row_newbcast:12 row_mask:0xf bank_mask:0xf
    v_mov_b32_dpp v117, v31 row_newbcast:13 row_mask:0xf bank_mask:0xf
    v_mov_b32_dpp v118, v31 row_newbcast:14 row_mask:0xf bank_mask:0xf
    v_mov_b32_dpp v119, v31 row_newbcast:15 row_mask:0xf bank_mask:0xf
    s_branch SCHK_29
SPOLL_28:
    s_load_dwordx2 s[24:25], s[32:33], s18 offset:0 glc
SCHK_29:
    s_add_u32 s5, s5, 1
    s_cmp_ge_u32 s5, 200000
    s_waitcnt lgkmcnt(0)
    s_cbranch_scc1 SDONE_30
    s_cmp_lg_u32 s24, s4
    s_cbranch_scc1 SPOLL_28
    s_cmp_lg_u32 s25, s4
    s_cbranch_scc1 SPOLL_28
SDONE_30:
    s_add_u32 s20, s17, s19
    buffer_load_dwordx4 v[224:227], v2, s[32:35], s20 offen sc1
    ds_read_b64_tr_b16 v[192:193], v36
    ds_read_b64_tr_b16 v[194:195], v36 offset:512
    ds_read_b64_tr_b16 v[196:197], v37
    ds_read_b64_tr_b16 v[198:199], v37 offset:512
    ds_read_b64_tr_b16 v[200:201], v38
    ds_read_b64_tr_b16 v[202:203], v38 offset:512
    ds_read_b64_tr_b16 v[204:205], v39
    ds_read_b64_tr_b16 v[206:207], v39 offset:512
    ds_read_b64_tr_b16 v[208:209], v36 offset:4096
    ds_read_b64_tr_b16 v[210:211], v36 offset:4608
    ds_read_b64_tr_b16 v[212:213], v37 offset:4096
    ds_read_b64_tr_b16 v[214:215], v37 offset:4608
    ds_read_b64_tr_b16 v[216:217], v38 offset:4096
    ds_read_b64_tr_b16 v[218:219], v38 offset:4608
    buffer_load_dwordx4 v[228:231], v2, s[32:35], s20 offen offset:1024 sc1
    buffer_load_dwordx4 v[232:235], v2, s[32:35], s20 offen offset:2048 sc1
    buffer_load_dwordx4 v[236:239], v2, s[32:35], s20 offen offset:3072 sc1
    s_barrier
    s_xor_b32 s96, s17, 4096
    s_add_u32 s20, s96, s19
    buffer_load_dwordx4 v[240:243], v2, s[32:35], s20 offen sc1
    buffer_load_dwordx4 v[244:247], v2, s[32:35], s20 offen offset:1024 sc1
    buffer_load_dwordx4 v[44:47], v2, s[32:35], s20 offen offset:2048 sc1
    buffer_load_dwordx4 v[48:51], v2, s[32:35], s20 offen offset:3072 sc1
    s_lshl_b32 s96, s21, 10
    s_add_u32 s13, s96, 14155776
    v_and_b32 v10, 15, v1
    v_lshlrev_b32 v10, 6, v10
    s_waitcnt vmcnt(7)
    s_waitcnt lgkmcnt(10)
    v_mfma_f32_16x16x32_bf16 v[120:123], v[192:195], v[224:227], 0
    ds_read_b64_tr_b16 v[220:221], v39 offset:4096
    ds_read_b64_tr_b16 v[222:223], v39 offset:4608
    v_mfma_f32_16x16x32_bf16 v[124:127], v[196:199], v[224:227], 0
    ds_read_b64_tr_b16 v[192:193], v36 offset:8192
    ds_read_b64_tr_b16 v[194:195], v36 offset:8704
    s_waitcnt lgkmcnt(10)
    v_mfma_f32_16x16x32_bf16 v[128:131], v[200:203], v[224:227], 0
    ds_read_b64_tr_b16 v[196:197], v37 offset:8192
    ds_read_b64_tr_b16 v[198:199], v37 offset:8704
    v_mfma_f32_16x16x32_bf16 v[132:135], v[204:207], v[224:227], 0
    ds_read_b64_tr_b16 v[200:201], v38 offset:8192
    ds_read_b64_tr_b16 v[202:203], v38 offset:8704
    s_xor_b32 s96, s17, 8192
    s_add_u32 s20, s96, s19
    buffer_load_dwordx4 v[224:227], v2, s[32:35], s20 offen sc1
    s_waitcnt vmcnt(7)
    s_waitcnt lgkmcnt(10)
    v_mfma_f32_16x16x32_bf16 v[120:123], v[208:211], v[228:231], v[120:123]
    ds_read_b64_tr_b16 v[204:205], v39 offset:8192
    ds_read_b64_tr_b16 v[206:207], v39 offset:8704
    v_mfma_f32_16x16x32_bf16 v[124:127], v[212:215], v[228:231], v[124:127]
    ds_read_b64_tr_b16 v[208:209], v36 offset:12288
    ds_read_b64_tr_b16 v[210:211], v36 offset:12800
    s_waitcnt lgkmcnt(10)
    v_mfma_f32_16x16x32_bf16 v[128:131], v[216:219], v[228:231], v[128:131]
    ds_read_b64_tr_b16 v[212:213], v37 offset:12288
    ds_read_b64_tr_b16 v[214:215], v37 offset:12800
    v_mfma_f32_16x16x32_bf16 v[132:135], v[220:223], v[228:231], v[132:135]
    ds_read_b64_tr_b16 v[216:217], v38 offset:12288
    ds_read_b64_tr_b16 v[218:219], v38 offset:12800
    buffer_load_dwordx4 v[228:231], v2, s[32:35], s20 offen offset:1024 sc1
    s_waitcnt vmcnt(7)
    s_waitcnt lgkmcnt(10)
    v_mfma_f32_16x16x32_bf16 v[120:123], v[192:195], v[232:235], v[120:123]
    ds_read_b64_tr_b16 v[220:221], v39 offset:12288
    ds_read_b64_tr_b16 v[222:223], v39 offset:12800
    v_mfma_f32_16x16x32_bf16 v[124:127], v[196:199], v[232:235], v[124:127]
    v_xor_b32 v36, 16384, v36
    ds_read_b64_tr_b16 v[192:193], v36
    ds_read_b64_tr_b16 v[194:195], v36 offset:512
    s_waitcnt lgkmcnt(10)
    v_mfma_f32_16x16x32_bf16 v[128:131], v[200:203], v[232:235], v[128:131]
    v_xor_b32 v37, 16384, v37
    ds_read_b64_tr_b16 v[196:197], v37
    ds_read_b64_tr_b16 v[198:199], v37 offset:512
    v_mfma_f32_16x16x32_bf16 v[132:135], v[204:207], v[232:235], v[132:135]
    v_xor_b32 v38, 16384, v38
    ds_read_b64_tr_b16 v[200:201], v38
    ds_read_b64_tr_b16 v[202:203], v38 offset:512
    buffer_load_dwordx4 v[232:235], v2, s[32:35], s20 offen offset:2048 sc1
    s_waitcnt vmcnt(7)
    s_waitcnt lgkmcnt(10)
    v_mfma_f32_16x16x32_bf16 v[120:123], v[208:211], v[236:239], v[120:123]
    v_xor_b32 v39, 16384, v39
    ds_read_b64_tr_b16 v[204:205], v39
    ds_read_b64_tr_b16 v[206:207], v39 offset:512
    v_mfma_f32_16x16x32_bf16 v[124:127], v[212:215], v[236:239], v[124:127]
    ds_read_b64_tr_b16 v[208:209], v36 offset:4096
    ds_read_b64_tr_b16 v[210:211], v36 offset:4608
    s_waitcnt lgkmcnt(10)
    v_mfma_f32_16x16x32_bf16 v[128:131], v[216:219], v[236:239], v[128:131]
    ds_read_b64_tr_b16 v[212:213], v37 offset:4096
    ds_read_b64_tr_b16 v[214:215], v37 offset:4608
    v_mfma_f32_16x16x32_bf16 v[132:135], v[220:223], v[236:239], v[132:135]
    ds_read_b64_tr_b16 v[216:217], v38 offset:4096
    ds_read_b64_tr_b16 v[218:219], v38 offset:4608
    buffer_load_dwordx4 v[236:239], v2, s[32:35], s20 offen offset:3072 sc1
    s_waitcnt vmcnt(7)
    s_waitcnt lgkmcnt(10)
    v_mfma_f32_16x16x32_bf16 v[120:123], v[192:195], v[240:243], v[120:123]
    ds_read_b64_tr_b16 v[220:221], v39 offset:4096
    ds_read_b64_tr_b16 v[222:223], v39 offset:4608
    v_mfma_f32_16x16x32_bf16 v[124:127], v[196:199], v[240:243], v[124:127]
    ds_read_b64_tr_b16 v[192:193], v36 offset:8192
    ds_read_b64_tr_b16 v[194:195], v36 offset:8704
    s_waitcnt lgkmcnt(10)
    v_mfma_f32_16x16x32_bf16 v[128:131], v[200:203], v[240:243], v[128:131]
    ds_read_b64_tr_b16 v[196:197], v37 offset:8192
    ds_read_b64_tr_b16 v[198:199], v37 offset:8704
    v_mfma_f32_16x16x32_bf16 v[132:135], v[204:207], v[240:243], v[132:135]
    ds_read_b64_tr_b16 v[200:201], v38 offset:8192
    ds_read_b64_tr_b16 v[202:203], v38 offset:8704
    s_xor_b32 s96, s17, 12288
    s_add_u32 s20, s96, s19
    buffer_load_dwordx4 v[240:243], v2, s[32:35], s20 offen sc1
    s_waitcnt vmcnt(7)
    s_waitcnt lgkmcnt(10)
    v_mfma_f32_16x16x32_bf16 v[120:123], v[208:211], v[244:247], v[120:123]
    ds_read_b64_tr_b16 v[204:205], v39 offset:8192
    ds_read_b64_tr_b16 v[206:207], v39 offset:8704
    v_mfma_f32_16x16x32_bf16 v[124:127], v[212:215], v[244:247], v[124:127]
    ds_read_b64_tr_b16 v[208:209], v36 offset:12288
    ds_read_b64_tr_b16 v[210:211], v36 offset:12800
    s_waitcnt lgkmcnt(10)
    v_mfma_f32_16x16x32_bf16 v[128:131], v[216:219], v[244:247], v[128:131]
    ds_read_b64_tr_b16 v[212:213], v37 offset:12288
    ds_read_b64_tr_b16 v[214:215], v37 offset:12800
    v_mfma_f32_16x16x32_bf16 v[132:135], v[220:223], v[244:247], v[132:135]
    ds_read_b64_tr_b16 v[216:217], v38 offset:12288
    ds_read_b64_tr_b16 v[218:219], v38 offset:12800
    buffer_load_dwordx4 v[244:247], v2, s[32:35], s20 offen offset:1024 sc1
    s_waitcnt vmcnt(7)
    s_waitcnt lgkmcnt(10)
    v_mfma_f32_16x16x32_bf16 v[120:123], v[192:195], v[44:47], v[120:123]
    ds_read_b64_tr_b16 v[220:221], v39 offset:12288
    ds_read_b64_tr_b16 v[222:223], v39 offset:12800
    v_mfma_f32_16x16x32_bf16 v[124:127], v[196:199], v[44:47], v[124:127]
    v_xor_b32 v36, 49152, v36
    ds_read_b64_tr_b16 v[192:193], v36
    ds_read_b64_tr_b16 v[194:195], v36 offset:512
    s_waitcnt lgkmcnt(10)
    v_mfma_f32_16x16x32_bf16 v[128:131], v[200:203], v[44:47], v[128:131]
    v_xor_b32 v37, 49152, v37
    ds_read_b64_tr_b16 v[196:197], v37
    ds_read_b64_tr_b16 v[198:199], v37 offset:512
    v_mfma_f32_16x16x32_bf16 v[132:135], v[204:207], v[44:47], v[132:135]
    v_xor_b32 v38, 49152, v38
    ds_read_b64_tr_b16 v[200:201], v38
    ds_read_b64_tr_b16 v[202:203], v38 offset:512
    buffer_load_dwordx4 v[44:47], v2, s[32:35], s20 offen offset:2048 sc1
    s_waitcnt vmcnt(7)
    s_waitcnt lgkmcnt(10)
    v_mfma_f32_16x16x32_bf16 v[120:123], v[208:211], v[48:51], v[120:123]
    v_xor_b32 v39, 49152, v39
    ds_read_b64_tr_b16 v[204:205], v39
    ds_read_b64_tr_b16 v[206:207], v39 offset:512
    v_mfma_f32_16x16x32_bf16 v[124:127], v[212:215], v[48:51], v[124:127]
    ds_read_b64_tr_b16 v[208:209], v36 offset:4096
    ds_read_b64_tr_b16 v[210:211], v36 offset:4608
    s_waitcnt lgkmcnt(10)
    v_mfma_f32_16x16x32_bf16 v[128:131], v[216:219], v[48:51], v[128:131]
    ds_read_b64_tr_b16 v[212:213], v37 offset:4096
    ds_read_b64_tr_b16 v[214:215], v37 offset:4608
    v_mfma_f32_16x16x32_bf16 v[132:135], v[220:223], v[48:51], v[132:135]
    ds_read_b64_tr_b16 v[216:217], v38 offset:4096
    ds_read_b64_tr_b16 v[218:219], v38 offset:4608
    buffer_load_dwordx4 v[48:51], v2, s[32:35], s20 offen offset:3072 sc1
    s_waitcnt vmcnt(7)
    s_waitcnt lgkmcnt(10)
    v_mfma_f32_16x16x32_bf16 v[120:123], v[192:195], v[224:227], v[120:123]
    ds_read_b64_tr_b16 v[220:221], v39 offset:4096
    ds_read_b64_tr_b16 v[222:223], v39 offset:4608
    v_mfma_f32_16x16x32_bf16 v[124:127], v[196:199], v[224:227], v[124:127]
    ds_read_b64_tr_b16 v[192:193], v36 offset:8192
    ds_read_b64_tr_b16 v[194:195], v36 offset:8704
L_PAD8:
    s_cbranch_execz L_RET8
    s_waitcnt lgkmcnt(10)
    v_mfma_f32_16x16x32_bf16 v[128:131], v[200:203], v[224:227], v[128:131]
    ds_read_b64_tr_b16 v[196:197], v37 offset:8192
    ds_read_b64_tr_b16 v[198:199], v37 offset:8704
    v_mfma_f32_16x16x32_bf16 v[132:135], v[204:207], v[224:227], v[132:135]
    ds_read_b64_tr_b16 v[200:201], v38 offset:8192
    ds_read_b64_tr_b16 v[202:203], v38 offset:8704
    s_xor_b32 s96, s17, 16384
    s_add_u32 s20, s96, s19
    buffer_load_dwordx4 v[224:227], v2, s[32:35], s20 offen sc1
    s_waitcnt vmcnt(7)
    s_waitcnt lgkmcnt(10)
    v_mfma_f32_16x16x32_bf16 v[120:123], v[208:211], v[228:231], v[120:123]
    ds_read_b64_tr_b16 v[204:205], v39 offset:8192
    ds_read_b64_tr_b16 v[206:207], v39 offset:8704
    v_mfma_f32_16x16x32_bf16 v[124:127], v[212:215], v[228:231], v[124:127]
    ds_read_b64_tr_b16 v[208:209], v36 offset:12288
    ds_read_b64_tr_b16 v[210:211], v36 offset:12800
    s_waitcnt lgkmcnt(10)
    v_mfma_f32_16x16x32_bf16 v[128:131], v[216:219], v[228:231], v[128:131]
    ds_read_b64_tr_b16 v[212:213], v37 offset:12288
    ds_read_b64_tr_b16 v[214:215], v37 offset:12800
    v_mfma_f32_16x16x32_bf16 v[132:135], v[220:223], v[228:231], v[132:135]
    ds_read_b64_tr_b16 v[216:217], v38 offset:12288
    ds_read_b64_tr_b16 v[218:219], v38 offset:12800
    buffer_load_dwordx4 v[228:231], v2, s[32:35], s20 offen offset:1024 sc1
    s_waitcnt vmcnt(7)
    s_waitcnt lgkmcnt(10)
    v_mfma_f32_16x16x32_bf16 v[120:123], v[192:195], v[232:235], v[120:123]
    ds_read_b64_tr_b16 v[220:221], v39 offset:12288
    ds_read_b64_tr_b16 v[222:223], v39 offset:12800
    v_mfma_f32_16x16x32_bf16 v[124:127], v[196:199], v[232:235], v[124:127]
    v_xor_b32 v36, 16384, v36
    ds_read_b64_tr_b16 v[192:193], v36
    ds_read_b64_tr_b16 v[194:195], v36 offset:512
    s_waitcnt lgkmcnt(10)
    v_mfma_f32_16x16x32_bf16 v[128:131], v[200:203], v[232:235], v[128:131]
    v_xor_b32 v37, 16384, v37
    ds_read_b64_tr_b16 v[196:197], v37
    ds_read_b64_tr_b16 v[198:199], v37 offset:512
    v_mfma_f32_16x16x32_bf16 v[132:135], v[204:207], v[232:235], v[132:135]
    v_xor_b32 v38, 16384, v38
    ds_read_b64_tr_b16 v[200:201], v38
    ds_read_b64_tr_b16 v[202:203], v38 offset:512
    buffer_load_dwordx4 v[232:235], v2, s[32:35], s20 offen offset:2048 sc1
    s_waitcnt vmcnt(7)
    s_waitcnt lgkmcnt(10)
    v_mfma_f32_16x16x32_bf16 v[120:123], v[208:211], v[236:239], v[120:123]
    v_xor_b32 v39, 16384, v39
    ds_read_b64_tr_b16 v[204:205], v39
    ds_read_b64_tr_b16 v[206:207], v39 offset:512
    v_mfma_f32_16x16x32_bf16 v[124:127], v[212:215], v[236:239], v[124:127]
    ds_read_b64_tr_b16 v[208:209], v36 offset:4096
    ds_read_b64_tr_b16 v[210:211], v36 offset:4608
    s_waitcnt lgkmcnt(10)
    v_mfma_f32_16x16x32_bf16 v[128:131], v[216:219], v[236:239], v[128:131]
    ds_read_b64_tr_b16 v[212:213], v37 offset:4096
    ds_read_b64_tr_b16 v[214:215], v37 offset:4608
    v_mfma_f32_16x16x32_bf16 v[132:135], v[220:223], v[236:239], v[132:135]
    ds_read_b64_tr_b16 v[216:217], v38 offset:4096
    ds_read_b64_tr_b16 v[218:219], v38 offset:4608
    buffer_load_dwordx4 v[236:239], v2, s[32:35], s20 offen offset:3072 sc1
    s_waitcnt vmcnt(7)
    s_waitcnt lgkmcnt(10)
    v_mfma_f32_16x16x32_bf16 v[120:123], v[192:195], v[240:243], v[120:123]
    ds_read_b64_tr_b16 v[220:221], v39 offset:4096
    ds_read_b64_tr_b16 v[222:223], v39 offset:4608
    v_mfma_f32_16x16x32_bf16 v[124:127], v[196:199], v[240:243], v[124:127]
    ds_read_b64_tr_b16 v[192:193], v36 offset:8192
    ds_read_b64_tr_b16 v[194:195], v36 offset:8704
    s_waitcnt lgkmcnt(10)
    v_mfma_f32_16x16x32_bf16 v[128:131], v[200:203], v[240:243], v[128:131]
    ds_read_b64_tr_b16 v[196:197], v37 offset:8192
    ds_read_b64_tr_b16 v[198:199], v37 offset:8704
    v_mfma_f32_16x16x32_bf16 v[132:135], v[204:207], v[240:243], v[132:135]
    ds_read_b64_tr_b16 v[200:201], v38 offset:8192
    ds_read_b64_tr_b16 v[202:203], v38 offset:8704
    s_xor_b32 s96, s17, 20480
    s_add_u32 s20, s96, s19
    buffer_load_dwordx4 v[240:243], v2, s[32:35], s20 offen sc1
    s_waitcnt vmcnt(7)
    s_waitcnt lgkmcnt(10)
    v_mfma_f32_16x16x32_bf16 v[120:123], v[208:211], v[244:247], v[120:123]
    ds_read_b64_tr_b16 v[204:205], v39 offset:8192
    ds_read_b64_tr_b16 v[206:207], v39 offset:8704
    v_mfma_f32_16x16x32_bf16 v[124:127], v[212:215], v[244:247], v[124:127]
    ds_read_b64_tr_b16 v[208:209], v36 offset:12288
    ds_read_b64_tr_b16 v[210:211], v36 offset:12800
    s_waitcnt lgkmcnt(10)
    v_mfma_f32_16x16x32_bf16 v[128:131], v[216:219], v[244:247], v[128:131]
    ds_read_b64_tr_b16 v[212:213], v37 offset:12288
    ds_read_b64_tr_b16 v[214:215], v37 offset:12800
    v_mfma_f32_16x16x32_bf16 v[132:135], v[220:223], v[244:247], v[132:135]
    ds_read_b64_tr_b16 v[216:217], v38 offset:12288
    ds_read_b64_tr_b16 v[218:219], v38 offset:12800
    buffer_load_dwordx4 v[244:247], v2, s[32:35], s20 offen offset:1024 sc1
    s_waitcnt vmcnt(7)
    s_waitcnt lgkmcnt(10)
    v_mfma_f32_16x16x32_bf16 v[120:123], v[192:195], v[44:47], v[120:123]
    ds_read_b64_tr_b16 v[220:221], v39 offset:12288
    ds_read_b64_tr_b16 v[222:223], v39 offset:12800
    v_mfma_f32_16x16x32_bf16 v[124:127], v[196:199], v[44:47], v[124:127]
    v_xor_b32 v36, 114688, v36
    ds_read_b64_tr_b16 v[192:193], v36
    ds_read_b64_tr_b16 v[194:195], v36 offset:512
    s_waitcnt lgkmcnt(10)
    v_mfma_f32_16x16x32_bf16 v[128:131], v[200:203], v[44:47], v[128:131]
    v_xor_b32 v37, 114688, v37
    ds_read_b64_tr_b16 v[196:197], v37
    ds_read_b64_tr_b16 v[198:199], v37 offset:512
    v_mfma_f32_16x16x32_bf16 v[132:135], v[204:207], v[44:47], v[132:135]
    v_xor_b32 v38, 114688, v38
    ds_read_b64_tr_b16 v[200:201], v38
    ds_read_b64_tr_b16 v[202:203], v38 offset:512
    buffer_load_dwordx4 v[44:47], v2, s[32:35], s20 offen offset:2048 sc1
    s_waitcnt vmcnt(7)
    s_waitcnt lgkmcnt(10)
    v_mfma_f32_16x16x32_bf16 v[120:123], v[208:211], v[48:51], v[120:123]
    v_xor_b32 v39, 114688, v39
    ds_read_b64_tr_b16 v[204:205], v39
    ds_read_b64_tr_b16 v[206:207], v39 offset:512
    v_mfma_f32_16x16x32_bf16 v[124:127], v[212:215], v[48:51], v[124:127]
    ds_read_b64_tr_b16 v[208:209], v36 offset:4096
    ds_read_b64_tr_b16 v[210:211], v36 offset:4608
    s_waitcnt lgkmcnt(10)
    v_mfma_f32_16x16x32_bf16 v[128:131], v[216:219], v[48:51], v[128:131]
    ds_read_b64_tr_b16 v[212:213], v37 offset:4096
    ds_read_b64_tr_b16 v[214:215], v37 offset:4608
    v_mfma_f32_16x16x32_bf16 v[132:135], v[220:223], v[48:51], v[132:135]
    ds_read_b64_tr_b16 v[216:217], v38 offset:4096
    ds_read_b64_tr_b16 v[218:219], v38 offset:4608
    buffer_load_dwordx4 v[48:51], v2, s[32:35], s20 offen offset:3072 sc1
    s_waitcnt vmcnt(7)
    s_waitcnt lgkmcnt(10)
    v_mfma_f32_16x16x32_bf16 v[120:123], v[192:195], v[224:227], v[120:123]
    ds_read_b64_tr_b16 v[220:221], v39 offset:4096
    ds_read_b64_tr_b16 v[222:223], v39 offset:4608
    v_mfma_f32_16x16x32_bf16 v[124:127], v[196:199], v[224:227], v[124:127]
    ds_read_b64_tr_b16 v[192:193], v36 offset:8192
    ds_read_b64_tr_b16 v[194:195], v36 offset:8704
    s_waitcnt lgkmcnt(10)
    v_mfma_f32_16x16x32_bf16 v[128:131], v[200:203], v[224:227], v[128:131]
    ds_read_b64_tr_b16 v[196:197], v37 offset:8192
    ds_read_b64_tr_b16 v[198:199], v37 offset:8704
    v_mfma_f32_16x16x32_bf16 v[132:135], v[204:207], v[224:227], v[132:135]
    ds_read_b64_tr_b16 v[200:201], v38 offset:8192
    ds_read_b64_tr_b16 v[202:203], v38 offset:8704
    s_xor_b32 s96, s17, 24576
    s_add_u32 s20, s96, s19
    buffer_load_dwordx4 v[224:227], v2, s[32:35], s20 offen sc1
    s_waitcnt vmcnt(7)
    s_waitcnt lgkmcnt(10)
    v_mfma_f32_16x16x32_bf16 v[120:123], v[208:211], v[228:231], v[120:123]
    ds_read_b64_tr_b16 v[204:205], v39 offset:8192
    ds_read_b64_tr_b16 v[206:207], v39 offset:8704
    v_mfma_f32_16x16x32_bf16 v[124:127], v[212:215], v[228:231], v[124:127]
    ds_read_b64_tr_b16 v[208:209], v36 offset:12288
    ds_read_b64_tr_b16 v[210:211], v36 offset:12800
    s_waitcnt lgkmcnt(10)
    v_mfma_f32_16x16x32_bf16 v[128:131], v[216:219], v[228:231], v[128:131]
    ds_read_b64_tr_b16 v[212:213], v37 offset:12288
    ds_read_b64_tr_b16 v[214:215], v37 offset:12800
    v_mfma_f32_16x16x32_bf16 v[132:135], v[220:223], v[228:231], v[132:135]
    ds_read_b64_tr_b16 v[216:217], v38 offset:12288
    ds_read_b64_tr_b16 v[218:219], v38 offset:12800
    buffer_load_dwordx4 v[228:231], v2, s[32:35], s20 offen offset:1024 sc1
    s_waitcnt vmcnt(7)
    s_waitcnt lgkmcnt(10)
    v_mfma_f32_16x16x32_bf16 v[120:123], v[192:195], v[232:235], v[120:123]
    ds_read_b64_tr_b16 v[220:221], v39 offset:12288
    ds_read_b64_tr_b16 v[222:223], v39 offset:12800
    v_mfma_f32_16x16x32_bf16 v[124:127], v[196:199], v[232:235], v[124:127]
    v_xor_b32 v36, 16384, v36
    ds_read_b64_tr_b16 v[192:193], v36
    ds_read_b64_tr_b16 v[194:195], v36 offset:512
    s_waitcnt lgkmcnt(10)
    v_mfma_f32_16x16x32_bf16 v[128:131], v[200:203], v[232:235], v[128:131]
    v_xor_b32 v37, 16384, v37
    ds_read_b64_tr_b16 v[196:197], v37
    ds_read_b64_tr_b16 v[198:199], v37 offset:512
    v_mfma_f32_16x16x32_bf16 v[132:135], v[204:207], v[232:235], v[132:135]
    v_xor_b32 v38, 16384, v38
    ds_read_b64_tr_b16 v[200:201], v38
    ds_read_b64_tr_b16 v[202:203], v38 offset:512
    buffer_load_dwordx4 v[232:235], v2, s[32:35], s20 offen offset:2048 sc1
    s_waitcnt vmcnt(7)
    s_waitcnt lgkmcnt(10)
    v_mfma_f32_16x16x32_bf16 v[120:123], v[208:211], v[236:239], v[120:123]
    v_xor_b32 v39, 16384, v39
    ds_read_b64_tr_b16 v[204:205], v39
    ds_read_b64_tr_b16 v[206:207], v39 offset:512
    v_mfma_f32_16x16x32_bf16 v[124:127], v[212:215], v[236:239], v[124:127]
    ds_read_b64_tr_b16 v[208:209], v36 offset:4096
    ds_read_b64_tr_b16 v[210:211], v36 offset:4608
    s_waitcnt lgkmcnt(10)
    v_mfma_f32_16x16x32_bf16 v[128:131], v[216:219], v[236:239], v[128:131]
    ds_read_b64_tr_b16 v[212:213], v37 offset:4096
    ds_read_b64_tr_b16 v[214:215], v37 offset:4608
    v_mfma_f32_16x16x32_bf16 v[132:135], v[220:223], v[236:239], v[132:135]
    ds_read_b64_tr_b16 v[216:217], v38 offset:4096
    ds_read_b64_tr_b16 v[218:219], v38 offset:4608
    buffer_load_dwordx4 v[236:239], v2, s[32:35], s20 offen offset:3072 sc1
    s_waitcnt vmcnt(7)
    s_waitcnt lgkmcnt(10)
    v_mfma_f32_16x16x32_bf16 v[120:123], v[192:195], v[240:243], v[120:123]
    ds_read_b64_tr_b16 v[220:221], v39 offset:4096
    ds_read_b64_tr_b16 v[222:223], v39 offset:4608
    v_mfma_f32_16x16x32_bf16 v[124:127], v[196:199], v[240:243], v[124:127]
    ds_read_b64_tr_b16 v[192:193], v36 offset:8192
    ds_read_b64_tr_b16 v[194:195], v36 offset:8704
    s_waitcnt lgkmcnt(10)
    v_mfma_f32_16x16x32_bf16 v[128:131], v[200:203], v[240:243], v[128:131]
    ds_read_b64_tr_b16 v[196:197], v37 offset:8192
    ds_read_b64_tr_b16 v[198:199], v37 offset:8704
    v_mfma_f32_16x16x32_bf16 v[132:135], v[204:207], v[240:243], v[132:135]
    ds_read_b64_tr_b16 v[200:201], v38 offset:8192
    ds_read_b64_tr_b16 v[202:203], v38 offset:8704
    s_xor_b32 s96, s17, 28672
    s_add_u32 s20, s96, s19
    buffer_load_dwordx4 v[240:243], v2, s[32:35], s20 offen sc1
    s_waitcnt vmcnt(7)
    s_waitcnt lgkmcnt(10)
    v_mfma_f32_16x16x32_bf16 v[120:123], v[208:211], v[244:247], v[120:123]
    ds_read_b64_tr_b16 v[204:205], v39 offset:8192
    ds_read_b64_tr_b16 v[206:207], v39 offset:8704
    v_mfma_f32_16x16x32_bf16 v[124:127], v[212:215], v[244:247], v[124:127]
    ds_read_b64_tr_b16 v[208:209], v36 offset:12288
    ds_read_b64_tr_b16 v[210:211], v36 offset:12800
    s_waitcnt lgkmcnt(10)
    v_mfma_f32_16x16x32_bf16 v[128:131], v[216:219], v[244:247], v[128:131]
    ds_read_b64_tr_b16 v[212:213], v37 offset:12288
    ds_read_b64_tr_b16 v[214:215], v37 offset:12800
    v_mfma_f32_16x16x32_bf16 v[132:135], v[220:223], v[244:247], v[132:135]
    ds_read_b64_tr_b16 v[216:217], v38 offset:12288
    ds_read_b64_tr_b16 v[218:219], v38 offset:12800
    buffer_load_dwordx4 v[244:247], v2, s[32:35], s20 offen offset:1024 sc1
    s_waitcnt vmcnt(7)
    s_waitcnt lgkmcnt(10)
    v_mfma_f32_16x16x32_bf16 v[120:123], v[192:195], v[44:47], v[120:123]
    ds_read_b64_tr_b16 v[220:221], v39 offset:12288
    ds_read_b64_tr_b16 v[222:223], v39 offset:12800
    v_mfma_f32_16x16x32_bf16 v[124:127], v[196:199], v[44:47], v[124:127]
    v_xor_b32 v36, 49152, v36
    ds_read_b64_tr_b16 v[192:193], v36
    ds_read_b64_tr_b16 v[194:195], v36 offset:512
    s_waitcnt lgkmcnt(10)
    v_mfma_f32_16x16x32_bf16 v[128:131], v[200:203], v[44:47], v[128:131]
    v_xor_b32 v37, 49152, v37
    ds_read_b64_tr_b16 v[196:197], v37
    ds_read_b64_tr_b16 v[198:199], v37 offset:512
    v_mfma_f32_16x16x32_bf16 v[132:135], v[204:207], v[44:47], v[132:135]
    v_xor_b32 v38, 49152, v38
    ds_read_b64_tr_b16 v[200:201], v38
    ds_read_b64_tr_b16 v[202:203], v38 offset:512
    buffer_load_dwordx4 v[44:47], v2, s[32:35], s20 offen offset:2048 sc1
    s_waitcnt vmcnt(7)
    s_waitcnt lgkmcnt(10)
    v_mfma_f32_16x16x32_bf16 v[120:123], v[208:211], v[48:51], v[120:123]
    v_xor_b32 v39, 49152, v39
    ds_read_b64_tr_b16 v[204:205], v39
    ds_read_b64_tr_b16 v[206:207], v39 offset:512
    v_mfma_f32_16x16x32_bf16 v[124:127], v[212:215], v[48:51], v[124:127]
    ds_read_b64_tr_b16 v[208:209], v36 offset:4096
    ds_read_b64_tr_b16 v[210:211], v36 offset:4608
    s_waitcnt lgkmcnt(10)
    v_mfma_f32_16x16x32_bf16 v[128:131], v[216:219], v[48:51], v[128:131]
    ds_read_b64_tr_b16 v[212:213], v37 offset:4096
    ds_read_b64_tr_b16 v[214:215], v37 offset:4608
    v_mfma_f32_16x16x32_bf16 v[132:135], v[220:223], v[48:51], v[132:135]
    ds_read_b64_tr_b16 v[216:217], v38 offset:4096
    ds_read_b64_tr_b16 v[218:219], v38 offset:4608
    buffer_load_dwordx4 v[48:51], v2, s[32:35], s20 offen offset:3072 sc1
    buffer_load_dwordx2 v[40:41], v10, s[32:35], s13 offen sc1
    s_cmp_ge_u32 s3, 4
    s_cbranch_scc1 L_FH_31
    s_mov_b32 s82, s80
    buffer_load_dwordx4 v[56:59], v27, s[56:59], s82 offen nt
    s_add_u32 s82, s80, 917504
    buffer_load_dwordx4 v[60:63], v27, s[56:59], s82 offen nt
L_FH_31:
    s_waitcnt vmcnt(8)
    s_waitcnt lgkmcnt(10)
    v_mfma_f32_16x16x32_bf16 v[120:123], v[192:195], v[224:227], v[120:123]
    ds_read_b64_tr_b16 v[220:221], v39 offset:4096
    ds_read_b64_tr_b16 v[222:223], v39 offset:4608
    v_mfma_f32_16x16x32_bf16 v[124:127], v[196:199], v[224:227], v[124:127]
    ds_read_b64_tr_b16 v[192:193], v36 offset:8192
    ds_read_b64_tr_b16 v[194:195], v36 offset:8704
    s_waitcnt lgkmcnt(10)
    v_mfma_f32_16x16x32_bf16 v[128:131], v[200:203], v[224:227], v[128:131]
    ds_read_b64_tr_b16 v[196:197], v37 offset:8192
    ds_read_b64_tr_b16 v[198:199], v37 offset:8704
    v_mfma_f32_16x16x32_bf16 v[132:135], v[204:207], v[224:227], v[132:135]
    ds_read_b64_tr_b16 v[200:201], v38 offset:8192
    ds_read_b64_tr_b16 v[202:203], v38 offset:8704
    s_waitcnt vmcnt(7)
    s_waitcnt lgkmcnt(10)
    v_mfma_f32_16x16x32_bf16 v[120:123], v[208:211], v[228:231], v[120:123]
    ds_read_b64_tr_b16 v[204:205], v39 offset:8192
    ds_read_b64_tr_b16 v[206:207], v39 offset:8704
    v_mfma_f32_16x16x32_bf16 v[124:127], v[212:215], v[228:231], v[124:127]
    ds_read_b64_tr_b16 v[208:209], v36 offset:12288
    ds_read_b64_tr_b16 v[210:211], v36 offset:12800
    s_waitcnt lgkmcnt(10)
    v_mfma_f32_16x16x32_bf16 v[128:131], v[216:219], v[228:231], v[128:131]
    ds_read_b64_tr_b16 v[212:213], v37 offset:12288
    ds_read_b64_tr_b16 v[214:215], v37 offset:12800
    v_mfma_f32_16x16x32_bf16 v[132:135], v[220:223], v[228:231], v[132:135]
    ds_read_b64_tr_b16 v[216:217], v38 offset:12288
    ds_read_b64_tr_b16 v[218:219], v38 offset:12800
    s_waitcnt vmcnt(6)
    s_waitcnt lgkmcnt(10)
    v_mfma_f32_16x16x32_bf16 v[120:123], v[192:195], v[232:235], v[120:123]
    ds_read_b64_tr_b16 v[220:221], v39 offset:12288
    ds_read_b64_tr_b16 v[222:223], v39 offset:12800
    v_mfma_f32_16x16x32_bf16 v[124:127], v[196:199], v[232:235], v[124:127]
    v_xor_b32 v36, 16384, v36
    ds_read_b64_tr_b16 v[192:193], v36
    ds_read_b64_tr_b16 v[194:195], v36 offset:512
    s_waitcnt lgkmcnt(10)
    v_mfma_f32_16x16x32_bf16 v[128:131], v[200:203], v[232:235], v[128:131]
    v_xor_b32 v37, 16384, v37
    ds_read_b64_tr_b16 v[196:197], v37
    ds_read_b64_tr_b16 v[198:199], v37 offset:512
    v_mfma_f32_16x16x32_bf16 v[132:135], v[204:207], v[232:235], v[132:135]
    v_xor_b32 v38, 16384, v38
    ds_read_b64_tr_b16 v[200:201], v38
    ds_read_b64_tr_b16 v[202:203], v38 offset:512
    s_waitcnt vmcnt(5)
    s_waitcnt lgkmcnt(10)
    v_mfma_f32_16x16x32_bf16 v[120:123], v[208:211], v[236:239], v[120:123]
    v_xor_b32 v39, 16384, v39
    ds_read_b64_tr_b16 v[204:205], v39
    ds_read_b64_tr_b16 v[206:207], v39 offset:512
    v_mfma_f32_16x16x32_bf16 v[124:127], v[212:215], v[236:239], v[124:127]
    ds_read_b64_tr_b16 v[208:209], v36 offset:4096
    ds_read_b64_tr_b16 v[210:211], v36 offset:4608
    s_waitcnt lgkmcnt(10)
    v_mfma_f32_16x16x32_bf16 v[128:131], v[216:219], v[236:239], v[128:131]
    ds_read_b64_tr_b16 v[212:213], v37 offset:4096
    ds_read_b64_tr_b16 v[214:215], v37 offset:4608
    v_mfma_f32_16x16x32_bf16 v[132:135], v[220:223], v[236:239], v[132:135]
    ds_read_b64_tr_b16 v[216:217], v38 offset:4096
    ds_read_b64_tr_b16 v[218:219], v38 offset:4608
    s_waitcnt vmcnt(4)
    s_waitcnt lgkmcnt(10)
    v_mfma_f32_16x16x32_bf16 v[120:123], v[192:195], v[240:243], v[120:123]
    ds_read_b64_tr_b16 v[220:221], v39 offset:4096
    ds_read_b64_tr_b16 v[222:223], v39 offset:4608
    v_mfma_f32_16x16x32_bf16 v[124:127], v[196:199], v[240:243], v[124:127]
    ds_read_b64_tr_b16 v[192:193], v36 offset:8192
    ds_read_b64_tr_b16 v[194:195], v36 offset:8704
    s_waitcnt lgkmcnt(10)
    v_mfma_f32_16x16x32_bf16 v[128:131], v[200:203], v[240:243], v[128:131]
    ds_read_b64_tr_b16 v[196:197], v37 offset:8192
    ds_read_b64_tr_b16 v[198:199], v37 offset:8704
    v_mfma_f32_16x16x32_bf16 v[132:135], v[204:207], v[240:243], v[132:135]
    ds_read_b64_tr_b16 v[200:201], v38 offset:8192
    ds_read_b64_tr_b16 v[202:203], v38 offset:8704
    s_waitcnt vmcnt(3)
    s_waitcnt lgkmcnt(10)
    v_mfma_f32_16x16x32_bf16 v[120:123], v[208:211], v[244:247], v[120:123]
    ds_read_b64_tr_b16 v[204:205], v39 offset:8192
    ds_read_b64_tr_b16 v[206:207], v39 offset:8704
    v_mfma_f32_16x16x32_bf16 v[124:127], v[212:215], v[244:247], v[124:127]
    ds_read_b64_tr_b16 v[208:209], v36 offset:12288
    ds_read_b64_tr_b16 v[210:211], v36 offset:12800
    s_waitcnt lgkmcnt(10)
    v_mfma_f32_16x16x32_bf16 v[128:131], v[216:219], v[244:247], v[128:131]
    ds_read_b64_tr_b16 v[212:213], v37 offset:12288
    ds_read_b64_tr_b16 v[214:215], v37 offset:12800
    v_mfma_f32_16x16x32_bf16 v[132:135], v[220:223], v[244:247], v[132:135]
    ds_read_b64_tr_b16 v[216:217], v38 offset:12288
    ds_read_b64_tr_b16 v[218:219], v38 offset:12800
    s_waitcnt vmcnt(2)
    s_waitcnt lgkmcnt(10)
    v_mfma_f32_16x16x32_bf16 v[120:123], v[192:195], v[44:47], v[120:123]
    ds_read_b64_tr_b16 v[220:221], v39 offset:12288
    ds_read_b64_tr_b16 v[222:223], v39 offset:12800
    v_mfma_f32_16x16x32_bf16 v[124:127], v[196:199], v[44:47], v[124:127]
    s_waitcnt lgkmcnt(8)
    v_mfma_f32_16x16x32_bf16 v[128:131], v[200:203], v[44:47], v[128:131]
    v_mfma_f32_16x16x32_bf16 v[132:135], v[204:207], v[44:47], v[132:135]
    s_waitcnt vmcnt(1)
    s_waitcnt lgkmcnt(4)
    v_mfma_f32_16x16x32_bf16 v[120:123], v[208:211], v[48:51], v[120:123]
    v_mfma_f32_16x16x32_bf16 v[124:127], v[212:215], v[48:51], v[124:127]
    s_waitcnt lgkmcnt(0)
    v_mfma_f32_16x16x32_bf16 v[128:131], v[216:219], v[48:51], v[128:131]
    v_mfma_f32_16x16x32_bf16 v[132:135], v[220:223], v[48:51], v[132:135]
    s_lshl3_add_u32 s96, s21, s3
    s_lshl4_add_u32 s97, s96, s12
    s_lshl_b32 s98, s97, 8
    s_add_u32 s14, s98, 12582912
    v_and_b32 v28, 15, v1
    v_lshlrev_b32 v28, 4, v28
    v_lshrrev_b32 v9, 4, v1
    v_lshl_add_u32 v28, v9, 2, v28
    v_cvt_pk_bf16_f32 v120, 0, v120
    v_cvt_pk_bf16_f32 v121, 0, v121
    v_cvt_pk_bf16_f32 v122, 0, v122
    v_cvt_pk_bf16_f32 v123, 0, v123
    v_cvt_pk_bf16_f32 v124, 0, v124
    v_cvt_pk_bf16_f32 v125, 0, v125
    v_cvt_pk_bf16_f32 v126, 0, v126
    v_cvt_pk_bf16_f32 v127, 0, v127
    v_pk_mul_f32 v[120:121], v[120:121], v[136:137]
    v_pk_mul_f32 v[122:123], v[122:123], v[138:139]
    v_pk_mul_f32 v[124:125], v[124:125], v[140:141]
    v_pk_mul_f32 v[126:127], v[126:127], v[142:143]
    v_cvt_pk_bf16_f32 v120, 0, v120
    v_cvt_pk_bf16_f32 v121, 0, v121
    v_cvt_pk_bf16_f32 v122, 0, v122
    v_cvt_pk_bf16_f32 v123, 0, v123
    v_cvt_pk_bf16_f32 v124, 0, v124
    v_cvt_pk_bf16_f32 v125, 0, v125
    v_cvt_pk_bf16_f32 v126, 0, v126
    v_cvt_pk_bf16_f32 v127, 0, v127
    v_pk_add_f32 v[120:121], v[120:121], v[152:153]
    v_pk_add_f32 v[122:123], v[122:123], v[154:155]
    v_pk_add_f32 v[124:125], v[124:125], v[156:157]
    v_pk_add_f32 v[126:127], v[126:127], v[158:159]
    v_cvt_pk_bf16_f32 v12, v120, v121
    v_cvt_pk_bf16_f32 v13, v122, v123
    v_cvt_pk_bf16_f32 v14, v124, v125
    v_cvt_pk_bf16_f32 v15, v126, v127
    v_dot2_f32_bf16 v4, v12, v12, 0
    v_dot2_f32_bf16 v5, v13, v13, 0
    v_dot2_f32_bf16 v4, v14, v14, v4
    v_dot2_f32_bf16 v5, v15, v15, v5
    v_mfma_f32_16x16x32_bf16 v[240:243], v[184:187], v[12:15], 0
    v_cvt_pk_bf16_f32 v128, 0, v128
    v_cvt_pk_bf16_f32 v129, 0, v129
    v_cvt_pk_bf16_f32 v130, 0, v130
    v_cvt_pk_bf16_f32 v131, 0, v131
    v_cvt_pk_bf16_f32 v132, 0, v132
    v_cvt_pk_bf16_f32 v133, 0, v133
    v_cvt_pk_bf16_f32 v134, 0, v134
    v_cvt_pk_bf16_f32 v135, 0, v135
    v_pk_mul_f32 v[128:129], v[128:129], v[144:145]
    v_pk_mul_f32 v[130:131], v[130:131], v[146:147]
    v_pk_mul_f32 v[132:133], v[132:133], v[148:149]
    v_pk_mul_f32 v[134:135], v[134:135], v[150:151]
    v_cvt_pk_bf16_f32 v128, 0, v128
    v_cvt_pk_bf16_f32 v129, 0, v129
    v_cvt_pk_bf16_f32 v130, 0, v130
    v_cvt_pk_bf16_f32 v131, 0, v131
    v_cvt_pk_bf16_f32 v132, 0, v132
    v_cvt_pk_bf16_f32 v133, 0, v133
    v_cvt_pk_bf16_f32 v134, 0, v134
    v_cvt_pk_bf16_f32 v135, 0, v135
    v_pk_add_f32 v[128:129], v[128:129], v[160:161]
    v_pk_add_f32 v[130:131], v[130:131], v[162:163]
    v_pk_add_f32 v[132:133], v[132:133], v[164:165]
    v_pk_add_f32 v[134:135], v[134:135], v[166:167]
    v_cvt_pk_bf16_f32 v16, v128, v129
    v_cvt_pk_bf16_f32 v17, v130, v131
    v_cvt_pk_bf16_f32 v18, v132, v133
    v_cvt_pk_bf16_f32 v19, v134, v135
    v_dot2_f32_bf16 v4, v16, v16, v4
    v_dot2_f32_bf16 v5, v17, v17, v5
    v_dot2_f32_bf16 v4, v18, v18, v4
    v_dot2_f32_bf16 v5, v19, v19, v5
    v_mfma_f32_16x16x32_bf16 v[240:243], v[188:191], v[16:19], v[240:243]
    v_and_b32 v7, 7, v1
    v_lshlrev_b32 v7, 15, v7
    v_bfe_u32 v9, v1, 3, 1
    v_lshl_add_u32 v7, v9, 12, v7
    v_add_f32 v4, v4, v5
    v_mov_b32 v5, v4
    s_nop 1
    v_permlane32_swap_b32 v4, v5
    v_add_f32 v4, v4, v5
    v_mov_b32 v5, v4
    s_nop 1
    v_permlane16_swap_b32 v4, v5
    v_add_f32 v4, v4, v5
    s_nop 1
    v_mov_b32_dpp v240, v4 quad_perm:[0,1,2,3] row_mask:0x8 bank_mask:0xf
    buffer_store_dword v240, v28, s[32:35], s14 offen sc1
    s_and_b32 s96, s12, 1
    s_lshr_b32 s97, s21, 2
    s_and_b32 s98, s21, 3
    s_lshl_b32 s99, s98, 6
    s_lshl1_add_u32 s98, s97, s99
    s_lshl_b32 s97, s98, 12
    s_lshr_b32 s99, s12, 1
    s_lshl_b32 s98, s99, 6
    s_add_u32 s99, s97, s98
    s_lshl2_add_u32 s97, s96, s99
    s_add_u32 s98, s97, 1048576
    s_add_u32 s16, s98, 1536
    s_barrier
    s_cmp_lg_u32 s3, 0
    s_cbranch_scc1 L_PE
    v_mov_b32 v6, s4
    s_mov_b32 exec_hi, 0
    s_mov_b32 exec_lo, 65535
    buffer_store_dword v6, v7, s[32:35], s16 offen sc1
    s_mov_b64 exec, -1
L_PE:
    s_add_u32 s82, s80, 57344
    s_lshl2_add_u32 m0, s83, 33792
    s_nop 0
    buffer_load_dwordx4 v27, s[56:59], s82 offen nt lds
    s_add_u32 s82, s80, 114688
    s_lshl2_add_u32 m0, s83, 34816
    s_nop 0
    buffer_load_dwordx4 v27, s[56:59], s82 offen nt lds
    s_lshl_b32 s15, s3, 12
    v_add_u32 v4, s15, v2
    v_add_u32 v7, 65536, v4
    s_waitcnt vmcnt(3)
    v_cmp_ne_u32 vcc, s4, v41
    s_cbranch_vccz L_UPOK
POLL_32:
    buffer_load_dwordx2 v[40:41], v10, s[32:35], s13 offen sc1
    s_waitcnt vmcnt(0)
    v_cmp_ne_u32 vcc, s4, v41
    s_cbranch_vccz PDONE_33
    s_add_u32 s5, s5, 1
    s_cmp_lt_u32 s5, 200000
    s_cbranch_scc1 POLL_32
PDONE_33:
L_UPOK:
    s_lshl3_add_u32 s96, s21, s3
    s_lshl_b32 s97, s96, 12
    s_add_u32 s14, s97, 12582912
    s_load_dwordx2 s[24:25], s[32:33], s92 offset:1536 glc
    v_add_f32_dpp v40, v40, v40 quad_perm:[1,0,3,2] row_mask:0xf bank_mask:0xf
    s_nop 1
    v_add_f32_dpp v40, v40, v40 quad_perm:[2,3,0,1] row_mask:0xf bank_mask:0xf
    s_nop 1
    v_add_f32_dpp v40, v40, v40 row_half_mirror row_mask:0xf bank_mask:0xf
    s_nop 1
    v_add_f32_dpp v40, v40, v40 row_mirror row_mask:0xf bank_mask:0xf
    v_lshlrev_b32 v152, 16, v12
    v_and_b32 v153, s6, v12
    v_lshlrev_b32 v154, 16, v13
    v_and_b32 v155, s6, v13
    v_lshlrev_b32 v156, 16, v14
    v_and_b32 v157, s6, v14
    v_lshlrev_b32 v158, 16, v15
    v_and_b32 v159, s6, v15
    v_lshlrev_b32 v160, 16, v16
    v_and_b32 v161, s6, v16
    v_lshlrev_b32 v162, 16, v17
    v_and_b32 v163, s6, v17
    v_lshlrev_b32 v164, 16, v18
    v_and_b32 v165, s6, v18
    v_lshlrev_b32 v166, 16, v19
    v_and_b32 v167, s6, v19
    s_lshl_b32 s96, s3, 9
    s_lshl1_add_u32 s15, s21, s96
    v_and_b32 v29, 15, v1
    v_lshl_add_u32 v29, v29, 5, s15
    v_xor_b32 v5, 0x4000, v4
    v_xor_b32 v8, 0x4000, v7
    s_waitcnt vmcnt(2)
    s_cmp_ge_u32 s3, 4
    s_cbranch_scc1 L_FW0
    ds_write_b128 v4, v[56:59] offset:32768
    ds_write_b128 v5, v[60:63] offset:32768
L_FW0:
    s_cmp_lt_u32 s3, 4
    s_cbranch_scc1 L_FW1
    ds_write_b128 v4, v[56:59] offset:0
    ds_write_b128 v5, v[60:63] offset:0
    ds_write_b128 v4, v[64:67] offset:1024
    ds_write_b128 v5, v[68:71] offset:1024
    ds_write_b128 v4, v[72:75] offset:2048
    ds_write_b128 v5, v[76:79] offset:2048
    ds_write_b128 v4, v[80:83] offset:3072
    ds_write_b128 v5, v[84:87] offset:3072
L_FW1:
    s_branch SCHK_35
SPOLL_34:
    s_load_dwordx2 s[24:25], s[32:33], s92 offset:1536 glc
SCHK_35:
    s_add_u32 s5, s5, 1
    s_cmp_ge_u32 s5, 200000
    s_waitcnt lgkmcnt(0)
    s_cbranch_scc1 SDONE_36
    s_cmp_lg_u32 s24, s4
    s_cbranch_scc1 SPOLL_34
    s_cmp_lg_u32 s25, s4
    s_cbranch_scc1 SPOLL_34
SDONE_36:
    s_barrier
    buffer_load_dwordx4 v[192:195], v2, s[32:35], s14 offen sc1
    buffer_load_dwordx4 v[196:199], v2, s[32:35], s14 offen offset:1024 sc1
    buffer_load_dwordx4 v[200:203], v2, s[32:35], s14 offen offset:2048 sc1
    buffer_load_dwordx4 v[204:207], v2, s[32:35], s14 offen offset:3072 sc1
    s_barrier
    s_add_u32 s82, s80, 172032
    s_lshl2_add_u32 m0, s83, 35840
    s_nop 0
    buffer_load_dwordx4 v27, s[56:59], s82 offen nt lds
    s_mov_b32 s82, s81
    s_lshl2_add_u32 m0, s83, 65536
    s_nop 0
    buffer_load_dwordx4 v253, s[60:63], s82 offen nt lds
    s_add_u32 s82, s81, 4096
    s_lshl2_add_u32 m0, s83, 66560
L_PAD9:
    s_cbranch_execz L_RET9
    s_nop 0
    buffer_load_dwordx4 v253, s[60:63], s82 offen nt lds
    s_add_u32 s82, s81, 8192
    s_lshl2_add_u32 m0, s83, 67584
    s_nop 0
    buffer_load_dwordx4 v253, s[60:63], s82 offen nt lds
    s_lshl3_add_u32 s15, s3, 156160
    v_mov_b32 v4, s15
    v_and_b32 v5, 7, v1
    v_lshlrev_b32 v5, 3, v5
    v_add_u32 v5, 156160, v5
    v_and_b32 v6, 3, v1
    v_lshlrev_b32 v6, 18, v6
    v_bfe_u32 v9, v1, 2, 2
    v_lshl_add_u32 v6, v9, 13, v6
    s_and_b32 s96, s21, 1
    s_and_b32 s97, s12, 7
    s_lshr_b32 s98, s12, 3
    s_lshl3_add_u32 s99, s97, s98
    s_lshl_b32 s97, s99, 12
    s_lshr_b32 s98, s21, 1
    s_lshl_b32 s99, s98, 6
    s_add_u32 s98, s97, s99
    s_lshl4_add_u32 s97, s96, s98
    s_add_u32 s99, s97, 1048576
    s_add_u32 s16, s99, 2560
    s_waitcnt vmcnt(4)
    v_pk_add_f32 v[192:193], v[192:193], v[196:197]
    v_pk_add_f32 v[200:201], v[200:201], v[204:205]
    v_pk_add_f32 v[194:195], v[194:195], v[198:199]
    v_pk_add_f32 v[202:203], v[202:203], v[206:207]
    v_pk_add_f32 v[192:193], v[192:193], v[200:201]
    v_pk_add_f32 v[194:195], v[194:195], v[202:203]
    v_add_f32 v193, v193, v194
    v_add_f32 v197, v192, v195
    v_cmp_u_f32 vcc, v193, v197
    s_cbranch_vccz POK_38
PRE_39:
    buffer_load_dwordx4 v[192:195], v2, s[32:35], s14 offen sc1
    buffer_load_dwordx4 v[196:199], v2, s[32:35], s14 offen offset:1024 sc1
    buffer_load_dwordx4 v[200:203], v2, s[32:35], s14 offen offset:2048 sc1
    buffer_load_dwordx4 v[204:207], v2, s[32:35], s14 offen offset:3072 sc1
    s_waitcnt vmcnt(0)
    v_pk_add_f32 v[192:193], v[192:193], v[196:197]
    v_pk_add_f32 v[200:201], v[200:201], v[204:205]
    v_pk_add_f32 v[194:195], v[194:195], v[198:199]
    v_pk_add_f32 v[202:203], v[202:203], v[206:207]
    v_pk_add_f32 v[192:193], v[192:193], v[200:201]
    v_pk_add_f32 v[194:195], v[194:195], v[202:203]
    v_add_f32 v193, v193, v194
    v_add_f32 v197, v192, v195
    v_cmp_u_f32 vcc, v193, v197
    s_cbranch_vccz POK_38
    s_add_u32 s5, s5, 1
    s_cmp_lt_u32 s5, 200000
    s_cbranch_scc1 PRE_39
POK_38:
    v_mov_b32 v196, v195
    s_nop 1
    v_permlane32_swap_b32 v195, v196
    v_permlane32_swap_b32 v192, v193
    v_add_f32 v195, v195, v196
    v_add_f32 v192, v192, v193
    s_nop 1
    v_permlane16_swap_b32 v192, v195
    v_add_f32 v193, v192, v195
    v_add_f32 v195, v192, v195
    s_nop 1
    v_permlane16_swap_b32 v193, v195
    v_mov_b32 v192, v193
    v_mul_f32 v195, 0x3a800000, v195
    s_nop 0
    v_permlane32_swap_b32 v192, v193
    v_mul_f32 v192, 0x3a800000, v192
    v_fma_f32 v31, -v192, v192, v195
    v_cvt_pk_bf16_f32 v30, 0, v192
    v_max_f32 v31, 0, v31
    v_cvt_pk_bf16_f32 v31, 0, v31
    v_fma_f32 v193, -v30, v40, v193
    v_add_f32 v31, 0x3727c5ac, v31
    v_cvt_pk_bf16_f32 v31, 0, v31
    v_sqrt_f32 v31, v31
    s_nop 0
    v_cvt_pk_bf16_f32 v31, 0, v31
    v_rcp_f32 v31, v31
    s_nop 0
    v_mul_f32 v32, v193, v31
    v_ashrrev_i32 v196, 31, v32
    v_or_b32 v196, 0x80000000, v196
    v_xor_b32 v32, v32, v196
    s_mov_b32 s15, 0xfffff000
    v_and_or_b32 v32, v32, s15, v29
    s_nop 1
    v_max_u32_dpp v244, v32, v32 quad_perm:[1,0,3,2] row_mask:0xf bank_mask:0xf
    v_min_u32_dpp v245, v32, v32 quad_perm:[1,0,3,2] row_mask:0xf bank_mask:0xf
    s_nop 0
    v_min_u32_dpp v196, v244, v244 quad_perm:[2,3,0,1] row_mask:0xf bank_mask:0xf
    v_max_u32_dpp v245, v245, v245 quad_perm:[2,3,0,1] row_mask:0xf bank_mask:0xf
    v_max_u32_dpp v244, v244, v244 quad_perm:[2,3,0,1] row_mask:0xf bank_mask:0xf
    v_max_u32 v245, v245, v196
    s_nop 0
    v_min_u32_dpp v196, v244, v244 row_half_mirror row_mask:0xf bank_mask:0xf
    v_max_u32_dpp v245, v245, v245 row_half_mirror row_mask:0xf bank_mask:0xf
    v_max_u32_dpp v244, v244, v244 row_half_mirror row_mask:0xf bank_mask:0xf
    v_max_u32 v245, v245, v196
    s_nop 0
    v_min_u32_dpp v196, v244, v244 row_mirror row_mask:0xf bank_mask:0xf
    v_max_u32_dpp v245, v245, v245 row_mirror row_mask:0xf bank_mask:0xf
    v_max_u32_dpp v244, v244, v244 row_mirror row_mask:0xf bank_mask:0xf
    v_max_u32 v245, v245, v196
    ds_write_b64 v4, v[244:245]
    s_waitcnt lgkmcnt(0)
    s_barrier
    ds_read_b64 v[244:245], v5
    v_pk_add_f32 v[208:209], v[152:153], v[30:31] op_sel_hi:[1,0] neg_lo:[0,1] neg_hi:[0,1]
    v_pk_add_f32 v[210:211], v[154:155], v[30:31] op_sel_hi:[1,0] neg_lo:[0,1] neg_hi:[0,1]
    v_pk_add_f32 v[212:213], v[156:157], v[30:31] op_sel_hi:[1,0] neg_lo:[0,1] neg_hi:[0,1]
    v_pk_add_f32 v[214:215], v[158:159], v[30:31] op_sel_hi:[1,0] neg_lo:[0,1] neg_hi:[0,1]
    v_pk_add_f32 v[216:217], v[160:161], v[30:31] op_sel_hi:[1,0] neg_lo:[0,1] neg_hi:[0,1]
    v_pk_add_f32 v[218:219], v[162:163], v[30:31] op_sel_hi:[1,0] neg_lo:[0,1] neg_hi:[0,1]
    v_pk_add_f32 v[220:221], v[164:165], v[30:31] op_sel_hi:[1,0] neg_lo:[0,1] neg_hi:[0,1]
    v_pk_add_f32 v[222:223], v[166:167], v[30:31] op_sel_hi:[1,0] neg_lo:[0,1] neg_hi:[0,1]
    s_waitcnt lgkmcnt(0)
    v_min_u32_dpp v196, v244, v244 quad_perm:[1,0,3,2] row_mask:0xf bank_mask:0xf
    v_max_u32_dpp v245, v245, v245 quad_perm:[1,0,3,2] row_mask:0xf bank_mask:0xf
    v_max_u32_dpp v244, v244, v244 quad_perm:[1,0,3,2] row_mask:0xf bank_mask:0xf
    v_max_u32 v245, v245, v196
    s_nop 0
    v_min_u32_dpp v196, v244, v244 quad_perm:[2,3,0,1] row_mask:0xf bank_mask:0xf
    v_max_u32_dpp v245, v245, v245 quad_perm:[2,3,0,1] row_mask:0xf bank_mask:0xf
    v_max_u32_dpp v244, v244, v244 quad_perm:[2,3,0,1] row_mask:0xf bank_mask:0xf
    v_max_u32 v245, v245, v196
    s_nop 0
    v_min_u32_dpp v196, v244, v244 row_half_mirror row_mask:0xf bank_mask:0xf
    v_max_u32_dpp v245, v245, v245 row_half_mirror row_mask:0xf bank_mask:0xf
    v_max_u32_dpp v244, v244, v244 row_half_mirror row_mask:0xf bank_mask:0xf
    v_max_u32 v245, v245, v196
    v_cmp_eq_u32 s[88:89], v32, v245
    v_cmp_eq_u32 vcc, v32, v244
    v_or_b32 v246, 1, v245
    v_mov_b32 v245, s4
    v_mov_b32 v247, s4
    s_or_b64 s[84:85], vcc, s[88:89]
    s_cmp_lg_u32 s3, 0
    s_cbranch_scc1 L_NOF
    s_mov_b64 exec, 0xffff
    buffer_store_dwordx4 v[244:247], v6, s[32:35], s16 offen sc1
    s_mov_b64 exec, -1
L_NOF:
    s_lshl4_add_u32 s13, s3, 156288
    v_mov_b32 v4, s13
    v_and_b32 v5, 7, v1
    v_lshlrev_b32 v5, 4, v5
    v_add_u32 v5, 156288, v5
    s_load_dwordx8 s[24:31], s[32:33], s92 offset:2560 glc
    v_cvt_pk_bf16_f32 v208, 0, v208
    v_cvt_pk_bf16_f32 v209, 0, v209
    v_cvt_pk_bf16_f32 v210, 0, v210
    v_cvt_pk_bf16_f32 v211, 0, v211
    v_cvt_pk_bf16_f32 v212, 0, v212
    v_cvt_pk_bf16_f32 v213, 0, v213
    v_cvt_pk_bf16_f32 v214, 0, v214
    v_cvt_pk_bf16_f32 v215, 0, v215
    v_cvt_pk_bf16_f32 v216, 0, v216
    v_cvt_pk_bf16_f32 v217, 0, v217
    v_cvt_pk_bf16_f32 v218, 0, v218
    v_cvt_pk_bf16_f32 v219, 0, v219
    v_cvt_pk_bf16_f32 v220, 0, v220
    v_cvt_pk_bf16_f32 v221, 0, v221
    v_cvt_pk_bf16_f32 v222, 0, v222
    v_cvt_pk_bf16_f32 v223, 0, v223
    v_pk_mul_f32 v[208:209], v[208:209], v[30:31] op_sel:[0,1]
    v_pk_mul_f32 v[210:211], v[210:211], v[30:31] op_sel:[0,1]
    v_pk_mul_f32 v[212:213], v[212:213], v[30:31] op_sel:[0,1]
    v_pk_mul_f32 v[214:215], v[214:215], v[30:31] op_sel:[0,1]
    v_pk_mul_f32 v[216:217], v[216:217], v[30:31] op_sel:[0,1]
    v_pk_mul_f32 v[218:219], v[218:219], v[30:31] op_sel:[0,1]
    v_pk_mul_f32 v[220:221], v[220:221], v[30:31] op_sel:[0,1]
    v_pk_mul_f32 v[222:223], v[222:223], v[30:31] op_sel:[0,1]
    v_cvt_pk_bf16_f32 v208, 0, v208
    v_cvt_pk_bf16_f32 v209, 0, v209
    v_cvt_pk_bf16_f32 v210, 0, v210
    v_cvt_pk_bf16_f32 v211, 0, v211
    v_cvt_pk_bf16_f32 v212, 0, v212
    v_cvt_pk_bf16_f32 v213, 0, v213
    v_cvt_pk_bf16_f32 v214, 0, v214
    v_cvt_pk_bf16_f32 v215, 0, v215
    v_cvt_pk_bf16_f32 v216, 0, v216
    v_cvt_pk_bf16_f32 v217, 0, v217
    v_cvt_pk_bf16_f32 v218, 0, v218
    v_cvt_pk_bf16_f32 v219, 0, v219
    v_cvt_pk_bf16_f32 v220, 0, v220
    v_cvt_pk_bf16_f32 v221, 0, v221
    v_cvt_pk_bf16_f32 v222, 0, v222
    v_cvt_pk_bf16_f32 v223, 0, v223
    v_pk_mul_f32 v[208:209], v[208:209], v[168:169]
    v_pk_mul_f32 v[210:211], v[210:211], v[170:171]
    v_pk_mul_f32 v[212:213], v[212:213], v[172:173]
    v_pk_mul_f32 v[214:215], v[214:215], v[174:175]
    v_pk_mul_f32 v[216:217], v[216:217], v[176:177]
    v_pk_mul_f32 v[218:219], v[218:219], v[178:179]
    v_pk_mul_f32 v[220:221], v[220:221], v[180:181]
    v_pk_mul_f32 v[222:223], v[222:223], v[182:183]
    v_cvt_pk_bf16_f32 v208, 0, v208
    v_cvt_pk_bf16_f32 v209, 0, v209
    v_cvt_pk_bf16_f32 v210, 0, v210
    v_cvt_pk_bf16_f32 v211, 0, v211
    v_cvt_pk_bf16_f32 v212, 0, v212
    v_cvt_pk_bf16_f32 v213, 0, v213
    v_cvt_pk_bf16_f32 v214, 0, v214
    v_cvt_pk_bf16_f32 v215, 0, v215
    v_cvt_pk_bf16_f32 v216, 0, v216
    v_cvt_pk_bf16_f32 v217, 0, v217
    v_cvt_pk_bf16_f32 v218, 0, v218
    v_cvt_pk_bf16_f32 v219, 0, v219
    v_cvt_pk_bf16_f32 v220, 0, v220
    v_cvt_pk_bf16_f32 v221, 0, v221
    v_cvt_pk_bf16_f32 v222, 0, v222
    v_cvt_pk_bf16_f32 v223, 0, v223
    v_pk_add_f32 v[208:209], v[208:209], v[88:89]
    v_pk_add_f32 v[210:211], v[210:211], v[90:91]
    v_pk_add_f32 v[212:213], v[212:213], v[92:93]
    v_pk_add_f32 v[214:215], v[214:215], v[94:95]
    v_pk_add_f32 v[216:217], v[216:217], v[96:97]
    v_pk_add_f32 v[218:219], v[218:219], v[98:99]
    v_pk_add_f32 v[220:221], v[220:221], v[100:101]
    v_pk_add_f32 v[222:223], v[222:223], v[102:103]
    v_cvt_pk_bf16_f32 v224, v208, v209
    v_cvt_pk_bf16_f32 v225, v210, v211
    v_cvt_pk_bf16_f32 v226, v212, v213
    v_cvt_pk_bf16_f32 v227, v214, v215
    v_cvt_pk_bf16_f32 v228, v216, v217
    v_cvt_pk_bf16_f32 v229, v218, v219
    v_cvt_pk_bf16_f32 v230, v220, v221
    v_cvt_pk_bf16_f32 v231, v222, v223
    s_cmp_eq_u64 s[84:85], 0
    s_cbranch_scc1 L_NOCAND
    v_mfma_f32_16x16x32_bf16 v[240:243], v[184:187], v[224:227], 0
    v_mfma_f32_16x16x32_bf16 v[240:243], v[188:191], v[228:231], v[240:243]
    v_mov_b32 v232, v224
    v_mov_b32 v233, v225
    v_mov_b32 v234, v226
    v_mov_b32 v235, v227
    v_mov_b32 v236, v228
    v_mov_b32 v237, v229
    v_mov_b32 v238, v230
    v_mov_b32 v239, v231
    s_lshl_b32 s96, s21, 14
    s_lshl_b32 s97, s12, 9
    s_add_u32 s98, s96, s97
    s_add_u32 s15, s98, 13631488
    v_lshrrev_b32 v7, 4, v1
    v_lshlrev_b32 v7, 4, v7
    v_add_u32 v8, 8192, v7
    v_permlane32_swap_b32 v232, v234
    v_permlane32_swap_b32 v233, v235
    v_permlane32_swap_b32 v236, v238
    v_permlane32_swap_b32 v237, v239
    v_permlane32_swap_b32 v12, v14
    v_permlane32_swap_b32 v13, v15
    v_permlane32_swap_b32 v16, v18
    v_permlane32_swap_b32 v17, v19
    v_cndmask_b32 v7, v7, v8, s[88:89]
    s_mov_b64 exec, s[84:85]
    buffer_store_dwordx4 v[232:235], v7, s[32:35], s15 offen sc1
    buffer_store_dwordx4 v[236:239], v7, s[32:35], s15 offen offset:64 sc1
    s_mov_b32 exec_lo, 0
    s_and_b32 exec_hi, s85, 0xffff0000
    buffer_store_dword v240, v7, s[32:35], s15 offen offset:208 sc1
    s_mov_b64 exec, s[84:85]
    buffer_store_dwordx4 v[12:15], v7, s[32:35], s15 offen offset:128 sc1
    buffer_store_dwordx4 v[16:19], v7, s[32:35], s15 offen offset:192 sc1
    s_mov_b64 exec, -1
L_NOCAND:
    s_add_u32 s82, s81, 12288
    s_lshl2_add_u32 m0, s83, 68608
    s_nop 0
    buffer_load_dwordx4 v253, s[60:63], s82 offen nt lds
    v_lshlrev_b32 v208, 16, v224
    v_and_b32 v209, s6, v224
    v_lshlrev_b32 v210, 16, v225
    v_and_b32 v211, s6, v225
    v_lshlrev_b32 v212, 16, v226
    v_and_b32 v213, s6, v226
    v_lshlrev_b32 v214, 16, v227
    v_and_b32 v215, s6, v227
    v_lshlrev_b32 v216, 16, v228
    v_and_b32 v217, s6, v228
    v_lshlrev_b32 v218, 16, v229
    v_and_b32 v219, s6, v229
    v_lshlrev_b32 v220, 16, v230
    v_and_b32 v221, s6, v230
    v_lshlrev_b32 v222, 16, v231
    v_and_b32 v223, s6, v231
    v_pk_mul_f32 v[208:209], v[208:209], v[104:105]
    v_pk_mul_f32 v[210:211], v[210:211], v[106:107]
    v_pk_mul_f32 v[212:213], v[212:213], v[108:109]
    v_pk_mul_f32 v[214:215], v[214:215], v[110:111]
    v_pk_mul_f32 v[216:217], v[216:217], v[112:113]
    v_pk_mul_f32 v[218:219], v[218:219], v[114:115]
    v_pk_mul_f32 v[220:221], v[220:221], v[116:117]
    v_pk_mul_f32 v[222:223], v[222:223], v[118:119]
    v_cvt_pk_bf16_f32 v208, 0, v208
    v_cvt_pk_bf16_f32 v209, 0, v209
    v_cvt_pk_bf16_f32 v210, 0, v210
    v_cvt_pk_bf16_f32 v211, 0, v211
    v_cvt_pk_bf16_f32 v212, 0, v212
    v_cvt_pk_bf16_f32 v213, 0, v213
    v_cvt_pk_bf16_f32 v214, 0, v214
    v_cvt_pk_bf16_f32 v215, 0, v215
    v_cvt_pk_bf16_f32 v216, 0, v216
    v_cvt_pk_bf16_f32 v217, 0, v217
    v_cvt_pk_bf16_f32 v218, 0, v218
    v_cvt_pk_bf16_f32 v219, 0, v219
    v_cvt_pk_bf16_f32 v220, 0, v220
    v_cvt_pk_bf16_f32 v221, 0, v221
    v_cvt_pk_bf16_f32 v222, 0, v222
    v_cvt_pk_bf16_f32 v223, 0, v223
    s_lshl_b32 s96, s3, 11
    s_add_u32 s13, s96, 98304
    v_lshrrev_b32 v202, 4, v1
    v_lshlrev_b32 v202, 4, v202
    v_and_b32 v203, 7, v1
    v_lshlrev_b32 v203, 4, v203
    v_xor_b32 v202, v202, v203
    v_and_b32 v204, 15, v1
    v_lshl_add_u32 v204, v204, 7, s13
    v_add_u32 v202, v202, v204
    v_xor_b32 v204, 64, v202
    v_lshrrev_b32 v205, 3, v1
    v_lshlrev_b32 v205, 4, v205
    v_xor_b32 v203, v205, v203
    v_lshrrev_b32 v205, 3, v1
    v_lshl_add_u32 v205, v205, 7, s13
    v_add_u32 v203, v203, v205
    s_lshl_b32 s96, s21, 7
    s_sub_u32 s97, 2047, s96
    s_lshl_b32 s98, s3, 4
    s_sub_u32 s13, s97, s98
    v_lshrrev_b32 v43, 3, v1
    v_sub_u32 v42, s13, v43
    v_subrev_u32 v43, 8, v42
    v_lshrrev_b32 v33, 3, v1
    v_lshlrev_b32 v33, 11, v33
    v_and_b32 v9, 7, v1
    v_lshl_add_u32 v33, v9, 4, v33
    s_lshl3_add_u32 s96, s21, s3
    s_lshl_b32 s97, s96, 15
    s_lshl_b32 s98, s12, 7
    s_add_u32 s16, s97, s98
    s_add_u32 s15, s16, 16384
    s_branch SCHK_41
SPOLL_40:
    s_load_dwordx8 s[24:31], s[32:33], s92 offset:2560 glc
SCHK_41:
    s_add_u32 s5, s5, 1
    s_cmp_ge_u32 s5, 200000
    s_waitcnt lgkmcnt(0)
    s_cbranch_scc1 SDONE_42
    s_cmp_lg_u32 s25, s4
    s_cbranch_scc1 SPOLL_40
    s_cmp_lg_u32 s27, s4
    s_cbranch_scc1 SPOLL_40
    s_cmp_lg_u32 s29, s4
    s_cbranch_scc1 SPOLL_40
    s_cmp_lg_u32 s31, s4
    s_cbranch_scc1 SPOLL_40
SDONE_42:
    s_min_u32 s25, s24, s28
    s_min_u32 s27, s26, s28
    s_min_u32 s29, s24, s30
    s_max_u32 s24, s24, s28
    s_max_u32 s26, s26, s30
    s_max_u32 s27, s27, s29
    s_max_u32 s25, s25, s26
    v_mov_b32 v244, s24
    v_mov_b32 v246, s27
    v_mov_b32 v245, s25
    ds_write_b128 v4, v[244:247]
    s_lshr_b32 s96, s3, 2
    s_lshl_b32 s97, s96, 15
    s_and_b32 s98, s3, 3
    s_lshl_b32 s99, s98, 5
    s_add_u32 s13, s97, s99
    v_lshrrev_b32 v34, 4, v1
    v_lshlrev_b32 v34, 13, v34
    v_bfe_u32 v9, v1, 2, 2
    v_lshl_add_u32 v34, v9, 7, v34
    v_bfe_u32 v9, v1, 3, 2
    v_lshl_add_u32 v34, v9, 5, v34
    v_and_b32 v9, 3, v1
    v_lshl_add_u32 v34, v9, 3, v34
    v_xor_b32 v34, s13, v34
    s_lshl_b32 s96, s75, 11
    s_add_u32 s13, s96, 13631488
    v_and_b32 v36, 7, v1
    v_lshl_add_u32 v36, v36, 4, s13
    v_lshrrev_b32 v9, 4, v1
    v_lshl_add_u32 v36, v9, 9, v36
    v_and_b32 v10, 15, v1
    v_lshlrev_b32 v10, 9, v10
    v_add_u32 v10, 13631744, v10
    s_waitcnt vmcnt(0)
    s_waitcnt lgkmcnt(0)
    s_barrier
    ds_read_b128 v[244:247], v5
    v_and_b32 v8, 8, v1
    v_cmp_eq_u32 s[22:23], 0, v8
    v_cmp_gt_u32 s[24:25], 16, v1
    v_cmp_gt_u32 s[26:27], 32, v1
    s_waitcnt lgkmcnt(0)
    v_min_u32_dpp v192, v244, v244 quad_perm:[1,0,3,2] row_mask:0xf bank_mask:0xf
    v_min_u32_dpp v193, v245, v244 quad_perm:[1,0,3,2] row_mask:0xf bank_mask:0xf
    v_min_u32_dpp v194, v244, v245 quad_perm:[1,0,3,2] row_mask:0xf bank_mask:0xf
    v_max_u32_dpp v246, v246, v246 quad_perm:[1,0,3,2] row_mask:0xf bank_mask:0xf
    v_max_u32_dpp v245, v245, v245 quad_perm:[1,0,3,2] row_mask:0xf bank_mask:0xf
    v_max_u32_dpp v244, v244, v244 quad_perm:[1,0,3,2] row_mask:0xf bank_mask:0xf
    v_max3_u32 v246, v246, v193, v194
    v_max_u32 v245, v245, v192
    v_min_u32_dpp v192, v244, v244 quad_perm:[2,3,0,1] row_mask:0xf bank_mask:0xf
    s_nop 0
    v_min_u32_dpp v193, v245, v244 quad_perm:[2,3,0,1] row_mask:0xf bank_mask:0xf
    v_min_u32_dpp v194, v244, v245 quad_perm:[2,3,0,1] row_mask:0xf bank_mask:0xf
    v_max_u32_dpp v246, v246, v246 quad_perm:[2,3,0,1] row_mask:0xf bank_mask:0xf
    v_max_u32_dpp v245, v245, v245 quad_perm:[2,3,0,1] row_mask:0xf bank_mask:0xf
    v_max_u32_dpp v244, v244, v244 quad_perm:[2,3,0,1] row_mask:0xf bank_mask:0xf
    v_max3_u32 v246, v246, v193, v194
    v_max_u32 v245, v245, v192
    v_min_u32_dpp v192, v244, v244 row_half_mirror row_mask:0xf bank_mask:0xf
    s_nop 0
    v_min_u32_dpp v193, v245, v244 row_half_mirror row_mask:0xf bank_mask:0xf
    v_min_u32_dpp v194, v244, v245 row_half_mirror row_mask:0xf bank_mask:0xf
    v_max_u32_dpp v246, v246, v246 row_half_mirror row_mask:0xf bank_mask:0xf
    v_max_u32_dpp v245, v245, v245 row_half_mirror row_mask:0xf bank_mask:0xf
    v_max_u32_dpp v244, v244, v244 row_half_mirror row_mask:0xf bank_mask:0xf
    v_max3_u32 v246, v246, v193, v194
    v_max_u32 v245, v245, v192
    v_cndmask_b32 v192, v245, v244, s[22:23]
    v_cndmask_b32 v201, v246, v245, s[26:27]
    v_and_b32 v193, 31, v246
    v_and_b32 v192, 31, v192
    v_cndmask_b32 v201, v201, v244, s[24:25]
    v_lshl_add_u32 v4, v192, 13, v36
    v_lshl_add_u32 v5, v193, 13, v36
    v_and_b32 v194, 31, v201
    v_lshl_add_u32 v6, v194, 13, v10
    buffer_load_dwordx4 v[192:195], v4, s[32:35], 0 offen sc1
    buffer_load_dwordx4 v[196:199], v5, s[32:35], 0 offen sc1
    buffer_load_dword v200, v6, s[32:35], 0 offen sc1
    s_barrier
    v_readfirstlane_b32 s91, v244
    v_readfirstlane_b32 s94, v245
    v_readfirstlane_b32 s95, v246
    ds_read_b64_tr_b16 v[56:57], v34
    ds_read_b64_tr_b16 v[58:59], v34 offset:512
    ds_read_b64_tr_b16 v[60:61], v34 offset:1024
    ds_read_b64_tr_b16 v[62:63], v34 offset:1536
    ds_read_b64_tr_b16 v[64:65], v34 offset:2048
    ds_read_b64_tr_b16 v[66:67], v34 offset:2560
    ds_read_b64_tr_b16 v[68:69], v34 offset:3072
    ds_read_b64_tr_b16 v[70:71], v34 offset:3584
    ds_read_b64_tr_b16 v[72:73], v34 offset:4096
    ds_read_b64_tr_b16 v[74:75], v34 offset:4608
    ds_read_b64_tr_b16 v[76:77], v34 offset:5120
    ds_read_b64_tr_b16 v[78:79], v34 offset:5632
    ds_read_b64_tr_b16 v[80:81], v34 offset:6144
    ds_read_b64_tr_b16 v[82:83], v34 offset:6656
    ds_read_b64_tr_b16 v[84:85], v34 offset:7168
    ds_read_b64_tr_b16 v[86:87], v34 offset:7680
    s_bfe_u32 s96, s91, 262145
    s_lshl_b32 s97, s96, 7
    s_bfe_u32 s98, s91, 458757
    s_add_u32 s99, s97, s98
    s_xor_b32 s17, s99, 2047
    s_bfe_u32 s96, s94, 262145
    s_lshl_b32 s97, s96, 7
    s_bfe_u32 s98, s94, 458757
    s_add_u32 s99, s97, s98
    s_xor_b32 s18, s99, 2047
    s_bfe_u32 s96, s95, 262145
    s_lshl_b32 s97, s96, 7
    s_bfe_u32 s98, s95, 458757
    s_add_u32 s99, s97, s98
    s_xor_b32 s19, s99, 2047
    s_waitcnt lgkmcnt(0)
    s_lshl_b32 s13, s3, 6
    v_bfe_u32 v35, v1, 2, 1
    v_lshlrev_b32 v35, 9, v35
    v_bfe_u32 v9, v1, 3, 1
    v_lshl_add_u32 v35, v9, 12, v35
    v_lshrrev_b32 v9, 5, v1
    v_lshl_add_u32 v35, v9, 11, v35
    v_bfe_u32 v9, v1, 2, 2
    v_lshl_add_u32 v35, v9, 6, v35
    v_bfe_u32 v9, v1, 4, 1
    v_lshl_add_u32 v35, v9, 5, v35
    v_and_b32 v9, 3, v1
    v_lshl_add_u32 v35, v9, 3, v35
    v_xor_b32 v35, s13, v35
    v_add_u32 v35, 65536, v35
    v_and_b32 v8, 15, v1
    v_lshlrev_b32 v8, 4, v8
    v_lshrrev_b32 v9, 5, v1
    v_lshl_add_u32 v8, v9, 3, v8
    s_lshl_b32 s96, s74, 13
    s_add_u32 s14, s96, 20971520
    s_lshl3_add_u32 s96, s75, s3
    s_lshl_b32 s97, s96, 8
    s_add_u32 s20, s97, s14
    v_bfe_u32 v7, v201, 1, 4
    v_bfe_u32 v201, v201, 5, 7
    v_lshl_or_b32 v201, v7, 7, v201
    v_xor_b32 v201, 0x7ff, v201
    s_waitcnt vmcnt(0)
    v_max3_u32 v7, v192, v196, v200
    v_cmp_eq_u32 vcc, -1, v7
    s_cbranch_vccz POK_44
PRE_45:
    buffer_load_dwordx4 v[192:195], v4, s[32:35], 0 offen sc1
    buffer_load_dwordx4 v[196:199], v5, s[32:35], 0 offen sc1
    buffer_load_dword v200, v6, s[32:35], 0 offen sc1
    s_waitcnt vmcnt(0)
    v_max3_u32 v7, v192, v196, v200
    v_cmp_eq_u32 vcc, -1, v7
    s_cbranch_vccz POK_44
    s_add_u32 s5, s5, 1
    s_cmp_lt_u32 s5, 200000
    s_cbranch_scc1 PRE_45
POK_44:
    v_add_f32_dpp v200, v200, v200 quad_perm:[1,0,3,2] row_mask:0xf bank_mask:0xf
    s_nop 1
    v_add_f32_dpp v200, v200, v200 quad_perm:[2,3,0,1] row_mask:0xf bank_mask:0xf
    s_nop 1
    v_add_f32_dpp v200, v200, v200 row_half_mirror row_mask:0xf bank_mask:0xf
    s_nop 1
    v_add_f32_dpp v200, v200, v200 row_mirror row_mask:0xf bank_mask:0xf
    v_cvt_pk_bf16_f32 v200, 0, v200
    v_ashrrev_i32 v7, 31, v200
    v_or_b32 v7, 0x80000000, v7
    v_xor_b32 v200, v200, v7
    v_lshrrev_b32 v200, 16, v200
    v_lshl_or_b32 v200, v200, 11, v201
    s_nop 0
    v_readlane_b32 s24, v200, 0
    v_readlane_b32 s25, v200, 16
    v_readlane_b32 s26, v200, 32
    s_not_b64 s[28:29], s[22:23]
    s_cmp_lt_u32 s24, s25
    s_cselect_b64 s[28:29], s[22:23], s[28:29]
    s_cselect_b32 s27, s24, s25
    s_cmp_gt_u32 s26, s27
    s_cselect_b64 vcc, s[28:29], 0
    v_cndmask_b32 v192, v192, v196, vcc
    v_cndmask_b32 v193, v193, v197, vcc
    v_cndmask_b32 v194, v194, v198, vcc
    v_cndmask_b32 v195, v195, v199, vcc
    s_bitcmp1_b32 vcc_lo, 0
    s_cselect_b32 s24, s26, s24
    s_cselect_b32 s19, s17, s19
    s_cselect_b32 s17, s95, s91
    s_bitcmp1_b32 vcc_lo, 8
    s_cselect_b32 s25, s26, s25
    s_cselect_b32 s19, s18, s19
    s_cselect_b32 s18, s95, s94
    s_waitcnt lgkmcnt(0)
    v_mfma_f32_16x16x32_bf16 v[136:139], v[192:195], v[56:59], 0
    v_mfma_f32_16x16x32_bf16 v[140:143], v[192:195], v[60:63], 0
    v_mfma_f32_16x16x32_bf16 v[144:147], v[192:195], v[64:67], 0
    v_mfma_f32_16x16x32_bf16 v[148:151], v[192:195], v[68:71], 0
    v_mfma_f32_16x16x32_bf16 v[168:171], v[192:195], v[72:75], 0
    v_mfma_f32_16x16x32_bf16 v[172:175], v[192:195], v[76:79], 0
    v_mfma_f32_16x16x32_bf16 v[176:179], v[192:195], v[80:83], 0
    v_mfma_f32_16x16x32_bf16 v[180:183], v[192:195], v[84:87], 0
    s_nop 1
    v_add_f32 v196, v136, v141
    s_nop 0
    v_add_f32 v197, v146, v151
    s_nop 0
    v_add_f32 v198, v168, v173
    s_nop 0
    v_add_f32 v199, v178, v183
    v_add_f32 v196, v196, v197
    v_add_f32 v198, v198, v199
    v_mov_b32 v197, s4
    s_nop 0
    v_permlane16_swap_b32 v198, v199
    s_cmp_ge_u32 s9, 28
    s_cbranch_scc1 L_NOHP
    v_add_f32 v196, v196, v199
    s_mov_b32 exec_lo, 0xffff
    s_mov_b32 exec_hi, 0xffff
    buffer_store_dwordx2 v[196:197], v8, s[32:35], s20 offen sc1
    s_mov_b64 exec, -1
L_NOHP:
    ds_read_b64_tr_b16 v[120:121], v35
    ds_read_b64_tr_b16 v[122:123], v35 offset:1024
    ds_read_b64_tr_b16 v[124:125], v35 offset:8192
    ds_read_b64_tr_b16 v[126:127], v35 offset:9216
    ds_read_b64_tr_b16 v[128:129], v35 offset:16384
    ds_read_b64_tr_b16 v[130:131], v35 offset:17408
    ds_read_b64_tr_b16 v[132:133], v35 offset:24576
    ds_read_b64_tr_b16 v[134:135], v35 offset:25600
    s_and_b32 s68, s24, 2047
    s_and_b32 s69, s25, 2047
    s_mov_b32 s70, s16
    s_mov_b32 s71, s15
    v_pk_add_f32 v[208:209], v[208:209], v[152:153]
    v_pk_add_f32 v[210:211], v[210:211], v[154:155]
    v_pk_add_f32 v[212:213], v[212:213], v[156:157]
    v_pk_add_f32 v[214:215], v[214:215], v[158:159]
    v_pk_add_f32 v[216:217], v[216:217], v[160:161]
    v_pk_add_f32 v[218:219], v[218:219], v[162:163]
    v_pk_add_f32 v[220:221], v[220:221], v[164:165]
    v_pk_add_f32 v[222:223], v[222:223], v[166:167]
    v_cvt_pk_bf16_f32 v232, v208, v209
    v_cvt_pk_bf16_f32 v233, v210, v211
    v_cvt_pk_bf16_f32 v234, v212, v213
    v_cvt_pk_bf16_f32 v235, v214, v215
    v_cvt_pk_bf16_f32 v236, v216, v217
    v_cvt_pk_bf16_f32 v237, v218, v219
    v_cvt_pk_bf16_f32 v238, v220, v221
    v_cvt_pk_bf16_f32 v239, v222, v223
    v_permlane32_swap_b32 v232, v234
    v_permlane32_swap_b32 v233, v235
    v_permlane32_swap_b32 v236, v238
    v_permlane32_swap_b32 v237, v239
    ds_write_b128 v202, v[232:235]
    ds_write_b128 v204, v[236:239]
    ds_read_b128 v[232:235], v203
    ds_read_b128 v[236:239], v203 offset:1024
    s_waitcnt lgkmcnt(0)
    s_cmp_lg_u32 s93, 7
    s_cbranch_scc1 L_NONON
    v_mov_b32 v6, s4
    v_mov_b32 v7, 0
    s_mov_b64 exec, 1
    buffer_store_dword v6, v7, s[32:35], 0 offen sc1
    s_mov_b64 exec, -1
L_NONON:
    s_cmp_ge_u32 s9, 28
    s_cbranch_scc1 L_FIN2
    s_cmp_lg_u32 s3, 7
    s_cbranch_scc1 L_NOFZ
    s_bitcmp1_b32 s9, 3
    s_cselect_b32 s15, s25, s24
    s_cselect_b32 s17, s18, s17
    s_andn2_b32 s18, 2047, s15
    s_lshr_b32 s96, s8, 1
    s_lshl2_add_u32 s19, s12, s96
    s_lshr_b32 s96, s19, 1
    s_lshr_b32 s97, s9, 3
    s_lshl_b32 s98, s97, 1
    s_lshl2_add_u32 s99, s96, s98
    s_and_b32 s97, s19, 1
    s_add_u32 s96, s99, s97
    s_mul_i32 s98, s96, 7168
    s_add_u32 s20, s98, 22020096
    s_lshl_b32 s96, s18, 11
    s_lshl_b32 s97, s19, 5
    s_add_u32 s82, s96, s97
    v_and_b32 v10, 7, v1
    v_lshlrev_b32 v10, 2, v10
    s_lshr_b32 s96, s8, 1
    s_lshl_b32 s97, s96, 6
    s_add_u32 s13, s97, 157184
    v_and_b32 v5, 7, v1
    v_lshl_add_u32 v5, v5, 3, s13
    ds_read_b64 v[206:207], v5
    s_and_b32 s96, s17, 31
    s_lshl_b32 s97, s96, 13
    s_lshl_b32 s98, s12, 9
    s_add_u32 s99, s97, s98
    s_lshr_b32 s96, s8, 1
    s_lshl_b32 s97, s96, 5
    s_add_u32 s98, s99, s97
    s_add_u32 s91, s98, 13631488
    s_lshr_b32 s13, s15, 11
    s_lshl_b32 s13, s13, 16
    s_ashr_i32 s15, s13, 31
    s_andn2_b32 s15, 0x7fff0000, s15
    s_or_b32 s15, s15, 0x80000000
L_PAD10:
    s_cbranch_execz L_RET10
    s_xor_b32 s13, s13, s15
    v_mov_b32 v204, s13
    v_mul_f32 v204, s7, v204
    v_exp_f32 v204, -v204
    s_nop 0
    v_add_f32 v204, 1.0, v204
    v_rcp_f32 v204, v204
    s_nop 0
    v_cvt_pk_bf16_f32 v204, 0, v204
L_NOFZ:
    s_cmp_ge_u32 s3, 4
    s_cbranch_scc1 L_NOH
    s_lshl_b32 s96, s3, 8
    s_add_u32 s13, s96, s14
    v_lshrrev_b32 v4, 4, v1
    v_lshlrev_b32 v4, 11, v4
    v_and_b32 v9, 15, v1
    v_lshl_add_u32 v4, v9, 4, v4
    s_lshl_b32 s96, s3, 5
    s_add_u32 s15, s96, 156672
    v_lshrrev_b32 v5, 5, v1
    v_lshl_add_u32 v5, v5, 7, s15
    v_bfe_u32 v9, v1, 2, 1
    v_lshl_add_u32 v5, v9, 4, v5
    v_bfe_u32 v9, v1, 1, 1
    v_lshl_add_u32 v5, v9, 3, v5
    v_bfe_u32 v9, v1, 3, 1
    v_lshl_add_u32 v5, v9, 2, v5
    v_and_b32 v9, 1, v1
    v_lshl_add_u32 v5, v9, 1, v5
SPOLL_46:
    s_load_dword s24, s[32:33], s13 offset:1276 glc
    s_load_dword s25, s[32:33], s13 offset:3324 glc
    s_load_dword s26, s[32:33], s13 offset:5372 glc
    s_load_dword s27, s[32:33], s13 offset:7420 glc
SCHK_47:
    s_add_u32 s5, s5, 1
    s_cmp_ge_u32 s5, 200000
    s_waitcnt lgkmcnt(0)
    s_cbranch_scc1 SDONE_48
    s_cmp_lg_u32 s24, s4
    s_cbranch_scc1 SPOLL_46
    s_cmp_lg_u32 s25, s4
    s_cbranch_scc1 SPOLL_46
    s_cmp_lg_u32 s26, s4
    s_cbranch_scc1 SPOLL_46
    s_cmp_lg_u32 s27, s4
    s_cbranch_scc1 SPOLL_46
SDONE_48:
POLL_49:
    buffer_load_dwordx4 v[88:91], v4, s[32:35], s13 offen sc1
    buffer_load_dwordx4 v[92:95], v4, s[32:35], s13 offen offset:1024 sc1
    s_waitcnt vmcnt(0)
    v_bitop3_b32 v6, v89, v91, s4 bitop3:0x7e
    v_bitop3_b32 v6, v6, v93, s4 bitop3:0xf6
    v_bitop3_b32 v6, v6, v95, s4 bitop3:0xf6
    v_cmp_ne_u32 vcc, 0, v6
    s_cbranch_vccz PDONE_50
    s_add_u32 s5, s5, 1
    s_cmp_lt_u32 s5, 200000
    s_cbranch_scc1 POLL_49
PDONE_50:
    v_permlane32_swap_b32 v88, v90
    v_permlane32_swap_b32 v92, v94
    v_add_f32 v88, v88, v90
    v_add_f32 v92, v92, v94
    v_mov_b32 v90, v88
    v_mov_b32 v94, v92
    s_nop 0
    v_permlane16_swap_b32 v88, v90
    v_permlane16_swap_b32 v92, v94
    v_add_f32 v88, v88, v90
    v_add_f32 v92, v92, v94
    v_cvt_pk_bf16_f32 v88, 0, v88
    v_cvt_pk_bf16_f32 v92, 0, v92
    v_mul_f32 v6, s7, v88
    v_exp_f32 v6, -v6
    s_nop 0
    v_add_f32 v6, 1.0, v6
    v_rcp_f32 v6, v6
    s_nop 0
    v_mul_f32 v88, v88, v6
    v_cvt_pk_bf16_f32 v88, 0, v88
    v_mul_f32 v88, v88, v92
    v_cvt_pk_bf16_f32 v88, v88, v88
    ds_write_b16 v5, v88
L_NOH:
    v_bfe_u32 v4, v1, 2, 1
    v_lshlrev_b32 v4, 7, v4
    v_lshrrev_b32 v9, 5, v1
    v_lshl_add_u32 v4, v9, 4, v4
    v_add_u32 v4, 156672, v4
    v_lshrrev_b32 v5, 4, v1
    v_mul_u32_u24 v5, 7168, v5
    v_and_b32 v9, 15, v1
    v_lshl_add_u32 v5, v9, 3, v5
    s_lshl3_add_u32 s96, s75, s3
    s_mul_i32 s97, s96, 28672
    s_lshl_b32 s98, s74, 7
    s_add_u32 s99, s97, s98
    s_add_u32 s13, s99, 22020096
    v_and_b32 v6, 1, v1
    v_lshlrev_b32 v6, 13, v6
    v_bfe_u32 v9, v1, 1, 1
    v_lshl_add_u32 v6, v9, 18, v6
    s_lshr_b32 s96, s9, 2
    s_and_b32 s97, s75, 1
    s_lshr_b32 s98, s3, 1
    s_lshl2_add_u32 s99, s97, s98
    s_and_b32 s97, s3, 1
    s_lshr_b32 s98, s75, 1
    s_lshl2_add_u32 s97, s97, s98
    s_lshl3_add_u32 s98, s99, s97
    s_lshl_b32 s99, s98, 12
    s_lshl_b32 s97, s8, 6
    s_add_u32 s98, s99, s97
    s_lshl2_add_u32 s99, s96, s98
    s_add_u32 s97, s99, 1048576
    s_add_u32 s14, s97, 3072
    s_waitcnt lgkmcnt(0)
    s_barrier
    ds_read_b128 v[88:91], v4
    ds_read_b128 v[92:95], v4 offset:32
    ds_read_b128 v[96:99], v4 offset:64
    ds_read_b128 v[100:103], v4 offset:96
    s_waitcnt lgkmcnt(3)
    v_mfma_f32_32x32x16_bf16 v[208:223], v[88:91], v[120:123], 0
    s_waitcnt lgkmcnt(2)
    v_mfma_f32_32x32x16_bf16 v[208:223], v[92:95], v[124:127], v[208:223]
    s_waitcnt lgkmcnt(1)
    v_mfma_f32_32x32x16_bf16 v[208:223], v[96:99], v[128:131], v[208:223]
    s_waitcnt lgkmcnt(0)
    v_mfma_f32_32x32x16_bf16 v[208:223], v[100:103], v[132:135], v[208:223]
    s_nop 11
    v_mov_b32 v209, s4
    buffer_store_dwordx2 v[208:209], v5, s[32:35], s13 offen sc1
    s_mov_b64 exec, 15
    buffer_store_dword v209, v6, s[32:35], s14 offen sc1
    s_mov_b64 exec, -1
    s_barrier
L_FIN2:
    v_cmp_ne_u32 vcc, s68, v42
    v_cmp_ne_u32 s[22:23], s69, v42
    s_nop 0
    s_and_b64 exec, vcc, s[22:23]
    buffer_store_dwordx4 v[232:235], v33, s[64:67], s70 offen sc1
    s_mov_b64 exec, -1
    v_cmp_ne_u32 vcc, s68, v43
    v_cmp_ne_u32 s[22:23], s69, v43
    s_nop 0
    s_and_b64 exec, vcc, s[22:23]
    buffer_store_dwordx4 v[236:239], v33, s[64:67], s71 offen sc1
    s_mov_b64 exec, -1
    s_cmp_ge_u32 s9, 16
    s_cbranch_scc1 L_FIN
SPOLL_51:
    s_load_dwordx8 s[24:31], s[32:33], s92 offset:3072 glc
SCHK_52:
    s_add_u32 s5, s5, 1
    s_cmp_ge_u32 s5, 200000
    s_waitcnt lgkmcnt(0)
    s_cbranch_scc1 SDONE_53
    s_cmp_lg_u32 s24, s4
    s_cbranch_scc1 SPOLL_51
    s_cmp_lg_u32 s25, s4
    s_cbranch_scc1 SPOLL_51
    s_cmp_lg_u32 s26, s4
    s_cbranch_scc1 SPOLL_51
    s_cmp_lg_u32 s27, s4
    s_cbranch_scc1 SPOLL_51
    s_cmp_lg_u32 s28, s4
    s_cbranch_scc1 SPOLL_51
    s_cmp_lg_u32 s29, s4
    s_cbranch_scc1 SPOLL_51
    s_cmp_lg_u32 s30, s4
    s_cbranch_scc1 SPOLL_51
SDONE_53:
    s_barrier
    s_cmp_lg_u32 s3, 7
    s_cbranch_scc1 L_FIN
    s_add_u32 s13, s20, 4096
    v_mov_b32 v5, s4
    v_not_b32 v6, v5
POLL_54:
    buffer_load_dwordx4 v[88:91], v2, s[32:35], s20 offen sc1
    buffer_load_dwordx4 v[92:95], v2, s[32:35], s20 offen offset:1024 sc1
    buffer_load_dwordx4 v[96:99], v2, s[32:35], s20 offen offset:2048 sc1
    buffer_load_dwordx4 v[100:103], v2, s[32:35], s20 offen offset:3072 sc1
    buffer_load_dwordx4 v[104:107], v2, s[32:35], s13 offen sc1
    buffer_load_dwordx4 v[108:111], v2, s[32:35], s13 offen offset:1024 sc1
    buffer_load_dwordx4 v[112:115], v2, s[32:35], s13 offen offset:2048 sc1
    buffer_load_dword v244, v10, s[32:35], s91 offen sc1
    buffer_load_dword v245, v10, s[32:35], s91 offen offset:128 sc1
    s_waitcnt vmcnt(0)
    v_max_u32 v246, v244, v245
    v_cmp_ne_u32 vcc, -1, v246
    s_nop 1
    v_cndmask_b32 v246, v6, v5, vcc
    v_bitop3_b32 v4, v89, v91, s4 bitop3:0x7e
    v_bitop3_b32 v4, v4, v93, s4 bitop3:0xf6
    v_bitop3_b32 v4, v4, v95, s4 bitop3:0xf6
    v_bitop3_b32 v4, v4, v97, s4 bitop3:0xf6
    v_bitop3_b32 v4, v4, v99, s4 bitop3:0xf6
    v_bitop3_b32 v4, v4, v101, s4 bitop3:0xf6
    v_bitop3_b32 v4, v4, v103, s4 bitop3:0xf6
    v_bitop3_b32 v4, v4, v105, s4 bitop3:0xf6
    v_bitop3_b32 v4, v4, v107, s4 bitop3:0xf6
    v_bitop3_b32 v4, v4, v109, s4 bitop3:0xf6
    v_bitop3_b32 v4, v4, v111, s4 bitop3:0xf6
    v_bitop3_b32 v4, v4, v113, s4 bitop3:0xf6
    v_bitop3_b32 v4, v4, v115, s4 bitop3:0xf6
    v_bitop3_b32 v4, v4, v246, s4 bitop3:0xf6
    v_cmp_ne_u32 vcc, 0, v4
    s_cbranch_vccz PDONE_55
    s_add_u32 s5, s5, 1
    s_cmp_lt_u32 s5, 200000
    s_cbranch_scc1 POLL_54
PDONE_55:
    v_add_f32 v88, v88, v92
    v_add_f32 v90, v90, v94
    v_add_f32 v88, v88, v96
    v_add_f32 v90, v90, v98
    v_add_f32 v88, v88, v100
    v_add_f32 v90, v90, v102
    v_add_f32 v88, v88, v104
    v_add_f32 v90, v90, v106
    v_add_f32 v88, v88, v108
    v_add_f32 v90, v90, v110
    v_add_f32 v88, v88, v112
    v_add_f32 v90, v90, v114
    v_mov_b32 v89, v90
    v_add_f32_dpp v88, v88, v88 row_ror:8 row_mask:0xf bank_mask:0xf
    s_nop 0
    v_add_f32_dpp v89, v89, v89 row_ror:8 row_mask:0xf bank_mask:0xf
    v_mov_b32 v90, v88
    v_mov_b32 v91, v89
    s_nop 0
    v_permlane16_swap_b32 v88, v90
    v_permlane16_swap_b32 v89, v91
    v_pk_add_f32 v[88:89], v[88:89], v[90:91]
    v_mov_b32 v90, v88
    v_mov_b32 v91, v89
    s_nop 0
    v_permlane32_swap_b32 v88, v90
    v_permlane32_swap_b32 v89, v91
    v_pk_add_f32 v[88:89], v[88:89], v[90:91]
    v_cvt_pk_bf16_f32 v88, 0, v88
    v_cvt_pk_bf16_f32 v89, 0, v89
    v_pk_mul_f32 v[88:89], v[88:89], v[204:205] op_sel_hi:[1,0]
    v_lshlrev_b32 v4, 16, v244
    v_and_b32 v5, s6, v244
    v_cvt_pk_bf16_f32 v88, 0, v88
    v_cvt_pk_bf16_f32 v89, 0, v89
    v_pk_add_f32 v[88:89], v[88:89], v[4:5]
    v_cvt_pk_bf16_f32 v88, 0, v88
    v_cvt_pk_bf16_f32 v89, 0, v89
    v_pk_mul_f32 v[88:89], v[88:89], v[206:207]
    v_lshlrev_b32 v4, 16, v245
    v_and_b32 v5, s6, v245
    v_cvt_pk_bf16_f32 v88, 0, v88
    v_cvt_pk_bf16_f32 v89, 0, v89
    v_pk_add_f32 v[88:89], v[88:89], v[4:5]
    v_cvt_pk_bf16_f32 v88, v88, v89
    s_mov_b64 exec, 0xff
    buffer_store_dword v88, v10, s[64:67], s82 offen sc1
    s_mov_b64 exec, -1
L_FIN:
L_END:
    s_endpgm
.p2align 10
.fill 768, 4, 0xbf800000
.section .rodata,"a"
.p2align 6
.amdhsa_kernel adaLN_cond__linear_kernel_hedgehog__moe_arch_mod__prompt_kernel
  .amdhsa_next_free_vgpr 256
  .amdhsa_next_free_sgpr 102
  .amdhsa_accum_offset 256
  .amdhsa_group_segment_fixed_size 0
  .amdhsa_kernarg_size 112
  .amdhsa_user_sgpr_count 2
  .amdhsa_user_sgpr_kernarg_segment_ptr 1
  .amdhsa_system_sgpr_workgroup_id_x 1
  .amdhsa_float_denorm_mode_32 3
  .amdhsa_float_denorm_mode_16_64 3
.end_amdhsa_kernel
```

```asm
; @launch grid=(256,1,1) block=(512,1,1) lds=163840
.amdgcn_target "amdgcn-amd-amdhsa--gfx950"
.text
.globl adaLN_cond__linear_kernel_hedgehog__moe_arch_mod__prompt_kernel
.p2align 12
.type adaLN_cond__linear_kernel_hedgehog__moe_arch_mod__prompt_kernel,@function
adaLN_cond__linear_kernel_hedgehog__moe_arch_mod__prompt_kernel:
    s_load_dwordx16 s[68:83], s[0:1], 0
    s_load_dwordx8 s[84:91], s[0:1], 64
    s_load_dwordx2 s[32:33], s[0:1], 104
    s_cmp_ge_u32 s2, 256
    s_cbranch_scc1 L_END
    v_lshrrev_b32 v4, 6, v0
    v_and_b32 v1, 63, v0
    s_nop 0
    v_readfirstlane_b32 s3, v4
    v_lshlrev_b32 v2, 4, v1
    s_mov_b32 s38, 4194304
    s_mov_b32 s39, 0x20000
    s_mov_b32 s50, 12582912
    s_mov_b32 s51, 0x20000
    s_mov_b32 s34, 268435456
    s_mov_b32 s35, 0x20000
    s_mov_b32 s42, 6291456
    s_mov_b32 s43, 0x20000
    s_mov_b32 s46, 2097152
    s_mov_b32 s47, 0x20000
    s_mov_b32 s54, 7340032
    s_mov_b32 s55, 0x20000
    s_mov_b32 s58, 7340032
    s_mov_b32 s59, 0x20000
    s_mov_b32 s62, 7340032
    s_mov_b32 s63, 0x20000
    s_mov_b32 s66, 4194304
    s_mov_b32 s67, 0x20000
    s_mov_b32 s5, 0
    s_mov_b32 s6, 0xffff0000
    s_mov_b32 s7, 0x3fb8aa3b
    s_and_b32 s8, s2, 7
    s_lshr_b32 s9, s2, 3
    s_lshl_b32 s96, s8, 5
    s_add_u32 s97, s96, s9
    s_lshl3_add_u32 s93, s97, s3
    s_and_b32 s96, s8, 4
    s_lshr_b32 s97, s9, 2
    s_lshl1_add_u32 s10, s96, s97
    s_and_b32 s96, s8, 3
    s_and_b32 s97, s9, 3
    s_xor_b32 s98, s97, 2
    s_lshl2_add_u32 s11, s96, s98
    s_and_b32 s96, s8, 1
    s_and_b32 s97, s9, 7
    s_lshl3_add_u32 s12, s96, s97
    s_lshr_b32 s96, s8, 1
    s_lshr_b32 s97, s9, 3
    s_lshl2_add_u32 s21, s96, s97
    s_lshl_b32 s96, s2, 6
    s_add_u32 s97, s96, s3
    s_lshl_b32 s98, s97, 6
    s_add_u32 s92, s98, 1048576
    s_lshl_b32 s16, s93, 11
    s_lshl3_add_u32 s96, s8, s3
    s_lshl_b32 s15, s96, 5
    s_mul_i32 s96, s15, 6144
    s_xor_b32 s97, s9, 1
    s_lshl_b32 s98, s97, 7
    s_add_u32 s13, s96, s98
    s_add_u32 s14, s13, 98304
    s_lshl3_add_u32 s96, s21, s3
    s_lshl_b32 s97, s96, 15
    s_lshl_b32 s98, s12, 7
    s_add_u32 s18, s97, s98
    s_lshr_b32 s96, s8, 1
    s_lshl4_add_u32 s97, s96, s12
    s_lshl4_add_u32 s98, s97, s3
    s_lshl_b32 s99, s98, 9
    s_add_u32 s17, s99, 524288
    v_lshrrev_b32 v248, 3, v1
    v_mul_u32_u24 v248, 12288, v248
    v_and_b32 v9, 7, v1
    v_lshl_add_u32 v248, v9, 4, v248
    v_lshrrev_b32 v249, 3, v1
    v_lshl_add_u32 v249, v249, 1, s15
    v_and_b32 v10, 15, v1
    v_lshlrev_b32 v10, 11, v10
    v_lshrrev_b32 v9, 4, v1
    v_lshl_add_u32 v10, v9, 4, v10
    s_waitcnt lgkmcnt(0)
    s_mov_b64 s[48:49], s[88:89]
    buffer_load_dwordx4 v[160:163], v248, s[48:51], s13 offen nt
    buffer_load_dwordx4 v[164:167], v248, s[48:51], s14 offen nt
    s_load_dword s4, s[32:33], 0
    global_load_ushort v168, v249, s[86:87]
    global_load_ushort v169, v249, s[86:87] offset:16
    s_mov_b64 s[36:37], s[68:69]
    s_load_dword s24, s[32:33], s92 offset:0 glc
    s_load_dword s25, s[32:33], s17 offset:508 glc
    s_load_dword s26, s[32:33], s17 offset:4604 glc
    s_barrier
    buffer_load_dwordx4 v[152:155], v2, s[36:39], s16 offen
    buffer_load_dwordx4 v[156:159], v2, s[36:39], s16 offen offset:1024
    s_mov_b64 s[40:41], s[70:71]
    s_mov_b64 s[44:45], s[74:75]
    s_mov_b64 s[52:53], s[80:81]
    s_mov_b64 s[56:57], s[82:83]
    s_mov_b64 s[60:61], s[84:85]
    s_mov_b64 s[64:65], s[90:91]
    s_getpc_b64 s[22:23]
    s_and_b32 s22, s22, 0xfffffc00
    s_lshl3_add_u32 s96, s9, s3
    s_lshl_b32 s19, s96, 7
    v_lshrrev_b32 v4, 5, v1
    v_lshl_add_u32 v4, v4, 15, s19
    v_min_u32 v4, 41984, v4
    global_load_dword v11, v4, s[22:23]
    s_lshr_b32 s76, s3, 2
    s_and_b32 s77, s3, 3
    s_lshl_b32 s83, s3, 10
    s_mul_i32 s96, s8, 7
    s_lshr_b32 s97, s9, 2
    s_add_u32 s74, s96, s97
    s_and_b32 s75, s9, 3
    v_bfe_u32 v6, v1, 4, 1
    v_lshlrev_b32 v6, 6, v6
    v_and_b32 v3, 7, v1
    v_lshlrev_b32 v3, 4, v3
    v_xor_b32 v3, v3, v6
    v_lshrrev_b32 v6, 3, v1
    v_mul_u32_u24 v6, 6144, v6
    v_add_u32 v3, v3, v6
    s_and_b32 s84, s9, 12
    s_mul_i32 s96, s3, 49152
    s_lshl_b32 s97, s11, 7
    s_add_u32 s85, s96, s97
    v_lshlrev_b32 v250, 3, v1
    v_lshlrev_b32 v251, 5, v1
    v_add_u32 v251, 147456, v251
    s_lshl2_add_u32 s13, s3, 147456
    v_lshrrev_b32 v252, 4, v1
    v_lshl_add_u32 v252, v252, 6, s13
    v_and_b32 v9, 7, v1
    v_lshl_add_u32 v252, v9, 8, v252
    v_bfe_u32 v9, v1, 3, 1
    v_lshl_add_u32 v252, v9, 5, v252
    buffer_load_dwordx4 v[12:15], v10, s[36:39], s18 offen
    buffer_load_dwordx4 v[16:19], v10, s[36:39], s18 offen offset:64
    s_lshr_b32 s96, s3, 1
    s_xor_b32 s97, s9, 1
    s_and_b32 s98, s97, 15
    s_lshl4_add_u32 s99, s96, s98
    s_lshr_b32 s97, s9, 4
    s_lshl1_add_u32 s96, s99, s97
    s_lshl3_add_u32 s98, s96, s8
    s_lshl_b32 s99, s98, 9
    s_add_u32 s13, s99, 524288
    s_waitcnt vmcnt(5)
    v_lshlrev_b32 v168, 16, v168
    v_mul_f32 v4, s7, v168
    v_exp_f32 v4, -v4
    s_nop 0
    v_add_f32 v4, 1.0, v4
    v_rcp_f32 v4, v4
    s_nop 0
    v_mul_f32 v168, v168, v4
    v_cvt_pk_bf16_f32 v168, 0, v168
    v_lshlrev_b32 v169, 16, v169
    v_mul_f32 v5, s7, v169
    v_exp_f32 v5, -v5
    s_nop 0
    v_add_f32 v5, 1.0, v5
    v_rcp_f32 v5, v5
    s_nop 0
    v_mul_f32 v169, v169, v5
    v_cvt_pk_bf16_f32 v169, 0, v169
    v_lshlrev_b32 v4, 16, v160
    v_and_b32 v5, s6, v160
    v_pk_mul_f32 v[176:177], v[4:5], v[168:169] op_sel:[0,0] op_sel_hi:[1,0]
    v_lshlrev_b32 v6, 16, v161
    v_and_b32 v7, s6, v161
    v_pk_mul_f32 v[178:179], v[6:7], v[168:169] op_sel:[0,0] op_sel_hi:[1,0]
    v_lshlrev_b32 v4, 16, v162
    v_and_b32 v5, s6, v162
    v_pk_mul_f32 v[180:181], v[4:5], v[168:169] op_sel:[0,0] op_sel_hi:[1,0]
    v_lshlrev_b32 v6, 16, v163
    v_and_b32 v7, s6, v163
    v_pk_mul_f32 v[182:183], v[6:7], v[168:169] op_sel:[0,0] op_sel_hi:[1,0]
    v_lshlrev_b32 v4, 16, v164
    v_and_b32 v5, s6, v164
    v_pk_fma_f32 v[176:177], v[4:5], v[168:169], v[176:177] op_sel:[0,1,0] op_sel_hi:[1,1,1]
    v_lshlrev_b32 v6, 16, v165
    v_and_b32 v7, s6, v165
    v_pk_fma_f32 v[178:179], v[6:7], v[168:169], v[178:179] op_sel:[0,1,0] op_sel_hi:[1,1,1]
    v_lshlrev_b32 v4, 16, v166
    v_and_b32 v5, s6, v166
    v_pk_fma_f32 v[180:181], v[4:5], v[168:169], v[180:181] op_sel:[0,1,0] op_sel_hi:[1,1,1]
    v_lshlrev_b32 v6, 16, v167
    v_and_b32 v7, s6, v167
    v_pk_fma_f32 v[182:183], v[6:7], v[168:169], v[182:183] op_sel:[0,1,0] op_sel_hi:[1,1,1]
    v_permlane32_swap_b32 v176, v180
    v_permlane32_swap_b32 v177, v181
    v_permlane32_swap_b32 v178, v182
    v_permlane32_swap_b32 v179, v183
    v_add_f32 v176, v176, v180
    v_add_f32 v177, v177, v181
    v_add_f32 v178, v178, v182
    v_add_f32 v179, v179, v183
    s_nop 0
    v_permlane16_swap_b32 v176, v178
    v_permlane16_swap_b32 v177, v179
    v_add_f32 v176, v176, v178
    v_add_f32 v177, v177, v179
    s_nop 0
    v_add_f32_dpp v176, v176, v176 row_ror:8 row_mask:0xf bank_mask:0xf
    v_add_f32_dpp v177, v177, v177 row_ror:8 row_mask:0xf bank_mask:0xf
    s_nop 1
    v_mov_b32_dpp v176, v177 quad_perm:[0,1,2,3] row_mask:0xf bank_mask:0xc
    s_waitcnt lgkmcnt(0)
    s_mul_i32 s4, s4, 0x9e3779b1
    s_add_u32 s4, s4, 0x7f4a7c15
    ds_write_b32 v252, v176
    s_waitcnt lgkmcnt(0)
    s_barrier
    ds_read_b128 v[176:179], v251
    ds_read_b128 v[180:183], v251 offset:16
    s_waitcnt lgkmcnt(0)
    v_pk_add_f32 v[176:177], v[176:177], v[178:179]
    v_pk_add_f32 v[180:181], v[180:181], v[182:183]
    v_pk_add_f32 v[176:177], v[176:177], v[180:181]
    v_add_f32 v176, v176, v177
    v_mov_b32 v177, s4
    s_bitcmp1_b32 s3, 0
    s_cselect_b32 exec_lo, 0, -1
    s_cselect_b32 exec_hi, -1, 0
    buffer_store_dwordx2 v[176:177], v250, s[32:35], s13 offen sc1
    s_mov_b64 exec, -1
    s_lshr_b32 s96, s9, 4
    s_lshl_b32 s94, s96, 1
    s_add_u32 s96, s94, s84
    s_and_b32 s97, s96, 15
    s_mul_i32 s98, s97, 393216
    s_add_u32 s91, s98, s85
    s_lshl_b32 s96, s94, 13
    s_add_u32 s94, s96, s83
    s_add_u32 s82, s91, 2048
    s_mov_b32 m0, s94
    s_nop 0
    buffer_load_dwordx4 v3, s[40:43], s82 offen lds
    s_add_u32 s82, s91, 4096
    s_add_u32 m0, s94, 49152
    s_nop 0
    buffer_load_dwordx4 v3, s[40:43], s82 offen lds
    s_waitcnt vmcnt(6)
    v_mov_b32 v8, 0x3f803f80
    v_dot2_f32_bf16 v4, v152, v8, 0
    v_dot2_f32_bf16 v5, v152, v152, 0
    v_dot2_f32_bf16 v6, v153, v8, 0
    v_dot2_f32_bf16 v7, v153, v153, 0
    v_dot2_f32_bf16 v4, v154, v8, v4
    v_dot2_f32_bf16 v5, v154, v154, v5
    v_dot2_f32_bf16 v6, v155, v8, v6
    v_dot2_f32_bf16 v7, v155, v155, v7
    v_dot2_f32_bf16 v4, v156, v8, v4
    v_dot2_f32_bf16 v5, v156, v156, v5
    v_dot2_f32_bf16 v6, v157, v8, v6
    v_dot2_f32_bf16 v7, v157, v157, v7
    v_dot2_f32_bf16 v4, v158, v8, v4
    v_dot2_f32_bf16 v5, v158, v158, v5
    v_dot2_f32_bf16 v6, v159, v8, v6
    v_dot2_f32_bf16 v7, v159, v159, v7
    s_nop 2
    v_pk_add_f32 v[4:5], v[4:5], v[6:7]
    s_nop 1
    v_add_f32_dpp v4, v4, v4 quad_perm:[1,0,3,2] row_mask:0xf bank_mask:0xf
    v_add_f32_dpp v5, v5, v5 quad_perm:[1,0,3,2] row_mask:0xf bank_mask:0xf
    s_nop 0
    v_add_f32_dpp v4, v4, v4 quad_perm:[2,3,0,1] row_mask:0xf bank_mask:0xf
    v_add_f32_dpp v5, v5, v5 quad_perm:[2,3,0,1] row_mask:0xf bank_mask:0xf
    s_nop 0
    v_add_f32_dpp v4, v4, v4 row_half_mirror row_mask:0xf bank_mask:0xf
    v_add_f32_dpp v5, v5, v5 row_half_mirror row_mask:0xf bank_mask:0xf
    s_nop 0
    v_add_f32_dpp v4, v4, v4 row_ror:8 row_mask:0xf bank_mask:0xf
    v_add_f32_dpp v5, v5, v5 row_ror:8 row_mask:0xf bank_mask:0xf
    s_nop 1
    v_permlane16_swap_b32 v4, v5
    v_add_f32 v8, v4, v5
    v_add_f32 v4, v4, v5
    s_nop 1
    v_permlane32_swap_b32 v4, v8
    v_add_f32 v4, v4, v8
    v_mul_f32 v8, 0x3a800000, v4
    v_mul_f32 v4, 0x3a800000, v4
    s_nop 1
    v_permlane16_swap_b32 v4, v8
    v_fma_f32 v173, -v4, v4, v8
    v_cvt_pk_bf16_f32 v172, 0, v4
    v_max_f32 v173, 0, v173
    v_cvt_pk_bf16_f32 v173, 0, v173
    v_add_f32 v173, 0x3727c5ac, v173
    v_cvt_pk_bf16_f32 v173, 0, v173
    v_sqrt_f32 v173, v173
    s_nop 0
    v_cvt_pk_bf16_f32 v173, 0, v173
    s_lshl3_add_u32 s13, s3, 153600
    v_lshrrev_b32 v172, 16, v172
    v_or_b32 v172, v172, v173
    v_mov_b32 v173, s4
    v_mov_b32 v4, s13
    ds_write_b64 v4, v[172:173]
    v_and_b32 v5, 3, v1
    v_lshlrev_b32 v5, 4, v5
    v_add_u32 v5, 153600, v5
    v_and_b32 v4, 3, v1
    v_lshlrev_b32 v4, 4, v4
    v_bfe_u32 v9, v1, 2, 1
    v_lshl_add_u32 v4, v9, 10, v4
    s_and_b32 s96, s8, 6
    s_and_b32 s97, s8, 1
    s_lshr_b32 s98, s9, 4
    s_lshl1_add_u32 s99, s97, s98
    s_lshl_b32 s97, s99, 6
    s_add_u32 s98, s96, s97
    s_lshl3_add_u32 s99, s3, s98
    s_lshl_b32 s96, s99, 10
    s_and_b32 s97, s9, 15
    s_lshl_b32 s98, s97, 6
    s_add_u32 s99, s96, s98
    s_add_u32 s13, s99, 262144
    s_waitcnt lgkmcnt(0)
    s_barrier
    ds_read_b128 v[172:175], v5
    s_waitcnt lgkmcnt(0)
    s_mov_b64 exec, 0xff
    buffer_store_dwordx4 v[172:175], v4, s[32:35], s13 offen sc1
    s_mov_b64 exec, -1
    s_mov_b32 s82, s91
    s_add_u32 m0, s94, 98304
    s_nop 0
    buffer_load_dwordx4 v3, s[40:43], s82 offen lds
    s_load_dword s24, s[32:33], s17 offset:508 glc
    s_load_dword s25, s[32:33], s17 offset:4604 glc
    v_and_b32 v4, 31, v1
    v_lshlrev_b32 v4, 4, v4
    v_lshrrev_b32 v9, 5, v1
    v_lshl_add_u32 v4, v9, 12, v4
    s_lshl2_add_u32 s14, s3, 155648
    v_lshl_add_u32 v5, v1, 6, s14
    v_and_b32 v6, 3, v1
    v_lshlrev_b32 v6, 5, v6
    v_lshrrev_b32 v9, 5, v1
    v_lshl_add_u32 v6, v9, 7, v6
    v_bfe_u32 v9, v1, 4, 1
    v_lshl_add_u32 v6, v9, 8, v6
    v_bfe_u32 v9, v1, 2, 2
    v_lshl_add_u32 v6, v9, 9, v6
    v_add_u32 v6, 155648, v6
    s_lshl3_add_u32 s96, s2, s3
    s_lshl_b32 s97, s96, 7
    s_add_u32 s14, s97, 262144
    v_and_b32 v8, 15, v1
    v_lshlrev_b32 v8, 3, v8
    s_branch SCHK_2
SPOLL_1:
    s_load_dword s24, s[32:33], s17 offset:508 glc
    s_load_dword s25, s[32:33], s17 offset:4604 glc
SCHK_2:
    s_add_u32 s5, s5, 1
    s_cmp_ge_u32 s5, 200000
    s_waitcnt lgkmcnt(0)
    s_cbranch_scc1 SDONE_3
    s_cmp_lg_u32 s24, s4
    s_cbranch_scc1 SPOLL_1
    s_cmp_lg_u32 s25, s4
    s_cbranch_scc1 SPOLL_1
SDONE_3:
    buffer_load_dwordx4 v[176:179], v4, s[32:35], s17 offen sc1
    s_load_dword s24, s[32:33], s14 offset:60 glc
    s_load_dword s25, s[32:33], s14 offset:124 glc
    s_waitcnt vmcnt(6)
    v_permlane32_swap_b32 v12, v14
    v_permlane32_swap_b32 v13, v15
    v_permlane32_swap_b32 v16, v18
    v_permlane32_swap_b32 v17, v19
    v_lshlrev_b32 v184, 16, v12
    v_and_b32 v185, s6, v12
    v_lshlrev_b32 v186, 16, v13
    v_and_b32 v187, s6, v13
    v_lshlrev_b32 v188, 16, v14
    v_and_b32 v189, s6, v14
    v_lshlrev_b32 v190, 16, v15
    v_and_b32 v191, s6, v15
    v_lshlrev_b32 v192, 16, v16
    v_and_b32 v193, s6, v16
    v_lshlrev_b32 v194, 16, v17
    v_and_b32 v195, s6, v17
    v_lshlrev_b32 v196, 16, v18
    v_and_b32 v197, s6, v18
    v_lshlrev_b32 v198, 16, v19
    v_and_b32 v199, s6, v19
    s_branch SCHK_6
SPOLL_5:
    s_load_dword s24, s[32:33], s14 offset:60 glc
    s_load_dword s25, s[32:33], s14 offset:124 glc
SCHK_6:
    s_add_u32 s5, s5, 1
    s_cmp_ge_u32 s5, 200000
    s_waitcnt lgkmcnt(0)
    s_cbranch_scc1 SDONE_7
    s_cmp_lg_u32 s24, s4
    s_cbranch_scc1 SPOLL_5
    s_cmp_lg_u32 s25, s4
    s_cbranch_scc1 SPOLL_5
SDONE_7:
    buffer_load_dwordx2 v[172:173], v8, s[32:35], s14 offen sc1
    s_lshr_b32 s96, s9, 4
    s_lshl_b32 s97, s96, 1
    s_xor_b32 s94, s97, 1
    s_add_u32 s96, s94, s84
    s_and_b32 s97, s96, 15
    s_mul_i32 s98, s97, 393216
    s_add_u32 s91, s98, s85
    s_lshl_b32 s96, s94, 13
    s_add_u32 s94, s96, s83
    s_add_u32 s82, s91, 2048
    s_mov_b32 m0, s94
    s_nop 0
    buffer_load_dwordx4 v3, s[40:43], s82 offen lds
    s_add_u32 s82, s91, 4096
    s_add_u32 m0, s94, 49152
    s_nop 0
    buffer_load_dwordx4 v3, s[40:43], s82 offen lds
    s_mov_b32 s82, s91
    s_add_u32 m0, s94, 98304
    s_nop 0
    buffer_load_dwordx4 v3, s[40:43], s82 offen lds
    s_waitcnt vmcnt(4)
    v_bitop3_b32 v7, v177, v179, s4 bitop3:0x7e
    v_cmp_ne_u32 vcc, 0, v7
    s_cbranch_vccz TOK_8
POLL_9:
    buffer_load_dwordx4 v[176:179], v4, s[32:35], s17 offen sc1
    s_waitcnt vmcnt(0)
    v_bitop3_b32 v7, v177, v179, s4 bitop3:0x7e
    v_cmp_ne_u32 vcc, 0, v7
    s_cbranch_vccz PDONE_10
    s_add_u32 s5, s5, 1
    s_cmp_lt_u32 s5, 200000
    s_cbranch_scc1 POLL_9
PDONE_10:
TOK_8:
    ds_write2_b32 v5, v176, v178 offset0:0 offset1:8
    s_waitcnt lgkmcnt(0)
    s_barrier
    ds_read_b128 v[208:211], v6 offset:2048
    ds_read_b128 v[212:215], v6 offset:2064
    ds_read_b128 v[200:203], v6
    ds_read_b128 v[204:207], v6 offset:16
    s_lshl_b32 s96, s11, 12
    s_lshl_b32 s97, s3, 9
    s_add_u32 s13, s96, s97
    v_add_u32 v4, s13, v2
    s_lshl_b32 s96, s3, 9
    s_add_u32 m0, s96, 159744
    s_mov_b32 exec_hi, 0
    global_load_lds_dwordx4 v4, s[72:73]
    s_mov_b32 exec_hi, -1
    s_lshl4_add_u32 s96, s21, s12
    s_lshr_b32 s97, s3, 1
    s_lshl2_add_u32 s98, s96, s97
    s_lshl_b32 s99, s98, 12
    s_and_b32 s96, s3, 1
    s_lshl_b32 s97, s96, 8
    s_add_u32 s98, s99, s97
    s_add_u32 s13, s98, 4194304
    v_and_b32 v4, 15, v1
    v_lshlrev_b32 v4, 4, v4
    v_bfe_u32 v9, v1, 4, 1
    v_lshl_add_u32 v4, v9, 10, v4
    v_lshrrev_b32 v9, 5, v1
    v_lshl_add_u32 v4, v9, 9, v4
    s_waitcnt lgkmcnt(2)
    v_pk_add_f32 v[208:209], v[208:209], v[210:211]
    v_pk_add_f32 v[212:213], v[212:213], v[214:215]
    v_pk_add_f32 v[208:209], v[208:209], v[212:213]
    v_add_f32 v208, v208, v209
    v_cvt_pk_bf16_f32 v208, 0, v208
    s_waitcnt lgkmcnt(0)
    v_pk_add_f32 v[200:201], v[200:201], v[202:203]
    v_pk_add_f32 v[204:205], v[204:205], v[206:207]
    v_pk_add_f32 v[200:201], v[200:201], v[204:205]
    v_add_f32 v200, v200, v201
    v_add_f32 v208, 1.0, v208
    v_cvt_pk_bf16_f32 v208, 0, v208
    v_cvt_pk_bf16_f32 v200, 0, v200
    s_waitcnt vmcnt(4)
    v_cmp_ne_u32 vcc, s4, v173
    s_cbranch_vccz L_STOK
POLL_11:
    buffer_load_dwordx2 v[172:173], v8, s[32:35], s14 offen sc1
    s_waitcnt vmcnt(0)
    v_cmp_ne_u32 vcc, s4, v173
    s_cbranch_vccz PDONE_12
    s_add_u32 s5, s5, 1
    s_cmp_lt_u32 s5, 200000
    s_cbranch_scc1 POLL_11
PDONE_12:
L_STOK:
    v_lshlrev_b32 v173, 16, v172
    v_and_b32 v172, s6, v172
    v_rcp_f32 v172, v172
    s_nop 0
    v_pk_add_f32 v[184:185], v[184:185], v[172:173] op_sel:[0,1] neg_lo:[0,1] neg_hi:[0,1]
    v_pk_add_f32 v[186:187], v[186:187], v[172:173] op_sel:[0,1] neg_lo:[0,1] neg_hi:[0,1]
    v_pk_add_f32 v[188:189], v[188:189], v[172:173] op_sel:[0,1] neg_lo:[0,1] neg_hi:[0,1]
    v_pk_add_f32 v[190:191], v[190:191], v[172:173] op_sel:[0,1] neg_lo:[0,1] neg_hi:[0,1]
    v_pk_add_f32 v[192:193], v[192:193], v[172:173] op_sel:[0,1] neg_lo:[0,1] neg_hi:[0,1]
    v_pk_add_f32 v[194:195], v[194:195], v[172:173] op_sel:[0,1] neg_lo:[0,1] neg_hi:[0,1]
    v_pk_add_f32 v[196:197], v[196:197], v[172:173] op_sel:[0,1] neg_lo:[0,1] neg_hi:[0,1]
    v_pk_add_f32 v[198:199], v[198:199], v[172:173] op_sel:[0,1] neg_lo:[0,1] neg_hi:[0,1]
    v_cvt_pk_bf16_f32 v184, 0, v184
    v_cvt_pk_bf16_f32 v185, 0, v185
    v_cvt_pk_bf16_f32 v186, 0, v186
    v_cvt_pk_bf16_f32 v187, 0, v187
    v_cvt_pk_bf16_f32 v188, 0, v188
    v_cvt_pk_bf16_f32 v189, 0, v189
    v_cvt_pk_bf16_f32 v190, 0, v190
    v_cvt_pk_bf16_f32 v191, 0, v191
    v_cvt_pk_bf16_f32 v192, 0, v192
    v_cvt_pk_bf16_f32 v193, 0, v193
    v_cvt_pk_bf16_f32 v194, 0, v194
    v_cvt_pk_bf16_f32 v195, 0, v195
    v_cvt_pk_bf16_f32 v196, 0, v196
    v_cvt_pk_bf16_f32 v197, 0, v197
    v_cvt_pk_bf16_f32 v198, 0, v198
    v_cvt_pk_bf16_f32 v199, 0, v199
    v_pk_mul_f32 v[184:185], v[184:185], v[172:173] op_sel_hi:[1,0]
    v_pk_mul_f32 v[186:187], v[186:187], v[172:173] op_sel_hi:[1,0]
    v_pk_mul_f32 v[188:189], v[188:189], v[172:173] op_sel_hi:[1,0]
    v_pk_mul_f32 v[190:191], v[190:191], v[172:173] op_sel_hi:[1,0]
    v_pk_mul_f32 v[192:193], v[192:193], v[172:173] op_sel_hi:[1,0]
    v_pk_mul_f32 v[194:195], v[194:195], v[172:173] op_sel_hi:[1,0]
    v_pk_mul_f32 v[196:197], v[196:197], v[172:173] op_sel_hi:[1,0]
    v_pk_mul_f32 v[198:199], v[198:199], v[172:173] op_sel_hi:[1,0]
    v_cvt_pk_bf16_f32 v184, 0, v184
    v_cvt_pk_bf16_f32 v185, 0, v185
    v_cvt_pk_bf16_f32 v186, 0, v186
    v_cvt_pk_bf16_f32 v187, 0, v187
    v_cvt_pk_bf16_f32 v188, 0, v188
    v_cvt_pk_bf16_f32 v189, 0, v189
    v_cvt_pk_bf16_f32 v190, 0, v190
    v_cvt_pk_bf16_f32 v191, 0, v191
    v_cvt_pk_bf16_f32 v192, 0, v192
    v_cvt_pk_bf16_f32 v193, 0, v193
    v_cvt_pk_bf16_f32 v194, 0, v194
    v_cvt_pk_bf16_f32 v195, 0, v195
    v_cvt_pk_bf16_f32 v196, 0, v196
    v_cvt_pk_bf16_f32 v197, 0, v197
    v_cvt_pk_bf16_f32 v198, 0, v198
    v_cvt_pk_bf16_f32 v199, 0, v199
    v_mul_f32_dpp v184, v208, v184 row_newbcast:0 row_mask:0xf bank_mask:0xf
    v_mul_f32_dpp v185, v208, v185 row_newbcast:1 row_mask:0xf bank_mask:0xf
    v_mul_f32_dpp v186, v208, v186 row_newbcast:2 row_mask:0xf bank_mask:0xf
    v_mul_f32_dpp v187, v208, v187 row_newbcast:3 row_mask:0xf bank_mask:0xf
    v_mul_f32_dpp v188, v208, v188 row_newbcast:4 row_mask:0xf bank_mask:0xf
    v_mul_f32_dpp v189, v208, v189 row_newbcast:5 row_mask:0xf bank_mask:0xf
    v_mul_f32_dpp v190, v208, v190 row_newbcast:6 row_mask:0xf bank_mask:0xf
    v_mul_f32_dpp v191, v208, v191 row_newbcast:7 row_mask:0xf bank_mask:0xf
    v_cvt_pk_bf16_f32 v184, 0, v184
    v_cvt_pk_bf16_f32 v185, 0, v185
    v_cvt_pk_bf16_f32 v186, 0, v186
    v_cvt_pk_bf16_f32 v187, 0, v187
    v_cvt_pk_bf16_f32 v188, 0, v188
    v_cvt_pk_bf16_f32 v189, 0, v189
    v_cvt_pk_bf16_f32 v190, 0, v190
    v_cvt_pk_bf16_f32 v191, 0, v191
    v_add_f32_dpp v184, v200, v184 row_newbcast:0 row_mask:0xf bank_mask:0xf
    v_add_f32_dpp v185, v200, v185 row_newbcast:1 row_mask:0xf bank_mask:0xf
    v_add_f32_dpp v186, v200, v186 row_newbcast:2 row_mask:0xf bank_mask:0xf
    v_add_f32_dpp v187, v200, v187 row_newbcast:3 row_mask:0xf bank_mask:0xf
    v_add_f32_dpp v188, v200, v188 row_newbcast:4 row_mask:0xf bank_mask:0xf
    v_add_f32_dpp v189, v200, v189 row_newbcast:5 row_mask:0xf bank_mask:0xf
    v_add_f32_dpp v190, v200, v190 row_newbcast:6 row_mask:0xf bank_mask:0xf
    v_add_f32_dpp v191, v200, v191 row_newbcast:7 row_mask:0xf bank_mask:0xf
    v_cvt_pk_bf16_f32 v216, v184, v185
    v_cvt_pk_bf16_f32 v217, v186, v187
    v_cvt_pk_bf16_f32 v218, v188, v189
    v_cvt_pk_bf16_f32 v219, v190, v191
    buffer_store_dwordx4 v[216:219], v4, s[32:35], s13 offen sc1
    v_mul_f32_dpp v192, v208, v192 row_newbcast:8 row_mask:0xf bank_mask:0xf
    v_mul_f32_dpp v193, v208, v193 row_newbcast:9 row_mask:0xf bank_mask:0xf
    v_mul_f32_dpp v194, v208, v194 row_newbcast:10 row_mask:0xf bank_mask:0xf
    v_mul_f32_dpp v195, v208, v195 row_newbcast:11 row_mask:0xf bank_mask:0xf
    v_mul_f32_dpp v196, v208, v196 row_newbcast:12 row_mask:0xf bank_mask:0xf
    v_mul_f32_dpp v197, v208, v197 row_newbcast:13 row_mask:0xf bank_mask:0xf
    v_mul_f32_dpp v198, v208, v198 row_newbcast:14 row_mask:0xf bank_mask:0xf
    v_mul_f32_dpp v199, v208, v199 row_newbcast:15 row_mask:0xf bank_mask:0xf
    v_cvt_pk_bf16_f32 v192, 0, v192
    v_cvt_pk_bf16_f32 v193, 0, v193
    v_cvt_pk_bf16_f32 v194, 0, v194
    v_cvt_pk_bf16_f32 v195, 0, v195
    v_cvt_pk_bf16_f32 v196, 0, v196
    v_cvt_pk_bf16_f32 v197, 0, v197
    v_cvt_pk_bf16_f32 v198, 0, v198
    v_cvt_pk_bf16_f32 v199, 0, v199
    v_add_f32_dpp v192, v200, v192 row_newbcast:8 row_mask:0xf bank_mask:0xf
    v_add_f32_dpp v193, v200, v193 row_newbcast:9 row_mask:0xf bank_mask:0xf
    v_add_f32_dpp v194, v200, v194 row_newbcast:10 row_mask:0xf bank_mask:0xf
    v_add_f32_dpp v195, v200, v195 row_newbcast:11 row_mask:0xf bank_mask:0xf
    v_add_f32_dpp v196, v200, v196 row_newbcast:12 row_mask:0xf bank_mask:0xf
    v_add_f32_dpp v197, v200, v197 row_newbcast:13 row_mask:0xf bank_mask:0xf
    v_add_f32_dpp v198, v200, v198 row_newbcast:14 row_mask:0xf bank_mask:0xf
    v_add_f32_dpp v199, v200, v199 row_newbcast:15 row_mask:0xf bank_mask:0xf
    v_cvt_pk_bf16_f32 v220, v192, v193
    v_cvt_pk_bf16_f32 v221, v194, v195
    v_cvt_pk_bf16_f32 v222, v196, v197
    v_cvt_pk_bf16_f32 v223, v198, v199
    buffer_store_dwordx4 v[220:223], v4, s[32:35], s13 offen offset:2048 sc1
    v_bfe_u32 v20, v1, 2, 2
    v_lshlrev_b32 v20, 7, v20
    v_bfe_u32 v9, v1, 3, 1
    v_lshl_add_u32 v20, v9, 6, v20
    v_bfe_u32 v9, v1, 4, 1
    v_lshl_add_u32 v20, v9, 5, v20
    v_and_b32 v9, 3, v1
    v_lshl_add_u32 v20, v9, 3, v20
    v_lshrrev_b32 v9, 5, v1
    v_lshl_add_u32 v20, v9, 9, v20
    v_xor_b32 v21, 64, v20
    v_add_u32 v22, 49152, v20
    v_add_u32 v23, 49152, v21
    v_add_u32 v24, 98304, v20
    v_add_u32 v25, 98304, v21
    v_and_b32 v5, 3, v1
    v_lshlrev_b32 v5, 15, v5
    v_bfe_u32 v9, v1, 2, 2
    v_lshl_add_u32 v5, v9, 12, v5
    s_and_b32 s96, s12, 1
    s_lshr_b32 s97, s21, 3
    s_and_b32 s98, s21, 7
    s_lshl_b32 s99, s98, 5
    s_lshl2_add_u32 s98, s97, s99
    s_lshl_b32 s97, s98, 12
    s_lshr_b32 s99, s12, 1
    s_lshl_b32 s98, s99, 6
    s_add_u32 s99, s97, s98
    s_lshl2_add_u32 s97, s96, s99
    s_add_u32 s13, s97, 1048576
    s_lshl_b32 s96, s10, 18
    s_lshl_b32 s97, s77, 12
    s_add_u32 s98, s96, s97
    s_add_u32 s88, s98, 4194304
    s_cmp_ge_u32 s9, 28
    s_cselect_b32 s54, 0, s54
    s_cselect_b32 s58, 0, s58
    s_cselect_b32 s62, 0, s62
    s_waitcnt vmcnt(0)
    s_barrier
    s_cmp_lg_u32 s3, 0
    s_cbranch_scc1 L_PB
    v_mov_b32 v6, s4
    s_mov_b32 exec_hi, 0
    s_mov_b32 exec_lo, 65535
    buffer_store_dword v6, v5, s[32:35], s13 offen sc1
    s_mov_b64 exec, -1
L_PB:
    s_lshr_b32 s96, s9, 4
    s_lshl_b32 s97, s96, 1
    s_xor_b32 s94, s97, 2
    s_add_u32 s96, s94, s84
    s_and_b32 s97, s96, 15
    s_mul_i32 s98, s97, 393216
    s_add_u32 s91, s98, s85
    s_lshl_b32 s96, s94, 13
    s_add_u32 s94, s96, s83
    s_add_u32 s82, s91, 2048
    s_mov_b32 m0, s94
    s_nop 0
    buffer_load_dwordx4 v3, s[40:43], s82 offen lds
    s_add_u32 s82, s91, 4096
    s_add_u32 m0, s94, 49152
    s_nop 0
    buffer_load_dwordx4 v3, s[40:43], s82 offen lds
    s_mov_b32 s82, s91
    s_add_u32 m0, s94, 98304
    s_nop 0
    buffer_load_dwordx4 v3, s[40:43], s82 offen lds
    s_lshr_b32 s96, s9, 4
    s_lshl_b32 s97, s96, 1
    s_xor_b32 s94, s97, 3
    s_add_u32 s96, s94, s84
    s_and_b32 s97, s96, 15
    s_mul_i32 s98, s97, 393216
    s_add_u32 s91, s98, s85
    s_lshl_b32 s96, s94, 13
    s_add_u32 s94, s96, s83
    s_add_u32 s82, s91, 2048
    s_mov_b32 m0, s94
    s_nop 0
    buffer_load_dwordx4 v3, s[40:43], s82 offen lds
    s_add_u32 s82, s91, 4096
    s_add_u32 m0, s94, 49152
    s_nop 0
    buffer_load_dwordx4 v3, s[40:43], s82 offen lds
    s_mov_b32 s82, s91
    s_add_u32 m0, s94, 98304
    s_nop 0
    buffer_load_dwordx4 v3, s[40:43], s82 offen lds
    s_lshl_b32 s96, s2, 12
    s_add_u32 s19, s96, 1048576
    s_and_b32 s96, s3, 3
    s_lshl_b32 s97, s96, 7
    s_add_u32 s20, s97, s19
    s_lshl_b32 s96, s84, 5
    s_add_u32 s19, s96, s19
    s_cmp_ge_u32 s3, 4
    s_cselect_b32 s19, s20, s19
    s_load_dwordx2 s[24:25], s[32:33], s19 offset:0 glc
    s_load_dwordx2 s[26:27], s[32:33], s19 offset:64 glc
    s_add_u32 s96, s84, 4
    s_and_b32 s97, s96, 15
    s_mul_i32 s98, s97, 393216
    s_add_u32 s91, s98, s85
    s_add_u32 s94, s83, 32768
    s_add_u32 s82, s91, 2048
    s_mov_b32 m0, s94
    s_nop 0
    buffer_load_dwordx4 v3, s[40:43], s82 offen lds
    s_add_u32 s82, s91, 4096
    s_add_u32 m0, s94, 49152
    s_nop 0
    buffer_load_dwordx4 v3, s[40:43], s82 offen lds
    s_mov_b32 s82, s91
    s_add_u32 m0, s94, 98304
    s_nop 0
    buffer_load_dwordx4 v3, s[40:43], s82 offen lds
    s_lshl_b32 s96, s3, 14
    s_lshl_b32 s97, s12, 7
    s_add_u32 s90, s96, s97
    s_and_b32 s96, s9, 1
    s_lshr_b32 s97, s9, 3
    s_lshl_b32 s98, s97, 1
    s_lshl3_add_u32 s99, s96, s98
    s_lshl_b32 s95, s99, 17
    s_lshl3_add_u32 s96, s75, s3
    s_mul_i32 s97, s96, 229376
    s_lshl_b32 s98, s74, 7
    s_add_u32 s80, s97, s98
    s_lshl3_add_u32 s96, s74, s3
    s_lshl_b32 s97, s96, 14
    s_lshl_b32 s98, s75, 9
    s_add_u32 s81, s97, s98
    s_and_b32 s96, s8, 3
    s_lshl3_add_u32 s97, s96, s3
    s_mul_i32 s98, s97, 393216
    s_lshr_b32 s99, s8, 2
    s_lshl1_add_u32 s96, s9, s99
    s_lshl_b32 s97, s96, 7
    s_add_u32 s99, s98, s97
    s_add_u32 s89, s99, 4096
    s_and_b32 s96, s3, 1
    s_lshl_b32 s14, s96, 6
    v_bfe_u32 v6, v1, 4, 1
    v_lshl_add_u32 v6, v6, 5, s14
    v_and_b32 v26, 7, v1
    v_lshlrev_b32 v26, 4, v26
    v_xor_b32 v26, v26, v6
    v_lshrrev_b32 v6, 3, v1
    v_lshlrev_b32 v6, 11, v6
    v_add_u32 v26, v26, v6
    s_and_b32 s96, s3, 2
    s_lshl_b32 s14, s96, 5
    v_bfe_u32 v6, v1, 4, 1
    v_lshl_add_u32 v6, v6, 5, s14
    v_and_b32 v27, 7, v1
    v_lshlrev_b32 v27, 4, v27
    v_xor_b32 v27, v27, v6
    v_lshrrev_b32 v6, 3, v1
    v_mul_u32_u24 v6, 7168, v6
    v_add_u32 v27, v27, v6
    s_and_b32 s96, s3, 1
    s_lshl_b32 s14, s96, 7
    v_lshrrev_b32 v6, 5, v1
    v_lshl_add_u32 v6, v6, 6, s14
    v_and_b32 v253, 31, v1
    v_lshlrev_b32 v253, 4, v253
    v_lshrrev_b32 v9, 5, v1
    v_lshl_add_u32 v253, v9, 11, v253
    v_xor_b32 v253, v253, v6
    s_lshl_b32 s16, s84, 14
    v_add_u32 v249, s88, v2
    s_lshl_b32 s96, s77, 11
    s_add_u32 s14, s96, 151552
    v_add_u32 v0, s14, v2
    s_mov_b64 exec, 0
    s_cmp_eq_u32 s3, 4
    s_cbranch_scc1 L_PAD2
    s_cmp_eq_u32 s3, 5
    s_cbranch_scc1 L_PAD3
    s_cmp_eq_u32 s3, 6
    s_cbranch_scc1 L_PAD4
    s_cmp_eq_u32 s3, 7
    s_cbranch_scc1 L_PAD5
    s_branch L_TEND
L_RET2:
    s_branch L_PAD6
L_RET6:
    s_branch L_PAD10
L_RET10:
    s_branch L_TEND
L_RET3:
    s_branch L_PAD7
L_RET7:
    s_branch L_TEND
L_RET4:
    s_branch L_PAD8
L_RET8:
    s_branch L_TEND
L_RET5:
    s_branch L_PAD9
L_RET9:
    s_branch L_TEND
    s_nop 0
    s_nop 0
    s_nop 0
    s_nop 0
    s_nop 0
    s_nop 0
    s_nop 0
    s_nop 0
    s_nop 0
    s_nop 0
    s_nop 0
    s_nop 0
    s_nop 0
    s_nop 0
    s_nop 0
    s_nop 0
    s_nop 0
    s_nop 0
    s_nop 0
    s_nop 0
    s_nop 0
    s_nop 0
    s_nop 0
    s_nop 0
    s_nop 0
    s_nop 0
    s_nop 0
    s_nop 0
L_TEND:
    s_mov_b64 exec, -1
    s_branch SCHK_14
SPOLL_13:
    s_load_dwordx2 s[24:25], s[32:33], s19 offset:0 glc
    s_load_dwordx2 s[26:27], s[32:33], s19 offset:64 glc
SCHK_14:
    s_add_u32 s5, s5, 1
    s_cmp_ge_u32 s5, 200000
    s_waitcnt lgkmcnt(0)
    s_cbranch_scc1 SDONE_15
    s_cmp_lg_u32 s24, s4
    s_cbranch_scc1 SPOLL_13
    s_cmp_lg_u32 s25, s4
    s_cbranch_scc1 SPOLL_13
    s_cmp_lg_u32 s26, s4
    s_cbranch_scc1 SPOLL_13
    s_cmp_lg_u32 s27, s4
    s_cbranch_scc1 SPOLL_13
SDONE_15:
    s_cmp_ge_u32 s3, 4
    s_cbranch_scc1 L_HELP
    s_setprio 2
    buffer_load_dwordx4 v[152:155], v249, s[32:35], s16 offen sc1
    buffer_load_dwordx4 v[156:159], v249, s[32:35], s16 offen offset:1024 sc1
    buffer_load_dwordx4 v[160:163], v249, s[32:35], s16 offen offset:2048 sc1
    buffer_load_dwordx4 v[164:167], v249, s[32:35], s16 offen offset:3072 sc1
    s_add_u32 s16, s16, 16384
    s_and_b32 s16, s16, 0x3ffff
    buffer_load_dwordx4 v[168:171], v249, s[32:35], s16 offen sc1
    buffer_load_dwordx4 v[172:175], v249, s[32:35], s16 offen offset:1024 sc1
    s_waitcnt vmcnt(9)
    s_barrier
    ds_read_b64_tr_b16 v[28:29], v20
    ds_read_b64_tr_b16 v[30:31], v20 offset:2048
    ds_read_b64_tr_b16 v[32:33], v21
    ds_read_b64_tr_b16 v[34:35], v21 offset:2048
    ds_read_b64_tr_b16 v[36:37], v24
    ds_read_b64_tr_b16 v[38:39], v24 offset:2048
    ds_read_b64_tr_b16 v[40:41], v25
    ds_read_b64_tr_b16 v[42:43], v25 offset:2048
    ds_read_b64_tr_b16 v[44:45], v22
    ds_read_b64_tr_b16 v[46:47], v22 offset:2048
    ds_read_b64_tr_b16 v[48:49], v23
    ds_read_b64_tr_b16 v[50:51], v23 offset:2048
    s_waitcnt vmcnt(5)
    s_waitcnt lgkmcnt(10)
    v_mfma_f32_32x32x16_bf16 v[56:71], v[28:31], v[152:155], 0
    ds_read_b64_tr_b16 v[52:53], v20 offset:1024
    ds_read_b64_tr_b16 v[54:55], v20 offset:3072
    s_waitcnt lgkmcnt(10)
    v_mfma_f32_32x32x16_bf16 v[72:87], v[32:35], v[152:155], 0
    ds_read_b64_tr_b16 v[28:29], v21 offset:1024
    ds_read_b64_tr_b16 v[30:31], v21 offset:3072
    s_waitcnt lgkmcnt(10)
    v_mfma_f32_32x32x16_bf16 v[120:135], v[36:39], v[152:155], 0
    ds_read_b64_tr_b16 v[32:33], v24 offset:1024
    ds_read_b64_tr_b16 v[34:35], v24 offset:3072
    s_waitcnt lgkmcnt(10)
    v_mfma_f32_32x32x16_bf16 v[136:151], v[40:43], v[152:155], 0
    ds_read_b64_tr_b16 v[36:37], v25 offset:1024
    ds_read_b64_tr_b16 v[38:39], v25 offset:3072
    s_waitcnt lgkmcnt(10)
    v_mfma_f32_32x32x16_bf16 v[88:103], v[44:47], v[152:155], 0
    buffer_load_dwordx4 v[176:179], v249, s[32:35], s16 offen offset:2048 sc1
    ds_read_b64_tr_b16 v[40:41], v22 offset:1024
    ds_read_b64_tr_b16 v[42:43], v22 offset:3072
    s_waitcnt lgkmcnt(10)
    v_mfma_f32_32x32x16_bf16 v[104:119], v[48:51], v[152:155], 0
    ds_read_b64_tr_b16 v[44:45], v23 offset:1024
    ds_read_b64_tr_b16 v[46:47], v23 offset:3072
    s_waitcnt vmcnt(5)
    s_waitcnt lgkmcnt(10)
    v_mfma_f32_32x32x16_bf16 v[56:71], v[52:55], v[156:159], v[56:71]
    ds_read_b64_tr_b16 v[48:49], v20 offset:4096
    ds_read_b64_tr_b16 v[50:51], v20 offset:6144
    s_waitcnt lgkmcnt(10)
    v_mfma_f32_32x32x16_bf16 v[72:87], v[28:31], v[156:159], v[72:87]
    ds_read_b64_tr_b16 v[52:53], v21 offset:4096
    ds_read_b64_tr_b16 v[54:55], v21 offset:6144
    s_waitcnt lgkmcnt(10)
    v_mfma_f32_32x32x16_bf16 v[120:135], v[32:35], v[156:159], v[120:135]
    ds_read_b64_tr_b16 v[28:29], v24 offset:4096
    ds_read_b64_tr_b16 v[30:31], v24 offset:6144
    s_waitcnt lgkmcnt(10)
    v_mfma_f32_32x32x16_bf16 v[136:151], v[36:39], v[156:159], v[136:151]
    buffer_load_dwordx4 v[180:183], v249, s[32:35], s16 offen offset:3072 sc1
    ds_read_b64_tr_b16 v[32:33], v25 offset:4096
    ds_read_b64_tr_b16 v[34:35], v25 offset:6144
    s_waitcnt lgkmcnt(10)
    v_mfma_f32_32x32x16_bf16 v[88:103], v[40:43], v[156:159], v[88:103]
    s_add_u32 s16, s16, 16384
    ds_read_b64_tr_b16 v[36:37], v22 offset:4096
    ds_read_b64_tr_b16 v[38:39], v22 offset:6144
    s_waitcnt lgkmcnt(10)
    v_mfma_f32_32x32x16_bf16 v[104:119], v[44:47], v[156:159], v[104:119]
    s_and_b32 s16, s16, 0x3ffff
    ds_read_b64_tr_b16 v[40:41], v23 offset:4096
    ds_read_b64_tr_b16 v[42:43], v23 offset:6144
    s_waitcnt vmcnt(5)
    s_waitcnt lgkmcnt(10)
    v_mfma_f32_32x32x16_bf16 v[56:71], v[48:51], v[160:163], v[56:71]
    ds_read_b64_tr_b16 v[44:45], v20 offset:5120
    ds_read_b64_tr_b16 v[46:47], v20 offset:7168
    s_waitcnt lgkmcnt(10)
    v_mfma_f32_32x32x16_bf16 v[72:87], v[52:55], v[160:163], v[72:87]
    ds_read_b64_tr_b16 v[48:49], v21 offset:5120
    ds_read_b64_tr_b16 v[50:51], v21 offset:7168
    s_waitcnt lgkmcnt(10)
    v_mfma_f32_32x32x16_bf16 v[120:135], v[28:31], v[160:163], v[120:135]
    buffer_load_dwordx4 v[184:187], v249, s[32:35], s16 offen sc1
    ds_read_b64_tr_b16 v[52:53], v24 offset:5120
    ds_read_b64_tr_b16 v[54:55], v24 offset:7168
    s_waitcnt lgkmcnt(10)
    v_mfma_f32_32x32x16_bf16 v[136:151], v[32:35], v[160:163], v[136:151]
    ds_read_b64_tr_b16 v[28:29], v25 offset:5120
    ds_read_b64_tr_b16 v[30:31], v25 offset:7168
    s_waitcnt lgkmcnt(10)
    v_mfma_f32_32x32x16_bf16 v[88:103], v[36:39], v[160:163], v[88:103]
    ds_read_b64_tr_b16 v[32:33], v22 offset:5120
    ds_read_b64_tr_b16 v[34:35], v22 offset:7168
    s_waitcnt lgkmcnt(10)
    v_mfma_f32_32x32x16_bf16 v[104:119], v[40:43], v[160:163], v[104:119]
    ds_read_b64_tr_b16 v[36:37], v23 offset:5120
    ds_read_b64_tr_b16 v[38:39], v23 offset:7168
    s_waitcnt vmcnt(5)
    s_waitcnt lgkmcnt(10)
    v_mfma_f32_32x32x16_bf16 v[56:71], v[44:47], v[164:167], v[56:71]
    ds_read_b64_tr_b16 v[40:41], v20 offset:8192
    ds_read_b64_tr_b16 v[42:43], v20 offset:10240
    s_waitcnt lgkmcnt(10)
    v_mfma_f32_32x32x16_bf16 v[72:87], v[48:51], v[164:167], v[72:87]
    buffer_load_dwordx4 v[188:191], v249, s[32:35], s16 offen offset:1024 sc1
    ds_read_b64_tr_b16 v[44:45], v21 offset:8192
    ds_read_b64_tr_b16 v[46:47], v21 offset:10240
    s_waitcnt lgkmcnt(10)
    v_mfma_f32_32x32x16_bf16 v[120:135], v[52:55], v[164:167], v[120:135]
    ds_read_b64_tr_b16 v[48:49], v24 offset:8192
    ds_read_b64_tr_b16 v[50:51], v24 offset:10240
    s_waitcnt lgkmcnt(10)
    v_mfma_f32_32x32x16_bf16 v[136:151], v[28:31], v[164:167], v[136:151]
    ds_read_b64_tr_b16 v[52:53], v25 offset:8192
    ds_read_b64_tr_b16 v[54:55], v25 offset:10240
    s_waitcnt lgkmcnt(10)
    v_mfma_f32_32x32x16_bf16 v[88:103], v[32:35], v[164:167], v[88:103]
    ds_read_b64_tr_b16 v[28:29], v22 offset:8192
    ds_read_b64_tr_b16 v[30:31], v22 offset:10240
    s_waitcnt lgkmcnt(10)
    v_mfma_f32_32x32x16_bf16 v[104:119], v[36:39], v[164:167], v[104:119]
    buffer_load_dwordx4 v[192:195], v249, s[32:35], s16 offen offset:2048 sc1
    ds_read_b64_tr_b16 v[32:33], v23 offset:8192
    ds_read_b64_tr_b16 v[34:35], v23 offset:10240
    s_barrier
    s_waitcnt vmcnt(6)
    s_waitcnt lgkmcnt(10)
    v_mfma_f32_32x32x16_bf16 v[56:71], v[40:43], v[168:171], v[56:71]
    ds_read_b64_tr_b16 v[36:37], v20 offset:9216
    ds_read_b64_tr_b16 v[38:39], v20 offset:11264
    s_waitcnt lgkmcnt(10)
    v_mfma_f32_32x32x16_bf16 v[72:87], v[44:47], v[168:171], v[72:87]
    ds_read_b64_tr_b16 v[40:41], v21 offset:9216
    ds_read_b64_tr_b16 v[42:43], v21 offset:11264
    s_waitcnt lgkmcnt(10)
    v_mfma_f32_32x32x16_bf16 v[120:135], v[48:51], v[168:171], v[120:135]
    ds_read_b64_tr_b16 v[44:45], v24 offset:9216
    ds_read_b64_tr_b16 v[46:47], v24 offset:11264
    s_waitcnt lgkmcnt(10)
    v_mfma_f32_32x32x16_bf16 v[136:151], v[52:55], v[168:171], v[136:151]
    ds_read_b64_tr_b16 v[48:49], v25 offset:9216
    ds_read_b64_tr_b16 v[50:51], v25 offset:11264
    s_waitcnt lgkmcnt(10)
    v_mfma_f32_32x32x16_bf16 v[88:103], v[28:31], v[168:171], v[88:103]
    buffer_load_dwordx4 v[196:199], v249, s[32:35], s16 offen offset:3072 sc1
    ds_read_b64_tr_b16 v[52:53], v22 offset:9216
    ds_read_b64_tr_b16 v[54:55], v22 offset:11264
    s_waitcnt lgkmcnt(10)
    v_mfma_f32_32x32x16_bf16 v[104:119], v[32:35], v[168:171], v[104:119]
    s_add_u32 s16, s16, 16384
    ds_read_b64_tr_b16 v[28:29], v23 offset:9216
    ds_read_b64_tr_b16 v[30:31], v23 offset:11264
    s_waitcnt vmcnt(6)
    s_waitcnt lgkmcnt(10)
    v_mfma_f32_32x32x16_bf16 v[56:71], v[36:39], v[172:175], v[56:71]
    s_and_b32 s16, s16, 0x3ffff
    ds_read_b64_tr_b16 v[32:33], v20 offset:12288
    ds_read_b64_tr_b16 v[34:35], v20 offset:14336
    s_waitcnt lgkmcnt(10)
    v_mfma_f32_32x32x16_bf16 v[72:87], v[40:43], v[172:175], v[72:87]
    ds_read_b64_tr_b16 v[36:37], v21 offset:12288
    ds_read_b64_tr_b16 v[38:39], v21 offset:14336
    s_waitcnt lgkmcnt(10)
    v_mfma_f32_32x32x16_bf16 v[120:135], v[44:47], v[172:175], v[120:135]
    ds_read_b64_tr_b16 v[40:41], v24 offset:12288
    ds_read_b64_tr_b16 v[42:43], v24 offset:14336
    s_waitcnt lgkmcnt(10)
    v_mfma_f32_32x32x16_bf16 v[136:151], v[48:51], v[172:175], v[136:151]
    buffer_load_dwordx4 v[200:203], v249, s[32:35], s16 offen sc1
    ds_read_b64_tr_b16 v[44:45], v25 offset:12288
    ds_read_b64_tr_b16 v[46:47], v25 offset:14336
    s_waitcnt lgkmcnt(10)
    v_mfma_f32_32x32x16_bf16 v[88:103], v[52:55], v[172:175], v[88:103]
    ds_read_b64_tr_b16 v[48:49], v22 offset:12288
    ds_read_b64_tr_b16 v[50:51], v22 offset:14336
    s_waitcnt lgkmcnt(10)
    v_mfma_f32_32x32x16_bf16 v[104:119], v[28:31], v[172:175], v[104:119]
    ds_read_b64_tr_b16 v[52:53], v23 offset:12288
    ds_read_b64_tr_b16 v[54:55], v23 offset:14336
    s_waitcnt vmcnt(6)
    s_waitcnt lgkmcnt(10)
    v_mfma_f32_32x32x16_bf16 v[56:71], v[32:35], v[176:179], v[56:71]
    ds_read_b64_tr_b16 v[28:29], v20 offset:13312
    ds_read_b64_tr_b16 v[30:31], v20 offset:15360
    s_waitcnt lgkmcnt(10)
    v_mfma_f32_32x32x16_bf16 v[72:87], v[36:39], v[176:179], v[72:87]
    ds_read_b64_tr_b16 v[32:33], v21 offset:13312
    ds_read_b64_tr_b16 v[34:35], v21 offset:15360
    s_waitcnt lgkmcnt(10)
    v_mfma_f32_32x32x16_bf16 v[120:135], v[40:43], v[176:179], v[120:135]
    buffer_load_dwordx4 v[204:207], v249, s[32:35], s16 offen offset:1024 sc1
    ds_read_b64_tr_b16 v[36:37], v24 offset:13312
    ds_read_b64_tr_b16 v[38:39], v24 offset:15360
    s_waitcnt lgkmcnt(10)
    v_mfma_f32_32x32x16_bf16 v[136:151], v[44:47], v[176:179], v[136:151]
    ds_read_b64_tr_b16 v[40:41], v25 offset:13312
    ds_read_b64_tr_b16 v[42:43], v25 offset:15360
    s_waitcnt lgkmcnt(10)
    v_mfma_f32_32x32x16_bf16 v[88:103], v[48:51], v[176:179], v[88:103]
    ds_read_b64_tr_b16 v[44:45], v22 offset:13312
    ds_read_b64_tr_b16 v[46:47], v22 offset:15360
    s_waitcnt lgkmcnt(10)
    v_mfma_f32_32x32x16_bf16 v[104:119], v[52:55], v[176:179], v[104:119]
    ds_read_b64_tr_b16 v[48:49], v23 offset:13312
    ds_read_b64_tr_b16 v[50:51], v23 offset:15360
    s_waitcnt vmcnt(6)
    s_waitcnt lgkmcnt(10)
    v_mfma_f32_32x32x16_bf16 v[56:71], v[28:31], v[180:183], v[56:71]
    ds_read_b64_tr_b16 v[52:53], v20 offset:16384
    ds_read_b64_tr_b16 v[54:55], v20 offset:18432
    s_waitcnt lgkmcnt(10)
    v_mfma_f32_32x32x16_bf16 v[72:87], v[32:35], v[180:183], v[72:87]
    buffer_load_dwordx4 v[208:211], v249, s[32:35], s16 offen offset:2048 sc1
    ds_read_b64_tr_b16 v[28:29], v21 offset:16384
    ds_read_b64_tr_b16 v[30:31], v21 offset:18432
    s_waitcnt lgkmcnt(10)
    v_mfma_f32_32x32x16_bf16 v[120:135], v[36:39], v[180:183], v[120:135]
    ds_read_b64_tr_b16 v[32:33], v24 offset:16384
    ds_read_b64_tr_b16 v[34:35], v24 offset:18432
    s_waitcnt lgkmcnt(10)
    v_mfma_f32_32x32x16_bf16 v[136:151], v[40:43], v[180:183], v[136:151]
    ds_read_b64_tr_b16 v[36:37], v25 offset:16384
    ds_read_b64_tr_b16 v[38:39], v25 offset:18432
    s_waitcnt lgkmcnt(10)
    v_mfma_f32_32x32x16_bf16 v[88:103], v[44:47], v[180:183], v[88:103]
    ds_read_b64_tr_b16 v[40:41], v22 offset:16384
    ds_read_b64_tr_b16 v[42:43], v22 offset:18432
    s_waitcnt lgkmcnt(10)
    v_mfma_f32_32x32x16_bf16 v[104:119], v[48:51], v[180:183], v[104:119]
    buffer_load_dwordx4 v[212:215], v249, s[32:35], s16 offen offset:3072 sc1
    ds_read_b64_tr_b16 v[44:45], v23 offset:16384
    ds_read_b64_tr_b16 v[46:47], v23 offset:18432
    s_barrier
    s_waitcnt vmcnt(7)
    s_waitcnt lgkmcnt(10)
    v_mfma_f32_32x32x16_bf16 v[56:71], v[52:55], v[184:187], v[56:71]
    s_add_u32 s16, s16, 16384
    ds_read_b64_tr_b16 v[48:49], v20 offset:17408
    ds_read_b64_tr_b16 v[50:51], v20 offset:19456
    s_waitcnt lgkmcnt(10)
    v_mfma_f32_32x32x16_bf16 v[72:87], v[28:31], v[184:187], v[72:87]
    s_and_b32 s16, s16, 0x3ffff
    ds_read_b64_tr_b16 v[52:53], v21 offset:17408
    ds_read_b64_tr_b16 v[54:55], v21 offset:19456
    s_waitcnt lgkmcnt(10)
    v_mfma_f32_32x32x16_bf16 v[120:135], v[32:35], v[184:187], v[120:135]
    ds_read_b64_tr_b16 v[28:29], v24 offset:17408
    ds_read_b64_tr_b16 v[30:31], v24 offset:19456
    s_waitcnt lgkmcnt(10)
    v_mfma_f32_32x32x16_bf16 v[136:151], v[36:39], v[184:187], v[136:151]
    ds_read_b64_tr_b16 v[32:33], v25 offset:17408
    ds_read_b64_tr_b16 v[34:35], v25 offset:19456
    s_waitcnt lgkmcnt(10)
    v_mfma_f32_32x32x16_bf16 v[88:103], v[40:43], v[184:187], v[88:103]
    buffer_load_dwordx4 v[216:219], v249, s[32:35], s16 offen sc1
    ds_read_b64_tr_b16 v[36:37], v22 offset:17408
    ds_read_b64_tr_b16 v[38:39], v22 offset:19456
    s_waitcnt lgkmcnt(10)
    v_mfma_f32_32x32x16_bf16 v[104:119], v[44:47], v[184:187], v[104:119]
    ds_read_b64_tr_b16 v[40:41], v23 offset:17408
    ds_read_b64_tr_b16 v[42:43], v23 offset:19456
    s_waitcnt vmcnt(7)
    s_waitcnt lgkmcnt(10)
    v_mfma_f32_32x32x16_bf16 v[56:71], v[48:51], v[188:191], v[56:71]
    ds_read_b64_tr_b16 v[44:45], v20 offset:20480
    ds_read_b64_tr_b16 v[46:47], v20 offset:22528
    s_waitcnt lgkmcnt(10)
    v_mfma_f32_32x32x16_bf16 v[72:87], v[52:55], v[188:191], v[72:87]
    ds_read_b64_tr_b16 v[48:49], v21 offset:20480
    ds_read_b64_tr_b16 v[50:51], v21 offset:22528
    s_waitcnt lgkmcnt(10)
    v_mfma_f32_32x32x16_bf16 v[120:135], v[28:31], v[188:191], v[120:135]
    ds_read_b64_tr_b16 v[52:53], v24 offset:20480
    ds_read_b64_tr_b16 v[54:55], v24 offset:22528
    s_waitcnt lgkmcnt(10)
    v_mfma_f32_32x32x16_bf16 v[136:151], v[32:35], v[188:191], v[136:151]
    buffer_load_dwordx4 v[220:223], v249, s[32:35], s16 offen offset:1024 sc1
    ds_read_b64_tr_b16 v[28:29], v25 offset:20480
    ds_read_b64_tr_b16 v[30:31], v25 offset:22528
    s_waitcnt lgkmcnt(10)
    v_mfma_f32_32x32x16_bf16 v[88:103], v[36:39], v[188:191], v[88:103]
    ds_read_b64_tr_b16 v[32:33], v22 offset:20480
    ds_read_b64_tr_b16 v[34:35], v22 offset:22528
    s_waitcnt lgkmcnt(10)
    v_mfma_f32_32x32x16_bf16 v[104:119], v[40:43], v[188:191], v[104:119]
    ds_read_b64_tr_b16 v[36:37], v23 offset:20480
    ds_read_b64_tr_b16 v[38:39], v23 offset:22528
    s_waitcnt vmcnt(7)
    s_waitcnt lgkmcnt(10)
    v_mfma_f32_32x32x16_bf16 v[56:71], v[44:47], v[192:195], v[56:71]
    ds_read_b64_tr_b16 v[40:41], v20 offset:21504
    ds_read_b64_tr_b16 v[42:43], v20 offset:23552
    s_waitcnt lgkmcnt(10)
    v_mfma_f32_32x32x16_bf16 v[72:87], v[48:51], v[192:195], v[72:87]
    ds_read_b64_tr_b16 v[44:45], v21 offset:21504
    ds_read_b64_tr_b16 v[46:47], v21 offset:23552
    s_waitcnt lgkmcnt(10)
    v_mfma_f32_32x32x16_bf16 v[120:135], v[52:55], v[192:195], v[120:135]
    buffer_load_dwordx4 v[224:227], v249, s[32:35], s16 offen offset:2048 sc1
    ds_read_b64_tr_b16 v[48:49], v24 offset:21504
    ds_read_b64_tr_b16 v[50:51], v24 offset:23552
    s_waitcnt lgkmcnt(10)
    v_mfma_f32_32x32x16_bf16 v[136:151], v[28:31], v[192:195], v[136:151]
    ds_read_b64_tr_b16 v[52:53], v25 offset:21504
    ds_read_b64_tr_b16 v[54:55], v25 offset:23552
    s_waitcnt lgkmcnt(10)
    v_mfma_f32_32x32x16_bf16 v[88:103], v[32:35], v[192:195], v[88:103]
    ds_read_b64_tr_b16 v[28:29], v22 offset:21504
    ds_read_b64_tr_b16 v[30:31], v22 offset:23552
    s_waitcnt lgkmcnt(10)
    v_mfma_f32_32x32x16_bf16 v[104:119], v[36:39], v[192:195], v[104:119]
    ds_read_b64_tr_b16 v[32:33], v23 offset:21504
    ds_read_b64_tr_b16 v[34:35], v23 offset:23552
    s_waitcnt vmcnt(7)
    s_waitcnt lgkmcnt(10)
    v_mfma_f32_32x32x16_bf16 v[56:71], v[40:43], v[196:199], v[56:71]
    ds_read_b64_tr_b16 v[36:37], v20 offset:24576
    ds_read_b64_tr_b16 v[38:39], v20 offset:26624
    s_waitcnt lgkmcnt(10)
    v_mfma_f32_32x32x16_bf16 v[72:87], v[44:47], v[196:199], v[72:87]
    buffer_load_dwordx4 v[228:231], v249, s[32:35], s16 offen offset:3072 sc1
    ds_read_b64_tr_b16 v[40:41], v21 offset:24576
    ds_read_b64_tr_b16 v[42:43], v21 offset:26624
    s_waitcnt lgkmcnt(10)
    v_mfma_f32_32x32x16_bf16 v[120:135], v[48:51], v[196:199], v[120:135]
    s_add_u32 s16, s16, 16384
    ds_read_b64_tr_b16 v[44:45], v24 offset:24576
    ds_read_b64_tr_b16 v[46:47], v24 offset:26624
    s_waitcnt lgkmcnt(10)
    v_mfma_f32_32x32x16_bf16 v[136:151], v[52:55], v[196:199], v[136:151]
    s_and_b32 s16, s16, 0x3ffff
    ds_read_b64_tr_b16 v[48:49], v25 offset:24576
    ds_read_b64_tr_b16 v[50:51], v25 offset:26624
    s_waitcnt lgkmcnt(10)
    v_mfma_f32_32x32x16_bf16 v[88:103], v[28:31], v[196:199], v[88:103]
    ds_read_b64_tr_b16 v[52:53], v22 offset:24576
    ds_read_b64_tr_b16 v[54:55], v22 offset:26624
    s_waitcnt lgkmcnt(10)
    v_mfma_f32_32x32x16_bf16 v[104:119], v[32:35], v[196:199], v[104:119]
    buffer_load_dwordx4 v[232:235], v249, s[32:35], s16 offen sc1
    ds_read_b64_tr_b16 v[28:29], v23 offset:24576
    ds_read_b64_tr_b16 v[30:31], v23 offset:26624
    s_barrier
    s_waitcnt vmcnt(8)
    s_waitcnt lgkmcnt(10)
    v_mfma_f32_32x32x16_bf16 v[56:71], v[36:39], v[200:203], v[56:71]
    ds_read_b64_tr_b16 v[32:33], v20 offset:25600
    ds_read_b64_tr_b16 v[34:35], v20 offset:27648
    s_waitcnt lgkmcnt(10)
    v_mfma_f32_32x32x16_bf16 v[72:87], v[40:43], v[200:203], v[72:87]
    ds_read_b64_tr_b16 v[36:37], v21 offset:25600
    ds_read_b64_tr_b16 v[38:39], v21 offset:27648
    s_waitcnt lgkmcnt(10)
    v_mfma_f32_32x32x16_bf16 v[120:135], v[44:47], v[200:203], v[120:135]
    ds_read_b64_tr_b16 v[40:41], v24 offset:25600
    ds_read_b64_tr_b16 v[42:43], v24 offset:27648
    s_waitcnt lgkmcnt(10)
    v_mfma_f32_32x32x16_bf16 v[136:151], v[48:51], v[200:203], v[136:151]
    ds_read_b64_tr_b16 v[44:45], v25 offset:25600
    ds_read_b64_tr_b16 v[46:47], v25 offset:27648
    s_waitcnt lgkmcnt(10)
    v_mfma_f32_32x32x16_bf16 v[88:103], v[52:55], v[200:203], v[88:103]
    buffer_load_dwordx4 v[236:239], v249, s[32:35], s16 offen offset:1024 sc1
    ds_read_b64_tr_b16 v[48:49], v22 offset:25600
    ds_read_b64_tr_b16 v[50:51], v22 offset:27648
    s_waitcnt lgkmcnt(10)
    v_mfma_f32_32x32x16_bf16 v[104:119], v[28:31], v[200:203], v[104:119]
    ds_read_b64_tr_b16 v[52:53], v23 offset:25600
    ds_read_b64_tr_b16 v[54:55], v23 offset:27648
    s_waitcnt vmcnt(8)
    s_waitcnt lgkmcnt(10)
    v_mfma_f32_32x32x16_bf16 v[56:71], v[32:35], v[204:207], v[56:71]
    ds_read_b64_tr_b16 v[28:29], v20 offset:28672
    ds_read_b64_tr_b16 v[30:31], v20 offset:30720
    s_waitcnt lgkmcnt(10)
    v_mfma_f32_32x32x16_bf16 v[72:87], v[36:39], v[204:207], v[72:87]
L_PAD2:
    s_cbranch_execz L_RET2
    ds_read_b64_tr_b16 v[32:33], v21 offset:28672
    ds_read_b64_tr_b16 v[34:35], v21 offset:30720
    s_waitcnt lgkmcnt(10)
    v_mfma_f32_32x32x16_bf16 v[120:135], v[40:43], v[204:207], v[120:135]
    ds_read_b64_tr_b16 v[36:37], v24 offset:28672
    ds_read_b64_tr_b16 v[38:39], v24 offset:30720
    s_waitcnt lgkmcnt(10)
    v_mfma_f32_32x32x16_bf16 v[136:151], v[44:47], v[204:207], v[136:151]
    buffer_load_dwordx4 v[240:243], v249, s[32:35], s16 offen offset:2048 sc1
    ds_read_b64_tr_b16 v[40:41], v25 offset:28672
    ds_read_b64_tr_b16 v[42:43], v25 offset:30720
    s_waitcnt lgkmcnt(10)
    v_mfma_f32_32x32x16_bf16 v[88:103], v[48:51], v[204:207], v[88:103]
    ds_read_b64_tr_b16 v[44:45], v22 offset:28672
    ds_read_b64_tr_b16 v[46:47], v22 offset:30720
    s_waitcnt lgkmcnt(10)
    v_mfma_f32_32x32x16_bf16 v[104:119], v[52:55], v[204:207], v[104:119]
    ds_read_b64_tr_b16 v[48:49], v23 offset:28672
    ds_read_b64_tr_b16 v[50:51], v23 offset:30720
    s_waitcnt vmcnt(8)
    s_waitcnt lgkmcnt(10)
    v_mfma_f32_32x32x16_bf16 v[56:71], v[28:31], v[208:211], v[56:71]
    ds_read_b64_tr_b16 v[52:53], v20 offset:29696
    ds_read_b64_tr_b16 v[54:55], v20 offset:31744
    s_waitcnt lgkmcnt(10)
    v_mfma_f32_32x32x16_bf16 v[72:87], v[32:35], v[208:211], v[72:87]
    ds_read_b64_tr_b16 v[28:29], v21 offset:29696
    ds_read_b64_tr_b16 v[30:31], v21 offset:31744
    s_waitcnt lgkmcnt(10)
    v_mfma_f32_32x32x16_bf16 v[120:135], v[36:39], v[208:211], v[120:135]
    buffer_load_dwordx4 v[244:247], v249, s[32:35], s16 offen offset:3072 sc1
    ds_read_b64_tr_b16 v[32:33], v24 offset:29696
    ds_read_b64_tr_b16 v[34:35], v24 offset:31744
    s_waitcnt lgkmcnt(10)
    v_mfma_f32_32x32x16_bf16 v[136:151], v[40:43], v[208:211], v[136:151]
    s_add_u32 s16, s16, 16384
    ds_read_b64_tr_b16 v[36:37], v25 offset:29696
    ds_read_b64_tr_b16 v[38:39], v25 offset:31744
    s_waitcnt lgkmcnt(10)
    v_mfma_f32_32x32x16_bf16 v[88:103], v[44:47], v[208:211], v[88:103]
    s_and_b32 s16, s16, 0x3ffff
    ds_read_b64_tr_b16 v[40:41], v22 offset:29696
    ds_read_b64_tr_b16 v[42:43], v22 offset:31744
    s_waitcnt lgkmcnt(10)
    v_mfma_f32_32x32x16_bf16 v[104:119], v[48:51], v[208:211], v[104:119]
    ds_read_b64_tr_b16 v[44:45], v23 offset:29696
    ds_read_b64_tr_b16 v[46:47], v23 offset:31744
    s_waitcnt vmcnt(8)
    s_waitcnt lgkmcnt(10)
    v_mfma_f32_32x32x16_bf16 v[56:71], v[52:55], v[212:215], v[56:71]
    ds_read_b64_tr_b16 v[48:49], v20 offset:32768
    ds_read_b64_tr_b16 v[50:51], v20 offset:34816
    s_waitcnt lgkmcnt(10)
    v_mfma_f32_32x32x16_bf16 v[72:87], v[28:31], v[212:215], v[72:87]
    buffer_load_dwordx4 v[152:155], v249, s[32:35], s16 offen sc1
    ds_read_b64_tr_b16 v[52:53], v21 offset:32768
    ds_read_b64_tr_b16 v[54:55], v21 offset:34816
    s_waitcnt lgkmcnt(10)
    v_mfma_f32_32x32x16_bf16 v[120:135], v[32:35], v[212:215], v[120:135]
    ds_read_b64_tr_b16 v[28:29], v24 offset:32768
    ds_read_b64_tr_b16 v[30:31], v24 offset:34816
    s_waitcnt lgkmcnt(10)
    v_mfma_f32_32x32x16_bf16 v[136:151], v[36:39], v[212:215], v[136:151]
    ds_read_b64_tr_b16 v[32:33], v25 offset:32768
    ds_read_b64_tr_b16 v[34:35], v25 offset:34816
    s_waitcnt lgkmcnt(10)
    v_mfma_f32_32x32x16_bf16 v[88:103], v[40:43], v[212:215], v[88:103]
    ds_read_b64_tr_b16 v[36:37], v22 offset:32768
    ds_read_b64_tr_b16 v[38:39], v22 offset:34816
    s_waitcnt lgkmcnt(10)
    v_mfma_f32_32x32x16_bf16 v[104:119], v[44:47], v[212:215], v[104:119]
    buffer_load_dwordx4 v[156:159], v249, s[32:35], s16 offen offset:1024 sc1
    ds_read_b64_tr_b16 v[40:41], v23 offset:32768
    ds_read_b64_tr_b16 v[42:43], v23 offset:34816
    s_barrier
    s_waitcnt vmcnt(9)
    s_waitcnt lgkmcnt(10)
    v_mfma_f32_32x32x16_bf16 v[56:71], v[48:51], v[216:219], v[56:71]
    ds_read_b64_tr_b16 v[44:45], v20 offset:33792
    ds_read_b64_tr_b16 v[46:47], v20 offset:35840
    s_waitcnt lgkmcnt(10)
    v_mfma_f32_32x32x16_bf16 v[72:87], v[52:55], v[216:219], v[72:87]
    ds_read_b64_tr_b16 v[48:49], v21 offset:33792
    ds_read_b64_tr_b16 v[50:51], v21 offset:35840
    s_waitcnt lgkmcnt(10)
    v_mfma_f32_32x32x16_bf16 v[120:135], v[28:31], v[216:219], v[120:135]
    ds_read_b64_tr_b16 v[52:53], v24 offset:33792
    ds_read_b64_tr_b16 v[54:55], v24 offset:35840
    s_waitcnt lgkmcnt(10)
    v_mfma_f32_32x32x16_bf16 v[136:151], v[32:35], v[216:219], v[136:151]
    ds_read_b64_tr_b16 v[28:29], v25 offset:33792
    ds_read_b64_tr_b16 v[30:31], v25 offset:35840
    s_waitcnt lgkmcnt(10)
    v_mfma_f32_32x32x16_bf16 v[88:103], v[36:39], v[216:219], v[88:103]
    buffer_load_dwordx4 v[160:163], v249, s[32:35], s16 offen offset:2048 sc1
    ds_read_b64_tr_b16 v[32:33], v22 offset:33792
    ds_read_b64_tr_b16 v[34:35], v22 offset:35840
    s_waitcnt lgkmcnt(10)
    v_mfma_f32_32x32x16_bf16 v[104:119], v[40:43], v[216:219], v[104:119]
    ds_read_b64_tr_b16 v[36:37], v23 offset:33792
    ds_read_b64_tr_b16 v[38:39], v23 offset:35840
    s_waitcnt vmcnt(9)
    s_waitcnt lgkmcnt(10)
    v_mfma_f32_32x32x16_bf16 v[56:71], v[44:47], v[220:223], v[56:71]
    ds_read_b64_tr_b16 v[40:41], v20 offset:36864
    ds_read_b64_tr_b16 v[42:43], v20 offset:38912
    s_waitcnt lgkmcnt(10)
    v_mfma_f32_32x32x16_bf16 v[72:87], v[48:51], v[220:223], v[72:87]
    ds_read_b64_tr_b16 v[44:45], v21 offset:36864
    ds_read_b64_tr_b16 v[46:47], v21 offset:38912
    s_waitcnt lgkmcnt(10)
    v_mfma_f32_32x32x16_bf16 v[120:135], v[52:55], v[220:223], v[120:135]
    ds_read_b64_tr_b16 v[48:49], v24 offset:36864
    ds_read_b64_tr_b16 v[50:51], v24 offset:38912
    s_waitcnt lgkmcnt(10)
    v_mfma_f32_32x32x16_bf16 v[136:151], v[28:31], v[220:223], v[136:151]
    buffer_load_dwordx4 v[164:167], v249, s[32:35], s16 offen offset:3072 sc1
    ds_read_b64_tr_b16 v[52:53], v25 offset:36864
    ds_read_b64_tr_b16 v[54:55], v25 offset:38912
    s_waitcnt lgkmcnt(10)
    v_mfma_f32_32x32x16_bf16 v[88:103], v[32:35], v[220:223], v[88:103]
    s_add_u32 s16, s16, 16384
    ds_read_b64_tr_b16 v[28:29], v22 offset:36864
    ds_read_b64_tr_b16 v[30:31], v22 offset:38912
    s_waitcnt lgkmcnt(10)
    v_mfma_f32_32x32x16_bf16 v[104:119], v[36:39], v[220:223], v[104:119]
    s_and_b32 s16, s16, 0x3ffff
    ds_read_b64_tr_b16 v[32:33], v23 offset:36864
    ds_read_b64_tr_b16 v[34:35], v23 offset:38912
    s_waitcnt vmcnt(9)
    s_waitcnt lgkmcnt(10)
    v_mfma_f32_32x32x16_bf16 v[56:71], v[40:43], v[224:227], v[56:71]
    ds_read_b64_tr_b16 v[36:37], v20 offset:37888
    ds_read_b64_tr_b16 v[38:39], v20 offset:39936
    s_waitcnt lgkmcnt(10)
    v_mfma_f32_32x32x16_bf16 v[72:87], v[44:47], v[224:227], v[72:87]
    ds_read_b64_tr_b16 v[40:41], v21 offset:37888
    ds_read_b64_tr_b16 v[42:43], v21 offset:39936
    s_waitcnt lgkmcnt(10)
    v_mfma_f32_32x32x16_bf16 v[120:135], v[48:51], v[224:227], v[120:135]
    buffer_load_dwordx4 v[168:171], v249, s[32:35], s16 offen sc1
    ds_read_b64_tr_b16 v[44:45], v24 offset:37888
    ds_read_b64_tr_b16 v[46:47], v24 offset:39936
    s_waitcnt lgkmcnt(10)
    v_mfma_f32_32x32x16_bf16 v[136:151], v[52:55], v[224:227], v[136:151]
    ds_read_b64_tr_b16 v[48:49], v25 offset:37888
    ds_read_b64_tr_b16 v[50:51], v25 offset:39936
    s_waitcnt lgkmcnt(10)
    v_mfma_f32_32x32x16_bf16 v[88:103], v[28:31], v[224:227], v[88:103]
    ds_read_b64_tr_b16 v[52:53], v22 offset:37888
    ds_read_b64_tr_b16 v[54:55], v22 offset:39936
    s_waitcnt lgkmcnt(10)
    v_mfma_f32_32x32x16_bf16 v[104:119], v[32:35], v[224:227], v[104:119]
    ds_read_b64_tr_b16 v[28:29], v23 offset:37888
    ds_read_b64_tr_b16 v[30:31], v23 offset:39936
    s_waitcnt vmcnt(9)
    s_waitcnt lgkmcnt(10)
    v_mfma_f32_32x32x16_bf16 v[56:71], v[36:39], v[228:231], v[56:71]
    ds_read_b64_tr_b16 v[32:33], v20 offset:40960
    ds_read_b64_tr_b16 v[34:35], v20 offset:43008
    s_waitcnt lgkmcnt(10)
    v_mfma_f32_32x32x16_bf16 v[72:87], v[40:43], v[228:231], v[72:87]
    buffer_load_dwordx4 v[172:175], v249, s[32:35], s16 offen offset:1024 sc1
    ds_read_b64_tr_b16 v[36:37], v21 offset:40960
    ds_read_b64_tr_b16 v[38:39], v21 offset:43008
    s_waitcnt lgkmcnt(10)
    v_mfma_f32_32x32x16_bf16 v[120:135], v[44:47], v[228:231], v[120:135]
    ds_read_b64_tr_b16 v[40:41], v24 offset:40960
    ds_read_b64_tr_b16 v[42:43], v24 offset:43008
    s_waitcnt lgkmcnt(10)
    v_mfma_f32_32x32x16_bf16 v[136:151], v[48:51], v[228:231], v[136:151]
    ds_read_b64_tr_b16 v[44:45], v25 offset:40960
    ds_read_b64_tr_b16 v[46:47], v25 offset:43008
    s_waitcnt lgkmcnt(10)
    v_mfma_f32_32x32x16_bf16 v[88:103], v[52:55], v[228:231], v[88:103]
    ds_read_b64_tr_b16 v[48:49], v22 offset:40960
    ds_read_b64_tr_b16 v[50:51], v22 offset:43008
    s_waitcnt lgkmcnt(10)
    v_mfma_f32_32x32x16_bf16 v[104:119], v[28:31], v[228:231], v[104:119]
    buffer_load_dwordx4 v[176:179], v249, s[32:35], s16 offen offset:2048 sc1
    ds_read_b64_tr_b16 v[52:53], v23 offset:40960
    ds_read_b64_tr_b16 v[54:55], v23 offset:43008
    s_barrier
    s_waitcnt vmcnt(10)
    s_waitcnt lgkmcnt(10)
    v_mfma_f32_32x32x16_bf16 v[56:71], v[32:35], v[232:235], v[56:71]
    ds_read_b64_tr_b16 v[28:29], v20 offset:41984
    ds_read_b64_tr_b16 v[30:31], v20 offset:44032
    s_waitcnt lgkmcnt(10)
    v_mfma_f32_32x32x16_bf16 v[72:87], v[36:39], v[232:235], v[72:87]
    ds_read_b64_tr_b16 v[32:33], v21 offset:41984
    ds_read_b64_tr_b16 v[34:35], v21 offset:44032
    s_waitcnt lgkmcnt(10)
    v_mfma_f32_32x32x16_bf16 v[120:135], v[40:43], v[232:235], v[120:135]
    ds_read_b64_tr_b16 v[36:37], v24 offset:41984
    ds_read_b64_tr_b16 v[38:39], v24 offset:44032
    s_waitcnt lgkmcnt(10)
    v_mfma_f32_32x32x16_bf16 v[136:151], v[44:47], v[232:235], v[136:151]
    buffer_load_dwordx4 v[180:183], v249, s[32:35], s16 offen offset:3072 sc1
    ds_read_b64_tr_b16 v[40:41], v25 offset:41984
    ds_read_b64_tr_b16 v[42:43], v25 offset:44032
    s_waitcnt lgkmcnt(10)
    v_mfma_f32_32x32x16_bf16 v[88:103], v[48:51], v[232:235], v[88:103]
    s_add_u32 s16, s16, 16384
    ds_read_b64_tr_b16 v[44:45], v22 offset:41984
    ds_read_b64_tr_b16 v[46:47], v22 offset:44032
    s_waitcnt lgkmcnt(10)
    v_mfma_f32_32x32x16_bf16 v[104:119], v[52:55], v[232:235], v[104:119]
    s_and_b32 s16, s16, 0x3ffff
    ds_read_b64_tr_b16 v[48:49], v23 offset:41984
    ds_read_b64_tr_b16 v[50:51], v23 offset:44032
    s_waitcnt vmcnt(10)
    s_waitcnt lgkmcnt(10)
    v_mfma_f32_32x32x16_bf16 v[56:71], v[28:31], v[236:239], v[56:71]
    buffer_load_dwordx4 v[184:187], v249, s[32:35], s16 offen sc1
    ds_read_b64_tr_b16 v[52:53], v20 offset:45056
    ds_read_b64_tr_b16 v[54:55], v20 offset:47104
    s_waitcnt lgkmcnt(10)
    v_mfma_f32_32x32x16_bf16 v[72:87], v[32:35], v[236:239], v[72:87]
    ds_read_b64_tr_b16 v[28:29], v21 offset:45056
    ds_read_b64_tr_b16 v[30:31], v21 offset:47104
    s_waitcnt lgkmcnt(10)
    v_mfma_f32_32x32x16_bf16 v[120:135], v[36:39], v[236:239], v[120:135]
    ds_read_b64_tr_b16 v[32:33], v24 offset:45056
    ds_read_b64_tr_b16 v[34:35], v24 offset:47104
    s_waitcnt lgkmcnt(10)
    v_mfma_f32_32x32x16_bf16 v[136:151], v[40:43], v[236:239], v[136:151]
    ds_read_b64_tr_b16 v[36:37], v25 offset:45056
    ds_read_b64_tr_b16 v[38:39], v25 offset:47104
    s_waitcnt lgkmcnt(10)
    v_mfma_f32_32x32x16_bf16 v[88:103], v[44:47], v[236:239], v[88:103]
    buffer_load_dwordx4 v[188:191], v249, s[32:35], s16 offen offset:1024 sc1
    ds_read_b64_tr_b16 v[40:41], v22 offset:45056
    ds_read_b64_tr_b16 v[42:43], v22 offset:47104
    s_waitcnt lgkmcnt(10)
    v_mfma_f32_32x32x16_bf16 v[104:119], v[48:51], v[236:239], v[104:119]
    ds_read_b64_tr_b16 v[44:45], v23 offset:45056
    ds_read_b64_tr_b16 v[46:47], v23 offset:47104
    s_waitcnt vmcnt(11)
    s_waitcnt lgkmcnt(10)
    v_mfma_f32_32x32x16_bf16 v[56:71], v[52:55], v[240:243], v[56:71]
    ds_read_b64_tr_b16 v[48:49], v20 offset:46080
    ds_read_b64_tr_b16 v[50:51], v20 offset:48128
    s_waitcnt lgkmcnt(10)
    v_mfma_f32_32x32x16_bf16 v[72:87], v[28:31], v[240:243], v[72:87]
    buffer_load_dwordx4 v[192:195], v249, s[32:35], s16 offen offset:2048 sc1
    ds_read_b64_tr_b16 v[52:53], v21 offset:46080
    ds_read_b64_tr_b16 v[54:55], v21 offset:48128
    s_waitcnt lgkmcnt(10)
    v_mfma_f32_32x32x16_bf16 v[120:135], v[32:35], v[240:243], v[120:135]
    ds_read_b64_tr_b16 v[28:29], v24 offset:46080
    ds_read_b64_tr_b16 v[30:31], v24 offset:48128
    s_waitcnt lgkmcnt(10)
    v_mfma_f32_32x32x16_bf16 v[136:151], v[36:39], v[240:243], v[136:151]
    ds_read_b64_tr_b16 v[32:33], v25 offset:46080
    ds_read_b64_tr_b16 v[34:35], v25 offset:48128
    s_waitcnt lgkmcnt(10)
    v_mfma_f32_32x32x16_bf16 v[88:103], v[40:43], v[240:243], v[88:103]
    ds_read_b64_tr_b16 v[36:37], v22 offset:46080
    ds_read_b64_tr_b16 v[38:39], v22 offset:48128
    s_waitcnt lgkmcnt(10)
    v_mfma_f32_32x32x16_bf16 v[104:119], v[44:47], v[240:243], v[104:119]
    buffer_load_dwordx4 v[196:199], v249, s[32:35], s16 offen offset:3072 sc1
    ds_read_b64_tr_b16 v[40:41], v23 offset:46080
    ds_read_b64_tr_b16 v[42:43], v23 offset:48128
    s_waitcnt vmcnt(12)
    s_waitcnt lgkmcnt(10)
    v_mfma_f32_32x32x16_bf16 v[56:71], v[48:51], v[244:247], v[56:71]
    s_add_u32 s16, s16, 16384
    ds_read_b64_tr_b16 v[44:45], v20
    ds_read_b64_tr_b16 v[46:47], v20 offset:2048
    s_waitcnt lgkmcnt(10)
    v_mfma_f32_32x32x16_bf16 v[72:87], v[52:55], v[244:247], v[72:87]
    s_and_b32 s16, s16, 0x3ffff
    ds_read_b64_tr_b16 v[48:49], v21
    ds_read_b64_tr_b16 v[50:51], v21 offset:2048
    s_waitcnt lgkmcnt(10)
    v_mfma_f32_32x32x16_bf16 v[120:135], v[28:31], v[244:247], v[120:135]
    buffer_load_dwordx4 v[200:203], v249, s[32:35], s16 offen sc1
    ds_read_b64_tr_b16 v[52:53], v24
    ds_read_b64_tr_b16 v[54:55], v24 offset:2048
    s_waitcnt lgkmcnt(10)
    v_mfma_f32_32x32x16_bf16 v[136:151], v[32:35], v[244:247], v[136:151]
    ds_read_b64_tr_b16 v[28:29], v25
    ds_read_b64_tr_b16 v[30:31], v25 offset:2048
    s_waitcnt lgkmcnt(10)
    v_mfma_f32_32x32x16_bf16 v[88:103], v[36:39], v[244:247], v[88:103]
    ds_read_b64_tr_b16 v[32:33], v22
    ds_read_b64_tr_b16 v[34:35], v22 offset:2048
    s_waitcnt lgkmcnt(10)
    v_mfma_f32_32x32x16_bf16 v[104:119], v[40:43], v[244:247], v[104:119]
    buffer_load_dwordx4 v[204:207], v249, s[32:35], s16 offen offset:1024 sc1
    ds_read_b64_tr_b16 v[36:37], v23
    ds_read_b64_tr_b16 v[38:39], v23 offset:2048
    s_barrier
    s_waitcnt vmcnt(13)
    s_waitcnt lgkmcnt(10)
    v_mfma_f32_32x32x16_bf16 v[56:71], v[44:47], v[152:155], v[56:71]
    ds_read_b64_tr_b16 v[40:41], v20 offset:1024
    ds_read_b64_tr_b16 v[42:43], v20 offset:3072
    s_waitcnt lgkmcnt(10)
    v_mfma_f32_32x32x16_bf16 v[72:87], v[48:51], v[152:155], v[72:87]
    ds_read_b64_tr_b16 v[44:45], v21 offset:1024
    ds_read_b64_tr_b16 v[46:47], v21 offset:3072
    s_waitcnt lgkmcnt(10)
    v_mfma_f32_32x32x16_bf16 v[120:135], v[52:55], v[152:155], v[120:135]
    ds_read_b64_tr_b16 v[48:49], v24 offset:1024
    ds_read_b64_tr_b16 v[50:51], v24 offset:3072
    s_waitcnt lgkmcnt(10)
    v_mfma_f32_32x32x16_bf16 v[136:151], v[28:31], v[152:155], v[136:151]
    buffer_load_dwordx4 v[208:211], v249, s[32:35], s16 offen offset:2048 sc1
    ds_read_b64_tr_b16 v[52:53], v25 offset:1024
    ds_read_b64_tr_b16 v[54:55], v25 offset:3072
    s_waitcnt lgkmcnt(10)
    v_mfma_f32_32x32x16_bf16 v[88:103], v[32:35], v[152:155], v[88:103]
    ds_read_b64_tr_b16 v[28:29], v22 offset:1024
    ds_read_b64_tr_b16 v[30:31], v22 offset:3072
    s_waitcnt lgkmcnt(10)
    v_mfma_f32_32x32x16_bf16 v[104:119], v[36:39], v[152:155], v[104:119]
    ds_read_b64_tr_b16 v[32:33], v23 offset:1024
    ds_read_b64_tr_b16 v[34:35], v23 offset:3072
    s_waitcnt vmcnt(13)
    s_waitcnt lgkmcnt(10)
    v_mfma_f32_32x32x16_bf16 v[56:71], v[40:43], v[156:159], v[56:71]
    buffer_load_dwordx4 v[212:215], v249, s[32:35], s16 offen offset:3072 sc1
    ds_read_b64_tr_b16 v[36:37], v20 offset:4096
    ds_read_b64_tr_b16 v[38:39], v20 offset:6144
    s_waitcnt lgkmcnt(10)
    v_mfma_f32_32x32x16_bf16 v[72:87], v[44:47], v[156:159], v[72:87]
    s_add_u32 s16, s16, 16384
    ds_read_b64_tr_b16 v[40:41], v21 offset:4096
    ds_read_b64_tr_b16 v[42:43], v21 offset:6144
    s_waitcnt lgkmcnt(10)
    v_mfma_f32_32x32x16_bf16 v[120:135], v[48:51], v[156:159], v[120:135]
    s_and_b32 s16, s16, 0x3ffff
    ds_read_b64_tr_b16 v[44:45], v24 offset:4096
    ds_read_b64_tr_b16 v[46:47], v24 offset:6144
    s_waitcnt lgkmcnt(10)
    v_mfma_f32_32x32x16_bf16 v[136:151], v[52:55], v[156:159], v[136:151]
    ds_read_b64_tr_b16 v[48:49], v25 offset:4096
    ds_read_b64_tr_b16 v[50:51], v25 offset:6144
    s_waitcnt lgkmcnt(10)
    v_mfma_f32_32x32x16_bf16 v[88:103], v[28:31], v[156:159], v[88:103]
    buffer_load_dwordx4 v[216:219], v249, s[32:35], s16 offen sc1
    ds_read_b64_tr_b16 v[52:53], v22 offset:4096
    ds_read_b64_tr_b16 v[54:55], v22 offset:6144
    s_waitcnt lgkmcnt(10)
    v_mfma_f32_32x32x16_bf16 v[104:119], v[32:35], v[156:159], v[104:119]
    ds_read_b64_tr_b16 v[28:29], v23 offset:4096
    ds_read_b64_tr_b16 v[30:31], v23 offset:6144
    s_waitcnt vmcnt(14)
    s_waitcnt lgkmcnt(10)
    v_mfma_f32_32x32x16_bf16 v[56:71], v[36:39], v[160:163], v[56:71]
    ds_read_b64_tr_b16 v[32:33], v20 offset:5120
    ds_read_b64_tr_b16 v[34:35], v20 offset:7168
    s_waitcnt lgkmcnt(10)
    v_mfma_f32_32x32x16_bf16 v[72:87], v[40:43], v[160:163], v[72:87]
    buffer_load_dwordx4 v[220:223], v249, s[32:35], s16 offen offset:1024 sc1
    ds_read_b64_tr_b16 v[36:37], v21 offset:5120
    ds_read_b64_tr_b16 v[38:39], v21 offset:7168
    s_waitcnt lgkmcnt(10)
    v_mfma_f32_32x32x16_bf16 v[120:135], v[44:47], v[160:163], v[120:135]
    ds_read_b64_tr_b16 v[40:41], v24 offset:5120
    ds_read_b64_tr_b16 v[42:43], v24 offset:7168
    s_waitcnt lgkmcnt(10)
    v_mfma_f32_32x32x16_bf16 v[136:151], v[48:51], v[160:163], v[136:151]
    ds_read_b64_tr_b16 v[44:45], v25 offset:5120
    ds_read_b64_tr_b16 v[46:47], v25 offset:7168
    s_waitcnt lgkmcnt(10)
    v_mfma_f32_32x32x16_bf16 v[88:103], v[52:55], v[160:163], v[88:103]
    ds_read_b64_tr_b16 v[48:49], v22 offset:5120
    ds_read_b64_tr_b16 v[50:51], v22 offset:7168
    s_waitcnt lgkmcnt(10)
    v_mfma_f32_32x32x16_bf16 v[104:119], v[28:31], v[160:163], v[104:119]
    buffer_load_dwordx4 v[224:227], v249, s[32:35], s16 offen offset:2048 sc1
    ds_read_b64_tr_b16 v[52:53], v23 offset:5120
    ds_read_b64_tr_b16 v[54:55], v23 offset:7168
    s_waitcnt vmcnt(15)
    s_waitcnt lgkmcnt(10)
    v_mfma_f32_32x32x16_bf16 v[56:71], v[32:35], v[164:167], v[56:71]
    ds_read_b64_tr_b16 v[28:29], v20 offset:8192
    ds_read_b64_tr_b16 v[30:31], v20 offset:10240
    s_waitcnt lgkmcnt(10)
    v_mfma_f32_32x32x16_bf16 v[72:87], v[36:39], v[164:167], v[72:87]
    ds_read_b64_tr_b16 v[32:33], v21 offset:8192
    ds_read_b64_tr_b16 v[34:35], v21 offset:10240
    s_waitcnt lgkmcnt(10)
    v_mfma_f32_32x32x16_bf16 v[120:135], v[40:43], v[164:167], v[120:135]
    buffer_load_dwordx4 v[228:231], v249, s[32:35], s16 offen offset:3072 sc1
    ds_read_b64_tr_b16 v[36:37], v24 offset:8192
    ds_read_b64_tr_b16 v[38:39], v24 offset:10240
    s_waitcnt lgkmcnt(10)
    v_mfma_f32_32x32x16_bf16 v[136:151], v[44:47], v[164:167], v[136:151]
    s_add_u32 s16, s16, 16384
    ds_read_b64_tr_b16 v[40:41], v25 offset:8192
    ds_read_b64_tr_b16 v[42:43], v25 offset:10240
    s_waitcnt lgkmcnt(10)
    v_mfma_f32_32x32x16_bf16 v[88:103], v[48:51], v[164:167], v[88:103]
    s_and_b32 s16, s16, 0x3ffff
    ds_read_b64_tr_b16 v[44:45], v22 offset:8192
    ds_read_b64_tr_b16 v[46:47], v22 offset:10240
    s_waitcnt lgkmcnt(10)
    v_mfma_f32_32x32x16_bf16 v[104:119], v[52:55], v[164:167], v[104:119]
    buffer_load_dwordx4 v[232:235], v249, s[32:35], s16 offen sc1
    ds_read_b64_tr_b16 v[48:49], v23 offset:8192
    ds_read_b64_tr_b16 v[50:51], v23 offset:10240
    s_barrier
    s_waitcnt vmcnt(16)
    s_waitcnt lgkmcnt(10)
    v_mfma_f32_32x32x16_bf16 v[56:71], v[28:31], v[168:171], v[56:71]
    ds_read_b64_tr_b16 v[52:53], v20 offset:9216
    ds_read_b64_tr_b16 v[54:55], v20 offset:11264
    s_waitcnt lgkmcnt(10)
    v_mfma_f32_32x32x16_bf16 v[72:87], v[32:35], v[168:171], v[72:87]
    ds_read_b64_tr_b16 v[28:29], v21 offset:9216
    ds_read_b64_tr_b16 v[30:31], v21 offset:11264
    s_waitcnt lgkmcnt(10)
    v_mfma_f32_32x32x16_bf16 v[120:135], v[36:39], v[168:171], v[120:135]
    ds_read_b64_tr_b16 v[32:33], v24 offset:9216
    ds_read_b64_tr_b16 v[34:35], v24 offset:11264
    s_waitcnt lgkmcnt(10)
    v_mfma_f32_32x32x16_bf16 v[136:151], v[40:43], v[168:171], v[136:151]
    buffer_load_dwordx4 v[236:239], v249, s[32:35], s16 offen offset:1024 sc1
    ds_read_b64_tr_b16 v[36:37], v25 offset:9216
    ds_read_b64_tr_b16 v[38:39], v25 offset:11264
    s_waitcnt lgkmcnt(10)
    v_mfma_f32_32x32x16_bf16 v[88:103], v[44:47], v[168:171], v[88:103]
    ds_read_b64_tr_b16 v[40:41], v22 offset:9216
    ds_read_b64_tr_b16 v[42:43], v22 offset:11264
    s_waitcnt lgkmcnt(10)
    v_mfma_f32_32x32x16_bf16 v[104:119], v[48:51], v[168:171], v[104:119]
    ds_read_b64_tr_b16 v[44:45], v23 offset:9216
    ds_read_b64_tr_b16 v[46:47], v23 offset:11264
    s_waitcnt vmcnt(16)
    s_waitcnt lgkmcnt(10)
    v_mfma_f32_32x32x16_bf16 v[56:71], v[52:55], v[172:175], v[56:71]
    buffer_load_dwordx4 v[240:243], v249, s[32:35], s16 offen offset:2048 sc1
    ds_read_b64_tr_b16 v[48:49], v20 offset:12288
    ds_read_b64_tr_b16 v[50:51], v20 offset:14336
    s_waitcnt lgkmcnt(10)
    v_mfma_f32_32x32x16_bf16 v[72:87], v[28:31], v[172:175], v[72:87]
    ds_read_b64_tr_b16 v[52:53], v21 offset:12288
    ds_read_b64_tr_b16 v[54:55], v21 offset:14336
    s_waitcnt lgkmcnt(10)
    v_mfma_f32_32x32x16_bf16 v[120:135], v[32:35], v[172:175], v[120:135]
    ds_read_b64_tr_b16 v[28:29], v24 offset:12288
    ds_read_b64_tr_b16 v[30:31], v24 offset:14336
    s_waitcnt lgkmcnt(10)
    v_mfma_f32_32x32x16_bf16 v[136:151], v[36:39], v[172:175], v[136:151]
    ds_read_b64_tr_b16 v[32:33], v25 offset:12288
    ds_read_b64_tr_b16 v[34:35], v25 offset:14336
    s_waitcnt lgkmcnt(10)
    v_mfma_f32_32x32x16_bf16 v[88:103], v[40:43], v[172:175], v[88:103]
    buffer_load_dwordx4 v[244:247], v249, s[32:35], s16 offen offset:3072 sc1
    ds_read_b64_tr_b16 v[36:37], v22 offset:12288
    ds_read_b64_tr_b16 v[38:39], v22 offset:14336
    s_waitcnt lgkmcnt(10)
    v_mfma_f32_32x32x16_bf16 v[104:119], v[44:47], v[172:175], v[104:119]
    s_add_u32 s16, s16, 16384
    ds_read_b64_tr_b16 v[40:41], v23 offset:12288
    ds_read_b64_tr_b16 v[42:43], v23 offset:14336
    s_waitcnt vmcnt(17)
    s_waitcnt lgkmcnt(10)
    v_mfma_f32_32x32x16_bf16 v[56:71], v[48:51], v[176:179], v[56:71]
    s_and_b32 s16, s16, 0x3ffff
    ds_read_b64_tr_b16 v[44:45], v20 offset:13312
    ds_read_b64_tr_b16 v[46:47], v20 offset:15360
    s_waitcnt lgkmcnt(10)
    v_mfma_f32_32x32x16_bf16 v[72:87], v[52:55], v[176:179], v[72:87]
    buffer_load_dwordx4 v[152:155], v249, s[32:35], s16 offen sc1
    ds_read_b64_tr_b16 v[48:49], v21 offset:13312
    ds_read_b64_tr_b16 v[50:51], v21 offset:15360
    s_waitcnt lgkmcnt(10)
    v_mfma_f32_32x32x16_bf16 v[120:135], v[28:31], v[176:179], v[120:135]
    ds_read_b64_tr_b16 v[52:53], v24 offset:13312
    ds_read_b64_tr_b16 v[54:55], v24 offset:15360
    s_waitcnt lgkmcnt(10)
    v_mfma_f32_32x32x16_bf16 v[136:151], v[32:35], v[176:179], v[136:151]
    ds_read_b64_tr_b16 v[28:29], v25 offset:13312
    ds_read_b64_tr_b16 v[30:31], v25 offset:15360
    s_waitcnt lgkmcnt(10)
    v_mfma_f32_32x32x16_bf16 v[88:103], v[36:39], v[176:179], v[88:103]
    ds_read_b64_tr_b16 v[32:33], v22 offset:13312
    ds_read_b64_tr_b16 v[34:35], v22 offset:15360
    s_waitcnt lgkmcnt(10)
    v_mfma_f32_32x32x16_bf16 v[104:119], v[40:43], v[176:179], v[104:119]
    buffer_load_dwordx4 v[156:159], v249, s[32:35], s16 offen offset:1024 sc1
    ds_read_b64_tr_b16 v[36:37], v23 offset:13312
    ds_read_b64_tr_b16 v[38:39], v23 offset:15360
    s_waitcnt vmcnt(18)
    s_waitcnt lgkmcnt(10)
    v_mfma_f32_32x32x16_bf16 v[56:71], v[44:47], v[180:183], v[56:71]
    ds_read_b64_tr_b16 v[40:41], v20 offset:16384
    ds_read_b64_tr_b16 v[42:43], v20 offset:18432
    s_waitcnt lgkmcnt(10)
    v_mfma_f32_32x32x16_bf16 v[72:87], v[48:51], v[180:183], v[72:87]
    ds_read_b64_tr_b16 v[44:45], v21 offset:16384
    ds_read_b64_tr_b16 v[46:47], v21 offset:18432
    s_waitcnt lgkmcnt(10)
    v_mfma_f32_32x32x16_bf16 v[120:135], v[52:55], v[180:183], v[120:135]
    buffer_load_dwordx4 v[160:163], v249, s[32:35], s16 offen offset:2048 sc1
    ds_read_b64_tr_b16 v[48:49], v24 offset:16384
    ds_read_b64_tr_b16 v[50:51], v24 offset:18432
    s_waitcnt lgkmcnt(10)
    v_mfma_f32_32x32x16_bf16 v[136:151], v[28:31], v[180:183], v[136:151]
    ds_read_b64_tr_b16 v[52:53], v25 offset:16384
    ds_read_b64_tr_b16 v[54:55], v25 offset:18432
    s_waitcnt lgkmcnt(10)
    v_mfma_f32_32x32x16_bf16 v[88:103], v[32:35], v[180:183], v[88:103]
    ds_read_b64_tr_b16 v[28:29], v22 offset:16384
    ds_read_b64_tr_b16 v[30:31], v22 offset:18432
    s_waitcnt lgkmcnt(10)
    v_mfma_f32_32x32x16_bf16 v[104:119], v[36:39], v[180:183], v[104:119]
    buffer_load_dwordx4 v[164:167], v249, s[32:35], s16 offen offset:3072 sc1
    ds_read_b64_tr_b16 v[32:33], v23 offset:16384
    ds_read_b64_tr_b16 v[34:35], v23 offset:18432
    s_barrier
    s_waitcnt vmcnt(19)
    s_waitcnt lgkmcnt(10)
    v_mfma_f32_32x32x16_bf16 v[56:71], v[40:43], v[184:187], v[56:71]
    s_add_u32 s16, s16, 16384
    ds_read_b64_tr_b16 v[36:37], v20 offset:17408
    ds_read_b64_tr_b16 v[38:39], v20 offset:19456
    s_waitcnt lgkmcnt(10)
    v_mfma_f32_32x32x16_bf16 v[72:87], v[44:47], v[184:187], v[72:87]
    s_and_b32 s16, s16, 0x3ffff
    ds_read_b64_tr_b16 v[40:41], v21 offset:17408
    ds_read_b64_tr_b16 v[42:43], v21 offset:19456
    s_waitcnt lgkmcnt(10)
    v_mfma_f32_32x32x16_bf16 v[120:135], v[48:51], v[184:187], v[120:135]
    ds_read_b64_tr_b16 v[44:45], v24 offset:17408
    ds_read_b64_tr_b16 v[46:47], v24 offset:19456
    s_waitcnt lgkmcnt(10)
    v_mfma_f32_32x32x16_bf16 v[136:151], v[52:55], v[184:187], v[136:151]
    buffer_load_dwordx4 v[168:171], v249, s[32:35], s16 offen sc1
    ds_read_b64_tr_b16 v[48:49], v25 offset:17408
    ds_read_b64_tr_b16 v[50:51], v25 offset:19456
    s_waitcnt lgkmcnt(10)
    v_mfma_f32_32x32x16_bf16 v[88:103], v[28:31], v[184:187], v[88:103]
    ds_read_b64_tr_b16 v[52:53], v22 offset:17408
    ds_read_b64_tr_b16 v[54:55], v22 offset:19456
    s_waitcnt lgkmcnt(10)
    v_mfma_f32_32x32x16_bf16 v[104:119], v[32:35], v[184:187], v[104:119]
    ds_read_b64_tr_b16 v[28:29], v23 offset:17408
    ds_read_b64_tr_b16 v[30:31], v23 offset:19456
    s_waitcnt vmcnt(19)
    s_waitcnt lgkmcnt(10)
    v_mfma_f32_32x32x16_bf16 v[56:71], v[36:39], v[188:191], v[56:71]
    ds_read_b64_tr_b16 v[32:33], v20 offset:20480
    ds_read_b64_tr_b16 v[34:35], v20 offset:22528
    s_waitcnt lgkmcnt(10)
    v_mfma_f32_32x32x16_bf16 v[72:87], v[40:43], v[188:191], v[72:87]
    buffer_load_dwordx4 v[172:175], v249, s[32:35], s16 offen offset:1024 sc1
    ds_read_b64_tr_b16 v[36:37], v21 offset:20480
    ds_read_b64_tr_b16 v[38:39], v21 offset:22528
    s_waitcnt lgkmcnt(10)
    v_mfma_f32_32x32x16_bf16 v[120:135], v[44:47], v[188:191], v[120:135]
    ds_read_b64_tr_b16 v[40:41], v24 offset:20480
    ds_read_b64_tr_b16 v[42:43], v24 offset:22528
    s_waitcnt lgkmcnt(10)
    v_mfma_f32_32x32x16_bf16 v[136:151], v[48:51], v[188:191], v[136:151]
    ds_read_b64_tr_b16 v[44:45], v25 offset:20480
    ds_read_b64_tr_b16 v[46:47], v25 offset:22528
    s_waitcnt lgkmcnt(10)
    v_mfma_f32_32x32x16_bf16 v[88:103], v[52:55], v[188:191], v[88:103]
    ds_read_b64_tr_b16 v[48:49], v22 offset:20480
    ds_read_b64_tr_b16 v[50:51], v22 offset:22528
    s_waitcnt lgkmcnt(10)
    v_mfma_f32_32x32x16_bf16 v[104:119], v[28:31], v[188:191], v[104:119]
    buffer_load_dwordx4 v[176:179], v249, s[32:35], s16 offen offset:2048 sc1
    ds_read_b64_tr_b16 v[52:53], v23 offset:20480
    ds_read_b64_tr_b16 v[54:55], v23 offset:22528
    s_waitcnt vmcnt(20)
    s_waitcnt lgkmcnt(10)
    v_mfma_f32_32x32x16_bf16 v[56:71], v[32:35], v[192:195], v[56:71]
    ds_read_b64_tr_b16 v[28:29], v20 offset:21504
    ds_read_b64_tr_b16 v[30:31], v20 offset:23552
    s_waitcnt lgkmcnt(10)
    v_mfma_f32_32x32x16_bf16 v[72:87], v[36:39], v[192:195], v[72:87]
    ds_read_b64_tr_b16 v[32:33], v21 offset:21504
    ds_read_b64_tr_b16 v[34:35], v21 offset:23552
    s_waitcnt lgkmcnt(10)
    v_mfma_f32_32x32x16_bf16 v[120:135], v[40:43], v[192:195], v[120:135]
    ds_read_b64_tr_b16 v[36:37], v24 offset:21504
    ds_read_b64_tr_b16 v[38:39], v24 offset:23552
    s_waitcnt lgkmcnt(10)
    v_mfma_f32_32x32x16_bf16 v[136:151], v[44:47], v[192:195], v[136:151]
    buffer_load_dwordx4 v[180:183], v249, s[32:35], s16 offen offset:3072 sc1
    ds_read_b64_tr_b16 v[40:41], v25 offset:21504
L_PAD3:
    s_cbranch_execz L_RET3
    ds_read_b64_tr_b16 v[42:43], v25 offset:23552
    s_waitcnt lgkmcnt(10)
    v_mfma_f32_32x32x16_bf16 v[88:103], v[48:51], v[192:195], v[88:103]
    s_add_u32 s16, s16, 16384
    ds_read_b64_tr_b16 v[44:45], v22 offset:21504
    ds_read_b64_tr_b16 v[46:47], v22 offset:23552
    s_waitcnt lgkmcnt(10)
    v_mfma_f32_32x32x16_bf16 v[104:119], v[52:55], v[192:195], v[104:119]
    s_and_b32 s16, s16, 0x3ffff
    ds_read_b64_tr_b16 v[48:49], v23 offset:21504
    ds_read_b64_tr_b16 v[50:51], v23 offset:23552
    s_waitcnt vmcnt(20)
    s_waitcnt lgkmcnt(10)
    v_mfma_f32_32x32x16_bf16 v[56:71], v[28:31], v[196:199], v[56:71]
    ds_read_b64_tr_b16 v[52:53], v20 offset:24576
    ds_read_b64_tr_b16 v[54:55], v20 offset:26624
    s_waitcnt lgkmcnt(10)
    v_mfma_f32_32x32x16_bf16 v[72:87], v[32:35], v[196:199], v[72:87]
    buffer_load_dwordx4 v[184:187], v249, s[32:35], s16 offen sc1
    ds_read_b64_tr_b16 v[28:29], v21 offset:24576
    ds_read_b64_tr_b16 v[30:31], v21 offset:26624
    s_waitcnt lgkmcnt(10)
    v_mfma_f32_32x32x16_bf16 v[120:135], v[36:39], v[196:199], v[120:135]
    ds_read_b64_tr_b16 v[32:33], v20 offset:25600
    ds_read_b64_tr_b16 v[34:35], v20 offset:27648
    s_waitcnt lgkmcnt(10)
    v_mfma_f32_32x32x16_bf16 v[136:151], v[40:43], v[196:199], v[136:151]
    ds_read_b64_tr_b16 v[36:37], v21 offset:25600
    ds_read_b64_tr_b16 v[38:39], v21 offset:27648
    s_waitcnt lgkmcnt(10)
    v_mfma_f32_32x32x16_bf16 v[88:103], v[44:47], v[196:199], v[88:103]
    ds_read_b64_tr_b16 v[40:41], v20 offset:28672
    ds_read_b64_tr_b16 v[42:43], v20 offset:30720
    s_waitcnt lgkmcnt(10)
    v_mfma_f32_32x32x16_bf16 v[104:119], v[48:51], v[196:199], v[104:119]
    buffer_load_dwordx4 v[188:191], v249, s[32:35], s16 offen offset:1024 sc1
    ds_read_b64_tr_b16 v[44:45], v21 offset:28672
    ds_read_b64_tr_b16 v[46:47], v21 offset:30720
    s_barrier
    s_waitcnt vmcnt(21)
    s_waitcnt lgkmcnt(10)
    v_mfma_f32_32x32x16_bf16 v[56:71], v[52:55], v[200:203], v[56:71]
    ds_read_b64_tr_b16 v[48:49], v20 offset:29696
    ds_read_b64_tr_b16 v[50:51], v20 offset:31744
    s_waitcnt lgkmcnt(10)
    v_mfma_f32_32x32x16_bf16 v[72:87], v[28:31], v[200:203], v[72:87]
    ds_read_b64_tr_b16 v[52:53], v21 offset:29696
    ds_read_b64_tr_b16 v[54:55], v21 offset:31744
    s_waitcnt vmcnt(20)
    s_waitcnt lgkmcnt(10)
    v_mfma_f32_32x32x16_bf16 v[56:71], v[32:35], v[204:207], v[56:71]
    ds_read_b64_tr_b16 v[28:29], v24 offset:24576
    ds_read_b64_tr_b16 v[30:31], v24 offset:26624
    s_waitcnt lgkmcnt(10)
    v_mfma_f32_32x32x16_bf16 v[72:87], v[36:39], v[204:207], v[72:87]
    buffer_load_dwordx4 v[192:195], v249, s[32:35], s16 offen offset:2048 sc1
    ds_read_b64_tr_b16 v[32:33], v25 offset:24576
    ds_read_b64_tr_b16 v[34:35], v25 offset:26624
    s_waitcnt vmcnt(20)
    s_waitcnt lgkmcnt(10)
    v_mfma_f32_32x32x16_bf16 v[56:71], v[40:43], v[208:211], v[56:71]
    ds_read_b64_tr_b16 v[36:37], v22 offset:24576
    ds_read_b64_tr_b16 v[38:39], v22 offset:26624
    s_waitcnt lgkmcnt(10)
    v_mfma_f32_32x32x16_bf16 v[72:87], v[44:47], v[208:211], v[72:87]
    ds_read_b64_tr_b16 v[40:41], v23 offset:24576
    ds_read_b64_tr_b16 v[42:43], v23 offset:26624
    s_waitcnt vmcnt(19)
    s_waitcnt lgkmcnt(10)
    v_mfma_f32_32x32x16_bf16 v[56:71], v[48:51], v[212:215], v[56:71]
    ds_read_b64_tr_b16 v[44:45], v24 offset:25600
    ds_read_b64_tr_b16 v[46:47], v24 offset:27648
    s_waitcnt lgkmcnt(10)
    v_mfma_f32_32x32x16_bf16 v[72:87], v[52:55], v[212:215], v[72:87]
    buffer_load_dwordx4 v[196:199], v249, s[32:35], s16 offen offset:3072 sc1
    ds_read_b64_tr_b16 v[48:49], v25 offset:25600
    ds_read_b64_tr_b16 v[50:51], v25 offset:27648
    s_barrier
    s_waitcnt lgkmcnt(10)
    v_mfma_f32_32x32x16_bf16 v[120:135], v[28:31], v[200:203], v[120:135]
    s_add_u32 s16, s16, 16384
    ds_read_b64_tr_b16 v[52:53], v22 offset:25600
    ds_read_b64_tr_b16 v[54:55], v22 offset:27648
    s_waitcnt lgkmcnt(10)
    v_mfma_f32_32x32x16_bf16 v[136:151], v[32:35], v[200:203], v[136:151]
    s_and_b32 s16, s16, 0x3ffff
    ds_read_b64_tr_b16 v[28:29], v23 offset:25600
    ds_read_b64_tr_b16 v[30:31], v23 offset:27648
    s_waitcnt lgkmcnt(10)
    v_mfma_f32_32x32x16_bf16 v[88:103], v[36:39], v[200:203], v[88:103]
    ds_read_b64_tr_b16 v[32:33], v24 offset:28672
    ds_read_b64_tr_b16 v[34:35], v24 offset:30720
    s_waitcnt lgkmcnt(10)
    v_mfma_f32_32x32x16_bf16 v[104:119], v[40:43], v[200:203], v[104:119]
    buffer_load_dwordx4 v[200:203], v249, s[32:35], s16 offen sc1
    ds_read_b64_tr_b16 v[36:37], v25 offset:28672
    ds_read_b64_tr_b16 v[38:39], v25 offset:30720
    s_waitcnt lgkmcnt(10)
    v_mfma_f32_32x32x16_bf16 v[120:135], v[44:47], v[204:207], v[120:135]
    ds_read_b64_tr_b16 v[40:41], v22 offset:28672
    ds_read_b64_tr_b16 v[42:43], v22 offset:30720
    s_waitcnt lgkmcnt(10)
    v_mfma_f32_32x32x16_bf16 v[136:151], v[48:51], v[204:207], v[136:151]
    ds_read_b64_tr_b16 v[44:45], v23 offset:28672
    ds_read_b64_tr_b16 v[46:47], v23 offset:30720
    s_waitcnt lgkmcnt(10)
    v_mfma_f32_32x32x16_bf16 v[88:103], v[52:55], v[204:207], v[88:103]
    ds_read_b64_tr_b16 v[48:49], v24 offset:29696
    ds_read_b64_tr_b16 v[50:51], v24 offset:31744
    s_waitcnt lgkmcnt(10)
    v_mfma_f32_32x32x16_bf16 v[104:119], v[28:31], v[204:207], v[104:119]
    buffer_load_dwordx4 v[204:207], v249, s[32:35], s16 offen offset:1024 sc1
    ds_read_b64_tr_b16 v[52:53], v25 offset:29696
    ds_read_b64_tr_b16 v[54:55], v25 offset:31744
    s_waitcnt lgkmcnt(10)
    v_mfma_f32_32x32x16_bf16 v[120:135], v[32:35], v[208:211], v[120:135]
    ds_read_b64_tr_b16 v[28:29], v22 offset:29696
    ds_read_b64_tr_b16 v[30:31], v22 offset:31744
    s_waitcnt lgkmcnt(10)
    v_mfma_f32_32x32x16_bf16 v[136:151], v[36:39], v[208:211], v[136:151]
    ds_read_b64_tr_b16 v[32:33], v23 offset:29696
    ds_read_b64_tr_b16 v[34:35], v23 offset:31744
    s_waitcnt lgkmcnt(10)
    v_mfma_f32_32x32x16_bf16 v[88:103], v[40:43], v[208:211], v[88:103]
    ds_read_b64_tr_b16 v[36:37], v20 offset:32768
    ds_read_b64_tr_b16 v[38:39], v20 offset:34816
    s_waitcnt lgkmcnt(10)
    v_mfma_f32_32x32x16_bf16 v[104:119], v[44:47], v[208:211], v[104:119]
    buffer_load_dwordx4 v[208:211], v249, s[32:35], s16 offen offset:2048 sc1
    ds_read_b64_tr_b16 v[40:41], v20 offset:33792
    ds_read_b64_tr_b16 v[42:43], v20 offset:35840
    s_waitcnt lgkmcnt(10)
    v_mfma_f32_32x32x16_bf16 v[120:135], v[48:51], v[212:215], v[120:135]
    ds_read_b64_tr_b16 v[44:45], v20 offset:36864
    ds_read_b64_tr_b16 v[46:47], v20 offset:38912
    s_waitcnt lgkmcnt(10)
    v_mfma_f32_32x32x16_bf16 v[136:151], v[52:55], v[212:215], v[136:151]
    ds_read_b64_tr_b16 v[48:49], v20 offset:37888
    ds_read_b64_tr_b16 v[50:51], v20 offset:39936
    s_waitcnt lgkmcnt(10)
    v_mfma_f32_32x32x16_bf16 v[88:103], v[28:31], v[212:215], v[88:103]
    ds_read_b64_tr_b16 v[52:53], v20 offset:40960
    ds_read_b64_tr_b16 v[54:55], v20 offset:43008
    s_waitcnt lgkmcnt(10)
    v_mfma_f32_32x32x16_bf16 v[104:119], v[32:35], v[212:215], v[104:119]
    buffer_load_dwordx4 v[212:215], v249, s[32:35], s16 offen offset:3072 sc1
    ds_read_b64_tr_b16 v[28:29], v20 offset:41984
    ds_read_b64_tr_b16 v[30:31], v20 offset:44032
    s_barrier
    s_waitcnt vmcnt(23)
    s_waitcnt lgkmcnt(10)
    v_mfma_f32_32x32x16_bf16 v[56:71], v[36:39], v[216:219], v[56:71]
    s_add_u32 s16, s16, 16384
    ds_read_b64_tr_b16 v[32:33], v20 offset:45056
    ds_read_b64_tr_b16 v[34:35], v20 offset:47104
    s_waitcnt vmcnt(22)
    s_waitcnt lgkmcnt(10)
    v_mfma_f32_32x32x16_bf16 v[56:71], v[40:43], v[220:223], v[56:71]
    s_and_b32 s16, s16, 0x3ffff
    ds_read_b64_tr_b16 v[36:37], v20 offset:46080
    ds_read_b64_tr_b16 v[38:39], v20 offset:48128
    s_waitcnt vmcnt(21)
    s_waitcnt lgkmcnt(10)
    v_mfma_f32_32x32x16_bf16 v[56:71], v[44:47], v[224:227], v[56:71]
    ds_read_b64_tr_b16 v[40:41], v20
    ds_read_b64_tr_b16 v[42:43], v20 offset:2048
    s_waitcnt vmcnt(20)
    s_waitcnt lgkmcnt(10)
    v_mfma_f32_32x32x16_bf16 v[56:71], v[48:51], v[228:231], v[56:71]
    ds_read_b64_tr_b16 v[44:45], v20 offset:1024
    ds_read_b64_tr_b16 v[46:47], v20 offset:3072
    s_waitcnt vmcnt(19)
    s_waitcnt lgkmcnt(10)
    v_mfma_f32_32x32x16_bf16 v[56:71], v[52:55], v[232:235], v[56:71]
    ds_read_b64_tr_b16 v[48:49], v20 offset:4096
    ds_read_b64_tr_b16 v[50:51], v20 offset:6144
    s_waitcnt vmcnt(18)
    s_waitcnt lgkmcnt(10)
    v_mfma_f32_32x32x16_bf16 v[56:71], v[28:31], v[236:239], v[56:71]
    ds_read_b64_tr_b16 v[52:53], v20 offset:5120
    ds_read_b64_tr_b16 v[54:55], v20 offset:7168
    s_waitcnt vmcnt(17)
    s_waitcnt lgkmcnt(10)
    v_mfma_f32_32x32x16_bf16 v[56:71], v[32:35], v[240:243], v[56:71]
    ds_read_b64_tr_b16 v[28:29], v20 offset:8192
    ds_read_b64_tr_b16 v[30:31], v20 offset:10240
    s_waitcnt vmcnt(16)
    s_waitcnt lgkmcnt(10)
    v_mfma_f32_32x32x16_bf16 v[56:71], v[36:39], v[244:247], v[56:71]
    ds_read_b64_tr_b16 v[32:33], v20 offset:9216
    ds_read_b64_tr_b16 v[34:35], v20 offset:11264
    s_waitcnt vmcnt(15)
    s_waitcnt lgkmcnt(10)
    v_mfma_f32_32x32x16_bf16 v[56:71], v[40:43], v[152:155], v[56:71]
    ds_read_b64_tr_b16 v[36:37], v20 offset:12288
    ds_read_b64_tr_b16 v[38:39], v20 offset:14336
    s_waitcnt vmcnt(14)
    s_waitcnt lgkmcnt(10)
    v_mfma_f32_32x32x16_bf16 v[56:71], v[44:47], v[156:159], v[56:71]
    ds_read_b64_tr_b16 v[40:41], v20 offset:13312
    ds_read_b64_tr_b16 v[42:43], v20 offset:15360
    s_waitcnt vmcnt(13)
    s_waitcnt lgkmcnt(10)
    v_mfma_f32_32x32x16_bf16 v[56:71], v[48:51], v[160:163], v[56:71]
    ds_read_b64_tr_b16 v[44:45], v20 offset:16384
    ds_read_b64_tr_b16 v[46:47], v20 offset:18432
    s_waitcnt vmcnt(12)
    s_waitcnt lgkmcnt(10)
    v_mfma_f32_32x32x16_bf16 v[56:71], v[52:55], v[164:167], v[56:71]
    ds_read_b64_tr_b16 v[48:49], v20 offset:17408
    ds_read_b64_tr_b16 v[50:51], v20 offset:19456
    s_waitcnt vmcnt(11)
    s_waitcnt lgkmcnt(10)
    v_mfma_f32_32x32x16_bf16 v[56:71], v[28:31], v[168:171], v[56:71]
    ds_read_b64_tr_b16 v[52:53], v20 offset:20480
    ds_read_b64_tr_b16 v[54:55], v20 offset:22528
    s_waitcnt vmcnt(10)
    s_waitcnt lgkmcnt(10)
    v_mfma_f32_32x32x16_bf16 v[56:71], v[32:35], v[172:175], v[56:71]
    ds_read_b64_tr_b16 v[28:29], v20 offset:21504
    ds_read_b64_tr_b16 v[30:31], v20 offset:23552
    s_barrier
    s_waitcnt vmcnt(9)
    s_waitcnt lgkmcnt(10)
    v_mfma_f32_32x32x16_bf16 v[56:71], v[36:39], v[176:179], v[56:71]
    ds_read_b64_tr_b16 v[32:33], v20 offset:24576
    ds_read_b64_tr_b16 v[34:35], v20 offset:26624
    s_waitcnt vmcnt(8)
    s_waitcnt lgkmcnt(10)
    v_mfma_f32_32x32x16_bf16 v[56:71], v[40:43], v[180:183], v[56:71]
    ds_read_b64_tr_b16 v[36:37], v20 offset:25600
    ds_read_b64_tr_b16 v[38:39], v20 offset:27648
    s_waitcnt vmcnt(7)
    s_waitcnt lgkmcnt(10)
    v_mfma_f32_32x32x16_bf16 v[56:71], v[44:47], v[184:187], v[56:71]
    ds_read_b64_tr_b16 v[40:41], v20 offset:28672
    ds_read_b64_tr_b16 v[42:43], v20 offset:30720
    s_waitcnt vmcnt(6)
    s_waitcnt lgkmcnt(10)
    v_mfma_f32_32x32x16_bf16 v[56:71], v[48:51], v[188:191], v[56:71]
    ds_read_b64_tr_b16 v[44:45], v20 offset:29696
    ds_read_b64_tr_b16 v[46:47], v20 offset:31744
    s_waitcnt vmcnt(5)
    s_waitcnt lgkmcnt(10)
    v_mfma_f32_32x32x16_bf16 v[56:71], v[52:55], v[192:195], v[56:71]
    ds_read_b64_tr_b16 v[48:49], v21 offset:32768
    ds_read_b64_tr_b16 v[50:51], v21 offset:34816
    s_waitcnt vmcnt(4)
    s_waitcnt lgkmcnt(10)
    v_mfma_f32_32x32x16_bf16 v[56:71], v[28:31], v[196:199], v[56:71]
    ds_read_b64_tr_b16 v[52:53], v21 offset:33792
    ds_read_b64_tr_b16 v[54:55], v21 offset:35840
    s_waitcnt vmcnt(3)
    s_waitcnt lgkmcnt(10)
    v_mfma_f32_32x32x16_bf16 v[56:71], v[32:35], v[200:203], v[56:71]
    ds_read_b64_tr_b16 v[28:29], v21 offset:36864
    ds_read_b64_tr_b16 v[30:31], v21 offset:38912
    s_waitcnt vmcnt(2)
    s_waitcnt lgkmcnt(10)
    v_mfma_f32_32x32x16_bf16 v[56:71], v[36:39], v[204:207], v[56:71]
    ds_read_b64_tr_b16 v[32:33], v21 offset:37888
    ds_read_b64_tr_b16 v[34:35], v21 offset:39936
    s_waitcnt vmcnt(1)
    s_waitcnt lgkmcnt(10)
    v_mfma_f32_32x32x16_bf16 v[56:71], v[40:43], v[208:211], v[56:71]
    ds_read_b64_tr_b16 v[36:37], v21 offset:40960
    ds_read_b64_tr_b16 v[38:39], v21 offset:43008
    s_waitcnt vmcnt(0)
    s_waitcnt lgkmcnt(10)
    v_mfma_f32_32x32x16_bf16 v[56:71], v[44:47], v[212:215], v[56:71]
    ds_read_b64_tr_b16 v[40:41], v21 offset:41984
    ds_read_b64_tr_b16 v[42:43], v21 offset:44032
    s_waitcnt lgkmcnt(10)
    v_mfma_f32_32x32x16_bf16 v[72:87], v[48:51], v[216:219], v[72:87]
    ds_read_b64_tr_b16 v[44:45], v21 offset:45056
    ds_read_b64_tr_b16 v[46:47], v21 offset:47104
    s_waitcnt lgkmcnt(10)
    v_mfma_f32_32x32x16_bf16 v[72:87], v[52:55], v[220:223], v[72:87]
    s_nop 3
    v_cvt_pk_bf16_f32 v56, v56, v57
    v_cvt_pk_bf16_f32 v57, v58, v59
    ds_read_b64_tr_b16 v[48:49], v21 offset:46080
    ds_read_b64_tr_b16 v[50:51], v21 offset:48128
    s_waitcnt lgkmcnt(10)
    v_mfma_f32_32x32x16_bf16 v[72:87], v[28:31], v[224:227], v[72:87]
    v_cvt_pk_bf16_f32 v58, v60, v61
    v_cvt_pk_bf16_f32 v59, v62, v63
    ds_read_b64_tr_b16 v[52:53], v21
    ds_read_b64_tr_b16 v[54:55], v21 offset:2048
    s_waitcnt lgkmcnt(10)
    v_mfma_f32_32x32x16_bf16 v[72:87], v[32:35], v[228:231], v[72:87]
    ds_write_b128 v0, v[56:59]
    v_cvt_pk_bf16_f32 v60, v64, v65
    ds_read_b64_tr_b16 v[28:29], v21 offset:1024
    ds_read_b64_tr_b16 v[30:31], v21 offset:3072
    s_waitcnt lgkmcnt(11)
    v_mfma_f32_32x32x16_bf16 v[72:87], v[36:39], v[232:235], v[72:87]
    v_cvt_pk_bf16_f32 v61, v66, v67
    v_cvt_pk_bf16_f32 v62, v68, v69
    ds_read_b64_tr_b16 v[32:33], v21 offset:4096
    ds_read_b64_tr_b16 v[34:35], v21 offset:6144
    s_waitcnt lgkmcnt(11)
    v_mfma_f32_32x32x16_bf16 v[72:87], v[40:43], v[236:239], v[72:87]
    v_cvt_pk_bf16_f32 v63, v70, v71
    ds_write_b128 v0, v[60:63] offset:1024
    ds_read_b64_tr_b16 v[36:37], v21 offset:5120
    ds_read_b64_tr_b16 v[38:39], v21 offset:7168
    s_waitcnt lgkmcnt(12)
    v_mfma_f32_32x32x16_bf16 v[72:87], v[44:47], v[240:243], v[72:87]
    v_subrev_u32 v0, 118784, v0
    ds_read_b64_tr_b16 v[40:41], v21 offset:8192
    ds_read_b64_tr_b16 v[42:43], v21 offset:10240
    s_waitcnt lgkmcnt(12)
    v_mfma_f32_32x32x16_bf16 v[72:87], v[48:51], v[244:247], v[72:87]
    ds_read_b64_tr_b16 v[44:45], v21 offset:9216
    ds_read_b64_tr_b16 v[46:47], v21 offset:11264
    s_waitcnt lgkmcnt(6)
    s_barrier
    v_mfma_f32_32x32x16_bf16 v[72:87], v[52:55], v[152:155], v[72:87]
    ds_read_b64_tr_b16 v[48:49], v21 offset:12288
    ds_read_b64_tr_b16 v[50:51], v21 offset:14336
    v_mfma_f32_32x32x16_bf16 v[72:87], v[28:31], v[156:159], v[72:87]
    ds_read_b64_tr_b16 v[52:53], v21 offset:13312
    ds_read_b64_tr_b16 v[54:55], v21 offset:15360
    v_mfma_f32_32x32x16_bf16 v[72:87], v[32:35], v[160:163], v[72:87]
    ds_read_b64_tr_b16 v[28:29], v21 offset:16384
    ds_read_b64_tr_b16 v[30:31], v21 offset:18432
    s_waitcnt lgkmcnt(10)
    v_mfma_f32_32x32x16_bf16 v[72:87], v[36:39], v[164:167], v[72:87]
    ds_read_b64_tr_b16 v[32:33], v21 offset:17408
    ds_read_b64_tr_b16 v[34:35], v21 offset:19456
    s_waitcnt lgkmcnt(10)
    v_mfma_f32_32x32x16_bf16 v[72:87], v[40:43], v[168:171], v[72:87]
    ds_read_b64_tr_b16 v[36:37], v21 offset:20480
    ds_read_b64_tr_b16 v[38:39], v21 offset:22528
    s_waitcnt lgkmcnt(10)
    v_mfma_f32_32x32x16_bf16 v[72:87], v[44:47], v[172:175], v[72:87]
    ds_read_b64_tr_b16 v[40:41], v21 offset:21504
    ds_read_b64_tr_b16 v[42:43], v21 offset:23552
    s_waitcnt lgkmcnt(10)
    v_mfma_f32_32x32x16_bf16 v[72:87], v[48:51], v[176:179], v[72:87]
    ds_read_b64_tr_b16 v[44:45], v21 offset:24576
    ds_read_b64_tr_b16 v[46:47], v21 offset:26624
    s_waitcnt lgkmcnt(10)
    v_mfma_f32_32x32x16_bf16 v[72:87], v[52:55], v[180:183], v[72:87]
    ds_read_b64_tr_b16 v[48:49], v21 offset:25600
    ds_read_b64_tr_b16 v[50:51], v21 offset:27648
    s_waitcnt lgkmcnt(10)
    v_mfma_f32_32x32x16_bf16 v[72:87], v[28:31], v[184:187], v[72:87]
    ds_read_b64_tr_b16 v[52:53], v21 offset:28672
    ds_read_b64_tr_b16 v[54:55], v21 offset:30720
    s_waitcnt lgkmcnt(10)
    v_mfma_f32_32x32x16_bf16 v[72:87], v[32:35], v[188:191], v[72:87]
    ds_read_b64_tr_b16 v[28:29], v21 offset:29696
    ds_read_b64_tr_b16 v[30:31], v21 offset:31744
    s_waitcnt lgkmcnt(10)
    v_mfma_f32_32x32x16_bf16 v[72:87], v[36:39], v[192:195], v[72:87]
    ds_read_b64_tr_b16 v[32:33], v22 offset:32768
    ds_read_b64_tr_b16 v[34:35], v22 offset:34816
    s_waitcnt lgkmcnt(10)
    v_mfma_f32_32x32x16_bf16 v[72:87], v[40:43], v[196:199], v[72:87]
    ds_read_b64_tr_b16 v[36:37], v23 offset:32768
    ds_read_b64_tr_b16 v[38:39], v23 offset:34816
    s_waitcnt lgkmcnt(10)
    v_mfma_f32_32x32x16_bf16 v[72:87], v[44:47], v[200:203], v[72:87]
    ds_read_b64_tr_b16 v[40:41], v22 offset:33792
    ds_read_b64_tr_b16 v[42:43], v22 offset:35840
    s_waitcnt lgkmcnt(10)
    v_mfma_f32_32x32x16_bf16 v[72:87], v[48:51], v[204:207], v[72:87]
    ds_read_b64_tr_b16 v[44:45], v23 offset:33792
    ds_read_b64_tr_b16 v[46:47], v23 offset:35840
    s_waitcnt lgkmcnt(10)
    v_mfma_f32_32x32x16_bf16 v[72:87], v[52:55], v[208:211], v[72:87]
    ds_read_b64_tr_b16 v[48:49], v22 offset:36864
    ds_read_b64_tr_b16 v[50:51], v22 offset:38912
    s_waitcnt lgkmcnt(10)
    v_mfma_f32_32x32x16_bf16 v[72:87], v[28:31], v[212:215], v[72:87]
    ds_read_b64_tr_b16 v[52:53], v23 offset:36864
    ds_read_b64_tr_b16 v[54:55], v23 offset:38912
    s_waitcnt lgkmcnt(10)
    v_mfma_f32_32x32x16_bf16 v[88:103], v[32:35], v[216:219], v[88:103]
    ds_read_b64_tr_b16 v[28:29], v22 offset:37888
    ds_read_b64_tr_b16 v[30:31], v22 offset:39936
    s_waitcnt lgkmcnt(10)
    v_mfma_f32_32x32x16_bf16 v[104:119], v[36:39], v[216:219], v[104:119]
    s_nop 3
    v_cvt_pk_bf16_f32 v72, v72, v73
    v_cvt_pk_bf16_f32 v73, v74, v75
    ds_read_b64_tr_b16 v[32:33], v23 offset:37888
    ds_read_b64_tr_b16 v[34:35], v23 offset:39936
    s_waitcnt lgkmcnt(10)
    v_mfma_f32_32x32x16_bf16 v[88:103], v[40:43], v[220:223], v[88:103]
    v_cvt_pk_bf16_f32 v74, v76, v77
    v_cvt_pk_bf16_f32 v75, v78, v79
    ds_read_b64_tr_b16 v[36:37], v22 offset:40960
    ds_read_b64_tr_b16 v[38:39], v22 offset:43008
    s_waitcnt lgkmcnt(10)
    v_mfma_f32_32x32x16_bf16 v[104:119], v[44:47], v[220:223], v[104:119]
    ds_write_b128 v0, v[72:75]
    v_cvt_pk_bf16_f32 v76, v80, v81
    ds_read_b64_tr_b16 v[40:41], v23 offset:40960
    ds_read_b64_tr_b16 v[42:43], v23 offset:43008
    s_waitcnt lgkmcnt(11)
    v_mfma_f32_32x32x16_bf16 v[88:103], v[48:51], v[224:227], v[88:103]
    v_cvt_pk_bf16_f32 v77, v82, v83
    v_cvt_pk_bf16_f32 v78, v84, v85
    ds_read_b64_tr_b16 v[44:45], v22 offset:41984
    ds_read_b64_tr_b16 v[46:47], v22 offset:44032
    s_waitcnt lgkmcnt(11)
    v_mfma_f32_32x32x16_bf16 v[104:119], v[52:55], v[224:227], v[104:119]
    v_cvt_pk_bf16_f32 v79, v86, v87
    ds_write_b128 v0, v[76:79] offset:1024
    ds_read_b64_tr_b16 v[48:49], v23 offset:41984
    ds_read_b64_tr_b16 v[50:51], v23 offset:44032
    s_waitcnt lgkmcnt(12)
    v_mfma_f32_32x32x16_bf16 v[88:103], v[28:31], v[228:231], v[88:103]
    ds_read_b64_tr_b16 v[52:53], v22 offset:45056
    ds_read_b64_tr_b16 v[54:55], v22 offset:47104
    s_waitcnt lgkmcnt(12)
    v_mfma_f32_32x32x16_bf16 v[104:119], v[32:35], v[228:231], v[104:119]
    ds_read_b64_tr_b16 v[28:29], v23 offset:45056
    ds_read_b64_tr_b16 v[30:31], v23 offset:47104
    s_waitcnt lgkmcnt(6)
    s_barrier
    v_mfma_f32_32x32x16_bf16 v[88:103], v[36:39], v[232:235], v[88:103]
    s_lshl_b32 s96, s77, 11
    s_add_u32 s14, s96, 32768
    v_and_b32 v0, 7, v1
    ds_read_b64_tr_b16 v[32:33], v22 offset:46080
    ds_read_b64_tr_b16 v[34:35], v22 offset:48128
    v_mfma_f32_32x32x16_bf16 v[104:119], v[40:43], v[232:235], v[104:119]
    v_lshl_add_u32 v0, v0, 4, s14
    ds_read_b64_tr_b16 v[36:37], v23 offset:46080
    ds_read_b64_tr_b16 v[38:39], v23 offset:48128
    v_mfma_f32_32x32x16_bf16 v[88:103], v[44:47], v[236:239], v[88:103]
    v_bfe_u32 v4, v1, 3, 2
    ds_read_b64_tr_b16 v[40:41], v22
    ds_read_b64_tr_b16 v[42:43], v22 offset:2048
    s_waitcnt lgkmcnt(10)
    v_mfma_f32_32x32x16_bf16 v[104:119], v[48:51], v[236:239], v[104:119]
    v_lshl_add_u32 v0, v4, 8, v0
    v_lshrrev_b32 v4, 5, v1
    ds_read_b64_tr_b16 v[44:45], v23
    ds_read_b64_tr_b16 v[46:47], v23 offset:2048
    s_waitcnt lgkmcnt(10)
    v_mfma_f32_32x32x16_bf16 v[88:103], v[52:55], v[240:243], v[88:103]
    v_lshl_add_u32 v0, v4, 7, v0
    ds_read_b64_tr_b16 v[48:49], v22 offset:1024
    ds_read_b64_tr_b16 v[50:51], v22 offset:3072
    s_waitcnt lgkmcnt(10)
    v_mfma_f32_32x32x16_bf16 v[104:119], v[28:31], v[240:243], v[104:119]
    ds_read_b64_tr_b16 v[52:53], v23 offset:1024
    ds_read_b64_tr_b16 v[54:55], v23 offset:3072
    s_waitcnt lgkmcnt(10)
    v_mfma_f32_32x32x16_bf16 v[88:103], v[32:35], v[244:247], v[88:103]
    ds_read_b64_tr_b16 v[28:29], v22 offset:4096
    ds_read_b64_tr_b16 v[30:31], v22 offset:6144
    s_waitcnt lgkmcnt(10)
    v_mfma_f32_32x32x16_bf16 v[104:119], v[36:39], v[244:247], v[104:119]
    ds_read_b64_tr_b16 v[32:33], v23 offset:4096
    ds_read_b64_tr_b16 v[34:35], v23 offset:6144
    s_waitcnt lgkmcnt(10)
    v_mfma_f32_32x32x16_bf16 v[88:103], v[40:43], v[152:155], v[88:103]
    ds_read_b64_tr_b16 v[36:37], v22 offset:5120
    ds_read_b64_tr_b16 v[38:39], v22 offset:7168
    s_waitcnt lgkmcnt(10)
    v_mfma_f32_32x32x16_bf16 v[104:119], v[44:47], v[152:155], v[104:119]
    ds_read_b64_tr_b16 v[40:41], v23 offset:5120
    ds_read_b64_tr_b16 v[42:43], v23 offset:7168
    s_waitcnt lgkmcnt(10)
    v_mfma_f32_32x32x16_bf16 v[88:103], v[48:51], v[156:159], v[88:103]
    ds_read_b64_tr_b16 v[44:45], v22 offset:8192
    ds_read_b64_tr_b16 v[46:47], v22 offset:10240
    s_waitcnt lgkmcnt(10)
    v_mfma_f32_32x32x16_bf16 v[104:119], v[52:55], v[156:159], v[104:119]
    ds_read_b64_tr_b16 v[48:49], v23 offset:8192
    ds_read_b64_tr_b16 v[50:51], v23 offset:10240
    s_waitcnt lgkmcnt(10)
    v_mfma_f32_32x32x16_bf16 v[88:103], v[28:31], v[160:163], v[88:103]
    ds_read_b64_tr_b16 v[52:53], v22 offset:9216
    ds_read_b64_tr_b16 v[54:55], v22 offset:11264
    s_waitcnt lgkmcnt(10)
    v_mfma_f32_32x32x16_bf16 v[104:119], v[32:35], v[160:163], v[104:119]
    ds_read_b64_tr_b16 v[28:29], v23 offset:9216
    ds_read_b64_tr_b16 v[30:31], v23 offset:11264
    s_waitcnt lgkmcnt(10)
    v_mfma_f32_32x32x16_bf16 v[88:103], v[36:39], v[164:167], v[88:103]
    ds_read_b64_tr_b16 v[32:33], v22 offset:12288
    ds_read_b64_tr_b16 v[34:35], v22 offset:14336
    s_waitcnt lgkmcnt(10)
    v_mfma_f32_32x32x16_bf16 v[104:119], v[40:43], v[164:167], v[104:119]
    ds_read_b64_tr_b16 v[36:37], v23 offset:12288
    ds_read_b64_tr_b16 v[38:39], v23 offset:14336
    s_waitcnt lgkmcnt(10)
    v_mfma_f32_32x32x16_bf16 v[88:103], v[44:47], v[168:171], v[88:103]
    ds_read_b64_tr_b16 v[40:41], v22 offset:13312
    ds_read_b64_tr_b16 v[42:43], v22 offset:15360
    s_waitcnt lgkmcnt(10)
    v_mfma_f32_32x32x16_bf16 v[104:119], v[48:51], v[168:171], v[104:119]
    ds_read_b64_tr_b16 v[44:45], v23 offset:13312
    ds_read_b64_tr_b16 v[46:47], v23 offset:15360
    s_waitcnt lgkmcnt(10)
    v_mfma_f32_32x32x16_bf16 v[88:103], v[52:55], v[172:175], v[88:103]
    ds_read_b64_tr_b16 v[48:49], v22 offset:16384
    ds_read_b64_tr_b16 v[50:51], v22 offset:18432
    s_waitcnt lgkmcnt(10)
    v_mfma_f32_32x32x16_bf16 v[104:119], v[28:31], v[172:175], v[104:119]
    ds_read_b64_tr_b16 v[52:53], v23 offset:16384
    ds_read_b64_tr_b16 v[54:55], v23 offset:18432
    s_waitcnt lgkmcnt(10)
    v_mfma_f32_32x32x16_bf16 v[88:103], v[32:35], v[176:179], v[88:103]
    ds_read_b64_tr_b16 v[28:29], v22 offset:17408
    ds_read_b64_tr_b16 v[30:31], v22 offset:19456
    s_waitcnt lgkmcnt(10)
    v_mfma_f32_32x32x16_bf16 v[104:119], v[36:39], v[176:179], v[104:119]
    ds_read_b64_tr_b16 v[32:33], v23 offset:17408
    ds_read_b64_tr_b16 v[34:35], v23 offset:19456
    s_waitcnt lgkmcnt(10)
    v_mfma_f32_32x32x16_bf16 v[88:103], v[40:43], v[180:183], v[88:103]
    ds_read_b64_tr_b16 v[36:37], v22 offset:20480
    ds_read_b64_tr_b16 v[38:39], v22 offset:22528
    s_waitcnt lgkmcnt(10)
    v_mfma_f32_32x32x16_bf16 v[104:119], v[44:47], v[180:183], v[104:119]
    ds_read_b64_tr_b16 v[40:41], v23 offset:20480
    ds_read_b64_tr_b16 v[42:43], v23 offset:22528
    s_waitcnt lgkmcnt(10)
    v_mfma_f32_32x32x16_bf16 v[88:103], v[48:51], v[184:187], v[88:103]
    ds_read_b64_tr_b16 v[44:45], v22 offset:21504
    ds_read_b64_tr_b16 v[46:47], v22 offset:23552
    s_waitcnt lgkmcnt(10)
    v_mfma_f32_32x32x16_bf16 v[104:119], v[52:55], v[184:187], v[104:119]
    ds_read_b64_tr_b16 v[48:49], v23 offset:21504
    ds_read_b64_tr_b16 v[50:51], v23 offset:23552
    s_waitcnt lgkmcnt(10)
    v_mfma_f32_32x32x16_bf16 v[88:103], v[28:31], v[188:191], v[88:103]
    ds_read_b64_tr_b16 v[52:53], v22 offset:24576
    ds_read_b64_tr_b16 v[54:55], v22 offset:26624
    s_waitcnt lgkmcnt(10)
    v_mfma_f32_32x32x16_bf16 v[104:119], v[32:35], v[188:191], v[104:119]
    ds_read_b64_tr_b16 v[28:29], v23 offset:24576
    ds_read_b64_tr_b16 v[30:31], v23 offset:26624
    s_waitcnt lgkmcnt(10)
    v_mfma_f32_32x32x16_bf16 v[88:103], v[36:39], v[192:195], v[88:103]
    ds_read_b64_tr_b16 v[32:33], v22 offset:25600
    ds_read_b64_tr_b16 v[34:35], v22 offset:27648
    s_waitcnt lgkmcnt(10)
    v_mfma_f32_32x32x16_bf16 v[104:119], v[40:43], v[192:195], v[104:119]
    ds_read_b64_tr_b16 v[36:37], v23 offset:25600
    ds_read_b64_tr_b16 v[38:39], v23 offset:27648
    s_waitcnt lgkmcnt(10)
    v_mfma_f32_32x32x16_bf16 v[88:103], v[44:47], v[196:199], v[88:103]
    ds_read_b64_tr_b16 v[40:41], v22 offset:28672
    ds_read_b64_tr_b16 v[42:43], v22 offset:30720
    s_waitcnt lgkmcnt(10)
    v_mfma_f32_32x32x16_bf16 v[104:119], v[48:51], v[196:199], v[104:119]
    ds_read_b64_tr_b16 v[44:45], v23 offset:28672
    ds_read_b64_tr_b16 v[46:47], v23 offset:30720
    s_waitcnt lgkmcnt(10)
    v_mfma_f32_32x32x16_bf16 v[88:103], v[52:55], v[200:203], v[88:103]
    ds_read_b64_tr_b16 v[48:49], v22 offset:29696
    ds_read_b64_tr_b16 v[50:51], v22 offset:31744
    s_waitcnt lgkmcnt(10)
    v_mfma_f32_32x32x16_bf16 v[104:119], v[28:31], v[200:203], v[104:119]
    ds_read_b64_tr_b16 v[52:53], v23 offset:29696
    ds_read_b64_tr_b16 v[54:55], v23 offset:31744
    s_waitcnt lgkmcnt(10)
    v_mfma_f32_32x32x16_bf16 v[88:103], v[32:35], v[204:207], v[88:103]
    ds_read_b64_tr_b16 v[28:29], v24 offset:32768
    ds_read_b64_tr_b16 v[30:31], v24 offset:34816
    s_waitcnt lgkmcnt(10)
    v_mfma_f32_32x32x16_bf16 v[104:119], v[36:39], v[204:207], v[104:119]
    ds_read_b64_tr_b16 v[32:33], v25 offset:32768
    ds_read_b64_tr_b16 v[34:35], v25 offset:34816
    s_waitcnt lgkmcnt(10)
    v_mfma_f32_32x32x16_bf16 v[88:103], v[40:43], v[208:211], v[88:103]
    ds_read_b64_tr_b16 v[36:37], v24 offset:33792
    ds_read_b64_tr_b16 v[38:39], v24 offset:35840
    s_waitcnt lgkmcnt(10)
    v_mfma_f32_32x32x16_bf16 v[104:119], v[44:47], v[208:211], v[104:119]
    ds_read_b64_tr_b16 v[40:41], v25 offset:33792
    ds_read_b64_tr_b16 v[42:43], v25 offset:35840
    s_waitcnt lgkmcnt(10)
    v_mfma_f32_32x32x16_bf16 v[88:103], v[48:51], v[212:215], v[88:103]
    ds_read_b64_tr_b16 v[44:45], v24 offset:36864
    ds_read_b64_tr_b16 v[46:47], v24 offset:38912
    s_waitcnt lgkmcnt(10)
    v_mfma_f32_32x32x16_bf16 v[104:119], v[52:55], v[212:215], v[104:119]
    ds_read_b64_tr_b16 v[48:49], v25 offset:36864
    ds_read_b64_tr_b16 v[50:51], v25 offset:38912
    s_barrier
    s_waitcnt lgkmcnt(10)
    v_mfma_f32_32x32x16_bf16 v[120:135], v[28:31], v[216:219], v[120:135]
    ds_read_b64_tr_b16 v[52:53], v24 offset:37888
    ds_read_b64_tr_b16 v[54:55], v24 offset:39936
L_PAD4:
    s_cbranch_execz L_RET4
    s_waitcnt lgkmcnt(10)
    v_mfma_f32_32x32x16_bf16 v[136:151], v[32:35], v[216:219], v[136:151]
    ds_read_b64_tr_b16 v[28:29], v25 offset:37888
    ds_read_b64_tr_b16 v[30:31], v25 offset:39936
    s_waitcnt lgkmcnt(10)
    v_mfma_f32_32x32x16_bf16 v[120:135], v[36:39], v[220:223], v[120:135]
    v_cvt_pk_bf16_f32 v88, v88, v89
    ds_read_b64_tr_b16 v[32:33], v24 offset:40960
    ds_read_b64_tr_b16 v[34:35], v24 offset:43008
    s_waitcnt lgkmcnt(10)
    v_mfma_f32_32x32x16_bf16 v[136:151], v[40:43], v[220:223], v[136:151]
    v_cvt_pk_bf16_f32 v89, v90, v91
    ds_read_b64_tr_b16 v[36:37], v25 offset:40960
    ds_read_b64_tr_b16 v[38:39], v25 offset:43008
    s_waitcnt lgkmcnt(10)
    v_mfma_f32_32x32x16_bf16 v[120:135], v[44:47], v[224:227], v[120:135]
    v_cvt_pk_bf16_f32 v90, v92, v93
    ds_read_b64_tr_b16 v[40:41], v24 offset:41984
    ds_read_b64_tr_b16 v[42:43], v24 offset:44032
    s_waitcnt lgkmcnt(10)
    v_mfma_f32_32x32x16_bf16 v[136:151], v[48:51], v[224:227], v[136:151]
    v_cvt_pk_bf16_f32 v91, v94, v95
    ds_read_b64_tr_b16 v[44:45], v25 offset:41984
    ds_read_b64_tr_b16 v[46:47], v25 offset:44032
    s_waitcnt lgkmcnt(10)
    v_mfma_f32_32x32x16_bf16 v[120:135], v[52:55], v[228:231], v[120:135]
    ds_write_b128 v0, v[88:91]
    ds_read_b64_tr_b16 v[48:49], v24 offset:45056
    ds_read_b64_tr_b16 v[50:51], v24 offset:47104
    s_waitcnt lgkmcnt(11)
    v_mfma_f32_32x32x16_bf16 v[136:151], v[28:31], v[228:231], v[136:151]
    v_cvt_pk_bf16_f32 v92, v96, v97
    ds_read_b64_tr_b16 v[52:53], v25 offset:45056
    ds_read_b64_tr_b16 v[54:55], v25 offset:47104
    s_waitcnt lgkmcnt(11)
    v_mfma_f32_32x32x16_bf16 v[120:135], v[32:35], v[232:235], v[120:135]
    v_cvt_pk_bf16_f32 v93, v98, v99
    ds_read_b64_tr_b16 v[28:29], v24 offset:46080
    ds_read_b64_tr_b16 v[30:31], v24 offset:48128
    s_waitcnt lgkmcnt(11)
    v_mfma_f32_32x32x16_bf16 v[136:151], v[36:39], v[232:235], v[136:151]
    v_cvt_pk_bf16_f32 v94, v100, v101
    ds_read_b64_tr_b16 v[32:33], v25 offset:46080
    ds_read_b64_tr_b16 v[34:35], v25 offset:48128
    s_waitcnt lgkmcnt(11)
    v_mfma_f32_32x32x16_bf16 v[120:135], v[40:43], v[236:239], v[120:135]
    v_cvt_pk_bf16_f32 v95, v102, v103
    ds_read_b64_tr_b16 v[36:37], v24
    ds_read_b64_tr_b16 v[38:39], v24 offset:2048
    s_waitcnt lgkmcnt(11)
    v_mfma_f32_32x32x16_bf16 v[136:151], v[44:47], v[236:239], v[136:151]
    ds_write_b128 v0, v[92:95] offset:1024
    ds_read_b64_tr_b16 v[40:41], v25
    ds_read_b64_tr_b16 v[42:43], v25 offset:2048
    s_waitcnt lgkmcnt(11)
    v_mfma_f32_32x32x16_bf16 v[120:135], v[48:51], v[240:243], v[120:135]
    v_cvt_pk_bf16_f32 v104, v104, v105
    ds_read_b64_tr_b16 v[44:45], v24 offset:1024
    ds_read_b64_tr_b16 v[46:47], v24 offset:3072
    s_waitcnt lgkmcnt(11)
    v_mfma_f32_32x32x16_bf16 v[136:151], v[52:55], v[240:243], v[136:151]
    v_cvt_pk_bf16_f32 v105, v106, v107
    ds_read_b64_tr_b16 v[48:49], v25 offset:1024
    ds_read_b64_tr_b16 v[50:51], v25 offset:3072
    s_waitcnt lgkmcnt(11)
    v_mfma_f32_32x32x16_bf16 v[120:135], v[28:31], v[244:247], v[120:135]
    v_cvt_pk_bf16_f32 v106, v108, v109
    ds_read_b64_tr_b16 v[52:53], v24 offset:4096
    ds_read_b64_tr_b16 v[54:55], v24 offset:6144
    s_waitcnt lgkmcnt(11)
    v_mfma_f32_32x32x16_bf16 v[136:151], v[32:35], v[244:247], v[136:151]
    v_cvt_pk_bf16_f32 v107, v110, v111
    ds_read_b64_tr_b16 v[28:29], v25 offset:4096
    ds_read_b64_tr_b16 v[30:31], v25 offset:6144
    s_waitcnt lgkmcnt(11)
    v_mfma_f32_32x32x16_bf16 v[120:135], v[36:39], v[152:155], v[120:135]
    ds_write_b128 v0, v[104:107] offset:8192
    ds_read_b64_tr_b16 v[32:33], v24 offset:5120
    ds_read_b64_tr_b16 v[34:35], v24 offset:7168
    s_waitcnt lgkmcnt(11)
    v_mfma_f32_32x32x16_bf16 v[136:151], v[40:43], v[152:155], v[136:151]
    v_cvt_pk_bf16_f32 v108, v112, v113
    ds_read_b64_tr_b16 v[36:37], v25 offset:5120
    ds_read_b64_tr_b16 v[38:39], v25 offset:7168
    s_waitcnt lgkmcnt(11)
    v_mfma_f32_32x32x16_bf16 v[120:135], v[44:47], v[156:159], v[120:135]
    v_cvt_pk_bf16_f32 v109, v114, v115
    ds_read_b64_tr_b16 v[40:41], v24 offset:8192
    ds_read_b64_tr_b16 v[42:43], v24 offset:10240
    s_waitcnt lgkmcnt(11)
    v_mfma_f32_32x32x16_bf16 v[136:151], v[48:51], v[156:159], v[136:151]
    v_cvt_pk_bf16_f32 v110, v116, v117
    ds_read_b64_tr_b16 v[44:45], v25 offset:8192
    ds_read_b64_tr_b16 v[46:47], v25 offset:10240
    s_waitcnt lgkmcnt(11)
    v_mfma_f32_32x32x16_bf16 v[120:135], v[52:55], v[160:163], v[120:135]
    v_cvt_pk_bf16_f32 v111, v118, v119
    ds_read_b64_tr_b16 v[48:49], v24 offset:9216
    ds_read_b64_tr_b16 v[50:51], v24 offset:11264
    s_waitcnt lgkmcnt(11)
    v_mfma_f32_32x32x16_bf16 v[136:151], v[28:31], v[160:163], v[136:151]
    ds_write_b128 v0, v[108:111] offset:9216
    ds_read_b64_tr_b16 v[52:53], v25 offset:9216
    ds_read_b64_tr_b16 v[54:55], v25 offset:11264
    s_waitcnt lgkmcnt(11)
    v_mfma_f32_32x32x16_bf16 v[120:135], v[32:35], v[164:167], v[120:135]
    ds_read_b64_tr_b16 v[28:29], v24 offset:12288
    ds_read_b64_tr_b16 v[30:31], v24 offset:14336
    s_waitcnt lgkmcnt(11)
    v_mfma_f32_32x32x16_bf16 v[136:151], v[36:39], v[164:167], v[136:151]
    ds_read_b64_tr_b16 v[32:33], v25 offset:12288
    ds_read_b64_tr_b16 v[34:35], v25 offset:14336
    s_waitcnt lgkmcnt(11)
    v_mfma_f32_32x32x16_bf16 v[120:135], v[40:43], v[168:171], v[120:135]
    ds_read_b64_tr_b16 v[36:37], v24 offset:13312
    ds_read_b64_tr_b16 v[38:39], v24 offset:15360
    s_waitcnt lgkmcnt(11)
    v_mfma_f32_32x32x16_bf16 v[136:151], v[44:47], v[168:171], v[136:151]
    ds_read_b64_tr_b16 v[40:41], v25 offset:13312
    ds_read_b64_tr_b16 v[42:43], v25 offset:15360
    s_waitcnt lgkmcnt(11)
    v_mfma_f32_32x32x16_bf16 v[120:135], v[48:51], v[172:175], v[120:135]
    ds_read_b64_tr_b16 v[44:45], v24 offset:16384
    ds_read_b64_tr_b16 v[46:47], v24 offset:18432
    s_waitcnt lgkmcnt(10)
    v_mfma_f32_32x32x16_bf16 v[136:151], v[52:55], v[172:175], v[136:151]
    ds_read_b64_tr_b16 v[48:49], v25 offset:16384
    ds_read_b64_tr_b16 v[50:51], v25 offset:18432
    s_waitcnt lgkmcnt(10)
    v_mfma_f32_32x32x16_bf16 v[120:135], v[28:31], v[176:179], v[120:135]
    ds_read_b64_tr_b16 v[52:53], v24 offset:17408
    ds_read_b64_tr_b16 v[54:55], v24 offset:19456
    s_waitcnt lgkmcnt(10)
    v_mfma_f32_32x32x16_bf16 v[136:151], v[32:35], v[176:179], v[136:151]
    ds_read_b64_tr_b16 v[28:29], v25 offset:17408
    ds_read_b64_tr_b16 v[30:31], v25 offset:19456
    s_waitcnt lgkmcnt(10)
    v_mfma_f32_32x32x16_bf16 v[120:135], v[36:39], v[180:183], v[120:135]
    ds_read_b64_tr_b16 v[32:33], v24 offset:20480
    ds_read_b64_tr_b16 v[34:35], v24 offset:22528
    s_waitcnt lgkmcnt(10)
    v_mfma_f32_32x32x16_bf16 v[136:151], v[40:43], v[180:183], v[136:151]
    ds_read_b64_tr_b16 v[36:37], v25 offset:20480
    ds_read_b64_tr_b16 v[38:39], v25 offset:22528
    s_waitcnt lgkmcnt(10)
    v_mfma_f32_32x32x16_bf16 v[120:135], v[44:47], v[184:187], v[120:135]
    ds_read_b64_tr_b16 v[40:41], v24 offset:21504
    ds_read_b64_tr_b16 v[42:43], v24 offset:23552
    s_waitcnt lgkmcnt(10)
    v_mfma_f32_32x32x16_bf16 v[136:151], v[48:51], v[184:187], v[136:151]
    ds_read_b64_tr_b16 v[44:45], v25 offset:21504
    ds_read_b64_tr_b16 v[46:47], v25 offset:23552
    s_waitcnt lgkmcnt(10)
    v_mfma_f32_32x32x16_bf16 v[120:135], v[52:55], v[188:191], v[120:135]
    ds_read_b64_tr_b16 v[48:49], v24 offset:24576
    ds_read_b64_tr_b16 v[50:51], v24 offset:26624
    s_waitcnt lgkmcnt(10)
    v_mfma_f32_32x32x16_bf16 v[136:151], v[28:31], v[188:191], v[136:151]
    ds_read_b64_tr_b16 v[52:53], v25 offset:24576
    ds_read_b64_tr_b16 v[54:55], v25 offset:26624
    s_waitcnt lgkmcnt(10)
    v_mfma_f32_32x32x16_bf16 v[120:135], v[32:35], v[192:195], v[120:135]
    ds_read_b64_tr_b16 v[28:29], v24 offset:25600
    ds_read_b64_tr_b16 v[30:31], v24 offset:27648
    s_waitcnt lgkmcnt(10)
    v_mfma_f32_32x32x16_bf16 v[136:151], v[36:39], v[192:195], v[136:151]
    ds_read_b64_tr_b16 v[32:33], v25 offset:25600
    ds_read_b64_tr_b16 v[34:35], v25 offset:27648
    s_waitcnt lgkmcnt(10)
    v_mfma_f32_32x32x16_bf16 v[120:135], v[40:43], v[196:199], v[120:135]
    ds_read_b64_tr_b16 v[36:37], v24 offset:28672
    ds_read_b64_tr_b16 v[38:39], v24 offset:30720
    s_waitcnt lgkmcnt(10)
    v_mfma_f32_32x32x16_bf16 v[136:151], v[44:47], v[196:199], v[136:151]
    ds_read_b64_tr_b16 v[40:41], v25 offset:28672
    ds_read_b64_tr_b16 v[42:43], v25 offset:30720
    s_waitcnt lgkmcnt(10)
    v_mfma_f32_32x32x16_bf16 v[120:135], v[48:51], v[200:203], v[120:135]
    ds_read_b64_tr_b16 v[44:45], v25 offset:29696
    ds_read_b64_tr_b16 v[46:47], v25 offset:31744
    s_waitcnt lgkmcnt(10)
    v_mfma_f32_32x32x16_bf16 v[136:151], v[52:55], v[200:203], v[136:151]
    ds_read_b64_tr_b16 v[48:49], v24 offset:29696
    ds_read_b64_tr_b16 v[50:51], v24 offset:31744
    s_waitcnt lgkmcnt(10)
    v_mfma_f32_32x32x16_bf16 v[120:135], v[28:31], v[204:207], v[120:135]
    s_waitcnt lgkmcnt(8)
    v_mfma_f32_32x32x16_bf16 v[136:151], v[32:35], v[204:207], v[136:151]
    s_waitcnt lgkmcnt(6)
    v_mfma_f32_32x32x16_bf16 v[120:135], v[36:39], v[208:211], v[120:135]
    s_waitcnt lgkmcnt(4)
    v_mfma_f32_32x32x16_bf16 v[136:151], v[40:43], v[208:211], v[136:151]
    s_waitcnt lgkmcnt(2)
    v_mfma_f32_32x32x16_bf16 v[136:151], v[44:47], v[212:215], v[136:151]
    s_waitcnt lgkmcnt(0)
    v_mfma_f32_32x32x16_bf16 v[120:135], v[48:51], v[212:215], v[120:135]
    s_lshl_b32 s96, s77, 11
    s_add_u32 s14, s96, 151552
    v_add_u32 v0, s14, v2
    v_bfe_u32 v4, v1, 2, 2
    v_lshlrev_b32 v4, 6, v4
    v_bfe_u32 v9, v1, 4, 1
    v_lshl_add_u32 v4, v9, 5, v4
    v_and_b32 v9, 3, v1
    v_lshl_add_u32 v4, v9, 3, v4
    v_lshrrev_b32 v9, 5, v1
    v_lshl_add_u32 v4, v9, 8, v4
    v_add_u32 v4, 159744, v4
    ds_read_b64_tr_b16 v[176:177], v4
    ds_read_b64_tr_b16 v[178:179], v4 offset:512
    ds_read_b64_tr_b16 v[180:181], v4 offset:1024
    ds_read_b64_tr_b16 v[182:183], v4 offset:1536
    v_cvt_pk_bf16_f32 v152, v136, v137
    v_cvt_pk_bf16_f32 v153, v138, v139
    v_cvt_pk_bf16_f32 v154, v140, v141
    v_cvt_pk_bf16_f32 v155, v142, v143
    v_cvt_pk_bf16_f32 v156, v144, v145
    v_cvt_pk_bf16_f32 v157, v146, v147
    v_cvt_pk_bf16_f32 v158, v148, v149
    v_cvt_pk_bf16_f32 v159, v150, v151
    ds_write_b128 v0, v[152:155]
    ds_write_b128 v0, v[156:159] offset:1024
    v_cvt_pk_bf16_f32 v168, v120, v121
    v_cvt_pk_bf16_f32 v169, v122, v123
    v_cvt_pk_bf16_f32 v170, v124, v125
    v_cvt_pk_bf16_f32 v171, v126, v127
    v_cvt_pk_bf16_f32 v172, v128, v129
    v_cvt_pk_bf16_f32 v173, v130, v131
    v_cvt_pk_bf16_f32 v174, v132, v133
    v_cvt_pk_bf16_f32 v175, v134, v135
    s_setprio 0
    s_branch L_JOIN
L_HELP:
    s_waitcnt vmcnt(3)
    s_barrier
    s_add_u32 s96, s84, 5
    s_and_b32 s97, s96, 15
    s_mul_i32 s98, s97, 393216
    s_add_u32 s99, s98, s85
    s_add_u32 s82, s99, 4294772736
    s_add_u32 m0, s83, 36864
    s_nop 0
    buffer_load_dwordx4 v3, s[40:43], s82 offen lds
    s_add_u32 s96, s84, 5
    s_and_b32 s97, s96, 15
    s_mul_i32 s98, s97, 393216
    s_add_u32 s99, s98, s85
    s_add_u32 s82, s99, 2048
    s_add_u32 m0, s83, 40960
    s_nop 0
    buffer_load_dwordx4 v3, s[40:43], s82 offen lds
    s_add_u32 s96, s84, 5
    s_and_b32 s97, s96, 15
    s_mul_i32 s98, s97, 393216
    s_add_u32 s99, s98, s85
    s_add_u32 s82, s99, 4294774784
    s_add_u32 m0, s83, 86016
    s_nop 0
    buffer_load_dwordx4 v3, s[40:43], s82 offen lds
    s_add_u32 s96, s84, 5
    s_and_b32 s97, s96, 15
    s_mul_i32 s98, s97, 393216
    s_add_u32 s99, s98, s85
    s_add_u32 s82, s99, 4096
    s_add_u32 m0, s83, 90112
    s_nop 0
    buffer_load_dwordx4 v3, s[40:43], s82 offen lds
    s_add_u32 s96, s84, 5
    s_and_b32 s97, s96, 15
    s_mul_i32 s98, s97, 393216
    s_add_u32 s99, s98, s85
    s_add_u32 s82, s99, 4294770688
    s_add_u32 m0, s83, 135168
    s_nop 0
    buffer_load_dwordx4 v3, s[40:43], s82 offen lds
    s_add_u32 s96, s84, 5
    s_and_b32 s97, s96, 15
    s_mul_i32 s98, s97, 393216
    s_add_u32 s82, s98, s85
    s_add_u32 m0, s83, 139264
    s_nop 0
    buffer_load_dwordx4 v3, s[40:43], s82 offen lds
    v_bfe_u32 v4, v1, 2, 2
    v_lshlrev_b32 v4, 6, v4
    v_bfe_u32 v9, v1, 4, 1
    v_lshl_add_u32 v4, v9, 5, v4
    v_and_b32 v9, 3, v1
    v_lshl_add_u32 v4, v9, 3, v4
    v_lshrrev_b32 v9, 5, v1
    v_lshl_add_u32 v4, v9, 8, v4
    v_add_u32 v4, 159744, v4
    ds_read_b64_tr_b16 v[168:169], v4
    ds_read_b64_tr_b16 v[170:171], v4 offset:512
    ds_read_b64_tr_b16 v[172:173], v4 offset:1024
    ds_read_b64_tr_b16 v[174:175], v4 offset:1536
    ds_read_b64_tr_b16 v[176:177], v4 offset:2048
    ds_read_b64_tr_b16 v[178:179], v4 offset:2560
    ds_read_b64_tr_b16 v[180:181], v4 offset:3072
    ds_read_b64_tr_b16 v[182:183], v4 offset:3584
    s_lshl_b32 s14, s77, 10
    v_and_b32 v232, 7, v1
    v_lshl_add_u32 v232, v232, 4, s14
    v_bfe_u32 v9, v1, 3, 2
    v_lshl_add_u32 v232, v9, 8, v232
    v_lshrrev_b32 v9, 5, v1
    v_lshl_add_u32 v232, v9, 7, v232
    s_and_b32 s96, s9, 1
    s_lshl1_add_u32 s18, s96, 1
    s_and_b32 s96, s8, 3
    s_lshl2_add_u32 s97, s96, s3
    s_sub_u32 s98, s97, 4
    s_lshl_b32 s82, s98, 7
    v_lshrrev_b32 v136, 3, v1
    v_lshl_add_u32 v136, v136, 1, s82
    global_load_ushort v120, v136, s[86:87] offset:0
    global_load_ushort v121, v136, s[86:87] offset:16
    global_load_ushort v122, v136, s[86:87] offset:32
    global_load_ushort v123, v136, s[86:87] offset:48
    global_load_ushort v124, v136, s[86:87] offset:64
    global_load_ushort v125, v136, s[86:87] offset:80
    global_load_ushort v126, v136, s[86:87] offset:96
    global_load_ushort v127, v136, s[86:87] offset:112
    s_and_b32 s96, s8, 3
    s_lshl2_add_u32 s97, s96, s3
    s_sub_u32 s98, s97, 4
    s_mul_i32 s99, s98, 786432
    s_lshr_b32 s96, s8, 2
    s_lshl1_add_u32 s97, s9, s96
    s_lshl_b32 s98, s97, 7
    s_add_u32 s96, s99, s98
    s_add_u32 s19, s96, 4096
    s_barrier
    s_add_u32 s96, s84, 6
    s_and_b32 s97, s96, 15
    s_mul_i32 s98, s97, 393216
    s_add_u32 s99, s98, s85
    s_add_u32 s82, s99, 4294772736
    s_add_u32 m0, s83, 4294963200
    s_nop 0
    buffer_load_dwordx4 v3, s[40:43], s82 offen lds
    s_add_u32 s96, s84, 6
    s_and_b32 s97, s96, 15
    s_mul_i32 s98, s97, 393216
    s_add_u32 s99, s98, s85
    s_add_u32 s82, s99, 2048
    s_mov_b32 m0, s83
    s_nop 0
    buffer_load_dwordx4 v3, s[40:43], s82 offen lds
    s_add_u32 s96, s84, 6
    s_and_b32 s97, s96, 15
    s_mul_i32 s98, s97, 393216
    s_add_u32 s99, s98, s85
    s_add_u32 s82, s99, 4294770688
    s_add_u32 m0, s83, 94208
    s_nop 0
    buffer_load_dwordx4 v3, s[40:43], s82 offen lds
    s_add_u32 s96, s84, 6
    s_and_b32 s97, s96, 15
    s_mul_i32 s98, s97, 393216
    s_add_u32 s82, s98, s85
    s_add_u32 m0, s83, 98304
    s_nop 0
    buffer_load_dwordx4 v3, s[40:43], s82 offen lds
    s_add_u32 s96, s84, 6
    s_and_b32 s97, s96, 15
    s_mul_i32 s98, s97, 393216
    s_add_u32 s99, s98, s85
    s_add_u32 s82, s99, 4294774784
    s_add_u32 m0, s83, 45056
    s_nop 0
    buffer_load_dwordx4 v3, s[40:43], s82 offen lds
    s_add_u32 s96, s84, 6
    s_and_b32 s97, s96, 15
    s_mul_i32 s98, s97, 393216
    s_add_u32 s99, s98, s85
    s_add_u32 s82, s99, 4096
    s_add_u32 m0, s83, 49152
    s_nop 0
    buffer_load_dwordx4 v3, s[40:43], s82 offen lds
    s_cmp_lg_u32 s18, 1
    s_cbranch_scc1 L_NM2_1_0
    s_mov_b32 s82, s19
    buffer_load_dwordx4 v[88:91], v248, s[48:51], s82 offen nt
    s_add_u32 s82, s19, 98304
    buffer_load_dwordx4 v[92:95], v248, s[48:51], s82 offen nt
    s_add_u32 s82, s19, 196608
    buffer_load_dwordx4 v[96:99], v248, s[48:51], s82 offen nt
    s_add_u32 s82, s19, 294912
    buffer_load_dwordx4 v[100:103], v248, s[48:51], s82 offen nt
    s_add_u32 s82, s19, 393216
    buffer_load_dwordx4 v[104:107], v248, s[48:51], s82 offen nt
    s_add_u32 s82, s19, 491520
    buffer_load_dwordx4 v[108:111], v248, s[48:51], s82 offen nt
    s_add_u32 s82, s19, 589824
    buffer_load_dwordx4 v[112:115], v248, s[48:51], s82 offen nt
    s_add_u32 s82, s19, 688128
    buffer_load_dwordx4 v[116:119], v248, s[48:51], s82 offen nt
L_NM2_1_0:
    s_waitcnt lgkmcnt(0)
    s_load_dword s24, s[32:33], s92 offset:512 glc
    s_load_dword s25, s[32:33], s92 offset:256 glc
    s_load_dword s26, s[32:33], s92 offset:3584 glc
    s_load_dword s27, s[32:33], s92 offset:3328 glc
    s_barrier
    s_add_u32 s96, s84, 7
    s_and_b32 s97, s96, 15
    s_mul_i32 s98, s97, 393216
    s_add_u32 s99, s98, s85
    s_add_u32 s82, s99, 4294772736
    s_add_u32 m0, s83, 4096
    s_nop 0
    buffer_load_dwordx4 v3, s[40:43], s82 offen lds
    s_add_u32 s96, s84, 7
    s_and_b32 s97, s96, 15
    s_mul_i32 s98, s97, 393216
    s_add_u32 s99, s98, s85
    s_add_u32 s82, s99, 2048
    s_add_u32 m0, s83, 8192
    s_nop 0
    buffer_load_dwordx4 v3, s[40:43], s82 offen lds
    s_add_u32 s96, s84, 7
    s_and_b32 s97, s96, 15
    s_mul_i32 s98, s97, 393216
    s_add_u32 s99, s98, s85
    s_add_u32 s82, s99, 4294770688
    s_add_u32 m0, s83, 102400
    s_nop 0
    buffer_load_dwordx4 v3, s[40:43], s82 offen lds
    s_add_u32 s96, s84, 7
    s_and_b32 s97, s96, 15
    s_mul_i32 s98, s97, 393216
    s_add_u32 s82, s98, s85
    s_add_u32 m0, s83, 106496
    s_nop 0
    buffer_load_dwordx4 v3, s[40:43], s82 offen lds
    s_add_u32 s96, s84, 7
    s_and_b32 s97, s96, 15
    s_mul_i32 s98, s97, 393216
    s_add_u32 s99, s98, s85
    s_add_u32 s82, s99, 4294774784
    s_add_u32 m0, s83, 53248
    s_nop 0
    buffer_load_dwordx4 v3, s[40:43], s82 offen lds
    s_add_u32 s96, s84, 7
    s_and_b32 s97, s96, 15
    s_mul_i32 s98, s97, 393216
    s_add_u32 s99, s98, s85
    s_add_u32 s82, s99, 4096
    s_add_u32 m0, s83, 57344
    s_nop 0
    buffer_load_dwordx4 v3, s[40:43], s82 offen lds
    s_cmp_lg_u32 s18, 2
    s_cbranch_scc1 L_NM2_2_0
    s_mov_b32 s82, s19
    buffer_load_dwordx4 v[88:91], v248, s[48:51], s82 offen nt
    s_add_u32 s82, s19, 98304
    buffer_load_dwordx4 v[92:95], v248, s[48:51], s82 offen nt
    s_add_u32 s82, s19, 196608
    buffer_load_dwordx4 v[96:99], v248, s[48:51], s82 offen nt
    s_add_u32 s82, s19, 294912
    buffer_load_dwordx4 v[100:103], v248, s[48:51], s82 offen nt
    s_add_u32 s82, s19, 393216
    buffer_load_dwordx4 v[104:107], v248, s[48:51], s82 offen nt
    s_add_u32 s82, s19, 491520
    buffer_load_dwordx4 v[108:111], v248, s[48:51], s82 offen nt
    s_add_u32 s82, s19, 589824
    buffer_load_dwordx4 v[112:115], v248, s[48:51], s82 offen nt
    s_add_u32 s82, s19, 688128
    buffer_load_dwordx4 v[116:119], v248, s[48:51], s82 offen nt
L_NM2_2_0:
    s_waitcnt vmcnt(26)
    s_barrier
    s_add_u32 s96, s84, 8
    s_and_b32 s97, s96, 15
    s_mul_i32 s98, s97, 393216
    s_add_u32 s99, s98, s85
    s_add_u32 s82, s99, 4294772736
    s_add_u32 m0, s83, 12288
    s_nop 0
    buffer_load_dwordx4 v3, s[40:43], s82 offen lds
    s_add_u32 s96, s84, 8
    s_and_b32 s97, s96, 15
    s_mul_i32 s98, s97, 393216
    s_add_u32 s99, s98, s85
    s_add_u32 s82, s99, 2048
    s_add_u32 m0, s83, 16384
    s_nop 0
    buffer_load_dwordx4 v3, s[40:43], s82 offen lds
    s_add_u32 s96, s84, 8
    s_and_b32 s97, s96, 15
    s_mul_i32 s98, s97, 393216
    s_add_u32 s99, s98, s85
    s_add_u32 s82, s99, 4294770688
    s_add_u32 m0, s83, 110592
    s_nop 0
    buffer_load_dwordx4 v3, s[40:43], s82 offen lds
    s_add_u32 s96, s84, 8
    s_and_b32 s97, s96, 15
    s_mul_i32 s98, s97, 393216
    s_add_u32 s82, s98, s85
    s_add_u32 m0, s83, 114688
    s_nop 0
    buffer_load_dwordx4 v3, s[40:43], s82 offen lds
    s_add_u32 s96, s84, 8
    s_and_b32 s97, s96, 15
    s_mul_i32 s98, s97, 393216
    s_add_u32 s99, s98, s85
    s_add_u32 s82, s99, 4294774784
    s_add_u32 m0, s83, 61440
    s_nop 0
    buffer_load_dwordx4 v3, s[40:43], s82 offen lds
    s_add_u32 s96, s84, 8
    s_and_b32 s97, s96, 15
    s_mul_i32 s98, s97, 393216
    s_add_u32 s99, s98, s85
    s_add_u32 s82, s99, 4096
    s_add_u32 m0, s83, 65536
    s_nop 0
    buffer_load_dwordx4 v3, s[40:43], s82 offen lds
    s_cmp_lg_u32 s18, 3
    s_cbranch_scc1 L_NM2_3_0
    s_mov_b32 s82, s19
    buffer_load_dwordx4 v[88:91], v248, s[48:51], s82 offen nt
    s_add_u32 s82, s19, 98304
    buffer_load_dwordx4 v[92:95], v248, s[48:51], s82 offen nt
    s_add_u32 s82, s19, 196608
    buffer_load_dwordx4 v[96:99], v248, s[48:51], s82 offen nt
    s_add_u32 s82, s19, 294912
    buffer_load_dwordx4 v[100:103], v248, s[48:51], s82 offen nt
    s_add_u32 s82, s19, 393216
    buffer_load_dwordx4 v[104:107], v248, s[48:51], s82 offen nt
    s_add_u32 s82, s19, 491520
    buffer_load_dwordx4 v[108:111], v248, s[48:51], s82 offen nt
    s_add_u32 s82, s19, 589824
    buffer_load_dwordx4 v[112:115], v248, s[48:51], s82 offen nt
    s_add_u32 s82, s19, 688128
    buffer_load_dwordx4 v[116:119], v248, s[48:51], s82 offen nt
L_NM2_3_0:
    s_waitcnt vmcnt(18)
    v_lshlrev_b32 v120, 16, v120
    v_mul_f32 v136, s7, v120
    v_exp_f32 v136, -v136
    s_nop 0
    v_add_f32 v136, 1.0, v136
    v_rcp_f32 v136, v136
    s_nop 0
    v_mul_f32 v120, v120, v136
    v_cvt_pk_bf16_f32 v120, 0, v120
    v_lshlrev_b32 v121, 16, v121
    v_mul_f32 v137, s7, v121
    v_exp_f32 v137, -v137
    s_nop 0
    v_add_f32 v137, 1.0, v137
    v_rcp_f32 v137, v137
    s_nop 0
    v_mul_f32 v121, v121, v137
    v_cvt_pk_bf16_f32 v121, 0, v121
    v_lshlrev_b32 v122, 16, v122
    v_mul_f32 v136, s7, v122
    v_exp_f32 v136, -v136
    s_nop 0
    v_add_f32 v136, 1.0, v136
    v_rcp_f32 v136, v136
    s_nop 0
    v_mul_f32 v122, v122, v136
    v_cvt_pk_bf16_f32 v122, 0, v122
    v_lshlrev_b32 v123, 16, v123
    v_mul_f32 v137, s7, v123
    v_exp_f32 v137, -v137
    s_nop 0
    v_add_f32 v137, 1.0, v137
    v_rcp_f32 v137, v137
    s_nop 0
    v_mul_f32 v123, v123, v137
    v_cvt_pk_bf16_f32 v123, 0, v123
    v_lshlrev_b32 v124, 16, v124
    v_mul_f32 v136, s7, v124
    v_exp_f32 v136, -v136
    s_nop 0
    v_add_f32 v136, 1.0, v136
    v_rcp_f32 v136, v136
    s_nop 0
    v_mul_f32 v124, v124, v136
    v_cvt_pk_bf16_f32 v124, 0, v124
    v_lshlrev_b32 v125, 16, v125
    v_mul_f32 v137, s7, v125
    v_exp_f32 v137, -v137
    s_nop 0
    v_add_f32 v137, 1.0, v137
    v_rcp_f32 v137, v137
    s_nop 0
    v_mul_f32 v125, v125, v137
    v_cvt_pk_bf16_f32 v125, 0, v125
    v_lshlrev_b32 v126, 16, v126
    v_mul_f32 v136, s7, v126
    v_exp_f32 v136, -v136
    s_nop 0
    v_add_f32 v136, 1.0, v136
    v_rcp_f32 v136, v136
    s_nop 0
    v_mul_f32 v126, v126, v136
    v_cvt_pk_bf16_f32 v126, 0, v126
    v_lshlrev_b32 v127, 16, v127
    v_mul_f32 v137, s7, v127
    v_exp_f32 v137, -v137
    s_nop 0
    v_add_f32 v137, 1.0, v137
    v_rcp_f32 v137, v137
    s_nop 0
    v_mul_f32 v127, v127, v137
    v_cvt_pk_bf16_f32 v127, 0, v127
    s_waitcnt lgkmcnt(0)
    s_load_dword s24, s[32:33], s92 offset:1024 glc
    s_load_dword s25, s[32:33], s92 offset:768 glc
    s_load_dword s26, s[32:33], s92 offset:1536 glc
    s_load_dword s27, s[32:33], s92 offset:1280 glc
    s_barrier
    s_add_u32 s96, s84, 9
    s_and_b32 s97, s96, 15
    s_mul_i32 s98, s97, 393216
    s_add_u32 s99, s98, s85
    s_add_u32 s82, s99, 4294772736
    s_add_u32 m0, s83, 20480
    s_nop 0
    buffer_load_dwordx4 v3, s[40:43], s82 offen lds
    s_add_u32 s96, s84, 9
    s_and_b32 s97, s96, 15
    s_mul_i32 s98, s97, 393216
    s_add_u32 s99, s98, s85
    s_add_u32 s82, s99, 2048
    s_add_u32 m0, s83, 24576
    s_nop 0
    buffer_load_dwordx4 v3, s[40:43], s82 offen lds
    s_add_u32 s96, s84, 9
    s_and_b32 s97, s96, 15
    s_mul_i32 s98, s97, 393216
    s_add_u32 s99, s98, s85
    s_add_u32 s82, s99, 4294770688
    s_add_u32 m0, s83, 118784
    s_nop 0
    buffer_load_dwordx4 v3, s[40:43], s82 offen lds
    s_add_u32 s96, s84, 9
    s_and_b32 s97, s96, 15
    s_mul_i32 s98, s97, 393216
    s_add_u32 s82, s98, s85
    s_add_u32 m0, s83, 122880
L_PAD5:
    s_cbranch_execz L_RET5
    s_nop 0
    buffer_load_dwordx4 v3, s[40:43], s82 offen lds
    s_add_u32 s96, s84, 9
    s_and_b32 s97, s96, 15
    s_mul_i32 s98, s97, 393216
    s_add_u32 s99, s98, s85
    s_add_u32 s82, s99, 4294774784
    s_add_u32 m0, s83, 69632
    s_nop 0
    buffer_load_dwordx4 v3, s[40:43], s82 offen lds
    s_add_u32 s96, s84, 9
    s_and_b32 s97, s96, 15
    s_mul_i32 s98, s97, 393216
    s_add_u32 s99, s98, s85
    s_add_u32 s82, s99, 4096
    s_add_u32 m0, s83, 73728
    s_nop 0
    buffer_load_dwordx4 v3, s[40:43], s82 offen lds
    s_waitcnt vmcnt(22)
    s_waitcnt vmcnt(20)
    s_waitcnt vmcnt(18)
    s_barrier
    s_add_u32 s96, s84, 10
    s_and_b32 s97, s96, 15
    s_mul_i32 s98, s97, 393216
    s_add_u32 s99, s98, s85
    s_add_u32 s82, s99, 4294772736
    s_add_u32 m0, s83, 28672
    s_nop 0
    buffer_load_dwordx4 v3, s[40:43], s82 offen lds
    s_add_u32 s96, s84, 10
    s_and_b32 s97, s96, 15
    s_mul_i32 s98, s97, 393216
    s_add_u32 s99, s98, s85
    s_add_u32 s82, s99, 2048
    s_add_u32 m0, s83, 32768
    s_nop 0
    buffer_load_dwordx4 v3, s[40:43], s82 offen lds
    s_add_u32 s96, s84, 10
    s_and_b32 s97, s96, 15
    s_mul_i32 s98, s97, 393216
    s_add_u32 s99, s98, s85
    s_add_u32 s82, s99, 4294774784
    s_add_u32 m0, s83, 77824
    s_nop 0
    buffer_load_dwordx4 v3, s[40:43], s82 offen lds
    s_add_u32 s96, s84, 10
    s_and_b32 s97, s96, 15
    s_mul_i32 s98, s97, 393216
    s_add_u32 s99, s98, s85
    s_add_u32 s82, s99, 4096
    s_add_u32 m0, s83, 81920
    s_nop 0
    buffer_load_dwordx4 v3, s[40:43], s82 offen lds
    s_waitcnt vmcnt(8)
    v_lshlrev_b32 v136, 16, v88
    v_and_b32 v137, s6, v88
    v_mul_f32 v128, v136, v120
    v_mul_f32 v129, v137, v120
    v_lshlrev_b32 v138, 16, v89
    v_and_b32 v139, s6, v89
    v_mul_f32 v130, v138, v120
    v_mul_f32 v131, v139, v120
    v_lshlrev_b32 v136, 16, v90
    v_and_b32 v137, s6, v90
    v_mul_f32 v132, v136, v120
    v_mul_f32 v133, v137, v120
    v_lshlrev_b32 v138, 16, v91
    v_and_b32 v139, s6, v91
    v_mul_f32 v134, v138, v120
    v_mul_f32 v135, v139, v120
    v_lshlrev_b32 v136, 16, v92
    v_and_b32 v137, s6, v92
    v_fmac_f32 v128, v136, v121
    v_fmac_f32 v129, v137, v121
    v_lshlrev_b32 v138, 16, v93
    v_and_b32 v139, s6, v93
    v_fmac_f32 v130, v138, v121
    v_fmac_f32 v131, v139, v121
    v_lshlrev_b32 v136, 16, v94
    v_and_b32 v137, s6, v94
    v_fmac_f32 v132, v136, v121
    v_fmac_f32 v133, v137, v121
    v_lshlrev_b32 v138, 16, v95
    v_and_b32 v139, s6, v95
    v_fmac_f32 v134, v138, v121
    v_fmac_f32 v135, v139, v121
    v_lshlrev_b32 v136, 16, v96
    v_and_b32 v137, s6, v96
    v_fmac_f32 v128, v136, v122
    v_fmac_f32 v129, v137, v122
    v_lshlrev_b32 v138, 16, v97
    v_and_b32 v139, s6, v97
    v_fmac_f32 v130, v138, v122
    v_fmac_f32 v131, v139, v122
    v_lshlrev_b32 v136, 16, v98
    v_and_b32 v137, s6, v98
    v_fmac_f32 v132, v136, v122
    v_fmac_f32 v133, v137, v122
    v_lshlrev_b32 v138, 16, v99
    v_and_b32 v139, s6, v99
    v_fmac_f32 v134, v138, v122
    v_fmac_f32 v135, v139, v122
    s_waitcnt lgkmcnt(0)
    s_load_dword s24, s[32:33], s92 offset:2560 glc
    s_load_dword s25, s[32:33], s92 offset:2304 glc
    s_load_dword s26, s[32:33], s92 offset:3072 glc
    s_load_dword s27, s[32:33], s92 offset:2816 glc
    s_barrier
    s_add_u32 s96, s84, 11
    s_and_b32 s97, s96, 15
    s_mul_i32 s98, s97, 393216
    s_add_u32 s99, s98, s85
    s_add_u32 s82, s99, 4294772736
    s_add_u32 m0, s83, 36864
    s_nop 0
    buffer_load_dwordx4 v3, s[40:43], s82 offen lds
    s_add_u32 s96, s84, 11
    s_and_b32 s97, s96, 15
    s_mul_i32 s98, s97, 393216
    s_add_u32 s99, s98, s85
    s_add_u32 s82, s99, 2048
    s_add_u32 m0, s83, 40960
    s_nop 0
    buffer_load_dwordx4 v3, s[40:43], s82 offen lds
    s_add_u32 s96, s84, 11
    s_and_b32 s97, s96, 15
    s_mul_i32 s98, s97, 393216
    s_add_u32 s99, s98, s85
    s_add_u32 s82, s99, 4294774784
    s_add_u32 m0, s83, 86016
    s_nop 0
    buffer_load_dwordx4 v3, s[40:43], s82 offen lds
    s_add_u32 s96, s84, 11
    s_and_b32 s97, s96, 15
    s_mul_i32 s98, s97, 393216
    s_add_u32 s99, s98, s85
    s_add_u32 s82, s99, 4096
    s_add_u32 m0, s83, 90112
    s_nop 0
    buffer_load_dwordx4 v3, s[40:43], s82 offen lds
    v_lshlrev_b32 v136, 16, v100
    v_and_b32 v137, s6, v100
    v_fmac_f32 v128, v136, v123
    v_fmac_f32 v129, v137, v123
    v_lshlrev_b32 v138, 16, v101
    v_and_b32 v139, s6, v101
    v_fmac_f32 v130, v138, v123
    v_fmac_f32 v131, v139, v123
    v_lshlrev_b32 v136, 16, v102
    v_and_b32 v137, s6, v102
    v_fmac_f32 v132, v136, v123
    v_fmac_f32 v133, v137, v123
    v_lshlrev_b32 v138, 16, v103
    v_and_b32 v139, s6, v103
    v_fmac_f32 v134, v138, v123
    v_fmac_f32 v135, v139, v123
    v_lshlrev_b32 v136, 16, v104
    v_and_b32 v137, s6, v104
    v_fmac_f32 v128, v136, v124
    v_fmac_f32 v129, v137, v124
    v_lshlrev_b32 v138, 16, v105
    v_and_b32 v139, s6, v105
    v_fmac_f32 v130, v138, v124
    v_fmac_f32 v131, v139, v124
    v_lshlrev_b32 v136, 16, v106
    v_and_b32 v137, s6, v106
    v_fmac_f32 v132, v136, v124
    v_fmac_f32 v133, v137, v124
    v_lshlrev_b32 v138, 16, v107
    v_and_b32 v139, s6, v107
    v_fmac_f32 v134, v138, v124
    v_fmac_f32 v135, v139, v124
    v_lshlrev_b32 v136, 16, v108
    v_and_b32 v137, s6, v108
    v_fmac_f32 v128, v136, v125
    v_fmac_f32 v129, v137, v125
    v_lshlrev_b32 v138, 16, v109
    v_and_b32 v139, s6, v109
    v_fmac_f32 v130, v138, v125
    v_fmac_f32 v131, v139, v125
    v_lshlrev_b32 v136, 16, v110
    v_and_b32 v137, s6, v110
    v_fmac_f32 v132, v136, v125
    v_fmac_f32 v133, v137, v125
    v_lshlrev_b32 v138, 16, v111
    v_and_b32 v139, s6, v111
    v_fmac_f32 v134, v138, v125
    v_fmac_f32 v135, v139, v125
    s_barrier
    s_add_u32 s96, s84, 12
    s_and_b32 s97, s96, 15
    s_mul_i32 s98, s97, 393216
    s_add_u32 s99, s98, s85
    s_add_u32 s82, s99, 4294772736
    s_add_u32 m0, s83, 4294963200
    s_nop 0
    buffer_load_dwordx4 v3, s[40:43], s82 offen lds
    s_add_u32 s96, s84, 12
    s_and_b32 s97, s96, 15
    s_mul_i32 s98, s97, 393216
    s_add_u32 s99, s98, s85
    s_add_u32 s82, s99, 2048
    s_mov_b32 m0, s83
    s_nop 0
    buffer_load_dwordx4 v3, s[40:43], s82 offen lds
    s_add_u32 s96, s84, 12
    s_and_b32 s97, s96, 15
    s_mul_i32 s98, s97, 393216
    s_add_u32 s99, s98, s85
    s_add_u32 s82, s99, 4294774784
    s_add_u32 m0, s83, 45056
    s_nop 0
    buffer_load_dwordx4 v3, s[40:43], s82 offen lds
    s_add_u32 s96, s84, 12
    s_and_b32 s97, s96, 15
    s_mul_i32 s98, s97, 393216
    s_add_u32 s99, s98, s85
    s_add_u32 s82, s99, 4096
    s_add_u32 m0, s83, 49152
    s_nop 0
    buffer_load_dwordx4 v3, s[40:43], s82 offen lds
    v_lshlrev_b32 v136, 16, v112
    v_and_b32 v137, s6, v112
    v_fmac_f32 v128, v136, v126
    v_fmac_f32 v129, v137, v126
    v_lshlrev_b32 v138, 16, v113
    v_and_b32 v139, s6, v113
    v_fmac_f32 v130, v138, v126
    v_fmac_f32 v131, v139, v126
    v_lshlrev_b32 v136, 16, v114
    v_and_b32 v137, s6, v114
    v_fmac_f32 v132, v136, v126
    v_fmac_f32 v133, v137, v126
    v_lshlrev_b32 v138, 16, v115
    v_and_b32 v139, s6, v115
    v_fmac_f32 v134, v138, v126
    v_fmac_f32 v135, v139, v126
    v_lshlrev_b32 v136, 16, v116
    v_and_b32 v137, s6, v116
    v_fmac_f32 v128, v136, v127
    v_fmac_f32 v129, v137, v127
    v_lshlrev_b32 v138, 16, v117
    v_and_b32 v139, s6, v117
    v_fmac_f32 v130, v138, v127
    v_fmac_f32 v131, v139, v127
    v_lshlrev_b32 v136, 16, v118
    v_and_b32 v137, s6, v118
    v_fmac_f32 v132, v136, v127
    v_fmac_f32 v133, v137, v127
    v_lshlrev_b32 v138, 16, v119
    v_and_b32 v139, s6, v119
    v_fmac_f32 v134, v138, v127
    v_fmac_f32 v135, v139, v127
    v_permlane32_swap_b32 v128, v132
    v_permlane32_swap_b32 v129, v133
    v_permlane32_swap_b32 v130, v134
    v_permlane32_swap_b32 v131, v135
    v_add_f32 v128, v128, v132
    v_add_f32 v129, v129, v133
    v_add_f32 v130, v130, v134
    v_add_f32 v131, v131, v135
    s_nop 0
    v_permlane16_swap_b32 v128, v130
    v_permlane16_swap_b32 v129, v131
    v_add_f32 v128, v128, v130
    v_add_f32 v129, v129, v131
    s_nop 0
    v_add_f32_dpp v128, v128, v128 row_ror:8 row_mask:0xf bank_mask:0xf
    v_add_f32_dpp v129, v129, v129 row_ror:8 row_mask:0xf bank_mask:0xf
    s_nop 1
    v_mov_b32_dpp v128, v129 quad_perm:[0,1,2,3] row_mask:0xf bank_mask:0xc
    ds_write_b32 v252, v128 offset:9984
    s_waitcnt lgkmcnt(0)
    s_barrier
    s_add_u32 s96, s84, 13
    s_and_b32 s97, s96, 15
    s_mul_i32 s98, s97, 393216
    s_add_u32 s99, s98, s85
    s_add_u32 s82, s99, 4294772736
    s_add_u32 m0, s83, 4096
    s_nop 0
    buffer_load_dwordx4 v3, s[40:43], s82 offen lds
    s_add_u32 s96, s84, 13
    s_and_b32 s97, s96, 15
    s_mul_i32 s98, s97, 393216
    s_add_u32 s99, s98, s85
    s_add_u32 s82, s99, 2048
    s_add_u32 m0, s83, 8192
    s_nop 0
    buffer_load_dwordx4 v3, s[40:43], s82 offen lds
    s_add_u32 s96, s84, 13
    s_and_b32 s97, s96, 15
    s_mul_i32 s98, s97, 393216
    s_add_u32 s99, s98, s85
    s_add_u32 s82, s99, 4294774784
    s_add_u32 m0, s83, 53248
    s_nop 0
    buffer_load_dwordx4 v3, s[40:43], s82 offen lds
    s_add_u32 s96, s84, 13
    s_and_b32 s97, s96, 15
    s_mul_i32 s98, s97, 393216
    s_add_u32 s99, s98, s85
    s_add_u32 s82, s99, 4096
    s_add_u32 m0, s83, 57344
    s_nop 0
    buffer_load_dwordx4 v3, s[40:43], s82 offen lds
    s_cmp_lg_u32 s3, 4
    s_cbranch_scc1 L_M2F
    ds_read_b128 v[128:131], v251 offset:10000
    s_lshr_b32 s96, s8, 2
    s_lshl1_add_u32 s97, s9, s96
    s_and_b32 s98, s8, 3
    s_lshl2_add_u32 s99, s97, s98
    s_lshl_b32 s96, s99, 9
    s_add_u32 s13, s96, 131072
    s_waitcnt lgkmcnt(0)
    v_add_f32 v128, v128, v129
    v_add_f32 v130, v130, v131
    v_mov_b32 v129, s4
    v_add_f32 v128, v128, v130
    buffer_store_dwordx2 v[128:129], v250, s[32:35], s13 offen sc1
L_M2F:
    s_lshl_b32 s96, s74, 13
    s_sub_u32 s97, s3, 4
    s_lshl_b32 s98, s97, 8
    s_add_u32 s99, s96, s98
    s_add_u32 s13, s99, 20971520
    s_waitcnt lgkmcnt(0)
    s_load_dword s24, s[32:33], s13 offset:1276 glc
    s_load_dword s25, s[32:33], s13 offset:3324 glc
    s_load_dword s26, s[32:33], s13 offset:5372 glc
    s_load_dword s27, s[32:33], s13 offset:7420 glc
    s_waitcnt vmcnt(18)
    s_waitcnt vmcnt(16)
    s_barrier
    s_add_u32 s96, s84, 14
    s_and_b32 s97, s96, 15
    s_mul_i32 s98, s97, 393216
    s_add_u32 s99, s98, s85
    s_add_u32 s82, s99, 4294772736
    s_add_u32 m0, s83, 12288
    s_nop 0
    buffer_load_dwordx4 v3, s[40:43], s82 offen lds
    s_add_u32 s96, s84, 14
    s_and_b32 s97, s96, 15
    s_mul_i32 s98, s97, 393216
    s_add_u32 s99, s98, s85
    s_add_u32 s82, s99, 2048
    s_add_u32 m0, s83, 16384
    s_nop 0
    buffer_load_dwordx4 v3, s[40:43], s82 offen lds
    s_waitcnt vmcnt(16)
    s_waitcnt vmcnt(12)
    s_barrier
    s_add_u32 s96, s84, 15
    s_and_b32 s97, s96, 15
    s_mul_i32 s98, s97, 393216
    s_add_u32 s99, s98, s85
    s_add_u32 s82, s99, 4294772736
    s_add_u32 m0, s83, 20480
    s_nop 0
    buffer_load_dwordx4 v3, s[40:43], s82 offen lds
    s_add_u32 s96, s84, 15
    s_and_b32 s97, s96, 15
    s_mul_i32 s98, s97, 393216
    s_add_u32 s99, s98, s85
    s_add_u32 s82, s99, 2048
    s_add_u32 m0, s83, 24576
    s_nop 0
    buffer_load_dwordx4 v3, s[40:43], s82 offen lds
    s_waitcnt vmcnt(10)
    s_waitcnt vmcnt(6)
    s_waitcnt vmcnt(2)
    s_barrier
    s_add_u32 s96, s84, 14
    s_and_b32 s97, s96, 15
    s_mul_i32 s98, s97, 393216
    s_add_u32 s99, s98, s85
    s_add_u32 s82, s99, 4294774784
    s_add_u32 m0, s83, 61440
    s_nop 0
    buffer_load_dwordx4 v3, s[40:43], s82 offen lds
    s_add_u32 s96, s84, 14
    s_and_b32 s97, s96, 15
    s_mul_i32 s98, s97, 393216
    s_add_u32 s99, s98, s85
    s_add_u32 s82, s99, 4096
    s_add_u32 m0, s83, 65536
    s_nop 0
    buffer_load_dwordx4 v3, s[40:43], s82 offen lds
    s_add_u32 s96, s84, 15
    s_and_b32 s97, s96, 15
    s_mul_i32 s98, s97, 393216
    s_add_u32 s99, s98, s85
    s_add_u32 s82, s99, 4294774784
    s_add_u32 m0, s83, 69632
    s_nop 0
    buffer_load_dwordx4 v3, s[40:43], s82 offen lds
    s_add_u32 s96, s84, 15
    s_and_b32 s97, s96, 15
    s_mul_i32 s98, s97, 393216
    s_add_u32 s99, s98, s85
    s_add_u32 s82, s99, 4096
    s_add_u32 m0, s83, 73728
    s_nop 0
    buffer_load_dwordx4 v3, s[40:43], s82 offen lds
    s_waitcnt vmcnt(4)
    s_barrier
    s_add_u32 s96, s84, 10
    s_and_b32 s97, s96, 15
    s_mul_i32 s98, s97, 393216
    s_add_u32 s99, s98, s85
    s_add_u32 s82, s99, 4294770688
    s_add_u32 m0, s83, 126976
    s_nop 0
    buffer_load_dwordx4 v3, s[40:43], s82 offen lds
    s_add_u32 s96, s84, 10
    s_and_b32 s97, s96, 15
    s_mul_i32 s98, s97, 393216
    s_add_u32 s82, s98, s85
    s_add_u32 m0, s83, 131072
    s_nop 0
    buffer_load_dwordx4 v3, s[40:43], s82 offen lds
    s_add_u32 s96, s84, 11
    s_and_b32 s97, s96, 15
    s_mul_i32 s98, s97, 393216
    s_add_u32 s99, s98, s85
    s_add_u32 s82, s99, 4294770688
    s_add_u32 m0, s83, 135168
    s_nop 0
    buffer_load_dwordx4 v3, s[40:43], s82 offen lds
    s_add_u32 s96, s84, 11
    s_and_b32 s97, s96, 15
    s_mul_i32 s98, s97, 393216
    s_add_u32 s82, s98, s85
    s_add_u32 m0, s83, 139264
    s_nop 0
    buffer_load_dwordx4 v3, s[40:43], s82 offen lds
    s_waitcnt lgkmcnt(0)
    s_barrier
    s_add_u32 s96, s84, 12
    s_and_b32 s97, s96, 15
    s_mul_i32 s98, s97, 393216
    s_add_u32 s99, s98, s85
    s_add_u32 s82, s99, 4294770688
    s_add_u32 m0, s83, 94208
    s_nop 0
    buffer_load_dwordx4 v3, s[40:43], s82 offen lds
    s_add_u32 s96, s84, 12
    s_and_b32 s97, s96, 15
    s_mul_i32 s98, s97, 393216
    s_add_u32 s82, s98, s85
    s_add_u32 m0, s83, 98304
    s_nop 0
    buffer_load_dwordx4 v3, s[40:43], s82 offen lds
    s_add_u32 s96, s84, 13
    s_and_b32 s97, s96, 15
    s_mul_i32 s98, s97, 393216
    s_add_u32 s99, s98, s85
    s_add_u32 s82, s99, 4294770688
    s_add_u32 m0, s83, 102400
    s_nop 0
    buffer_load_dwordx4 v3, s[40:43], s82 offen lds
    s_add_u32 s96, s84, 13
    s_and_b32 s97, s96, 15
    s_mul_i32 s98, s97, 393216
    s_add_u32 s82, s98, s85
    s_add_u32 m0, s83, 106496
    s_nop 0
    buffer_load_dwordx4 v3, s[40:43], s82 offen lds
    s_setprio 3
    ds_read_b128 v[152:155], v0
    ds_read_b128 v[156:159], v0 offset:1024
    v_subrev_u32 v0, 118784, v0
    s_waitcnt lgkmcnt(1)
    v_mfma_f32_32x32x16_bf16 v[184:199], v[168:171], v[152:155], 0
    s_waitcnt lgkmcnt(0)
    v_mfma_f32_32x32x16_bf16 v[184:199], v[172:175], v[156:159], v[184:199]
    s_setprio 0
    s_nop 10
    v_cvt_pk_bf16_f32 v184, 0, v184
    v_cvt_pk_bf16_f32 v185, 0, v185
    v_cvt_pk_bf16_f32 v186, 0, v186
    v_cvt_pk_bf16_f32 v187, 0, v187
    v_cvt_pk_bf16_f32 v188, 0, v188
    v_cvt_pk_bf16_f32 v189, 0, v189
    v_cvt_pk_bf16_f32 v190, 0, v190
    v_cvt_pk_bf16_f32 v191, 0, v191
    v_cvt_pk_bf16_f32 v192, 0, v192
    v_cvt_pk_bf16_f32 v193, 0, v193
    v_cvt_pk_bf16_f32 v194, 0, v194
    v_cvt_pk_bf16_f32 v195, 0, v195
    v_cvt_pk_bf16_f32 v196, 0, v196
    v_cvt_pk_bf16_f32 v197, 0, v197
    v_cvt_pk_bf16_f32 v198, 0, v198
    v_cvt_pk_bf16_f32 v199, 0, v199
    v_max3_f32 v4, v184, v185, v186
    v_min3_f32 v5, v184, v185, v186
    v_max3_f32 v4, v4, v187, v188
    v_min3_f32 v5, v5, v187, v188
    v_max3_f32 v4, v4, v189, v190
    v_min3_f32 v5, v5, v189, v190
    v_max3_f32 v4, v4, v191, v192
    v_min3_f32 v5, v5, v191, v192
    v_max3_f32 v4, v4, v193, v194
    v_min3_f32 v5, v5, v193, v194
    v_max3_f32 v4, v4, v195, v196
    v_min3_f32 v5, v5, v195, v196
    v_max3_f32 v4, v4, v197, v198
    v_min3_f32 v5, v5, v197, v198
    v_max_f32 v6, v4, v199
    v_min_f32 v7, v5, v199
    v_max_f32 v4, v4, v199
    v_min_f32 v5, v5, v199
    s_nop 0
    v_permlane32_swap_b32 v4, v6
    v_permlane32_swap_b32 v5, v7
    v_max_f32 v4, v4, v6
    v_min_f32 v5, v5, v7
    v_mul_f32_e64 v4, v4, s7
    v_mul_f32_e64 v5, v5, s7
    v_fma_f32 v216, v184, s7, -v4
    v_fma_f32 v217, v185, s7, -v4
    v_fma_f32 v184, -v184, s7, v5
    v_fma_f32 v185, -v185, s7, v5
    v_fma_f32 v218, v186, s7, -v4
    v_fma_f32 v219, v187, s7, -v4
    v_fma_f32 v186, -v186, s7, v5
    v_fma_f32 v187, -v187, s7, v5
    s_waitcnt vmcnt(10)
    s_waitcnt vmcnt(8)
    s_waitcnt vmcnt(6)
    s_barrier
    s_add_u32 s96, s84, 14
    s_and_b32 s97, s96, 15
    s_mul_i32 s98, s97, 393216
    s_add_u32 s99, s98, s85
    s_add_u32 s82, s99, 4294770688
    s_add_u32 m0, s83, 110592
    s_nop 0
    buffer_load_dwordx4 v3, s[40:43], s82 offen lds
    s_add_u32 s96, s84, 14
    s_and_b32 s97, s96, 15
    s_mul_i32 s98, s97, 393216
    s_add_u32 s82, s98, s85
    s_add_u32 m0, s83, 114688
    s_nop 0
    buffer_load_dwordx4 v3, s[40:43], s82 offen lds
    s_add_u32 s96, s84, 15
    s_and_b32 s97, s96, 15
    s_mul_i32 s98, s97, 393216
    s_add_u32 s99, s98, s85
    s_add_u32 s82, s99, 4294770688
    s_add_u32 m0, s83, 118784
    s_nop 0
    buffer_load_dwordx4 v3, s[40:43], s82 offen lds
    s_add_u32 s96, s84, 15
    s_and_b32 s97, s96, 15
    s_mul_i32 s98, s97, 393216
    s_add_u32 s82, s98, s85
    s_add_u32 m0, s83, 122880
    s_nop 0
    buffer_load_dwordx4 v3, s[40:43], s82 offen lds
    s_setprio 3
    ds_read_b128 v[152:155], v0
    ds_read_b128 v[156:159], v0 offset:1024
    s_waitcnt lgkmcnt(1)
    v_mfma_f32_32x32x16_bf16 v[200:215], v[176:179], v[152:155], 0
    s_waitcnt lgkmcnt(0)
    v_mfma_f32_32x32x16_bf16 v[200:215], v[180:183], v[156:159], v[200:215]
    s_setprio 0
    v_fma_f32 v220, v188, s7, -v4
    v_fma_f32 v221, v189, s7, -v4
    v_fma_f32 v188, -v188, s7, v5
    v_fma_f32 v189, -v189, s7, v5
    v_fma_f32 v222, v190, s7, -v4
    s_mov_b32 s82, s80
    buffer_load_dwordx4 v[56:59], v27, s[52:55], s82 offen nt
    v_fma_f32 v223, v191, s7, -v4
    v_fma_f32 v190, -v190, s7, v5
    v_fma_f32 v191, -v191, s7, v5
    v_fma_f32 v224, v192, s7, -v4
    v_fma_f32 v225, v193, s7, -v4
    v_fma_f32 v192, -v192, s7, v5
    v_fma_f32 v193, -v193, s7, v5
    v_fma_f32 v226, v194, s7, -v4
    v_fma_f32 v227, v195, s7, -v4
    v_fma_f32 v194, -v194, s7, v5
    v_fma_f32 v195, -v195, s7, v5
    v_fma_f32 v228, v196, s7, -v4
    v_fma_f32 v229, v197, s7, -v4
    v_fma_f32 v196, -v196, s7, v5
    v_fma_f32 v197, -v197, s7, v5
    v_fma_f32 v230, v198, s7, -v4
    v_fma_f32 v231, v199, s7, -v4
    v_fma_f32 v198, -v198, s7, v5
    v_fma_f32 v199, -v199, s7, v5
    v_exp_f32 v216, v216
    s_add_u32 s82, s80, 4294049792
    buffer_load_dwordx4 v[60:63], v27, s[52:55], s82 offen nt
    v_exp_f32 v184, v184
    v_exp_f32 v217, v217
    v_exp_f32 v185, v185
    v_exp_f32 v218, v218
    v_exp_f32 v186, v186
    v_exp_f32 v219, v219
    v_exp_f32 v187, v187
    v_exp_f32 v220, v220
    v_exp_f32 v188, v188
    v_exp_f32 v221, v221
    v_exp_f32 v189, v189
    v_exp_f32 v222, v222
    v_exp_f32 v190, v190
    v_exp_f32 v223, v223
    v_exp_f32 v191, v191
    v_exp_f32 v224, v224
    v_exp_f32 v192, v192
    v_exp_f32 v225, v225
    v_exp_f32 v193, v193
    v_exp_f32 v226, v226
    s_add_u32 s82, s80, 57344
    buffer_load_dwordx4 v[64:67], v27, s[52:55], s82 offen nt
    v_exp_f32 v194, v194
    v_exp_f32 v227, v227
    v_exp_f32 v195, v195
    v_exp_f32 v228, v228
    v_exp_f32 v196, v196
    v_exp_f32 v229, v229
    v_exp_f32 v197, v197
    v_exp_f32 v230, v230
    v_exp_f32 v198, v198
    v_exp_f32 v231, v231
    v_exp_f32 v199, v199
    v_add_f32 v8, v216, v218
    v_add_f32 v9, v217, v219
    v_add_f32 v10, v184, v186
    v_add_f32 v11, v185, v187
    v_add_f32 v8, v8, v220
    v_add_f32 v9, v9, v221
    v_add_f32 v10, v10, v188
    v_add_f32 v11, v11, v189
    v_add_f32 v8, v8, v222
    s_add_u32 s82, s80, 4294107136
    buffer_load_dwordx4 v[68:71], v27, s[52:55], s82 offen nt
    v_add_f32 v9, v9, v223
    v_add_f32 v10, v10, v190
    v_add_f32 v11, v11, v191
    v_add_f32 v8, v8, v224
    v_add_f32 v9, v9, v225
    v_add_f32 v10, v10, v192
    v_add_f32 v11, v11, v193
    v_add_f32 v8, v8, v226
    v_add_f32 v9, v9, v227
    v_add_f32 v10, v10, v194
    v_add_f32 v11, v11, v195
    v_add_f32 v8, v8, v228
    v_add_f32 v9, v9, v229
    v_add_f32 v10, v10, v196
    v_add_f32 v11, v11, v197
    v_add_f32 v8, v8, v230
    v_add_f32 v9, v9, v231
    v_add_f32 v10, v10, v198
    v_add_f32 v11, v11, v199
    v_add_f32 v6, v8, v9
    s_add_u32 s82, s80, 114688
    buffer_load_dwordx4 v[72:75], v27, s[52:55], s82 offen nt
    v_add_f32 v7, v10, v11
    v_add_f32 v4, v8, v9
    v_add_f32 v5, v10, v11
    s_nop 0
    v_permlane32_swap_b32 v4, v6
    v_permlane32_swap_b32 v5, v7
    v_add_f32 v4, v4, v6
    v_add_f32 v5, v5, v7
    v_rcp_f32 v4, v4
    v_rcp_f32 v5, v5
    v_mul_f32 v216, v216, v4
    v_mul_f32 v217, v217, v4
    v_mul_f32 v184, v184, v5
    v_mul_f32 v185, v185, v5
    v_mul_f32 v218, v218, v4
    v_mul_f32 v219, v219, v4
    v_mul_f32 v186, v186, v5
    v_mul_f32 v187, v187, v5
    v_mul_f32 v220, v220, v4
    v_mul_f32 v221, v221, v4
    v_mul_f32 v188, v188, v5
    s_add_u32 s82, s80, 4294164480
    buffer_load_dwordx4 v[76:79], v27, s[52:55], s82 offen nt
    v_mul_f32 v189, v189, v5
    v_mul_f32 v222, v222, v4
    v_mul_f32 v223, v223, v4
    v_mul_f32 v190, v190, v5
    v_mul_f32 v191, v191, v5
    v_mul_f32 v224, v224, v4
    v_mul_f32 v225, v225, v4
    v_mul_f32 v192, v192, v5
    v_mul_f32 v193, v193, v5
    v_mul_f32 v226, v226, v4
    v_mul_f32 v227, v227, v4
    v_mul_f32 v194, v194, v5
    v_mul_f32 v195, v195, v5
    v_mul_f32 v228, v228, v4
    v_mul_f32 v229, v229, v4
    v_mul_f32 v196, v196, v5
    v_mul_f32 v197, v197, v5
    v_mul_f32 v230, v230, v4
    v_mul_f32 v231, v231, v4
    v_mul_f32 v198, v198, v5
    s_add_u32 s82, s80, 172032
    buffer_load_dwordx4 v[80:83], v27, s[52:55], s82 offen nt
    v_mul_f32 v199, v199, v5
    v_cvt_pk_bf16_f32 v216, v216, v217
    v_cvt_pk_bf16_f32 v217, v218, v219
    v_cvt_pk_bf16_f32 v218, v220, v221
    v_cvt_pk_bf16_f32 v219, v222, v223
    v_cvt_pk_bf16_f32 v220, v224, v225
    v_cvt_pk_bf16_f32 v221, v226, v227
    v_cvt_pk_bf16_f32 v222, v228, v229
    v_cvt_pk_bf16_f32 v223, v230, v231
    ds_write_b128 v232, v[216:219]
    v_cvt_pk_bf16_f32 v224, v184, v185
    v_cvt_pk_bf16_f32 v225, v186, v187
    v_cvt_pk_bf16_f32 v226, v188, v189
    v_cvt_pk_bf16_f32 v227, v190, v191
    ds_write_b128 v232, v[220:223] offset:4096
    ds_write_b128 v232, v[224:227] offset:8192
    v_cvt_pk_bf16_f32 v228, v192, v193
    v_cvt_pk_bf16_f32 v229, v194, v195
    v_cvt_pk_bf16_f32 v230, v196, v197
    v_cvt_pk_bf16_f32 v231, v198, v199
    s_add_u32 s82, s80, 4294221824
    buffer_load_dwordx4 v[84:87], v27, s[52:55], s82 offen nt
    ds_write_b128 v232, v[228:231] offset:12288
    s_waitcnt vmcnt(16)
    s_waitcnt vmcnt(14)
    s_waitcnt vmcnt(12)
    s_waitcnt vmcnt(10)
    s_waitcnt vmcnt(8)
    s_barrier
    v_cvt_pk_bf16_f32 v200, 0, v200
    v_cvt_pk_bf16_f32 v201, 0, v201
    v_cvt_pk_bf16_f32 v202, 0, v202
    v_cvt_pk_bf16_f32 v203, 0, v203
    s_xor_b32 s96, s95, 786432
    s_add_u32 s97, s96, s90
    s_sub_u32 s82, s97, 65536
L_PAD6:
    s_cbranch_execz L_RET6
    s_add_u32 m0, s83, 45056
    s_nop 0
    buffer_load_dwordx4 v26, s[44:47], s82 offen lds
    v_cvt_pk_bf16_f32 v204, 0, v204
    v_cvt_pk_bf16_f32 v205, 0, v205
    v_cvt_pk_bf16_f32 v206, 0, v206
    v_cvt_pk_bf16_f32 v207, 0, v207
    v_cvt_pk_bf16_f32 v208, 0, v208
    v_cvt_pk_bf16_f32 v209, 0, v209
    v_cvt_pk_bf16_f32 v210, 0, v210
    v_cvt_pk_bf16_f32 v211, 0, v211
    v_cvt_pk_bf16_f32 v212, 0, v212
    v_cvt_pk_bf16_f32 v213, 0, v213
    v_cvt_pk_bf16_f32 v214, 0, v214
    v_cvt_pk_bf16_f32 v215, 0, v215
    v_max3_f32 v4, v200, v201, v202
    v_min3_f32 v5, v200, v201, v202
    s_xor_b32 s96, s95, 786432
    s_add_u32 s82, s96, s90
    s_add_u32 m0, s83, 49152
    s_nop 0
    buffer_load_dwordx4 v26, s[44:47], s82 offen lds
    v_max3_f32 v4, v4, v203, v204
    v_min3_f32 v5, v5, v203, v204
    v_max3_f32 v4, v4, v205, v206
    v_min3_f32 v5, v5, v205, v206
    v_max3_f32 v4, v4, v207, v208
    v_min3_f32 v5, v5, v207, v208
    v_max3_f32 v4, v4, v209, v210
    v_min3_f32 v5, v5, v209, v210
    v_max3_f32 v4, v4, v211, v212
    v_min3_f32 v5, v5, v211, v212
    v_max3_f32 v4, v4, v213, v214
    v_min3_f32 v5, v5, v213, v214
    v_max_f32 v6, v4, v215
    v_min_f32 v7, v5, v215
    s_xor_b32 s96, s95, 917504
    s_add_u32 s97, s96, s90
    s_sub_u32 s82, s97, 65536
    s_add_u32 m0, s83, 53248
    s_nop 0
    buffer_load_dwordx4 v26, s[44:47], s82 offen lds
    v_max_f32 v4, v4, v215
    s_waitcnt lgkmcnt(0)
    v_min_f32 v5, v5, v215
    v_permlane32_swap_b32 v4, v6
    s_nop 0
    v_permlane32_swap_b32 v5, v7
    v_max_f32 v4, v4, v6
    v_min_f32 v5, v5, v7
    v_mul_f32_e64 v4, v4, s7
    v_mul_f32_e64 v5, v5, s7
    v_fma_f32 v216, v200, s7, -v4
    v_fma_f32 v217, v201, s7, -v4
    v_fma_f32 v200, -v200, s7, v5
    v_fma_f32 v201, -v201, s7, v5
    v_fma_f32 v218, v202, s7, -v4
    s_xor_b32 s96, s95, 917504
    s_add_u32 s82, s96, s90
    s_add_u32 m0, s83, 57344
    s_nop 0
    buffer_load_dwordx4 v26, s[44:47], s82 offen lds
    v_fma_f32 v219, v203, s7, -v4
    v_fma_f32 v202, -v202, s7, v5
    v_fma_f32 v203, -v203, s7, v5
    v_fma_f32 v220, v204, s7, -v4
    v_fma_f32 v221, v205, s7, -v4
    v_fma_f32 v204, -v204, s7, v5
    v_fma_f32 v205, -v205, s7, v5
    v_fma_f32 v222, v206, s7, -v4
    v_fma_f32 v223, v207, s7, -v4
    v_fma_f32 v206, -v206, s7, v5
    v_fma_f32 v207, -v207, s7, v5
    v_fma_f32 v224, v208, s7, -v4
    v_fma_f32 v225, v209, s7, -v4
    v_fma_f32 v208, -v208, s7, v5
    s_xor_b32 s96, s95, 1048576
    s_add_u32 s97, s96, s90
    s_sub_u32 s82, s97, 65536
    s_add_u32 m0, s83, 61440
    s_nop 0
    buffer_load_dwordx4 v26, s[44:47], s82 offen lds
    v_fma_f32 v209, -v209, s7, v5
    v_fma_f32 v226, v210, s7, -v4
    v_fma_f32 v227, v211, s7, -v4
    v_fma_f32 v210, -v210, s7, v5
    v_fma_f32 v211, -v211, s7, v5
    v_fma_f32 v228, v212, s7, -v4
    v_fma_f32 v229, v213, s7, -v4
    v_fma_f32 v212, -v212, s7, v5
    v_fma_f32 v213, -v213, s7, v5
    v_fma_f32 v230, v214, s7, -v4
    v_fma_f32 v231, v215, s7, -v4
    v_fma_f32 v214, -v214, s7, v5
    v_fma_f32 v215, -v215, s7, v5
    v_exp_f32 v216, v216
    s_xor_b32 s96, s95, 1048576
    s_add_u32 s82, s96, s90
    s_add_u32 m0, s83, 65536
    s_nop 0
    buffer_load_dwordx4 v26, s[44:47], s82 offen lds
    v_exp_f32 v200, v200
    v_exp_f32 v217, v217
    v_exp_f32 v201, v201
    v_exp_f32 v218, v218
    v_exp_f32 v202, v202
    v_exp_f32 v219, v219
    v_exp_f32 v203, v203
    v_exp_f32 v220, v220
    v_exp_f32 v204, v204
    v_exp_f32 v221, v221
    v_exp_f32 v205, v205
    v_exp_f32 v222, v222
    v_exp_f32 v206, v206
    v_exp_f32 v223, v223
    s_xor_b32 s96, s95, 1179648
    s_add_u32 s97, s96, s90
    s_sub_u32 s82, s97, 65536
    s_add_u32 m0, s83, 69632
    s_nop 0
    buffer_load_dwordx4 v26, s[44:47], s82 offen lds
    v_exp_f32 v207, v207
    v_exp_f32 v224, v224
    v_exp_f32 v208, v208
    v_exp_f32 v225, v225
    v_exp_f32 v209, v209
    v_exp_f32 v226, v226
    v_exp_f32 v210, v210
    v_exp_f32 v227, v227
    v_exp_f32 v211, v211
    v_exp_f32 v228, v228
    v_exp_f32 v212, v212
    v_exp_f32 v229, v229
    v_exp_f32 v213, v213
    v_exp_f32 v230, v230
    s_xor_b32 s96, s95, 1179648
    s_add_u32 s82, s96, s90
    s_add_u32 m0, s83, 73728
    s_nop 0
    buffer_load_dwordx4 v26, s[44:47], s82 offen lds
    v_exp_f32 v214, v214
    v_exp_f32 v231, v231
    v_exp_f32 v215, v215
    v_add_f32 v8, v216, v218
    v_add_f32 v9, v217, v219
    v_add_f32 v10, v200, v202
    v_add_f32 v11, v201, v203
    v_add_f32 v8, v8, v220
    v_add_f32 v9, v9, v221
    v_add_f32 v10, v10, v204
    v_add_f32 v11, v11, v205
    v_add_f32 v8, v8, v222
    v_add_f32 v9, v9, v223
    v_add_f32 v10, v10, v206
    s_xor_b32 s96, s95, 1310720
    s_add_u32 s97, s96, s90
    s_sub_u32 s82, s97, 65536
    s_add_u32 m0, s83, 77824
    s_nop 0
    buffer_load_dwordx4 v26, s[44:47], s82 offen lds
    v_add_f32 v11, v11, v207
    v_add_f32 v8, v8, v224
    v_add_f32 v9, v9, v225
    v_add_f32 v10, v10, v208
    v_add_f32 v11, v11, v209
    v_add_f32 v8, v8, v226
    v_add_f32 v9, v9, v227
    v_add_f32 v10, v10, v210
    v_add_f32 v11, v11, v211
    v_add_f32 v8, v8, v228
    v_add_f32 v9, v9, v229
    v_add_f32 v10, v10, v212
    v_add_f32 v11, v11, v213
    v_add_f32 v8, v8, v230
    s_xor_b32 s96, s95, 1310720
    s_add_u32 s82, s96, s90
    s_add_u32 m0, s83, 81920
    s_nop 0
    buffer_load_dwordx4 v26, s[44:47], s82 offen lds
    v_add_f32 v9, v9, v231
    v_add_f32 v10, v10, v214
    v_add_f32 v11, v11, v215
    v_add_f32 v6, v8, v9
    v_add_f32 v7, v10, v11
    v_add_f32 v4, v8, v9
    v_add_f32 v5, v10, v11
    s_nop 0
    v_permlane32_swap_b32 v4, v6
    v_permlane32_swap_b32 v5, v7
    v_add_f32 v4, v4, v6
    v_add_f32 v5, v5, v7
    v_rcp_f32 v4, v4
    v_rcp_f32 v5, v5
    v_mul_f32 v216, v216, v4
    s_xor_b32 s96, s95, 1441792
    s_add_u32 s97, s96, s90
    s_sub_u32 s82, s97, 65536
    s_add_u32 m0, s83, 86016
    s_nop 0
    buffer_load_dwordx4 v26, s[44:47], s82 offen lds
    v_mul_f32 v217, v217, v4
    v_mul_f32 v200, v200, v5
    v_mul_f32 v201, v201, v5
    v_mul_f32 v218, v218, v4
    v_mul_f32 v219, v219, v4
    v_mul_f32 v202, v202, v5
    v_mul_f32 v203, v203, v5
    v_mul_f32 v220, v220, v4
    v_mul_f32 v221, v221, v4
    v_mul_f32 v204, v204, v5
    v_mul_f32 v205, v205, v5
    v_mul_f32 v222, v222, v4
    v_mul_f32 v223, v223, v4
    v_mul_f32 v206, v206, v5
    s_xor_b32 s96, s95, 1441792
    s_add_u32 s82, s96, s90
    s_add_u32 m0, s83, 90112
    s_nop 0
    buffer_load_dwordx4 v26, s[44:47], s82 offen lds
    v_mul_f32 v207, v207, v5
    v_mul_f32 v224, v224, v4
    v_mul_f32 v225, v225, v4
    v_mul_f32 v208, v208, v5
    v_mul_f32 v209, v209, v5
    v_mul_f32 v226, v226, v4
    v_mul_f32 v227, v227, v4
    v_mul_f32 v210, v210, v5
    v_mul_f32 v211, v211, v5
    v_mul_f32 v228, v228, v4
    v_mul_f32 v229, v229, v4
    v_mul_f32 v212, v212, v5
    v_mul_f32 v213, v213, v5
    v_mul_f32 v230, v230, v4
    v_mul_f32 v231, v231, v4
    v_mul_f32 v214, v214, v5
    v_mul_f32 v215, v215, v5
    v_cvt_pk_bf16_f32 v216, v216, v217
    v_cvt_pk_bf16_f32 v217, v218, v219
    v_cvt_pk_bf16_f32 v218, v220, v221
    v_cvt_pk_bf16_f32 v219, v222, v223
    v_cvt_pk_bf16_f32 v220, v224, v225
    v_cvt_pk_bf16_f32 v221, v226, v227
    v_cvt_pk_bf16_f32 v222, v228, v229
    v_cvt_pk_bf16_f32 v223, v230, v231
    ds_write_b128 v232, v[216:219] offset:16384
    v_cvt_pk_bf16_f32 v224, v200, v201
    v_cvt_pk_bf16_f32 v225, v202, v203
    v_cvt_pk_bf16_f32 v226, v204, v205
    v_cvt_pk_bf16_f32 v227, v206, v207
    ds_write_b128 v232, v[220:223] offset:20480
    ds_write_b128 v232, v[224:227] offset:24576
    v_cvt_pk_bf16_f32 v228, v208, v209
    v_cvt_pk_bf16_f32 v229, v210, v211
    v_cvt_pk_bf16_f32 v230, v212, v213
    v_cvt_pk_bf16_f32 v231, v214, v215
    ds_write_b128 v232, v[228:231] offset:28672
    s_lshl_b32 s96, s77, 11
    s_add_u32 s14, s96, 151552
    v_add_u32 v0, s14, v2
    s_setprio 0
L_JOIN:
    v_and_b32 v45, 1, v1
    v_lshlrev_b32 v45, 3, v45
    v_bfe_u32 v9, v1, 2, 2
    v_lshl_add_u32 v45, v9, 4, v45
    v_bfe_u32 v9, v1, 4, 1
    v_lshl_add_u32 v45, v9, 6, v45
    v_bfe_u32 v9, v1, 1, 1
    v_lshl_add_u32 v45, v9, 7, v45
    v_lshrrev_b32 v9, 5, v1
    v_lshl_add_u32 v45, v9, 8, v45
    s_lshl_b32 s13, s3, 12
    v_add_u32 v44, s13, v45
    s_lshl_b32 s96, s76, 13
    s_add_u32 s13, s96, 32768
    v_add_u32 v45, s13, v45
    v_mov_b32 v244, 0x3f803f80
    v_mov_b32 v245, 0x3f803f80
    v_mov_b32 v246, 0x3f803f80
    v_mov_b32 v247, 0x3f803f80
    s_lshl3_add_u32 s96, s11, s3
    s_lshl_b32 s97, s96, 5
    s_add_u32 s98, s97, s10
    s_lshl_b32 s99, s98, 10
    s_add_u32 s13, s99, 25165824
    s_add_u32 s15, s13, 16384
    s_lshl3_add_u32 s96, s11, s3
    s_lshl_b32 s97, s96, 10
    s_add_u32 s16, s97, 21495808
    s_lshl_b32 s96, s10, 6
    s_add_u32 s14, s96, s16
    s_waitcnt lgkmcnt(0)
    s_barrier
    ds_read_b64_tr_b16 v[184:185], v44
    ds_read_b64_tr_b16 v[186:187], v44 offset:512
    ds_read_b64_tr_b16 v[200:201], v45
    ds_read_b64_tr_b16 v[202:203], v45 offset:512
    ds_read_b64_tr_b16 v[204:205], v45 offset:1024
    ds_read_b64_tr_b16 v[206:207], v45 offset:1536
    ds_read_b64_tr_b16 v[188:189], v44 offset:1024
    ds_read_b64_tr_b16 v[190:191], v44 offset:1536
    ds_read_b64_tr_b16 v[208:209], v45 offset:2048
    ds_read_b64_tr_b16 v[210:211], v45 offset:2560
    ds_read_b64_tr_b16 v[212:213], v45 offset:3072
    ds_read_b64_tr_b16 v[214:215], v45 offset:3584
    ds_read_b64_tr_b16 v[192:193], v44 offset:2048
    ds_read_b64_tr_b16 v[194:195], v44 offset:2560
    ds_read_b64_tr_b16 v[216:217], v45 offset:4096
    ds_read_b64_tr_b16 v[218:219], v45 offset:4608
    ds_read_b64_tr_b16 v[220:221], v45 offset:5120
    ds_read_b64_tr_b16 v[222:223], v45 offset:5632
    s_waitcnt lgkmcnt(12)
    v_mfma_f32_16x16x32_bf16 v[232:235], v[184:187], v[200:203], 0
    v_mfma_f32_16x16x32_bf16 v[236:239], v[184:187], v[204:207], 0
    v_mfma_f32_16x16x32_bf16 v[240:243], v[184:187], v[244:247], 0
    ds_read_b64_tr_b16 v[196:197], v44 offset:3072
    ds_read_b64_tr_b16 v[198:199], v44 offset:3584
    ds_read_b64_tr_b16 v[224:225], v45 offset:6144
    ds_read_b64_tr_b16 v[226:227], v45 offset:6656
    ds_read_b64_tr_b16 v[228:229], v45 offset:7168
    ds_read_b64_tr_b16 v[230:231], v45 offset:7680
    s_waitcnt lgkmcnt(12)
    v_mfma_f32_16x16x32_bf16 v[232:235], v[188:191], v[208:211], v[232:235]
    v_mfma_f32_16x16x32_bf16 v[236:239], v[188:191], v[212:215], v[236:239]
    v_mfma_f32_16x16x32_bf16 v[240:243], v[188:191], v[244:247], v[240:243]
    s_waitcnt lgkmcnt(6)
    v_mfma_f32_16x16x32_bf16 v[232:235], v[192:195], v[216:219], v[232:235]
    v_mfma_f32_16x16x32_bf16 v[236:239], v[192:195], v[220:223], v[236:239]
    v_mfma_f32_16x16x32_bf16 v[240:243], v[192:195], v[244:247], v[240:243]
    s_waitcnt lgkmcnt(0)
    v_mfma_f32_16x16x32_bf16 v[232:235], v[196:199], v[224:227], v[232:235]
    v_mfma_f32_16x16x32_bf16 v[236:239], v[196:199], v[228:231], v[236:239]
    v_mfma_f32_16x16x32_bf16 v[240:243], v[196:199], v[244:247], v[240:243]
    s_cmp_lt_u32 s3, 4
    s_cbranch_scc1 L_NOQX
    ds_read_b128 v[168:171], v0
    ds_read_b128 v[172:175], v0 offset:1024
L_NOQX:
    s_nop 3
    buffer_store_dwordx4 v[232:235], v2, s[32:35], s13 offen sc1
    buffer_store_dwordx4 v[236:239], v2, s[32:35], s15 offen sc1
    s_mov_b32 exec_lo, 0x00010001
    s_mov_b32 exec_hi, 0x00010001
    buffer_store_dwordx4 v[240:243], v1, s[32:35], s14 offen sc1
    s_mov_b64 exec, -1
    s_waitcnt lgkmcnt(0)
    v_mfma_f32_32x32x16_bf16 v[120:135], v[176:179], v[168:171], 0
    v_mfma_f32_32x32x16_bf16 v[120:135], v[180:183], v[172:175], v[120:135]
    v_and_b32 v46, 7, v1
    v_lshlrev_b32 v46, 17, v46
    v_bfe_u32 v9, v1, 3, 1
    v_lshl_add_u32 v46, v9, 14, v46
    s_and_b32 s96, s10, 1
    s_and_b32 s97, s2, 27
    s_lshl_b32 s98, s97, 12
    s_lshr_b32 s99, s10, 1
    s_lshl_b32 s97, s99, 6
    s_add_u32 s99, s98, s97
    s_lshl2_add_u32 s98, s96, s99
    s_add_u32 s97, s98, 1048576
    s_add_u32 s17, s97, 512
    v_lshrrev_b32 v47, 3, v1
    v_lshlrev_b32 v47, 10, v47
    v_and_b32 v9, 7, v1
    v_lshl_add_u32 v47, v9, 4, v47
    v_and_b32 v48, 7, v1
    v_lshlrev_b32 v48, 4, v48
    v_lshrrev_b32 v9, 5, v1
    v_lshl_add_u32 v48, v9, 3, v48
    v_cvt_pk_bf16_f32 v120, 0, v120
    v_cvt_pk_bf16_f32 v121, 0, v121
    v_cvt_pk_bf16_f32 v122, 0, v122
    v_cvt_pk_bf16_f32 v123, 0, v123
    v_cvt_pk_bf16_f32 v124, 0, v124
    v_cvt_pk_bf16_f32 v125, 0, v125
    v_cvt_pk_bf16_f32 v126, 0, v126
    v_cvt_pk_bf16_f32 v127, 0, v127
    v_cvt_pk_bf16_f32 v128, 0, v128
    v_cvt_pk_bf16_f32 v129, 0, v129
    v_cvt_pk_bf16_f32 v130, 0, v130
    v_cvt_pk_bf16_f32 v131, 0, v131
    v_cvt_pk_bf16_f32 v132, 0, v132
    v_cvt_pk_bf16_f32 v133, 0, v133
    v_cvt_pk_bf16_f32 v134, 0, v134
    v_cvt_pk_bf16_f32 v135, 0, v135
    v_max3_f32 v4, v120, v121, v122
    v_min3_f32 v5, v120, v121, v122
    v_max3_f32 v4, v4, v123, v124
    v_min3_f32 v5, v5, v123, v124
    v_max3_f32 v4, v4, v125, v126
    v_min3_f32 v5, v5, v125, v126
    v_max3_f32 v4, v4, v127, v128
    v_min3_f32 v5, v5, v127, v128
    v_max3_f32 v4, v4, v129, v130
    v_min3_f32 v5, v5, v129, v130
    v_max3_f32 v4, v4, v131, v132
    v_min3_f32 v5, v5, v131, v132
    v_max3_f32 v4, v4, v133, v134
    v_min3_f32 v5, v5, v133, v134
    v_max_f32 v6, v4, v135
    v_min_f32 v7, v5, v135
    v_max_f32 v4, v4, v135
    v_min_f32 v5, v5, v135
    s_nop 0
    v_permlane32_swap_b32 v4, v6
    v_permlane32_swap_b32 v5, v7
    v_max_f32 v4, v4, v6
    v_min_f32 v5, v5, v7
    v_pk_mul_f32 v[4:5], v[4:5], s[6:7] op_sel:[0,1]
    v_pk_fma_f32 v[136:137], v[120:121], s[6:7], v[4:5] op_sel:[0,1,0] op_sel_hi:[1,1,0] neg_lo:[0,0,1] neg_hi:[0,0,1]
    v_pk_fma_f32 v[120:121], v[120:121], s[6:7], v[4:5] op_sel:[0,1,1] neg_lo:[1,0,0] neg_hi:[1,0,0]
    v_pk_fma_f32 v[138:139], v[122:123], s[6:7], v[4:5] op_sel:[0,1,0] op_sel_hi:[1,1,0] neg_lo:[0,0,1] neg_hi:[0,0,1]
    v_pk_fma_f32 v[122:123], v[122:123], s[6:7], v[4:5] op_sel:[0,1,1] neg_lo:[1,0,0] neg_hi:[1,0,0]
    v_pk_fma_f32 v[140:141], v[124:125], s[6:7], v[4:5] op_sel:[0,1,0] op_sel_hi:[1,1,0] neg_lo:[0,0,1] neg_hi:[0,0,1]
    v_pk_fma_f32 v[124:125], v[124:125], s[6:7], v[4:5] op_sel:[0,1,1] neg_lo:[1,0,0] neg_hi:[1,0,0]
    v_pk_fma_f32 v[142:143], v[126:127], s[6:7], v[4:5] op_sel:[0,1,0] op_sel_hi:[1,1,0] neg_lo:[0,0,1] neg_hi:[0,0,1]
    v_pk_fma_f32 v[126:127], v[126:127], s[6:7], v[4:5] op_sel:[0,1,1] neg_lo:[1,0,0] neg_hi:[1,0,0]
    v_pk_fma_f32 v[144:145], v[128:129], s[6:7], v[4:5] op_sel:[0,1,0] op_sel_hi:[1,1,0] neg_lo:[0,0,1] neg_hi:[0,0,1]
    v_pk_fma_f32 v[128:129], v[128:129], s[6:7], v[4:5] op_sel:[0,1,1] neg_lo:[1,0,0] neg_hi:[1,0,0]
    v_pk_fma_f32 v[146:147], v[130:131], s[6:7], v[4:5] op_sel:[0,1,0] op_sel_hi:[1,1,0] neg_lo:[0,0,1] neg_hi:[0,0,1]
    v_pk_fma_f32 v[130:131], v[130:131], s[6:7], v[4:5] op_sel:[0,1,1] neg_lo:[1,0,0] neg_hi:[1,0,0]
    v_pk_fma_f32 v[148:149], v[132:133], s[6:7], v[4:5] op_sel:[0,1,0] op_sel_hi:[1,1,0] neg_lo:[0,0,1] neg_hi:[0,0,1]
    v_pk_fma_f32 v[132:133], v[132:133], s[6:7], v[4:5] op_sel:[0,1,1] neg_lo:[1,0,0] neg_hi:[1,0,0]
    v_pk_fma_f32 v[150:151], v[134:135], s[6:7], v[4:5] op_sel:[0,1,0] op_sel_hi:[1,1,0] neg_lo:[0,0,1] neg_hi:[0,0,1]
    v_pk_fma_f32 v[134:135], v[134:135], s[6:7], v[4:5] op_sel:[0,1,1] neg_lo:[1,0,0] neg_hi:[1,0,0]
    v_exp_f32 v136, v136
    v_exp_f32 v120, v120
    v_exp_f32 v137, v137
    v_exp_f32 v121, v121
    v_exp_f32 v138, v138
    v_exp_f32 v122, v122
    v_exp_f32 v139, v139
    v_exp_f32 v123, v123
    v_exp_f32 v140, v140
    v_exp_f32 v124, v124
    v_exp_f32 v141, v141
    v_exp_f32 v125, v125
    v_exp_f32 v142, v142
    v_exp_f32 v126, v126
    v_exp_f32 v143, v143
    v_exp_f32 v127, v127
    s_waitcnt vmcnt(0)
    s_barrier
    s_cmp_lg_u32 s3, 0
    s_cbranch_scc1 L_PC
    v_mov_b32 v45, s4
    s_mov_b32 exec_hi, 0
    s_mov_b32 exec_lo, 65535
    buffer_store_dword v45, v46, s[32:35], s17 offen sc1
    s_mov_b64 exec, -1
L_PC:
    s_xor_b32 s96, s95, 1572864
    s_add_u32 s82, s96, s90
    s_add_u32 m0, s83, 98304
    s_nop 0
    buffer_load_dwordx4 v26, s[44:47], s82 offen lds
    v_exp_f32 v144, v144
    v_exp_f32 v128, v128
    v_exp_f32 v145, v145
    v_exp_f32 v129, v129
    v_exp_f32 v146, v146
    v_exp_f32 v130, v130
    v_exp_f32 v147, v147
    v_exp_f32 v131, v131
    s_xor_b32 s96, s95, 1703936
    s_add_u32 s82, s96, s90
    s_add_u32 m0, s83, 106496
    s_nop 0
    buffer_load_dwordx4 v26, s[44:47], s82 offen lds
    v_exp_f32 v148, v148
    v_exp_f32 v132, v132
    v_exp_f32 v149, v149
    v_exp_f32 v133, v133
    v_exp_f32 v150, v150
    v_exp_f32 v134, v134
    v_exp_f32 v151, v151
    v_exp_f32 v135, v135
    s_lshl4_add_u32 s96, s11, s10
    s_lshl_b32 s97, s96, 14
    s_lshl_b32 s98, s3, 7
    s_add_u32 s99, s97, s98
    s_add_u32 s13, s99, 25165824
    s_add_u32 s14, s13, 8192
    s_lshl4_add_u32 s96, s11, s10
    s_lshl_b32 s97, s96, 10
    s_lshl_b32 s98, s3, 7
    s_add_u32 s99, s97, s98
    s_add_u32 s15, s99, 29360128
    s_add_u32 s17, s17, 3072
    s_load_dwordx2 s[24:25], s[32:33], s92 offset:512 glc
    s_xor_b32 s96, s95, 1835008
    s_add_u32 s82, s96, s90
    s_add_u32 m0, s83, 114688
    s_nop 0
    buffer_load_dwordx4 v26, s[44:47], s82 offen lds
    v_pk_add_f32 v[8:9], v[136:137], v[138:139]
    v_pk_add_f32 v[10:11], v[120:121], v[122:123]
    v_pk_add_f32 v[8:9], v[8:9], v[140:141]
    v_pk_add_f32 v[10:11], v[10:11], v[124:125]
    v_pk_add_f32 v[8:9], v[8:9], v[142:143]
    v_pk_add_f32 v[10:11], v[10:11], v[126:127]
    v_pk_add_f32 v[8:9], v[8:9], v[144:145]
    v_pk_add_f32 v[10:11], v[10:11], v[128:129]
    v_pk_add_f32 v[8:9], v[8:9], v[146:147]
    v_pk_add_f32 v[10:11], v[10:11], v[130:131]
    v_pk_add_f32 v[8:9], v[8:9], v[148:149]
    v_pk_add_f32 v[10:11], v[10:11], v[132:133]
    v_pk_add_f32 v[8:9], v[8:9], v[150:151]
    v_pk_add_f32 v[10:11], v[10:11], v[134:135]
    s_xor_b32 s96, s95, 1966080
    s_add_u32 s82, s96, s90
    s_add_u32 m0, s83, 122880
    s_nop 0
    buffer_load_dwordx4 v26, s[44:47], s82 offen lds
    v_add_f32 v6, v8, v9
    v_add_f32 v7, v10, v11
    v_add_f32 v4, v8, v9
    v_add_f32 v5, v10, v11
    s_nop 0
    v_permlane32_swap_b32 v4, v6
    v_permlane32_swap_b32 v5, v7
    v_pk_add_f32 v[4:5], v[4:5], v[6:7]
    v_rcp_f32 v4, v4
    v_rcp_f32 v5, v5
    s_nop 0
    v_pk_mul_f32 v[136:137], v[136:137], v[4:5] op_sel_hi:[1,0]
    v_pk_mul_f32 v[120:121], v[120:121], v[4:5] op_sel:[0,1]
    v_pk_mul_f32 v[138:139], v[138:139], v[4:5] op_sel_hi:[1,0]
    v_pk_mul_f32 v[122:123], v[122:123], v[4:5] op_sel:[0,1]
    v_pk_mul_f32 v[140:141], v[140:141], v[4:5] op_sel_hi:[1,0]
    s_add_u32 s82, s95, s90
    s_mov_b32 m0, s83
    s_nop 0
    buffer_load_dwordx4 v26, s[44:47], s82 offen lds
    v_pk_mul_f32 v[124:125], v[124:125], v[4:5] op_sel:[0,1]
    v_pk_mul_f32 v[142:143], v[142:143], v[4:5] op_sel_hi:[1,0]
    v_pk_mul_f32 v[126:127], v[126:127], v[4:5] op_sel:[0,1]
    v_pk_mul_f32 v[144:145], v[144:145], v[4:5] op_sel_hi:[1,0]
    v_pk_mul_f32 v[128:129], v[128:129], v[4:5] op_sel:[0,1]
    v_pk_mul_f32 v[146:147], v[146:147], v[4:5] op_sel_hi:[1,0]
    v_pk_mul_f32 v[130:131], v[130:131], v[4:5] op_sel:[0,1]
    v_pk_mul_f32 v[148:149], v[148:149], v[4:5] op_sel_hi:[1,0]
    v_pk_mul_f32 v[132:133], v[132:133], v[4:5] op_sel:[0,1]
    v_pk_mul_f32 v[150:151], v[150:151], v[4:5] op_sel_hi:[1,0]
    v_pk_mul_f32 v[134:135], v[134:135], v[4:5] op_sel:[0,1]
    v_cvt_pk_bf16_f32 v152, v136, v137
    v_cvt_pk_bf16_f32 v153, v138, v139
    v_cvt_pk_bf16_f32 v154, v140, v141
    s_xor_b32 s96, s95, 131072
    s_add_u32 s82, s96, s90
    s_add_u32 m0, s83, 8192
    s_nop 0
    buffer_load_dwordx4 v26, s[44:47], s82 offen lds
    v_cvt_pk_bf16_f32 v155, v142, v143
    v_cvt_pk_bf16_f32 v156, v144, v145
    v_cvt_pk_bf16_f32 v157, v146, v147
    v_cvt_pk_bf16_f32 v158, v148, v149
    v_cvt_pk_bf16_f32 v159, v150, v151
    v_cvt_pk_bf16_f32 v160, v120, v121
    v_cvt_pk_bf16_f32 v161, v122, v123
    v_cvt_pk_bf16_f32 v162, v124, v125
    v_cvt_pk_bf16_f32 v163, v126, v127
    v_cvt_pk_bf16_f32 v164, v128, v129
    v_cvt_pk_bf16_f32 v165, v130, v131
    v_cvt_pk_bf16_f32 v166, v132, v133
    v_cvt_pk_bf16_f32 v167, v134, v135
    s_branch SCHK_17
SPOLL_16:
    s_load_dwordx2 s[24:25], s[32:33], s92 offset:512 glc
SCHK_17:
    s_add_u32 s5, s5, 1
    s_cmp_ge_u32 s5, 200000
    s_waitcnt lgkmcnt(0)
    s_cbranch_scc1 SDONE_18
    s_cmp_lg_u32 s24, s4
    s_cbranch_scc1 SPOLL_16
    s_cmp_lg_u32 s25, s4
    s_cbranch_scc1 SPOLL_16
SDONE_18:
    s_barrier
    buffer_load_dwordx4 v[184:187], v47, s[32:35], s13 offen sc1
    buffer_load_dwordx4 v[188:191], v47, s[32:35], s14 offen sc1
    buffer_load_dwordx4 v[192:195], v2, s[32:35], s16 offen sc1
    s_lshl_b32 s96, s3, 5
    s_add_u32 s14, s96, 155648
    v_and_b32 v6, 3, v1
    v_lshl_add_u32 v6, v6, 3, s14
    v_lshrrev_b32 v9, 5, v1
    v_lshl_add_u32 v6, v9, 2, v6
    s_lshl_b32 s96, s3, 10
    s_add_u32 s14, s96, 147456
    v_and_b32 v5, 15, v1
    v_lshl_add_u32 v5, v5, 4, s14
    v_lshrrev_b32 v9, 5, v1
    v_lshl_add_u32 v5, v9, 9, v5
    v_bfe_u32 v9, v1, 4, 1
    v_lshl_add_u32 v5, v9, 3, v5
    s_lshl_b32 s96, s76, 7
    s_add_u32 s14, s96, 155648
    v_lshrrev_b32 v7, 5, v1
    v_lshl_add_u32 v7, v7, 4, s14
    s_lshl_b32 s96, s76, 12
    s_add_u32 s14, s96, 147456
    v_add_u32 v44, s14, v2
    s_waitcnt vmcnt(1)
    v_pk_add_f32 v[184:185], v[184:185], v[188:189]
    v_pk_add_f32 v[186:187], v[186:187], v[190:191]
    s_nop 1
    v_permlane32_swap_b32 v184, v186
    v_permlane32_swap_b32 v185, v187
    v_pk_add_f32 v[184:185], v[184:185], v[186:187]
    s_nop 1
    v_add_f32_dpp v184, v184, v184 row_ror:8 row_mask:0xf bank_mask:0xf
    v_add_f32_dpp v185, v185, v185 row_ror:8 row_mask:0xf bank_mask:0xf
    v_mov_b32 v186, v184
    v_mov_b32 v187, v185
    s_nop 0
    v_permlane16_swap_b32 v184, v186
    v_permlane16_swap_b32 v185, v187
    v_pk_add_f32 v[184:185], v[184:185], v[186:187]
    v_cvt_pk_bf16_f32 v184, v184, v185
    v_mov_b32 v185, s4
    s_mov_b32 exec_lo, 0xff
    s_mov_b32 exec_hi, 0xff
    buffer_store_dwordx2 v[184:185], v48, s[32:35], s15 offen sc1
    s_mov_b64 exec, -1
    s_barrier
    s_cmp_lg_u32 s3, 0
    s_cbranch_scc1 L_PC2
    v_mov_b32 v45, s4
    s_mov_b32 exec_hi, 0
    s_mov_b32 exec_lo, 65535
    buffer_store_dword v45, v46, s[32:35], s17 offen sc1
    s_mov_b64 exec, -1
L_PC2:
    s_waitcnt vmcnt(1)
    s_xor_b32 s96, s95, 262144
    s_add_u32 s82, s96, s90
    s_add_u32 m0, s83, 16384
    s_nop 0
    buffer_load_dwordx4 v26, s[44:47], s82 offen lds
    v_permlane32_swap_b32 v192, v194
    v_permlane32_swap_b32 v193, v195
    v_pk_add_f32 v[192:193], v[192:193], v[194:195]
    s_nop 1
    v_add_f32_dpp v192, v192, v192 row_ror:4 row_mask:0xf bank_mask:0xf
    s_xor_b32 s96, s95, 393216
    s_add_u32 s82, s96, s90
    s_add_u32 m0, s83, 24576
    s_nop 0
    buffer_load_dwordx4 v26, s[44:47], s82 offen lds
    v_add_f32_dpp v193, v193, v193 row_ror:4 row_mask:0xf bank_mask:0xf
    v_add_f32_dpp v192, v192, v192 row_ror:8 row_mask:0xf bank_mask:0xf
    s_nop 0
    v_add_f32_dpp v193, v193, v193 row_ror:8 row_mask:0xf bank_mask:0xf
    s_xor_b32 s96, s95, 524288
    s_add_u32 s82, s96, s90
    s_add_u32 m0, s83, 32768
    s_nop 0
    buffer_load_dwordx4 v26, s[44:47], s82 offen lds
    v_mov_b32 v194, v192
    v_mov_b32 v195, v193
    s_nop 0
    v_permlane16_swap_b32 v192, v194
    s_xor_b32 s96, s95, 655360
    s_add_u32 s82, s96, s90
    s_add_u32 m0, s83, 40960
    s_nop 0
    buffer_load_dwordx4 v26, s[44:47], s82 offen lds
    v_permlane16_swap_b32 v193, v195
    v_pk_add_f32 v[192:193], v[192:193], v[194:195]
    v_cvt_pk_bf16_f32 v192, v192, v193
    ds_write_b32 v6, v192
    s_waitcnt lgkmcnt(0)
    s_barrier
    ds_read_b128 v[196:199], v7
    ds_read_b128 v[200:203], v7 offset:32
L_PAD7:
    s_cbranch_execz L_RET7
    ds_read_b128 v[204:207], v7 offset:64
    ds_read_b128 v[208:211], v7 offset:96
    s_lshr_b32 s96, s8, 2
    s_lshl1_add_u32 s97, s9, s96
    s_and_b32 s98, s8, 3
    s_lshl2_add_u32 s99, s97, s98
    s_lshl_b32 s96, s99, 9
    s_add_u32 s18, s96, 131072
    s_waitcnt lgkmcnt(0)
    s_lshl3_add_u32 s96, s11, s3
    s_lshl_b32 s97, s96, 11
    s_add_u32 s13, s97, 29360128
    s_load_dwordx2 s[24:25], s[32:33], s92 offset:3584 glc
    v_mfma_f32_32x32x16_bf16 v[136:151], v[196:199], v[152:155], 0
    v_mfma_f32_32x32x16_bf16 v[136:151], v[200:203], v[156:159], v[136:151]
    v_mfma_f32_32x32x16_bf16 v[136:151], v[204:207], v[160:163], v[136:151]
    v_mfma_f32_32x32x16_bf16 v[136:151], v[208:211], v[164:167], v[136:151]
    s_nop 11
    v_cvt_pk_bf16_f32 v136, 0, v136
    v_add_f32 v136, 0x358637bd, v136
    v_cvt_pk_bf16_f32 v136, 0, v136
    v_rcp_f32 v136, v136
    s_branch SCHK_20
SPOLL_19:
    s_load_dwordx2 s[24:25], s[32:33], s92 offset:3584 glc
SCHK_20:
    s_add_u32 s5, s5, 1
    s_cmp_ge_u32 s5, 200000
    s_waitcnt lgkmcnt(0)
    s_cbranch_scc1 SDONE_21
    s_cmp_lg_u32 s24, s4
    s_cbranch_scc1 SPOLL_19
    s_cmp_lg_u32 s25, s4
    s_cbranch_scc1 SPOLL_19
SDONE_21:
    buffer_load_dwordx4 v[228:231], v2, s[32:35], s13 offen sc1
    buffer_load_dwordx4 v[232:235], v2, s[32:35], s13 offen offset:1024 sc1
    s_waitcnt vmcnt(0)
    v_bitop3_b32 v4, v229, v231, s4 bitop3:0x7e
    v_bitop3_b32 v4, v4, v233, s4 bitop3:0xf6
    v_bitop3_b32 v4, v4, v235, s4 bitop3:0xf6
    v_cmp_ne_u32 vcc, 0, v4
    s_cbranch_vccz TOK_23
POLL_24:
    buffer_load_dwordx4 v[228:231], v2, s[32:35], s13 offen sc1
    buffer_load_dwordx4 v[232:235], v2, s[32:35], s13 offen offset:1024 sc1
    s_waitcnt vmcnt(0)
    v_bitop3_b32 v4, v229, v231, s4 bitop3:0x7e
    v_bitop3_b32 v4, v4, v233, s4 bitop3:0xf6
    v_bitop3_b32 v4, v4, v235, s4 bitop3:0xf6
    v_cmp_ne_u32 vcc, 0, v4
    s_cbranch_vccz PDONE_25
    s_add_u32 s5, s5, 1
    s_cmp_lt_u32 s5, 200000
    s_cbranch_scc1 POLL_24
PDONE_25:
TOK_23:
    ds_write2_b32 v5, v228, v230 offset0:0 offset1:1
    ds_write2_b32 v5, v232, v234 offset0:64 offset1:65
    s_waitcnt lgkmcnt(0)
    s_barrier
    ds_read_b128 v[212:215], v44
    ds_read_b128 v[216:219], v44 offset:1024
    ds_read_b128 v[220:223], v44 offset:2048
    ds_read_b128 v[224:227], v44 offset:3072
    s_lshl_b32 s96, s77, 1
    s_lshl3_add_u32 s97, s10, s96
    s_lshl_b32 s98, s97, 5
    s_lshl1_add_u32 s99, s11, s98
    s_add_u32 s96, s99, s76
    s_lshl_b32 s97, s96, 10
    s_add_u32 s13, s97, 8388608
    v_and_b32 v47, 15, v1
    v_lshlrev_b32 v47, 4, v47
    v_bfe_u32 v9, v1, 4, 1
    v_lshl_add_u32 v47, v9, 15, v47
    v_lshrrev_b32 v9, 5, v1
    v_lshl_add_u32 v47, v9, 8, v47
    s_waitcnt lgkmcnt(3)
    v_mfma_f32_32x32x16_bf16 v[120:135], v[212:215], v[152:155], 0
    s_waitcnt lgkmcnt(2)
    v_mfma_f32_32x32x16_bf16 v[120:135], v[216:219], v[156:159], v[120:135]
    s_waitcnt lgkmcnt(1)
    v_mfma_f32_32x32x16_bf16 v[120:135], v[220:223], v[160:163], v[120:135]
    s_waitcnt lgkmcnt(0)
    v_mfma_f32_32x32x16_bf16 v[120:135], v[224:227], v[164:167], v[120:135]
    s_lshr_b32 s96, s3, 1
    s_lshl4_add_u32 s97, s96, s12
    s_lshl_b32 s98, s97, 11
    s_and_b32 s99, s3, 1
    s_lshl_b32 s96, s99, 10
    s_add_u32 s97, s98, s96
    s_add_u32 s18, s97, 131072
    s_lshl_b32 s19, s12, 7
    v_and_b32 v44, 3, v1
    v_lshl_add_u32 v44, v44, 1, s19
    v_lshrrev_b32 v9, 5, v1
    v_lshl_add_u32 v44, v9, 3, v44
    v_bfe_u32 v9, v1, 4, 1
    v_lshl_add_u32 v44, v9, 4, v44
    v_bfe_u32 v9, v1, 2, 2
    v_lshl_add_u32 v44, v9, 5, v44
    global_load_ushort v32, v44, s[78:79]
    buffer_load_dwordx4 v[28:31], v2, s[32:35], s18 offen sc1
    v_cvt_pk_bf16_f32 v120, 0, v120
    v_cvt_pk_bf16_f32 v121, 0, v121
    v_cvt_pk_bf16_f32 v122, 0, v122
    v_cvt_pk_bf16_f32 v123, 0, v123
    v_cvt_pk_bf16_f32 v124, 0, v124
    v_cvt_pk_bf16_f32 v125, 0, v125
    v_cvt_pk_bf16_f32 v126, 0, v126
    v_cvt_pk_bf16_f32 v127, 0, v127
    v_pk_mul_f32 v[120:121], v[120:121], v[136:137] op_sel_hi:[1,0]
    v_pk_mul_f32 v[122:123], v[122:123], v[136:137] op_sel_hi:[1,0]
    v_pk_mul_f32 v[124:125], v[124:125], v[136:137] op_sel_hi:[1,0]
    v_pk_mul_f32 v[126:127], v[126:127], v[136:137] op_sel_hi:[1,0]
    v_cvt_pk_bf16_f32 v168, v120, v121
    v_cvt_pk_bf16_f32 v169, v122, v123
    v_cvt_pk_bf16_f32 v170, v124, v125
    v_cvt_pk_bf16_f32 v171, v126, v127
    buffer_store_dwordx4 v[168:171], v47, s[32:35], s13 offen sc1
    v_cvt_pk_bf16_f32 v128, 0, v128
    v_cvt_pk_bf16_f32 v129, 0, v129
    v_cvt_pk_bf16_f32 v130, 0, v130
    v_cvt_pk_bf16_f32 v131, 0, v131
    v_cvt_pk_bf16_f32 v132, 0, v132
    v_cvt_pk_bf16_f32 v133, 0, v133
    v_cvt_pk_bf16_f32 v134, 0, v134
    v_cvt_pk_bf16_f32 v135, 0, v135
    v_pk_mul_f32 v[128:129], v[128:129], v[136:137] op_sel_hi:[1,0]
    v_pk_mul_f32 v[130:131], v[130:131], v[136:137] op_sel_hi:[1,0]
    v_pk_mul_f32 v[132:133], v[132:133], v[136:137] op_sel_hi:[1,0]
    v_pk_mul_f32 v[134:135], v[134:135], v[136:137] op_sel_hi:[1,0]
    v_cvt_pk_bf16_f32 v172, v128, v129
    v_cvt_pk_bf16_f32 v173, v130, v131
    v_cvt_pk_bf16_f32 v174, v132, v133
    v_cvt_pk_bf16_f32 v175, v134, v135
    buffer_store_dwordx4 v[172:175], v47, s[32:35], s13 offen offset:512 sc1
    v_mov_b32 v50, -1
    v_mov_b32 v51, -1
    v_mov_b32 v52, -1
    v_mov_b32 v53, -1
    s_lshl3_add_u32 s96, s21, s3
    s_lshl4_add_u32 s97, s96, s12
    s_lshl_b32 s98, s97, 8
    s_add_u32 s19, s98, 12582912
    v_lshlrev_b32 v54, 2, v1
    buffer_store_dword v50, v54, s[32:35], s19 offen sc1
    s_lshl_b32 s96, s21, 14
    s_lshl_b32 s97, s12, 9
    s_add_u32 s98, s96, s97
    s_add_u32 s19, s98, 13631488
    v_and_b32 v54, 31, v1
    v_lshlrev_b32 v54, 4, v54
    v_lshrrev_b32 v55, 5, v1
    v_lshl_add_u32 v54, v55, 13, v54
    s_cmp_lg_u32 s3, 5
    s_cbranch_scc1 L_NOPO
    buffer_store_dwordx4 v[50:53], v54, s[32:35], s19 offen sc1
L_NOPO:
    v_bfe_u32 v36, v1, 2, 2
    v_lshlrev_b32 v36, 7, v36
    v_lshrrev_b32 v9, 4, v1
    v_lshl_add_u32 v36, v9, 10, v36
    v_and_b32 v9, 1, v1
    v_lshl_add_u32 v36, v9, 4, v36
    v_bfe_u32 v9, v1, 1, 1
    v_lshl_add_u32 v36, v9, 3, v36
    v_bfe_u32 v9, v1, 3, 2
    v_lshl_add_u32 v36, v9, 5, v36
    s_and_b32 s96, s9, 1
    s_lshl_b32 s97, s96, 2
    s_xor_b32 s98, s3, s97
    s_lshl_b32 s17, s98, 12
    s_lshl_b32 s96, s17, 2
    s_lshr_b32 s97, s95, 4
    s_xor_b32 s14, s96, s97
    v_add_u32 v36, s14, v36
    v_xor_b32 v37, 32, v36
    v_xor_b32 v38, 64, v36
    v_xor_b32 v39, 96, v36
    v_and_b32 v5, 7, v1
    v_lshlrev_b32 v5, 15, v5
    v_bfe_u32 v9, v1, 3, 1
    v_lshl_add_u32 v5, v9, 12, v5
    s_and_b32 s96, s11, 1
    s_lshr_b32 s97, s10, 2
    s_and_b32 s98, s10, 3
    s_lshl_b32 s99, s98, 6
    s_lshl1_add_u32 s98, s97, s99
    s_lshl_b32 s97, s98, 12
    s_lshr_b32 s99, s11, 1
    s_lshl_b32 s98, s99, 6
    s_add_u32 s99, s97, s98
    s_lshl2_add_u32 s97, s96, s99
    s_add_u32 s98, s97, 1048576
    s_add_u32 s15, s98, 1024
    v_lshlrev_b32 v152, 16, v12
    v_and_b32 v153, s6, v12
    v_lshlrev_b32 v154, 16, v13
    v_and_b32 v155, s6, v13
    v_lshlrev_b32 v156, 16, v14
    v_and_b32 v157, s6, v14
    v_lshlrev_b32 v158, 16, v15
    v_and_b32 v159, s6, v15
    v_lshlrev_b32 v160, 16, v16
    v_and_b32 v161, s6, v16
    v_lshlrev_b32 v162, 16, v17
    v_and_b32 v163, s6, v17
    v_lshlrev_b32 v164, 16, v18
    v_and_b32 v165, s6, v18
    v_lshlrev_b32 v166, 16, v19
    v_and_b32 v167, s6, v19
    s_lshl3_add_u32 s96, s21, s3
    s_lshl_b32 s97, s96, 15
    s_add_u32 s19, s97, 8388608
    s_waitcnt vmcnt(3)
    v_bitop3_b32 v4, v29, v31, s4 bitop3:0x7e
    v_cmp_ne_u32 vcc, 0, v4
    s_cbranch_vccz L_MGOK
POLL_26:
    buffer_load_dwordx4 v[28:31], v2, s[32:35], s18 offen sc1
    s_waitcnt vmcnt(0)
    v_bitop3_b32 v4, v29, v31, s4 bitop3:0x7e
    v_cmp_ne_u32 vcc, 0, v4
    s_cbranch_vccz PDONE_27
    s_add_u32 s5, s5, 1
    s_cmp_lt_u32 s5, 200000
    s_cbranch_scc1 POLL_26
PDONE_27:
L_MGOK:
    s_and_b32 s96, s3, 1
    s_lshr_b32 s97, s3, 1
    s_lshl_b32 s98, s97, 10
    s_lshl3_add_u32 s99, s96, s98
    s_add_u32 s14, s99, 159744
    v_and_b32 v4, 31, v1
    v_lshl_add_u32 v4, v4, 5, s14
    v_lshrrev_b32 v9, 5, v1
    v_lshl_add_u32 v4, v9, 2, v4
    ds_write2_b32 v4, v28, v30 offset0:0 offset1:4
    v_and_b32 v7, 3, v1
    v_lshlrev_b32 v7, 4, v7
    v_lshrrev_b32 v9, 5, v1
    v_lshl_add_u32 v7, v9, 6, v7
    v_bfe_u32 v9, v1, 4, 1
    v_lshl_add_u32 v7, v9, 7, v7
    v_bfe_u32 v9, v1, 2, 2
    v_lshl_add_u32 v7, v9, 8, v7
    v_add_u32 v7, 159744, v7
    s_lshl_b32 s96, s2, 12
    s_lshr_b32 s97, s17, 6
    s_add_u32 s98, s96, s97
    s_add_u32 s99, s98, 1048576
    s_add_u32 s18, s99, 1024
    s_waitcnt vmcnt(1)
    s_waitcnt lgkmcnt(0)
    s_barrier
    s_cmp_lg_u32 s3, 0
    s_cbranch_scc1 L_PD
    v_mov_b32 v6, s4
    s_mov_b32 exec_hi, 0
    s_mov_b32 exec_lo, 65535
    buffer_store_dword v6, v5, s[32:35], s15 offen sc1
    s_mov_b64 exec, -1
L_PD:
    ds_read_b128 v[192:195], v7
    ds_read_b128 v[196:199], v7 offset:1024
    ds_read_b128 v[200:203], v7 offset:2048
    ds_read_b128 v[204:207], v7 offset:3072
    v_and_b32 v8, 3, v1
    v_lshlrev_b32 v8, 2, v8
    v_lshrrev_b32 v9, 5, v1
    v_lshl_add_u32 v8, v9, 4, v8
    v_bfe_u32 v9, v1, 4, 1
    v_lshl_add_u32 v8, v9, 5, v8
    v_bfe_u32 v9, v1, 2, 2
    v_lshl_add_u32 v8, v9, 6, v8
    v_add_u32 v8, 157184, v8
    s_lshl4_add_u32 s96, s21, s12
    s_lshl_b32 s97, s96, 6
    s_add_u32 s13, s97, 14155776
    s_waitcnt lgkmcnt(0)
    s_load_dwordx2 s[24:25], s[32:33], s18 offset:0 glc
    v_pk_add_f32 v[192:193], v[192:193], v[194:195]
    v_add_f32 v28, v192, v193
    v_pk_add_f32 v[196:197], v[196:197], v[198:199]
    v_add_f32 v29, v196, v197
    v_pk_add_f32 v[200:201], v[200:201], v[202:203]
    v_add_f32 v30, v200, v201
    v_pk_add_f32 v[204:205], v[204:205], v[206:207]
    v_add_f32 v31, v204, v205
    v_cvt_pk_bf16_f32 v28, 0, v28
    v_cvt_pk_bf16_f32 v29, 0, v29
    v_cvt_pk_bf16_f32 v30, 0, v30
    v_cvt_pk_bf16_f32 v31, 0, v31
    v_add_f32 v30, 1.0, v30
    v_lshlrev_b32 v32, 16, v32
    v_cvt_pk_bf16_f32 v30, 0, v30
    ds_write_b32 v8, v31
    v_mul_f32 v192, v30, v32
    v_cvt_pk_bf16_f32 v193, 0, v192
    v_sub_f32 v194, v192, v193
    v_add_f32_dpp v192, v192, v192 quad_perm:[1,0,3,2] row_mask:0xf bank_mask:0xf
    s_nop 1
    v_add_f32_dpp v192, v192, v192 quad_perm:[2,3,0,1] row_mask:0xf bank_mask:0xf
    s_nop 1
    v_add_f32_dpp v192, v192, v192 row_half_mirror row_mask:0xf bank_mask:0xf
    s_nop 1
    v_add_f32_dpp v192, v192, v192 row_ror:8 row_mask:0xf bank_mask:0xf
    v_mov_b32 v199, v192
    s_nop 1
    v_permlane16_swap_b32 v192, v199
    v_add_f32 v192, v192, v199
    v_mov_b32 v199, v192
    s_nop 1
    v_permlane32_swap_b32 v192, v199
    v_add_f32 v192, v192, v199
    v_mov_b32_dpp v196, v193 row_shl:1 row_mask:0xf bank_mask:0xf
    v_mov_b32_dpp v197, v194 row_shl:1 row_mask:0xf bank_mask:0xf
    v_mov_b32_dpp v198, v32 row_shl:1 row_mask:0xf bank_mask:0xf
    v_cvt_pk_bf16_f32 v196, v193, v196
    v_cvt_pk_bf16_f32 v197, v194, v197
    v_cvt_pk_bf16_f32 v198, v32, v198
    v_mov_b32 v193, s4
    v_mov_b32 v194, 0
    s_cmp_lg_u32 s3, 2
    s_cbranch_scc1 L_NOUP
    s_mov_b64 exec, 1
    buffer_store_dwordx2 v[192:193], v194, s[32:35], s13 offen sc1
    s_mov_b64 exec, -1
L_NOUP:
    v_mov_b32 v184, 0x3f803f80
    s_nop 1
    v_mov_b32_dpp v184, v196 row_newbcast:0 row_mask:0xf bank_mask:0x2
    s_nop 1
    v_mov_b32_dpp v184, v197 row_newbcast:0 row_mask:0xf bank_mask:0x4
    s_nop 1
    v_mov_b32_dpp v184, v198 row_newbcast:0 row_mask:0xf bank_mask:0x8
    v_mov_b32 v185, 0x3f803f80
    s_nop 1
    v_mov_b32_dpp v185, v196 row_newbcast:2 row_mask:0xf bank_mask:0x2
    s_nop 1
    v_mov_b32_dpp v185, v197 row_newbcast:2 row_mask:0xf bank_mask:0x4
    s_nop 1
    v_mov_b32_dpp v185, v198 row_newbcast:2 row_mask:0xf bank_mask:0x8
    v_mov_b32 v186, 0x3f803f80
    s_nop 1
    v_mov_b32_dpp v186, v196 row_newbcast:4 row_mask:0xf bank_mask:0x2
    s_nop 1
    v_mov_b32_dpp v186, v197 row_newbcast:4 row_mask:0xf bank_mask:0x4
    s_nop 1
    v_mov_b32_dpp v186, v198 row_newbcast:4 row_mask:0xf bank_mask:0x8
    v_mov_b32 v187, 0x3f803f80
    s_nop 1
    v_mov_b32_dpp v187, v196 row_newbcast:6 row_mask:0xf bank_mask:0x2
    s_nop 1
    v_mov_b32_dpp v187, v197 row_newbcast:6 row_mask:0xf bank_mask:0x4
    s_nop 1
    v_mov_b32_dpp v187, v198 row_newbcast:6 row_mask:0xf bank_mask:0x8
    v_mov_b32 v188, 0x3f803f80
    s_nop 1
    v_mov_b32_dpp v188, v196 row_newbcast:8 row_mask:0xf bank_mask:0x2
    s_nop 1
    v_mov_b32_dpp v188, v197 row_newbcast:8 row_mask:0xf bank_mask:0x4
    s_nop 1
    v_mov_b32_dpp v188, v198 row_newbcast:8 row_mask:0xf bank_mask:0x8
    v_mov_b32 v189, 0x3f803f80
    s_nop 1
    v_mov_b32_dpp v189, v196 row_newbcast:10 row_mask:0xf bank_mask:0x2
    s_nop 1
    v_mov_b32_dpp v189, v197 row_newbcast:10 row_mask:0xf bank_mask:0x4
    s_nop 1
    v_mov_b32_dpp v189, v198 row_newbcast:10 row_mask:0xf bank_mask:0x8
    v_mov_b32 v190, 0x3f803f80
    s_nop 1
    v_mov_b32_dpp v190, v196 row_newbcast:12 row_mask:0xf bank_mask:0x2
    s_nop 1
    v_mov_b32_dpp v190, v197 row_newbcast:12 row_mask:0xf bank_mask:0x4
    s_nop 1
    v_mov_b32_dpp v190, v198 row_newbcast:12 row_mask:0xf bank_mask:0x8
    v_mov_b32 v191, 0x3f803f80
    s_nop 1
    v_mov_b32_dpp v191, v196 row_newbcast:14 row_mask:0xf bank_mask:0x2
    s_nop 1
    v_mov_b32_dpp v191, v197 row_newbcast:14 row_mask:0xf bank_mask:0x4
    s_nop 1
    v_mov_b32_dpp v191, v198 row_newbcast:14 row_mask:0xf bank_mask:0x8
    v_mov_b32 v42, v29
    v_mov_b32 v43, v31
    v_mov_b32_dpp v136, v28 row_newbcast:0 row_mask:0xf bank_mask:0xf
    v_mov_b32_dpp v137, v28 row_newbcast:1 row_mask:0xf bank_mask:0xf
    v_mov_b32_dpp v138, v28 row_newbcast:2 row_mask:0xf bank_mask:0xf
    v_mov_b32_dpp v139, v28 row_newbcast:3 row_mask:0xf bank_mask:0xf
    v_mov_b32_dpp v140, v28 row_newbcast:4 row_mask:0xf bank_mask:0xf
    v_mov_b32_dpp v141, v28 row_newbcast:5 row_mask:0xf bank_mask:0xf
    v_mov_b32_dpp v142, v28 row_newbcast:6 row_mask:0xf bank_mask:0xf
    v_mov_b32_dpp v143, v28 row_newbcast:7 row_mask:0xf bank_mask:0xf
    v_mov_b32_dpp v144, v28 row_newbcast:8 row_mask:0xf bank_mask:0xf
    v_mov_b32_dpp v145, v28 row_newbcast:9 row_mask:0xf bank_mask:0xf
    v_mov_b32_dpp v146, v28 row_newbcast:10 row_mask:0xf bank_mask:0xf
    v_mov_b32_dpp v147, v28 row_newbcast:11 row_mask:0xf bank_mask:0xf
    v_mov_b32_dpp v148, v28 row_newbcast:12 row_mask:0xf bank_mask:0xf
    v_mov_b32_dpp v149, v28 row_newbcast:13 row_mask:0xf bank_mask:0xf
    v_mov_b32_dpp v150, v28 row_newbcast:14 row_mask:0xf bank_mask:0xf
    v_mov_b32_dpp v151, v28 row_newbcast:15 row_mask:0xf bank_mask:0xf
    v_mov_b32_dpp v168, v30 row_newbcast:0 row_mask:0xf bank_mask:0xf
    v_mov_b32_dpp v169, v30 row_newbcast:1 row_mask:0xf bank_mask:0xf
    v_mov_b32_dpp v170, v30 row_newbcast:2 row_mask:0xf bank_mask:0xf
    v_mov_b32_dpp v171, v30 row_newbcast:3 row_mask:0xf bank_mask:0xf
    v_mov_b32_dpp v172, v30 row_newbcast:4 row_mask:0xf bank_mask:0xf
    v_mov_b32_dpp v173, v30 row_newbcast:5 row_mask:0xf bank_mask:0xf
    v_mov_b32_dpp v174, v30 row_newbcast:6 row_mask:0xf bank_mask:0xf
    v_mov_b32_dpp v175, v30 row_newbcast:7 row_mask:0xf bank_mask:0xf
    v_mov_b32_dpp v176, v30 row_newbcast:8 row_mask:0xf bank_mask:0xf
    v_mov_b32_dpp v177, v30 row_newbcast:9 row_mask:0xf bank_mask:0xf
    v_mov_b32_dpp v178, v30 row_newbcast:10 row_mask:0xf bank_mask:0xf
    v_mov_b32_dpp v179, v30 row_newbcast:11 row_mask:0xf bank_mask:0xf
    v_mov_b32_dpp v180, v30 row_newbcast:12 row_mask:0xf bank_mask:0xf
    v_mov_b32_dpp v181, v30 row_newbcast:13 row_mask:0xf bank_mask:0xf
    v_mov_b32_dpp v182, v30 row_newbcast:14 row_mask:0xf bank_mask:0xf
    v_mov_b32_dpp v183, v30 row_newbcast:15 row_mask:0xf bank_mask:0xf
    s_branch SCHK_29
SPOLL_28:
    s_load_dwordx2 s[24:25], s[32:33], s18 offset:0 glc
SCHK_29:
    s_add_u32 s5, s5, 1
    s_cmp_ge_u32 s5, 200000
    s_waitcnt lgkmcnt(0)
    s_cbranch_scc1 SDONE_30
    s_cmp_lg_u32 s24, s4
    s_cbranch_scc1 SPOLL_28
    s_cmp_lg_u32 s25, s4
    s_cbranch_scc1 SPOLL_28
SDONE_30:
    s_add_u32 s20, s17, s19
    buffer_load_dwordx4 v[224:227], v2, s[32:35], s20 offen sc1
    ds_read_b64_tr_b16 v[192:193], v36
    ds_read_b64_tr_b16 v[194:195], v36 offset:512
    ds_read_b64_tr_b16 v[196:197], v37
    ds_read_b64_tr_b16 v[198:199], v37 offset:512
    ds_read_b64_tr_b16 v[200:201], v38
    ds_read_b64_tr_b16 v[202:203], v38 offset:512
    ds_read_b64_tr_b16 v[204:205], v39
    ds_read_b64_tr_b16 v[206:207], v39 offset:512
    ds_read_b64_tr_b16 v[208:209], v36 offset:4096
    ds_read_b64_tr_b16 v[210:211], v36 offset:4608
    ds_read_b64_tr_b16 v[212:213], v37 offset:4096
    ds_read_b64_tr_b16 v[214:215], v37 offset:4608
    ds_read_b64_tr_b16 v[216:217], v38 offset:4096
    ds_read_b64_tr_b16 v[218:219], v38 offset:4608
    buffer_load_dwordx4 v[228:231], v2, s[32:35], s20 offen offset:1024 sc1
    buffer_load_dwordx4 v[232:235], v2, s[32:35], s20 offen offset:2048 sc1
    buffer_load_dwordx4 v[236:239], v2, s[32:35], s20 offen offset:3072 sc1
    s_barrier
    s_xor_b32 s96, s17, 4096
    s_add_u32 s20, s96, s19
    buffer_load_dwordx4 v[240:243], v2, s[32:35], s20 offen sc1
    buffer_load_dwordx4 v[244:247], v2, s[32:35], s20 offen offset:1024 sc1
    buffer_load_dwordx4 v[44:47], v2, s[32:35], s20 offen offset:2048 sc1
    buffer_load_dwordx4 v[48:51], v2, s[32:35], s20 offen offset:3072 sc1
    s_lshl_b32 s96, s21, 10
    s_add_u32 s13, s96, 14155776
    v_and_b32 v10, 15, v1
    v_lshlrev_b32 v10, 6, v10
    s_waitcnt vmcnt(7)
    s_waitcnt lgkmcnt(6)
    v_mfma_f32_16x16x32_bf16 v[120:123], v[192:195], v[224:227], 0
    ds_read_b64_tr_b16 v[220:221], v39 offset:4096
    ds_read_b64_tr_b16 v[222:223], v39 offset:4608
    v_mfma_f32_16x16x32_bf16 v[124:127], v[196:199], v[224:227], 0
    ds_read_b64_tr_b16 v[192:193], v36 offset:8192
    ds_read_b64_tr_b16 v[194:195], v36 offset:8704
    v_mfma_f32_16x16x32_bf16 v[128:131], v[200:203], v[224:227], 0
    ds_read_b64_tr_b16 v[196:197], v37 offset:8192
    ds_read_b64_tr_b16 v[198:199], v37 offset:8704
    v_mfma_f32_16x16x32_bf16 v[132:135], v[204:207], v[224:227], 0
    ds_read_b64_tr_b16 v[200:201], v38 offset:8192
    ds_read_b64_tr_b16 v[202:203], v38 offset:8704
    s_xor_b32 s96, s17, 8192
    s_add_u32 s20, s96, s19
    buffer_load_dwordx4 v[224:227], v2, s[32:35], s20 offen sc1
    s_waitcnt vmcnt(7)
    s_waitcnt lgkmcnt(6)
    v_mfma_f32_16x16x32_bf16 v[120:123], v[208:211], v[228:231], v[120:123]
    ds_read_b64_tr_b16 v[204:205], v39 offset:8192
    ds_read_b64_tr_b16 v[206:207], v39 offset:8704
    v_mfma_f32_16x16x32_bf16 v[124:127], v[212:215], v[228:231], v[124:127]
    ds_read_b64_tr_b16 v[208:209], v36 offset:12288
    ds_read_b64_tr_b16 v[210:211], v36 offset:12800
    v_xor_b32 v36, 16384, v36
    v_mfma_f32_16x16x32_bf16 v[128:131], v[216:219], v[228:231], v[128:131]
    ds_read_b64_tr_b16 v[212:213], v37 offset:12288
    ds_read_b64_tr_b16 v[214:215], v37 offset:12800
    v_xor_b32 v37, 16384, v37
    v_mfma_f32_16x16x32_bf16 v[132:135], v[220:223], v[228:231], v[132:135]
    ds_read_b64_tr_b16 v[216:217], v38 offset:12288
    ds_read_b64_tr_b16 v[218:219], v38 offset:12800
    v_xor_b32 v38, 16384, v38
    buffer_load_dwordx4 v[228:231], v2, s[32:35], s20 offen offset:1024 sc1
    s_waitcnt vmcnt(7)
    s_waitcnt lgkmcnt(6)
    v_mfma_f32_16x16x32_bf16 v[120:123], v[192:195], v[232:235], v[120:123]
    ds_read_b64_tr_b16 v[220:221], v39 offset:12288
    ds_read_b64_tr_b16 v[222:223], v39 offset:12800
    v_xor_b32 v39, 16384, v39
    v_mfma_f32_16x16x32_bf16 v[124:127], v[196:199], v[232:235], v[124:127]
    ds_read_b64_tr_b16 v[192:193], v36
    ds_read_b64_tr_b16 v[194:195], v36 offset:512
    v_mfma_f32_16x16x32_bf16 v[128:131], v[200:203], v[232:235], v[128:131]
    ds_read_b64_tr_b16 v[196:197], v37
    ds_read_b64_tr_b16 v[198:199], v37 offset:512
    v_mfma_f32_16x16x32_bf16 v[132:135], v[204:207], v[232:235], v[132:135]
    ds_read_b64_tr_b16 v[200:201], v38
    ds_read_b64_tr_b16 v[202:203], v38 offset:512
    buffer_load_dwordx4 v[232:235], v2, s[32:35], s20 offen offset:2048 sc1
    s_waitcnt vmcnt(7)
    s_waitcnt lgkmcnt(6)
    v_mfma_f32_16x16x32_bf16 v[120:123], v[208:211], v[236:239], v[120:123]
    ds_read_b64_tr_b16 v[204:205], v39
    ds_read_b64_tr_b16 v[206:207], v39 offset:512
    v_mfma_f32_16x16x32_bf16 v[124:127], v[212:215], v[236:239], v[124:127]
    ds_read_b64_tr_b16 v[208:209], v36 offset:4096
    ds_read_b64_tr_b16 v[210:211], v36 offset:4608
    v_mfma_f32_16x16x32_bf16 v[128:131], v[216:219], v[236:239], v[128:131]
    ds_read_b64_tr_b16 v[212:213], v37 offset:4096
    ds_read_b64_tr_b16 v[214:215], v37 offset:4608
    v_mfma_f32_16x16x32_bf16 v[132:135], v[220:223], v[236:239], v[132:135]
    ds_read_b64_tr_b16 v[216:217], v38 offset:4096
    ds_read_b64_tr_b16 v[218:219], v38 offset:4608
    buffer_load_dwordx4 v[236:239], v2, s[32:35], s20 offen offset:3072 sc1
    s_waitcnt vmcnt(7)
    s_waitcnt lgkmcnt(6)
    v_mfma_f32_16x16x32_bf16 v[120:123], v[192:195], v[240:243], v[120:123]
    ds_read_b64_tr_b16 v[220:221], v39 offset:4096
    ds_read_b64_tr_b16 v[222:223], v39 offset:4608
    v_mfma_f32_16x16x32_bf16 v[124:127], v[196:199], v[240:243], v[124:127]
    ds_read_b64_tr_b16 v[192:193], v36 offset:8192
    ds_read_b64_tr_b16 v[194:195], v36 offset:8704
    v_mfma_f32_16x16x32_bf16 v[128:131], v[200:203], v[240:243], v[128:131]
    ds_read_b64_tr_b16 v[196:197], v37 offset:8192
    ds_read_b64_tr_b16 v[198:199], v37 offset:8704
    v_mfma_f32_16x16x32_bf16 v[132:135], v[204:207], v[240:243], v[132:135]
    ds_read_b64_tr_b16 v[200:201], v38 offset:8192
    ds_read_b64_tr_b16 v[202:203], v38 offset:8704
    s_xor_b32 s96, s17, 12288
    s_add_u32 s20, s96, s19
    buffer_load_dwordx4 v[240:243], v2, s[32:35], s20 offen sc1
    s_waitcnt vmcnt(7)
    s_waitcnt lgkmcnt(6)
    v_mfma_f32_16x16x32_bf16 v[120:123], v[208:211], v[244:247], v[120:123]
    ds_read_b64_tr_b16 v[204:205], v39 offset:8192
    ds_read_b64_tr_b16 v[206:207], v39 offset:8704
    v_mfma_f32_16x16x32_bf16 v[124:127], v[212:215], v[244:247], v[124:127]
    ds_read_b64_tr_b16 v[208:209], v36 offset:12288
    ds_read_b64_tr_b16 v[210:211], v36 offset:12800
    v_xor_b32 v36, 49152, v36
    v_mfma_f32_16x16x32_bf16 v[128:131], v[216:219], v[244:247], v[128:131]
    ds_read_b64_tr_b16 v[212:213], v37 offset:12288
    ds_read_b64_tr_b16 v[214:215], v37 offset:12800
    v_xor_b32 v37, 49152, v37
    v_mfma_f32_16x16x32_bf16 v[132:135], v[220:223], v[244:247], v[132:135]
    ds_read_b64_tr_b16 v[216:217], v38 offset:12288
    ds_read_b64_tr_b16 v[218:219], v38 offset:12800
    v_xor_b32 v38, 49152, v38
    buffer_load_dwordx4 v[244:247], v2, s[32:35], s20 offen offset:1024 sc1
    s_waitcnt vmcnt(7)
    s_waitcnt lgkmcnt(6)
    v_mfma_f32_16x16x32_bf16 v[120:123], v[192:195], v[44:47], v[120:123]
    ds_read_b64_tr_b16 v[220:221], v39 offset:12288
    ds_read_b64_tr_b16 v[222:223], v39 offset:12800
    v_xor_b32 v39, 49152, v39
    v_mfma_f32_16x16x32_bf16 v[124:127], v[196:199], v[44:47], v[124:127]
    ds_read_b64_tr_b16 v[192:193], v36
    ds_read_b64_tr_b16 v[194:195], v36 offset:512
    v_mfma_f32_16x16x32_bf16 v[128:131], v[200:203], v[44:47], v[128:131]
    ds_read_b64_tr_b16 v[196:197], v37
    ds_read_b64_tr_b16 v[198:199], v37 offset:512
    v_mfma_f32_16x16x32_bf16 v[132:135], v[204:207], v[44:47], v[132:135]
    ds_read_b64_tr_b16 v[200:201], v38
    ds_read_b64_tr_b16 v[202:203], v38 offset:512
    buffer_load_dwordx4 v[44:47], v2, s[32:35], s20 offen offset:2048 sc1
    s_waitcnt vmcnt(7)
    s_waitcnt lgkmcnt(6)
    v_mfma_f32_16x16x32_bf16 v[120:123], v[208:211], v[48:51], v[120:123]
    ds_read_b64_tr_b16 v[204:205], v39
    ds_read_b64_tr_b16 v[206:207], v39 offset:512
    v_mfma_f32_16x16x32_bf16 v[124:127], v[212:215], v[48:51], v[124:127]
    ds_read_b64_tr_b16 v[208:209], v36 offset:4096
    ds_read_b64_tr_b16 v[210:211], v36 offset:4608
    v_mfma_f32_16x16x32_bf16 v[128:131], v[216:219], v[48:51], v[128:131]
    ds_read_b64_tr_b16 v[212:213], v37 offset:4096
    ds_read_b64_tr_b16 v[214:215], v37 offset:4608
    v_mfma_f32_16x16x32_bf16 v[132:135], v[220:223], v[48:51], v[132:135]
    ds_read_b64_tr_b16 v[216:217], v38 offset:4096
    ds_read_b64_tr_b16 v[218:219], v38 offset:4608
    buffer_load_dwordx4 v[48:51], v2, s[32:35], s20 offen offset:3072 sc1
    s_waitcnt vmcnt(7)
    s_waitcnt lgkmcnt(6)
    v_mfma_f32_16x16x32_bf16 v[120:123], v[192:195], v[224:227], v[120:123]
    ds_read_b64_tr_b16 v[220:221], v39 offset:4096
    ds_read_b64_tr_b16 v[222:223], v39 offset:4608
    v_mfma_f32_16x16x32_bf16 v[124:127], v[196:199], v[224:227], v[124:127]
    ds_read_b64_tr_b16 v[192:193], v36 offset:8192
    ds_read_b64_tr_b16 v[194:195], v36 offset:8704
    v_mfma_f32_16x16x32_bf16 v[128:131], v[200:203], v[224:227], v[128:131]
    ds_read_b64_tr_b16 v[196:197], v37 offset:8192
    ds_read_b64_tr_b16 v[198:199], v37 offset:8704
    v_mfma_f32_16x16x32_bf16 v[132:135], v[204:207], v[224:227], v[132:135]
    ds_read_b64_tr_b16 v[200:201], v38 offset:8192
    ds_read_b64_tr_b16 v[202:203], v38 offset:8704
    s_xor_b32 s96, s17, 16384
    s_add_u32 s20, s96, s19
    buffer_load_dwordx4 v[224:227], v2, s[32:35], s20 offen sc1
    s_waitcnt vmcnt(7)
    s_waitcnt lgkmcnt(6)
    v_mfma_f32_16x16x32_bf16 v[120:123], v[208:211], v[228:231], v[120:123]
    ds_read_b64_tr_b16 v[204:205], v39 offset:8192
    ds_read_b64_tr_b16 v[206:207], v39 offset:8704
    v_mfma_f32_16x16x32_bf16 v[124:127], v[212:215], v[228:231], v[124:127]
    ds_read_b64_tr_b16 v[208:209], v36 offset:12288
    ds_read_b64_tr_b16 v[210:211], v36 offset:12800
    v_xor_b32 v36, 16384, v36
    v_mfma_f32_16x16x32_bf16 v[128:131], v[216:219], v[228:231], v[128:131]
    ds_read_b64_tr_b16 v[212:213], v37 offset:12288
    ds_read_b64_tr_b16 v[214:215], v37 offset:12800
    v_xor_b32 v37, 16384, v37
    v_mfma_f32_16x16x32_bf16 v[132:135], v[220:223], v[228:231], v[132:135]
    ds_read_b64_tr_b16 v[216:217], v38 offset:12288
    ds_read_b64_tr_b16 v[218:219], v38 offset:12800
    v_xor_b32 v38, 16384, v38
    buffer_load_dwordx4 v[228:231], v2, s[32:35], s20 offen offset:1024 sc1
    s_waitcnt vmcnt(7)
    s_waitcnt lgkmcnt(6)
    v_mfma_f32_16x16x32_bf16 v[120:123], v[192:195], v[232:235], v[120:123]
    ds_read_b64_tr_b16 v[220:221], v39 offset:12288
    ds_read_b64_tr_b16 v[222:223], v39 offset:12800
    v_xor_b32 v39, 16384, v39
    v_mfma_f32_16x16x32_bf16 v[124:127], v[196:199], v[232:235], v[124:127]
    ds_read_b64_tr_b16 v[192:193], v36
    ds_read_b64_tr_b16 v[194:195], v36 offset:512
    v_mfma_f32_16x16x32_bf16 v[128:131], v[200:203], v[232:235], v[128:131]
    ds_read_b64_tr_b16 v[196:197], v37
L_PAD8:
    s_cbranch_execz L_RET8
    ds_read_b64_tr_b16 v[198:199], v37 offset:512
    v_mfma_f32_16x16x32_bf16 v[132:135], v[204:207], v[232:235], v[132:135]
    ds_read_b64_tr_b16 v[200:201], v38
    ds_read_b64_tr_b16 v[202:203], v38 offset:512
    buffer_load_dwordx4 v[232:235], v2, s[32:35], s20 offen offset:2048 sc1
    s_waitcnt vmcnt(7)
    s_waitcnt lgkmcnt(6)
    v_mfma_f32_16x16x32_bf16 v[120:123], v[208:211], v[236:239], v[120:123]
    ds_read_b64_tr_b16 v[204:205], v39
    ds_read_b64_tr_b16 v[206:207], v39 offset:512
    v_mfma_f32_16x16x32_bf16 v[124:127], v[212:215], v[236:239], v[124:127]
    ds_read_b64_tr_b16 v[208:209], v36 offset:4096
    ds_read_b64_tr_b16 v[210:211], v36 offset:4608
    v_mfma_f32_16x16x32_bf16 v[128:131], v[216:219], v[236:239], v[128:131]
    ds_read_b64_tr_b16 v[212:213], v37 offset:4096
    ds_read_b64_tr_b16 v[214:215], v37 offset:4608
    v_mfma_f32_16x16x32_bf16 v[132:135], v[220:223], v[236:239], v[132:135]
    ds_read_b64_tr_b16 v[216:217], v38 offset:4096
    ds_read_b64_tr_b16 v[218:219], v38 offset:4608
    buffer_load_dwordx4 v[236:239], v2, s[32:35], s20 offen offset:3072 sc1
    s_waitcnt vmcnt(7)
    s_waitcnt lgkmcnt(6)
    v_mfma_f32_16x16x32_bf16 v[120:123], v[192:195], v[240:243], v[120:123]
    ds_read_b64_tr_b16 v[220:221], v39 offset:4096
    ds_read_b64_tr_b16 v[222:223], v39 offset:4608
    v_mfma_f32_16x16x32_bf16 v[124:127], v[196:199], v[240:243], v[124:127]
    ds_read_b64_tr_b16 v[192:193], v36 offset:8192
    ds_read_b64_tr_b16 v[194:195], v36 offset:8704
    v_mfma_f32_16x16x32_bf16 v[128:131], v[200:203], v[240:243], v[128:131]
    ds_read_b64_tr_b16 v[196:197], v37 offset:8192
    ds_read_b64_tr_b16 v[198:199], v37 offset:8704
    v_mfma_f32_16x16x32_bf16 v[132:135], v[204:207], v[240:243], v[132:135]
    ds_read_b64_tr_b16 v[200:201], v38 offset:8192
    ds_read_b64_tr_b16 v[202:203], v38 offset:8704
    s_xor_b32 s96, s17, 20480
    s_add_u32 s20, s96, s19
    buffer_load_dwordx4 v[240:243], v2, s[32:35], s20 offen sc1
    s_waitcnt vmcnt(7)
    s_waitcnt lgkmcnt(6)
    v_mfma_f32_16x16x32_bf16 v[120:123], v[208:211], v[244:247], v[120:123]
    ds_read_b64_tr_b16 v[204:205], v39 offset:8192
    ds_read_b64_tr_b16 v[206:207], v39 offset:8704
    v_mfma_f32_16x16x32_bf16 v[124:127], v[212:215], v[244:247], v[124:127]
    ds_read_b64_tr_b16 v[208:209], v36 offset:12288
    ds_read_b64_tr_b16 v[210:211], v36 offset:12800
    v_xor_b32 v36, 114688, v36
    v_mfma_f32_16x16x32_bf16 v[128:131], v[216:219], v[244:247], v[128:131]
    ds_read_b64_tr_b16 v[212:213], v37 offset:12288
    ds_read_b64_tr_b16 v[214:215], v37 offset:12800
    v_xor_b32 v37, 114688, v37
    v_mfma_f32_16x16x32_bf16 v[132:135], v[220:223], v[244:247], v[132:135]
    ds_read_b64_tr_b16 v[216:217], v38 offset:12288
    ds_read_b64_tr_b16 v[218:219], v38 offset:12800
    v_xor_b32 v38, 114688, v38
    buffer_load_dwordx4 v[244:247], v2, s[32:35], s20 offen offset:1024 sc1
    s_waitcnt vmcnt(7)
    s_waitcnt lgkmcnt(6)
    v_mfma_f32_16x16x32_bf16 v[120:123], v[192:195], v[44:47], v[120:123]
    ds_read_b64_tr_b16 v[220:221], v39 offset:12288
    ds_read_b64_tr_b16 v[222:223], v39 offset:12800
    v_xor_b32 v39, 114688, v39
    v_mfma_f32_16x16x32_bf16 v[124:127], v[196:199], v[44:47], v[124:127]
    ds_read_b64_tr_b16 v[192:193], v36
    ds_read_b64_tr_b16 v[194:195], v36 offset:512
    v_mfma_f32_16x16x32_bf16 v[128:131], v[200:203], v[44:47], v[128:131]
    ds_read_b64_tr_b16 v[196:197], v37
    ds_read_b64_tr_b16 v[198:199], v37 offset:512
    v_mfma_f32_16x16x32_bf16 v[132:135], v[204:207], v[44:47], v[132:135]
    ds_read_b64_tr_b16 v[200:201], v38
    ds_read_b64_tr_b16 v[202:203], v38 offset:512
    buffer_load_dwordx4 v[44:47], v2, s[32:35], s20 offen offset:2048 sc1
    s_waitcnt vmcnt(7)
    s_waitcnt lgkmcnt(6)
    v_mfma_f32_16x16x32_bf16 v[120:123], v[208:211], v[48:51], v[120:123]
    ds_read_b64_tr_b16 v[204:205], v39
    ds_read_b64_tr_b16 v[206:207], v39 offset:512
    v_mfma_f32_16x16x32_bf16 v[124:127], v[212:215], v[48:51], v[124:127]
    ds_read_b64_tr_b16 v[208:209], v36 offset:4096
    ds_read_b64_tr_b16 v[210:211], v36 offset:4608
    v_mfma_f32_16x16x32_bf16 v[128:131], v[216:219], v[48:51], v[128:131]
    ds_read_b64_tr_b16 v[212:213], v37 offset:4096
    ds_read_b64_tr_b16 v[214:215], v37 offset:4608
    v_mfma_f32_16x16x32_bf16 v[132:135], v[220:223], v[48:51], v[132:135]
    ds_read_b64_tr_b16 v[216:217], v38 offset:4096
    ds_read_b64_tr_b16 v[218:219], v38 offset:4608
    buffer_load_dwordx4 v[48:51], v2, s[32:35], s20 offen offset:3072 sc1
    s_waitcnt vmcnt(7)
    s_waitcnt lgkmcnt(6)
    v_mfma_f32_16x16x32_bf16 v[120:123], v[192:195], v[224:227], v[120:123]
    ds_read_b64_tr_b16 v[220:221], v39 offset:4096
    ds_read_b64_tr_b16 v[222:223], v39 offset:4608
    v_mfma_f32_16x16x32_bf16 v[124:127], v[196:199], v[224:227], v[124:127]
    ds_read_b64_tr_b16 v[192:193], v36 offset:8192
    ds_read_b64_tr_b16 v[194:195], v36 offset:8704
    v_mfma_f32_16x16x32_bf16 v[128:131], v[200:203], v[224:227], v[128:131]
    ds_read_b64_tr_b16 v[196:197], v37 offset:8192
    ds_read_b64_tr_b16 v[198:199], v37 offset:8704
    v_mfma_f32_16x16x32_bf16 v[132:135], v[204:207], v[224:227], v[132:135]
    ds_read_b64_tr_b16 v[200:201], v38 offset:8192
    ds_read_b64_tr_b16 v[202:203], v38 offset:8704
    s_xor_b32 s96, s17, 24576
    s_add_u32 s20, s96, s19
    buffer_load_dwordx4 v[224:227], v2, s[32:35], s20 offen sc1
    s_waitcnt vmcnt(7)
    s_waitcnt lgkmcnt(6)
    v_mfma_f32_16x16x32_bf16 v[120:123], v[208:211], v[228:231], v[120:123]
    ds_read_b64_tr_b16 v[204:205], v39 offset:8192
    ds_read_b64_tr_b16 v[206:207], v39 offset:8704
    v_mfma_f32_16x16x32_bf16 v[124:127], v[212:215], v[228:231], v[124:127]
    ds_read_b64_tr_b16 v[208:209], v36 offset:12288
    ds_read_b64_tr_b16 v[210:211], v36 offset:12800
    v_xor_b32 v36, 16384, v36
    v_mfma_f32_16x16x32_bf16 v[128:131], v[216:219], v[228:231], v[128:131]
    ds_read_b64_tr_b16 v[212:213], v37 offset:12288
    ds_read_b64_tr_b16 v[214:215], v37 offset:12800
    v_xor_b32 v37, 16384, v37
    v_mfma_f32_16x16x32_bf16 v[132:135], v[220:223], v[228:231], v[132:135]
    ds_read_b64_tr_b16 v[216:217], v38 offset:12288
    ds_read_b64_tr_b16 v[218:219], v38 offset:12800
    v_xor_b32 v38, 16384, v38
    buffer_load_dwordx4 v[228:231], v2, s[32:35], s20 offen offset:1024 sc1
    s_waitcnt vmcnt(7)
    s_waitcnt lgkmcnt(6)
    v_mfma_f32_16x16x32_bf16 v[120:123], v[192:195], v[232:235], v[120:123]
    ds_read_b64_tr_b16 v[220:221], v39 offset:12288
    ds_read_b64_tr_b16 v[222:223], v39 offset:12800
    v_xor_b32 v39, 16384, v39
    v_mfma_f32_16x16x32_bf16 v[124:127], v[196:199], v[232:235], v[124:127]
    ds_read_b64_tr_b16 v[192:193], v36
    ds_read_b64_tr_b16 v[194:195], v36 offset:512
    v_mfma_f32_16x16x32_bf16 v[128:131], v[200:203], v[232:235], v[128:131]
    ds_read_b64_tr_b16 v[196:197], v37
    ds_read_b64_tr_b16 v[198:199], v37 offset:512
    v_mfma_f32_16x16x32_bf16 v[132:135], v[204:207], v[232:235], v[132:135]
    ds_read_b64_tr_b16 v[200:201], v38
    ds_read_b64_tr_b16 v[202:203], v38 offset:512
    buffer_load_dwordx4 v[232:235], v2, s[32:35], s20 offen offset:2048 sc1
    s_waitcnt vmcnt(7)
    s_waitcnt lgkmcnt(6)
    v_mfma_f32_16x16x32_bf16 v[120:123], v[208:211], v[236:239], v[120:123]
    ds_read_b64_tr_b16 v[204:205], v39
    ds_read_b64_tr_b16 v[206:207], v39 offset:512
    v_mfma_f32_16x16x32_bf16 v[124:127], v[212:215], v[236:239], v[124:127]
    ds_read_b64_tr_b16 v[208:209], v36 offset:4096
    ds_read_b64_tr_b16 v[210:211], v36 offset:4608
    v_mfma_f32_16x16x32_bf16 v[128:131], v[216:219], v[236:239], v[128:131]
    ds_read_b64_tr_b16 v[212:213], v37 offset:4096
    ds_read_b64_tr_b16 v[214:215], v37 offset:4608
    v_mfma_f32_16x16x32_bf16 v[132:135], v[220:223], v[236:239], v[132:135]
    ds_read_b64_tr_b16 v[216:217], v38 offset:4096
    ds_read_b64_tr_b16 v[218:219], v38 offset:4608
    buffer_load_dwordx4 v[236:239], v2, s[32:35], s20 offen offset:3072 sc1
    s_waitcnt vmcnt(7)
    s_waitcnt lgkmcnt(6)
    v_mfma_f32_16x16x32_bf16 v[120:123], v[192:195], v[240:243], v[120:123]
    ds_read_b64_tr_b16 v[220:221], v39 offset:4096
    ds_read_b64_tr_b16 v[222:223], v39 offset:4608
    v_mfma_f32_16x16x32_bf16 v[124:127], v[196:199], v[240:243], v[124:127]
    ds_read_b64_tr_b16 v[192:193], v36 offset:8192
    ds_read_b64_tr_b16 v[194:195], v36 offset:8704
    v_mfma_f32_16x16x32_bf16 v[128:131], v[200:203], v[240:243], v[128:131]
    ds_read_b64_tr_b16 v[196:197], v37 offset:8192
    ds_read_b64_tr_b16 v[198:199], v37 offset:8704
    v_mfma_f32_16x16x32_bf16 v[132:135], v[204:207], v[240:243], v[132:135]
    ds_read_b64_tr_b16 v[200:201], v38 offset:8192
    ds_read_b64_tr_b16 v[202:203], v38 offset:8704
    s_xor_b32 s96, s17, 28672
    s_add_u32 s20, s96, s19
    buffer_load_dwordx4 v[240:243], v2, s[32:35], s20 offen sc1
    s_waitcnt vmcnt(7)
    s_waitcnt lgkmcnt(6)
    v_mfma_f32_16x16x32_bf16 v[120:123], v[208:211], v[244:247], v[120:123]
    ds_read_b64_tr_b16 v[204:205], v39 offset:8192
    ds_read_b64_tr_b16 v[206:207], v39 offset:8704
    v_mfma_f32_16x16x32_bf16 v[124:127], v[212:215], v[244:247], v[124:127]
    ds_read_b64_tr_b16 v[208:209], v36 offset:12288
    ds_read_b64_tr_b16 v[210:211], v36 offset:12800
    v_xor_b32 v36, 49152, v36
    v_mfma_f32_16x16x32_bf16 v[128:131], v[216:219], v[244:247], v[128:131]
    ds_read_b64_tr_b16 v[212:213], v37 offset:12288
    ds_read_b64_tr_b16 v[214:215], v37 offset:12800
    v_xor_b32 v37, 49152, v37
    v_mfma_f32_16x16x32_bf16 v[132:135], v[220:223], v[244:247], v[132:135]
    ds_read_b64_tr_b16 v[216:217], v38 offset:12288
    ds_read_b64_tr_b16 v[218:219], v38 offset:12800
    v_xor_b32 v38, 49152, v38
    buffer_load_dwordx4 v[244:247], v2, s[32:35], s20 offen offset:1024 sc1
    s_waitcnt vmcnt(7)
    s_waitcnt lgkmcnt(6)
    v_mfma_f32_16x16x32_bf16 v[120:123], v[192:195], v[44:47], v[120:123]
    ds_read_b64_tr_b16 v[220:221], v39 offset:12288
    ds_read_b64_tr_b16 v[222:223], v39 offset:12800
    v_xor_b32 v39, 49152, v39
    v_mfma_f32_16x16x32_bf16 v[124:127], v[196:199], v[44:47], v[124:127]
    ds_read_b64_tr_b16 v[192:193], v36
    ds_read_b64_tr_b16 v[194:195], v36 offset:512
    v_mfma_f32_16x16x32_bf16 v[128:131], v[200:203], v[44:47], v[128:131]
    ds_read_b64_tr_b16 v[196:197], v37
    ds_read_b64_tr_b16 v[198:199], v37 offset:512
    v_mfma_f32_16x16x32_bf16 v[132:135], v[204:207], v[44:47], v[132:135]
    ds_read_b64_tr_b16 v[200:201], v38
    ds_read_b64_tr_b16 v[202:203], v38 offset:512
    buffer_load_dwordx4 v[44:47], v2, s[32:35], s20 offen offset:2048 sc1
    s_waitcnt vmcnt(7)
    s_waitcnt lgkmcnt(6)
    v_mfma_f32_16x16x32_bf16 v[120:123], v[208:211], v[48:51], v[120:123]
    ds_read_b64_tr_b16 v[204:205], v39
    ds_read_b64_tr_b16 v[206:207], v39 offset:512
    v_mfma_f32_16x16x32_bf16 v[124:127], v[212:215], v[48:51], v[124:127]
    ds_read_b64_tr_b16 v[208:209], v36 offset:4096
    ds_read_b64_tr_b16 v[210:211], v36 offset:4608
    v_mfma_f32_16x16x32_bf16 v[128:131], v[216:219], v[48:51], v[128:131]
    ds_read_b64_tr_b16 v[212:213], v37 offset:4096
    ds_read_b64_tr_b16 v[214:215], v37 offset:4608
    v_mfma_f32_16x16x32_bf16 v[132:135], v[220:223], v[48:51], v[132:135]
    ds_read_b64_tr_b16 v[216:217], v38 offset:4096
    ds_read_b64_tr_b16 v[218:219], v38 offset:4608
    buffer_load_dwordx4 v[48:51], v2, s[32:35], s20 offen offset:3072 sc1
    buffer_load_dwordx2 v[40:41], v10, s[32:35], s13 offen sc1
    s_mov_b32 s82, s80
    buffer_load_dwordx4 v[88:91], v27, s[56:59], s82 offen nt
    s_add_u32 s82, s80, 57344
    buffer_load_dwordx4 v[92:95], v27, s[56:59], s82 offen nt
    s_waitcnt vmcnt(10)
    s_waitcnt lgkmcnt(6)
    v_mfma_f32_16x16x32_bf16 v[120:123], v[192:195], v[224:227], v[120:123]
    ds_read_b64_tr_b16 v[220:221], v39 offset:4096
    ds_read_b64_tr_b16 v[222:223], v39 offset:4608
    v_mfma_f32_16x16x32_bf16 v[124:127], v[196:199], v[224:227], v[124:127]
    ds_read_b64_tr_b16 v[192:193], v36 offset:8192
    ds_read_b64_tr_b16 v[194:195], v36 offset:8704
    v_mfma_f32_16x16x32_bf16 v[128:131], v[200:203], v[224:227], v[128:131]
    ds_read_b64_tr_b16 v[196:197], v37 offset:8192
    ds_read_b64_tr_b16 v[198:199], v37 offset:8704
    v_mfma_f32_16x16x32_bf16 v[132:135], v[204:207], v[224:227], v[132:135]
    ds_read_b64_tr_b16 v[200:201], v38 offset:8192
    ds_read_b64_tr_b16 v[202:203], v38 offset:8704
    s_waitcnt vmcnt(9)
    s_waitcnt lgkmcnt(6)
    v_mfma_f32_16x16x32_bf16 v[120:123], v[208:211], v[228:231], v[120:123]
    ds_read_b64_tr_b16 v[204:205], v39 offset:8192
    ds_read_b64_tr_b16 v[206:207], v39 offset:8704
    v_mfma_f32_16x16x32_bf16 v[124:127], v[212:215], v[228:231], v[124:127]
    ds_read_b64_tr_b16 v[208:209], v36 offset:12288
    ds_read_b64_tr_b16 v[210:211], v36 offset:12800
    v_xor_b32 v36, 16384, v36
    v_mfma_f32_16x16x32_bf16 v[128:131], v[216:219], v[228:231], v[128:131]
    ds_read_b64_tr_b16 v[212:213], v37 offset:12288
    ds_read_b64_tr_b16 v[214:215], v37 offset:12800
    v_xor_b32 v37, 16384, v37
    v_mfma_f32_16x16x32_bf16 v[132:135], v[220:223], v[228:231], v[132:135]
    ds_read_b64_tr_b16 v[216:217], v38 offset:12288
    ds_read_b64_tr_b16 v[218:219], v38 offset:12800
    v_xor_b32 v38, 16384, v38
    s_waitcnt vmcnt(8)
    s_waitcnt lgkmcnt(6)
    v_mfma_f32_16x16x32_bf16 v[120:123], v[192:195], v[232:235], v[120:123]
    ds_read_b64_tr_b16 v[220:221], v39 offset:12288
    ds_read_b64_tr_b16 v[222:223], v39 offset:12800
    v_xor_b32 v39, 16384, v39
    v_mfma_f32_16x16x32_bf16 v[124:127], v[196:199], v[232:235], v[124:127]
    ds_read_b64_tr_b16 v[192:193], v36
    ds_read_b64_tr_b16 v[194:195], v36 offset:512
    v_mfma_f32_16x16x32_bf16 v[128:131], v[200:203], v[232:235], v[128:131]
    ds_read_b64_tr_b16 v[196:197], v37
    ds_read_b64_tr_b16 v[198:199], v37 offset:512
    v_mfma_f32_16x16x32_bf16 v[132:135], v[204:207], v[232:235], v[132:135]
    ds_read_b64_tr_b16 v[200:201], v38
    ds_read_b64_tr_b16 v[202:203], v38 offset:512
    s_waitcnt vmcnt(7)
    s_waitcnt lgkmcnt(6)
    v_mfma_f32_16x16x32_bf16 v[120:123], v[208:211], v[236:239], v[120:123]
    ds_read_b64_tr_b16 v[204:205], v39
    ds_read_b64_tr_b16 v[206:207], v39 offset:512
    v_mfma_f32_16x16x32_bf16 v[124:127], v[212:215], v[236:239], v[124:127]
    ds_read_b64_tr_b16 v[208:209], v36 offset:4096
    ds_read_b64_tr_b16 v[210:211], v36 offset:4608
    v_mfma_f32_16x16x32_bf16 v[128:131], v[216:219], v[236:239], v[128:131]
    ds_read_b64_tr_b16 v[212:213], v37 offset:4096
    ds_read_b64_tr_b16 v[214:215], v37 offset:4608
    v_mfma_f32_16x16x32_bf16 v[132:135], v[220:223], v[236:239], v[132:135]
    ds_read_b64_tr_b16 v[216:217], v38 offset:4096
    ds_read_b64_tr_b16 v[218:219], v38 offset:4608
    s_waitcnt vmcnt(6)
    s_waitcnt lgkmcnt(6)
    v_mfma_f32_16x16x32_bf16 v[120:123], v[192:195], v[240:243], v[120:123]
    ds_read_b64_tr_b16 v[220:221], v39 offset:4096
    ds_read_b64_tr_b16 v[222:223], v39 offset:4608
    v_mfma_f32_16x16x32_bf16 v[124:127], v[196:199], v[240:243], v[124:127]
    ds_read_b64_tr_b16 v[192:193], v36 offset:8192
    ds_read_b64_tr_b16 v[194:195], v36 offset:8704
    v_mfma_f32_16x16x32_bf16 v[128:131], v[200:203], v[240:243], v[128:131]
    ds_read_b64_tr_b16 v[196:197], v37 offset:8192
    ds_read_b64_tr_b16 v[198:199], v37 offset:8704
    v_mfma_f32_16x16x32_bf16 v[132:135], v[204:207], v[240:243], v[132:135]
    ds_read_b64_tr_b16 v[200:201], v38 offset:8192
    ds_read_b64_tr_b16 v[202:203], v38 offset:8704
    s_waitcnt vmcnt(5)
    s_waitcnt lgkmcnt(6)
    v_mfma_f32_16x16x32_bf16 v[120:123], v[208:211], v[244:247], v[120:123]
    ds_read_b64_tr_b16 v[204:205], v39 offset:8192
    ds_read_b64_tr_b16 v[206:207], v39 offset:8704
    v_mfma_f32_16x16x32_bf16 v[124:127], v[212:215], v[244:247], v[124:127]
    ds_read_b64_tr_b16 v[208:209], v36 offset:12288
    ds_read_b64_tr_b16 v[210:211], v36 offset:12800
    v_mfma_f32_16x16x32_bf16 v[128:131], v[216:219], v[244:247], v[128:131]
    ds_read_b64_tr_b16 v[212:213], v37 offset:12288
    ds_read_b64_tr_b16 v[214:215], v37 offset:12800
    v_mfma_f32_16x16x32_bf16 v[132:135], v[220:223], v[244:247], v[132:135]
    ds_read_b64_tr_b16 v[216:217], v38 offset:12288
    ds_read_b64_tr_b16 v[218:219], v38 offset:12800
    s_waitcnt vmcnt(4)
    s_waitcnt lgkmcnt(6)
    v_mfma_f32_16x16x32_bf16 v[120:123], v[192:195], v[44:47], v[120:123]
    ds_read_b64_tr_b16 v[220:221], v39 offset:12288
    ds_read_b64_tr_b16 v[222:223], v39 offset:12800
    v_mfma_f32_16x16x32_bf16 v[124:127], v[196:199], v[44:47], v[124:127]
    v_mfma_f32_16x16x32_bf16 v[128:131], v[200:203], v[44:47], v[128:131]
    v_mfma_f32_16x16x32_bf16 v[132:135], v[204:207], v[44:47], v[132:135]
    s_waitcnt vmcnt(3)
    s_waitcnt lgkmcnt(0)
    v_mfma_f32_16x16x32_bf16 v[120:123], v[208:211], v[48:51], v[120:123]
    v_mfma_f32_16x16x32_bf16 v[124:127], v[212:215], v[48:51], v[124:127]
    v_mfma_f32_16x16x32_bf16 v[128:131], v[216:219], v[48:51], v[128:131]
    v_mfma_f32_16x16x32_bf16 v[132:135], v[220:223], v[48:51], v[132:135]
    s_lshl3_add_u32 s96, s21, s3
    s_lshl4_add_u32 s97, s96, s12
    s_lshl_b32 s98, s97, 8
    s_add_u32 s14, s98, 12582912
    v_and_b32 v28, 15, v1
    v_lshlrev_b32 v28, 4, v28
    v_lshrrev_b32 v9, 4, v1
    v_lshl_add_u32 v28, v9, 2, v28
    v_cvt_pk_bf16_f32 v120, 0, v120
    v_cvt_pk_bf16_f32 v121, 0, v121
    v_cvt_pk_bf16_f32 v122, 0, v122
    v_cvt_pk_bf16_f32 v123, 0, v123
    v_cvt_pk_bf16_f32 v124, 0, v124
    v_cvt_pk_bf16_f32 v125, 0, v125
    v_cvt_pk_bf16_f32 v126, 0, v126
    v_cvt_pk_bf16_f32 v127, 0, v127
    v_pk_mul_f32 v[120:121], v[120:121], v[136:137]
    v_pk_mul_f32 v[122:123], v[122:123], v[138:139]
    v_pk_mul_f32 v[124:125], v[124:125], v[140:141]
    v_pk_mul_f32 v[126:127], v[126:127], v[142:143]
    v_cvt_pk_bf16_f32 v120, 0, v120
    v_cvt_pk_bf16_f32 v121, 0, v121
    v_cvt_pk_bf16_f32 v122, 0, v122
    v_cvt_pk_bf16_f32 v123, 0, v123
    v_cvt_pk_bf16_f32 v124, 0, v124
    v_cvt_pk_bf16_f32 v125, 0, v125
    v_cvt_pk_bf16_f32 v126, 0, v126
    v_cvt_pk_bf16_f32 v127, 0, v127
    v_pk_add_f32 v[120:121], v[120:121], v[152:153]
    v_pk_add_f32 v[122:123], v[122:123], v[154:155]
    v_pk_add_f32 v[124:125], v[124:125], v[156:157]
    v_pk_add_f32 v[126:127], v[126:127], v[158:159]
    v_cvt_pk_bf16_f32 v12, v120, v121
    v_cvt_pk_bf16_f32 v13, v122, v123
    v_cvt_pk_bf16_f32 v14, v124, v125
    v_cvt_pk_bf16_f32 v15, v126, v127
    v_dot2_f32_bf16 v4, v12, v12, 0
    v_dot2_f32_bf16 v5, v13, v13, 0
    v_dot2_f32_bf16 v4, v14, v14, v4
    v_dot2_f32_bf16 v5, v15, v15, v5
    v_mfma_f32_16x16x32_bf16 v[240:243], v[184:187], v[12:15], 0
    v_cvt_pk_bf16_f32 v128, 0, v128
    v_cvt_pk_bf16_f32 v129, 0, v129
    v_cvt_pk_bf16_f32 v130, 0, v130
    v_cvt_pk_bf16_f32 v131, 0, v131
    v_cvt_pk_bf16_f32 v132, 0, v132
    v_cvt_pk_bf16_f32 v133, 0, v133
    v_cvt_pk_bf16_f32 v134, 0, v134
    v_cvt_pk_bf16_f32 v135, 0, v135
    v_pk_mul_f32 v[128:129], v[128:129], v[144:145]
    v_pk_mul_f32 v[130:131], v[130:131], v[146:147]
    v_pk_mul_f32 v[132:133], v[132:133], v[148:149]
    v_pk_mul_f32 v[134:135], v[134:135], v[150:151]
    v_cvt_pk_bf16_f32 v128, 0, v128
    v_cvt_pk_bf16_f32 v129, 0, v129
    v_cvt_pk_bf16_f32 v130, 0, v130
    v_cvt_pk_bf16_f32 v131, 0, v131
    v_cvt_pk_bf16_f32 v132, 0, v132
    v_cvt_pk_bf16_f32 v133, 0, v133
    v_cvt_pk_bf16_f32 v134, 0, v134
    v_cvt_pk_bf16_f32 v135, 0, v135
    v_pk_add_f32 v[128:129], v[128:129], v[160:161]
    v_pk_add_f32 v[130:131], v[130:131], v[162:163]
    v_pk_add_f32 v[132:133], v[132:133], v[164:165]
    v_pk_add_f32 v[134:135], v[134:135], v[166:167]
    v_cvt_pk_bf16_f32 v16, v128, v129
    v_cvt_pk_bf16_f32 v17, v130, v131
    v_cvt_pk_bf16_f32 v18, v132, v133
    v_cvt_pk_bf16_f32 v19, v134, v135
    v_dot2_f32_bf16 v4, v16, v16, v4
    v_dot2_f32_bf16 v5, v17, v17, v5
    v_dot2_f32_bf16 v4, v18, v18, v4
    v_dot2_f32_bf16 v5, v19, v19, v5
    v_mfma_f32_16x16x32_bf16 v[240:243], v[188:191], v[16:19], v[240:243]
    v_and_b32 v7, 7, v1
    v_lshlrev_b32 v7, 15, v7
    v_bfe_u32 v9, v1, 3, 1
    v_lshl_add_u32 v7, v9, 12, v7
    v_add_f32 v4, v4, v5
    v_mov_b32 v5, v4
    s_nop 1
    v_permlane32_swap_b32 v4, v5
    v_add_f32 v4, v4, v5
    v_mov_b32 v5, v4
    s_nop 1
    v_permlane16_swap_b32 v4, v5
    v_add_f32 v4, v4, v5
    s_nop 1
    v_mov_b32_dpp v240, v4 quad_perm:[0,1,2,3] row_mask:0x8 bank_mask:0xf
    buffer_store_dword v240, v28, s[32:35], s14 offen sc1
    s_and_b32 s96, s12, 1
    s_lshr_b32 s97, s21, 2
    s_and_b32 s98, s21, 3
    s_lshl_b32 s99, s98, 6
    s_lshl1_add_u32 s98, s97, s99
    s_lshl_b32 s97, s98, 12
    s_lshr_b32 s99, s12, 1
    s_lshl_b32 s98, s99, 6
    s_add_u32 s99, s97, s98
    s_lshl2_add_u32 s97, s96, s99
    s_add_u32 s98, s97, 1048576
    s_add_u32 s16, s98, 1536
    s_barrier
    s_cmp_lg_u32 s3, 0
    s_cbranch_scc1 L_PE
    v_mov_b32 v6, s4
    s_mov_b32 exec_hi, 0
    s_mov_b32 exec_lo, 65535
    buffer_store_dword v6, v7, s[32:35], s16 offen sc1
    s_mov_b64 exec, -1
L_PE:
    s_add_u32 s82, s80, 114688
    s_lshl2_add_u32 m0, s83, 34816
    s_nop 0
    buffer_load_dwordx4 v27, s[56:59], s82 offen nt lds
    s_add_u32 s82, s80, 172032
    s_lshl2_add_u32 m0, s83, 35840
    s_nop 0
    buffer_load_dwordx4 v27, s[56:59], s82 offen nt lds
    s_lshl_b32 s15, s3, 12
    v_add_u32 v4, s15, v2
    v_add_u32 v7, 65536, v4
    s_waitcnt vmcnt(5)
    v_cmp_ne_u32 vcc, s4, v41
    s_cbranch_vccz L_UPOK
POLL_31:
    buffer_load_dwordx2 v[40:41], v10, s[32:35], s13 offen sc1
    s_waitcnt vmcnt(0)
    v_cmp_ne_u32 vcc, s4, v41
    s_cbranch_vccz PDONE_32
    s_add_u32 s5, s5, 1
    s_cmp_lt_u32 s5, 200000
    s_cbranch_scc1 POLL_31
PDONE_32:
L_UPOK:
    s_lshl3_add_u32 s96, s21, s3
    s_lshl_b32 s97, s96, 12
    s_add_u32 s14, s97, 12582912
    s_load_dwordx2 s[24:25], s[32:33], s92 offset:1536 glc
    v_add_f32_dpp v40, v40, v40 quad_perm:[1,0,3,2] row_mask:0xf bank_mask:0xf
    s_nop 1
    v_add_f32_dpp v40, v40, v40 quad_perm:[2,3,0,1] row_mask:0xf bank_mask:0xf
    s_nop 1
    v_add_f32_dpp v40, v40, v40 row_half_mirror row_mask:0xf bank_mask:0xf
    s_nop 1
    v_add_f32_dpp v40, v40, v40 row_mirror row_mask:0xf bank_mask:0xf
    v_lshlrev_b32 v152, 16, v12
    v_and_b32 v153, s6, v12
    v_lshlrev_b32 v154, 16, v13
    v_and_b32 v155, s6, v13
    v_lshlrev_b32 v156, 16, v14
    v_and_b32 v157, s6, v14
    v_lshlrev_b32 v158, 16, v15
    v_and_b32 v159, s6, v15
    v_lshlrev_b32 v160, 16, v16
    v_and_b32 v161, s6, v16
    v_lshlrev_b32 v162, 16, v17
    v_and_b32 v163, s6, v17
    v_lshlrev_b32 v164, 16, v18
    v_and_b32 v165, s6, v18
    v_lshlrev_b32 v166, 16, v19
    v_and_b32 v167, s6, v19
    s_lshl_b32 s96, s3, 9
    s_lshl1_add_u32 s15, s21, s96
    v_and_b32 v29, 15, v1
    v_lshl_add_u32 v29, v29, 5, s15
    v_xor_b32 v5, 0x4000, v4
    v_xor_b32 v8, 0x4000, v7
    s_waitcnt vmcnt(3)
    ds_write_b128 v4, v[88:91] offset:32768
    ds_write_b128 v4, v[92:95] offset:33792
    s_cmp_lt_u32 s3, 4
    s_cbranch_scc1 L_FW1
    ds_write_b128 v4, v[56:59] offset:0
    ds_write_b128 v5, v[60:63] offset:0
    ds_write_b128 v4, v[64:67] offset:1024
    ds_write_b128 v5, v[68:71] offset:1024
    ds_write_b128 v4, v[72:75] offset:2048
    ds_write_b128 v5, v[76:79] offset:2048
    ds_write_b128 v4, v[80:83] offset:3072
    ds_write_b128 v5, v[84:87] offset:3072
L_FW1:
    s_branch SCHK_34
SPOLL_33:
    s_load_dwordx2 s[24:25], s[32:33], s92 offset:1536 glc
SCHK_34:
    s_add_u32 s5, s5, 1
    s_cmp_ge_u32 s5, 200000
    s_waitcnt lgkmcnt(0)
    s_cbranch_scc1 SDONE_35
    s_cmp_lg_u32 s24, s4
    s_cbranch_scc1 SPOLL_33
    s_cmp_lg_u32 s25, s4
    s_cbranch_scc1 SPOLL_33
SDONE_35:
    s_barrier
    buffer_load_dwordx4 v[192:195], v2, s[32:35], s14 offen sc1
    buffer_load_dwordx4 v[196:199], v2, s[32:35], s14 offen offset:1024 sc1
    buffer_load_dwordx4 v[200:203], v2, s[32:35], s14 offen offset:2048 sc1
    buffer_load_dwordx4 v[204:207], v2, s[32:35], s14 offen offset:3072 sc1
    s_barrier
    s_mov_b32 s82, s81
    s_lshl2_add_u32 m0, s83, 65536
    s_nop 0
    buffer_load_dwordx4 v253, s[60:63], s82 offen nt lds
    s_add_u32 s82, s81, 4096
    s_lshl2_add_u32 m0, s83, 66560
    s_nop 0
    buffer_load_dwordx4 v253, s[60:63], s82 offen nt lds
    s_add_u32 s82, s81, 8192
    s_lshl2_add_u32 m0, s83, 67584
    s_nop 0
    buffer_load_dwordx4 v253, s[60:63], s82 offen nt lds
    s_add_u32 s82, s81, 12288
    s_lshl2_add_u32 m0, s83, 68608
    s_nop 0
    buffer_load_dwordx4 v253, s[60:63], s82 offen nt lds
    v_mov_b32_dpp v88, v42 row_newbcast:0 row_mask:0xf bank_mask:0xf
    v_mov_b32_dpp v89, v42 row_newbcast:1 row_mask:0xf bank_mask:0xf
    v_mov_b32_dpp v90, v42 row_newbcast:2 row_mask:0xf bank_mask:0xf
    v_mov_b32_dpp v91, v42 row_newbcast:3 row_mask:0xf bank_mask:0xf
    v_mov_b32_dpp v92, v42 row_newbcast:4 row_mask:0xf bank_mask:0xf
    v_mov_b32_dpp v93, v42 row_newbcast:5 row_mask:0xf bank_mask:0xf
    v_mov_b32_dpp v94, v42 row_newbcast:6 row_mask:0xf bank_mask:0xf
    v_mov_b32_dpp v95, v42 row_newbcast:7 row_mask:0xf bank_mask:0xf
    v_mov_b32_dpp v96, v42 row_newbcast:8 row_mask:0xf bank_mask:0xf
    v_mov_b32_dpp v97, v42 row_newbcast:9 row_mask:0xf bank_mask:0xf
    v_mov_b32_dpp v98, v42 row_newbcast:10 row_mask:0xf bank_mask:0xf
    v_mov_b32_dpp v99, v42 row_newbcast:11 row_mask:0xf bank_mask:0xf
    v_mov_b32_dpp v100, v42 row_newbcast:12 row_mask:0xf bank_mask:0xf
    v_mov_b32_dpp v101, v42 row_newbcast:13 row_mask:0xf bank_mask:0xf
    v_mov_b32_dpp v102, v42 row_newbcast:14 row_mask:0xf bank_mask:0xf
    v_mov_b32_dpp v103, v42 row_newbcast:15 row_mask:0xf bank_mask:0xf
    v_mov_b32_dpp v104, v43 row_newbcast:0 row_mask:0xf bank_mask:0xf
    v_mov_b32_dpp v105, v43 row_newbcast:1 row_mask:0xf bank_mask:0xf
    v_mov_b32_dpp v106, v43 row_newbcast:2 row_mask:0xf bank_mask:0xf
    v_mov_b32_dpp v107, v43 row_newbcast:3 row_mask:0xf bank_mask:0xf
    v_mov_b32_dpp v108, v43 row_newbcast:4 row_mask:0xf bank_mask:0xf
    v_mov_b32_dpp v109, v43 row_newbcast:5 row_mask:0xf bank_mask:0xf
    v_mov_b32_dpp v110, v43 row_newbcast:6 row_mask:0xf bank_mask:0xf
    v_mov_b32_dpp v111, v43 row_newbcast:7 row_mask:0xf bank_mask:0xf
    v_mov_b32_dpp v112, v43 row_newbcast:8 row_mask:0xf bank_mask:0xf
    v_mov_b32_dpp v113, v43 row_newbcast:9 row_mask:0xf bank_mask:0xf
    v_mov_b32_dpp v114, v43 row_newbcast:10 row_mask:0xf bank_mask:0xf
    v_mov_b32_dpp v115, v43 row_newbcast:11 row_mask:0xf bank_mask:0xf
    v_mov_b32_dpp v116, v43 row_newbcast:12 row_mask:0xf bank_mask:0xf
    v_mov_b32_dpp v117, v43 row_newbcast:13 row_mask:0xf bank_mask:0xf
    v_mov_b32_dpp v118, v43 row_newbcast:14 row_mask:0xf bank_mask:0xf
    v_mov_b32_dpp v119, v43 row_newbcast:15 row_mask:0xf bank_mask:0xf
    s_lshl3_add_u32 s15, s3, 156160
    v_mov_b32 v4, s15
    v_and_b32 v5, 7, v1
    v_lshlrev_b32 v5, 3, v5
    v_add_u32 v5, 156160, v5
    v_and_b32 v6, 3, v1
    v_lshlrev_b32 v6, 18, v6
    v_bfe_u32 v9, v1, 2, 2
    v_lshl_add_u32 v6, v9, 13, v6
    s_and_b32 s96, s21, 1
    s_and_b32 s97, s12, 7
    s_lshr_b32 s98, s12, 3
    s_lshl3_add_u32 s99, s97, s98
    s_lshl_b32 s97, s99, 12
    s_lshr_b32 s98, s21, 1
    s_lshl_b32 s99, s98, 6
    s_add_u32 s98, s97, s99
    s_lshl4_add_u32 s97, s96, s98
    s_add_u32 s99, s97, 1048576
L_PAD9:
    s_cbranch_execz L_RET9
    s_add_u32 s16, s99, 2560
    s_waitcnt vmcnt(4)
    v_pk_add_f32 v[192:193], v[192:193], v[196:197]
    v_pk_add_f32 v[200:201], v[200:201], v[204:205]
    v_pk_add_f32 v[194:195], v[194:195], v[198:199]
    v_pk_add_f32 v[202:203], v[202:203], v[206:207]
    v_pk_add_f32 v[192:193], v[192:193], v[200:201]
    v_pk_add_f32 v[194:195], v[194:195], v[202:203]
    v_add_f32 v193, v193, v194
    v_add_f32 v197, v192, v195
    v_cmp_u_f32 vcc, v193, v197
    s_cbranch_vccz POK_37
PRE_38:
    buffer_load_dwordx4 v[192:195], v2, s[32:35], s14 offen sc1
    buffer_load_dwordx4 v[196:199], v2, s[32:35], s14 offen offset:1024 sc1
    buffer_load_dwordx4 v[200:203], v2, s[32:35], s14 offen offset:2048 sc1
    buffer_load_dwordx4 v[204:207], v2, s[32:35], s14 offen offset:3072 sc1
    s_waitcnt vmcnt(0)
    v_pk_add_f32 v[192:193], v[192:193], v[196:197]
    v_pk_add_f32 v[200:201], v[200:201], v[204:205]
    v_pk_add_f32 v[194:195], v[194:195], v[198:199]
    v_pk_add_f32 v[202:203], v[202:203], v[206:207]
    v_pk_add_f32 v[192:193], v[192:193], v[200:201]
    v_pk_add_f32 v[194:195], v[194:195], v[202:203]
    v_add_f32 v193, v193, v194
    v_add_f32 v197, v192, v195
    v_cmp_u_f32 vcc, v193, v197
    s_cbranch_vccz POK_37
    s_add_u32 s5, s5, 1
    s_cmp_lt_u32 s5, 200000
    s_cbranch_scc1 PRE_38
POK_37:
    v_mov_b32 v196, v195
    s_nop 1
    v_permlane32_swap_b32 v195, v196
    v_permlane32_swap_b32 v192, v193
    v_add_f32 v195, v195, v196
    v_add_f32 v192, v192, v193
    s_nop 1
    v_permlane16_swap_b32 v192, v195
    v_add_f32 v193, v192, v195
    v_add_f32 v195, v192, v195
    s_nop 1
    v_permlane16_swap_b32 v193, v195
    v_mov_b32 v192, v193
    v_mul_f32 v195, 0x3a800000, v195
    s_nop 0
    v_permlane32_swap_b32 v192, v193
    v_mul_f32 v192, 0x3a800000, v192
    v_fma_f32 v31, -v192, v192, v195
    v_cvt_pk_bf16_f32 v30, 0, v192
    v_max_f32 v31, 0, v31
    v_cvt_pk_bf16_f32 v31, 0, v31
    v_fma_f32 v193, -v30, v40, v193
    v_add_f32 v31, 0x3727c5ac, v31
    v_cvt_pk_bf16_f32 v31, 0, v31
    v_sqrt_f32 v31, v31
    s_nop 0
    v_cvt_pk_bf16_f32 v31, 0, v31
    v_rcp_f32 v31, v31
    s_nop 0
    v_mul_f32 v32, v193, v31
    v_ashrrev_i32 v196, 31, v32
    v_or_b32 v196, 0x80000000, v196
    v_xor_b32 v32, v32, v196
    s_mov_b32 s15, 0xfffff000
    v_and_or_b32 v32, v32, s15, v29
    s_nop 1
    v_max_u32_dpp v244, v32, v32 quad_perm:[1,0,3,2] row_mask:0xf bank_mask:0xf
    v_min_u32_dpp v245, v32, v32 quad_perm:[1,0,3,2] row_mask:0xf bank_mask:0xf
    s_nop 0
    v_min_u32_dpp v196, v244, v244 quad_perm:[2,3,0,1] row_mask:0xf bank_mask:0xf
    v_max_u32_dpp v245, v245, v245 quad_perm:[2,3,0,1] row_mask:0xf bank_mask:0xf
    v_max_u32_dpp v244, v244, v244 quad_perm:[2,3,0,1] row_mask:0xf bank_mask:0xf
    v_max_u32 v245, v245, v196
    s_nop 0
    v_min_u32_dpp v196, v244, v244 row_half_mirror row_mask:0xf bank_mask:0xf
    v_max_u32_dpp v245, v245, v245 row_half_mirror row_mask:0xf bank_mask:0xf
    v_max_u32_dpp v244, v244, v244 row_half_mirror row_mask:0xf bank_mask:0xf
    v_max_u32 v245, v245, v196
    s_nop 0
    v_min_u32_dpp v196, v244, v244 row_mirror row_mask:0xf bank_mask:0xf
    v_max_u32_dpp v245, v245, v245 row_mirror row_mask:0xf bank_mask:0xf
    v_max_u32_dpp v244, v244, v244 row_mirror row_mask:0xf bank_mask:0xf
    v_max_u32 v245, v245, v196
    ds_write_b64 v4, v[244:245]
    s_waitcnt lgkmcnt(0)
    s_barrier
    ds_read_b64 v[244:245], v5
    v_pk_add_f32 v[208:209], v[152:153], v[30:31] op_sel_hi:[1,0] neg_lo:[0,1] neg_hi:[0,1]
    v_pk_add_f32 v[210:211], v[154:155], v[30:31] op_sel_hi:[1,0] neg_lo:[0,1] neg_hi:[0,1]
    v_pk_add_f32 v[212:213], v[156:157], v[30:31] op_sel_hi:[1,0] neg_lo:[0,1] neg_hi:[0,1]
    v_pk_add_f32 v[214:215], v[158:159], v[30:31] op_sel_hi:[1,0] neg_lo:[0,1] neg_hi:[0,1]
    v_pk_add_f32 v[216:217], v[160:161], v[30:31] op_sel_hi:[1,0] neg_lo:[0,1] neg_hi:[0,1]
    v_pk_add_f32 v[218:219], v[162:163], v[30:31] op_sel_hi:[1,0] neg_lo:[0,1] neg_hi:[0,1]
    v_pk_add_f32 v[220:221], v[164:165], v[30:31] op_sel_hi:[1,0] neg_lo:[0,1] neg_hi:[0,1]
    v_pk_add_f32 v[222:223], v[166:167], v[30:31] op_sel_hi:[1,0] neg_lo:[0,1] neg_hi:[0,1]
    s_waitcnt lgkmcnt(0)
    v_min_u32_dpp v196, v244, v244 quad_perm:[1,0,3,2] row_mask:0xf bank_mask:0xf
    v_max_u32_dpp v245, v245, v245 quad_perm:[1,0,3,2] row_mask:0xf bank_mask:0xf
    v_max_u32_dpp v244, v244, v244 quad_perm:[1,0,3,2] row_mask:0xf bank_mask:0xf
    v_max_u32 v245, v245, v196
    s_nop 0
    v_min_u32_dpp v196, v244, v244 quad_perm:[2,3,0,1] row_mask:0xf bank_mask:0xf
    v_max_u32_dpp v245, v245, v245 quad_perm:[2,3,0,1] row_mask:0xf bank_mask:0xf
    v_max_u32_dpp v244, v244, v244 quad_perm:[2,3,0,1] row_mask:0xf bank_mask:0xf
    v_max_u32 v245, v245, v196
    s_nop 0
    v_min_u32_dpp v196, v244, v244 row_half_mirror row_mask:0xf bank_mask:0xf
    v_max_u32_dpp v245, v245, v245 row_half_mirror row_mask:0xf bank_mask:0xf
    v_max_u32_dpp v244, v244, v244 row_half_mirror row_mask:0xf bank_mask:0xf
    v_max_u32 v245, v245, v196
    v_cmp_eq_u32 s[88:89], v32, v245
    v_cmp_eq_u32 vcc, v32, v244
    v_or_b32 v246, 1, v245
    v_mov_b32 v245, s4
    v_mov_b32 v247, s4
    s_or_b64 s[84:85], vcc, s[88:89]
    s_cmp_lg_u32 s3, 0
    s_cbranch_scc1 L_NOF
    s_mov_b64 exec, 0xffff
    buffer_store_dwordx4 v[244:247], v6, s[32:35], s16 offen sc1
    s_mov_b64 exec, -1
L_NOF:
    s_lshl4_add_u32 s13, s3, 156288
    v_mov_b32 v4, s13
    v_and_b32 v5, 7, v1
    v_lshlrev_b32 v5, 4, v5
    v_add_u32 v5, 156288, v5
    s_load_dwordx8 s[24:31], s[32:33], s92 offset:2560 glc
    v_cvt_pk_bf16_f32 v208, 0, v208
    v_cvt_pk_bf16_f32 v209, 0, v209
    v_cvt_pk_bf16_f32 v210, 0, v210
    v_cvt_pk_bf16_f32 v211, 0, v211
    v_cvt_pk_bf16_f32 v212, 0, v212
    v_cvt_pk_bf16_f32 v213, 0, v213
    v_cvt_pk_bf16_f32 v214, 0, v214
    v_cvt_pk_bf16_f32 v215, 0, v215
    v_cvt_pk_bf16_f32 v216, 0, v216
    v_cvt_pk_bf16_f32 v217, 0, v217
    v_cvt_pk_bf16_f32 v218, 0, v218
    v_cvt_pk_bf16_f32 v219, 0, v219
    v_cvt_pk_bf16_f32 v220, 0, v220
    v_cvt_pk_bf16_f32 v221, 0, v221
    v_cvt_pk_bf16_f32 v222, 0, v222
    v_cvt_pk_bf16_f32 v223, 0, v223
    v_pk_mul_f32 v[208:209], v[208:209], v[30:31] op_sel:[0,1]
    v_pk_mul_f32 v[210:211], v[210:211], v[30:31] op_sel:[0,1]
    v_pk_mul_f32 v[212:213], v[212:213], v[30:31] op_sel:[0,1]
    v_pk_mul_f32 v[214:215], v[214:215], v[30:31] op_sel:[0,1]
    v_pk_mul_f32 v[216:217], v[216:217], v[30:31] op_sel:[0,1]
    v_pk_mul_f32 v[218:219], v[218:219], v[30:31] op_sel:[0,1]
    v_pk_mul_f32 v[220:221], v[220:221], v[30:31] op_sel:[0,1]
    v_pk_mul_f32 v[222:223], v[222:223], v[30:31] op_sel:[0,1]
    v_cvt_pk_bf16_f32 v208, 0, v208
    v_cvt_pk_bf16_f32 v209, 0, v209
    v_cvt_pk_bf16_f32 v210, 0, v210
    v_cvt_pk_bf16_f32 v211, 0, v211
    v_cvt_pk_bf16_f32 v212, 0, v212
    v_cvt_pk_bf16_f32 v213, 0, v213
    v_cvt_pk_bf16_f32 v214, 0, v214
    v_cvt_pk_bf16_f32 v215, 0, v215
    v_cvt_pk_bf16_f32 v216, 0, v216
    v_cvt_pk_bf16_f32 v217, 0, v217
    v_cvt_pk_bf16_f32 v218, 0, v218
    v_cvt_pk_bf16_f32 v219, 0, v219
    v_cvt_pk_bf16_f32 v220, 0, v220
    v_cvt_pk_bf16_f32 v221, 0, v221
    v_cvt_pk_bf16_f32 v222, 0, v222
    v_cvt_pk_bf16_f32 v223, 0, v223
    v_pk_mul_f32 v[208:209], v[208:209], v[168:169]
    v_pk_mul_f32 v[210:211], v[210:211], v[170:171]
    v_pk_mul_f32 v[212:213], v[212:213], v[172:173]
    v_pk_mul_f32 v[214:215], v[214:215], v[174:175]
    v_pk_mul_f32 v[216:217], v[216:217], v[176:177]
    v_pk_mul_f32 v[218:219], v[218:219], v[178:179]
    v_pk_mul_f32 v[220:221], v[220:221], v[180:181]
    v_pk_mul_f32 v[222:223], v[222:223], v[182:183]
    v_cvt_pk_bf16_f32 v208, 0, v208
    v_cvt_pk_bf16_f32 v209, 0, v209
    v_cvt_pk_bf16_f32 v210, 0, v210
    v_cvt_pk_bf16_f32 v211, 0, v211
    v_cvt_pk_bf16_f32 v212, 0, v212
    v_cvt_pk_bf16_f32 v213, 0, v213
    v_cvt_pk_bf16_f32 v214, 0, v214
    v_cvt_pk_bf16_f32 v215, 0, v215
    v_cvt_pk_bf16_f32 v216, 0, v216
    v_cvt_pk_bf16_f32 v217, 0, v217
    v_cvt_pk_bf16_f32 v218, 0, v218
    v_cvt_pk_bf16_f32 v219, 0, v219
    v_cvt_pk_bf16_f32 v220, 0, v220
    v_cvt_pk_bf16_f32 v221, 0, v221
    v_cvt_pk_bf16_f32 v222, 0, v222
    v_cvt_pk_bf16_f32 v223, 0, v223
    v_pk_add_f32 v[208:209], v[208:209], v[88:89]
    v_pk_add_f32 v[210:211], v[210:211], v[90:91]
    v_pk_add_f32 v[212:213], v[212:213], v[92:93]
    v_pk_add_f32 v[214:215], v[214:215], v[94:95]
    v_pk_add_f32 v[216:217], v[216:217], v[96:97]
    v_pk_add_f32 v[218:219], v[218:219], v[98:99]
    v_pk_add_f32 v[220:221], v[220:221], v[100:101]
    v_pk_add_f32 v[222:223], v[222:223], v[102:103]
    v_cvt_pk_bf16_f32 v224, v208, v209
    v_cvt_pk_bf16_f32 v225, v210, v211
    v_cvt_pk_bf16_f32 v226, v212, v213
    v_cvt_pk_bf16_f32 v227, v214, v215
    v_cvt_pk_bf16_f32 v228, v216, v217
    v_cvt_pk_bf16_f32 v229, v218, v219
    v_cvt_pk_bf16_f32 v230, v220, v221
    v_cvt_pk_bf16_f32 v231, v222, v223
    s_cmp_eq_u64 s[84:85], 0
    s_cbranch_scc1 L_NOCAND
    v_mfma_f32_16x16x32_bf16 v[240:243], v[184:187], v[224:227], 0
    v_mfma_f32_16x16x32_bf16 v[240:243], v[188:191], v[228:231], v[240:243]
    v_mov_b32 v232, v224
    v_mov_b32 v233, v225
    v_mov_b32 v234, v226
    v_mov_b32 v235, v227
    v_mov_b32 v236, v228
    v_mov_b32 v237, v229
    v_mov_b32 v238, v230
    v_mov_b32 v239, v231
    s_lshl_b32 s96, s21, 14
    s_lshl_b32 s97, s12, 9
    s_add_u32 s98, s96, s97
    s_add_u32 s15, s98, 13631488
    v_lshrrev_b32 v7, 4, v1
    v_lshlrev_b32 v7, 4, v7
    v_add_u32 v8, 8192, v7
    v_permlane32_swap_b32 v232, v234
    v_permlane32_swap_b32 v233, v235
    v_permlane32_swap_b32 v236, v238
    v_permlane32_swap_b32 v237, v239
    v_permlane32_swap_b32 v12, v14
    v_permlane32_swap_b32 v13, v15
    v_permlane32_swap_b32 v16, v18
    v_permlane32_swap_b32 v17, v19
    v_cndmask_b32 v7, v7, v8, s[88:89]
    s_mov_b64 exec, s[84:85]
    buffer_store_dwordx4 v[232:235], v7, s[32:35], s15 offen sc1
    buffer_store_dwordx4 v[236:239], v7, s[32:35], s15 offen offset:64 sc1
    s_mov_b32 exec_lo, 0
    s_and_b32 exec_hi, s85, 0xffff0000
    buffer_store_dword v240, v7, s[32:35], s15 offen offset:208 sc1
    s_mov_b64 exec, s[84:85]
    buffer_store_dwordx4 v[12:15], v7, s[32:35], s15 offen offset:128 sc1
    buffer_store_dwordx4 v[16:19], v7, s[32:35], s15 offen offset:192 sc1
    s_mov_b64 exec, -1
L_NOCAND:
    v_lshlrev_b32 v208, 16, v224
    v_and_b32 v209, s6, v224
    v_lshlrev_b32 v210, 16, v225
    v_and_b32 v211, s6, v225
    v_lshlrev_b32 v212, 16, v226
    v_and_b32 v213, s6, v226
    v_lshlrev_b32 v214, 16, v227
    v_and_b32 v215, s6, v227
    v_lshlrev_b32 v216, 16, v228
    v_and_b32 v217, s6, v228
    v_lshlrev_b32 v218, 16, v229
    v_and_b32 v219, s6, v229
    v_lshlrev_b32 v220, 16, v230
    v_and_b32 v221, s6, v230
    v_lshlrev_b32 v222, 16, v231
    v_and_b32 v223, s6, v231
    v_pk_mul_f32 v[208:209], v[208:209], v[104:105]
    v_pk_mul_f32 v[210:211], v[210:211], v[106:107]
    v_pk_mul_f32 v[212:213], v[212:213], v[108:109]
    v_pk_mul_f32 v[214:215], v[214:215], v[110:111]
    v_pk_mul_f32 v[216:217], v[216:217], v[112:113]
    v_pk_mul_f32 v[218:219], v[218:219], v[114:115]
    v_pk_mul_f32 v[220:221], v[220:221], v[116:117]
    v_pk_mul_f32 v[222:223], v[222:223], v[118:119]
    v_cvt_pk_bf16_f32 v208, 0, v208
    v_cvt_pk_bf16_f32 v209, 0, v209
    v_cvt_pk_bf16_f32 v210, 0, v210
    v_cvt_pk_bf16_f32 v211, 0, v211
    v_cvt_pk_bf16_f32 v212, 0, v212
    v_cvt_pk_bf16_f32 v213, 0, v213
    v_cvt_pk_bf16_f32 v214, 0, v214
    v_cvt_pk_bf16_f32 v215, 0, v215
    v_cvt_pk_bf16_f32 v216, 0, v216
    v_cvt_pk_bf16_f32 v217, 0, v217
    v_cvt_pk_bf16_f32 v218, 0, v218
    v_cvt_pk_bf16_f32 v219, 0, v219
    v_cvt_pk_bf16_f32 v220, 0, v220
    v_cvt_pk_bf16_f32 v221, 0, v221
    v_cvt_pk_bf16_f32 v222, 0, v222
    v_cvt_pk_bf16_f32 v223, 0, v223
    s_lshl_b32 s96, s3, 11
    s_add_u32 s13, s96, 98304
    v_lshrrev_b32 v202, 4, v1
    v_lshlrev_b32 v202, 4, v202
    v_and_b32 v203, 7, v1
    v_lshlrev_b32 v203, 4, v203
    v_xor_b32 v202, v202, v203
    v_and_b32 v204, 15, v1
    v_lshl_add_u32 v204, v204, 7, s13
    v_add_u32 v202, v202, v204
    v_xor_b32 v204, 64, v202
    v_lshrrev_b32 v205, 3, v1
    v_lshlrev_b32 v205, 4, v205
    v_xor_b32 v203, v205, v203
    v_lshrrev_b32 v205, 3, v1
    v_lshl_add_u32 v205, v205, 7, s13
    v_add_u32 v203, v203, v205
    s_lshl_b32 s96, s21, 7
    s_sub_u32 s97, 2047, s96
    s_lshl_b32 s98, s3, 4
    s_sub_u32 s13, s97, s98
    v_lshrrev_b32 v43, 3, v1
    v_sub_u32 v42, s13, v43
    v_subrev_u32 v43, 8, v42
    v_lshrrev_b32 v33, 3, v1
    v_lshlrev_b32 v33, 11, v33
    v_and_b32 v9, 7, v1
    v_lshl_add_u32 v33, v9, 4, v33
    s_lshl3_add_u32 s96, s21, s3
    s_lshl_b32 s97, s96, 15
    s_lshl_b32 s98, s12, 7
    s_add_u32 s16, s97, s98
    s_add_u32 s15, s16, 16384
    s_branch SCHK_40
SPOLL_39:
    s_load_dwordx8 s[24:31], s[32:33], s92 offset:2560 glc
SCHK_40:
    s_add_u32 s5, s5, 1
    s_cmp_ge_u32 s5, 200000
    s_waitcnt lgkmcnt(0)
    s_cbranch_scc1 SDONE_41
    s_cmp_lg_u32 s25, s4
    s_cbranch_scc1 SPOLL_39
    s_cmp_lg_u32 s27, s4
    s_cbranch_scc1 SPOLL_39
    s_cmp_lg_u32 s29, s4
    s_cbranch_scc1 SPOLL_39
    s_cmp_lg_u32 s31, s4
    s_cbranch_scc1 SPOLL_39
SDONE_41:
    s_min_u32 s25, s24, s28
    s_min_u32 s27, s26, s28
    s_min_u32 s29, s24, s30
    s_max_u32 s24, s24, s28
    s_max_u32 s26, s26, s30
    s_max_u32 s27, s27, s29
    s_max_u32 s25, s25, s26
    v_mov_b32 v244, s24
    v_mov_b32 v246, s27
    v_mov_b32 v245, s25
    ds_write_b128 v4, v[244:247]
    s_lshr_b32 s96, s3, 2
    s_lshl_b32 s97, s96, 15
    s_and_b32 s98, s3, 3
    s_lshl_b32 s99, s98, 5
    s_add_u32 s13, s97, s99
    v_lshrrev_b32 v34, 4, v1
    v_lshlrev_b32 v34, 13, v34
    v_bfe_u32 v9, v1, 2, 2
    v_lshl_add_u32 v34, v9, 7, v34
    v_bfe_u32 v9, v1, 3, 2
    v_lshl_add_u32 v34, v9, 5, v34
    v_and_b32 v9, 3, v1
    v_lshl_add_u32 v34, v9, 3, v34
    v_xor_b32 v34, s13, v34
    s_lshl_b32 s96, s75, 11
    s_add_u32 s13, s96, 13631488
    v_and_b32 v36, 7, v1
    v_lshl_add_u32 v36, v36, 4, s13
    v_lshrrev_b32 v9, 4, v1
    v_lshl_add_u32 v36, v9, 9, v36
    v_and_b32 v10, 15, v1
    v_lshlrev_b32 v10, 9, v10
    v_add_u32 v10, 13631744, v10
    s_waitcnt vmcnt(0)
    s_waitcnt lgkmcnt(0)
    s_barrier
    ds_read_b128 v[244:247], v5
    v_and_b32 v8, 8, v1
    v_cmp_eq_u32 s[22:23], 0, v8
    v_cmp_gt_u32 s[24:25], 16, v1
    v_cmp_gt_u32 s[26:27], 32, v1
    s_waitcnt lgkmcnt(0)
    v_min_u32_dpp v192, v244, v244 quad_perm:[1,0,3,2] row_mask:0xf bank_mask:0xf
    v_min_u32_dpp v193, v245, v244 quad_perm:[1,0,3,2] row_mask:0xf bank_mask:0xf
    v_min_u32_dpp v194, v244, v245 quad_perm:[1,0,3,2] row_mask:0xf bank_mask:0xf
    v_max_u32_dpp v246, v246, v246 quad_perm:[1,0,3,2] row_mask:0xf bank_mask:0xf
    v_max_u32_dpp v245, v245, v245 quad_perm:[1,0,3,2] row_mask:0xf bank_mask:0xf
    v_max_u32_dpp v244, v244, v244 quad_perm:[1,0,3,2] row_mask:0xf bank_mask:0xf
    v_max3_u32 v246, v246, v193, v194
    v_max_u32 v245, v245, v192
    v_min_u32_dpp v192, v244, v244 quad_perm:[2,3,0,1] row_mask:0xf bank_mask:0xf
    s_nop 0
    v_min_u32_dpp v193, v245, v244 quad_perm:[2,3,0,1] row_mask:0xf bank_mask:0xf
    v_min_u32_dpp v194, v244, v245 quad_perm:[2,3,0,1] row_mask:0xf bank_mask:0xf
    v_max_u32_dpp v246, v246, v246 quad_perm:[2,3,0,1] row_mask:0xf bank_mask:0xf
    v_max_u32_dpp v245, v245, v245 quad_perm:[2,3,0,1] row_mask:0xf bank_mask:0xf
    v_max_u32_dpp v244, v244, v244 quad_perm:[2,3,0,1] row_mask:0xf bank_mask:0xf
    v_max3_u32 v246, v246, v193, v194
    v_max_u32 v245, v245, v192
    v_min_u32_dpp v192, v244, v244 row_half_mirror row_mask:0xf bank_mask:0xf
    s_nop 0
    v_min_u32_dpp v193, v245, v244 row_half_mirror row_mask:0xf bank_mask:0xf
    v_min_u32_dpp v194, v244, v245 row_half_mirror row_mask:0xf bank_mask:0xf
    v_max_u32_dpp v246, v246, v246 row_half_mirror row_mask:0xf bank_mask:0xf
    v_max_u32_dpp v245, v245, v245 row_half_mirror row_mask:0xf bank_mask:0xf
    v_max_u32_dpp v244, v244, v244 row_half_mirror row_mask:0xf bank_mask:0xf
    v_max3_u32 v246, v246, v193, v194
    v_max_u32 v245, v245, v192
    v_cndmask_b32 v192, v245, v244, s[22:23]
    v_cndmask_b32 v201, v246, v245, s[26:27]
    v_and_b32 v193, 31, v246
    v_and_b32 v192, 31, v192
    v_cndmask_b32 v201, v201, v244, s[24:25]
    v_lshl_add_u32 v4, v192, 13, v36
    v_lshl_add_u32 v5, v193, 13, v36
    v_and_b32 v194, 31, v201
    v_lshl_add_u32 v6, v194, 13, v10
    buffer_load_dwordx4 v[192:195], v4, s[32:35], 0 offen sc1
    buffer_load_dwordx4 v[196:199], v5, s[32:35], 0 offen sc1
    buffer_load_dword v200, v6, s[32:35], 0 offen sc1
    s_barrier
    v_readfirstlane_b32 s91, v244
    v_readfirstlane_b32 s94, v245
    v_readfirstlane_b32 s95, v246
    ds_read_b64_tr_b16 v[56:57], v34
    ds_read_b64_tr_b16 v[58:59], v34 offset:512
    ds_read_b64_tr_b16 v[60:61], v34 offset:1024
    ds_read_b64_tr_b16 v[62:63], v34 offset:1536
    ds_read_b64_tr_b16 v[64:65], v34 offset:2048
    ds_read_b64_tr_b16 v[66:67], v34 offset:2560
    ds_read_b64_tr_b16 v[68:69], v34 offset:3072
    ds_read_b64_tr_b16 v[70:71], v34 offset:3584
    ds_read_b64_tr_b16 v[72:73], v34 offset:4096
    ds_read_b64_tr_b16 v[74:75], v34 offset:4608
    ds_read_b64_tr_b16 v[76:77], v34 offset:5120
    ds_read_b64_tr_b16 v[78:79], v34 offset:5632
    ds_read_b64_tr_b16 v[80:81], v34 offset:6144
    ds_read_b64_tr_b16 v[82:83], v34 offset:6656
    ds_read_b64_tr_b16 v[84:85], v34 offset:7168
    ds_read_b64_tr_b16 v[86:87], v34 offset:7680
    s_bfe_u32 s96, s91, 262145
    s_lshl_b32 s97, s96, 7
    s_bfe_u32 s98, s91, 458757
    s_add_u32 s99, s97, s98
    s_xor_b32 s17, s99, 2047
    s_bfe_u32 s96, s94, 262145
    s_lshl_b32 s97, s96, 7
    s_bfe_u32 s98, s94, 458757
    s_add_u32 s99, s97, s98
    s_xor_b32 s18, s99, 2047
    s_bfe_u32 s96, s95, 262145
    s_lshl_b32 s97, s96, 7
    s_bfe_u32 s98, s95, 458757
    s_add_u32 s99, s97, s98
    s_xor_b32 s19, s99, 2047
    s_waitcnt lgkmcnt(0)
    s_lshl_b32 s13, s3, 6
    v_bfe_u32 v35, v1, 2, 1
    v_lshlrev_b32 v35, 9, v35
    v_bfe_u32 v9, v1, 3, 1
    v_lshl_add_u32 v35, v9, 12, v35
    v_lshrrev_b32 v9, 5, v1
    v_lshl_add_u32 v35, v9, 11, v35
    v_bfe_u32 v9, v1, 2, 2
    v_lshl_add_u32 v35, v9, 6, v35
    v_bfe_u32 v9, v1, 4, 1
    v_lshl_add_u32 v35, v9, 5, v35
    v_and_b32 v9, 3, v1
    v_lshl_add_u32 v35, v9, 3, v35
    v_xor_b32 v35, s13, v35
    v_add_u32 v35, 65536, v35
    v_and_b32 v8, 15, v1
    v_lshlrev_b32 v8, 4, v8
    v_lshrrev_b32 v9, 5, v1
    v_lshl_add_u32 v8, v9, 3, v8
    s_lshl_b32 s96, s74, 13
    s_add_u32 s14, s96, 20971520
    s_lshl3_add_u32 s96, s75, s3
    s_lshl_b32 s97, s96, 8
    s_add_u32 s20, s97, s14
    v_bfe_u32 v7, v201, 1, 4
    v_bfe_u32 v201, v201, 5, 7
    v_lshl_or_b32 v201, v7, 7, v201
    v_xor_b32 v201, 0x7ff, v201
    s_waitcnt vmcnt(0)
    v_max3_u32 v7, v192, v196, v200
    v_cmp_eq_u32 vcc, -1, v7
    s_cbranch_vccz POK_43
PRE_44:
    buffer_load_dwordx4 v[192:195], v4, s[32:35], 0 offen sc1
    buffer_load_dwordx4 v[196:199], v5, s[32:35], 0 offen sc1
    buffer_load_dword v200, v6, s[32:35], 0 offen sc1
    s_waitcnt vmcnt(0)
    v_max3_u32 v7, v192, v196, v200
    v_cmp_eq_u32 vcc, -1, v7
    s_cbranch_vccz POK_43
    s_add_u32 s5, s5, 1
    s_cmp_lt_u32 s5, 200000
    s_cbranch_scc1 PRE_44
POK_43:
    v_add_f32_dpp v200, v200, v200 quad_perm:[1,0,3,2] row_mask:0xf bank_mask:0xf
    s_nop 1
    v_add_f32_dpp v200, v200, v200 quad_perm:[2,3,0,1] row_mask:0xf bank_mask:0xf
    s_nop 1
    v_add_f32_dpp v200, v200, v200 row_half_mirror row_mask:0xf bank_mask:0xf
    s_nop 1
    v_add_f32_dpp v200, v200, v200 row_mirror row_mask:0xf bank_mask:0xf
    v_cvt_pk_bf16_f32 v200, 0, v200
    v_ashrrev_i32 v7, 31, v200
    v_or_b32 v7, 0x80000000, v7
    v_xor_b32 v200, v200, v7
    v_lshrrev_b32 v200, 16, v200
    v_lshl_or_b32 v200, v200, 11, v201
    s_nop 0
    v_readlane_b32 s24, v200, 0
    v_readlane_b32 s25, v200, 16
    v_readlane_b32 s26, v200, 32
    s_not_b64 s[28:29], s[22:23]
    s_cmp_lt_u32 s24, s25
    s_cselect_b64 s[28:29], s[22:23], s[28:29]
    s_cselect_b32 s27, s24, s25
    s_cmp_gt_u32 s26, s27
    s_cselect_b64 vcc, s[28:29], 0
    v_cndmask_b32 v192, v192, v196, vcc
    v_cndmask_b32 v193, v193, v197, vcc
    v_cndmask_b32 v194, v194, v198, vcc
    v_cndmask_b32 v195, v195, v199, vcc
    s_bitcmp1_b32 vcc_lo, 0
    s_cselect_b32 s24, s26, s24
    s_cselect_b32 s19, s17, s19
    s_cselect_b32 s17, s95, s91
    s_bitcmp1_b32 vcc_lo, 8
    s_cselect_b32 s25, s26, s25
    s_cselect_b32 s19, s18, s19
    s_cselect_b32 s18, s95, s94
    s_waitcnt lgkmcnt(0)
    v_mfma_f32_16x16x32_bf16 v[136:139], v[192:195], v[56:59], 0
    v_mfma_f32_16x16x32_bf16 v[140:143], v[192:195], v[60:63], 0
    v_mfma_f32_16x16x32_bf16 v[144:147], v[192:195], v[64:67], 0
    v_mfma_f32_16x16x32_bf16 v[148:151], v[192:195], v[68:71], 0
    v_mfma_f32_16x16x32_bf16 v[168:171], v[192:195], v[72:75], 0
    v_mfma_f32_16x16x32_bf16 v[172:175], v[192:195], v[76:79], 0
    v_mfma_f32_16x16x32_bf16 v[176:179], v[192:195], v[80:83], 0
    v_mfma_f32_16x16x32_bf16 v[180:183], v[192:195], v[84:87], 0
    s_nop 1
    v_add_f32 v196, v136, v141
    s_nop 0
    v_add_f32 v197, v146, v151
    s_nop 0
    v_add_f32 v198, v168, v173
    s_nop 0
    v_add_f32 v199, v178, v183
    v_add_f32 v196, v196, v197
    v_add_f32 v198, v198, v199
    v_mov_b32 v197, s4
    s_nop 0
    v_permlane16_swap_b32 v198, v199
    s_cmp_ge_u32 s9, 28
    s_cbranch_scc1 L_NOHP
    v_add_f32 v196, v196, v199
    s_mov_b32 exec_lo, 0xffff
    s_mov_b32 exec_hi, 0xffff
    buffer_store_dwordx2 v[196:197], v8, s[32:35], s20 offen sc1
    s_mov_b64 exec, -1
L_NOHP:
    ds_read_b64_tr_b16 v[120:121], v35
    ds_read_b64_tr_b16 v[122:123], v35 offset:1024
    ds_read_b64_tr_b16 v[124:125], v35 offset:8192
    ds_read_b64_tr_b16 v[126:127], v35 offset:9216
    ds_read_b64_tr_b16 v[128:129], v35 offset:16384
    ds_read_b64_tr_b16 v[130:131], v35 offset:17408
    ds_read_b64_tr_b16 v[132:133], v35 offset:24576
    ds_read_b64_tr_b16 v[134:135], v35 offset:25600
    s_and_b32 s68, s24, 2047
    s_and_b32 s69, s25, 2047
    s_mov_b32 s70, s16
    s_mov_b32 s71, s15
    v_pk_add_f32 v[208:209], v[208:209], v[152:153]
    v_pk_add_f32 v[210:211], v[210:211], v[154:155]
    v_pk_add_f32 v[212:213], v[212:213], v[156:157]
    v_pk_add_f32 v[214:215], v[214:215], v[158:159]
    v_pk_add_f32 v[216:217], v[216:217], v[160:161]
    v_pk_add_f32 v[218:219], v[218:219], v[162:163]
    v_pk_add_f32 v[220:221], v[220:221], v[164:165]
    v_pk_add_f32 v[222:223], v[222:223], v[166:167]
    v_cvt_pk_bf16_f32 v232, v208, v209
    v_cvt_pk_bf16_f32 v233, v210, v211
    v_cvt_pk_bf16_f32 v234, v212, v213
    v_cvt_pk_bf16_f32 v235, v214, v215
    v_cvt_pk_bf16_f32 v236, v216, v217
    v_cvt_pk_bf16_f32 v237, v218, v219
    v_cvt_pk_bf16_f32 v238, v220, v221
    v_cvt_pk_bf16_f32 v239, v222, v223
    v_permlane32_swap_b32 v232, v234
    v_permlane32_swap_b32 v233, v235
    v_permlane32_swap_b32 v236, v238
    v_permlane32_swap_b32 v237, v239
    ds_write_b128 v202, v[232:235]
    ds_write_b128 v204, v[236:239]
    ds_read_b128 v[232:235], v203
    ds_read_b128 v[236:239], v203 offset:1024
    s_waitcnt lgkmcnt(0)
    s_cmp_lg_u32 s93, 7
    s_cbranch_scc1 L_NONON
    v_mov_b32 v6, s4
    v_mov_b32 v7, 0
    s_mov_b64 exec, 1
    buffer_store_dword v6, v7, s[32:35], 0 offen sc1
    s_mov_b64 exec, -1
L_NONON:
    s_cmp_ge_u32 s9, 28
    s_cbranch_scc1 L_FIN2
    s_cmp_lg_u32 s3, 7
    s_cbranch_scc1 L_NOFZ
    s_bitcmp1_b32 s9, 3
    s_cselect_b32 s15, s25, s24
    s_cselect_b32 s17, s18, s17
    s_andn2_b32 s18, 2047, s15
    s_lshr_b32 s96, s8, 1
    s_lshl2_add_u32 s19, s12, s96
    s_lshr_b32 s96, s19, 1
    s_lshr_b32 s97, s9, 3
    s_lshl_b32 s98, s97, 1
    s_lshl2_add_u32 s99, s96, s98
    s_and_b32 s97, s19, 1
    s_add_u32 s96, s99, s97
    s_mul_i32 s98, s96, 7168
    s_add_u32 s20, s98, 22020096
    s_lshl_b32 s96, s18, 11
    s_lshl_b32 s97, s19, 5
    s_add_u32 s82, s96, s97
    v_and_b32 v10, 7, v1
    v_lshlrev_b32 v10, 2, v10
    s_lshr_b32 s96, s8, 1
    s_lshl_b32 s97, s96, 6
    s_add_u32 s13, s97, 157184
    v_and_b32 v5, 7, v1
    v_lshl_add_u32 v5, v5, 3, s13
    ds_read_b64 v[206:207], v5
    s_and_b32 s96, s17, 31
    s_lshl_b32 s97, s96, 13
    s_lshl_b32 s98, s12, 9
    s_add_u32 s99, s97, s98
    s_lshr_b32 s96, s8, 1
    s_lshl_b32 s97, s96, 5
    s_add_u32 s98, s99, s97
    s_add_u32 s91, s98, 13631488
    s_lshr_b32 s13, s15, 11
    s_lshl_b32 s13, s13, 16
    s_ashr_i32 s15, s13, 31
    s_andn2_b32 s15, 0x7fff0000, s15
    s_or_b32 s15, s15, 0x80000000
    s_xor_b32 s13, s13, s15
    v_mov_b32 v204, s13
    v_mul_f32 v204, s7, v204
    v_exp_f32 v204, -v204
    s_nop 0
    v_add_f32 v204, 1.0, v204
    v_rcp_f32 v204, v204
    s_nop 0
    v_cvt_pk_bf16_f32 v204, 0, v204
L_NOFZ:
    s_cmp_ge_u32 s3, 4
    s_cbranch_scc1 L_NOH
    s_lshl_b32 s96, s3, 8
    s_add_u32 s13, s96, s14
    v_lshrrev_b32 v4, 4, v1
    v_lshlrev_b32 v4, 11, v4
    v_and_b32 v9, 15, v1
    v_lshl_add_u32 v4, v9, 4, v4
    s_lshl_b32 s96, s3, 5
    s_add_u32 s15, s96, 156672
    v_lshrrev_b32 v5, 5, v1
    v_lshl_add_u32 v5, v5, 7, s15
    v_bfe_u32 v9, v1, 2, 1
    v_lshl_add_u32 v5, v9, 4, v5
    v_bfe_u32 v9, v1, 1, 1
    v_lshl_add_u32 v5, v9, 3, v5
    v_bfe_u32 v9, v1, 3, 1
    v_lshl_add_u32 v5, v9, 2, v5
    v_and_b32 v9, 1, v1
    v_lshl_add_u32 v5, v9, 1, v5
SPOLL_45:
L_PAD10:
    s_cbranch_execz L_RET10
    s_load_dword s24, s[32:33], s13 offset:1276 glc
    s_load_dword s25, s[32:33], s13 offset:3324 glc
    s_load_dword s26, s[32:33], s13 offset:5372 glc
    s_load_dword s27, s[32:33], s13 offset:7420 glc
SCHK_46:
    s_add_u32 s5, s5, 1
    s_cmp_ge_u32 s5, 200000
    s_waitcnt lgkmcnt(0)
    s_cbranch_scc1 SDONE_47
    s_cmp_lg_u32 s24, s4
    s_cbranch_scc1 SPOLL_45
    s_cmp_lg_u32 s25, s4
    s_cbranch_scc1 SPOLL_45
    s_cmp_lg_u32 s26, s4
    s_cbranch_scc1 SPOLL_45
    s_cmp_lg_u32 s27, s4
    s_cbranch_scc1 SPOLL_45
SDONE_47:
POLL_48:
    buffer_load_dwordx4 v[88:91], v4, s[32:35], s13 offen sc1
    buffer_load_dwordx4 v[92:95], v4, s[32:35], s13 offen offset:1024 sc1
    s_waitcnt vmcnt(0)
    v_bitop3_b32 v6, v89, v91, s4 bitop3:0x7e
    v_bitop3_b32 v6, v6, v93, s4 bitop3:0xf6
    v_bitop3_b32 v6, v6, v95, s4 bitop3:0xf6
    v_cmp_ne_u32 vcc, 0, v6
    s_cbranch_vccz PDONE_49
    s_add_u32 s5, s5, 1
    s_cmp_lt_u32 s5, 200000
    s_cbranch_scc1 POLL_48
PDONE_49:
    v_permlane32_swap_b32 v88, v90
    v_permlane32_swap_b32 v92, v94
    v_add_f32 v88, v88, v90
    v_add_f32 v92, v92, v94
    v_mov_b32 v90, v88
    v_mov_b32 v94, v92
    s_nop 0
    v_permlane16_swap_b32 v88, v90
    v_permlane16_swap_b32 v92, v94
    v_add_f32 v88, v88, v90
    v_add_f32 v92, v92, v94
    v_cvt_pk_bf16_f32 v88, 0, v88
    v_cvt_pk_bf16_f32 v92, 0, v92
    v_mul_f32 v6, s7, v88
    v_exp_f32 v6, -v6
    s_nop 0
    v_add_f32 v6, 1.0, v6
    v_rcp_f32 v6, v6
    s_nop 0
    v_mul_f32 v88, v88, v6
    v_cvt_pk_bf16_f32 v88, 0, v88
    v_mul_f32 v88, v88, v92
    v_cvt_pk_bf16_f32 v88, v88, v88
    ds_write_b16 v5, v88
L_NOH:
    v_bfe_u32 v4, v1, 2, 1
    v_lshlrev_b32 v4, 7, v4
    v_lshrrev_b32 v9, 5, v1
    v_lshl_add_u32 v4, v9, 4, v4
    v_add_u32 v4, 156672, v4
    v_lshrrev_b32 v5, 4, v1
    v_mul_u32_u24 v5, 7168, v5
    v_and_b32 v9, 15, v1
    v_lshl_add_u32 v5, v9, 3, v5
    s_lshl3_add_u32 s96, s75, s3
    s_mul_i32 s97, s96, 28672
    s_lshl_b32 s98, s74, 7
    s_add_u32 s99, s97, s98
    s_add_u32 s13, s99, 22020096
    v_and_b32 v6, 1, v1
    v_lshlrev_b32 v6, 13, v6
    v_bfe_u32 v9, v1, 1, 1
    v_lshl_add_u32 v6, v9, 18, v6
    s_lshr_b32 s96, s9, 2
    s_and_b32 s97, s75, 1
    s_lshr_b32 s98, s3, 1
    s_lshl2_add_u32 s99, s97, s98
    s_and_b32 s97, s3, 1
    s_lshr_b32 s98, s75, 1
    s_lshl2_add_u32 s97, s97, s98
    s_lshl3_add_u32 s98, s99, s97
    s_lshl_b32 s99, s98, 12
    s_lshl_b32 s97, s8, 6
    s_add_u32 s98, s99, s97
    s_lshl2_add_u32 s99, s96, s98
    s_add_u32 s97, s99, 1048576
    s_add_u32 s14, s97, 3072
    s_waitcnt lgkmcnt(0)
    s_barrier
    ds_read_b128 v[88:91], v4
    ds_read_b128 v[92:95], v4 offset:32
    ds_read_b128 v[96:99], v4 offset:64
    ds_read_b128 v[100:103], v4 offset:96
    s_waitcnt lgkmcnt(3)
    v_mfma_f32_32x32x16_bf16 v[208:223], v[88:91], v[120:123], 0
    s_waitcnt lgkmcnt(2)
    v_mfma_f32_32x32x16_bf16 v[208:223], v[92:95], v[124:127], v[208:223]
    s_waitcnt lgkmcnt(1)
    v_mfma_f32_32x32x16_bf16 v[208:223], v[96:99], v[128:131], v[208:223]
    s_waitcnt lgkmcnt(0)
    v_mfma_f32_32x32x16_bf16 v[208:223], v[100:103], v[132:135], v[208:223]
    s_nop 11
    v_mov_b32 v209, s4
    buffer_store_dwordx2 v[208:209], v5, s[32:35], s13 offen sc1
    s_mov_b64 exec, 15
    buffer_store_dword v209, v6, s[32:35], s14 offen sc1
    s_mov_b64 exec, -1
    s_barrier
L_FIN2:
    v_cmp_ne_u32 vcc, s68, v42
    v_cmp_ne_u32 s[22:23], s69, v42
    s_nop 0
    s_and_b64 exec, vcc, s[22:23]
    buffer_store_dwordx4 v[232:235], v33, s[64:67], s70 offen sc1
    s_mov_b64 exec, -1
    v_cmp_ne_u32 vcc, s68, v43
    v_cmp_ne_u32 s[22:23], s69, v43
    s_nop 0
    s_and_b64 exec, vcc, s[22:23]
    buffer_store_dwordx4 v[236:239], v33, s[64:67], s71 offen sc1
    s_mov_b64 exec, -1
    s_cmp_ge_u32 s9, 16
    s_cbranch_scc1 L_FIN
SPOLL_50:
    s_load_dwordx8 s[24:31], s[32:33], s92 offset:3072 glc
SCHK_51:
    s_add_u32 s5, s5, 1
    s_cmp_ge_u32 s5, 200000
    s_waitcnt lgkmcnt(0)
    s_cbranch_scc1 SDONE_52
    s_cmp_lg_u32 s24, s4
    s_cbranch_scc1 SPOLL_50
    s_cmp_lg_u32 s25, s4
    s_cbranch_scc1 SPOLL_50
    s_cmp_lg_u32 s26, s4
    s_cbranch_scc1 SPOLL_50
    s_cmp_lg_u32 s27, s4
    s_cbranch_scc1 SPOLL_50
    s_cmp_lg_u32 s28, s4
    s_cbranch_scc1 SPOLL_50
    s_cmp_lg_u32 s29, s4
    s_cbranch_scc1 SPOLL_50
    s_cmp_lg_u32 s30, s4
    s_cbranch_scc1 SPOLL_50
SDONE_52:
    s_barrier
    s_cmp_lg_u32 s3, 7
    s_cbranch_scc1 L_FIN
    s_add_u32 s13, s20, 4096
    v_mov_b32 v5, s4
    v_not_b32 v6, v5
POLL_53:
    buffer_load_dwordx4 v[88:91], v2, s[32:35], s20 offen sc1
    buffer_load_dwordx4 v[92:95], v2, s[32:35], s20 offen offset:1024 sc1
    buffer_load_dwordx4 v[96:99], v2, s[32:35], s20 offen offset:2048 sc1
    buffer_load_dwordx4 v[100:103], v2, s[32:35], s20 offen offset:3072 sc1
    buffer_load_dwordx4 v[104:107], v2, s[32:35], s13 offen sc1
    buffer_load_dwordx4 v[108:111], v2, s[32:35], s13 offen offset:1024 sc1
    buffer_load_dwordx4 v[112:115], v2, s[32:35], s13 offen offset:2048 sc1
    buffer_load_dword v244, v10, s[32:35], s91 offen sc1
    buffer_load_dword v245, v10, s[32:35], s91 offen offset:128 sc1
    s_waitcnt vmcnt(0)
    v_max_u32 v246, v244, v245
    v_cmp_ne_u32 vcc, -1, v246
    s_nop 1
    v_cndmask_b32 v246, v6, v5, vcc
    v_bitop3_b32 v4, v89, v91, s4 bitop3:0x7e
    v_bitop3_b32 v4, v4, v93, s4 bitop3:0xf6
    v_bitop3_b32 v4, v4, v95, s4 bitop3:0xf6
    v_bitop3_b32 v4, v4, v97, s4 bitop3:0xf6
    v_bitop3_b32 v4, v4, v99, s4 bitop3:0xf6
    v_bitop3_b32 v4, v4, v101, s4 bitop3:0xf6
    v_bitop3_b32 v4, v4, v103, s4 bitop3:0xf6
    v_bitop3_b32 v4, v4, v105, s4 bitop3:0xf6
    v_bitop3_b32 v4, v4, v107, s4 bitop3:0xf6
    v_bitop3_b32 v4, v4, v109, s4 bitop3:0xf6
    v_bitop3_b32 v4, v4, v111, s4 bitop3:0xf6
    v_bitop3_b32 v4, v4, v113, s4 bitop3:0xf6
    v_bitop3_b32 v4, v4, v115, s4 bitop3:0xf6
    v_bitop3_b32 v4, v4, v246, s4 bitop3:0xf6
    v_cmp_ne_u32 vcc, 0, v4
    s_cbranch_vccz PDONE_54
    s_add_u32 s5, s5, 1
    s_cmp_lt_u32 s5, 200000
    s_cbranch_scc1 POLL_53
PDONE_54:
    v_add_f32 v88, v88, v92
    v_add_f32 v90, v90, v94
    v_add_f32 v88, v88, v96
    v_add_f32 v90, v90, v98
    v_add_f32 v88, v88, v100
    v_add_f32 v90, v90, v102
    v_add_f32 v88, v88, v104
    v_add_f32 v90, v90, v106
    v_add_f32 v88, v88, v108
    v_add_f32 v90, v90, v110
    v_add_f32 v88, v88, v112
    v_add_f32 v90, v90, v114
    v_mov_b32 v89, v90
    v_add_f32_dpp v88, v88, v88 row_ror:8 row_mask:0xf bank_mask:0xf
    s_nop 0
    v_add_f32_dpp v89, v89, v89 row_ror:8 row_mask:0xf bank_mask:0xf
    v_mov_b32 v90, v88
    v_mov_b32 v91, v89
    s_nop 0
    v_permlane16_swap_b32 v88, v90
    v_permlane16_swap_b32 v89, v91
    v_pk_add_f32 v[88:89], v[88:89], v[90:91]
    v_mov_b32 v90, v88
    v_mov_b32 v91, v89
    s_nop 0
    v_permlane32_swap_b32 v88, v90
    v_permlane32_swap_b32 v89, v91
    v_pk_add_f32 v[88:89], v[88:89], v[90:91]
    v_cvt_pk_bf16_f32 v88, 0, v88
    v_cvt_pk_bf16_f32 v89, 0, v89
    v_pk_mul_f32 v[88:89], v[88:89], v[204:205] op_sel_hi:[1,0]
    v_lshlrev_b32 v4, 16, v244
    v_and_b32 v5, s6, v244
    v_cvt_pk_bf16_f32 v88, 0, v88
    v_cvt_pk_bf16_f32 v89, 0, v89
    v_pk_add_f32 v[88:89], v[88:89], v[4:5]
    v_cvt_pk_bf16_f32 v88, 0, v88
    v_cvt_pk_bf16_f32 v89, 0, v89
    v_pk_mul_f32 v[88:89], v[88:89], v[206:207]
    v_lshlrev_b32 v4, 16, v245
    v_and_b32 v5, s6, v245
    v_cvt_pk_bf16_f32 v88, 0, v88
    v_cvt_pk_bf16_f32 v89, 0, v89
    v_pk_add_f32 v[88:89], v[88:89], v[4:5]
    v_cvt_pk_bf16_f32 v88, v88, v89
    s_mov_b64 exec, 0xff
    buffer_store_dword v88, v10, s[64:67], s82 offen sc1
    s_mov_b64 exec, -1
L_FIN:
L_END:
    s_endpgm
.p2align 10
.fill 768, 4, 0xbf800000
.section .rodata,"a"
.p2align 6
.amdhsa_kernel adaLN_cond__linear_kernel_hedgehog__moe_arch_mod__prompt_kernel
  .amdhsa_next_free_vgpr 256
  .amdhsa_next_free_sgpr 102
  .amdhsa_accum_offset 256
  .amdhsa_group_segment_fixed_size 0
  .amdhsa_kernarg_size 112
  .amdhsa_user_sgpr_count 2
  .amdhsa_user_sgpr_kernarg_segment_ptr 1
  .amdhsa_system_sgpr_workgroup_id_x 1
  .amdhsa_float_denorm_mode_32 3
  .amdhsa_float_denorm_mode_16_64 3
.end_amdhsa_kernel
```

```asm
; @launch grid=(256,1,1) block=(512,1,1) lds=163840
.amdgcn_target "amdgcn-amd-amdhsa--gfx950"
.text
.globl adaLN_cond__linear_kernel_hedgehog__moe_arch_mod__prompt_kernel
.p2align 12
.type adaLN_cond__linear_kernel_hedgehog__moe_arch_mod__prompt_kernel,@function
adaLN_cond__linear_kernel_hedgehog__moe_arch_mod__prompt_kernel:
    s_load_dwordx16 s[68:83], s[0:1], 0
    s_load_dwordx8 s[84:91], s[0:1], 64
    s_load_dwordx2 s[32:33], s[0:1], 104
    s_cmp_ge_u32 s2, 256
    s_cbranch_scc1 L_END
    v_lshrrev_b32 v4, 6, v0
    v_and_b32 v1, 63, v0
    s_nop 0
    v_readfirstlane_b32 s3, v4
    v_lshlrev_b32 v2, 4, v1
    s_mov_b32 s38, 4194304
    s_mov_b32 s39, 0x20000
    s_mov_b32 s50, 12582912
    s_mov_b32 s51, 0x20000
    s_mov_b32 s34, 268435456
    s_mov_b32 s35, 0x20000
    s_mov_b32 s42, 6291456
    s_mov_b32 s43, 0x20000
    s_mov_b32 s46, 2097152
    s_mov_b32 s47, 0x20000
    s_mov_b32 s54, 7340032
    s_mov_b32 s55, 0x20000
    s_mov_b32 s58, 7340032
    s_mov_b32 s59, 0x20000
    s_mov_b32 s62, 7340032
    s_mov_b32 s63, 0x20000
    s_mov_b32 s66, 4194304
    s_mov_b32 s67, 0x20000
    s_mov_b32 s5, 0
    s_mov_b32 s6, 0xffff0000
    s_mov_b32 s7, 0x3fb8aa3b
    s_and_b32 s8, s2, 7
    s_lshr_b32 s9, s2, 3
    s_lshl_b32 s96, s8, 5
    s_add_u32 s97, s96, s9
    s_lshl3_add_u32 s93, s97, s3
    s_and_b32 s96, s8, 4
    s_lshr_b32 s97, s9, 2
    s_lshl1_add_u32 s10, s96, s97
    s_and_b32 s96, s8, 3
    s_and_b32 s97, s9, 3
    s_xor_b32 s98, s97, 2
    s_lshl2_add_u32 s11, s96, s98
    s_and_b32 s96, s8, 1
    s_and_b32 s97, s9, 7
    s_lshl3_add_u32 s12, s96, s97
    s_lshr_b32 s96, s8, 1
    s_lshr_b32 s97, s9, 3
    s_lshl2_add_u32 s21, s96, s97
    s_lshl_b32 s96, s2, 6
    s_add_u32 s97, s96, s3
    s_lshl_b32 s98, s97, 6
    s_add_u32 s92, s98, 1048576
    s_lshl_b32 s16, s93, 11
    s_lshl3_add_u32 s96, s8, s3
    s_lshl_b32 s15, s96, 5
    s_mul_i32 s96, s15, 6144
    s_xor_b32 s97, s9, 1
    s_lshl_b32 s98, s97, 7
    s_add_u32 s13, s96, s98
    s_add_u32 s14, s13, 98304
    s_lshl3_add_u32 s96, s21, s3
    s_lshl_b32 s97, s96, 15
    s_lshl_b32 s98, s12, 7
    s_add_u32 s18, s97, s98
    s_lshr_b32 s96, s8, 1
    s_lshl4_add_u32 s97, s96, s12
    s_lshl4_add_u32 s98, s97, s3
    s_lshl_b32 s99, s98, 9
    s_add_u32 s17, s99, 524288
    v_lshrrev_b32 v248, 3, v1
    v_mul_u32_u24 v248, 12288, v248
    v_and_b32 v9, 7, v1
    v_lshl_add_u32 v248, v9, 4, v248
    v_lshrrev_b32 v249, 3, v1
    v_lshl_add_u32 v249, v249, 1, s15
    v_and_b32 v10, 15, v1
    v_lshlrev_b32 v10, 11, v10
    v_lshrrev_b32 v9, 4, v1
    v_lshl_add_u32 v10, v9, 4, v10
    s_waitcnt lgkmcnt(0)
    s_mov_b64 s[48:49], s[88:89]
    buffer_load_dwordx4 v[160:163], v248, s[48:51], s13 offen nt
    buffer_load_dwordx4 v[164:167], v248, s[48:51], s14 offen nt
    s_load_dword s4, s[32:33], 0
    global_load_ushort v168, v249, s[86:87]
    global_load_ushort v169, v249, s[86:87] offset:16
    s_mov_b64 s[36:37], s[68:69]
    s_load_dword s24, s[32:33], s92 offset:0 glc
    s_load_dword s25, s[32:33], s17 offset:508 glc
    s_load_dword s26, s[32:33], s17 offset:4604 glc
    s_barrier
    buffer_load_dwordx4 v[152:155], v2, s[36:39], s16 offen
    buffer_load_dwordx4 v[156:159], v2, s[36:39], s16 offen offset:1024
    s_mov_b64 s[40:41], s[70:71]
    s_mov_b64 s[44:45], s[74:75]
    s_mov_b64 s[52:53], s[80:81]
    s_mov_b64 s[56:57], s[82:83]
    s_mov_b64 s[60:61], s[84:85]
    s_mov_b64 s[64:65], s[90:91]
    s_getpc_b64 s[22:23]
    s_and_b32 s22, s22, 0xfffffc00
    s_lshl3_add_u32 s96, s9, s3
    s_lshl_b32 s19, s96, 7
    v_lshrrev_b32 v4, 5, v1
    v_lshl_add_u32 v4, v4, 15, s19
    v_min_u32 v4, 41984, v4
    global_load_dword v11, v4, s[22:23]
    s_lshr_b32 s76, s3, 2
    s_and_b32 s77, s3, 3
    s_lshl_b32 s83, s3, 10
    s_mul_i32 s96, s8, 7
    s_lshr_b32 s97, s9, 2
    s_add_u32 s74, s96, s97
    s_and_b32 s75, s9, 3
    v_bfe_u32 v6, v1, 4, 1
    v_lshlrev_b32 v6, 6, v6
    v_and_b32 v3, 7, v1
    v_lshlrev_b32 v3, 4, v3
    v_xor_b32 v3, v3, v6
    v_lshrrev_b32 v6, 3, v1
    v_mul_u32_u24 v6, 6144, v6
    v_add_u32 v3, v3, v6
    s_and_b32 s84, s9, 12
    s_mul_i32 s96, s3, 49152
    s_lshl_b32 s97, s11, 7
    s_add_u32 s85, s96, s97
    v_lshlrev_b32 v250, 3, v1
    v_lshlrev_b32 v251, 5, v1
    v_add_u32 v251, 147456, v251
    s_lshl2_add_u32 s13, s3, 147456
    v_lshrrev_b32 v252, 4, v1
    v_lshl_add_u32 v252, v252, 6, s13
    v_and_b32 v9, 7, v1
    v_lshl_add_u32 v252, v9, 8, v252
    v_bfe_u32 v9, v1, 3, 1
    v_lshl_add_u32 v252, v9, 5, v252
    buffer_load_dwordx4 v[12:15], v10, s[36:39], s18 offen
    buffer_load_dwordx4 v[16:19], v10, s[36:39], s18 offen offset:64
    s_lshr_b32 s96, s3, 1
    s_xor_b32 s97, s9, 1
    s_and_b32 s98, s97, 15
    s_lshl4_add_u32 s99, s96, s98
    s_lshr_b32 s97, s9, 4
    s_lshl1_add_u32 s96, s99, s97
    s_lshl3_add_u32 s98, s96, s8
    s_lshl_b32 s99, s98, 9
    s_add_u32 s13, s99, 524288
    s_waitcnt vmcnt(5)
    v_lshlrev_b32 v168, 16, v168
    v_mul_f32 v4, s7, v168
    v_exp_f32 v4, -v4
    s_nop 0
    v_add_f32 v4, 1.0, v4
    v_rcp_f32 v4, v4
    s_nop 0
    v_mul_f32 v168, v168, v4
    v_cvt_pk_bf16_f32 v168, 0, v168
    v_lshlrev_b32 v169, 16, v169
    v_mul_f32 v5, s7, v169
    v_exp_f32 v5, -v5
    s_nop 0
    v_add_f32 v5, 1.0, v5
    v_rcp_f32 v5, v5
    s_nop 0
    v_mul_f32 v169, v169, v5
    v_cvt_pk_bf16_f32 v169, 0, v169
    v_lshlrev_b32 v4, 16, v160
    v_and_b32 v5, s6, v160
    v_pk_mul_f32 v[176:177], v[4:5], v[168:169] op_sel:[0,0] op_sel_hi:[1,0]
    v_lshlrev_b32 v6, 16, v161
    v_and_b32 v7, s6, v161
    v_pk_mul_f32 v[178:179], v[6:7], v[168:169] op_sel:[0,0] op_sel_hi:[1,0]
    v_lshlrev_b32 v4, 16, v162
    v_and_b32 v5, s6, v162
    v_pk_mul_f32 v[180:181], v[4:5], v[168:169] op_sel:[0,0] op_sel_hi:[1,0]
    v_lshlrev_b32 v6, 16, v163
    v_and_b32 v7, s6, v163
    v_pk_mul_f32 v[182:183], v[6:7], v[168:169] op_sel:[0,0] op_sel_hi:[1,0]
    v_lshlrev_b32 v4, 16, v164
    v_and_b32 v5, s6, v164
    v_pk_fma_f32 v[176:177], v[4:5], v[168:169], v[176:177] op_sel:[0,1,0] op_sel_hi:[1,1,1]
    v_lshlrev_b32 v6, 16, v165
    v_and_b32 v7, s6, v165
    v_pk_fma_f32 v[178:179], v[6:7], v[168:169], v[178:179] op_sel:[0,1,0] op_sel_hi:[1,1,1]
    v_lshlrev_b32 v4, 16, v166
    v_and_b32 v5, s6, v166
    v_pk_fma_f32 v[180:181], v[4:5], v[168:169], v[180:181] op_sel:[0,1,0] op_sel_hi:[1,1,1]
    v_lshlrev_b32 v6, 16, v167
    v_and_b32 v7, s6, v167
    v_pk_fma_f32 v[182:183], v[6:7], v[168:169], v[182:183] op_sel:[0,1,0] op_sel_hi:[1,1,1]
    v_permlane32_swap_b32 v176, v180
    v_permlane32_swap_b32 v177, v181
    v_permlane32_swap_b32 v178, v182
    v_permlane32_swap_b32 v179, v183
    v_add_f32 v176, v176, v180
    v_add_f32 v177, v177, v181
    v_add_f32 v178, v178, v182
    v_add_f32 v179, v179, v183
    s_nop 0
    v_permlane16_swap_b32 v176, v178
    v_permlane16_swap_b32 v177, v179
    v_add_f32 v176, v176, v178
    v_add_f32 v177, v177, v179
    s_nop 0
    v_add_f32_dpp v176, v176, v176 row_ror:8 row_mask:0xf bank_mask:0xf
    v_add_f32_dpp v177, v177, v177 row_ror:8 row_mask:0xf bank_mask:0xf
    s_nop 1
    v_mov_b32_dpp v176, v177 quad_perm:[0,1,2,3] row_mask:0xf bank_mask:0xc
    s_waitcnt lgkmcnt(0)
    s_mul_i32 s4, s4, 0x9e3779b1
    s_add_u32 s4, s4, 0x7f4a7c15
    ds_write_b32 v252, v176
    s_waitcnt lgkmcnt(0)
    s_barrier
    ds_read_b128 v[176:179], v251
    ds_read_b128 v[180:183], v251 offset:16
    s_waitcnt lgkmcnt(0)
    v_pk_add_f32 v[176:177], v[176:177], v[178:179]
    v_pk_add_f32 v[180:181], v[180:181], v[182:183]
    v_pk_add_f32 v[176:177], v[176:177], v[180:181]
    v_add_f32 v176, v176, v177
    v_mov_b32 v177, s4
    s_bitcmp1_b32 s3, 0
    s_cselect_b32 exec_lo, 0, -1
    s_cselect_b32 exec_hi, -1, 0
    buffer_store_dwordx2 v[176:177], v250, s[32:35], s13 offen sc1
    s_mov_b64 exec, -1
    s_lshr_b32 s96, s9, 4
    s_lshl_b32 s94, s96, -1
    s_add_u32 s96, s94, s84
    s_and_b32 s97, s96, 15
    s_mul_i32 s98, s97, 393216
    s_add_u32 s91, s98, s85
    s_lshl_b32 s96, s94, 13
    s_add_u32 s94, s96, s83
    s_add_u32 s82, s91, 2048
    s_mov_b32 m0, s94
    s_nop 0
    buffer_load_dwordx4 v3, s[40:43], s82 offen lds
    s_add_u32 s82, s91, 4096
    s_add_u32 m0, s94, 49152
    s_nop 0
    buffer_load_dwordx4 v3, s[40:43], s82 offen lds
    s_waitcnt vmcnt(6)
    v_mov_b32 v8, 0x3f803f80
    v_dot2_f32_bf16 v4, v152, v8, 0
    v_dot2_f32_bf16 v5, v152, v152, 0
    v_dot2_f32_bf16 v6, v153, v8, 0
    v_dot2_f32_bf16 v7, v153, v153, 0
    v_dot2_f32_bf16 v4, v154, v8, v4
    v_dot2_f32_bf16 v5, v154, v154, v5
    v_dot2_f32_bf16 v6, v155, v8, v6
    v_dot2_f32_bf16 v7, v155, v155, v7
    v_dot2_f32_bf16 v4, v156, v8, v4
    v_dot2_f32_bf16 v5, v156, v156, v5
    v_dot2_f32_bf16 v6, v157, v8, v6
    v_dot2_f32_bf16 v7, v157, v157, v7
    v_dot2_f32_bf16 v4, v158, v8, v4
    v_dot2_f32_bf16 v5, v158, v158, v5
    v_dot2_f32_bf16 v6, v159, v8, v6
    v_dot2_f32_bf16 v7, v159, v159, v7
    s_nop 2
    v_pk_add_f32 v[4:5], v[4:5], v[6:7]
    s_nop 1
    v_add_f32_dpp v4, v4, v4 quad_perm:[1,0,3,2] row_mask:0xf bank_mask:0xf
    v_add_f32_dpp v5, v5, v5 quad_perm:[1,0,3,2] row_mask:0xf bank_mask:0xf
    s_nop 0
    v_add_f32_dpp v4, v4, v4 quad_perm:[2,3,0,1] row_mask:0xf bank_mask:0xf
    v_add_f32_dpp v5, v5, v5 quad_perm:[2,3,0,1] row_mask:0xf bank_mask:0xf
    s_nop 0
    v_add_f32_dpp v4, v4, v4 row_half_mirror row_mask:0xf bank_mask:0xf
    v_add_f32_dpp v5, v5, v5 row_half_mirror row_mask:0xf bank_mask:0xf
    s_nop 0
    v_add_f32_dpp v4, v4, v4 row_ror:8 row_mask:0xf bank_mask:0xf
    v_add_f32_dpp v5, v5, v5 row_ror:8 row_mask:0xf bank_mask:0xf
    s_nop 1
    v_permlane16_swap_b32 v4, v5
    v_add_f32 v8, v4, v5
    v_add_f32 v4, v4, v5
    s_nop 1
    v_permlane32_swap_b32 v4, v8
    v_add_f32 v4, v4, v8
    v_mul_f32 v8, 0x3a800000, v4
    v_mul_f32 v4, 0x3a800000, v4
    s_nop 1
    v_permlane16_swap_b32 v4, v8
    v_fma_f32 v173, -v4, v4, v8
    v_cvt_pk_bf16_f32 v172, 0, v4
    v_max_f32 v173, 0, v173
    v_cvt_pk_bf16_f32 v173, 0, v173
    v_add_f32 v173, 0x3727c5ac, v173
    v_cvt_pk_bf16_f32 v173, 0, v173
    v_sqrt_f32 v173, v173
    s_nop 0
    v_cvt_pk_bf16_f32 v173, 0, v173
    s_lshl3_add_u32 s13, s3, 153600
    v_lshrrev_b32 v172, 16, v172
    v_or_b32 v172, v172, v173
    v_mov_b32 v173, s4
    v_mov_b32 v4, s13
    ds_write_b64 v4, v[172:173]
    v_and_b32 v5, 3, v1
    v_lshlrev_b32 v5, 4, v5
    v_add_u32 v5, 153600, v5
    v_and_b32 v4, 3, v1
    v_lshlrev_b32 v4, 4, v4
    v_bfe_u32 v9, v1, 2, 1
    v_lshl_add_u32 v4, v9, 10, v4
    s_and_b32 s96, s8, 6
    s_and_b32 s97, s8, 1
    s_lshr_b32 s98, s9, 4
    s_lshl1_add_u32 s99, s97, s98
    s_lshl_b32 s97, s99, 6
    s_add_u32 s98, s96, s97
    s_lshl3_add_u32 s99, s3, s98
    s_lshl_b32 s96, s99, 10
    s_and_b32 s97, s9, 15
    s_lshl_b32 s98, s97, 6
    s_add_u32 s99, s96, s98
    s_add_u32 s13, s99, 262144
    s_waitcnt lgkmcnt(0)
    s_barrier
    ds_read_b128 v[172:175], v5
    s_waitcnt lgkmcnt(0)
    s_mov_b64 exec, 0xff
    buffer_store_dwordx4 v[172:175], v4, s[32:35], s13 offen sc1
    s_mov_b64 exec, -1
    s_mov_b32 s82, s91
    s_add_u32 m0, s94, 98304
    s_nop 0
    buffer_load_dwordx4 v3, s[40:43], s82 offen lds
    s_load_dword s24, s[32:33], s17 offset:508 glc
    s_load_dword s25, s[32:33], s17 offset:4604 glc
    v_and_b32 v4, 31, v1
    v_lshlrev_b32 v4, 4, v4
    v_lshrrev_b32 v9, 5, v1
    v_lshl_add_u32 v4, v9, 12, v4
    s_lshl2_add_u32 s14, s3, 155648
    v_lshl_add_u32 v5, v1, 6, s14
    v_and_b32 v6, 3, v1
    v_lshlrev_b32 v6, 5, v6
    v_lshrrev_b32 v9, 5, v1
    v_lshl_add_u32 v6, v9, 7, v6
    v_bfe_u32 v9, v1, 4, 1
    v_lshl_add_u32 v6, v9, 8, v6
    v_bfe_u32 v9, v1, 2, 2
    v_lshl_add_u32 v6, v9, 9, v6
    v_add_u32 v6, 155648, v6
    s_lshl3_add_u32 s96, s2, s3
    s_lshl_b32 s97, s96, 7
    s_add_u32 s14, s97, 262144
    v_and_b32 v8, 15, v1
    v_lshlrev_b32 v8, 3, v8
    s_branch SCHK_2
SPOLL_1:
    s_load_dword s24, s[32:33], s17 offset:508 glc
    s_load_dword s25, s[32:33], s17 offset:4604 glc
SCHK_2:
    s_add_u32 s5, s5, 1
    s_cmp_ge_u32 s5, 200000
    s_waitcnt lgkmcnt(0)
    s_cbranch_scc1 SDONE_3
    s_cmp_lg_u32 s24, s4
    s_cbranch_scc1 SPOLL_1
    s_cmp_lg_u32 s25, s4
    s_cbranch_scc1 SPOLL_1
SDONE_3:
    buffer_load_dwordx4 v[176:179], v4, s[32:35], s17 offen sc1
    s_load_dword s24, s[32:33], s14 offset:60 glc
    s_load_dword s25, s[32:33], s14 offset:124 glc
    s_waitcnt vmcnt(6)
    v_permlane32_swap_b32 v12, v14
    v_permlane32_swap_b32 v13, v15
    v_permlane32_swap_b32 v16, v18
    v_permlane32_swap_b32 v17, v19
    v_lshlrev_b32 v184, 16, v12
    v_and_b32 v185, s6, v12
    v_lshlrev_b32 v186, 16, v13
    v_and_b32 v187, s6, v13
    v_lshlrev_b32 v188, 16, v14
    v_and_b32 v189, s6, v14
    v_lshlrev_b32 v190, 16, v15
    v_and_b32 v191, s6, v15
    v_lshlrev_b32 v192, 16, v16
    v_and_b32 v193, s6, v16
    v_lshlrev_b32 v194, 16, v17
    v_and_b32 v195, s6, v17
    v_lshlrev_b32 v196, 16, v18
    v_and_b32 v197, s6, v18
    v_lshlrev_b32 v198, 16, v19
    v_and_b32 v199, s6, v19
    s_branch SCHK_6
SPOLL_5:
    s_load_dword s24, s[32:33], s14 offset:60 glc
    s_load_dword s25, s[32:33], s14 offset:124 glc
SCHK_6:
    s_add_u32 s5, s5, 1
    s_cmp_ge_u32 s5, 200000
    s_waitcnt lgkmcnt(0)
    s_cbranch_scc1 SDONE_7
    s_cmp_lg_u32 s24, s4
    s_cbranch_scc1 SPOLL_5
    s_cmp_lg_u32 s25, s4
    s_cbranch_scc1 SPOLL_5
SDONE_7:
    buffer_load_dwordx2 v[172:173], v8, s[32:35], s14 offen sc1
    s_lshr_b32 s96, s9, 4
    s_lshl_b32 s97, s96, -1
    s_xor_b32 s94, s97, 1
    s_add_u32 s96, s94, s84
    s_and_b32 s97, s96, 15
    s_mul_i32 s98, s97, 393216
    s_add_u32 s91, s98, s85
    s_lshl_b32 s96, s94, 13
    s_add_u32 s94, s96, s83
    s_add_u32 s82, s91, 2048
    s_mov_b32 m0, s94
    s_nop 0
    buffer_load_dwordx4 v3, s[40:43], s82 offen lds
    s_add_u32 s82, s91, 4096
    s_add_u32 m0, s94, 49152
    s_nop 0
    buffer_load_dwordx4 v3, s[40:43], s82 offen lds
    s_mov_b32 s82, s91
    s_add_u32 m0, s94, 98304
    s_nop 0
    buffer_load_dwordx4 v3, s[40:43], s82 offen lds
    s_waitcnt vmcnt(4)
    v_bitop3_b32 v7, v177, v179, s4 bitop3:0x7e
    v_cmp_ne_u32 vcc, 0, v7
    s_cbranch_vccz TOK_8
POLL_9:
    buffer_load_dwordx4 v[176:179], v4, s[32:35], s17 offen sc1
    s_waitcnt vmcnt(0)
    v_bitop3_b32 v7, v177, v179, s4 bitop3:0x7e
    v_cmp_ne_u32 vcc, 0, v7
    s_cbranch_vccz PDONE_10
    s_add_u32 s5, s5, 1
    s_cmp_lt_u32 s5, 200000
    s_cbranch_scc1 POLL_9
PDONE_10:
TOK_8:
    ds_write2_b32 v5, v176, v178 offset0:0 offset1:8
    s_waitcnt lgkmcnt(0)
    s_barrier
    ds_read_b128 v[208:211], v6 offset:2048
    ds_read_b128 v[212:215], v6 offset:2064
    ds_read_b128 v[200:203], v6
    ds_read_b128 v[204:207], v6 offset:16
    s_lshl_b32 s96, s11, 12
    s_lshl_b32 s97, s3, 9
    s_add_u32 s13, s96, s97
    v_add_u32 v4, s13, v2
    s_lshl_b32 s96, s3, 9
    s_add_u32 m0, s96, 159744
    s_mov_b32 exec_hi, 0
    global_load_lds_dwordx4 v4, s[72:73]
    s_mov_b32 exec_hi, -1
    s_lshl4_add_u32 s96, s21, s12
    s_lshr_b32 s97, s3, 1
    s_lshl2_add_u32 s98, s96, s97
    s_lshl_b32 s99, s98, 12
    s_and_b32 s96, s3, 1
    s_lshl_b32 s97, s96, 8
    s_add_u32 s98, s99, s97
    s_add_u32 s13, s98, 4194304
    v_and_b32 v4, 15, v1
    v_lshlrev_b32 v4, 4, v4
    v_bfe_u32 v9, v1, 4, 1
    v_lshl_add_u32 v4, v9, 10, v4
    v_lshrrev_b32 v9, 5, v1
    v_lshl_add_u32 v4, v9, 9, v4
    s_waitcnt lgkmcnt(2)
    v_pk_add_f32 v[208:209], v[208:209], v[210:211]
    v_pk_add_f32 v[212:213], v[212:213], v[214:215]
    v_pk_add_f32 v[208:209], v[208:209], v[212:213]
    v_add_f32 v208, v208, v209
    v_cvt_pk_bf16_f32 v208, 0, v208
    s_waitcnt lgkmcnt(0)
    v_pk_add_f32 v[200:201], v[200:201], v[202:203]
    v_pk_add_f32 v[204:205], v[204:205], v[206:207]
    v_pk_add_f32 v[200:201], v[200:201], v[204:205]
    v_add_f32 v200, v200, v201
    v_add_f32 v208, 1.0, v208
    v_cvt_pk_bf16_f32 v208, 0, v208
    v_cvt_pk_bf16_f32 v200, 0, v200
    s_waitcnt vmcnt(4)
    v_cmp_ne_u32 vcc, s4, v173
    s_cbranch_vccz L_STOK
POLL_11:
    buffer_load_dwordx2 v[172:173], v8, s[32:35], s14 offen sc1
    s_waitcnt vmcnt(0)
    v_cmp_ne_u32 vcc, s4, v173
    s_cbranch_vccz PDONE_12
    s_add_u32 s5, s5, 1
    s_cmp_lt_u32 s5, 200000
    s_cbranch_scc1 POLL_11
PDONE_12:
L_STOK:
    v_lshlrev_b32 v173, 16, v172
    v_and_b32 v172, s6, v172
    v_rcp_f32 v172, v172
    s_nop 0
    v_pk_add_f32 v[184:185], v[184:185], v[172:173] op_sel:[0,1] neg_lo:[0,1] neg_hi:[0,1]
    v_pk_add_f32 v[186:187], v[186:187], v[172:173] op_sel:[0,1] neg_lo:[0,1] neg_hi:[0,1]
    v_pk_add_f32 v[188:189], v[188:189], v[172:173] op_sel:[0,1] neg_lo:[0,1] neg_hi:[0,1]
    v_pk_add_f32 v[190:191], v[190:191], v[172:173] op_sel:[0,1] neg_lo:[0,1] neg_hi:[0,1]
    v_pk_add_f32 v[192:193], v[192:193], v[172:173] op_sel:[0,1] neg_lo:[0,1] neg_hi:[0,1]
    v_pk_add_f32 v[194:195], v[194:195], v[172:173] op_sel:[0,1] neg_lo:[0,1] neg_hi:[0,1]
    v_pk_add_f32 v[196:197], v[196:197], v[172:173] op_sel:[0,1] neg_lo:[0,1] neg_hi:[0,1]
    v_pk_add_f32 v[198:199], v[198:199], v[172:173] op_sel:[0,1] neg_lo:[0,1] neg_hi:[0,1]
    v_cvt_pk_bf16_f32 v184, 0, v184
    v_cvt_pk_bf16_f32 v185, 0, v185
    v_cvt_pk_bf16_f32 v186, 0, v186
    v_cvt_pk_bf16_f32 v187, 0, v187
    v_cvt_pk_bf16_f32 v188, 0, v188
    v_cvt_pk_bf16_f32 v189, 0, v189
    v_cvt_pk_bf16_f32 v190, 0, v190
    v_cvt_pk_bf16_f32 v191, 0, v191
    v_cvt_pk_bf16_f32 v192, 0, v192
    v_cvt_pk_bf16_f32 v193, 0, v193
    v_cvt_pk_bf16_f32 v194, 0, v194
    v_cvt_pk_bf16_f32 v195, 0, v195
    v_cvt_pk_bf16_f32 v196, 0, v196
    v_cvt_pk_bf16_f32 v197, 0, v197
    v_cvt_pk_bf16_f32 v198, 0, v198
    v_cvt_pk_bf16_f32 v199, 0, v199
    v_pk_mul_f32 v[184:185], v[184:185], v[172:173] op_sel_hi:[1,0]
    v_pk_mul_f32 v[186:187], v[186:187], v[172:173] op_sel_hi:[1,0]
    v_pk_mul_f32 v[188:189], v[188:189], v[172:173] op_sel_hi:[1,0]
    v_pk_mul_f32 v[190:191], v[190:191], v[172:173] op_sel_hi:[1,0]
    v_pk_mul_f32 v[192:193], v[192:193], v[172:173] op_sel_hi:[1,0]
    v_pk_mul_f32 v[194:195], v[194:195], v[172:173] op_sel_hi:[1,0]
    v_pk_mul_f32 v[196:197], v[196:197], v[172:173] op_sel_hi:[1,0]
    v_pk_mul_f32 v[198:199], v[198:199], v[172:173] op_sel_hi:[1,0]
    v_cvt_pk_bf16_f32 v184, 0, v184
    v_cvt_pk_bf16_f32 v185, 0, v185
    v_cvt_pk_bf16_f32 v186, 0, v186
    v_cvt_pk_bf16_f32 v187, 0, v187
    v_cvt_pk_bf16_f32 v188, 0, v188
    v_cvt_pk_bf16_f32 v189, 0, v189
    v_cvt_pk_bf16_f32 v190, 0, v190
    v_cvt_pk_bf16_f32 v191, 0, v191
    v_cvt_pk_bf16_f32 v192, 0, v192
    v_cvt_pk_bf16_f32 v193, 0, v193
    v_cvt_pk_bf16_f32 v194, 0, v194
    v_cvt_pk_bf16_f32 v195, 0, v195
    v_cvt_pk_bf16_f32 v196, 0, v196
    v_cvt_pk_bf16_f32 v197, 0, v197
    v_cvt_pk_bf16_f32 v198, 0, v198
    v_cvt_pk_bf16_f32 v199, 0, v199
    v_mul_f32_dpp v184, v208, v184 row_newbcast:0 row_mask:0xf bank_mask:0xf
    v_mul_f32_dpp v185, v208, v185 row_newbcast:1 row_mask:0xf bank_mask:0xf
    v_mul_f32_dpp v186, v208, v186 row_newbcast:2 row_mask:0xf bank_mask:0xf
    v_mul_f32_dpp v187, v208, v187 row_newbcast:3 row_mask:0xf bank_mask:0xf
    v_mul_f32_dpp v188, v208, v188 row_newbcast:4 row_mask:0xf bank_mask:0xf
    v_mul_f32_dpp v189, v208, v189 row_newbcast:5 row_mask:0xf bank_mask:0xf
    v_mul_f32_dpp v190, v208, v190 row_newbcast:6 row_mask:0xf bank_mask:0xf
    v_mul_f32_dpp v191, v208, v191 row_newbcast:7 row_mask:0xf bank_mask:0xf
    v_cvt_pk_bf16_f32 v184, 0, v184
    v_cvt_pk_bf16_f32 v185, 0, v185
    v_cvt_pk_bf16_f32 v186, 0, v186
    v_cvt_pk_bf16_f32 v187, 0, v187
    v_cvt_pk_bf16_f32 v188, 0, v188
    v_cvt_pk_bf16_f32 v189, 0, v189
    v_cvt_pk_bf16_f32 v190, 0, v190
    v_cvt_pk_bf16_f32 v191, 0, v191
    v_add_f32_dpp v184, v200, v184 row_newbcast:0 row_mask:0xf bank_mask:0xf
    v_add_f32_dpp v185, v200, v185 row_newbcast:1 row_mask:0xf bank_mask:0xf
    v_add_f32_dpp v186, v200, v186 row_newbcast:2 row_mask:0xf bank_mask:0xf
    v_add_f32_dpp v187, v200, v187 row_newbcast:3 row_mask:0xf bank_mask:0xf
    v_add_f32_dpp v188, v200, v188 row_newbcast:4 row_mask:0xf bank_mask:0xf
    v_add_f32_dpp v189, v200, v189 row_newbcast:5 row_mask:0xf bank_mask:0xf
    v_add_f32_dpp v190, v200, v190 row_newbcast:6 row_mask:0xf bank_mask:0xf
    v_add_f32_dpp v191, v200, v191 row_newbcast:7 row_mask:0xf bank_mask:0xf
    v_cvt_pk_bf16_f32 v216, v184, v185
    v_cvt_pk_bf16_f32 v217, v186, v187
    v_cvt_pk_bf16_f32 v218, v188, v189
    v_cvt_pk_bf16_f32 v219, v190, v191
    buffer_store_dwordx4 v[216:219], v4, s[32:35], s13 offen sc1
    v_mul_f32_dpp v192, v208, v192 row_newbcast:8 row_mask:0xf bank_mask:0xf
    v_mul_f32_dpp v193, v208, v193 row_newbcast:9 row_mask:0xf bank_mask:0xf
    v_mul_f32_dpp v194, v208, v194 row_newbcast:10 row_mask:0xf bank_mask:0xf
    v_mul_f32_dpp v195, v208, v195 row_newbcast:11 row_mask:0xf bank_mask:0xf
    v_mul_f32_dpp v196, v208, v196 row_newbcast:12 row_mask:0xf bank_mask:0xf
    v_mul_f32_dpp v197, v208, v197 row_newbcast:13 row_mask:0xf bank_mask:0xf
    v_mul_f32_dpp v198, v208, v198 row_newbcast:14 row_mask:0xf bank_mask:0xf
    v_mul_f32_dpp v199, v208, v199 row_newbcast:15 row_mask:0xf bank_mask:0xf
    v_cvt_pk_bf16_f32 v192, 0, v192
    v_cvt_pk_bf16_f32 v193, 0, v193
    v_cvt_pk_bf16_f32 v194, 0, v194
    v_cvt_pk_bf16_f32 v195, 0, v195
    v_cvt_pk_bf16_f32 v196, 0, v196
    v_cvt_pk_bf16_f32 v197, 0, v197
    v_cvt_pk_bf16_f32 v198, 0, v198
    v_cvt_pk_bf16_f32 v199, 0, v199
    v_add_f32_dpp v192, v200, v192 row_newbcast:8 row_mask:0xf bank_mask:0xf
    v_add_f32_dpp v193, v200, v193 row_newbcast:9 row_mask:0xf bank_mask:0xf
    v_add_f32_dpp v194, v200, v194 row_newbcast:10 row_mask:0xf bank_mask:0xf
    v_add_f32_dpp v195, v200, v195 row_newbcast:11 row_mask:0xf bank_mask:0xf
    v_add_f32_dpp v196, v200, v196 row_newbcast:12 row_mask:0xf bank_mask:0xf
    v_add_f32_dpp v197, v200, v197 row_newbcast:13 row_mask:0xf bank_mask:0xf
    v_add_f32_dpp v198, v200, v198 row_newbcast:14 row_mask:0xf bank_mask:0xf
    v_add_f32_dpp v199, v200, v199 row_newbcast:15 row_mask:0xf bank_mask:0xf
    v_cvt_pk_bf16_f32 v220, v192, v193
    v_cvt_pk_bf16_f32 v221, v194, v195
    v_cvt_pk_bf16_f32 v222, v196, v197
    v_cvt_pk_bf16_f32 v223, v198, v199
    buffer_store_dwordx4 v[220:223], v4, s[32:35], s13 offen offset:2048 sc1
    v_bfe_u32 v20, v1, 2, 2
    v_lshlrev_b32 v20, 7, v20
    v_bfe_u32 v9, v1, 3, 1
    v_lshl_add_u32 v20, v9, 6, v20
    v_bfe_u32 v9, v1, 4, 1
    v_lshl_add_u32 v20, v9, 5, v20
    v_and_b32 v9, 3, v1
    v_lshl_add_u32 v20, v9, 3, v20
    v_lshrrev_b32 v9, 5, v1
    v_lshl_add_u32 v20, v9, 9, v20
    v_xor_b32 v21, 64, v20
    v_add_u32 v22, 49152, v20
    v_add_u32 v23, 49152, v21
    v_add_u32 v24, 98304, v20
    v_add_u32 v25, 98304, v21
    v_and_b32 v5, 3, v1
    v_lshlrev_b32 v5, 15, v5
    v_bfe_u32 v9, v1, 2, 2
    v_lshl_add_u32 v5, v9, 12, v5
    s_and_b32 s96, s12, 1
    s_lshr_b32 s97, s21, 3
    s_and_b32 s98, s21, 7
    s_lshl_b32 s99, s98, 5
    s_lshl2_add_u32 s98, s97, s99
    s_lshl_b32 s97, s98, 12
    s_lshr_b32 s99, s12, 1
    s_lshl_b32 s98, s99, 6
    s_add_u32 s99, s97, s98
    s_lshl2_add_u32 s97, s96, s99
    s_add_u32 s13, s97, 1048576
    s_lshl_b32 s96, s10, 18
    s_lshl_b32 s97, s77, 12
    s_add_u32 s98, s96, s97
    s_add_u32 s88, s98, 4194304
    s_cmp_ge_u32 s9, 28
    s_cselect_b32 s54, 0, s54
    s_cselect_b32 s58, 0, s58
    s_cselect_b32 s62, 0, s62
    s_waitcnt vmcnt(0)
    s_barrier
    s_cmp_lg_u32 s3, 0
    s_cbranch_scc1 L_PB
    v_mov_b32 v6, s4
    s_mov_b32 exec_hi, 0
    s_mov_b32 exec_lo, 65535
    buffer_store_dword v6, v5, s[32:35], s13 offen sc1
    s_mov_b64 exec, -1
L_PB:
    s_lshr_b32 s96, s9, 4
    s_lshl_b32 s97, s96, -1
    s_xor_b32 s94, s97, 2
    s_add_u32 s96, s94, s84
    s_and_b32 s97, s96, 15
    s_mul_i32 s98, s97, 393216
    s_add_u32 s91, s98, s85
    s_lshl_b32 s96, s94, 13
    s_add_u32 s94, s96, s83
    s_add_u32 s82, s91, 2048
    s_mov_b32 m0, s94
    s_nop 0
    buffer_load_dwordx4 v3, s[40:43], s82 offen lds
    s_add_u32 s82, s91, 4096
    s_add_u32 m0, s94, 49152
    s_nop 0
    buffer_load_dwordx4 v3, s[40:43], s82 offen lds
    s_mov_b32 s82, s91
    s_add_u32 m0, s94, 98304
    s_nop 0
    buffer_load_dwordx4 v3, s[40:43], s82 offen lds
    s_lshr_b32 s96, s9, 4
    s_lshl_b32 s97, s96, -1
    s_xor_b32 s94, s97, 3
    s_add_u32 s96, s94, s84
    s_and_b32 s97, s96, 15
    s_mul_i32 s98, s97, 393216
    s_add_u32 s91, s98, s85
    s_lshl_b32 s96, s94, 13
    s_add_u32 s94, s96, s83
    s_add_u32 s82, s91, 2048
    s_mov_b32 m0, s94
    s_nop 0
    buffer_load_dwordx4 v3, s[40:43], s82 offen lds
    s_add_u32 s82, s91, 4096
    s_add_u32 m0, s94, 49152
    s_nop 0
    buffer_load_dwordx4 v3, s[40:43], s82 offen lds
    s_mov_b32 s82, s91
    s_add_u32 m0, s94, 98304
    s_nop 0
    buffer_load_dwordx4 v3, s[40:43], s82 offen lds
    s_lshl_b32 s96, s2, 12
    s_add_u32 s19, s96, 1048576
    s_and_b32 s96, s3, 3
    s_lshl_b32 s97, s96, 7
    s_add_u32 s20, s97, s19
    s_lshl_b32 s96, s84, 5
    s_add_u32 s19, s96, s19
    s_cmp_ge_u32 s3, 4
    s_cselect_b32 s19, s20, s19
    s_load_dwordx2 s[24:25], s[32:33], s19 offset:0 glc
    s_load_dwordx2 s[26:27], s[32:33], s19 offset:64 glc
    s_lshl_b32 s96, s3, 14
    s_lshl_b32 s97, s12, 7
    s_add_u32 s90, s96, s97
    s_and_b32 s96, s9, 1
    s_lshr_b32 s97, s9, 3
    s_lshl_b32 s98, s97, 1
    s_lshl3_add_u32 s99, s96, s98
    s_lshl_b32 s95, s99, 17
    s_lshl3_add_u32 s96, s75, s3
    s_mul_i32 s97, s96, 229376
    s_lshl_b32 s98, s74, 7
    s_add_u32 s80, s97, s98
    s_lshl3_add_u32 s96, s74, s3
    s_lshl_b32 s97, s96, 14
    s_lshl_b32 s98, s75, 9
    s_add_u32 s81, s97, s98
    s_and_b32 s96, s8, 3
    s_lshl3_add_u32 s97, s96, s3
    s_mul_i32 s98, s97, 393216
    s_lshr_b32 s99, s8, 2
    s_lshl1_add_u32 s96, s9, s99
    s_lshl_b32 s97, s96, 7
    s_add_u32 s99, s98, s97
    s_add_u32 s89, s99, 4096
    s_and_b32 s96, s3, 1
    s_lshl_b32 s14, s96, 6
    v_bfe_u32 v6, v1, 4, 1
    v_lshl_add_u32 v6, v6, 5, s14
    v_and_b32 v26, 7, v1
    v_lshlrev_b32 v26, 4, v26
    v_xor_b32 v26, v26, v6
    v_lshrrev_b32 v6, 3, v1
    v_lshlrev_b32 v6, 11, v6
    v_add_u32 v26, v26, v6
    s_and_b32 s96, s3, 2
    s_lshl_b32 s14, s96, 5
    v_bfe_u32 v6, v1, 4, 1
    v_lshl_add_u32 v6, v6, 5, s14
    v_and_b32 v27, 7, v1
    v_lshlrev_b32 v27, 4, v27
    v_xor_b32 v27, v27, v6
    v_lshrrev_b32 v6, 3, v1
    v_mul_u32_u24 v6, 7168, v6
    v_add_u32 v27, v27, v6
    s_and_b32 s96, s3, 1
    s_lshl_b32 s14, s96, 7
    v_lshrrev_b32 v6, 5, v1
    v_lshl_add_u32 v6, v6, 6, s14
    v_and_b32 v253, 31, v1
    v_lshlrev_b32 v253, 4, v253
    v_lshrrev_b32 v9, 5, v1
    v_lshl_add_u32 v253, v9, 11, v253
    v_xor_b32 v253, v253, v6
    s_lshl_b32 s16, s84, 14
    v_add_u32 v249, s88, v2
    s_lshl_b32 s96, s77, 11
    s_add_u32 s14, s96, 151552
    v_add_u32 v0, s14, v2
    s_mov_b64 exec, 0
    s_cmp_eq_u32 s3, 4
    s_cbranch_scc1 L_PAD2
    s_cmp_eq_u32 s3, 5
    s_cbranch_scc1 L_PAD3
    s_cmp_eq_u32 s3, 6
    s_cbranch_scc1 L_PAD4
    s_cmp_eq_u32 s3, 7
    s_cbranch_scc1 L_PAD5
    s_branch L_TEND
L_RET2:
    s_branch L_PAD6
L_RET6:
    s_branch L_PAD10
L_RET10:
    s_branch L_TEND
L_RET3:
    s_branch L_PAD7
L_RET7:
    s_branch L_TEND
L_RET4:
    s_branch L_PAD8
L_RET8:
    s_branch L_TEND
L_RET5:
    s_branch L_PAD9
L_RET9:
    s_branch L_TEND
    s_nop 0
    s_nop 0
    s_nop 0
    s_nop 0
    s_nop 0
    s_nop 0
    s_nop 0
    s_nop 0
    s_nop 0
    s_nop 0
    s_nop 0
    s_nop 0
    s_nop 0
    s_nop 0
    s_nop 0
    s_nop 0
    s_nop 0
    s_nop 0
    s_nop 0
    s_nop 0
    s_nop 0
    s_nop 0
    s_nop 0
    s_nop 0
    s_nop 0
    s_nop 0
    s_nop 0
    s_nop 0
L_TEND:
    s_mov_b64 exec, -1
    s_branch SCHK_14
SPOLL_13:
    s_load_dwordx2 s[24:25], s[32:33], s19 offset:0 glc
    s_load_dwordx2 s[26:27], s[32:33], s19 offset:64 glc
SCHK_14:
    s_add_u32 s5, s5, 1
    s_cmp_ge_u32 s5, 200000
    s_waitcnt lgkmcnt(0)
    s_cbranch_scc1 SDONE_15
    s_cmp_lg_u32 s24, s4
    s_cbranch_scc1 SPOLL_13
    s_cmp_lg_u32 s25, s4
    s_cbranch_scc1 SPOLL_13
    s_cmp_lg_u32 s26, s4
    s_cbranch_scc1 SPOLL_13
    s_cmp_lg_u32 s27, s4
    s_cbranch_scc1 SPOLL_13
SDONE_15:
    s_cmp_ge_u32 s3, 4
    s_cbranch_scc1 L_HELP
    s_setprio 2
    buffer_load_dwordx4 v[152:155], v249, s[32:35], s16 offen sc1
    buffer_load_dwordx4 v[156:159], v249, s[32:35], s16 offen offset:1024 sc1
    buffer_load_dwordx4 v[160:163], v249, s[32:35], s16 offen offset:2048 sc1
    buffer_load_dwordx4 v[164:167], v249, s[32:35], s16 offen offset:3072 sc1
    s_add_u32 s16, s16, 16384
    s_and_b32 s16, s16, 0x3ffff
    buffer_load_dwordx4 v[168:171], v249, s[32:35], s16 offen sc1
    buffer_load_dwordx4 v[172:175], v249, s[32:35], s16 offen offset:1024 sc1
    s_barrier
    ds_read_b64_tr_b16 v[28:29], v20
    ds_read_b64_tr_b16 v[30:31], v20 offset:2048
    ds_read_b64_tr_b16 v[32:33], v21
    ds_read_b64_tr_b16 v[34:35], v21 offset:2048
    ds_read_b64_tr_b16 v[36:37], v24
    ds_read_b64_tr_b16 v[38:39], v24 offset:2048
    ds_read_b64_tr_b16 v[40:41], v25
    ds_read_b64_tr_b16 v[42:43], v25 offset:2048
    ds_read_b64_tr_b16 v[44:45], v22
    ds_read_b64_tr_b16 v[46:47], v22 offset:2048
    ds_read_b64_tr_b16 v[48:49], v23
    ds_read_b64_tr_b16 v[50:51], v23 offset:2048
    s_waitcnt vmcnt(5)
    s_waitcnt lgkmcnt(10)
    v_mfma_f32_32x32x16_bf16 v[56:71], v[28:31], v[152:155], 0
    ds_read_b64_tr_b16 v[52:53], v20 offset:1024
    ds_read_b64_tr_b16 v[54:55], v20 offset:3072
    s_waitcnt lgkmcnt(10)
    v_mfma_f32_32x32x16_bf16 v[72:87], v[32:35], v[152:155], 0
    ds_read_b64_tr_b16 v[28:29], v21 offset:1024
    ds_read_b64_tr_b16 v[30:31], v21 offset:3072
    s_waitcnt lgkmcnt(10)
    v_mfma_f32_32x32x16_bf16 v[120:135], v[36:39], v[152:155], 0
    ds_read_b64_tr_b16 v[32:33], v24 offset:1024
    ds_read_b64_tr_b16 v[34:35], v24 offset:3072
    s_waitcnt lgkmcnt(10)
    v_mfma_f32_32x32x16_bf16 v[136:151], v[40:43], v[152:155], 0
    ds_read_b64_tr_b16 v[36:37], v25 offset:1024
    ds_read_b64_tr_b16 v[38:39], v25 offset:3072
    s_waitcnt lgkmcnt(10)
    v_mfma_f32_32x32x16_bf16 v[88:103], v[44:47], v[152:155], 0
    buffer_load_dwordx4 v[176:179], v249, s[32:35], s16 offen offset:2048 sc1
    ds_read_b64_tr_b16 v[40:41], v22 offset:1024
    ds_read_b64_tr_b16 v[42:43], v22 offset:3072
    s_waitcnt lgkmcnt(10)
    v_mfma_f32_32x32x16_bf16 v[104:119], v[48:51], v[152:155], 0
    ds_read_b64_tr_b16 v[44:45], v23 offset:1024
    ds_read_b64_tr_b16 v[46:47], v23 offset:3072
    s_waitcnt vmcnt(5)
    s_waitcnt lgkmcnt(10)
    v_mfma_f32_32x32x16_bf16 v[56:71], v[52:55], v[156:159], v[56:71]
    ds_read_b64_tr_b16 v[48:49], v20 offset:4096
    ds_read_b64_tr_b16 v[50:51], v20 offset:6144
    s_waitcnt lgkmcnt(10)
    v_mfma_f32_32x32x16_bf16 v[72:87], v[28:31], v[156:159], v[72:87]
    ds_read_b64_tr_b16 v[52:53], v21 offset:4096
    ds_read_b64_tr_b16 v[54:55], v21 offset:6144
    s_waitcnt lgkmcnt(10)
    v_mfma_f32_32x32x16_bf16 v[120:135], v[32:35], v[156:159], v[120:135]
    ds_read_b64_tr_b16 v[28:29], v24 offset:4096
    ds_read_b64_tr_b16 v[30:31], v24 offset:6144
    s_waitcnt lgkmcnt(10)
    v_mfma_f32_32x32x16_bf16 v[136:151], v[36:39], v[156:159], v[136:151]
    buffer_load_dwordx4 v[180:183], v249, s[32:35], s16 offen offset:3072 sc1
    ds_read_b64_tr_b16 v[32:33], v25 offset:4096
    ds_read_b64_tr_b16 v[34:35], v25 offset:6144
    s_waitcnt lgkmcnt(10)
    v_mfma_f32_32x32x16_bf16 v[88:103], v[40:43], v[156:159], v[88:103]
    s_add_u32 s16, s16, 16384
    ds_read_b64_tr_b16 v[36:37], v22 offset:4096
    ds_read_b64_tr_b16 v[38:39], v22 offset:6144
    s_waitcnt lgkmcnt(10)
    v_mfma_f32_32x32x16_bf16 v[104:119], v[44:47], v[156:159], v[104:119]
    s_and_b32 s16, s16, 0x3ffff
    ds_read_b64_tr_b16 v[40:41], v23 offset:4096
    ds_read_b64_tr_b16 v[42:43], v23 offset:6144
    s_waitcnt vmcnt(5)
    s_waitcnt lgkmcnt(10)
    v_mfma_f32_32x32x16_bf16 v[56:71], v[48:51], v[160:163], v[56:71]
    ds_read_b64_tr_b16 v[44:45], v20 offset:5120
    ds_read_b64_tr_b16 v[46:47], v20 offset:7168
    s_waitcnt lgkmcnt(10)
    v_mfma_f32_32x32x16_bf16 v[72:87], v[52:55], v[160:163], v[72:87]
    ds_read_b64_tr_b16 v[48:49], v21 offset:5120
    ds_read_b64_tr_b16 v[50:51], v21 offset:7168
    s_waitcnt lgkmcnt(10)
    v_mfma_f32_32x32x16_bf16 v[120:135], v[28:31], v[160:163], v[120:135]
    buffer_load_dwordx4 v[184:187], v249, s[32:35], s16 offen sc1
    ds_read_b64_tr_b16 v[52:53], v24 offset:5120
    ds_read_b64_tr_b16 v[54:55], v24 offset:7168
    s_waitcnt lgkmcnt(10)
    v_mfma_f32_32x32x16_bf16 v[136:151], v[32:35], v[160:163], v[136:151]
    ds_read_b64_tr_b16 v[28:29], v25 offset:5120
    ds_read_b64_tr_b16 v[30:31], v25 offset:7168
    s_waitcnt lgkmcnt(10)
    v_mfma_f32_32x32x16_bf16 v[88:103], v[36:39], v[160:163], v[88:103]
    ds_read_b64_tr_b16 v[32:33], v22 offset:5120
    ds_read_b64_tr_b16 v[34:35], v22 offset:7168
    s_waitcnt lgkmcnt(10)
    v_mfma_f32_32x32x16_bf16 v[104:119], v[40:43], v[160:163], v[104:119]
    ds_read_b64_tr_b16 v[36:37], v23 offset:5120
    ds_read_b64_tr_b16 v[38:39], v23 offset:7168
    s_waitcnt vmcnt(5)
    s_waitcnt lgkmcnt(10)
    v_mfma_f32_32x32x16_bf16 v[56:71], v[44:47], v[164:167], v[56:71]
    ds_read_b64_tr_b16 v[40:41], v20 offset:8192
    ds_read_b64_tr_b16 v[42:43], v20 offset:10240
    s_waitcnt lgkmcnt(10)
    v_mfma_f32_32x32x16_bf16 v[72:87], v[48:51], v[164:167], v[72:87]
    buffer_load_dwordx4 v[188:191], v249, s[32:35], s16 offen offset:1024 sc1
    ds_read_b64_tr_b16 v[44:45], v21 offset:8192
    ds_read_b64_tr_b16 v[46:47], v21 offset:10240
    s_waitcnt lgkmcnt(10)
    v_mfma_f32_32x32x16_bf16 v[120:135], v[52:55], v[164:167], v[120:135]
    ds_read_b64_tr_b16 v[48:49], v24 offset:8192
    ds_read_b64_tr_b16 v[50:51], v24 offset:10240
    s_waitcnt lgkmcnt(10)
    v_mfma_f32_32x32x16_bf16 v[136:151], v[28:31], v[164:167], v[136:151]
    ds_read_b64_tr_b16 v[52:53], v25 offset:8192
    ds_read_b64_tr_b16 v[54:55], v25 offset:10240
    s_waitcnt lgkmcnt(10)
    v_mfma_f32_32x32x16_bf16 v[88:103], v[32:35], v[164:167], v[88:103]
    ds_read_b64_tr_b16 v[28:29], v22 offset:8192
    ds_read_b64_tr_b16 v[30:31], v22 offset:10240
    s_waitcnt lgkmcnt(10)
    v_mfma_f32_32x32x16_bf16 v[104:119], v[36:39], v[164:167], v[104:119]
    buffer_load_dwordx4 v[192:195], v249, s[32:35], s16 offen offset:2048 sc1
    ds_read_b64_tr_b16 v[32:33], v23 offset:8192
    ds_read_b64_tr_b16 v[34:35], v23 offset:10240
    s_barrier
    s_waitcnt vmcnt(6)
    s_waitcnt lgkmcnt(10)
    v_mfma_f32_32x32x16_bf16 v[56:71], v[40:43], v[168:171], v[56:71]
    ds_read_b64_tr_b16 v[36:37], v20 offset:9216
    ds_read_b64_tr_b16 v[38:39], v20 offset:11264
    s_waitcnt lgkmcnt(10)
    v_mfma_f32_32x32x16_bf16 v[72:87], v[44:47], v[168:171], v[72:87]
    ds_read_b64_tr_b16 v[40:41], v21 offset:9216
    ds_read_b64_tr_b16 v[42:43], v21 offset:11264
    s_waitcnt lgkmcnt(10)
    v_mfma_f32_32x32x16_bf16 v[120:135], v[48:51], v[168:171], v[120:135]
    ds_read_b64_tr_b16 v[44:45], v24 offset:9216
    ds_read_b64_tr_b16 v[46:47], v24 offset:11264
    s_waitcnt lgkmcnt(10)
    v_mfma_f32_32x32x16_bf16 v[136:151], v[52:55], v[168:171], v[136:151]
    ds_read_b64_tr_b16 v[48:49], v25 offset:9216
    ds_read_b64_tr_b16 v[50:51], v25 offset:11264
    s_waitcnt lgkmcnt(10)
    v_mfma_f32_32x32x16_bf16 v[88:103], v[28:31], v[168:171], v[88:103]
    buffer_load_dwordx4 v[196:199], v249, s[32:35], s16 offen offset:3072 sc1
    ds_read_b64_tr_b16 v[52:53], v22 offset:9216
    ds_read_b64_tr_b16 v[54:55], v22 offset:11264
    s_waitcnt lgkmcnt(10)
    v_mfma_f32_32x32x16_bf16 v[104:119], v[32:35], v[168:171], v[104:119]
    s_add_u32 s16, s16, 16384
    ds_read_b64_tr_b16 v[28:29], v23 offset:9216
    ds_read_b64_tr_b16 v[30:31], v23 offset:11264
    s_waitcnt vmcnt(6)
    s_waitcnt lgkmcnt(10)
    v_mfma_f32_32x32x16_bf16 v[56:71], v[36:39], v[172:175], v[56:71]
    s_and_b32 s16, s16, 0x3ffff
    ds_read_b64_tr_b16 v[32:33], v20 offset:12288
    ds_read_b64_tr_b16 v[34:35], v20 offset:14336
    s_waitcnt lgkmcnt(10)
    v_mfma_f32_32x32x16_bf16 v[72:87], v[40:43], v[172:175], v[72:87]
    ds_read_b64_tr_b16 v[36:37], v21 offset:12288
    ds_read_b64_tr_b16 v[38:39], v21 offset:14336
    s_waitcnt lgkmcnt(10)
    v_mfma_f32_32x32x16_bf16 v[120:135], v[44:47], v[172:175], v[120:135]
    ds_read_b64_tr_b16 v[40:41], v24 offset:12288
    ds_read_b64_tr_b16 v[42:43], v24 offset:14336
    s_waitcnt lgkmcnt(10)
    v_mfma_f32_32x32x16_bf16 v[136:151], v[48:51], v[172:175], v[136:151]
    buffer_load_dwordx4 v[200:203], v249, s[32:35], s16 offen sc1
    ds_read_b64_tr_b16 v[44:45], v25 offset:12288
    ds_read_b64_tr_b16 v[46:47], v25 offset:14336
    s_waitcnt lgkmcnt(10)
    v_mfma_f32_32x32x16_bf16 v[88:103], v[52:55], v[172:175], v[88:103]
    ds_read_b64_tr_b16 v[48:49], v22 offset:12288
    ds_read_b64_tr_b16 v[50:51], v22 offset:14336
    s_waitcnt lgkmcnt(10)
    v_mfma_f32_32x32x16_bf16 v[104:119], v[28:31], v[172:175], v[104:119]
    ds_read_b64_tr_b16 v[52:53], v23 offset:12288
    ds_read_b64_tr_b16 v[54:55], v23 offset:14336
    s_waitcnt vmcnt(6)
    s_waitcnt lgkmcnt(10)
    v_mfma_f32_32x32x16_bf16 v[56:71], v[32:35], v[176:179], v[56:71]
    ds_read_b64_tr_b16 v[28:29], v20 offset:13312
    ds_read_b64_tr_b16 v[30:31], v20 offset:15360
    s_waitcnt lgkmcnt(10)
    v_mfma_f32_32x32x16_bf16 v[72:87], v[36:39], v[176:179], v[72:87]
    ds_read_b64_tr_b16 v[32:33], v21 offset:13312
    ds_read_b64_tr_b16 v[34:35], v21 offset:15360
    s_waitcnt lgkmcnt(10)
    v_mfma_f32_32x32x16_bf16 v[120:135], v[40:43], v[176:179], v[120:135]
    buffer_load_dwordx4 v[204:207], v249, s[32:35], s16 offen offset:1024 sc1
    ds_read_b64_tr_b16 v[36:37], v24 offset:13312
    ds_read_b64_tr_b16 v[38:39], v24 offset:15360
    s_waitcnt lgkmcnt(10)
    v_mfma_f32_32x32x16_bf16 v[136:151], v[44:47], v[176:179], v[136:151]
    ds_read_b64_tr_b16 v[40:41], v25 offset:13312
    ds_read_b64_tr_b16 v[42:43], v25 offset:15360
    s_waitcnt lgkmcnt(10)
    v_mfma_f32_32x32x16_bf16 v[88:103], v[48:51], v[176:179], v[88:103]
    ds_read_b64_tr_b16 v[44:45], v22 offset:13312
    ds_read_b64_tr_b16 v[46:47], v22 offset:15360
    s_waitcnt lgkmcnt(10)
    v_mfma_f32_32x32x16_bf16 v[104:119], v[52:55], v[176:179], v[104:119]
    ds_read_b64_tr_b16 v[48:49], v23 offset:13312
    ds_read_b64_tr_b16 v[50:51], v23 offset:15360
    s_waitcnt vmcnt(6)
    s_waitcnt lgkmcnt(10)
    v_mfma_f32_32x32x16_bf16 v[56:71], v[28:31], v[180:183], v[56:71]
    ds_read_b64_tr_b16 v[52:53], v20 offset:16384
    ds_read_b64_tr_b16 v[54:55], v20 offset:18432
    s_waitcnt lgkmcnt(10)
    v_mfma_f32_32x32x16_bf16 v[72:87], v[32:35], v[180:183], v[72:87]
    buffer_load_dwordx4 v[208:211], v249, s[32:35], s16 offen offset:2048 sc1
    ds_read_b64_tr_b16 v[28:29], v21 offset:16384
    ds_read_b64_tr_b16 v[30:31], v21 offset:18432
    s_waitcnt lgkmcnt(10)
    v_mfma_f32_32x32x16_bf16 v[120:135], v[36:39], v[180:183], v[120:135]
    ds_read_b64_tr_b16 v[32:33], v24 offset:16384
    ds_read_b64_tr_b16 v[34:35], v24 offset:18432
    s_waitcnt lgkmcnt(10)
    v_mfma_f32_32x32x16_bf16 v[136:151], v[40:43], v[180:183], v[136:151]
    ds_read_b64_tr_b16 v[36:37], v25 offset:16384
    ds_read_b64_tr_b16 v[38:39], v25 offset:18432
    s_waitcnt lgkmcnt(10)
    v_mfma_f32_32x32x16_bf16 v[88:103], v[44:47], v[180:183], v[88:103]
    ds_read_b64_tr_b16 v[40:41], v22 offset:16384
    ds_read_b64_tr_b16 v[42:43], v22 offset:18432
    s_waitcnt lgkmcnt(10)
    v_mfma_f32_32x32x16_bf16 v[104:119], v[48:51], v[180:183], v[104:119]
    buffer_load_dwordx4 v[212:215], v249, s[32:35], s16 offen offset:3072 sc1
    ds_read_b64_tr_b16 v[44:45], v23 offset:16384
    ds_read_b64_tr_b16 v[46:47], v23 offset:18432
    s_barrier
    s_waitcnt vmcnt(7)
    s_waitcnt lgkmcnt(10)
    v_mfma_f32_32x32x16_bf16 v[56:71], v[52:55], v[184:187], v[56:71]
    s_add_u32 s16, s16, 16384
    ds_read_b64_tr_b16 v[48:49], v20 offset:17408
    ds_read_b64_tr_b16 v[50:51], v20 offset:19456
    s_waitcnt lgkmcnt(10)
    v_mfma_f32_32x32x16_bf16 v[72:87], v[28:31], v[184:187], v[72:87]
    s_and_b32 s16, s16, 0x3ffff
    ds_read_b64_tr_b16 v[52:53], v21 offset:17408
    ds_read_b64_tr_b16 v[54:55], v21 offset:19456
    s_waitcnt lgkmcnt(10)
    v_mfma_f32_32x32x16_bf16 v[120:135], v[32:35], v[184:187], v[120:135]
    ds_read_b64_tr_b16 v[28:29], v24 offset:17408
    ds_read_b64_tr_b16 v[30:31], v24 offset:19456
    s_waitcnt lgkmcnt(10)
    v_mfma_f32_32x32x16_bf16 v[136:151], v[36:39], v[184:187], v[136:151]
    ds_read_b64_tr_b16 v[32:33], v25 offset:17408
    ds_read_b64_tr_b16 v[34:35], v25 offset:19456
    s_waitcnt lgkmcnt(10)
    v_mfma_f32_32x32x16_bf16 v[88:103], v[40:43], v[184:187], v[88:103]
    buffer_load_dwordx4 v[216:219], v249, s[32:35], s16 offen sc1
    ds_read_b64_tr_b16 v[36:37], v22 offset:17408
    ds_read_b64_tr_b16 v[38:39], v22 offset:19456
    s_waitcnt lgkmcnt(10)
    v_mfma_f32_32x32x16_bf16 v[104:119], v[44:47], v[184:187], v[104:119]
    ds_read_b64_tr_b16 v[40:41], v23 offset:17408
    ds_read_b64_tr_b16 v[42:43], v23 offset:19456
    s_waitcnt vmcnt(7)
    s_waitcnt lgkmcnt(10)
    v_mfma_f32_32x32x16_bf16 v[56:71], v[48:51], v[188:191], v[56:71]
    ds_read_b64_tr_b16 v[44:45], v20 offset:20480
    ds_read_b64_tr_b16 v[46:47], v20 offset:22528
    s_waitcnt lgkmcnt(10)
    v_mfma_f32_32x32x16_bf16 v[72:87], v[52:55], v[188:191], v[72:87]
    ds_read_b64_tr_b16 v[48:49], v21 offset:20480
    ds_read_b64_tr_b16 v[50:51], v21 offset:22528
    s_waitcnt lgkmcnt(10)
    v_mfma_f32_32x32x16_bf16 v[120:135], v[28:31], v[188:191], v[120:135]
    ds_read_b64_tr_b16 v[52:53], v24 offset:20480
    ds_read_b64_tr_b16 v[54:55], v24 offset:22528
    s_waitcnt lgkmcnt(10)
    v_mfma_f32_32x32x16_bf16 v[136:151], v[32:35], v[188:191], v[136:151]
    buffer_load_dwordx4 v[220:223], v249, s[32:35], s16 offen offset:1024 sc1
    ds_read_b64_tr_b16 v[28:29], v25 offset:20480
    ds_read_b64_tr_b16 v[30:31], v25 offset:22528
    s_waitcnt lgkmcnt(10)
    v_mfma_f32_32x32x16_bf16 v[88:103], v[36:39], v[188:191], v[88:103]
    ds_read_b64_tr_b16 v[32:33], v22 offset:20480
    ds_read_b64_tr_b16 v[34:35], v22 offset:22528
    s_waitcnt lgkmcnt(10)
    v_mfma_f32_32x32x16_bf16 v[104:119], v[40:43], v[188:191], v[104:119]
    ds_read_b64_tr_b16 v[36:37], v23 offset:20480
    ds_read_b64_tr_b16 v[38:39], v23 offset:22528
    s_waitcnt vmcnt(7)
    s_waitcnt lgkmcnt(10)
    v_mfma_f32_32x32x16_bf16 v[56:71], v[44:47], v[192:195], v[56:71]
    ds_read_b64_tr_b16 v[40:41], v20 offset:21504
    ds_read_b64_tr_b16 v[42:43], v20 offset:23552
    s_waitcnt lgkmcnt(10)
    v_mfma_f32_32x32x16_bf16 v[72:87], v[48:51], v[192:195], v[72:87]
    ds_read_b64_tr_b16 v[44:45], v21 offset:21504
    ds_read_b64_tr_b16 v[46:47], v21 offset:23552
    s_waitcnt lgkmcnt(10)
    v_mfma_f32_32x32x16_bf16 v[120:135], v[52:55], v[192:195], v[120:135]
    buffer_load_dwordx4 v[224:227], v249, s[32:35], s16 offen offset:2048 sc1
    ds_read_b64_tr_b16 v[48:49], v24 offset:21504
    ds_read_b64_tr_b16 v[50:51], v24 offset:23552
    s_waitcnt lgkmcnt(10)
    v_mfma_f32_32x32x16_bf16 v[136:151], v[28:31], v[192:195], v[136:151]
    ds_read_b64_tr_b16 v[52:53], v25 offset:21504
    ds_read_b64_tr_b16 v[54:55], v25 offset:23552
    s_waitcnt lgkmcnt(10)
    v_mfma_f32_32x32x16_bf16 v[88:103], v[32:35], v[192:195], v[88:103]
    ds_read_b64_tr_b16 v[28:29], v22 offset:21504
    ds_read_b64_tr_b16 v[30:31], v22 offset:23552
    s_waitcnt lgkmcnt(10)
    v_mfma_f32_32x32x16_bf16 v[104:119], v[36:39], v[192:195], v[104:119]
    ds_read_b64_tr_b16 v[32:33], v23 offset:21504
    ds_read_b64_tr_b16 v[34:35], v23 offset:23552
    s_waitcnt vmcnt(7)
    s_waitcnt lgkmcnt(10)
    v_mfma_f32_32x32x16_bf16 v[56:71], v[40:43], v[196:199], v[56:71]
    ds_read_b64_tr_b16 v[36:37], v20 offset:24576
    ds_read_b64_tr_b16 v[38:39], v20 offset:26624
    s_waitcnt lgkmcnt(10)
    v_mfma_f32_32x32x16_bf16 v[72:87], v[44:47], v[196:199], v[72:87]
    buffer_load_dwordx4 v[228:231], v249, s[32:35], s16 offen offset:3072 sc1
    ds_read_b64_tr_b16 v[40:41], v21 offset:24576
    ds_read_b64_tr_b16 v[42:43], v21 offset:26624
    s_waitcnt lgkmcnt(10)
    v_mfma_f32_32x32x16_bf16 v[120:135], v[48:51], v[196:199], v[120:135]
    s_add_u32 s16, s16, 16384
    ds_read_b64_tr_b16 v[44:45], v24 offset:24576
    ds_read_b64_tr_b16 v[46:47], v24 offset:26624
    s_waitcnt lgkmcnt(10)
    v_mfma_f32_32x32x16_bf16 v[136:151], v[52:55], v[196:199], v[136:151]
    s_and_b32 s16, s16, 0x3ffff
    ds_read_b64_tr_b16 v[48:49], v25 offset:24576
    ds_read_b64_tr_b16 v[50:51], v25 offset:26624
    s_waitcnt lgkmcnt(10)
    v_mfma_f32_32x32x16_bf16 v[88:103], v[28:31], v[196:199], v[88:103]
    ds_read_b64_tr_b16 v[52:53], v22 offset:24576
    ds_read_b64_tr_b16 v[54:55], v22 offset:26624
    s_waitcnt lgkmcnt(10)
    v_mfma_f32_32x32x16_bf16 v[104:119], v[32:35], v[196:199], v[104:119]
    buffer_load_dwordx4 v[232:235], v249, s[32:35], s16 offen sc1
    ds_read_b64_tr_b16 v[28:29], v23 offset:24576
    ds_read_b64_tr_b16 v[30:31], v23 offset:26624
    s_barrier
    s_waitcnt vmcnt(8)
    s_waitcnt lgkmcnt(10)
    v_mfma_f32_32x32x16_bf16 v[56:71], v[36:39], v[200:203], v[56:71]
    ds_read_b64_tr_b16 v[32:33], v20 offset:25600
    ds_read_b64_tr_b16 v[34:35], v20 offset:27648
    s_waitcnt lgkmcnt(10)
    v_mfma_f32_32x32x16_bf16 v[72:87], v[40:43], v[200:203], v[72:87]
    ds_read_b64_tr_b16 v[36:37], v21 offset:25600
    ds_read_b64_tr_b16 v[38:39], v21 offset:27648
    s_waitcnt lgkmcnt(10)
    v_mfma_f32_32x32x16_bf16 v[120:135], v[44:47], v[200:203], v[120:135]
    ds_read_b64_tr_b16 v[40:41], v24 offset:25600
    ds_read_b64_tr_b16 v[42:43], v24 offset:27648
    s_waitcnt lgkmcnt(10)
    v_mfma_f32_32x32x16_bf16 v[136:151], v[48:51], v[200:203], v[136:151]
    ds_read_b64_tr_b16 v[44:45], v25 offset:25600
    ds_read_b64_tr_b16 v[46:47], v25 offset:27648
    s_waitcnt lgkmcnt(10)
    v_mfma_f32_32x32x16_bf16 v[88:103], v[52:55], v[200:203], v[88:103]
    buffer_load_dwordx4 v[236:239], v249, s[32:35], s16 offen offset:1024 sc1
    ds_read_b64_tr_b16 v[48:49], v22 offset:25600
    ds_read_b64_tr_b16 v[50:51], v22 offset:27648
    s_waitcnt lgkmcnt(10)
    v_mfma_f32_32x32x16_bf16 v[104:119], v[28:31], v[200:203], v[104:119]
    ds_read_b64_tr_b16 v[52:53], v23 offset:25600
    ds_read_b64_tr_b16 v[54:55], v23 offset:27648
    s_waitcnt vmcnt(8)
    s_waitcnt lgkmcnt(10)
    v_mfma_f32_32x32x16_bf16 v[56:71], v[32:35], v[204:207], v[56:71]
    ds_read_b64_tr_b16 v[28:29], v20 offset:28672
    ds_read_b64_tr_b16 v[30:31], v20 offset:30720
    s_waitcnt lgkmcnt(10)
    v_mfma_f32_32x32x16_bf16 v[72:87], v[36:39], v[204:207], v[72:87]
    ds_read_b64_tr_b16 v[32:33], v21 offset:28672
    ds_read_b64_tr_b16 v[34:35], v21 offset:30720
    s_waitcnt lgkmcnt(10)
    v_mfma_f32_32x32x16_bf16 v[120:135], v[40:43], v[204:207], v[120:135]
    ds_read_b64_tr_b16 v[36:37], v24 offset:28672
    ds_read_b64_tr_b16 v[38:39], v24 offset:30720
    s_waitcnt lgkmcnt(10)
    v_mfma_f32_32x32x16_bf16 v[136:151], v[44:47], v[204:207], v[136:151]
    buffer_load_dwordx4 v[240:243], v249, s[32:35], s16 offen offset:2048 sc1
    ds_read_b64_tr_b16 v[40:41], v25 offset:28672
    ds_read_b64_tr_b16 v[42:43], v25 offset:30720
    s_waitcnt lgkmcnt(10)
    v_mfma_f32_32x32x16_bf16 v[88:103], v[48:51], v[204:207], v[88:103]
    ds_read_b64_tr_b16 v[44:45], v22 offset:28672
    ds_read_b64_tr_b16 v[46:47], v22 offset:30720
L_PAD2:
    s_cbranch_execz L_RET2
    s_waitcnt lgkmcnt(10)
    v_mfma_f32_32x32x16_bf16 v[104:119], v[52:55], v[204:207], v[104:119]
    ds_read_b64_tr_b16 v[48:49], v23 offset:28672
    ds_read_b64_tr_b16 v[50:51], v23 offset:30720
    s_waitcnt vmcnt(8)
    s_waitcnt lgkmcnt(10)
    v_mfma_f32_32x32x16_bf16 v[56:71], v[28:31], v[208:211], v[56:71]
    ds_read_b64_tr_b16 v[52:53], v20 offset:29696
    ds_read_b64_tr_b16 v[54:55], v20 offset:31744
    s_waitcnt lgkmcnt(10)
    v_mfma_f32_32x32x16_bf16 v[72:87], v[32:35], v[208:211], v[72:87]
    ds_read_b64_tr_b16 v[28:29], v21 offset:29696
    ds_read_b64_tr_b16 v[30:31], v21 offset:31744
    s_waitcnt lgkmcnt(10)
    v_mfma_f32_32x32x16_bf16 v[120:135], v[36:39], v[208:211], v[120:135]
    buffer_load_dwordx4 v[244:247], v249, s[32:35], s16 offen offset:3072 sc1
    ds_read_b64_tr_b16 v[32:33], v24 offset:29696
    ds_read_b64_tr_b16 v[34:35], v24 offset:31744
    s_waitcnt lgkmcnt(10)
    v_mfma_f32_32x32x16_bf16 v[136:151], v[40:43], v[208:211], v[136:151]
    s_add_u32 s16, s16, 16384
    ds_read_b64_tr_b16 v[36:37], v25 offset:29696
    ds_read_b64_tr_b16 v[38:39], v25 offset:31744
    s_waitcnt lgkmcnt(10)
    v_mfma_f32_32x32x16_bf16 v[88:103], v[44:47], v[208:211], v[88:103]
    s_and_b32 s16, s16, 0x3ffff
    ds_read_b64_tr_b16 v[40:41], v22 offset:29696
    ds_read_b64_tr_b16 v[42:43], v22 offset:31744
    s_waitcnt lgkmcnt(10)
    v_mfma_f32_32x32x16_bf16 v[104:119], v[48:51], v[208:211], v[104:119]
    ds_read_b64_tr_b16 v[44:45], v23 offset:29696
    ds_read_b64_tr_b16 v[46:47], v23 offset:31744
    s_waitcnt vmcnt(8)
    s_waitcnt lgkmcnt(10)
    v_mfma_f32_32x32x16_bf16 v[56:71], v[52:55], v[212:215], v[56:71]
    ds_read_b64_tr_b16 v[48:49], v20 offset:32768
    ds_read_b64_tr_b16 v[50:51], v20 offset:34816
    s_waitcnt lgkmcnt(10)
    v_mfma_f32_32x32x16_bf16 v[72:87], v[28:31], v[212:215], v[72:87]
    buffer_load_dwordx4 v[152:155], v249, s[32:35], s16 offen sc1
    ds_read_b64_tr_b16 v[52:53], v21 offset:32768
    ds_read_b64_tr_b16 v[54:55], v21 offset:34816
    s_waitcnt lgkmcnt(10)
    v_mfma_f32_32x32x16_bf16 v[120:135], v[32:35], v[212:215], v[120:135]
    ds_read_b64_tr_b16 v[28:29], v24 offset:32768
    ds_read_b64_tr_b16 v[30:31], v24 offset:34816
    s_waitcnt lgkmcnt(10)
    v_mfma_f32_32x32x16_bf16 v[136:151], v[36:39], v[212:215], v[136:151]
    ds_read_b64_tr_b16 v[32:33], v25 offset:32768
    ds_read_b64_tr_b16 v[34:35], v25 offset:34816
    s_waitcnt lgkmcnt(10)
    v_mfma_f32_32x32x16_bf16 v[88:103], v[40:43], v[212:215], v[88:103]
    ds_read_b64_tr_b16 v[36:37], v22 offset:32768
    ds_read_b64_tr_b16 v[38:39], v22 offset:34816
    s_waitcnt lgkmcnt(10)
    v_mfma_f32_32x32x16_bf16 v[104:119], v[44:47], v[212:215], v[104:119]
    buffer_load_dwordx4 v[156:159], v249, s[32:35], s16 offen offset:1024 sc1
    ds_read_b64_tr_b16 v[40:41], v23 offset:32768
    ds_read_b64_tr_b16 v[42:43], v23 offset:34816
    s_barrier
    s_waitcnt vmcnt(9)
    s_waitcnt lgkmcnt(10)
    v_mfma_f32_32x32x16_bf16 v[56:71], v[48:51], v[216:219], v[56:71]
    ds_read_b64_tr_b16 v[44:45], v20 offset:33792
    ds_read_b64_tr_b16 v[46:47], v20 offset:35840
    s_waitcnt lgkmcnt(10)
    v_mfma_f32_32x32x16_bf16 v[72:87], v[52:55], v[216:219], v[72:87]
    ds_read_b64_tr_b16 v[48:49], v21 offset:33792
    ds_read_b64_tr_b16 v[50:51], v21 offset:35840
    s_waitcnt lgkmcnt(10)
    v_mfma_f32_32x32x16_bf16 v[120:135], v[28:31], v[216:219], v[120:135]
    ds_read_b64_tr_b16 v[52:53], v24 offset:33792
    ds_read_b64_tr_b16 v[54:55], v24 offset:35840
    s_waitcnt lgkmcnt(10)
    v_mfma_f32_32x32x16_bf16 v[136:151], v[32:35], v[216:219], v[136:151]
    ds_read_b64_tr_b16 v[28:29], v25 offset:33792
    ds_read_b64_tr_b16 v[30:31], v25 offset:35840
    s_waitcnt lgkmcnt(10)
    v_mfma_f32_32x32x16_bf16 v[88:103], v[36:39], v[216:219], v[88:103]
    buffer_load_dwordx4 v[160:163], v249, s[32:35], s16 offen offset:2048 sc1
    ds_read_b64_tr_b16 v[32:33], v22 offset:33792
    ds_read_b64_tr_b16 v[34:35], v22 offset:35840
    s_waitcnt lgkmcnt(10)
    v_mfma_f32_32x32x16_bf16 v[104:119], v[40:43], v[216:219], v[104:119]
    ds_read_b64_tr_b16 v[36:37], v23 offset:33792
    ds_read_b64_tr_b16 v[38:39], v23 offset:35840
    s_waitcnt vmcnt(9)
    s_waitcnt lgkmcnt(10)
    v_mfma_f32_32x32x16_bf16 v[56:71], v[44:47], v[220:223], v[56:71]
    ds_read_b64_tr_b16 v[40:41], v20 offset:36864
    ds_read_b64_tr_b16 v[42:43], v20 offset:38912
    s_waitcnt lgkmcnt(10)
    v_mfma_f32_32x32x16_bf16 v[72:87], v[48:51], v[220:223], v[72:87]
    ds_read_b64_tr_b16 v[44:45], v21 offset:36864
    ds_read_b64_tr_b16 v[46:47], v21 offset:38912
    s_waitcnt lgkmcnt(10)
    v_mfma_f32_32x32x16_bf16 v[120:135], v[52:55], v[220:223], v[120:135]
    ds_read_b64_tr_b16 v[48:49], v24 offset:36864
    ds_read_b64_tr_b16 v[50:51], v24 offset:38912
    s_waitcnt lgkmcnt(10)
    v_mfma_f32_32x32x16_bf16 v[136:151], v[28:31], v[220:223], v[136:151]
    buffer_load_dwordx4 v[164:167], v249, s[32:35], s16 offen offset:3072 sc1
    ds_read_b64_tr_b16 v[52:53], v25 offset:36864
    ds_read_b64_tr_b16 v[54:55], v25 offset:38912
    s_waitcnt lgkmcnt(10)
    v_mfma_f32_32x32x16_bf16 v[88:103], v[32:35], v[220:223], v[88:103]
    s_add_u32 s16, s16, 16384
    ds_read_b64_tr_b16 v[28:29], v22 offset:36864
    ds_read_b64_tr_b16 v[30:31], v22 offset:38912
    s_waitcnt lgkmcnt(10)
    v_mfma_f32_32x32x16_bf16 v[104:119], v[36:39], v[220:223], v[104:119]
    s_and_b32 s16, s16, 0x3ffff
    ds_read_b64_tr_b16 v[32:33], v23 offset:36864
    ds_read_b64_tr_b16 v[34:35], v23 offset:38912
    s_waitcnt vmcnt(9)
    s_waitcnt lgkmcnt(10)
    v_mfma_f32_32x32x16_bf16 v[56:71], v[40:43], v[224:227], v[56:71]
    ds_read_b64_tr_b16 v[36:37], v20 offset:37888
    ds_read_b64_tr_b16 v[38:39], v20 offset:39936
    s_waitcnt lgkmcnt(10)
    v_mfma_f32_32x32x16_bf16 v[72:87], v[44:47], v[224:227], v[72:87]
    ds_read_b64_tr_b16 v[40:41], v21 offset:37888
    ds_read_b64_tr_b16 v[42:43], v21 offset:39936
    s_waitcnt lgkmcnt(10)
    v_mfma_f32_32x32x16_bf16 v[120:135], v[48:51], v[224:227], v[120:135]
    buffer_load_dwordx4 v[168:171], v249, s[32:35], s16 offen sc1
    ds_read_b64_tr_b16 v[44:45], v24 offset:37888
    ds_read_b64_tr_b16 v[46:47], v24 offset:39936
    s_waitcnt lgkmcnt(10)
    v_mfma_f32_32x32x16_bf16 v[136:151], v[52:55], v[224:227], v[136:151]
    ds_read_b64_tr_b16 v[48:49], v25 offset:37888
    ds_read_b64_tr_b16 v[50:51], v25 offset:39936
    s_waitcnt lgkmcnt(10)
    v_mfma_f32_32x32x16_bf16 v[88:103], v[28:31], v[224:227], v[88:103]
    ds_read_b64_tr_b16 v[52:53], v22 offset:37888
    ds_read_b64_tr_b16 v[54:55], v22 offset:39936
    s_waitcnt lgkmcnt(10)
    v_mfma_f32_32x32x16_bf16 v[104:119], v[32:35], v[224:227], v[104:119]
    ds_read_b64_tr_b16 v[28:29], v23 offset:37888
    ds_read_b64_tr_b16 v[30:31], v23 offset:39936
    s_waitcnt vmcnt(9)
    s_waitcnt lgkmcnt(10)
    v_mfma_f32_32x32x16_bf16 v[56:71], v[36:39], v[228:231], v[56:71]
    ds_read_b64_tr_b16 v[32:33], v20 offset:40960
    ds_read_b64_tr_b16 v[34:35], v20 offset:43008
    s_waitcnt lgkmcnt(10)
    v_mfma_f32_32x32x16_bf16 v[72:87], v[40:43], v[228:231], v[72:87]
    buffer_load_dwordx4 v[172:175], v249, s[32:35], s16 offen offset:1024 sc1
    ds_read_b64_tr_b16 v[36:37], v21 offset:40960
    ds_read_b64_tr_b16 v[38:39], v21 offset:43008
    s_waitcnt lgkmcnt(10)
    v_mfma_f32_32x32x16_bf16 v[120:135], v[44:47], v[228:231], v[120:135]
    ds_read_b64_tr_b16 v[40:41], v24 offset:40960
    ds_read_b64_tr_b16 v[42:43], v24 offset:43008
    s_waitcnt lgkmcnt(10)
    v_mfma_f32_32x32x16_bf16 v[136:151], v[48:51], v[228:231], v[136:151]
    ds_read_b64_tr_b16 v[44:45], v25 offset:40960
    ds_read_b64_tr_b16 v[46:47], v25 offset:43008
    s_waitcnt lgkmcnt(10)
    v_mfma_f32_32x32x16_bf16 v[88:103], v[52:55], v[228:231], v[88:103]
    ds_read_b64_tr_b16 v[48:49], v22 offset:40960
    ds_read_b64_tr_b16 v[50:51], v22 offset:43008
    s_waitcnt lgkmcnt(10)
    v_mfma_f32_32x32x16_bf16 v[104:119], v[28:31], v[228:231], v[104:119]
    buffer_load_dwordx4 v[176:179], v249, s[32:35], s16 offen offset:2048 sc1
    ds_read_b64_tr_b16 v[52:53], v23 offset:40960
    ds_read_b64_tr_b16 v[54:55], v23 offset:43008
    s_barrier
    s_waitcnt vmcnt(10)
    s_waitcnt lgkmcnt(10)
    v_mfma_f32_32x32x16_bf16 v[56:71], v[32:35], v[232:235], v[56:71]
    ds_read_b64_tr_b16 v[28:29], v20 offset:41984
    ds_read_b64_tr_b16 v[30:31], v20 offset:44032
    s_waitcnt lgkmcnt(10)
    v_mfma_f32_32x32x16_bf16 v[72:87], v[36:39], v[232:235], v[72:87]
    ds_read_b64_tr_b16 v[32:33], v21 offset:41984
    ds_read_b64_tr_b16 v[34:35], v21 offset:44032
    s_waitcnt lgkmcnt(10)
    v_mfma_f32_32x32x16_bf16 v[120:135], v[40:43], v[232:235], v[120:135]
    ds_read_b64_tr_b16 v[36:37], v24 offset:41984
    ds_read_b64_tr_b16 v[38:39], v24 offset:44032
    s_waitcnt lgkmcnt(10)
    v_mfma_f32_32x32x16_bf16 v[136:151], v[44:47], v[232:235], v[136:151]
    buffer_load_dwordx4 v[180:183], v249, s[32:35], s16 offen offset:3072 sc1
    ds_read_b64_tr_b16 v[40:41], v25 offset:41984
    ds_read_b64_tr_b16 v[42:43], v25 offset:44032
    s_waitcnt lgkmcnt(10)
    v_mfma_f32_32x32x16_bf16 v[88:103], v[48:51], v[232:235], v[88:103]
    s_add_u32 s16, s16, 16384
    ds_read_b64_tr_b16 v[44:45], v22 offset:41984
    ds_read_b64_tr_b16 v[46:47], v22 offset:44032
    s_waitcnt lgkmcnt(10)
    v_mfma_f32_32x32x16_bf16 v[104:119], v[52:55], v[232:235], v[104:119]
    s_and_b32 s16, s16, 0x3ffff
    ds_read_b64_tr_b16 v[48:49], v23 offset:41984
    ds_read_b64_tr_b16 v[50:51], v23 offset:44032
    s_waitcnt vmcnt(10)
    s_waitcnt lgkmcnt(10)
    v_mfma_f32_32x32x16_bf16 v[56:71], v[28:31], v[236:239], v[56:71]
    buffer_load_dwordx4 v[184:187], v249, s[32:35], s16 offen sc1
    ds_read_b64_tr_b16 v[52:53], v20 offset:45056
    ds_read_b64_tr_b16 v[54:55], v20 offset:47104
    s_waitcnt lgkmcnt(10)
    v_mfma_f32_32x32x16_bf16 v[72:87], v[32:35], v[236:239], v[72:87]
    ds_read_b64_tr_b16 v[28:29], v21 offset:45056
    ds_read_b64_tr_b16 v[30:31], v21 offset:47104
    s_waitcnt lgkmcnt(10)
    v_mfma_f32_32x32x16_bf16 v[120:135], v[36:39], v[236:239], v[120:135]
    ds_read_b64_tr_b16 v[32:33], v24 offset:45056
    ds_read_b64_tr_b16 v[34:35], v24 offset:47104
    s_waitcnt lgkmcnt(10)
    v_mfma_f32_32x32x16_bf16 v[136:151], v[40:43], v[236:239], v[136:151]
    ds_read_b64_tr_b16 v[36:37], v25 offset:45056
    ds_read_b64_tr_b16 v[38:39], v25 offset:47104
    s_waitcnt lgkmcnt(10)
    v_mfma_f32_32x32x16_bf16 v[88:103], v[44:47], v[236:239], v[88:103]
    buffer_load_dwordx4 v[188:191], v249, s[32:35], s16 offen offset:1024 sc1
    ds_read_b64_tr_b16 v[40:41], v22 offset:45056
    ds_read_b64_tr_b16 v[42:43], v22 offset:47104
    s_waitcnt lgkmcnt(10)
    v_mfma_f32_32x32x16_bf16 v[104:119], v[48:51], v[236:239], v[104:119]
    ds_read_b64_tr_b16 v[44:45], v23 offset:45056
    ds_read_b64_tr_b16 v[46:47], v23 offset:47104
    s_waitcnt vmcnt(11)
    s_waitcnt lgkmcnt(10)
    v_mfma_f32_32x32x16_bf16 v[56:71], v[52:55], v[240:243], v[56:71]
    ds_read_b64_tr_b16 v[48:49], v20 offset:46080
    ds_read_b64_tr_b16 v[50:51], v20 offset:48128
    s_waitcnt lgkmcnt(10)
    v_mfma_f32_32x32x16_bf16 v[72:87], v[28:31], v[240:243], v[72:87]
    buffer_load_dwordx4 v[192:195], v249, s[32:35], s16 offen offset:2048 sc1
    ds_read_b64_tr_b16 v[52:53], v21 offset:46080
    ds_read_b64_tr_b16 v[54:55], v21 offset:48128
    s_waitcnt lgkmcnt(10)
    v_mfma_f32_32x32x16_bf16 v[120:135], v[32:35], v[240:243], v[120:135]
    ds_read_b64_tr_b16 v[28:29], v24 offset:46080
    ds_read_b64_tr_b16 v[30:31], v24 offset:48128
    s_waitcnt lgkmcnt(10)
    v_mfma_f32_32x32x16_bf16 v[136:151], v[36:39], v[240:243], v[136:151]
    ds_read_b64_tr_b16 v[32:33], v25 offset:46080
    ds_read_b64_tr_b16 v[34:35], v25 offset:48128
    s_waitcnt lgkmcnt(10)
    v_mfma_f32_32x32x16_bf16 v[88:103], v[40:43], v[240:243], v[88:103]
    ds_read_b64_tr_b16 v[36:37], v22 offset:46080
    ds_read_b64_tr_b16 v[38:39], v22 offset:48128
    s_waitcnt lgkmcnt(10)
    v_mfma_f32_32x32x16_bf16 v[104:119], v[44:47], v[240:243], v[104:119]
    buffer_load_dwordx4 v[196:199], v249, s[32:35], s16 offen offset:3072 sc1
    ds_read_b64_tr_b16 v[40:41], v23 offset:46080
    ds_read_b64_tr_b16 v[42:43], v23 offset:48128
    s_waitcnt vmcnt(12)
    s_waitcnt lgkmcnt(10)
    v_mfma_f32_32x32x16_bf16 v[56:71], v[48:51], v[244:247], v[56:71]
    s_add_u32 s16, s16, 16384
    ds_read_b64_tr_b16 v[44:45], v20
    ds_read_b64_tr_b16 v[46:47], v20 offset:2048
    s_waitcnt lgkmcnt(10)
    v_mfma_f32_32x32x16_bf16 v[72:87], v[52:55], v[244:247], v[72:87]
    s_and_b32 s16, s16, 0x3ffff
    ds_read_b64_tr_b16 v[48:49], v21
    ds_read_b64_tr_b16 v[50:51], v21 offset:2048
    s_waitcnt lgkmcnt(10)
    v_mfma_f32_32x32x16_bf16 v[120:135], v[28:31], v[244:247], v[120:135]
    buffer_load_dwordx4 v[200:203], v249, s[32:35], s16 offen sc1
    ds_read_b64_tr_b16 v[52:53], v24
    ds_read_b64_tr_b16 v[54:55], v24 offset:2048
    s_waitcnt lgkmcnt(10)
    v_mfma_f32_32x32x16_bf16 v[136:151], v[32:35], v[244:247], v[136:151]
    ds_read_b64_tr_b16 v[28:29], v25
    ds_read_b64_tr_b16 v[30:31], v25 offset:2048
    s_waitcnt lgkmcnt(10)
    v_mfma_f32_32x32x16_bf16 v[88:103], v[36:39], v[244:247], v[88:103]
    ds_read_b64_tr_b16 v[32:33], v22
    ds_read_b64_tr_b16 v[34:35], v22 offset:2048
    s_waitcnt lgkmcnt(10)
    v_mfma_f32_32x32x16_bf16 v[104:119], v[40:43], v[244:247], v[104:119]
    buffer_load_dwordx4 v[204:207], v249, s[32:35], s16 offen offset:1024 sc1
    ds_read_b64_tr_b16 v[36:37], v23
    ds_read_b64_tr_b16 v[38:39], v23 offset:2048
    s_barrier
    s_waitcnt vmcnt(13)
    s_waitcnt lgkmcnt(10)
    v_mfma_f32_32x32x16_bf16 v[56:71], v[44:47], v[152:155], v[56:71]
    ds_read_b64_tr_b16 v[40:41], v20 offset:1024
    ds_read_b64_tr_b16 v[42:43], v20 offset:3072
    s_waitcnt lgkmcnt(10)
    v_mfma_f32_32x32x16_bf16 v[72:87], v[48:51], v[152:155], v[72:87]
    ds_read_b64_tr_b16 v[44:45], v21 offset:1024
    ds_read_b64_tr_b16 v[46:47], v21 offset:3072
    s_waitcnt lgkmcnt(10)
    v_mfma_f32_32x32x16_bf16 v[120:135], v[52:55], v[152:155], v[120:135]
    ds_read_b64_tr_b16 v[48:49], v24 offset:1024
    ds_read_b64_tr_b16 v[50:51], v24 offset:3072
    s_waitcnt lgkmcnt(10)
    v_mfma_f32_32x32x16_bf16 v[136:151], v[28:31], v[152:155], v[136:151]
    buffer_load_dwordx4 v[208:211], v249, s[32:35], s16 offen offset:2048 sc1
    ds_read_b64_tr_b16 v[52:53], v25 offset:1024
    ds_read_b64_tr_b16 v[54:55], v25 offset:3072
    s_waitcnt lgkmcnt(10)
    v_mfma_f32_32x32x16_bf16 v[88:103], v[32:35], v[152:155], v[88:103]
    ds_read_b64_tr_b16 v[28:29], v22 offset:1024
    ds_read_b64_tr_b16 v[30:31], v22 offset:3072
    s_waitcnt lgkmcnt(10)
    v_mfma_f32_32x32x16_bf16 v[104:119], v[36:39], v[152:155], v[104:119]
    ds_read_b64_tr_b16 v[32:33], v23 offset:1024
    ds_read_b64_tr_b16 v[34:35], v23 offset:3072
    s_waitcnt vmcnt(13)
    s_waitcnt lgkmcnt(10)
    v_mfma_f32_32x32x16_bf16 v[56:71], v[40:43], v[156:159], v[56:71]
    buffer_load_dwordx4 v[212:215], v249, s[32:35], s16 offen offset:3072 sc1
    ds_read_b64_tr_b16 v[36:37], v20 offset:4096
    ds_read_b64_tr_b16 v[38:39], v20 offset:6144
    s_waitcnt lgkmcnt(10)
    v_mfma_f32_32x32x16_bf16 v[72:87], v[44:47], v[156:159], v[72:87]
    s_add_u32 s16, s16, 16384
    ds_read_b64_tr_b16 v[40:41], v21 offset:4096
    ds_read_b64_tr_b16 v[42:43], v21 offset:6144
    s_waitcnt lgkmcnt(10)
    v_mfma_f32_32x32x16_bf16 v[120:135], v[48:51], v[156:159], v[120:135]
    s_and_b32 s16, s16, 0x3ffff
    ds_read_b64_tr_b16 v[44:45], v24 offset:4096
    ds_read_b64_tr_b16 v[46:47], v24 offset:6144
    s_waitcnt lgkmcnt(10)
    v_mfma_f32_32x32x16_bf16 v[136:151], v[52:55], v[156:159], v[136:151]
    ds_read_b64_tr_b16 v[48:49], v25 offset:4096
    ds_read_b64_tr_b16 v[50:51], v25 offset:6144
    s_waitcnt lgkmcnt(10)
    v_mfma_f32_32x32x16_bf16 v[88:103], v[28:31], v[156:159], v[88:103]
    buffer_load_dwordx4 v[216:219], v249, s[32:35], s16 offen sc1
    ds_read_b64_tr_b16 v[52:53], v22 offset:4096
    ds_read_b64_tr_b16 v[54:55], v22 offset:6144
    s_waitcnt lgkmcnt(10)
    v_mfma_f32_32x32x16_bf16 v[104:119], v[32:35], v[156:159], v[104:119]
    ds_read_b64_tr_b16 v[28:29], v23 offset:4096
    ds_read_b64_tr_b16 v[30:31], v23 offset:6144
    s_waitcnt vmcnt(14)
    s_waitcnt lgkmcnt(10)
    v_mfma_f32_32x32x16_bf16 v[56:71], v[36:39], v[160:163], v[56:71]
    ds_read_b64_tr_b16 v[32:33], v20 offset:5120
    ds_read_b64_tr_b16 v[34:35], v20 offset:7168
    s_waitcnt lgkmcnt(10)
    v_mfma_f32_32x32x16_bf16 v[72:87], v[40:43], v[160:163], v[72:87]
    buffer_load_dwordx4 v[220:223], v249, s[32:35], s16 offen offset:1024 sc1
    ds_read_b64_tr_b16 v[36:37], v21 offset:5120
    ds_read_b64_tr_b16 v[38:39], v21 offset:7168
    s_waitcnt lgkmcnt(10)
    v_mfma_f32_32x32x16_bf16 v[120:135], v[44:47], v[160:163], v[120:135]
    ds_read_b64_tr_b16 v[40:41], v24 offset:5120
    ds_read_b64_tr_b16 v[42:43], v24 offset:7168
    s_waitcnt lgkmcnt(10)
    v_mfma_f32_32x32x16_bf16 v[136:151], v[48:51], v[160:163], v[136:151]
    ds_read_b64_tr_b16 v[44:45], v25 offset:5120
    ds_read_b64_tr_b16 v[46:47], v25 offset:7168
    s_waitcnt lgkmcnt(10)
    v_mfma_f32_32x32x16_bf16 v[88:103], v[52:55], v[160:163], v[88:103]
    ds_read_b64_tr_b16 v[48:49], v22 offset:5120
    ds_read_b64_tr_b16 v[50:51], v22 offset:7168
    s_waitcnt lgkmcnt(10)
    v_mfma_f32_32x32x16_bf16 v[104:119], v[28:31], v[160:163], v[104:119]
    buffer_load_dwordx4 v[224:227], v249, s[32:35], s16 offen offset:2048 sc1
    ds_read_b64_tr_b16 v[52:53], v23 offset:5120
    ds_read_b64_tr_b16 v[54:55], v23 offset:7168
    s_waitcnt vmcnt(15)
    s_waitcnt lgkmcnt(10)
    v_mfma_f32_32x32x16_bf16 v[56:71], v[32:35], v[164:167], v[56:71]
    ds_read_b64_tr_b16 v[28:29], v20 offset:8192
    ds_read_b64_tr_b16 v[30:31], v20 offset:10240
    s_waitcnt lgkmcnt(10)
    v_mfma_f32_32x32x16_bf16 v[72:87], v[36:39], v[164:167], v[72:87]
    ds_read_b64_tr_b16 v[32:33], v21 offset:8192
    ds_read_b64_tr_b16 v[34:35], v21 offset:10240
    s_waitcnt lgkmcnt(10)
    v_mfma_f32_32x32x16_bf16 v[120:135], v[40:43], v[164:167], v[120:135]
    buffer_load_dwordx4 v[228:231], v249, s[32:35], s16 offen offset:3072 sc1
    ds_read_b64_tr_b16 v[36:37], v24 offset:8192
    ds_read_b64_tr_b16 v[38:39], v24 offset:10240
    s_waitcnt lgkmcnt(10)
    v_mfma_f32_32x32x16_bf16 v[136:151], v[44:47], v[164:167], v[136:151]
    s_add_u32 s16, s16, 16384
    ds_read_b64_tr_b16 v[40:41], v25 offset:8192
    ds_read_b64_tr_b16 v[42:43], v25 offset:10240
    s_waitcnt lgkmcnt(10)
    v_mfma_f32_32x32x16_bf16 v[88:103], v[48:51], v[164:167], v[88:103]
    s_and_b32 s16, s16, 0x3ffff
    ds_read_b64_tr_b16 v[44:45], v22 offset:8192
    ds_read_b64_tr_b16 v[46:47], v22 offset:10240
    s_waitcnt lgkmcnt(10)
    v_mfma_f32_32x32x16_bf16 v[104:119], v[52:55], v[164:167], v[104:119]
    buffer_load_dwordx4 v[232:235], v249, s[32:35], s16 offen sc1
    ds_read_b64_tr_b16 v[48:49], v23 offset:8192
    ds_read_b64_tr_b16 v[50:51], v23 offset:10240
    s_barrier
    s_waitcnt vmcnt(16)
    s_waitcnt lgkmcnt(10)
    v_mfma_f32_32x32x16_bf16 v[56:71], v[28:31], v[168:171], v[56:71]
    ds_read_b64_tr_b16 v[52:53], v20 offset:9216
    ds_read_b64_tr_b16 v[54:55], v20 offset:11264
    s_waitcnt lgkmcnt(10)
    v_mfma_f32_32x32x16_bf16 v[72:87], v[32:35], v[168:171], v[72:87]
    ds_read_b64_tr_b16 v[28:29], v21 offset:9216
    ds_read_b64_tr_b16 v[30:31], v21 offset:11264
    s_waitcnt lgkmcnt(10)
    v_mfma_f32_32x32x16_bf16 v[120:135], v[36:39], v[168:171], v[120:135]
    ds_read_b64_tr_b16 v[32:33], v24 offset:9216
    ds_read_b64_tr_b16 v[34:35], v24 offset:11264
    s_waitcnt lgkmcnt(10)
    v_mfma_f32_32x32x16_bf16 v[136:151], v[40:43], v[168:171], v[136:151]
    buffer_load_dwordx4 v[236:239], v249, s[32:35], s16 offen offset:1024 sc1
    ds_read_b64_tr_b16 v[36:37], v25 offset:9216
    ds_read_b64_tr_b16 v[38:39], v25 offset:11264
    s_waitcnt lgkmcnt(10)
    v_mfma_f32_32x32x16_bf16 v[88:103], v[44:47], v[168:171], v[88:103]
    ds_read_b64_tr_b16 v[40:41], v22 offset:9216
    ds_read_b64_tr_b16 v[42:43], v22 offset:11264
    s_waitcnt lgkmcnt(10)
    v_mfma_f32_32x32x16_bf16 v[104:119], v[48:51], v[168:171], v[104:119]
    ds_read_b64_tr_b16 v[44:45], v23 offset:9216
    ds_read_b64_tr_b16 v[46:47], v23 offset:11264
    s_waitcnt vmcnt(16)
    s_waitcnt lgkmcnt(10)
    v_mfma_f32_32x32x16_bf16 v[56:71], v[52:55], v[172:175], v[56:71]
    buffer_load_dwordx4 v[240:243], v249, s[32:35], s16 offen offset:2048 sc1
    ds_read_b64_tr_b16 v[48:49], v20 offset:12288
    ds_read_b64_tr_b16 v[50:51], v20 offset:14336
    s_waitcnt lgkmcnt(10)
    v_mfma_f32_32x32x16_bf16 v[72:87], v[28:31], v[172:175], v[72:87]
    ds_read_b64_tr_b16 v[52:53], v21 offset:12288
    ds_read_b64_tr_b16 v[54:55], v21 offset:14336
    s_waitcnt lgkmcnt(10)
    v_mfma_f32_32x32x16_bf16 v[120:135], v[32:35], v[172:175], v[120:135]
    ds_read_b64_tr_b16 v[28:29], v24 offset:12288
    ds_read_b64_tr_b16 v[30:31], v24 offset:14336
    s_waitcnt lgkmcnt(10)
    v_mfma_f32_32x32x16_bf16 v[136:151], v[36:39], v[172:175], v[136:151]
    ds_read_b64_tr_b16 v[32:33], v25 offset:12288
    ds_read_b64_tr_b16 v[34:35], v25 offset:14336
    s_waitcnt lgkmcnt(10)
    v_mfma_f32_32x32x16_bf16 v[88:103], v[40:43], v[172:175], v[88:103]
    buffer_load_dwordx4 v[244:247], v249, s[32:35], s16 offen offset:3072 sc1
    ds_read_b64_tr_b16 v[36:37], v22 offset:12288
    ds_read_b64_tr_b16 v[38:39], v22 offset:14336
    s_waitcnt lgkmcnt(10)
    v_mfma_f32_32x32x16_bf16 v[104:119], v[44:47], v[172:175], v[104:119]
    s_add_u32 s16, s16, 16384
    ds_read_b64_tr_b16 v[40:41], v23 offset:12288
    ds_read_b64_tr_b16 v[42:43], v23 offset:14336
    s_waitcnt vmcnt(17)
    s_waitcnt lgkmcnt(10)
    v_mfma_f32_32x32x16_bf16 v[56:71], v[48:51], v[176:179], v[56:71]
    s_and_b32 s16, s16, 0x3ffff
    ds_read_b64_tr_b16 v[44:45], v20 offset:13312
    ds_read_b64_tr_b16 v[46:47], v20 offset:15360
    s_waitcnt lgkmcnt(10)
    v_mfma_f32_32x32x16_bf16 v[72:87], v[52:55], v[176:179], v[72:87]
    buffer_load_dwordx4 v[152:155], v249, s[32:35], s16 offen sc1
    ds_read_b64_tr_b16 v[48:49], v21 offset:13312
    ds_read_b64_tr_b16 v[50:51], v21 offset:15360
    s_waitcnt lgkmcnt(10)
    v_mfma_f32_32x32x16_bf16 v[120:135], v[28:31], v[176:179], v[120:135]
    ds_read_b64_tr_b16 v[52:53], v24 offset:13312
    ds_read_b64_tr_b16 v[54:55], v24 offset:15360
    s_waitcnt lgkmcnt(10)
    v_mfma_f32_32x32x16_bf16 v[136:151], v[32:35], v[176:179], v[136:151]
    ds_read_b64_tr_b16 v[28:29], v25 offset:13312
    ds_read_b64_tr_b16 v[30:31], v25 offset:15360
    s_waitcnt lgkmcnt(10)
    v_mfma_f32_32x32x16_bf16 v[88:103], v[36:39], v[176:179], v[88:103]
    ds_read_b64_tr_b16 v[32:33], v22 offset:13312
    ds_read_b64_tr_b16 v[34:35], v22 offset:15360
    s_waitcnt lgkmcnt(10)
    v_mfma_f32_32x32x16_bf16 v[104:119], v[40:43], v[176:179], v[104:119]
    buffer_load_dwordx4 v[156:159], v249, s[32:35], s16 offen offset:1024 sc1
    ds_read_b64_tr_b16 v[36:37], v23 offset:13312
    ds_read_b64_tr_b16 v[38:39], v23 offset:15360
    s_waitcnt vmcnt(18)
    s_waitcnt lgkmcnt(10)
    v_mfma_f32_32x32x16_bf16 v[56:71], v[44:47], v[180:183], v[56:71]
    ds_read_b64_tr_b16 v[40:41], v20 offset:16384
    ds_read_b64_tr_b16 v[42:43], v20 offset:18432
    s_waitcnt lgkmcnt(10)
    v_mfma_f32_32x32x16_bf16 v[72:87], v[48:51], v[180:183], v[72:87]
    ds_read_b64_tr_b16 v[44:45], v21 offset:16384
    ds_read_b64_tr_b16 v[46:47], v21 offset:18432
    s_waitcnt lgkmcnt(10)
    v_mfma_f32_32x32x16_bf16 v[120:135], v[52:55], v[180:183], v[120:135]
    buffer_load_dwordx4 v[160:163], v249, s[32:35], s16 offen offset:2048 sc1
    ds_read_b64_tr_b16 v[48:49], v24 offset:16384
    ds_read_b64_tr_b16 v[50:51], v24 offset:18432
    s_waitcnt lgkmcnt(10)
    v_mfma_f32_32x32x16_bf16 v[136:151], v[28:31], v[180:183], v[136:151]
    ds_read_b64_tr_b16 v[52:53], v25 offset:16384
    ds_read_b64_tr_b16 v[54:55], v25 offset:18432
    s_waitcnt lgkmcnt(10)
    v_mfma_f32_32x32x16_bf16 v[88:103], v[32:35], v[180:183], v[88:103]
    ds_read_b64_tr_b16 v[28:29], v22 offset:16384
    ds_read_b64_tr_b16 v[30:31], v22 offset:18432
    s_waitcnt lgkmcnt(10)
    v_mfma_f32_32x32x16_bf16 v[104:119], v[36:39], v[180:183], v[104:119]
    buffer_load_dwordx4 v[164:167], v249, s[32:35], s16 offen offset:3072 sc1
    ds_read_b64_tr_b16 v[32:33], v23 offset:16384
    ds_read_b64_tr_b16 v[34:35], v23 offset:18432
    s_barrier
    s_waitcnt vmcnt(19)
    s_waitcnt lgkmcnt(10)
    v_mfma_f32_32x32x16_bf16 v[56:71], v[40:43], v[184:187], v[56:71]
    s_add_u32 s16, s16, 16384
    ds_read_b64_tr_b16 v[36:37], v20 offset:17408
    ds_read_b64_tr_b16 v[38:39], v20 offset:19456
    s_waitcnt lgkmcnt(10)
    v_mfma_f32_32x32x16_bf16 v[72:87], v[44:47], v[184:187], v[72:87]
    s_and_b32 s16, s16, 0x3ffff
    ds_read_b64_tr_b16 v[40:41], v21 offset:17408
    ds_read_b64_tr_b16 v[42:43], v21 offset:19456
    s_waitcnt lgkmcnt(10)
    v_mfma_f32_32x32x16_bf16 v[120:135], v[48:51], v[184:187], v[120:135]
    ds_read_b64_tr_b16 v[44:45], v24 offset:17408
    ds_read_b64_tr_b16 v[46:47], v24 offset:19456
    s_waitcnt lgkmcnt(10)
    v_mfma_f32_32x32x16_bf16 v[136:151], v[52:55], v[184:187], v[136:151]
    buffer_load_dwordx4 v[168:171], v249, s[32:35], s16 offen sc1
    ds_read_b64_tr_b16 v[48:49], v25 offset:17408
    ds_read_b64_tr_b16 v[50:51], v25 offset:19456
    s_waitcnt lgkmcnt(10)
    v_mfma_f32_32x32x16_bf16 v[88:103], v[28:31], v[184:187], v[88:103]
    ds_read_b64_tr_b16 v[52:53], v22 offset:17408
    ds_read_b64_tr_b16 v[54:55], v22 offset:19456
    s_waitcnt lgkmcnt(10)
    v_mfma_f32_32x32x16_bf16 v[104:119], v[32:35], v[184:187], v[104:119]
    ds_read_b64_tr_b16 v[28:29], v23 offset:17408
    ds_read_b64_tr_b16 v[30:31], v23 offset:19456
    s_waitcnt vmcnt(19)
    s_waitcnt lgkmcnt(10)
    v_mfma_f32_32x32x16_bf16 v[56:71], v[36:39], v[188:191], v[56:71]
    ds_read_b64_tr_b16 v[32:33], v20 offset:20480
    ds_read_b64_tr_b16 v[34:35], v20 offset:22528
    s_waitcnt lgkmcnt(10)
    v_mfma_f32_32x32x16_bf16 v[72:87], v[40:43], v[188:191], v[72:87]
    buffer_load_dwordx4 v[172:175], v249, s[32:35], s16 offen offset:1024 sc1
    ds_read_b64_tr_b16 v[36:37], v21 offset:20480
    ds_read_b64_tr_b16 v[38:39], v21 offset:22528
    s_waitcnt lgkmcnt(10)
    v_mfma_f32_32x32x16_bf16 v[120:135], v[44:47], v[188:191], v[120:135]
    ds_read_b64_tr_b16 v[40:41], v24 offset:20480
    ds_read_b64_tr_b16 v[42:43], v24 offset:22528
    s_waitcnt lgkmcnt(10)
    v_mfma_f32_32x32x16_bf16 v[136:151], v[48:51], v[188:191], v[136:151]
    ds_read_b64_tr_b16 v[44:45], v25 offset:20480
    ds_read_b64_tr_b16 v[46:47], v25 offset:22528
    s_waitcnt lgkmcnt(10)
    v_mfma_f32_32x32x16_bf16 v[88:103], v[52:55], v[188:191], v[88:103]
    ds_read_b64_tr_b16 v[48:49], v22 offset:20480
    ds_read_b64_tr_b16 v[50:51], v22 offset:22528
    s_waitcnt lgkmcnt(10)
    v_mfma_f32_32x32x16_bf16 v[104:119], v[28:31], v[188:191], v[104:119]
    buffer_load_dwordx4 v[176:179], v249, s[32:35], s16 offen offset:2048 sc1
    ds_read_b64_tr_b16 v[52:53], v23 offset:20480
    ds_read_b64_tr_b16 v[54:55], v23 offset:22528
    s_waitcnt vmcnt(20)
    s_waitcnt lgkmcnt(10)
    v_mfma_f32_32x32x16_bf16 v[56:71], v[32:35], v[192:195], v[56:71]
    ds_read_b64_tr_b16 v[28:29], v20 offset:21504
    ds_read_b64_tr_b16 v[30:31], v20 offset:23552
    s_waitcnt lgkmcnt(10)
    v_mfma_f32_32x32x16_bf16 v[72:87], v[36:39], v[192:195], v[72:87]
    ds_read_b64_tr_b16 v[32:33], v21 offset:21504
    ds_read_b64_tr_b16 v[34:35], v21 offset:23552
    s_waitcnt lgkmcnt(10)
    v_mfma_f32_32x32x16_bf16 v[120:135], v[40:43], v[192:195], v[120:135]
    ds_read_b64_tr_b16 v[36:37], v24 offset:21504
    ds_read_b64_tr_b16 v[38:39], v24 offset:23552
    s_waitcnt lgkmcnt(10)
    v_mfma_f32_32x32x16_bf16 v[136:151], v[44:47], v[192:195], v[136:151]
    buffer_load_dwordx4 v[180:183], v249, s[32:35], s16 offen offset:3072 sc1
    ds_read_b64_tr_b16 v[40:41], v25 offset:21504
    ds_read_b64_tr_b16 v[42:43], v25 offset:23552
    s_waitcnt lgkmcnt(10)
    v_mfma_f32_32x32x16_bf16 v[88:103], v[48:51], v[192:195], v[88:103]
    s_add_u32 s16, s16, 16384
    ds_read_b64_tr_b16 v[44:45], v22 offset:21504
    ds_read_b64_tr_b16 v[46:47], v22 offset:23552
    s_waitcnt lgkmcnt(10)
    v_mfma_f32_32x32x16_bf16 v[104:119], v[52:55], v[192:195], v[104:119]
    s_and_b32 s16, s16, 0x3ffff
    ds_read_b64_tr_b16 v[48:49], v23 offset:21504
    ds_read_b64_tr_b16 v[50:51], v23 offset:23552
    s_waitcnt vmcnt(20)
    s_waitcnt lgkmcnt(10)
    v_mfma_f32_32x32x16_bf16 v[56:71], v[28:31], v[196:199], v[56:71]
    ds_read_b64_tr_b16 v[52:53], v20 offset:24576
L_PAD3:
    s_cbranch_execz L_RET3
    ds_read_b64_tr_b16 v[54:55], v20 offset:26624
    s_waitcnt lgkmcnt(10)
    v_mfma_f32_32x32x16_bf16 v[72:87], v[32:35], v[196:199], v[72:87]
    buffer_load_dwordx4 v[184:187], v249, s[32:35], s16 offen sc1
    ds_read_b64_tr_b16 v[28:29], v21 offset:24576
    ds_read_b64_tr_b16 v[30:31], v21 offset:26624
    s_waitcnt lgkmcnt(10)
    v_mfma_f32_32x32x16_bf16 v[120:135], v[36:39], v[196:199], v[120:135]
    ds_read_b64_tr_b16 v[32:33], v20 offset:25600
    ds_read_b64_tr_b16 v[34:35], v20 offset:27648
    s_waitcnt lgkmcnt(10)
    v_mfma_f32_32x32x16_bf16 v[136:151], v[40:43], v[196:199], v[136:151]
    ds_read_b64_tr_b16 v[36:37], v21 offset:25600
    ds_read_b64_tr_b16 v[38:39], v21 offset:27648
    s_waitcnt lgkmcnt(10)
    v_mfma_f32_32x32x16_bf16 v[88:103], v[44:47], v[196:199], v[88:103]
    ds_read_b64_tr_b16 v[40:41], v20 offset:28672
    ds_read_b64_tr_b16 v[42:43], v20 offset:30720
    s_waitcnt lgkmcnt(10)
    v_mfma_f32_32x32x16_bf16 v[104:119], v[48:51], v[196:199], v[104:119]
    buffer_load_dwordx4 v[188:191], v249, s[32:35], s16 offen offset:1024 sc1
    ds_read_b64_tr_b16 v[44:45], v21 offset:28672
    ds_read_b64_tr_b16 v[46:47], v21 offset:30720
    s_barrier
    s_waitcnt vmcnt(21)
    s_waitcnt lgkmcnt(10)
    v_mfma_f32_32x32x16_bf16 v[56:71], v[52:55], v[200:203], v[56:71]
    ds_read_b64_tr_b16 v[48:49], v20 offset:29696
    ds_read_b64_tr_b16 v[50:51], v20 offset:31744
    s_waitcnt lgkmcnt(10)
    v_mfma_f32_32x32x16_bf16 v[72:87], v[28:31], v[200:203], v[72:87]
    ds_read_b64_tr_b16 v[52:53], v21 offset:29696
    ds_read_b64_tr_b16 v[54:55], v21 offset:31744
    s_waitcnt vmcnt(20)
    s_waitcnt lgkmcnt(10)
    v_mfma_f32_32x32x16_bf16 v[56:71], v[32:35], v[204:207], v[56:71]
    ds_read_b64_tr_b16 v[28:29], v24 offset:24576
    ds_read_b64_tr_b16 v[30:31], v24 offset:26624
    s_waitcnt lgkmcnt(10)
    v_mfma_f32_32x32x16_bf16 v[72:87], v[36:39], v[204:207], v[72:87]
    buffer_load_dwordx4 v[192:195], v249, s[32:35], s16 offen offset:2048 sc1
    ds_read_b64_tr_b16 v[32:33], v25 offset:24576
    ds_read_b64_tr_b16 v[34:35], v25 offset:26624
    s_waitcnt vmcnt(20)
    s_waitcnt lgkmcnt(10)
    v_mfma_f32_32x32x16_bf16 v[56:71], v[40:43], v[208:211], v[56:71]
    ds_read_b64_tr_b16 v[36:37], v22 offset:24576
    ds_read_b64_tr_b16 v[38:39], v22 offset:26624
    s_waitcnt lgkmcnt(10)
    v_mfma_f32_32x32x16_bf16 v[72:87], v[44:47], v[208:211], v[72:87]
    ds_read_b64_tr_b16 v[40:41], v23 offset:24576
    ds_read_b64_tr_b16 v[42:43], v23 offset:26624
    s_waitcnt vmcnt(19)
    s_waitcnt lgkmcnt(10)
    v_mfma_f32_32x32x16_bf16 v[56:71], v[48:51], v[212:215], v[56:71]
    ds_read_b64_tr_b16 v[44:45], v24 offset:25600
    ds_read_b64_tr_b16 v[46:47], v24 offset:27648
    s_waitcnt lgkmcnt(10)
    v_mfma_f32_32x32x16_bf16 v[72:87], v[52:55], v[212:215], v[72:87]
    buffer_load_dwordx4 v[196:199], v249, s[32:35], s16 offen offset:3072 sc1
    ds_read_b64_tr_b16 v[48:49], v25 offset:25600
    ds_read_b64_tr_b16 v[50:51], v25 offset:27648
    s_barrier
    s_waitcnt lgkmcnt(10)
    v_mfma_f32_32x32x16_bf16 v[120:135], v[28:31], v[200:203], v[120:135]
    s_add_u32 s16, s16, 16384
    ds_read_b64_tr_b16 v[52:53], v22 offset:25600
    ds_read_b64_tr_b16 v[54:55], v22 offset:27648
    s_waitcnt lgkmcnt(10)
    v_mfma_f32_32x32x16_bf16 v[136:151], v[32:35], v[200:203], v[136:151]
    s_and_b32 s16, s16, 0x3ffff
    ds_read_b64_tr_b16 v[28:29], v23 offset:25600
    ds_read_b64_tr_b16 v[30:31], v23 offset:27648
    s_waitcnt lgkmcnt(10)
    v_mfma_f32_32x32x16_bf16 v[88:103], v[36:39], v[200:203], v[88:103]
    ds_read_b64_tr_b16 v[32:33], v24 offset:28672
    ds_read_b64_tr_b16 v[34:35], v24 offset:30720
    s_waitcnt lgkmcnt(10)
    v_mfma_f32_32x32x16_bf16 v[104:119], v[40:43], v[200:203], v[104:119]
    buffer_load_dwordx4 v[200:203], v249, s[32:35], s16 offen sc1
    ds_read_b64_tr_b16 v[36:37], v25 offset:28672
    ds_read_b64_tr_b16 v[38:39], v25 offset:30720
    s_waitcnt lgkmcnt(10)
    v_mfma_f32_32x32x16_bf16 v[120:135], v[44:47], v[204:207], v[120:135]
    ds_read_b64_tr_b16 v[40:41], v22 offset:28672
    ds_read_b64_tr_b16 v[42:43], v22 offset:30720
    s_waitcnt lgkmcnt(10)
    v_mfma_f32_32x32x16_bf16 v[136:151], v[48:51], v[204:207], v[136:151]
    ds_read_b64_tr_b16 v[44:45], v23 offset:28672
    ds_read_b64_tr_b16 v[46:47], v23 offset:30720
    s_waitcnt lgkmcnt(10)
    v_mfma_f32_32x32x16_bf16 v[88:103], v[52:55], v[204:207], v[88:103]
    ds_read_b64_tr_b16 v[48:49], v24 offset:29696
    ds_read_b64_tr_b16 v[50:51], v24 offset:31744
    s_waitcnt lgkmcnt(10)
    v_mfma_f32_32x32x16_bf16 v[104:119], v[28:31], v[204:207], v[104:119]
    buffer_load_dwordx4 v[204:207], v249, s[32:35], s16 offen offset:1024 sc1
    ds_read_b64_tr_b16 v[52:53], v25 offset:29696
    ds_read_b64_tr_b16 v[54:55], v25 offset:31744
    s_waitcnt lgkmcnt(10)
    v_mfma_f32_32x32x16_bf16 v[120:135], v[32:35], v[208:211], v[120:135]
    ds_read_b64_tr_b16 v[28:29], v22 offset:29696
    ds_read_b64_tr_b16 v[30:31], v22 offset:31744
    s_waitcnt lgkmcnt(10)
    v_mfma_f32_32x32x16_bf16 v[136:151], v[36:39], v[208:211], v[136:151]
    ds_read_b64_tr_b16 v[32:33], v23 offset:29696
    ds_read_b64_tr_b16 v[34:35], v23 offset:31744
    s_waitcnt lgkmcnt(10)
    v_mfma_f32_32x32x16_bf16 v[88:103], v[40:43], v[208:211], v[88:103]
    ds_read_b64_tr_b16 v[36:37], v20 offset:32768
    ds_read_b64_tr_b16 v[38:39], v20 offset:34816
    s_waitcnt lgkmcnt(10)
    v_mfma_f32_32x32x16_bf16 v[104:119], v[44:47], v[208:211], v[104:119]
    buffer_load_dwordx4 v[208:211], v249, s[32:35], s16 offen offset:2048 sc1
    ds_read_b64_tr_b16 v[40:41], v20 offset:33792
    ds_read_b64_tr_b16 v[42:43], v20 offset:35840
    s_waitcnt lgkmcnt(10)
    v_mfma_f32_32x32x16_bf16 v[120:135], v[48:51], v[212:215], v[120:135]
    ds_read_b64_tr_b16 v[44:45], v20 offset:36864
    ds_read_b64_tr_b16 v[46:47], v20 offset:38912
    s_waitcnt lgkmcnt(10)
    v_mfma_f32_32x32x16_bf16 v[136:151], v[52:55], v[212:215], v[136:151]
    ds_read_b64_tr_b16 v[48:49], v20 offset:37888
    ds_read_b64_tr_b16 v[50:51], v20 offset:39936
    s_waitcnt lgkmcnt(10)
    v_mfma_f32_32x32x16_bf16 v[88:103], v[28:31], v[212:215], v[88:103]
    ds_read_b64_tr_b16 v[52:53], v20 offset:40960
    ds_read_b64_tr_b16 v[54:55], v20 offset:43008
    s_waitcnt lgkmcnt(10)
    v_mfma_f32_32x32x16_bf16 v[104:119], v[32:35], v[212:215], v[104:119]
    buffer_load_dwordx4 v[212:215], v249, s[32:35], s16 offen offset:3072 sc1
    ds_read_b64_tr_b16 v[28:29], v20 offset:41984
    ds_read_b64_tr_b16 v[30:31], v20 offset:44032
    s_barrier
    s_waitcnt vmcnt(23)
    s_waitcnt lgkmcnt(10)
    v_mfma_f32_32x32x16_bf16 v[56:71], v[36:39], v[216:219], v[56:71]
    s_add_u32 s16, s16, 16384
    ds_read_b64_tr_b16 v[32:33], v20 offset:45056
    ds_read_b64_tr_b16 v[34:35], v20 offset:47104
    s_waitcnt vmcnt(22)
    s_waitcnt lgkmcnt(10)
    v_mfma_f32_32x32x16_bf16 v[56:71], v[40:43], v[220:223], v[56:71]
    s_and_b32 s16, s16, 0x3ffff
    ds_read_b64_tr_b16 v[36:37], v20 offset:46080
    ds_read_b64_tr_b16 v[38:39], v20 offset:48128
    s_waitcnt vmcnt(21)
    s_waitcnt lgkmcnt(10)
    v_mfma_f32_32x32x16_bf16 v[56:71], v[44:47], v[224:227], v[56:71]
    ds_read_b64_tr_b16 v[40:41], v20
    ds_read_b64_tr_b16 v[42:43], v20 offset:2048
    s_waitcnt vmcnt(20)
    s_waitcnt lgkmcnt(10)
    v_mfma_f32_32x32x16_bf16 v[56:71], v[48:51], v[228:231], v[56:71]
    ds_read_b64_tr_b16 v[44:45], v20 offset:1024
    ds_read_b64_tr_b16 v[46:47], v20 offset:3072
    s_waitcnt vmcnt(19)
    s_waitcnt lgkmcnt(10)
    v_mfma_f32_32x32x16_bf16 v[56:71], v[52:55], v[232:235], v[56:71]
    ds_read_b64_tr_b16 v[48:49], v20 offset:4096
    ds_read_b64_tr_b16 v[50:51], v20 offset:6144
    s_waitcnt vmcnt(18)
    s_waitcnt lgkmcnt(10)
    v_mfma_f32_32x32x16_bf16 v[56:71], v[28:31], v[236:239], v[56:71]
    ds_read_b64_tr_b16 v[52:53], v20 offset:5120
    ds_read_b64_tr_b16 v[54:55], v20 offset:7168
    s_waitcnt vmcnt(17)
    s_waitcnt lgkmcnt(10)
    v_mfma_f32_32x32x16_bf16 v[56:71], v[32:35], v[240:243], v[56:71]
    ds_read_b64_tr_b16 v[28:29], v20 offset:8192
    ds_read_b64_tr_b16 v[30:31], v20 offset:10240
    s_waitcnt vmcnt(16)
    s_waitcnt lgkmcnt(10)
    v_mfma_f32_32x32x16_bf16 v[56:71], v[36:39], v[244:247], v[56:71]
    ds_read_b64_tr_b16 v[32:33], v20 offset:9216
    ds_read_b64_tr_b16 v[34:35], v20 offset:11264
    s_waitcnt vmcnt(15)
    s_waitcnt lgkmcnt(10)
    v_mfma_f32_32x32x16_bf16 v[56:71], v[40:43], v[152:155], v[56:71]
    ds_read_b64_tr_b16 v[36:37], v20 offset:12288
    ds_read_b64_tr_b16 v[38:39], v20 offset:14336
    s_waitcnt vmcnt(14)
    s_waitcnt lgkmcnt(10)
    v_mfma_f32_32x32x16_bf16 v[56:71], v[44:47], v[156:159], v[56:71]
    ds_read_b64_tr_b16 v[40:41], v20 offset:13312
    ds_read_b64_tr_b16 v[42:43], v20 offset:15360
    s_waitcnt vmcnt(13)
    s_waitcnt lgkmcnt(10)
    v_mfma_f32_32x32x16_bf16 v[56:71], v[48:51], v[160:163], v[56:71]
    ds_read_b64_tr_b16 v[44:45], v20 offset:16384
    ds_read_b64_tr_b16 v[46:47], v20 offset:18432
    s_waitcnt vmcnt(12)
    s_waitcnt lgkmcnt(10)
    v_mfma_f32_32x32x16_bf16 v[56:71], v[52:55], v[164:167], v[56:71]
    ds_read_b64_tr_b16 v[48:49], v20 offset:17408
    ds_read_b64_tr_b16 v[50:51], v20 offset:19456
    s_waitcnt vmcnt(11)
    s_waitcnt lgkmcnt(10)
    v_mfma_f32_32x32x16_bf16 v[56:71], v[28:31], v[168:171], v[56:71]
    ds_read_b64_tr_b16 v[52:53], v20 offset:20480
    ds_read_b64_tr_b16 v[54:55], v20 offset:22528
    s_waitcnt vmcnt(10)
    s_waitcnt lgkmcnt(10)
    v_mfma_f32_32x32x16_bf16 v[56:71], v[32:35], v[172:175], v[56:71]
    ds_read_b64_tr_b16 v[28:29], v20 offset:21504
    ds_read_b64_tr_b16 v[30:31], v20 offset:23552
    s_barrier
    s_waitcnt vmcnt(9)
    s_waitcnt lgkmcnt(10)
    v_mfma_f32_32x32x16_bf16 v[56:71], v[36:39], v[176:179], v[56:71]
    ds_read_b64_tr_b16 v[32:33], v20 offset:24576
    ds_read_b64_tr_b16 v[34:35], v20 offset:26624
    s_waitcnt vmcnt(8)
    s_waitcnt lgkmcnt(10)
    v_mfma_f32_32x32x16_bf16 v[56:71], v[40:43], v[180:183], v[56:71]
    ds_read_b64_tr_b16 v[36:37], v20 offset:25600
    ds_read_b64_tr_b16 v[38:39], v20 offset:27648
    s_waitcnt vmcnt(7)
    s_waitcnt lgkmcnt(10)
    v_mfma_f32_32x32x16_bf16 v[56:71], v[44:47], v[184:187], v[56:71]
    ds_read_b64_tr_b16 v[40:41], v20 offset:28672
    ds_read_b64_tr_b16 v[42:43], v20 offset:30720
    s_waitcnt vmcnt(6)
    s_waitcnt lgkmcnt(10)
    v_mfma_f32_32x32x16_bf16 v[56:71], v[48:51], v[188:191], v[56:71]
    ds_read_b64_tr_b16 v[44:45], v20 offset:29696
    ds_read_b64_tr_b16 v[46:47], v20 offset:31744
    s_waitcnt vmcnt(5)
    s_waitcnt lgkmcnt(10)
    v_mfma_f32_32x32x16_bf16 v[56:71], v[52:55], v[192:195], v[56:71]
    ds_read_b64_tr_b16 v[48:49], v21 offset:32768
    ds_read_b64_tr_b16 v[50:51], v21 offset:34816
    s_waitcnt vmcnt(4)
    s_waitcnt lgkmcnt(10)
    v_mfma_f32_32x32x16_bf16 v[56:71], v[28:31], v[196:199], v[56:71]
    ds_read_b64_tr_b16 v[52:53], v21 offset:33792
    ds_read_b64_tr_b16 v[54:55], v21 offset:35840
    s_waitcnt vmcnt(3)
    s_waitcnt lgkmcnt(10)
    v_mfma_f32_32x32x16_bf16 v[56:71], v[32:35], v[200:203], v[56:71]
    ds_read_b64_tr_b16 v[28:29], v21 offset:36864
    ds_read_b64_tr_b16 v[30:31], v21 offset:38912
    s_waitcnt vmcnt(2)
    s_waitcnt lgkmcnt(10)
    v_mfma_f32_32x32x16_bf16 v[56:71], v[36:39], v[204:207], v[56:71]
    ds_read_b64_tr_b16 v[32:33], v21 offset:37888
    ds_read_b64_tr_b16 v[34:35], v21 offset:39936
    s_waitcnt vmcnt(1)
    s_waitcnt lgkmcnt(10)
    v_mfma_f32_32x32x16_bf16 v[56:71], v[40:43], v[208:211], v[56:71]
    ds_read_b64_tr_b16 v[36:37], v21 offset:40960
    ds_read_b64_tr_b16 v[38:39], v21 offset:43008
    s_waitcnt vmcnt(0)
    s_waitcnt lgkmcnt(10)
    v_mfma_f32_32x32x16_bf16 v[56:71], v[44:47], v[212:215], v[56:71]
    ds_read_b64_tr_b16 v[40:41], v21 offset:41984
    ds_read_b64_tr_b16 v[42:43], v21 offset:44032
    s_waitcnt lgkmcnt(10)
    v_mfma_f32_32x32x16_bf16 v[72:87], v[48:51], v[216:219], v[72:87]
    ds_read_b64_tr_b16 v[44:45], v21 offset:45056
    ds_read_b64_tr_b16 v[46:47], v21 offset:47104
    s_waitcnt lgkmcnt(10)
    v_mfma_f32_32x32x16_bf16 v[72:87], v[52:55], v[220:223], v[72:87]
    s_nop 3
    v_cvt_pk_bf16_f32 v56, v56, v57
    v_cvt_pk_bf16_f32 v57, v58, v59
    ds_read_b64_tr_b16 v[48:49], v21 offset:46080
    ds_read_b64_tr_b16 v[50:51], v21 offset:48128
    s_waitcnt lgkmcnt(10)
    v_mfma_f32_32x32x16_bf16 v[72:87], v[28:31], v[224:227], v[72:87]
    v_cvt_pk_bf16_f32 v58, v60, v61
    v_cvt_pk_bf16_f32 v59, v62, v63
    ds_read_b64_tr_b16 v[52:53], v21
    ds_read_b64_tr_b16 v[54:55], v21 offset:2048
    s_waitcnt lgkmcnt(10)
    v_mfma_f32_32x32x16_bf16 v[72:87], v[32:35], v[228:231], v[72:87]
    ds_write_b128 v0, v[56:59]
    v_cvt_pk_bf16_f32 v60, v64, v65
    ds_read_b64_tr_b16 v[28:29], v21 offset:1024
    ds_read_b64_tr_b16 v[30:31], v21 offset:3072
    s_waitcnt lgkmcnt(11)
    v_mfma_f32_32x32x16_bf16 v[72:87], v[36:39], v[232:235], v[72:87]
    v_cvt_pk_bf16_f32 v61, v66, v67
    v_cvt_pk_bf16_f32 v62, v68, v69
    ds_read_b64_tr_b16 v[32:33], v21 offset:4096
    ds_read_b64_tr_b16 v[34:35], v21 offset:6144
    s_waitcnt lgkmcnt(11)
    v_mfma_f32_32x32x16_bf16 v[72:87], v[40:43], v[236:239], v[72:87]
    v_cvt_pk_bf16_f32 v63, v70, v71
    ds_write_b128 v0, v[60:63] offset:1024
    ds_read_b64_tr_b16 v[36:37], v21 offset:5120
    ds_read_b64_tr_b16 v[38:39], v21 offset:7168
    s_waitcnt lgkmcnt(12)
    v_mfma_f32_32x32x16_bf16 v[72:87], v[44:47], v[240:243], v[72:87]
    v_subrev_u32 v0, 118784, v0
    ds_read_b64_tr_b16 v[40:41], v21 offset:8192
    ds_read_b64_tr_b16 v[42:43], v21 offset:10240
    s_waitcnt lgkmcnt(12)
    v_mfma_f32_32x32x16_bf16 v[72:87], v[48:51], v[244:247], v[72:87]
    ds_read_b64_tr_b16 v[44:45], v21 offset:9216
    ds_read_b64_tr_b16 v[46:47], v21 offset:11264
    s_waitcnt lgkmcnt(6)
    s_barrier
    v_mfma_f32_32x32x16_bf16 v[72:87], v[52:55], v[152:155], v[72:87]
    ds_read_b64_tr_b16 v[48:49], v21 offset:12288
    ds_read_b64_tr_b16 v[50:51], v21 offset:14336
    v_mfma_f32_32x32x16_bf16 v[72:87], v[28:31], v[156:159], v[72:87]
    ds_read_b64_tr_b16 v[52:53], v21 offset:13312
    ds_read_b64_tr_b16 v[54:55], v21 offset:15360
    v_mfma_f32_32x32x16_bf16 v[72:87], v[32:35], v[160:163], v[72:87]
    ds_read_b64_tr_b16 v[28:29], v21 offset:16384
    ds_read_b64_tr_b16 v[30:31], v21 offset:18432
    s_waitcnt lgkmcnt(10)
    v_mfma_f32_32x32x16_bf16 v[72:87], v[36:39], v[164:167], v[72:87]
    ds_read_b64_tr_b16 v[32:33], v21 offset:17408
    ds_read_b64_tr_b16 v[34:35], v21 offset:19456
    s_waitcnt lgkmcnt(10)
    v_mfma_f32_32x32x16_bf16 v[72:87], v[40:43], v[168:171], v[72:87]
    ds_read_b64_tr_b16 v[36:37], v21 offset:20480
    ds_read_b64_tr_b16 v[38:39], v21 offset:22528
    s_waitcnt lgkmcnt(10)
    v_mfma_f32_32x32x16_bf16 v[72:87], v[44:47], v[172:175], v[72:87]
    ds_read_b64_tr_b16 v[40:41], v21 offset:21504
    ds_read_b64_tr_b16 v[42:43], v21 offset:23552
    s_waitcnt lgkmcnt(10)
    v_mfma_f32_32x32x16_bf16 v[72:87], v[48:51], v[176:179], v[72:87]
    ds_read_b64_tr_b16 v[44:45], v21 offset:24576
    ds_read_b64_tr_b16 v[46:47], v21 offset:26624
    s_waitcnt lgkmcnt(10)
    v_mfma_f32_32x32x16_bf16 v[72:87], v[52:55], v[180:183], v[72:87]
    ds_read_b64_tr_b16 v[48:49], v21 offset:25600
    ds_read_b64_tr_b16 v[50:51], v21 offset:27648
    s_waitcnt lgkmcnt(10)
    v_mfma_f32_32x32x16_bf16 v[72:87], v[28:31], v[184:187], v[72:87]
    ds_read_b64_tr_b16 v[52:53], v21 offset:28672
    ds_read_b64_tr_b16 v[54:55], v21 offset:30720
    s_waitcnt lgkmcnt(10)
    v_mfma_f32_32x32x16_bf16 v[72:87], v[32:35], v[188:191], v[72:87]
    ds_read_b64_tr_b16 v[28:29], v21 offset:29696
    ds_read_b64_tr_b16 v[30:31], v21 offset:31744
    s_waitcnt lgkmcnt(10)
    v_mfma_f32_32x32x16_bf16 v[72:87], v[36:39], v[192:195], v[72:87]
    ds_read_b64_tr_b16 v[32:33], v22 offset:32768
    ds_read_b64_tr_b16 v[34:35], v22 offset:34816
    s_waitcnt lgkmcnt(10)
    v_mfma_f32_32x32x16_bf16 v[72:87], v[40:43], v[196:199], v[72:87]
    ds_read_b64_tr_b16 v[36:37], v23 offset:32768
    ds_read_b64_tr_b16 v[38:39], v23 offset:34816
    s_waitcnt lgkmcnt(10)
    v_mfma_f32_32x32x16_bf16 v[72:87], v[44:47], v[200:203], v[72:87]
    ds_read_b64_tr_b16 v[40:41], v22 offset:33792
    ds_read_b64_tr_b16 v[42:43], v22 offset:35840
    s_waitcnt lgkmcnt(10)
    v_mfma_f32_32x32x16_bf16 v[72:87], v[48:51], v[204:207], v[72:87]
    ds_read_b64_tr_b16 v[44:45], v23 offset:33792
    ds_read_b64_tr_b16 v[46:47], v23 offset:35840
    s_waitcnt lgkmcnt(10)
    v_mfma_f32_32x32x16_bf16 v[72:87], v[52:55], v[208:211], v[72:87]
    ds_read_b64_tr_b16 v[48:49], v22 offset:36864
    ds_read_b64_tr_b16 v[50:51], v22 offset:38912
    s_waitcnt lgkmcnt(10)
    v_mfma_f32_32x32x16_bf16 v[72:87], v[28:31], v[212:215], v[72:87]
    ds_read_b64_tr_b16 v[52:53], v23 offset:36864
    ds_read_b64_tr_b16 v[54:55], v23 offset:38912
    s_waitcnt lgkmcnt(10)
    v_mfma_f32_32x32x16_bf16 v[88:103], v[32:35], v[216:219], v[88:103]
    ds_read_b64_tr_b16 v[28:29], v22 offset:37888
    ds_read_b64_tr_b16 v[30:31], v22 offset:39936
    s_waitcnt lgkmcnt(10)
    v_mfma_f32_32x32x16_bf16 v[104:119], v[36:39], v[216:219], v[104:119]
    s_nop 3
    v_cvt_pk_bf16_f32 v72, v72, v73
    v_cvt_pk_bf16_f32 v73, v74, v75
    ds_read_b64_tr_b16 v[32:33], v23 offset:37888
    ds_read_b64_tr_b16 v[34:35], v23 offset:39936
    s_waitcnt lgkmcnt(10)
    v_mfma_f32_32x32x16_bf16 v[88:103], v[40:43], v[220:223], v[88:103]
    v_cvt_pk_bf16_f32 v74, v76, v77
    v_cvt_pk_bf16_f32 v75, v78, v79
    ds_read_b64_tr_b16 v[36:37], v22 offset:40960
    ds_read_b64_tr_b16 v[38:39], v22 offset:43008
    s_waitcnt lgkmcnt(10)
    v_mfma_f32_32x32x16_bf16 v[104:119], v[44:47], v[220:223], v[104:119]
    ds_write_b128 v0, v[72:75]
    v_cvt_pk_bf16_f32 v76, v80, v81
    ds_read_b64_tr_b16 v[40:41], v23 offset:40960
    ds_read_b64_tr_b16 v[42:43], v23 offset:43008
    s_waitcnt lgkmcnt(11)
    v_mfma_f32_32x32x16_bf16 v[88:103], v[48:51], v[224:227], v[88:103]
    v_cvt_pk_bf16_f32 v77, v82, v83
    v_cvt_pk_bf16_f32 v78, v84, v85
    ds_read_b64_tr_b16 v[44:45], v22 offset:41984
    ds_read_b64_tr_b16 v[46:47], v22 offset:44032
    s_waitcnt lgkmcnt(11)
    v_mfma_f32_32x32x16_bf16 v[104:119], v[52:55], v[224:227], v[104:119]
    v_cvt_pk_bf16_f32 v79, v86, v87
    ds_write_b128 v0, v[76:79] offset:1024
    ds_read_b64_tr_b16 v[48:49], v23 offset:41984
    ds_read_b64_tr_b16 v[50:51], v23 offset:44032
    s_waitcnt lgkmcnt(12)
    v_mfma_f32_32x32x16_bf16 v[88:103], v[28:31], v[228:231], v[88:103]
    ds_read_b64_tr_b16 v[52:53], v22 offset:45056
    ds_read_b64_tr_b16 v[54:55], v22 offset:47104
    s_waitcnt lgkmcnt(12)
    v_mfma_f32_32x32x16_bf16 v[104:119], v[32:35], v[228:231], v[104:119]
    ds_read_b64_tr_b16 v[28:29], v23 offset:45056
    ds_read_b64_tr_b16 v[30:31], v23 offset:47104
    s_waitcnt lgkmcnt(6)
    s_barrier
    v_mfma_f32_32x32x16_bf16 v[88:103], v[36:39], v[232:235], v[88:103]
    s_lshl_b32 s96, s77, 11
    s_add_u32 s14, s96, 32768
    v_and_b32 v0, 7, v1
    ds_read_b64_tr_b16 v[32:33], v22 offset:46080
    ds_read_b64_tr_b16 v[34:35], v22 offset:48128
    v_mfma_f32_32x32x16_bf16 v[104:119], v[40:43], v[232:235], v[104:119]
    v_lshl_add_u32 v0, v0, 4, s14
    ds_read_b64_tr_b16 v[36:37], v23 offset:46080
    ds_read_b64_tr_b16 v[38:39], v23 offset:48128
    v_mfma_f32_32x32x16_bf16 v[88:103], v[44:47], v[236:239], v[88:103]
    v_bfe_u32 v4, v1, 3, 2
    ds_read_b64_tr_b16 v[40:41], v22
    ds_read_b64_tr_b16 v[42:43], v22 offset:2048
    s_waitcnt lgkmcnt(10)
    v_mfma_f32_32x32x16_bf16 v[104:119], v[48:51], v[236:239], v[104:119]
    v_lshl_add_u32 v0, v4, 8, v0
    v_lshrrev_b32 v4, 5, v1
    ds_read_b64_tr_b16 v[44:45], v23
    ds_read_b64_tr_b16 v[46:47], v23 offset:2048
    s_waitcnt lgkmcnt(10)
    v_mfma_f32_32x32x16_bf16 v[88:103], v[52:55], v[240:243], v[88:103]
    v_lshl_add_u32 v0, v4, 7, v0
    ds_read_b64_tr_b16 v[48:49], v22 offset:1024
    ds_read_b64_tr_b16 v[50:51], v22 offset:3072
    s_waitcnt lgkmcnt(10)
    v_mfma_f32_32x32x16_bf16 v[104:119], v[28:31], v[240:243], v[104:119]
    ds_read_b64_tr_b16 v[52:53], v23 offset:1024
    ds_read_b64_tr_b16 v[54:55], v23 offset:3072
    s_waitcnt lgkmcnt(10)
    v_mfma_f32_32x32x16_bf16 v[88:103], v[32:35], v[244:247], v[88:103]
    ds_read_b64_tr_b16 v[28:29], v22 offset:4096
    ds_read_b64_tr_b16 v[30:31], v22 offset:6144
    s_waitcnt lgkmcnt(10)
    v_mfma_f32_32x32x16_bf16 v[104:119], v[36:39], v[244:247], v[104:119]
    ds_read_b64_tr_b16 v[32:33], v23 offset:4096
    ds_read_b64_tr_b16 v[34:35], v23 offset:6144
    s_waitcnt lgkmcnt(10)
    v_mfma_f32_32x32x16_bf16 v[88:103], v[40:43], v[152:155], v[88:103]
    ds_read_b64_tr_b16 v[36:37], v22 offset:5120
    ds_read_b64_tr_b16 v[38:39], v22 offset:7168
    s_waitcnt lgkmcnt(10)
    v_mfma_f32_32x32x16_bf16 v[104:119], v[44:47], v[152:155], v[104:119]
    ds_read_b64_tr_b16 v[40:41], v23 offset:5120
    ds_read_b64_tr_b16 v[42:43], v23 offset:7168
    s_waitcnt lgkmcnt(10)
    v_mfma_f32_32x32x16_bf16 v[88:103], v[48:51], v[156:159], v[88:103]
    ds_read_b64_tr_b16 v[44:45], v22 offset:8192
    ds_read_b64_tr_b16 v[46:47], v22 offset:10240
    s_waitcnt lgkmcnt(10)
    v_mfma_f32_32x32x16_bf16 v[104:119], v[52:55], v[156:159], v[104:119]
    ds_read_b64_tr_b16 v[48:49], v23 offset:8192
    ds_read_b64_tr_b16 v[50:51], v23 offset:10240
    s_waitcnt lgkmcnt(10)
    v_mfma_f32_32x32x16_bf16 v[88:103], v[28:31], v[160:163], v[88:103]
    ds_read_b64_tr_b16 v[52:53], v22 offset:9216
    ds_read_b64_tr_b16 v[54:55], v22 offset:11264
    s_waitcnt lgkmcnt(10)
    v_mfma_f32_32x32x16_bf16 v[104:119], v[32:35], v[160:163], v[104:119]
    ds_read_b64_tr_b16 v[28:29], v23 offset:9216
    ds_read_b64_tr_b16 v[30:31], v23 offset:11264
    s_waitcnt lgkmcnt(10)
    v_mfma_f32_32x32x16_bf16 v[88:103], v[36:39], v[164:167], v[88:103]
    ds_read_b64_tr_b16 v[32:33], v22 offset:12288
    ds_read_b64_tr_b16 v[34:35], v22 offset:14336
    s_waitcnt lgkmcnt(10)
    v_mfma_f32_32x32x16_bf16 v[104:119], v[40:43], v[164:167], v[104:119]
    ds_read_b64_tr_b16 v[36:37], v23 offset:12288
    ds_read_b64_tr_b16 v[38:39], v23 offset:14336
    s_waitcnt lgkmcnt(10)
    v_mfma_f32_32x32x16_bf16 v[88:103], v[44:47], v[168:171], v[88:103]
    ds_read_b64_tr_b16 v[40:41], v22 offset:13312
    ds_read_b64_tr_b16 v[42:43], v22 offset:15360
    s_waitcnt lgkmcnt(10)
    v_mfma_f32_32x32x16_bf16 v[104:119], v[48:51], v[168:171], v[104:119]
    ds_read_b64_tr_b16 v[44:45], v23 offset:13312
    ds_read_b64_tr_b16 v[46:47], v23 offset:15360
    s_waitcnt lgkmcnt(10)
    v_mfma_f32_32x32x16_bf16 v[88:103], v[52:55], v[172:175], v[88:103]
    ds_read_b64_tr_b16 v[48:49], v22 offset:16384
    ds_read_b64_tr_b16 v[50:51], v22 offset:18432
    s_waitcnt lgkmcnt(10)
    v_mfma_f32_32x32x16_bf16 v[104:119], v[28:31], v[172:175], v[104:119]
    ds_read_b64_tr_b16 v[52:53], v23 offset:16384
    ds_read_b64_tr_b16 v[54:55], v23 offset:18432
    s_waitcnt lgkmcnt(10)
    v_mfma_f32_32x32x16_bf16 v[88:103], v[32:35], v[176:179], v[88:103]
    ds_read_b64_tr_b16 v[28:29], v22 offset:17408
    ds_read_b64_tr_b16 v[30:31], v22 offset:19456
    s_waitcnt lgkmcnt(10)
    v_mfma_f32_32x32x16_bf16 v[104:119], v[36:39], v[176:179], v[104:119]
    ds_read_b64_tr_b16 v[32:33], v23 offset:17408
    ds_read_b64_tr_b16 v[34:35], v23 offset:19456
    s_waitcnt lgkmcnt(10)
    v_mfma_f32_32x32x16_bf16 v[88:103], v[40:43], v[180:183], v[88:103]
    ds_read_b64_tr_b16 v[36:37], v22 offset:20480
    ds_read_b64_tr_b16 v[38:39], v22 offset:22528
    s_waitcnt lgkmcnt(10)
    v_mfma_f32_32x32x16_bf16 v[104:119], v[44:47], v[180:183], v[104:119]
    ds_read_b64_tr_b16 v[40:41], v23 offset:20480
    ds_read_b64_tr_b16 v[42:43], v23 offset:22528
    s_waitcnt lgkmcnt(10)
    v_mfma_f32_32x32x16_bf16 v[88:103], v[48:51], v[184:187], v[88:103]
    ds_read_b64_tr_b16 v[44:45], v22 offset:21504
    ds_read_b64_tr_b16 v[46:47], v22 offset:23552
    s_waitcnt lgkmcnt(10)
    v_mfma_f32_32x32x16_bf16 v[104:119], v[52:55], v[184:187], v[104:119]
    ds_read_b64_tr_b16 v[48:49], v23 offset:21504
    ds_read_b64_tr_b16 v[50:51], v23 offset:23552
    s_waitcnt lgkmcnt(10)
    v_mfma_f32_32x32x16_bf16 v[88:103], v[28:31], v[188:191], v[88:103]
    ds_read_b64_tr_b16 v[52:53], v22 offset:24576
    ds_read_b64_tr_b16 v[54:55], v22 offset:26624
    s_waitcnt lgkmcnt(10)
    v_mfma_f32_32x32x16_bf16 v[104:119], v[32:35], v[188:191], v[104:119]
    ds_read_b64_tr_b16 v[28:29], v23 offset:24576
    ds_read_b64_tr_b16 v[30:31], v23 offset:26624
    s_waitcnt lgkmcnt(10)
    v_mfma_f32_32x32x16_bf16 v[88:103], v[36:39], v[192:195], v[88:103]
    ds_read_b64_tr_b16 v[32:33], v22 offset:25600
    ds_read_b64_tr_b16 v[34:35], v22 offset:27648
    s_waitcnt lgkmcnt(10)
    v_mfma_f32_32x32x16_bf16 v[104:119], v[40:43], v[192:195], v[104:119]
    ds_read_b64_tr_b16 v[36:37], v23 offset:25600
    ds_read_b64_tr_b16 v[38:39], v23 offset:27648
    s_waitcnt lgkmcnt(10)
    v_mfma_f32_32x32x16_bf16 v[88:103], v[44:47], v[196:199], v[88:103]
    ds_read_b64_tr_b16 v[40:41], v22 offset:28672
    ds_read_b64_tr_b16 v[42:43], v22 offset:30720
    s_waitcnt lgkmcnt(10)
    v_mfma_f32_32x32x16_bf16 v[104:119], v[48:51], v[196:199], v[104:119]
    ds_read_b64_tr_b16 v[44:45], v23 offset:28672
    ds_read_b64_tr_b16 v[46:47], v23 offset:30720
    s_waitcnt lgkmcnt(10)
    v_mfma_f32_32x32x16_bf16 v[88:103], v[52:55], v[200:203], v[88:103]
    ds_read_b64_tr_b16 v[48:49], v22 offset:29696
    ds_read_b64_tr_b16 v[50:51], v22 offset:31744
    s_waitcnt lgkmcnt(10)
    v_mfma_f32_32x32x16_bf16 v[104:119], v[28:31], v[200:203], v[104:119]
    ds_read_b64_tr_b16 v[52:53], v23 offset:29696
    ds_read_b64_tr_b16 v[54:55], v23 offset:31744
    s_waitcnt lgkmcnt(10)
    v_mfma_f32_32x32x16_bf16 v[88:103], v[32:35], v[204:207], v[88:103]
    ds_read_b64_tr_b16 v[28:29], v24 offset:32768
    ds_read_b64_tr_b16 v[30:31], v24 offset:34816
    s_waitcnt lgkmcnt(10)
    v_mfma_f32_32x32x16_bf16 v[104:119], v[36:39], v[204:207], v[104:119]
    ds_read_b64_tr_b16 v[32:33], v25 offset:32768
    ds_read_b64_tr_b16 v[34:35], v25 offset:34816
    s_waitcnt lgkmcnt(10)
    v_mfma_f32_32x32x16_bf16 v[88:103], v[40:43], v[208:211], v[88:103]
    ds_read_b64_tr_b16 v[36:37], v24 offset:33792
    ds_read_b64_tr_b16 v[38:39], v24 offset:35840
    s_waitcnt lgkmcnt(10)
    v_mfma_f32_32x32x16_bf16 v[104:119], v[44:47], v[208:211], v[104:119]
    ds_read_b64_tr_b16 v[40:41], v25 offset:33792
    ds_read_b64_tr_b16 v[42:43], v25 offset:35840
    s_waitcnt lgkmcnt(10)
    v_mfma_f32_32x32x16_bf16 v[88:103], v[48:51], v[212:215], v[88:103]
    ds_read_b64_tr_b16 v[44:45], v24 offset:36864
    ds_read_b64_tr_b16 v[46:47], v24 offset:38912
    s_waitcnt lgkmcnt(10)
    v_mfma_f32_32x32x16_bf16 v[104:119], v[52:55], v[212:215], v[104:119]
    ds_read_b64_tr_b16 v[48:49], v25 offset:36864
    ds_read_b64_tr_b16 v[50:51], v25 offset:38912
    s_barrier
    s_waitcnt lgkmcnt(10)
    v_mfma_f32_32x32x16_bf16 v[120:135], v[28:31], v[216:219], v[120:135]
    ds_read_b64_tr_b16 v[52:53], v24 offset:37888
    ds_read_b64_tr_b16 v[54:55], v24 offset:39936
    s_waitcnt lgkmcnt(10)
    v_mfma_f32_32x32x16_bf16 v[136:151], v[32:35], v[216:219], v[136:151]
    ds_read_b64_tr_b16 v[28:29], v25 offset:37888
    ds_read_b64_tr_b16 v[30:31], v25 offset:39936
    s_waitcnt lgkmcnt(10)
    v_mfma_f32_32x32x16_bf16 v[120:135], v[36:39], v[220:223], v[120:135]
    v_cvt_pk_bf16_f32 v88, v88, v89
    ds_read_b64_tr_b16 v[32:33], v24 offset:40960
    ds_read_b64_tr_b16 v[34:35], v24 offset:43008
    s_waitcnt lgkmcnt(10)
    v_mfma_f32_32x32x16_bf16 v[136:151], v[40:43], v[220:223], v[136:151]
    v_cvt_pk_bf16_f32 v89, v90, v91
    ds_read_b64_tr_b16 v[36:37], v25 offset:40960
    ds_read_b64_tr_b16 v[38:39], v25 offset:43008
    s_waitcnt lgkmcnt(10)
    v_mfma_f32_32x32x16_bf16 v[120:135], v[44:47], v[224:227], v[120:135]
L_PAD4:
    s_cbranch_execz L_RET4
    v_cvt_pk_bf16_f32 v90, v92, v93
    ds_read_b64_tr_b16 v[40:41], v24 offset:41984
    ds_read_b64_tr_b16 v[42:43], v24 offset:44032
    s_waitcnt lgkmcnt(10)
    v_mfma_f32_32x32x16_bf16 v[136:151], v[48:51], v[224:227], v[136:151]
    v_cvt_pk_bf16_f32 v91, v94, v95
    ds_read_b64_tr_b16 v[44:45], v25 offset:41984
    ds_read_b64_tr_b16 v[46:47], v25 offset:44032
    s_waitcnt lgkmcnt(10)
    v_mfma_f32_32x32x16_bf16 v[120:135], v[52:55], v[228:231], v[120:135]
    ds_write_b128 v0, v[88:91]
    ds_read_b64_tr_b16 v[48:49], v24 offset:45056
    ds_read_b64_tr_b16 v[50:51], v24 offset:47104
    s_waitcnt lgkmcnt(11)
    v_mfma_f32_32x32x16_bf16 v[136:151], v[28:31], v[228:231], v[136:151]
    v_cvt_pk_bf16_f32 v92, v96, v97
    ds_read_b64_tr_b16 v[52:53], v25 offset:45056
    ds_read_b64_tr_b16 v[54:55], v25 offset:47104
    s_waitcnt lgkmcnt(11)
    v_mfma_f32_32x32x16_bf16 v[120:135], v[32:35], v[232:235], v[120:135]
    v_cvt_pk_bf16_f32 v93, v98, v99
    ds_read_b64_tr_b16 v[28:29], v24 offset:46080
    ds_read_b64_tr_b16 v[30:31], v24 offset:48128
    s_waitcnt lgkmcnt(11)
    v_mfma_f32_32x32x16_bf16 v[136:151], v[36:39], v[232:235], v[136:151]
    v_cvt_pk_bf16_f32 v94, v100, v101
    ds_read_b64_tr_b16 v[32:33], v25 offset:46080
    ds_read_b64_tr_b16 v[34:35], v25 offset:48128
    s_waitcnt lgkmcnt(11)
    v_mfma_f32_32x32x16_bf16 v[120:135], v[40:43], v[236:239], v[120:135]
    v_cvt_pk_bf16_f32 v95, v102, v103
    ds_read_b64_tr_b16 v[36:37], v24
    ds_read_b64_tr_b16 v[38:39], v24 offset:2048
    s_waitcnt lgkmcnt(11)
    v_mfma_f32_32x32x16_bf16 v[136:151], v[44:47], v[236:239], v[136:151]
    ds_write_b128 v0, v[92:95] offset:1024
    ds_read_b64_tr_b16 v[40:41], v25
    ds_read_b64_tr_b16 v[42:43], v25 offset:2048
    s_waitcnt lgkmcnt(11)
    v_mfma_f32_32x32x16_bf16 v[120:135], v[48:51], v[240:243], v[120:135]
    v_cvt_pk_bf16_f32 v104, v104, v105
    ds_read_b64_tr_b16 v[44:45], v24 offset:1024
    ds_read_b64_tr_b16 v[46:47], v24 offset:3072
    s_waitcnt lgkmcnt(11)
    v_mfma_f32_32x32x16_bf16 v[136:151], v[52:55], v[240:243], v[136:151]
    v_cvt_pk_bf16_f32 v105, v106, v107
    ds_read_b64_tr_b16 v[48:49], v25 offset:1024
    ds_read_b64_tr_b16 v[50:51], v25 offset:3072
    s_waitcnt lgkmcnt(11)
    v_mfma_f32_32x32x16_bf16 v[120:135], v[28:31], v[244:247], v[120:135]
    v_cvt_pk_bf16_f32 v106, v108, v109
    ds_read_b64_tr_b16 v[52:53], v24 offset:4096
    ds_read_b64_tr_b16 v[54:55], v24 offset:6144
    s_waitcnt lgkmcnt(11)
    v_mfma_f32_32x32x16_bf16 v[136:151], v[32:35], v[244:247], v[136:151]
    v_cvt_pk_bf16_f32 v107, v110, v111
    ds_read_b64_tr_b16 v[28:29], v25 offset:4096
    ds_read_b64_tr_b16 v[30:31], v25 offset:6144
    s_waitcnt lgkmcnt(11)
    v_mfma_f32_32x32x16_bf16 v[120:135], v[36:39], v[152:155], v[120:135]
    ds_write_b128 v0, v[104:107] offset:8192
    ds_read_b64_tr_b16 v[32:33], v24 offset:5120
    ds_read_b64_tr_b16 v[34:35], v24 offset:7168
    s_waitcnt lgkmcnt(11)
    v_mfma_f32_32x32x16_bf16 v[136:151], v[40:43], v[152:155], v[136:151]
    v_cvt_pk_bf16_f32 v108, v112, v113
    ds_read_b64_tr_b16 v[36:37], v25 offset:5120
    ds_read_b64_tr_b16 v[38:39], v25 offset:7168
    s_waitcnt lgkmcnt(11)
    v_mfma_f32_32x32x16_bf16 v[120:135], v[44:47], v[156:159], v[120:135]
    v_cvt_pk_bf16_f32 v109, v114, v115
    ds_read_b64_tr_b16 v[40:41], v24 offset:8192
    ds_read_b64_tr_b16 v[42:43], v24 offset:10240
    s_waitcnt lgkmcnt(11)
    v_mfma_f32_32x32x16_bf16 v[136:151], v[48:51], v[156:159], v[136:151]
    v_cvt_pk_bf16_f32 v110, v116, v117
    ds_read_b64_tr_b16 v[44:45], v25 offset:8192
    ds_read_b64_tr_b16 v[46:47], v25 offset:10240
    s_waitcnt lgkmcnt(11)
    v_mfma_f32_32x32x16_bf16 v[120:135], v[52:55], v[160:163], v[120:135]
    v_cvt_pk_bf16_f32 v111, v118, v119
    ds_read_b64_tr_b16 v[48:49], v24 offset:9216
    ds_read_b64_tr_b16 v[50:51], v24 offset:11264
    s_waitcnt lgkmcnt(11)
    v_mfma_f32_32x32x16_bf16 v[136:151], v[28:31], v[160:163], v[136:151]
    ds_write_b128 v0, v[108:111] offset:9216
    ds_read_b64_tr_b16 v[52:53], v25 offset:9216
    ds_read_b64_tr_b16 v[54:55], v25 offset:11264
    s_waitcnt lgkmcnt(11)
    v_mfma_f32_32x32x16_bf16 v[120:135], v[32:35], v[164:167], v[120:135]
    ds_read_b64_tr_b16 v[28:29], v24 offset:12288
    ds_read_b64_tr_b16 v[30:31], v24 offset:14336
    s_waitcnt lgkmcnt(11)
    v_mfma_f32_32x32x16_bf16 v[136:151], v[36:39], v[164:167], v[136:151]
    ds_read_b64_tr_b16 v[32:33], v25 offset:12288
    ds_read_b64_tr_b16 v[34:35], v25 offset:14336
    s_waitcnt lgkmcnt(11)
    v_mfma_f32_32x32x16_bf16 v[120:135], v[40:43], v[168:171], v[120:135]
    ds_read_b64_tr_b16 v[36:37], v24 offset:13312
    ds_read_b64_tr_b16 v[38:39], v24 offset:15360
    s_waitcnt lgkmcnt(11)
    v_mfma_f32_32x32x16_bf16 v[136:151], v[44:47], v[168:171], v[136:151]
    ds_read_b64_tr_b16 v[40:41], v25 offset:13312
    ds_read_b64_tr_b16 v[42:43], v25 offset:15360
    s_waitcnt lgkmcnt(11)
    v_mfma_f32_32x32x16_bf16 v[120:135], v[48:51], v[172:175], v[120:135]
    ds_read_b64_tr_b16 v[44:45], v24 offset:16384
    ds_read_b64_tr_b16 v[46:47], v24 offset:18432
    s_waitcnt lgkmcnt(10)
    v_mfma_f32_32x32x16_bf16 v[136:151], v[52:55], v[172:175], v[136:151]
    ds_read_b64_tr_b16 v[48:49], v25 offset:16384
    ds_read_b64_tr_b16 v[50:51], v25 offset:18432
    s_waitcnt lgkmcnt(10)
    v_mfma_f32_32x32x16_bf16 v[120:135], v[28:31], v[176:179], v[120:135]
    ds_read_b64_tr_b16 v[52:53], v24 offset:17408
    ds_read_b64_tr_b16 v[54:55], v24 offset:19456
    s_waitcnt lgkmcnt(10)
    v_mfma_f32_32x32x16_bf16 v[136:151], v[32:35], v[176:179], v[136:151]
    ds_read_b64_tr_b16 v[28:29], v25 offset:17408
    ds_read_b64_tr_b16 v[30:31], v25 offset:19456
    s_waitcnt lgkmcnt(10)
    v_mfma_f32_32x32x16_bf16 v[120:135], v[36:39], v[180:183], v[120:135]
    ds_read_b64_tr_b16 v[32:33], v24 offset:20480
    ds_read_b64_tr_b16 v[34:35], v24 offset:22528
    s_waitcnt lgkmcnt(10)
    v_mfma_f32_32x32x16_bf16 v[136:151], v[40:43], v[180:183], v[136:151]
    ds_read_b64_tr_b16 v[36:37], v25 offset:20480
    ds_read_b64_tr_b16 v[38:39], v25 offset:22528
    s_waitcnt lgkmcnt(10)
    v_mfma_f32_32x32x16_bf16 v[120:135], v[44:47], v[184:187], v[120:135]
    ds_read_b64_tr_b16 v[40:41], v24 offset:21504
    ds_read_b64_tr_b16 v[42:43], v24 offset:23552
    s_waitcnt lgkmcnt(10)
    v_mfma_f32_32x32x16_bf16 v[136:151], v[48:51], v[184:187], v[136:151]
    ds_read_b64_tr_b16 v[44:45], v25 offset:21504
    ds_read_b64_tr_b16 v[46:47], v25 offset:23552
    s_waitcnt lgkmcnt(10)
    v_mfma_f32_32x32x16_bf16 v[120:135], v[52:55], v[188:191], v[120:135]
    ds_read_b64_tr_b16 v[48:49], v24 offset:24576
    ds_read_b64_tr_b16 v[50:51], v24 offset:26624
    s_waitcnt lgkmcnt(10)
    v_mfma_f32_32x32x16_bf16 v[136:151], v[28:31], v[188:191], v[136:151]
    ds_read_b64_tr_b16 v[52:53], v25 offset:24576
    ds_read_b64_tr_b16 v[54:55], v25 offset:26624
    s_waitcnt lgkmcnt(10)
    v_mfma_f32_32x32x16_bf16 v[120:135], v[32:35], v[192:195], v[120:135]
    ds_read_b64_tr_b16 v[28:29], v24 offset:25600
    ds_read_b64_tr_b16 v[30:31], v24 offset:27648
    s_waitcnt lgkmcnt(10)
    v_mfma_f32_32x32x16_bf16 v[136:151], v[36:39], v[192:195], v[136:151]
    ds_read_b64_tr_b16 v[32:33], v25 offset:25600
    ds_read_b64_tr_b16 v[34:35], v25 offset:27648
    s_waitcnt lgkmcnt(10)
    v_mfma_f32_32x32x16_bf16 v[120:135], v[40:43], v[196:199], v[120:135]
    ds_read_b64_tr_b16 v[36:37], v24 offset:28672
    ds_read_b64_tr_b16 v[38:39], v24 offset:30720
    s_waitcnt lgkmcnt(10)
    v_mfma_f32_32x32x16_bf16 v[136:151], v[44:47], v[196:199], v[136:151]
    ds_read_b64_tr_b16 v[40:41], v25 offset:28672
    ds_read_b64_tr_b16 v[42:43], v25 offset:30720
    s_waitcnt lgkmcnt(10)
    v_mfma_f32_32x32x16_bf16 v[120:135], v[48:51], v[200:203], v[120:135]
    ds_read_b64_tr_b16 v[44:45], v25 offset:29696
    ds_read_b64_tr_b16 v[46:47], v25 offset:31744
    s_waitcnt lgkmcnt(10)
    v_mfma_f32_32x32x16_bf16 v[136:151], v[52:55], v[200:203], v[136:151]
    ds_read_b64_tr_b16 v[48:49], v24 offset:29696
    ds_read_b64_tr_b16 v[50:51], v24 offset:31744
    s_waitcnt lgkmcnt(10)
    v_mfma_f32_32x32x16_bf16 v[120:135], v[28:31], v[204:207], v[120:135]
    s_waitcnt lgkmcnt(8)
    v_mfma_f32_32x32x16_bf16 v[136:151], v[32:35], v[204:207], v[136:151]
    s_waitcnt lgkmcnt(6)
    v_mfma_f32_32x32x16_bf16 v[120:135], v[36:39], v[208:211], v[120:135]
    s_waitcnt lgkmcnt(4)
    v_mfma_f32_32x32x16_bf16 v[136:151], v[40:43], v[208:211], v[136:151]
    s_waitcnt lgkmcnt(2)
    v_mfma_f32_32x32x16_bf16 v[136:151], v[44:47], v[212:215], v[136:151]
    s_waitcnt lgkmcnt(0)
    v_mfma_f32_32x32x16_bf16 v[120:135], v[48:51], v[212:215], v[120:135]
    s_lshl_b32 s96, s77, 11
    s_add_u32 s14, s96, 151552
    v_add_u32 v0, s14, v2
    v_bfe_u32 v4, v1, 2, 2
    v_lshlrev_b32 v4, 6, v4
    v_bfe_u32 v9, v1, 4, 1
    v_lshl_add_u32 v4, v9, 5, v4
    v_and_b32 v9, 3, v1
    v_lshl_add_u32 v4, v9, 3, v4
    v_lshrrev_b32 v9, 5, v1
    v_lshl_add_u32 v4, v9, 8, v4
    v_add_u32 v4, 159744, v4
    ds_read_b64_tr_b16 v[176:177], v4
    ds_read_b64_tr_b16 v[178:179], v4 offset:512
    ds_read_b64_tr_b16 v[180:181], v4 offset:1024
    ds_read_b64_tr_b16 v[182:183], v4 offset:1536
    v_cvt_pk_bf16_f32 v152, v136, v137
    v_cvt_pk_bf16_f32 v153, v138, v139
    v_cvt_pk_bf16_f32 v154, v140, v141
    v_cvt_pk_bf16_f32 v155, v142, v143
    v_cvt_pk_bf16_f32 v156, v144, v145
    v_cvt_pk_bf16_f32 v157, v146, v147
    v_cvt_pk_bf16_f32 v158, v148, v149
    v_cvt_pk_bf16_f32 v159, v150, v151
    ds_write_b128 v0, v[152:155]
    ds_write_b128 v0, v[156:159] offset:1024
    v_cvt_pk_bf16_f32 v168, v120, v121
    v_cvt_pk_bf16_f32 v169, v122, v123
    v_cvt_pk_bf16_f32 v170, v124, v125
    v_cvt_pk_bf16_f32 v171, v126, v127
    v_cvt_pk_bf16_f32 v172, v128, v129
    v_cvt_pk_bf16_f32 v173, v130, v131
    v_cvt_pk_bf16_f32 v174, v132, v133
    v_cvt_pk_bf16_f32 v175, v134, v135
    s_setprio 0
    s_branch L_JOIN
L_HELP:
    s_barrier
    s_add_u32 s96, s84, 4
    s_and_b32 s97, s96, 15
    s_mul_i32 s98, s97, 393216
    s_add_u32 s99, s98, s85
    s_add_u32 s82, s99, 4294772736
    s_add_u32 m0, s83, 28672
    s_nop 0
    buffer_load_dwordx4 v3, s[40:43], s82 offen lds
    s_add_u32 s96, s84, 4
    s_and_b32 s97, s96, 15
    s_mul_i32 s98, s97, 393216
    s_add_u32 s99, s98, s85
    s_add_u32 s82, s99, 2048
    s_add_u32 m0, s83, 32768
    s_nop 0
    buffer_load_dwordx4 v3, s[40:43], s82 offen lds
    s_add_u32 s96, s84, 4
    s_and_b32 s97, s96, 15
    s_mul_i32 s98, s97, 393216
    s_add_u32 s99, s98, s85
    s_add_u32 s82, s99, 4294774784
    s_add_u32 m0, s83, 77824
    s_nop 0
    buffer_load_dwordx4 v3, s[40:43], s82 offen lds
    s_add_u32 s96, s84, 4
    s_and_b32 s97, s96, 15
    s_mul_i32 s98, s97, 393216
    s_add_u32 s99, s98, s85
    s_add_u32 s82, s99, 4096
    s_add_u32 m0, s83, 81920
    s_nop 0
    buffer_load_dwordx4 v3, s[40:43], s82 offen lds
    s_add_u32 s96, s84, 4
    s_and_b32 s97, s96, 15
    s_mul_i32 s98, s97, 393216
    s_add_u32 s99, s98, s85
    s_add_u32 s82, s99, 4294770688
    s_add_u32 m0, s83, 126976
    s_nop 0
    buffer_load_dwordx4 v3, s[40:43], s82 offen lds
    s_add_u32 s96, s84, 4
    s_and_b32 s97, s96, 15
    s_mul_i32 s98, s97, 393216
    s_add_u32 s82, s98, s85
    s_add_u32 m0, s83, 131072
    s_nop 0
    buffer_load_dwordx4 v3, s[40:43], s82 offen lds
    s_add_u32 s96, s84, 5
    s_and_b32 s97, s96, 15
    s_mul_i32 s98, s97, 393216
    s_add_u32 s99, s98, s85
    s_add_u32 s82, s99, 4294772736
    s_add_u32 m0, s83, 36864
    s_nop 0
    buffer_load_dwordx4 v3, s[40:43], s82 offen lds
    s_add_u32 s96, s84, 5
    s_and_b32 s97, s96, 15
    s_mul_i32 s98, s97, 393216
    s_add_u32 s99, s98, s85
    s_add_u32 s82, s99, 2048
    s_add_u32 m0, s83, 40960
    s_nop 0
    buffer_load_dwordx4 v3, s[40:43], s82 offen lds
    s_add_u32 s96, s84, 5
    s_and_b32 s97, s96, 15
    s_mul_i32 s98, s97, 393216
    s_add_u32 s99, s98, s85
    s_add_u32 s82, s99, 4294774784
    s_add_u32 m0, s83, 86016
    s_nop 0
    buffer_load_dwordx4 v3, s[40:43], s82 offen lds
    s_add_u32 s96, s84, 5
    s_and_b32 s97, s96, 15
    s_mul_i32 s98, s97, 393216
    s_add_u32 s99, s98, s85
    s_add_u32 s82, s99, 4096
    s_add_u32 m0, s83, 90112
    s_nop 0
    buffer_load_dwordx4 v3, s[40:43], s82 offen lds
    s_add_u32 s96, s84, 5
    s_and_b32 s97, s96, 15
    s_mul_i32 s98, s97, 393216
    s_add_u32 s99, s98, s85
    s_add_u32 s82, s99, 4294770688
    s_add_u32 m0, s83, 135168
    s_nop 0
    buffer_load_dwordx4 v3, s[40:43], s82 offen lds
    s_add_u32 s96, s84, 5
    s_and_b32 s97, s96, 15
    s_mul_i32 s98, s97, 393216
    s_add_u32 s82, s98, s85
    s_add_u32 m0, s83, 139264
    s_nop 0
    buffer_load_dwordx4 v3, s[40:43], s82 offen lds
    v_bfe_u32 v4, v1, 2, 2
    v_lshlrev_b32 v4, 6, v4
    v_bfe_u32 v9, v1, 4, 1
    v_lshl_add_u32 v4, v9, 5, v4
    v_and_b32 v9, 3, v1
    v_lshl_add_u32 v4, v9, 3, v4
    v_lshrrev_b32 v9, 5, v1
    v_lshl_add_u32 v4, v9, 8, v4
    v_add_u32 v4, 159744, v4
    ds_read_b64_tr_b16 v[168:169], v4
    ds_read_b64_tr_b16 v[170:171], v4 offset:512
    ds_read_b64_tr_b16 v[172:173], v4 offset:1024
    ds_read_b64_tr_b16 v[174:175], v4 offset:1536
    ds_read_b64_tr_b16 v[176:177], v4 offset:2048
    ds_read_b64_tr_b16 v[178:179], v4 offset:2560
    ds_read_b64_tr_b16 v[180:181], v4 offset:3072
    ds_read_b64_tr_b16 v[182:183], v4 offset:3584
    s_lshl_b32 s14, s77, 10
    v_and_b32 v232, 7, v1
    v_lshl_add_u32 v232, v232, 4, s14
    v_bfe_u32 v9, v1, 3, 2
    v_lshl_add_u32 v232, v9, 8, v232
    v_lshrrev_b32 v9, 5, v1
    v_lshl_add_u32 v232, v9, 7, v232
    s_and_b32 s96, s9, 1
    s_lshl1_add_u32 s18, s96, 1
    s_and_b32 s96, s8, 3
    s_lshl2_add_u32 s97, s96, s3
    s_sub_u32 s98, s97, 4
    s_lshl_b32 s82, s98, 7
    v_lshrrev_b32 v136, 3, v1
    v_lshl_add_u32 v136, v136, 1, s82
    global_load_ushort v120, v136, s[86:87] offset:0
    global_load_ushort v121, v136, s[86:87] offset:16
    global_load_ushort v122, v136, s[86:87] offset:32
    global_load_ushort v123, v136, s[86:87] offset:48
    global_load_ushort v124, v136, s[86:87] offset:64
    global_load_ushort v125, v136, s[86:87] offset:80
    global_load_ushort v126, v136, s[86:87] offset:96
    global_load_ushort v127, v136, s[86:87] offset:112
    s_and_b32 s96, s8, 3
    s_lshl2_add_u32 s97, s96, s3
    s_sub_u32 s98, s97, 4
    s_mul_i32 s99, s98, 786432
    s_lshr_b32 s96, s8, 2
    s_lshl1_add_u32 s97, s9, s96
    s_lshl_b32 s98, s97, 7
    s_add_u32 s96, s99, s98
    s_add_u32 s19, s96, 4096
    s_waitcnt vmcnt(23)
    s_barrier
    s_add_u32 s96, s84, 6
    s_and_b32 s97, s96, 15
    s_mul_i32 s98, s97, 393216
    s_add_u32 s99, s98, s85
    s_add_u32 s82, s99, 4294772736
    s_add_u32 m0, s83, 4294963200
    s_nop 0
    buffer_load_dwordx4 v3, s[40:43], s82 offen lds
    s_add_u32 s96, s84, 6
    s_and_b32 s97, s96, 15
    s_mul_i32 s98, s97, 393216
    s_add_u32 s99, s98, s85
    s_add_u32 s82, s99, 2048
    s_mov_b32 m0, s83
    s_nop 0
    buffer_load_dwordx4 v3, s[40:43], s82 offen lds
    s_add_u32 s96, s84, 6
    s_and_b32 s97, s96, 15
    s_mul_i32 s98, s97, 393216
    s_add_u32 s99, s98, s85
    s_add_u32 s82, s99, 4294770688
    s_add_u32 m0, s83, 94208
    s_nop 0
    buffer_load_dwordx4 v3, s[40:43], s82 offen lds
    s_add_u32 s96, s84, 6
    s_and_b32 s97, s96, 15
    s_mul_i32 s98, s97, 393216
    s_add_u32 s82, s98, s85
    s_add_u32 m0, s83, 98304
    s_nop 0
    buffer_load_dwordx4 v3, s[40:43], s82 offen lds
    s_add_u32 s96, s84, 6
    s_and_b32 s97, s96, 15
    s_mul_i32 s98, s97, 393216
    s_add_u32 s99, s98, s85
    s_add_u32 s82, s99, 4294774784
    s_add_u32 m0, s83, 45056
    s_nop 0
    buffer_load_dwordx4 v3, s[40:43], s82 offen lds
    s_add_u32 s96, s84, 6
    s_and_b32 s97, s96, 15
    s_mul_i32 s98, s97, 393216
    s_add_u32 s99, s98, s85
    s_add_u32 s82, s99, 4096
    s_add_u32 m0, s83, 49152
    s_nop 0
    buffer_load_dwordx4 v3, s[40:43], s82 offen lds
    s_cmp_lg_u32 s18, 1
    s_cbranch_scc1 L_NM2_1_0
    s_mov_b32 s82, s19
    buffer_load_dwordx4 v[88:91], v248, s[48:51], s82 offen nt
    s_add_u32 s82, s19, 98304
    buffer_load_dwordx4 v[92:95], v248, s[48:51], s82 offen nt
    s_add_u32 s82, s19, 196608
    buffer_load_dwordx4 v[96:99], v248, s[48:51], s82 offen nt
    s_add_u32 s82, s19, 294912
    buffer_load_dwordx4 v[100:103], v248, s[48:51], s82 offen nt
    s_add_u32 s82, s19, 393216
    buffer_load_dwordx4 v[104:107], v248, s[48:51], s82 offen nt
    s_add_u32 s82, s19, 491520
    buffer_load_dwordx4 v[108:111], v248, s[48:51], s82 offen nt
    s_add_u32 s82, s19, 589824
    buffer_load_dwordx4 v[112:115], v248, s[48:51], s82 offen nt
    s_add_u32 s82, s19, 688128
    buffer_load_dwordx4 v[116:119], v248, s[48:51], s82 offen nt
L_NM2_1_0:
    s_waitcnt lgkmcnt(0)
    s_load_dword s24, s[32:33], s92 offset:512 glc
    s_load_dword s25, s[32:33], s92 offset:256 glc
    s_load_dword s26, s[32:33], s92 offset:3584 glc
    s_load_dword s27, s[32:33], s92 offset:3328 glc
    s_waitcnt vmcnt(26)
    s_barrier
    s_add_u32 s96, s84, 7
    s_and_b32 s97, s96, 15
    s_mul_i32 s98, s97, 393216
    s_add_u32 s99, s98, s85
    s_add_u32 s82, s99, 4294772736
    s_add_u32 m0, s83, 4096
    s_nop 0
    buffer_load_dwordx4 v3, s[40:43], s82 offen lds
    s_add_u32 s96, s84, 7
    s_and_b32 s97, s96, 15
    s_mul_i32 s98, s97, 393216
    s_add_u32 s99, s98, s85
    s_add_u32 s82, s99, 2048
    s_add_u32 m0, s83, 8192
    s_nop 0
    buffer_load_dwordx4 v3, s[40:43], s82 offen lds
    s_add_u32 s96, s84, 7
    s_and_b32 s97, s96, 15
    s_mul_i32 s98, s97, 393216
    s_add_u32 s99, s98, s85
    s_add_u32 s82, s99, 4294770688
    s_add_u32 m0, s83, 102400
    s_nop 0
    buffer_load_dwordx4 v3, s[40:43], s82 offen lds
    s_add_u32 s96, s84, 7
    s_and_b32 s97, s96, 15
    s_mul_i32 s98, s97, 393216
    s_add_u32 s82, s98, s85
    s_add_u32 m0, s83, 106496
    s_nop 0
    buffer_load_dwordx4 v3, s[40:43], s82 offen lds
    s_add_u32 s96, s84, 7
    s_and_b32 s97, s96, 15
    s_mul_i32 s98, s97, 393216
    s_add_u32 s99, s98, s85
    s_add_u32 s82, s99, 4294774784
    s_add_u32 m0, s83, 53248
    s_nop 0
    buffer_load_dwordx4 v3, s[40:43], s82 offen lds
    s_add_u32 s96, s84, 7
    s_and_b32 s97, s96, 15
    s_mul_i32 s98, s97, 393216
    s_add_u32 s99, s98, s85
    s_add_u32 s82, s99, 4096
    s_add_u32 m0, s83, 57344
    s_nop 0
    buffer_load_dwordx4 v3, s[40:43], s82 offen lds
    s_cmp_lg_u32 s18, 2
    s_cbranch_scc1 L_NM2_2_0
    s_mov_b32 s82, s19
    buffer_load_dwordx4 v[88:91], v248, s[48:51], s82 offen nt
    s_add_u32 s82, s19, 98304
    buffer_load_dwordx4 v[92:95], v248, s[48:51], s82 offen nt
    s_add_u32 s82, s19, 196608
    buffer_load_dwordx4 v[96:99], v248, s[48:51], s82 offen nt
    s_add_u32 s82, s19, 294912
    buffer_load_dwordx4 v[100:103], v248, s[48:51], s82 offen nt
    s_add_u32 s82, s19, 393216
    buffer_load_dwordx4 v[104:107], v248, s[48:51], s82 offen nt
    s_add_u32 s82, s19, 491520
    buffer_load_dwordx4 v[108:111], v248, s[48:51], s82 offen nt
    s_add_u32 s82, s19, 589824
    buffer_load_dwordx4 v[112:115], v248, s[48:51], s82 offen nt
    s_add_u32 s82, s19, 688128
    buffer_load_dwordx4 v[116:119], v248, s[48:51], s82 offen nt
L_NM2_2_0:
    s_waitcnt vmcnt(30)
    s_waitcnt vmcnt(26)
    s_barrier
    s_add_u32 s96, s84, 8
    s_and_b32 s97, s96, 15
    s_mul_i32 s98, s97, 393216
    s_add_u32 s99, s98, s85
    s_add_u32 s82, s99, 4294772736
    s_add_u32 m0, s83, 12288
    s_nop 0
    buffer_load_dwordx4 v3, s[40:43], s82 offen lds
    s_add_u32 s96, s84, 8
    s_and_b32 s97, s96, 15
    s_mul_i32 s98, s97, 393216
    s_add_u32 s99, s98, s85
    s_add_u32 s82, s99, 2048
    s_add_u32 m0, s83, 16384
    s_nop 0
    buffer_load_dwordx4 v3, s[40:43], s82 offen lds
    s_add_u32 s96, s84, 8
    s_and_b32 s97, s96, 15
    s_mul_i32 s98, s97, 393216
    s_add_u32 s99, s98, s85
    s_add_u32 s82, s99, 4294770688
    s_add_u32 m0, s83, 110592
    s_nop 0
    buffer_load_dwordx4 v3, s[40:43], s82 offen lds
    s_add_u32 s96, s84, 8
    s_and_b32 s97, s96, 15
    s_mul_i32 s98, s97, 393216
    s_add_u32 s82, s98, s85
    s_add_u32 m0, s83, 114688
    s_nop 0
    buffer_load_dwordx4 v3, s[40:43], s82 offen lds
    s_add_u32 s96, s84, 8
    s_and_b32 s97, s96, 15
    s_mul_i32 s98, s97, 393216
    s_add_u32 s99, s98, s85
    s_add_u32 s82, s99, 4294774784
    s_add_u32 m0, s83, 61440
    s_nop 0
    buffer_load_dwordx4 v3, s[40:43], s82 offen lds
    s_add_u32 s96, s84, 8
    s_and_b32 s97, s96, 15
    s_mul_i32 s98, s97, 393216
    s_add_u32 s99, s98, s85
    s_add_u32 s82, s99, 4096
    s_add_u32 m0, s83, 65536
    s_nop 0
    buffer_load_dwordx4 v3, s[40:43], s82 offen lds
    s_cmp_lg_u32 s18, 3
    s_cbranch_scc1 L_NM2_3_0
    s_mov_b32 s82, s19
    buffer_load_dwordx4 v[88:91], v248, s[48:51], s82 offen nt
    s_add_u32 s82, s19, 98304
    buffer_load_dwordx4 v[92:95], v248, s[48:51], s82 offen nt
    s_add_u32 s82, s19, 196608
    buffer_load_dwordx4 v[96:99], v248, s[48:51], s82 offen nt
    s_add_u32 s82, s19, 294912
    buffer_load_dwordx4 v[100:103], v248, s[48:51], s82 offen nt
    s_add_u32 s82, s19, 393216
    buffer_load_dwordx4 v[104:107], v248, s[48:51], s82 offen nt
    s_add_u32 s82, s19, 491520
    buffer_load_dwordx4 v[108:111], v248, s[48:51], s82 offen nt
    s_add_u32 s82, s19, 589824
    buffer_load_dwordx4 v[112:115], v248, s[48:51], s82 offen nt
    s_add_u32 s82, s19, 688128
    buffer_load_dwordx4 v[116:119], v248, s[48:51], s82 offen nt
L_NM2_3_0:
    s_waitcnt vmcnt(18)
    v_lshlrev_b32 v120, 16, v120
    v_mul_f32 v136, s7, v120
    v_exp_f32 v136, -v136
    s_nop 0
    v_add_f32 v136, 1.0, v136
    v_rcp_f32 v136, v136
    s_nop 0
    v_mul_f32 v120, v120, v136
    v_cvt_pk_bf16_f32 v120, 0, v120
    v_lshlrev_b32 v121, 16, v121
    v_mul_f32 v137, s7, v121
    v_exp_f32 v137, -v137
    s_nop 0
    v_add_f32 v137, 1.0, v137
    v_rcp_f32 v137, v137
    s_nop 0
    v_mul_f32 v121, v121, v137
    v_cvt_pk_bf16_f32 v121, 0, v121
    v_lshlrev_b32 v122, 16, v122
    v_mul_f32 v136, s7, v122
    v_exp_f32 v136, -v136
    s_nop 0
    v_add_f32 v136, 1.0, v136
    v_rcp_f32 v136, v136
    s_nop 0
    v_mul_f32 v122, v122, v136
    v_cvt_pk_bf16_f32 v122, 0, v122
    v_lshlrev_b32 v123, 16, v123
    v_mul_f32 v137, s7, v123
    v_exp_f32 v137, -v137
    s_nop 0
    v_add_f32 v137, 1.0, v137
    v_rcp_f32 v137, v137
    s_nop 0
    v_mul_f32 v123, v123, v137
    v_cvt_pk_bf16_f32 v123, 0, v123
    v_lshlrev_b32 v124, 16, v124
    v_mul_f32 v136, s7, v124
    v_exp_f32 v136, -v136
    s_nop 0
    v_add_f32 v136, 1.0, v136
    v_rcp_f32 v136, v136
    s_nop 0
    v_mul_f32 v124, v124, v136
    v_cvt_pk_bf16_f32 v124, 0, v124
    v_lshlrev_b32 v125, 16, v125
    v_mul_f32 v137, s7, v125
    v_exp_f32 v137, -v137
    s_nop 0
    v_add_f32 v137, 1.0, v137
    v_rcp_f32 v137, v137
    s_nop 0
    v_mul_f32 v125, v125, v137
    v_cvt_pk_bf16_f32 v125, 0, v125
    v_lshlrev_b32 v126, 16, v126
    v_mul_f32 v136, s7, v126
    v_exp_f32 v136, -v136
    s_nop 0
    v_add_f32 v136, 1.0, v136
    v_rcp_f32 v136, v136
    s_nop 0
    v_mul_f32 v126, v126, v136
    v_cvt_pk_bf16_f32 v126, 0, v126
    v_lshlrev_b32 v127, 16, v127
    v_mul_f32 v137, s7, v127
    v_exp_f32 v137, -v137
    s_nop 0
    v_add_f32 v137, 1.0, v137
    v_rcp_f32 v137, v137
    s_nop 0
    v_mul_f32 v127, v127, v137
    v_cvt_pk_bf16_f32 v127, 0, v127
    s_waitcnt lgkmcnt(0)
    s_load_dword s24, s[32:33], s92 offset:1024 glc
    s_load_dword s25, s[32:33], s92 offset:768 glc
    s_load_dword s26, s[32:33], s92 offset:1536 glc
    s_load_dword s27, s[32:33], s92 offset:1280 glc
L_PAD5:
    s_cbranch_execz L_RET5
    s_barrier
    s_add_u32 s96, s84, 9
    s_and_b32 s97, s96, 15
    s_mul_i32 s98, s97, 393216
    s_add_u32 s99, s98, s85
    s_add_u32 s82, s99, 4294772736
    s_add_u32 m0, s83, 20480
    s_nop 0
    buffer_load_dwordx4 v3, s[40:43], s82 offen lds
    s_add_u32 s96, s84, 9
    s_and_b32 s97, s96, 15
    s_mul_i32 s98, s97, 393216
    s_add_u32 s99, s98, s85
    s_add_u32 s82, s99, 2048
    s_add_u32 m0, s83, 24576
    s_nop 0
    buffer_load_dwordx4 v3, s[40:43], s82 offen lds
    s_add_u32 s96, s84, 9
    s_and_b32 s97, s96, 15
    s_mul_i32 s98, s97, 393216
    s_add_u32 s99, s98, s85
    s_add_u32 s82, s99, 4294770688
    s_add_u32 m0, s83, 118784
    s_nop 0
    buffer_load_dwordx4 v3, s[40:43], s82 offen lds
    s_add_u32 s96, s84, 9
    s_and_b32 s97, s96, 15
    s_mul_i32 s98, s97, 393216
    s_add_u32 s82, s98, s85
    s_add_u32 m0, s83, 122880
    s_nop 0
    buffer_load_dwordx4 v3, s[40:43], s82 offen lds
    s_add_u32 s96, s84, 9
    s_and_b32 s97, s96, 15
    s_mul_i32 s98, s97, 393216
    s_add_u32 s99, s98, s85
    s_add_u32 s82, s99, 4294774784
    s_add_u32 m0, s83, 69632
    s_nop 0
    buffer_load_dwordx4 v3, s[40:43], s82 offen lds
    s_add_u32 s96, s84, 9
    s_and_b32 s97, s96, 15
    s_mul_i32 s98, s97, 393216
    s_add_u32 s99, s98, s85
    s_add_u32 s82, s99, 4096
    s_add_u32 m0, s83, 73728
    s_nop 0
    buffer_load_dwordx4 v3, s[40:43], s82 offen lds
    s_waitcnt vmcnt(22)
    s_waitcnt vmcnt(20)
    s_waitcnt vmcnt(18)
    s_barrier
    s_add_u32 s96, s84, 10
    s_and_b32 s97, s96, 15
    s_mul_i32 s98, s97, 393216
    s_add_u32 s99, s98, s85
    s_add_u32 s82, s99, 4294772736
    s_add_u32 m0, s83, 28672
    s_nop 0
    buffer_load_dwordx4 v3, s[40:43], s82 offen lds
    s_add_u32 s96, s84, 10
    s_and_b32 s97, s96, 15
    s_mul_i32 s98, s97, 393216
    s_add_u32 s99, s98, s85
    s_add_u32 s82, s99, 2048
    s_add_u32 m0, s83, 32768
    s_nop 0
    buffer_load_dwordx4 v3, s[40:43], s82 offen lds
    s_add_u32 s96, s84, 10
    s_and_b32 s97, s96, 15
    s_mul_i32 s98, s97, 393216
    s_add_u32 s99, s98, s85
    s_add_u32 s82, s99, 4294774784
    s_add_u32 m0, s83, 77824
    s_nop 0
    buffer_load_dwordx4 v3, s[40:43], s82 offen lds
    s_add_u32 s96, s84, 10
    s_and_b32 s97, s96, 15
    s_mul_i32 s98, s97, 393216
    s_add_u32 s99, s98, s85
    s_add_u32 s82, s99, 4096
    s_add_u32 m0, s83, 81920
    s_nop 0
    buffer_load_dwordx4 v3, s[40:43], s82 offen lds
    s_waitcnt vmcnt(8)
    v_lshlrev_b32 v136, 16, v88
    v_and_b32 v137, s6, v88
    v_mul_f32 v128, v136, v120
    v_mul_f32 v129, v137, v120
    v_lshlrev_b32 v138, 16, v89
    v_and_b32 v139, s6, v89
    v_mul_f32 v130, v138, v120
    v_mul_f32 v131, v139, v120
    v_lshlrev_b32 v136, 16, v90
    v_and_b32 v137, s6, v90
    v_mul_f32 v132, v136, v120
    v_mul_f32 v133, v137, v120
    v_lshlrev_b32 v138, 16, v91
    v_and_b32 v139, s6, v91
    v_mul_f32 v134, v138, v120
    v_mul_f32 v135, v139, v120
    v_lshlrev_b32 v136, 16, v92
    v_and_b32 v137, s6, v92
    v_fmac_f32 v128, v136, v121
    v_fmac_f32 v129, v137, v121
    v_lshlrev_b32 v138, 16, v93
    v_and_b32 v139, s6, v93
    v_fmac_f32 v130, v138, v121
    v_fmac_f32 v131, v139, v121
    v_lshlrev_b32 v136, 16, v94
    v_and_b32 v137, s6, v94
    v_fmac_f32 v132, v136, v121
    v_fmac_f32 v133, v137, v121
    v_lshlrev_b32 v138, 16, v95
    v_and_b32 v139, s6, v95
    v_fmac_f32 v134, v138, v121
    v_fmac_f32 v135, v139, v121
    v_lshlrev_b32 v136, 16, v96
    v_and_b32 v137, s6, v96
    v_fmac_f32 v128, v136, v122
    v_fmac_f32 v129, v137, v122
    v_lshlrev_b32 v138, 16, v97
    v_and_b32 v139, s6, v97
    v_fmac_f32 v130, v138, v122
    v_fmac_f32 v131, v139, v122
    v_lshlrev_b32 v136, 16, v98
    v_and_b32 v137, s6, v98
    v_fmac_f32 v132, v136, v122
    v_fmac_f32 v133, v137, v122
    v_lshlrev_b32 v138, 16, v99
    v_and_b32 v139, s6, v99
    v_fmac_f32 v134, v138, v122
    v_fmac_f32 v135, v139, v122
    s_waitcnt lgkmcnt(0)
    s_load_dword s24, s[32:33], s92 offset:2560 glc
    s_load_dword s25, s[32:33], s92 offset:2304 glc
    s_load_dword s26, s[32:33], s92 offset:3072 glc
    s_load_dword s27, s[32:33], s92 offset:2816 glc
    s_barrier
    s_add_u32 s96, s84, 11
    s_and_b32 s97, s96, 15
    s_mul_i32 s98, s97, 393216
    s_add_u32 s99, s98, s85
    s_add_u32 s82, s99, 4294772736
    s_add_u32 m0, s83, 36864
    s_nop 0
    buffer_load_dwordx4 v3, s[40:43], s82 offen lds
    s_add_u32 s96, s84, 11
    s_and_b32 s97, s96, 15
    s_mul_i32 s98, s97, 393216
    s_add_u32 s99, s98, s85
    s_add_u32 s82, s99, 2048
    s_add_u32 m0, s83, 40960
    s_nop 0
    buffer_load_dwordx4 v3, s[40:43], s82 offen lds
    s_add_u32 s96, s84, 11
    s_and_b32 s97, s96, 15
    s_mul_i32 s98, s97, 393216
    s_add_u32 s99, s98, s85
    s_add_u32 s82, s99, 4294774784
    s_add_u32 m0, s83, 86016
    s_nop 0
    buffer_load_dwordx4 v3, s[40:43], s82 offen lds
    s_add_u32 s96, s84, 11
    s_and_b32 s97, s96, 15
    s_mul_i32 s98, s97, 393216
    s_add_u32 s99, s98, s85
    s_add_u32 s82, s99, 4096
    s_add_u32 m0, s83, 90112
    s_nop 0
    buffer_load_dwordx4 v3, s[40:43], s82 offen lds
    v_lshlrev_b32 v136, 16, v100
    v_and_b32 v137, s6, v100
    v_fmac_f32 v128, v136, v123
    v_fmac_f32 v129, v137, v123
    v_lshlrev_b32 v138, 16, v101
    v_and_b32 v139, s6, v101
    v_fmac_f32 v130, v138, v123
    v_fmac_f32 v131, v139, v123
    v_lshlrev_b32 v136, 16, v102
    v_and_b32 v137, s6, v102
    v_fmac_f32 v132, v136, v123
    v_fmac_f32 v133, v137, v123
    v_lshlrev_b32 v138, 16, v103
    v_and_b32 v139, s6, v103
    v_fmac_f32 v134, v138, v123
    v_fmac_f32 v135, v139, v123
    v_lshlrev_b32 v136, 16, v104
    v_and_b32 v137, s6, v104
    v_fmac_f32 v128, v136, v124
    v_fmac_f32 v129, v137, v124
    v_lshlrev_b32 v138, 16, v105
    v_and_b32 v139, s6, v105
    v_fmac_f32 v130, v138, v124
    v_fmac_f32 v131, v139, v124
    v_lshlrev_b32 v136, 16, v106
    v_and_b32 v137, s6, v106
    v_fmac_f32 v132, v136, v124
    v_fmac_f32 v133, v137, v124
    v_lshlrev_b32 v138, 16, v107
    v_and_b32 v139, s6, v107
    v_fmac_f32 v134, v138, v124
    v_fmac_f32 v135, v139, v124
    v_lshlrev_b32 v136, 16, v108
    v_and_b32 v137, s6, v108
    v_fmac_f32 v128, v136, v125
    v_fmac_f32 v129, v137, v125
    v_lshlrev_b32 v138, 16, v109
    v_and_b32 v139, s6, v109
    v_fmac_f32 v130, v138, v125
    v_fmac_f32 v131, v139, v125
    v_lshlrev_b32 v136, 16, v110
    v_and_b32 v137, s6, v110
    v_fmac_f32 v132, v136, v125
    v_fmac_f32 v133, v137, v125
    v_lshlrev_b32 v138, 16, v111
    v_and_b32 v139, s6, v111
    v_fmac_f32 v134, v138, v125
    v_fmac_f32 v135, v139, v125
    s_barrier
    s_add_u32 s96, s84, 12
    s_and_b32 s97, s96, 15
    s_mul_i32 s98, s97, 393216
    s_add_u32 s99, s98, s85
    s_add_u32 s82, s99, 4294772736
    s_add_u32 m0, s83, 4294963200
    s_nop 0
    buffer_load_dwordx4 v3, s[40:43], s82 offen lds
    s_add_u32 s96, s84, 12
    s_and_b32 s97, s96, 15
    s_mul_i32 s98, s97, 393216
    s_add_u32 s99, s98, s85
    s_add_u32 s82, s99, 2048
    s_mov_b32 m0, s83
    s_nop 0
    buffer_load_dwordx4 v3, s[40:43], s82 offen lds
    s_add_u32 s96, s84, 12
    s_and_b32 s97, s96, 15
    s_mul_i32 s98, s97, 393216
    s_add_u32 s99, s98, s85
    s_add_u32 s82, s99, 4294774784
    s_add_u32 m0, s83, 45056
    s_nop 0
    buffer_load_dwordx4 v3, s[40:43], s82 offen lds
    s_add_u32 s96, s84, 12
    s_and_b32 s97, s96, 15
    s_mul_i32 s98, s97, 393216
    s_add_u32 s99, s98, s85
    s_add_u32 s82, s99, 4096
    s_add_u32 m0, s83, 49152
    s_nop 0
    buffer_load_dwordx4 v3, s[40:43], s82 offen lds
    v_lshlrev_b32 v136, 16, v112
    v_and_b32 v137, s6, v112
    v_fmac_f32 v128, v136, v126
    v_fmac_f32 v129, v137, v126
    v_lshlrev_b32 v138, 16, v113
    v_and_b32 v139, s6, v113
    v_fmac_f32 v130, v138, v126
    v_fmac_f32 v131, v139, v126
    v_lshlrev_b32 v136, 16, v114
    v_and_b32 v137, s6, v114
    v_fmac_f32 v132, v136, v126
    v_fmac_f32 v133, v137, v126
    v_lshlrev_b32 v138, 16, v115
    v_and_b32 v139, s6, v115
    v_fmac_f32 v134, v138, v126
    v_fmac_f32 v135, v139, v126
    v_lshlrev_b32 v136, 16, v116
    v_and_b32 v137, s6, v116
    v_fmac_f32 v128, v136, v127
    v_fmac_f32 v129, v137, v127
    v_lshlrev_b32 v138, 16, v117
    v_and_b32 v139, s6, v117
    v_fmac_f32 v130, v138, v127
    v_fmac_f32 v131, v139, v127
    v_lshlrev_b32 v136, 16, v118
    v_and_b32 v137, s6, v118
    v_fmac_f32 v132, v136, v127
    v_fmac_f32 v133, v137, v127
    v_lshlrev_b32 v138, 16, v119
    v_and_b32 v139, s6, v119
    v_fmac_f32 v134, v138, v127
    v_fmac_f32 v135, v139, v127
    v_permlane32_swap_b32 v128, v132
    v_permlane32_swap_b32 v129, v133
    v_permlane32_swap_b32 v130, v134
    v_permlane32_swap_b32 v131, v135
    v_add_f32 v128, v128, v132
    v_add_f32 v129, v129, v133
    v_add_f32 v130, v130, v134
    v_add_f32 v131, v131, v135
    s_nop 0
    v_permlane16_swap_b32 v128, v130
    v_permlane16_swap_b32 v129, v131
    v_add_f32 v128, v128, v130
    v_add_f32 v129, v129, v131
    s_nop 0
    v_add_f32_dpp v128, v128, v128 row_ror:8 row_mask:0xf bank_mask:0xf
    v_add_f32_dpp v129, v129, v129 row_ror:8 row_mask:0xf bank_mask:0xf
    s_nop 1
    v_mov_b32_dpp v128, v129 quad_perm:[0,1,2,3] row_mask:0xf bank_mask:0xc
    ds_write_b32 v252, v128 offset:9984
    s_waitcnt lgkmcnt(0)
    s_barrier
    s_add_u32 s96, s84, 13
    s_and_b32 s97, s96, 15
    s_mul_i32 s98, s97, 393216
    s_add_u32 s99, s98, s85
    s_add_u32 s82, s99, 4294772736
    s_add_u32 m0, s83, 4096
    s_nop 0
    buffer_load_dwordx4 v3, s[40:43], s82 offen lds
    s_add_u32 s96, s84, 13
    s_and_b32 s97, s96, 15
    s_mul_i32 s98, s97, 393216
    s_add_u32 s99, s98, s85
    s_add_u32 s82, s99, 2048
    s_add_u32 m0, s83, 8192
    s_nop 0
    buffer_load_dwordx4 v3, s[40:43], s82 offen lds
    s_add_u32 s96, s84, 13
    s_and_b32 s97, s96, 15
    s_mul_i32 s98, s97, 393216
    s_add_u32 s99, s98, s85
    s_add_u32 s82, s99, 4294774784
    s_add_u32 m0, s83, 53248
    s_nop 0
    buffer_load_dwordx4 v3, s[40:43], s82 offen lds
    s_add_u32 s96, s84, 13
    s_and_b32 s97, s96, 15
    s_mul_i32 s98, s97, 393216
    s_add_u32 s99, s98, s85
    s_add_u32 s82, s99, 4096
    s_add_u32 m0, s83, 57344
    s_nop 0
    buffer_load_dwordx4 v3, s[40:43], s82 offen lds
    s_cmp_lg_u32 s3, 4
    s_cbranch_scc1 L_M2F
    ds_read_b128 v[128:131], v251 offset:10000
    s_lshr_b32 s96, s8, 2
    s_lshl1_add_u32 s97, s9, s96
    s_and_b32 s98, s8, 3
    s_lshl2_add_u32 s99, s97, s98
    s_lshl_b32 s96, s99, 9
    s_add_u32 s13, s96, 131072
    s_waitcnt lgkmcnt(0)
    v_add_f32 v128, v128, v129
    v_add_f32 v130, v130, v131
    v_mov_b32 v129, s4
    v_add_f32 v128, v128, v130
    buffer_store_dwordx2 v[128:129], v250, s[32:35], s13 offen sc1
L_M2F:
    s_lshl_b32 s96, s74, 13
    s_sub_u32 s97, s3, 4
    s_lshl_b32 s98, s97, 8
    s_add_u32 s99, s96, s98
    s_add_u32 s13, s99, 20971520
    s_waitcnt lgkmcnt(0)
    s_load_dword s24, s[32:33], s13 offset:1276 glc
    s_load_dword s25, s[32:33], s13 offset:3324 glc
    s_load_dword s26, s[32:33], s13 offset:5372 glc
    s_load_dword s27, s[32:33], s13 offset:7420 glc
    s_waitcnt vmcnt(18)
    s_waitcnt vmcnt(16)
    s_barrier
    s_add_u32 s96, s84, 14
    s_and_b32 s97, s96, 15
    s_mul_i32 s98, s97, 393216
    s_add_u32 s99, s98, s85
    s_add_u32 s82, s99, 4294772736
    s_add_u32 m0, s83, 12288
    s_nop 0
    buffer_load_dwordx4 v3, s[40:43], s82 offen lds
    s_add_u32 s96, s84, 14
    s_and_b32 s97, s96, 15
    s_mul_i32 s98, s97, 393216
    s_add_u32 s99, s98, s85
    s_add_u32 s82, s99, 2048
    s_add_u32 m0, s83, 16384
    s_nop 0
    buffer_load_dwordx4 v3, s[40:43], s82 offen lds
    s_waitcnt vmcnt(16)
    s_waitcnt vmcnt(12)
    s_barrier
    s_add_u32 s96, s84, 15
    s_and_b32 s97, s96, 15
    s_mul_i32 s98, s97, 393216
    s_add_u32 s99, s98, s85
    s_add_u32 s82, s99, 4294772736
    s_add_u32 m0, s83, 20480
    s_nop 0
    buffer_load_dwordx4 v3, s[40:43], s82 offen lds
    s_add_u32 s96, s84, 15
    s_and_b32 s97, s96, 15
    s_mul_i32 s98, s97, 393216
    s_add_u32 s99, s98, s85
    s_add_u32 s82, s99, 2048
    s_add_u32 m0, s83, 24576
    s_nop 0
    buffer_load_dwordx4 v3, s[40:43], s82 offen lds
    s_waitcnt vmcnt(10)
    s_waitcnt vmcnt(6)
    s_waitcnt vmcnt(2)
    s_barrier
    s_add_u32 s96, s84, 14
    s_and_b32 s97, s96, 15
    s_mul_i32 s98, s97, 393216
    s_add_u32 s99, s98, s85
    s_add_u32 s82, s99, 4294774784
    s_add_u32 m0, s83, 61440
    s_nop 0
    buffer_load_dwordx4 v3, s[40:43], s82 offen lds
    s_add_u32 s96, s84, 14
    s_and_b32 s97, s96, 15
    s_mul_i32 s98, s97, 393216
    s_add_u32 s99, s98, s85
    s_add_u32 s82, s99, 4096
    s_add_u32 m0, s83, 65536
    s_nop 0
    buffer_load_dwordx4 v3, s[40:43], s82 offen lds
    s_add_u32 s96, s84, 15
    s_and_b32 s97, s96, 15
    s_mul_i32 s98, s97, 393216
    s_add_u32 s99, s98, s85
    s_add_u32 s82, s99, 4294774784
    s_add_u32 m0, s83, 69632
    s_nop 0
    buffer_load_dwordx4 v3, s[40:43], s82 offen lds
    s_add_u32 s96, s84, 15
    s_and_b32 s97, s96, 15
    s_mul_i32 s98, s97, 393216
    s_add_u32 s99, s98, s85
    s_add_u32 s82, s99, 4096
    s_add_u32 m0, s83, 73728
    s_nop 0
    buffer_load_dwordx4 v3, s[40:43], s82 offen lds
    s_waitcnt vmcnt(4)
    s_barrier
    s_add_u32 s96, s84, 10
    s_and_b32 s97, s96, 15
    s_mul_i32 s98, s97, 393216
    s_add_u32 s99, s98, s85
    s_add_u32 s82, s99, 4294770688
    s_add_u32 m0, s83, 126976
    s_nop 0
    buffer_load_dwordx4 v3, s[40:43], s82 offen lds
    s_add_u32 s96, s84, 10
    s_and_b32 s97, s96, 15
    s_mul_i32 s98, s97, 393216
    s_add_u32 s82, s98, s85
    s_add_u32 m0, s83, 131072
    s_nop 0
    buffer_load_dwordx4 v3, s[40:43], s82 offen lds
    s_add_u32 s96, s84, 11
    s_and_b32 s97, s96, 15
    s_mul_i32 s98, s97, 393216
    s_add_u32 s99, s98, s85
    s_add_u32 s82, s99, 4294770688
    s_add_u32 m0, s83, 135168
    s_nop 0
    buffer_load_dwordx4 v3, s[40:43], s82 offen lds
    s_add_u32 s96, s84, 11
    s_and_b32 s97, s96, 15
    s_mul_i32 s98, s97, 393216
    s_add_u32 s82, s98, s85
    s_add_u32 m0, s83, 139264
    s_nop 0
    buffer_load_dwordx4 v3, s[40:43], s82 offen lds
    s_waitcnt lgkmcnt(0)
    s_barrier
    s_add_u32 s96, s84, 12
    s_and_b32 s97, s96, 15
    s_mul_i32 s98, s97, 393216
    s_add_u32 s99, s98, s85
    s_add_u32 s82, s99, 4294770688
    s_add_u32 m0, s83, 94208
    s_nop 0
    buffer_load_dwordx4 v3, s[40:43], s82 offen lds
    s_add_u32 s96, s84, 12
    s_and_b32 s97, s96, 15
    s_mul_i32 s98, s97, 393216
    s_add_u32 s82, s98, s85
    s_add_u32 m0, s83, 98304
    s_nop 0
    buffer_load_dwordx4 v3, s[40:43], s82 offen lds
    s_add_u32 s96, s84, 13
    s_and_b32 s97, s96, 15
    s_mul_i32 s98, s97, 393216
    s_add_u32 s99, s98, s85
    s_add_u32 s82, s99, 4294770688
    s_add_u32 m0, s83, 102400
    s_nop 0
    buffer_load_dwordx4 v3, s[40:43], s82 offen lds
    s_add_u32 s96, s84, 13
    s_and_b32 s97, s96, 15
    s_mul_i32 s98, s97, 393216
    s_add_u32 s82, s98, s85
    s_add_u32 m0, s83, 106496
    s_nop 0
    buffer_load_dwordx4 v3, s[40:43], s82 offen lds
    s_setprio 3
    ds_read_b128 v[152:155], v0
    ds_read_b128 v[156:159], v0 offset:1024
    v_subrev_u32 v0, 118784, v0
    s_waitcnt lgkmcnt(1)
    v_mfma_f32_32x32x16_bf16 v[184:199], v[168:171], v[152:155], 0
    s_waitcnt lgkmcnt(0)
    v_mfma_f32_32x32x16_bf16 v[184:199], v[172:175], v[156:159], v[184:199]
    s_setprio 0
    s_nop 10
    v_cvt_pk_bf16_f32 v184, 0, v184
    v_cvt_pk_bf16_f32 v185, 0, v185
    v_cvt_pk_bf16_f32 v186, 0, v186
    v_cvt_pk_bf16_f32 v187, 0, v187
    v_cvt_pk_bf16_f32 v188, 0, v188
    v_cvt_pk_bf16_f32 v189, 0, v189
    v_cvt_pk_bf16_f32 v190, 0, v190
    v_cvt_pk_bf16_f32 v191, 0, v191
    v_cvt_pk_bf16_f32 v192, 0, v192
    v_cvt_pk_bf16_f32 v193, 0, v193
    v_cvt_pk_bf16_f32 v194, 0, v194
    v_cvt_pk_bf16_f32 v195, 0, v195
    v_cvt_pk_bf16_f32 v196, 0, v196
    v_cvt_pk_bf16_f32 v197, 0, v197
    v_cvt_pk_bf16_f32 v198, 0, v198
    v_cvt_pk_bf16_f32 v199, 0, v199
    v_max3_f32 v4, v184, v185, v186
    v_min3_f32 v5, v184, v185, v186
    v_max3_f32 v4, v4, v187, v188
    v_min3_f32 v5, v5, v187, v188
    v_max3_f32 v4, v4, v189, v190
    v_min3_f32 v5, v5, v189, v190
    v_max3_f32 v4, v4, v191, v192
    v_min3_f32 v5, v5, v191, v192
    v_max3_f32 v4, v4, v193, v194
    v_min3_f32 v5, v5, v193, v194
    v_max3_f32 v4, v4, v195, v196
    v_min3_f32 v5, v5, v195, v196
    v_max3_f32 v4, v4, v197, v198
    v_min3_f32 v5, v5, v197, v198
    v_max_f32 v6, v4, v199
    v_min_f32 v7, v5, v199
    v_max_f32 v4, v4, v199
    v_min_f32 v5, v5, v199
    s_nop 0
    v_permlane32_swap_b32 v4, v6
    v_permlane32_swap_b32 v5, v7
    v_max_f32 v4, v4, v6
    v_min_f32 v5, v5, v7
    v_mul_f32_e64 v4, v4, s7
    v_mul_f32_e64 v5, v5, s7
    v_fma_f32 v216, v184, s7, -v4
    v_fma_f32 v217, v185, s7, -v4
    v_fma_f32 v184, -v184, s7, v5
    v_fma_f32 v185, -v185, s7, v5
    v_fma_f32 v218, v186, s7, -v4
    v_fma_f32 v219, v187, s7, -v4
    v_fma_f32 v186, -v186, s7, v5
    v_fma_f32 v187, -v187, s7, v5
    s_waitcnt vmcnt(10)
    s_waitcnt vmcnt(8)
    s_waitcnt vmcnt(6)
    s_barrier
    s_add_u32 s96, s84, 14
    s_and_b32 s97, s96, 15
    s_mul_i32 s98, s97, 393216
    s_add_u32 s99, s98, s85
    s_add_u32 s82, s99, 4294770688
    s_add_u32 m0, s83, 110592
    s_nop 0
    buffer_load_dwordx4 v3, s[40:43], s82 offen lds
    s_add_u32 s96, s84, 14
    s_and_b32 s97, s96, 15
    s_mul_i32 s98, s97, 393216
    s_add_u32 s82, s98, s85
    s_add_u32 m0, s83, 114688
    s_nop 0
    buffer_load_dwordx4 v3, s[40:43], s82 offen lds
    s_add_u32 s96, s84, 15
    s_and_b32 s97, s96, 15
    s_mul_i32 s98, s97, 393216
    s_add_u32 s99, s98, s85
    s_add_u32 s82, s99, 4294770688
    s_add_u32 m0, s83, 118784
    s_nop 0
    buffer_load_dwordx4 v3, s[40:43], s82 offen lds
    s_add_u32 s96, s84, 15
    s_and_b32 s97, s96, 15
    s_mul_i32 s98, s97, 393216
    s_add_u32 s82, s98, s85
    s_add_u32 m0, s83, 122880
    s_nop 0
    buffer_load_dwordx4 v3, s[40:43], s82 offen lds
    s_setprio 3
    ds_read_b128 v[152:155], v0
    ds_read_b128 v[156:159], v0 offset:1024
    s_waitcnt lgkmcnt(1)
    v_mfma_f32_32x32x16_bf16 v[200:215], v[176:179], v[152:155], 0
    s_waitcnt lgkmcnt(0)
    v_mfma_f32_32x32x16_bf16 v[200:215], v[180:183], v[156:159], v[200:215]
    s_setprio 0
    v_fma_f32 v220, v188, s7, -v4
    v_fma_f32 v221, v189, s7, -v4
    v_fma_f32 v188, -v188, s7, v5
    v_fma_f32 v189, -v189, s7, v5
    v_fma_f32 v222, v190, s7, -v4
    s_mov_b32 s82, s80
    buffer_load_dwordx4 v[56:59], v27, s[52:55], s82 offen nt
    v_fma_f32 v223, v191, s7, -v4
    v_fma_f32 v190, -v190, s7, v5
    v_fma_f32 v191, -v191, s7, v5
    v_fma_f32 v224, v192, s7, -v4
    v_fma_f32 v225, v193, s7, -v4
    v_fma_f32 v192, -v192, s7, v5
    v_fma_f32 v193, -v193, s7, v5
    v_fma_f32 v226, v194, s7, -v4
    v_fma_f32 v227, v195, s7, -v4
    v_fma_f32 v194, -v194, s7, v5
    v_fma_f32 v195, -v195, s7, v5
    v_fma_f32 v228, v196, s7, -v4
    v_fma_f32 v229, v197, s7, -v4
    v_fma_f32 v196, -v196, s7, v5
    v_fma_f32 v197, -v197, s7, v5
    v_fma_f32 v230, v198, s7, -v4
    v_fma_f32 v231, v199, s7, -v4
    v_fma_f32 v198, -v198, s7, v5
    v_fma_f32 v199, -v199, s7, v5
    v_exp_f32 v216, v216
    s_add_u32 s82, s80, 4294049792
    buffer_load_dwordx4 v[60:63], v27, s[52:55], s82 offen nt
    v_exp_f32 v184, v184
    v_exp_f32 v217, v217
    v_exp_f32 v185, v185
    v_exp_f32 v218, v218
    v_exp_f32 v186, v186
    v_exp_f32 v219, v219
    v_exp_f32 v187, v187
    v_exp_f32 v220, v220
    v_exp_f32 v188, v188
    v_exp_f32 v221, v221
    v_exp_f32 v189, v189
    v_exp_f32 v222, v222
    v_exp_f32 v190, v190
    v_exp_f32 v223, v223
    v_exp_f32 v191, v191
    v_exp_f32 v224, v224
    v_exp_f32 v192, v192
    v_exp_f32 v225, v225
    v_exp_f32 v193, v193
    v_exp_f32 v226, v226
    s_add_u32 s82, s80, 57344
    buffer_load_dwordx4 v[64:67], v27, s[52:55], s82 offen nt
    v_exp_f32 v194, v194
    v_exp_f32 v227, v227
    v_exp_f32 v195, v195
    v_exp_f32 v228, v228
    v_exp_f32 v196, v196
    v_exp_f32 v229, v229
    v_exp_f32 v197, v197
    v_exp_f32 v230, v230
    v_exp_f32 v198, v198
    v_exp_f32 v231, v231
    v_exp_f32 v199, v199
    v_add_f32 v8, v216, v218
    v_add_f32 v9, v217, v219
    v_add_f32 v10, v184, v186
    v_add_f32 v11, v185, v187
    v_add_f32 v8, v8, v220
    v_add_f32 v9, v9, v221
    v_add_f32 v10, v10, v188
    v_add_f32 v11, v11, v189
    v_add_f32 v8, v8, v222
    s_add_u32 s82, s80, 4294107136
    buffer_load_dwordx4 v[68:71], v27, s[52:55], s82 offen nt
    v_add_f32 v9, v9, v223
    v_add_f32 v10, v10, v190
    v_add_f32 v11, v11, v191
    v_add_f32 v8, v8, v224
    v_add_f32 v9, v9, v225
    v_add_f32 v10, v10, v192
    v_add_f32 v11, v11, v193
    v_add_f32 v8, v8, v226
    v_add_f32 v9, v9, v227
    v_add_f32 v10, v10, v194
    v_add_f32 v11, v11, v195
    v_add_f32 v8, v8, v228
    v_add_f32 v9, v9, v229
    v_add_f32 v10, v10, v196
    v_add_f32 v11, v11, v197
    v_add_f32 v8, v8, v230
    v_add_f32 v9, v9, v231
    v_add_f32 v10, v10, v198
    v_add_f32 v11, v11, v199
    v_add_f32 v6, v8, v9
    s_add_u32 s82, s80, 114688
    buffer_load_dwordx4 v[72:75], v27, s[52:55], s82 offen nt
    v_add_f32 v7, v10, v11
    v_add_f32 v4, v8, v9
    v_add_f32 v5, v10, v11
    s_nop 0
    v_permlane32_swap_b32 v4, v6
    v_permlane32_swap_b32 v5, v7
    v_add_f32 v4, v4, v6
    v_add_f32 v5, v5, v7
    v_rcp_f32 v4, v4
    v_rcp_f32 v5, v5
    v_mul_f32 v216, v216, v4
    v_mul_f32 v217, v217, v4
    v_mul_f32 v184, v184, v5
    v_mul_f32 v185, v185, v5
    v_mul_f32 v218, v218, v4
    v_mul_f32 v219, v219, v4
    v_mul_f32 v186, v186, v5
    v_mul_f32 v187, v187, v5
    v_mul_f32 v220, v220, v4
    v_mul_f32 v221, v221, v4
    v_mul_f32 v188, v188, v5
    s_add_u32 s82, s80, 4294164480
    buffer_load_dwordx4 v[76:79], v27, s[52:55], s82 offen nt
    v_mul_f32 v189, v189, v5
    v_mul_f32 v222, v222, v4
    v_mul_f32 v223, v223, v4
    v_mul_f32 v190, v190, v5
    v_mul_f32 v191, v191, v5
    v_mul_f32 v224, v224, v4
    v_mul_f32 v225, v225, v4
    v_mul_f32 v192, v192, v5
    v_mul_f32 v193, v193, v5
    v_mul_f32 v226, v226, v4
    v_mul_f32 v227, v227, v4
    v_mul_f32 v194, v194, v5
    v_mul_f32 v195, v195, v5
    v_mul_f32 v228, v228, v4
    v_mul_f32 v229, v229, v4
    v_mul_f32 v196, v196, v5
    v_mul_f32 v197, v197, v5
    v_mul_f32 v230, v230, v4
    v_mul_f32 v231, v231, v4
    v_mul_f32 v198, v198, v5
    s_add_u32 s82, s80, 172032
    buffer_load_dwordx4 v[80:83], v27, s[52:55], s82 offen nt
    v_mul_f32 v199, v199, v5
    v_cvt_pk_bf16_f32 v216, v216, v217
    v_cvt_pk_bf16_f32 v217, v218, v219
    v_cvt_pk_bf16_f32 v218, v220, v221
    v_cvt_pk_bf16_f32 v219, v222, v223
    v_cvt_pk_bf16_f32 v220, v224, v225
    v_cvt_pk_bf16_f32 v221, v226, v227
    v_cvt_pk_bf16_f32 v222, v228, v229
    v_cvt_pk_bf16_f32 v223, v230, v231
    ds_write_b128 v232, v[216:219]
L_PAD6:
    s_cbranch_execz L_RET6
    v_cvt_pk_bf16_f32 v224, v184, v185
    v_cvt_pk_bf16_f32 v225, v186, v187
    v_cvt_pk_bf16_f32 v226, v188, v189
    v_cvt_pk_bf16_f32 v227, v190, v191
    ds_write_b128 v232, v[220:223] offset:4096
    ds_write_b128 v232, v[224:227] offset:8192
    v_cvt_pk_bf16_f32 v228, v192, v193
    v_cvt_pk_bf16_f32 v229, v194, v195
    v_cvt_pk_bf16_f32 v230, v196, v197
    v_cvt_pk_bf16_f32 v231, v198, v199
    s_add_u32 s82, s80, 4294221824
    buffer_load_dwordx4 v[84:87], v27, s[52:55], s82 offen nt
    ds_write_b128 v232, v[228:231] offset:12288
    s_waitcnt vmcnt(16)
    s_waitcnt vmcnt(14)
    s_waitcnt vmcnt(12)
    s_waitcnt vmcnt(10)
    s_waitcnt vmcnt(8)
    s_barrier
    v_cvt_pk_bf16_f32 v200, 0, v200
    v_cvt_pk_bf16_f32 v201, 0, v201
    v_cvt_pk_bf16_f32 v202, 0, v202
    v_cvt_pk_bf16_f32 v203, 0, v203
    s_xor_b32 s96, s95, 786432
    s_add_u32 s97, s96, s90
    s_sub_u32 s82, s97, 65536
    s_add_u32 m0, s83, 45056
    s_nop 0
    buffer_load_dwordx4 v26, s[44:47], s82 offen lds
    v_cvt_pk_bf16_f32 v204, 0, v204
    v_cvt_pk_bf16_f32 v205, 0, v205
    v_cvt_pk_bf16_f32 v206, 0, v206
    v_cvt_pk_bf16_f32 v207, 0, v207
    v_cvt_pk_bf16_f32 v208, 0, v208
    v_cvt_pk_bf16_f32 v209, 0, v209
    v_cvt_pk_bf16_f32 v210, 0, v210
    v_cvt_pk_bf16_f32 v211, 0, v211
    v_cvt_pk_bf16_f32 v212, 0, v212
    v_cvt_pk_bf16_f32 v213, 0, v213
    v_cvt_pk_bf16_f32 v214, 0, v214
    v_cvt_pk_bf16_f32 v215, 0, v215
    v_max3_f32 v4, v200, v201, v202
    v_min3_f32 v5, v200, v201, v202
    s_xor_b32 s96, s95, 786432
    s_add_u32 s82, s96, s90
    s_add_u32 m0, s83, 49152
    s_nop 0
    buffer_load_dwordx4 v26, s[44:47], s82 offen lds
    v_max3_f32 v4, v4, v203, v204
    v_min3_f32 v5, v5, v203, v204
    v_max3_f32 v4, v4, v205, v206
    v_min3_f32 v5, v5, v205, v206
    v_max3_f32 v4, v4, v207, v208
    v_min3_f32 v5, v5, v207, v208
    v_max3_f32 v4, v4, v209, v210
    v_min3_f32 v5, v5, v209, v210
    v_max3_f32 v4, v4, v211, v212
    v_min3_f32 v5, v5, v211, v212
    v_max3_f32 v4, v4, v213, v214
    v_min3_f32 v5, v5, v213, v214
    v_max_f32 v6, v4, v215
    v_min_f32 v7, v5, v215
    s_xor_b32 s96, s95, 917504
    s_add_u32 s97, s96, s90
    s_sub_u32 s82, s97, 65536
    s_add_u32 m0, s83, 53248
    s_nop 0
    buffer_load_dwordx4 v26, s[44:47], s82 offen lds
    v_max_f32 v4, v4, v215
    s_waitcnt lgkmcnt(0)
    v_min_f32 v5, v5, v215
    v_permlane32_swap_b32 v4, v6
    s_nop 0
    v_permlane32_swap_b32 v5, v7
    v_max_f32 v4, v4, v6
    v_min_f32 v5, v5, v7
    v_mul_f32_e64 v4, v4, s7
    v_mul_f32_e64 v5, v5, s7
    v_fma_f32 v216, v200, s7, -v4
    v_fma_f32 v217, v201, s7, -v4
    v_fma_f32 v200, -v200, s7, v5
    v_fma_f32 v201, -v201, s7, v5
    v_fma_f32 v218, v202, s7, -v4
    s_xor_b32 s96, s95, 917504
    s_add_u32 s82, s96, s90
    s_add_u32 m0, s83, 57344
    s_nop 0
    buffer_load_dwordx4 v26, s[44:47], s82 offen lds
    v_fma_f32 v219, v203, s7, -v4
    v_fma_f32 v202, -v202, s7, v5
    v_fma_f32 v203, -v203, s7, v5
    v_fma_f32 v220, v204, s7, -v4
    v_fma_f32 v221, v205, s7, -v4
    v_fma_f32 v204, -v204, s7, v5
    v_fma_f32 v205, -v205, s7, v5
    v_fma_f32 v222, v206, s7, -v4
    v_fma_f32 v223, v207, s7, -v4
    v_fma_f32 v206, -v206, s7, v5
    v_fma_f32 v207, -v207, s7, v5
    v_fma_f32 v224, v208, s7, -v4
    v_fma_f32 v225, v209, s7, -v4
    v_fma_f32 v208, -v208, s7, v5
    s_xor_b32 s96, s95, 1048576
    s_add_u32 s97, s96, s90
    s_sub_u32 s82, s97, 65536
    s_add_u32 m0, s83, 61440
    s_nop 0
    buffer_load_dwordx4 v26, s[44:47], s82 offen lds
    v_fma_f32 v209, -v209, s7, v5
    v_fma_f32 v226, v210, s7, -v4
    v_fma_f32 v227, v211, s7, -v4
    v_fma_f32 v210, -v210, s7, v5
    v_fma_f32 v211, -v211, s7, v5
    v_fma_f32 v228, v212, s7, -v4
    v_fma_f32 v229, v213, s7, -v4
    v_fma_f32 v212, -v212, s7, v5
    v_fma_f32 v213, -v213, s7, v5
    v_fma_f32 v230, v214, s7, -v4
    v_fma_f32 v231, v215, s7, -v4
    v_fma_f32 v214, -v214, s7, v5
    v_fma_f32 v215, -v215, s7, v5
    v_exp_f32 v216, v216
    s_xor_b32 s96, s95, 1048576
    s_add_u32 s82, s96, s90
    s_add_u32 m0, s83, 65536
    s_nop 0
    buffer_load_dwordx4 v26, s[44:47], s82 offen lds
    v_exp_f32 v200, v200
    v_exp_f32 v217, v217
    v_exp_f32 v201, v201
    v_exp_f32 v218, v218
    v_exp_f32 v202, v202
    v_exp_f32 v219, v219
    v_exp_f32 v203, v203
    v_exp_f32 v220, v220
    v_exp_f32 v204, v204
    v_exp_f32 v221, v221
    v_exp_f32 v205, v205
    v_exp_f32 v222, v222
    v_exp_f32 v206, v206
    v_exp_f32 v223, v223
    s_xor_b32 s96, s95, 1179648
    s_add_u32 s97, s96, s90
    s_sub_u32 s82, s97, 65536
    s_add_u32 m0, s83, 69632
    s_nop 0
    buffer_load_dwordx4 v26, s[44:47], s82 offen lds
    v_exp_f32 v207, v207
    v_exp_f32 v224, v224
    v_exp_f32 v208, v208
    v_exp_f32 v225, v225
    v_exp_f32 v209, v209
    v_exp_f32 v226, v226
    v_exp_f32 v210, v210
    v_exp_f32 v227, v227
    v_exp_f32 v211, v211
    v_exp_f32 v228, v228
    v_exp_f32 v212, v212
    v_exp_f32 v229, v229
    v_exp_f32 v213, v213
    v_exp_f32 v230, v230
    s_xor_b32 s96, s95, 1179648
    s_add_u32 s82, s96, s90
    s_add_u32 m0, s83, 73728
    s_nop 0
    buffer_load_dwordx4 v26, s[44:47], s82 offen lds
    v_exp_f32 v214, v214
    v_exp_f32 v231, v231
    v_exp_f32 v215, v215
    v_add_f32 v8, v216, v218
    v_add_f32 v9, v217, v219
    v_add_f32 v10, v200, v202
    v_add_f32 v11, v201, v203
    v_add_f32 v8, v8, v220
    v_add_f32 v9, v9, v221
    v_add_f32 v10, v10, v204
    v_add_f32 v11, v11, v205
    v_add_f32 v8, v8, v222
    v_add_f32 v9, v9, v223
    v_add_f32 v10, v10, v206
    s_xor_b32 s96, s95, 1310720
    s_add_u32 s97, s96, s90
    s_sub_u32 s82, s97, 65536
    s_add_u32 m0, s83, 77824
    s_nop 0
    buffer_load_dwordx4 v26, s[44:47], s82 offen lds
    v_add_f32 v11, v11, v207
    v_add_f32 v8, v8, v224
    v_add_f32 v9, v9, v225
    v_add_f32 v10, v10, v208
    v_add_f32 v11, v11, v209
    v_add_f32 v8, v8, v226
    v_add_f32 v9, v9, v227
    v_add_f32 v10, v10, v210
    v_add_f32 v11, v11, v211
    v_add_f32 v8, v8, v228
    v_add_f32 v9, v9, v229
    v_add_f32 v10, v10, v212
    v_add_f32 v11, v11, v213
    v_add_f32 v8, v8, v230
    s_xor_b32 s96, s95, 1310720
    s_add_u32 s82, s96, s90
    s_add_u32 m0, s83, 81920
    s_nop 0
    buffer_load_dwordx4 v26, s[44:47], s82 offen lds
    v_add_f32 v9, v9, v231
    v_add_f32 v10, v10, v214
    v_add_f32 v11, v11, v215
    v_add_f32 v6, v8, v9
    v_add_f32 v7, v10, v11
    v_add_f32 v4, v8, v9
    v_add_f32 v5, v10, v11
    s_nop 0
    v_permlane32_swap_b32 v4, v6
    v_permlane32_swap_b32 v5, v7
    v_add_f32 v4, v4, v6
    v_add_f32 v5, v5, v7
    v_rcp_f32 v4, v4
    v_rcp_f32 v5, v5
    v_mul_f32 v216, v216, v4
    s_xor_b32 s96, s95, 1441792
    s_add_u32 s97, s96, s90
    s_sub_u32 s82, s97, 65536
    s_add_u32 m0, s83, 86016
    s_nop 0
    buffer_load_dwordx4 v26, s[44:47], s82 offen lds
    v_mul_f32 v217, v217, v4
    v_mul_f32 v200, v200, v5
    v_mul_f32 v201, v201, v5
    v_mul_f32 v218, v218, v4
    v_mul_f32 v219, v219, v4
    v_mul_f32 v202, v202, v5
    v_mul_f32 v203, v203, v5
    v_mul_f32 v220, v220, v4
    v_mul_f32 v221, v221, v4
    v_mul_f32 v204, v204, v5
    v_mul_f32 v205, v205, v5
    v_mul_f32 v222, v222, v4
    v_mul_f32 v223, v223, v4
    v_mul_f32 v206, v206, v5
    s_xor_b32 s96, s95, 1441792
    s_add_u32 s82, s96, s90
    s_add_u32 m0, s83, 90112
    s_nop 0
    buffer_load_dwordx4 v26, s[44:47], s82 offen lds
    v_mul_f32 v207, v207, v5
    v_mul_f32 v224, v224, v4
    v_mul_f32 v225, v225, v4
    v_mul_f32 v208, v208, v5
    v_mul_f32 v209, v209, v5
    v_mul_f32 v226, v226, v4
    v_mul_f32 v227, v227, v4
    v_mul_f32 v210, v210, v5
    v_mul_f32 v211, v211, v5
    v_mul_f32 v228, v228, v4
    v_mul_f32 v229, v229, v4
    v_mul_f32 v212, v212, v5
    v_mul_f32 v213, v213, v5
    v_mul_f32 v230, v230, v4
    v_mul_f32 v231, v231, v4
    v_mul_f32 v214, v214, v5
    v_mul_f32 v215, v215, v5
    v_cvt_pk_bf16_f32 v216, v216, v217
    v_cvt_pk_bf16_f32 v217, v218, v219
    v_cvt_pk_bf16_f32 v218, v220, v221
    v_cvt_pk_bf16_f32 v219, v222, v223
    v_cvt_pk_bf16_f32 v220, v224, v225
    v_cvt_pk_bf16_f32 v221, v226, v227
    v_cvt_pk_bf16_f32 v222, v228, v229
    v_cvt_pk_bf16_f32 v223, v230, v231
    ds_write_b128 v232, v[216:219] offset:16384
    v_cvt_pk_bf16_f32 v224, v200, v201
    v_cvt_pk_bf16_f32 v225, v202, v203
    v_cvt_pk_bf16_f32 v226, v204, v205
    v_cvt_pk_bf16_f32 v227, v206, v207
    ds_write_b128 v232, v[220:223] offset:20480
    ds_write_b128 v232, v[224:227] offset:24576
    v_cvt_pk_bf16_f32 v228, v208, v209
    v_cvt_pk_bf16_f32 v229, v210, v211
    v_cvt_pk_bf16_f32 v230, v212, v213
    v_cvt_pk_bf16_f32 v231, v214, v215
    ds_write_b128 v232, v[228:231] offset:28672
    s_lshl_b32 s96, s77, 11
    s_add_u32 s14, s96, 151552
    v_add_u32 v0, s14, v2
    s_setprio 0
L_JOIN:
    v_and_b32 v45, 1, v1
    v_lshlrev_b32 v45, 3, v45
    v_bfe_u32 v9, v1, 2, 2
    v_lshl_add_u32 v45, v9, 4, v45
    v_bfe_u32 v9, v1, 4, 1
    v_lshl_add_u32 v45, v9, 6, v45
    v_bfe_u32 v9, v1, 1, 1
    v_lshl_add_u32 v45, v9, 7, v45
    v_lshrrev_b32 v9, 5, v1
    v_lshl_add_u32 v45, v9, 8, v45
    s_lshl_b32 s13, s3, 12
    v_add_u32 v44, s13, v45
    s_lshl_b32 s96, s76, 13
    s_add_u32 s13, s96, 32768
    v_add_u32 v45, s13, v45
    v_mov_b32 v244, 0x3f803f80
    v_mov_b32 v245, 0x3f803f80
    v_mov_b32 v246, 0x3f803f80
    v_mov_b32 v247, 0x3f803f80
    s_lshl3_add_u32 s96, s11, s3
    s_lshl_b32 s97, s96, 5
    s_add_u32 s98, s97, s10
    s_lshl_b32 s99, s98, 10
    s_add_u32 s13, s99, 25165824
    s_add_u32 s15, s13, 16384
    s_lshl3_add_u32 s96, s11, s3
    s_lshl_b32 s97, s96, 10
    s_add_u32 s16, s97, 21495808
    s_lshl_b32 s96, s10, 6
    s_add_u32 s14, s96, s16
    s_waitcnt lgkmcnt(0)
    s_barrier
    ds_read_b64_tr_b16 v[184:185], v44
    ds_read_b64_tr_b16 v[186:187], v44 offset:512
    ds_read_b64_tr_b16 v[200:201], v45
    ds_read_b64_tr_b16 v[202:203], v45 offset:512
    ds_read_b64_tr_b16 v[204:205], v45 offset:1024
    ds_read_b64_tr_b16 v[206:207], v45 offset:1536
    ds_read_b64_tr_b16 v[188:189], v44 offset:1024
    ds_read_b64_tr_b16 v[190:191], v44 offset:1536
    ds_read_b64_tr_b16 v[208:209], v45 offset:2048
    ds_read_b64_tr_b16 v[210:211], v45 offset:2560
    ds_read_b64_tr_b16 v[212:213], v45 offset:3072
    ds_read_b64_tr_b16 v[214:215], v45 offset:3584
    ds_read_b64_tr_b16 v[192:193], v44 offset:2048
    ds_read_b64_tr_b16 v[194:195], v44 offset:2560
    ds_read_b64_tr_b16 v[216:217], v45 offset:4096
    ds_read_b64_tr_b16 v[218:219], v45 offset:4608
    ds_read_b64_tr_b16 v[220:221], v45 offset:5120
    ds_read_b64_tr_b16 v[222:223], v45 offset:5632
    s_waitcnt lgkmcnt(12)
    v_mfma_f32_16x16x32_bf16 v[232:235], v[184:187], v[200:203], 0
    v_mfma_f32_16x16x32_bf16 v[236:239], v[184:187], v[204:207], 0
    v_mfma_f32_16x16x32_bf16 v[240:243], v[184:187], v[244:247], 0
    ds_read_b64_tr_b16 v[196:197], v44 offset:3072
    ds_read_b64_tr_b16 v[198:199], v44 offset:3584
    ds_read_b64_tr_b16 v[224:225], v45 offset:6144
    ds_read_b64_tr_b16 v[226:227], v45 offset:6656
    ds_read_b64_tr_b16 v[228:229], v45 offset:7168
    ds_read_b64_tr_b16 v[230:231], v45 offset:7680
    s_waitcnt lgkmcnt(12)
    v_mfma_f32_16x16x32_bf16 v[232:235], v[188:191], v[208:211], v[232:235]
    v_mfma_f32_16x16x32_bf16 v[236:239], v[188:191], v[212:215], v[236:239]
    v_mfma_f32_16x16x32_bf16 v[240:243], v[188:191], v[244:247], v[240:243]
    s_waitcnt lgkmcnt(6)
    v_mfma_f32_16x16x32_bf16 v[232:235], v[192:195], v[216:219], v[232:235]
    v_mfma_f32_16x16x32_bf16 v[236:239], v[192:195], v[220:223], v[236:239]
    v_mfma_f32_16x16x32_bf16 v[240:243], v[192:195], v[244:247], v[240:243]
    s_waitcnt lgkmcnt(0)
    v_mfma_f32_16x16x32_bf16 v[232:235], v[196:199], v[224:227], v[232:235]
    v_mfma_f32_16x16x32_bf16 v[236:239], v[196:199], v[228:231], v[236:239]
    v_mfma_f32_16x16x32_bf16 v[240:243], v[196:199], v[244:247], v[240:243]
    s_cmp_lt_u32 s3, 4
    s_cbranch_scc1 L_NOQX
    ds_read_b128 v[168:171], v0
    ds_read_b128 v[172:175], v0 offset:1024
L_NOQX:
    s_nop 3
    buffer_store_dwordx4 v[232:235], v2, s[32:35], s13 offen sc1
    buffer_store_dwordx4 v[236:239], v2, s[32:35], s15 offen sc1
    s_mov_b32 exec_lo, 0x00010001
    s_mov_b32 exec_hi, 0x00010001
    buffer_store_dwordx4 v[240:243], v1, s[32:35], s14 offen sc1
    s_mov_b64 exec, -1
    s_waitcnt lgkmcnt(0)
    v_mfma_f32_32x32x16_bf16 v[120:135], v[176:179], v[168:171], 0
    v_mfma_f32_32x32x16_bf16 v[120:135], v[180:183], v[172:175], v[120:135]
    v_and_b32 v46, 7, v1
    v_lshlrev_b32 v46, 17, v46
    v_bfe_u32 v9, v1, 3, 1
    v_lshl_add_u32 v46, v9, 14, v46
    s_and_b32 s96, s10, 1
    s_and_b32 s97, s2, 27
    s_lshl_b32 s98, s97, 12
    s_lshr_b32 s99, s10, 1
    s_lshl_b32 s97, s99, 6
    s_add_u32 s99, s98, s97
    s_lshl2_add_u32 s98, s96, s99
    s_add_u32 s97, s98, 1048576
    s_add_u32 s17, s97, 512
    v_lshrrev_b32 v47, 3, v1
    v_lshlrev_b32 v47, 10, v47
    v_and_b32 v9, 7, v1
    v_lshl_add_u32 v47, v9, 4, v47
    v_and_b32 v48, 7, v1
    v_lshlrev_b32 v48, 4, v48
    v_lshrrev_b32 v9, 5, v1
    v_lshl_add_u32 v48, v9, 3, v48
    v_cvt_pk_bf16_f32 v120, 0, v120
    v_cvt_pk_bf16_f32 v121, 0, v121
    v_cvt_pk_bf16_f32 v122, 0, v122
    v_cvt_pk_bf16_f32 v123, 0, v123
    v_cvt_pk_bf16_f32 v124, 0, v124
    v_cvt_pk_bf16_f32 v125, 0, v125
    v_cvt_pk_bf16_f32 v126, 0, v126
    v_cvt_pk_bf16_f32 v127, 0, v127
    v_cvt_pk_bf16_f32 v128, 0, v128
    v_cvt_pk_bf16_f32 v129, 0, v129
    v_cvt_pk_bf16_f32 v130, 0, v130
    v_cvt_pk_bf16_f32 v131, 0, v131
    v_cvt_pk_bf16_f32 v132, 0, v132
    v_cvt_pk_bf16_f32 v133, 0, v133
    v_cvt_pk_bf16_f32 v134, 0, v134
    v_cvt_pk_bf16_f32 v135, 0, v135
    v_max3_f32 v4, v120, v121, v122
    v_min3_f32 v5, v120, v121, v122
    v_max3_f32 v4, v4, v123, v124
    v_min3_f32 v5, v5, v123, v124
    v_max3_f32 v4, v4, v125, v126
    v_min3_f32 v5, v5, v125, v126
    v_max3_f32 v4, v4, v127, v128
    v_min3_f32 v5, v5, v127, v128
    v_max3_f32 v4, v4, v129, v130
    v_min3_f32 v5, v5, v129, v130
    v_max3_f32 v4, v4, v131, v132
    v_min3_f32 v5, v5, v131, v132
    v_max3_f32 v4, v4, v133, v134
    v_min3_f32 v5, v5, v133, v134
    v_max_f32 v6, v4, v135
    v_min_f32 v7, v5, v135
    v_max_f32 v4, v4, v135
    v_min_f32 v5, v5, v135
    s_nop 0
    v_permlane32_swap_b32 v4, v6
    v_permlane32_swap_b32 v5, v7
    v_max_f32 v4, v4, v6
    v_min_f32 v5, v5, v7
    v_pk_mul_f32 v[4:5], v[4:5], s[6:7] op_sel:[0,1]
    v_pk_fma_f32 v[136:137], v[120:121], s[6:7], v[4:5] op_sel:[0,1,0] op_sel_hi:[1,1,0] neg_lo:[0,0,1] neg_hi:[0,0,1]
    v_pk_fma_f32 v[120:121], v[120:121], s[6:7], v[4:5] op_sel:[0,1,1] neg_lo:[1,0,0] neg_hi:[1,0,0]
    v_pk_fma_f32 v[138:139], v[122:123], s[6:7], v[4:5] op_sel:[0,1,0] op_sel_hi:[1,1,0] neg_lo:[0,0,1] neg_hi:[0,0,1]
    v_pk_fma_f32 v[122:123], v[122:123], s[6:7], v[4:5] op_sel:[0,1,1] neg_lo:[1,0,0] neg_hi:[1,0,0]
    v_pk_fma_f32 v[140:141], v[124:125], s[6:7], v[4:5] op_sel:[0,1,0] op_sel_hi:[1,1,0] neg_lo:[0,0,1] neg_hi:[0,0,1]
    v_pk_fma_f32 v[124:125], v[124:125], s[6:7], v[4:5] op_sel:[0,1,1] neg_lo:[1,0,0] neg_hi:[1,0,0]
    v_pk_fma_f32 v[142:143], v[126:127], s[6:7], v[4:5] op_sel:[0,1,0] op_sel_hi:[1,1,0] neg_lo:[0,0,1] neg_hi:[0,0,1]
    v_pk_fma_f32 v[126:127], v[126:127], s[6:7], v[4:5] op_sel:[0,1,1] neg_lo:[1,0,0] neg_hi:[1,0,0]
    v_pk_fma_f32 v[144:145], v[128:129], s[6:7], v[4:5] op_sel:[0,1,0] op_sel_hi:[1,1,0] neg_lo:[0,0,1] neg_hi:[0,0,1]
    v_pk_fma_f32 v[128:129], v[128:129], s[6:7], v[4:5] op_sel:[0,1,1] neg_lo:[1,0,0] neg_hi:[1,0,0]
    v_pk_fma_f32 v[146:147], v[130:131], s[6:7], v[4:5] op_sel:[0,1,0] op_sel_hi:[1,1,0] neg_lo:[0,0,1] neg_hi:[0,0,1]
    v_pk_fma_f32 v[130:131], v[130:131], s[6:7], v[4:5] op_sel:[0,1,1] neg_lo:[1,0,0] neg_hi:[1,0,0]
    v_pk_fma_f32 v[148:149], v[132:133], s[6:7], v[4:5] op_sel:[0,1,0] op_sel_hi:[1,1,0] neg_lo:[0,0,1] neg_hi:[0,0,1]
    v_pk_fma_f32 v[132:133], v[132:133], s[6:7], v[4:5] op_sel:[0,1,1] neg_lo:[1,0,0] neg_hi:[1,0,0]
    v_pk_fma_f32 v[150:151], v[134:135], s[6:7], v[4:5] op_sel:[0,1,0] op_sel_hi:[1,1,0] neg_lo:[0,0,1] neg_hi:[0,0,1]
    v_pk_fma_f32 v[134:135], v[134:135], s[6:7], v[4:5] op_sel:[0,1,1] neg_lo:[1,0,0] neg_hi:[1,0,0]
    v_exp_f32 v136, v136
    v_exp_f32 v120, v120
    v_exp_f32 v137, v137
    v_exp_f32 v121, v121
    v_exp_f32 v138, v138
    v_exp_f32 v122, v122
    v_exp_f32 v139, v139
    v_exp_f32 v123, v123
    v_exp_f32 v140, v140
    v_exp_f32 v124, v124
    v_exp_f32 v141, v141
    v_exp_f32 v125, v125
    v_exp_f32 v142, v142
    v_exp_f32 v126, v126
    v_exp_f32 v143, v143
    v_exp_f32 v127, v127
    s_waitcnt vmcnt(0)
    s_barrier
    s_cmp_lg_u32 s3, 0
    s_cbranch_scc1 L_PC
    v_mov_b32 v45, s4
    s_mov_b32 exec_hi, 0
    s_mov_b32 exec_lo, 65535
    buffer_store_dword v45, v46, s[32:35], s17 offen sc1
    s_mov_b64 exec, -1
L_PC:
    s_xor_b32 s96, s95, 1572864
    s_add_u32 s82, s96, s90
    s_add_u32 m0, s83, 98304
    s_nop 0
    buffer_load_dwordx4 v26, s[44:47], s82 offen lds
    v_exp_f32 v144, v144
    v_exp_f32 v128, v128
    v_exp_f32 v145, v145
    v_exp_f32 v129, v129
    v_exp_f32 v146, v146
    v_exp_f32 v130, v130
    v_exp_f32 v147, v147
    v_exp_f32 v131, v131
    s_xor_b32 s96, s95, 1703936
    s_add_u32 s82, s96, s90
    s_add_u32 m0, s83, 106496
    s_nop 0
    buffer_load_dwordx4 v26, s[44:47], s82 offen lds
    v_exp_f32 v148, v148
    v_exp_f32 v132, v132
    v_exp_f32 v149, v149
    v_exp_f32 v133, v133
    v_exp_f32 v150, v150
    v_exp_f32 v134, v134
    v_exp_f32 v151, v151
    v_exp_f32 v135, v135
    s_lshl4_add_u32 s96, s11, s10
    s_lshl_b32 s97, s96, 14
    s_lshl_b32 s98, s3, 7
    s_add_u32 s99, s97, s98
    s_add_u32 s13, s99, 25165824
    s_add_u32 s14, s13, 8192
    s_lshl4_add_u32 s96, s11, s10
    s_lshl_b32 s97, s96, 10
    s_lshl_b32 s98, s3, 7
    s_add_u32 s99, s97, s98
    s_add_u32 s15, s99, 29360128
    s_add_u32 s17, s17, 3072
    s_load_dwordx2 s[24:25], s[32:33], s92 offset:512 glc
    s_xor_b32 s96, s95, 1835008
    s_add_u32 s82, s96, s90
    s_add_u32 m0, s83, 114688
    s_nop 0
    buffer_load_dwordx4 v26, s[44:47], s82 offen lds
    v_pk_add_f32 v[8:9], v[136:137], v[138:139]
    v_pk_add_f32 v[10:11], v[120:121], v[122:123]
    v_pk_add_f32 v[8:9], v[8:9], v[140:141]
    v_pk_add_f32 v[10:11], v[10:11], v[124:125]
    v_pk_add_f32 v[8:9], v[8:9], v[142:143]
    v_pk_add_f32 v[10:11], v[10:11], v[126:127]
    v_pk_add_f32 v[8:9], v[8:9], v[144:145]
    v_pk_add_f32 v[10:11], v[10:11], v[128:129]
    v_pk_add_f32 v[8:9], v[8:9], v[146:147]
    v_pk_add_f32 v[10:11], v[10:11], v[130:131]
    v_pk_add_f32 v[8:9], v[8:9], v[148:149]
    v_pk_add_f32 v[10:11], v[10:11], v[132:133]
    v_pk_add_f32 v[8:9], v[8:9], v[150:151]
    v_pk_add_f32 v[10:11], v[10:11], v[134:135]
    s_xor_b32 s96, s95, 1966080
    s_add_u32 s82, s96, s90
    s_add_u32 m0, s83, 122880
    s_nop 0
    buffer_load_dwordx4 v26, s[44:47], s82 offen lds
    v_add_f32 v6, v8, v9
    v_add_f32 v7, v10, v11
    v_add_f32 v4, v8, v9
    v_add_f32 v5, v10, v11
    s_nop 0
    v_permlane32_swap_b32 v4, v6
    v_permlane32_swap_b32 v5, v7
    v_pk_add_f32 v[4:5], v[4:5], v[6:7]
    v_rcp_f32 v4, v4
    v_rcp_f32 v5, v5
    s_nop 0
    v_pk_mul_f32 v[136:137], v[136:137], v[4:5] op_sel_hi:[1,0]
    v_pk_mul_f32 v[120:121], v[120:121], v[4:5] op_sel:[0,1]
    v_pk_mul_f32 v[138:139], v[138:139], v[4:5] op_sel_hi:[1,0]
    v_pk_mul_f32 v[122:123], v[122:123], v[4:5] op_sel:[0,1]
    v_pk_mul_f32 v[140:141], v[140:141], v[4:5] op_sel_hi:[1,0]
    s_add_u32 s82, s95, s90
    s_mov_b32 m0, s83
    s_nop 0
    buffer_load_dwordx4 v26, s[44:47], s82 offen lds
    v_pk_mul_f32 v[124:125], v[124:125], v[4:5] op_sel:[0,1]
    v_pk_mul_f32 v[142:143], v[142:143], v[4:5] op_sel_hi:[1,0]
    v_pk_mul_f32 v[126:127], v[126:127], v[4:5] op_sel:[0,1]
    v_pk_mul_f32 v[144:145], v[144:145], v[4:5] op_sel_hi:[1,0]
    v_pk_mul_f32 v[128:129], v[128:129], v[4:5] op_sel:[0,1]
    v_pk_mul_f32 v[146:147], v[146:147], v[4:5] op_sel_hi:[1,0]
    v_pk_mul_f32 v[130:131], v[130:131], v[4:5] op_sel:[0,1]
    v_pk_mul_f32 v[148:149], v[148:149], v[4:5] op_sel_hi:[1,0]
    v_pk_mul_f32 v[132:133], v[132:133], v[4:5] op_sel:[0,1]
    v_pk_mul_f32 v[150:151], v[150:151], v[4:5] op_sel_hi:[1,0]
    v_pk_mul_f32 v[134:135], v[134:135], v[4:5] op_sel:[0,1]
    v_cvt_pk_bf16_f32 v152, v136, v137
    v_cvt_pk_bf16_f32 v153, v138, v139
    v_cvt_pk_bf16_f32 v154, v140, v141
    s_xor_b32 s96, s95, 131072
    s_add_u32 s82, s96, s90
    s_add_u32 m0, s83, 8192
    s_nop 0
    buffer_load_dwordx4 v26, s[44:47], s82 offen lds
    v_cvt_pk_bf16_f32 v155, v142, v143
    v_cvt_pk_bf16_f32 v156, v144, v145
    v_cvt_pk_bf16_f32 v157, v146, v147
    v_cvt_pk_bf16_f32 v158, v148, v149
    v_cvt_pk_bf16_f32 v159, v150, v151
    v_cvt_pk_bf16_f32 v160, v120, v121
    v_cvt_pk_bf16_f32 v161, v122, v123
    v_cvt_pk_bf16_f32 v162, v124, v125
    v_cvt_pk_bf16_f32 v163, v126, v127
    v_cvt_pk_bf16_f32 v164, v128, v129
    v_cvt_pk_bf16_f32 v165, v130, v131
    v_cvt_pk_bf16_f32 v166, v132, v133
    v_cvt_pk_bf16_f32 v167, v134, v135
    s_branch SCHK_17
SPOLL_16:
    s_load_dwordx2 s[24:25], s[32:33], s92 offset:512 glc
SCHK_17:
    s_add_u32 s5, s5, 1
    s_cmp_ge_u32 s5, 200000
    s_waitcnt lgkmcnt(0)
    s_cbranch_scc1 SDONE_18
    s_cmp_lg_u32 s24, s4
    s_cbranch_scc1 SPOLL_16
    s_cmp_lg_u32 s25, s4
    s_cbranch_scc1 SPOLL_16
SDONE_18:
    s_barrier
    buffer_load_dwordx4 v[184:187], v47, s[32:35], s13 offen sc1
    buffer_load_dwordx4 v[188:191], v47, s[32:35], s14 offen sc1
    buffer_load_dwordx4 v[192:195], v2, s[32:35], s16 offen sc1
    s_lshl_b32 s96, s3, 5
    s_add_u32 s14, s96, 155648
    v_and_b32 v6, 3, v1
    v_lshl_add_u32 v6, v6, 3, s14
    v_lshrrev_b32 v9, 5, v1
    v_lshl_add_u32 v6, v9, 2, v6
    s_lshl_b32 s96, s3, 10
    s_add_u32 s14, s96, 147456
    v_and_b32 v5, 15, v1
    v_lshl_add_u32 v5, v5, 4, s14
    v_lshrrev_b32 v9, 5, v1
    v_lshl_add_u32 v5, v9, 9, v5
    v_bfe_u32 v9, v1, 4, 1
    v_lshl_add_u32 v5, v9, 3, v5
    s_lshl_b32 s96, s76, 7
    s_add_u32 s14, s96, 155648
    v_lshrrev_b32 v7, 5, v1
    v_lshl_add_u32 v7, v7, 4, s14
    s_lshl_b32 s96, s76, 12
    s_add_u32 s14, s96, 147456
    v_add_u32 v44, s14, v2
    s_waitcnt vmcnt(1)
    v_pk_add_f32 v[184:185], v[184:185], v[188:189]
    v_pk_add_f32 v[186:187], v[186:187], v[190:191]
    s_nop 1
    v_permlane32_swap_b32 v184, v186
    v_permlane32_swap_b32 v185, v187
    v_pk_add_f32 v[184:185], v[184:185], v[186:187]
    s_nop 1
    v_add_f32_dpp v184, v184, v184 row_ror:8 row_mask:0xf bank_mask:0xf
    v_add_f32_dpp v185, v185, v185 row_ror:8 row_mask:0xf bank_mask:0xf
    v_mov_b32 v186, v184
    v_mov_b32 v187, v185
    s_nop 0
    v_permlane16_swap_b32 v184, v186
    v_permlane16_swap_b32 v185, v187
    v_pk_add_f32 v[184:185], v[184:185], v[186:187]
    v_cvt_pk_bf16_f32 v184, v184, v185
    v_mov_b32 v185, s4
    s_mov_b32 exec_lo, 0xff
    s_mov_b32 exec_hi, 0xff
    buffer_store_dwordx2 v[184:185], v48, s[32:35], s15 offen sc1
    s_mov_b64 exec, -1
    s_barrier
    s_cmp_lg_u32 s3, 0
    s_cbranch_scc1 L_PC2
    v_mov_b32 v45, s4
    s_mov_b32 exec_hi, 0
    s_mov_b32 exec_lo, 65535
    buffer_store_dword v45, v46, s[32:35], s17 offen sc1
    s_mov_b64 exec, -1
L_PC2:
    s_waitcnt vmcnt(1)
    s_xor_b32 s96, s95, 262144
    s_add_u32 s82, s96, s90
    s_add_u32 m0, s83, 16384
    s_nop 0
    buffer_load_dwordx4 v26, s[44:47], s82 offen lds
    v_permlane32_swap_b32 v192, v194
    v_permlane32_swap_b32 v193, v195
    v_pk_add_f32 v[192:193], v[192:193], v[194:195]
    s_nop 1
    v_add_f32_dpp v192, v192, v192 row_ror:4 row_mask:0xf bank_mask:0xf
    s_xor_b32 s96, s95, 393216
L_PAD7:
    s_cbranch_execz L_RET7
    s_add_u32 s82, s96, s90
    s_add_u32 m0, s83, 24576
    s_nop 0
    buffer_load_dwordx4 v26, s[44:47], s82 offen lds
    v_add_f32_dpp v193, v193, v193 row_ror:4 row_mask:0xf bank_mask:0xf
    v_add_f32_dpp v192, v192, v192 row_ror:8 row_mask:0xf bank_mask:0xf
    s_nop 0
    v_add_f32_dpp v193, v193, v193 row_ror:8 row_mask:0xf bank_mask:0xf
    s_xor_b32 s96, s95, 524288
    s_add_u32 s82, s96, s90
    s_add_u32 m0, s83, 32768
    s_nop 0
    buffer_load_dwordx4 v26, s[44:47], s82 offen lds
    v_mov_b32 v194, v192
    v_mov_b32 v195, v193
    s_nop 0
    v_permlane16_swap_b32 v192, v194
    s_xor_b32 s96, s95, 655360
    s_add_u32 s82, s96, s90
    s_add_u32 m0, s83, 40960
    s_nop 0
    buffer_load_dwordx4 v26, s[44:47], s82 offen lds
    v_permlane16_swap_b32 v193, v195
    v_pk_add_f32 v[192:193], v[192:193], v[194:195]
    v_cvt_pk_bf16_f32 v192, v192, v193
    ds_write_b32 v6, v192
    s_waitcnt lgkmcnt(0)
    s_barrier
    ds_read_b128 v[196:199], v7
    ds_read_b128 v[200:203], v7 offset:32
    ds_read_b128 v[204:207], v7 offset:64
    ds_read_b128 v[208:211], v7 offset:96
    s_lshr_b32 s96, s8, 2
    s_lshl1_add_u32 s97, s9, s96
    s_and_b32 s98, s8, 3
    s_lshl2_add_u32 s99, s97, s98
    s_lshl_b32 s96, s99, 9
    s_add_u32 s18, s96, 131072
    s_waitcnt lgkmcnt(0)
    s_lshl3_add_u32 s96, s11, s3
    s_lshl_b32 s97, s96, 11
    s_add_u32 s13, s97, 29360128
    s_load_dwordx2 s[24:25], s[32:33], s92 offset:3584 glc
    v_mfma_f32_32x32x16_bf16 v[136:151], v[196:199], v[152:155], 0
    v_mfma_f32_32x32x16_bf16 v[136:151], v[200:203], v[156:159], v[136:151]
    v_mfma_f32_32x32x16_bf16 v[136:151], v[204:207], v[160:163], v[136:151]
    v_mfma_f32_32x32x16_bf16 v[136:151], v[208:211], v[164:167], v[136:151]
    s_nop 11
    v_cvt_pk_bf16_f32 v136, 0, v136
    v_add_f32 v136, 0x358637bd, v136
    v_cvt_pk_bf16_f32 v136, 0, v136
    v_rcp_f32 v136, v136
    s_branch SCHK_20
SPOLL_19:
    s_load_dwordx2 s[24:25], s[32:33], s92 offset:3584 glc
SCHK_20:
    s_add_u32 s5, s5, 1
    s_cmp_ge_u32 s5, 200000
    s_waitcnt lgkmcnt(0)
    s_cbranch_scc1 SDONE_21
    s_cmp_lg_u32 s24, s4
    s_cbranch_scc1 SPOLL_19
    s_cmp_lg_u32 s25, s4
    s_cbranch_scc1 SPOLL_19
SDONE_21:
    buffer_load_dwordx4 v[228:231], v2, s[32:35], s13 offen sc1
    buffer_load_dwordx4 v[232:235], v2, s[32:35], s13 offen offset:1024 sc1
    s_waitcnt vmcnt(0)
    v_bitop3_b32 v4, v229, v231, s4 bitop3:0x7e
    v_bitop3_b32 v4, v4, v233, s4 bitop3:0xf6
    v_bitop3_b32 v4, v4, v235, s4 bitop3:0xf6
    v_cmp_ne_u32 vcc, 0, v4
    s_cbranch_vccz TOK_23
POLL_24:
    buffer_load_dwordx4 v[228:231], v2, s[32:35], s13 offen sc1
    buffer_load_dwordx4 v[232:235], v2, s[32:35], s13 offen offset:1024 sc1
    s_waitcnt vmcnt(0)
    v_bitop3_b32 v4, v229, v231, s4 bitop3:0x7e
    v_bitop3_b32 v4, v4, v233, s4 bitop3:0xf6
    v_bitop3_b32 v4, v4, v235, s4 bitop3:0xf6
    v_cmp_ne_u32 vcc, 0, v4
    s_cbranch_vccz PDONE_25
    s_add_u32 s5, s5, 1
    s_cmp_lt_u32 s5, 200000
    s_cbranch_scc1 POLL_24
PDONE_25:
TOK_23:
    ds_write2_b32 v5, v228, v230 offset0:0 offset1:1
    ds_write2_b32 v5, v232, v234 offset0:64 offset1:65
    s_waitcnt lgkmcnt(0)
    s_barrier
    ds_read_b128 v[212:215], v44
    ds_read_b128 v[216:219], v44 offset:1024
    ds_read_b128 v[220:223], v44 offset:2048
    ds_read_b128 v[224:227], v44 offset:3072
    s_lshl_b32 s96, s77, 1
    s_lshl3_add_u32 s97, s10, s96
    s_lshl_b32 s98, s97, 5
    s_lshl1_add_u32 s99, s11, s98
    s_add_u32 s96, s99, s76
    s_lshl_b32 s97, s96, 10
    s_add_u32 s13, s97, 8388608
    v_and_b32 v47, 15, v1
    v_lshlrev_b32 v47, 4, v47
    v_bfe_u32 v9, v1, 4, 1
    v_lshl_add_u32 v47, v9, 15, v47
    v_lshrrev_b32 v9, 5, v1
    v_lshl_add_u32 v47, v9, 8, v47
    s_waitcnt lgkmcnt(3)
    v_mfma_f32_32x32x16_bf16 v[120:135], v[212:215], v[152:155], 0
    s_waitcnt lgkmcnt(2)
    v_mfma_f32_32x32x16_bf16 v[120:135], v[216:219], v[156:159], v[120:135]
    s_waitcnt lgkmcnt(1)
    v_mfma_f32_32x32x16_bf16 v[120:135], v[220:223], v[160:163], v[120:135]
    s_waitcnt lgkmcnt(0)
    v_mfma_f32_32x32x16_bf16 v[120:135], v[224:227], v[164:167], v[120:135]
    s_lshr_b32 s96, s3, 1
    s_lshl4_add_u32 s97, s96, s12
    s_lshl_b32 s98, s97, 11
    s_and_b32 s99, s3, 1
    s_lshl_b32 s96, s99, 10
    s_add_u32 s97, s98, s96
    s_add_u32 s18, s97, 131072
    s_lshl_b32 s19, s12, 7
    v_and_b32 v44, 3, v1
    v_lshl_add_u32 v44, v44, 1, s19
    v_lshrrev_b32 v9, 5, v1
    v_lshl_add_u32 v44, v9, 3, v44
    v_bfe_u32 v9, v1, 4, 1
    v_lshl_add_u32 v44, v9, 4, v44
    v_bfe_u32 v9, v1, 2, 2
    v_lshl_add_u32 v44, v9, 5, v44
    global_load_ushort v32, v44, s[78:79]
    buffer_load_dwordx4 v[28:31], v2, s[32:35], s18 offen sc1
    v_cvt_pk_bf16_f32 v120, 0, v120
    v_cvt_pk_bf16_f32 v121, 0, v121
    v_cvt_pk_bf16_f32 v122, 0, v122
    v_cvt_pk_bf16_f32 v123, 0, v123
    v_cvt_pk_bf16_f32 v124, 0, v124
    v_cvt_pk_bf16_f32 v125, 0, v125
    v_cvt_pk_bf16_f32 v126, 0, v126
    v_cvt_pk_bf16_f32 v127, 0, v127
    v_pk_mul_f32 v[120:121], v[120:121], v[136:137] op_sel_hi:[1,0]
    v_pk_mul_f32 v[122:123], v[122:123], v[136:137] op_sel_hi:[1,0]
    v_pk_mul_f32 v[124:125], v[124:125], v[136:137] op_sel_hi:[1,0]
    v_pk_mul_f32 v[126:127], v[126:127], v[136:137] op_sel_hi:[1,0]
    v_cvt_pk_bf16_f32 v168, v120, v121
    v_cvt_pk_bf16_f32 v169, v122, v123
    v_cvt_pk_bf16_f32 v170, v124, v125
    v_cvt_pk_bf16_f32 v171, v126, v127
    buffer_store_dwordx4 v[168:171], v47, s[32:35], s13 offen sc1
    v_cvt_pk_bf16_f32 v128, 0, v128
    v_cvt_pk_bf16_f32 v129, 0, v129
    v_cvt_pk_bf16_f32 v130, 0, v130
    v_cvt_pk_bf16_f32 v131, 0, v131
    v_cvt_pk_bf16_f32 v132, 0, v132
    v_cvt_pk_bf16_f32 v133, 0, v133
    v_cvt_pk_bf16_f32 v134, 0, v134
    v_cvt_pk_bf16_f32 v135, 0, v135
    v_pk_mul_f32 v[128:129], v[128:129], v[136:137] op_sel_hi:[1,0]
    v_pk_mul_f32 v[130:131], v[130:131], v[136:137] op_sel_hi:[1,0]
    v_pk_mul_f32 v[132:133], v[132:133], v[136:137] op_sel_hi:[1,0]
    v_pk_mul_f32 v[134:135], v[134:135], v[136:137] op_sel_hi:[1,0]
    v_cvt_pk_bf16_f32 v172, v128, v129
    v_cvt_pk_bf16_f32 v173, v130, v131
    v_cvt_pk_bf16_f32 v174, v132, v133
    v_cvt_pk_bf16_f32 v175, v134, v135
    buffer_store_dwordx4 v[172:175], v47, s[32:35], s13 offen offset:512 sc1
    v_mov_b32 v50, -1
    v_mov_b32 v51, -1
    v_mov_b32 v52, -1
    v_mov_b32 v53, -1
    s_lshl3_add_u32 s96, s21, s3
    s_lshl4_add_u32 s97, s96, s12
    s_lshl_b32 s98, s97, 8
    s_add_u32 s19, s98, 12582912
    v_lshlrev_b32 v54, 2, v1
    buffer_store_dword v50, v54, s[32:35], s19 offen sc1
    s_lshl_b32 s96, s21, 14
    s_lshl_b32 s97, s12, 9
    s_add_u32 s98, s96, s97
    s_add_u32 s19, s98, 13631488
    v_and_b32 v54, 31, v1
    v_lshlrev_b32 v54, 4, v54
    v_lshrrev_b32 v55, 5, v1
    v_lshl_add_u32 v54, v55, 13, v54
    s_cmp_lg_u32 s3, 5
    s_cbranch_scc1 L_NOPO
    buffer_store_dwordx4 v[50:53], v54, s[32:35], s19 offen sc1
L_NOPO:
    v_bfe_u32 v36, v1, 2, 2
    v_lshlrev_b32 v36, 7, v36
    v_lshrrev_b32 v9, 4, v1
    v_lshl_add_u32 v36, v9, 10, v36
    v_and_b32 v9, 1, v1
    v_lshl_add_u32 v36, v9, 4, v36
    v_bfe_u32 v9, v1, 1, 1
    v_lshl_add_u32 v36, v9, 3, v36
    v_bfe_u32 v9, v1, 3, 2
    v_lshl_add_u32 v36, v9, 5, v36
    s_and_b32 s96, s9, 1
    s_lshl_b32 s97, s96, 2
    s_xor_b32 s98, s3, s97
    s_lshl_b32 s17, s98, 12
    s_lshl_b32 s96, s17, 2
    s_lshr_b32 s97, s95, 4
    s_xor_b32 s14, s96, s97
    v_add_u32 v36, s14, v36
    v_xor_b32 v37, 32, v36
    v_xor_b32 v38, 64, v36
    v_xor_b32 v39, 96, v36
    v_and_b32 v5, 7, v1
    v_lshlrev_b32 v5, 15, v5
    v_bfe_u32 v9, v1, 3, 1
    v_lshl_add_u32 v5, v9, 12, v5
    s_and_b32 s96, s11, 1
    s_lshr_b32 s97, s10, 2
    s_and_b32 s98, s10, 3
    s_lshl_b32 s99, s98, 6
    s_lshl1_add_u32 s98, s97, s99
    s_lshl_b32 s97, s98, 12
    s_lshr_b32 s99, s11, 1
    s_lshl_b32 s98, s99, 6
    s_add_u32 s99, s97, s98
    s_lshl2_add_u32 s97, s96, s99
    s_add_u32 s98, s97, 1048576
    s_add_u32 s15, s98, 1024
    v_lshlrev_b32 v152, 16, v12
    v_and_b32 v153, s6, v12
    v_lshlrev_b32 v154, 16, v13
    v_and_b32 v155, s6, v13
    v_lshlrev_b32 v156, 16, v14
    v_and_b32 v157, s6, v14
    v_lshlrev_b32 v158, 16, v15
    v_and_b32 v159, s6, v15
    v_lshlrev_b32 v160, 16, v16
    v_and_b32 v161, s6, v16
    v_lshlrev_b32 v162, 16, v17
    v_and_b32 v163, s6, v17
    v_lshlrev_b32 v164, 16, v18
    v_and_b32 v165, s6, v18
    v_lshlrev_b32 v166, 16, v19
    v_and_b32 v167, s6, v19
    s_lshl3_add_u32 s96, s21, s3
    s_lshl_b32 s97, s96, 15
    s_add_u32 s19, s97, 8388608
    s_waitcnt vmcnt(3)
    v_bitop3_b32 v4, v29, v31, s4 bitop3:0x7e
    v_cmp_ne_u32 vcc, 0, v4
    s_cbranch_vccz L_MGOK
POLL_26:
    buffer_load_dwordx4 v[28:31], v2, s[32:35], s18 offen sc1
    s_waitcnt vmcnt(0)
    v_bitop3_b32 v4, v29, v31, s4 bitop3:0x7e
    v_cmp_ne_u32 vcc, 0, v4
    s_cbranch_vccz PDONE_27
    s_add_u32 s5, s5, 1
    s_cmp_lt_u32 s5, 200000
    s_cbranch_scc1 POLL_26
PDONE_27:
L_MGOK:
    s_and_b32 s96, s3, 1
    s_lshr_b32 s97, s3, 1
    s_lshl_b32 s98, s97, 10
    s_lshl3_add_u32 s99, s96, s98
    s_add_u32 s14, s99, 159744
    v_and_b32 v4, 31, v1
    v_lshl_add_u32 v4, v4, 5, s14
    v_lshrrev_b32 v9, 5, v1
    v_lshl_add_u32 v4, v9, 2, v4
    ds_write2_b32 v4, v28, v30 offset0:0 offset1:4
    v_and_b32 v7, 3, v1
    v_lshlrev_b32 v7, 4, v7
    v_lshrrev_b32 v9, 5, v1
    v_lshl_add_u32 v7, v9, 6, v7
    v_bfe_u32 v9, v1, 4, 1
    v_lshl_add_u32 v7, v9, 7, v7
    v_bfe_u32 v9, v1, 2, 2
    v_lshl_add_u32 v7, v9, 8, v7
    v_add_u32 v7, 159744, v7
    s_lshl_b32 s96, s2, 12
    s_lshr_b32 s97, s17, 6
    s_add_u32 s98, s96, s97
    s_add_u32 s99, s98, 1048576
    s_add_u32 s18, s99, 1024
    s_waitcnt vmcnt(1)
    s_waitcnt lgkmcnt(0)
    s_barrier
    s_cmp_lg_u32 s3, 0
    s_cbranch_scc1 L_PD
    v_mov_b32 v6, s4
    s_mov_b32 exec_hi, 0
    s_mov_b32 exec_lo, 65535
    buffer_store_dword v6, v5, s[32:35], s15 offen sc1
    s_mov_b64 exec, -1
L_PD:
    ds_read_b128 v[192:195], v7
    ds_read_b128 v[196:199], v7 offset:1024
    ds_read_b128 v[200:203], v7 offset:2048
    ds_read_b128 v[204:207], v7 offset:3072
    v_and_b32 v8, 3, v1
    v_lshlrev_b32 v8, 2, v8
    v_lshrrev_b32 v9, 5, v1
    v_lshl_add_u32 v8, v9, 4, v8
    v_bfe_u32 v9, v1, 4, 1
    v_lshl_add_u32 v8, v9, 5, v8
    v_bfe_u32 v9, v1, 2, 2
    v_lshl_add_u32 v8, v9, 6, v8
    v_add_u32 v8, 157184, v8
    s_lshl4_add_u32 s96, s21, s12
    s_lshl_b32 s97, s96, 6
    s_add_u32 s13, s97, 14155776
    s_waitcnt lgkmcnt(0)
    s_load_dwordx2 s[24:25], s[32:33], s18 offset:0 glc
    v_pk_add_f32 v[192:193], v[192:193], v[194:195]
    v_add_f32 v28, v192, v193
    v_pk_add_f32 v[196:197], v[196:197], v[198:199]
    v_add_f32 v29, v196, v197
    v_pk_add_f32 v[200:201], v[200:201], v[202:203]
    v_add_f32 v30, v200, v201
    v_pk_add_f32 v[204:205], v[204:205], v[206:207]
    v_add_f32 v31, v204, v205
    v_cvt_pk_bf16_f32 v28, 0, v28
    v_cvt_pk_bf16_f32 v29, 0, v29
    v_cvt_pk_bf16_f32 v30, 0, v30
    v_cvt_pk_bf16_f32 v31, 0, v31
    v_add_f32 v30, 1.0, v30
    v_lshlrev_b32 v32, 16, v32
    v_cvt_pk_bf16_f32 v30, 0, v30
    ds_write_b32 v8, v31
    v_mul_f32 v192, v30, v32
    v_cvt_pk_bf16_f32 v193, 0, v192
    v_sub_f32 v194, v192, v193
    v_add_f32_dpp v192, v192, v192 quad_perm:[1,0,3,2] row_mask:0xf bank_mask:0xf
    s_nop 1
    v_add_f32_dpp v192, v192, v192 quad_perm:[2,3,0,1] row_mask:0xf bank_mask:0xf
    s_nop 1
    v_add_f32_dpp v192, v192, v192 row_half_mirror row_mask:0xf bank_mask:0xf
    s_nop 1
    v_add_f32_dpp v192, v192, v192 row_ror:8 row_mask:0xf bank_mask:0xf
    v_mov_b32 v199, v192
    s_nop 1
    v_permlane16_swap_b32 v192, v199
    v_add_f32 v192, v192, v199
    v_mov_b32 v199, v192
    s_nop 1
    v_permlane32_swap_b32 v192, v199
    v_add_f32 v192, v192, v199
    v_mov_b32_dpp v196, v193 row_shl:1 row_mask:0xf bank_mask:0xf
    v_mov_b32_dpp v197, v194 row_shl:1 row_mask:0xf bank_mask:0xf
    v_mov_b32_dpp v198, v32 row_shl:1 row_mask:0xf bank_mask:0xf
    v_cvt_pk_bf16_f32 v196, v193, v196
    v_cvt_pk_bf16_f32 v197, v194, v197
    v_cvt_pk_bf16_f32 v198, v32, v198
    v_mov_b32 v193, s4
    v_mov_b32 v194, 0
    s_cmp_lg_u32 s3, 2
    s_cbranch_scc1 L_NOUP
    s_mov_b64 exec, 1
    buffer_store_dwordx2 v[192:193], v194, s[32:35], s13 offen sc1
    s_mov_b64 exec, -1
L_NOUP:
    v_mov_b32 v184, 0x3f803f80
    s_nop 1
    v_mov_b32_dpp v184, v196 row_newbcast:0 row_mask:0xf bank_mask:0x2
    s_nop 1
    v_mov_b32_dpp v184, v197 row_newbcast:0 row_mask:0xf bank_mask:0x4
    s_nop 1
    v_mov_b32_dpp v184, v198 row_newbcast:0 row_mask:0xf bank_mask:0x8
    v_mov_b32 v185, 0x3f803f80
    s_nop 1
    v_mov_b32_dpp v185, v196 row_newbcast:2 row_mask:0xf bank_mask:0x2
    s_nop 1
    v_mov_b32_dpp v185, v197 row_newbcast:2 row_mask:0xf bank_mask:0x4
    s_nop 1
    v_mov_b32_dpp v185, v198 row_newbcast:2 row_mask:0xf bank_mask:0x8
    v_mov_b32 v186, 0x3f803f80
    s_nop 1
    v_mov_b32_dpp v186, v196 row_newbcast:4 row_mask:0xf bank_mask:0x2
    s_nop 1
    v_mov_b32_dpp v186, v197 row_newbcast:4 row_mask:0xf bank_mask:0x4
    s_nop 1
    v_mov_b32_dpp v186, v198 row_newbcast:4 row_mask:0xf bank_mask:0x8
    v_mov_b32 v187, 0x3f803f80
    s_nop 1
    v_mov_b32_dpp v187, v196 row_newbcast:6 row_mask:0xf bank_mask:0x2
    s_nop 1
    v_mov_b32_dpp v187, v197 row_newbcast:6 row_mask:0xf bank_mask:0x4
    s_nop 1
    v_mov_b32_dpp v187, v198 row_newbcast:6 row_mask:0xf bank_mask:0x8
    v_mov_b32 v188, 0x3f803f80
    s_nop 1
    v_mov_b32_dpp v188, v196 row_newbcast:8 row_mask:0xf bank_mask:0x2
    s_nop 1
    v_mov_b32_dpp v188, v197 row_newbcast:8 row_mask:0xf bank_mask:0x4
    s_nop 1
    v_mov_b32_dpp v188, v198 row_newbcast:8 row_mask:0xf bank_mask:0x8
    v_mov_b32 v189, 0x3f803f80
    s_nop 1
    v_mov_b32_dpp v189, v196 row_newbcast:10 row_mask:0xf bank_mask:0x2
    s_nop 1
    v_mov_b32_dpp v189, v197 row_newbcast:10 row_mask:0xf bank_mask:0x4
    s_nop 1
    v_mov_b32_dpp v189, v198 row_newbcast:10 row_mask:0xf bank_mask:0x8
    v_mov_b32 v190, 0x3f803f80
    s_nop 1
    v_mov_b32_dpp v190, v196 row_newbcast:12 row_mask:0xf bank_mask:0x2
    s_nop 1
    v_mov_b32_dpp v190, v197 row_newbcast:12 row_mask:0xf bank_mask:0x4
    s_nop 1
    v_mov_b32_dpp v190, v198 row_newbcast:12 row_mask:0xf bank_mask:0x8
    v_mov_b32 v191, 0x3f803f80
    s_nop 1
    v_mov_b32_dpp v191, v196 row_newbcast:14 row_mask:0xf bank_mask:0x2
    s_nop 1
    v_mov_b32_dpp v191, v197 row_newbcast:14 row_mask:0xf bank_mask:0x4
    s_nop 1
    v_mov_b32_dpp v191, v198 row_newbcast:14 row_mask:0xf bank_mask:0x8
    v_mov_b32 v42, v29
    v_mov_b32 v43, v31
    v_mov_b32_dpp v136, v28 row_newbcast:0 row_mask:0xf bank_mask:0xf
    v_mov_b32_dpp v137, v28 row_newbcast:1 row_mask:0xf bank_mask:0xf
    v_mov_b32_dpp v138, v28 row_newbcast:2 row_mask:0xf bank_mask:0xf
    v_mov_b32_dpp v139, v28 row_newbcast:3 row_mask:0xf bank_mask:0xf
    v_mov_b32_dpp v140, v28 row_newbcast:4 row_mask:0xf bank_mask:0xf
    v_mov_b32_dpp v141, v28 row_newbcast:5 row_mask:0xf bank_mask:0xf
    v_mov_b32_dpp v142, v28 row_newbcast:6 row_mask:0xf bank_mask:0xf
    v_mov_b32_dpp v143, v28 row_newbcast:7 row_mask:0xf bank_mask:0xf
    v_mov_b32_dpp v144, v28 row_newbcast:8 row_mask:0xf bank_mask:0xf
    v_mov_b32_dpp v145, v28 row_newbcast:9 row_mask:0xf bank_mask:0xf
    v_mov_b32_dpp v146, v28 row_newbcast:10 row_mask:0xf bank_mask:0xf
    v_mov_b32_dpp v147, v28 row_newbcast:11 row_mask:0xf bank_mask:0xf
    v_mov_b32_dpp v148, v28 row_newbcast:12 row_mask:0xf bank_mask:0xf
    v_mov_b32_dpp v149, v28 row_newbcast:13 row_mask:0xf bank_mask:0xf
    v_mov_b32_dpp v150, v28 row_newbcast:14 row_mask:0xf bank_mask:0xf
    v_mov_b32_dpp v151, v28 row_newbcast:15 row_mask:0xf bank_mask:0xf
    v_mov_b32_dpp v168, v30 row_newbcast:0 row_mask:0xf bank_mask:0xf
    v_mov_b32_dpp v169, v30 row_newbcast:1 row_mask:0xf bank_mask:0xf
    v_mov_b32_dpp v170, v30 row_newbcast:2 row_mask:0xf bank_mask:0xf
    v_mov_b32_dpp v171, v30 row_newbcast:3 row_mask:0xf bank_mask:0xf
    v_mov_b32_dpp v172, v30 row_newbcast:4 row_mask:0xf bank_mask:0xf
    v_mov_b32_dpp v173, v30 row_newbcast:5 row_mask:0xf bank_mask:0xf
    v_mov_b32_dpp v174, v30 row_newbcast:6 row_mask:0xf bank_mask:0xf
    v_mov_b32_dpp v175, v30 row_newbcast:7 row_mask:0xf bank_mask:0xf
    v_mov_b32_dpp v176, v30 row_newbcast:8 row_mask:0xf bank_mask:0xf
    v_mov_b32_dpp v177, v30 row_newbcast:9 row_mask:0xf bank_mask:0xf
    v_mov_b32_dpp v178, v30 row_newbcast:10 row_mask:0xf bank_mask:0xf
    v_mov_b32_dpp v179, v30 row_newbcast:11 row_mask:0xf bank_mask:0xf
    v_mov_b32_dpp v180, v30 row_newbcast:12 row_mask:0xf bank_mask:0xf
    v_mov_b32_dpp v181, v30 row_newbcast:13 row_mask:0xf bank_mask:0xf
    v_mov_b32_dpp v182, v30 row_newbcast:14 row_mask:0xf bank_mask:0xf
    v_mov_b32_dpp v183, v30 row_newbcast:15 row_mask:0xf bank_mask:0xf
    s_branch SCHK_29
SPOLL_28:
    s_load_dwordx2 s[24:25], s[32:33], s18 offset:0 glc
SCHK_29:
    s_add_u32 s5, s5, 1
    s_cmp_ge_u32 s5, 200000
    s_waitcnt lgkmcnt(0)
    s_cbranch_scc1 SDONE_30
    s_cmp_lg_u32 s24, s4
    s_cbranch_scc1 SPOLL_28
    s_cmp_lg_u32 s25, s4
    s_cbranch_scc1 SPOLL_28
SDONE_30:
    s_add_u32 s20, s17, s19
    buffer_load_dwordx4 v[224:227], v2, s[32:35], s20 offen sc1
    ds_read_b64_tr_b16 v[192:193], v36
    ds_read_b64_tr_b16 v[194:195], v36 offset:512
    ds_read_b64_tr_b16 v[196:197], v37
    ds_read_b64_tr_b16 v[198:199], v37 offset:512
    ds_read_b64_tr_b16 v[200:201], v38
    ds_read_b64_tr_b16 v[202:203], v38 offset:512
    ds_read_b64_tr_b16 v[204:205], v39
    ds_read_b64_tr_b16 v[206:207], v39 offset:512
    ds_read_b64_tr_b16 v[208:209], v36 offset:4096
    ds_read_b64_tr_b16 v[210:211], v36 offset:4608
    ds_read_b64_tr_b16 v[212:213], v37 offset:4096
    ds_read_b64_tr_b16 v[214:215], v37 offset:4608
    ds_read_b64_tr_b16 v[216:217], v38 offset:4096
    ds_read_b64_tr_b16 v[218:219], v38 offset:4608
    buffer_load_dwordx4 v[228:231], v2, s[32:35], s20 offen offset:1024 sc1
    buffer_load_dwordx4 v[232:235], v2, s[32:35], s20 offen offset:2048 sc1
    buffer_load_dwordx4 v[236:239], v2, s[32:35], s20 offen offset:3072 sc1
    s_barrier
    s_xor_b32 s96, s17, 4096
    s_add_u32 s20, s96, s19
    buffer_load_dwordx4 v[240:243], v2, s[32:35], s20 offen sc1
    buffer_load_dwordx4 v[244:247], v2, s[32:35], s20 offen offset:1024 sc1
    buffer_load_dwordx4 v[44:47], v2, s[32:35], s20 offen offset:2048 sc1
    buffer_load_dwordx4 v[48:51], v2, s[32:35], s20 offen offset:3072 sc1
    s_lshl_b32 s96, s21, 10
    s_add_u32 s13, s96, 14155776
    v_and_b32 v10, 15, v1
    v_lshlrev_b32 v10, 6, v10
    s_waitcnt vmcnt(7)
    s_waitcnt lgkmcnt(6)
    v_mfma_f32_16x16x32_bf16 v[120:123], v[192:195], v[224:227], 0
    ds_read_b64_tr_b16 v[220:221], v39 offset:4096
    ds_read_b64_tr_b16 v[222:223], v39 offset:4608
    v_mfma_f32_16x16x32_bf16 v[124:127], v[196:199], v[224:227], 0
    ds_read_b64_tr_b16 v[192:193], v36 offset:8192
    ds_read_b64_tr_b16 v[194:195], v36 offset:8704
    v_mfma_f32_16x16x32_bf16 v[128:131], v[200:203], v[224:227], 0
    ds_read_b64_tr_b16 v[196:197], v37 offset:8192
    ds_read_b64_tr_b16 v[198:199], v37 offset:8704
    v_mfma_f32_16x16x32_bf16 v[132:135], v[204:207], v[224:227], 0
    ds_read_b64_tr_b16 v[200:201], v38 offset:8192
    ds_read_b64_tr_b16 v[202:203], v38 offset:8704
    s_xor_b32 s96, s17, 8192
    s_add_u32 s20, s96, s19
    buffer_load_dwordx4 v[224:227], v2, s[32:35], s20 offen sc1
    s_waitcnt vmcnt(7)
    s_waitcnt lgkmcnt(6)
    v_mfma_f32_16x16x32_bf16 v[120:123], v[208:211], v[228:231], v[120:123]
    ds_read_b64_tr_b16 v[204:205], v39 offset:8192
    ds_read_b64_tr_b16 v[206:207], v39 offset:8704
    v_mfma_f32_16x16x32_bf16 v[124:127], v[212:215], v[228:231], v[124:127]
    ds_read_b64_tr_b16 v[208:209], v36 offset:12288
    ds_read_b64_tr_b16 v[210:211], v36 offset:12800
    v_xor_b32 v36, 16384, v36
    v_mfma_f32_16x16x32_bf16 v[128:131], v[216:219], v[228:231], v[128:131]
    ds_read_b64_tr_b16 v[212:213], v37 offset:12288
    ds_read_b64_tr_b16 v[214:215], v37 offset:12800
    v_xor_b32 v37, 16384, v37
    v_mfma_f32_16x16x32_bf16 v[132:135], v[220:223], v[228:231], v[132:135]
    ds_read_b64_tr_b16 v[216:217], v38 offset:12288
    ds_read_b64_tr_b16 v[218:219], v38 offset:12800
    v_xor_b32 v38, 16384, v38
    buffer_load_dwordx4 v[228:231], v2, s[32:35], s20 offen offset:1024 sc1
    s_waitcnt vmcnt(7)
    s_waitcnt lgkmcnt(6)
    v_mfma_f32_16x16x32_bf16 v[120:123], v[192:195], v[232:235], v[120:123]
    ds_read_b64_tr_b16 v[220:221], v39 offset:12288
    ds_read_b64_tr_b16 v[222:223], v39 offset:12800
    v_xor_b32 v39, 16384, v39
    v_mfma_f32_16x16x32_bf16 v[124:127], v[196:199], v[232:235], v[124:127]
    ds_read_b64_tr_b16 v[192:193], v36
    ds_read_b64_tr_b16 v[194:195], v36 offset:512
    v_mfma_f32_16x16x32_bf16 v[128:131], v[200:203], v[232:235], v[128:131]
    ds_read_b64_tr_b16 v[196:197], v37
    ds_read_b64_tr_b16 v[198:199], v37 offset:512
    v_mfma_f32_16x16x32_bf16 v[132:135], v[204:207], v[232:235], v[132:135]
    ds_read_b64_tr_b16 v[200:201], v38
    ds_read_b64_tr_b16 v[202:203], v38 offset:512
    buffer_load_dwordx4 v[232:235], v2, s[32:35], s20 offen offset:2048 sc1
    s_waitcnt vmcnt(7)
    s_waitcnt lgkmcnt(6)
    v_mfma_f32_16x16x32_bf16 v[120:123], v[208:211], v[236:239], v[120:123]
    ds_read_b64_tr_b16 v[204:205], v39
    ds_read_b64_tr_b16 v[206:207], v39 offset:512
    v_mfma_f32_16x16x32_bf16 v[124:127], v[212:215], v[236:239], v[124:127]
    ds_read_b64_tr_b16 v[208:209], v36 offset:4096
    ds_read_b64_tr_b16 v[210:211], v36 offset:4608
    v_mfma_f32_16x16x32_bf16 v[128:131], v[216:219], v[236:239], v[128:131]
    ds_read_b64_tr_b16 v[212:213], v37 offset:4096
    ds_read_b64_tr_b16 v[214:215], v37 offset:4608
    v_mfma_f32_16x16x32_bf16 v[132:135], v[220:223], v[236:239], v[132:135]
    ds_read_b64_tr_b16 v[216:217], v38 offset:4096
    ds_read_b64_tr_b16 v[218:219], v38 offset:4608
    buffer_load_dwordx4 v[236:239], v2, s[32:35], s20 offen offset:3072 sc1
    s_waitcnt vmcnt(7)
    s_waitcnt lgkmcnt(6)
    v_mfma_f32_16x16x32_bf16 v[120:123], v[192:195], v[240:243], v[120:123]
    ds_read_b64_tr_b16 v[220:221], v39 offset:4096
    ds_read_b64_tr_b16 v[222:223], v39 offset:4608
    v_mfma_f32_16x16x32_bf16 v[124:127], v[196:199], v[240:243], v[124:127]
    ds_read_b64_tr_b16 v[192:193], v36 offset:8192
    ds_read_b64_tr_b16 v[194:195], v36 offset:8704
    v_mfma_f32_16x16x32_bf16 v[128:131], v[200:203], v[240:243], v[128:131]
    ds_read_b64_tr_b16 v[196:197], v37 offset:8192
    ds_read_b64_tr_b16 v[198:199], v37 offset:8704
    v_mfma_f32_16x16x32_bf16 v[132:135], v[204:207], v[240:243], v[132:135]
    ds_read_b64_tr_b16 v[200:201], v38 offset:8192
    ds_read_b64_tr_b16 v[202:203], v38 offset:8704
    s_xor_b32 s96, s17, 12288
    s_add_u32 s20, s96, s19
    buffer_load_dwordx4 v[240:243], v2, s[32:35], s20 offen sc1
    s_waitcnt vmcnt(7)
    s_waitcnt lgkmcnt(6)
    v_mfma_f32_16x16x32_bf16 v[120:123], v[208:211], v[244:247], v[120:123]
    ds_read_b64_tr_b16 v[204:205], v39 offset:8192
    ds_read_b64_tr_b16 v[206:207], v39 offset:8704
    v_mfma_f32_16x16x32_bf16 v[124:127], v[212:215], v[244:247], v[124:127]
    ds_read_b64_tr_b16 v[208:209], v36 offset:12288
    ds_read_b64_tr_b16 v[210:211], v36 offset:12800
    v_xor_b32 v36, 49152, v36
    v_mfma_f32_16x16x32_bf16 v[128:131], v[216:219], v[244:247], v[128:131]
    ds_read_b64_tr_b16 v[212:213], v37 offset:12288
    ds_read_b64_tr_b16 v[214:215], v37 offset:12800
    v_xor_b32 v37, 49152, v37
    v_mfma_f32_16x16x32_bf16 v[132:135], v[220:223], v[244:247], v[132:135]
    ds_read_b64_tr_b16 v[216:217], v38 offset:12288
    ds_read_b64_tr_b16 v[218:219], v38 offset:12800
    v_xor_b32 v38, 49152, v38
    buffer_load_dwordx4 v[244:247], v2, s[32:35], s20 offen offset:1024 sc1
    s_waitcnt vmcnt(7)
    s_waitcnt lgkmcnt(6)
    v_mfma_f32_16x16x32_bf16 v[120:123], v[192:195], v[44:47], v[120:123]
    ds_read_b64_tr_b16 v[220:221], v39 offset:12288
    ds_read_b64_tr_b16 v[222:223], v39 offset:12800
    v_xor_b32 v39, 49152, v39
    v_mfma_f32_16x16x32_bf16 v[124:127], v[196:199], v[44:47], v[124:127]
    ds_read_b64_tr_b16 v[192:193], v36
    ds_read_b64_tr_b16 v[194:195], v36 offset:512
    v_mfma_f32_16x16x32_bf16 v[128:131], v[200:203], v[44:47], v[128:131]
    ds_read_b64_tr_b16 v[196:197], v37
    ds_read_b64_tr_b16 v[198:199], v37 offset:512
    v_mfma_f32_16x16x32_bf16 v[132:135], v[204:207], v[44:47], v[132:135]
    ds_read_b64_tr_b16 v[200:201], v38
    ds_read_b64_tr_b16 v[202:203], v38 offset:512
    buffer_load_dwordx4 v[44:47], v2, s[32:35], s20 offen offset:2048 sc1
    s_waitcnt vmcnt(7)
    s_waitcnt lgkmcnt(6)
    v_mfma_f32_16x16x32_bf16 v[120:123], v[208:211], v[48:51], v[120:123]
    ds_read_b64_tr_b16 v[204:205], v39
    ds_read_b64_tr_b16 v[206:207], v39 offset:512
    v_mfma_f32_16x16x32_bf16 v[124:127], v[212:215], v[48:51], v[124:127]
    ds_read_b64_tr_b16 v[208:209], v36 offset:4096
    ds_read_b64_tr_b16 v[210:211], v36 offset:4608
    v_mfma_f32_16x16x32_bf16 v[128:131], v[216:219], v[48:51], v[128:131]
    ds_read_b64_tr_b16 v[212:213], v37 offset:4096
    ds_read_b64_tr_b16 v[214:215], v37 offset:4608
    v_mfma_f32_16x16x32_bf16 v[132:135], v[220:223], v[48:51], v[132:135]
    ds_read_b64_tr_b16 v[216:217], v38 offset:4096
    ds_read_b64_tr_b16 v[218:219], v38 offset:4608
    buffer_load_dwordx4 v[48:51], v2, s[32:35], s20 offen offset:3072 sc1
    s_waitcnt vmcnt(7)
    s_waitcnt lgkmcnt(6)
    v_mfma_f32_16x16x32_bf16 v[120:123], v[192:195], v[224:227], v[120:123]
    ds_read_b64_tr_b16 v[220:221], v39 offset:4096
    ds_read_b64_tr_b16 v[222:223], v39 offset:4608
    v_mfma_f32_16x16x32_bf16 v[124:127], v[196:199], v[224:227], v[124:127]
    ds_read_b64_tr_b16 v[192:193], v36 offset:8192
    ds_read_b64_tr_b16 v[194:195], v36 offset:8704
    v_mfma_f32_16x16x32_bf16 v[128:131], v[200:203], v[224:227], v[128:131]
    ds_read_b64_tr_b16 v[196:197], v37 offset:8192
    ds_read_b64_tr_b16 v[198:199], v37 offset:8704
    v_mfma_f32_16x16x32_bf16 v[132:135], v[204:207], v[224:227], v[132:135]
    ds_read_b64_tr_b16 v[200:201], v38 offset:8192
    ds_read_b64_tr_b16 v[202:203], v38 offset:8704
    s_xor_b32 s96, s17, 16384
    s_add_u32 s20, s96, s19
    buffer_load_dwordx4 v[224:227], v2, s[32:35], s20 offen sc1
    s_waitcnt vmcnt(7)
    s_waitcnt lgkmcnt(6)
    v_mfma_f32_16x16x32_bf16 v[120:123], v[208:211], v[228:231], v[120:123]
    ds_read_b64_tr_b16 v[204:205], v39 offset:8192
    ds_read_b64_tr_b16 v[206:207], v39 offset:8704
L_PAD8:
    s_cbranch_execz L_RET8
    v_mfma_f32_16x16x32_bf16 v[124:127], v[212:215], v[228:231], v[124:127]
    ds_read_b64_tr_b16 v[208:209], v36 offset:12288
    ds_read_b64_tr_b16 v[210:211], v36 offset:12800
    v_xor_b32 v36, 16384, v36
    v_mfma_f32_16x16x32_bf16 v[128:131], v[216:219], v[228:231], v[128:131]
    ds_read_b64_tr_b16 v[212:213], v37 offset:12288
    ds_read_b64_tr_b16 v[214:215], v37 offset:12800
    v_xor_b32 v37, 16384, v37
    v_mfma_f32_16x16x32_bf16 v[132:135], v[220:223], v[228:231], v[132:135]
    ds_read_b64_tr_b16 v[216:217], v38 offset:12288
    ds_read_b64_tr_b16 v[218:219], v38 offset:12800
    v_xor_b32 v38, 16384, v38
    buffer_load_dwordx4 v[228:231], v2, s[32:35], s20 offen offset:1024 sc1
    s_waitcnt vmcnt(7)
    s_waitcnt lgkmcnt(6)
    v_mfma_f32_16x16x32_bf16 v[120:123], v[192:195], v[232:235], v[120:123]
    ds_read_b64_tr_b16 v[220:221], v39 offset:12288
    ds_read_b64_tr_b16 v[222:223], v39 offset:12800
    v_xor_b32 v39, 16384, v39
    v_mfma_f32_16x16x32_bf16 v[124:127], v[196:199], v[232:235], v[124:127]
    ds_read_b64_tr_b16 v[192:193], v36
    ds_read_b64_tr_b16 v[194:195], v36 offset:512
    v_mfma_f32_16x16x32_bf16 v[128:131], v[200:203], v[232:235], v[128:131]
    ds_read_b64_tr_b16 v[196:197], v37
    ds_read_b64_tr_b16 v[198:199], v37 offset:512
    v_mfma_f32_16x16x32_bf16 v[132:135], v[204:207], v[232:235], v[132:135]
    ds_read_b64_tr_b16 v[200:201], v38
    ds_read_b64_tr_b16 v[202:203], v38 offset:512
    buffer_load_dwordx4 v[232:235], v2, s[32:35], s20 offen offset:2048 sc1
    s_waitcnt vmcnt(7)
    s_waitcnt lgkmcnt(6)
    v_mfma_f32_16x16x32_bf16 v[120:123], v[208:211], v[236:239], v[120:123]
    ds_read_b64_tr_b16 v[204:205], v39
    ds_read_b64_tr_b16 v[206:207], v39 offset:512
    v_mfma_f32_16x16x32_bf16 v[124:127], v[212:215], v[236:239], v[124:127]
    ds_read_b64_tr_b16 v[208:209], v36 offset:4096
    ds_read_b64_tr_b16 v[210:211], v36 offset:4608
    v_mfma_f32_16x16x32_bf16 v[128:131], v[216:219], v[236:239], v[128:131]
    ds_read_b64_tr_b16 v[212:213], v37 offset:4096
    ds_read_b64_tr_b16 v[214:215], v37 offset:4608
    v_mfma_f32_16x16x32_bf16 v[132:135], v[220:223], v[236:239], v[132:135]
    ds_read_b64_tr_b16 v[216:217], v38 offset:4096
    ds_read_b64_tr_b16 v[218:219], v38 offset:4608
    buffer_load_dwordx4 v[236:239], v2, s[32:35], s20 offen offset:3072 sc1
    s_waitcnt vmcnt(7)
    s_waitcnt lgkmcnt(6)
    v_mfma_f32_16x16x32_bf16 v[120:123], v[192:195], v[240:243], v[120:123]
    ds_read_b64_tr_b16 v[220:221], v39 offset:4096
    ds_read_b64_tr_b16 v[222:223], v39 offset:4608
    v_mfma_f32_16x16x32_bf16 v[124:127], v[196:199], v[240:243], v[124:127]
    ds_read_b64_tr_b16 v[192:193], v36 offset:8192
    ds_read_b64_tr_b16 v[194:195], v36 offset:8704
    v_mfma_f32_16x16x32_bf16 v[128:131], v[200:203], v[240:243], v[128:131]
    ds_read_b64_tr_b16 v[196:197], v37 offset:8192
    ds_read_b64_tr_b16 v[198:199], v37 offset:8704
    v_mfma_f32_16x16x32_bf16 v[132:135], v[204:207], v[240:243], v[132:135]
    ds_read_b64_tr_b16 v[200:201], v38 offset:8192
    ds_read_b64_tr_b16 v[202:203], v38 offset:8704
    s_xor_b32 s96, s17, 20480
    s_add_u32 s20, s96, s19
    buffer_load_dwordx4 v[240:243], v2, s[32:35], s20 offen sc1
    s_waitcnt vmcnt(7)
    s_waitcnt lgkmcnt(6)
    v_mfma_f32_16x16x32_bf16 v[120:123], v[208:211], v[244:247], v[120:123]
    ds_read_b64_tr_b16 v[204:205], v39 offset:8192
    ds_read_b64_tr_b16 v[206:207], v39 offset:8704
    v_mfma_f32_16x16x32_bf16 v[124:127], v[212:215], v[244:247], v[124:127]
    ds_read_b64_tr_b16 v[208:209], v36 offset:12288
    ds_read_b64_tr_b16 v[210:211], v36 offset:12800
    v_xor_b32 v36, 114688, v36
    v_mfma_f32_16x16x32_bf16 v[128:131], v[216:219], v[244:247], v[128:131]
    ds_read_b64_tr_b16 v[212:213], v37 offset:12288
    ds_read_b64_tr_b16 v[214:215], v37 offset:12800
    v_xor_b32 v37, 114688, v37
    v_mfma_f32_16x16x32_bf16 v[132:135], v[220:223], v[244:247], v[132:135]
    ds_read_b64_tr_b16 v[216:217], v38 offset:12288
    ds_read_b64_tr_b16 v[218:219], v38 offset:12800
    v_xor_b32 v38, 114688, v38
    buffer_load_dwordx4 v[244:247], v2, s[32:35], s20 offen offset:1024 sc1
    s_waitcnt vmcnt(7)
    s_waitcnt lgkmcnt(6)
    v_mfma_f32_16x16x32_bf16 v[120:123], v[192:195], v[44:47], v[120:123]
    ds_read_b64_tr_b16 v[220:221], v39 offset:12288
    ds_read_b64_tr_b16 v[222:223], v39 offset:12800
    v_xor_b32 v39, 114688, v39
    v_mfma_f32_16x16x32_bf16 v[124:127], v[196:199], v[44:47], v[124:127]
    ds_read_b64_tr_b16 v[192:193], v36
    ds_read_b64_tr_b16 v[194:195], v36 offset:512
    v_mfma_f32_16x16x32_bf16 v[128:131], v[200:203], v[44:47], v[128:131]
    ds_read_b64_tr_b16 v[196:197], v37
    ds_read_b64_tr_b16 v[198:199], v37 offset:512
    v_mfma_f32_16x16x32_bf16 v[132:135], v[204:207], v[44:47], v[132:135]
    ds_read_b64_tr_b16 v[200:201], v38
    ds_read_b64_tr_b16 v[202:203], v38 offset:512
    buffer_load_dwordx4 v[44:47], v2, s[32:35], s20 offen offset:2048 sc1
    s_waitcnt vmcnt(7)
    s_waitcnt lgkmcnt(6)
    v_mfma_f32_16x16x32_bf16 v[120:123], v[208:211], v[48:51], v[120:123]
    ds_read_b64_tr_b16 v[204:205], v39
    ds_read_b64_tr_b16 v[206:207], v39 offset:512
    v_mfma_f32_16x16x32_bf16 v[124:127], v[212:215], v[48:51], v[124:127]
    ds_read_b64_tr_b16 v[208:209], v36 offset:4096
    ds_read_b64_tr_b16 v[210:211], v36 offset:4608
    v_mfma_f32_16x16x32_bf16 v[128:131], v[216:219], v[48:51], v[128:131]
    ds_read_b64_tr_b16 v[212:213], v37 offset:4096
    ds_read_b64_tr_b16 v[214:215], v37 offset:4608
    v_mfma_f32_16x16x32_bf16 v[132:135], v[220:223], v[48:51], v[132:135]
    ds_read_b64_tr_b16 v[216:217], v38 offset:4096
    ds_read_b64_tr_b16 v[218:219], v38 offset:4608
    buffer_load_dwordx4 v[48:51], v2, s[32:35], s20 offen offset:3072 sc1
    s_waitcnt vmcnt(7)
    s_waitcnt lgkmcnt(6)
    v_mfma_f32_16x16x32_bf16 v[120:123], v[192:195], v[224:227], v[120:123]
    ds_read_b64_tr_b16 v[220:221], v39 offset:4096
    ds_read_b64_tr_b16 v[222:223], v39 offset:4608
    v_mfma_f32_16x16x32_bf16 v[124:127], v[196:199], v[224:227], v[124:127]
    ds_read_b64_tr_b16 v[192:193], v36 offset:8192
    ds_read_b64_tr_b16 v[194:195], v36 offset:8704
    v_mfma_f32_16x16x32_bf16 v[128:131], v[200:203], v[224:227], v[128:131]
    ds_read_b64_tr_b16 v[196:197], v37 offset:8192
    ds_read_b64_tr_b16 v[198:199], v37 offset:8704
    v_mfma_f32_16x16x32_bf16 v[132:135], v[204:207], v[224:227], v[132:135]
    ds_read_b64_tr_b16 v[200:201], v38 offset:8192
    ds_read_b64_tr_b16 v[202:203], v38 offset:8704
    s_xor_b32 s96, s17, 24576
    s_add_u32 s20, s96, s19
    buffer_load_dwordx4 v[224:227], v2, s[32:35], s20 offen sc1
    s_waitcnt vmcnt(7)
    s_waitcnt lgkmcnt(6)
    v_mfma_f32_16x16x32_bf16 v[120:123], v[208:211], v[228:231], v[120:123]
    ds_read_b64_tr_b16 v[204:205], v39 offset:8192
    ds_read_b64_tr_b16 v[206:207], v39 offset:8704
    v_mfma_f32_16x16x32_bf16 v[124:127], v[212:215], v[228:231], v[124:127]
    ds_read_b64_tr_b16 v[208:209], v36 offset:12288
    ds_read_b64_tr_b16 v[210:211], v36 offset:12800
    v_xor_b32 v36, 16384, v36
    v_mfma_f32_16x16x32_bf16 v[128:131], v[216:219], v[228:231], v[128:131]
    ds_read_b64_tr_b16 v[212:213], v37 offset:12288
    ds_read_b64_tr_b16 v[214:215], v37 offset:12800
    v_xor_b32 v37, 16384, v37
    v_mfma_f32_16x16x32_bf16 v[132:135], v[220:223], v[228:231], v[132:135]
    ds_read_b64_tr_b16 v[216:217], v38 offset:12288
    ds_read_b64_tr_b16 v[218:219], v38 offset:12800
    v_xor_b32 v38, 16384, v38
    buffer_load_dwordx4 v[228:231], v2, s[32:35], s20 offen offset:1024 sc1
    s_waitcnt vmcnt(7)
    s_waitcnt lgkmcnt(6)
    v_mfma_f32_16x16x32_bf16 v[120:123], v[192:195], v[232:235], v[120:123]
    ds_read_b64_tr_b16 v[220:221], v39 offset:12288
    ds_read_b64_tr_b16 v[222:223], v39 offset:12800
    v_xor_b32 v39, 16384, v39
    v_mfma_f32_16x16x32_bf16 v[124:127], v[196:199], v[232:235], v[124:127]
    ds_read_b64_tr_b16 v[192:193], v36
    ds_read_b64_tr_b16 v[194:195], v36 offset:512
    v_mfma_f32_16x16x32_bf16 v[128:131], v[200:203], v[232:235], v[128:131]
    ds_read_b64_tr_b16 v[196:197], v37
    ds_read_b64_tr_b16 v[198:199], v37 offset:512
    v_mfma_f32_16x16x32_bf16 v[132:135], v[204:207], v[232:235], v[132:135]
    ds_read_b64_tr_b16 v[200:201], v38
    ds_read_b64_tr_b16 v[202:203], v38 offset:512
    buffer_load_dwordx4 v[232:235], v2, s[32:35], s20 offen offset:2048 sc1
    s_waitcnt vmcnt(7)
    s_waitcnt lgkmcnt(6)
    v_mfma_f32_16x16x32_bf16 v[120:123], v[208:211], v[236:239], v[120:123]
    ds_read_b64_tr_b16 v[204:205], v39
    ds_read_b64_tr_b16 v[206:207], v39 offset:512
    v_mfma_f32_16x16x32_bf16 v[124:127], v[212:215], v[236:239], v[124:127]
    ds_read_b64_tr_b16 v[208:209], v36 offset:4096
    ds_read_b64_tr_b16 v[210:211], v36 offset:4608
    v_mfma_f32_16x16x32_bf16 v[128:131], v[216:219], v[236:239], v[128:131]
    ds_read_b64_tr_b16 v[212:213], v37 offset:4096
    ds_read_b64_tr_b16 v[214:215], v37 offset:4608
    v_mfma_f32_16x16x32_bf16 v[132:135], v[220:223], v[236:239], v[132:135]
    ds_read_b64_tr_b16 v[216:217], v38 offset:4096
    ds_read_b64_tr_b16 v[218:219], v38 offset:4608
    buffer_load_dwordx4 v[236:239], v2, s[32:35], s20 offen offset:3072 sc1
    s_waitcnt vmcnt(7)
    s_waitcnt lgkmcnt(6)
    v_mfma_f32_16x16x32_bf16 v[120:123], v[192:195], v[240:243], v[120:123]
    ds_read_b64_tr_b16 v[220:221], v39 offset:4096
    ds_read_b64_tr_b16 v[222:223], v39 offset:4608
    v_mfma_f32_16x16x32_bf16 v[124:127], v[196:199], v[240:243], v[124:127]
    ds_read_b64_tr_b16 v[192:193], v36 offset:8192
    ds_read_b64_tr_b16 v[194:195], v36 offset:8704
    v_mfma_f32_16x16x32_bf16 v[128:131], v[200:203], v[240:243], v[128:131]
    ds_read_b64_tr_b16 v[196:197], v37 offset:8192
    ds_read_b64_tr_b16 v[198:199], v37 offset:8704
    v_mfma_f32_16x16x32_bf16 v[132:135], v[204:207], v[240:243], v[132:135]
    ds_read_b64_tr_b16 v[200:201], v38 offset:8192
    ds_read_b64_tr_b16 v[202:203], v38 offset:8704
    s_xor_b32 s96, s17, 28672
    s_add_u32 s20, s96, s19
    buffer_load_dwordx4 v[240:243], v2, s[32:35], s20 offen sc1
    s_waitcnt vmcnt(7)
    s_waitcnt lgkmcnt(6)
    v_mfma_f32_16x16x32_bf16 v[120:123], v[208:211], v[244:247], v[120:123]
    ds_read_b64_tr_b16 v[204:205], v39 offset:8192
    ds_read_b64_tr_b16 v[206:207], v39 offset:8704
    v_mfma_f32_16x16x32_bf16 v[124:127], v[212:215], v[244:247], v[124:127]
    ds_read_b64_tr_b16 v[208:209], v36 offset:12288
    ds_read_b64_tr_b16 v[210:211], v36 offset:12800
    v_xor_b32 v36, 49152, v36
    v_mfma_f32_16x16x32_bf16 v[128:131], v[216:219], v[244:247], v[128:131]
    ds_read_b64_tr_b16 v[212:213], v37 offset:12288
    ds_read_b64_tr_b16 v[214:215], v37 offset:12800
    v_xor_b32 v37, 49152, v37
    v_mfma_f32_16x16x32_bf16 v[132:135], v[220:223], v[244:247], v[132:135]
    ds_read_b64_tr_b16 v[216:217], v38 offset:12288
    ds_read_b64_tr_b16 v[218:219], v38 offset:12800
    v_xor_b32 v38, 49152, v38
    buffer_load_dwordx4 v[244:247], v2, s[32:35], s20 offen offset:1024 sc1
    s_waitcnt vmcnt(7)
    s_waitcnt lgkmcnt(6)
    v_mfma_f32_16x16x32_bf16 v[120:123], v[192:195], v[44:47], v[120:123]
    ds_read_b64_tr_b16 v[220:221], v39 offset:12288
    ds_read_b64_tr_b16 v[222:223], v39 offset:12800
    v_xor_b32 v39, 49152, v39
    v_mfma_f32_16x16x32_bf16 v[124:127], v[196:199], v[44:47], v[124:127]
    ds_read_b64_tr_b16 v[192:193], v36
    ds_read_b64_tr_b16 v[194:195], v36 offset:512
    v_mfma_f32_16x16x32_bf16 v[128:131], v[200:203], v[44:47], v[128:131]
    ds_read_b64_tr_b16 v[196:197], v37
    ds_read_b64_tr_b16 v[198:199], v37 offset:512
    v_mfma_f32_16x16x32_bf16 v[132:135], v[204:207], v[44:47], v[132:135]
    ds_read_b64_tr_b16 v[200:201], v38
    ds_read_b64_tr_b16 v[202:203], v38 offset:512
    buffer_load_dwordx4 v[44:47], v2, s[32:35], s20 offen offset:2048 sc1
    s_waitcnt vmcnt(7)
    s_waitcnt lgkmcnt(6)
    v_mfma_f32_16x16x32_bf16 v[120:123], v[208:211], v[48:51], v[120:123]
    ds_read_b64_tr_b16 v[204:205], v39
    ds_read_b64_tr_b16 v[206:207], v39 offset:512
    v_mfma_f32_16x16x32_bf16 v[124:127], v[212:215], v[48:51], v[124:127]
    ds_read_b64_tr_b16 v[208:209], v36 offset:4096
    ds_read_b64_tr_b16 v[210:211], v36 offset:4608
    v_mfma_f32_16x16x32_bf16 v[128:131], v[216:219], v[48:51], v[128:131]
    ds_read_b64_tr_b16 v[212:213], v37 offset:4096
    ds_read_b64_tr_b16 v[214:215], v37 offset:4608
    v_mfma_f32_16x16x32_bf16 v[132:135], v[220:223], v[48:51], v[132:135]
    ds_read_b64_tr_b16 v[216:217], v38 offset:4096
    ds_read_b64_tr_b16 v[218:219], v38 offset:4608
    buffer_load_dwordx4 v[48:51], v2, s[32:35], s20 offen offset:3072 sc1
    buffer_load_dwordx2 v[40:41], v10, s[32:35], s13 offen sc1
    s_mov_b32 s82, s80
    buffer_load_dwordx4 v[88:91], v27, s[56:59], s82 offen nt
    s_add_u32 s82, s80, 57344
    buffer_load_dwordx4 v[92:95], v27, s[56:59], s82 offen nt
    s_waitcnt vmcnt(10)
    s_waitcnt lgkmcnt(6)
    v_mfma_f32_16x16x32_bf16 v[120:123], v[192:195], v[224:227], v[120:123]
    ds_read_b64_tr_b16 v[220:221], v39 offset:4096
    ds_read_b64_tr_b16 v[222:223], v39 offset:4608
    v_mfma_f32_16x16x32_bf16 v[124:127], v[196:199], v[224:227], v[124:127]
    ds_read_b64_tr_b16 v[192:193], v36 offset:8192
    ds_read_b64_tr_b16 v[194:195], v36 offset:8704
    v_mfma_f32_16x16x32_bf16 v[128:131], v[200:203], v[224:227], v[128:131]
    ds_read_b64_tr_b16 v[196:197], v37 offset:8192
    ds_read_b64_tr_b16 v[198:199], v37 offset:8704
    v_mfma_f32_16x16x32_bf16 v[132:135], v[204:207], v[224:227], v[132:135]
    ds_read_b64_tr_b16 v[200:201], v38 offset:8192
    ds_read_b64_tr_b16 v[202:203], v38 offset:8704
    s_waitcnt vmcnt(9)
    s_waitcnt lgkmcnt(6)
    v_mfma_f32_16x16x32_bf16 v[120:123], v[208:211], v[228:231], v[120:123]
    ds_read_b64_tr_b16 v[204:205], v39 offset:8192
    ds_read_b64_tr_b16 v[206:207], v39 offset:8704
    v_mfma_f32_16x16x32_bf16 v[124:127], v[212:215], v[228:231], v[124:127]
    ds_read_b64_tr_b16 v[208:209], v36 offset:12288
    ds_read_b64_tr_b16 v[210:211], v36 offset:12800
    v_xor_b32 v36, 16384, v36
    v_mfma_f32_16x16x32_bf16 v[128:131], v[216:219], v[228:231], v[128:131]
    ds_read_b64_tr_b16 v[212:213], v37 offset:12288
    ds_read_b64_tr_b16 v[214:215], v37 offset:12800
    v_xor_b32 v37, 16384, v37
    v_mfma_f32_16x16x32_bf16 v[132:135], v[220:223], v[228:231], v[132:135]
    ds_read_b64_tr_b16 v[216:217], v38 offset:12288
    ds_read_b64_tr_b16 v[218:219], v38 offset:12800
    v_xor_b32 v38, 16384, v38
    s_waitcnt vmcnt(8)
    s_waitcnt lgkmcnt(6)
    v_mfma_f32_16x16x32_bf16 v[120:123], v[192:195], v[232:235], v[120:123]
    ds_read_b64_tr_b16 v[220:221], v39 offset:12288
    ds_read_b64_tr_b16 v[222:223], v39 offset:12800
    v_xor_b32 v39, 16384, v39
    v_mfma_f32_16x16x32_bf16 v[124:127], v[196:199], v[232:235], v[124:127]
    ds_read_b64_tr_b16 v[192:193], v36
    ds_read_b64_tr_b16 v[194:195], v36 offset:512
    v_mfma_f32_16x16x32_bf16 v[128:131], v[200:203], v[232:235], v[128:131]
    ds_read_b64_tr_b16 v[196:197], v37
    ds_read_b64_tr_b16 v[198:199], v37 offset:512
    v_mfma_f32_16x16x32_bf16 v[132:135], v[204:207], v[232:235], v[132:135]
    ds_read_b64_tr_b16 v[200:201], v38
    ds_read_b64_tr_b16 v[202:203], v38 offset:512
    s_waitcnt vmcnt(7)
    s_waitcnt lgkmcnt(6)
    v_mfma_f32_16x16x32_bf16 v[120:123], v[208:211], v[236:239], v[120:123]
    ds_read_b64_tr_b16 v[204:205], v39
    ds_read_b64_tr_b16 v[206:207], v39 offset:512
    v_mfma_f32_16x16x32_bf16 v[124:127], v[212:215], v[236:239], v[124:127]
    ds_read_b64_tr_b16 v[208:209], v36 offset:4096
    ds_read_b64_tr_b16 v[210:211], v36 offset:4608
    v_mfma_f32_16x16x32_bf16 v[128:131], v[216:219], v[236:239], v[128:131]
    ds_read_b64_tr_b16 v[212:213], v37 offset:4096
    ds_read_b64_tr_b16 v[214:215], v37 offset:4608
    v_mfma_f32_16x16x32_bf16 v[132:135], v[220:223], v[236:239], v[132:135]
    ds_read_b64_tr_b16 v[216:217], v38 offset:4096
    ds_read_b64_tr_b16 v[218:219], v38 offset:4608
    s_waitcnt vmcnt(6)
    s_waitcnt lgkmcnt(6)
    v_mfma_f32_16x16x32_bf16 v[120:123], v[192:195], v[240:243], v[120:123]
    ds_read_b64_tr_b16 v[220:221], v39 offset:4096
    ds_read_b64_tr_b16 v[222:223], v39 offset:4608
    v_mfma_f32_16x16x32_bf16 v[124:127], v[196:199], v[240:243], v[124:127]
    ds_read_b64_tr_b16 v[192:193], v36 offset:8192
    ds_read_b64_tr_b16 v[194:195], v36 offset:8704
    v_mfma_f32_16x16x32_bf16 v[128:131], v[200:203], v[240:243], v[128:131]
    ds_read_b64_tr_b16 v[196:197], v37 offset:8192
    ds_read_b64_tr_b16 v[198:199], v37 offset:8704
    v_mfma_f32_16x16x32_bf16 v[132:135], v[204:207], v[240:243], v[132:135]
    ds_read_b64_tr_b16 v[200:201], v38 offset:8192
    ds_read_b64_tr_b16 v[202:203], v38 offset:8704
    s_waitcnt vmcnt(5)
    s_waitcnt lgkmcnt(6)
    v_mfma_f32_16x16x32_bf16 v[120:123], v[208:211], v[244:247], v[120:123]
    ds_read_b64_tr_b16 v[204:205], v39 offset:8192
    ds_read_b64_tr_b16 v[206:207], v39 offset:8704
    v_mfma_f32_16x16x32_bf16 v[124:127], v[212:215], v[244:247], v[124:127]
    ds_read_b64_tr_b16 v[208:209], v36 offset:12288
    ds_read_b64_tr_b16 v[210:211], v36 offset:12800
    v_mfma_f32_16x16x32_bf16 v[128:131], v[216:219], v[244:247], v[128:131]
    ds_read_b64_tr_b16 v[212:213], v37 offset:12288
    ds_read_b64_tr_b16 v[214:215], v37 offset:12800
    v_mfma_f32_16x16x32_bf16 v[132:135], v[220:223], v[244:247], v[132:135]
    ds_read_b64_tr_b16 v[216:217], v38 offset:12288
    ds_read_b64_tr_b16 v[218:219], v38 offset:12800
    s_waitcnt vmcnt(4)
    s_waitcnt lgkmcnt(6)
    v_mfma_f32_16x16x32_bf16 v[120:123], v[192:195], v[44:47], v[120:123]
    ds_read_b64_tr_b16 v[220:221], v39 offset:12288
    ds_read_b64_tr_b16 v[222:223], v39 offset:12800
    v_mfma_f32_16x16x32_bf16 v[124:127], v[196:199], v[44:47], v[124:127]
    v_mfma_f32_16x16x32_bf16 v[128:131], v[200:203], v[44:47], v[128:131]
    v_mfma_f32_16x16x32_bf16 v[132:135], v[204:207], v[44:47], v[132:135]
    s_waitcnt vmcnt(3)
    s_waitcnt lgkmcnt(0)
    v_mfma_f32_16x16x32_bf16 v[120:123], v[208:211], v[48:51], v[120:123]
    v_mfma_f32_16x16x32_bf16 v[124:127], v[212:215], v[48:51], v[124:127]
    v_mfma_f32_16x16x32_bf16 v[128:131], v[216:219], v[48:51], v[128:131]
    v_mfma_f32_16x16x32_bf16 v[132:135], v[220:223], v[48:51], v[132:135]
    s_lshl3_add_u32 s96, s21, s3
    s_lshl4_add_u32 s97, s96, s12
    s_lshl_b32 s98, s97, 8
    s_add_u32 s14, s98, 12582912
    v_and_b32 v28, 15, v1
    v_lshlrev_b32 v28, 4, v28
    v_lshrrev_b32 v9, 4, v1
    v_lshl_add_u32 v28, v9, 2, v28
    v_cvt_pk_bf16_f32 v120, 0, v120
    v_cvt_pk_bf16_f32 v121, 0, v121
    v_cvt_pk_bf16_f32 v122, 0, v122
    v_cvt_pk_bf16_f32 v123, 0, v123
    v_cvt_pk_bf16_f32 v124, 0, v124
    v_cvt_pk_bf16_f32 v125, 0, v125
    v_cvt_pk_bf16_f32 v126, 0, v126
    v_cvt_pk_bf16_f32 v127, 0, v127
    v_pk_mul_f32 v[120:121], v[120:121], v[136:137]
    v_pk_mul_f32 v[122:123], v[122:123], v[138:139]
    v_pk_mul_f32 v[124:125], v[124:125], v[140:141]
    v_pk_mul_f32 v[126:127], v[126:127], v[142:143]
    v_cvt_pk_bf16_f32 v120, 0, v120
    v_cvt_pk_bf16_f32 v121, 0, v121
    v_cvt_pk_bf16_f32 v122, 0, v122
    v_cvt_pk_bf16_f32 v123, 0, v123
    v_cvt_pk_bf16_f32 v124, 0, v124
    v_cvt_pk_bf16_f32 v125, 0, v125
    v_cvt_pk_bf16_f32 v126, 0, v126
    v_cvt_pk_bf16_f32 v127, 0, v127
    v_pk_add_f32 v[120:121], v[120:121], v[152:153]
    v_pk_add_f32 v[122:123], v[122:123], v[154:155]
    v_pk_add_f32 v[124:125], v[124:125], v[156:157]
    v_pk_add_f32 v[126:127], v[126:127], v[158:159]
    v_cvt_pk_bf16_f32 v12, v120, v121
    v_cvt_pk_bf16_f32 v13, v122, v123
    v_cvt_pk_bf16_f32 v14, v124, v125
    v_cvt_pk_bf16_f32 v15, v126, v127
    v_dot2_f32_bf16 v4, v12, v12, 0
    v_dot2_f32_bf16 v5, v13, v13, 0
    v_dot2_f32_bf16 v4, v14, v14, v4
    v_dot2_f32_bf16 v5, v15, v15, v5
    v_mfma_f32_16x16x32_bf16 v[240:243], v[184:187], v[12:15], 0
    v_cvt_pk_bf16_f32 v128, 0, v128
    v_cvt_pk_bf16_f32 v129, 0, v129
    v_cvt_pk_bf16_f32 v130, 0, v130
    v_cvt_pk_bf16_f32 v131, 0, v131
    v_cvt_pk_bf16_f32 v132, 0, v132
    v_cvt_pk_bf16_f32 v133, 0, v133
    v_cvt_pk_bf16_f32 v134, 0, v134
    v_cvt_pk_bf16_f32 v135, 0, v135
    v_pk_mul_f32 v[128:129], v[128:129], v[144:145]
    v_pk_mul_f32 v[130:131], v[130:131], v[146:147]
    v_pk_mul_f32 v[132:133], v[132:133], v[148:149]
    v_pk_mul_f32 v[134:135], v[134:135], v[150:151]
    v_cvt_pk_bf16_f32 v128, 0, v128
    v_cvt_pk_bf16_f32 v129, 0, v129
    v_cvt_pk_bf16_f32 v130, 0, v130
    v_cvt_pk_bf16_f32 v131, 0, v131
    v_cvt_pk_bf16_f32 v132, 0, v132
    v_cvt_pk_bf16_f32 v133, 0, v133
    v_cvt_pk_bf16_f32 v134, 0, v134
    v_cvt_pk_bf16_f32 v135, 0, v135
    v_pk_add_f32 v[128:129], v[128:129], v[160:161]
    v_pk_add_f32 v[130:131], v[130:131], v[162:163]
    v_pk_add_f32 v[132:133], v[132:133], v[164:165]
    v_pk_add_f32 v[134:135], v[134:135], v[166:167]
    v_cvt_pk_bf16_f32 v16, v128, v129
    v_cvt_pk_bf16_f32 v17, v130, v131
    v_cvt_pk_bf16_f32 v18, v132, v133
    v_cvt_pk_bf16_f32 v19, v134, v135
    v_dot2_f32_bf16 v4, v16, v16, v4
    v_dot2_f32_bf16 v5, v17, v17, v5
    v_dot2_f32_bf16 v4, v18, v18, v4
    v_dot2_f32_bf16 v5, v19, v19, v5
    v_mfma_f32_16x16x32_bf16 v[240:243], v[188:191], v[16:19], v[240:243]
    v_and_b32 v7, 7, v1
    v_lshlrev_b32 v7, 15, v7
    v_bfe_u32 v9, v1, 3, 1
    v_lshl_add_u32 v7, v9, 12, v7
    v_add_f32 v4, v4, v5
    v_mov_b32 v5, v4
    s_nop 1
    v_permlane32_swap_b32 v4, v5
    v_add_f32 v4, v4, v5
    v_mov_b32 v5, v4
    s_nop 1
    v_permlane16_swap_b32 v4, v5
    v_add_f32 v4, v4, v5
    s_nop 1
    v_mov_b32_dpp v240, v4 quad_perm:[0,1,2,3] row_mask:0x8 bank_mask:0xf
    buffer_store_dword v240, v28, s[32:35], s14 offen sc1
    s_and_b32 s96, s12, 1
    s_lshr_b32 s97, s21, 2
    s_and_b32 s98, s21, 3
    s_lshl_b32 s99, s98, 6
    s_lshl1_add_u32 s98, s97, s99
    s_lshl_b32 s97, s98, 12
    s_lshr_b32 s99, s12, 1
    s_lshl_b32 s98, s99, 6
    s_add_u32 s99, s97, s98
    s_lshl2_add_u32 s97, s96, s99
    s_add_u32 s98, s97, 1048576
    s_add_u32 s16, s98, 1536
    s_barrier
    s_cmp_lg_u32 s3, 0
    s_cbranch_scc1 L_PE
    v_mov_b32 v6, s4
    s_mov_b32 exec_hi, 0
    s_mov_b32 exec_lo, 65535
    buffer_store_dword v6, v7, s[32:35], s16 offen sc1
    s_mov_b64 exec, -1
L_PE:
    s_add_u32 s82, s80, 114688
    s_lshl2_add_u32 m0, s83, 34816
    s_nop 0
    buffer_load_dwordx4 v27, s[56:59], s82 offen nt lds
    s_add_u32 s82, s80, 172032
    s_lshl2_add_u32 m0, s83, 35840
    s_nop 0
    buffer_load_dwordx4 v27, s[56:59], s82 offen nt lds
    s_lshl_b32 s15, s3, 12
    v_add_u32 v4, s15, v2
    v_add_u32 v7, 65536, v4
    s_waitcnt vmcnt(5)
    v_cmp_ne_u32 vcc, s4, v41
    s_cbranch_vccz L_UPOK
POLL_31:
    buffer_load_dwordx2 v[40:41], v10, s[32:35], s13 offen sc1
    s_waitcnt vmcnt(0)
    v_cmp_ne_u32 vcc, s4, v41
    s_cbranch_vccz PDONE_32
    s_add_u32 s5, s5, 1
    s_cmp_lt_u32 s5, 200000
    s_cbranch_scc1 POLL_31
PDONE_32:
L_UPOK:
    s_lshl3_add_u32 s96, s21, s3
    s_lshl_b32 s97, s96, 12
    s_add_u32 s14, s97, 12582912
    s_load_dwordx2 s[24:25], s[32:33], s92 offset:1536 glc
    v_add_f32_dpp v40, v40, v40 quad_perm:[1,0,3,2] row_mask:0xf bank_mask:0xf
    s_nop 1
    v_add_f32_dpp v40, v40, v40 quad_perm:[2,3,0,1] row_mask:0xf bank_mask:0xf
    s_nop 1
    v_add_f32_dpp v40, v40, v40 row_half_mirror row_mask:0xf bank_mask:0xf
    s_nop 1
    v_add_f32_dpp v40, v40, v40 row_mirror row_mask:0xf bank_mask:0xf
    v_lshlrev_b32 v152, 16, v12
    v_and_b32 v153, s6, v12
    v_lshlrev_b32 v154, 16, v13
    v_and_b32 v155, s6, v13
    v_lshlrev_b32 v156, 16, v14
    v_and_b32 v157, s6, v14
    v_lshlrev_b32 v158, 16, v15
    v_and_b32 v159, s6, v15
    v_lshlrev_b32 v160, 16, v16
    v_and_b32 v161, s6, v16
    v_lshlrev_b32 v162, 16, v17
    v_and_b32 v163, s6, v17
    v_lshlrev_b32 v164, 16, v18
    v_and_b32 v165, s6, v18
    v_lshlrev_b32 v166, 16, v19
    v_and_b32 v167, s6, v19
    s_lshl_b32 s96, s3, 9
    s_lshl1_add_u32 s15, s21, s96
    v_and_b32 v29, 15, v1
    v_lshl_add_u32 v29, v29, 5, s15
    v_xor_b32 v5, 0x4000, v4
    v_xor_b32 v8, 0x4000, v7
    s_waitcnt vmcnt(3)
    ds_write_b128 v4, v[88:91] offset:32768
    ds_write_b128 v4, v[92:95] offset:33792
    s_cmp_lt_u32 s3, 4
    s_cbranch_scc1 L_FW1
    ds_write_b128 v4, v[56:59] offset:0
    ds_write_b128 v5, v[60:63] offset:0
    ds_write_b128 v4, v[64:67] offset:1024
    ds_write_b128 v5, v[68:71] offset:1024
    ds_write_b128 v4, v[72:75] offset:2048
    ds_write_b128 v5, v[76:79] offset:2048
    ds_write_b128 v4, v[80:83] offset:3072
    ds_write_b128 v5, v[84:87] offset:3072
L_FW1:
    s_branch SCHK_34
SPOLL_33:
    s_load_dwordx2 s[24:25], s[32:33], s92 offset:1536 glc
SCHK_34:
    s_add_u32 s5, s5, 1
    s_cmp_ge_u32 s5, 200000
    s_waitcnt lgkmcnt(0)
    s_cbranch_scc1 SDONE_35
    s_cmp_lg_u32 s24, s4
    s_cbranch_scc1 SPOLL_33
    s_cmp_lg_u32 s25, s4
    s_cbranch_scc1 SPOLL_33
SDONE_35:
    s_barrier
    buffer_load_dwordx4 v[192:195], v2, s[32:35], s14 offen sc1
    buffer_load_dwordx4 v[196:199], v2, s[32:35], s14 offen offset:1024 sc1
    buffer_load_dwordx4 v[200:203], v2, s[32:35], s14 offen offset:2048 sc1
    buffer_load_dwordx4 v[204:207], v2, s[32:35], s14 offen offset:3072 sc1
    s_barrier
    s_mov_b32 s82, s81
    s_lshl2_add_u32 m0, s83, 65536
    s_nop 0
    buffer_load_dwordx4 v253, s[60:63], s82 offen nt lds
    s_add_u32 s82, s81, 4096
    s_lshl2_add_u32 m0, s83, 66560
    s_nop 0
    buffer_load_dwordx4 v253, s[60:63], s82 offen nt lds
    s_add_u32 s82, s81, 8192
    s_lshl2_add_u32 m0, s83, 67584
    s_nop 0
    buffer_load_dwordx4 v253, s[60:63], s82 offen nt lds
    s_add_u32 s82, s81, 12288
    s_lshl2_add_u32 m0, s83, 68608
    s_nop 0
    buffer_load_dwordx4 v253, s[60:63], s82 offen nt lds
    v_mov_b32_dpp v88, v42 row_newbcast:0 row_mask:0xf bank_mask:0xf
    v_mov_b32_dpp v89, v42 row_newbcast:1 row_mask:0xf bank_mask:0xf
    v_mov_b32_dpp v90, v42 row_newbcast:2 row_mask:0xf bank_mask:0xf
    v_mov_b32_dpp v91, v42 row_newbcast:3 row_mask:0xf bank_mask:0xf
    v_mov_b32_dpp v92, v42 row_newbcast:4 row_mask:0xf bank_mask:0xf
    v_mov_b32_dpp v93, v42 row_newbcast:5 row_mask:0xf bank_mask:0xf
    v_mov_b32_dpp v94, v42 row_newbcast:6 row_mask:0xf bank_mask:0xf
    v_mov_b32_dpp v95, v42 row_newbcast:7 row_mask:0xf bank_mask:0xf
    v_mov_b32_dpp v96, v42 row_newbcast:8 row_mask:0xf bank_mask:0xf
    v_mov_b32_dpp v97, v42 row_newbcast:9 row_mask:0xf bank_mask:0xf
    v_mov_b32_dpp v98, v42 row_newbcast:10 row_mask:0xf bank_mask:0xf
    v_mov_b32_dpp v99, v42 row_newbcast:11 row_mask:0xf bank_mask:0xf
    v_mov_b32_dpp v100, v42 row_newbcast:12 row_mask:0xf bank_mask:0xf
    v_mov_b32_dpp v101, v42 row_newbcast:13 row_mask:0xf bank_mask:0xf
    v_mov_b32_dpp v102, v42 row_newbcast:14 row_mask:0xf bank_mask:0xf
    v_mov_b32_dpp v103, v42 row_newbcast:15 row_mask:0xf bank_mask:0xf
    v_mov_b32_dpp v104, v43 row_newbcast:0 row_mask:0xf bank_mask:0xf
    v_mov_b32_dpp v105, v43 row_newbcast:1 row_mask:0xf bank_mask:0xf
    v_mov_b32_dpp v106, v43 row_newbcast:2 row_mask:0xf bank_mask:0xf
    v_mov_b32_dpp v107, v43 row_newbcast:3 row_mask:0xf bank_mask:0xf
    v_mov_b32_dpp v108, v43 row_newbcast:4 row_mask:0xf bank_mask:0xf
    v_mov_b32_dpp v109, v43 row_newbcast:5 row_mask:0xf bank_mask:0xf
L_PAD9:
    s_cbranch_execz L_RET9
    v_mov_b32_dpp v110, v43 row_newbcast:6 row_mask:0xf bank_mask:0xf
    v_mov_b32_dpp v111, v43 row_newbcast:7 row_mask:0xf bank_mask:0xf
    v_mov_b32_dpp v112, v43 row_newbcast:8 row_mask:0xf bank_mask:0xf
    v_mov_b32_dpp v113, v43 row_newbcast:9 row_mask:0xf bank_mask:0xf
    v_mov_b32_dpp v114, v43 row_newbcast:10 row_mask:0xf bank_mask:0xf
    v_mov_b32_dpp v115, v43 row_newbcast:11 row_mask:0xf bank_mask:0xf
    v_mov_b32_dpp v116, v43 row_newbcast:12 row_mask:0xf bank_mask:0xf
    v_mov_b32_dpp v117, v43 row_newbcast:13 row_mask:0xf bank_mask:0xf
    v_mov_b32_dpp v118, v43 row_newbcast:14 row_mask:0xf bank_mask:0xf
    v_mov_b32_dpp v119, v43 row_newbcast:15 row_mask:0xf bank_mask:0xf
    s_lshl3_add_u32 s15, s3, 156160
    v_mov_b32 v4, s15
    v_and_b32 v5, 7, v1
    v_lshlrev_b32 v5, 3, v5
    v_add_u32 v5, 156160, v5
    v_and_b32 v6, 3, v1
    v_lshlrev_b32 v6, 18, v6
    v_bfe_u32 v9, v1, 2, 2
    v_lshl_add_u32 v6, v9, 13, v6
    s_and_b32 s96, s21, 1
    s_and_b32 s97, s12, 7
    s_lshr_b32 s98, s12, 3
    s_lshl3_add_u32 s99, s97, s98
    s_lshl_b32 s97, s99, 12
    s_lshr_b32 s98, s21, 1
    s_lshl_b32 s99, s98, 6
    s_add_u32 s98, s97, s99
    s_lshl4_add_u32 s97, s96, s98
    s_add_u32 s99, s97, 1048576
    s_add_u32 s16, s99, 2560
    s_waitcnt vmcnt(4)
    v_pk_add_f32 v[192:193], v[192:193], v[196:197]
    v_pk_add_f32 v[200:201], v[200:201], v[204:205]
    v_pk_add_f32 v[194:195], v[194:195], v[198:199]
    v_pk_add_f32 v[202:203], v[202:203], v[206:207]
    v_pk_add_f32 v[192:193], v[192:193], v[200:201]
    v_pk_add_f32 v[194:195], v[194:195], v[202:203]
    v_add_f32 v193, v193, v194
    v_add_f32 v197, v192, v195
    v_cmp_u_f32 vcc, v193, v197
    s_cbranch_vccz POK_37
PRE_38:
    buffer_load_dwordx4 v[192:195], v2, s[32:35], s14 offen sc1
    buffer_load_dwordx4 v[196:199], v2, s[32:35], s14 offen offset:1024 sc1
    buffer_load_dwordx4 v[200:203], v2, s[32:35], s14 offen offset:2048 sc1
    buffer_load_dwordx4 v[204:207], v2, s[32:35], s14 offen offset:3072 sc1
    s_waitcnt vmcnt(0)
    v_pk_add_f32 v[192:193], v[192:193], v[196:197]
    v_pk_add_f32 v[200:201], v[200:201], v[204:205]
    v_pk_add_f32 v[194:195], v[194:195], v[198:199]
    v_pk_add_f32 v[202:203], v[202:203], v[206:207]
    v_pk_add_f32 v[192:193], v[192:193], v[200:201]
    v_pk_add_f32 v[194:195], v[194:195], v[202:203]
    v_add_f32 v193, v193, v194
    v_add_f32 v197, v192, v195
    v_cmp_u_f32 vcc, v193, v197
    s_cbranch_vccz POK_37
    s_add_u32 s5, s5, 1
    s_cmp_lt_u32 s5, 200000
    s_cbranch_scc1 PRE_38
POK_37:
    v_mov_b32 v196, v195
    s_nop 1
    v_permlane32_swap_b32 v195, v196
    v_permlane32_swap_b32 v192, v193
    v_add_f32 v195, v195, v196
    v_add_f32 v192, v192, v193
    s_nop 1
    v_permlane16_swap_b32 v192, v195
    v_add_f32 v193, v192, v195
    v_add_f32 v195, v192, v195
    s_nop 1
    v_permlane16_swap_b32 v193, v195
    v_mov_b32 v192, v193
    v_mul_f32 v195, 0x3a800000, v195
    s_nop 0
    v_permlane32_swap_b32 v192, v193
    v_mul_f32 v192, 0x3a800000, v192
    v_fma_f32 v31, -v192, v192, v195
    v_cvt_pk_bf16_f32 v30, 0, v192
    v_max_f32 v31, 0, v31
    v_cvt_pk_bf16_f32 v31, 0, v31
    v_fma_f32 v193, -v30, v40, v193
    v_add_f32 v31, 0x3727c5ac, v31
    v_cvt_pk_bf16_f32 v31, 0, v31
    v_sqrt_f32 v31, v31
    s_nop 0
    v_cvt_pk_bf16_f32 v31, 0, v31
    v_rcp_f32 v31, v31
    s_nop 0
    v_mul_f32 v32, v193, v31
    v_ashrrev_i32 v196, 31, v32
    v_or_b32 v196, 0x80000000, v196
    v_xor_b32 v32, v32, v196
    s_mov_b32 s15, 0xfffff000
    v_and_or_b32 v32, v32, s15, v29
    s_nop 1
    v_max_u32_dpp v244, v32, v32 quad_perm:[1,0,3,2] row_mask:0xf bank_mask:0xf
    v_min_u32_dpp v245, v32, v32 quad_perm:[1,0,3,2] row_mask:0xf bank_mask:0xf
    s_nop 0
    v_min_u32_dpp v196, v244, v244 quad_perm:[2,3,0,1] row_mask:0xf bank_mask:0xf
    v_max_u32_dpp v245, v245, v245 quad_perm:[2,3,0,1] row_mask:0xf bank_mask:0xf
    v_max_u32_dpp v244, v244, v244 quad_perm:[2,3,0,1] row_mask:0xf bank_mask:0xf
    v_max_u32 v245, v245, v196
    s_nop 0
    v_min_u32_dpp v196, v244, v244 row_half_mirror row_mask:0xf bank_mask:0xf
    v_max_u32_dpp v245, v245, v245 row_half_mirror row_mask:0xf bank_mask:0xf
    v_max_u32_dpp v244, v244, v244 row_half_mirror row_mask:0xf bank_mask:0xf
    v_max_u32 v245, v245, v196
    s_nop 0
    v_min_u32_dpp v196, v244, v244 row_mirror row_mask:0xf bank_mask:0xf
    v_max_u32_dpp v245, v245, v245 row_mirror row_mask:0xf bank_mask:0xf
    v_max_u32_dpp v244, v244, v244 row_mirror row_mask:0xf bank_mask:0xf
    v_max_u32 v245, v245, v196
    ds_write_b64 v4, v[244:245]
    s_waitcnt lgkmcnt(0)
    s_barrier
    ds_read_b64 v[244:245], v5
    v_pk_add_f32 v[208:209], v[152:153], v[30:31] op_sel_hi:[1,0] neg_lo:[0,1] neg_hi:[0,1]
    v_pk_add_f32 v[210:211], v[154:155], v[30:31] op_sel_hi:[1,0] neg_lo:[0,1] neg_hi:[0,1]
    v_pk_add_f32 v[212:213], v[156:157], v[30:31] op_sel_hi:[1,0] neg_lo:[0,1] neg_hi:[0,1]
    v_pk_add_f32 v[214:215], v[158:159], v[30:31] op_sel_hi:[1,0] neg_lo:[0,1] neg_hi:[0,1]
    v_pk_add_f32 v[216:217], v[160:161], v[30:31] op_sel_hi:[1,0] neg_lo:[0,1] neg_hi:[0,1]
    v_pk_add_f32 v[218:219], v[162:163], v[30:31] op_sel_hi:[1,0] neg_lo:[0,1] neg_hi:[0,1]
    v_pk_add_f32 v[220:221], v[164:165], v[30:31] op_sel_hi:[1,0] neg_lo:[0,1] neg_hi:[0,1]
    v_pk_add_f32 v[222:223], v[166:167], v[30:31] op_sel_hi:[1,0] neg_lo:[0,1] neg_hi:[0,1]
    s_waitcnt lgkmcnt(0)
    v_min_u32_dpp v196, v244, v244 quad_perm:[1,0,3,2] row_mask:0xf bank_mask:0xf
    v_max_u32_dpp v245, v245, v245 quad_perm:[1,0,3,2] row_mask:0xf bank_mask:0xf
    v_max_u32_dpp v244, v244, v244 quad_perm:[1,0,3,2] row_mask:0xf bank_mask:0xf
    v_max_u32 v245, v245, v196
    s_nop 0
    v_min_u32_dpp v196, v244, v244 quad_perm:[2,3,0,1] row_mask:0xf bank_mask:0xf
    v_max_u32_dpp v245, v245, v245 quad_perm:[2,3,0,1] row_mask:0xf bank_mask:0xf
    v_max_u32_dpp v244, v244, v244 quad_perm:[2,3,0,1] row_mask:0xf bank_mask:0xf
    v_max_u32 v245, v245, v196
    s_nop 0
    v_min_u32_dpp v196, v244, v244 row_half_mirror row_mask:0xf bank_mask:0xf
    v_max_u32_dpp v245, v245, v245 row_half_mirror row_mask:0xf bank_mask:0xf
    v_max_u32_dpp v244, v244, v244 row_half_mirror row_mask:0xf bank_mask:0xf
    v_max_u32 v245, v245, v196
    v_cmp_eq_u32 s[88:89], v32, v245
    v_cmp_eq_u32 vcc, v32, v244
    v_or_b32 v246, 1, v245
    v_mov_b32 v245, s4
    v_mov_b32 v247, s4
    s_or_b64 s[84:85], vcc, s[88:89]
    s_cmp_lg_u32 s3, 0
    s_cbranch_scc1 L_NOF
    s_mov_b64 exec, 0xffff
    buffer_store_dwordx4 v[244:247], v6, s[32:35], s16 offen sc1
    s_mov_b64 exec, -1
L_NOF:
    s_lshl4_add_u32 s13, s3, 156288
    v_mov_b32 v4, s13
    v_and_b32 v5, 7, v1
    v_lshlrev_b32 v5, 4, v5
    v_add_u32 v5, 156288, v5
    s_load_dwordx8 s[24:31], s[32:33], s92 offset:2560 glc
    v_cvt_pk_bf16_f32 v208, 0, v208
    v_cvt_pk_bf16_f32 v209, 0, v209
    v_cvt_pk_bf16_f32 v210, 0, v210
    v_cvt_pk_bf16_f32 v211, 0, v211
    v_cvt_pk_bf16_f32 v212, 0, v212
    v_cvt_pk_bf16_f32 v213, 0, v213
    v_cvt_pk_bf16_f32 v214, 0, v214
    v_cvt_pk_bf16_f32 v215, 0, v215
    v_cvt_pk_bf16_f32 v216, 0, v216
    v_cvt_pk_bf16_f32 v217, 0, v217
    v_cvt_pk_bf16_f32 v218, 0, v218
    v_cvt_pk_bf16_f32 v219, 0, v219
    v_cvt_pk_bf16_f32 v220, 0, v220
    v_cvt_pk_bf16_f32 v221, 0, v221
    v_cvt_pk_bf16_f32 v222, 0, v222
    v_cvt_pk_bf16_f32 v223, 0, v223
    v_pk_mul_f32 v[208:209], v[208:209], v[30:31] op_sel:[0,1]
    v_pk_mul_f32 v[210:211], v[210:211], v[30:31] op_sel:[0,1]
    v_pk_mul_f32 v[212:213], v[212:213], v[30:31] op_sel:[0,1]
    v_pk_mul_f32 v[214:215], v[214:215], v[30:31] op_sel:[0,1]
    v_pk_mul_f32 v[216:217], v[216:217], v[30:31] op_sel:[0,1]
    v_pk_mul_f32 v[218:219], v[218:219], v[30:31] op_sel:[0,1]
    v_pk_mul_f32 v[220:221], v[220:221], v[30:31] op_sel:[0,1]
    v_pk_mul_f32 v[222:223], v[222:223], v[30:31] op_sel:[0,1]
    v_cvt_pk_bf16_f32 v208, 0, v208
    v_cvt_pk_bf16_f32 v209, 0, v209
    v_cvt_pk_bf16_f32 v210, 0, v210
    v_cvt_pk_bf16_f32 v211, 0, v211
    v_cvt_pk_bf16_f32 v212, 0, v212
    v_cvt_pk_bf16_f32 v213, 0, v213
    v_cvt_pk_bf16_f32 v214, 0, v214
    v_cvt_pk_bf16_f32 v215, 0, v215
    v_cvt_pk_bf16_f32 v216, 0, v216
    v_cvt_pk_bf16_f32 v217, 0, v217
    v_cvt_pk_bf16_f32 v218, 0, v218
    v_cvt_pk_bf16_f32 v219, 0, v219
    v_cvt_pk_bf16_f32 v220, 0, v220
    v_cvt_pk_bf16_f32 v221, 0, v221
    v_cvt_pk_bf16_f32 v222, 0, v222
    v_cvt_pk_bf16_f32 v223, 0, v223
    v_pk_mul_f32 v[208:209], v[208:209], v[168:169]
    v_pk_mul_f32 v[210:211], v[210:211], v[170:171]
    v_pk_mul_f32 v[212:213], v[212:213], v[172:173]
    v_pk_mul_f32 v[214:215], v[214:215], v[174:175]
    v_pk_mul_f32 v[216:217], v[216:217], v[176:177]
    v_pk_mul_f32 v[218:219], v[218:219], v[178:179]
    v_pk_mul_f32 v[220:221], v[220:221], v[180:181]
    v_pk_mul_f32 v[222:223], v[222:223], v[182:183]
    v_cvt_pk_bf16_f32 v208, 0, v208
    v_cvt_pk_bf16_f32 v209, 0, v209
    v_cvt_pk_bf16_f32 v210, 0, v210
    v_cvt_pk_bf16_f32 v211, 0, v211
    v_cvt_pk_bf16_f32 v212, 0, v212
    v_cvt_pk_bf16_f32 v213, 0, v213
    v_cvt_pk_bf16_f32 v214, 0, v214
    v_cvt_pk_bf16_f32 v215, 0, v215
    v_cvt_pk_bf16_f32 v216, 0, v216
    v_cvt_pk_bf16_f32 v217, 0, v217
    v_cvt_pk_bf16_f32 v218, 0, v218
    v_cvt_pk_bf16_f32 v219, 0, v219
    v_cvt_pk_bf16_f32 v220, 0, v220
    v_cvt_pk_bf16_f32 v221, 0, v221
    v_cvt_pk_bf16_f32 v222, 0, v222
    v_cvt_pk_bf16_f32 v223, 0, v223
    v_pk_add_f32 v[208:209], v[208:209], v[88:89]
    v_pk_add_f32 v[210:211], v[210:211], v[90:91]
    v_pk_add_f32 v[212:213], v[212:213], v[92:93]
    v_pk_add_f32 v[214:215], v[214:215], v[94:95]
    v_pk_add_f32 v[216:217], v[216:217], v[96:97]
    v_pk_add_f32 v[218:219], v[218:219], v[98:99]
    v_pk_add_f32 v[220:221], v[220:221], v[100:101]
    v_pk_add_f32 v[222:223], v[222:223], v[102:103]
    v_cvt_pk_bf16_f32 v224, v208, v209
    v_cvt_pk_bf16_f32 v225, v210, v211
    v_cvt_pk_bf16_f32 v226, v212, v213
    v_cvt_pk_bf16_f32 v227, v214, v215
    v_cvt_pk_bf16_f32 v228, v216, v217
    v_cvt_pk_bf16_f32 v229, v218, v219
    v_cvt_pk_bf16_f32 v230, v220, v221
    v_cvt_pk_bf16_f32 v231, v222, v223
    s_cmp_eq_u64 s[84:85], 0
    s_cbranch_scc1 L_NOCAND
    v_mfma_f32_16x16x32_bf16 v[240:243], v[184:187], v[224:227], 0
    v_mfma_f32_16x16x32_bf16 v[240:243], v[188:191], v[228:231], v[240:243]
    v_mov_b32 v232, v224
    v_mov_b32 v233, v225
    v_mov_b32 v234, v226
    v_mov_b32 v235, v227
    v_mov_b32 v236, v228
    v_mov_b32 v237, v229
    v_mov_b32 v238, v230
    v_mov_b32 v239, v231
    s_lshl_b32 s96, s21, 14
    s_lshl_b32 s97, s12, 9
    s_add_u32 s98, s96, s97
    s_add_u32 s15, s98, 13631488
    v_lshrrev_b32 v7, 4, v1
    v_lshlrev_b32 v7, 4, v7
    v_add_u32 v8, 8192, v7
    v_permlane32_swap_b32 v232, v234
    v_permlane32_swap_b32 v233, v235
    v_permlane32_swap_b32 v236, v238
    v_permlane32_swap_b32 v237, v239
    v_permlane32_swap_b32 v12, v14
    v_permlane32_swap_b32 v13, v15
    v_permlane32_swap_b32 v16, v18
    v_permlane32_swap_b32 v17, v19
    v_cndmask_b32 v7, v7, v8, s[88:89]
    s_mov_b64 exec, s[84:85]
    buffer_store_dwordx4 v[232:235], v7, s[32:35], s15 offen sc1
    buffer_store_dwordx4 v[236:239], v7, s[32:35], s15 offen offset:64 sc1
    s_mov_b32 exec_lo, 0
    s_and_b32 exec_hi, s85, 0xffff0000
    buffer_store_dword v240, v7, s[32:35], s15 offen offset:208 sc1
    s_mov_b64 exec, s[84:85]
    buffer_store_dwordx4 v[12:15], v7, s[32:35], s15 offen offset:128 sc1
    buffer_store_dwordx4 v[16:19], v7, s[32:35], s15 offen offset:192 sc1
    s_mov_b64 exec, -1
L_NOCAND:
    v_lshlrev_b32 v208, 16, v224
    v_and_b32 v209, s6, v224
    v_lshlrev_b32 v210, 16, v225
    v_and_b32 v211, s6, v225
    v_lshlrev_b32 v212, 16, v226
    v_and_b32 v213, s6, v226
    v_lshlrev_b32 v214, 16, v227
    v_and_b32 v215, s6, v227
    v_lshlrev_b32 v216, 16, v228
    v_and_b32 v217, s6, v228
    v_lshlrev_b32 v218, 16, v229
    v_and_b32 v219, s6, v229
    v_lshlrev_b32 v220, 16, v230
    v_and_b32 v221, s6, v230
    v_lshlrev_b32 v222, 16, v231
    v_and_b32 v223, s6, v231
    v_pk_mul_f32 v[208:209], v[208:209], v[104:105]
    v_pk_mul_f32 v[210:211], v[210:211], v[106:107]
    v_pk_mul_f32 v[212:213], v[212:213], v[108:109]
    v_pk_mul_f32 v[214:215], v[214:215], v[110:111]
    v_pk_mul_f32 v[216:217], v[216:217], v[112:113]
    v_pk_mul_f32 v[218:219], v[218:219], v[114:115]
    v_pk_mul_f32 v[220:221], v[220:221], v[116:117]
    v_pk_mul_f32 v[222:223], v[222:223], v[118:119]
    v_cvt_pk_bf16_f32 v208, 0, v208
    v_cvt_pk_bf16_f32 v209, 0, v209
    v_cvt_pk_bf16_f32 v210, 0, v210
    v_cvt_pk_bf16_f32 v211, 0, v211
    v_cvt_pk_bf16_f32 v212, 0, v212
    v_cvt_pk_bf16_f32 v213, 0, v213
    v_cvt_pk_bf16_f32 v214, 0, v214
    v_cvt_pk_bf16_f32 v215, 0, v215
    v_cvt_pk_bf16_f32 v216, 0, v216
    v_cvt_pk_bf16_f32 v217, 0, v217
    v_cvt_pk_bf16_f32 v218, 0, v218
    v_cvt_pk_bf16_f32 v219, 0, v219
    v_cvt_pk_bf16_f32 v220, 0, v220
    v_cvt_pk_bf16_f32 v221, 0, v221
    v_cvt_pk_bf16_f32 v222, 0, v222
    v_cvt_pk_bf16_f32 v223, 0, v223
    s_lshl_b32 s96, s3, 11
    s_add_u32 s13, s96, 98304
    v_lshrrev_b32 v202, 4, v1
    v_lshlrev_b32 v202, 4, v202
    v_and_b32 v203, 7, v1
    v_lshlrev_b32 v203, 4, v203
    v_xor_b32 v202, v202, v203
    v_and_b32 v204, 15, v1
    v_lshl_add_u32 v204, v204, 7, s13
    v_add_u32 v202, v202, v204
    v_xor_b32 v204, 64, v202
    v_lshrrev_b32 v205, 3, v1
    v_lshlrev_b32 v205, 4, v205
    v_xor_b32 v203, v205, v203
    v_lshrrev_b32 v205, 3, v1
    v_lshl_add_u32 v205, v205, 7, s13
    v_add_u32 v203, v203, v205
    s_lshl_b32 s96, s21, 7
    s_sub_u32 s97, 2047, s96
    s_lshl_b32 s98, s3, 4
    s_sub_u32 s13, s97, s98
    v_lshrrev_b32 v43, 3, v1
    v_sub_u32 v42, s13, v43
    v_subrev_u32 v43, 8, v42
    v_lshrrev_b32 v33, 3, v1
    v_lshlrev_b32 v33, 11, v33
    v_and_b32 v9, 7, v1
    v_lshl_add_u32 v33, v9, 4, v33
    s_lshl3_add_u32 s96, s21, s3
    s_lshl_b32 s97, s96, 15
    s_lshl_b32 s98, s12, 7
    s_add_u32 s16, s97, s98
    s_add_u32 s15, s16, 16384
    s_branch SCHK_40
SPOLL_39:
    s_load_dwordx8 s[24:31], s[32:33], s92 offset:2560 glc
SCHK_40:
    s_add_u32 s5, s5, 1
    s_cmp_ge_u32 s5, 200000
    s_waitcnt lgkmcnt(0)
    s_cbranch_scc1 SDONE_41
    s_cmp_lg_u32 s25, s4
    s_cbranch_scc1 SPOLL_39
    s_cmp_lg_u32 s27, s4
    s_cbranch_scc1 SPOLL_39
    s_cmp_lg_u32 s29, s4
    s_cbranch_scc1 SPOLL_39
    s_cmp_lg_u32 s31, s4
    s_cbranch_scc1 SPOLL_39
SDONE_41:
    s_min_u32 s25, s24, s28
    s_min_u32 s27, s26, s28
    s_min_u32 s29, s24, s30
    s_max_u32 s24, s24, s28
    s_max_u32 s26, s26, s30
    s_max_u32 s27, s27, s29
    s_max_u32 s25, s25, s26
    v_mov_b32 v244, s24
    v_mov_b32 v246, s27
    v_mov_b32 v245, s25
    ds_write_b128 v4, v[244:247]
    s_lshr_b32 s96, s3, 2
    s_lshl_b32 s97, s96, 15
    s_and_b32 s98, s3, 3
    s_lshl_b32 s99, s98, 5
    s_add_u32 s13, s97, s99
    v_lshrrev_b32 v34, 4, v1
    v_lshlrev_b32 v34, 13, v34
    v_bfe_u32 v9, v1, 2, 2
    v_lshl_add_u32 v34, v9, 7, v34
    v_bfe_u32 v9, v1, 3, 2
    v_lshl_add_u32 v34, v9, 5, v34
    v_and_b32 v9, 3, v1
    v_lshl_add_u32 v34, v9, 3, v34
    v_xor_b32 v34, s13, v34
    s_lshl_b32 s96, s75, 11
    s_add_u32 s13, s96, 13631488
    v_and_b32 v36, 7, v1
    v_lshl_add_u32 v36, v36, 4, s13
    v_lshrrev_b32 v9, 4, v1
    v_lshl_add_u32 v36, v9, 9, v36
    v_and_b32 v10, 15, v1
    v_lshlrev_b32 v10, 9, v10
    v_add_u32 v10, 13631744, v10
    s_waitcnt vmcnt(0)
    s_waitcnt lgkmcnt(0)
    s_barrier
    ds_read_b128 v[244:247], v5
    v_and_b32 v8, 8, v1
    v_cmp_eq_u32 s[22:23], 0, v8
    v_cmp_gt_u32 s[24:25], 16, v1
    v_cmp_gt_u32 s[26:27], 32, v1
    s_waitcnt lgkmcnt(0)
    v_min_u32_dpp v192, v244, v244 quad_perm:[1,0,3,2] row_mask:0xf bank_mask:0xf
    v_min_u32_dpp v193, v245, v244 quad_perm:[1,0,3,2] row_mask:0xf bank_mask:0xf
    v_min_u32_dpp v194, v244, v245 quad_perm:[1,0,3,2] row_mask:0xf bank_mask:0xf
    v_max_u32_dpp v246, v246, v246 quad_perm:[1,0,3,2] row_mask:0xf bank_mask:0xf
    v_max_u32_dpp v245, v245, v245 quad_perm:[1,0,3,2] row_mask:0xf bank_mask:0xf
    v_max_u32_dpp v244, v244, v244 quad_perm:[1,0,3,2] row_mask:0xf bank_mask:0xf
    v_max3_u32 v246, v246, v193, v194
    v_max_u32 v245, v245, v192
    v_min_u32_dpp v192, v244, v244 quad_perm:[2,3,0,1] row_mask:0xf bank_mask:0xf
    s_nop 0
    v_min_u32_dpp v193, v245, v244 quad_perm:[2,3,0,1] row_mask:0xf bank_mask:0xf
    v_min_u32_dpp v194, v244, v245 quad_perm:[2,3,0,1] row_mask:0xf bank_mask:0xf
    v_max_u32_dpp v246, v246, v246 quad_perm:[2,3,0,1] row_mask:0xf bank_mask:0xf
    v_max_u32_dpp v245, v245, v245 quad_perm:[2,3,0,1] row_mask:0xf bank_mask:0xf
    v_max_u32_dpp v244, v244, v244 quad_perm:[2,3,0,1] row_mask:0xf bank_mask:0xf
    v_max3_u32 v246, v246, v193, v194
    v_max_u32 v245, v245, v192
    v_min_u32_dpp v192, v244, v244 row_half_mirror row_mask:0xf bank_mask:0xf
    s_nop 0
    v_min_u32_dpp v193, v245, v244 row_half_mirror row_mask:0xf bank_mask:0xf
    v_min_u32_dpp v194, v244, v245 row_half_mirror row_mask:0xf bank_mask:0xf
    v_max_u32_dpp v246, v246, v246 row_half_mirror row_mask:0xf bank_mask:0xf
    v_max_u32_dpp v245, v245, v245 row_half_mirror row_mask:0xf bank_mask:0xf
    v_max_u32_dpp v244, v244, v244 row_half_mirror row_mask:0xf bank_mask:0xf
    v_max3_u32 v246, v246, v193, v194
    v_max_u32 v245, v245, v192
    v_cndmask_b32 v192, v245, v244, s[22:23]
    v_cndmask_b32 v201, v246, v245, s[26:27]
    v_and_b32 v193, 31, v246
    v_and_b32 v192, 31, v192
    v_cndmask_b32 v201, v201, v244, s[24:25]
    v_lshl_add_u32 v4, v192, 13, v36
    v_lshl_add_u32 v5, v193, 13, v36
    v_and_b32 v194, 31, v201
    v_lshl_add_u32 v6, v194, 13, v10
    buffer_load_dwordx4 v[192:195], v4, s[32:35], 0 offen sc1
    buffer_load_dwordx4 v[196:199], v5, s[32:35], 0 offen sc1
    buffer_load_dword v200, v6, s[32:35], 0 offen sc1
    s_barrier
    v_readfirstlane_b32 s91, v244
    v_readfirstlane_b32 s94, v245
    v_readfirstlane_b32 s95, v246
    ds_read_b64_tr_b16 v[56:57], v34
    ds_read_b64_tr_b16 v[58:59], v34 offset:512
    ds_read_b64_tr_b16 v[60:61], v34 offset:1024
    ds_read_b64_tr_b16 v[62:63], v34 offset:1536
    ds_read_b64_tr_b16 v[64:65], v34 offset:2048
    ds_read_b64_tr_b16 v[66:67], v34 offset:2560
    ds_read_b64_tr_b16 v[68:69], v34 offset:3072
    ds_read_b64_tr_b16 v[70:71], v34 offset:3584
    ds_read_b64_tr_b16 v[72:73], v34 offset:4096
    ds_read_b64_tr_b16 v[74:75], v34 offset:4608
    ds_read_b64_tr_b16 v[76:77], v34 offset:5120
    ds_read_b64_tr_b16 v[78:79], v34 offset:5632
    ds_read_b64_tr_b16 v[80:81], v34 offset:6144
    ds_read_b64_tr_b16 v[82:83], v34 offset:6656
    ds_read_b64_tr_b16 v[84:85], v34 offset:7168
    ds_read_b64_tr_b16 v[86:87], v34 offset:7680
    s_bfe_u32 s96, s91, 262145
    s_lshl_b32 s97, s96, 7
    s_bfe_u32 s98, s91, 458757
    s_add_u32 s99, s97, s98
    s_xor_b32 s17, s99, 2047
    s_bfe_u32 s96, s94, 262145
    s_lshl_b32 s97, s96, 7
    s_bfe_u32 s98, s94, 458757
    s_add_u32 s99, s97, s98
    s_xor_b32 s18, s99, 2047
    s_bfe_u32 s96, s95, 262145
    s_lshl_b32 s97, s96, 7
    s_bfe_u32 s98, s95, 458757
    s_add_u32 s99, s97, s98
    s_xor_b32 s19, s99, 2047
    s_waitcnt lgkmcnt(0)
    s_lshl_b32 s13, s3, 6
    v_bfe_u32 v35, v1, 2, 1
    v_lshlrev_b32 v35, 9, v35
    v_bfe_u32 v9, v1, 3, 1
    v_lshl_add_u32 v35, v9, 12, v35
    v_lshrrev_b32 v9, 5, v1
    v_lshl_add_u32 v35, v9, 11, v35
    v_bfe_u32 v9, v1, 2, 2
    v_lshl_add_u32 v35, v9, 6, v35
    v_bfe_u32 v9, v1, 4, 1
    v_lshl_add_u32 v35, v9, 5, v35
    v_and_b32 v9, 3, v1
    v_lshl_add_u32 v35, v9, 3, v35
    v_xor_b32 v35, s13, v35
    v_add_u32 v35, 65536, v35
    v_and_b32 v8, 15, v1
    v_lshlrev_b32 v8, 4, v8
    v_lshrrev_b32 v9, 5, v1
    v_lshl_add_u32 v8, v9, 3, v8
    s_lshl_b32 s96, s74, 13
    s_add_u32 s14, s96, 20971520
    s_lshl3_add_u32 s96, s75, s3
    s_lshl_b32 s97, s96, 8
    s_add_u32 s20, s97, s14
    v_bfe_u32 v7, v201, 1, 4
    v_bfe_u32 v201, v201, 5, 7
    v_lshl_or_b32 v201, v7, 7, v201
    v_xor_b32 v201, 0x7ff, v201
    s_waitcnt vmcnt(0)
    v_max3_u32 v7, v192, v196, v200
    v_cmp_eq_u32 vcc, -1, v7
    s_cbranch_vccz POK_43
PRE_44:
    buffer_load_dwordx4 v[192:195], v4, s[32:35], 0 offen sc1
    buffer_load_dwordx4 v[196:199], v5, s[32:35], 0 offen sc1
    buffer_load_dword v200, v6, s[32:35], 0 offen sc1
    s_waitcnt vmcnt(0)
    v_max3_u32 v7, v192, v196, v200
    v_cmp_eq_u32 vcc, -1, v7
    s_cbranch_vccz POK_43
    s_add_u32 s5, s5, 1
    s_cmp_lt_u32 s5, 200000
    s_cbranch_scc1 PRE_44
POK_43:
    v_add_f32_dpp v200, v200, v200 quad_perm:[1,0,3,2] row_mask:0xf bank_mask:0xf
    s_nop 1
    v_add_f32_dpp v200, v200, v200 quad_perm:[2,3,0,1] row_mask:0xf bank_mask:0xf
    s_nop 1
    v_add_f32_dpp v200, v200, v200 row_half_mirror row_mask:0xf bank_mask:0xf
    s_nop 1
    v_add_f32_dpp v200, v200, v200 row_mirror row_mask:0xf bank_mask:0xf
    v_cvt_pk_bf16_f32 v200, 0, v200
    v_ashrrev_i32 v7, 31, v200
    v_or_b32 v7, 0x80000000, v7
    v_xor_b32 v200, v200, v7
    v_lshrrev_b32 v200, 16, v200
    v_lshl_or_b32 v200, v200, 11, v201
    s_nop 0
    v_readlane_b32 s24, v200, 0
    v_readlane_b32 s25, v200, 16
    v_readlane_b32 s26, v200, 32
    s_not_b64 s[28:29], s[22:23]
    s_cmp_lt_u32 s24, s25
    s_cselect_b64 s[28:29], s[22:23], s[28:29]
    s_cselect_b32 s27, s24, s25
    s_cmp_gt_u32 s26, s27
    s_cselect_b64 vcc, s[28:29], 0
    v_cndmask_b32 v192, v192, v196, vcc
    v_cndmask_b32 v193, v193, v197, vcc
    v_cndmask_b32 v194, v194, v198, vcc
    v_cndmask_b32 v195, v195, v199, vcc
    s_bitcmp1_b32 vcc_lo, 0
    s_cselect_b32 s24, s26, s24
    s_cselect_b32 s19, s17, s19
    s_cselect_b32 s17, s95, s91
    s_bitcmp1_b32 vcc_lo, 8
    s_cselect_b32 s25, s26, s25
    s_cselect_b32 s19, s18, s19
    s_cselect_b32 s18, s95, s94
    s_waitcnt lgkmcnt(0)
    v_mfma_f32_16x16x32_bf16 v[136:139], v[192:195], v[56:59], 0
    v_mfma_f32_16x16x32_bf16 v[140:143], v[192:195], v[60:63], 0
    v_mfma_f32_16x16x32_bf16 v[144:147], v[192:195], v[64:67], 0
    v_mfma_f32_16x16x32_bf16 v[148:151], v[192:195], v[68:71], 0
    v_mfma_f32_16x16x32_bf16 v[168:171], v[192:195], v[72:75], 0
    v_mfma_f32_16x16x32_bf16 v[172:175], v[192:195], v[76:79], 0
    v_mfma_f32_16x16x32_bf16 v[176:179], v[192:195], v[80:83], 0
    v_mfma_f32_16x16x32_bf16 v[180:183], v[192:195], v[84:87], 0
    s_nop 1
    v_add_f32 v196, v136, v141
    s_nop 0
    v_add_f32 v197, v146, v151
    s_nop 0
    v_add_f32 v198, v168, v173
    s_nop 0
    v_add_f32 v199, v178, v183
    v_add_f32 v196, v196, v197
    v_add_f32 v198, v198, v199
    v_mov_b32 v197, s4
    s_nop 0
    v_permlane16_swap_b32 v198, v199
    s_cmp_ge_u32 s9, 28
    s_cbranch_scc1 L_NOHP
    v_add_f32 v196, v196, v199
    s_mov_b32 exec_lo, 0xffff
    s_mov_b32 exec_hi, 0xffff
    buffer_store_dwordx2 v[196:197], v8, s[32:35], s20 offen sc1
    s_mov_b64 exec, -1
L_NOHP:
    ds_read_b64_tr_b16 v[120:121], v35
    ds_read_b64_tr_b16 v[122:123], v35 offset:1024
    ds_read_b64_tr_b16 v[124:125], v35 offset:8192
    ds_read_b64_tr_b16 v[126:127], v35 offset:9216
    ds_read_b64_tr_b16 v[128:129], v35 offset:16384
    ds_read_b64_tr_b16 v[130:131], v35 offset:17408
    ds_read_b64_tr_b16 v[132:133], v35 offset:24576
    ds_read_b64_tr_b16 v[134:135], v35 offset:25600
    s_and_b32 s68, s24, 2047
    s_and_b32 s69, s25, 2047
    s_mov_b32 s70, s16
    s_mov_b32 s71, s15
    v_pk_add_f32 v[208:209], v[208:209], v[152:153]
    v_pk_add_f32 v[210:211], v[210:211], v[154:155]
    v_pk_add_f32 v[212:213], v[212:213], v[156:157]
    v_pk_add_f32 v[214:215], v[214:215], v[158:159]
    v_pk_add_f32 v[216:217], v[216:217], v[160:161]
    v_pk_add_f32 v[218:219], v[218:219], v[162:163]
    v_pk_add_f32 v[220:221], v[220:221], v[164:165]
    v_pk_add_f32 v[222:223], v[222:223], v[166:167]
    v_cvt_pk_bf16_f32 v232, v208, v209
    v_cvt_pk_bf16_f32 v233, v210, v211
    v_cvt_pk_bf16_f32 v234, v212, v213
    v_cvt_pk_bf16_f32 v235, v214, v215
    v_cvt_pk_bf16_f32 v236, v216, v217
    v_cvt_pk_bf16_f32 v237, v218, v219
    v_cvt_pk_bf16_f32 v238, v220, v221
    v_cvt_pk_bf16_f32 v239, v222, v223
    v_permlane32_swap_b32 v232, v234
    v_permlane32_swap_b32 v233, v235
    v_permlane32_swap_b32 v236, v238
    v_permlane32_swap_b32 v237, v239
    ds_write_b128 v202, v[232:235]
    ds_write_b128 v204, v[236:239]
    ds_read_b128 v[232:235], v203
    ds_read_b128 v[236:239], v203 offset:1024
    s_waitcnt lgkmcnt(0)
    s_cmp_lg_u32 s93, 7
    s_cbranch_scc1 L_NONON
    v_mov_b32 v6, s4
    v_mov_b32 v7, 0
    s_mov_b64 exec, 1
    buffer_store_dword v6, v7, s[32:35], 0 offen sc1
    s_mov_b64 exec, -1
L_NONON:
    s_cmp_ge_u32 s9, 28
    s_cbranch_scc1 L_FIN2
    s_cmp_lg_u32 s3, 7
    s_cbranch_scc1 L_NOFZ
    s_bitcmp1_b32 s9, 3
    s_cselect_b32 s15, s25, s24
    s_cselect_b32 s17, s18, s17
    s_andn2_b32 s18, 2047, s15
    s_lshr_b32 s96, s8, 1
    s_lshl2_add_u32 s19, s12, s96
    s_lshr_b32 s96, s19, 1
    s_lshr_b32 s97, s9, 3
    s_lshl_b32 s98, s97, 1
    s_lshl2_add_u32 s99, s96, s98
    s_and_b32 s97, s19, 1
    s_add_u32 s96, s99, s97
    s_mul_i32 s98, s96, 7168
    s_add_u32 s20, s98, 22020096
    s_lshl_b32 s96, s18, 11
    s_lshl_b32 s97, s19, 5
    s_add_u32 s82, s96, s97
    v_and_b32 v10, 7, v1
    v_lshlrev_b32 v10, 2, v10
    s_lshr_b32 s96, s8, 1
    s_lshl_b32 s97, s96, 6
    s_add_u32 s13, s97, 157184
    v_and_b32 v5, 7, v1
    v_lshl_add_u32 v5, v5, 3, s13
    ds_read_b64 v[206:207], v5
    s_and_b32 s96, s17, 31
    s_lshl_b32 s97, s96, 13
    s_lshl_b32 s98, s12, 9
    s_add_u32 s99, s97, s98
    s_lshr_b32 s96, s8, 1
    s_lshl_b32 s97, s96, 5
    s_add_u32 s98, s99, s97
    s_add_u32 s91, s98, 13631488
    s_lshr_b32 s13, s15, 11
    s_lshl_b32 s13, s13, 16
    s_ashr_i32 s15, s13, 31
L_PAD10:
    s_cbranch_execz L_RET10
    s_andn2_b32 s15, 0x7fff0000, s15
    s_or_b32 s15, s15, 0x80000000
    s_xor_b32 s13, s13, s15
    v_mov_b32 v204, s13
    v_mul_f32 v204, s7, v204
    v_exp_f32 v204, -v204
    s_nop 0
    v_add_f32 v204, 1.0, v204
    v_rcp_f32 v204, v204
    s_nop 0
    v_cvt_pk_bf16_f32 v204, 0, v204
L_NOFZ:
    s_cmp_ge_u32 s3, 4
    s_cbranch_scc1 L_NOH
    s_lshl_b32 s96, s3, 8
    s_add_u32 s13, s96, s14
    v_lshrrev_b32 v4, 4, v1
    v_lshlrev_b32 v4, 11, v4
    v_and_b32 v9, 15, v1
    v_lshl_add_u32 v4, v9, 4, v4
    s_lshl_b32 s96, s3, 5
    s_add_u32 s15, s96, 156672
    v_lshrrev_b32 v5, 5, v1
    v_lshl_add_u32 v5, v5, 7, s15
    v_bfe_u32 v9, v1, 2, 1
    v_lshl_add_u32 v5, v9, 4, v5
    v_bfe_u32 v9, v1, 1, 1
    v_lshl_add_u32 v5, v9, 3, v5
    v_bfe_u32 v9, v1, 3, 1
    v_lshl_add_u32 v5, v9, 2, v5
    v_and_b32 v9, 1, v1
    v_lshl_add_u32 v5, v9, 1, v5
SPOLL_45:
    s_load_dword s24, s[32:33], s13 offset:1276 glc
    s_load_dword s25, s[32:33], s13 offset:3324 glc
    s_load_dword s26, s[32:33], s13 offset:5372 glc
    s_load_dword s27, s[32:33], s13 offset:7420 glc
SCHK_46:
    s_add_u32 s5, s5, 1
    s_cmp_ge_u32 s5, 200000
    s_waitcnt lgkmcnt(0)
    s_cbranch_scc1 SDONE_47
    s_cmp_lg_u32 s24, s4
    s_cbranch_scc1 SPOLL_45
    s_cmp_lg_u32 s25, s4
    s_cbranch_scc1 SPOLL_45
    s_cmp_lg_u32 s26, s4
    s_cbranch_scc1 SPOLL_45
    s_cmp_lg_u32 s27, s4
    s_cbranch_scc1 SPOLL_45
SDONE_47:
POLL_48:
    buffer_load_dwordx4 v[88:91], v4, s[32:35], s13 offen sc1
    buffer_load_dwordx4 v[92:95], v4, s[32:35], s13 offen offset:1024 sc1
    s_waitcnt vmcnt(0)
    v_bitop3_b32 v6, v89, v91, s4 bitop3:0x7e
    v_bitop3_b32 v6, v6, v93, s4 bitop3:0xf6
    v_bitop3_b32 v6, v6, v95, s4 bitop3:0xf6
    v_cmp_ne_u32 vcc, 0, v6
    s_cbranch_vccz PDONE_49
    s_add_u32 s5, s5, 1
    s_cmp_lt_u32 s5, 200000
    s_cbranch_scc1 POLL_48
PDONE_49:
    v_permlane32_swap_b32 v88, v90
    v_permlane32_swap_b32 v92, v94
    v_add_f32 v88, v88, v90
    v_add_f32 v92, v92, v94
    v_mov_b32 v90, v88
    v_mov_b32 v94, v92
    s_nop 0
    v_permlane16_swap_b32 v88, v90
    v_permlane16_swap_b32 v92, v94
    v_add_f32 v88, v88, v90
    v_add_f32 v92, v92, v94
    v_cvt_pk_bf16_f32 v88, 0, v88
    v_cvt_pk_bf16_f32 v92, 0, v92
    v_mul_f32 v6, s7, v88
    v_exp_f32 v6, -v6
    s_nop 0
    v_add_f32 v6, 1.0, v6
    v_rcp_f32 v6, v6
    s_nop 0
    v_mul_f32 v88, v88, v6
    v_cvt_pk_bf16_f32 v88, 0, v88
    v_mul_f32 v88, v88, v92
    v_cvt_pk_bf16_f32 v88, v88, v88
    ds_write_b16 v5, v88
L_NOH:
    v_bfe_u32 v4, v1, 2, 1
    v_lshlrev_b32 v4, 7, v4
    v_lshrrev_b32 v9, 5, v1
    v_lshl_add_u32 v4, v9, 4, v4
    v_add_u32 v4, 156672, v4
    v_lshrrev_b32 v5, 4, v1
    v_mul_u32_u24 v5, 7168, v5
    v_and_b32 v9, 15, v1
    v_lshl_add_u32 v5, v9, 3, v5
    s_lshl3_add_u32 s96, s75, s3
    s_mul_i32 s97, s96, 28672
    s_lshl_b32 s98, s74, 7
    s_add_u32 s99, s97, s98
    s_add_u32 s13, s99, 22020096
    v_and_b32 v6, 1, v1
    v_lshlrev_b32 v6, 13, v6
    v_bfe_u32 v9, v1, 1, 1
    v_lshl_add_u32 v6, v9, 18, v6
    s_lshr_b32 s96, s9, 2
    s_and_b32 s97, s75, 1
    s_lshr_b32 s98, s3, 1
    s_lshl2_add_u32 s99, s97, s98
    s_and_b32 s97, s3, 1
    s_lshr_b32 s98, s75, 1
    s_lshl2_add_u32 s97, s97, s98
    s_lshl3_add_u32 s98, s99, s97
    s_lshl_b32 s99, s98, 12
    s_lshl_b32 s97, s8, 6
    s_add_u32 s98, s99, s97
    s_lshl2_add_u32 s99, s96, s98
    s_add_u32 s97, s99, 1048576
    s_add_u32 s14, s97, 3072
    s_waitcnt lgkmcnt(0)
    s_barrier
    ds_read_b128 v[88:91], v4
    ds_read_b128 v[92:95], v4 offset:32
    ds_read_b128 v[96:99], v4 offset:64
    ds_read_b128 v[100:103], v4 offset:96
    s_waitcnt lgkmcnt(3)
    v_mfma_f32_32x32x16_bf16 v[208:223], v[88:91], v[120:123], 0
    s_waitcnt lgkmcnt(2)
    v_mfma_f32_32x32x16_bf16 v[208:223], v[92:95], v[124:127], v[208:223]
    s_waitcnt lgkmcnt(1)
    v_mfma_f32_32x32x16_bf16 v[208:223], v[96:99], v[128:131], v[208:223]
    s_waitcnt lgkmcnt(0)
    v_mfma_f32_32x32x16_bf16 v[208:223], v[100:103], v[132:135], v[208:223]
    s_nop 11
    v_mov_b32 v209, s4
    buffer_store_dwordx2 v[208:209], v5, s[32:35], s13 offen sc1
    s_mov_b64 exec, 15
    buffer_store_dword v209, v6, s[32:35], s14 offen sc1
    s_mov_b64 exec, -1
    s_barrier
L_FIN2:
    v_cmp_ne_u32 vcc, s68, v42
    v_cmp_ne_u32 s[22:23], s69, v42
    s_nop 0
    s_and_b64 exec, vcc, s[22:23]
    buffer_store_dwordx4 v[232:235], v33, s[64:67], s70 offen sc1
    s_mov_b64 exec, -1
    v_cmp_ne_u32 vcc, s68, v43
    v_cmp_ne_u32 s[22:23], s69, v43
    s_nop 0
    s_and_b64 exec, vcc, s[22:23]
    buffer_store_dwordx4 v[236:239], v33, s[64:67], s71 offen sc1
    s_mov_b64 exec, -1
    s_cmp_ge_u32 s9, 16
    s_cbranch_scc1 L_FIN
SPOLL_50:
    s_load_dwordx8 s[24:31], s[32:33], s92 offset:3072 glc
SCHK_51:
    s_add_u32 s5, s5, 1
    s_cmp_ge_u32 s5, 200000
    s_waitcnt lgkmcnt(0)
    s_cbranch_scc1 SDONE_52
    s_cmp_lg_u32 s24, s4
    s_cbranch_scc1 SPOLL_50
    s_cmp_lg_u32 s25, s4
    s_cbranch_scc1 SPOLL_50
    s_cmp_lg_u32 s26, s4
    s_cbranch_scc1 SPOLL_50
    s_cmp_lg_u32 s27, s4
    s_cbranch_scc1 SPOLL_50
    s_cmp_lg_u32 s28, s4
    s_cbranch_scc1 SPOLL_50
    s_cmp_lg_u32 s29, s4
    s_cbranch_scc1 SPOLL_50
    s_cmp_lg_u32 s30, s4
    s_cbranch_scc1 SPOLL_50
SDONE_52:
    s_barrier
    s_cmp_lg_u32 s3, 7
    s_cbranch_scc1 L_FIN
    s_add_u32 s13, s20, 4096
    v_mov_b32 v5, s4
    v_not_b32 v6, v5
POLL_53:
    buffer_load_dwordx4 v[88:91], v2, s[32:35], s20 offen sc1
    buffer_load_dwordx4 v[92:95], v2, s[32:35], s20 offen offset:1024 sc1
    buffer_load_dwordx4 v[96:99], v2, s[32:35], s20 offen offset:2048 sc1
    buffer_load_dwordx4 v[100:103], v2, s[32:35], s20 offen offset:3072 sc1
    buffer_load_dwordx4 v[104:107], v2, s[32:35], s13 offen sc1
    buffer_load_dwordx4 v[108:111], v2, s[32:35], s13 offen offset:1024 sc1
    buffer_load_dwordx4 v[112:115], v2, s[32:35], s13 offen offset:2048 sc1
    buffer_load_dword v244, v10, s[32:35], s91 offen sc1
    buffer_load_dword v245, v10, s[32:35], s91 offen offset:128 sc1
    s_waitcnt vmcnt(0)
    v_max_u32 v246, v244, v245
    v_cmp_ne_u32 vcc, -1, v246
    s_nop 1
    v_cndmask_b32 v246, v6, v5, vcc
    v_bitop3_b32 v4, v89, v91, s4 bitop3:0x7e
    v_bitop3_b32 v4, v4, v93, s4 bitop3:0xf6
    v_bitop3_b32 v4, v4, v95, s4 bitop3:0xf6
    v_bitop3_b32 v4, v4, v97, s4 bitop3:0xf6
    v_bitop3_b32 v4, v4, v99, s4 bitop3:0xf6
    v_bitop3_b32 v4, v4, v101, s4 bitop3:0xf6
    v_bitop3_b32 v4, v4, v103, s4 bitop3:0xf6
    v_bitop3_b32 v4, v4, v105, s4 bitop3:0xf6
    v_bitop3_b32 v4, v4, v107, s4 bitop3:0xf6
    v_bitop3_b32 v4, v4, v109, s4 bitop3:0xf6
    v_bitop3_b32 v4, v4, v111, s4 bitop3:0xf6
    v_bitop3_b32 v4, v4, v113, s4 bitop3:0xf6
    v_bitop3_b32 v4, v4, v115, s4 bitop3:0xf6
    v_bitop3_b32 v4, v4, v246, s4 bitop3:0xf6
    v_cmp_ne_u32 vcc, 0, v4
    s_cbranch_vccz PDONE_54
    s_add_u32 s5, s5, 1
    s_cmp_lt_u32 s5, 200000
    s_cbranch_scc1 POLL_53
PDONE_54:
    v_add_f32 v88, v88, v92
    v_add_f32 v90, v90, v94
    v_add_f32 v88, v88, v96
    v_add_f32 v90, v90, v98
    v_add_f32 v88, v88, v100
    v_add_f32 v90, v90, v102
    v_add_f32 v88, v88, v104
    v_add_f32 v90, v90, v106
    v_add_f32 v88, v88, v108
    v_add_f32 v90, v90, v110
    v_add_f32 v88, v88, v112
    v_add_f32 v90, v90, v114
    v_mov_b32 v89, v90
    v_add_f32_dpp v88, v88, v88 row_ror:8 row_mask:0xf bank_mask:0xf
    s_nop 0
    v_add_f32_dpp v89, v89, v89 row_ror:8 row_mask:0xf bank_mask:0xf
    v_mov_b32 v90, v88
    v_mov_b32 v91, v89
    s_nop 0
    v_permlane16_swap_b32 v88, v90
    v_permlane16_swap_b32 v89, v91
    v_pk_add_f32 v[88:89], v[88:89], v[90:91]
    v_mov_b32 v90, v88
    v_mov_b32 v91, v89
    s_nop 0
    v_permlane32_swap_b32 v88, v90
    v_permlane32_swap_b32 v89, v91
    v_pk_add_f32 v[88:89], v[88:89], v[90:91]
    v_cvt_pk_bf16_f32 v88, 0, v88
    v_cvt_pk_bf16_f32 v89, 0, v89
    v_pk_mul_f32 v[88:89], v[88:89], v[204:205] op_sel_hi:[1,0]
    v_lshlrev_b32 v4, 16, v244
    v_and_b32 v5, s6, v244
    v_cvt_pk_bf16_f32 v88, 0, v88
    v_cvt_pk_bf16_f32 v89, 0, v89
    v_pk_add_f32 v[88:89], v[88:89], v[4:5]
    v_cvt_pk_bf16_f32 v88, 0, v88
    v_cvt_pk_bf16_f32 v89, 0, v89
    v_pk_mul_f32 v[88:89], v[88:89], v[206:207]
    v_lshlrev_b32 v4, 16, v245
    v_and_b32 v5, s6, v245
    v_cvt_pk_bf16_f32 v88, 0, v88
    v_cvt_pk_bf16_f32 v89, 0, v89
    v_pk_add_f32 v[88:89], v[88:89], v[4:5]
    v_cvt_pk_bf16_f32 v88, v88, v89
    s_mov_b64 exec, 0xff
    buffer_store_dword v88, v10, s[64:67], s82 offen
    s_mov_b64 exec, -1
L_FIN:
L_END:
    s_endpgm
.p2align 10
.fill 768, 4, 0xbf800000
.section .rodata,"a"
.p2align 6
.amdhsa_kernel adaLN_cond__linear_kernel_hedgehog__moe_arch_mod__prompt_kernel
  .amdhsa_next_free_vgpr 256
  .amdhsa_next_free_sgpr 102
  .amdhsa_accum_offset 256
  .amdhsa_group_segment_fixed_size 0
  .amdhsa_kernarg_size 112
  .amdhsa_user_sgpr_count 2
  .amdhsa_user_sgpr_kernarg_segment_ptr 1
  .amdhsa_system_sgpr_workgroup_id_x 1
  .amdhsa_float_denorm_mode_32 3
  .amdhsa_float_denorm_mode_16_64 3
.end_amdhsa_kernel
```

```asm
; @launch grid=(256,1,1) block=(512,1,1) lds=163840
.amdgcn_target "amdgcn-amd-amdhsa--gfx950"
.text
.globl adaLN_cond__linear_kernel_hedgehog__moe_arch_mod__prompt_kernel
.p2align 12
.type adaLN_cond__linear_kernel_hedgehog__moe_arch_mod__prompt_kernel,@function
adaLN_cond__linear_kernel_hedgehog__moe_arch_mod__prompt_kernel:
    s_load_dwordx16 s[68:83], s[0:1], 0
    s_load_dwordx8 s[84:91], s[0:1], 64
    s_load_dwordx2 s[32:33], s[0:1], 104
    s_cmp_ge_u32 s2, 256
    s_cbranch_scc1 L_END
    v_lshrrev_b32 v4, 6, v0
    v_and_b32 v1, 63, v0
    s_nop 0
    v_readfirstlane_b32 s3, v4
    v_lshlrev_b32 v2, 4, v1
    s_mov_b32 s38, 4194304
    s_mov_b32 s39, 0x20000
    s_mov_b32 s50, 12582912
    s_mov_b32 s51, 0x20000
    s_mov_b32 s34, 268435456
    s_mov_b32 s35, 0x20000
    s_mov_b32 s42, 6291456
    s_mov_b32 s43, 0x20000
    s_mov_b32 s46, 2097152
    s_mov_b32 s47, 0x20000
    s_mov_b32 s54, 7340032
    s_mov_b32 s55, 0x20000
    s_mov_b32 s58, 7340032
    s_mov_b32 s59, 0x20000
    s_mov_b32 s62, 7340032
    s_mov_b32 s63, 0x20000
    s_mov_b32 s66, 4194304
    s_mov_b32 s67, 0x20000
    s_mov_b32 s5, 0
    s_mov_b32 s6, 0xffff0000
    s_mov_b32 s7, 0x3fb8aa3b
    s_and_b32 s8, s2, 7
    s_lshr_b32 s9, s2, 3
    s_lshl_b32 s96, s8, 5
    s_add_u32 s97, s96, s9
    s_lshl3_add_u32 s93, s97, s3
    s_and_b32 s96, s8, 4
    s_lshr_b32 s97, s9, 2
    s_lshl1_add_u32 s10, s96, s97
    s_and_b32 s96, s8, 3
    s_and_b32 s97, s9, 3
    s_xor_b32 s98, s97, 2
    s_lshl2_add_u32 s11, s96, s98
    s_and_b32 s96, s8, 1
    s_and_b32 s97, s9, 7
    s_lshl3_add_u32 s12, s96, s97
    s_lshr_b32 s96, s8, 1
    s_lshr_b32 s97, s9, 3
    s_lshl2_add_u32 s21, s96, s97
    s_lshl_b32 s96, s2, 6
    s_add_u32 s97, s96, s3
    s_lshl_b32 s98, s97, 6
    s_add_u32 s92, s98, 1048576
    s_lshl_b32 s16, s93, 11
    s_lshl3_add_u32 s96, s8, s3
    s_lshl_b32 s15, s96, 5
    s_mul_i32 s96, s15, 6144
    s_xor_b32 s97, s9, 1
    s_lshl_b32 s98, s97, 7
    s_add_u32 s13, s96, s98
    s_add_u32 s14, s13, 98304
    s_lshl3_add_u32 s96, s21, s3
    s_lshl_b32 s97, s96, 15
    s_lshl_b32 s98, s12, 7
    s_add_u32 s18, s97, s98
    s_lshr_b32 s96, s8, 1
    s_lshl4_add_u32 s97, s96, s12
    s_lshl4_add_u32 s98, s97, s3
    s_lshl_b32 s99, s98, 9
    s_add_u32 s17, s99, 524288
    v_lshrrev_b32 v248, 3, v1
    v_mul_u32_u24 v248, 12288, v248
    v_and_b32 v9, 7, v1
    v_lshl_add_u32 v248, v9, 4, v248
    v_lshrrev_b32 v249, 3, v1
    v_lshl_add_u32 v249, v249, 1, s15
    v_and_b32 v10, 15, v1
    v_lshlrev_b32 v10, 11, v10
    v_lshrrev_b32 v9, 4, v1
    v_lshl_add_u32 v10, v9, 4, v10
    s_waitcnt lgkmcnt(0)
    s_mov_b64 s[48:49], s[88:89]
    buffer_load_dwordx4 v[160:163], v248, s[48:51], s13 offen nt
    buffer_load_dwordx4 v[164:167], v248, s[48:51], s14 offen nt
    s_load_dword s4, s[32:33], 0
    global_load_ushort v168, v249, s[86:87]
    global_load_ushort v169, v249, s[86:87] offset:16
    s_mov_b64 s[36:37], s[68:69]
    s_load_dword s24, s[32:33], s92 offset:0 glc
    s_load_dword s25, s[32:33], s17 offset:508 glc
    s_load_dword s26, s[32:33], s17 offset:4604 glc
    s_barrier
    buffer_load_dwordx4 v[152:155], v2, s[36:39], s16 offen
    buffer_load_dwordx4 v[156:159], v2, s[36:39], s16 offen offset:1024
    s_mov_b64 s[40:41], s[70:71]
    s_mov_b64 s[44:45], s[74:75]
    s_mov_b64 s[52:53], s[80:81]
    s_mov_b64 s[56:57], s[82:83]
    s_mov_b64 s[60:61], s[84:85]
    s_mov_b64 s[64:65], s[90:91]
    s_getpc_b64 s[22:23]
    s_and_b32 s22, s22, 0xfffffc00
    s_lshl3_add_u32 s96, s9, s3
    s_lshl_b32 s19, s96, 7
    v_lshrrev_b32 v4, 5, v1
    v_lshl_add_u32 v4, v4, 15, s19
    v_min_u32 v4, 41984, v4
    global_load_dword v11, v4, s[22:23]
    s_lshr_b32 s76, s3, 2
    s_and_b32 s77, s3, 3
    s_lshl_b32 s83, s3, 10
    s_mul_i32 s96, s8, 7
    s_lshr_b32 s97, s9, 2
    s_add_u32 s74, s96, s97
    s_and_b32 s75, s9, 3
    v_bfe_u32 v6, v1, 4, 1
    v_lshlrev_b32 v6, 6, v6
    v_and_b32 v3, 7, v1
    v_lshlrev_b32 v3, 4, v3
    v_xor_b32 v3, v3, v6
    v_lshrrev_b32 v6, 3, v1
    v_mul_u32_u24 v6, 6144, v6
    v_add_u32 v3, v3, v6
    s_and_b32 s84, s9, 12
    s_mul_i32 s96, s3, 49152
    s_lshl_b32 s97, s11, 7
    s_add_u32 s85, s96, s97
    v_lshlrev_b32 v250, 3, v1
    v_lshlrev_b32 v251, 5, v1
    v_add_u32 v251, 147456, v251
    s_lshl2_add_u32 s13, s3, 147456
    v_lshrrev_b32 v252, 4, v1
    v_lshl_add_u32 v252, v252, 6, s13
    v_and_b32 v9, 7, v1
    v_lshl_add_u32 v252, v9, 8, v252
    v_bfe_u32 v9, v1, 3, 1
    v_lshl_add_u32 v252, v9, 5, v252
    buffer_load_dwordx4 v[12:15], v10, s[36:39], s18 offen
    buffer_load_dwordx4 v[16:19], v10, s[36:39], s18 offen offset:64
    s_lshr_b32 s96, s3, 1
    s_xor_b32 s97, s9, 1
    s_and_b32 s98, s97, 15
    s_lshl4_add_u32 s99, s96, s98
    s_lshr_b32 s97, s9, 4
    s_lshl1_add_u32 s96, s99, s97
    s_lshl3_add_u32 s98, s96, s8
    s_lshl_b32 s99, s98, 9
    s_add_u32 s13, s99, 524288
    s_waitcnt vmcnt(5)
    v_lshlrev_b32 v168, 16, v168
    v_mul_f32 v4, s7, v168
    v_exp_f32 v4, -v4
    s_nop 0
    v_add_f32 v4, 1.0, v4
    v_rcp_f32 v4, v4
    s_nop 0
    v_mul_f32 v168, v168, v4
    v_cvt_pk_bf16_f32 v168, 0, v168
    v_lshlrev_b32 v169, 16, v169
    v_mul_f32 v5, s7, v169
    v_exp_f32 v5, -v5
    s_nop 0
    v_add_f32 v5, 1.0, v5
    v_rcp_f32 v5, v5
    s_nop 0
    v_mul_f32 v169, v169, v5
    v_cvt_pk_bf16_f32 v169, 0, v169
    v_lshlrev_b32 v4, 16, v160
    v_and_b32 v5, s6, v160
    v_pk_mul_f32 v[176:177], v[168:169], v[4:5] op_sel:[0,0] op_sel_hi:[0,1]
    v_lshlrev_b32 v6, 16, v161
    v_and_b32 v7, s6, v161
    v_pk_mul_f32 v[178:179], v[168:169], v[6:7] op_sel:[0,0] op_sel_hi:[0,1]
    v_lshlrev_b32 v4, 16, v162
    v_and_b32 v5, s6, v162
    v_pk_mul_f32 v[180:181], v[168:169], v[4:5] op_sel:[0,0] op_sel_hi:[0,1]
    v_lshlrev_b32 v6, 16, v163
    v_and_b32 v7, s6, v163
    v_pk_mul_f32 v[182:183], v[168:169], v[6:7] op_sel:[0,0] op_sel_hi:[0,1]
    v_lshlrev_b32 v4, 16, v164
    v_and_b32 v5, s6, v164
    v_pk_fma_f32 v[176:177], v[168:169], v[4:5], v[176:177] op_sel:[1,0,0] op_sel_hi:[1,1,1]
    v_lshlrev_b32 v6, 16, v165
    v_and_b32 v7, s6, v165
    v_pk_fma_f32 v[178:179], v[168:169], v[6:7], v[178:179] op_sel:[1,0,0] op_sel_hi:[1,1,1]
    v_lshlrev_b32 v4, 16, v166
    v_and_b32 v5, s6, v166
    v_pk_fma_f32 v[180:181], v[168:169], v[4:5], v[180:181] op_sel:[1,0,0] op_sel_hi:[1,1,1]
    v_lshlrev_b32 v6, 16, v167
    v_and_b32 v7, s6, v167
    v_pk_fma_f32 v[182:183], v[168:169], v[6:7], v[182:183] op_sel:[1,0,0] op_sel_hi:[1,1,1]
    v_permlane32_swap_b32 v176, v180
    v_permlane32_swap_b32 v177, v181
    v_permlane32_swap_b32 v178, v182
    v_permlane32_swap_b32 v179, v183
    v_add_f32 v176, v176, v180
    v_add_f32 v177, v177, v181
    v_add_f32 v178, v178, v182
    v_add_f32 v179, v179, v183
    s_nop 0
    v_permlane16_swap_b32 v176, v178
    v_permlane16_swap_b32 v177, v179
    v_add_f32 v176, v176, v178
    v_add_f32 v177, v177, v179
    s_nop 0
    v_add_f32_dpp v176, v176, v176 row_ror:8 row_mask:0xf bank_mask:0xf
    v_add_f32_dpp v177, v177, v177 row_ror:8 row_mask:0xf bank_mask:0xf
    s_nop 1
    v_mov_b32_dpp v176, v177 quad_perm:[0,1,2,3] row_mask:0xf bank_mask:0xc
    s_waitcnt lgkmcnt(0)
    s_mul_i32 s4, s4, 0x9e3779b1
    s_add_u32 s4, s4, 0x7f4a7c15
    ds_write_b32 v252, v176
    s_waitcnt lgkmcnt(0)
    s_barrier
    ds_read_b128 v[176:179], v251
    ds_read_b128 v[180:183], v251 offset:16
    s_waitcnt lgkmcnt(0)
    v_pk_add_f32 v[176:177], v[176:177], v[178:179]
    v_pk_add_f32 v[180:181], v[180:181], v[182:183]
    v_pk_add_f32 v[176:177], v[176:177], v[180:181]
    v_add_f32 v176, v176, v177
    v_mov_b32 v177, s4
    s_bitcmp1_b32 s3, 0
    s_cselect_b32 exec_lo, 0, -1
    s_cselect_b32 exec_hi, -1, 0
    buffer_store_dwordx2 v[176:177], v250, s[32:35], s13 offen sc1
    s_mov_b64 exec, -1
    s_lshr_b32 s96, s9, 4
    s_lshl_b32 s94, s96, -1
    s_add_u32 s96, s94, s84
    s_and_b32 s97, s96, 15
    s_mul_i32 s98, s97, 393216
    s_add_u32 s91, s98, s85
    s_lshl_b32 s96, s94, 13
    s_add_u32 s94, s96, s83
    s_add_u32 s82, s91, 2048
    s_mov_b32 m0, s94
    s_nop 0
    buffer_load_dwordx4 v3, s[40:43], s82 offen lds
    s_add_u32 s82, s91, 4096
    s_add_u32 m0, s94, 49152
    s_nop 0
    buffer_load_dwordx4 v3, s[40:43], s82 offen lds
    s_waitcnt vmcnt(6)
    v_mov_b32 v8, 0x3f803f80
    v_dot2_f32_bf16 v4, v152, v8, 0
    v_dot2_f32_bf16 v5, v152, v152, 0
    v_dot2_f32_bf16 v6, v153, v8, 0
    v_dot2_f32_bf16 v7, v153, v153, 0
    v_dot2_f32_bf16 v4, v154, v8, v4
    v_dot2_f32_bf16 v5, v154, v154, v5
    v_dot2_f32_bf16 v6, v155, v8, v6
    v_dot2_f32_bf16 v7, v155, v155, v7
    v_dot2_f32_bf16 v4, v156, v8, v4
    v_dot2_f32_bf16 v5, v156, v156, v5
    v_dot2_f32_bf16 v6, v157, v8, v6
    v_dot2_f32_bf16 v7, v157, v157, v7
    v_dot2_f32_bf16 v4, v158, v8, v4
    v_dot2_f32_bf16 v5, v158, v158, v5
    v_dot2_f32_bf16 v6, v159, v8, v6
    v_dot2_f32_bf16 v7, v159, v159, v7
    s_nop 2
    v_pk_add_f32 v[4:5], v[4:5], v[6:7]
    s_nop 1
    v_add_f32_dpp v4, v4, v4 quad_perm:[1,0,3,2] row_mask:0xf bank_mask:0xf
    v_add_f32_dpp v5, v5, v5 quad_perm:[1,0,3,2] row_mask:0xf bank_mask:0xf
    s_nop 0
    v_add_f32_dpp v4, v4, v4 quad_perm:[2,3,0,1] row_mask:0xf bank_mask:0xf
    v_add_f32_dpp v5, v5, v5 quad_perm:[2,3,0,1] row_mask:0xf bank_mask:0xf
    s_nop 0
    v_add_f32_dpp v4, v4, v4 row_half_mirror row_mask:0xf bank_mask:0xf
    v_add_f32_dpp v5, v5, v5 row_half_mirror row_mask:0xf bank_mask:0xf
    s_nop 0
    v_add_f32_dpp v4, v4, v4 row_ror:8 row_mask:0xf bank_mask:0xf
    v_add_f32_dpp v5, v5, v5 row_ror:8 row_mask:0xf bank_mask:0xf
    s_nop 1
    v_permlane16_swap_b32 v4, v5
    v_add_f32 v8, v4, v5
    v_add_f32 v4, v4, v5
    s_nop 1
    v_permlane32_swap_b32 v4, v8
    v_add_f32 v4, v4, v8
    v_mul_f32 v8, 0x3a800000, v4
    v_mul_f32 v4, 0x3a800000, v4
    s_nop 1
    v_permlane16_swap_b32 v4, v8
    v_fma_f32 v173, -v4, v4, v8
    v_cvt_pk_bf16_f32 v172, 0, v4
    v_max_f32 v173, 0, v173
    v_cvt_pk_bf16_f32 v173, 0, v173
    v_add_f32 v173, 0x3727c5ac, v173
    v_cvt_pk_bf16_f32 v173, 0, v173
    v_sqrt_f32 v173, v173
    s_nop 0
    v_cvt_pk_bf16_f32 v173, 0, v173
    s_lshl3_add_u32 s13, s3, 153600
    v_lshrrev_b32 v172, 16, v172
    v_or_b32 v172, v172, v173
    v_mov_b32 v173, s4
    v_mov_b32 v4, s13
    ds_write_b64 v4, v[172:173]
    v_and_b32 v5, 3, v1
    v_lshlrev_b32 v5, 4, v5
    v_add_u32 v5, 153600, v5
    v_and_b32 v4, 3, v1
    v_lshlrev_b32 v4, 4, v4
    v_bfe_u32 v9, v1, 2, 1
    v_lshl_add_u32 v4, v9, 10, v4
    s_and_b32 s96, s8, 6
    s_and_b32 s97, s8, 1
    s_lshr_b32 s98, s9, 4
    s_lshl1_add_u32 s99, s97, s98
    s_lshl_b32 s97, s99, 6
    s_add_u32 s98, s96, s97
    s_lshl3_add_u32 s99, s3, s98
    s_lshl_b32 s96, s99, 10
    s_and_b32 s97, s9, 15
    s_lshl_b32 s98, s97, 6
    s_add_u32 s99, s96, s98
    s_add_u32 s13, s99, 262144
    s_waitcnt lgkmcnt(0)
    s_barrier
    ds_read_b128 v[172:175], v5
    s_waitcnt lgkmcnt(0)
    s_mov_b64 exec, 0xff
    buffer_store_dwordx4 v[172:175], v4, s[32:35], s13 offen sc1
    s_mov_b64 exec, -1
    s_mov_b32 s82, s91
    s_add_u32 m0, s94, 98304
    s_nop 0
    buffer_load_dwordx4 v3, s[40:43], s82 offen lds
    s_load_dword s24, s[32:33], s17 offset:508 glc
    s_load_dword s25, s[32:33], s17 offset:4604 glc
    v_and_b32 v4, 31, v1
    v_lshlrev_b32 v4, 4, v4
    v_lshrrev_b32 v9, 5, v1
    v_lshl_add_u32 v4, v9, 12, v4
    s_lshl2_add_u32 s14, s3, 155648
    v_lshl_add_u32 v5, v1, 6, s14
    v_and_b32 v6, 3, v1
    v_lshlrev_b32 v6, 5, v6
    v_lshrrev_b32 v9, 5, v1
    v_lshl_add_u32 v6, v9, 7, v6
    v_bfe_u32 v9, v1, 4, 1
    v_lshl_add_u32 v6, v9, 8, v6
    v_bfe_u32 v9, v1, 2, 2
    v_lshl_add_u32 v6, v9, 9, v6
    v_add_u32 v6, 155648, v6
    s_lshl3_add_u32 s96, s2, s3
    s_lshl_b32 s97, s96, 7
    s_add_u32 s14, s97, 262144
    v_and_b32 v8, 15, v1
    v_lshlrev_b32 v8, 3, v8
    s_branch SCHK_2
SPOLL_1:
    s_load_dword s24, s[32:33], s17 offset:508 glc
    s_load_dword s25, s[32:33], s17 offset:4604 glc
SCHK_2:
    s_add_u32 s5, s5, 1
    s_cmp_ge_u32 s5, 200000
    s_waitcnt lgkmcnt(0)
    s_cbranch_scc1 SDONE_3
    s_cmp_lg_u32 s24, s4
    s_cbranch_scc1 SPOLL_1
    s_cmp_lg_u32 s25, s4
    s_cbranch_scc1 SPOLL_1
SDONE_3:
    buffer_load_dwordx4 v[176:179], v4, s[32:35], s17 offen sc1
    s_load_dword s24, s[32:33], s14 offset:60 glc
    s_load_dword s25, s[32:33], s14 offset:124 glc
    s_waitcnt vmcnt(6)
    v_permlane32_swap_b32 v12, v14
    v_permlane32_swap_b32 v13, v15
    v_permlane32_swap_b32 v16, v18
    v_permlane32_swap_b32 v17, v19
    v_lshlrev_b32 v184, 16, v12
    v_and_b32 v185, s6, v12
    v_lshlrev_b32 v186, 16, v13
    v_and_b32 v187, s6, v13
    v_lshlrev_b32 v188, 16, v14
    v_and_b32 v189, s6, v14
    v_lshlrev_b32 v190, 16, v15
    v_and_b32 v191, s6, v15
    v_lshlrev_b32 v192, 16, v16
    v_and_b32 v193, s6, v16
    v_lshlrev_b32 v194, 16, v17
    v_and_b32 v195, s6, v17
    v_lshlrev_b32 v196, 16, v18
    v_and_b32 v197, s6, v18
    v_lshlrev_b32 v198, 16, v19
    v_and_b32 v199, s6, v19
    s_branch SCHK_6
SPOLL_5:
    s_load_dword s24, s[32:33], s14 offset:60 glc
    s_load_dword s25, s[32:33], s14 offset:124 glc
SCHK_6:
    s_add_u32 s5, s5, 1
    s_cmp_ge_u32 s5, 200000
    s_waitcnt lgkmcnt(0)
    s_cbranch_scc1 SDONE_7
    s_cmp_lg_u32 s24, s4
    s_cbranch_scc1 SPOLL_5
    s_cmp_lg_u32 s25, s4
    s_cbranch_scc1 SPOLL_5
SDONE_7:
    buffer_load_dwordx2 v[172:173], v8, s[32:35], s14 offen sc1
    s_lshr_b32 s96, s9, 4
    s_lshl_b32 s97, s96, -1
    s_xor_b32 s94, s97, 1
    s_add_u32 s96, s94, s84
    s_and_b32 s97, s96, 15
    s_mul_i32 s98, s97, 393216
    s_add_u32 s91, s98, s85
    s_lshl_b32 s96, s94, 13
    s_add_u32 s94, s96, s83
    s_add_u32 s82, s91, 2048
    s_mov_b32 m0, s94
    s_nop 0
    buffer_load_dwordx4 v3, s[40:43], s82 offen lds
    s_add_u32 s82, s91, 4096
    s_add_u32 m0, s94, 49152
    s_nop 0
    buffer_load_dwordx4 v3, s[40:43], s82 offen lds
    s_mov_b32 s82, s91
    s_add_u32 m0, s94, 98304
    s_nop 0
    buffer_load_dwordx4 v3, s[40:43], s82 offen lds
    s_waitcnt vmcnt(4)
    v_bitop3_b32 v7, v177, v179, s4 bitop3:0x7e
    v_cmp_ne_u32 vcc, 0, v7
    s_cbranch_vccz TOK_8
POLL_9:
    buffer_load_dwordx4 v[176:179], v4, s[32:35], s17 offen sc1
    s_waitcnt vmcnt(0)
    v_bitop3_b32 v7, v177, v179, s4 bitop3:0x7e
    v_cmp_ne_u32 vcc, 0, v7
    s_cbranch_vccz PDONE_10
    s_add_u32 s5, s5, 1
    s_cmp_lt_u32 s5, 200000
    s_cbranch_scc1 POLL_9
PDONE_10:
TOK_8:
    ds_write2_b32 v5, v176, v178 offset0:0 offset1:8
    s_waitcnt lgkmcnt(0)
    s_barrier
    ds_read_b128 v[208:211], v6 offset:2048
    ds_read_b128 v[212:215], v6 offset:2064
    ds_read_b128 v[200:203], v6
    ds_read_b128 v[204:207], v6 offset:16
    s_lshl_b32 s96, s11, 12
    s_lshl_b32 s97, s3, 9
    s_add_u32 s13, s96, s97
    v_add_u32 v4, s13, v2
    s_lshl_b32 s96, s3, 9
    s_add_u32 m0, s96, 159744
    s_mov_b32 exec_hi, 0
    global_load_lds_dwordx4 v4, s[72:73]
    s_mov_b32 exec_hi, -1
    s_lshl4_add_u32 s96, s21, s12
    s_lshr_b32 s97, s3, 1
    s_lshl2_add_u32 s98, s96, s97
    s_lshl_b32 s99, s98, 12
    s_and_b32 s96, s3, 1
    s_lshl_b32 s97, s96, 8
    s_add_u32 s98, s99, s97
    s_add_u32 s13, s98, 4194304
    v_and_b32 v4, 15, v1
    v_lshlrev_b32 v4, 4, v4
    v_bfe_u32 v9, v1, 4, 1
    v_lshl_add_u32 v4, v9, 10, v4
    v_lshrrev_b32 v9, 5, v1
    v_lshl_add_u32 v4, v9, 9, v4
    s_waitcnt lgkmcnt(2)
    v_pk_add_f32 v[208:209], v[208:209], v[210:211]
    v_pk_add_f32 v[212:213], v[212:213], v[214:215]
    v_pk_add_f32 v[208:209], v[208:209], v[212:213]
    v_add_f32 v208, v208, v209
    v_cvt_pk_bf16_f32 v208, 0, v208
    s_waitcnt lgkmcnt(0)
    v_pk_add_f32 v[200:201], v[200:201], v[202:203]
    v_pk_add_f32 v[204:205], v[204:205], v[206:207]
    v_pk_add_f32 v[200:201], v[200:201], v[204:205]
    v_add_f32 v200, v200, v201
    v_add_f32 v208, 1.0, v208
    v_cvt_pk_bf16_f32 v208, 0, v208
    v_cvt_pk_bf16_f32 v200, 0, v200
    s_waitcnt vmcnt(4)
    v_cmp_ne_u32 vcc, s4, v173
    s_cbranch_vccz L_STOK
POLL_11:
    buffer_load_dwordx2 v[172:173], v8, s[32:35], s14 offen sc1
    s_waitcnt vmcnt(0)
    v_cmp_ne_u32 vcc, s4, v173
    s_cbranch_vccz PDONE_12
    s_add_u32 s5, s5, 1
    s_cmp_lt_u32 s5, 200000
    s_cbranch_scc1 POLL_11
PDONE_12:
L_STOK:
    v_lshlrev_b32 v173, 16, v172
    v_and_b32 v172, s6, v172
    v_rcp_f32 v172, v172
    s_nop 0
    v_pk_add_f32 v[184:185], v[172:173], v[184:185] op_sel:[1,0] neg_lo:[1,0] neg_hi:[1,0]
    v_pk_add_f32 v[186:187], v[172:173], v[186:187] op_sel:[1,0] neg_lo:[1,0] neg_hi:[1,0]
    v_pk_add_f32 v[188:189], v[172:173], v[188:189] op_sel:[1,0] neg_lo:[1,0] neg_hi:[1,0]
    v_pk_add_f32 v[190:191], v[172:173], v[190:191] op_sel:[1,0] neg_lo:[1,0] neg_hi:[1,0]
    v_pk_add_f32 v[192:193], v[172:173], v[192:193] op_sel:[1,0] neg_lo:[1,0] neg_hi:[1,0]
    v_pk_add_f32 v[194:195], v[172:173], v[194:195] op_sel:[1,0] neg_lo:[1,0] neg_hi:[1,0]
    v_pk_add_f32 v[196:197], v[172:173], v[196:197] op_sel:[1,0] neg_lo:[1,0] neg_hi:[1,0]
    v_pk_add_f32 v[198:199], v[172:173], v[198:199] op_sel:[1,0] neg_lo:[1,0] neg_hi:[1,0]
    v_cvt_pk_bf16_f32 v184, 0, v184
    v_cvt_pk_bf16_f32 v185, 0, v185
    v_cvt_pk_bf16_f32 v186, 0, v186
    v_cvt_pk_bf16_f32 v187, 0, v187
    v_cvt_pk_bf16_f32 v188, 0, v188
    v_cvt_pk_bf16_f32 v189, 0, v189
    v_cvt_pk_bf16_f32 v190, 0, v190
    v_cvt_pk_bf16_f32 v191, 0, v191
    v_cvt_pk_bf16_f32 v192, 0, v192
    v_cvt_pk_bf16_f32 v193, 0, v193
    v_cvt_pk_bf16_f32 v194, 0, v194
    v_cvt_pk_bf16_f32 v195, 0, v195
    v_cvt_pk_bf16_f32 v196, 0, v196
    v_cvt_pk_bf16_f32 v197, 0, v197
    v_cvt_pk_bf16_f32 v198, 0, v198
    v_cvt_pk_bf16_f32 v199, 0, v199
    v_pk_mul_f32 v[184:185], v[184:185], v[172:173] op_sel_hi:[1,0]
    v_pk_mul_f32 v[186:187], v[186:187], v[172:173] op_sel_hi:[1,0]
    v_pk_mul_f32 v[188:189], v[188:189], v[172:173] op_sel_hi:[1,0]
    v_pk_mul_f32 v[190:191], v[190:191], v[172:173] op_sel_hi:[1,0]
    v_pk_mul_f32 v[192:193], v[192:193], v[172:173] op_sel_hi:[1,0]
    v_pk_mul_f32 v[194:195], v[194:195], v[172:173] op_sel_hi:[1,0]
    v_pk_mul_f32 v[196:197], v[196:197], v[172:173] op_sel_hi:[1,0]
    v_pk_mul_f32 v[198:199], v[198:199], v[172:173] op_sel_hi:[1,0]
    v_cvt_pk_bf16_f32 v184, 0, v184
    v_cvt_pk_bf16_f32 v185, 0, v185
    v_cvt_pk_bf16_f32 v186, 0, v186
    v_cvt_pk_bf16_f32 v187, 0, v187
    v_cvt_pk_bf16_f32 v188, 0, v188
    v_cvt_pk_bf16_f32 v189, 0, v189
    v_cvt_pk_bf16_f32 v190, 0, v190
    v_cvt_pk_bf16_f32 v191, 0, v191
    v_cvt_pk_bf16_f32 v192, 0, v192
    v_cvt_pk_bf16_f32 v193, 0, v193
    v_cvt_pk_bf16_f32 v194, 0, v194
    v_cvt_pk_bf16_f32 v195, 0, v195
    v_cvt_pk_bf16_f32 v196, 0, v196
    v_cvt_pk_bf16_f32 v197, 0, v197
    v_cvt_pk_bf16_f32 v198, 0, v198
    v_cvt_pk_bf16_f32 v199, 0, v199
    v_mul_f32_dpp v184, v208, v184 row_newbcast:0 row_mask:0xf bank_mask:0xf
    v_mul_f32_dpp v185, v208, v185 row_newbcast:1 row_mask:0xf bank_mask:0xf
    v_mul_f32_dpp v186, v208, v186 row_newbcast:2 row_mask:0xf bank_mask:0xf
    v_mul_f32_dpp v187, v208, v187 row_newbcast:3 row_mask:0xf bank_mask:0xf
    v_mul_f32_dpp v188, v208, v188 row_newbcast:4 row_mask:0xf bank_mask:0xf
    v_mul_f32_dpp v189, v208, v189 row_newbcast:5 row_mask:0xf bank_mask:0xf
    v_mul_f32_dpp v190, v208, v190 row_newbcast:6 row_mask:0xf bank_mask:0xf
    v_mul_f32_dpp v191, v208, v191 row_newbcast:7 row_mask:0xf bank_mask:0xf
    v_cvt_pk_bf16_f32 v184, 0, v184
    v_cvt_pk_bf16_f32 v185, 0, v185
    v_cvt_pk_bf16_f32 v186, 0, v186
    v_cvt_pk_bf16_f32 v187, 0, v187
    v_cvt_pk_bf16_f32 v188, 0, v188
    v_cvt_pk_bf16_f32 v189, 0, v189
    v_cvt_pk_bf16_f32 v190, 0, v190
    v_cvt_pk_bf16_f32 v191, 0, v191
    v_add_f32_dpp v184, v200, v184 row_newbcast:0 row_mask:0xf bank_mask:0xf
    v_add_f32_dpp v185, v200, v185 row_newbcast:1 row_mask:0xf bank_mask:0xf
    v_add_f32_dpp v186, v200, v186 row_newbcast:2 row_mask:0xf bank_mask:0xf
    v_add_f32_dpp v187, v200, v187 row_newbcast:3 row_mask:0xf bank_mask:0xf
    v_add_f32_dpp v188, v200, v188 row_newbcast:4 row_mask:0xf bank_mask:0xf
    v_add_f32_dpp v189, v200, v189 row_newbcast:5 row_mask:0xf bank_mask:0xf
    v_add_f32_dpp v190, v200, v190 row_newbcast:6 row_mask:0xf bank_mask:0xf
    v_add_f32_dpp v191, v200, v191 row_newbcast:7 row_mask:0xf bank_mask:0xf
    v_cvt_pk_bf16_f32 v216, v184, v185
    v_cvt_pk_bf16_f32 v217, v186, v187
    v_cvt_pk_bf16_f32 v218, v188, v189
    v_cvt_pk_bf16_f32 v219, v190, v191
    buffer_store_dwordx4 v[216:219], v4, s[32:35], s13 offen sc1
    v_mul_f32_dpp v192, v208, v192 row_newbcast:8 row_mask:0xf bank_mask:0xf
    v_mul_f32_dpp v193, v208, v193 row_newbcast:9 row_mask:0xf bank_mask:0xf
    v_mul_f32_dpp v194, v208, v194 row_newbcast:10 row_mask:0xf bank_mask:0xf
    v_mul_f32_dpp v195, v208, v195 row_newbcast:11 row_mask:0xf bank_mask:0xf
    v_mul_f32_dpp v196, v208, v196 row_newbcast:12 row_mask:0xf bank_mask:0xf
    v_mul_f32_dpp v197, v208, v197 row_newbcast:13 row_mask:0xf bank_mask:0xf
    v_mul_f32_dpp v198, v208, v198 row_newbcast:14 row_mask:0xf bank_mask:0xf
    v_mul_f32_dpp v199, v208, v199 row_newbcast:15 row_mask:0xf bank_mask:0xf
    v_cvt_pk_bf16_f32 v192, 0, v192
    v_cvt_pk_bf16_f32 v193, 0, v193
    v_cvt_pk_bf16_f32 v194, 0, v194
    v_cvt_pk_bf16_f32 v195, 0, v195
    v_cvt_pk_bf16_f32 v196, 0, v196
    v_cvt_pk_bf16_f32 v197, 0, v197
    v_cvt_pk_bf16_f32 v198, 0, v198
    v_cvt_pk_bf16_f32 v199, 0, v199
    v_add_f32_dpp v192, v200, v192 row_newbcast:8 row_mask:0xf bank_mask:0xf
    v_add_f32_dpp v193, v200, v193 row_newbcast:9 row_mask:0xf bank_mask:0xf
    v_add_f32_dpp v194, v200, v194 row_newbcast:10 row_mask:0xf bank_mask:0xf
    v_add_f32_dpp v195, v200, v195 row_newbcast:11 row_mask:0xf bank_mask:0xf
    v_add_f32_dpp v196, v200, v196 row_newbcast:12 row_mask:0xf bank_mask:0xf
    v_add_f32_dpp v197, v200, v197 row_newbcast:13 row_mask:0xf bank_mask:0xf
    v_add_f32_dpp v198, v200, v198 row_newbcast:14 row_mask:0xf bank_mask:0xf
    v_add_f32_dpp v199, v200, v199 row_newbcast:15 row_mask:0xf bank_mask:0xf
    v_cvt_pk_bf16_f32 v220, v192, v193
    v_cvt_pk_bf16_f32 v221, v194, v195
    v_cvt_pk_bf16_f32 v222, v196, v197
    v_cvt_pk_bf16_f32 v223, v198, v199
    buffer_store_dwordx4 v[220:223], v4, s[32:35], s13 offen offset:2048 sc1
    v_bfe_u32 v20, v1, 2, 2
    v_lshlrev_b32 v20, 7, v20
    v_bfe_u32 v9, v1, 3, 1
    v_lshl_add_u32 v20, v9, 6, v20
    v_bfe_u32 v9, v1, 4, 1
    v_lshl_add_u32 v20, v9, 5, v20
    v_and_b32 v9, 3, v1
    v_lshl_add_u32 v20, v9, 3, v20
    v_lshrrev_b32 v9, 5, v1
    v_lshl_add_u32 v20, v9, 9, v20
    v_xor_b32 v21, 64, v20
    v_add_u32 v22, 49152, v20
    v_add_u32 v23, 49152, v21
    v_add_u32 v24, 98304, v20
    v_add_u32 v25, 98304, v21
    v_and_b32 v5, 3, v1
    v_lshlrev_b32 v5, 15, v5
    v_bfe_u32 v9, v1, 2, 2
    v_lshl_add_u32 v5, v9, 12, v5
    s_and_b32 s96, s12, 1
    s_lshr_b32 s97, s21, 3
    s_and_b32 s98, s21, 7
    s_lshl_b32 s99, s98, 5
    s_lshl2_add_u32 s98, s97, s99
    s_lshl_b32 s97, s98, 12
    s_lshr_b32 s99, s12, 1
    s_lshl_b32 s98, s99, 6
    s_add_u32 s99, s97, s98
    s_lshl2_add_u32 s97, s96, s99
    s_add_u32 s13, s97, 1048576
    s_lshl_b32 s96, s10, 18
    s_lshl_b32 s97, s77, 12
    s_add_u32 s98, s96, s97
    s_add_u32 s88, s98, 4194304
    s_cmp_ge_u32 s9, 28
    s_cselect_b32 s54, 0, s54
    s_cselect_b32 s58, 0, s58
    s_cselect_b32 s62, 0, s62
    s_waitcnt vmcnt(0)
    s_barrier
    s_cmp_lg_u32 s3, 0
    s_cbranch_scc1 L_PB
    v_mov_b32 v6, s4
    s_mov_b32 exec_hi, 0
    s_mov_b32 exec_lo, 65535
    buffer_store_dword v6, v5, s[32:35], s13 offen sc1
    s_mov_b64 exec, -1
L_PB:
    s_lshr_b32 s96, s9, 4
    s_lshl_b32 s97, s96, -1
    s_xor_b32 s94, s97, 2
    s_add_u32 s96, s94, s84
    s_and_b32 s97, s96, 15
    s_mul_i32 s98, s97, 393216
    s_add_u32 s91, s98, s85
    s_lshl_b32 s96, s94, 13
    s_add_u32 s94, s96, s83
    s_add_u32 s82, s91, 2048
    s_mov_b32 m0, s94
    s_nop 0
    buffer_load_dwordx4 v3, s[40:43], s82 offen lds
    s_add_u32 s82, s91, 4096
    s_add_u32 m0, s94, 49152
    s_nop 0
    buffer_load_dwordx4 v3, s[40:43], s82 offen lds
    s_mov_b32 s82, s91
    s_add_u32 m0, s94, 98304
    s_nop 0
    buffer_load_dwordx4 v3, s[40:43], s82 offen lds
    s_lshr_b32 s96, s9, 4
    s_lshl_b32 s97, s96, -1
    s_xor_b32 s94, s97, 3
    s_add_u32 s96, s94, s84
    s_and_b32 s97, s96, 15
    s_mul_i32 s98, s97, 393216
    s_add_u32 s91, s98, s85
    s_lshl_b32 s96, s94, 13
    s_add_u32 s94, s96, s83
    s_add_u32 s82, s91, 2048
    s_mov_b32 m0, s94
    s_nop 0
    buffer_load_dwordx4 v3, s[40:43], s82 offen lds
    s_add_u32 s82, s91, 4096
    s_add_u32 m0, s94, 49152
    s_nop 0
    buffer_load_dwordx4 v3, s[40:43], s82 offen lds
    s_mov_b32 s82, s91
    s_add_u32 m0, s94, 98304
    s_nop 0
    buffer_load_dwordx4 v3, s[40:43], s82 offen lds
    s_lshl_b32 s96, s2, 12
    s_add_u32 s19, s96, 1048576
    s_and_b32 s96, s3, 3
    s_lshl_b32 s97, s96, 7
    s_add_u32 s20, s97, s19
    s_lshl_b32 s96, s84, 5
    s_add_u32 s19, s96, s19
    s_cmp_ge_u32 s3, 4
    s_cselect_b32 s19, s20, s19
    s_load_dwordx2 s[24:25], s[32:33], s19 offset:0 glc
    s_load_dwordx2 s[26:27], s[32:33], s19 offset:64 glc
    s_lshl_b32 s96, s3, 14
    s_lshl_b32 s97, s12, 7
    s_add_u32 s90, s96, s97
    s_and_b32 s96, s9, 1
    s_lshr_b32 s97, s9, 3
    s_lshl_b32 s98, s97, 1
    s_lshl3_add_u32 s99, s96, s98
    s_lshl_b32 s95, s99, 17
    s_lshl3_add_u32 s96, s75, s3
    s_mul_i32 s97, s96, 229376
    s_lshl_b32 s98, s74, 7
    s_add_u32 s80, s97, s98
    s_lshl3_add_u32 s96, s74, s3
    s_lshl_b32 s97, s96, 14
    s_lshl_b32 s98, s75, 9
    s_add_u32 s81, s97, s98
    s_and_b32 s96, s8, 3
    s_lshl3_add_u32 s97, s96, s3
    s_mul_i32 s98, s97, 393216
    s_lshr_b32 s99, s8, 2
    s_lshl1_add_u32 s96, s9, s99
    s_lshl_b32 s97, s96, 7
    s_add_u32 s99, s98, s97
    s_add_u32 s89, s99, 4096
    s_and_b32 s96, s3, 1
    s_lshl_b32 s14, s96, 6
    v_bfe_u32 v6, v1, 4, 1
    v_lshl_add_u32 v6, v6, 5, s14
    v_and_b32 v26, 7, v1
    v_lshlrev_b32 v26, 4, v26
    v_xor_b32 v26, v26, v6
    v_lshrrev_b32 v6, 3, v1
    v_lshlrev_b32 v6, 11, v6
    v_add_u32 v26, v26, v6
    s_and_b32 s96, s3, 2
    s_lshl_b32 s14, s96, 5
    v_bfe_u32 v6, v1, 4, 1
    v_lshl_add_u32 v6, v6, 5, s14
    v_and_b32 v27, 7, v1
    v_lshlrev_b32 v27, 4, v27
    v_xor_b32 v27, v27, v6
    v_lshrrev_b32 v6, 3, v1
    v_mul_u32_u24 v6, 7168, v6
    v_add_u32 v27, v27, v6
    s_and_b32 s96, s3, 1
    s_lshl_b32 s14, s96, 7
    v_lshrrev_b32 v6, 5, v1
    v_lshl_add_u32 v6, v6, 6, s14
    v_and_b32 v253, 31, v1
    v_lshlrev_b32 v253, 4, v253
    v_lshrrev_b32 v9, 5, v1
    v_lshl_add_u32 v253, v9, 11, v253
    v_xor_b32 v253, v253, v6
    s_lshl_b32 s16, s84, 14
    v_add_u32 v249, s88, v2
    s_lshl_b32 s96, s77, 11
    s_add_u32 s14, s96, 151552
    v_add_u32 v0, s14, v2
    s_mov_b64 exec, 0
    s_cmp_eq_u32 s3, 4
    s_cbranch_scc1 L_PAD2
    s_cmp_eq_u32 s3, 5
    s_cbranch_scc1 L_PAD3
    s_cmp_eq_u32 s3, 6
    s_cbranch_scc1 L_PAD4
    s_cmp_eq_u32 s3, 7
    s_cbranch_scc1 L_PAD5
    s_branch L_TEND
L_RET2:
    s_branch L_PAD6
L_RET6:
    s_branch L_PAD10
L_RET10:
    s_branch L_TEND
L_RET3:
    s_branch L_PAD7
L_RET7:
    s_branch L_TEND
L_RET4:
    s_branch L_PAD8
L_RET8:
    s_branch L_TEND
L_RET5:
    s_branch L_PAD9
L_RET9:
    s_branch L_TEND
    s_nop 0
    s_nop 0
    s_nop 0
    s_nop 0
    s_nop 0
    s_nop 0
    s_nop 0
    s_nop 0
    s_nop 0
    s_nop 0
    s_nop 0
    s_nop 0
    s_nop 0
    s_nop 0
    s_nop 0
    s_nop 0
    s_nop 0
    s_nop 0
    s_nop 0
    s_nop 0
    s_nop 0
    s_nop 0
    s_nop 0
    s_nop 0
    s_nop 0
    s_nop 0
    s_nop 0
    s_nop 0
L_TEND:
    s_mov_b64 exec, -1
    s_branch SCHK_14
SPOLL_13:
    s_load_dwordx2 s[24:25], s[32:33], s19 offset:0 glc
    s_load_dwordx2 s[26:27], s[32:33], s19 offset:64 glc
SCHK_14:
    s_add_u32 s5, s5, 1
    s_cmp_ge_u32 s5, 200000
    s_waitcnt lgkmcnt(0)
    s_cbranch_scc1 SDONE_15
    s_cmp_lg_u32 s24, s4
    s_cbranch_scc1 SPOLL_13
    s_cmp_lg_u32 s25, s4
    s_cbranch_scc1 SPOLL_13
    s_cmp_lg_u32 s26, s4
    s_cbranch_scc1 SPOLL_13
    s_cmp_lg_u32 s27, s4
    s_cbranch_scc1 SPOLL_13
SDONE_15:
    s_cmp_ge_u32 s3, 4
    s_cbranch_scc1 L_HELP
    s_setprio 2
    buffer_load_dwordx4 v[152:155], v249, s[32:35], s16 offen sc1
    buffer_load_dwordx4 v[156:159], v249, s[32:35], s16 offen offset:1024 sc1
    buffer_load_dwordx4 v[160:163], v249, s[32:35], s16 offen offset:2048 sc1
    buffer_load_dwordx4 v[164:167], v249, s[32:35], s16 offen offset:3072 sc1
    s_add_u32 s16, s16, 16384
    s_and_b32 s16, s16, 0x3ffff
    buffer_load_dwordx4 v[168:171], v249, s[32:35], s16 offen sc1
    buffer_load_dwordx4 v[172:175], v249, s[32:35], s16 offen offset:1024 sc1
    s_barrier
    ds_read_b64_tr_b16 v[28:29], v20
    ds_read_b64_tr_b16 v[30:31], v20 offset:2048
    ds_read_b64_tr_b16 v[32:33], v21
    ds_read_b64_tr_b16 v[34:35], v21 offset:2048
    ds_read_b64_tr_b16 v[36:37], v24
    ds_read_b64_tr_b16 v[38:39], v24 offset:2048
    ds_read_b64_tr_b16 v[40:41], v25
    ds_read_b64_tr_b16 v[42:43], v25 offset:2048
    ds_read_b64_tr_b16 v[44:45], v22
    ds_read_b64_tr_b16 v[46:47], v22 offset:2048
    ds_read_b64_tr_b16 v[48:49], v23
    ds_read_b64_tr_b16 v[50:51], v23 offset:2048
    s_waitcnt vmcnt(5)
    s_waitcnt lgkmcnt(10)
    v_mfma_f32_32x32x16_bf16 v[56:71], v[28:31], v[152:155], 0
    ds_read_b64_tr_b16 v[52:53], v20 offset:1024
    ds_read_b64_tr_b16 v[54:55], v20 offset:3072
    s_waitcnt lgkmcnt(10)
    v_mfma_f32_32x32x16_bf16 v[72:87], v[32:35], v[152:155], 0
    ds_read_b64_tr_b16 v[28:29], v21 offset:1024
    ds_read_b64_tr_b16 v[30:31], v21 offset:3072
    s_waitcnt lgkmcnt(10)
    v_mfma_f32_32x32x16_bf16 v[120:135], v[36:39], v[152:155], 0
    ds_read_b64_tr_b16 v[32:33], v24 offset:1024
    ds_read_b64_tr_b16 v[34:35], v24 offset:3072
    s_waitcnt lgkmcnt(10)
    v_mfma_f32_32x32x16_bf16 v[136:151], v[40:43], v[152:155], 0
    ds_read_b64_tr_b16 v[36:37], v25 offset:1024
    ds_read_b64_tr_b16 v[38:39], v25 offset:3072
    s_waitcnt lgkmcnt(10)
    v_mfma_f32_32x32x16_bf16 v[88:103], v[44:47], v[152:155], 0
    buffer_load_dwordx4 v[176:179], v249, s[32:35], s16 offen offset:2048 sc1
    ds_read_b64_tr_b16 v[40:41], v22 offset:1024
    ds_read_b64_tr_b16 v[42:43], v22 offset:3072
    s_waitcnt lgkmcnt(10)
    v_mfma_f32_32x32x16_bf16 v[104:119], v[48:51], v[152:155], 0
    ds_read_b64_tr_b16 v[44:45], v23 offset:1024
    ds_read_b64_tr_b16 v[46:47], v23 offset:3072
    s_waitcnt vmcnt(5)
    s_waitcnt lgkmcnt(10)
    v_mfma_f32_32x32x16_bf16 v[56:71], v[52:55], v[156:159], v[56:71]
    ds_read_b64_tr_b16 v[48:49], v20 offset:4096
    ds_read_b64_tr_b16 v[50:51], v20 offset:6144
    s_waitcnt lgkmcnt(10)
    v_mfma_f32_32x32x16_bf16 v[72:87], v[28:31], v[156:159], v[72:87]
    ds_read_b64_tr_b16 v[52:53], v21 offset:4096
    ds_read_b64_tr_b16 v[54:55], v21 offset:6144
    s_waitcnt lgkmcnt(10)
    v_mfma_f32_32x32x16_bf16 v[120:135], v[32:35], v[156:159], v[120:135]
    ds_read_b64_tr_b16 v[28:29], v24 offset:4096
    ds_read_b64_tr_b16 v[30:31], v24 offset:6144
    s_waitcnt lgkmcnt(10)
    v_mfma_f32_32x32x16_bf16 v[136:151], v[36:39], v[156:159], v[136:151]
    buffer_load_dwordx4 v[180:183], v249, s[32:35], s16 offen offset:3072 sc1
    ds_read_b64_tr_b16 v[32:33], v25 offset:4096
    ds_read_b64_tr_b16 v[34:35], v25 offset:6144
    s_waitcnt lgkmcnt(10)
    v_mfma_f32_32x32x16_bf16 v[88:103], v[40:43], v[156:159], v[88:103]
    s_add_u32 s16, s16, 16384
    ds_read_b64_tr_b16 v[36:37], v22 offset:4096
    ds_read_b64_tr_b16 v[38:39], v22 offset:6144
    s_waitcnt lgkmcnt(10)
    v_mfma_f32_32x32x16_bf16 v[104:119], v[44:47], v[156:159], v[104:119]
    s_and_b32 s16, s16, 0x3ffff
    ds_read_b64_tr_b16 v[40:41], v23 offset:4096
    ds_read_b64_tr_b16 v[42:43], v23 offset:6144
    s_waitcnt vmcnt(5)
    s_waitcnt lgkmcnt(10)
    v_mfma_f32_32x32x16_bf16 v[56:71], v[48:51], v[160:163], v[56:71]
    ds_read_b64_tr_b16 v[44:45], v20 offset:5120
    ds_read_b64_tr_b16 v[46:47], v20 offset:7168
    s_waitcnt lgkmcnt(10)
    v_mfma_f32_32x32x16_bf16 v[72:87], v[52:55], v[160:163], v[72:87]
    ds_read_b64_tr_b16 v[48:49], v21 offset:5120
    ds_read_b64_tr_b16 v[50:51], v21 offset:7168
    s_waitcnt lgkmcnt(10)
    v_mfma_f32_32x32x16_bf16 v[120:135], v[28:31], v[160:163], v[120:135]
    buffer_load_dwordx4 v[184:187], v249, s[32:35], s16 offen sc1
    ds_read_b64_tr_b16 v[52:53], v24 offset:5120
    ds_read_b64_tr_b16 v[54:55], v24 offset:7168
    s_waitcnt lgkmcnt(10)
    v_mfma_f32_32x32x16_bf16 v[136:151], v[32:35], v[160:163], v[136:151]
    ds_read_b64_tr_b16 v[28:29], v25 offset:5120
    ds_read_b64_tr_b16 v[30:31], v25 offset:7168
    s_waitcnt lgkmcnt(10)
    v_mfma_f32_32x32x16_bf16 v[88:103], v[36:39], v[160:163], v[88:103]
    ds_read_b64_tr_b16 v[32:33], v22 offset:5120
    ds_read_b64_tr_b16 v[34:35], v22 offset:7168
    s_waitcnt lgkmcnt(10)
    v_mfma_f32_32x32x16_bf16 v[104:119], v[40:43], v[160:163], v[104:119]
    ds_read_b64_tr_b16 v[36:37], v23 offset:5120
    ds_read_b64_tr_b16 v[38:39], v23 offset:7168
    s_waitcnt vmcnt(5)
    s_waitcnt lgkmcnt(10)
    v_mfma_f32_32x32x16_bf16 v[56:71], v[44:47], v[164:167], v[56:71]
    ds_read_b64_tr_b16 v[40:41], v20 offset:8192
    ds_read_b64_tr_b16 v[42:43], v20 offset:10240
    s_waitcnt lgkmcnt(10)
    v_mfma_f32_32x32x16_bf16 v[72:87], v[48:51], v[164:167], v[72:87]
    buffer_load_dwordx4 v[188:191], v249, s[32:35], s16 offen offset:1024 sc1
    ds_read_b64_tr_b16 v[44:45], v21 offset:8192
    ds_read_b64_tr_b16 v[46:47], v21 offset:10240
    s_waitcnt lgkmcnt(10)
    v_mfma_f32_32x32x16_bf16 v[120:135], v[52:55], v[164:167], v[120:135]
    ds_read_b64_tr_b16 v[48:49], v24 offset:8192
    ds_read_b64_tr_b16 v[50:51], v24 offset:10240
    s_waitcnt lgkmcnt(10)
    v_mfma_f32_32x32x16_bf16 v[136:151], v[28:31], v[164:167], v[136:151]
    ds_read_b64_tr_b16 v[52:53], v25 offset:8192
    ds_read_b64_tr_b16 v[54:55], v25 offset:10240
    s_waitcnt lgkmcnt(10)
    v_mfma_f32_32x32x16_bf16 v[88:103], v[32:35], v[164:167], v[88:103]
    ds_read_b64_tr_b16 v[28:29], v22 offset:8192
    ds_read_b64_tr_b16 v[30:31], v22 offset:10240
    s_waitcnt lgkmcnt(10)
    v_mfma_f32_32x32x16_bf16 v[104:119], v[36:39], v[164:167], v[104:119]
    buffer_load_dwordx4 v[192:195], v249, s[32:35], s16 offen offset:2048 sc1
    ds_read_b64_tr_b16 v[32:33], v23 offset:8192
    ds_read_b64_tr_b16 v[34:35], v23 offset:10240
    s_barrier
    s_waitcnt vmcnt(6)
    s_waitcnt lgkmcnt(10)
    v_mfma_f32_32x32x16_bf16 v[56:71], v[40:43], v[168:171], v[56:71]
    ds_read_b64_tr_b16 v[36:37], v20 offset:9216
    ds_read_b64_tr_b16 v[38:39], v20 offset:11264
    s_waitcnt lgkmcnt(10)
    v_mfma_f32_32x32x16_bf16 v[72:87], v[44:47], v[168:171], v[72:87]
    ds_read_b64_tr_b16 v[40:41], v21 offset:9216
    ds_read_b64_tr_b16 v[42:43], v21 offset:11264
    s_waitcnt lgkmcnt(10)
    v_mfma_f32_32x32x16_bf16 v[120:135], v[48:51], v[168:171], v[120:135]
    ds_read_b64_tr_b16 v[44:45], v24 offset:9216
    ds_read_b64_tr_b16 v[46:47], v24 offset:11264
    s_waitcnt lgkmcnt(10)
    v_mfma_f32_32x32x16_bf16 v[136:151], v[52:55], v[168:171], v[136:151]
    ds_read_b64_tr_b16 v[48:49], v25 offset:9216
    ds_read_b64_tr_b16 v[50:51], v25 offset:11264
    s_waitcnt lgkmcnt(10)
    v_mfma_f32_32x32x16_bf16 v[88:103], v[28:31], v[168:171], v[88:103]
    buffer_load_dwordx4 v[196:199], v249, s[32:35], s16 offen offset:3072 sc1
    ds_read_b64_tr_b16 v[52:53], v22 offset:9216
    ds_read_b64_tr_b16 v[54:55], v22 offset:11264
    s_waitcnt lgkmcnt(10)
    v_mfma_f32_32x32x16_bf16 v[104:119], v[32:35], v[168:171], v[104:119]
    s_add_u32 s16, s16, 16384
    ds_read_b64_tr_b16 v[28:29], v23 offset:9216
    ds_read_b64_tr_b16 v[30:31], v23 offset:11264
    s_waitcnt vmcnt(6)
    s_waitcnt lgkmcnt(10)
    v_mfma_f32_32x32x16_bf16 v[56:71], v[36:39], v[172:175], v[56:71]
    s_and_b32 s16, s16, 0x3ffff
    ds_read_b64_tr_b16 v[32:33], v20 offset:12288
    ds_read_b64_tr_b16 v[34:35], v20 offset:14336
    s_waitcnt lgkmcnt(10)
    v_mfma_f32_32x32x16_bf16 v[72:87], v[40:43], v[172:175], v[72:87]
    ds_read_b64_tr_b16 v[36:37], v21 offset:12288
    ds_read_b64_tr_b16 v[38:39], v21 offset:14336
    s_waitcnt lgkmcnt(10)
    v_mfma_f32_32x32x16_bf16 v[120:135], v[44:47], v[172:175], v[120:135]
    ds_read_b64_tr_b16 v[40:41], v24 offset:12288
    ds_read_b64_tr_b16 v[42:43], v24 offset:14336
    s_waitcnt lgkmcnt(10)
    v_mfma_f32_32x32x16_bf16 v[136:151], v[48:51], v[172:175], v[136:151]
    buffer_load_dwordx4 v[200:203], v249, s[32:35], s16 offen sc1
    ds_read_b64_tr_b16 v[44:45], v25 offset:12288
    ds_read_b64_tr_b16 v[46:47], v25 offset:14336
    s_waitcnt lgkmcnt(10)
    v_mfma_f32_32x32x16_bf16 v[88:103], v[52:55], v[172:175], v[88:103]
    ds_read_b64_tr_b16 v[48:49], v22 offset:12288
    ds_read_b64_tr_b16 v[50:51], v22 offset:14336
    s_waitcnt lgkmcnt(10)
    v_mfma_f32_32x32x16_bf16 v[104:119], v[28:31], v[172:175], v[104:119]
    ds_read_b64_tr_b16 v[52:53], v23 offset:12288
    ds_read_b64_tr_b16 v[54:55], v23 offset:14336
    s_waitcnt vmcnt(6)
    s_waitcnt lgkmcnt(10)
    v_mfma_f32_32x32x16_bf16 v[56:71], v[32:35], v[176:179], v[56:71]
    ds_read_b64_tr_b16 v[28:29], v20 offset:13312
    ds_read_b64_tr_b16 v[30:31], v20 offset:15360
    s_waitcnt lgkmcnt(10)
    v_mfma_f32_32x32x16_bf16 v[72:87], v[36:39], v[176:179], v[72:87]
    ds_read_b64_tr_b16 v[32:33], v21 offset:13312
    ds_read_b64_tr_b16 v[34:35], v21 offset:15360
    s_waitcnt lgkmcnt(10)
    v_mfma_f32_32x32x16_bf16 v[120:135], v[40:43], v[176:179], v[120:135]
    buffer_load_dwordx4 v[204:207], v249, s[32:35], s16 offen offset:1024 sc1
    ds_read_b64_tr_b16 v[36:37], v24 offset:13312
    ds_read_b64_tr_b16 v[38:39], v24 offset:15360
    s_waitcnt lgkmcnt(10)
    v_mfma_f32_32x32x16_bf16 v[136:151], v[44:47], v[176:179], v[136:151]
    ds_read_b64_tr_b16 v[40:41], v25 offset:13312
    ds_read_b64_tr_b16 v[42:43], v25 offset:15360
    s_waitcnt lgkmcnt(10)
    v_mfma_f32_32x32x16_bf16 v[88:103], v[48:51], v[176:179], v[88:103]
    ds_read_b64_tr_b16 v[44:45], v22 offset:13312
    ds_read_b64_tr_b16 v[46:47], v22 offset:15360
    s_waitcnt lgkmcnt(10)
    v_mfma_f32_32x32x16_bf16 v[104:119], v[52:55], v[176:179], v[104:119]
    ds_read_b64_tr_b16 v[48:49], v23 offset:13312
    ds_read_b64_tr_b16 v[50:51], v23 offset:15360
    s_waitcnt vmcnt(6)
    s_waitcnt lgkmcnt(10)
    v_mfma_f32_32x32x16_bf16 v[56:71], v[28:31], v[180:183], v[56:71]
    ds_read_b64_tr_b16 v[52:53], v20 offset:16384
    ds_read_b64_tr_b16 v[54:55], v20 offset:18432
    s_waitcnt lgkmcnt(10)
    v_mfma_f32_32x32x16_bf16 v[72:87], v[32:35], v[180:183], v[72:87]
    buffer_load_dwordx4 v[208:211], v249, s[32:35], s16 offen offset:2048 sc1
    ds_read_b64_tr_b16 v[28:29], v21 offset:16384
    ds_read_b64_tr_b16 v[30:31], v21 offset:18432
    s_waitcnt lgkmcnt(10)
    v_mfma_f32_32x32x16_bf16 v[120:135], v[36:39], v[180:183], v[120:135]
    ds_read_b64_tr_b16 v[32:33], v24 offset:16384
    ds_read_b64_tr_b16 v[34:35], v24 offset:18432
    s_waitcnt lgkmcnt(10)
    v_mfma_f32_32x32x16_bf16 v[136:151], v[40:43], v[180:183], v[136:151]
    ds_read_b64_tr_b16 v[36:37], v25 offset:16384
    ds_read_b64_tr_b16 v[38:39], v25 offset:18432
    s_waitcnt lgkmcnt(10)
    v_mfma_f32_32x32x16_bf16 v[88:103], v[44:47], v[180:183], v[88:103]
    ds_read_b64_tr_b16 v[40:41], v22 offset:16384
    ds_read_b64_tr_b16 v[42:43], v22 offset:18432
    s_waitcnt lgkmcnt(10)
    v_mfma_f32_32x32x16_bf16 v[104:119], v[48:51], v[180:183], v[104:119]
    buffer_load_dwordx4 v[212:215], v249, s[32:35], s16 offen offset:3072 sc1
    ds_read_b64_tr_b16 v[44:45], v23 offset:16384
    ds_read_b64_tr_b16 v[46:47], v23 offset:18432
    s_barrier
    s_waitcnt vmcnt(7)
    s_waitcnt lgkmcnt(10)
    v_mfma_f32_32x32x16_bf16 v[56:71], v[52:55], v[184:187], v[56:71]
    s_add_u32 s16, s16, 16384
    ds_read_b64_tr_b16 v[48:49], v20 offset:17408
    ds_read_b64_tr_b16 v[50:51], v20 offset:19456
    s_waitcnt lgkmcnt(10)
    v_mfma_f32_32x32x16_bf16 v[72:87], v[28:31], v[184:187], v[72:87]
    s_and_b32 s16, s16, 0x3ffff
    ds_read_b64_tr_b16 v[52:53], v21 offset:17408
    ds_read_b64_tr_b16 v[54:55], v21 offset:19456
    s_waitcnt lgkmcnt(10)
    v_mfma_f32_32x32x16_bf16 v[120:135], v[32:35], v[184:187], v[120:135]
    ds_read_b64_tr_b16 v[28:29], v24 offset:17408
    ds_read_b64_tr_b16 v[30:31], v24 offset:19456
    s_waitcnt lgkmcnt(10)
    v_mfma_f32_32x32x16_bf16 v[136:151], v[36:39], v[184:187], v[136:151]
    ds_read_b64_tr_b16 v[32:33], v25 offset:17408
    ds_read_b64_tr_b16 v[34:35], v25 offset:19456
    s_waitcnt lgkmcnt(10)
    v_mfma_f32_32x32x16_bf16 v[88:103], v[40:43], v[184:187], v[88:103]
    buffer_load_dwordx4 v[216:219], v249, s[32:35], s16 offen sc1
    ds_read_b64_tr_b16 v[36:37], v22 offset:17408
    ds_read_b64_tr_b16 v[38:39], v22 offset:19456
    s_waitcnt lgkmcnt(10)
    v_mfma_f32_32x32x16_bf16 v[104:119], v[44:47], v[184:187], v[104:119]
    ds_read_b64_tr_b16 v[40:41], v23 offset:17408
    ds_read_b64_tr_b16 v[42:43], v23 offset:19456
    s_waitcnt vmcnt(7)
    s_waitcnt lgkmcnt(10)
    v_mfma_f32_32x32x16_bf16 v[56:71], v[48:51], v[188:191], v[56:71]
    ds_read_b64_tr_b16 v[44:45], v20 offset:20480
    ds_read_b64_tr_b16 v[46:47], v20 offset:22528
    s_waitcnt lgkmcnt(10)
    v_mfma_f32_32x32x16_bf16 v[72:87], v[52:55], v[188:191], v[72:87]
    ds_read_b64_tr_b16 v[48:49], v21 offset:20480
    ds_read_b64_tr_b16 v[50:51], v21 offset:22528
    s_waitcnt lgkmcnt(10)
    v_mfma_f32_32x32x16_bf16 v[120:135], v[28:31], v[188:191], v[120:135]
    ds_read_b64_tr_b16 v[52:53], v24 offset:20480
    ds_read_b64_tr_b16 v[54:55], v24 offset:22528
    s_waitcnt lgkmcnt(10)
    v_mfma_f32_32x32x16_bf16 v[136:151], v[32:35], v[188:191], v[136:151]
    buffer_load_dwordx4 v[220:223], v249, s[32:35], s16 offen offset:1024 sc1
    ds_read_b64_tr_b16 v[28:29], v25 offset:20480
    ds_read_b64_tr_b16 v[30:31], v25 offset:22528
    s_waitcnt lgkmcnt(10)
    v_mfma_f32_32x32x16_bf16 v[88:103], v[36:39], v[188:191], v[88:103]
    ds_read_b64_tr_b16 v[32:33], v22 offset:20480
    ds_read_b64_tr_b16 v[34:35], v22 offset:22528
    s_waitcnt lgkmcnt(10)
    v_mfma_f32_32x32x16_bf16 v[104:119], v[40:43], v[188:191], v[104:119]
    ds_read_b64_tr_b16 v[36:37], v23 offset:20480
    ds_read_b64_tr_b16 v[38:39], v23 offset:22528
    s_waitcnt vmcnt(7)
    s_waitcnt lgkmcnt(10)
    v_mfma_f32_32x32x16_bf16 v[56:71], v[44:47], v[192:195], v[56:71]
    ds_read_b64_tr_b16 v[40:41], v20 offset:21504
    ds_read_b64_tr_b16 v[42:43], v20 offset:23552
    s_waitcnt lgkmcnt(10)
    v_mfma_f32_32x32x16_bf16 v[72:87], v[48:51], v[192:195], v[72:87]
    ds_read_b64_tr_b16 v[44:45], v21 offset:21504
    ds_read_b64_tr_b16 v[46:47], v21 offset:23552
    s_waitcnt lgkmcnt(10)
    v_mfma_f32_32x32x16_bf16 v[120:135], v[52:55], v[192:195], v[120:135]
    buffer_load_dwordx4 v[224:227], v249, s[32:35], s16 offen offset:2048 sc1
    ds_read_b64_tr_b16 v[48:49], v24 offset:21504
    ds_read_b64_tr_b16 v[50:51], v24 offset:23552
    s_waitcnt lgkmcnt(10)
    v_mfma_f32_32x32x16_bf16 v[136:151], v[28:31], v[192:195], v[136:151]
    ds_read_b64_tr_b16 v[52:53], v25 offset:21504
    ds_read_b64_tr_b16 v[54:55], v25 offset:23552
    s_waitcnt lgkmcnt(10)
    v_mfma_f32_32x32x16_bf16 v[88:103], v[32:35], v[192:195], v[88:103]
    ds_read_b64_tr_b16 v[28:29], v22 offset:21504
    ds_read_b64_tr_b16 v[30:31], v22 offset:23552
    s_waitcnt lgkmcnt(10)
    v_mfma_f32_32x32x16_bf16 v[104:119], v[36:39], v[192:195], v[104:119]
    ds_read_b64_tr_b16 v[32:33], v23 offset:21504
    ds_read_b64_tr_b16 v[34:35], v23 offset:23552
    s_waitcnt vmcnt(7)
    s_waitcnt lgkmcnt(10)
    v_mfma_f32_32x32x16_bf16 v[56:71], v[40:43], v[196:199], v[56:71]
    ds_read_b64_tr_b16 v[36:37], v20 offset:24576
    ds_read_b64_tr_b16 v[38:39], v20 offset:26624
    s_waitcnt lgkmcnt(10)
    v_mfma_f32_32x32x16_bf16 v[72:87], v[44:47], v[196:199], v[72:87]
    buffer_load_dwordx4 v[228:231], v249, s[32:35], s16 offen offset:3072 sc1
    ds_read_b64_tr_b16 v[40:41], v21 offset:24576
    ds_read_b64_tr_b16 v[42:43], v21 offset:26624
    s_waitcnt lgkmcnt(10)
    v_mfma_f32_32x32x16_bf16 v[120:135], v[48:51], v[196:199], v[120:135]
    s_add_u32 s16, s16, 16384
    ds_read_b64_tr_b16 v[44:45], v24 offset:24576
    ds_read_b64_tr_b16 v[46:47], v24 offset:26624
    s_waitcnt lgkmcnt(10)
    v_mfma_f32_32x32x16_bf16 v[136:151], v[52:55], v[196:199], v[136:151]
    s_and_b32 s16, s16, 0x3ffff
    ds_read_b64_tr_b16 v[48:49], v25 offset:24576
    ds_read_b64_tr_b16 v[50:51], v25 offset:26624
    s_waitcnt lgkmcnt(10)
    v_mfma_f32_32x32x16_bf16 v[88:103], v[28:31], v[196:199], v[88:103]
    ds_read_b64_tr_b16 v[52:53], v22 offset:24576
    ds_read_b64_tr_b16 v[54:55], v22 offset:26624
    s_waitcnt lgkmcnt(10)
    v_mfma_f32_32x32x16_bf16 v[104:119], v[32:35], v[196:199], v[104:119]
    buffer_load_dwordx4 v[232:235], v249, s[32:35], s16 offen sc1
    ds_read_b64_tr_b16 v[28:29], v23 offset:24576
    ds_read_b64_tr_b16 v[30:31], v23 offset:26624
    s_barrier
    s_waitcnt vmcnt(8)
    s_waitcnt lgkmcnt(10)
    v_mfma_f32_32x32x16_bf16 v[56:71], v[36:39], v[200:203], v[56:71]
    ds_read_b64_tr_b16 v[32:33], v20 offset:25600
    ds_read_b64_tr_b16 v[34:35], v20 offset:27648
    s_waitcnt lgkmcnt(10)
    v_mfma_f32_32x32x16_bf16 v[72:87], v[40:43], v[200:203], v[72:87]
    ds_read_b64_tr_b16 v[36:37], v21 offset:25600
    ds_read_b64_tr_b16 v[38:39], v21 offset:27648
    s_waitcnt lgkmcnt(10)
    v_mfma_f32_32x32x16_bf16 v[120:135], v[44:47], v[200:203], v[120:135]
    ds_read_b64_tr_b16 v[40:41], v24 offset:25600
    ds_read_b64_tr_b16 v[42:43], v24 offset:27648
    s_waitcnt lgkmcnt(10)
    v_mfma_f32_32x32x16_bf16 v[136:151], v[48:51], v[200:203], v[136:151]
    ds_read_b64_tr_b16 v[44:45], v25 offset:25600
    ds_read_b64_tr_b16 v[46:47], v25 offset:27648
    s_waitcnt lgkmcnt(10)
    v_mfma_f32_32x32x16_bf16 v[88:103], v[52:55], v[200:203], v[88:103]
    buffer_load_dwordx4 v[236:239], v249, s[32:35], s16 offen offset:1024 sc1
    ds_read_b64_tr_b16 v[48:49], v22 offset:25600
    ds_read_b64_tr_b16 v[50:51], v22 offset:27648
    s_waitcnt lgkmcnt(10)
    v_mfma_f32_32x32x16_bf16 v[104:119], v[28:31], v[200:203], v[104:119]
    ds_read_b64_tr_b16 v[52:53], v23 offset:25600
    ds_read_b64_tr_b16 v[54:55], v23 offset:27648
    s_waitcnt vmcnt(8)
    s_waitcnt lgkmcnt(10)
    v_mfma_f32_32x32x16_bf16 v[56:71], v[32:35], v[204:207], v[56:71]
    ds_read_b64_tr_b16 v[28:29], v20 offset:28672
    ds_read_b64_tr_b16 v[30:31], v20 offset:30720
    s_waitcnt lgkmcnt(10)
    v_mfma_f32_32x32x16_bf16 v[72:87], v[36:39], v[204:207], v[72:87]
    ds_read_b64_tr_b16 v[32:33], v21 offset:28672
    ds_read_b64_tr_b16 v[34:35], v21 offset:30720
    s_waitcnt lgkmcnt(10)
    v_mfma_f32_32x32x16_bf16 v[120:135], v[40:43], v[204:207], v[120:135]
    ds_read_b64_tr_b16 v[36:37], v24 offset:28672
    ds_read_b64_tr_b16 v[38:39], v24 offset:30720
    s_waitcnt lgkmcnt(10)
    v_mfma_f32_32x32x16_bf16 v[136:151], v[44:47], v[204:207], v[136:151]
    buffer_load_dwordx4 v[240:243], v249, s[32:35], s16 offen offset:2048 sc1
    ds_read_b64_tr_b16 v[40:41], v25 offset:28672
    ds_read_b64_tr_b16 v[42:43], v25 offset:30720
    s_waitcnt lgkmcnt(10)
    v_mfma_f32_32x32x16_bf16 v[88:103], v[48:51], v[204:207], v[88:103]
    ds_read_b64_tr_b16 v[44:45], v22 offset:28672
    ds_read_b64_tr_b16 v[46:47], v22 offset:30720
L_PAD2:
    s_cbranch_execz L_RET2
    s_waitcnt lgkmcnt(10)
    v_mfma_f32_32x32x16_bf16 v[104:119], v[52:55], v[204:207], v[104:119]
    ds_read_b64_tr_b16 v[48:49], v23 offset:28672
    ds_read_b64_tr_b16 v[50:51], v23 offset:30720
    s_waitcnt vmcnt(8)
    s_waitcnt lgkmcnt(10)
    v_mfma_f32_32x32x16_bf16 v[56:71], v[28:31], v[208:211], v[56:71]
    ds_read_b64_tr_b16 v[52:53], v20 offset:29696
    ds_read_b64_tr_b16 v[54:55], v20 offset:31744
    s_waitcnt lgkmcnt(10)
    v_mfma_f32_32x32x16_bf16 v[72:87], v[32:35], v[208:211], v[72:87]
    ds_read_b64_tr_b16 v[28:29], v21 offset:29696
    ds_read_b64_tr_b16 v[30:31], v21 offset:31744
    s_waitcnt lgkmcnt(10)
    v_mfma_f32_32x32x16_bf16 v[120:135], v[36:39], v[208:211], v[120:135]
    buffer_load_dwordx4 v[244:247], v249, s[32:35], s16 offen offset:3072 sc1
    ds_read_b64_tr_b16 v[32:33], v24 offset:29696
    ds_read_b64_tr_b16 v[34:35], v24 offset:31744
    s_waitcnt lgkmcnt(10)
    v_mfma_f32_32x32x16_bf16 v[136:151], v[40:43], v[208:211], v[136:151]
    s_add_u32 s16, s16, 16384
    ds_read_b64_tr_b16 v[36:37], v25 offset:29696
    ds_read_b64_tr_b16 v[38:39], v25 offset:31744
    s_waitcnt lgkmcnt(10)
    v_mfma_f32_32x32x16_bf16 v[88:103], v[44:47], v[208:211], v[88:103]
    s_and_b32 s16, s16, 0x3ffff
    ds_read_b64_tr_b16 v[40:41], v22 offset:29696
    ds_read_b64_tr_b16 v[42:43], v22 offset:31744
    s_waitcnt lgkmcnt(10)
    v_mfma_f32_32x32x16_bf16 v[104:119], v[48:51], v[208:211], v[104:119]
    ds_read_b64_tr_b16 v[44:45], v23 offset:29696
    ds_read_b64_tr_b16 v[46:47], v23 offset:31744
    s_waitcnt vmcnt(8)
    s_waitcnt lgkmcnt(10)
    v_mfma_f32_32x32x16_bf16 v[56:71], v[52:55], v[212:215], v[56:71]
    ds_read_b64_tr_b16 v[48:49], v20 offset:32768
    ds_read_b64_tr_b16 v[50:51], v20 offset:34816
    s_waitcnt lgkmcnt(10)
    v_mfma_f32_32x32x16_bf16 v[72:87], v[28:31], v[212:215], v[72:87]
    buffer_load_dwordx4 v[152:155], v249, s[32:35], s16 offen sc1
    ds_read_b64_tr_b16 v[52:53], v21 offset:32768
    ds_read_b64_tr_b16 v[54:55], v21 offset:34816
    s_waitcnt lgkmcnt(10)
    v_mfma_f32_32x32x16_bf16 v[120:135], v[32:35], v[212:215], v[120:135]
    ds_read_b64_tr_b16 v[28:29], v24 offset:32768
    ds_read_b64_tr_b16 v[30:31], v24 offset:34816
    s_waitcnt lgkmcnt(10)
    v_mfma_f32_32x32x16_bf16 v[136:151], v[36:39], v[212:215], v[136:151]
    ds_read_b64_tr_b16 v[32:33], v25 offset:32768
    ds_read_b64_tr_b16 v[34:35], v25 offset:34816
    s_waitcnt lgkmcnt(10)
    v_mfma_f32_32x32x16_bf16 v[88:103], v[40:43], v[212:215], v[88:103]
    ds_read_b64_tr_b16 v[36:37], v22 offset:32768
    ds_read_b64_tr_b16 v[38:39], v22 offset:34816
    s_waitcnt lgkmcnt(10)
    v_mfma_f32_32x32x16_bf16 v[104:119], v[44:47], v[212:215], v[104:119]
    buffer_load_dwordx4 v[156:159], v249, s[32:35], s16 offen offset:1024 sc1
    ds_read_b64_tr_b16 v[40:41], v23 offset:32768
    ds_read_b64_tr_b16 v[42:43], v23 offset:34816
    s_barrier
    s_waitcnt vmcnt(9)
    s_waitcnt lgkmcnt(10)
    v_mfma_f32_32x32x16_bf16 v[56:71], v[48:51], v[216:219], v[56:71]
    ds_read_b64_tr_b16 v[44:45], v20 offset:33792
    ds_read_b64_tr_b16 v[46:47], v20 offset:35840
    s_waitcnt lgkmcnt(10)
    v_mfma_f32_32x32x16_bf16 v[72:87], v[52:55], v[216:219], v[72:87]
    ds_read_b64_tr_b16 v[48:49], v21 offset:33792
    ds_read_b64_tr_b16 v[50:51], v21 offset:35840
    s_waitcnt lgkmcnt(10)
    v_mfma_f32_32x32x16_bf16 v[120:135], v[28:31], v[216:219], v[120:135]
    ds_read_b64_tr_b16 v[52:53], v24 offset:33792
    ds_read_b64_tr_b16 v[54:55], v24 offset:35840
    s_waitcnt lgkmcnt(10)
    v_mfma_f32_32x32x16_bf16 v[136:151], v[32:35], v[216:219], v[136:151]
    ds_read_b64_tr_b16 v[28:29], v25 offset:33792
    ds_read_b64_tr_b16 v[30:31], v25 offset:35840
    s_waitcnt lgkmcnt(10)
    v_mfma_f32_32x32x16_bf16 v[88:103], v[36:39], v[216:219], v[88:103]
    buffer_load_dwordx4 v[160:163], v249, s[32:35], s16 offen offset:2048 sc1
    ds_read_b64_tr_b16 v[32:33], v22 offset:33792
    ds_read_b64_tr_b16 v[34:35], v22 offset:35840
    s_waitcnt lgkmcnt(10)
    v_mfma_f32_32x32x16_bf16 v[104:119], v[40:43], v[216:219], v[104:119]
    ds_read_b64_tr_b16 v[36:37], v23 offset:33792
    ds_read_b64_tr_b16 v[38:39], v23 offset:35840
    s_waitcnt vmcnt(9)
    s_waitcnt lgkmcnt(10)
    v_mfma_f32_32x32x16_bf16 v[56:71], v[44:47], v[220:223], v[56:71]
    ds_read_b64_tr_b16 v[40:41], v20 offset:36864
    ds_read_b64_tr_b16 v[42:43], v20 offset:38912
    s_waitcnt lgkmcnt(10)
    v_mfma_f32_32x32x16_bf16 v[72:87], v[48:51], v[220:223], v[72:87]
    ds_read_b64_tr_b16 v[44:45], v21 offset:36864
    ds_read_b64_tr_b16 v[46:47], v21 offset:38912
    s_waitcnt lgkmcnt(10)
    v_mfma_f32_32x32x16_bf16 v[120:135], v[52:55], v[220:223], v[120:135]
    ds_read_b64_tr_b16 v[48:49], v24 offset:36864
    ds_read_b64_tr_b16 v[50:51], v24 offset:38912
    s_waitcnt lgkmcnt(10)
    v_mfma_f32_32x32x16_bf16 v[136:151], v[28:31], v[220:223], v[136:151]
    buffer_load_dwordx4 v[164:167], v249, s[32:35], s16 offen offset:3072 sc1
    ds_read_b64_tr_b16 v[52:53], v25 offset:36864
    ds_read_b64_tr_b16 v[54:55], v25 offset:38912
    s_waitcnt lgkmcnt(10)
    v_mfma_f32_32x32x16_bf16 v[88:103], v[32:35], v[220:223], v[88:103]
    s_add_u32 s16, s16, 16384
    ds_read_b64_tr_b16 v[28:29], v22 offset:36864
    ds_read_b64_tr_b16 v[30:31], v22 offset:38912
    s_waitcnt lgkmcnt(10)
    v_mfma_f32_32x32x16_bf16 v[104:119], v[36:39], v[220:223], v[104:119]
    s_and_b32 s16, s16, 0x3ffff
    ds_read_b64_tr_b16 v[32:33], v23 offset:36864
    ds_read_b64_tr_b16 v[34:35], v23 offset:38912
    s_waitcnt vmcnt(9)
    s_waitcnt lgkmcnt(10)
    v_mfma_f32_32x32x16_bf16 v[56:71], v[40:43], v[224:227], v[56:71]
    ds_read_b64_tr_b16 v[36:37], v20 offset:37888
    ds_read_b64_tr_b16 v[38:39], v20 offset:39936
    s_waitcnt lgkmcnt(10)
    v_mfma_f32_32x32x16_bf16 v[72:87], v[44:47], v[224:227], v[72:87]
    ds_read_b64_tr_b16 v[40:41], v21 offset:37888
    ds_read_b64_tr_b16 v[42:43], v21 offset:39936
    s_waitcnt lgkmcnt(10)
    v_mfma_f32_32x32x16_bf16 v[120:135], v[48:51], v[224:227], v[120:135]
    buffer_load_dwordx4 v[168:171], v249, s[32:35], s16 offen sc1
    ds_read_b64_tr_b16 v[44:45], v24 offset:37888
    ds_read_b64_tr_b16 v[46:47], v24 offset:39936
    s_waitcnt lgkmcnt(10)
    v_mfma_f32_32x32x16_bf16 v[136:151], v[52:55], v[224:227], v[136:151]
    ds_read_b64_tr_b16 v[48:49], v25 offset:37888
    ds_read_b64_tr_b16 v[50:51], v25 offset:39936
    s_waitcnt lgkmcnt(10)
    v_mfma_f32_32x32x16_bf16 v[88:103], v[28:31], v[224:227], v[88:103]
    ds_read_b64_tr_b16 v[52:53], v22 offset:37888
    ds_read_b64_tr_b16 v[54:55], v22 offset:39936
    s_waitcnt lgkmcnt(10)
    v_mfma_f32_32x32x16_bf16 v[104:119], v[32:35], v[224:227], v[104:119]
    ds_read_b64_tr_b16 v[28:29], v23 offset:37888
    ds_read_b64_tr_b16 v[30:31], v23 offset:39936
    s_waitcnt vmcnt(9)
    s_waitcnt lgkmcnt(10)
    v_mfma_f32_32x32x16_bf16 v[56:71], v[36:39], v[228:231], v[56:71]
    ds_read_b64_tr_b16 v[32:33], v20 offset:40960
    ds_read_b64_tr_b16 v[34:35], v20 offset:43008
    s_waitcnt lgkmcnt(10)
    v_mfma_f32_32x32x16_bf16 v[72:87], v[40:43], v[228:231], v[72:87]
    buffer_load_dwordx4 v[172:175], v249, s[32:35], s16 offen offset:1024 sc1
    ds_read_b64_tr_b16 v[36:37], v21 offset:40960
    ds_read_b64_tr_b16 v[38:39], v21 offset:43008
    s_waitcnt lgkmcnt(10)
    v_mfma_f32_32x32x16_bf16 v[120:135], v[44:47], v[228:231], v[120:135]
    ds_read_b64_tr_b16 v[40:41], v24 offset:40960
    ds_read_b64_tr_b16 v[42:43], v24 offset:43008
    s_waitcnt lgkmcnt(10)
    v_mfma_f32_32x32x16_bf16 v[136:151], v[48:51], v[228:231], v[136:151]
    ds_read_b64_tr_b16 v[44:45], v25 offset:40960
    ds_read_b64_tr_b16 v[46:47], v25 offset:43008
    s_waitcnt lgkmcnt(10)
    v_mfma_f32_32x32x16_bf16 v[88:103], v[52:55], v[228:231], v[88:103]
    ds_read_b64_tr_b16 v[48:49], v22 offset:40960
    ds_read_b64_tr_b16 v[50:51], v22 offset:43008
    s_waitcnt lgkmcnt(10)
    v_mfma_f32_32x32x16_bf16 v[104:119], v[28:31], v[228:231], v[104:119]
    buffer_load_dwordx4 v[176:179], v249, s[32:35], s16 offen offset:2048 sc1
    ds_read_b64_tr_b16 v[52:53], v23 offset:40960
    ds_read_b64_tr_b16 v[54:55], v23 offset:43008
    s_barrier
    s_waitcnt vmcnt(10)
    s_waitcnt lgkmcnt(10)
    v_mfma_f32_32x32x16_bf16 v[56:71], v[32:35], v[232:235], v[56:71]
    ds_read_b64_tr_b16 v[28:29], v20 offset:41984
    ds_read_b64_tr_b16 v[30:31], v20 offset:44032
    s_waitcnt lgkmcnt(10)
    v_mfma_f32_32x32x16_bf16 v[72:87], v[36:39], v[232:235], v[72:87]
    ds_read_b64_tr_b16 v[32:33], v21 offset:41984
    ds_read_b64_tr_b16 v[34:35], v21 offset:44032
    s_waitcnt lgkmcnt(10)
    v_mfma_f32_32x32x16_bf16 v[120:135], v[40:43], v[232:235], v[120:135]
    ds_read_b64_tr_b16 v[36:37], v24 offset:41984
    ds_read_b64_tr_b16 v[38:39], v24 offset:44032
    s_waitcnt lgkmcnt(10)
    v_mfma_f32_32x32x16_bf16 v[136:151], v[44:47], v[232:235], v[136:151]
    buffer_load_dwordx4 v[180:183], v249, s[32:35], s16 offen offset:3072 sc1
    ds_read_b64_tr_b16 v[40:41], v25 offset:41984
    ds_read_b64_tr_b16 v[42:43], v25 offset:44032
    s_waitcnt lgkmcnt(10)
    v_mfma_f32_32x32x16_bf16 v[88:103], v[48:51], v[232:235], v[88:103]
    s_add_u32 s16, s16, 16384
    ds_read_b64_tr_b16 v[44:45], v22 offset:41984
    ds_read_b64_tr_b16 v[46:47], v22 offset:44032
    s_waitcnt lgkmcnt(10)
    v_mfma_f32_32x32x16_bf16 v[104:119], v[52:55], v[232:235], v[104:119]
    s_and_b32 s16, s16, 0x3ffff
    ds_read_b64_tr_b16 v[48:49], v23 offset:41984
    ds_read_b64_tr_b16 v[50:51], v23 offset:44032
    s_waitcnt vmcnt(10)
    s_waitcnt lgkmcnt(10)
    v_mfma_f32_32x32x16_bf16 v[56:71], v[28:31], v[236:239], v[56:71]
    buffer_load_dwordx4 v[184:187], v249, s[32:35], s16 offen sc1
    ds_read_b64_tr_b16 v[52:53], v20 offset:45056
    ds_read_b64_tr_b16 v[54:55], v20 offset:47104
    s_waitcnt lgkmcnt(10)
    v_mfma_f32_32x32x16_bf16 v[72:87], v[32:35], v[236:239], v[72:87]
    ds_read_b64_tr_b16 v[28:29], v21 offset:45056
    ds_read_b64_tr_b16 v[30:31], v21 offset:47104
    s_waitcnt lgkmcnt(10)
    v_mfma_f32_32x32x16_bf16 v[120:135], v[36:39], v[236:239], v[120:135]
    ds_read_b64_tr_b16 v[32:33], v24 offset:45056
    ds_read_b64_tr_b16 v[34:35], v24 offset:47104
    s_waitcnt lgkmcnt(10)
    v_mfma_f32_32x32x16_bf16 v[136:151], v[40:43], v[236:239], v[136:151]
    ds_read_b64_tr_b16 v[36:37], v25 offset:45056
    ds_read_b64_tr_b16 v[38:39], v25 offset:47104
    s_waitcnt lgkmcnt(10)
    v_mfma_f32_32x32x16_bf16 v[88:103], v[44:47], v[236:239], v[88:103]
    buffer_load_dwordx4 v[188:191], v249, s[32:35], s16 offen offset:1024 sc1
    ds_read_b64_tr_b16 v[40:41], v22 offset:45056
    ds_read_b64_tr_b16 v[42:43], v22 offset:47104
    s_waitcnt lgkmcnt(10)
    v_mfma_f32_32x32x16_bf16 v[104:119], v[48:51], v[236:239], v[104:119]
    ds_read_b64_tr_b16 v[44:45], v23 offset:45056
    ds_read_b64_tr_b16 v[46:47], v23 offset:47104
    s_waitcnt vmcnt(11)
    s_waitcnt lgkmcnt(10)
    v_mfma_f32_32x32x16_bf16 v[56:71], v[52:55], v[240:243], v[56:71]
    ds_read_b64_tr_b16 v[48:49], v20 offset:46080
    ds_read_b64_tr_b16 v[50:51], v20 offset:48128
    s_waitcnt lgkmcnt(10)
    v_mfma_f32_32x32x16_bf16 v[72:87], v[28:31], v[240:243], v[72:87]
    buffer_load_dwordx4 v[192:195], v249, s[32:35], s16 offen offset:2048 sc1
    ds_read_b64_tr_b16 v[52:53], v21 offset:46080
    ds_read_b64_tr_b16 v[54:55], v21 offset:48128
    s_waitcnt lgkmcnt(10)
    v_mfma_f32_32x32x16_bf16 v[120:135], v[32:35], v[240:243], v[120:135]
    ds_read_b64_tr_b16 v[28:29], v24 offset:46080
    ds_read_b64_tr_b16 v[30:31], v24 offset:48128
    s_waitcnt lgkmcnt(10)
    v_mfma_f32_32x32x16_bf16 v[136:151], v[36:39], v[240:243], v[136:151]
    ds_read_b64_tr_b16 v[32:33], v25 offset:46080
    ds_read_b64_tr_b16 v[34:35], v25 offset:48128
    s_waitcnt lgkmcnt(10)
    v_mfma_f32_32x32x16_bf16 v[88:103], v[40:43], v[240:243], v[88:103]
    ds_read_b64_tr_b16 v[36:37], v22 offset:46080
    ds_read_b64_tr_b16 v[38:39], v22 offset:48128
    s_waitcnt lgkmcnt(10)
    v_mfma_f32_32x32x16_bf16 v[104:119], v[44:47], v[240:243], v[104:119]
    buffer_load_dwordx4 v[196:199], v249, s[32:35], s16 offen offset:3072 sc1
    ds_read_b64_tr_b16 v[40:41], v23 offset:46080
    ds_read_b64_tr_b16 v[42:43], v23 offset:48128
    s_waitcnt vmcnt(12)
    s_waitcnt lgkmcnt(10)
    v_mfma_f32_32x32x16_bf16 v[56:71], v[48:51], v[244:247], v[56:71]
    s_add_u32 s16, s16, 16384
    ds_read_b64_tr_b16 v[44:45], v20
    ds_read_b64_tr_b16 v[46:47], v20 offset:2048
    s_waitcnt lgkmcnt(10)
    v_mfma_f32_32x32x16_bf16 v[72:87], v[52:55], v[244:247], v[72:87]
    s_and_b32 s16, s16, 0x3ffff
    ds_read_b64_tr_b16 v[48:49], v21
    ds_read_b64_tr_b16 v[50:51], v21 offset:2048
    s_waitcnt lgkmcnt(10)
    v_mfma_f32_32x32x16_bf16 v[120:135], v[28:31], v[244:247], v[120:135]
    buffer_load_dwordx4 v[200:203], v249, s[32:35], s16 offen sc1
    ds_read_b64_tr_b16 v[52:53], v24
    ds_read_b64_tr_b16 v[54:55], v24 offset:2048
    s_waitcnt lgkmcnt(10)
    v_mfma_f32_32x32x16_bf16 v[136:151], v[32:35], v[244:247], v[136:151]
    ds_read_b64_tr_b16 v[28:29], v25
    ds_read_b64_tr_b16 v[30:31], v25 offset:2048
    s_waitcnt lgkmcnt(10)
    v_mfma_f32_32x32x16_bf16 v[88:103], v[36:39], v[244:247], v[88:103]
    ds_read_b64_tr_b16 v[32:33], v22
    ds_read_b64_tr_b16 v[34:35], v22 offset:2048
    s_waitcnt lgkmcnt(10)
    v_mfma_f32_32x32x16_bf16 v[104:119], v[40:43], v[244:247], v[104:119]
    buffer_load_dwordx4 v[204:207], v249, s[32:35], s16 offen offset:1024 sc1
    ds_read_b64_tr_b16 v[36:37], v23
    ds_read_b64_tr_b16 v[38:39], v23 offset:2048
    s_barrier
    s_waitcnt vmcnt(13)
    s_waitcnt lgkmcnt(10)
    v_mfma_f32_32x32x16_bf16 v[56:71], v[44:47], v[152:155], v[56:71]
    ds_read_b64_tr_b16 v[40:41], v20 offset:1024
    ds_read_b64_tr_b16 v[42:43], v20 offset:3072
    s_waitcnt lgkmcnt(10)
    v_mfma_f32_32x32x16_bf16 v[72:87], v[48:51], v[152:155], v[72:87]
    ds_read_b64_tr_b16 v[44:45], v21 offset:1024
    ds_read_b64_tr_b16 v[46:47], v21 offset:3072
    s_waitcnt lgkmcnt(10)
    v_mfma_f32_32x32x16_bf16 v[120:135], v[52:55], v[152:155], v[120:135]
    ds_read_b64_tr_b16 v[48:49], v24 offset:1024
    ds_read_b64_tr_b16 v[50:51], v24 offset:3072
    s_waitcnt lgkmcnt(10)
    v_mfma_f32_32x32x16_bf16 v[136:151], v[28:31], v[152:155], v[136:151]
    buffer_load_dwordx4 v[208:211], v249, s[32:35], s16 offen offset:2048 sc1
    ds_read_b64_tr_b16 v[52:53], v25 offset:1024
    ds_read_b64_tr_b16 v[54:55], v25 offset:3072
    s_waitcnt lgkmcnt(10)
    v_mfma_f32_32x32x16_bf16 v[88:103], v[32:35], v[152:155], v[88:103]
    ds_read_b64_tr_b16 v[28:29], v22 offset:1024
    ds_read_b64_tr_b16 v[30:31], v22 offset:3072
    s_waitcnt lgkmcnt(10)
    v_mfma_f32_32x32x16_bf16 v[104:119], v[36:39], v[152:155], v[104:119]
    ds_read_b64_tr_b16 v[32:33], v23 offset:1024
    ds_read_b64_tr_b16 v[34:35], v23 offset:3072
    s_waitcnt vmcnt(13)
    s_waitcnt lgkmcnt(10)
    v_mfma_f32_32x32x16_bf16 v[56:71], v[40:43], v[156:159], v[56:71]
    buffer_load_dwordx4 v[212:215], v249, s[32:35], s16 offen offset:3072 sc1
    ds_read_b64_tr_b16 v[36:37], v20 offset:4096
    ds_read_b64_tr_b16 v[38:39], v20 offset:6144
    s_waitcnt lgkmcnt(10)
    v_mfma_f32_32x32x16_bf16 v[72:87], v[44:47], v[156:159], v[72:87]
    s_add_u32 s16, s16, 16384
    ds_read_b64_tr_b16 v[40:41], v21 offset:4096
    ds_read_b64_tr_b16 v[42:43], v21 offset:6144
    s_waitcnt lgkmcnt(10)
    v_mfma_f32_32x32x16_bf16 v[120:135], v[48:51], v[156:159], v[120:135]
    s_and_b32 s16, s16, 0x3ffff
    ds_read_b64_tr_b16 v[44:45], v24 offset:4096
    ds_read_b64_tr_b16 v[46:47], v24 offset:6144
    s_waitcnt lgkmcnt(10)
    v_mfma_f32_32x32x16_bf16 v[136:151], v[52:55], v[156:159], v[136:151]
    ds_read_b64_tr_b16 v[48:49], v25 offset:4096
    ds_read_b64_tr_b16 v[50:51], v25 offset:6144
    s_waitcnt lgkmcnt(10)
    v_mfma_f32_32x32x16_bf16 v[88:103], v[28:31], v[156:159], v[88:103]
    buffer_load_dwordx4 v[216:219], v249, s[32:35], s16 offen sc1
    ds_read_b64_tr_b16 v[52:53], v22 offset:4096
    ds_read_b64_tr_b16 v[54:55], v22 offset:6144
    s_waitcnt lgkmcnt(10)
    v_mfma_f32_32x32x16_bf16 v[104:119], v[32:35], v[156:159], v[104:119]
    ds_read_b64_tr_b16 v[28:29], v23 offset:4096
    ds_read_b64_tr_b16 v[30:31], v23 offset:6144
    s_waitcnt vmcnt(14)
    s_waitcnt lgkmcnt(10)
    v_mfma_f32_32x32x16_bf16 v[56:71], v[36:39], v[160:163], v[56:71]
    ds_read_b64_tr_b16 v[32:33], v20 offset:5120
    ds_read_b64_tr_b16 v[34:35], v20 offset:7168
    s_waitcnt lgkmcnt(10)
    v_mfma_f32_32x32x16_bf16 v[72:87], v[40:43], v[160:163], v[72:87]
    buffer_load_dwordx4 v[220:223], v249, s[32:35], s16 offen offset:1024 sc1
    ds_read_b64_tr_b16 v[36:37], v21 offset:5120
    ds_read_b64_tr_b16 v[38:39], v21 offset:7168
    s_waitcnt lgkmcnt(10)
    v_mfma_f32_32x32x16_bf16 v[120:135], v[44:47], v[160:163], v[120:135]
    ds_read_b64_tr_b16 v[40:41], v24 offset:5120
    ds_read_b64_tr_b16 v[42:43], v24 offset:7168
    s_waitcnt lgkmcnt(10)
    v_mfma_f32_32x32x16_bf16 v[136:151], v[48:51], v[160:163], v[136:151]
    ds_read_b64_tr_b16 v[44:45], v25 offset:5120
    ds_read_b64_tr_b16 v[46:47], v25 offset:7168
    s_waitcnt lgkmcnt(10)
    v_mfma_f32_32x32x16_bf16 v[88:103], v[52:55], v[160:163], v[88:103]
    ds_read_b64_tr_b16 v[48:49], v22 offset:5120
    ds_read_b64_tr_b16 v[50:51], v22 offset:7168
    s_waitcnt lgkmcnt(10)
    v_mfma_f32_32x32x16_bf16 v[104:119], v[28:31], v[160:163], v[104:119]
    buffer_load_dwordx4 v[224:227], v249, s[32:35], s16 offen offset:2048 sc1
    ds_read_b64_tr_b16 v[52:53], v23 offset:5120
    ds_read_b64_tr_b16 v[54:55], v23 offset:7168
    s_waitcnt vmcnt(15)
    s_waitcnt lgkmcnt(10)
    v_mfma_f32_32x32x16_bf16 v[56:71], v[32:35], v[164:167], v[56:71]
    ds_read_b64_tr_b16 v[28:29], v20 offset:8192
    ds_read_b64_tr_b16 v[30:31], v20 offset:10240
    s_waitcnt lgkmcnt(10)
    v_mfma_f32_32x32x16_bf16 v[72:87], v[36:39], v[164:167], v[72:87]
    ds_read_b64_tr_b16 v[32:33], v21 offset:8192
    ds_read_b64_tr_b16 v[34:35], v21 offset:10240
    s_waitcnt lgkmcnt(10)
    v_mfma_f32_32x32x16_bf16 v[120:135], v[40:43], v[164:167], v[120:135]
    buffer_load_dwordx4 v[228:231], v249, s[32:35], s16 offen offset:3072 sc1
    ds_read_b64_tr_b16 v[36:37], v24 offset:8192
    ds_read_b64_tr_b16 v[38:39], v24 offset:10240
    s_waitcnt lgkmcnt(10)
    v_mfma_f32_32x32x16_bf16 v[136:151], v[44:47], v[164:167], v[136:151]
    s_add_u32 s16, s16, 16384
    ds_read_b64_tr_b16 v[40:41], v25 offset:8192
    ds_read_b64_tr_b16 v[42:43], v25 offset:10240
    s_waitcnt lgkmcnt(10)
    v_mfma_f32_32x32x16_bf16 v[88:103], v[48:51], v[164:167], v[88:103]
    s_and_b32 s16, s16, 0x3ffff
    ds_read_b64_tr_b16 v[44:45], v22 offset:8192
    ds_read_b64_tr_b16 v[46:47], v22 offset:10240
    s_waitcnt lgkmcnt(10)
    v_mfma_f32_32x32x16_bf16 v[104:119], v[52:55], v[164:167], v[104:119]
    buffer_load_dwordx4 v[232:235], v249, s[32:35], s16 offen sc1
    ds_read_b64_tr_b16 v[48:49], v23 offset:8192
    ds_read_b64_tr_b16 v[50:51], v23 offset:10240
    s_barrier
    s_waitcnt vmcnt(16)
    s_waitcnt lgkmcnt(10)
    v_mfma_f32_32x32x16_bf16 v[56:71], v[28:31], v[168:171], v[56:71]
    ds_read_b64_tr_b16 v[52:53], v20 offset:9216
    ds_read_b64_tr_b16 v[54:55], v20 offset:11264
    s_waitcnt lgkmcnt(10)
    v_mfma_f32_32x32x16_bf16 v[72:87], v[32:35], v[168:171], v[72:87]
    ds_read_b64_tr_b16 v[28:29], v21 offset:9216
    ds_read_b64_tr_b16 v[30:31], v21 offset:11264
    s_waitcnt lgkmcnt(10)
    v_mfma_f32_32x32x16_bf16 v[120:135], v[36:39], v[168:171], v[120:135]
    ds_read_b64_tr_b16 v[32:33], v24 offset:9216
    ds_read_b64_tr_b16 v[34:35], v24 offset:11264
    s_waitcnt lgkmcnt(10)
    v_mfma_f32_32x32x16_bf16 v[136:151], v[40:43], v[168:171], v[136:151]
    buffer_load_dwordx4 v[236:239], v249, s[32:35], s16 offen offset:1024 sc1
    ds_read_b64_tr_b16 v[36:37], v25 offset:9216
    ds_read_b64_tr_b16 v[38:39], v25 offset:11264
    s_waitcnt lgkmcnt(10)
    v_mfma_f32_32x32x16_bf16 v[88:103], v[44:47], v[168:171], v[88:103]
    ds_read_b64_tr_b16 v[40:41], v22 offset:9216
    ds_read_b64_tr_b16 v[42:43], v22 offset:11264
    s_waitcnt lgkmcnt(10)
    v_mfma_f32_32x32x16_bf16 v[104:119], v[48:51], v[168:171], v[104:119]
    ds_read_b64_tr_b16 v[44:45], v23 offset:9216
    ds_read_b64_tr_b16 v[46:47], v23 offset:11264
    s_waitcnt vmcnt(16)
    s_waitcnt lgkmcnt(10)
    v_mfma_f32_32x32x16_bf16 v[56:71], v[52:55], v[172:175], v[56:71]
    buffer_load_dwordx4 v[240:243], v249, s[32:35], s16 offen offset:2048 sc1
    ds_read_b64_tr_b16 v[48:49], v20 offset:12288
    ds_read_b64_tr_b16 v[50:51], v20 offset:14336
    s_waitcnt lgkmcnt(10)
    v_mfma_f32_32x32x16_bf16 v[72:87], v[28:31], v[172:175], v[72:87]
    ds_read_b64_tr_b16 v[52:53], v21 offset:12288
    ds_read_b64_tr_b16 v[54:55], v21 offset:14336
    s_waitcnt lgkmcnt(10)
    v_mfma_f32_32x32x16_bf16 v[120:135], v[32:35], v[172:175], v[120:135]
    ds_read_b64_tr_b16 v[28:29], v24 offset:12288
    ds_read_b64_tr_b16 v[30:31], v24 offset:14336
    s_waitcnt lgkmcnt(10)
    v_mfma_f32_32x32x16_bf16 v[136:151], v[36:39], v[172:175], v[136:151]
    ds_read_b64_tr_b16 v[32:33], v25 offset:12288
    ds_read_b64_tr_b16 v[34:35], v25 offset:14336
    s_waitcnt lgkmcnt(10)
    v_mfma_f32_32x32x16_bf16 v[88:103], v[40:43], v[172:175], v[88:103]
    buffer_load_dwordx4 v[244:247], v249, s[32:35], s16 offen offset:3072 sc1
    ds_read_b64_tr_b16 v[36:37], v22 offset:12288
    ds_read_b64_tr_b16 v[38:39], v22 offset:14336
    s_waitcnt lgkmcnt(10)
    v_mfma_f32_32x32x16_bf16 v[104:119], v[44:47], v[172:175], v[104:119]
    s_add_u32 s16, s16, 16384
    ds_read_b64_tr_b16 v[40:41], v23 offset:12288
    ds_read_b64_tr_b16 v[42:43], v23 offset:14336
    s_waitcnt vmcnt(17)
    s_waitcnt lgkmcnt(10)
    v_mfma_f32_32x32x16_bf16 v[56:71], v[48:51], v[176:179], v[56:71]
    s_and_b32 s16, s16, 0x3ffff
    ds_read_b64_tr_b16 v[44:45], v20 offset:13312
    ds_read_b64_tr_b16 v[46:47], v20 offset:15360
    s_waitcnt lgkmcnt(10)
    v_mfma_f32_32x32x16_bf16 v[72:87], v[52:55], v[176:179], v[72:87]
    buffer_load_dwordx4 v[152:155], v249, s[32:35], s16 offen sc1
    ds_read_b64_tr_b16 v[48:49], v21 offset:13312
    ds_read_b64_tr_b16 v[50:51], v21 offset:15360
    s_waitcnt lgkmcnt(10)
    v_mfma_f32_32x32x16_bf16 v[120:135], v[28:31], v[176:179], v[120:135]
    ds_read_b64_tr_b16 v[52:53], v24 offset:13312
    ds_read_b64_tr_b16 v[54:55], v24 offset:15360
    s_waitcnt lgkmcnt(10)
    v_mfma_f32_32x32x16_bf16 v[136:151], v[32:35], v[176:179], v[136:151]
    ds_read_b64_tr_b16 v[28:29], v25 offset:13312
    ds_read_b64_tr_b16 v[30:31], v25 offset:15360
    s_waitcnt lgkmcnt(10)
    v_mfma_f32_32x32x16_bf16 v[88:103], v[36:39], v[176:179], v[88:103]
    ds_read_b64_tr_b16 v[32:33], v22 offset:13312
    ds_read_b64_tr_b16 v[34:35], v22 offset:15360
    s_waitcnt lgkmcnt(10)
    v_mfma_f32_32x32x16_bf16 v[104:119], v[40:43], v[176:179], v[104:119]
    buffer_load_dwordx4 v[156:159], v249, s[32:35], s16 offen offset:1024 sc1
    ds_read_b64_tr_b16 v[36:37], v23 offset:13312
    ds_read_b64_tr_b16 v[38:39], v23 offset:15360
    s_waitcnt vmcnt(18)
    s_waitcnt lgkmcnt(10)
    v_mfma_f32_32x32x16_bf16 v[56:71], v[44:47], v[180:183], v[56:71]
    ds_read_b64_tr_b16 v[40:41], v20 offset:16384
    ds_read_b64_tr_b16 v[42:43], v20 offset:18432
    s_waitcnt lgkmcnt(10)
    v_mfma_f32_32x32x16_bf16 v[72:87], v[48:51], v[180:183], v[72:87]
    ds_read_b64_tr_b16 v[44:45], v21 offset:16384
    ds_read_b64_tr_b16 v[46:47], v21 offset:18432
    s_waitcnt lgkmcnt(10)
    v_mfma_f32_32x32x16_bf16 v[120:135], v[52:55], v[180:183], v[120:135]
    buffer_load_dwordx4 v[160:163], v249, s[32:35], s16 offen offset:2048 sc1
    ds_read_b64_tr_b16 v[48:49], v24 offset:16384
    ds_read_b64_tr_b16 v[50:51], v24 offset:18432
    s_waitcnt lgkmcnt(10)
    v_mfma_f32_32x32x16_bf16 v[136:151], v[28:31], v[180:183], v[136:151]
    ds_read_b64_tr_b16 v[52:53], v25 offset:16384
    ds_read_b64_tr_b16 v[54:55], v25 offset:18432
    s_waitcnt lgkmcnt(10)
    v_mfma_f32_32x32x16_bf16 v[88:103], v[32:35], v[180:183], v[88:103]
    ds_read_b64_tr_b16 v[28:29], v22 offset:16384
    ds_read_b64_tr_b16 v[30:31], v22 offset:18432
    s_waitcnt lgkmcnt(10)
    v_mfma_f32_32x32x16_bf16 v[104:119], v[36:39], v[180:183], v[104:119]
    buffer_load_dwordx4 v[164:167], v249, s[32:35], s16 offen offset:3072 sc1
    ds_read_b64_tr_b16 v[32:33], v23 offset:16384
    ds_read_b64_tr_b16 v[34:35], v23 offset:18432
    s_barrier
    s_waitcnt vmcnt(19)
    s_waitcnt lgkmcnt(10)
    v_mfma_f32_32x32x16_bf16 v[56:71], v[40:43], v[184:187], v[56:71]
    s_add_u32 s16, s16, 16384
    ds_read_b64_tr_b16 v[36:37], v20 offset:17408
    ds_read_b64_tr_b16 v[38:39], v20 offset:19456
    s_waitcnt lgkmcnt(10)
    v_mfma_f32_32x32x16_bf16 v[72:87], v[44:47], v[184:187], v[72:87]
    s_and_b32 s16, s16, 0x3ffff
    ds_read_b64_tr_b16 v[40:41], v21 offset:17408
    ds_read_b64_tr_b16 v[42:43], v21 offset:19456
    s_waitcnt lgkmcnt(10)
    v_mfma_f32_32x32x16_bf16 v[120:135], v[48:51], v[184:187], v[120:135]
    ds_read_b64_tr_b16 v[44:45], v24 offset:17408
    ds_read_b64_tr_b16 v[46:47], v24 offset:19456
    s_waitcnt lgkmcnt(10)
    v_mfma_f32_32x32x16_bf16 v[136:151], v[52:55], v[184:187], v[136:151]
    buffer_load_dwordx4 v[168:171], v249, s[32:35], s16 offen sc1
    ds_read_b64_tr_b16 v[48:49], v25 offset:17408
    ds_read_b64_tr_b16 v[50:51], v25 offset:19456
    s_waitcnt lgkmcnt(10)
    v_mfma_f32_32x32x16_bf16 v[88:103], v[28:31], v[184:187], v[88:103]
    ds_read_b64_tr_b16 v[52:53], v22 offset:17408
    ds_read_b64_tr_b16 v[54:55], v22 offset:19456
    s_waitcnt lgkmcnt(10)
    v_mfma_f32_32x32x16_bf16 v[104:119], v[32:35], v[184:187], v[104:119]
    ds_read_b64_tr_b16 v[28:29], v23 offset:17408
    ds_read_b64_tr_b16 v[30:31], v23 offset:19456
    s_waitcnt vmcnt(19)
    s_waitcnt lgkmcnt(10)
    v_mfma_f32_32x32x16_bf16 v[56:71], v[36:39], v[188:191], v[56:71]
    ds_read_b64_tr_b16 v[32:33], v20 offset:20480
    ds_read_b64_tr_b16 v[34:35], v20 offset:22528
    s_waitcnt lgkmcnt(10)
    v_mfma_f32_32x32x16_bf16 v[72:87], v[40:43], v[188:191], v[72:87]
    buffer_load_dwordx4 v[172:175], v249, s[32:35], s16 offen offset:1024 sc1
    ds_read_b64_tr_b16 v[36:37], v21 offset:20480
    ds_read_b64_tr_b16 v[38:39], v21 offset:22528
    s_waitcnt lgkmcnt(10)
    v_mfma_f32_32x32x16_bf16 v[120:135], v[44:47], v[188:191], v[120:135]
    ds_read_b64_tr_b16 v[40:41], v24 offset:20480
    ds_read_b64_tr_b16 v[42:43], v24 offset:22528
    s_waitcnt lgkmcnt(10)
    v_mfma_f32_32x32x16_bf16 v[136:151], v[48:51], v[188:191], v[136:151]
    ds_read_b64_tr_b16 v[44:45], v25 offset:20480
    ds_read_b64_tr_b16 v[46:47], v25 offset:22528
    s_waitcnt lgkmcnt(10)
    v_mfma_f32_32x32x16_bf16 v[88:103], v[52:55], v[188:191], v[88:103]
    ds_read_b64_tr_b16 v[48:49], v22 offset:20480
    ds_read_b64_tr_b16 v[50:51], v22 offset:22528
    s_waitcnt lgkmcnt(10)
    v_mfma_f32_32x32x16_bf16 v[104:119], v[28:31], v[188:191], v[104:119]
    buffer_load_dwordx4 v[176:179], v249, s[32:35], s16 offen offset:2048 sc1
    ds_read_b64_tr_b16 v[52:53], v23 offset:20480
    ds_read_b64_tr_b16 v[54:55], v23 offset:22528
    s_waitcnt vmcnt(20)
    s_waitcnt lgkmcnt(10)
    v_mfma_f32_32x32x16_bf16 v[56:71], v[32:35], v[192:195], v[56:71]
    ds_read_b64_tr_b16 v[28:29], v20 offset:21504
    ds_read_b64_tr_b16 v[30:31], v20 offset:23552
    s_waitcnt lgkmcnt(10)
    v_mfma_f32_32x32x16_bf16 v[72:87], v[36:39], v[192:195], v[72:87]
    ds_read_b64_tr_b16 v[32:33], v21 offset:21504
    ds_read_b64_tr_b16 v[34:35], v21 offset:23552
    s_waitcnt lgkmcnt(10)
    v_mfma_f32_32x32x16_bf16 v[120:135], v[40:43], v[192:195], v[120:135]
    ds_read_b64_tr_b16 v[36:37], v24 offset:21504
    ds_read_b64_tr_b16 v[38:39], v24 offset:23552
    s_waitcnt lgkmcnt(10)
    v_mfma_f32_32x32x16_bf16 v[136:151], v[44:47], v[192:195], v[136:151]
    buffer_load_dwordx4 v[180:183], v249, s[32:35], s16 offen offset:3072 sc1
    ds_read_b64_tr_b16 v[40:41], v25 offset:21504
    ds_read_b64_tr_b16 v[42:43], v25 offset:23552
    s_waitcnt lgkmcnt(10)
    v_mfma_f32_32x32x16_bf16 v[88:103], v[48:51], v[192:195], v[88:103]
    s_add_u32 s16, s16, 16384
    ds_read_b64_tr_b16 v[44:45], v22 offset:21504
    ds_read_b64_tr_b16 v[46:47], v22 offset:23552
    s_waitcnt lgkmcnt(10)
    v_mfma_f32_32x32x16_bf16 v[104:119], v[52:55], v[192:195], v[104:119]
    s_and_b32 s16, s16, 0x3ffff
    ds_read_b64_tr_b16 v[48:49], v23 offset:21504
    ds_read_b64_tr_b16 v[50:51], v23 offset:23552
    s_waitcnt vmcnt(20)
    s_waitcnt lgkmcnt(10)
    v_mfma_f32_32x32x16_bf16 v[56:71], v[28:31], v[196:199], v[56:71]
    ds_read_b64_tr_b16 v[52:53], v20 offset:24576
L_PAD3:
    s_cbranch_execz L_RET3
    ds_read_b64_tr_b16 v[54:55], v20 offset:26624
    s_waitcnt lgkmcnt(10)
    v_mfma_f32_32x32x16_bf16 v[72:87], v[32:35], v[196:199], v[72:87]
    buffer_load_dwordx4 v[184:187], v249, s[32:35], s16 offen sc1
    ds_read_b64_tr_b16 v[28:29], v21 offset:24576
    ds_read_b64_tr_b16 v[30:31], v21 offset:26624
    s_waitcnt lgkmcnt(10)
    v_mfma_f32_32x32x16_bf16 v[120:135], v[36:39], v[196:199], v[120:135]
    ds_read_b64_tr_b16 v[32:33], v20 offset:25600
    ds_read_b64_tr_b16 v[34:35], v20 offset:27648
    s_waitcnt lgkmcnt(10)
    v_mfma_f32_32x32x16_bf16 v[136:151], v[40:43], v[196:199], v[136:151]
    ds_read_b64_tr_b16 v[36:37], v21 offset:25600
    ds_read_b64_tr_b16 v[38:39], v21 offset:27648
    s_waitcnt lgkmcnt(10)
    v_mfma_f32_32x32x16_bf16 v[88:103], v[44:47], v[196:199], v[88:103]
    ds_read_b64_tr_b16 v[40:41], v20 offset:28672
    ds_read_b64_tr_b16 v[42:43], v20 offset:30720
    s_waitcnt lgkmcnt(10)
    v_mfma_f32_32x32x16_bf16 v[104:119], v[48:51], v[196:199], v[104:119]
    buffer_load_dwordx4 v[188:191], v249, s[32:35], s16 offen offset:1024 sc1
    ds_read_b64_tr_b16 v[44:45], v21 offset:28672
    ds_read_b64_tr_b16 v[46:47], v21 offset:30720
    s_barrier
    s_waitcnt vmcnt(21)
    s_waitcnt lgkmcnt(10)
    v_mfma_f32_32x32x16_bf16 v[56:71], v[52:55], v[200:203], v[56:71]
    ds_read_b64_tr_b16 v[48:49], v20 offset:29696
    ds_read_b64_tr_b16 v[50:51], v20 offset:31744
    s_waitcnt lgkmcnt(10)
    v_mfma_f32_32x32x16_bf16 v[72:87], v[28:31], v[200:203], v[72:87]
    ds_read_b64_tr_b16 v[52:53], v21 offset:29696
    ds_read_b64_tr_b16 v[54:55], v21 offset:31744
    s_waitcnt vmcnt(20)
    s_waitcnt lgkmcnt(10)
    v_mfma_f32_32x32x16_bf16 v[56:71], v[32:35], v[204:207], v[56:71]
    ds_read_b64_tr_b16 v[28:29], v24 offset:24576
    ds_read_b64_tr_b16 v[30:31], v24 offset:26624
    s_waitcnt lgkmcnt(10)
    v_mfma_f32_32x32x16_bf16 v[72:87], v[36:39], v[204:207], v[72:87]
    buffer_load_dwordx4 v[192:195], v249, s[32:35], s16 offen offset:2048 sc1
    ds_read_b64_tr_b16 v[32:33], v25 offset:24576
    ds_read_b64_tr_b16 v[34:35], v25 offset:26624
    s_waitcnt vmcnt(20)
    s_waitcnt lgkmcnt(10)
    v_mfma_f32_32x32x16_bf16 v[56:71], v[40:43], v[208:211], v[56:71]
    ds_read_b64_tr_b16 v[36:37], v22 offset:24576
    ds_read_b64_tr_b16 v[38:39], v22 offset:26624
    s_waitcnt lgkmcnt(10)
    v_mfma_f32_32x32x16_bf16 v[72:87], v[44:47], v[208:211], v[72:87]
    ds_read_b64_tr_b16 v[40:41], v23 offset:24576
    ds_read_b64_tr_b16 v[42:43], v23 offset:26624
    s_waitcnt vmcnt(19)
    s_waitcnt lgkmcnt(10)
    v_mfma_f32_32x32x16_bf16 v[56:71], v[48:51], v[212:215], v[56:71]
    ds_read_b64_tr_b16 v[44:45], v24 offset:25600
    ds_read_b64_tr_b16 v[46:47], v24 offset:27648
    s_waitcnt lgkmcnt(10)
    v_mfma_f32_32x32x16_bf16 v[72:87], v[52:55], v[212:215], v[72:87]
    buffer_load_dwordx4 v[196:199], v249, s[32:35], s16 offen offset:3072 sc1
    ds_read_b64_tr_b16 v[48:49], v25 offset:25600
    ds_read_b64_tr_b16 v[50:51], v25 offset:27648
    s_barrier
    s_waitcnt lgkmcnt(10)
    v_mfma_f32_32x32x16_bf16 v[120:135], v[28:31], v[200:203], v[120:135]
    s_add_u32 s16, s16, 16384
    ds_read_b64_tr_b16 v[52:53], v22 offset:25600
    ds_read_b64_tr_b16 v[54:55], v22 offset:27648
    s_waitcnt lgkmcnt(10)
    v_mfma_f32_32x32x16_bf16 v[136:151], v[32:35], v[200:203], v[136:151]
    s_and_b32 s16, s16, 0x3ffff
    ds_read_b64_tr_b16 v[28:29], v23 offset:25600
    ds_read_b64_tr_b16 v[30:31], v23 offset:27648
    s_waitcnt lgkmcnt(10)
    v_mfma_f32_32x32x16_bf16 v[88:103], v[36:39], v[200:203], v[88:103]
    ds_read_b64_tr_b16 v[32:33], v24 offset:28672
    ds_read_b64_tr_b16 v[34:35], v24 offset:30720
    s_waitcnt lgkmcnt(10)
    v_mfma_f32_32x32x16_bf16 v[104:119], v[40:43], v[200:203], v[104:119]
    buffer_load_dwordx4 v[200:203], v249, s[32:35], s16 offen sc1
    ds_read_b64_tr_b16 v[36:37], v25 offset:28672
    ds_read_b64_tr_b16 v[38:39], v25 offset:30720
    s_waitcnt lgkmcnt(10)
    v_mfma_f32_32x32x16_bf16 v[120:135], v[44:47], v[204:207], v[120:135]
    ds_read_b64_tr_b16 v[40:41], v22 offset:28672
    ds_read_b64_tr_b16 v[42:43], v22 offset:30720
    s_waitcnt lgkmcnt(10)
    v_mfma_f32_32x32x16_bf16 v[136:151], v[48:51], v[204:207], v[136:151]
    ds_read_b64_tr_b16 v[44:45], v23 offset:28672
    ds_read_b64_tr_b16 v[46:47], v23 offset:30720
    s_waitcnt lgkmcnt(10)
    v_mfma_f32_32x32x16_bf16 v[88:103], v[52:55], v[204:207], v[88:103]
    ds_read_b64_tr_b16 v[48:49], v24 offset:29696
    ds_read_b64_tr_b16 v[50:51], v24 offset:31744
    s_waitcnt lgkmcnt(10)
    v_mfma_f32_32x32x16_bf16 v[104:119], v[28:31], v[204:207], v[104:119]
    buffer_load_dwordx4 v[204:207], v249, s[32:35], s16 offen offset:1024 sc1
    ds_read_b64_tr_b16 v[52:53], v25 offset:29696
    ds_read_b64_tr_b16 v[54:55], v25 offset:31744
    s_waitcnt lgkmcnt(10)
    v_mfma_f32_32x32x16_bf16 v[120:135], v[32:35], v[208:211], v[120:135]
    ds_read_b64_tr_b16 v[28:29], v22 offset:29696
    ds_read_b64_tr_b16 v[30:31], v22 offset:31744
    s_waitcnt lgkmcnt(10)
    v_mfma_f32_32x32x16_bf16 v[136:151], v[36:39], v[208:211], v[136:151]
    ds_read_b64_tr_b16 v[32:33], v23 offset:29696
    ds_read_b64_tr_b16 v[34:35], v23 offset:31744
    s_waitcnt lgkmcnt(10)
    v_mfma_f32_32x32x16_bf16 v[88:103], v[40:43], v[208:211], v[88:103]
    ds_read_b64_tr_b16 v[36:37], v20 offset:32768
    ds_read_b64_tr_b16 v[38:39], v20 offset:34816
    s_waitcnt lgkmcnt(10)
    v_mfma_f32_32x32x16_bf16 v[104:119], v[44:47], v[208:211], v[104:119]
    buffer_load_dwordx4 v[208:211], v249, s[32:35], s16 offen offset:2048 sc1
    ds_read_b64_tr_b16 v[40:41], v20 offset:33792
    ds_read_b64_tr_b16 v[42:43], v20 offset:35840
    s_waitcnt lgkmcnt(10)
    v_mfma_f32_32x32x16_bf16 v[120:135], v[48:51], v[212:215], v[120:135]
    ds_read_b64_tr_b16 v[44:45], v20 offset:36864
    ds_read_b64_tr_b16 v[46:47], v20 offset:38912
    s_waitcnt lgkmcnt(10)
    v_mfma_f32_32x32x16_bf16 v[136:151], v[52:55], v[212:215], v[136:151]
    ds_read_b64_tr_b16 v[48:49], v20 offset:37888
    ds_read_b64_tr_b16 v[50:51], v20 offset:39936
    s_waitcnt lgkmcnt(10)
    v_mfma_f32_32x32x16_bf16 v[88:103], v[28:31], v[212:215], v[88:103]
    ds_read_b64_tr_b16 v[52:53], v20 offset:40960
    ds_read_b64_tr_b16 v[54:55], v20 offset:43008
    s_waitcnt lgkmcnt(10)
    v_mfma_f32_32x32x16_bf16 v[104:119], v[32:35], v[212:215], v[104:119]
    buffer_load_dwordx4 v[212:215], v249, s[32:35], s16 offen offset:3072 sc1
    ds_read_b64_tr_b16 v[28:29], v20 offset:41984
    ds_read_b64_tr_b16 v[30:31], v20 offset:44032
    s_barrier
    s_waitcnt vmcnt(23)
    s_waitcnt lgkmcnt(10)
    v_mfma_f32_32x32x16_bf16 v[56:71], v[36:39], v[216:219], v[56:71]
    s_add_u32 s16, s16, 16384
    ds_read_b64_tr_b16 v[32:33], v20 offset:45056
    ds_read_b64_tr_b16 v[34:35], v20 offset:47104
    s_waitcnt vmcnt(22)
    s_waitcnt lgkmcnt(10)
    v_mfma_f32_32x32x16_bf16 v[56:71], v[40:43], v[220:223], v[56:71]
    s_and_b32 s16, s16, 0x3ffff
    ds_read_b64_tr_b16 v[36:37], v20 offset:46080
    ds_read_b64_tr_b16 v[38:39], v20 offset:48128
    s_waitcnt vmcnt(21)
    s_waitcnt lgkmcnt(10)
    v_mfma_f32_32x32x16_bf16 v[56:71], v[44:47], v[224:227], v[56:71]
    ds_read_b64_tr_b16 v[40:41], v20
    ds_read_b64_tr_b16 v[42:43], v20 offset:2048
    s_waitcnt vmcnt(20)
    s_waitcnt lgkmcnt(10)
    v_mfma_f32_32x32x16_bf16 v[56:71], v[48:51], v[228:231], v[56:71]
    ds_read_b64_tr_b16 v[44:45], v20 offset:1024
    ds_read_b64_tr_b16 v[46:47], v20 offset:3072
    s_waitcnt vmcnt(19)
    s_waitcnt lgkmcnt(10)
    v_mfma_f32_32x32x16_bf16 v[56:71], v[52:55], v[232:235], v[56:71]
    ds_read_b64_tr_b16 v[48:49], v20 offset:4096
    ds_read_b64_tr_b16 v[50:51], v20 offset:6144
    s_waitcnt vmcnt(18)
    s_waitcnt lgkmcnt(10)
    v_mfma_f32_32x32x16_bf16 v[56:71], v[28:31], v[236:239], v[56:71]
    ds_read_b64_tr_b16 v[52:53], v20 offset:5120
    ds_read_b64_tr_b16 v[54:55], v20 offset:7168
    s_waitcnt vmcnt(17)
    s_waitcnt lgkmcnt(10)
    v_mfma_f32_32x32x16_bf16 v[56:71], v[32:35], v[240:243], v[56:71]
    ds_read_b64_tr_b16 v[28:29], v20 offset:8192
    ds_read_b64_tr_b16 v[30:31], v20 offset:10240
    s_waitcnt vmcnt(16)
    s_waitcnt lgkmcnt(10)
    v_mfma_f32_32x32x16_bf16 v[56:71], v[36:39], v[244:247], v[56:71]
    ds_read_b64_tr_b16 v[32:33], v20 offset:9216
    ds_read_b64_tr_b16 v[34:35], v20 offset:11264
    s_waitcnt vmcnt(15)
    s_waitcnt lgkmcnt(10)
    v_mfma_f32_32x32x16_bf16 v[56:71], v[40:43], v[152:155], v[56:71]
    ds_read_b64_tr_b16 v[36:37], v20 offset:12288
    ds_read_b64_tr_b16 v[38:39], v20 offset:14336
    s_waitcnt vmcnt(14)
    s_waitcnt lgkmcnt(10)
    v_mfma_f32_32x32x16_bf16 v[56:71], v[44:47], v[156:159], v[56:71]
    ds_read_b64_tr_b16 v[40:41], v20 offset:13312
    ds_read_b64_tr_b16 v[42:43], v20 offset:15360
    s_waitcnt vmcnt(13)
    s_waitcnt lgkmcnt(10)
    v_mfma_f32_32x32x16_bf16 v[56:71], v[48:51], v[160:163], v[56:71]
    ds_read_b64_tr_b16 v[44:45], v20 offset:16384
    ds_read_b64_tr_b16 v[46:47], v20 offset:18432
    s_waitcnt vmcnt(12)
    s_waitcnt lgkmcnt(10)
    v_mfma_f32_32x32x16_bf16 v[56:71], v[52:55], v[164:167], v[56:71]
    ds_read_b64_tr_b16 v[48:49], v20 offset:17408
    ds_read_b64_tr_b16 v[50:51], v20 offset:19456
    s_waitcnt vmcnt(11)
    s_waitcnt lgkmcnt(10)
    v_mfma_f32_32x32x16_bf16 v[56:71], v[28:31], v[168:171], v[56:71]
    ds_read_b64_tr_b16 v[52:53], v20 offset:20480
    ds_read_b64_tr_b16 v[54:55], v20 offset:22528
    s_waitcnt vmcnt(10)
    s_waitcnt lgkmcnt(10)
    v_mfma_f32_32x32x16_bf16 v[56:71], v[32:35], v[172:175], v[56:71]
    ds_read_b64_tr_b16 v[28:29], v20 offset:21504
    ds_read_b64_tr_b16 v[30:31], v20 offset:23552
    s_barrier
    s_waitcnt vmcnt(9)
    s_waitcnt lgkmcnt(10)
    v_mfma_f32_32x32x16_bf16 v[56:71], v[36:39], v[176:179], v[56:71]
    ds_read_b64_tr_b16 v[32:33], v20 offset:24576
    ds_read_b64_tr_b16 v[34:35], v20 offset:26624
    s_waitcnt vmcnt(8)
    s_waitcnt lgkmcnt(10)
    v_mfma_f32_32x32x16_bf16 v[56:71], v[40:43], v[180:183], v[56:71]
    ds_read_b64_tr_b16 v[36:37], v20 offset:25600
    ds_read_b64_tr_b16 v[38:39], v20 offset:27648
    s_waitcnt vmcnt(7)
    s_waitcnt lgkmcnt(10)
    v_mfma_f32_32x32x16_bf16 v[56:71], v[44:47], v[184:187], v[56:71]
    ds_read_b64_tr_b16 v[40:41], v20 offset:28672
    ds_read_b64_tr_b16 v[42:43], v20 offset:30720
    s_waitcnt vmcnt(6)
    s_waitcnt lgkmcnt(10)
    v_mfma_f32_32x32x16_bf16 v[56:71], v[48:51], v[188:191], v[56:71]
    ds_read_b64_tr_b16 v[44:45], v20 offset:29696
    ds_read_b64_tr_b16 v[46:47], v20 offset:31744
    s_waitcnt vmcnt(5)
    s_waitcnt lgkmcnt(10)
    v_mfma_f32_32x32x16_bf16 v[56:71], v[52:55], v[192:195], v[56:71]
    ds_read_b64_tr_b16 v[48:49], v21 offset:32768
    ds_read_b64_tr_b16 v[50:51], v21 offset:34816
    s_waitcnt vmcnt(4)
    s_waitcnt lgkmcnt(10)
    v_mfma_f32_32x32x16_bf16 v[56:71], v[28:31], v[196:199], v[56:71]
    ds_read_b64_tr_b16 v[52:53], v21 offset:33792
    ds_read_b64_tr_b16 v[54:55], v21 offset:35840
    s_waitcnt vmcnt(3)
    s_waitcnt lgkmcnt(10)
    v_mfma_f32_32x32x16_bf16 v[56:71], v[32:35], v[200:203], v[56:71]
    ds_read_b64_tr_b16 v[28:29], v21 offset:36864
    ds_read_b64_tr_b16 v[30:31], v21 offset:38912
    s_waitcnt vmcnt(2)
    s_waitcnt lgkmcnt(10)
    v_mfma_f32_32x32x16_bf16 v[56:71], v[36:39], v[204:207], v[56:71]
    ds_read_b64_tr_b16 v[32:33], v21 offset:37888
    ds_read_b64_tr_b16 v[34:35], v21 offset:39936
    s_waitcnt vmcnt(1)
    s_waitcnt lgkmcnt(10)
    v_mfma_f32_32x32x16_bf16 v[56:71], v[40:43], v[208:211], v[56:71]
    ds_read_b64_tr_b16 v[36:37], v21 offset:40960
    ds_read_b64_tr_b16 v[38:39], v21 offset:43008
    s_waitcnt vmcnt(0)
    s_waitcnt lgkmcnt(10)
    v_mfma_f32_32x32x16_bf16 v[56:71], v[44:47], v[212:215], v[56:71]
    ds_read_b64_tr_b16 v[40:41], v21 offset:41984
    ds_read_b64_tr_b16 v[42:43], v21 offset:44032
    s_waitcnt lgkmcnt(10)
    v_mfma_f32_32x32x16_bf16 v[72:87], v[48:51], v[216:219], v[72:87]
    ds_read_b64_tr_b16 v[44:45], v21 offset:45056
    ds_read_b64_tr_b16 v[46:47], v21 offset:47104
    s_waitcnt lgkmcnt(10)
    v_mfma_f32_32x32x16_bf16 v[72:87], v[52:55], v[220:223], v[72:87]
    s_nop 3
    v_cvt_pk_bf16_f32 v56, v56, v57
    v_cvt_pk_bf16_f32 v57, v58, v59
    ds_read_b64_tr_b16 v[48:49], v21 offset:46080
    ds_read_b64_tr_b16 v[50:51], v21 offset:48128
    s_waitcnt lgkmcnt(10)
    v_mfma_f32_32x32x16_bf16 v[72:87], v[28:31], v[224:227], v[72:87]
    v_cvt_pk_bf16_f32 v58, v60, v61
    v_cvt_pk_bf16_f32 v59, v62, v63
    ds_read_b64_tr_b16 v[52:53], v21
    ds_read_b64_tr_b16 v[54:55], v21 offset:2048
    s_waitcnt lgkmcnt(10)
    v_mfma_f32_32x32x16_bf16 v[72:87], v[32:35], v[228:231], v[72:87]
    ds_write_b128 v0, v[56:59]
    v_cvt_pk_bf16_f32 v60, v64, v65
    ds_read_b64_tr_b16 v[28:29], v21 offset:1024
    ds_read_b64_tr_b16 v[30:31], v21 offset:3072
    s_waitcnt lgkmcnt(11)
    v_mfma_f32_32x32x16_bf16 v[72:87], v[36:39], v[232:235], v[72:87]
    v_cvt_pk_bf16_f32 v61, v66, v67
    v_cvt_pk_bf16_f32 v62, v68, v69
    ds_read_b64_tr_b16 v[32:33], v21 offset:4096
    ds_read_b64_tr_b16 v[34:35], v21 offset:6144
    s_waitcnt lgkmcnt(11)
    v_mfma_f32_32x32x16_bf16 v[72:87], v[40:43], v[236:239], v[72:87]
    v_cvt_pk_bf16_f32 v63, v70, v71
    ds_write_b128 v0, v[60:63] offset:1024
    ds_read_b64_tr_b16 v[36:37], v21 offset:5120
    ds_read_b64_tr_b16 v[38:39], v21 offset:7168
    s_waitcnt lgkmcnt(12)
    v_mfma_f32_32x32x16_bf16 v[72:87], v[44:47], v[240:243], v[72:87]
    v_subrev_u32 v0, 118784, v0
    ds_read_b64_tr_b16 v[40:41], v21 offset:8192
    ds_read_b64_tr_b16 v[42:43], v21 offset:10240
    s_waitcnt lgkmcnt(12)
    v_mfma_f32_32x32x16_bf16 v[72:87], v[48:51], v[244:247], v[72:87]
    ds_read_b64_tr_b16 v[44:45], v21 offset:9216
    ds_read_b64_tr_b16 v[46:47], v21 offset:11264
    s_waitcnt lgkmcnt(6)
    s_barrier
    v_mfma_f32_32x32x16_bf16 v[72:87], v[52:55], v[152:155], v[72:87]
    ds_read_b64_tr_b16 v[48:49], v21 offset:12288
    ds_read_b64_tr_b16 v[50:51], v21 offset:14336
    v_mfma_f32_32x32x16_bf16 v[72:87], v[28:31], v[156:159], v[72:87]
    ds_read_b64_tr_b16 v[52:53], v21 offset:13312
    ds_read_b64_tr_b16 v[54:55], v21 offset:15360
    v_mfma_f32_32x32x16_bf16 v[72:87], v[32:35], v[160:163], v[72:87]
    ds_read_b64_tr_b16 v[28:29], v21 offset:16384
    ds_read_b64_tr_b16 v[30:31], v21 offset:18432
    s_waitcnt lgkmcnt(10)
    v_mfma_f32_32x32x16_bf16 v[72:87], v[36:39], v[164:167], v[72:87]
    ds_read_b64_tr_b16 v[32:33], v21 offset:17408
    ds_read_b64_tr_b16 v[34:35], v21 offset:19456
    s_waitcnt lgkmcnt(10)
    v_mfma_f32_32x32x16_bf16 v[72:87], v[40:43], v[168:171], v[72:87]
    ds_read_b64_tr_b16 v[36:37], v21 offset:20480
    ds_read_b64_tr_b16 v[38:39], v21 offset:22528
    s_waitcnt lgkmcnt(10)
    v_mfma_f32_32x32x16_bf16 v[72:87], v[44:47], v[172:175], v[72:87]
    ds_read_b64_tr_b16 v[40:41], v21 offset:21504
    ds_read_b64_tr_b16 v[42:43], v21 offset:23552
    s_waitcnt lgkmcnt(10)
    v_mfma_f32_32x32x16_bf16 v[72:87], v[48:51], v[176:179], v[72:87]
    ds_read_b64_tr_b16 v[44:45], v21 offset:24576
    ds_read_b64_tr_b16 v[46:47], v21 offset:26624
    s_waitcnt lgkmcnt(10)
    v_mfma_f32_32x32x16_bf16 v[72:87], v[52:55], v[180:183], v[72:87]
    ds_read_b64_tr_b16 v[48:49], v21 offset:25600
    ds_read_b64_tr_b16 v[50:51], v21 offset:27648
    s_waitcnt lgkmcnt(10)
    v_mfma_f32_32x32x16_bf16 v[72:87], v[28:31], v[184:187], v[72:87]
    ds_read_b64_tr_b16 v[52:53], v21 offset:28672
    ds_read_b64_tr_b16 v[54:55], v21 offset:30720
    s_waitcnt lgkmcnt(10)
    v_mfma_f32_32x32x16_bf16 v[72:87], v[32:35], v[188:191], v[72:87]
    ds_read_b64_tr_b16 v[28:29], v21 offset:29696
    ds_read_b64_tr_b16 v[30:31], v21 offset:31744
    s_waitcnt lgkmcnt(10)
    v_mfma_f32_32x32x16_bf16 v[72:87], v[36:39], v[192:195], v[72:87]
    ds_read_b64_tr_b16 v[32:33], v22 offset:32768
    ds_read_b64_tr_b16 v[34:35], v22 offset:34816
    s_waitcnt lgkmcnt(10)
    v_mfma_f32_32x32x16_bf16 v[72:87], v[40:43], v[196:199], v[72:87]
    ds_read_b64_tr_b16 v[36:37], v23 offset:32768
    ds_read_b64_tr_b16 v[38:39], v23 offset:34816
    s_waitcnt lgkmcnt(10)
    v_mfma_f32_32x32x16_bf16 v[72:87], v[44:47], v[200:203], v[72:87]
    ds_read_b64_tr_b16 v[40:41], v22 offset:33792
    ds_read_b64_tr_b16 v[42:43], v22 offset:35840
    s_waitcnt lgkmcnt(10)
    v_mfma_f32_32x32x16_bf16 v[72:87], v[48:51], v[204:207], v[72:87]
    ds_read_b64_tr_b16 v[44:45], v23 offset:33792
    ds_read_b64_tr_b16 v[46:47], v23 offset:35840
    s_waitcnt lgkmcnt(10)
    v_mfma_f32_32x32x16_bf16 v[72:87], v[52:55], v[208:211], v[72:87]
    ds_read_b64_tr_b16 v[48:49], v22 offset:36864
    ds_read_b64_tr_b16 v[50:51], v22 offset:38912
    s_waitcnt lgkmcnt(10)
    v_mfma_f32_32x32x16_bf16 v[72:87], v[28:31], v[212:215], v[72:87]
    ds_read_b64_tr_b16 v[52:53], v23 offset:36864
    ds_read_b64_tr_b16 v[54:55], v23 offset:38912
    s_waitcnt lgkmcnt(10)
    v_mfma_f32_32x32x16_bf16 v[88:103], v[32:35], v[216:219], v[88:103]
    ds_read_b64_tr_b16 v[28:29], v22 offset:37888
    ds_read_b64_tr_b16 v[30:31], v22 offset:39936
    s_waitcnt lgkmcnt(10)
    v_mfma_f32_32x32x16_bf16 v[104:119], v[36:39], v[216:219], v[104:119]
    s_nop 3
    v_cvt_pk_bf16_f32 v72, v72, v73
    v_cvt_pk_bf16_f32 v73, v74, v75
    ds_read_b64_tr_b16 v[32:33], v23 offset:37888
    ds_read_b64_tr_b16 v[34:35], v23 offset:39936
    s_waitcnt lgkmcnt(10)
    v_mfma_f32_32x32x16_bf16 v[88:103], v[40:43], v[220:223], v[88:103]
    v_cvt_pk_bf16_f32 v74, v76, v77
    v_cvt_pk_bf16_f32 v75, v78, v79
    ds_read_b64_tr_b16 v[36:37], v22 offset:40960
    ds_read_b64_tr_b16 v[38:39], v22 offset:43008
    s_waitcnt lgkmcnt(10)
    v_mfma_f32_32x32x16_bf16 v[104:119], v[44:47], v[220:223], v[104:119]
    ds_write_b128 v0, v[72:75]
    v_cvt_pk_bf16_f32 v76, v80, v81
    ds_read_b64_tr_b16 v[40:41], v23 offset:40960
    ds_read_b64_tr_b16 v[42:43], v23 offset:43008
    s_waitcnt lgkmcnt(11)
    v_mfma_f32_32x32x16_bf16 v[88:103], v[48:51], v[224:227], v[88:103]
    v_cvt_pk_bf16_f32 v77, v82, v83
    v_cvt_pk_bf16_f32 v78, v84, v85
    ds_read_b64_tr_b16 v[44:45], v22 offset:41984
    ds_read_b64_tr_b16 v[46:47], v22 offset:44032
    s_waitcnt lgkmcnt(11)
    v_mfma_f32_32x32x16_bf16 v[104:119], v[52:55], v[224:227], v[104:119]
    v_cvt_pk_bf16_f32 v79, v86, v87
    ds_write_b128 v0, v[76:79] offset:1024
    ds_read_b64_tr_b16 v[48:49], v23 offset:41984
    ds_read_b64_tr_b16 v[50:51], v23 offset:44032
    s_waitcnt lgkmcnt(12)
    v_mfma_f32_32x32x16_bf16 v[88:103], v[28:31], v[228:231], v[88:103]
    ds_read_b64_tr_b16 v[52:53], v22 offset:45056
    ds_read_b64_tr_b16 v[54:55], v22 offset:47104
    s_waitcnt lgkmcnt(12)
    v_mfma_f32_32x32x16_bf16 v[104:119], v[32:35], v[228:231], v[104:119]
    ds_read_b64_tr_b16 v[28:29], v23 offset:45056
    ds_read_b64_tr_b16 v[30:31], v23 offset:47104
    s_waitcnt lgkmcnt(6)
    s_barrier
    v_mfma_f32_32x32x16_bf16 v[88:103], v[36:39], v[232:235], v[88:103]
    s_lshl_b32 s96, s77, 11
    s_add_u32 s14, s96, 32768
    v_and_b32 v0, 7, v1
    ds_read_b64_tr_b16 v[32:33], v22 offset:46080
    ds_read_b64_tr_b16 v[34:35], v22 offset:48128
    v_mfma_f32_32x32x16_bf16 v[104:119], v[40:43], v[232:235], v[104:119]
    v_lshl_add_u32 v0, v0, 4, s14
    ds_read_b64_tr_b16 v[36:37], v23 offset:46080
    ds_read_b64_tr_b16 v[38:39], v23 offset:48128
    v_mfma_f32_32x32x16_bf16 v[88:103], v[44:47], v[236:239], v[88:103]
    v_bfe_u32 v4, v1, 3, 2
    ds_read_b64_tr_b16 v[40:41], v22
    ds_read_b64_tr_b16 v[42:43], v22 offset:2048
    s_waitcnt lgkmcnt(10)
    v_mfma_f32_32x32x16_bf16 v[104:119], v[48:51], v[236:239], v[104:119]
    v_lshl_add_u32 v0, v4, 8, v0
    v_lshrrev_b32 v4, 5, v1
    ds_read_b64_tr_b16 v[44:45], v23
    ds_read_b64_tr_b16 v[46:47], v23 offset:2048
    s_waitcnt lgkmcnt(10)
    v_mfma_f32_32x32x16_bf16 v[88:103], v[52:55], v[240:243], v[88:103]
    v_lshl_add_u32 v0, v4, 7, v0
    ds_read_b64_tr_b16 v[48:49], v22 offset:1024
    ds_read_b64_tr_b16 v[50:51], v22 offset:3072
    s_waitcnt lgkmcnt(10)
    v_mfma_f32_32x32x16_bf16 v[104:119], v[28:31], v[240:243], v[104:119]
    ds_read_b64_tr_b16 v[52:53], v23 offset:1024
    ds_read_b64_tr_b16 v[54:55], v23 offset:3072
    s_waitcnt lgkmcnt(10)
    v_mfma_f32_32x32x16_bf16 v[88:103], v[32:35], v[244:247], v[88:103]
    ds_read_b64_tr_b16 v[28:29], v22 offset:4096
    ds_read_b64_tr_b16 v[30:31], v22 offset:6144
    s_waitcnt lgkmcnt(10)
    v_mfma_f32_32x32x16_bf16 v[104:119], v[36:39], v[244:247], v[104:119]
    ds_read_b64_tr_b16 v[32:33], v23 offset:4096
    ds_read_b64_tr_b16 v[34:35], v23 offset:6144
    s_waitcnt lgkmcnt(10)
    v_mfma_f32_32x32x16_bf16 v[88:103], v[40:43], v[152:155], v[88:103]
    ds_read_b64_tr_b16 v[36:37], v22 offset:5120
    ds_read_b64_tr_b16 v[38:39], v22 offset:7168
    s_waitcnt lgkmcnt(10)
    v_mfma_f32_32x32x16_bf16 v[104:119], v[44:47], v[152:155], v[104:119]
    ds_read_b64_tr_b16 v[40:41], v23 offset:5120
    ds_read_b64_tr_b16 v[42:43], v23 offset:7168
    s_waitcnt lgkmcnt(10)
    v_mfma_f32_32x32x16_bf16 v[88:103], v[48:51], v[156:159], v[88:103]
    ds_read_b64_tr_b16 v[44:45], v22 offset:8192
    ds_read_b64_tr_b16 v[46:47], v22 offset:10240
    s_waitcnt lgkmcnt(10)
    v_mfma_f32_32x32x16_bf16 v[104:119], v[52:55], v[156:159], v[104:119]
    ds_read_b64_tr_b16 v[48:49], v23 offset:8192
    ds_read_b64_tr_b16 v[50:51], v23 offset:10240
    s_waitcnt lgkmcnt(10)
    v_mfma_f32_32x32x16_bf16 v[88:103], v[28:31], v[160:163], v[88:103]
    ds_read_b64_tr_b16 v[52:53], v22 offset:9216
    ds_read_b64_tr_b16 v[54:55], v22 offset:11264
    s_waitcnt lgkmcnt(10)
    v_mfma_f32_32x32x16_bf16 v[104:119], v[32:35], v[160:163], v[104:119]
    ds_read_b64_tr_b16 v[28:29], v23 offset:9216
    ds_read_b64_tr_b16 v[30:31], v23 offset:11264
    s_waitcnt lgkmcnt(10)
    v_mfma_f32_32x32x16_bf16 v[88:103], v[36:39], v[164:167], v[88:103]
    ds_read_b64_tr_b16 v[32:33], v22 offset:12288
    ds_read_b64_tr_b16 v[34:35], v22 offset:14336
    s_waitcnt lgkmcnt(10)
    v_mfma_f32_32x32x16_bf16 v[104:119], v[40:43], v[164:167], v[104:119]
    ds_read_b64_tr_b16 v[36:37], v23 offset:12288
    ds_read_b64_tr_b16 v[38:39], v23 offset:14336
    s_waitcnt lgkmcnt(10)
    v_mfma_f32_32x32x16_bf16 v[88:103], v[44:47], v[168:171], v[88:103]
    ds_read_b64_tr_b16 v[40:41], v22 offset:13312
    ds_read_b64_tr_b16 v[42:43], v22 offset:15360
    s_waitcnt lgkmcnt(10)
    v_mfma_f32_32x32x16_bf16 v[104:119], v[48:51], v[168:171], v[104:119]
    ds_read_b64_tr_b16 v[44:45], v23 offset:13312
    ds_read_b64_tr_b16 v[46:47], v23 offset:15360
    s_waitcnt lgkmcnt(10)
    v_mfma_f32_32x32x16_bf16 v[88:103], v[52:55], v[172:175], v[88:103]
    ds_read_b64_tr_b16 v[48:49], v22 offset:16384
    ds_read_b64_tr_b16 v[50:51], v22 offset:18432
    s_waitcnt lgkmcnt(10)
    v_mfma_f32_32x32x16_bf16 v[104:119], v[28:31], v[172:175], v[104:119]
    ds_read_b64_tr_b16 v[52:53], v23 offset:16384
    ds_read_b64_tr_b16 v[54:55], v23 offset:18432
    s_waitcnt lgkmcnt(10)
    v_mfma_f32_32x32x16_bf16 v[88:103], v[32:35], v[176:179], v[88:103]
    ds_read_b64_tr_b16 v[28:29], v22 offset:17408
    ds_read_b64_tr_b16 v[30:31], v22 offset:19456
    s_waitcnt lgkmcnt(10)
    v_mfma_f32_32x32x16_bf16 v[104:119], v[36:39], v[176:179], v[104:119]
    ds_read_b64_tr_b16 v[32:33], v23 offset:17408
    ds_read_b64_tr_b16 v[34:35], v23 offset:19456
    s_waitcnt lgkmcnt(10)
    v_mfma_f32_32x32x16_bf16 v[88:103], v[40:43], v[180:183], v[88:103]
    ds_read_b64_tr_b16 v[36:37], v22 offset:20480
    ds_read_b64_tr_b16 v[38:39], v22 offset:22528
    s_waitcnt lgkmcnt(10)
    v_mfma_f32_32x32x16_bf16 v[104:119], v[44:47], v[180:183], v[104:119]
    ds_read_b64_tr_b16 v[40:41], v23 offset:20480
    ds_read_b64_tr_b16 v[42:43], v23 offset:22528
    s_waitcnt lgkmcnt(10)
    v_mfma_f32_32x32x16_bf16 v[88:103], v[48:51], v[184:187], v[88:103]
    ds_read_b64_tr_b16 v[44:45], v22 offset:21504
    ds_read_b64_tr_b16 v[46:47], v22 offset:23552
    s_waitcnt lgkmcnt(10)
    v_mfma_f32_32x32x16_bf16 v[104:119], v[52:55], v[184:187], v[104:119]
    ds_read_b64_tr_b16 v[48:49], v23 offset:21504
    ds_read_b64_tr_b16 v[50:51], v23 offset:23552
    s_waitcnt lgkmcnt(10)
    v_mfma_f32_32x32x16_bf16 v[88:103], v[28:31], v[188:191], v[88:103]
    ds_read_b64_tr_b16 v[52:53], v22 offset:24576
    ds_read_b64_tr_b16 v[54:55], v22 offset:26624
    s_waitcnt lgkmcnt(10)
    v_mfma_f32_32x32x16_bf16 v[104:119], v[32:35], v[188:191], v[104:119]
    ds_read_b64_tr_b16 v[28:29], v23 offset:24576
    ds_read_b64_tr_b16 v[30:31], v23 offset:26624
    s_waitcnt lgkmcnt(10)
    v_mfma_f32_32x32x16_bf16 v[88:103], v[36:39], v[192:195], v[88:103]
    ds_read_b64_tr_b16 v[32:33], v22 offset:25600
    ds_read_b64_tr_b16 v[34:35], v22 offset:27648
    s_waitcnt lgkmcnt(10)
    v_mfma_f32_32x32x16_bf16 v[104:119], v[40:43], v[192:195], v[104:119]
    ds_read_b64_tr_b16 v[36:37], v23 offset:25600
    ds_read_b64_tr_b16 v[38:39], v23 offset:27648
    s_waitcnt lgkmcnt(10)
    v_mfma_f32_32x32x16_bf16 v[88:103], v[44:47], v[196:199], v[88:103]
    ds_read_b64_tr_b16 v[40:41], v22 offset:28672
    ds_read_b64_tr_b16 v[42:43], v22 offset:30720
    s_waitcnt lgkmcnt(10)
    v_mfma_f32_32x32x16_bf16 v[104:119], v[48:51], v[196:199], v[104:119]
    ds_read_b64_tr_b16 v[44:45], v23 offset:28672
    ds_read_b64_tr_b16 v[46:47], v23 offset:30720
    s_waitcnt lgkmcnt(10)
    v_mfma_f32_32x32x16_bf16 v[88:103], v[52:55], v[200:203], v[88:103]
    ds_read_b64_tr_b16 v[48:49], v22 offset:29696
    ds_read_b64_tr_b16 v[50:51], v22 offset:31744
    s_waitcnt lgkmcnt(10)
    v_mfma_f32_32x32x16_bf16 v[104:119], v[28:31], v[200:203], v[104:119]
    ds_read_b64_tr_b16 v[52:53], v23 offset:29696
    ds_read_b64_tr_b16 v[54:55], v23 offset:31744
    s_waitcnt lgkmcnt(10)
    v_mfma_f32_32x32x16_bf16 v[88:103], v[32:35], v[204:207], v[88:103]
    ds_read_b64_tr_b16 v[28:29], v24 offset:32768
    ds_read_b64_tr_b16 v[30:31], v24 offset:34816
    s_waitcnt lgkmcnt(10)
    v_mfma_f32_32x32x16_bf16 v[104:119], v[36:39], v[204:207], v[104:119]
    ds_read_b64_tr_b16 v[32:33], v25 offset:32768
    ds_read_b64_tr_b16 v[34:35], v25 offset:34816
    s_waitcnt lgkmcnt(10)
    v_mfma_f32_32x32x16_bf16 v[88:103], v[40:43], v[208:211], v[88:103]
    ds_read_b64_tr_b16 v[36:37], v24 offset:33792
    ds_read_b64_tr_b16 v[38:39], v24 offset:35840
    s_waitcnt lgkmcnt(10)
    v_mfma_f32_32x32x16_bf16 v[104:119], v[44:47], v[208:211], v[104:119]
    ds_read_b64_tr_b16 v[40:41], v25 offset:33792
    ds_read_b64_tr_b16 v[42:43], v25 offset:35840
    s_waitcnt lgkmcnt(10)
    v_mfma_f32_32x32x16_bf16 v[88:103], v[48:51], v[212:215], v[88:103]
    ds_read_b64_tr_b16 v[44:45], v24 offset:36864
    ds_read_b64_tr_b16 v[46:47], v24 offset:38912
    s_waitcnt lgkmcnt(10)
    v_mfma_f32_32x32x16_bf16 v[104:119], v[52:55], v[212:215], v[104:119]
    ds_read_b64_tr_b16 v[48:49], v25 offset:36864
    ds_read_b64_tr_b16 v[50:51], v25 offset:38912
    s_barrier
    s_waitcnt lgkmcnt(10)
    v_mfma_f32_32x32x16_bf16 v[120:135], v[28:31], v[216:219], v[120:135]
    ds_read_b64_tr_b16 v[52:53], v24 offset:37888
    ds_read_b64_tr_b16 v[54:55], v24 offset:39936
    s_waitcnt lgkmcnt(10)
    v_mfma_f32_32x32x16_bf16 v[136:151], v[32:35], v[216:219], v[136:151]
    ds_read_b64_tr_b16 v[28:29], v25 offset:37888
    ds_read_b64_tr_b16 v[30:31], v25 offset:39936
    s_waitcnt lgkmcnt(10)
    v_mfma_f32_32x32x16_bf16 v[120:135], v[36:39], v[220:223], v[120:135]
    v_cvt_pk_bf16_f32 v88, v88, v89
    ds_read_b64_tr_b16 v[32:33], v24 offset:40960
    ds_read_b64_tr_b16 v[34:35], v24 offset:43008
    s_waitcnt lgkmcnt(10)
    v_mfma_f32_32x32x16_bf16 v[136:151], v[40:43], v[220:223], v[136:151]
    v_cvt_pk_bf16_f32 v89, v90, v91
    ds_read_b64_tr_b16 v[36:37], v25 offset:40960
    ds_read_b64_tr_b16 v[38:39], v25 offset:43008
    s_waitcnt lgkmcnt(10)
    v_mfma_f32_32x32x16_bf16 v[120:135], v[44:47], v[224:227], v[120:135]
L_PAD4:
    s_cbranch_execz L_RET4
    v_cvt_pk_bf16_f32 v90, v92, v93
    ds_read_b64_tr_b16 v[40:41], v24 offset:41984
    ds_read_b64_tr_b16 v[42:43], v24 offset:44032
    s_waitcnt lgkmcnt(10)
    v_mfma_f32_32x32x16_bf16 v[136:151], v[48:51], v[224:227], v[136:151]
    v_cvt_pk_bf16_f32 v91, v94, v95
    ds_read_b64_tr_b16 v[44:45], v25 offset:41984
    ds_read_b64_tr_b16 v[46:47], v25 offset:44032
    s_waitcnt lgkmcnt(10)
    v_mfma_f32_32x32x16_bf16 v[120:135], v[52:55], v[228:231], v[120:135]
    ds_write_b128 v0, v[88:91]
    ds_read_b64_tr_b16 v[48:49], v24 offset:45056
    ds_read_b64_tr_b16 v[50:51], v24 offset:47104
    s_waitcnt lgkmcnt(11)
    v_mfma_f32_32x32x16_bf16 v[136:151], v[28:31], v[228:231], v[136:151]
    v_cvt_pk_bf16_f32 v92, v96, v97
    ds_read_b64_tr_b16 v[52:53], v25 offset:45056
    ds_read_b64_tr_b16 v[54:55], v25 offset:47104
    s_waitcnt lgkmcnt(11)
    v_mfma_f32_32x32x16_bf16 v[120:135], v[32:35], v[232:235], v[120:135]
    v_cvt_pk_bf16_f32 v93, v98, v99
    ds_read_b64_tr_b16 v[28:29], v24 offset:46080
    ds_read_b64_tr_b16 v[30:31], v24 offset:48128
    s_waitcnt lgkmcnt(11)
    v_mfma_f32_32x32x16_bf16 v[136:151], v[36:39], v[232:235], v[136:151]
    v_cvt_pk_bf16_f32 v94, v100, v101
    ds_read_b64_tr_b16 v[32:33], v25 offset:46080
    ds_read_b64_tr_b16 v[34:35], v25 offset:48128
    s_waitcnt lgkmcnt(11)
    v_mfma_f32_32x32x16_bf16 v[120:135], v[40:43], v[236:239], v[120:135]
    v_cvt_pk_bf16_f32 v95, v102, v103
    ds_read_b64_tr_b16 v[36:37], v24
    ds_read_b64_tr_b16 v[38:39], v24 offset:2048
    s_waitcnt lgkmcnt(11)
    v_mfma_f32_32x32x16_bf16 v[136:151], v[44:47], v[236:239], v[136:151]
    ds_write_b128 v0, v[92:95] offset:1024
    ds_read_b64_tr_b16 v[40:41], v25
    ds_read_b64_tr_b16 v[42:43], v25 offset:2048
    s_waitcnt lgkmcnt(11)
    v_mfma_f32_32x32x16_bf16 v[120:135], v[48:51], v[240:243], v[120:135]
    v_cvt_pk_bf16_f32 v104, v104, v105
    ds_read_b64_tr_b16 v[44:45], v24 offset:1024
    ds_read_b64_tr_b16 v[46:47], v24 offset:3072
    s_waitcnt lgkmcnt(11)
    v_mfma_f32_32x32x16_bf16 v[136:151], v[52:55], v[240:243], v[136:151]
    v_cvt_pk_bf16_f32 v105, v106, v107
    ds_read_b64_tr_b16 v[48:49], v25 offset:1024
    ds_read_b64_tr_b16 v[50:51], v25 offset:3072
    s_waitcnt lgkmcnt(11)
    v_mfma_f32_32x32x16_bf16 v[120:135], v[28:31], v[244:247], v[120:135]
    v_cvt_pk_bf16_f32 v106, v108, v109
    ds_read_b64_tr_b16 v[52:53], v24 offset:4096
    ds_read_b64_tr_b16 v[54:55], v24 offset:6144
    s_waitcnt lgkmcnt(11)
    v_mfma_f32_32x32x16_bf16 v[136:151], v[32:35], v[244:247], v[136:151]
    v_cvt_pk_bf16_f32 v107, v110, v111
    ds_read_b64_tr_b16 v[28:29], v25 offset:4096
    ds_read_b64_tr_b16 v[30:31], v25 offset:6144
    s_waitcnt lgkmcnt(11)
    v_mfma_f32_32x32x16_bf16 v[120:135], v[36:39], v[152:155], v[120:135]
    ds_write_b128 v0, v[104:107] offset:8192
    ds_read_b64_tr_b16 v[32:33], v24 offset:5120
    ds_read_b64_tr_b16 v[34:35], v24 offset:7168
    s_waitcnt lgkmcnt(11)
    v_mfma_f32_32x32x16_bf16 v[136:151], v[40:43], v[152:155], v[136:151]
    v_cvt_pk_bf16_f32 v108, v112, v113
    ds_read_b64_tr_b16 v[36:37], v25 offset:5120
    ds_read_b64_tr_b16 v[38:39], v25 offset:7168
    s_waitcnt lgkmcnt(11)
    v_mfma_f32_32x32x16_bf16 v[120:135], v[44:47], v[156:159], v[120:135]
    v_cvt_pk_bf16_f32 v109, v114, v115
    ds_read_b64_tr_b16 v[40:41], v24 offset:8192
    ds_read_b64_tr_b16 v[42:43], v24 offset:10240
    s_waitcnt lgkmcnt(11)
    v_mfma_f32_32x32x16_bf16 v[136:151], v[48:51], v[156:159], v[136:151]
    v_cvt_pk_bf16_f32 v110, v116, v117
    ds_read_b64_tr_b16 v[44:45], v25 offset:8192
    ds_read_b64_tr_b16 v[46:47], v25 offset:10240
    s_waitcnt lgkmcnt(11)
    v_mfma_f32_32x32x16_bf16 v[120:135], v[52:55], v[160:163], v[120:135]
    v_cvt_pk_bf16_f32 v111, v118, v119
    ds_read_b64_tr_b16 v[48:49], v24 offset:9216
    ds_read_b64_tr_b16 v[50:51], v24 offset:11264
    s_waitcnt lgkmcnt(11)
    v_mfma_f32_32x32x16_bf16 v[136:151], v[28:31], v[160:163], v[136:151]
    ds_write_b128 v0, v[108:111] offset:9216
    ds_read_b64_tr_b16 v[52:53], v25 offset:9216
    ds_read_b64_tr_b16 v[54:55], v25 offset:11264
    s_waitcnt lgkmcnt(11)
    v_mfma_f32_32x32x16_bf16 v[120:135], v[32:35], v[164:167], v[120:135]
    ds_read_b64_tr_b16 v[28:29], v24 offset:12288
    ds_read_b64_tr_b16 v[30:31], v24 offset:14336
    s_waitcnt lgkmcnt(11)
    v_mfma_f32_32x32x16_bf16 v[136:151], v[36:39], v[164:167], v[136:151]
    ds_read_b64_tr_b16 v[32:33], v25 offset:12288
    ds_read_b64_tr_b16 v[34:35], v25 offset:14336
    s_waitcnt lgkmcnt(11)
    v_mfma_f32_32x32x16_bf16 v[120:135], v[40:43], v[168:171], v[120:135]
    ds_read_b64_tr_b16 v[36:37], v24 offset:13312
    ds_read_b64_tr_b16 v[38:39], v24 offset:15360
    s_waitcnt lgkmcnt(11)
    v_mfma_f32_32x32x16_bf16 v[136:151], v[44:47], v[168:171], v[136:151]
    ds_read_b64_tr_b16 v[40:41], v25 offset:13312
    ds_read_b64_tr_b16 v[42:43], v25 offset:15360
    s_waitcnt lgkmcnt(11)
    v_mfma_f32_32x32x16_bf16 v[120:135], v[48:51], v[172:175], v[120:135]
    ds_read_b64_tr_b16 v[44:45], v24 offset:16384
    ds_read_b64_tr_b16 v[46:47], v24 offset:18432
    s_waitcnt lgkmcnt(10)
    v_mfma_f32_32x32x16_bf16 v[136:151], v[52:55], v[172:175], v[136:151]
    ds_read_b64_tr_b16 v[48:49], v25 offset:16384
    ds_read_b64_tr_b16 v[50:51], v25 offset:18432
    s_waitcnt lgkmcnt(10)
    v_mfma_f32_32x32x16_bf16 v[120:135], v[28:31], v[176:179], v[120:135]
    ds_read_b64_tr_b16 v[52:53], v24 offset:17408
    ds_read_b64_tr_b16 v[54:55], v24 offset:19456
    s_waitcnt lgkmcnt(10)
    v_mfma_f32_32x32x16_bf16 v[136:151], v[32:35], v[176:179], v[136:151]
    ds_read_b64_tr_b16 v[28:29], v25 offset:17408
    ds_read_b64_tr_b16 v[30:31], v25 offset:19456
    s_waitcnt lgkmcnt(10)
    v_mfma_f32_32x32x16_bf16 v[120:135], v[36:39], v[180:183], v[120:135]
    ds_read_b64_tr_b16 v[32:33], v24 offset:20480
    ds_read_b64_tr_b16 v[34:35], v24 offset:22528
    s_waitcnt lgkmcnt(10)
    v_mfma_f32_32x32x16_bf16 v[136:151], v[40:43], v[180:183], v[136:151]
    ds_read_b64_tr_b16 v[36:37], v25 offset:20480
    ds_read_b64_tr_b16 v[38:39], v25 offset:22528
    s_waitcnt lgkmcnt(10)
    v_mfma_f32_32x32x16_bf16 v[120:135], v[44:47], v[184:187], v[120:135]
    ds_read_b64_tr_b16 v[40:41], v24 offset:21504
    ds_read_b64_tr_b16 v[42:43], v24 offset:23552
    s_waitcnt lgkmcnt(10)
    v_mfma_f32_32x32x16_bf16 v[136:151], v[48:51], v[184:187], v[136:151]
    ds_read_b64_tr_b16 v[44:45], v25 offset:21504
    ds_read_b64_tr_b16 v[46:47], v25 offset:23552
    s_waitcnt lgkmcnt(10)
    v_mfma_f32_32x32x16_bf16 v[120:135], v[52:55], v[188:191], v[120:135]
    ds_read_b64_tr_b16 v[48:49], v24 offset:24576
    ds_read_b64_tr_b16 v[50:51], v24 offset:26624
    s_waitcnt lgkmcnt(10)
    v_mfma_f32_32x32x16_bf16 v[136:151], v[28:31], v[188:191], v[136:151]
    ds_read_b64_tr_b16 v[52:53], v25 offset:24576
    ds_read_b64_tr_b16 v[54:55], v25 offset:26624
    s_waitcnt lgkmcnt(10)
    v_mfma_f32_32x32x16_bf16 v[120:135], v[32:35], v[192:195], v[120:135]
    ds_read_b64_tr_b16 v[28:29], v24 offset:25600
    ds_read_b64_tr_b16 v[30:31], v24 offset:27648
    s_waitcnt lgkmcnt(10)
    v_mfma_f32_32x32x16_bf16 v[136:151], v[36:39], v[192:195], v[136:151]
    ds_read_b64_tr_b16 v[32:33], v25 offset:25600
    ds_read_b64_tr_b16 v[34:35], v25 offset:27648
    s_waitcnt lgkmcnt(10)
    v_mfma_f32_32x32x16_bf16 v[120:135], v[40:43], v[196:199], v[120:135]
    ds_read_b64_tr_b16 v[36:37], v24 offset:28672
    ds_read_b64_tr_b16 v[38:39], v24 offset:30720
    s_waitcnt lgkmcnt(10)
    v_mfma_f32_32x32x16_bf16 v[136:151], v[44:47], v[196:199], v[136:151]
    ds_read_b64_tr_b16 v[40:41], v25 offset:28672
    ds_read_b64_tr_b16 v[42:43], v25 offset:30720
    s_waitcnt lgkmcnt(10)
    v_mfma_f32_32x32x16_bf16 v[120:135], v[48:51], v[200:203], v[120:135]
    ds_read_b64_tr_b16 v[44:45], v25 offset:29696
    ds_read_b64_tr_b16 v[46:47], v25 offset:31744
    s_waitcnt lgkmcnt(10)
    v_mfma_f32_32x32x16_bf16 v[136:151], v[52:55], v[200:203], v[136:151]
    ds_read_b64_tr_b16 v[48:49], v24 offset:29696
    ds_read_b64_tr_b16 v[50:51], v24 offset:31744
    s_waitcnt lgkmcnt(10)
    v_mfma_f32_32x32x16_bf16 v[120:135], v[28:31], v[204:207], v[120:135]
    s_waitcnt lgkmcnt(8)
    v_mfma_f32_32x32x16_bf16 v[136:151], v[32:35], v[204:207], v[136:151]
    s_waitcnt lgkmcnt(6)
    v_mfma_f32_32x32x16_bf16 v[120:135], v[36:39], v[208:211], v[120:135]
    s_waitcnt lgkmcnt(4)
    v_mfma_f32_32x32x16_bf16 v[136:151], v[40:43], v[208:211], v[136:151]
    s_waitcnt lgkmcnt(2)
    v_mfma_f32_32x32x16_bf16 v[136:151], v[44:47], v[212:215], v[136:151]
    s_waitcnt lgkmcnt(0)
    v_mfma_f32_32x32x16_bf16 v[120:135], v[48:51], v[212:215], v[120:135]
    s_lshl_b32 s96, s77, 11
    s_add_u32 s14, s96, 151552
    v_add_u32 v0, s14, v2
    v_bfe_u32 v4, v1, 2, 2
    v_lshlrev_b32 v4, 6, v4
    v_bfe_u32 v9, v1, 4, 1
    v_lshl_add_u32 v4, v9, 5, v4
    v_and_b32 v9, 3, v1
    v_lshl_add_u32 v4, v9, 3, v4
    v_lshrrev_b32 v9, 5, v1
    v_lshl_add_u32 v4, v9, 8, v4
    v_add_u32 v4, 159744, v4
    ds_read_b64_tr_b16 v[176:177], v4
    ds_read_b64_tr_b16 v[178:179], v4 offset:512
    ds_read_b64_tr_b16 v[180:181], v4 offset:1024
    ds_read_b64_tr_b16 v[182:183], v4 offset:1536
    v_cvt_pk_bf16_f32 v152, v136, v137
    v_cvt_pk_bf16_f32 v153, v138, v139
    v_cvt_pk_bf16_f32 v154, v140, v141
    v_cvt_pk_bf16_f32 v155, v142, v143
    v_cvt_pk_bf16_f32 v156, v144, v145
    v_cvt_pk_bf16_f32 v157, v146, v147
    v_cvt_pk_bf16_f32 v158, v148, v149
    v_cvt_pk_bf16_f32 v159, v150, v151
    ds_write_b128 v0, v[152:155]
    ds_write_b128 v0, v[156:159] offset:1024
    v_cvt_pk_bf16_f32 v168, v120, v121
    v_cvt_pk_bf16_f32 v169, v122, v123
    v_cvt_pk_bf16_f32 v170, v124, v125
    v_cvt_pk_bf16_f32 v171, v126, v127
    v_cvt_pk_bf16_f32 v172, v128, v129
    v_cvt_pk_bf16_f32 v173, v130, v131
    v_cvt_pk_bf16_f32 v174, v132, v133
    v_cvt_pk_bf16_f32 v175, v134, v135
    s_setprio 0
    s_branch L_JOIN
L_HELP:
    s_barrier
    s_add_u32 s96, s84, 4
    s_and_b32 s97, s96, 15
    s_mul_i32 s98, s97, 393216
    s_add_u32 s99, s98, s85
    s_add_u32 s82, s99, 4294772736
    s_add_u32 m0, s83, 28672
    s_nop 0
    buffer_load_dwordx4 v3, s[40:43], s82 offen lds
    s_add_u32 s96, s84, 4
    s_and_b32 s97, s96, 15
    s_mul_i32 s98, s97, 393216
    s_add_u32 s99, s98, s85
    s_add_u32 s82, s99, 2048
    s_add_u32 m0, s83, 32768
    s_nop 0
    buffer_load_dwordx4 v3, s[40:43], s82 offen lds
    s_add_u32 s96, s84, 4
    s_and_b32 s97, s96, 15
    s_mul_i32 s98, s97, 393216
    s_add_u32 s99, s98, s85
    s_add_u32 s82, s99, 4294774784
    s_add_u32 m0, s83, 77824
    s_nop 0
    buffer_load_dwordx4 v3, s[40:43], s82 offen lds
    s_add_u32 s96, s84, 4
    s_and_b32 s97, s96, 15
    s_mul_i32 s98, s97, 393216
    s_add_u32 s99, s98, s85
    s_add_u32 s82, s99, 4096
    s_add_u32 m0, s83, 81920
    s_nop 0
    buffer_load_dwordx4 v3, s[40:43], s82 offen lds
    s_add_u32 s96, s84, 4
    s_and_b32 s97, s96, 15
    s_mul_i32 s98, s97, 393216
    s_add_u32 s99, s98, s85
    s_add_u32 s82, s99, 4294770688
    s_add_u32 m0, s83, 126976
    s_nop 0
    buffer_load_dwordx4 v3, s[40:43], s82 offen lds
    s_add_u32 s96, s84, 4
    s_and_b32 s97, s96, 15
    s_mul_i32 s98, s97, 393216
    s_add_u32 s82, s98, s85
    s_add_u32 m0, s83, 131072
    s_nop 0
    buffer_load_dwordx4 v3, s[40:43], s82 offen lds
    s_add_u32 s96, s84, 5
    s_and_b32 s97, s96, 15
    s_mul_i32 s98, s97, 393216
    s_add_u32 s99, s98, s85
    s_add_u32 s82, s99, 4294772736
    s_add_u32 m0, s83, 36864
    s_nop 0
    buffer_load_dwordx4 v3, s[40:43], s82 offen lds
    s_add_u32 s96, s84, 5
    s_and_b32 s97, s96, 15
    s_mul_i32 s98, s97, 393216
    s_add_u32 s99, s98, s85
    s_add_u32 s82, s99, 2048
    s_add_u32 m0, s83, 40960
    s_nop 0
    buffer_load_dwordx4 v3, s[40:43], s82 offen lds
    s_add_u32 s96, s84, 5
    s_and_b32 s97, s96, 15
    s_mul_i32 s98, s97, 393216
    s_add_u32 s99, s98, s85
    s_add_u32 s82, s99, 4294774784
    s_add_u32 m0, s83, 86016
    s_nop 0
    buffer_load_dwordx4 v3, s[40:43], s82 offen lds
    s_add_u32 s96, s84, 5
    s_and_b32 s97, s96, 15
    s_mul_i32 s98, s97, 393216
    s_add_u32 s99, s98, s85
    s_add_u32 s82, s99, 4096
    s_add_u32 m0, s83, 90112
    s_nop 0
    buffer_load_dwordx4 v3, s[40:43], s82 offen lds
    s_add_u32 s96, s84, 5
    s_and_b32 s97, s96, 15
    s_mul_i32 s98, s97, 393216
    s_add_u32 s99, s98, s85
    s_add_u32 s82, s99, 4294770688
    s_add_u32 m0, s83, 135168
    s_nop 0
    buffer_load_dwordx4 v3, s[40:43], s82 offen lds
    s_add_u32 s96, s84, 5
    s_and_b32 s97, s96, 15
    s_mul_i32 s98, s97, 393216
    s_add_u32 s82, s98, s85
    s_add_u32 m0, s83, 139264
    s_nop 0
    buffer_load_dwordx4 v3, s[40:43], s82 offen lds
    v_bfe_u32 v4, v1, 2, 2
    v_lshlrev_b32 v4, 6, v4
    v_bfe_u32 v9, v1, 4, 1
    v_lshl_add_u32 v4, v9, 5, v4
    v_and_b32 v9, 3, v1
    v_lshl_add_u32 v4, v9, 3, v4
    v_lshrrev_b32 v9, 5, v1
    v_lshl_add_u32 v4, v9, 8, v4
    v_add_u32 v4, 159744, v4
    ds_read_b64_tr_b16 v[168:169], v4
    ds_read_b64_tr_b16 v[170:171], v4 offset:512
    ds_read_b64_tr_b16 v[172:173], v4 offset:1024
    ds_read_b64_tr_b16 v[174:175], v4 offset:1536
    ds_read_b64_tr_b16 v[176:177], v4 offset:2048
    ds_read_b64_tr_b16 v[178:179], v4 offset:2560
    ds_read_b64_tr_b16 v[180:181], v4 offset:3072
    ds_read_b64_tr_b16 v[182:183], v4 offset:3584
    s_lshl_b32 s14, s77, 10
    v_and_b32 v232, 7, v1
    v_lshl_add_u32 v232, v232, 4, s14
    v_bfe_u32 v9, v1, 3, 2
    v_lshl_add_u32 v232, v9, 8, v232
    v_lshrrev_b32 v9, 5, v1
    v_lshl_add_u32 v232, v9, 7, v232
    s_and_b32 s96, s9, 1
    s_lshl1_add_u32 s18, s96, 1
    s_and_b32 s96, s8, 3
    s_lshl2_add_u32 s97, s96, s3
    s_sub_u32 s98, s97, 4
    s_lshl_b32 s82, s98, 7
    v_lshrrev_b32 v136, 3, v1
    v_lshl_add_u32 v136, v136, 1, s82
    global_load_ushort v120, v136, s[86:87] offset:0
    global_load_ushort v121, v136, s[86:87] offset:16
    global_load_ushort v122, v136, s[86:87] offset:32
    global_load_ushort v123, v136, s[86:87] offset:48
    global_load_ushort v124, v136, s[86:87] offset:64
    global_load_ushort v125, v136, s[86:87] offset:80
    global_load_ushort v126, v136, s[86:87] offset:96
    global_load_ushort v127, v136, s[86:87] offset:112
    s_and_b32 s96, s8, 3
    s_lshl2_add_u32 s97, s96, s3
    s_sub_u32 s98, s97, 4
    s_mul_i32 s99, s98, 786432
    s_lshr_b32 s96, s8, 2
    s_lshl1_add_u32 s97, s9, s96
    s_lshl_b32 s98, s97, 7
    s_add_u32 s96, s99, s98
    s_add_u32 s19, s96, 4096
    s_waitcnt vmcnt(23)
    s_barrier
    s_add_u32 s96, s84, 6
    s_and_b32 s97, s96, 15
    s_mul_i32 s98, s97, 393216
    s_add_u32 s99, s98, s85
    s_add_u32 s82, s99, 4294772736
    s_add_u32 m0, s83, 4294963200
    s_nop 0
    buffer_load_dwordx4 v3, s[40:43], s82 offen lds
    s_add_u32 s96, s84, 6
    s_and_b32 s97, s96, 15
    s_mul_i32 s98, s97, 393216
    s_add_u32 s99, s98, s85
    s_add_u32 s82, s99, 2048
    s_mov_b32 m0, s83
    s_nop 0
    buffer_load_dwordx4 v3, s[40:43], s82 offen lds
    s_add_u32 s96, s84, 6
    s_and_b32 s97, s96, 15
    s_mul_i32 s98, s97, 393216
    s_add_u32 s99, s98, s85
    s_add_u32 s82, s99, 4294770688
    s_add_u32 m0, s83, 94208
    s_nop 0
    buffer_load_dwordx4 v3, s[40:43], s82 offen lds
    s_add_u32 s96, s84, 6
    s_and_b32 s97, s96, 15
    s_mul_i32 s98, s97, 393216
    s_add_u32 s82, s98, s85
    s_add_u32 m0, s83, 98304
    s_nop 0
    buffer_load_dwordx4 v3, s[40:43], s82 offen lds
    s_add_u32 s96, s84, 6
    s_and_b32 s97, s96, 15
    s_mul_i32 s98, s97, 393216
    s_add_u32 s99, s98, s85
    s_add_u32 s82, s99, 4294774784
    s_add_u32 m0, s83, 45056
    s_nop 0
    buffer_load_dwordx4 v3, s[40:43], s82 offen lds
    s_add_u32 s96, s84, 6
    s_and_b32 s97, s96, 15
    s_mul_i32 s98, s97, 393216
    s_add_u32 s99, s98, s85
    s_add_u32 s82, s99, 4096
    s_add_u32 m0, s83, 49152
    s_nop 0
    buffer_load_dwordx4 v3, s[40:43], s82 offen lds
    s_cmp_lg_u32 s18, 1
    s_cbranch_scc1 L_NM2_1_0
    s_mov_b32 s82, s19
    buffer_load_dwordx4 v[88:91], v248, s[48:51], s82 offen nt
    s_add_u32 s82, s19, 98304
    buffer_load_dwordx4 v[92:95], v248, s[48:51], s82 offen nt
    s_add_u32 s82, s19, 196608
    buffer_load_dwordx4 v[96:99], v248, s[48:51], s82 offen nt
    s_add_u32 s82, s19, 294912
    buffer_load_dwordx4 v[100:103], v248, s[48:51], s82 offen nt
    s_add_u32 s82, s19, 393216
    buffer_load_dwordx4 v[104:107], v248, s[48:51], s82 offen nt
    s_add_u32 s82, s19, 491520
    buffer_load_dwordx4 v[108:111], v248, s[48:51], s82 offen nt
    s_add_u32 s82, s19, 589824
    buffer_load_dwordx4 v[112:115], v248, s[48:51], s82 offen nt
    s_add_u32 s82, s19, 688128
    buffer_load_dwordx4 v[116:119], v248, s[48:51], s82 offen nt
L_NM2_1_0:
    s_waitcnt lgkmcnt(0)
    s_load_dword s24, s[32:33], s92 offset:512 glc
    s_load_dword s25, s[32:33], s92 offset:256 glc
    s_load_dword s26, s[32:33], s92 offset:3584 glc
    s_load_dword s27, s[32:33], s92 offset:3328 glc
    s_waitcnt vmcnt(26)
    s_barrier
    s_add_u32 s96, s84, 7
    s_and_b32 s97, s96, 15
    s_mul_i32 s98, s97, 393216
    s_add_u32 s99, s98, s85
    s_add_u32 s82, s99, 4294772736
    s_add_u32 m0, s83, 4096
    s_nop 0
    buffer_load_dwordx4 v3, s[40:43], s82 offen lds
    s_add_u32 s96, s84, 7
    s_and_b32 s97, s96, 15
    s_mul_i32 s98, s97, 393216
    s_add_u32 s99, s98, s85
    s_add_u32 s82, s99, 2048
    s_add_u32 m0, s83, 8192
    s_nop 0
    buffer_load_dwordx4 v3, s[40:43], s82 offen lds
    s_add_u32 s96, s84, 7
    s_and_b32 s97, s96, 15
    s_mul_i32 s98, s97, 393216
    s_add_u32 s99, s98, s85
    s_add_u32 s82, s99, 4294770688
    s_add_u32 m0, s83, 102400
    s_nop 0
    buffer_load_dwordx4 v3, s[40:43], s82 offen lds
    s_add_u32 s96, s84, 7
    s_and_b32 s97, s96, 15
    s_mul_i32 s98, s97, 393216
    s_add_u32 s82, s98, s85
    s_add_u32 m0, s83, 106496
    s_nop 0
    buffer_load_dwordx4 v3, s[40:43], s82 offen lds
    s_add_u32 s96, s84, 7
    s_and_b32 s97, s96, 15
    s_mul_i32 s98, s97, 393216
    s_add_u32 s99, s98, s85
    s_add_u32 s82, s99, 4294774784
    s_add_u32 m0, s83, 53248
    s_nop 0
    buffer_load_dwordx4 v3, s[40:43], s82 offen lds
    s_add_u32 s96, s84, 7
    s_and_b32 s97, s96, 15
    s_mul_i32 s98, s97, 393216
    s_add_u32 s99, s98, s85
    s_add_u32 s82, s99, 4096
    s_add_u32 m0, s83, 57344
    s_nop 0
    buffer_load_dwordx4 v3, s[40:43], s82 offen lds
    s_cmp_lg_u32 s18, 2
    s_cbranch_scc1 L_NM2_2_0
    s_mov_b32 s82, s19
    buffer_load_dwordx4 v[88:91], v248, s[48:51], s82 offen nt
    s_add_u32 s82, s19, 98304
    buffer_load_dwordx4 v[92:95], v248, s[48:51], s82 offen nt
    s_add_u32 s82, s19, 196608
    buffer_load_dwordx4 v[96:99], v248, s[48:51], s82 offen nt
    s_add_u32 s82, s19, 294912
    buffer_load_dwordx4 v[100:103], v248, s[48:51], s82 offen nt
    s_add_u32 s82, s19, 393216
    buffer_load_dwordx4 v[104:107], v248, s[48:51], s82 offen nt
    s_add_u32 s82, s19, 491520
    buffer_load_dwordx4 v[108:111], v248, s[48:51], s82 offen nt
    s_add_u32 s82, s19, 589824
    buffer_load_dwordx4 v[112:115], v248, s[48:51], s82 offen nt
    s_add_u32 s82, s19, 688128
    buffer_load_dwordx4 v[116:119], v248, s[48:51], s82 offen nt
L_NM2_2_0:
    s_waitcnt vmcnt(30)
    s_waitcnt vmcnt(26)
    s_barrier
    s_add_u32 s96, s84, 8
    s_and_b32 s97, s96, 15
    s_mul_i32 s98, s97, 393216
    s_add_u32 s99, s98, s85
    s_add_u32 s82, s99, 4294772736
    s_add_u32 m0, s83, 12288
    s_nop 0
    buffer_load_dwordx4 v3, s[40:43], s82 offen lds
    s_add_u32 s96, s84, 8
    s_and_b32 s97, s96, 15
    s_mul_i32 s98, s97, 393216
    s_add_u32 s99, s98, s85
    s_add_u32 s82, s99, 2048
    s_add_u32 m0, s83, 16384
    s_nop 0
    buffer_load_dwordx4 v3, s[40:43], s82 offen lds
    s_add_u32 s96, s84, 8
    s_and_b32 s97, s96, 15
    s_mul_i32 s98, s97, 393216
    s_add_u32 s99, s98, s85
    s_add_u32 s82, s99, 4294770688
    s_add_u32 m0, s83, 110592
    s_nop 0
    buffer_load_dwordx4 v3, s[40:43], s82 offen lds
    s_add_u32 s96, s84, 8
    s_and_b32 s97, s96, 15
    s_mul_i32 s98, s97, 393216
    s_add_u32 s82, s98, s85
    s_add_u32 m0, s83, 114688
    s_nop 0
    buffer_load_dwordx4 v3, s[40:43], s82 offen lds
    s_add_u32 s96, s84, 8
    s_and_b32 s97, s96, 15
    s_mul_i32 s98, s97, 393216
    s_add_u32 s99, s98, s85
    s_add_u32 s82, s99, 4294774784
    s_add_u32 m0, s83, 61440
    s_nop 0
    buffer_load_dwordx4 v3, s[40:43], s82 offen lds
    s_add_u32 s96, s84, 8
    s_and_b32 s97, s96, 15
    s_mul_i32 s98, s97, 393216
    s_add_u32 s99, s98, s85
    s_add_u32 s82, s99, 4096
    s_add_u32 m0, s83, 65536
    s_nop 0
    buffer_load_dwordx4 v3, s[40:43], s82 offen lds
    s_cmp_lg_u32 s18, 3
    s_cbranch_scc1 L_NM2_3_0
    s_mov_b32 s82, s19
    buffer_load_dwordx4 v[88:91], v248, s[48:51], s82 offen nt
    s_add_u32 s82, s19, 98304
    buffer_load_dwordx4 v[92:95], v248, s[48:51], s82 offen nt
    s_add_u32 s82, s19, 196608
    buffer_load_dwordx4 v[96:99], v248, s[48:51], s82 offen nt
    s_add_u32 s82, s19, 294912
    buffer_load_dwordx4 v[100:103], v248, s[48:51], s82 offen nt
    s_add_u32 s82, s19, 393216
    buffer_load_dwordx4 v[104:107], v248, s[48:51], s82 offen nt
    s_add_u32 s82, s19, 491520
    buffer_load_dwordx4 v[108:111], v248, s[48:51], s82 offen nt
    s_add_u32 s82, s19, 589824
    buffer_load_dwordx4 v[112:115], v248, s[48:51], s82 offen nt
    s_add_u32 s82, s19, 688128
    buffer_load_dwordx4 v[116:119], v248, s[48:51], s82 offen nt
L_NM2_3_0:
    s_waitcnt vmcnt(18)
    v_lshlrev_b32 v120, 16, v120
    v_mul_f32 v136, s7, v120
    v_exp_f32 v136, -v136
    s_nop 0
    v_add_f32 v136, 1.0, v136
    v_rcp_f32 v136, v136
    s_nop 0
    v_mul_f32 v120, v120, v136
    v_cvt_pk_bf16_f32 v120, 0, v120
    v_lshlrev_b32 v121, 16, v121
    v_mul_f32 v137, s7, v121
    v_exp_f32 v137, -v137
    s_nop 0
    v_add_f32 v137, 1.0, v137
    v_rcp_f32 v137, v137
    s_nop 0
    v_mul_f32 v121, v121, v137
    v_cvt_pk_bf16_f32 v121, 0, v121
    v_lshlrev_b32 v122, 16, v122
    v_mul_f32 v136, s7, v122
    v_exp_f32 v136, -v136
    s_nop 0
    v_add_f32 v136, 1.0, v136
    v_rcp_f32 v136, v136
    s_nop 0
    v_mul_f32 v122, v122, v136
    v_cvt_pk_bf16_f32 v122, 0, v122
    v_lshlrev_b32 v123, 16, v123
    v_mul_f32 v137, s7, v123
    v_exp_f32 v137, -v137
    s_nop 0
    v_add_f32 v137, 1.0, v137
    v_rcp_f32 v137, v137
    s_nop 0
    v_mul_f32 v123, v123, v137
    v_cvt_pk_bf16_f32 v123, 0, v123
    v_lshlrev_b32 v124, 16, v124
    v_mul_f32 v136, s7, v124
    v_exp_f32 v136, -v136
    s_nop 0
    v_add_f32 v136, 1.0, v136
    v_rcp_f32 v136, v136
    s_nop 0
    v_mul_f32 v124, v124, v136
    v_cvt_pk_bf16_f32 v124, 0, v124
    v_lshlrev_b32 v125, 16, v125
    v_mul_f32 v137, s7, v125
    v_exp_f32 v137, -v137
    s_nop 0
    v_add_f32 v137, 1.0, v137
    v_rcp_f32 v137, v137
    s_nop 0
    v_mul_f32 v125, v125, v137
    v_cvt_pk_bf16_f32 v125, 0, v125
    v_lshlrev_b32 v126, 16, v126
    v_mul_f32 v136, s7, v126
    v_exp_f32 v136, -v136
    s_nop 0
    v_add_f32 v136, 1.0, v136
    v_rcp_f32 v136, v136
    s_nop 0
    v_mul_f32 v126, v126, v136
    v_cvt_pk_bf16_f32 v126, 0, v126
    v_lshlrev_b32 v127, 16, v127
    v_mul_f32 v137, s7, v127
    v_exp_f32 v137, -v137
    s_nop 0
    v_add_f32 v137, 1.0, v137
    v_rcp_f32 v137, v137
    s_nop 0
    v_mul_f32 v127, v127, v137
    v_cvt_pk_bf16_f32 v127, 0, v127
    s_waitcnt lgkmcnt(0)
    s_load_dword s24, s[32:33], s92 offset:1024 glc
    s_load_dword s25, s[32:33], s92 offset:768 glc
    s_load_dword s26, s[32:33], s92 offset:1536 glc
    s_load_dword s27, s[32:33], s92 offset:1280 glc
L_PAD5:
    s_cbranch_execz L_RET5
    s_barrier
    s_add_u32 s96, s84, 9
    s_and_b32 s97, s96, 15
    s_mul_i32 s98, s97, 393216
    s_add_u32 s99, s98, s85
    s_add_u32 s82, s99, 4294772736
    s_add_u32 m0, s83, 20480
    s_nop 0
    buffer_load_dwordx4 v3, s[40:43], s82 offen lds
    s_add_u32 s96, s84, 9
    s_and_b32 s97, s96, 15
    s_mul_i32 s98, s97, 393216
    s_add_u32 s99, s98, s85
    s_add_u32 s82, s99, 2048
    s_add_u32 m0, s83, 24576
    s_nop 0
    buffer_load_dwordx4 v3, s[40:43], s82 offen lds
    s_add_u32 s96, s84, 9
    s_and_b32 s97, s96, 15
    s_mul_i32 s98, s97, 393216
    s_add_u32 s99, s98, s85
    s_add_u32 s82, s99, 4294770688
    s_add_u32 m0, s83, 118784
    s_nop 0
    buffer_load_dwordx4 v3, s[40:43], s82 offen lds
    s_add_u32 s96, s84, 9
    s_and_b32 s97, s96, 15
    s_mul_i32 s98, s97, 393216
    s_add_u32 s82, s98, s85
    s_add_u32 m0, s83, 122880
    s_nop 0
    buffer_load_dwordx4 v3, s[40:43], s82 offen lds
    s_add_u32 s96, s84, 9
    s_and_b32 s97, s96, 15
    s_mul_i32 s98, s97, 393216
    s_add_u32 s99, s98, s85
    s_add_u32 s82, s99, 4294774784
    s_add_u32 m0, s83, 69632
    s_nop 0
    buffer_load_dwordx4 v3, s[40:43], s82 offen lds
    s_add_u32 s96, s84, 9
    s_and_b32 s97, s96, 15
    s_mul_i32 s98, s97, 393216
    s_add_u32 s99, s98, s85
    s_add_u32 s82, s99, 4096
    s_add_u32 m0, s83, 73728
    s_nop 0
    buffer_load_dwordx4 v3, s[40:43], s82 offen lds
    s_waitcnt vmcnt(22)
    s_waitcnt vmcnt(20)
    s_waitcnt vmcnt(18)
    s_barrier
    s_add_u32 s96, s84, 10
    s_and_b32 s97, s96, 15
    s_mul_i32 s98, s97, 393216
    s_add_u32 s99, s98, s85
    s_add_u32 s82, s99, 4294772736
    s_add_u32 m0, s83, 28672
    s_nop 0
    buffer_load_dwordx4 v3, s[40:43], s82 offen lds
    s_add_u32 s96, s84, 10
    s_and_b32 s97, s96, 15
    s_mul_i32 s98, s97, 393216
    s_add_u32 s99, s98, s85
    s_add_u32 s82, s99, 2048
    s_add_u32 m0, s83, 32768
    s_nop 0
    buffer_load_dwordx4 v3, s[40:43], s82 offen lds
    s_add_u32 s96, s84, 10
    s_and_b32 s97, s96, 15
    s_mul_i32 s98, s97, 393216
    s_add_u32 s99, s98, s85
    s_add_u32 s82, s99, 4294774784
    s_add_u32 m0, s83, 77824
    s_nop 0
    buffer_load_dwordx4 v3, s[40:43], s82 offen lds
    s_add_u32 s96, s84, 10
    s_and_b32 s97, s96, 15
    s_mul_i32 s98, s97, 393216
    s_add_u32 s99, s98, s85
    s_add_u32 s82, s99, 4096
    s_add_u32 m0, s83, 81920
    s_nop 0
    buffer_load_dwordx4 v3, s[40:43], s82 offen lds
    s_waitcnt vmcnt(8)
    v_lshlrev_b32 v136, 16, v88
    v_and_b32 v137, s6, v88
    v_mul_f32 v128, v136, v120
    v_mul_f32 v129, v137, v120
    v_lshlrev_b32 v138, 16, v89
    v_and_b32 v139, s6, v89
    v_mul_f32 v130, v138, v120
    v_mul_f32 v131, v139, v120
    v_lshlrev_b32 v136, 16, v90
    v_and_b32 v137, s6, v90
    v_mul_f32 v132, v136, v120
    v_mul_f32 v133, v137, v120
    v_lshlrev_b32 v138, 16, v91
    v_and_b32 v139, s6, v91
    v_mul_f32 v134, v138, v120
    v_mul_f32 v135, v139, v120
    v_lshlrev_b32 v136, 16, v92
    v_and_b32 v137, s6, v92
    v_fmac_f32 v128, v136, v121
    v_fmac_f32 v129, v137, v121
    v_lshlrev_b32 v138, 16, v93
    v_and_b32 v139, s6, v93
    v_fmac_f32 v130, v138, v121
    v_fmac_f32 v131, v139, v121
    v_lshlrev_b32 v136, 16, v94
    v_and_b32 v137, s6, v94
    v_fmac_f32 v132, v136, v121
    v_fmac_f32 v133, v137, v121
    v_lshlrev_b32 v138, 16, v95
    v_and_b32 v139, s6, v95
    v_fmac_f32 v134, v138, v121
    v_fmac_f32 v135, v139, v121
    v_lshlrev_b32 v136, 16, v96
    v_and_b32 v137, s6, v96
    v_fmac_f32 v128, v136, v122
    v_fmac_f32 v129, v137, v122
    v_lshlrev_b32 v138, 16, v97
    v_and_b32 v139, s6, v97
    v_fmac_f32 v130, v138, v122
    v_fmac_f32 v131, v139, v122
    v_lshlrev_b32 v136, 16, v98
    v_and_b32 v137, s6, v98
    v_fmac_f32 v132, v136, v122
    v_fmac_f32 v133, v137, v122
    v_lshlrev_b32 v138, 16, v99
    v_and_b32 v139, s6, v99
    v_fmac_f32 v134, v138, v122
    v_fmac_f32 v135, v139, v122
    s_waitcnt lgkmcnt(0)
    s_load_dword s24, s[32:33], s92 offset:2560 glc
    s_load_dword s25, s[32:33], s92 offset:2304 glc
    s_load_dword s26, s[32:33], s92 offset:3072 glc
    s_load_dword s27, s[32:33], s92 offset:2816 glc
    s_barrier
    s_add_u32 s96, s84, 11
    s_and_b32 s97, s96, 15
    s_mul_i32 s98, s97, 393216
    s_add_u32 s99, s98, s85
    s_add_u32 s82, s99, 4294772736
    s_add_u32 m0, s83, 36864
    s_nop 0
    buffer_load_dwordx4 v3, s[40:43], s82 offen lds
    s_add_u32 s96, s84, 11
    s_and_b32 s97, s96, 15
    s_mul_i32 s98, s97, 393216
    s_add_u32 s99, s98, s85
    s_add_u32 s82, s99, 2048
    s_add_u32 m0, s83, 40960
    s_nop 0
    buffer_load_dwordx4 v3, s[40:43], s82 offen lds
    s_add_u32 s96, s84, 11
    s_and_b32 s97, s96, 15
    s_mul_i32 s98, s97, 393216
    s_add_u32 s99, s98, s85
    s_add_u32 s82, s99, 4294774784
    s_add_u32 m0, s83, 86016
    s_nop 0
    buffer_load_dwordx4 v3, s[40:43], s82 offen lds
    s_add_u32 s96, s84, 11
    s_and_b32 s97, s96, 15
    s_mul_i32 s98, s97, 393216
    s_add_u32 s99, s98, s85
    s_add_u32 s82, s99, 4096
    s_add_u32 m0, s83, 90112
    s_nop 0
    buffer_load_dwordx4 v3, s[40:43], s82 offen lds
    v_lshlrev_b32 v136, 16, v100
    v_and_b32 v137, s6, v100
    v_fmac_f32 v128, v136, v123
    v_fmac_f32 v129, v137, v123
    v_lshlrev_b32 v138, 16, v101
    v_and_b32 v139, s6, v101
    v_fmac_f32 v130, v138, v123
    v_fmac_f32 v131, v139, v123
    v_lshlrev_b32 v136, 16, v102
    v_and_b32 v137, s6, v102
    v_fmac_f32 v132, v136, v123
    v_fmac_f32 v133, v137, v123
    v_lshlrev_b32 v138, 16, v103
    v_and_b32 v139, s6, v103
    v_fmac_f32 v134, v138, v123
    v_fmac_f32 v135, v139, v123
    v_lshlrev_b32 v136, 16, v104
    v_and_b32 v137, s6, v104
    v_fmac_f32 v128, v136, v124
    v_fmac_f32 v129, v137, v124
    v_lshlrev_b32 v138, 16, v105
    v_and_b32 v139, s6, v105
    v_fmac_f32 v130, v138, v124
    v_fmac_f32 v131, v139, v124
    v_lshlrev_b32 v136, 16, v106
    v_and_b32 v137, s6, v106
    v_fmac_f32 v132, v136, v124
    v_fmac_f32 v133, v137, v124
    v_lshlrev_b32 v138, 16, v107
    v_and_b32 v139, s6, v107
    v_fmac_f32 v134, v138, v124
    v_fmac_f32 v135, v139, v124
    v_lshlrev_b32 v136, 16, v108
    v_and_b32 v137, s6, v108
    v_fmac_f32 v128, v136, v125
    v_fmac_f32 v129, v137, v125
    v_lshlrev_b32 v138, 16, v109
    v_and_b32 v139, s6, v109
    v_fmac_f32 v130, v138, v125
    v_fmac_f32 v131, v139, v125
    v_lshlrev_b32 v136, 16, v110
    v_and_b32 v137, s6, v110
    v_fmac_f32 v132, v136, v125
    v_fmac_f32 v133, v137, v125
    v_lshlrev_b32 v138, 16, v111
    v_and_b32 v139, s6, v111
    v_fmac_f32 v134, v138, v125
    v_fmac_f32 v135, v139, v125
    s_barrier
    s_add_u32 s96, s84, 12
    s_and_b32 s97, s96, 15
    s_mul_i32 s98, s97, 393216
    s_add_u32 s99, s98, s85
    s_add_u32 s82, s99, 4294772736
    s_add_u32 m0, s83, 4294963200
    s_nop 0
    buffer_load_dwordx4 v3, s[40:43], s82 offen lds
    s_add_u32 s96, s84, 12
    s_and_b32 s97, s96, 15
    s_mul_i32 s98, s97, 393216
    s_add_u32 s99, s98, s85
    s_add_u32 s82, s99, 2048
    s_mov_b32 m0, s83
    s_nop 0
    buffer_load_dwordx4 v3, s[40:43], s82 offen lds
    s_add_u32 s96, s84, 12
    s_and_b32 s97, s96, 15
    s_mul_i32 s98, s97, 393216
    s_add_u32 s99, s98, s85
    s_add_u32 s82, s99, 4294774784
    s_add_u32 m0, s83, 45056
    s_nop 0
    buffer_load_dwordx4 v3, s[40:43], s82 offen lds
    s_add_u32 s96, s84, 12
    s_and_b32 s97, s96, 15
    s_mul_i32 s98, s97, 393216
    s_add_u32 s99, s98, s85
    s_add_u32 s82, s99, 4096
    s_add_u32 m0, s83, 49152
    s_nop 0
    buffer_load_dwordx4 v3, s[40:43], s82 offen lds
    v_lshlrev_b32 v136, 16, v112
    v_and_b32 v137, s6, v112
    v_fmac_f32 v128, v136, v126
    v_fmac_f32 v129, v137, v126
    v_lshlrev_b32 v138, 16, v113
    v_and_b32 v139, s6, v113
    v_fmac_f32 v130, v138, v126
    v_fmac_f32 v131, v139, v126
    v_lshlrev_b32 v136, 16, v114
    v_and_b32 v137, s6, v114
    v_fmac_f32 v132, v136, v126
    v_fmac_f32 v133, v137, v126
    v_lshlrev_b32 v138, 16, v115
    v_and_b32 v139, s6, v115
    v_fmac_f32 v134, v138, v126
    v_fmac_f32 v135, v139, v126
    v_lshlrev_b32 v136, 16, v116
    v_and_b32 v137, s6, v116
    v_fmac_f32 v128, v136, v127
    v_fmac_f32 v129, v137, v127
    v_lshlrev_b32 v138, 16, v117
    v_and_b32 v139, s6, v117
    v_fmac_f32 v130, v138, v127
    v_fmac_f32 v131, v139, v127
    v_lshlrev_b32 v136, 16, v118
    v_and_b32 v137, s6, v118
    v_fmac_f32 v132, v136, v127
    v_fmac_f32 v133, v137, v127
    v_lshlrev_b32 v138, 16, v119
    v_and_b32 v139, s6, v119
    v_fmac_f32 v134, v138, v127
    v_fmac_f32 v135, v139, v127
    v_permlane32_swap_b32 v128, v132
    v_permlane32_swap_b32 v129, v133
    v_permlane32_swap_b32 v130, v134
    v_permlane32_swap_b32 v131, v135
    v_add_f32 v128, v128, v132
    v_add_f32 v129, v129, v133
    v_add_f32 v130, v130, v134
    v_add_f32 v131, v131, v135
    s_nop 0
    v_permlane16_swap_b32 v128, v130
    v_permlane16_swap_b32 v129, v131
    v_add_f32 v128, v128, v130
    v_add_f32 v129, v129, v131
    s_nop 0
    v_add_f32_dpp v128, v128, v128 row_ror:8 row_mask:0xf bank_mask:0xf
    v_add_f32_dpp v129, v129, v129 row_ror:8 row_mask:0xf bank_mask:0xf
    s_nop 1
    v_mov_b32_dpp v128, v129 quad_perm:[0,1,2,3] row_mask:0xf bank_mask:0xc
    ds_write_b32 v252, v128 offset:9984
    s_waitcnt lgkmcnt(0)
    s_barrier
    s_add_u32 s96, s84, 13
    s_and_b32 s97, s96, 15
    s_mul_i32 s98, s97, 393216
    s_add_u32 s99, s98, s85
    s_add_u32 s82, s99, 4294772736
    s_add_u32 m0, s83, 4096
    s_nop 0
    buffer_load_dwordx4 v3, s[40:43], s82 offen lds
    s_add_u32 s96, s84, 13
    s_and_b32 s97, s96, 15
    s_mul_i32 s98, s97, 393216
    s_add_u32 s99, s98, s85
    s_add_u32 s82, s99, 2048
    s_add_u32 m0, s83, 8192
    s_nop 0
    buffer_load_dwordx4 v3, s[40:43], s82 offen lds
    s_add_u32 s96, s84, 13
    s_and_b32 s97, s96, 15
    s_mul_i32 s98, s97, 393216
    s_add_u32 s99, s98, s85
    s_add_u32 s82, s99, 4294774784
    s_add_u32 m0, s83, 53248
    s_nop 0
    buffer_load_dwordx4 v3, s[40:43], s82 offen lds
    s_add_u32 s96, s84, 13
    s_and_b32 s97, s96, 15
    s_mul_i32 s98, s97, 393216
    s_add_u32 s99, s98, s85
    s_add_u32 s82, s99, 4096
    s_add_u32 m0, s83, 57344
    s_nop 0
    buffer_load_dwordx4 v3, s[40:43], s82 offen lds
    s_cmp_lg_u32 s3, 4
    s_cbranch_scc1 L_M2F
    ds_read_b128 v[128:131], v251 offset:10000
    s_lshr_b32 s96, s8, 2
    s_lshl1_add_u32 s97, s9, s96
    s_and_b32 s98, s8, 3
    s_lshl2_add_u32 s99, s97, s98
    s_lshl_b32 s96, s99, 9
    s_add_u32 s13, s96, 131072
    s_waitcnt lgkmcnt(0)
    v_add_f32 v128, v128, v129
    v_add_f32 v130, v130, v131
    v_mov_b32 v129, s4
    v_add_f32 v128, v128, v130
    buffer_store_dwordx2 v[128:129], v250, s[32:35], s13 offen sc1
L_M2F:
    s_lshl_b32 s96, s74, 13
    s_sub_u32 s97, s3, 4
    s_lshl_b32 s98, s97, 8
    s_add_u32 s99, s96, s98
    s_add_u32 s13, s99, 20971520
    s_waitcnt lgkmcnt(0)
    s_load_dword s24, s[32:33], s13 offset:1276 glc
    s_load_dword s25, s[32:33], s13 offset:3324 glc
    s_load_dword s26, s[32:33], s13 offset:5372 glc
    s_load_dword s27, s[32:33], s13 offset:7420 glc
    s_waitcnt vmcnt(18)
    s_waitcnt vmcnt(16)
    s_barrier
    s_add_u32 s96, s84, 14
    s_and_b32 s97, s96, 15
    s_mul_i32 s98, s97, 393216
    s_add_u32 s99, s98, s85
    s_add_u32 s82, s99, 4294772736
    s_add_u32 m0, s83, 12288
    s_nop 0
    buffer_load_dwordx4 v3, s[40:43], s82 offen lds
    s_add_u32 s96, s84, 14
    s_and_b32 s97, s96, 15
    s_mul_i32 s98, s97, 393216
    s_add_u32 s99, s98, s85
    s_add_u32 s82, s99, 2048
    s_add_u32 m0, s83, 16384
    s_nop 0
    buffer_load_dwordx4 v3, s[40:43], s82 offen lds
    s_waitcnt vmcnt(16)
    s_waitcnt vmcnt(12)
    s_barrier
    s_add_u32 s96, s84, 15
    s_and_b32 s97, s96, 15
    s_mul_i32 s98, s97, 393216
    s_add_u32 s99, s98, s85
    s_add_u32 s82, s99, 4294772736
    s_add_u32 m0, s83, 20480
    s_nop 0
    buffer_load_dwordx4 v3, s[40:43], s82 offen lds
    s_add_u32 s96, s84, 15
    s_and_b32 s97, s96, 15
    s_mul_i32 s98, s97, 393216
    s_add_u32 s99, s98, s85
    s_add_u32 s82, s99, 2048
    s_add_u32 m0, s83, 24576
    s_nop 0
    buffer_load_dwordx4 v3, s[40:43], s82 offen lds
    s_waitcnt vmcnt(10)
    s_waitcnt vmcnt(6)
    s_waitcnt vmcnt(2)
    s_barrier
    s_add_u32 s96, s84, 14
    s_and_b32 s97, s96, 15
    s_mul_i32 s98, s97, 393216
    s_add_u32 s99, s98, s85
    s_add_u32 s82, s99, 4294774784
    s_add_u32 m0, s83, 61440
    s_nop 0
    buffer_load_dwordx4 v3, s[40:43], s82 offen lds
    s_add_u32 s96, s84, 14
    s_and_b32 s97, s96, 15
    s_mul_i32 s98, s97, 393216
    s_add_u32 s99, s98, s85
    s_add_u32 s82, s99, 4096
    s_add_u32 m0, s83, 65536
    s_nop 0
    buffer_load_dwordx4 v3, s[40:43], s82 offen lds
    s_add_u32 s96, s84, 15
    s_and_b32 s97, s96, 15
    s_mul_i32 s98, s97, 393216
    s_add_u32 s99, s98, s85
    s_add_u32 s82, s99, 4294774784
    s_add_u32 m0, s83, 69632
    s_nop 0
    buffer_load_dwordx4 v3, s[40:43], s82 offen lds
    s_add_u32 s96, s84, 15
    s_and_b32 s97, s96, 15
    s_mul_i32 s98, s97, 393216
    s_add_u32 s99, s98, s85
    s_add_u32 s82, s99, 4096
    s_add_u32 m0, s83, 73728
    s_nop 0
    buffer_load_dwordx4 v3, s[40:43], s82 offen lds
    s_waitcnt vmcnt(4)
    s_barrier
    s_add_u32 s96, s84, 10
    s_and_b32 s97, s96, 15
    s_mul_i32 s98, s97, 393216
    s_add_u32 s99, s98, s85
    s_add_u32 s82, s99, 4294770688
    s_add_u32 m0, s83, 126976
    s_nop 0
    buffer_load_dwordx4 v3, s[40:43], s82 offen lds
    s_add_u32 s96, s84, 10
    s_and_b32 s97, s96, 15
    s_mul_i32 s98, s97, 393216
    s_add_u32 s82, s98, s85
    s_add_u32 m0, s83, 131072
    s_nop 0
    buffer_load_dwordx4 v3, s[40:43], s82 offen lds
    s_add_u32 s96, s84, 11
    s_and_b32 s97, s96, 15
    s_mul_i32 s98, s97, 393216
    s_add_u32 s99, s98, s85
    s_add_u32 s82, s99, 4294770688
    s_add_u32 m0, s83, 135168
    s_nop 0
    buffer_load_dwordx4 v3, s[40:43], s82 offen lds
    s_add_u32 s96, s84, 11
    s_and_b32 s97, s96, 15
    s_mul_i32 s98, s97, 393216
    s_add_u32 s82, s98, s85
    s_add_u32 m0, s83, 139264
    s_nop 0
    buffer_load_dwordx4 v3, s[40:43], s82 offen lds
    s_waitcnt lgkmcnt(0)
    s_barrier
    s_add_u32 s96, s84, 12
    s_and_b32 s97, s96, 15
    s_mul_i32 s98, s97, 393216
    s_add_u32 s99, s98, s85
    s_add_u32 s82, s99, 4294770688
    s_add_u32 m0, s83, 94208
    s_nop 0
    buffer_load_dwordx4 v3, s[40:43], s82 offen lds
    s_add_u32 s96, s84, 12
    s_and_b32 s97, s96, 15
    s_mul_i32 s98, s97, 393216
    s_add_u32 s82, s98, s85
    s_add_u32 m0, s83, 98304
    s_nop 0
    buffer_load_dwordx4 v3, s[40:43], s82 offen lds
    s_add_u32 s96, s84, 13
    s_and_b32 s97, s96, 15
    s_mul_i32 s98, s97, 393216
    s_add_u32 s99, s98, s85
    s_add_u32 s82, s99, 4294770688
    s_add_u32 m0, s83, 102400
    s_nop 0
    buffer_load_dwordx4 v3, s[40:43], s82 offen lds
    s_add_u32 s96, s84, 13
    s_and_b32 s97, s96, 15
    s_mul_i32 s98, s97, 393216
    s_add_u32 s82, s98, s85
    s_add_u32 m0, s83, 106496
    s_nop 0
    buffer_load_dwordx4 v3, s[40:43], s82 offen lds
    s_setprio 3
    ds_read_b128 v[152:155], v0
    ds_read_b128 v[156:159], v0 offset:1024
    v_subrev_u32 v0, 118784, v0
    s_waitcnt lgkmcnt(1)
    v_mfma_f32_32x32x16_bf16 v[184:199], v[168:171], v[152:155], 0
    s_waitcnt lgkmcnt(0)
    v_mfma_f32_32x32x16_bf16 v[184:199], v[172:175], v[156:159], v[184:199]
    s_setprio 0
    s_nop 10
    v_cvt_pk_bf16_f32 v184, 0, v184
    v_cvt_pk_bf16_f32 v185, 0, v185
    v_cvt_pk_bf16_f32 v186, 0, v186
    v_cvt_pk_bf16_f32 v187, 0, v187
    v_cvt_pk_bf16_f32 v188, 0, v188
    v_cvt_pk_bf16_f32 v189, 0, v189
    v_cvt_pk_bf16_f32 v190, 0, v190
    v_cvt_pk_bf16_f32 v191, 0, v191
    v_cvt_pk_bf16_f32 v192, 0, v192
    v_cvt_pk_bf16_f32 v193, 0, v193
    v_cvt_pk_bf16_f32 v194, 0, v194
    v_cvt_pk_bf16_f32 v195, 0, v195
    v_cvt_pk_bf16_f32 v196, 0, v196
    v_cvt_pk_bf16_f32 v197, 0, v197
    v_cvt_pk_bf16_f32 v198, 0, v198
    v_cvt_pk_bf16_f32 v199, 0, v199
    v_max3_f32 v4, v184, v185, v186
    v_min3_f32 v5, v184, v185, v186
    v_max3_f32 v4, v4, v187, v188
    v_min3_f32 v5, v5, v187, v188
    v_max3_f32 v4, v4, v189, v190
    v_min3_f32 v5, v5, v189, v190
    v_max3_f32 v4, v4, v191, v192
    v_min3_f32 v5, v5, v191, v192
    v_max3_f32 v4, v4, v193, v194
    v_min3_f32 v5, v5, v193, v194
    v_max3_f32 v4, v4, v195, v196
    v_min3_f32 v5, v5, v195, v196
    v_max3_f32 v4, v4, v197, v198
    v_min3_f32 v5, v5, v197, v198
    v_max_f32 v6, v4, v199
    v_min_f32 v7, v5, v199
    v_max_f32 v4, v4, v199
    v_min_f32 v5, v5, v199
    s_nop 0
    v_permlane32_swap_b32 v4, v6
    v_permlane32_swap_b32 v5, v7
    v_max_f32 v4, v4, v6
    v_min_f32 v5, v5, v7
    v_mul_f32_e64 v4, v4, s7
    v_mul_f32_e64 v5, v5, s7
    v_fma_f32 v216, v184, s7, -v4
    v_fma_f32 v217, v185, s7, -v4
    v_fma_f32 v184, -v184, s7, v5
    v_fma_f32 v185, -v185, s7, v5
    v_fma_f32 v218, v186, s7, -v4
    v_fma_f32 v219, v187, s7, -v4
    v_fma_f32 v186, -v186, s7, v5
    v_fma_f32 v187, -v187, s7, v5
    s_waitcnt vmcnt(10)
    s_waitcnt vmcnt(8)
    s_waitcnt vmcnt(6)
    s_barrier
    s_add_u32 s96, s84, 14
    s_and_b32 s97, s96, 15
    s_mul_i32 s98, s97, 393216
    s_add_u32 s99, s98, s85
    s_add_u32 s82, s99, 4294770688
    s_add_u32 m0, s83, 110592
    s_nop 0
    buffer_load_dwordx4 v3, s[40:43], s82 offen lds
    s_add_u32 s96, s84, 14
    s_and_b32 s97, s96, 15
    s_mul_i32 s98, s97, 393216
    s_add_u32 s82, s98, s85
    s_add_u32 m0, s83, 114688
    s_nop 0
    buffer_load_dwordx4 v3, s[40:43], s82 offen lds
    s_add_u32 s96, s84, 15
    s_and_b32 s97, s96, 15
    s_mul_i32 s98, s97, 393216
    s_add_u32 s99, s98, s85
    s_add_u32 s82, s99, 4294770688
    s_add_u32 m0, s83, 118784
    s_nop 0
    buffer_load_dwordx4 v3, s[40:43], s82 offen lds
    s_add_u32 s96, s84, 15
    s_and_b32 s97, s96, 15
    s_mul_i32 s98, s97, 393216
    s_add_u32 s82, s98, s85
    s_add_u32 m0, s83, 122880
    s_nop 0
    buffer_load_dwordx4 v3, s[40:43], s82 offen lds
    s_setprio 3
    ds_read_b128 v[152:155], v0
    ds_read_b128 v[156:159], v0 offset:1024
    s_waitcnt lgkmcnt(1)
    v_mfma_f32_32x32x16_bf16 v[200:215], v[176:179], v[152:155], 0
    s_waitcnt lgkmcnt(0)
    v_mfma_f32_32x32x16_bf16 v[200:215], v[180:183], v[156:159], v[200:215]
    s_setprio 0
    v_fma_f32 v220, v188, s7, -v4
    v_fma_f32 v221, v189, s7, -v4
    v_fma_f32 v188, -v188, s7, v5
    v_fma_f32 v189, -v189, s7, v5
    v_fma_f32 v222, v190, s7, -v4
    s_mov_b32 s82, s80
    buffer_load_dwordx4 v[56:59], v27, s[52:55], s82 offen nt
    v_fma_f32 v223, v191, s7, -v4
    v_fma_f32 v190, -v190, s7, v5
    v_fma_f32 v191, -v191, s7, v5
    v_fma_f32 v224, v192, s7, -v4
    v_fma_f32 v225, v193, s7, -v4
    v_fma_f32 v192, -v192, s7, v5
    v_fma_f32 v193, -v193, s7, v5
    v_fma_f32 v226, v194, s7, -v4
    v_fma_f32 v227, v195, s7, -v4
    v_fma_f32 v194, -v194, s7, v5
    v_fma_f32 v195, -v195, s7, v5
    v_fma_f32 v228, v196, s7, -v4
    v_fma_f32 v229, v197, s7, -v4
    v_fma_f32 v196, -v196, s7, v5
    v_fma_f32 v197, -v197, s7, v5
    v_fma_f32 v230, v198, s7, -v4
    v_fma_f32 v231, v199, s7, -v4
    v_fma_f32 v198, -v198, s7, v5
    v_fma_f32 v199, -v199, s7, v5
    v_exp_f32 v216, v216
    s_add_u32 s82, s80, 4294049792
    buffer_load_dwordx4 v[60:63], v27, s[52:55], s82 offen nt
    v_exp_f32 v184, v184
    v_exp_f32 v217, v217
    v_exp_f32 v185, v185
    v_exp_f32 v218, v218
    v_exp_f32 v186, v186
    v_exp_f32 v219, v219
    v_exp_f32 v187, v187
    v_exp_f32 v220, v220
    v_exp_f32 v188, v188
    v_exp_f32 v221, v221
    v_exp_f32 v189, v189
    v_exp_f32 v222, v222
    v_exp_f32 v190, v190
    v_exp_f32 v223, v223
    v_exp_f32 v191, v191
    v_exp_f32 v224, v224
    v_exp_f32 v192, v192
    v_exp_f32 v225, v225
    v_exp_f32 v193, v193
    v_exp_f32 v226, v226
    s_add_u32 s82, s80, 57344
    buffer_load_dwordx4 v[64:67], v27, s[52:55], s82 offen nt
    v_exp_f32 v194, v194
    v_exp_f32 v227, v227
    v_exp_f32 v195, v195
    v_exp_f32 v228, v228
    v_exp_f32 v196, v196
    v_exp_f32 v229, v229
    v_exp_f32 v197, v197
    v_exp_f32 v230, v230
    v_exp_f32 v198, v198
    v_exp_f32 v231, v231
    v_exp_f32 v199, v199
    v_add_f32 v8, v216, v218
    v_add_f32 v9, v217, v219
    v_add_f32 v10, v184, v186
    v_add_f32 v11, v185, v187
    v_add_f32 v8, v8, v220
    v_add_f32 v9, v9, v221
    v_add_f32 v10, v10, v188
    v_add_f32 v11, v11, v189
    v_add_f32 v8, v8, v222
    s_add_u32 s82, s80, 4294107136
    buffer_load_dwordx4 v[68:71], v27, s[52:55], s82 offen nt
    v_add_f32 v9, v9, v223
    v_add_f32 v10, v10, v190
    v_add_f32 v11, v11, v191
    v_add_f32 v8, v8, v224
    v_add_f32 v9, v9, v225
    v_add_f32 v10, v10, v192
    v_add_f32 v11, v11, v193
    v_add_f32 v8, v8, v226
    v_add_f32 v9, v9, v227
    v_add_f32 v10, v10, v194
    v_add_f32 v11, v11, v195
    v_add_f32 v8, v8, v228
    v_add_f32 v9, v9, v229
    v_add_f32 v10, v10, v196
    v_add_f32 v11, v11, v197
    v_add_f32 v8, v8, v230
    v_add_f32 v9, v9, v231
    v_add_f32 v10, v10, v198
    v_add_f32 v11, v11, v199
    v_add_f32 v6, v8, v9
    s_add_u32 s82, s80, 114688
    buffer_load_dwordx4 v[72:75], v27, s[52:55], s82 offen nt
    v_add_f32 v7, v10, v11
    v_add_f32 v4, v8, v9
    v_add_f32 v5, v10, v11
    s_nop 0
    v_permlane32_swap_b32 v4, v6
    v_permlane32_swap_b32 v5, v7
    v_add_f32 v4, v4, v6
    v_add_f32 v5, v5, v7
    v_rcp_f32 v4, v4
    v_rcp_f32 v5, v5
    v_mul_f32 v216, v216, v4
    v_mul_f32 v217, v217, v4
    v_mul_f32 v184, v184, v5
    v_mul_f32 v185, v185, v5
    v_mul_f32 v218, v218, v4
    v_mul_f32 v219, v219, v4
    v_mul_f32 v186, v186, v5
    v_mul_f32 v187, v187, v5
    v_mul_f32 v220, v220, v4
    v_mul_f32 v221, v221, v4
    v_mul_f32 v188, v188, v5
    s_add_u32 s82, s80, 4294164480
    buffer_load_dwordx4 v[76:79], v27, s[52:55], s82 offen nt
    v_mul_f32 v189, v189, v5
    v_mul_f32 v222, v222, v4
    v_mul_f32 v223, v223, v4
    v_mul_f32 v190, v190, v5
    v_mul_f32 v191, v191, v5
    v_mul_f32 v224, v224, v4
    v_mul_f32 v225, v225, v4
    v_mul_f32 v192, v192, v5
    v_mul_f32 v193, v193, v5
    v_mul_f32 v226, v226, v4
    v_mul_f32 v227, v227, v4
    v_mul_f32 v194, v194, v5
    v_mul_f32 v195, v195, v5
    v_mul_f32 v228, v228, v4
    v_mul_f32 v229, v229, v4
    v_mul_f32 v196, v196, v5
    v_mul_f32 v197, v197, v5
    v_mul_f32 v230, v230, v4
    v_mul_f32 v231, v231, v4
    v_mul_f32 v198, v198, v5
    s_add_u32 s82, s80, 172032
    buffer_load_dwordx4 v[80:83], v27, s[52:55], s82 offen nt
    v_mul_f32 v199, v199, v5
    v_cvt_pk_bf16_f32 v216, v216, v217
    v_cvt_pk_bf16_f32 v217, v218, v219
    v_cvt_pk_bf16_f32 v218, v220, v221
    v_cvt_pk_bf16_f32 v219, v222, v223
    v_cvt_pk_bf16_f32 v220, v224, v225
    v_cvt_pk_bf16_f32 v221, v226, v227
    v_cvt_pk_bf16_f32 v222, v228, v229
    v_cvt_pk_bf16_f32 v223, v230, v231
    ds_write_b128 v232, v[216:219]
L_PAD6:
    s_cbranch_execz L_RET6
    v_cvt_pk_bf16_f32 v224, v184, v185
    v_cvt_pk_bf16_f32 v225, v186, v187
    v_cvt_pk_bf16_f32 v226, v188, v189
    v_cvt_pk_bf16_f32 v227, v190, v191
    ds_write_b128 v232, v[220:223] offset:4096
    ds_write_b128 v232, v[224:227] offset:8192
    v_cvt_pk_bf16_f32 v228, v192, v193
    v_cvt_pk_bf16_f32 v229, v194, v195
    v_cvt_pk_bf16_f32 v230, v196, v197
    v_cvt_pk_bf16_f32 v231, v198, v199
    s_add_u32 s82, s80, 4294221824
    buffer_load_dwordx4 v[84:87], v27, s[52:55], s82 offen nt
    ds_write_b128 v232, v[228:231] offset:12288
    s_waitcnt vmcnt(16)
    s_waitcnt vmcnt(14)
    s_waitcnt vmcnt(12)
    s_waitcnt vmcnt(10)
    s_waitcnt vmcnt(8)
    s_barrier
    v_cvt_pk_bf16_f32 v200, 0, v200
    v_cvt_pk_bf16_f32 v201, 0, v201
    v_cvt_pk_bf16_f32 v202, 0, v202
    v_cvt_pk_bf16_f32 v203, 0, v203
    s_xor_b32 s96, s95, 786432
    s_add_u32 s97, s96, s90
    s_sub_u32 s82, s97, 65536
    s_add_u32 m0, s83, 45056
    s_nop 0
    buffer_load_dwordx4 v26, s[44:47], s82 offen lds
    v_cvt_pk_bf16_f32 v204, 0, v204
    v_cvt_pk_bf16_f32 v205, 0, v205
    v_cvt_pk_bf16_f32 v206, 0, v206
    v_cvt_pk_bf16_f32 v207, 0, v207
    v_cvt_pk_bf16_f32 v208, 0, v208
    v_cvt_pk_bf16_f32 v209, 0, v209
    v_cvt_pk_bf16_f32 v210, 0, v210
    v_cvt_pk_bf16_f32 v211, 0, v211
    v_cvt_pk_bf16_f32 v212, 0, v212
    v_cvt_pk_bf16_f32 v213, 0, v213
    v_cvt_pk_bf16_f32 v214, 0, v214
    v_cvt_pk_bf16_f32 v215, 0, v215
    v_max3_f32 v4, v200, v201, v202
    v_min3_f32 v5, v200, v201, v202
    s_xor_b32 s96, s95, 786432
    s_add_u32 s82, s96, s90
    s_add_u32 m0, s83, 49152
    s_nop 0
    buffer_load_dwordx4 v26, s[44:47], s82 offen lds
    v_max3_f32 v4, v4, v203, v204
    v_min3_f32 v5, v5, v203, v204
    v_max3_f32 v4, v4, v205, v206
    v_min3_f32 v5, v5, v205, v206
    v_max3_f32 v4, v4, v207, v208
    v_min3_f32 v5, v5, v207, v208
    v_max3_f32 v4, v4, v209, v210
    v_min3_f32 v5, v5, v209, v210
    v_max3_f32 v4, v4, v211, v212
    v_min3_f32 v5, v5, v211, v212
    v_max3_f32 v4, v4, v213, v214
    v_min3_f32 v5, v5, v213, v214
    v_max_f32 v6, v4, v215
    v_min_f32 v7, v5, v215
    s_xor_b32 s96, s95, 917504
    s_add_u32 s97, s96, s90
    s_sub_u32 s82, s97, 65536
    s_add_u32 m0, s83, 53248
    s_nop 0
    buffer_load_dwordx4 v26, s[44:47], s82 offen lds
    v_max_f32 v4, v4, v215
    s_waitcnt lgkmcnt(0)
    v_min_f32 v5, v5, v215
    v_permlane32_swap_b32 v4, v6
    s_nop 0
    v_permlane32_swap_b32 v5, v7
    v_max_f32 v4, v4, v6
    v_min_f32 v5, v5, v7
    v_mul_f32_e64 v4, v4, s7
    v_mul_f32_e64 v5, v5, s7
    v_fma_f32 v216, v200, s7, -v4
    v_fma_f32 v217, v201, s7, -v4
    v_fma_f32 v200, -v200, s7, v5
    v_fma_f32 v201, -v201, s7, v5
    v_fma_f32 v218, v202, s7, -v4
    s_xor_b32 s96, s95, 917504
    s_add_u32 s82, s96, s90
    s_add_u32 m0, s83, 57344
    s_nop 0
    buffer_load_dwordx4 v26, s[44:47], s82 offen lds
    v_fma_f32 v219, v203, s7, -v4
    v_fma_f32 v202, -v202, s7, v5
    v_fma_f32 v203, -v203, s7, v5
    v_fma_f32 v220, v204, s7, -v4
    v_fma_f32 v221, v205, s7, -v4
    v_fma_f32 v204, -v204, s7, v5
    v_fma_f32 v205, -v205, s7, v5
    v_fma_f32 v222, v206, s7, -v4
    v_fma_f32 v223, v207, s7, -v4
    v_fma_f32 v206, -v206, s7, v5
    v_fma_f32 v207, -v207, s7, v5
    v_fma_f32 v224, v208, s7, -v4
    v_fma_f32 v225, v209, s7, -v4
    v_fma_f32 v208, -v208, s7, v5
    s_xor_b32 s96, s95, 1048576
    s_add_u32 s97, s96, s90
    s_sub_u32 s82, s97, 65536
    s_add_u32 m0, s83, 61440
    s_nop 0
    buffer_load_dwordx4 v26, s[44:47], s82 offen lds
    v_fma_f32 v209, -v209, s7, v5
    v_fma_f32 v226, v210, s7, -v4
    v_fma_f32 v227, v211, s7, -v4
    v_fma_f32 v210, -v210, s7, v5
    v_fma_f32 v211, -v211, s7, v5
    v_fma_f32 v228, v212, s7, -v4
    v_fma_f32 v229, v213, s7, -v4
    v_fma_f32 v212, -v212, s7, v5
    v_fma_f32 v213, -v213, s7, v5
    v_fma_f32 v230, v214, s7, -v4
    v_fma_f32 v231, v215, s7, -v4
    v_fma_f32 v214, -v214, s7, v5
    v_fma_f32 v215, -v215, s7, v5
    v_exp_f32 v216, v216
    s_xor_b32 s96, s95, 1048576
    s_add_u32 s82, s96, s90
    s_add_u32 m0, s83, 65536
    s_nop 0
    buffer_load_dwordx4 v26, s[44:47], s82 offen lds
    v_exp_f32 v200, v200
    v_exp_f32 v217, v217
    v_exp_f32 v201, v201
    v_exp_f32 v218, v218
    v_exp_f32 v202, v202
    v_exp_f32 v219, v219
    v_exp_f32 v203, v203
    v_exp_f32 v220, v220
    v_exp_f32 v204, v204
    v_exp_f32 v221, v221
    v_exp_f32 v205, v205
    v_exp_f32 v222, v222
    v_exp_f32 v206, v206
    v_exp_f32 v223, v223
    s_xor_b32 s96, s95, 1179648
    s_add_u32 s97, s96, s90
    s_sub_u32 s82, s97, 65536
    s_add_u32 m0, s83, 69632
    s_nop 0
    buffer_load_dwordx4 v26, s[44:47], s82 offen lds
    v_exp_f32 v207, v207
    v_exp_f32 v224, v224
    v_exp_f32 v208, v208
    v_exp_f32 v225, v225
    v_exp_f32 v209, v209
    v_exp_f32 v226, v226
    v_exp_f32 v210, v210
    v_exp_f32 v227, v227
    v_exp_f32 v211, v211
    v_exp_f32 v228, v228
    v_exp_f32 v212, v212
    v_exp_f32 v229, v229
    v_exp_f32 v213, v213
    v_exp_f32 v230, v230
    s_xor_b32 s96, s95, 1179648
    s_add_u32 s82, s96, s90
    s_add_u32 m0, s83, 73728
    s_nop 0
    buffer_load_dwordx4 v26, s[44:47], s82 offen lds
    v_exp_f32 v214, v214
    v_exp_f32 v231, v231
    v_exp_f32 v215, v215
    v_add_f32 v8, v216, v218
    v_add_f32 v9, v217, v219
    v_add_f32 v10, v200, v202
    v_add_f32 v11, v201, v203
    v_add_f32 v8, v8, v220
    v_add_f32 v9, v9, v221
    v_add_f32 v10, v10, v204
    v_add_f32 v11, v11, v205
    v_add_f32 v8, v8, v222
    v_add_f32 v9, v9, v223
    v_add_f32 v10, v10, v206
    s_xor_b32 s96, s95, 1310720
    s_add_u32 s97, s96, s90
    s_sub_u32 s82, s97, 65536
    s_add_u32 m0, s83, 77824
    s_nop 0
    buffer_load_dwordx4 v26, s[44:47], s82 offen lds
    v_add_f32 v11, v11, v207
    v_add_f32 v8, v8, v224
    v_add_f32 v9, v9, v225
    v_add_f32 v10, v10, v208
    v_add_f32 v11, v11, v209
    v_add_f32 v8, v8, v226
    v_add_f32 v9, v9, v227
    v_add_f32 v10, v10, v210
    v_add_f32 v11, v11, v211
    v_add_f32 v8, v8, v228
    v_add_f32 v9, v9, v229
    v_add_f32 v10, v10, v212
    v_add_f32 v11, v11, v213
    v_add_f32 v8, v8, v230
    s_xor_b32 s96, s95, 1310720
    s_add_u32 s82, s96, s90
    s_add_u32 m0, s83, 81920
    s_nop 0
    buffer_load_dwordx4 v26, s[44:47], s82 offen lds
    v_add_f32 v9, v9, v231
    v_add_f32 v10, v10, v214
    v_add_f32 v11, v11, v215
    v_add_f32 v6, v8, v9
    v_add_f32 v7, v10, v11
    v_add_f32 v4, v8, v9
    v_add_f32 v5, v10, v11
    s_nop 0
    v_permlane32_swap_b32 v4, v6
    v_permlane32_swap_b32 v5, v7
    v_add_f32 v4, v4, v6
    v_add_f32 v5, v5, v7
    v_rcp_f32 v4, v4
    v_rcp_f32 v5, v5
    v_mul_f32 v216, v216, v4
    s_xor_b32 s96, s95, 1441792
    s_add_u32 s97, s96, s90
    s_sub_u32 s82, s97, 65536
    s_add_u32 m0, s83, 86016
    s_nop 0
    buffer_load_dwordx4 v26, s[44:47], s82 offen lds
    v_mul_f32 v217, v217, v4
    v_mul_f32 v200, v200, v5
    v_mul_f32 v201, v201, v5
    v_mul_f32 v218, v218, v4
    v_mul_f32 v219, v219, v4
    v_mul_f32 v202, v202, v5
    v_mul_f32 v203, v203, v5
    v_mul_f32 v220, v220, v4
    v_mul_f32 v221, v221, v4
    v_mul_f32 v204, v204, v5
    v_mul_f32 v205, v205, v5
    v_mul_f32 v222, v222, v4
    v_mul_f32 v223, v223, v4
    v_mul_f32 v206, v206, v5
    s_xor_b32 s96, s95, 1441792
    s_add_u32 s82, s96, s90
    s_add_u32 m0, s83, 90112
    s_nop 0
    buffer_load_dwordx4 v26, s[44:47], s82 offen lds
    v_mul_f32 v207, v207, v5
    v_mul_f32 v224, v224, v4
    v_mul_f32 v225, v225, v4
    v_mul_f32 v208, v208, v5
    v_mul_f32 v209, v209, v5
    v_mul_f32 v226, v226, v4
    v_mul_f32 v227, v227, v4
    v_mul_f32 v210, v210, v5
    v_mul_f32 v211, v211, v5
    v_mul_f32 v228, v228, v4
    v_mul_f32 v229, v229, v4
    v_mul_f32 v212, v212, v5
    v_mul_f32 v213, v213, v5
    v_mul_f32 v230, v230, v4
    v_mul_f32 v231, v231, v4
    v_mul_f32 v214, v214, v5
    v_mul_f32 v215, v215, v5
    v_cvt_pk_bf16_f32 v216, v216, v217
    v_cvt_pk_bf16_f32 v217, v218, v219
    v_cvt_pk_bf16_f32 v218, v220, v221
    v_cvt_pk_bf16_f32 v219, v222, v223
    v_cvt_pk_bf16_f32 v220, v224, v225
    v_cvt_pk_bf16_f32 v221, v226, v227
    v_cvt_pk_bf16_f32 v222, v228, v229
    v_cvt_pk_bf16_f32 v223, v230, v231
    ds_write_b128 v232, v[216:219] offset:16384
    v_cvt_pk_bf16_f32 v224, v200, v201
    v_cvt_pk_bf16_f32 v225, v202, v203
    v_cvt_pk_bf16_f32 v226, v204, v205
    v_cvt_pk_bf16_f32 v227, v206, v207
    ds_write_b128 v232, v[220:223] offset:20480
    ds_write_b128 v232, v[224:227] offset:24576
    v_cvt_pk_bf16_f32 v228, v208, v209
    v_cvt_pk_bf16_f32 v229, v210, v211
    v_cvt_pk_bf16_f32 v230, v212, v213
    v_cvt_pk_bf16_f32 v231, v214, v215
    ds_write_b128 v232, v[228:231] offset:28672
    s_lshl_b32 s96, s77, 11
    s_add_u32 s14, s96, 151552
    v_add_u32 v0, s14, v2
    s_setprio 0
L_JOIN:
    v_and_b32 v45, 1, v1
    v_lshlrev_b32 v45, 3, v45
    v_bfe_u32 v9, v1, 2, 2
    v_lshl_add_u32 v45, v9, 4, v45
    v_bfe_u32 v9, v1, 4, 1
    v_lshl_add_u32 v45, v9, 6, v45
    v_bfe_u32 v9, v1, 1, 1
    v_lshl_add_u32 v45, v9, 7, v45
    v_lshrrev_b32 v9, 5, v1
    v_lshl_add_u32 v45, v9, 8, v45
    s_lshl_b32 s13, s3, 12
    v_add_u32 v44, s13, v45
    s_lshl_b32 s96, s76, 13
    s_add_u32 s13, s96, 32768
    v_add_u32 v45, s13, v45
    v_mov_b32 v244, 0x3f803f80
    v_mov_b32 v245, 0x3f803f80
    v_mov_b32 v246, 0x3f803f80
    v_mov_b32 v247, 0x3f803f80
    s_lshl3_add_u32 s96, s11, s3
    s_lshl_b32 s97, s96, 5
    s_add_u32 s98, s97, s10
    s_lshl_b32 s99, s98, 10
    s_add_u32 s13, s99, 25165824
    s_add_u32 s15, s13, 16384
    s_lshl3_add_u32 s96, s11, s3
    s_lshl_b32 s97, s96, 10
    s_add_u32 s16, s97, 21495808
    s_lshl_b32 s96, s10, 6
    s_add_u32 s14, s96, s16
    s_waitcnt lgkmcnt(0)
    s_barrier
    ds_read_b64_tr_b16 v[184:185], v44
    ds_read_b64_tr_b16 v[186:187], v44 offset:512
    ds_read_b64_tr_b16 v[200:201], v45
    ds_read_b64_tr_b16 v[202:203], v45 offset:512
    ds_read_b64_tr_b16 v[204:205], v45 offset:1024
    ds_read_b64_tr_b16 v[206:207], v45 offset:1536
    ds_read_b64_tr_b16 v[188:189], v44 offset:1024
    ds_read_b64_tr_b16 v[190:191], v44 offset:1536
    ds_read_b64_tr_b16 v[208:209], v45 offset:2048
    ds_read_b64_tr_b16 v[210:211], v45 offset:2560
    ds_read_b64_tr_b16 v[212:213], v45 offset:3072
    ds_read_b64_tr_b16 v[214:215], v45 offset:3584
    ds_read_b64_tr_b16 v[192:193], v44 offset:2048
    ds_read_b64_tr_b16 v[194:195], v44 offset:2560
    ds_read_b64_tr_b16 v[216:217], v45 offset:4096
    ds_read_b64_tr_b16 v[218:219], v45 offset:4608
    ds_read_b64_tr_b16 v[220:221], v45 offset:5120
    ds_read_b64_tr_b16 v[222:223], v45 offset:5632
    s_waitcnt lgkmcnt(12)
    v_mfma_f32_16x16x32_bf16 v[232:235], v[184:187], v[200:203], 0
    v_mfma_f32_16x16x32_bf16 v[236:239], v[184:187], v[204:207], 0
    v_mfma_f32_16x16x32_bf16 v[240:243], v[184:187], v[244:247], 0
    ds_read_b64_tr_b16 v[196:197], v44 offset:3072
    ds_read_b64_tr_b16 v[198:199], v44 offset:3584
    ds_read_b64_tr_b16 v[224:225], v45 offset:6144
    ds_read_b64_tr_b16 v[226:227], v45 offset:6656
    ds_read_b64_tr_b16 v[228:229], v45 offset:7168
    ds_read_b64_tr_b16 v[230:231], v45 offset:7680
    s_waitcnt lgkmcnt(12)
    v_mfma_f32_16x16x32_bf16 v[232:235], v[188:191], v[208:211], v[232:235]
    v_mfma_f32_16x16x32_bf16 v[236:239], v[188:191], v[212:215], v[236:239]
    v_mfma_f32_16x16x32_bf16 v[240:243], v[188:191], v[244:247], v[240:243]
    s_waitcnt lgkmcnt(6)
    v_mfma_f32_16x16x32_bf16 v[232:235], v[192:195], v[216:219], v[232:235]
    v_mfma_f32_16x16x32_bf16 v[236:239], v[192:195], v[220:223], v[236:239]
    v_mfma_f32_16x16x32_bf16 v[240:243], v[192:195], v[244:247], v[240:243]
    s_waitcnt lgkmcnt(0)
    v_mfma_f32_16x16x32_bf16 v[232:235], v[196:199], v[224:227], v[232:235]
    v_mfma_f32_16x16x32_bf16 v[236:239], v[196:199], v[228:231], v[236:239]
    v_mfma_f32_16x16x32_bf16 v[240:243], v[196:199], v[244:247], v[240:243]
    s_cmp_lt_u32 s3, 4
    s_cbranch_scc1 L_NOQX
    ds_read_b128 v[168:171], v0
    ds_read_b128 v[172:175], v0 offset:1024
L_NOQX:
    s_nop 3
    buffer_store_dwordx4 v[232:235], v2, s[32:35], s13 offen sc1
    buffer_store_dwordx4 v[236:239], v2, s[32:35], s15 offen sc1
    s_mov_b32 exec_lo, 0x00010001
    s_mov_b32 exec_hi, 0x00010001
    buffer_store_dwordx4 v[240:243], v1, s[32:35], s14 offen sc1
    s_mov_b64 exec, -1
    s_waitcnt lgkmcnt(0)
    v_mfma_f32_32x32x16_bf16 v[120:135], v[176:179], v[168:171], 0
    v_mfma_f32_32x32x16_bf16 v[120:135], v[180:183], v[172:175], v[120:135]
    v_and_b32 v46, 7, v1
    v_lshlrev_b32 v46, 17, v46
    v_bfe_u32 v9, v1, 3, 1
    v_lshl_add_u32 v46, v9, 14, v46
    s_and_b32 s96, s10, 1
    s_and_b32 s97, s2, 27
    s_lshl_b32 s98, s97, 12
    s_lshr_b32 s99, s10, 1
    s_lshl_b32 s97, s99, 6
    s_add_u32 s99, s98, s97
    s_lshl2_add_u32 s98, s96, s99
    s_add_u32 s97, s98, 1048576
    s_add_u32 s17, s97, 512
    v_lshrrev_b32 v47, 3, v1
    v_lshlrev_b32 v47, 10, v47
    v_and_b32 v9, 7, v1
    v_lshl_add_u32 v47, v9, 4, v47
    v_and_b32 v48, 7, v1
    v_lshlrev_b32 v48, 4, v48
    v_lshrrev_b32 v9, 5, v1
    v_lshl_add_u32 v48, v9, 3, v48
    v_cvt_pk_bf16_f32 v120, 0, v120
    v_cvt_pk_bf16_f32 v121, 0, v121
    v_cvt_pk_bf16_f32 v122, 0, v122
    v_cvt_pk_bf16_f32 v123, 0, v123
    v_cvt_pk_bf16_f32 v124, 0, v124
    v_cvt_pk_bf16_f32 v125, 0, v125
    v_cvt_pk_bf16_f32 v126, 0, v126
    v_cvt_pk_bf16_f32 v127, 0, v127
    v_cvt_pk_bf16_f32 v128, 0, v128
    v_cvt_pk_bf16_f32 v129, 0, v129
    v_cvt_pk_bf16_f32 v130, 0, v130
    v_cvt_pk_bf16_f32 v131, 0, v131
    v_cvt_pk_bf16_f32 v132, 0, v132
    v_cvt_pk_bf16_f32 v133, 0, v133
    v_cvt_pk_bf16_f32 v134, 0, v134
    v_cvt_pk_bf16_f32 v135, 0, v135
    v_max3_f32 v4, v120, v121, v122
    v_min3_f32 v5, v120, v121, v122
    v_max3_f32 v4, v4, v123, v124
    v_min3_f32 v5, v5, v123, v124
    v_max3_f32 v4, v4, v125, v126
    v_min3_f32 v5, v5, v125, v126
    v_max3_f32 v4, v4, v127, v128
    v_min3_f32 v5, v5, v127, v128
    v_max3_f32 v4, v4, v129, v130
    v_min3_f32 v5, v5, v129, v130
    v_max3_f32 v4, v4, v131, v132
    v_min3_f32 v5, v5, v131, v132
    v_max3_f32 v4, v4, v133, v134
    v_min3_f32 v5, v5, v133, v134
    v_max_f32 v6, v4, v135
    v_min_f32 v7, v5, v135
    v_max_f32 v4, v4, v135
    v_min_f32 v5, v5, v135
    s_nop 0
    v_permlane32_swap_b32 v4, v6
    v_permlane32_swap_b32 v5, v7
    v_max_f32 v4, v4, v6
    v_min_f32 v5, v5, v7
    v_pk_mul_f32 v[4:5], v[4:5], s[6:7] op_sel:[0,1]
    v_mov_b32 v6, v5
    v_pk_fma_f32 v[136:137], v[120:121], s[6:7], v[4:5] op_sel:[0,1,0] op_sel_hi:[1,1,0] neg_lo:[0,0,1] neg_hi:[0,0,1]
    v_pk_fma_f32 v[120:121], v[120:121], s[6:7], v[6:7] op_sel:[0,1,0] op_sel_hi:[1,1,0] neg_lo:[1,0,0] neg_hi:[1,0,0]
    v_pk_fma_f32 v[138:139], v[122:123], s[6:7], v[4:5] op_sel:[0,1,0] op_sel_hi:[1,1,0] neg_lo:[0,0,1] neg_hi:[0,0,1]
    v_pk_fma_f32 v[122:123], v[122:123], s[6:7], v[6:7] op_sel:[0,1,0] op_sel_hi:[1,1,0] neg_lo:[1,0,0] neg_hi:[1,0,0]
    v_pk_fma_f32 v[140:141], v[124:125], s[6:7], v[4:5] op_sel:[0,1,0] op_sel_hi:[1,1,0] neg_lo:[0,0,1] neg_hi:[0,0,1]
    v_pk_fma_f32 v[124:125], v[124:125], s[6:7], v[6:7] op_sel:[0,1,0] op_sel_hi:[1,1,0] neg_lo:[1,0,0] neg_hi:[1,0,0]
    v_pk_fma_f32 v[142:143], v[126:127], s[6:7], v[4:5] op_sel:[0,1,0] op_sel_hi:[1,1,0] neg_lo:[0,0,1] neg_hi:[0,0,1]
    v_pk_fma_f32 v[126:127], v[126:127], s[6:7], v[6:7] op_sel:[0,1,0] op_sel_hi:[1,1,0] neg_lo:[1,0,0] neg_hi:[1,0,0]
    v_pk_fma_f32 v[144:145], v[128:129], s[6:7], v[4:5] op_sel:[0,1,0] op_sel_hi:[1,1,0] neg_lo:[0,0,1] neg_hi:[0,0,1]
    v_pk_fma_f32 v[128:129], v[128:129], s[6:7], v[6:7] op_sel:[0,1,0] op_sel_hi:[1,1,0] neg_lo:[1,0,0] neg_hi:[1,0,0]
    v_pk_fma_f32 v[146:147], v[130:131], s[6:7], v[4:5] op_sel:[0,1,0] op_sel_hi:[1,1,0] neg_lo:[0,0,1] neg_hi:[0,0,1]
    v_pk_fma_f32 v[130:131], v[130:131], s[6:7], v[6:7] op_sel:[0,1,0] op_sel_hi:[1,1,0] neg_lo:[1,0,0] neg_hi:[1,0,0]
    v_pk_fma_f32 v[148:149], v[132:133], s[6:7], v[4:5] op_sel:[0,1,0] op_sel_hi:[1,1,0] neg_lo:[0,0,1] neg_hi:[0,0,1]
    v_pk_fma_f32 v[132:133], v[132:133], s[6:7], v[6:7] op_sel:[0,1,0] op_sel_hi:[1,1,0] neg_lo:[1,0,0] neg_hi:[1,0,0]
    v_pk_fma_f32 v[150:151], v[134:135], s[6:7], v[4:5] op_sel:[0,1,0] op_sel_hi:[1,1,0] neg_lo:[0,0,1] neg_hi:[0,0,1]
    v_pk_fma_f32 v[134:135], v[134:135], s[6:7], v[6:7] op_sel:[0,1,0] op_sel_hi:[1,1,0] neg_lo:[1,0,0] neg_hi:[1,0,0]
    v_exp_f32 v136, v136
    v_exp_f32 v120, v120
    v_exp_f32 v137, v137
    v_exp_f32 v121, v121
    v_exp_f32 v138, v138
    v_exp_f32 v122, v122
    v_exp_f32 v139, v139
    v_exp_f32 v123, v123
    v_exp_f32 v140, v140
    v_exp_f32 v124, v124
    v_exp_f32 v141, v141
    v_exp_f32 v125, v125
    v_exp_f32 v142, v142
    v_exp_f32 v126, v126
    v_exp_f32 v143, v143
    v_exp_f32 v127, v127
    s_waitcnt vmcnt(0)
    s_barrier
    s_cmp_lg_u32 s3, 0
    s_cbranch_scc1 L_PC
    v_mov_b32 v45, s4
    s_mov_b32 exec_hi, 0
    s_mov_b32 exec_lo, 65535
    buffer_store_dword v45, v46, s[32:35], s17 offen sc1
    s_mov_b64 exec, -1
L_PC:
    s_xor_b32 s96, s95, 1572864
    s_add_u32 s82, s96, s90
    s_add_u32 m0, s83, 98304
    s_nop 0
    buffer_load_dwordx4 v26, s[44:47], s82 offen lds
    v_exp_f32 v144, v144
    v_exp_f32 v128, v128
    v_exp_f32 v145, v145
    v_exp_f32 v129, v129
    v_exp_f32 v146, v146
    v_exp_f32 v130, v130
    v_exp_f32 v147, v147
    v_exp_f32 v131, v131
    s_xor_b32 s96, s95, 1703936
    s_add_u32 s82, s96, s90
    s_add_u32 m0, s83, 106496
    s_nop 0
    buffer_load_dwordx4 v26, s[44:47], s82 offen lds
    v_exp_f32 v148, v148
    v_exp_f32 v132, v132
    v_exp_f32 v149, v149
    v_exp_f32 v133, v133
    v_exp_f32 v150, v150
    v_exp_f32 v134, v134
    v_exp_f32 v151, v151
    v_exp_f32 v135, v135
    s_lshl4_add_u32 s96, s11, s10
    s_lshl_b32 s97, s96, 14
    s_lshl_b32 s98, s3, 7
    s_add_u32 s99, s97, s98
    s_add_u32 s13, s99, 25165824
    s_add_u32 s14, s13, 8192
    s_lshl4_add_u32 s96, s11, s10
    s_lshl_b32 s97, s96, 10
    s_lshl_b32 s98, s3, 7
    s_add_u32 s99, s97, s98
    s_add_u32 s15, s99, 29360128
    s_add_u32 s17, s17, 3072
    s_load_dwordx2 s[24:25], s[32:33], s92 offset:512 glc
    s_xor_b32 s96, s95, 1835008
    s_add_u32 s82, s96, s90
    s_add_u32 m0, s83, 114688
    s_nop 0
    buffer_load_dwordx4 v26, s[44:47], s82 offen lds
    v_pk_add_f32 v[8:9], v[136:137], v[138:139]
    v_pk_add_f32 v[10:11], v[120:121], v[122:123]
    v_pk_add_f32 v[8:9], v[8:9], v[140:141]
    v_pk_add_f32 v[10:11], v[10:11], v[124:125]
    v_pk_add_f32 v[8:9], v[8:9], v[142:143]
    v_pk_add_f32 v[10:11], v[10:11], v[126:127]
    v_pk_add_f32 v[8:9], v[8:9], v[144:145]
    v_pk_add_f32 v[10:11], v[10:11], v[128:129]
    v_pk_add_f32 v[8:9], v[8:9], v[146:147]
    v_pk_add_f32 v[10:11], v[10:11], v[130:131]
    v_pk_add_f32 v[8:9], v[8:9], v[148:149]
    v_pk_add_f32 v[10:11], v[10:11], v[132:133]
    v_pk_add_f32 v[8:9], v[8:9], v[150:151]
    v_pk_add_f32 v[10:11], v[10:11], v[134:135]
    s_xor_b32 s96, s95, 1966080
    s_add_u32 s82, s96, s90
    s_add_u32 m0, s83, 122880
    s_nop 0
    buffer_load_dwordx4 v26, s[44:47], s82 offen lds
    v_add_f32 v6, v8, v9
    v_add_f32 v7, v10, v11
    v_add_f32 v4, v8, v9
    v_add_f32 v5, v10, v11
    s_nop 0
    v_permlane32_swap_b32 v4, v6
    v_permlane32_swap_b32 v5, v7
    v_pk_add_f32 v[4:5], v[4:5], v[6:7]
    v_rcp_f32 v4, v4
    v_rcp_f32 v5, v5
    s_nop 0
    v_pk_mul_f32 v[136:137], v[136:137], v[4:5] op_sel_hi:[1,0]
    v_pk_mul_f32 v[120:121], v[4:5], v[120:121] op_sel:[1,0]
    v_pk_mul_f32 v[138:139], v[138:139], v[4:5] op_sel_hi:[1,0]
    v_pk_mul_f32 v[122:123], v[4:5], v[122:123] op_sel:[1,0]
    v_pk_mul_f32 v[140:141], v[140:141], v[4:5] op_sel_hi:[1,0]
    s_add_u32 s82, s95, s90
    s_mov_b32 m0, s83
    s_nop 0
    buffer_load_dwordx4 v26, s[44:47], s82 offen lds
    v_pk_mul_f32 v[124:125], v[4:5], v[124:125] op_sel:[1,0]
    v_pk_mul_f32 v[142:143], v[142:143], v[4:5] op_sel_hi:[1,0]
    v_pk_mul_f32 v[126:127], v[4:5], v[126:127] op_sel:[1,0]
    v_pk_mul_f32 v[144:145], v[144:145], v[4:5] op_sel_hi:[1,0]
    v_pk_mul_f32 v[128:129], v[4:5], v[128:129] op_sel:[1,0]
    v_pk_mul_f32 v[146:147], v[146:147], v[4:5] op_sel_hi:[1,0]
    v_pk_mul_f32 v[130:131], v[4:5], v[130:131] op_sel:[1,0]
    v_pk_mul_f32 v[148:149], v[148:149], v[4:5] op_sel_hi:[1,0]
    v_pk_mul_f32 v[132:133], v[4:5], v[132:133] op_sel:[1,0]
    v_pk_mul_f32 v[150:151], v[150:151], v[4:5] op_sel_hi:[1,0]
    v_pk_mul_f32 v[134:135], v[4:5], v[134:135] op_sel:[1,0]
    v_cvt_pk_bf16_f32 v152, v136, v137
    v_cvt_pk_bf16_f32 v153, v138, v139
    v_cvt_pk_bf16_f32 v154, v140, v141
    s_xor_b32 s96, s95, 131072
    s_add_u32 s82, s96, s90
    s_add_u32 m0, s83, 8192
    s_nop 0
    buffer_load_dwordx4 v26, s[44:47], s82 offen lds
    v_cvt_pk_bf16_f32 v155, v142, v143
    v_cvt_pk_bf16_f32 v156, v144, v145
    v_cvt_pk_bf16_f32 v157, v146, v147
    v_cvt_pk_bf16_f32 v158, v148, v149
    v_cvt_pk_bf16_f32 v159, v150, v151
    v_cvt_pk_bf16_f32 v160, v120, v121
    v_cvt_pk_bf16_f32 v161, v122, v123
    v_cvt_pk_bf16_f32 v162, v124, v125
    v_cvt_pk_bf16_f32 v163, v126, v127
    v_cvt_pk_bf16_f32 v164, v128, v129
    v_cvt_pk_bf16_f32 v165, v130, v131
    v_cvt_pk_bf16_f32 v166, v132, v133
    v_cvt_pk_bf16_f32 v167, v134, v135
    s_branch SCHK_17
SPOLL_16:
    s_load_dwordx2 s[24:25], s[32:33], s92 offset:512 glc
SCHK_17:
    s_add_u32 s5, s5, 1
    s_cmp_ge_u32 s5, 200000
    s_waitcnt lgkmcnt(0)
    s_cbranch_scc1 SDONE_18
    s_cmp_lg_u32 s24, s4
    s_cbranch_scc1 SPOLL_16
    s_cmp_lg_u32 s25, s4
    s_cbranch_scc1 SPOLL_16
SDONE_18:
    s_barrier
    buffer_load_dwordx4 v[184:187], v47, s[32:35], s13 offen sc1
    buffer_load_dwordx4 v[188:191], v47, s[32:35], s14 offen sc1
    buffer_load_dwordx4 v[192:195], v2, s[32:35], s16 offen sc1
    s_lshl_b32 s96, s3, 5
    s_add_u32 s14, s96, 155648
    v_and_b32 v6, 3, v1
    v_lshl_add_u32 v6, v6, 3, s14
    v_lshrrev_b32 v9, 5, v1
    v_lshl_add_u32 v6, v9, 2, v6
    s_lshl_b32 s96, s3, 10
    s_add_u32 s14, s96, 147456
    v_and_b32 v5, 15, v1
    v_lshl_add_u32 v5, v5, 4, s14
    v_lshrrev_b32 v9, 5, v1
    v_lshl_add_u32 v5, v9, 9, v5
    v_bfe_u32 v9, v1, 4, 1
    v_lshl_add_u32 v5, v9, 3, v5
    s_lshl_b32 s96, s76, 7
    s_add_u32 s14, s96, 155648
    v_lshrrev_b32 v7, 5, v1
    v_lshl_add_u32 v7, v7, 4, s14
    s_lshl_b32 s96, s76, 12
    s_add_u32 s14, s96, 147456
    v_add_u32 v44, s14, v2
    s_waitcnt vmcnt(1)
    v_pk_add_f32 v[184:185], v[184:185], v[188:189]
    v_pk_add_f32 v[186:187], v[186:187], v[190:191]
    s_nop 1
    v_permlane32_swap_b32 v184, v186
    v_permlane32_swap_b32 v185, v187
    v_pk_add_f32 v[184:185], v[184:185], v[186:187]
    s_nop 1
    v_add_f32_dpp v184, v184, v184 row_ror:8 row_mask:0xf bank_mask:0xf
    v_add_f32_dpp v185, v185, v185 row_ror:8 row_mask:0xf bank_mask:0xf
    v_mov_b32 v186, v184
    v_mov_b32 v187, v185
    s_nop 0
    v_permlane16_swap_b32 v184, v186
    v_permlane16_swap_b32 v185, v187
    v_pk_add_f32 v[184:185], v[184:185], v[186:187]
    v_cvt_pk_bf16_f32 v184, v184, v185
    v_mov_b32 v185, s4
    s_mov_b32 exec_lo, 0xff
    s_mov_b32 exec_hi, 0xff
    buffer_store_dwordx2 v[184:185], v48, s[32:35], s15 offen sc1
    s_mov_b64 exec, -1
    s_barrier
    s_cmp_lg_u32 s3, 0
    s_cbranch_scc1 L_PC2
    v_mov_b32 v45, s4
    s_mov_b32 exec_hi, 0
    s_mov_b32 exec_lo, 65535
    buffer_store_dword v45, v46, s[32:35], s17 offen sc1
    s_mov_b64 exec, -1
L_PC2:
    s_waitcnt vmcnt(1)
    s_xor_b32 s96, s95, 262144
    s_add_u32 s82, s96, s90
    s_add_u32 m0, s83, 16384
    s_nop 0
    buffer_load_dwordx4 v26, s[44:47], s82 offen lds
    v_permlane32_swap_b32 v192, v194
    v_permlane32_swap_b32 v193, v195
    v_pk_add_f32 v[192:193], v[192:193], v[194:195]
    s_nop 1
    v_add_f32_dpp v192, v192, v192 row_ror:4 row_mask:0xf bank_mask:0xf
    s_xor_b32 s96, s95, 393216
L_PAD7:
    s_cbranch_execz L_RET7
    s_add_u32 s82, s96, s90
    s_add_u32 m0, s83, 24576
    s_nop 0
    buffer_load_dwordx4 v26, s[44:47], s82 offen lds
    v_add_f32_dpp v193, v193, v193 row_ror:4 row_mask:0xf bank_mask:0xf
    v_add_f32_dpp v192, v192, v192 row_ror:8 row_mask:0xf bank_mask:0xf
    s_nop 0
    v_add_f32_dpp v193, v193, v193 row_ror:8 row_mask:0xf bank_mask:0xf
    s_xor_b32 s96, s95, 524288
    s_add_u32 s82, s96, s90
    s_add_u32 m0, s83, 32768
    s_nop 0
    buffer_load_dwordx4 v26, s[44:47], s82 offen lds
    v_mov_b32 v194, v192
    v_mov_b32 v195, v193
    s_nop 0
    v_permlane16_swap_b32 v192, v194
    s_xor_b32 s96, s95, 655360
    s_add_u32 s82, s96, s90
    s_add_u32 m0, s83, 40960
    s_nop 0
    buffer_load_dwordx4 v26, s[44:47], s82 offen lds
    v_permlane16_swap_b32 v193, v195
    v_pk_add_f32 v[192:193], v[192:193], v[194:195]
    v_cvt_pk_bf16_f32 v192, v192, v193
    ds_write_b32 v6, v192
    s_waitcnt lgkmcnt(0)
    s_barrier
    ds_read_b128 v[196:199], v7
    ds_read_b128 v[200:203], v7 offset:32
    ds_read_b128 v[204:207], v7 offset:64
    ds_read_b128 v[208:211], v7 offset:96
    s_lshr_b32 s96, s8, 2
    s_lshl1_add_u32 s97, s9, s96
    s_and_b32 s98, s8, 3
    s_lshl2_add_u32 s99, s97, s98
    s_lshl_b32 s96, s99, 9
    s_add_u32 s18, s96, 131072
    s_waitcnt lgkmcnt(0)
    s_lshl3_add_u32 s96, s11, s3
    s_lshl_b32 s97, s96, 11
    s_add_u32 s13, s97, 29360128
    s_load_dwordx2 s[24:25], s[32:33], s92 offset:3584 glc
    v_mfma_f32_32x32x16_bf16 v[136:151], v[196:199], v[152:155], 0
    v_mfma_f32_32x32x16_bf16 v[136:151], v[200:203], v[156:159], v[136:151]
    v_mfma_f32_32x32x16_bf16 v[136:151], v[204:207], v[160:163], v[136:151]
    v_mfma_f32_32x32x16_bf16 v[136:151], v[208:211], v[164:167], v[136:151]
    s_nop 11
    v_cvt_pk_bf16_f32 v136, 0, v136
    v_add_f32 v136, 0x358637bd, v136
    v_cvt_pk_bf16_f32 v136, 0, v136
    v_rcp_f32 v136, v136
    s_branch SCHK_20
SPOLL_19:
    s_load_dwordx2 s[24:25], s[32:33], s92 offset:3584 glc
SCHK_20:
    s_add_u32 s5, s5, 1
    s_cmp_ge_u32 s5, 200000
    s_waitcnt lgkmcnt(0)
    s_cbranch_scc1 SDONE_21
    s_cmp_lg_u32 s24, s4
    s_cbranch_scc1 SPOLL_19
    s_cmp_lg_u32 s25, s4
    s_cbranch_scc1 SPOLL_19
SDONE_21:
    buffer_load_dwordx4 v[228:231], v2, s[32:35], s13 offen sc1
    buffer_load_dwordx4 v[232:235], v2, s[32:35], s13 offen offset:1024 sc1
    s_waitcnt vmcnt(0)
    v_bitop3_b32 v4, v229, v231, s4 bitop3:0x7e
    v_bitop3_b32 v4, v4, v233, s4 bitop3:0xf6
    v_bitop3_b32 v4, v4, v235, s4 bitop3:0xf6
    v_cmp_ne_u32 vcc, 0, v4
    s_cbranch_vccz TOK_23
POLL_24:
    buffer_load_dwordx4 v[228:231], v2, s[32:35], s13 offen sc1
    buffer_load_dwordx4 v[232:235], v2, s[32:35], s13 offen offset:1024 sc1
    s_waitcnt vmcnt(0)
    v_bitop3_b32 v4, v229, v231, s4 bitop3:0x7e
    v_bitop3_b32 v4, v4, v233, s4 bitop3:0xf6
    v_bitop3_b32 v4, v4, v235, s4 bitop3:0xf6
    v_cmp_ne_u32 vcc, 0, v4
    s_cbranch_vccz PDONE_25
    s_add_u32 s5, s5, 1
    s_cmp_lt_u32 s5, 200000
    s_cbranch_scc1 POLL_24
PDONE_25:
TOK_23:
    ds_write2_b32 v5, v228, v230 offset0:0 offset1:1
    ds_write2_b32 v5, v232, v234 offset0:64 offset1:65
    s_waitcnt lgkmcnt(0)
    s_barrier
    ds_read_b128 v[212:215], v44
    ds_read_b128 v[216:219], v44 offset:1024
    ds_read_b128 v[220:223], v44 offset:2048
    ds_read_b128 v[224:227], v44 offset:3072
    s_lshl_b32 s96, s77, 1
    s_lshl3_add_u32 s97, s10, s96
    s_lshl_b32 s98, s97, 5
    s_lshl1_add_u32 s99, s11, s98
    s_add_u32 s96, s99, s76
    s_lshl_b32 s97, s96, 10
    s_add_u32 s13, s97, 8388608
    v_and_b32 v47, 15, v1
    v_lshlrev_b32 v47, 4, v47
    v_bfe_u32 v9, v1, 4, 1
    v_lshl_add_u32 v47, v9, 15, v47
    v_lshrrev_b32 v9, 5, v1
    v_lshl_add_u32 v47, v9, 8, v47
    s_waitcnt lgkmcnt(3)
    v_mfma_f32_32x32x16_bf16 v[120:135], v[212:215], v[152:155], 0
    s_waitcnt lgkmcnt(2)
    v_mfma_f32_32x32x16_bf16 v[120:135], v[216:219], v[156:159], v[120:135]
    s_waitcnt lgkmcnt(1)
    v_mfma_f32_32x32x16_bf16 v[120:135], v[220:223], v[160:163], v[120:135]
    s_waitcnt lgkmcnt(0)
    v_mfma_f32_32x32x16_bf16 v[120:135], v[224:227], v[164:167], v[120:135]
    s_lshr_b32 s96, s3, 1
    s_lshl4_add_u32 s97, s96, s12
    s_lshl_b32 s98, s97, 11
    s_and_b32 s99, s3, 1
    s_lshl_b32 s96, s99, 10
    s_add_u32 s97, s98, s96
    s_add_u32 s18, s97, 131072
    s_lshl_b32 s19, s12, 7
    v_and_b32 v44, 3, v1
    v_lshl_add_u32 v44, v44, 1, s19
    v_lshrrev_b32 v9, 5, v1
    v_lshl_add_u32 v44, v9, 3, v44
    v_bfe_u32 v9, v1, 4, 1
    v_lshl_add_u32 v44, v9, 4, v44
    v_bfe_u32 v9, v1, 2, 2
    v_lshl_add_u32 v44, v9, 5, v44
    global_load_ushort v32, v44, s[78:79]
    buffer_load_dwordx4 v[28:31], v2, s[32:35], s18 offen sc1
    v_cvt_pk_bf16_f32 v120, 0, v120
    v_cvt_pk_bf16_f32 v121, 0, v121
    v_cvt_pk_bf16_f32 v122, 0, v122
    v_cvt_pk_bf16_f32 v123, 0, v123
    v_cvt_pk_bf16_f32 v124, 0, v124
    v_cvt_pk_bf16_f32 v125, 0, v125
    v_cvt_pk_bf16_f32 v126, 0, v126
    v_cvt_pk_bf16_f32 v127, 0, v127
    v_pk_mul_f32 v[120:121], v[120:121], v[136:137] op_sel_hi:[1,0]
    v_pk_mul_f32 v[122:123], v[122:123], v[136:137] op_sel_hi:[1,0]
    v_pk_mul_f32 v[124:125], v[124:125], v[136:137] op_sel_hi:[1,0]
    v_pk_mul_f32 v[126:127], v[126:127], v[136:137] op_sel_hi:[1,0]
    v_cvt_pk_bf16_f32 v168, v120, v121
    v_cvt_pk_bf16_f32 v169, v122, v123
    v_cvt_pk_bf16_f32 v170, v124, v125
    v_cvt_pk_bf16_f32 v171, v126, v127
    buffer_store_dwordx4 v[168:171], v47, s[32:35], s13 offen sc1
    v_cvt_pk_bf16_f32 v128, 0, v128
    v_cvt_pk_bf16_f32 v129, 0, v129
    v_cvt_pk_bf16_f32 v130, 0, v130
    v_cvt_pk_bf16_f32 v131, 0, v131
    v_cvt_pk_bf16_f32 v132, 0, v132
    v_cvt_pk_bf16_f32 v133, 0, v133
    v_cvt_pk_bf16_f32 v134, 0, v134
    v_cvt_pk_bf16_f32 v135, 0, v135
    v_pk_mul_f32 v[128:129], v[128:129], v[136:137] op_sel_hi:[1,0]
    v_pk_mul_f32 v[130:131], v[130:131], v[136:137] op_sel_hi:[1,0]
    v_pk_mul_f32 v[132:133], v[132:133], v[136:137] op_sel_hi:[1,0]
    v_pk_mul_f32 v[134:135], v[134:135], v[136:137] op_sel_hi:[1,0]
    v_cvt_pk_bf16_f32 v172, v128, v129
    v_cvt_pk_bf16_f32 v173, v130, v131
    v_cvt_pk_bf16_f32 v174, v132, v133
    v_cvt_pk_bf16_f32 v175, v134, v135
    buffer_store_dwordx4 v[172:175], v47, s[32:35], s13 offen offset:512 sc1
    v_mov_b32 v50, -1
    v_mov_b32 v51, -1
    v_mov_b32 v52, -1
    v_mov_b32 v53, -1
    s_lshl3_add_u32 s96, s21, s3
    s_lshl4_add_u32 s97, s96, s12
    s_lshl_b32 s98, s97, 8
    s_add_u32 s19, s98, 12582912
    v_lshlrev_b32 v54, 2, v1
    buffer_store_dword v50, v54, s[32:35], s19 offen sc1
    s_lshl_b32 s96, s21, 14
    s_lshl_b32 s97, s12, 9
    s_add_u32 s98, s96, s97
    s_add_u32 s19, s98, 13631488
    v_and_b32 v54, 31, v1
    v_lshlrev_b32 v54, 4, v54
    v_lshrrev_b32 v55, 5, v1
    v_lshl_add_u32 v54, v55, 13, v54
    s_cmp_lg_u32 s3, 5
    s_cbranch_scc1 L_NOPO
    buffer_store_dwordx4 v[50:53], v54, s[32:35], s19 offen sc1
L_NOPO:
    v_bfe_u32 v36, v1, 2, 2
    v_lshlrev_b32 v36, 7, v36
    v_lshrrev_b32 v9, 4, v1
    v_lshl_add_u32 v36, v9, 10, v36
    v_and_b32 v9, 1, v1
    v_lshl_add_u32 v36, v9, 4, v36
    v_bfe_u32 v9, v1, 1, 1
    v_lshl_add_u32 v36, v9, 3, v36
    v_bfe_u32 v9, v1, 3, 2
    v_lshl_add_u32 v36, v9, 5, v36
    s_and_b32 s96, s9, 1
    s_lshl_b32 s97, s96, 2
    s_xor_b32 s98, s3, s97
    s_lshl_b32 s17, s98, 12
    s_lshl_b32 s96, s17, 2
    s_lshr_b32 s97, s95, 4
    s_xor_b32 s14, s96, s97
    v_add_u32 v36, s14, v36
    v_xor_b32 v37, 32, v36
    v_xor_b32 v38, 64, v36
    v_xor_b32 v39, 96, v36
    v_and_b32 v5, 7, v1
    v_lshlrev_b32 v5, 15, v5
    v_bfe_u32 v9, v1, 3, 1
    v_lshl_add_u32 v5, v9, 12, v5
    s_and_b32 s96, s11, 1
    s_lshr_b32 s97, s10, 2
    s_and_b32 s98, s10, 3
    s_lshl_b32 s99, s98, 6
    s_lshl1_add_u32 s98, s97, s99
    s_lshl_b32 s97, s98, 12
    s_lshr_b32 s99, s11, 1
    s_lshl_b32 s98, s99, 6
    s_add_u32 s99, s97, s98
    s_lshl2_add_u32 s97, s96, s99
    s_add_u32 s98, s97, 1048576
    s_add_u32 s15, s98, 1024
    v_lshlrev_b32 v152, 16, v12
    v_and_b32 v153, s6, v12
    v_lshlrev_b32 v154, 16, v13
    v_and_b32 v155, s6, v13
    v_lshlrev_b32 v156, 16, v14
    v_and_b32 v157, s6, v14
    v_lshlrev_b32 v158, 16, v15
    v_and_b32 v159, s6, v15
    v_lshlrev_b32 v160, 16, v16
    v_and_b32 v161, s6, v16
    v_lshlrev_b32 v162, 16, v17
    v_and_b32 v163, s6, v17
    v_lshlrev_b32 v164, 16, v18
    v_and_b32 v165, s6, v18
    v_lshlrev_b32 v166, 16, v19
    v_and_b32 v167, s6, v19
    s_lshl3_add_u32 s96, s21, s3
    s_lshl_b32 s97, s96, 15
    s_add_u32 s19, s97, 8388608
    s_waitcnt vmcnt(3)
    v_bitop3_b32 v4, v29, v31, s4 bitop3:0x7e
    v_cmp_ne_u32 vcc, 0, v4
    s_cbranch_vccz L_MGOK
POLL_26:
    buffer_load_dwordx4 v[28:31], v2, s[32:35], s18 offen sc1
    s_waitcnt vmcnt(0)
    v_bitop3_b32 v4, v29, v31, s4 bitop3:0x7e
    v_cmp_ne_u32 vcc, 0, v4
    s_cbranch_vccz PDONE_27
    s_add_u32 s5, s5, 1
    s_cmp_lt_u32 s5, 200000
    s_cbranch_scc1 POLL_26
PDONE_27:
L_MGOK:
    s_and_b32 s96, s3, 1
    s_lshr_b32 s97, s3, 1
    s_lshl_b32 s98, s97, 10
    s_lshl3_add_u32 s99, s96, s98
    s_add_u32 s14, s99, 159744
    v_and_b32 v4, 31, v1
    v_lshl_add_u32 v4, v4, 5, s14
    v_lshrrev_b32 v9, 5, v1
    v_lshl_add_u32 v4, v9, 2, v4
    ds_write2_b32 v4, v28, v30 offset0:0 offset1:4
    v_and_b32 v7, 3, v1
    v_lshlrev_b32 v7, 4, v7
    v_lshrrev_b32 v9, 5, v1
    v_lshl_add_u32 v7, v9, 6, v7
    v_bfe_u32 v9, v1, 4, 1
    v_lshl_add_u32 v7, v9, 7, v7
    v_bfe_u32 v9, v1, 2, 2
    v_lshl_add_u32 v7, v9, 8, v7
    v_add_u32 v7, 159744, v7
    s_lshl_b32 s96, s2, 12
    s_lshr_b32 s97, s17, 6
    s_add_u32 s98, s96, s97
    s_add_u32 s99, s98, 1048576
    s_add_u32 s18, s99, 1024
    s_waitcnt vmcnt(1)
    s_waitcnt lgkmcnt(0)
    s_barrier
    s_cmp_lg_u32 s3, 0
    s_cbranch_scc1 L_PD
    v_mov_b32 v6, s4
    s_mov_b32 exec_hi, 0
    s_mov_b32 exec_lo, 65535
    buffer_store_dword v6, v5, s[32:35], s15 offen sc1
    s_mov_b64 exec, -1
L_PD:
    ds_read_b128 v[192:195], v7
    ds_read_b128 v[196:199], v7 offset:1024
    ds_read_b128 v[200:203], v7 offset:2048
    ds_read_b128 v[204:207], v7 offset:3072
    v_and_b32 v8, 3, v1
    v_lshlrev_b32 v8, 2, v8
    v_lshrrev_b32 v9, 5, v1
    v_lshl_add_u32 v8, v9, 4, v8
    v_bfe_u32 v9, v1, 4, 1
    v_lshl_add_u32 v8, v9, 5, v8
    v_bfe_u32 v9, v1, 2, 2
    v_lshl_add_u32 v8, v9, 6, v8
    v_add_u32 v8, 157184, v8
    s_lshl4_add_u32 s96, s21, s12
    s_lshl_b32 s97, s96, 6
    s_add_u32 s13, s97, 14155776
    s_waitcnt lgkmcnt(0)
    s_load_dwordx2 s[24:25], s[32:33], s18 offset:0 glc
    v_pk_add_f32 v[192:193], v[192:193], v[194:195]
    v_add_f32 v28, v192, v193
    v_pk_add_f32 v[196:197], v[196:197], v[198:199]
    v_add_f32 v29, v196, v197
    v_pk_add_f32 v[200:201], v[200:201], v[202:203]
    v_add_f32 v30, v200, v201
    v_pk_add_f32 v[204:205], v[204:205], v[206:207]
    v_add_f32 v31, v204, v205
    v_cvt_pk_bf16_f32 v28, 0, v28
    v_cvt_pk_bf16_f32 v29, 0, v29
    v_cvt_pk_bf16_f32 v30, 0, v30
    v_cvt_pk_bf16_f32 v31, 0, v31
    v_add_f32 v30, 1.0, v30
    v_lshlrev_b32 v32, 16, v32
    v_cvt_pk_bf16_f32 v30, 0, v30
    ds_write_b32 v8, v31
    v_mul_f32 v192, v30, v32
    v_cvt_pk_bf16_f32 v193, 0, v192
    v_sub_f32 v194, v192, v193
    v_add_f32_dpp v192, v192, v192 quad_perm:[1,0,3,2] row_mask:0xf bank_mask:0xf
    s_nop 1
    v_add_f32_dpp v192, v192, v192 quad_perm:[2,3,0,1] row_mask:0xf bank_mask:0xf
    s_nop 1
    v_add_f32_dpp v192, v192, v192 row_half_mirror row_mask:0xf bank_mask:0xf
    s_nop 1
    v_add_f32_dpp v192, v192, v192 row_ror:8 row_mask:0xf bank_mask:0xf
    v_mov_b32 v199, v192
    s_nop 1
    v_permlane16_swap_b32 v192, v199
    v_add_f32 v192, v192, v199
    v_mov_b32 v199, v192
    s_nop 1
    v_permlane32_swap_b32 v192, v199
    v_add_f32 v192, v192, v199
    v_mov_b32_dpp v196, v193 row_shl:1 row_mask:0xf bank_mask:0xf
    v_mov_b32_dpp v197, v194 row_shl:1 row_mask:0xf bank_mask:0xf
    v_mov_b32_dpp v198, v32 row_shl:1 row_mask:0xf bank_mask:0xf
    v_cvt_pk_bf16_f32 v196, v193, v196
    v_cvt_pk_bf16_f32 v197, v194, v197
    v_cvt_pk_bf16_f32 v198, v32, v198
    v_mov_b32 v193, s4
    v_mov_b32 v194, 0
    s_cmp_lg_u32 s3, 2
    s_cbranch_scc1 L_NOUP
    s_mov_b64 exec, 1
    buffer_store_dwordx2 v[192:193], v194, s[32:35], s13 offen sc1
    s_mov_b64 exec, -1
L_NOUP:
    v_mov_b32 v184, 0x3f803f80
    s_nop 1
    v_mov_b32_dpp v184, v196 row_newbcast:0 row_mask:0xf bank_mask:0x2
    s_nop 1
    v_mov_b32_dpp v184, v197 row_newbcast:0 row_mask:0xf bank_mask:0x4
    s_nop 1
    v_mov_b32_dpp v184, v198 row_newbcast:0 row_mask:0xf bank_mask:0x8
    v_mov_b32 v185, 0x3f803f80
    s_nop 1
    v_mov_b32_dpp v185, v196 row_newbcast:2 row_mask:0xf bank_mask:0x2
    s_nop 1
    v_mov_b32_dpp v185, v197 row_newbcast:2 row_mask:0xf bank_mask:0x4
    s_nop 1
    v_mov_b32_dpp v185, v198 row_newbcast:2 row_mask:0xf bank_mask:0x8
    v_mov_b32 v186, 0x3f803f80
    s_nop 1
    v_mov_b32_dpp v186, v196 row_newbcast:4 row_mask:0xf bank_mask:0x2
    s_nop 1
    v_mov_b32_dpp v186, v197 row_newbcast:4 row_mask:0xf bank_mask:0x4
    s_nop 1
    v_mov_b32_dpp v186, v198 row_newbcast:4 row_mask:0xf bank_mask:0x8
    v_mov_b32 v187, 0x3f803f80
    s_nop 1
    v_mov_b32_dpp v187, v196 row_newbcast:6 row_mask:0xf bank_mask:0x2
    s_nop 1
    v_mov_b32_dpp v187, v197 row_newbcast:6 row_mask:0xf bank_mask:0x4
    s_nop 1
    v_mov_b32_dpp v187, v198 row_newbcast:6 row_mask:0xf bank_mask:0x8
    v_mov_b32 v188, 0x3f803f80
    s_nop 1
    v_mov_b32_dpp v188, v196 row_newbcast:8 row_mask:0xf bank_mask:0x2
    s_nop 1
    v_mov_b32_dpp v188, v197 row_newbcast:8 row_mask:0xf bank_mask:0x4
    s_nop 1
    v_mov_b32_dpp v188, v198 row_newbcast:8 row_mask:0xf bank_mask:0x8
    v_mov_b32 v189, 0x3f803f80
    s_nop 1
    v_mov_b32_dpp v189, v196 row_newbcast:10 row_mask:0xf bank_mask:0x2
    s_nop 1
    v_mov_b32_dpp v189, v197 row_newbcast:10 row_mask:0xf bank_mask:0x4
    s_nop 1
    v_mov_b32_dpp v189, v198 row_newbcast:10 row_mask:0xf bank_mask:0x8
    v_mov_b32 v190, 0x3f803f80
    s_nop 1
    v_mov_b32_dpp v190, v196 row_newbcast:12 row_mask:0xf bank_mask:0x2
    s_nop 1
    v_mov_b32_dpp v190, v197 row_newbcast:12 row_mask:0xf bank_mask:0x4
    s_nop 1
    v_mov_b32_dpp v190, v198 row_newbcast:12 row_mask:0xf bank_mask:0x8
    v_mov_b32 v191, 0x3f803f80
    s_nop 1
    v_mov_b32_dpp v191, v196 row_newbcast:14 row_mask:0xf bank_mask:0x2
    s_nop 1
    v_mov_b32_dpp v191, v197 row_newbcast:14 row_mask:0xf bank_mask:0x4
    s_nop 1
    v_mov_b32_dpp v191, v198 row_newbcast:14 row_mask:0xf bank_mask:0x8
    v_mov_b32 v42, v29
    v_mov_b32 v43, v31
    v_mov_b32_dpp v136, v28 row_newbcast:0 row_mask:0xf bank_mask:0xf
    v_mov_b32_dpp v137, v28 row_newbcast:1 row_mask:0xf bank_mask:0xf
    v_mov_b32_dpp v138, v28 row_newbcast:2 row_mask:0xf bank_mask:0xf
    v_mov_b32_dpp v139, v28 row_newbcast:3 row_mask:0xf bank_mask:0xf
    v_mov_b32_dpp v140, v28 row_newbcast:4 row_mask:0xf bank_mask:0xf
    v_mov_b32_dpp v141, v28 row_newbcast:5 row_mask:0xf bank_mask:0xf
    v_mov_b32_dpp v142, v28 row_newbcast:6 row_mask:0xf bank_mask:0xf
    v_mov_b32_dpp v143, v28 row_newbcast:7 row_mask:0xf bank_mask:0xf
    v_mov_b32_dpp v144, v28 row_newbcast:8 row_mask:0xf bank_mask:0xf
    v_mov_b32_dpp v145, v28 row_newbcast:9 row_mask:0xf bank_mask:0xf
    v_mov_b32_dpp v146, v28 row_newbcast:10 row_mask:0xf bank_mask:0xf
    v_mov_b32_dpp v147, v28 row_newbcast:11 row_mask:0xf bank_mask:0xf
    v_mov_b32_dpp v148, v28 row_newbcast:12 row_mask:0xf bank_mask:0xf
    v_mov_b32_dpp v149, v28 row_newbcast:13 row_mask:0xf bank_mask:0xf
    v_mov_b32_dpp v150, v28 row_newbcast:14 row_mask:0xf bank_mask:0xf
    v_mov_b32_dpp v151, v28 row_newbcast:15 row_mask:0xf bank_mask:0xf
    v_mov_b32_dpp v168, v30 row_newbcast:0 row_mask:0xf bank_mask:0xf
    v_mov_b32_dpp v169, v30 row_newbcast:1 row_mask:0xf bank_mask:0xf
    v_mov_b32_dpp v170, v30 row_newbcast:2 row_mask:0xf bank_mask:0xf
    v_mov_b32_dpp v171, v30 row_newbcast:3 row_mask:0xf bank_mask:0xf
    v_mov_b32_dpp v172, v30 row_newbcast:4 row_mask:0xf bank_mask:0xf
    v_mov_b32_dpp v173, v30 row_newbcast:5 row_mask:0xf bank_mask:0xf
    v_mov_b32_dpp v174, v30 row_newbcast:6 row_mask:0xf bank_mask:0xf
    v_mov_b32_dpp v175, v30 row_newbcast:7 row_mask:0xf bank_mask:0xf
    v_mov_b32_dpp v176, v30 row_newbcast:8 row_mask:0xf bank_mask:0xf
    v_mov_b32_dpp v177, v30 row_newbcast:9 row_mask:0xf bank_mask:0xf
    v_mov_b32_dpp v178, v30 row_newbcast:10 row_mask:0xf bank_mask:0xf
    v_mov_b32_dpp v179, v30 row_newbcast:11 row_mask:0xf bank_mask:0xf
    v_mov_b32_dpp v180, v30 row_newbcast:12 row_mask:0xf bank_mask:0xf
    v_mov_b32_dpp v181, v30 row_newbcast:13 row_mask:0xf bank_mask:0xf
    v_mov_b32_dpp v182, v30 row_newbcast:14 row_mask:0xf bank_mask:0xf
    v_mov_b32_dpp v183, v30 row_newbcast:15 row_mask:0xf bank_mask:0xf
    s_branch SCHK_29
SPOLL_28:
    s_load_dwordx2 s[24:25], s[32:33], s18 offset:0 glc
SCHK_29:
    s_add_u32 s5, s5, 1
    s_cmp_ge_u32 s5, 200000
    s_waitcnt lgkmcnt(0)
    s_cbranch_scc1 SDONE_30
    s_cmp_lg_u32 s24, s4
    s_cbranch_scc1 SPOLL_28
    s_cmp_lg_u32 s25, s4
    s_cbranch_scc1 SPOLL_28
SDONE_30:
    s_add_u32 s20, s17, s19
    buffer_load_dwordx4 v[224:227], v2, s[32:35], s20 offen sc1
    ds_read_b64_tr_b16 v[192:193], v36
    ds_read_b64_tr_b16 v[194:195], v36 offset:512
    ds_read_b64_tr_b16 v[196:197], v37
    ds_read_b64_tr_b16 v[198:199], v37 offset:512
    ds_read_b64_tr_b16 v[200:201], v38
    ds_read_b64_tr_b16 v[202:203], v38 offset:512
    ds_read_b64_tr_b16 v[204:205], v39
    ds_read_b64_tr_b16 v[206:207], v39 offset:512
    ds_read_b64_tr_b16 v[208:209], v36 offset:4096
    ds_read_b64_tr_b16 v[210:211], v36 offset:4608
    ds_read_b64_tr_b16 v[212:213], v37 offset:4096
    ds_read_b64_tr_b16 v[214:215], v37 offset:4608
    ds_read_b64_tr_b16 v[216:217], v38 offset:4096
    ds_read_b64_tr_b16 v[218:219], v38 offset:4608
    buffer_load_dwordx4 v[228:231], v2, s[32:35], s20 offen offset:1024 sc1
    buffer_load_dwordx4 v[232:235], v2, s[32:35], s20 offen offset:2048 sc1
    buffer_load_dwordx4 v[236:239], v2, s[32:35], s20 offen offset:3072 sc1
    s_barrier
    s_xor_b32 s96, s17, 4096
    s_add_u32 s20, s96, s19
    buffer_load_dwordx4 v[240:243], v2, s[32:35], s20 offen sc1
    buffer_load_dwordx4 v[244:247], v2, s[32:35], s20 offen offset:1024 sc1
    buffer_load_dwordx4 v[44:47], v2, s[32:35], s20 offen offset:2048 sc1
    buffer_load_dwordx4 v[48:51], v2, s[32:35], s20 offen offset:3072 sc1
    s_lshl_b32 s96, s21, 10
    s_add_u32 s13, s96, 14155776
    v_and_b32 v10, 15, v1
    v_lshlrev_b32 v10, 6, v10
    s_waitcnt vmcnt(7)
    s_waitcnt lgkmcnt(6)
    v_mfma_f32_16x16x32_bf16 v[120:123], v[192:195], v[224:227], 0
    ds_read_b64_tr_b16 v[220:221], v39 offset:4096
    ds_read_b64_tr_b16 v[222:223], v39 offset:4608
    v_mfma_f32_16x16x32_bf16 v[124:127], v[196:199], v[224:227], 0
    ds_read_b64_tr_b16 v[192:193], v36 offset:8192
    ds_read_b64_tr_b16 v[194:195], v36 offset:8704
    v_mfma_f32_16x16x32_bf16 v[128:131], v[200:203], v[224:227], 0
    ds_read_b64_tr_b16 v[196:197], v37 offset:8192
    ds_read_b64_tr_b16 v[198:199], v37 offset:8704
    v_mfma_f32_16x16x32_bf16 v[132:135], v[204:207], v[224:227], 0
    ds_read_b64_tr_b16 v[200:201], v38 offset:8192
    ds_read_b64_tr_b16 v[202:203], v38 offset:8704
    s_xor_b32 s96, s17, 8192
    s_add_u32 s20, s96, s19
    buffer_load_dwordx4 v[224:227], v2, s[32:35], s20 offen sc1
    s_waitcnt vmcnt(7)
    s_waitcnt lgkmcnt(6)
    v_mfma_f32_16x16x32_bf16 v[120:123], v[208:211], v[228:231], v[120:123]
    ds_read_b64_tr_b16 v[204:205], v39 offset:8192
    ds_read_b64_tr_b16 v[206:207], v39 offset:8704
    v_mfma_f32_16x16x32_bf16 v[124:127], v[212:215], v[228:231], v[124:127]
    ds_read_b64_tr_b16 v[208:209], v36 offset:12288
    ds_read_b64_tr_b16 v[210:211], v36 offset:12800
    v_xor_b32 v36, 16384, v36
    v_mfma_f32_16x16x32_bf16 v[128:131], v[216:219], v[228:231], v[128:131]
    ds_read_b64_tr_b16 v[212:213], v37 offset:12288
    ds_read_b64_tr_b16 v[214:215], v37 offset:12800
    v_xor_b32 v37, 16384, v37
    v_mfma_f32_16x16x32_bf16 v[132:135], v[220:223], v[228:231], v[132:135]
    ds_read_b64_tr_b16 v[216:217], v38 offset:12288
    ds_read_b64_tr_b16 v[218:219], v38 offset:12800
    v_xor_b32 v38, 16384, v38
    buffer_load_dwordx4 v[228:231], v2, s[32:35], s20 offen offset:1024 sc1
    s_waitcnt vmcnt(7)
    s_waitcnt lgkmcnt(6)
    v_mfma_f32_16x16x32_bf16 v[120:123], v[192:195], v[232:235], v[120:123]
    ds_read_b64_tr_b16 v[220:221], v39 offset:12288
    ds_read_b64_tr_b16 v[222:223], v39 offset:12800
    v_xor_b32 v39, 16384, v39
    v_mfma_f32_16x16x32_bf16 v[124:127], v[196:199], v[232:235], v[124:127]
    ds_read_b64_tr_b16 v[192:193], v36
    ds_read_b64_tr_b16 v[194:195], v36 offset:512
    v_mfma_f32_16x16x32_bf16 v[128:131], v[200:203], v[232:235], v[128:131]
    ds_read_b64_tr_b16 v[196:197], v37
    ds_read_b64_tr_b16 v[198:199], v37 offset:512
    v_mfma_f32_16x16x32_bf16 v[132:135], v[204:207], v[232:235], v[132:135]
    ds_read_b64_tr_b16 v[200:201], v38
    ds_read_b64_tr_b16 v[202:203], v38 offset:512
    buffer_load_dwordx4 v[232:235], v2, s[32:35], s20 offen offset:2048 sc1
    s_waitcnt vmcnt(7)
    s_waitcnt lgkmcnt(6)
    v_mfma_f32_16x16x32_bf16 v[120:123], v[208:211], v[236:239], v[120:123]
    ds_read_b64_tr_b16 v[204:205], v39
    ds_read_b64_tr_b16 v[206:207], v39 offset:512
    v_mfma_f32_16x16x32_bf16 v[124:127], v[212:215], v[236:239], v[124:127]
    ds_read_b64_tr_b16 v[208:209], v36 offset:4096
    ds_read_b64_tr_b16 v[210:211], v36 offset:4608
    v_mfma_f32_16x16x32_bf16 v[128:131], v[216:219], v[236:239], v[128:131]
    ds_read_b64_tr_b16 v[212:213], v37 offset:4096
    ds_read_b64_tr_b16 v[214:215], v37 offset:4608
    v_mfma_f32_16x16x32_bf16 v[132:135], v[220:223], v[236:239], v[132:135]
    ds_read_b64_tr_b16 v[216:217], v38 offset:4096
    ds_read_b64_tr_b16 v[218:219], v38 offset:4608
    buffer_load_dwordx4 v[236:239], v2, s[32:35], s20 offen offset:3072 sc1
    s_waitcnt vmcnt(7)
    s_waitcnt lgkmcnt(6)
    v_mfma_f32_16x16x32_bf16 v[120:123], v[192:195], v[240:243], v[120:123]
    ds_read_b64_tr_b16 v[220:221], v39 offset:4096
    ds_read_b64_tr_b16 v[222:223], v39 offset:4608
    v_mfma_f32_16x16x32_bf16 v[124:127], v[196:199], v[240:243], v[124:127]
    ds_read_b64_tr_b16 v[192:193], v36 offset:8192
    ds_read_b64_tr_b16 v[194:195], v36 offset:8704
    v_mfma_f32_16x16x32_bf16 v[128:131], v[200:203], v[240:243], v[128:131]
    ds_read_b64_tr_b16 v[196:197], v37 offset:8192
    ds_read_b64_tr_b16 v[198:199], v37 offset:8704
    v_mfma_f32_16x16x32_bf16 v[132:135], v[204:207], v[240:243], v[132:135]
    ds_read_b64_tr_b16 v[200:201], v38 offset:8192
    ds_read_b64_tr_b16 v[202:203], v38 offset:8704
    s_xor_b32 s96, s17, 12288
    s_add_u32 s20, s96, s19
    buffer_load_dwordx4 v[240:243], v2, s[32:35], s20 offen sc1
    s_waitcnt vmcnt(7)
    s_waitcnt lgkmcnt(6)
    v_mfma_f32_16x16x32_bf16 v[120:123], v[208:211], v[244:247], v[120:123]
    ds_read_b64_tr_b16 v[204:205], v39 offset:8192
    ds_read_b64_tr_b16 v[206:207], v39 offset:8704
    v_mfma_f32_16x16x32_bf16 v[124:127], v[212:215], v[244:247], v[124:127]
    ds_read_b64_tr_b16 v[208:209], v36 offset:12288
    ds_read_b64_tr_b16 v[210:211], v36 offset:12800
    v_xor_b32 v36, 49152, v36
    v_mfma_f32_16x16x32_bf16 v[128:131], v[216:219], v[244:247], v[128:131]
    ds_read_b64_tr_b16 v[212:213], v37 offset:12288
    ds_read_b64_tr_b16 v[214:215], v37 offset:12800
    v_xor_b32 v37, 49152, v37
    v_mfma_f32_16x16x32_bf16 v[132:135], v[220:223], v[244:247], v[132:135]
    ds_read_b64_tr_b16 v[216:217], v38 offset:12288
    ds_read_b64_tr_b16 v[218:219], v38 offset:12800
    v_xor_b32 v38, 49152, v38
    buffer_load_dwordx4 v[244:247], v2, s[32:35], s20 offen offset:1024 sc1
    s_waitcnt vmcnt(7)
    s_waitcnt lgkmcnt(6)
    v_mfma_f32_16x16x32_bf16 v[120:123], v[192:195], v[44:47], v[120:123]
    ds_read_b64_tr_b16 v[220:221], v39 offset:12288
    ds_read_b64_tr_b16 v[222:223], v39 offset:12800
    v_xor_b32 v39, 49152, v39
    v_mfma_f32_16x16x32_bf16 v[124:127], v[196:199], v[44:47], v[124:127]
    ds_read_b64_tr_b16 v[192:193], v36
    ds_read_b64_tr_b16 v[194:195], v36 offset:512
    v_mfma_f32_16x16x32_bf16 v[128:131], v[200:203], v[44:47], v[128:131]
    ds_read_b64_tr_b16 v[196:197], v37
    ds_read_b64_tr_b16 v[198:199], v37 offset:512
    v_mfma_f32_16x16x32_bf16 v[132:135], v[204:207], v[44:47], v[132:135]
    ds_read_b64_tr_b16 v[200:201], v38
    ds_read_b64_tr_b16 v[202:203], v38 offset:512
    buffer_load_dwordx4 v[44:47], v2, s[32:35], s20 offen offset:2048 sc1
    s_waitcnt vmcnt(7)
    s_waitcnt lgkmcnt(6)
    v_mfma_f32_16x16x32_bf16 v[120:123], v[208:211], v[48:51], v[120:123]
    ds_read_b64_tr_b16 v[204:205], v39
    ds_read_b64_tr_b16 v[206:207], v39 offset:512
    v_mfma_f32_16x16x32_bf16 v[124:127], v[212:215], v[48:51], v[124:127]
    ds_read_b64_tr_b16 v[208:209], v36 offset:4096
    ds_read_b64_tr_b16 v[210:211], v36 offset:4608
    v_mfma_f32_16x16x32_bf16 v[128:131], v[216:219], v[48:51], v[128:131]
    ds_read_b64_tr_b16 v[212:213], v37 offset:4096
    ds_read_b64_tr_b16 v[214:215], v37 offset:4608
    v_mfma_f32_16x16x32_bf16 v[132:135], v[220:223], v[48:51], v[132:135]
    ds_read_b64_tr_b16 v[216:217], v38 offset:4096
    ds_read_b64_tr_b16 v[218:219], v38 offset:4608
    buffer_load_dwordx4 v[48:51], v2, s[32:35], s20 offen offset:3072 sc1
    s_waitcnt vmcnt(7)
    s_waitcnt lgkmcnt(6)
    v_mfma_f32_16x16x32_bf16 v[120:123], v[192:195], v[224:227], v[120:123]
    ds_read_b64_tr_b16 v[220:221], v39 offset:4096
    ds_read_b64_tr_b16 v[222:223], v39 offset:4608
    v_mfma_f32_16x16x32_bf16 v[124:127], v[196:199], v[224:227], v[124:127]
    ds_read_b64_tr_b16 v[192:193], v36 offset:8192
    ds_read_b64_tr_b16 v[194:195], v36 offset:8704
    v_mfma_f32_16x16x32_bf16 v[128:131], v[200:203], v[224:227], v[128:131]
    ds_read_b64_tr_b16 v[196:197], v37 offset:8192
    ds_read_b64_tr_b16 v[198:199], v37 offset:8704
    v_mfma_f32_16x16x32_bf16 v[132:135], v[204:207], v[224:227], v[132:135]
    ds_read_b64_tr_b16 v[200:201], v38 offset:8192
    ds_read_b64_tr_b16 v[202:203], v38 offset:8704
    s_xor_b32 s96, s17, 16384
    s_add_u32 s20, s96, s19
    buffer_load_dwordx4 v[224:227], v2, s[32:35], s20 offen sc1
    s_waitcnt vmcnt(7)
    s_waitcnt lgkmcnt(6)
    v_mfma_f32_16x16x32_bf16 v[120:123], v[208:211], v[228:231], v[120:123]
    ds_read_b64_tr_b16 v[204:205], v39 offset:8192
    ds_read_b64_tr_b16 v[206:207], v39 offset:8704
L_PAD8:
    s_cbranch_execz L_RET8
    v_mfma_f32_16x16x32_bf16 v[124:127], v[212:215], v[228:231], v[124:127]
    ds_read_b64_tr_b16 v[208:209], v36 offset:12288
    ds_read_b64_tr_b16 v[210:211], v36 offset:12800
    v_xor_b32 v36, 16384, v36
    v_mfma_f32_16x16x32_bf16 v[128:131], v[216:219], v[228:231], v[128:131]
    ds_read_b64_tr_b16 v[212:213], v37 offset:12288
    ds_read_b64_tr_b16 v[214:215], v37 offset:12800
    v_xor_b32 v37, 16384, v37
    v_mfma_f32_16x16x32_bf16 v[132:135], v[220:223], v[228:231], v[132:135]
    ds_read_b64_tr_b16 v[216:217], v38 offset:12288
    ds_read_b64_tr_b16 v[218:219], v38 offset:12800
    v_xor_b32 v38, 16384, v38
    buffer_load_dwordx4 v[228:231], v2, s[32:35], s20 offen offset:1024 sc1
    s_waitcnt vmcnt(7)
    s_waitcnt lgkmcnt(6)
    v_mfma_f32_16x16x32_bf16 v[120:123], v[192:195], v[232:235], v[120:123]
    ds_read_b64_tr_b16 v[220:221], v39 offset:12288
    ds_read_b64_tr_b16 v[222:223], v39 offset:12800
    v_xor_b32 v39, 16384, v39
    v_mfma_f32_16x16x32_bf16 v[124:127], v[196:199], v[232:235], v[124:127]
    ds_read_b64_tr_b16 v[192:193], v36
    ds_read_b64_tr_b16 v[194:195], v36 offset:512
    v_mfma_f32_16x16x32_bf16 v[128:131], v[200:203], v[232:235], v[128:131]
    ds_read_b64_tr_b16 v[196:197], v37
    ds_read_b64_tr_b16 v[198:199], v37 offset:512
    v_mfma_f32_16x16x32_bf16 v[132:135], v[204:207], v[232:235], v[132:135]
    ds_read_b64_tr_b16 v[200:201], v38
    ds_read_b64_tr_b16 v[202:203], v38 offset:512
    buffer_load_dwordx4 v[232:235], v2, s[32:35], s20 offen offset:2048 sc1
    s_waitcnt vmcnt(7)
    s_waitcnt lgkmcnt(6)
    v_mfma_f32_16x16x32_bf16 v[120:123], v[208:211], v[236:239], v[120:123]
    ds_read_b64_tr_b16 v[204:205], v39
    ds_read_b64_tr_b16 v[206:207], v39 offset:512
    v_mfma_f32_16x16x32_bf16 v[124:127], v[212:215], v[236:239], v[124:127]
    ds_read_b64_tr_b16 v[208:209], v36 offset:4096
    ds_read_b64_tr_b16 v[210:211], v36 offset:4608
    v_mfma_f32_16x16x32_bf16 v[128:131], v[216:219], v[236:239], v[128:131]
    ds_read_b64_tr_b16 v[212:213], v37 offset:4096
    ds_read_b64_tr_b16 v[214:215], v37 offset:4608
    v_mfma_f32_16x16x32_bf16 v[132:135], v[220:223], v[236:239], v[132:135]
    ds_read_b64_tr_b16 v[216:217], v38 offset:4096
    ds_read_b64_tr_b16 v[218:219], v38 offset:4608
    buffer_load_dwordx4 v[236:239], v2, s[32:35], s20 offen offset:3072 sc1
    s_waitcnt vmcnt(7)
    s_waitcnt lgkmcnt(6)
    v_mfma_f32_16x16x32_bf16 v[120:123], v[192:195], v[240:243], v[120:123]
    ds_read_b64_tr_b16 v[220:221], v39 offset:4096
    ds_read_b64_tr_b16 v[222:223], v39 offset:4608
    v_mfma_f32_16x16x32_bf16 v[124:127], v[196:199], v[240:243], v[124:127]
    ds_read_b64_tr_b16 v[192:193], v36 offset:8192
    ds_read_b64_tr_b16 v[194:195], v36 offset:8704
    v_mfma_f32_16x16x32_bf16 v[128:131], v[200:203], v[240:243], v[128:131]
    ds_read_b64_tr_b16 v[196:197], v37 offset:8192
    ds_read_b64_tr_b16 v[198:199], v37 offset:8704
    v_mfma_f32_16x16x32_bf16 v[132:135], v[204:207], v[240:243], v[132:135]
    ds_read_b64_tr_b16 v[200:201], v38 offset:8192
    ds_read_b64_tr_b16 v[202:203], v38 offset:8704
    s_xor_b32 s96, s17, 20480
    s_add_u32 s20, s96, s19
    buffer_load_dwordx4 v[240:243], v2, s[32:35], s20 offen sc1
    s_waitcnt vmcnt(7)
    s_waitcnt lgkmcnt(6)
    v_mfma_f32_16x16x32_bf16 v[120:123], v[208:211], v[244:247], v[120:123]
    ds_read_b64_tr_b16 v[204:205], v39 offset:8192
    ds_read_b64_tr_b16 v[206:207], v39 offset:8704
    v_mfma_f32_16x16x32_bf16 v[124:127], v[212:215], v[244:247], v[124:127]
    ds_read_b64_tr_b16 v[208:209], v36 offset:12288
    ds_read_b64_tr_b16 v[210:211], v36 offset:12800
    v_xor_b32 v36, 114688, v36
    v_mfma_f32_16x16x32_bf16 v[128:131], v[216:219], v[244:247], v[128:131]
    ds_read_b64_tr_b16 v[212:213], v37 offset:12288
    ds_read_b64_tr_b16 v[214:215], v37 offset:12800
    v_xor_b32 v37, 114688, v37
    v_mfma_f32_16x16x32_bf16 v[132:135], v[220:223], v[244:247], v[132:135]
    ds_read_b64_tr_b16 v[216:217], v38 offset:12288
    ds_read_b64_tr_b16 v[218:219], v38 offset:12800
    v_xor_b32 v38, 114688, v38
    buffer_load_dwordx4 v[244:247], v2, s[32:35], s20 offen offset:1024 sc1
    s_waitcnt vmcnt(7)
    s_waitcnt lgkmcnt(6)
    v_mfma_f32_16x16x32_bf16 v[120:123], v[192:195], v[44:47], v[120:123]
    ds_read_b64_tr_b16 v[220:221], v39 offset:12288
    ds_read_b64_tr_b16 v[222:223], v39 offset:12800
    v_xor_b32 v39, 114688, v39
    v_mfma_f32_16x16x32_bf16 v[124:127], v[196:199], v[44:47], v[124:127]
    ds_read_b64_tr_b16 v[192:193], v36
    ds_read_b64_tr_b16 v[194:195], v36 offset:512
    v_mfma_f32_16x16x32_bf16 v[128:131], v[200:203], v[44:47], v[128:131]
    ds_read_b64_tr_b16 v[196:197], v37
    ds_read_b64_tr_b16 v[198:199], v37 offset:512
    v_mfma_f32_16x16x32_bf16 v[132:135], v[204:207], v[44:47], v[132:135]
    ds_read_b64_tr_b16 v[200:201], v38
    ds_read_b64_tr_b16 v[202:203], v38 offset:512
    buffer_load_dwordx4 v[44:47], v2, s[32:35], s20 offen offset:2048 sc1
    s_waitcnt vmcnt(7)
    s_waitcnt lgkmcnt(6)
    v_mfma_f32_16x16x32_bf16 v[120:123], v[208:211], v[48:51], v[120:123]
    ds_read_b64_tr_b16 v[204:205], v39
    ds_read_b64_tr_b16 v[206:207], v39 offset:512
    v_mfma_f32_16x16x32_bf16 v[124:127], v[212:215], v[48:51], v[124:127]
    ds_read_b64_tr_b16 v[208:209], v36 offset:4096
    ds_read_b64_tr_b16 v[210:211], v36 offset:4608
    v_mfma_f32_16x16x32_bf16 v[128:131], v[216:219], v[48:51], v[128:131]
    ds_read_b64_tr_b16 v[212:213], v37 offset:4096
    ds_read_b64_tr_b16 v[214:215], v37 offset:4608
    v_mfma_f32_16x16x32_bf16 v[132:135], v[220:223], v[48:51], v[132:135]
    ds_read_b64_tr_b16 v[216:217], v38 offset:4096
    ds_read_b64_tr_b16 v[218:219], v38 offset:4608
    buffer_load_dwordx4 v[48:51], v2, s[32:35], s20 offen offset:3072 sc1
    s_waitcnt vmcnt(7)
    s_waitcnt lgkmcnt(6)
    v_mfma_f32_16x16x32_bf16 v[120:123], v[192:195], v[224:227], v[120:123]
    ds_read_b64_tr_b16 v[220:221], v39 offset:4096
    ds_read_b64_tr_b16 v[222:223], v39 offset:4608
    v_mfma_f32_16x16x32_bf16 v[124:127], v[196:199], v[224:227], v[124:127]
    ds_read_b64_tr_b16 v[192:193], v36 offset:8192
    ds_read_b64_tr_b16 v[194:195], v36 offset:8704
    v_mfma_f32_16x16x32_bf16 v[128:131], v[200:203], v[224:227], v[128:131]
    ds_read_b64_tr_b16 v[196:197], v37 offset:8192
    ds_read_b64_tr_b16 v[198:199], v37 offset:8704
    v_mfma_f32_16x16x32_bf16 v[132:135], v[204:207], v[224:227], v[132:135]
    ds_read_b64_tr_b16 v[200:201], v38 offset:8192
    ds_read_b64_tr_b16 v[202:203], v38 offset:8704
    s_xor_b32 s96, s17, 24576
    s_add_u32 s20, s96, s19
    buffer_load_dwordx4 v[224:227], v2, s[32:35], s20 offen sc1
    s_waitcnt vmcnt(7)
    s_waitcnt lgkmcnt(6)
    v_mfma_f32_16x16x32_bf16 v[120:123], v[208:211], v[228:231], v[120:123]
    ds_read_b64_tr_b16 v[204:205], v39 offset:8192
    ds_read_b64_tr_b16 v[206:207], v39 offset:8704
    v_mfma_f32_16x16x32_bf16 v[124:127], v[212:215], v[228:231], v[124:127]
    ds_read_b64_tr_b16 v[208:209], v36 offset:12288
    ds_read_b64_tr_b16 v[210:211], v36 offset:12800
    v_xor_b32 v36, 16384, v36
    v_mfma_f32_16x16x32_bf16 v[128:131], v[216:219], v[228:231], v[128:131]
    ds_read_b64_tr_b16 v[212:213], v37 offset:12288
    ds_read_b64_tr_b16 v[214:215], v37 offset:12800
    v_xor_b32 v37, 16384, v37
    v_mfma_f32_16x16x32_bf16 v[132:135], v[220:223], v[228:231], v[132:135]
    ds_read_b64_tr_b16 v[216:217], v38 offset:12288
    ds_read_b64_tr_b16 v[218:219], v38 offset:12800
    v_xor_b32 v38, 16384, v38
    buffer_load_dwordx4 v[228:231], v2, s[32:35], s20 offen offset:1024 sc1
    s_waitcnt vmcnt(7)
    s_waitcnt lgkmcnt(6)
    v_mfma_f32_16x16x32_bf16 v[120:123], v[192:195], v[232:235], v[120:123]
    ds_read_b64_tr_b16 v[220:221], v39 offset:12288
    ds_read_b64_tr_b16 v[222:223], v39 offset:12800
    v_xor_b32 v39, 16384, v39
    v_mfma_f32_16x16x32_bf16 v[124:127], v[196:199], v[232:235], v[124:127]
    ds_read_b64_tr_b16 v[192:193], v36
    ds_read_b64_tr_b16 v[194:195], v36 offset:512
    v_mfma_f32_16x16x32_bf16 v[128:131], v[200:203], v[232:235], v[128:131]
    ds_read_b64_tr_b16 v[196:197], v37
    ds_read_b64_tr_b16 v[198:199], v37 offset:512
    v_mfma_f32_16x16x32_bf16 v[132:135], v[204:207], v[232:235], v[132:135]
    ds_read_b64_tr_b16 v[200:201], v38
    ds_read_b64_tr_b16 v[202:203], v38 offset:512
    buffer_load_dwordx4 v[232:235], v2, s[32:35], s20 offen offset:2048 sc1
    s_waitcnt vmcnt(7)
    s_waitcnt lgkmcnt(6)
    v_mfma_f32_16x16x32_bf16 v[120:123], v[208:211], v[236:239], v[120:123]
    ds_read_b64_tr_b16 v[204:205], v39
    ds_read_b64_tr_b16 v[206:207], v39 offset:512
    v_mfma_f32_16x16x32_bf16 v[124:127], v[212:215], v[236:239], v[124:127]
    ds_read_b64_tr_b16 v[208:209], v36 offset:4096
    ds_read_b64_tr_b16 v[210:211], v36 offset:4608
    v_mfma_f32_16x16x32_bf16 v[128:131], v[216:219], v[236:239], v[128:131]
    ds_read_b64_tr_b16 v[212:213], v37 offset:4096
    ds_read_b64_tr_b16 v[214:215], v37 offset:4608
    v_mfma_f32_16x16x32_bf16 v[132:135], v[220:223], v[236:239], v[132:135]
    ds_read_b64_tr_b16 v[216:217], v38 offset:4096
    ds_read_b64_tr_b16 v[218:219], v38 offset:4608
    buffer_load_dwordx4 v[236:239], v2, s[32:35], s20 offen offset:3072 sc1
    s_waitcnt vmcnt(7)
    s_waitcnt lgkmcnt(6)
    v_mfma_f32_16x16x32_bf16 v[120:123], v[192:195], v[240:243], v[120:123]
    ds_read_b64_tr_b16 v[220:221], v39 offset:4096
    ds_read_b64_tr_b16 v[222:223], v39 offset:4608
    v_mfma_f32_16x16x32_bf16 v[124:127], v[196:199], v[240:243], v[124:127]
    ds_read_b64_tr_b16 v[192:193], v36 offset:8192
    ds_read_b64_tr_b16 v[194:195], v36 offset:8704
    v_mfma_f32_16x16x32_bf16 v[128:131], v[200:203], v[240:243], v[128:131]
    ds_read_b64_tr_b16 v[196:197], v37 offset:8192
    ds_read_b64_tr_b16 v[198:199], v37 offset:8704
    v_mfma_f32_16x16x32_bf16 v[132:135], v[204:207], v[240:243], v[132:135]
    ds_read_b64_tr_b16 v[200:201], v38 offset:8192
    ds_read_b64_tr_b16 v[202:203], v38 offset:8704
    s_xor_b32 s96, s17, 28672
    s_add_u32 s20, s96, s19
    buffer_load_dwordx4 v[240:243], v2, s[32:35], s20 offen sc1
    s_waitcnt vmcnt(7)
    s_waitcnt lgkmcnt(6)
    v_mfma_f32_16x16x32_bf16 v[120:123], v[208:211], v[244:247], v[120:123]
    ds_read_b64_tr_b16 v[204:205], v39 offset:8192
    ds_read_b64_tr_b16 v[206:207], v39 offset:8704
    v_mfma_f32_16x16x32_bf16 v[124:127], v[212:215], v[244:247], v[124:127]
    ds_read_b64_tr_b16 v[208:209], v36 offset:12288
    ds_read_b64_tr_b16 v[210:211], v36 offset:12800
    v_xor_b32 v36, 49152, v36
    v_mfma_f32_16x16x32_bf16 v[128:131], v[216:219], v[244:247], v[128:131]
    ds_read_b64_tr_b16 v[212:213], v37 offset:12288
    ds_read_b64_tr_b16 v[214:215], v37 offset:12800
    v_xor_b32 v37, 49152, v37
    v_mfma_f32_16x16x32_bf16 v[132:135], v[220:223], v[244:247], v[132:135]
    ds_read_b64_tr_b16 v[216:217], v38 offset:12288
    ds_read_b64_tr_b16 v[218:219], v38 offset:12800
    v_xor_b32 v38, 49152, v38
    buffer_load_dwordx4 v[244:247], v2, s[32:35], s20 offen offset:1024 sc1
    s_waitcnt vmcnt(7)
    s_waitcnt lgkmcnt(6)
    v_mfma_f32_16x16x32_bf16 v[120:123], v[192:195], v[44:47], v[120:123]
    ds_read_b64_tr_b16 v[220:221], v39 offset:12288
    ds_read_b64_tr_b16 v[222:223], v39 offset:12800
    v_xor_b32 v39, 49152, v39
    v_mfma_f32_16x16x32_bf16 v[124:127], v[196:199], v[44:47], v[124:127]
    ds_read_b64_tr_b16 v[192:193], v36
    ds_read_b64_tr_b16 v[194:195], v36 offset:512
    v_mfma_f32_16x16x32_bf16 v[128:131], v[200:203], v[44:47], v[128:131]
    ds_read_b64_tr_b16 v[196:197], v37
    ds_read_b64_tr_b16 v[198:199], v37 offset:512
    v_mfma_f32_16x16x32_bf16 v[132:135], v[204:207], v[44:47], v[132:135]
    ds_read_b64_tr_b16 v[200:201], v38
    ds_read_b64_tr_b16 v[202:203], v38 offset:512
    buffer_load_dwordx4 v[44:47], v2, s[32:35], s20 offen offset:2048 sc1
    s_waitcnt vmcnt(7)
    s_waitcnt lgkmcnt(6)
    v_mfma_f32_16x16x32_bf16 v[120:123], v[208:211], v[48:51], v[120:123]
    ds_read_b64_tr_b16 v[204:205], v39
    ds_read_b64_tr_b16 v[206:207], v39 offset:512
    v_mfma_f32_16x16x32_bf16 v[124:127], v[212:215], v[48:51], v[124:127]
    ds_read_b64_tr_b16 v[208:209], v36 offset:4096
    ds_read_b64_tr_b16 v[210:211], v36 offset:4608
    v_mfma_f32_16x16x32_bf16 v[128:131], v[216:219], v[48:51], v[128:131]
    ds_read_b64_tr_b16 v[212:213], v37 offset:4096
    ds_read_b64_tr_b16 v[214:215], v37 offset:4608
    v_mfma_f32_16x16x32_bf16 v[132:135], v[220:223], v[48:51], v[132:135]
    ds_read_b64_tr_b16 v[216:217], v38 offset:4096
    ds_read_b64_tr_b16 v[218:219], v38 offset:4608
    buffer_load_dwordx4 v[48:51], v2, s[32:35], s20 offen offset:3072 sc1
    buffer_load_dwordx2 v[40:41], v10, s[32:35], s13 offen sc1
    s_mov_b32 s82, s80
    buffer_load_dwordx4 v[88:91], v27, s[56:59], s82 offen nt
    s_add_u32 s82, s80, 57344
    buffer_load_dwordx4 v[92:95], v27, s[56:59], s82 offen nt
    s_waitcnt vmcnt(10)
    s_waitcnt lgkmcnt(6)
    v_mfma_f32_16x16x32_bf16 v[120:123], v[192:195], v[224:227], v[120:123]
    ds_read_b64_tr_b16 v[220:221], v39 offset:4096
    ds_read_b64_tr_b16 v[222:223], v39 offset:4608
    v_mfma_f32_16x16x32_bf16 v[124:127], v[196:199], v[224:227], v[124:127]
    ds_read_b64_tr_b16 v[192:193], v36 offset:8192
    ds_read_b64_tr_b16 v[194:195], v36 offset:8704
    v_mfma_f32_16x16x32_bf16 v[128:131], v[200:203], v[224:227], v[128:131]
    ds_read_b64_tr_b16 v[196:197], v37 offset:8192
    ds_read_b64_tr_b16 v[198:199], v37 offset:8704
    v_mfma_f32_16x16x32_bf16 v[132:135], v[204:207], v[224:227], v[132:135]
    ds_read_b64_tr_b16 v[200:201], v38 offset:8192
    ds_read_b64_tr_b16 v[202:203], v38 offset:8704
    s_waitcnt vmcnt(9)
    s_waitcnt lgkmcnt(6)
    v_mfma_f32_16x16x32_bf16 v[120:123], v[208:211], v[228:231], v[120:123]
    ds_read_b64_tr_b16 v[204:205], v39 offset:8192
    ds_read_b64_tr_b16 v[206:207], v39 offset:8704
    v_mfma_f32_16x16x32_bf16 v[124:127], v[212:215], v[228:231], v[124:127]
    ds_read_b64_tr_b16 v[208:209], v36 offset:12288
    ds_read_b64_tr_b16 v[210:211], v36 offset:12800
    v_xor_b32 v36, 16384, v36
    v_mfma_f32_16x16x32_bf16 v[128:131], v[216:219], v[228:231], v[128:131]
    ds_read_b64_tr_b16 v[212:213], v37 offset:12288
    ds_read_b64_tr_b16 v[214:215], v37 offset:12800
    v_xor_b32 v37, 16384, v37
    v_mfma_f32_16x16x32_bf16 v[132:135], v[220:223], v[228:231], v[132:135]
    ds_read_b64_tr_b16 v[216:217], v38 offset:12288
    ds_read_b64_tr_b16 v[218:219], v38 offset:12800
    v_xor_b32 v38, 16384, v38
    s_waitcnt vmcnt(8)
    s_waitcnt lgkmcnt(6)
    v_mfma_f32_16x16x32_bf16 v[120:123], v[192:195], v[232:235], v[120:123]
    ds_read_b64_tr_b16 v[220:221], v39 offset:12288
    ds_read_b64_tr_b16 v[222:223], v39 offset:12800
    v_xor_b32 v39, 16384, v39
    v_mfma_f32_16x16x32_bf16 v[124:127], v[196:199], v[232:235], v[124:127]
    ds_read_b64_tr_b16 v[192:193], v36
    ds_read_b64_tr_b16 v[194:195], v36 offset:512
    v_mfma_f32_16x16x32_bf16 v[128:131], v[200:203], v[232:235], v[128:131]
    ds_read_b64_tr_b16 v[196:197], v37
    ds_read_b64_tr_b16 v[198:199], v37 offset:512
    v_mfma_f32_16x16x32_bf16 v[132:135], v[204:207], v[232:235], v[132:135]
    ds_read_b64_tr_b16 v[200:201], v38
    ds_read_b64_tr_b16 v[202:203], v38 offset:512
    s_waitcnt vmcnt(7)
    s_waitcnt lgkmcnt(6)
    v_mfma_f32_16x16x32_bf16 v[120:123], v[208:211], v[236:239], v[120:123]
    ds_read_b64_tr_b16 v[204:205], v39
    ds_read_b64_tr_b16 v[206:207], v39 offset:512
    v_mfma_f32_16x16x32_bf16 v[124:127], v[212:215], v[236:239], v[124:127]
    ds_read_b64_tr_b16 v[208:209], v36 offset:4096
    ds_read_b64_tr_b16 v[210:211], v36 offset:4608
    v_mfma_f32_16x16x32_bf16 v[128:131], v[216:219], v[236:239], v[128:131]
    ds_read_b64_tr_b16 v[212:213], v37 offset:4096
    ds_read_b64_tr_b16 v[214:215], v37 offset:4608
    v_mfma_f32_16x16x32_bf16 v[132:135], v[220:223], v[236:239], v[132:135]
    ds_read_b64_tr_b16 v[216:217], v38 offset:4096
    ds_read_b64_tr_b16 v[218:219], v38 offset:4608
    s_waitcnt vmcnt(6)
    s_waitcnt lgkmcnt(6)
    v_mfma_f32_16x16x32_bf16 v[120:123], v[192:195], v[240:243], v[120:123]
    ds_read_b64_tr_b16 v[220:221], v39 offset:4096
    ds_read_b64_tr_b16 v[222:223], v39 offset:4608
    v_mfma_f32_16x16x32_bf16 v[124:127], v[196:199], v[240:243], v[124:127]
    ds_read_b64_tr_b16 v[192:193], v36 offset:8192
    ds_read_b64_tr_b16 v[194:195], v36 offset:8704
    v_mfma_f32_16x16x32_bf16 v[128:131], v[200:203], v[240:243], v[128:131]
    ds_read_b64_tr_b16 v[196:197], v37 offset:8192
    ds_read_b64_tr_b16 v[198:199], v37 offset:8704
    v_mfma_f32_16x16x32_bf16 v[132:135], v[204:207], v[240:243], v[132:135]
    ds_read_b64_tr_b16 v[200:201], v38 offset:8192
    ds_read_b64_tr_b16 v[202:203], v38 offset:8704
    s_waitcnt vmcnt(5)
    s_waitcnt lgkmcnt(6)
    v_mfma_f32_16x16x32_bf16 v[120:123], v[208:211], v[244:247], v[120:123]
    ds_read_b64_tr_b16 v[204:205], v39 offset:8192
    ds_read_b64_tr_b16 v[206:207], v39 offset:8704
    v_mfma_f32_16x16x32_bf16 v[124:127], v[212:215], v[244:247], v[124:127]
    ds_read_b64_tr_b16 v[208:209], v36 offset:12288
    ds_read_b64_tr_b16 v[210:211], v36 offset:12800
    v_mfma_f32_16x16x32_bf16 v[128:131], v[216:219], v[244:247], v[128:131]
    ds_read_b64_tr_b16 v[212:213], v37 offset:12288
    ds_read_b64_tr_b16 v[214:215], v37 offset:12800
    v_mfma_f32_16x16x32_bf16 v[132:135], v[220:223], v[244:247], v[132:135]
    ds_read_b64_tr_b16 v[216:217], v38 offset:12288
    ds_read_b64_tr_b16 v[218:219], v38 offset:12800
    s_waitcnt vmcnt(4)
    s_waitcnt lgkmcnt(6)
    v_mfma_f32_16x16x32_bf16 v[120:123], v[192:195], v[44:47], v[120:123]
    ds_read_b64_tr_b16 v[220:221], v39 offset:12288
    ds_read_b64_tr_b16 v[222:223], v39 offset:12800
    v_mfma_f32_16x16x32_bf16 v[124:127], v[196:199], v[44:47], v[124:127]
    v_mfma_f32_16x16x32_bf16 v[128:131], v[200:203], v[44:47], v[128:131]
    v_mfma_f32_16x16x32_bf16 v[132:135], v[204:207], v[44:47], v[132:135]
    s_waitcnt vmcnt(3)
    s_waitcnt lgkmcnt(0)
    v_mfma_f32_16x16x32_bf16 v[120:123], v[208:211], v[48:51], v[120:123]
    v_mfma_f32_16x16x32_bf16 v[124:127], v[212:215], v[48:51], v[124:127]
    v_mfma_f32_16x16x32_bf16 v[128:131], v[216:219], v[48:51], v[128:131]
    v_mfma_f32_16x16x32_bf16 v[132:135], v[220:223], v[48:51], v[132:135]
    s_lshl3_add_u32 s96, s21, s3
    s_lshl4_add_u32 s97, s96, s12
    s_lshl_b32 s98, s97, 8
    s_add_u32 s14, s98, 12582912
    v_and_b32 v28, 15, v1
    v_lshlrev_b32 v28, 4, v28
    v_lshrrev_b32 v9, 4, v1
    v_lshl_add_u32 v28, v9, 2, v28
    v_cvt_pk_bf16_f32 v120, 0, v120
    v_cvt_pk_bf16_f32 v121, 0, v121
    v_cvt_pk_bf16_f32 v122, 0, v122
    v_cvt_pk_bf16_f32 v123, 0, v123
    v_cvt_pk_bf16_f32 v124, 0, v124
    v_cvt_pk_bf16_f32 v125, 0, v125
    v_cvt_pk_bf16_f32 v126, 0, v126
    v_cvt_pk_bf16_f32 v127, 0, v127
    v_pk_mul_f32 v[120:121], v[120:121], v[136:137]
    v_pk_mul_f32 v[122:123], v[122:123], v[138:139]
    v_pk_mul_f32 v[124:125], v[124:125], v[140:141]
    v_pk_mul_f32 v[126:127], v[126:127], v[142:143]
    v_cvt_pk_bf16_f32 v120, 0, v120
    v_cvt_pk_bf16_f32 v121, 0, v121
    v_cvt_pk_bf16_f32 v122, 0, v122
    v_cvt_pk_bf16_f32 v123, 0, v123
    v_cvt_pk_bf16_f32 v124, 0, v124
    v_cvt_pk_bf16_f32 v125, 0, v125
    v_cvt_pk_bf16_f32 v126, 0, v126
    v_cvt_pk_bf16_f32 v127, 0, v127
    v_pk_add_f32 v[120:121], v[120:121], v[152:153]
    v_pk_add_f32 v[122:123], v[122:123], v[154:155]
    v_pk_add_f32 v[124:125], v[124:125], v[156:157]
    v_pk_add_f32 v[126:127], v[126:127], v[158:159]
    v_cvt_pk_bf16_f32 v12, v120, v121
    v_cvt_pk_bf16_f32 v13, v122, v123
    v_cvt_pk_bf16_f32 v14, v124, v125
    v_cvt_pk_bf16_f32 v15, v126, v127
    v_dot2_f32_bf16 v4, v12, v12, 0
    v_dot2_f32_bf16 v5, v13, v13, 0
    v_dot2_f32_bf16 v4, v14, v14, v4
    v_dot2_f32_bf16 v5, v15, v15, v5
    v_mfma_f32_16x16x32_bf16 v[240:243], v[184:187], v[12:15], 0
    v_cvt_pk_bf16_f32 v128, 0, v128
    v_cvt_pk_bf16_f32 v129, 0, v129
    v_cvt_pk_bf16_f32 v130, 0, v130
    v_cvt_pk_bf16_f32 v131, 0, v131
    v_cvt_pk_bf16_f32 v132, 0, v132
    v_cvt_pk_bf16_f32 v133, 0, v133
    v_cvt_pk_bf16_f32 v134, 0, v134
    v_cvt_pk_bf16_f32 v135, 0, v135
    v_pk_mul_f32 v[128:129], v[128:129], v[144:145]
    v_pk_mul_f32 v[130:131], v[130:131], v[146:147]
    v_pk_mul_f32 v[132:133], v[132:133], v[148:149]
    v_pk_mul_f32 v[134:135], v[134:135], v[150:151]
    v_cvt_pk_bf16_f32 v128, 0, v128
    v_cvt_pk_bf16_f32 v129, 0, v129
    v_cvt_pk_bf16_f32 v130, 0, v130
    v_cvt_pk_bf16_f32 v131, 0, v131
    v_cvt_pk_bf16_f32 v132, 0, v132
    v_cvt_pk_bf16_f32 v133, 0, v133
    v_cvt_pk_bf16_f32 v134, 0, v134
    v_cvt_pk_bf16_f32 v135, 0, v135
    v_pk_add_f32 v[128:129], v[128:129], v[160:161]
    v_pk_add_f32 v[130:131], v[130:131], v[162:163]
    v_pk_add_f32 v[132:133], v[132:133], v[164:165]
    v_pk_add_f32 v[134:135], v[134:135], v[166:167]
    v_cvt_pk_bf16_f32 v16, v128, v129
    v_cvt_pk_bf16_f32 v17, v130, v131
    v_cvt_pk_bf16_f32 v18, v132, v133
    v_cvt_pk_bf16_f32 v19, v134, v135
    v_dot2_f32_bf16 v4, v16, v16, v4
    v_dot2_f32_bf16 v5, v17, v17, v5
    v_dot2_f32_bf16 v4, v18, v18, v4
    v_dot2_f32_bf16 v5, v19, v19, v5
    v_mfma_f32_16x16x32_bf16 v[240:243], v[188:191], v[16:19], v[240:243]
    v_and_b32 v7, 7, v1
    v_lshlrev_b32 v7, 15, v7
    v_bfe_u32 v9, v1, 3, 1
    v_lshl_add_u32 v7, v9, 12, v7
    v_add_f32 v4, v4, v5
    v_mov_b32 v5, v4
    s_nop 1
    v_permlane32_swap_b32 v4, v5
    v_add_f32 v4, v4, v5
    v_mov_b32 v5, v4
    s_nop 1
    v_permlane16_swap_b32 v4, v5
    v_add_f32 v4, v4, v5
    s_nop 1
    v_mov_b32_dpp v240, v4 quad_perm:[0,1,2,3] row_mask:0x8 bank_mask:0xf
    buffer_store_dword v240, v28, s[32:35], s14 offen sc1
    s_and_b32 s96, s12, 1
    s_lshr_b32 s97, s21, 2
    s_and_b32 s98, s21, 3
    s_lshl_b32 s99, s98, 6
    s_lshl1_add_u32 s98, s97, s99
    s_lshl_b32 s97, s98, 12
    s_lshr_b32 s99, s12, 1
    s_lshl_b32 s98, s99, 6
    s_add_u32 s99, s97, s98
    s_lshl2_add_u32 s97, s96, s99
    s_add_u32 s98, s97, 1048576
    s_add_u32 s16, s98, 1536
    s_barrier
    s_cmp_lg_u32 s3, 0
    s_cbranch_scc1 L_PE
    v_mov_b32 v6, s4
    s_mov_b32 exec_hi, 0
    s_mov_b32 exec_lo, 65535
    buffer_store_dword v6, v7, s[32:35], s16 offen sc1
    s_mov_b64 exec, -1
L_PE:
    s_add_u32 s82, s80, 114688
    s_lshl2_add_u32 m0, s83, 34816
    s_nop 0
    buffer_load_dwordx4 v27, s[56:59], s82 offen nt lds
    s_add_u32 s82, s80, 172032
    s_lshl2_add_u32 m0, s83, 35840
    s_nop 0
    buffer_load_dwordx4 v27, s[56:59], s82 offen nt lds
    s_lshl_b32 s15, s3, 12
    v_add_u32 v4, s15, v2
    v_add_u32 v7, 65536, v4
    s_waitcnt vmcnt(5)
    v_cmp_ne_u32 vcc, s4, v41
    s_cbranch_vccz L_UPOK
POLL_31:
    buffer_load_dwordx2 v[40:41], v10, s[32:35], s13 offen sc1
    s_waitcnt vmcnt(0)
    v_cmp_ne_u32 vcc, s4, v41
    s_cbranch_vccz PDONE_32
    s_add_u32 s5, s5, 1
    s_cmp_lt_u32 s5, 200000
    s_cbranch_scc1 POLL_31
PDONE_32:
L_UPOK:
    s_lshl3_add_u32 s96, s21, s3
    s_lshl_b32 s97, s96, 12
    s_add_u32 s14, s97, 12582912
    s_load_dwordx2 s[24:25], s[32:33], s92 offset:1536 glc
    v_add_f32_dpp v40, v40, v40 quad_perm:[1,0,3,2] row_mask:0xf bank_mask:0xf
    s_nop 1
    v_add_f32_dpp v40, v40, v40 quad_perm:[2,3,0,1] row_mask:0xf bank_mask:0xf
    s_nop 1
    v_add_f32_dpp v40, v40, v40 row_half_mirror row_mask:0xf bank_mask:0xf
    s_nop 1
    v_add_f32_dpp v40, v40, v40 row_mirror row_mask:0xf bank_mask:0xf
    v_lshlrev_b32 v152, 16, v12
    v_and_b32 v153, s6, v12
    v_lshlrev_b32 v154, 16, v13
    v_and_b32 v155, s6, v13
    v_lshlrev_b32 v156, 16, v14
    v_and_b32 v157, s6, v14
    v_lshlrev_b32 v158, 16, v15
    v_and_b32 v159, s6, v15
    v_lshlrev_b32 v160, 16, v16
    v_and_b32 v161, s6, v16
    v_lshlrev_b32 v162, 16, v17
    v_and_b32 v163, s6, v17
    v_lshlrev_b32 v164, 16, v18
    v_and_b32 v165, s6, v18
    v_lshlrev_b32 v166, 16, v19
    v_and_b32 v167, s6, v19
    s_lshl_b32 s96, s3, 9
    s_lshl1_add_u32 s15, s21, s96
    v_and_b32 v29, 15, v1
    v_lshl_add_u32 v29, v29, 5, s15
    v_xor_b32 v5, 0x4000, v4
    v_xor_b32 v8, 0x4000, v7
    s_waitcnt vmcnt(3)
    ds_write_b128 v4, v[88:91] offset:32768
    ds_write_b128 v4, v[92:95] offset:33792
    s_cmp_lt_u32 s3, 4
    s_cbranch_scc1 L_FW1
    ds_write_b128 v4, v[56:59] offset:0
    ds_write_b128 v5, v[60:63] offset:0
    ds_write_b128 v4, v[64:67] offset:1024
    ds_write_b128 v5, v[68:71] offset:1024
    ds_write_b128 v4, v[72:75] offset:2048
    ds_write_b128 v5, v[76:79] offset:2048
    ds_write_b128 v4, v[80:83] offset:3072
    ds_write_b128 v5, v[84:87] offset:3072
L_FW1:
    s_branch SCHK_34
SPOLL_33:
    s_load_dwordx2 s[24:25], s[32:33], s92 offset:1536 glc
SCHK_34:
    s_add_u32 s5, s5, 1
    s_cmp_ge_u32 s5, 200000
    s_waitcnt lgkmcnt(0)
    s_cbranch_scc1 SDONE_35
    s_cmp_lg_u32 s24, s4
    s_cbranch_scc1 SPOLL_33
    s_cmp_lg_u32 s25, s4
    s_cbranch_scc1 SPOLL_33
SDONE_35:
    s_barrier
    buffer_load_dwordx4 v[192:195], v2, s[32:35], s14 offen sc1
    buffer_load_dwordx4 v[196:199], v2, s[32:35], s14 offen offset:1024 sc1
    buffer_load_dwordx4 v[200:203], v2, s[32:35], s14 offen offset:2048 sc1
    buffer_load_dwordx4 v[204:207], v2, s[32:35], s14 offen offset:3072 sc1
    s_barrier
    s_mov_b32 s82, s81
    s_lshl2_add_u32 m0, s83, 65536
    s_nop 0
    buffer_load_dwordx4 v253, s[60:63], s82 offen nt lds
    s_add_u32 s82, s81, 4096
    s_lshl2_add_u32 m0, s83, 66560
    s_nop 0
    buffer_load_dwordx4 v253, s[60:63], s82 offen nt lds
    s_add_u32 s82, s81, 8192
    s_lshl2_add_u32 m0, s83, 67584
    s_nop 0
    buffer_load_dwordx4 v253, s[60:63], s82 offen nt lds
    s_add_u32 s82, s81, 12288
    s_lshl2_add_u32 m0, s83, 68608
    s_nop 0
    buffer_load_dwordx4 v253, s[60:63], s82 offen nt lds
    v_mov_b32_dpp v88, v42 row_newbcast:0 row_mask:0xf bank_mask:0xf
    v_mov_b32_dpp v89, v42 row_newbcast:1 row_mask:0xf bank_mask:0xf
    v_mov_b32_dpp v90, v42 row_newbcast:2 row_mask:0xf bank_mask:0xf
    v_mov_b32_dpp v91, v42 row_newbcast:3 row_mask:0xf bank_mask:0xf
    v_mov_b32_dpp v92, v42 row_newbcast:4 row_mask:0xf bank_mask:0xf
    v_mov_b32_dpp v93, v42 row_newbcast:5 row_mask:0xf bank_mask:0xf
    v_mov_b32_dpp v94, v42 row_newbcast:6 row_mask:0xf bank_mask:0xf
    v_mov_b32_dpp v95, v42 row_newbcast:7 row_mask:0xf bank_mask:0xf
    v_mov_b32_dpp v96, v42 row_newbcast:8 row_mask:0xf bank_mask:0xf
    v_mov_b32_dpp v97, v42 row_newbcast:9 row_mask:0xf bank_mask:0xf
    v_mov_b32_dpp v98, v42 row_newbcast:10 row_mask:0xf bank_mask:0xf
    v_mov_b32_dpp v99, v42 row_newbcast:11 row_mask:0xf bank_mask:0xf
    v_mov_b32_dpp v100, v42 row_newbcast:12 row_mask:0xf bank_mask:0xf
    v_mov_b32_dpp v101, v42 row_newbcast:13 row_mask:0xf bank_mask:0xf
    v_mov_b32_dpp v102, v42 row_newbcast:14 row_mask:0xf bank_mask:0xf
    v_mov_b32_dpp v103, v42 row_newbcast:15 row_mask:0xf bank_mask:0xf
    v_mov_b32_dpp v104, v43 row_newbcast:0 row_mask:0xf bank_mask:0xf
    v_mov_b32_dpp v105, v43 row_newbcast:1 row_mask:0xf bank_mask:0xf
    v_mov_b32_dpp v106, v43 row_newbcast:2 row_mask:0xf bank_mask:0xf
    v_mov_b32_dpp v107, v43 row_newbcast:3 row_mask:0xf bank_mask:0xf
    v_mov_b32_dpp v108, v43 row_newbcast:4 row_mask:0xf bank_mask:0xf
L_PAD9:
    s_cbranch_execz L_RET9
    v_mov_b32_dpp v109, v43 row_newbcast:5 row_mask:0xf bank_mask:0xf
    v_mov_b32_dpp v110, v43 row_newbcast:6 row_mask:0xf bank_mask:0xf
    v_mov_b32_dpp v111, v43 row_newbcast:7 row_mask:0xf bank_mask:0xf
    v_mov_b32_dpp v112, v43 row_newbcast:8 row_mask:0xf bank_mask:0xf
    v_mov_b32_dpp v113, v43 row_newbcast:9 row_mask:0xf bank_mask:0xf
    v_mov_b32_dpp v114, v43 row_newbcast:10 row_mask:0xf bank_mask:0xf
    v_mov_b32_dpp v115, v43 row_newbcast:11 row_mask:0xf bank_mask:0xf
    v_mov_b32_dpp v116, v43 row_newbcast:12 row_mask:0xf bank_mask:0xf
    v_mov_b32_dpp v117, v43 row_newbcast:13 row_mask:0xf bank_mask:0xf
    v_mov_b32_dpp v118, v43 row_newbcast:14 row_mask:0xf bank_mask:0xf
    v_mov_b32_dpp v119, v43 row_newbcast:15 row_mask:0xf bank_mask:0xf
    s_lshl3_add_u32 s15, s3, 156160
    v_mov_b32 v4, s15
    v_and_b32 v5, 7, v1
    v_lshlrev_b32 v5, 3, v5
    v_add_u32 v5, 156160, v5
    v_and_b32 v6, 3, v1
    v_lshlrev_b32 v6, 18, v6
    v_bfe_u32 v9, v1, 2, 2
    v_lshl_add_u32 v6, v9, 13, v6
    s_and_b32 s96, s21, 1
    s_and_b32 s97, s12, 7
    s_lshr_b32 s98, s12, 3
    s_lshl3_add_u32 s99, s97, s98
    s_lshl_b32 s97, s99, 12
    s_lshr_b32 s98, s21, 1
    s_lshl_b32 s99, s98, 6
    s_add_u32 s98, s97, s99
    s_lshl4_add_u32 s97, s96, s98
    s_add_u32 s99, s97, 1048576
    s_add_u32 s16, s99, 2560
    s_waitcnt vmcnt(4)
    v_pk_add_f32 v[192:193], v[192:193], v[196:197]
    v_pk_add_f32 v[200:201], v[200:201], v[204:205]
    v_pk_add_f32 v[194:195], v[194:195], v[198:199]
    v_pk_add_f32 v[202:203], v[202:203], v[206:207]
    v_pk_add_f32 v[192:193], v[192:193], v[200:201]
    v_pk_add_f32 v[194:195], v[194:195], v[202:203]
    v_add_f32 v193, v193, v194
    v_add_f32 v197, v192, v195
    v_cmp_u_f32 vcc, v193, v197
    s_cbranch_vccz POK_37
PRE_38:
    buffer_load_dwordx4 v[192:195], v2, s[32:35], s14 offen sc1
    buffer_load_dwordx4 v[196:199], v2, s[32:35], s14 offen offset:1024 sc1
    buffer_load_dwordx4 v[200:203], v2, s[32:35], s14 offen offset:2048 sc1
    buffer_load_dwordx4 v[204:207], v2, s[32:35], s14 offen offset:3072 sc1
    s_waitcnt vmcnt(0)
    v_pk_add_f32 v[192:193], v[192:193], v[196:197]
    v_pk_add_f32 v[200:201], v[200:201], v[204:205]
    v_pk_add_f32 v[194:195], v[194:195], v[198:199]
    v_pk_add_f32 v[202:203], v[202:203], v[206:207]
    v_pk_add_f32 v[192:193], v[192:193], v[200:201]
    v_pk_add_f32 v[194:195], v[194:195], v[202:203]
    v_add_f32 v193, v193, v194
    v_add_f32 v197, v192, v195
    v_cmp_u_f32 vcc, v193, v197
    s_cbranch_vccz POK_37
    s_add_u32 s5, s5, 1
    s_cmp_lt_u32 s5, 200000
    s_cbranch_scc1 PRE_38
POK_37:
    v_mov_b32 v196, v195
    s_nop 1
    v_permlane32_swap_b32 v195, v196
    v_permlane32_swap_b32 v192, v193
    v_add_f32 v195, v195, v196
    v_add_f32 v192, v192, v193
    s_nop 1
    v_permlane16_swap_b32 v192, v195
    v_add_f32 v193, v192, v195
    v_add_f32 v195, v192, v195
    s_nop 1
    v_permlane16_swap_b32 v193, v195
    v_mov_b32 v192, v193
    v_mul_f32 v195, 0x3a800000, v195
    s_nop 0
    v_permlane32_swap_b32 v192, v193
    v_mul_f32 v192, 0x3a800000, v192
    v_fma_f32 v31, -v192, v192, v195
    v_cvt_pk_bf16_f32 v30, 0, v192
    v_max_f32 v31, 0, v31
    v_cvt_pk_bf16_f32 v31, 0, v31
    v_fma_f32 v193, -v30, v40, v193
    v_add_f32 v31, 0x3727c5ac, v31
    v_cvt_pk_bf16_f32 v31, 0, v31
    v_sqrt_f32 v31, v31
    s_nop 0
    v_cvt_pk_bf16_f32 v31, 0, v31
    v_rcp_f32 v31, v31
    s_nop 0
    v_mul_f32 v32, v193, v31
    v_ashrrev_i32 v196, 31, v32
    v_or_b32 v196, 0x80000000, v196
    v_xor_b32 v32, v32, v196
    s_mov_b32 s15, 0xfffff000
    v_and_or_b32 v32, v32, s15, v29
    s_nop 1
    v_max_u32_dpp v244, v32, v32 quad_perm:[1,0,3,2] row_mask:0xf bank_mask:0xf
    v_min_u32_dpp v245, v32, v32 quad_perm:[1,0,3,2] row_mask:0xf bank_mask:0xf
    s_nop 0
    v_min_u32_dpp v196, v244, v244 quad_perm:[2,3,0,1] row_mask:0xf bank_mask:0xf
    v_max_u32_dpp v245, v245, v245 quad_perm:[2,3,0,1] row_mask:0xf bank_mask:0xf
    v_max_u32_dpp v244, v244, v244 quad_perm:[2,3,0,1] row_mask:0xf bank_mask:0xf
    v_max_u32 v245, v245, v196
    s_nop 0
    v_min_u32_dpp v196, v244, v244 row_half_mirror row_mask:0xf bank_mask:0xf
    v_max_u32_dpp v245, v245, v245 row_half_mirror row_mask:0xf bank_mask:0xf
    v_max_u32_dpp v244, v244, v244 row_half_mirror row_mask:0xf bank_mask:0xf
    v_max_u32 v245, v245, v196
    s_nop 0
    v_min_u32_dpp v196, v244, v244 row_mirror row_mask:0xf bank_mask:0xf
    v_max_u32_dpp v245, v245, v245 row_mirror row_mask:0xf bank_mask:0xf
    v_max_u32_dpp v244, v244, v244 row_mirror row_mask:0xf bank_mask:0xf
    v_max_u32 v245, v245, v196
    ds_write_b64 v4, v[244:245]
    s_waitcnt lgkmcnt(0)
    s_barrier
    ds_read_b64 v[244:245], v5
    v_pk_add_f32 v[208:209], v[152:153], v[30:31] op_sel_hi:[1,0] neg_lo:[0,1] neg_hi:[0,1]
    v_pk_add_f32 v[210:211], v[154:155], v[30:31] op_sel_hi:[1,0] neg_lo:[0,1] neg_hi:[0,1]
    v_pk_add_f32 v[212:213], v[156:157], v[30:31] op_sel_hi:[1,0] neg_lo:[0,1] neg_hi:[0,1]
    v_pk_add_f32 v[214:215], v[158:159], v[30:31] op_sel_hi:[1,0] neg_lo:[0,1] neg_hi:[0,1]
    v_pk_add_f32 v[216:217], v[160:161], v[30:31] op_sel_hi:[1,0] neg_lo:[0,1] neg_hi:[0,1]
    v_pk_add_f32 v[218:219], v[162:163], v[30:31] op_sel_hi:[1,0] neg_lo:[0,1] neg_hi:[0,1]
    v_pk_add_f32 v[220:221], v[164:165], v[30:31] op_sel_hi:[1,0] neg_lo:[0,1] neg_hi:[0,1]
    v_pk_add_f32 v[222:223], v[166:167], v[30:31] op_sel_hi:[1,0] neg_lo:[0,1] neg_hi:[0,1]
    s_waitcnt lgkmcnt(0)
    v_min_u32_dpp v196, v244, v244 quad_perm:[1,0,3,2] row_mask:0xf bank_mask:0xf
    v_max_u32_dpp v245, v245, v245 quad_perm:[1,0,3,2] row_mask:0xf bank_mask:0xf
    v_max_u32_dpp v244, v244, v244 quad_perm:[1,0,3,2] row_mask:0xf bank_mask:0xf
    v_max_u32 v245, v245, v196
    s_nop 0
    v_min_u32_dpp v196, v244, v244 quad_perm:[2,3,0,1] row_mask:0xf bank_mask:0xf
    v_max_u32_dpp v245, v245, v245 quad_perm:[2,3,0,1] row_mask:0xf bank_mask:0xf
    v_max_u32_dpp v244, v244, v244 quad_perm:[2,3,0,1] row_mask:0xf bank_mask:0xf
    v_max_u32 v245, v245, v196
    s_nop 0
    v_min_u32_dpp v196, v244, v244 row_half_mirror row_mask:0xf bank_mask:0xf
    v_max_u32_dpp v245, v245, v245 row_half_mirror row_mask:0xf bank_mask:0xf
    v_max_u32_dpp v244, v244, v244 row_half_mirror row_mask:0xf bank_mask:0xf
    v_max_u32 v245, v245, v196
    v_cmp_eq_u32 s[88:89], v32, v245
    v_cmp_eq_u32 vcc, v32, v244
    v_or_b32 v246, 1, v245
    v_mov_b32 v245, s4
    v_mov_b32 v247, s4
    s_or_b64 s[84:85], vcc, s[88:89]
    s_cmp_lg_u32 s3, 0
    s_cbranch_scc1 L_NOF
    s_mov_b64 exec, 0xffff
    buffer_store_dwordx4 v[244:247], v6, s[32:35], s16 offen sc1
    s_mov_b64 exec, -1
L_NOF:
    s_lshl4_add_u32 s13, s3, 156288
    v_mov_b32 v4, s13
    v_and_b32 v5, 7, v1
    v_lshlrev_b32 v5, 4, v5
    v_add_u32 v5, 156288, v5
    s_load_dwordx8 s[24:31], s[32:33], s92 offset:2560 glc
    v_cvt_pk_bf16_f32 v208, 0, v208
    v_cvt_pk_bf16_f32 v209, 0, v209
    v_cvt_pk_bf16_f32 v210, 0, v210
    v_cvt_pk_bf16_f32 v211, 0, v211
    v_cvt_pk_bf16_f32 v212, 0, v212
    v_cvt_pk_bf16_f32 v213, 0, v213
    v_cvt_pk_bf16_f32 v214, 0, v214
    v_cvt_pk_bf16_f32 v215, 0, v215
    v_cvt_pk_bf16_f32 v216, 0, v216
    v_cvt_pk_bf16_f32 v217, 0, v217
    v_cvt_pk_bf16_f32 v218, 0, v218
    v_cvt_pk_bf16_f32 v219, 0, v219
    v_cvt_pk_bf16_f32 v220, 0, v220
    v_cvt_pk_bf16_f32 v221, 0, v221
    v_cvt_pk_bf16_f32 v222, 0, v222
    v_cvt_pk_bf16_f32 v223, 0, v223
    v_pk_mul_f32 v[208:209], v[30:31], v[208:209] op_sel:[1,0]
    v_pk_mul_f32 v[210:211], v[30:31], v[210:211] op_sel:[1,0]
    v_pk_mul_f32 v[212:213], v[30:31], v[212:213] op_sel:[1,0]
    v_pk_mul_f32 v[214:215], v[30:31], v[214:215] op_sel:[1,0]
    v_pk_mul_f32 v[216:217], v[30:31], v[216:217] op_sel:[1,0]
    v_pk_mul_f32 v[218:219], v[30:31], v[218:219] op_sel:[1,0]
    v_pk_mul_f32 v[220:221], v[30:31], v[220:221] op_sel:[1,0]
    v_pk_mul_f32 v[222:223], v[30:31], v[222:223] op_sel:[1,0]
    v_cvt_pk_bf16_f32 v208, 0, v208
    v_cvt_pk_bf16_f32 v209, 0, v209
    v_cvt_pk_bf16_f32 v210, 0, v210
    v_cvt_pk_bf16_f32 v211, 0, v211
    v_cvt_pk_bf16_f32 v212, 0, v212
    v_cvt_pk_bf16_f32 v213, 0, v213
    v_cvt_pk_bf16_f32 v214, 0, v214
    v_cvt_pk_bf16_f32 v215, 0, v215
    v_cvt_pk_bf16_f32 v216, 0, v216
    v_cvt_pk_bf16_f32 v217, 0, v217
    v_cvt_pk_bf16_f32 v218, 0, v218
    v_cvt_pk_bf16_f32 v219, 0, v219
    v_cvt_pk_bf16_f32 v220, 0, v220
    v_cvt_pk_bf16_f32 v221, 0, v221
    v_cvt_pk_bf16_f32 v222, 0, v222
    v_cvt_pk_bf16_f32 v223, 0, v223
    v_pk_mul_f32 v[208:209], v[208:209], v[168:169]
    v_pk_mul_f32 v[210:211], v[210:211], v[170:171]
    v_pk_mul_f32 v[212:213], v[212:213], v[172:173]
    v_pk_mul_f32 v[214:215], v[214:215], v[174:175]
    v_pk_mul_f32 v[216:217], v[216:217], v[176:177]
    v_pk_mul_f32 v[218:219], v[218:219], v[178:179]
    v_pk_mul_f32 v[220:221], v[220:221], v[180:181]
    v_pk_mul_f32 v[222:223], v[222:223], v[182:183]
    v_cvt_pk_bf16_f32 v208, 0, v208
    v_cvt_pk_bf16_f32 v209, 0, v209
    v_cvt_pk_bf16_f32 v210, 0, v210
    v_cvt_pk_bf16_f32 v211, 0, v211
    v_cvt_pk_bf16_f32 v212, 0, v212
    v_cvt_pk_bf16_f32 v213, 0, v213
    v_cvt_pk_bf16_f32 v214, 0, v214
    v_cvt_pk_bf16_f32 v215, 0, v215
    v_cvt_pk_bf16_f32 v216, 0, v216
    v_cvt_pk_bf16_f32 v217, 0, v217
    v_cvt_pk_bf16_f32 v218, 0, v218
    v_cvt_pk_bf16_f32 v219, 0, v219
    v_cvt_pk_bf16_f32 v220, 0, v220
    v_cvt_pk_bf16_f32 v221, 0, v221
    v_cvt_pk_bf16_f32 v222, 0, v222
    v_cvt_pk_bf16_f32 v223, 0, v223
    v_pk_add_f32 v[208:209], v[208:209], v[88:89]
    v_pk_add_f32 v[210:211], v[210:211], v[90:91]
    v_pk_add_f32 v[212:213], v[212:213], v[92:93]
    v_pk_add_f32 v[214:215], v[214:215], v[94:95]
    v_pk_add_f32 v[216:217], v[216:217], v[96:97]
    v_pk_add_f32 v[218:219], v[218:219], v[98:99]
    v_pk_add_f32 v[220:221], v[220:221], v[100:101]
    v_pk_add_f32 v[222:223], v[222:223], v[102:103]
    v_cvt_pk_bf16_f32 v224, v208, v209
    v_cvt_pk_bf16_f32 v225, v210, v211
    v_cvt_pk_bf16_f32 v226, v212, v213
    v_cvt_pk_bf16_f32 v227, v214, v215
    v_cvt_pk_bf16_f32 v228, v216, v217
    v_cvt_pk_bf16_f32 v229, v218, v219
    v_cvt_pk_bf16_f32 v230, v220, v221
    v_cvt_pk_bf16_f32 v231, v222, v223
    s_cmp_eq_u64 s[84:85], 0
    s_cbranch_scc1 L_NOCAND
    v_mfma_f32_16x16x32_bf16 v[240:243], v[184:187], v[224:227], 0
    v_mfma_f32_16x16x32_bf16 v[240:243], v[188:191], v[228:231], v[240:243]
    v_mov_b32 v232, v224
    v_mov_b32 v233, v225
    v_mov_b32 v234, v226
    v_mov_b32 v235, v227
    v_mov_b32 v236, v228
    v_mov_b32 v237, v229
    v_mov_b32 v238, v230
    v_mov_b32 v239, v231
    s_lshl_b32 s96, s21, 14
    s_lshl_b32 s97, s12, 9
    s_add_u32 s98, s96, s97
    s_add_u32 s15, s98, 13631488
    v_lshrrev_b32 v7, 4, v1
    v_lshlrev_b32 v7, 4, v7
    v_add_u32 v8, 8192, v7
    v_permlane32_swap_b32 v232, v234
    v_permlane32_swap_b32 v233, v235
    v_permlane32_swap_b32 v236, v238
    v_permlane32_swap_b32 v237, v239
    v_permlane32_swap_b32 v12, v14
    v_permlane32_swap_b32 v13, v15
    v_permlane32_swap_b32 v16, v18
    v_permlane32_swap_b32 v17, v19
    v_cndmask_b32 v7, v7, v8, s[88:89]
    s_mov_b64 exec, s[84:85]
    buffer_store_dwordx4 v[232:235], v7, s[32:35], s15 offen sc1
    buffer_store_dwordx4 v[236:239], v7, s[32:35], s15 offen offset:64 sc1
    s_mov_b32 exec_lo, 0
    s_and_b32 exec_hi, s85, 0xffff0000
    buffer_store_dword v240, v7, s[32:35], s15 offen offset:208 sc1
    s_mov_b64 exec, s[84:85]
    buffer_store_dwordx4 v[12:15], v7, s[32:35], s15 offen offset:128 sc1
    buffer_store_dwordx4 v[16:19], v7, s[32:35], s15 offen offset:192 sc1
    s_mov_b64 exec, -1
L_NOCAND:
    v_lshlrev_b32 v208, 16, v224
    v_and_b32 v209, s6, v224
    v_lshlrev_b32 v210, 16, v225
    v_and_b32 v211, s6, v225
    v_lshlrev_b32 v212, 16, v226
    v_and_b32 v213, s6, v226
    v_lshlrev_b32 v214, 16, v227
    v_and_b32 v215, s6, v227
    v_lshlrev_b32 v216, 16, v228
    v_and_b32 v217, s6, v228
    v_lshlrev_b32 v218, 16, v229
    v_and_b32 v219, s6, v229
    v_lshlrev_b32 v220, 16, v230
    v_and_b32 v221, s6, v230
    v_lshlrev_b32 v222, 16, v231
    v_and_b32 v223, s6, v231
    v_pk_mul_f32 v[208:209], v[208:209], v[104:105]
    v_pk_mul_f32 v[210:211], v[210:211], v[106:107]
    v_pk_mul_f32 v[212:213], v[212:213], v[108:109]
    v_pk_mul_f32 v[214:215], v[214:215], v[110:111]
    v_pk_mul_f32 v[216:217], v[216:217], v[112:113]
    v_pk_mul_f32 v[218:219], v[218:219], v[114:115]
    v_pk_mul_f32 v[220:221], v[220:221], v[116:117]
    v_pk_mul_f32 v[222:223], v[222:223], v[118:119]
    v_cvt_pk_bf16_f32 v208, 0, v208
    v_cvt_pk_bf16_f32 v209, 0, v209
    v_cvt_pk_bf16_f32 v210, 0, v210
    v_cvt_pk_bf16_f32 v211, 0, v211
    v_cvt_pk_bf16_f32 v212, 0, v212
    v_cvt_pk_bf16_f32 v213, 0, v213
    v_cvt_pk_bf16_f32 v214, 0, v214
    v_cvt_pk_bf16_f32 v215, 0, v215
    v_cvt_pk_bf16_f32 v216, 0, v216
    v_cvt_pk_bf16_f32 v217, 0, v217
    v_cvt_pk_bf16_f32 v218, 0, v218
    v_cvt_pk_bf16_f32 v219, 0, v219
    v_cvt_pk_bf16_f32 v220, 0, v220
    v_cvt_pk_bf16_f32 v221, 0, v221
    v_cvt_pk_bf16_f32 v222, 0, v222
    v_cvt_pk_bf16_f32 v223, 0, v223
    s_lshl_b32 s96, s3, 11
    s_add_u32 s13, s96, 98304
    v_lshrrev_b32 v202, 4, v1
    v_lshlrev_b32 v202, 4, v202
    v_and_b32 v203, 7, v1
    v_lshlrev_b32 v203, 4, v203
    v_xor_b32 v202, v202, v203
    v_and_b32 v204, 15, v1
    v_lshl_add_u32 v204, v204, 7, s13
    v_add_u32 v202, v202, v204
    v_xor_b32 v204, 64, v202
    v_lshrrev_b32 v205, 3, v1
    v_lshlrev_b32 v205, 4, v205
    v_xor_b32 v203, v205, v203
    v_lshrrev_b32 v205, 3, v1
    v_lshl_add_u32 v205, v205, 7, s13
    v_add_u32 v203, v203, v205
    s_lshl_b32 s96, s21, 7
    s_sub_u32 s97, 2047, s96
    s_lshl_b32 s98, s3, 4
    s_sub_u32 s13, s97, s98
    v_lshrrev_b32 v43, 3, v1
    v_sub_u32 v42, s13, v43
    v_subrev_u32 v43, 8, v42
    v_lshrrev_b32 v33, 3, v1
    v_lshlrev_b32 v33, 11, v33
    v_and_b32 v9, 7, v1
    v_lshl_add_u32 v33, v9, 4, v33
    s_lshl3_add_u32 s96, s21, s3
    s_lshl_b32 s97, s96, 15
    s_lshl_b32 s98, s12, 7
    s_add_u32 s16, s97, s98
    s_add_u32 s15, s16, 16384
    s_branch SCHK_40
SPOLL_39:
    s_load_dwordx8 s[24:31], s[32:33], s92 offset:2560 glc
SCHK_40:
    s_add_u32 s5, s5, 1
    s_cmp_ge_u32 s5, 200000
    s_waitcnt lgkmcnt(0)
    s_cbranch_scc1 SDONE_41
    s_cmp_lg_u32 s25, s4
    s_cbranch_scc1 SPOLL_39
    s_cmp_lg_u32 s27, s4
    s_cbranch_scc1 SPOLL_39
    s_cmp_lg_u32 s29, s4
    s_cbranch_scc1 SPOLL_39
    s_cmp_lg_u32 s31, s4
    s_cbranch_scc1 SPOLL_39
SDONE_41:
    s_min_u32 s25, s24, s28
    s_min_u32 s27, s26, s28
    s_min_u32 s29, s24, s30
    s_max_u32 s24, s24, s28
    s_max_u32 s26, s26, s30
    s_max_u32 s27, s27, s29
    s_max_u32 s25, s25, s26
    v_mov_b32 v244, s24
    v_mov_b32 v246, s27
    v_mov_b32 v245, s25
    ds_write_b128 v4, v[244:247]
    s_lshr_b32 s96, s3, 2
    s_lshl_b32 s97, s96, 15
    s_and_b32 s98, s3, 3
    s_lshl_b32 s99, s98, 5
    s_add_u32 s13, s97, s99
    v_lshrrev_b32 v34, 4, v1
    v_lshlrev_b32 v34, 13, v34
    v_bfe_u32 v9, v1, 2, 2
    v_lshl_add_u32 v34, v9, 7, v34
    v_bfe_u32 v9, v1, 3, 2
    v_lshl_add_u32 v34, v9, 5, v34
    v_and_b32 v9, 3, v1
    v_lshl_add_u32 v34, v9, 3, v34
    v_xor_b32 v34, s13, v34
    s_lshl_b32 s96, s75, 11
    s_add_u32 s13, s96, 13631488
    v_and_b32 v36, 7, v1
    v_lshl_add_u32 v36, v36, 4, s13
    v_lshrrev_b32 v9, 4, v1
    v_lshl_add_u32 v36, v9, 9, v36
    v_and_b32 v10, 15, v1
    v_lshlrev_b32 v10, 9, v10
    v_add_u32 v10, 13631744, v10
    s_waitcnt vmcnt(0)
    s_waitcnt lgkmcnt(0)
    s_barrier
    ds_read_b128 v[244:247], v5
    v_and_b32 v8, 8, v1
    v_cmp_eq_u32 s[22:23], 0, v8
    v_cmp_gt_u32 s[24:25], 16, v1
    v_cmp_gt_u32 s[26:27], 32, v1
    s_waitcnt lgkmcnt(0)
    v_min_u32_dpp v192, v244, v244 quad_perm:[1,0,3,2] row_mask:0xf bank_mask:0xf
    v_min_u32_dpp v193, v245, v244 quad_perm:[1,0,3,2] row_mask:0xf bank_mask:0xf
    v_min_u32_dpp v194, v244, v245 quad_perm:[1,0,3,2] row_mask:0xf bank_mask:0xf
    v_max_u32_dpp v246, v246, v246 quad_perm:[1,0,3,2] row_mask:0xf bank_mask:0xf
    v_max_u32_dpp v245, v245, v245 quad_perm:[1,0,3,2] row_mask:0xf bank_mask:0xf
    v_max_u32_dpp v244, v244, v244 quad_perm:[1,0,3,2] row_mask:0xf bank_mask:0xf
    v_max3_u32 v246, v246, v193, v194
    v_max_u32 v245, v245, v192
    v_min_u32_dpp v192, v244, v244 quad_perm:[2,3,0,1] row_mask:0xf bank_mask:0xf
    s_nop 0
    v_min_u32_dpp v193, v245, v244 quad_perm:[2,3,0,1] row_mask:0xf bank_mask:0xf
    v_min_u32_dpp v194, v244, v245 quad_perm:[2,3,0,1] row_mask:0xf bank_mask:0xf
    v_max_u32_dpp v246, v246, v246 quad_perm:[2,3,0,1] row_mask:0xf bank_mask:0xf
    v_max_u32_dpp v245, v245, v245 quad_perm:[2,3,0,1] row_mask:0xf bank_mask:0xf
    v_max_u32_dpp v244, v244, v244 quad_perm:[2,3,0,1] row_mask:0xf bank_mask:0xf
    v_max3_u32 v246, v246, v193, v194
    v_max_u32 v245, v245, v192
    v_min_u32_dpp v192, v244, v244 row_half_mirror row_mask:0xf bank_mask:0xf
    s_nop 0
    v_min_u32_dpp v193, v245, v244 row_half_mirror row_mask:0xf bank_mask:0xf
    v_min_u32_dpp v194, v244, v245 row_half_mirror row_mask:0xf bank_mask:0xf
    v_max_u32_dpp v246, v246, v246 row_half_mirror row_mask:0xf bank_mask:0xf
    v_max_u32_dpp v245, v245, v245 row_half_mirror row_mask:0xf bank_mask:0xf
    v_max_u32_dpp v244, v244, v244 row_half_mirror row_mask:0xf bank_mask:0xf
    v_max3_u32 v246, v246, v193, v194
    v_max_u32 v245, v245, v192
    v_cndmask_b32 v192, v245, v244, s[22:23]
    v_cndmask_b32 v201, v246, v245, s[26:27]
    v_and_b32 v193, 31, v246
    v_and_b32 v192, 31, v192
    v_cndmask_b32 v201, v201, v244, s[24:25]
    v_lshl_add_u32 v4, v192, 13, v36
    v_lshl_add_u32 v5, v193, 13, v36
    v_and_b32 v194, 31, v201
    v_lshl_add_u32 v6, v194, 13, v10
    buffer_load_dwordx4 v[192:195], v4, s[32:35], 0 offen sc1
    buffer_load_dwordx4 v[196:199], v5, s[32:35], 0 offen sc1
    buffer_load_dword v200, v6, s[32:35], 0 offen sc1
    s_barrier
    v_readfirstlane_b32 s91, v244
    v_readfirstlane_b32 s94, v245
    v_readfirstlane_b32 s95, v246
    ds_read_b64_tr_b16 v[56:57], v34
    ds_read_b64_tr_b16 v[58:59], v34 offset:512
    ds_read_b64_tr_b16 v[60:61], v34 offset:1024
    ds_read_b64_tr_b16 v[62:63], v34 offset:1536
    ds_read_b64_tr_b16 v[64:65], v34 offset:2048
    ds_read_b64_tr_b16 v[66:67], v34 offset:2560
    ds_read_b64_tr_b16 v[68:69], v34 offset:3072
    ds_read_b64_tr_b16 v[70:71], v34 offset:3584
    ds_read_b64_tr_b16 v[72:73], v34 offset:4096
    ds_read_b64_tr_b16 v[74:75], v34 offset:4608
    ds_read_b64_tr_b16 v[76:77], v34 offset:5120
    ds_read_b64_tr_b16 v[78:79], v34 offset:5632
    ds_read_b64_tr_b16 v[80:81], v34 offset:6144
    ds_read_b64_tr_b16 v[82:83], v34 offset:6656
    ds_read_b64_tr_b16 v[84:85], v34 offset:7168
    ds_read_b64_tr_b16 v[86:87], v34 offset:7680
    s_bfe_u32 s96, s91, 262145
    s_lshl_b32 s97, s96, 7
    s_bfe_u32 s98, s91, 458757
    s_add_u32 s99, s97, s98
    s_xor_b32 s17, s99, 2047
    s_bfe_u32 s96, s94, 262145
    s_lshl_b32 s97, s96, 7
    s_bfe_u32 s98, s94, 458757
    s_add_u32 s99, s97, s98
    s_xor_b32 s18, s99, 2047
    s_bfe_u32 s96, s95, 262145
    s_lshl_b32 s97, s96, 7
    s_bfe_u32 s98, s95, 458757
    s_add_u32 s99, s97, s98
    s_xor_b32 s19, s99, 2047
    s_waitcnt lgkmcnt(0)
    s_lshl_b32 s13, s3, 6
    v_bfe_u32 v35, v1, 2, 1
    v_lshlrev_b32 v35, 9, v35
    v_bfe_u32 v9, v1, 3, 1
    v_lshl_add_u32 v35, v9, 12, v35
    v_lshrrev_b32 v9, 5, v1
    v_lshl_add_u32 v35, v9, 11, v35
    v_bfe_u32 v9, v1, 2, 2
    v_lshl_add_u32 v35, v9, 6, v35
    v_bfe_u32 v9, v1, 4, 1
    v_lshl_add_u32 v35, v9, 5, v35
    v_and_b32 v9, 3, v1
    v_lshl_add_u32 v35, v9, 3, v35
    v_xor_b32 v35, s13, v35
    v_add_u32 v35, 65536, v35
    v_and_b32 v8, 15, v1
    v_lshlrev_b32 v8, 4, v8
    v_lshrrev_b32 v9, 5, v1
    v_lshl_add_u32 v8, v9, 3, v8
    s_lshl_b32 s96, s74, 13
    s_add_u32 s14, s96, 20971520
    s_lshl3_add_u32 s96, s75, s3
    s_lshl_b32 s97, s96, 8
    s_add_u32 s20, s97, s14
    v_bfe_u32 v7, v201, 1, 4
    v_bfe_u32 v201, v201, 5, 7
    v_lshl_or_b32 v201, v7, 7, v201
    v_xor_b32 v201, 0x7ff, v201
    s_waitcnt vmcnt(0)
    v_max3_u32 v7, v192, v196, v200
    v_cmp_eq_u32 vcc, -1, v7
    s_cbranch_vccz POK_43
PRE_44:
    buffer_load_dwordx4 v[192:195], v4, s[32:35], 0 offen sc1
    buffer_load_dwordx4 v[196:199], v5, s[32:35], 0 offen sc1
    buffer_load_dword v200, v6, s[32:35], 0 offen sc1
    s_waitcnt vmcnt(0)
    v_max3_u32 v7, v192, v196, v200
    v_cmp_eq_u32 vcc, -1, v7
    s_cbranch_vccz POK_43
    s_add_u32 s5, s5, 1
    s_cmp_lt_u32 s5, 200000
    s_cbranch_scc1 PRE_44
POK_43:
    v_add_f32_dpp v200, v200, v200 quad_perm:[1,0,3,2] row_mask:0xf bank_mask:0xf
    s_nop 1
    v_add_f32_dpp v200, v200, v200 quad_perm:[2,3,0,1] row_mask:0xf bank_mask:0xf
    s_nop 1
    v_add_f32_dpp v200, v200, v200 row_half_mirror row_mask:0xf bank_mask:0xf
    s_nop 1
    v_add_f32_dpp v200, v200, v200 row_mirror row_mask:0xf bank_mask:0xf
    v_cvt_pk_bf16_f32 v200, 0, v200
    v_ashrrev_i32 v7, 31, v200
    v_or_b32 v7, 0x80000000, v7
    v_xor_b32 v200, v200, v7
    v_lshrrev_b32 v200, 16, v200
    v_lshl_or_b32 v200, v200, 11, v201
    s_nop 0
    v_readlane_b32 s24, v200, 0
    v_readlane_b32 s25, v200, 16
    v_readlane_b32 s26, v200, 32
    s_not_b64 s[28:29], s[22:23]
    s_cmp_lt_u32 s24, s25
    s_cselect_b64 s[28:29], s[22:23], s[28:29]
    s_cselect_b32 s27, s24, s25
    s_cmp_gt_u32 s26, s27
    s_cselect_b64 vcc, s[28:29], 0
    v_cndmask_b32 v192, v192, v196, vcc
    v_cndmask_b32 v193, v193, v197, vcc
    v_cndmask_b32 v194, v194, v198, vcc
    v_cndmask_b32 v195, v195, v199, vcc
    s_bitcmp1_b32 vcc_lo, 0
    s_cselect_b32 s24, s26, s24
    s_cselect_b32 s19, s17, s19
    s_cselect_b32 s17, s95, s91
    s_bitcmp1_b32 vcc_lo, 8
    s_cselect_b32 s25, s26, s25
    s_cselect_b32 s19, s18, s19
    s_cselect_b32 s18, s95, s94
    s_waitcnt lgkmcnt(0)
    v_mfma_f32_16x16x32_bf16 v[136:139], v[192:195], v[56:59], 0
    v_mfma_f32_16x16x32_bf16 v[140:143], v[192:195], v[60:63], 0
    v_mfma_f32_16x16x32_bf16 v[144:147], v[192:195], v[64:67], 0
    v_mfma_f32_16x16x32_bf16 v[148:151], v[192:195], v[68:71], 0
    v_mfma_f32_16x16x32_bf16 v[168:171], v[192:195], v[72:75], 0
    v_mfma_f32_16x16x32_bf16 v[172:175], v[192:195], v[76:79], 0
    v_mfma_f32_16x16x32_bf16 v[176:179], v[192:195], v[80:83], 0
    v_mfma_f32_16x16x32_bf16 v[180:183], v[192:195], v[84:87], 0
    s_nop 1
    v_add_f32 v196, v136, v141
    s_nop 0
    v_add_f32 v197, v146, v151
    s_nop 0
    v_add_f32 v198, v168, v173
    s_nop 0
    v_add_f32 v199, v178, v183
    v_add_f32 v196, v196, v197
    v_add_f32 v198, v198, v199
    v_mov_b32 v197, s4
    s_nop 0
    v_permlane16_swap_b32 v198, v199
    s_cmp_ge_u32 s9, 28
    s_cbranch_scc1 L_NOHP
    v_add_f32 v196, v196, v199
    s_mov_b32 exec_lo, 0xffff
    s_mov_b32 exec_hi, 0xffff
    buffer_store_dwordx2 v[196:197], v8, s[32:35], s20 offen sc1
    s_mov_b64 exec, -1
L_NOHP:
    ds_read_b64_tr_b16 v[120:121], v35
    ds_read_b64_tr_b16 v[122:123], v35 offset:1024
    ds_read_b64_tr_b16 v[124:125], v35 offset:8192
    ds_read_b64_tr_b16 v[126:127], v35 offset:9216
    ds_read_b64_tr_b16 v[128:129], v35 offset:16384
    ds_read_b64_tr_b16 v[130:131], v35 offset:17408
    ds_read_b64_tr_b16 v[132:133], v35 offset:24576
    ds_read_b64_tr_b16 v[134:135], v35 offset:25600
    s_and_b32 s68, s24, 2047
    s_and_b32 s69, s25, 2047
    s_mov_b32 s70, s16
    s_mov_b32 s71, s15
    v_pk_add_f32 v[208:209], v[208:209], v[152:153]
    v_pk_add_f32 v[210:211], v[210:211], v[154:155]
    v_pk_add_f32 v[212:213], v[212:213], v[156:157]
    v_pk_add_f32 v[214:215], v[214:215], v[158:159]
    v_pk_add_f32 v[216:217], v[216:217], v[160:161]
    v_pk_add_f32 v[218:219], v[218:219], v[162:163]
    v_pk_add_f32 v[220:221], v[220:221], v[164:165]
    v_pk_add_f32 v[222:223], v[222:223], v[166:167]
    v_cvt_pk_bf16_f32 v232, v208, v209
    v_cvt_pk_bf16_f32 v233, v210, v211
    v_cvt_pk_bf16_f32 v234, v212, v213
    v_cvt_pk_bf16_f32 v235, v214, v215
    v_cvt_pk_bf16_f32 v236, v216, v217
    v_cvt_pk_bf16_f32 v237, v218, v219
    v_cvt_pk_bf16_f32 v238, v220, v221
    v_cvt_pk_bf16_f32 v239, v222, v223
    v_permlane32_swap_b32 v232, v234
    v_permlane32_swap_b32 v233, v235
    v_permlane32_swap_b32 v236, v238
    v_permlane32_swap_b32 v237, v239
    ds_write_b128 v202, v[232:235]
    ds_write_b128 v204, v[236:239]
    ds_read_b128 v[232:235], v203
    ds_read_b128 v[236:239], v203 offset:1024
    s_waitcnt lgkmcnt(0)
    s_cmp_lg_u32 s93, 7
    s_cbranch_scc1 L_NONON
    v_mov_b32 v6, s4
    v_mov_b32 v7, 0
    s_mov_b64 exec, 1
    buffer_store_dword v6, v7, s[32:35], 0 offen sc1
    s_mov_b64 exec, -1
L_NONON:
    s_cmp_ge_u32 s9, 28
    s_cbranch_scc1 L_FIN2
    s_cmp_lg_u32 s3, 7
    s_cbranch_scc1 L_NOFZ
    s_bitcmp1_b32 s9, 3
    s_cselect_b32 s15, s25, s24
    s_cselect_b32 s17, s18, s17
    s_andn2_b32 s18, 2047, s15
    s_lshr_b32 s96, s8, 1
    s_lshl2_add_u32 s19, s12, s96
    s_lshr_b32 s96, s19, 1
    s_lshr_b32 s97, s9, 3
    s_lshl_b32 s98, s97, 1
    s_lshl2_add_u32 s99, s96, s98
    s_and_b32 s97, s19, 1
    s_add_u32 s96, s99, s97
    s_mul_i32 s98, s96, 7168
    s_add_u32 s20, s98, 22020096
    s_lshl_b32 s96, s18, 11
    s_lshl_b32 s97, s19, 5
    s_add_u32 s82, s96, s97
    v_and_b32 v10, 7, v1
    v_lshlrev_b32 v10, 2, v10
    s_lshr_b32 s96, s8, 1
    s_lshl_b32 s97, s96, 6
    s_add_u32 s13, s97, 157184
    v_and_b32 v5, 7, v1
    v_lshl_add_u32 v5, v5, 3, s13
    ds_read_b64 v[206:207], v5
    s_and_b32 s96, s17, 31
    s_lshl_b32 s97, s96, 13
    s_lshl_b32 s98, s12, 9
    s_add_u32 s99, s97, s98
    s_lshr_b32 s96, s8, 1
    s_lshl_b32 s97, s96, 5
    s_add_u32 s98, s99, s97
    s_add_u32 s91, s98, 13631488
    s_lshr_b32 s13, s15, 11
    s_lshl_b32 s13, s13, 16
L_PAD10:
    s_cbranch_execz L_RET10
    s_ashr_i32 s15, s13, 31
    s_andn2_b32 s15, 0x7fff0000, s15
    s_or_b32 s15, s15, 0x80000000
    s_xor_b32 s13, s13, s15
    v_mov_b32 v204, s13
    v_mul_f32 v204, s7, v204
    v_exp_f32 v204, -v204
    s_nop 0
    v_add_f32 v204, 1.0, v204
    v_rcp_f32 v204, v204
    s_nop 0
    v_cvt_pk_bf16_f32 v204, 0, v204
L_NOFZ:
    s_cmp_ge_u32 s3, 4
    s_cbranch_scc1 L_NOH
    s_lshl_b32 s96, s3, 8
    s_add_u32 s13, s96, s14
    v_lshrrev_b32 v4, 4, v1
    v_lshlrev_b32 v4, 11, v4
    v_and_b32 v9, 15, v1
    v_lshl_add_u32 v4, v9, 4, v4
    s_lshl_b32 s96, s3, 5
    s_add_u32 s15, s96, 156672
    v_lshrrev_b32 v5, 5, v1
    v_lshl_add_u32 v5, v5, 7, s15
    v_bfe_u32 v9, v1, 2, 1
    v_lshl_add_u32 v5, v9, 4, v5
    v_bfe_u32 v9, v1, 1, 1
    v_lshl_add_u32 v5, v9, 3, v5
    v_bfe_u32 v9, v1, 3, 1
    v_lshl_add_u32 v5, v9, 2, v5
    v_and_b32 v9, 1, v1
    v_lshl_add_u32 v5, v9, 1, v5
SPOLL_45:
    s_load_dword s24, s[32:33], s13 offset:1276 glc
    s_load_dword s25, s[32:33], s13 offset:3324 glc
    s_load_dword s26, s[32:33], s13 offset:5372 glc
    s_load_dword s27, s[32:33], s13 offset:7420 glc
SCHK_46:
    s_add_u32 s5, s5, 1
    s_cmp_ge_u32 s5, 200000
    s_waitcnt lgkmcnt(0)
    s_cbranch_scc1 SDONE_47
    s_cmp_lg_u32 s24, s4
    s_cbranch_scc1 SPOLL_45
    s_cmp_lg_u32 s25, s4
    s_cbranch_scc1 SPOLL_45
    s_cmp_lg_u32 s26, s4
    s_cbranch_scc1 SPOLL_45
    s_cmp_lg_u32 s27, s4
    s_cbranch_scc1 SPOLL_45
SDONE_47:
POLL_48:
    buffer_load_dwordx4 v[88:91], v4, s[32:35], s13 offen sc1
    buffer_load_dwordx4 v[92:95], v4, s[32:35], s13 offen offset:1024 sc1
    s_waitcnt vmcnt(0)
    v_bitop3_b32 v6, v89, v91, s4 bitop3:0x7e
    v_bitop3_b32 v6, v6, v93, s4 bitop3:0xf6
    v_bitop3_b32 v6, v6, v95, s4 bitop3:0xf6
    v_cmp_ne_u32 vcc, 0, v6
    s_cbranch_vccz PDONE_49
    s_add_u32 s5, s5, 1
    s_cmp_lt_u32 s5, 200000
    s_cbranch_scc1 POLL_48
PDONE_49:
    v_permlane32_swap_b32 v88, v90
    v_permlane32_swap_b32 v92, v94
    v_add_f32 v88, v88, v90
    v_add_f32 v92, v92, v94
    v_mov_b32 v90, v88
    v_mov_b32 v94, v92
    s_nop 0
    v_permlane16_swap_b32 v88, v90
    v_permlane16_swap_b32 v92, v94
    v_add_f32 v88, v88, v90
    v_add_f32 v92, v92, v94
    v_cvt_pk_bf16_f32 v88, 0, v88
    v_cvt_pk_bf16_f32 v92, 0, v92
    v_mul_f32 v6, s7, v88
    v_exp_f32 v6, -v6
    s_nop 0
    v_add_f32 v6, 1.0, v6
    v_rcp_f32 v6, v6
    s_nop 0
    v_mul_f32 v88, v88, v6
    v_cvt_pk_bf16_f32 v88, 0, v88
    v_mul_f32 v88, v88, v92
    v_cvt_pk_bf16_f32 v88, v88, v88
    ds_write_b16 v5, v88
L_NOH:
    v_bfe_u32 v4, v1, 2, 1
    v_lshlrev_b32 v4, 7, v4
    v_lshrrev_b32 v9, 5, v1
    v_lshl_add_u32 v4, v9, 4, v4
    v_add_u32 v4, 156672, v4
    v_lshrrev_b32 v5, 4, v1
    v_mul_u32_u24 v5, 7168, v5
    v_and_b32 v9, 15, v1
    v_lshl_add_u32 v5, v9, 3, v5
    s_lshl3_add_u32 s96, s75, s3
    s_mul_i32 s97, s96, 28672
    s_lshl_b32 s98, s74, 7
    s_add_u32 s99, s97, s98
    s_add_u32 s13, s99, 22020096
    v_and_b32 v6, 1, v1
    v_lshlrev_b32 v6, 13, v6
    v_bfe_u32 v9, v1, 1, 1
    v_lshl_add_u32 v6, v9, 18, v6
    s_lshr_b32 s96, s9, 2
    s_and_b32 s97, s75, 1
    s_lshr_b32 s98, s3, 1
    s_lshl2_add_u32 s99, s97, s98
    s_and_b32 s97, s3, 1
    s_lshr_b32 s98, s75, 1
    s_lshl2_add_u32 s97, s97, s98
    s_lshl3_add_u32 s98, s99, s97
    s_lshl_b32 s99, s98, 12
    s_lshl_b32 s97, s8, 6
    s_add_u32 s98, s99, s97
    s_lshl2_add_u32 s99, s96, s98
    s_add_u32 s97, s99, 1048576
    s_add_u32 s14, s97, 3072
    s_waitcnt lgkmcnt(0)
    s_barrier
    ds_read_b128 v[88:91], v4
    ds_read_b128 v[92:95], v4 offset:32
    ds_read_b128 v[96:99], v4 offset:64
    ds_read_b128 v[100:103], v4 offset:96
    s_waitcnt lgkmcnt(3)
    v_mfma_f32_32x32x16_bf16 v[208:223], v[88:91], v[120:123], 0
    s_waitcnt lgkmcnt(2)
    v_mfma_f32_32x32x16_bf16 v[208:223], v[92:95], v[124:127], v[208:223]
    s_waitcnt lgkmcnt(1)
    v_mfma_f32_32x32x16_bf16 v[208:223], v[96:99], v[128:131], v[208:223]
    s_waitcnt lgkmcnt(0)
    v_mfma_f32_32x32x16_bf16 v[208:223], v[100:103], v[132:135], v[208:223]
    s_nop 11
    v_mov_b32 v209, s4
    buffer_store_dwordx2 v[208:209], v5, s[32:35], s13 offen sc1
    s_mov_b64 exec, 15
    buffer_store_dword v209, v6, s[32:35], s14 offen sc1
    s_mov_b64 exec, -1
    s_barrier
L_FIN2:
    v_cmp_ne_u32 vcc, s68, v42
    v_cmp_ne_u32 s[22:23], s69, v42
    s_nop 0
    s_and_b64 exec, vcc, s[22:23]
    buffer_store_dwordx4 v[232:235], v33, s[64:67], s70 offen sc1
    s_mov_b64 exec, -1
    v_cmp_ne_u32 vcc, s68, v43
    v_cmp_ne_u32 s[22:23], s69, v43
    s_nop 0
    s_and_b64 exec, vcc, s[22:23]
    buffer_store_dwordx4 v[236:239], v33, s[64:67], s71 offen sc1
    s_mov_b64 exec, -1
    s_cmp_ge_u32 s9, 16
    s_cbranch_scc1 L_FIN
SPOLL_50:
    s_load_dwordx8 s[24:31], s[32:33], s92 offset:3072 glc
SCHK_51:
    s_add_u32 s5, s5, 1
    s_cmp_ge_u32 s5, 200000
    s_waitcnt lgkmcnt(0)
    s_cbranch_scc1 SDONE_52
    s_cmp_lg_u32 s24, s4
    s_cbranch_scc1 SPOLL_50
    s_cmp_lg_u32 s25, s4
    s_cbranch_scc1 SPOLL_50
    s_cmp_lg_u32 s26, s4
    s_cbranch_scc1 SPOLL_50
    s_cmp_lg_u32 s27, s4
    s_cbranch_scc1 SPOLL_50
    s_cmp_lg_u32 s28, s4
    s_cbranch_scc1 SPOLL_50
    s_cmp_lg_u32 s29, s4
    s_cbranch_scc1 SPOLL_50
    s_cmp_lg_u32 s30, s4
    s_cbranch_scc1 SPOLL_50
SDONE_52:
    s_barrier
    s_cmp_lg_u32 s3, 7
    s_cbranch_scc1 L_FIN
    s_add_u32 s13, s20, 4096
    v_mov_b32 v5, s4
    v_not_b32 v6, v5
POLL_53:
    buffer_load_dwordx4 v[88:91], v2, s[32:35], s20 offen sc1
    buffer_load_dwordx4 v[92:95], v2, s[32:35], s20 offen offset:1024 sc1
    buffer_load_dwordx4 v[96:99], v2, s[32:35], s20 offen offset:2048 sc1
    buffer_load_dwordx4 v[100:103], v2, s[32:35], s20 offen offset:3072 sc1
    buffer_load_dwordx4 v[104:107], v2, s[32:35], s13 offen sc1
    buffer_load_dwordx4 v[108:111], v2, s[32:35], s13 offen offset:1024 sc1
    buffer_load_dwordx4 v[112:115], v2, s[32:35], s13 offen offset:2048 sc1
    buffer_load_dword v244, v10, s[32:35], s91 offen sc1
    buffer_load_dword v245, v10, s[32:35], s91 offen offset:128 sc1
    s_waitcnt vmcnt(0)
    v_max_u32 v246, v244, v245
    v_cmp_ne_u32 vcc, -1, v246
    s_nop 1
    v_cndmask_b32 v246, v6, v5, vcc
    v_bitop3_b32 v4, v89, v91, s4 bitop3:0x7e
    v_bitop3_b32 v4, v4, v93, s4 bitop3:0xf6
    v_bitop3_b32 v4, v4, v95, s4 bitop3:0xf6
    v_bitop3_b32 v4, v4, v97, s4 bitop3:0xf6
    v_bitop3_b32 v4, v4, v99, s4 bitop3:0xf6
    v_bitop3_b32 v4, v4, v101, s4 bitop3:0xf6
    v_bitop3_b32 v4, v4, v103, s4 bitop3:0xf6
    v_bitop3_b32 v4, v4, v105, s4 bitop3:0xf6
    v_bitop3_b32 v4, v4, v107, s4 bitop3:0xf6
    v_bitop3_b32 v4, v4, v109, s4 bitop3:0xf6
    v_bitop3_b32 v4, v4, v111, s4 bitop3:0xf6
    v_bitop3_b32 v4, v4, v113, s4 bitop3:0xf6
    v_bitop3_b32 v4, v4, v115, s4 bitop3:0xf6
    v_bitop3_b32 v4, v4, v246, s4 bitop3:0xf6
    v_cmp_ne_u32 vcc, 0, v4
    s_cbranch_vccz PDONE_54
    s_add_u32 s5, s5, 1
    s_cmp_lt_u32 s5, 200000
    s_cbranch_scc1 POLL_53
PDONE_54:
    v_add_f32 v88, v88, v92
    v_add_f32 v90, v90, v94
    v_add_f32 v88, v88, v96
    v_add_f32 v90, v90, v98
    v_add_f32 v88, v88, v100
    v_add_f32 v90, v90, v102
    v_add_f32 v88, v88, v104
    v_add_f32 v90, v90, v106
    v_add_f32 v88, v88, v108
    v_add_f32 v90, v90, v110
    v_add_f32 v88, v88, v112
    v_add_f32 v90, v90, v114
    v_mov_b32 v89, v90
    v_add_f32_dpp v88, v88, v88 row_ror:8 row_mask:0xf bank_mask:0xf
    s_nop 0
    v_add_f32_dpp v89, v89, v89 row_ror:8 row_mask:0xf bank_mask:0xf
    v_mov_b32 v90, v88
    v_mov_b32 v91, v89
    s_nop 0
    v_permlane16_swap_b32 v88, v90
    v_permlane16_swap_b32 v89, v91
    v_pk_add_f32 v[88:89], v[88:89], v[90:91]
    v_mov_b32 v90, v88
    v_mov_b32 v91, v89
    s_nop 0
    v_permlane32_swap_b32 v88, v90
    v_permlane32_swap_b32 v89, v91
    v_pk_add_f32 v[88:89], v[88:89], v[90:91]
    v_cvt_pk_bf16_f32 v88, 0, v88
    v_cvt_pk_bf16_f32 v89, 0, v89
    v_pk_mul_f32 v[88:89], v[88:89], v[204:205] op_sel_hi:[1,0]
    v_lshlrev_b32 v4, 16, v244
    v_and_b32 v5, s6, v244
    v_cvt_pk_bf16_f32 v88, 0, v88
    v_cvt_pk_bf16_f32 v89, 0, v89
    v_pk_add_f32 v[88:89], v[88:89], v[4:5]
    v_cvt_pk_bf16_f32 v88, 0, v88
    v_cvt_pk_bf16_f32 v89, 0, v89
    v_pk_mul_f32 v[88:89], v[88:89], v[206:207]
    v_lshlrev_b32 v4, 16, v245
    v_and_b32 v5, s6, v245
    v_cvt_pk_bf16_f32 v88, 0, v88
    v_cvt_pk_bf16_f32 v89, 0, v89
    v_pk_add_f32 v[88:89], v[88:89], v[4:5]
    v_cvt_pk_bf16_f32 v88, v88, v89
    s_mov_b64 exec, 0xff
    buffer_store_dword v88, v10, s[64:67], s82 offen
    s_mov_b64 exec, -1
L_FIN:
L_END:
    s_endpgm
.p2align 10
.fill 768, 4, 0xbf800000
.section .rodata,"a"
.p2align 6
.amdhsa_kernel adaLN_cond__linear_kernel_hedgehog__moe_arch_mod__prompt_kernel
  .amdhsa_next_free_vgpr 256
  .amdhsa_next_free_sgpr 102
  .amdhsa_accum_offset 256
  .amdhsa_group_segment_fixed_size 0
  .amdhsa_kernarg_size 112
  .amdhsa_user_sgpr_count 2
  .amdhsa_user_sgpr_kernarg_segment_ptr 1
  .amdhsa_system_sgpr_workgroup_id_x 1
  .amdhsa_float_denorm_mode_32 3
  .amdhsa_float_denorm_mode_16_64 3
.end_amdhsa_kernel
```

```asm
; @launch grid=(256,1,1) block=(512,1,1) lds=163840
.amdgcn_target "amdgcn-amd-amdhsa--gfx950"
.text
.globl adaLN_cond__linear_kernel_hedgehog__moe_arch_mod__prompt_kernel
.p2align 12
.type adaLN_cond__linear_kernel_hedgehog__moe_arch_mod__prompt_kernel,@function
adaLN_cond__linear_kernel_hedgehog__moe_arch_mod__prompt_kernel:
    s_load_dwordx16 s[68:83], s[0:1], 0
    s_load_dwordx8 s[84:91], s[0:1], 64
    s_load_dwordx2 s[32:33], s[0:1], 104
    s_cmp_ge_u32 s2, 256
    s_cbranch_scc1 L_END
    v_lshrrev_b32 v4, 6, v0
    v_and_b32 v1, 63, v0
    s_nop 0
    v_readfirstlane_b32 s3, v4
    v_lshlrev_b32 v2, 4, v1
    s_mov_b32 s38, 4194304
    s_mov_b32 s39, 0x20000
    s_mov_b32 s50, 12582912
    s_mov_b32 s51, 0x20000
    s_mov_b32 s34, 268435456
    s_mov_b32 s35, 0x20000
    s_mov_b32 s42, 6291456
    s_mov_b32 s43, 0x20000
    s_mov_b32 s46, 2097152
    s_mov_b32 s47, 0x20000
    s_mov_b32 s54, 7340032
    s_mov_b32 s55, 0x20000
    s_mov_b32 s58, 7340032
    s_mov_b32 s59, 0x20000
    s_mov_b32 s62, 7340032
    s_mov_b32 s63, 0x20000
    s_mov_b32 s66, 4194304
    s_mov_b32 s67, 0x20000
    s_mov_b32 s5, 0
    s_mov_b32 s6, 0xffff0000
    s_mov_b32 s7, 0x3fb8aa3b
    s_and_b32 s8, s2, 7
    s_lshr_b32 s9, s2, 3
    s_lshl_b32 s96, s8, 5
    s_add_u32 s97, s96, s9
    s_lshl3_add_u32 s93, s97, s3
    s_and_b32 s96, s8, 4
    s_lshr_b32 s97, s9, 2
    s_lshl1_add_u32 s10, s96, s97
    s_and_b32 s96, s8, 3
    s_and_b32 s97, s9, 3
    s_xor_b32 s98, s97, 2
    s_lshl2_add_u32 s11, s96, s98
    s_and_b32 s96, s8, 1
    s_and_b32 s97, s9, 7
    s_lshl3_add_u32 s12, s96, s97
    s_lshr_b32 s96, s8, 1
    s_lshr_b32 s97, s9, 3
    s_lshl2_add_u32 s21, s96, s97
    s_lshl_b32 s96, s2, 6
    s_add_u32 s97, s96, s3
    s_lshl_b32 s98, s97, 6
    s_add_u32 s92, s98, 1048576
    s_lshl_b32 s16, s93, 11
    s_lshl3_add_u32 s96, s8, s3
    s_lshl_b32 s15, s96, 5
    s_mul_i32 s96, s15, 6144
    s_xor_b32 s97, s9, 1
    s_lshl_b32 s98, s97, 7
    s_add_u32 s13, s96, s98
    s_add_u32 s14, s13, 98304
    s_lshl3_add_u32 s96, s21, s3
    s_lshl_b32 s97, s96, 15
    s_lshl_b32 s98, s12, 7
    s_add_u32 s18, s97, s98
    s_lshr_b32 s96, s8, 1
    s_lshl4_add_u32 s97, s96, s12
    s_lshl4_add_u32 s98, s97, s3
    s_lshl_b32 s99, s98, 9
    s_add_u32 s17, s99, 524288
    v_lshrrev_b32 v248, 3, v1
    v_mul_u32_u24 v248, 12288, v248
    v_and_b32 v9, 7, v1
    v_lshl_add_u32 v248, v9, 4, v248
    v_lshrrev_b32 v249, 3, v1
    v_lshl_add_u32 v249, v249, 1, s15
    v_and_b32 v10, 15, v1
    v_lshlrev_b32 v10, 11, v10
    v_lshrrev_b32 v9, 4, v1
    v_lshl_add_u32 v10, v9, 4, v10
    s_waitcnt lgkmcnt(0)
    s_mov_b64 s[48:49], s[88:89]
    buffer_load_dwordx4 v[160:163], v248, s[48:51], s13 offen nt
    buffer_load_dwordx4 v[164:167], v248, s[48:51], s14 offen nt
    s_load_dword s4, s[32:33], 0
    global_load_ushort v168, v249, s[86:87]
    global_load_ushort v169, v249, s[86:87] offset:16
    s_mov_b64 s[36:37], s[68:69]
    s_load_dword s24, s[32:33], s92 offset:0 glc
    s_load_dword s25, s[32:33], s17 offset:508 glc
    s_load_dword s26, s[32:33], s17 offset:4604 glc
    s_barrier
    buffer_load_dwordx4 v[152:155], v2, s[36:39], s16 offen
    buffer_load_dwordx4 v[156:159], v2, s[36:39], s16 offen offset:1024
    s_mov_b64 s[40:41], s[70:71]
    s_mov_b64 s[44:45], s[74:75]
    s_mov_b64 s[52:53], s[80:81]
    s_mov_b64 s[56:57], s[82:83]
    s_mov_b64 s[60:61], s[84:85]
    s_mov_b64 s[64:65], s[90:91]
    s_getpc_b64 s[22:23]
    s_and_b32 s22, s22, 0xfffffc00
    s_lshl3_add_u32 s96, s9, s3
    s_lshl_b32 s19, s96, 7
    v_lshrrev_b32 v4, 5, v1
    v_lshl_add_u32 v4, v4, 15, s19
    v_min_u32 v4, 41984, v4
    global_load_dword v11, v4, s[22:23]
    s_lshr_b32 s76, s3, 2
    s_and_b32 s77, s3, 3
    s_lshl_b32 s83, s3, 10
    s_mul_i32 s96, s8, 7
    s_lshr_b32 s97, s9, 2
    s_add_u32 s74, s96, s97
    s_and_b32 s75, s9, 3
    v_bfe_u32 v6, v1, 4, 1
    v_lshlrev_b32 v6, 6, v6
    v_and_b32 v3, 7, v1
    v_lshlrev_b32 v3, 4, v3
    v_xor_b32 v3, v3, v6
    v_lshrrev_b32 v6, 3, v1
    v_mul_u32_u24 v6, 6144, v6
    v_add_u32 v3, v3, v6
    s_and_b32 s84, s9, 12
    s_mul_i32 s96, s3, 49152
    s_lshl_b32 s97, s11, 7
    s_add_u32 s85, s96, s97
    v_lshlrev_b32 v250, 3, v1
    v_lshlrev_b32 v251, 5, v1
    v_add_u32 v251, 147456, v251
    s_lshl2_add_u32 s13, s3, 147456
    v_lshrrev_b32 v252, 4, v1
    v_lshl_add_u32 v252, v252, 6, s13
    v_and_b32 v9, 7, v1
    v_lshl_add_u32 v252, v9, 8, v252
    v_bfe_u32 v9, v1, 3, 1
    v_lshl_add_u32 v252, v9, 5, v252
    buffer_load_dwordx4 v[12:15], v10, s[36:39], s18 offen
    buffer_load_dwordx4 v[16:19], v10, s[36:39], s18 offen offset:64
    s_lshr_b32 s96, s3, 1
    s_xor_b32 s97, s9, 1
    s_and_b32 s98, s97, 15
    s_lshl4_add_u32 s99, s96, s98
    s_lshr_b32 s97, s9, 4
    s_lshl1_add_u32 s96, s99, s97
    s_lshl3_add_u32 s98, s96, s8
    s_lshl_b32 s99, s98, 9
    s_add_u32 s13, s99, 524288
    s_waitcnt vmcnt(5)
    v_lshlrev_b32 v168, 16, v168
    v_mul_f32 v4, s7, v168
    v_exp_f32 v4, -v4
    s_nop 0
    v_add_f32 v4, 1.0, v4
    v_rcp_f32 v4, v4
    s_nop 0
    v_mul_f32 v168, v168, v4
    v_cvt_pk_bf16_f32 v168, 0, v168
    v_lshlrev_b32 v169, 16, v169
    v_mul_f32 v5, s7, v169
    v_exp_f32 v5, -v5
    s_nop 0
    v_add_f32 v5, 1.0, v5
    v_rcp_f32 v5, v5
    s_nop 0
    v_mul_f32 v169, v169, v5
    v_cvt_pk_bf16_f32 v169, 0, v169
    v_lshlrev_b32 v4, 16, v160
    v_and_b32 v5, s6, v160
    v_pk_mul_f32 v[176:177], v[168:169], v[4:5] op_sel:[0,0] op_sel_hi:[0,1]
    v_lshlrev_b32 v6, 16, v161
    v_and_b32 v7, s6, v161
    v_pk_mul_f32 v[178:179], v[168:169], v[6:7] op_sel:[0,0] op_sel_hi:[0,1]
    v_lshlrev_b32 v4, 16, v162
    v_and_b32 v5, s6, v162
    v_pk_mul_f32 v[180:181], v[168:169], v[4:5] op_sel:[0,0] op_sel_hi:[0,1]
    v_lshlrev_b32 v6, 16, v163
    v_and_b32 v7, s6, v163
    v_pk_mul_f32 v[182:183], v[168:169], v[6:7] op_sel:[0,0] op_sel_hi:[0,1]
    v_lshlrev_b32 v4, 16, v164
    v_and_b32 v5, s6, v164
    v_pk_fma_f32 v[176:177], v[168:169], v[4:5], v[176:177] op_sel:[1,0,0] op_sel_hi:[1,1,1]
    v_lshlrev_b32 v6, 16, v165
    v_and_b32 v7, s6, v165
    v_pk_fma_f32 v[178:179], v[168:169], v[6:7], v[178:179] op_sel:[1,0,0] op_sel_hi:[1,1,1]
    v_lshlrev_b32 v4, 16, v166
    v_and_b32 v5, s6, v166
    v_pk_fma_f32 v[180:181], v[168:169], v[4:5], v[180:181] op_sel:[1,0,0] op_sel_hi:[1,1,1]
    v_lshlrev_b32 v6, 16, v167
    v_and_b32 v7, s6, v167
    v_pk_fma_f32 v[182:183], v[168:169], v[6:7], v[182:183] op_sel:[1,0,0] op_sel_hi:[1,1,1]
    v_permlane32_swap_b32 v176, v180
    v_permlane32_swap_b32 v177, v181
    v_permlane32_swap_b32 v178, v182
    v_permlane32_swap_b32 v179, v183
    v_add_f32 v176, v176, v180
    v_add_f32 v177, v177, v181
    v_add_f32 v178, v178, v182
    v_add_f32 v179, v179, v183
    s_nop 0
    v_permlane16_swap_b32 v176, v178
    v_permlane16_swap_b32 v177, v179
    v_add_f32 v176, v176, v178
    v_add_f32 v177, v177, v179
    s_nop 0
    v_add_f32_dpp v176, v176, v176 row_ror:8 row_mask:0xf bank_mask:0xf
    v_add_f32_dpp v177, v177, v177 row_ror:8 row_mask:0xf bank_mask:0xf
    s_nop 1
    v_mov_b32_dpp v176, v177 quad_perm:[0,1,2,3] row_mask:0xf bank_mask:0xc
    s_waitcnt lgkmcnt(0)
    s_mul_i32 s4, s4, 0x9e3779b1
    s_add_u32 s4, s4, 0x7f4a7c15
    ds_write_b32 v252, v176
    s_waitcnt lgkmcnt(0)
    s_barrier
    ds_read_b128 v[176:179], v251
    ds_read_b128 v[180:183], v251 offset:16
    s_waitcnt lgkmcnt(0)
    v_pk_add_f32 v[176:177], v[176:177], v[178:179]
    v_pk_add_f32 v[180:181], v[180:181], v[182:183]
    v_pk_add_f32 v[176:177], v[176:177], v[180:181]
    v_add_f32 v176, v176, v177
    v_mov_b32 v177, s4
    s_bitcmp1_b32 s3, 0
    s_cselect_b32 exec_lo, 0, -1
    s_cselect_b32 exec_hi, -1, 0
    buffer_store_dwordx2 v[176:177], v250, s[32:35], s13 offen sc1
    s_mov_b64 exec, -1
    s_lshr_b32 s96, s9, 4
    s_lshl_b32 s94, s96, -1
    s_add_u32 s96, s94, s84
    s_and_b32 s97, s96, 15
    s_mul_i32 s98, s97, 393216
    s_add_u32 s91, s98, s85
    s_lshl_b32 s96, s94, 13
    s_add_u32 s94, s96, s83
    s_add_u32 s82, s91, 2048
    s_mov_b32 m0, s94
    s_nop 0
    buffer_load_dwordx4 v3, s[40:43], s82 offen lds
    s_add_u32 s82, s91, 4096
    s_add_u32 m0, s94, 49152
    s_nop 0
    buffer_load_dwordx4 v3, s[40:43], s82 offen lds
    s_waitcnt vmcnt(6)
    v_mov_b32 v8, 0x3f803f80
    v_dot2_f32_bf16 v4, v152, v8, 0
    v_dot2_f32_bf16 v5, v152, v152, 0
    v_dot2_f32_bf16 v6, v153, v8, 0
    v_dot2_f32_bf16 v7, v153, v153, 0
    v_dot2_f32_bf16 v4, v154, v8, v4
    v_dot2_f32_bf16 v5, v154, v154, v5
    v_dot2_f32_bf16 v6, v155, v8, v6
    v_dot2_f32_bf16 v7, v155, v155, v7
    v_dot2_f32_bf16 v4, v156, v8, v4
    v_dot2_f32_bf16 v5, v156, v156, v5
    v_dot2_f32_bf16 v6, v157, v8, v6
    v_dot2_f32_bf16 v7, v157, v157, v7
    v_dot2_f32_bf16 v4, v158, v8, v4
    v_dot2_f32_bf16 v5, v158, v158, v5
    v_dot2_f32_bf16 v6, v159, v8, v6
    v_dot2_f32_bf16 v7, v159, v159, v7
    s_nop 2
    v_pk_add_f32 v[4:5], v[4:5], v[6:7]
    s_nop 1
    v_add_f32_dpp v4, v4, v4 quad_perm:[1,0,3,2] row_mask:0xf bank_mask:0xf
    v_add_f32_dpp v5, v5, v5 quad_perm:[1,0,3,2] row_mask:0xf bank_mask:0xf
    s_nop 0
    v_add_f32_dpp v4, v4, v4 quad_perm:[2,3,0,1] row_mask:0xf bank_mask:0xf
    v_add_f32_dpp v5, v5, v5 quad_perm:[2,3,0,1] row_mask:0xf bank_mask:0xf
    s_nop 0
    v_add_f32_dpp v4, v4, v4 row_half_mirror row_mask:0xf bank_mask:0xf
    v_add_f32_dpp v5, v5, v5 row_half_mirror row_mask:0xf bank_mask:0xf
    s_nop 0
    v_add_f32_dpp v4, v4, v4 row_ror:8 row_mask:0xf bank_mask:0xf
    v_add_f32_dpp v5, v5, v5 row_ror:8 row_mask:0xf bank_mask:0xf
    s_nop 1
    v_permlane16_swap_b32 v4, v5
    v_add_f32 v8, v4, v5
    v_add_f32 v4, v4, v5
    s_nop 1
    v_permlane32_swap_b32 v4, v8
    v_add_f32 v4, v4, v8
    v_mul_f32 v8, 0x3a800000, v4
    v_mul_f32 v4, 0x3a800000, v4
    s_nop 1
    v_permlane16_swap_b32 v4, v8
    v_fma_f32 v173, -v4, v4, v8
    v_cvt_pk_bf16_f32 v172, 0, v4
    v_max_f32 v173, 0, v173
    v_cvt_pk_bf16_f32 v173, 0, v173
    v_add_f32 v173, 0x3727c5ac, v173
    v_cvt_pk_bf16_f32 v173, 0, v173
    v_sqrt_f32 v173, v173
    s_nop 0
    v_cvt_pk_bf16_f32 v173, 0, v173
    s_lshl3_add_u32 s13, s3, 153600
    v_lshrrev_b32 v172, 16, v172
    v_or_b32 v172, v172, v173
    v_mov_b32 v173, s4
    v_mov_b32 v4, s13
    ds_write_b64 v4, v[172:173]
    v_and_b32 v5, 3, v1
    v_lshlrev_b32 v5, 4, v5
    v_add_u32 v5, 153600, v5
    v_and_b32 v4, 3, v1
    v_lshlrev_b32 v4, 4, v4
    v_bfe_u32 v9, v1, 2, 1
    v_lshl_add_u32 v4, v9, 10, v4
    s_and_b32 s96, s8, 6
    s_and_b32 s97, s8, 1
    s_lshr_b32 s98, s9, 4
    s_lshl1_add_u32 s99, s97, s98
    s_lshl_b32 s97, s99, 6
    s_add_u32 s98, s96, s97
    s_lshl3_add_u32 s99, s3, s98
    s_lshl_b32 s96, s99, 10
    s_and_b32 s97, s9, 15
    s_lshl_b32 s98, s97, 6
    s_add_u32 s99, s96, s98
    s_add_u32 s13, s99, 262144
    s_waitcnt lgkmcnt(0)
    s_barrier
    ds_read_b128 v[172:175], v5
    s_waitcnt lgkmcnt(0)
    s_mov_b64 exec, 0xff
    buffer_store_dwordx4 v[172:175], v4, s[32:35], s13 offen sc1
    s_mov_b64 exec, -1
    s_mov_b32 s82, s91
    s_add_u32 m0, s94, 98304
    s_nop 0
    buffer_load_dwordx4 v3, s[40:43], s82 offen lds
    s_load_dword s24, s[32:33], s17 offset:508 glc
    s_load_dword s25, s[32:33], s17 offset:4604 glc
    v_and_b32 v4, 31, v1
    v_lshlrev_b32 v4, 4, v4
    v_lshrrev_b32 v9, 5, v1
    v_lshl_add_u32 v4, v9, 12, v4
    s_lshl2_add_u32 s14, s3, 155648
    v_lshl_add_u32 v5, v1, 6, s14
    v_and_b32 v6, 3, v1
    v_lshlrev_b32 v6, 5, v6
    v_lshrrev_b32 v9, 5, v1
    v_lshl_add_u32 v6, v9, 7, v6
    v_bfe_u32 v9, v1, 4, 1
    v_lshl_add_u32 v6, v9, 8, v6
    v_bfe_u32 v9, v1, 2, 2
    v_lshl_add_u32 v6, v9, 9, v6
    v_add_u32 v6, 155648, v6
    s_lshl3_add_u32 s96, s2, s3
    s_lshl_b32 s97, s96, 7
    s_add_u32 s14, s97, 262144
    v_and_b32 v8, 15, v1
    v_lshlrev_b32 v8, 3, v8
    s_branch SCHK_2
SPOLL_1:
    s_load_dword s24, s[32:33], s17 offset:508 glc
    s_load_dword s25, s[32:33], s17 offset:4604 glc
SCHK_2:
    s_add_u32 s5, s5, 1
    s_cmp_ge_u32 s5, 200000
    s_waitcnt lgkmcnt(0)
    s_cbranch_scc1 SDONE_3
    s_cmp_lg_u32 s24, s4
    s_cbranch_scc1 SPOLL_1
    s_cmp_lg_u32 s25, s4
    s_cbranch_scc1 SPOLL_1
SDONE_3:
    buffer_load_dwordx4 v[176:179], v4, s[32:35], s17 offen sc1
    s_load_dword s24, s[32:33], s14 offset:60 glc
    s_load_dword s25, s[32:33], s14 offset:124 glc
    s_waitcnt vmcnt(6)
    v_permlane32_swap_b32 v12, v14
    v_permlane32_swap_b32 v13, v15
    v_permlane32_swap_b32 v16, v18
    v_permlane32_swap_b32 v17, v19
    v_lshlrev_b32 v184, 16, v12
    v_and_b32 v185, s6, v12
    v_lshlrev_b32 v186, 16, v13
    v_and_b32 v187, s6, v13
    v_lshlrev_b32 v188, 16, v14
    v_and_b32 v189, s6, v14
    v_lshlrev_b32 v190, 16, v15
    v_and_b32 v191, s6, v15
    v_lshlrev_b32 v192, 16, v16
    v_and_b32 v193, s6, v16
    v_lshlrev_b32 v194, 16, v17
    v_and_b32 v195, s6, v17
    v_lshlrev_b32 v196, 16, v18
    v_and_b32 v197, s6, v18
    v_lshlrev_b32 v198, 16, v19
    v_and_b32 v199, s6, v19
    s_branch SCHK_6
SPOLL_5:
    s_load_dword s24, s[32:33], s14 offset:60 glc
    s_load_dword s25, s[32:33], s14 offset:124 glc
SCHK_6:
    s_add_u32 s5, s5, 1
    s_cmp_ge_u32 s5, 200000
    s_waitcnt lgkmcnt(0)
    s_cbranch_scc1 SDONE_7
    s_cmp_lg_u32 s24, s4
    s_cbranch_scc1 SPOLL_5
    s_cmp_lg_u32 s25, s4
    s_cbranch_scc1 SPOLL_5
SDONE_7:
    buffer_load_dwordx2 v[172:173], v8, s[32:35], s14 offen sc1
    s_lshr_b32 s96, s9, 4
    s_lshl_b32 s97, s96, -1
    s_xor_b32 s94, s97, 1
    s_add_u32 s96, s94, s84
    s_and_b32 s97, s96, 15
    s_mul_i32 s98, s97, 393216
    s_add_u32 s91, s98, s85
    s_lshl_b32 s96, s94, 13
    s_add_u32 s94, s96, s83
    s_add_u32 s82, s91, 2048
    s_mov_b32 m0, s94
    s_nop 0
    buffer_load_dwordx4 v3, s[40:43], s82 offen lds
    s_add_u32 s82, s91, 4096
    s_add_u32 m0, s94, 49152
    s_nop 0
    buffer_load_dwordx4 v3, s[40:43], s82 offen lds
    s_mov_b32 s82, s91
    s_add_u32 m0, s94, 98304
    s_nop 0
    buffer_load_dwordx4 v3, s[40:43], s82 offen lds
    s_waitcnt vmcnt(4)
    v_bitop3_b32 v7, v177, v179, s4 bitop3:0x7e
    v_cmp_ne_u32 vcc, 0, v7
    s_cbranch_vccz TOK_8
POLL_9:
    buffer_load_dwordx4 v[176:179], v4, s[32:35], s17 offen sc1
    s_waitcnt vmcnt(0)
    v_bitop3_b32 v7, v177, v179, s4 bitop3:0x7e
    v_cmp_ne_u32 vcc, 0, v7
    s_cbranch_vccz PDONE_10
    s_add_u32 s5, s5, 1
    s_cmp_lt_u32 s5, 200000
    s_cbranch_scc1 POLL_9
PDONE_10:
TOK_8:
    ds_write2_b32 v5, v176, v178 offset0:0 offset1:8
    s_waitcnt lgkmcnt(0)
    s_barrier
    ds_read_b128 v[208:211], v6 offset:2048
    ds_read_b128 v[212:215], v6 offset:2064
    ds_read_b128 v[200:203], v6
    ds_read_b128 v[204:207], v6 offset:16
    s_lshl_b32 s96, s11, 12
    s_lshl_b32 s97, s3, 9
    s_add_u32 s13, s96, s97
    v_add_u32 v4, s13, v2
    s_lshl_b32 s96, s3, 9
    s_add_u32 m0, s96, 159744
    s_mov_b32 exec_hi, 0
    global_load_lds_dwordx4 v4, s[72:73]
    s_mov_b32 exec_hi, -1
    s_lshl4_add_u32 s96, s21, s12
    s_lshr_b32 s97, s3, 1
    s_lshl2_add_u32 s98, s96, s97
    s_lshl_b32 s99, s98, 12
    s_and_b32 s96, s3, 1
    s_lshl_b32 s97, s96, 8
    s_add_u32 s98, s99, s97
    s_add_u32 s13, s98, 4194304
    v_and_b32 v4, 15, v1
    v_lshlrev_b32 v4, 4, v4
    v_bfe_u32 v9, v1, 4, 1
    v_lshl_add_u32 v4, v9, 10, v4
    v_lshrrev_b32 v9, 5, v1
    v_lshl_add_u32 v4, v9, 9, v4
    s_waitcnt lgkmcnt(2)
    v_pk_add_f32 v[208:209], v[208:209], v[210:211]
    v_pk_add_f32 v[212:213], v[212:213], v[214:215]
    v_pk_add_f32 v[208:209], v[208:209], v[212:213]
    v_add_f32 v208, v208, v209
    v_cvt_pk_bf16_f32 v208, 0, v208
    s_waitcnt lgkmcnt(0)
    v_pk_add_f32 v[200:201], v[200:201], v[202:203]
    v_pk_add_f32 v[204:205], v[204:205], v[206:207]
    v_pk_add_f32 v[200:201], v[200:201], v[204:205]
    v_add_f32 v200, v200, v201
    v_add_f32 v208, 1.0, v208
    v_cvt_pk_bf16_f32 v208, 0, v208
    v_cvt_pk_bf16_f32 v200, 0, v200
    s_waitcnt vmcnt(4)
    v_cmp_ne_u32 vcc, s4, v173
    s_cbranch_vccz L_STOK
POLL_11:
    buffer_load_dwordx2 v[172:173], v8, s[32:35], s14 offen sc1
    s_waitcnt vmcnt(0)
    v_cmp_ne_u32 vcc, s4, v173
    s_cbranch_vccz PDONE_12
    s_add_u32 s5, s5, 1
    s_cmp_lt_u32 s5, 200000
    s_cbranch_scc1 POLL_11
PDONE_12:
L_STOK:
    v_lshlrev_b32 v173, 16, v172
    v_and_b32 v172, s6, v172
    v_rcp_f32 v172, v172
    s_nop 0
    v_pk_add_f32 v[184:185], v[172:173], v[184:185] op_sel:[1,0] neg_lo:[1,0] neg_hi:[1,0]
    v_pk_add_f32 v[186:187], v[172:173], v[186:187] op_sel:[1,0] neg_lo:[1,0] neg_hi:[1,0]
    v_pk_add_f32 v[188:189], v[172:173], v[188:189] op_sel:[1,0] neg_lo:[1,0] neg_hi:[1,0]
    v_pk_add_f32 v[190:191], v[172:173], v[190:191] op_sel:[1,0] neg_lo:[1,0] neg_hi:[1,0]
    v_pk_add_f32 v[192:193], v[172:173], v[192:193] op_sel:[1,0] neg_lo:[1,0] neg_hi:[1,0]
    v_pk_add_f32 v[194:195], v[172:173], v[194:195] op_sel:[1,0] neg_lo:[1,0] neg_hi:[1,0]
    v_pk_add_f32 v[196:197], v[172:173], v[196:197] op_sel:[1,0] neg_lo:[1,0] neg_hi:[1,0]
    v_pk_add_f32 v[198:199], v[172:173], v[198:199] op_sel:[1,0] neg_lo:[1,0] neg_hi:[1,0]
    v_cvt_pk_bf16_f32 v184, 0, v184
    v_cvt_pk_bf16_f32 v185, 0, v185
    v_cvt_pk_bf16_f32 v186, 0, v186
    v_cvt_pk_bf16_f32 v187, 0, v187
    v_cvt_pk_bf16_f32 v188, 0, v188
    v_cvt_pk_bf16_f32 v189, 0, v189
    v_cvt_pk_bf16_f32 v190, 0, v190
    v_cvt_pk_bf16_f32 v191, 0, v191
    v_cvt_pk_bf16_f32 v192, 0, v192
    v_cvt_pk_bf16_f32 v193, 0, v193
    v_cvt_pk_bf16_f32 v194, 0, v194
    v_cvt_pk_bf16_f32 v195, 0, v195
    v_cvt_pk_bf16_f32 v196, 0, v196
    v_cvt_pk_bf16_f32 v197, 0, v197
    v_cvt_pk_bf16_f32 v198, 0, v198
    v_cvt_pk_bf16_f32 v199, 0, v199
    v_pk_mul_f32 v[184:185], v[184:185], v[172:173] op_sel_hi:[1,0]
    v_pk_mul_f32 v[186:187], v[186:187], v[172:173] op_sel_hi:[1,0]
    v_pk_mul_f32 v[188:189], v[188:189], v[172:173] op_sel_hi:[1,0]
    v_pk_mul_f32 v[190:191], v[190:191], v[172:173] op_sel_hi:[1,0]
    v_pk_mul_f32 v[192:193], v[192:193], v[172:173] op_sel_hi:[1,0]
    v_pk_mul_f32 v[194:195], v[194:195], v[172:173] op_sel_hi:[1,0]
    v_pk_mul_f32 v[196:197], v[196:197], v[172:173] op_sel_hi:[1,0]
    v_pk_mul_f32 v[198:199], v[198:199], v[172:173] op_sel_hi:[1,0]
    v_cvt_pk_bf16_f32 v184, 0, v184
    v_cvt_pk_bf16_f32 v185, 0, v185
    v_cvt_pk_bf16_f32 v186, 0, v186
    v_cvt_pk_bf16_f32 v187, 0, v187
    v_cvt_pk_bf16_f32 v188, 0, v188
    v_cvt_pk_bf16_f32 v189, 0, v189
    v_cvt_pk_bf16_f32 v190, 0, v190
    v_cvt_pk_bf16_f32 v191, 0, v191
    v_cvt_pk_bf16_f32 v192, 0, v192
    v_cvt_pk_bf16_f32 v193, 0, v193
    v_cvt_pk_bf16_f32 v194, 0, v194
    v_cvt_pk_bf16_f32 v195, 0, v195
    v_cvt_pk_bf16_f32 v196, 0, v196
    v_cvt_pk_bf16_f32 v197, 0, v197
    v_cvt_pk_bf16_f32 v198, 0, v198
    v_cvt_pk_bf16_f32 v199, 0, v199
    v_mul_f32_dpp v184, v208, v184 row_newbcast:0 row_mask:0xf bank_mask:0xf
    v_mul_f32_dpp v185, v208, v185 row_newbcast:1 row_mask:0xf bank_mask:0xf
    v_mul_f32_dpp v186, v208, v186 row_newbcast:2 row_mask:0xf bank_mask:0xf
    v_mul_f32_dpp v187, v208, v187 row_newbcast:3 row_mask:0xf bank_mask:0xf
    v_mul_f32_dpp v188, v208, v188 row_newbcast:4 row_mask:0xf bank_mask:0xf
    v_mul_f32_dpp v189, v208, v189 row_newbcast:5 row_mask:0xf bank_mask:0xf
    v_mul_f32_dpp v190, v208, v190 row_newbcast:6 row_mask:0xf bank_mask:0xf
    v_mul_f32_dpp v191, v208, v191 row_newbcast:7 row_mask:0xf bank_mask:0xf
    v_cvt_pk_bf16_f32 v184, 0, v184
    v_cvt_pk_bf16_f32 v185, 0, v185
    v_cvt_pk_bf16_f32 v186, 0, v186
    v_cvt_pk_bf16_f32 v187, 0, v187
    v_cvt_pk_bf16_f32 v188, 0, v188
    v_cvt_pk_bf16_f32 v189, 0, v189
    v_cvt_pk_bf16_f32 v190, 0, v190
    v_cvt_pk_bf16_f32 v191, 0, v191
    v_add_f32_dpp v184, v200, v184 row_newbcast:0 row_mask:0xf bank_mask:0xf
    v_add_f32_dpp v185, v200, v185 row_newbcast:1 row_mask:0xf bank_mask:0xf
    v_add_f32_dpp v186, v200, v186 row_newbcast:2 row_mask:0xf bank_mask:0xf
    v_add_f32_dpp v187, v200, v187 row_newbcast:3 row_mask:0xf bank_mask:0xf
    v_add_f32_dpp v188, v200, v188 row_newbcast:4 row_mask:0xf bank_mask:0xf
    v_add_f32_dpp v189, v200, v189 row_newbcast:5 row_mask:0xf bank_mask:0xf
    v_add_f32_dpp v190, v200, v190 row_newbcast:6 row_mask:0xf bank_mask:0xf
    v_add_f32_dpp v191, v200, v191 row_newbcast:7 row_mask:0xf bank_mask:0xf
    v_cvt_pk_bf16_f32 v216, v184, v185
    v_cvt_pk_bf16_f32 v217, v186, v187
    v_cvt_pk_bf16_f32 v218, v188, v189
    v_cvt_pk_bf16_f32 v219, v190, v191
    buffer_store_dwordx4 v[216:219], v4, s[32:35], s13 offen sc1
    v_mul_f32_dpp v192, v208, v192 row_newbcast:8 row_mask:0xf bank_mask:0xf
    v_mul_f32_dpp v193, v208, v193 row_newbcast:9 row_mask:0xf bank_mask:0xf
    v_mul_f32_dpp v194, v208, v194 row_newbcast:10 row_mask:0xf bank_mask:0xf
    v_mul_f32_dpp v195, v208, v195 row_newbcast:11 row_mask:0xf bank_mask:0xf
    v_mul_f32_dpp v196, v208, v196 row_newbcast:12 row_mask:0xf bank_mask:0xf
    v_mul_f32_dpp v197, v208, v197 row_newbcast:13 row_mask:0xf bank_mask:0xf
    v_mul_f32_dpp v198, v208, v198 row_newbcast:14 row_mask:0xf bank_mask:0xf
    v_mul_f32_dpp v199, v208, v199 row_newbcast:15 row_mask:0xf bank_mask:0xf
    v_cvt_pk_bf16_f32 v192, 0, v192
    v_cvt_pk_bf16_f32 v193, 0, v193
    v_cvt_pk_bf16_f32 v194, 0, v194
    v_cvt_pk_bf16_f32 v195, 0, v195
    v_cvt_pk_bf16_f32 v196, 0, v196
    v_cvt_pk_bf16_f32 v197, 0, v197
    v_cvt_pk_bf16_f32 v198, 0, v198
    v_cvt_pk_bf16_f32 v199, 0, v199
    v_add_f32_dpp v192, v200, v192 row_newbcast:8 row_mask:0xf bank_mask:0xf
    v_add_f32_dpp v193, v200, v193 row_newbcast:9 row_mask:0xf bank_mask:0xf
    v_add_f32_dpp v194, v200, v194 row_newbcast:10 row_mask:0xf bank_mask:0xf
    v_add_f32_dpp v195, v200, v195 row_newbcast:11 row_mask:0xf bank_mask:0xf
    v_add_f32_dpp v196, v200, v196 row_newbcast:12 row_mask:0xf bank_mask:0xf
    v_add_f32_dpp v197, v200, v197 row_newbcast:13 row_mask:0xf bank_mask:0xf
    v_add_f32_dpp v198, v200, v198 row_newbcast:14 row_mask:0xf bank_mask:0xf
    v_add_f32_dpp v199, v200, v199 row_newbcast:15 row_mask:0xf bank_mask:0xf
    v_cvt_pk_bf16_f32 v220, v192, v193
    v_cvt_pk_bf16_f32 v221, v194, v195
    v_cvt_pk_bf16_f32 v222, v196, v197
    v_cvt_pk_bf16_f32 v223, v198, v199
    buffer_store_dwordx4 v[220:223], v4, s[32:35], s13 offen offset:2048 sc1
    v_bfe_u32 v20, v1, 2, 2
    v_lshlrev_b32 v20, 7, v20
    v_bfe_u32 v9, v1, 3, 1
    v_lshl_add_u32 v20, v9, 6, v20
    v_bfe_u32 v9, v1, 4, 1
    v_lshl_add_u32 v20, v9, 5, v20
    v_and_b32 v9, 3, v1
    v_lshl_add_u32 v20, v9, 3, v20
    v_lshrrev_b32 v9, 5, v1
    v_lshl_add_u32 v20, v9, 9, v20
    v_xor_b32 v21, 64, v20
    v_add_u32 v22, 49152, v20
    v_add_u32 v23, 49152, v21
    v_add_u32 v24, 98304, v20
    v_add_u32 v25, 98304, v21
    v_and_b32 v5, 3, v1
    v_lshlrev_b32 v5, 15, v5
    v_bfe_u32 v9, v1, 2, 2
    v_lshl_add_u32 v5, v9, 12, v5
    s_and_b32 s96, s12, 1
    s_lshr_b32 s97, s21, 3
    s_and_b32 s98, s21, 7
    s_lshl_b32 s99, s98, 5
    s_lshl2_add_u32 s98, s97, s99
    s_lshl_b32 s97, s98, 12
    s_lshr_b32 s99, s12, 1
    s_lshl_b32 s98, s99, 6
    s_add_u32 s99, s97, s98
    s_lshl2_add_u32 s97, s96, s99
    s_add_u32 s13, s97, 1048576
    s_lshl_b32 s96, s10, 18
    s_lshl_b32 s97, s77, 12
    s_add_u32 s98, s96, s97
    s_add_u32 s88, s98, 4194304
    s_cmp_ge_u32 s9, 28
    s_cselect_b32 s54, 0, s54
    s_cselect_b32 s58, 0, s58
    s_cselect_b32 s62, 0, s62
    s_waitcnt vmcnt(0)
    s_barrier
    s_cmp_lg_u32 s3, 0
    s_cbranch_scc1 L_PB
    v_mov_b32 v6, s4
    s_mov_b32 exec_hi, 0
    s_mov_b32 exec_lo, 65535
    buffer_store_dword v6, v5, s[32:35], s13 offen sc1
    s_mov_b64 exec, -1
L_PB:
    s_lshr_b32 s96, s9, 4
    s_lshl_b32 s97, s96, -1
    s_xor_b32 s94, s97, 2
    s_add_u32 s96, s94, s84
    s_and_b32 s97, s96, 15
    s_mul_i32 s98, s97, 393216
    s_add_u32 s91, s98, s85
    s_lshl_b32 s96, s94, 13
    s_add_u32 s94, s96, s83
    s_add_u32 s82, s91, 2048
    s_mov_b32 m0, s94
    s_nop 0
    buffer_load_dwordx4 v3, s[40:43], s82 offen lds
    s_add_u32 s82, s91, 4096
    s_add_u32 m0, s94, 49152
    s_nop 0
    buffer_load_dwordx4 v3, s[40:43], s82 offen lds
    s_mov_b32 s82, s91
    s_add_u32 m0, s94, 98304
    s_nop 0
    buffer_load_dwordx4 v3, s[40:43], s82 offen lds
    s_lshr_b32 s96, s9, 4
    s_lshl_b32 s97, s96, -1
    s_xor_b32 s94, s97, 3
    s_add_u32 s96, s94, s84
    s_and_b32 s97, s96, 15
    s_mul_i32 s98, s97, 393216
    s_add_u32 s91, s98, s85
    s_lshl_b32 s96, s94, 13
    s_add_u32 s94, s96, s83
    s_add_u32 s82, s91, 2048
    s_mov_b32 m0, s94
    s_nop 0
    buffer_load_dwordx4 v3, s[40:43], s82 offen lds
    s_add_u32 s82, s91, 4096
    s_add_u32 m0, s94, 49152
    s_nop 0
    buffer_load_dwordx4 v3, s[40:43], s82 offen lds
    s_mov_b32 s82, s91
    s_add_u32 m0, s94, 98304
    s_nop 0
    buffer_load_dwordx4 v3, s[40:43], s82 offen lds
    s_lshl_b32 s96, s2, 12
    s_add_u32 s19, s96, 1048576
    s_and_b32 s96, s3, 3
    s_lshl_b32 s97, s96, 7
    s_add_u32 s20, s97, s19
    s_lshl_b32 s96, s84, 5
    s_add_u32 s19, s96, s19
    s_cmp_ge_u32 s3, 4
    s_cselect_b32 s19, s20, s19
    s_load_dwordx2 s[24:25], s[32:33], s19 offset:0 glc
    s_load_dwordx2 s[26:27], s[32:33], s19 offset:64 glc
    s_lshl_b32 s96, s3, 14
    s_lshl_b32 s97, s12, 7
    s_add_u32 s90, s96, s97
    s_and_b32 s96, s9, 1
    s_lshr_b32 s97, s9, 3
    s_lshl_b32 s98, s97, 1
    s_lshl3_add_u32 s99, s96, s98
    s_lshl_b32 s95, s99, 17
    s_lshl3_add_u32 s96, s75, s3
    s_mul_i32 s97, s96, 229376
    s_lshl_b32 s98, s74, 7
    s_add_u32 s80, s97, s98
    s_lshl3_add_u32 s96, s74, s3
    s_lshl_b32 s97, s96, 14
    s_lshl_b32 s98, s75, 9
    s_add_u32 s81, s97, s98
    s_and_b32 s96, s8, 3
    s_lshl3_add_u32 s97, s96, s3
    s_mul_i32 s98, s97, 393216
    s_lshr_b32 s99, s8, 2
    s_lshl1_add_u32 s96, s9, s99
    s_lshl_b32 s97, s96, 7
    s_add_u32 s99, s98, s97
    s_add_u32 s89, s99, 4096
    s_and_b32 s96, s3, 1
    s_lshl_b32 s14, s96, 6
    v_bfe_u32 v6, v1, 4, 1
    v_lshl_add_u32 v6, v6, 5, s14
    v_and_b32 v26, 7, v1
    v_lshlrev_b32 v26, 4, v26
    v_xor_b32 v26, v26, v6
    v_lshrrev_b32 v6, 3, v1
    v_lshlrev_b32 v6, 11, v6
    v_add_u32 v26, v26, v6
    s_and_b32 s96, s3, 2
    s_lshl_b32 s14, s96, 5
    v_bfe_u32 v6, v1, 4, 1
    v_lshl_add_u32 v6, v6, 5, s14
    v_and_b32 v27, 7, v1
    v_lshlrev_b32 v27, 4, v27
    v_xor_b32 v27, v27, v6
    v_lshrrev_b32 v6, 3, v1
    v_mul_u32_u24 v6, 7168, v6
    v_add_u32 v27, v27, v6
    s_and_b32 s96, s3, 1
    s_lshl_b32 s14, s96, 7
    v_lshrrev_b32 v6, 5, v1
    v_lshl_add_u32 v6, v6, 6, s14
    v_and_b32 v253, 31, v1
    v_lshlrev_b32 v253, 4, v253
    v_lshrrev_b32 v9, 5, v1
    v_lshl_add_u32 v253, v9, 11, v253
    v_xor_b32 v253, v253, v6
    s_lshl_b32 s16, s84, 14
    v_add_u32 v249, s88, v2
    s_lshl_b32 s96, s77, 11
    s_add_u32 s14, s96, 151552
    v_add_u32 v0, s14, v2
    s_mov_b64 exec, 0
    s_cmp_eq_u32 s3, 4
    s_cbranch_scc1 L_PAD2
    s_cmp_eq_u32 s3, 5
    s_cbranch_scc1 L_PAD3
    s_cmp_eq_u32 s3, 6
    s_cbranch_scc1 L_PAD4
    s_cmp_eq_u32 s3, 7
    s_cbranch_scc1 L_PAD5
    s_branch L_TEND
L_RET2:
    s_branch L_PAD6
L_RET6:
    s_branch L_PAD10
L_RET10:
    s_branch L_TEND
L_RET3:
    s_branch L_PAD7
L_RET7:
    s_branch L_TEND
L_RET4:
    s_branch L_PAD8
L_RET8:
    s_branch L_TEND
L_RET5:
    s_branch L_PAD9
L_RET9:
    s_branch L_TEND
    s_nop 0
    s_nop 0
    s_nop 0
    s_nop 0
    s_nop 0
    s_nop 0
    s_nop 0
    s_nop 0
    s_nop 0
    s_nop 0
    s_nop 0
    s_nop 0
    s_nop 0
    s_nop 0
    s_nop 0
    s_nop 0
    s_nop 0
    s_nop 0
    s_nop 0
    s_nop 0
    s_nop 0
    s_nop 0
    s_nop 0
    s_nop 0
    s_nop 0
    s_nop 0
    s_nop 0
    s_nop 0
L_TEND:
    s_mov_b64 exec, -1
    s_branch SCHK_14
SPOLL_13:
    s_load_dwordx2 s[24:25], s[32:33], s19 offset:0 glc
    s_load_dwordx2 s[26:27], s[32:33], s19 offset:64 glc
SCHK_14:
    s_add_u32 s5, s5, 1
    s_cmp_ge_u32 s5, 200000
    s_waitcnt lgkmcnt(0)
    s_cbranch_scc1 SDONE_15
    s_cmp_lg_u32 s24, s4
    s_cbranch_scc1 SPOLL_13
    s_cmp_lg_u32 s25, s4
    s_cbranch_scc1 SPOLL_13
    s_cmp_lg_u32 s26, s4
    s_cbranch_scc1 SPOLL_13
    s_cmp_lg_u32 s27, s4
    s_cbranch_scc1 SPOLL_13
SDONE_15:
    s_cmp_ge_u32 s3, 4
    s_cbranch_scc1 L_HELP
    s_setprio 2
    buffer_load_dwordx4 v[152:155], v249, s[32:35], s16 offen sc1
    buffer_load_dwordx4 v[156:159], v249, s[32:35], s16 offen offset:1024 sc1
    buffer_load_dwordx4 v[160:163], v249, s[32:35], s16 offen offset:2048 sc1
    buffer_load_dwordx4 v[164:167], v249, s[32:35], s16 offen offset:3072 sc1
    s_add_u32 s16, s16, 16384
    s_and_b32 s16, s16, 0x3ffff
    buffer_load_dwordx4 v[168:171], v249, s[32:35], s16 offen sc1
    buffer_load_dwordx4 v[172:175], v249, s[32:35], s16 offen offset:1024 sc1
    s_barrier
    ds_read_b64_tr_b16 v[28:29], v20
    ds_read_b64_tr_b16 v[30:31], v20 offset:2048
    ds_read_b64_tr_b16 v[32:33], v21
    ds_read_b64_tr_b16 v[34:35], v21 offset:2048
    ds_read_b64_tr_b16 v[36:37], v24
    ds_read_b64_tr_b16 v[38:39], v24 offset:2048
    ds_read_b64_tr_b16 v[40:41], v25
    ds_read_b64_tr_b16 v[42:43], v25 offset:2048
    ds_read_b64_tr_b16 v[44:45], v22
    ds_read_b64_tr_b16 v[46:47], v22 offset:2048
    ds_read_b64_tr_b16 v[48:49], v23
    ds_read_b64_tr_b16 v[50:51], v23 offset:2048
    s_waitcnt vmcnt(5)
    s_waitcnt lgkmcnt(10)
    v_mfma_f32_32x32x16_bf16 v[56:71], v[28:31], v[152:155], 0
    ds_read_b64_tr_b16 v[52:53], v20 offset:1024
    ds_read_b64_tr_b16 v[54:55], v20 offset:3072
    s_waitcnt lgkmcnt(10)
    v_mfma_f32_32x32x16_bf16 v[72:87], v[32:35], v[152:155], 0
    ds_read_b64_tr_b16 v[28:29], v21 offset:1024
    ds_read_b64_tr_b16 v[30:31], v21 offset:3072
    s_waitcnt lgkmcnt(10)
    v_mfma_f32_32x32x16_bf16 v[120:135], v[36:39], v[152:155], 0
    ds_read_b64_tr_b16 v[32:33], v24 offset:1024
    ds_read_b64_tr_b16 v[34:35], v24 offset:3072
    s_waitcnt lgkmcnt(10)
    v_mfma_f32_32x32x16_bf16 v[136:151], v[40:43], v[152:155], 0
    ds_read_b64_tr_b16 v[36:37], v25 offset:1024
    ds_read_b64_tr_b16 v[38:39], v25 offset:3072
    s_waitcnt lgkmcnt(10)
    v_mfma_f32_32x32x16_bf16 v[88:103], v[44:47], v[152:155], 0
    buffer_load_dwordx4 v[176:179], v249, s[32:35], s16 offen offset:2048 sc1
    ds_read_b64_tr_b16 v[40:41], v22 offset:1024
    ds_read_b64_tr_b16 v[42:43], v22 offset:3072
    s_waitcnt lgkmcnt(10)
    v_mfma_f32_32x32x16_bf16 v[104:119], v[48:51], v[152:155], 0
    ds_read_b64_tr_b16 v[44:45], v23 offset:1024
    ds_read_b64_tr_b16 v[46:47], v23 offset:3072
    s_waitcnt vmcnt(5)
    s_waitcnt lgkmcnt(10)
    v_mfma_f32_32x32x16_bf16 v[56:71], v[52:55], v[156:159], v[56:71]
    ds_read_b64_tr_b16 v[48:49], v20 offset:4096
    ds_read_b64_tr_b16 v[50:51], v20 offset:6144
    s_waitcnt lgkmcnt(10)
    v_mfma_f32_32x32x16_bf16 v[72:87], v[28:31], v[156:159], v[72:87]
    ds_read_b64_tr_b16 v[52:53], v21 offset:4096
    ds_read_b64_tr_b16 v[54:55], v21 offset:6144
    s_waitcnt lgkmcnt(10)
    v_mfma_f32_32x32x16_bf16 v[120:135], v[32:35], v[156:159], v[120:135]
    ds_read_b64_tr_b16 v[28:29], v24 offset:4096
    ds_read_b64_tr_b16 v[30:31], v24 offset:6144
    s_waitcnt lgkmcnt(10)
    v_mfma_f32_32x32x16_bf16 v[136:151], v[36:39], v[156:159], v[136:151]
    buffer_load_dwordx4 v[180:183], v249, s[32:35], s16 offen offset:3072 sc1
    ds_read_b64_tr_b16 v[32:33], v25 offset:4096
    ds_read_b64_tr_b16 v[34:35], v25 offset:6144
    s_waitcnt lgkmcnt(10)
    v_mfma_f32_32x32x16_bf16 v[88:103], v[40:43], v[156:159], v[88:103]
    s_add_u32 s16, s16, 16384
    ds_read_b64_tr_b16 v[36:37], v22 offset:4096
    ds_read_b64_tr_b16 v[38:39], v22 offset:6144
    s_waitcnt lgkmcnt(10)
    v_mfma_f32_32x32x16_bf16 v[104:119], v[44:47], v[156:159], v[104:119]
    s_and_b32 s16, s16, 0x3ffff
    ds_read_b64_tr_b16 v[40:41], v23 offset:4096
    ds_read_b64_tr_b16 v[42:43], v23 offset:6144
    s_waitcnt vmcnt(5)
    s_waitcnt lgkmcnt(10)
    v_mfma_f32_32x32x16_bf16 v[56:71], v[48:51], v[160:163], v[56:71]
    ds_read_b64_tr_b16 v[44:45], v20 offset:5120
    ds_read_b64_tr_b16 v[46:47], v20 offset:7168
    s_waitcnt lgkmcnt(10)
    v_mfma_f32_32x32x16_bf16 v[72:87], v[52:55], v[160:163], v[72:87]
    ds_read_b64_tr_b16 v[48:49], v21 offset:5120
    ds_read_b64_tr_b16 v[50:51], v21 offset:7168
    s_waitcnt lgkmcnt(10)
    v_mfma_f32_32x32x16_bf16 v[120:135], v[28:31], v[160:163], v[120:135]
    buffer_load_dwordx4 v[184:187], v249, s[32:35], s16 offen sc1
    ds_read_b64_tr_b16 v[52:53], v24 offset:5120
    ds_read_b64_tr_b16 v[54:55], v24 offset:7168
    s_waitcnt lgkmcnt(10)
    v_mfma_f32_32x32x16_bf16 v[136:151], v[32:35], v[160:163], v[136:151]
    ds_read_b64_tr_b16 v[28:29], v25 offset:5120
    ds_read_b64_tr_b16 v[30:31], v25 offset:7168
    s_waitcnt lgkmcnt(10)
    v_mfma_f32_32x32x16_bf16 v[88:103], v[36:39], v[160:163], v[88:103]
    ds_read_b64_tr_b16 v[32:33], v22 offset:5120
    ds_read_b64_tr_b16 v[34:35], v22 offset:7168
    s_waitcnt lgkmcnt(10)
    v_mfma_f32_32x32x16_bf16 v[104:119], v[40:43], v[160:163], v[104:119]
    ds_read_b64_tr_b16 v[36:37], v23 offset:5120
    ds_read_b64_tr_b16 v[38:39], v23 offset:7168
    s_waitcnt vmcnt(5)
    s_waitcnt lgkmcnt(10)
    v_mfma_f32_32x32x16_bf16 v[56:71], v[44:47], v[164:167], v[56:71]
    ds_read_b64_tr_b16 v[40:41], v20 offset:8192
    ds_read_b64_tr_b16 v[42:43], v20 offset:10240
    s_waitcnt lgkmcnt(10)
    v_mfma_f32_32x32x16_bf16 v[72:87], v[48:51], v[164:167], v[72:87]
    buffer_load_dwordx4 v[188:191], v249, s[32:35], s16 offen offset:1024 sc1
    ds_read_b64_tr_b16 v[44:45], v21 offset:8192
    ds_read_b64_tr_b16 v[46:47], v21 offset:10240
    s_waitcnt lgkmcnt(10)
    v_mfma_f32_32x32x16_bf16 v[120:135], v[52:55], v[164:167], v[120:135]
    ds_read_b64_tr_b16 v[48:49], v24 offset:8192
    ds_read_b64_tr_b16 v[50:51], v24 offset:10240
    s_waitcnt lgkmcnt(10)
    v_mfma_f32_32x32x16_bf16 v[136:151], v[28:31], v[164:167], v[136:151]
    ds_read_b64_tr_b16 v[52:53], v25 offset:8192
    ds_read_b64_tr_b16 v[54:55], v25 offset:10240
    s_waitcnt lgkmcnt(10)
    v_mfma_f32_32x32x16_bf16 v[88:103], v[32:35], v[164:167], v[88:103]
    ds_read_b64_tr_b16 v[28:29], v22 offset:8192
    ds_read_b64_tr_b16 v[30:31], v22 offset:10240
    s_waitcnt lgkmcnt(10)
    v_mfma_f32_32x32x16_bf16 v[104:119], v[36:39], v[164:167], v[104:119]
    buffer_load_dwordx4 v[192:195], v249, s[32:35], s16 offen offset:2048 sc1
    ds_read_b64_tr_b16 v[32:33], v23 offset:8192
    ds_read_b64_tr_b16 v[34:35], v23 offset:10240
    s_barrier
    s_waitcnt vmcnt(6)
    s_waitcnt lgkmcnt(10)
    v_mfma_f32_32x32x16_bf16 v[56:71], v[40:43], v[168:171], v[56:71]
    ds_read_b64_tr_b16 v[36:37], v20 offset:9216
    ds_read_b64_tr_b16 v[38:39], v20 offset:11264
    s_waitcnt lgkmcnt(10)
    v_mfma_f32_32x32x16_bf16 v[72:87], v[44:47], v[168:171], v[72:87]
    ds_read_b64_tr_b16 v[40:41], v21 offset:9216
    ds_read_b64_tr_b16 v[42:43], v21 offset:11264
    s_waitcnt lgkmcnt(10)
    v_mfma_f32_32x32x16_bf16 v[120:135], v[48:51], v[168:171], v[120:135]
    ds_read_b64_tr_b16 v[44:45], v24 offset:9216
    ds_read_b64_tr_b16 v[46:47], v24 offset:11264
    s_waitcnt lgkmcnt(10)
    v_mfma_f32_32x32x16_bf16 v[136:151], v[52:55], v[168:171], v[136:151]
    ds_read_b64_tr_b16 v[48:49], v25 offset:9216
    ds_read_b64_tr_b16 v[50:51], v25 offset:11264
    s_waitcnt lgkmcnt(10)
    v_mfma_f32_32x32x16_bf16 v[88:103], v[28:31], v[168:171], v[88:103]
    buffer_load_dwordx4 v[196:199], v249, s[32:35], s16 offen offset:3072 sc1
    ds_read_b64_tr_b16 v[52:53], v22 offset:9216
    ds_read_b64_tr_b16 v[54:55], v22 offset:11264
    s_waitcnt lgkmcnt(10)
    v_mfma_f32_32x32x16_bf16 v[104:119], v[32:35], v[168:171], v[104:119]
    s_add_u32 s16, s16, 16384
    ds_read_b64_tr_b16 v[28:29], v23 offset:9216
    ds_read_b64_tr_b16 v[30:31], v23 offset:11264
    s_waitcnt vmcnt(6)
    s_waitcnt lgkmcnt(10)
    v_mfma_f32_32x32x16_bf16 v[56:71], v[36:39], v[172:175], v[56:71]
    s_and_b32 s16, s16, 0x3ffff
    ds_read_b64_tr_b16 v[32:33], v20 offset:12288
    ds_read_b64_tr_b16 v[34:35], v20 offset:14336
    s_waitcnt lgkmcnt(10)
    v_mfma_f32_32x32x16_bf16 v[72:87], v[40:43], v[172:175], v[72:87]
    ds_read_b64_tr_b16 v[36:37], v21 offset:12288
    ds_read_b64_tr_b16 v[38:39], v21 offset:14336
    s_waitcnt lgkmcnt(10)
    v_mfma_f32_32x32x16_bf16 v[120:135], v[44:47], v[172:175], v[120:135]
    ds_read_b64_tr_b16 v[40:41], v24 offset:12288
    ds_read_b64_tr_b16 v[42:43], v24 offset:14336
    s_waitcnt lgkmcnt(10)
    v_mfma_f32_32x32x16_bf16 v[136:151], v[48:51], v[172:175], v[136:151]
    buffer_load_dwordx4 v[200:203], v249, s[32:35], s16 offen sc1
    ds_read_b64_tr_b16 v[44:45], v25 offset:12288
    ds_read_b64_tr_b16 v[46:47], v25 offset:14336
    s_waitcnt lgkmcnt(10)
    v_mfma_f32_32x32x16_bf16 v[88:103], v[52:55], v[172:175], v[88:103]
    ds_read_b64_tr_b16 v[48:49], v22 offset:12288
    ds_read_b64_tr_b16 v[50:51], v22 offset:14336
    s_waitcnt lgkmcnt(10)
    v_mfma_f32_32x32x16_bf16 v[104:119], v[28:31], v[172:175], v[104:119]
    ds_read_b64_tr_b16 v[52:53], v23 offset:12288
    ds_read_b64_tr_b16 v[54:55], v23 offset:14336
    s_waitcnt vmcnt(6)
    s_waitcnt lgkmcnt(10)
    v_mfma_f32_32x32x16_bf16 v[56:71], v[32:35], v[176:179], v[56:71]
    ds_read_b64_tr_b16 v[28:29], v20 offset:13312
    ds_read_b64_tr_b16 v[30:31], v20 offset:15360
    s_waitcnt lgkmcnt(10)
    v_mfma_f32_32x32x16_bf16 v[72:87], v[36:39], v[176:179], v[72:87]
    ds_read_b64_tr_b16 v[32:33], v21 offset:13312
    ds_read_b64_tr_b16 v[34:35], v21 offset:15360
    s_waitcnt lgkmcnt(10)
    v_mfma_f32_32x32x16_bf16 v[120:135], v[40:43], v[176:179], v[120:135]
    buffer_load_dwordx4 v[204:207], v249, s[32:35], s16 offen offset:1024 sc1
    ds_read_b64_tr_b16 v[36:37], v24 offset:13312
    ds_read_b64_tr_b16 v[38:39], v24 offset:15360
    s_waitcnt lgkmcnt(10)
    v_mfma_f32_32x32x16_bf16 v[136:151], v[44:47], v[176:179], v[136:151]
    ds_read_b64_tr_b16 v[40:41], v25 offset:13312
    ds_read_b64_tr_b16 v[42:43], v25 offset:15360
    s_waitcnt lgkmcnt(10)
    v_mfma_f32_32x32x16_bf16 v[88:103], v[48:51], v[176:179], v[88:103]
    ds_read_b64_tr_b16 v[44:45], v22 offset:13312
    ds_read_b64_tr_b16 v[46:47], v22 offset:15360
    s_waitcnt lgkmcnt(10)
    v_mfma_f32_32x32x16_bf16 v[104:119], v[52:55], v[176:179], v[104:119]
    ds_read_b64_tr_b16 v[48:49], v23 offset:13312
    ds_read_b64_tr_b16 v[50:51], v23 offset:15360
    s_waitcnt vmcnt(6)
    s_waitcnt lgkmcnt(10)
    v_mfma_f32_32x32x16_bf16 v[56:71], v[28:31], v[180:183], v[56:71]
    ds_read_b64_tr_b16 v[52:53], v20 offset:16384
    ds_read_b64_tr_b16 v[54:55], v20 offset:18432
    s_waitcnt lgkmcnt(10)
    v_mfma_f32_32x32x16_bf16 v[72:87], v[32:35], v[180:183], v[72:87]
    buffer_load_dwordx4 v[208:211], v249, s[32:35], s16 offen offset:2048 sc1
    ds_read_b64_tr_b16 v[28:29], v21 offset:16384
    ds_read_b64_tr_b16 v[30:31], v21 offset:18432
    s_waitcnt lgkmcnt(10)
    v_mfma_f32_32x32x16_bf16 v[120:135], v[36:39], v[180:183], v[120:135]
    ds_read_b64_tr_b16 v[32:33], v24 offset:16384
    ds_read_b64_tr_b16 v[34:35], v24 offset:18432
    s_waitcnt lgkmcnt(10)
    v_mfma_f32_32x32x16_bf16 v[136:151], v[40:43], v[180:183], v[136:151]
    ds_read_b64_tr_b16 v[36:37], v25 offset:16384
    ds_read_b64_tr_b16 v[38:39], v25 offset:18432
    s_waitcnt lgkmcnt(10)
    v_mfma_f32_32x32x16_bf16 v[88:103], v[44:47], v[180:183], v[88:103]
    ds_read_b64_tr_b16 v[40:41], v22 offset:16384
    ds_read_b64_tr_b16 v[42:43], v22 offset:18432
    s_waitcnt lgkmcnt(10)
    v_mfma_f32_32x32x16_bf16 v[104:119], v[48:51], v[180:183], v[104:119]
    buffer_load_dwordx4 v[212:215], v249, s[32:35], s16 offen offset:3072 sc1
    ds_read_b64_tr_b16 v[44:45], v23 offset:16384
    ds_read_b64_tr_b16 v[46:47], v23 offset:18432
    s_barrier
    s_waitcnt vmcnt(7)
    s_waitcnt lgkmcnt(10)
    v_mfma_f32_32x32x16_bf16 v[56:71], v[52:55], v[184:187], v[56:71]
    s_add_u32 s16, s16, 16384
    ds_read_b64_tr_b16 v[48:49], v20 offset:17408
    ds_read_b64_tr_b16 v[50:51], v20 offset:19456
    s_waitcnt lgkmcnt(10)
    v_mfma_f32_32x32x16_bf16 v[72:87], v[28:31], v[184:187], v[72:87]
    s_and_b32 s16, s16, 0x3ffff
    ds_read_b64_tr_b16 v[52:53], v21 offset:17408
    ds_read_b64_tr_b16 v[54:55], v21 offset:19456
    s_waitcnt lgkmcnt(10)
    v_mfma_f32_32x32x16_bf16 v[120:135], v[32:35], v[184:187], v[120:135]
    ds_read_b64_tr_b16 v[28:29], v24 offset:17408
    ds_read_b64_tr_b16 v[30:31], v24 offset:19456
    s_waitcnt lgkmcnt(10)
    v_mfma_f32_32x32x16_bf16 v[136:151], v[36:39], v[184:187], v[136:151]
    ds_read_b64_tr_b16 v[32:33], v25 offset:17408
    ds_read_b64_tr_b16 v[34:35], v25 offset:19456
    s_waitcnt lgkmcnt(10)
    v_mfma_f32_32x32x16_bf16 v[88:103], v[40:43], v[184:187], v[88:103]
    buffer_load_dwordx4 v[216:219], v249, s[32:35], s16 offen sc1
    ds_read_b64_tr_b16 v[36:37], v22 offset:17408
    ds_read_b64_tr_b16 v[38:39], v22 offset:19456
    s_waitcnt lgkmcnt(10)
    v_mfma_f32_32x32x16_bf16 v[104:119], v[44:47], v[184:187], v[104:119]
    ds_read_b64_tr_b16 v[40:41], v23 offset:17408
    ds_read_b64_tr_b16 v[42:43], v23 offset:19456
    s_waitcnt vmcnt(7)
    s_waitcnt lgkmcnt(10)
    v_mfma_f32_32x32x16_bf16 v[56:71], v[48:51], v[188:191], v[56:71]
    ds_read_b64_tr_b16 v[44:45], v20 offset:20480
    ds_read_b64_tr_b16 v[46:47], v20 offset:22528
    s_waitcnt lgkmcnt(10)
    v_mfma_f32_32x32x16_bf16 v[72:87], v[52:55], v[188:191], v[72:87]
    ds_read_b64_tr_b16 v[48:49], v21 offset:20480
    ds_read_b64_tr_b16 v[50:51], v21 offset:22528
    s_waitcnt lgkmcnt(10)
    v_mfma_f32_32x32x16_bf16 v[120:135], v[28:31], v[188:191], v[120:135]
    ds_read_b64_tr_b16 v[52:53], v24 offset:20480
    ds_read_b64_tr_b16 v[54:55], v24 offset:22528
    s_waitcnt lgkmcnt(10)
    v_mfma_f32_32x32x16_bf16 v[136:151], v[32:35], v[188:191], v[136:151]
    buffer_load_dwordx4 v[220:223], v249, s[32:35], s16 offen offset:1024 sc1
    ds_read_b64_tr_b16 v[28:29], v25 offset:20480
    ds_read_b64_tr_b16 v[30:31], v25 offset:22528
    s_waitcnt lgkmcnt(10)
    v_mfma_f32_32x32x16_bf16 v[88:103], v[36:39], v[188:191], v[88:103]
    ds_read_b64_tr_b16 v[32:33], v22 offset:20480
    ds_read_b64_tr_b16 v[34:35], v22 offset:22528
    s_waitcnt lgkmcnt(10)
    v_mfma_f32_32x32x16_bf16 v[104:119], v[40:43], v[188:191], v[104:119]
    ds_read_b64_tr_b16 v[36:37], v23 offset:20480
    ds_read_b64_tr_b16 v[38:39], v23 offset:22528
    s_waitcnt vmcnt(7)
    s_waitcnt lgkmcnt(10)
    v_mfma_f32_32x32x16_bf16 v[56:71], v[44:47], v[192:195], v[56:71]
    ds_read_b64_tr_b16 v[40:41], v20 offset:21504
    ds_read_b64_tr_b16 v[42:43], v20 offset:23552
    s_waitcnt lgkmcnt(10)
    v_mfma_f32_32x32x16_bf16 v[72:87], v[48:51], v[192:195], v[72:87]
    ds_read_b64_tr_b16 v[44:45], v21 offset:21504
    ds_read_b64_tr_b16 v[46:47], v21 offset:23552
    s_waitcnt lgkmcnt(10)
    v_mfma_f32_32x32x16_bf16 v[120:135], v[52:55], v[192:195], v[120:135]
    buffer_load_dwordx4 v[224:227], v249, s[32:35], s16 offen offset:2048 sc1
    ds_read_b64_tr_b16 v[48:49], v24 offset:21504
    ds_read_b64_tr_b16 v[50:51], v24 offset:23552
    s_waitcnt lgkmcnt(10)
    v_mfma_f32_32x32x16_bf16 v[136:151], v[28:31], v[192:195], v[136:151]
    ds_read_b64_tr_b16 v[52:53], v25 offset:21504
    ds_read_b64_tr_b16 v[54:55], v25 offset:23552
    s_waitcnt lgkmcnt(10)
    v_mfma_f32_32x32x16_bf16 v[88:103], v[32:35], v[192:195], v[88:103]
    ds_read_b64_tr_b16 v[28:29], v22 offset:21504
    ds_read_b64_tr_b16 v[30:31], v22 offset:23552
    s_waitcnt lgkmcnt(10)
    v_mfma_f32_32x32x16_bf16 v[104:119], v[36:39], v[192:195], v[104:119]
    ds_read_b64_tr_b16 v[32:33], v23 offset:21504
    ds_read_b64_tr_b16 v[34:35], v23 offset:23552
    s_waitcnt vmcnt(7)
    s_waitcnt lgkmcnt(10)
    v_mfma_f32_32x32x16_bf16 v[56:71], v[40:43], v[196:199], v[56:71]
    ds_read_b64_tr_b16 v[36:37], v20 offset:24576
    ds_read_b64_tr_b16 v[38:39], v20 offset:26624
    s_waitcnt lgkmcnt(10)
    v_mfma_f32_32x32x16_bf16 v[72:87], v[44:47], v[196:199], v[72:87]
    buffer_load_dwordx4 v[228:231], v249, s[32:35], s16 offen offset:3072 sc1
    ds_read_b64_tr_b16 v[40:41], v21 offset:24576
    ds_read_b64_tr_b16 v[42:43], v21 offset:26624
    s_waitcnt lgkmcnt(10)
    v_mfma_f32_32x32x16_bf16 v[120:135], v[48:51], v[196:199], v[120:135]
    s_add_u32 s16, s16, 16384
    ds_read_b64_tr_b16 v[44:45], v24 offset:24576
    ds_read_b64_tr_b16 v[46:47], v24 offset:26624
    s_waitcnt lgkmcnt(10)
    v_mfma_f32_32x32x16_bf16 v[136:151], v[52:55], v[196:199], v[136:151]
    s_and_b32 s16, s16, 0x3ffff
    ds_read_b64_tr_b16 v[48:49], v25 offset:24576
    ds_read_b64_tr_b16 v[50:51], v25 offset:26624
    s_waitcnt lgkmcnt(10)
    v_mfma_f32_32x32x16_bf16 v[88:103], v[28:31], v[196:199], v[88:103]
    ds_read_b64_tr_b16 v[52:53], v22 offset:24576
    ds_read_b64_tr_b16 v[54:55], v22 offset:26624
    s_waitcnt lgkmcnt(10)
    v_mfma_f32_32x32x16_bf16 v[104:119], v[32:35], v[196:199], v[104:119]
    buffer_load_dwordx4 v[232:235], v249, s[32:35], s16 offen sc1
    ds_read_b64_tr_b16 v[28:29], v23 offset:24576
    ds_read_b64_tr_b16 v[30:31], v23 offset:26624
    s_barrier
    s_waitcnt vmcnt(8)
    s_waitcnt lgkmcnt(10)
    v_mfma_f32_32x32x16_bf16 v[56:71], v[36:39], v[200:203], v[56:71]
    ds_read_b64_tr_b16 v[32:33], v20 offset:25600
    ds_read_b64_tr_b16 v[34:35], v20 offset:27648
    s_waitcnt lgkmcnt(10)
    v_mfma_f32_32x32x16_bf16 v[72:87], v[40:43], v[200:203], v[72:87]
    ds_read_b64_tr_b16 v[36:37], v21 offset:25600
    ds_read_b64_tr_b16 v[38:39], v21 offset:27648
    s_waitcnt lgkmcnt(10)
    v_mfma_f32_32x32x16_bf16 v[120:135], v[44:47], v[200:203], v[120:135]
    ds_read_b64_tr_b16 v[40:41], v24 offset:25600
    ds_read_b64_tr_b16 v[42:43], v24 offset:27648
    s_waitcnt lgkmcnt(10)
    v_mfma_f32_32x32x16_bf16 v[136:151], v[48:51], v[200:203], v[136:151]
    ds_read_b64_tr_b16 v[44:45], v25 offset:25600
    ds_read_b64_tr_b16 v[46:47], v25 offset:27648
    s_waitcnt lgkmcnt(10)
    v_mfma_f32_32x32x16_bf16 v[88:103], v[52:55], v[200:203], v[88:103]
    buffer_load_dwordx4 v[236:239], v249, s[32:35], s16 offen offset:1024 sc1
    ds_read_b64_tr_b16 v[48:49], v22 offset:25600
    ds_read_b64_tr_b16 v[50:51], v22 offset:27648
    s_waitcnt lgkmcnt(10)
    v_mfma_f32_32x32x16_bf16 v[104:119], v[28:31], v[200:203], v[104:119]
    ds_read_b64_tr_b16 v[52:53], v23 offset:25600
    ds_read_b64_tr_b16 v[54:55], v23 offset:27648
    s_waitcnt vmcnt(8)
    s_waitcnt lgkmcnt(10)
    v_mfma_f32_32x32x16_bf16 v[56:71], v[32:35], v[204:207], v[56:71]
    ds_read_b64_tr_b16 v[28:29], v20 offset:28672
    ds_read_b64_tr_b16 v[30:31], v20 offset:30720
    s_waitcnt lgkmcnt(10)
    v_mfma_f32_32x32x16_bf16 v[72:87], v[36:39], v[204:207], v[72:87]
    ds_read_b64_tr_b16 v[32:33], v21 offset:28672
    ds_read_b64_tr_b16 v[34:35], v21 offset:30720
    s_waitcnt lgkmcnt(10)
    v_mfma_f32_32x32x16_bf16 v[120:135], v[40:43], v[204:207], v[120:135]
    ds_read_b64_tr_b16 v[36:37], v24 offset:28672
    ds_read_b64_tr_b16 v[38:39], v24 offset:30720
    s_waitcnt lgkmcnt(10)
    v_mfma_f32_32x32x16_bf16 v[136:151], v[44:47], v[204:207], v[136:151]
    buffer_load_dwordx4 v[240:243], v249, s[32:35], s16 offen offset:2048 sc1
    ds_read_b64_tr_b16 v[40:41], v25 offset:28672
    ds_read_b64_tr_b16 v[42:43], v25 offset:30720
    s_waitcnt lgkmcnt(10)
    v_mfma_f32_32x32x16_bf16 v[88:103], v[48:51], v[204:207], v[88:103]
    ds_read_b64_tr_b16 v[44:45], v22 offset:28672
    ds_read_b64_tr_b16 v[46:47], v22 offset:30720
L_PAD2:
    s_cbranch_execz L_RET2
    s_waitcnt lgkmcnt(10)
    v_mfma_f32_32x32x16_bf16 v[104:119], v[52:55], v[204:207], v[104:119]
    ds_read_b64_tr_b16 v[48:49], v23 offset:28672
    ds_read_b64_tr_b16 v[50:51], v23 offset:30720
    s_waitcnt vmcnt(8)
    s_waitcnt lgkmcnt(10)
    v_mfma_f32_32x32x16_bf16 v[56:71], v[28:31], v[208:211], v[56:71]
    ds_read_b64_tr_b16 v[52:53], v20 offset:29696
    ds_read_b64_tr_b16 v[54:55], v20 offset:31744
    s_waitcnt lgkmcnt(10)
    v_mfma_f32_32x32x16_bf16 v[72:87], v[32:35], v[208:211], v[72:87]
    ds_read_b64_tr_b16 v[28:29], v21 offset:29696
    ds_read_b64_tr_b16 v[30:31], v21 offset:31744
    s_waitcnt lgkmcnt(10)
    v_mfma_f32_32x32x16_bf16 v[120:135], v[36:39], v[208:211], v[120:135]
    buffer_load_dwordx4 v[244:247], v249, s[32:35], s16 offen offset:3072 sc1
    ds_read_b64_tr_b16 v[32:33], v24 offset:29696
    ds_read_b64_tr_b16 v[34:35], v24 offset:31744
    s_waitcnt lgkmcnt(10)
    v_mfma_f32_32x32x16_bf16 v[136:151], v[40:43], v[208:211], v[136:151]
    s_add_u32 s16, s16, 16384
    ds_read_b64_tr_b16 v[36:37], v25 offset:29696
    ds_read_b64_tr_b16 v[38:39], v25 offset:31744
    s_waitcnt lgkmcnt(10)
    v_mfma_f32_32x32x16_bf16 v[88:103], v[44:47], v[208:211], v[88:103]
    s_and_b32 s16, s16, 0x3ffff
    ds_read_b64_tr_b16 v[40:41], v22 offset:29696
    ds_read_b64_tr_b16 v[42:43], v22 offset:31744
    s_waitcnt lgkmcnt(10)
    v_mfma_f32_32x32x16_bf16 v[104:119], v[48:51], v[208:211], v[104:119]
    ds_read_b64_tr_b16 v[44:45], v23 offset:29696
    ds_read_b64_tr_b16 v[46:47], v23 offset:31744
    s_waitcnt vmcnt(8)
    s_waitcnt lgkmcnt(10)
    v_mfma_f32_32x32x16_bf16 v[56:71], v[52:55], v[212:215], v[56:71]
    ds_read_b64_tr_b16 v[48:49], v20 offset:32768
    ds_read_b64_tr_b16 v[50:51], v20 offset:34816
    s_waitcnt lgkmcnt(10)
    v_mfma_f32_32x32x16_bf16 v[72:87], v[28:31], v[212:215], v[72:87]
    buffer_load_dwordx4 v[152:155], v249, s[32:35], s16 offen sc1
    ds_read_b64_tr_b16 v[52:53], v21 offset:32768
    ds_read_b64_tr_b16 v[54:55], v21 offset:34816
    s_waitcnt lgkmcnt(10)
    v_mfma_f32_32x32x16_bf16 v[120:135], v[32:35], v[212:215], v[120:135]
    ds_read_b64_tr_b16 v[28:29], v24 offset:32768
    ds_read_b64_tr_b16 v[30:31], v24 offset:34816
    s_waitcnt lgkmcnt(10)
    v_mfma_f32_32x32x16_bf16 v[136:151], v[36:39], v[212:215], v[136:151]
    ds_read_b64_tr_b16 v[32:33], v25 offset:32768
    ds_read_b64_tr_b16 v[34:35], v25 offset:34816
    s_waitcnt lgkmcnt(10)
    v_mfma_f32_32x32x16_bf16 v[88:103], v[40:43], v[212:215], v[88:103]
    ds_read_b64_tr_b16 v[36:37], v22 offset:32768
    ds_read_b64_tr_b16 v[38:39], v22 offset:34816
    s_waitcnt lgkmcnt(10)
    v_mfma_f32_32x32x16_bf16 v[104:119], v[44:47], v[212:215], v[104:119]
    buffer_load_dwordx4 v[156:159], v249, s[32:35], s16 offen offset:1024 sc1
    ds_read_b64_tr_b16 v[40:41], v23 offset:32768
    ds_read_b64_tr_b16 v[42:43], v23 offset:34816
    s_barrier
    s_waitcnt vmcnt(9)
    s_waitcnt lgkmcnt(10)
    v_mfma_f32_32x32x16_bf16 v[56:71], v[48:51], v[216:219], v[56:71]
    ds_read_b64_tr_b16 v[44:45], v20 offset:33792
    ds_read_b64_tr_b16 v[46:47], v20 offset:35840
    s_waitcnt lgkmcnt(10)
    v_mfma_f32_32x32x16_bf16 v[72:87], v[52:55], v[216:219], v[72:87]
    ds_read_b64_tr_b16 v[48:49], v21 offset:33792
    ds_read_b64_tr_b16 v[50:51], v21 offset:35840
    s_waitcnt lgkmcnt(10)
    v_mfma_f32_32x32x16_bf16 v[120:135], v[28:31], v[216:219], v[120:135]
    ds_read_b64_tr_b16 v[52:53], v24 offset:33792
    ds_read_b64_tr_b16 v[54:55], v24 offset:35840
    s_waitcnt lgkmcnt(10)
    v_mfma_f32_32x32x16_bf16 v[136:151], v[32:35], v[216:219], v[136:151]
    ds_read_b64_tr_b16 v[28:29], v25 offset:33792
    ds_read_b64_tr_b16 v[30:31], v25 offset:35840
    s_waitcnt lgkmcnt(10)
    v_mfma_f32_32x32x16_bf16 v[88:103], v[36:39], v[216:219], v[88:103]
    buffer_load_dwordx4 v[160:163], v249, s[32:35], s16 offen offset:2048 sc1
    ds_read_b64_tr_b16 v[32:33], v22 offset:33792
    ds_read_b64_tr_b16 v[34:35], v22 offset:35840
    s_waitcnt lgkmcnt(10)
    v_mfma_f32_32x32x16_bf16 v[104:119], v[40:43], v[216:219], v[104:119]
    ds_read_b64_tr_b16 v[36:37], v23 offset:33792
    ds_read_b64_tr_b16 v[38:39], v23 offset:35840
    s_waitcnt vmcnt(9)
    s_waitcnt lgkmcnt(10)
    v_mfma_f32_32x32x16_bf16 v[56:71], v[44:47], v[220:223], v[56:71]
    ds_read_b64_tr_b16 v[40:41], v20 offset:36864
    ds_read_b64_tr_b16 v[42:43], v20 offset:38912
    s_waitcnt lgkmcnt(10)
    v_mfma_f32_32x32x16_bf16 v[72:87], v[48:51], v[220:223], v[72:87]
    ds_read_b64_tr_b16 v[44:45], v21 offset:36864
    ds_read_b64_tr_b16 v[46:47], v21 offset:38912
    s_waitcnt lgkmcnt(10)
    v_mfma_f32_32x32x16_bf16 v[120:135], v[52:55], v[220:223], v[120:135]
    ds_read_b64_tr_b16 v[48:49], v24 offset:36864
    ds_read_b64_tr_b16 v[50:51], v24 offset:38912
    s_waitcnt lgkmcnt(10)
    v_mfma_f32_32x32x16_bf16 v[136:151], v[28:31], v[220:223], v[136:151]
    buffer_load_dwordx4 v[164:167], v249, s[32:35], s16 offen offset:3072 sc1
    ds_read_b64_tr_b16 v[52:53], v25 offset:36864
    ds_read_b64_tr_b16 v[54:55], v25 offset:38912
    s_waitcnt lgkmcnt(10)
    v_mfma_f32_32x32x16_bf16 v[88:103], v[32:35], v[220:223], v[88:103]
    s_add_u32 s16, s16, 16384
    ds_read_b64_tr_b16 v[28:29], v22 offset:36864
    ds_read_b64_tr_b16 v[30:31], v22 offset:38912
    s_waitcnt lgkmcnt(10)
    v_mfma_f32_32x32x16_bf16 v[104:119], v[36:39], v[220:223], v[104:119]
    s_and_b32 s16, s16, 0x3ffff
    ds_read_b64_tr_b16 v[32:33], v23 offset:36864
    ds_read_b64_tr_b16 v[34:35], v23 offset:38912
    s_waitcnt vmcnt(9)
    s_waitcnt lgkmcnt(10)
    v_mfma_f32_32x32x16_bf16 v[56:71], v[40:43], v[224:227], v[56:71]
    ds_read_b64_tr_b16 v[36:37], v20 offset:37888
    ds_read_b64_tr_b16 v[38:39], v20 offset:39936
    s_waitcnt lgkmcnt(10)
    v_mfma_f32_32x32x16_bf16 v[72:87], v[44:47], v[224:227], v[72:87]
    ds_read_b64_tr_b16 v[40:41], v21 offset:37888
    ds_read_b64_tr_b16 v[42:43], v21 offset:39936
    s_waitcnt lgkmcnt(10)
    v_mfma_f32_32x32x16_bf16 v[120:135], v[48:51], v[224:227], v[120:135]
    buffer_load_dwordx4 v[168:171], v249, s[32:35], s16 offen sc1
    ds_read_b64_tr_b16 v[44:45], v24 offset:37888
    ds_read_b64_tr_b16 v[46:47], v24 offset:39936
    s_waitcnt lgkmcnt(10)
    v_mfma_f32_32x32x16_bf16 v[136:151], v[52:55], v[224:227], v[136:151]
    ds_read_b64_tr_b16 v[48:49], v25 offset:37888
    ds_read_b64_tr_b16 v[50:51], v25 offset:39936
    s_waitcnt lgkmcnt(10)
    v_mfma_f32_32x32x16_bf16 v[88:103], v[28:31], v[224:227], v[88:103]
    ds_read_b64_tr_b16 v[52:53], v22 offset:37888
    ds_read_b64_tr_b16 v[54:55], v22 offset:39936
    s_waitcnt lgkmcnt(10)
    v_mfma_f32_32x32x16_bf16 v[104:119], v[32:35], v[224:227], v[104:119]
    ds_read_b64_tr_b16 v[28:29], v23 offset:37888
    ds_read_b64_tr_b16 v[30:31], v23 offset:39936
    s_waitcnt vmcnt(9)
    s_waitcnt lgkmcnt(10)
    v_mfma_f32_32x32x16_bf16 v[56:71], v[36:39], v[228:231], v[56:71]
    ds_read_b64_tr_b16 v[32:33], v20 offset:40960
    ds_read_b64_tr_b16 v[34:35], v20 offset:43008
    s_waitcnt lgkmcnt(10)
    v_mfma_f32_32x32x16_bf16 v[72:87], v[40:43], v[228:231], v[72:87]
    buffer_load_dwordx4 v[172:175], v249, s[32:35], s16 offen offset:1024 sc1
    ds_read_b64_tr_b16 v[36:37], v21 offset:40960
    ds_read_b64_tr_b16 v[38:39], v21 offset:43008
    s_waitcnt lgkmcnt(10)
    v_mfma_f32_32x32x16_bf16 v[120:135], v[44:47], v[228:231], v[120:135]
    ds_read_b64_tr_b16 v[40:41], v24 offset:40960
    ds_read_b64_tr_b16 v[42:43], v24 offset:43008
    s_waitcnt lgkmcnt(10)
    v_mfma_f32_32x32x16_bf16 v[136:151], v[48:51], v[228:231], v[136:151]
    ds_read_b64_tr_b16 v[44:45], v25 offset:40960
    ds_read_b64_tr_b16 v[46:47], v25 offset:43008
    s_waitcnt lgkmcnt(10)
    v_mfma_f32_32x32x16_bf16 v[88:103], v[52:55], v[228:231], v[88:103]
    ds_read_b64_tr_b16 v[48:49], v22 offset:40960
    ds_read_b64_tr_b16 v[50:51], v22 offset:43008
    s_waitcnt lgkmcnt(10)
    v_mfma_f32_32x32x16_bf16 v[104:119], v[28:31], v[228:231], v[104:119]
    buffer_load_dwordx4 v[176:179], v249, s[32:35], s16 offen offset:2048 sc1
    ds_read_b64_tr_b16 v[52:53], v23 offset:40960
    ds_read_b64_tr_b16 v[54:55], v23 offset:43008
    s_barrier
    s_waitcnt vmcnt(10)
    s_waitcnt lgkmcnt(10)
    v_mfma_f32_32x32x16_bf16 v[56:71], v[32:35], v[232:235], v[56:71]
    ds_read_b64_tr_b16 v[28:29], v20 offset:41984
    ds_read_b64_tr_b16 v[30:31], v20 offset:44032
    s_waitcnt lgkmcnt(10)
    v_mfma_f32_32x32x16_bf16 v[72:87], v[36:39], v[232:235], v[72:87]
    ds_read_b64_tr_b16 v[32:33], v21 offset:41984
    ds_read_b64_tr_b16 v[34:35], v21 offset:44032
    s_waitcnt lgkmcnt(10)
    v_mfma_f32_32x32x16_bf16 v[120:135], v[40:43], v[232:235], v[120:135]
    ds_read_b64_tr_b16 v[36:37], v24 offset:41984
    ds_read_b64_tr_b16 v[38:39], v24 offset:44032
    s_waitcnt lgkmcnt(10)
    v_mfma_f32_32x32x16_bf16 v[136:151], v[44:47], v[232:235], v[136:151]
    buffer_load_dwordx4 v[180:183], v249, s[32:35], s16 offen offset:3072 sc1
    ds_read_b64_tr_b16 v[40:41], v25 offset:41984
    ds_read_b64_tr_b16 v[42:43], v25 offset:44032
    s_waitcnt lgkmcnt(10)
    v_mfma_f32_32x32x16_bf16 v[88:103], v[48:51], v[232:235], v[88:103]
    s_add_u32 s16, s16, 16384
    ds_read_b64_tr_b16 v[44:45], v22 offset:41984
    ds_read_b64_tr_b16 v[46:47], v22 offset:44032
    s_waitcnt lgkmcnt(10)
    v_mfma_f32_32x32x16_bf16 v[104:119], v[52:55], v[232:235], v[104:119]
    s_and_b32 s16, s16, 0x3ffff
    ds_read_b64_tr_b16 v[48:49], v23 offset:41984
    ds_read_b64_tr_b16 v[50:51], v23 offset:44032
    s_waitcnt vmcnt(10)
    s_waitcnt lgkmcnt(10)
    v_mfma_f32_32x32x16_bf16 v[56:71], v[28:31], v[236:239], v[56:71]
    buffer_load_dwordx4 v[184:187], v249, s[32:35], s16 offen sc1
    ds_read_b64_tr_b16 v[52:53], v20 offset:45056
    ds_read_b64_tr_b16 v[54:55], v20 offset:47104
    s_waitcnt lgkmcnt(10)
    v_mfma_f32_32x32x16_bf16 v[72:87], v[32:35], v[236:239], v[72:87]
    ds_read_b64_tr_b16 v[28:29], v21 offset:45056
    ds_read_b64_tr_b16 v[30:31], v21 offset:47104
    s_waitcnt lgkmcnt(10)
    v_mfma_f32_32x32x16_bf16 v[120:135], v[36:39], v[236:239], v[120:135]
    ds_read_b64_tr_b16 v[32:33], v24 offset:45056
    ds_read_b64_tr_b16 v[34:35], v24 offset:47104
    s_waitcnt lgkmcnt(10)
    v_mfma_f32_32x32x16_bf16 v[136:151], v[40:43], v[236:239], v[136:151]
    ds_read_b64_tr_b16 v[36:37], v25 offset:45056
    ds_read_b64_tr_b16 v[38:39], v25 offset:47104
    s_waitcnt lgkmcnt(10)
    v_mfma_f32_32x32x16_bf16 v[88:103], v[44:47], v[236:239], v[88:103]
    buffer_load_dwordx4 v[188:191], v249, s[32:35], s16 offen offset:1024 sc1
    ds_read_b64_tr_b16 v[40:41], v22 offset:45056
    ds_read_b64_tr_b16 v[42:43], v22 offset:47104
    s_waitcnt lgkmcnt(10)
    v_mfma_f32_32x32x16_bf16 v[104:119], v[48:51], v[236:239], v[104:119]
    ds_read_b64_tr_b16 v[44:45], v23 offset:45056
    ds_read_b64_tr_b16 v[46:47], v23 offset:47104
    s_waitcnt vmcnt(11)
    s_waitcnt lgkmcnt(10)
    v_mfma_f32_32x32x16_bf16 v[56:71], v[52:55], v[240:243], v[56:71]
    ds_read_b64_tr_b16 v[48:49], v20 offset:46080
    ds_read_b64_tr_b16 v[50:51], v20 offset:48128
    s_waitcnt lgkmcnt(10)
    v_mfma_f32_32x32x16_bf16 v[72:87], v[28:31], v[240:243], v[72:87]
    buffer_load_dwordx4 v[192:195], v249, s[32:35], s16 offen offset:2048 sc1
    ds_read_b64_tr_b16 v[52:53], v21 offset:46080
    ds_read_b64_tr_b16 v[54:55], v21 offset:48128
    s_waitcnt lgkmcnt(10)
    v_mfma_f32_32x32x16_bf16 v[120:135], v[32:35], v[240:243], v[120:135]
    ds_read_b64_tr_b16 v[28:29], v24 offset:46080
    ds_read_b64_tr_b16 v[30:31], v24 offset:48128
    s_waitcnt lgkmcnt(10)
    v_mfma_f32_32x32x16_bf16 v[136:151], v[36:39], v[240:243], v[136:151]
    ds_read_b64_tr_b16 v[32:33], v25 offset:46080
    ds_read_b64_tr_b16 v[34:35], v25 offset:48128
    s_waitcnt lgkmcnt(10)
    v_mfma_f32_32x32x16_bf16 v[88:103], v[40:43], v[240:243], v[88:103]
    ds_read_b64_tr_b16 v[36:37], v22 offset:46080
    ds_read_b64_tr_b16 v[38:39], v22 offset:48128
    s_waitcnt lgkmcnt(10)
    v_mfma_f32_32x32x16_bf16 v[104:119], v[44:47], v[240:243], v[104:119]
    buffer_load_dwordx4 v[196:199], v249, s[32:35], s16 offen offset:3072 sc1
    ds_read_b64_tr_b16 v[40:41], v23 offset:46080
    ds_read_b64_tr_b16 v[42:43], v23 offset:48128
    s_waitcnt vmcnt(12)
    s_waitcnt lgkmcnt(10)
    v_mfma_f32_32x32x16_bf16 v[56:71], v[48:51], v[244:247], v[56:71]
    s_add_u32 s16, s16, 16384
    ds_read_b64_tr_b16 v[44:45], v20
    ds_read_b64_tr_b16 v[46:47], v20 offset:2048
    s_waitcnt lgkmcnt(10)
    v_mfma_f32_32x32x16_bf16 v[72:87], v[52:55], v[244:247], v[72:87]
    s_and_b32 s16, s16, 0x3ffff
    ds_read_b64_tr_b16 v[48:49], v21
    ds_read_b64_tr_b16 v[50:51], v21 offset:2048
    s_waitcnt lgkmcnt(10)
    v_mfma_f32_32x32x16_bf16 v[120:135], v[28:31], v[244:247], v[120:135]
    buffer_load_dwordx4 v[200:203], v249, s[32:35], s16 offen sc1
    ds_read_b64_tr_b16 v[52:53], v24
    ds_read_b64_tr_b16 v[54:55], v24 offset:2048
    s_waitcnt lgkmcnt(10)
    v_mfma_f32_32x32x16_bf16 v[136:151], v[32:35], v[244:247], v[136:151]
    ds_read_b64_tr_b16 v[28:29], v25
    ds_read_b64_tr_b16 v[30:31], v25 offset:2048
    s_waitcnt lgkmcnt(10)
    v_mfma_f32_32x32x16_bf16 v[88:103], v[36:39], v[244:247], v[88:103]
    ds_read_b64_tr_b16 v[32:33], v22
    ds_read_b64_tr_b16 v[34:35], v22 offset:2048
    s_waitcnt lgkmcnt(10)
    v_mfma_f32_32x32x16_bf16 v[104:119], v[40:43], v[244:247], v[104:119]
    buffer_load_dwordx4 v[204:207], v249, s[32:35], s16 offen offset:1024 sc1
    ds_read_b64_tr_b16 v[36:37], v23
    ds_read_b64_tr_b16 v[38:39], v23 offset:2048
    s_barrier
    s_waitcnt vmcnt(13)
    s_waitcnt lgkmcnt(10)
    v_mfma_f32_32x32x16_bf16 v[56:71], v[44:47], v[152:155], v[56:71]
    ds_read_b64_tr_b16 v[40:41], v20 offset:1024
    ds_read_b64_tr_b16 v[42:43], v20 offset:3072
    s_waitcnt lgkmcnt(10)
    v_mfma_f32_32x32x16_bf16 v[72:87], v[48:51], v[152:155], v[72:87]
    ds_read_b64_tr_b16 v[44:45], v21 offset:1024
    ds_read_b64_tr_b16 v[46:47], v21 offset:3072
    s_waitcnt lgkmcnt(10)
    v_mfma_f32_32x32x16_bf16 v[120:135], v[52:55], v[152:155], v[120:135]
    ds_read_b64_tr_b16 v[48:49], v24 offset:1024
    ds_read_b64_tr_b16 v[50:51], v24 offset:3072
    s_waitcnt lgkmcnt(10)
    v_mfma_f32_32x32x16_bf16 v[136:151], v[28:31], v[152:155], v[136:151]
    buffer_load_dwordx4 v[208:211], v249, s[32:35], s16 offen offset:2048 sc1
    ds_read_b64_tr_b16 v[52:53], v25 offset:1024
    ds_read_b64_tr_b16 v[54:55], v25 offset:3072
    s_waitcnt lgkmcnt(10)
    v_mfma_f32_32x32x16_bf16 v[88:103], v[32:35], v[152:155], v[88:103]
    ds_read_b64_tr_b16 v[28:29], v22 offset:1024
    ds_read_b64_tr_b16 v[30:31], v22 offset:3072
    s_waitcnt lgkmcnt(10)
    v_mfma_f32_32x32x16_bf16 v[104:119], v[36:39], v[152:155], v[104:119]
    ds_read_b64_tr_b16 v[32:33], v23 offset:1024
    ds_read_b64_tr_b16 v[34:35], v23 offset:3072
    s_waitcnt vmcnt(13)
    s_waitcnt lgkmcnt(10)
    v_mfma_f32_32x32x16_bf16 v[56:71], v[40:43], v[156:159], v[56:71]
    buffer_load_dwordx4 v[212:215], v249, s[32:35], s16 offen offset:3072 sc1
    ds_read_b64_tr_b16 v[36:37], v20 offset:4096
    ds_read_b64_tr_b16 v[38:39], v20 offset:6144
    s_waitcnt lgkmcnt(10)
    v_mfma_f32_32x32x16_bf16 v[72:87], v[44:47], v[156:159], v[72:87]
    s_add_u32 s16, s16, 16384
    ds_read_b64_tr_b16 v[40:41], v21 offset:4096
    ds_read_b64_tr_b16 v[42:43], v21 offset:6144
    s_waitcnt lgkmcnt(10)
    v_mfma_f32_32x32x16_bf16 v[120:135], v[48:51], v[156:159], v[120:135]
    s_and_b32 s16, s16, 0x3ffff
    ds_read_b64_tr_b16 v[44:45], v24 offset:4096
    ds_read_b64_tr_b16 v[46:47], v24 offset:6144
    s_waitcnt lgkmcnt(10)
    v_mfma_f32_32x32x16_bf16 v[136:151], v[52:55], v[156:159], v[136:151]
    ds_read_b64_tr_b16 v[48:49], v25 offset:4096
    ds_read_b64_tr_b16 v[50:51], v25 offset:6144
    s_waitcnt lgkmcnt(10)
    v_mfma_f32_32x32x16_bf16 v[88:103], v[28:31], v[156:159], v[88:103]
    buffer_load_dwordx4 v[216:219], v249, s[32:35], s16 offen sc1
    ds_read_b64_tr_b16 v[52:53], v22 offset:4096
    ds_read_b64_tr_b16 v[54:55], v22 offset:6144
    s_waitcnt lgkmcnt(10)
    v_mfma_f32_32x32x16_bf16 v[104:119], v[32:35], v[156:159], v[104:119]
    ds_read_b64_tr_b16 v[28:29], v23 offset:4096
    ds_read_b64_tr_b16 v[30:31], v23 offset:6144
    s_waitcnt vmcnt(14)
    s_waitcnt lgkmcnt(10)
    v_mfma_f32_32x32x16_bf16 v[56:71], v[36:39], v[160:163], v[56:71]
    ds_read_b64_tr_b16 v[32:33], v20 offset:5120
    ds_read_b64_tr_b16 v[34:35], v20 offset:7168
    s_waitcnt lgkmcnt(10)
    v_mfma_f32_32x32x16_bf16 v[72:87], v[40:43], v[160:163], v[72:87]
    buffer_load_dwordx4 v[220:223], v249, s[32:35], s16 offen offset:1024 sc1
    ds_read_b64_tr_b16 v[36:37], v21 offset:5120
    ds_read_b64_tr_b16 v[38:39], v21 offset:7168
    s_waitcnt lgkmcnt(10)
    v_mfma_f32_32x32x16_bf16 v[120:135], v[44:47], v[160:163], v[120:135]
    ds_read_b64_tr_b16 v[40:41], v24 offset:5120
    ds_read_b64_tr_b16 v[42:43], v24 offset:7168
    s_waitcnt lgkmcnt(10)
    v_mfma_f32_32x32x16_bf16 v[136:151], v[48:51], v[160:163], v[136:151]
    ds_read_b64_tr_b16 v[44:45], v25 offset:5120
    ds_read_b64_tr_b16 v[46:47], v25 offset:7168
    s_waitcnt lgkmcnt(10)
    v_mfma_f32_32x32x16_bf16 v[88:103], v[52:55], v[160:163], v[88:103]
    ds_read_b64_tr_b16 v[48:49], v22 offset:5120
    ds_read_b64_tr_b16 v[50:51], v22 offset:7168
    s_waitcnt lgkmcnt(10)
    v_mfma_f32_32x32x16_bf16 v[104:119], v[28:31], v[160:163], v[104:119]
    buffer_load_dwordx4 v[224:227], v249, s[32:35], s16 offen offset:2048 sc1
    ds_read_b64_tr_b16 v[52:53], v23 offset:5120
    ds_read_b64_tr_b16 v[54:55], v23 offset:7168
    s_waitcnt vmcnt(15)
    s_waitcnt lgkmcnt(10)
    v_mfma_f32_32x32x16_bf16 v[56:71], v[32:35], v[164:167], v[56:71]
    ds_read_b64_tr_b16 v[28:29], v20 offset:8192
    ds_read_b64_tr_b16 v[30:31], v20 offset:10240
    s_waitcnt lgkmcnt(10)
    v_mfma_f32_32x32x16_bf16 v[72:87], v[36:39], v[164:167], v[72:87]
    ds_read_b64_tr_b16 v[32:33], v21 offset:8192
    ds_read_b64_tr_b16 v[34:35], v21 offset:10240
    s_waitcnt lgkmcnt(10)
    v_mfma_f32_32x32x16_bf16 v[120:135], v[40:43], v[164:167], v[120:135]
    buffer_load_dwordx4 v[228:231], v249, s[32:35], s16 offen offset:3072 sc1
    ds_read_b64_tr_b16 v[36:37], v24 offset:8192
    ds_read_b64_tr_b16 v[38:39], v24 offset:10240
    s_waitcnt lgkmcnt(10)
    v_mfma_f32_32x32x16_bf16 v[136:151], v[44:47], v[164:167], v[136:151]
    s_add_u32 s16, s16, 16384
    ds_read_b64_tr_b16 v[40:41], v25 offset:8192
    ds_read_b64_tr_b16 v[42:43], v25 offset:10240
    s_waitcnt lgkmcnt(10)
    v_mfma_f32_32x32x16_bf16 v[88:103], v[48:51], v[164:167], v[88:103]
    s_and_b32 s16, s16, 0x3ffff
    ds_read_b64_tr_b16 v[44:45], v22 offset:8192
    ds_read_b64_tr_b16 v[46:47], v22 offset:10240
    s_waitcnt lgkmcnt(10)
    v_mfma_f32_32x32x16_bf16 v[104:119], v[52:55], v[164:167], v[104:119]
    buffer_load_dwordx4 v[232:235], v249, s[32:35], s16 offen sc1
    ds_read_b64_tr_b16 v[48:49], v23 offset:8192
    ds_read_b64_tr_b16 v[50:51], v23 offset:10240
    s_barrier
    s_waitcnt vmcnt(16)
    s_waitcnt lgkmcnt(10)
    v_mfma_f32_32x32x16_bf16 v[56:71], v[28:31], v[168:171], v[56:71]
    ds_read_b64_tr_b16 v[52:53], v20 offset:9216
    ds_read_b64_tr_b16 v[54:55], v20 offset:11264
    s_waitcnt lgkmcnt(10)
    v_mfma_f32_32x32x16_bf16 v[72:87], v[32:35], v[168:171], v[72:87]
    ds_read_b64_tr_b16 v[28:29], v21 offset:9216
    ds_read_b64_tr_b16 v[30:31], v21 offset:11264
    s_waitcnt lgkmcnt(10)
    v_mfma_f32_32x32x16_bf16 v[120:135], v[36:39], v[168:171], v[120:135]
    ds_read_b64_tr_b16 v[32:33], v24 offset:9216
    ds_read_b64_tr_b16 v[34:35], v24 offset:11264
    s_waitcnt lgkmcnt(10)
    v_mfma_f32_32x32x16_bf16 v[136:151], v[40:43], v[168:171], v[136:151]
    buffer_load_dwordx4 v[236:239], v249, s[32:35], s16 offen offset:1024 sc1
    ds_read_b64_tr_b16 v[36:37], v25 offset:9216
    ds_read_b64_tr_b16 v[38:39], v25 offset:11264
    s_waitcnt lgkmcnt(10)
    v_mfma_f32_32x32x16_bf16 v[88:103], v[44:47], v[168:171], v[88:103]
    ds_read_b64_tr_b16 v[40:41], v22 offset:9216
    ds_read_b64_tr_b16 v[42:43], v22 offset:11264
    s_waitcnt lgkmcnt(10)
    v_mfma_f32_32x32x16_bf16 v[104:119], v[48:51], v[168:171], v[104:119]
    ds_read_b64_tr_b16 v[44:45], v23 offset:9216
    ds_read_b64_tr_b16 v[46:47], v23 offset:11264
    s_waitcnt vmcnt(16)
    s_waitcnt lgkmcnt(10)
    v_mfma_f32_32x32x16_bf16 v[56:71], v[52:55], v[172:175], v[56:71]
    buffer_load_dwordx4 v[240:243], v249, s[32:35], s16 offen offset:2048 sc1
    ds_read_b64_tr_b16 v[48:49], v20 offset:12288
    ds_read_b64_tr_b16 v[50:51], v20 offset:14336
    s_waitcnt lgkmcnt(10)
    v_mfma_f32_32x32x16_bf16 v[72:87], v[28:31], v[172:175], v[72:87]
    ds_read_b64_tr_b16 v[52:53], v21 offset:12288
    ds_read_b64_tr_b16 v[54:55], v21 offset:14336
    s_waitcnt lgkmcnt(10)
    v_mfma_f32_32x32x16_bf16 v[120:135], v[32:35], v[172:175], v[120:135]
    ds_read_b64_tr_b16 v[28:29], v24 offset:12288
    ds_read_b64_tr_b16 v[30:31], v24 offset:14336
    s_waitcnt lgkmcnt(10)
    v_mfma_f32_32x32x16_bf16 v[136:151], v[36:39], v[172:175], v[136:151]
    ds_read_b64_tr_b16 v[32:33], v25 offset:12288
    ds_read_b64_tr_b16 v[34:35], v25 offset:14336
    s_waitcnt lgkmcnt(10)
    v_mfma_f32_32x32x16_bf16 v[88:103], v[40:43], v[172:175], v[88:103]
    buffer_load_dwordx4 v[244:247], v249, s[32:35], s16 offen offset:3072 sc1
    ds_read_b64_tr_b16 v[36:37], v22 offset:12288
    ds_read_b64_tr_b16 v[38:39], v22 offset:14336
    s_waitcnt lgkmcnt(10)
    v_mfma_f32_32x32x16_bf16 v[104:119], v[44:47], v[172:175], v[104:119]
    s_add_u32 s16, s16, 16384
    ds_read_b64_tr_b16 v[40:41], v23 offset:12288
    ds_read_b64_tr_b16 v[42:43], v23 offset:14336
    s_waitcnt vmcnt(17)
    s_waitcnt lgkmcnt(10)
    v_mfma_f32_32x32x16_bf16 v[56:71], v[48:51], v[176:179], v[56:71]
    s_and_b32 s16, s16, 0x3ffff
    ds_read_b64_tr_b16 v[44:45], v20 offset:13312
    ds_read_b64_tr_b16 v[46:47], v20 offset:15360
    s_waitcnt lgkmcnt(10)
    v_mfma_f32_32x32x16_bf16 v[72:87], v[52:55], v[176:179], v[72:87]
    buffer_load_dwordx4 v[152:155], v249, s[32:35], s16 offen sc1
    ds_read_b64_tr_b16 v[48:49], v21 offset:13312
    ds_read_b64_tr_b16 v[50:51], v21 offset:15360
    s_waitcnt lgkmcnt(10)
    v_mfma_f32_32x32x16_bf16 v[120:135], v[28:31], v[176:179], v[120:135]
    ds_read_b64_tr_b16 v[52:53], v24 offset:13312
    ds_read_b64_tr_b16 v[54:55], v24 offset:15360
    s_waitcnt lgkmcnt(10)
    v_mfma_f32_32x32x16_bf16 v[136:151], v[32:35], v[176:179], v[136:151]
    ds_read_b64_tr_b16 v[28:29], v25 offset:13312
    ds_read_b64_tr_b16 v[30:31], v25 offset:15360
    s_waitcnt lgkmcnt(10)
    v_mfma_f32_32x32x16_bf16 v[88:103], v[36:39], v[176:179], v[88:103]
    ds_read_b64_tr_b16 v[32:33], v22 offset:13312
    ds_read_b64_tr_b16 v[34:35], v22 offset:15360
    s_waitcnt lgkmcnt(10)
    v_mfma_f32_32x32x16_bf16 v[104:119], v[40:43], v[176:179], v[104:119]
    buffer_load_dwordx4 v[156:159], v249, s[32:35], s16 offen offset:1024 sc1
    ds_read_b64_tr_b16 v[36:37], v23 offset:13312
    ds_read_b64_tr_b16 v[38:39], v23 offset:15360
    s_waitcnt vmcnt(18)
    s_waitcnt lgkmcnt(10)
    v_mfma_f32_32x32x16_bf16 v[56:71], v[44:47], v[180:183], v[56:71]
    ds_read_b64_tr_b16 v[40:41], v20 offset:16384
    ds_read_b64_tr_b16 v[42:43], v20 offset:18432
    s_waitcnt lgkmcnt(10)
    v_mfma_f32_32x32x16_bf16 v[72:87], v[48:51], v[180:183], v[72:87]
    ds_read_b64_tr_b16 v[44:45], v21 offset:16384
    ds_read_b64_tr_b16 v[46:47], v21 offset:18432
    s_waitcnt lgkmcnt(10)
    v_mfma_f32_32x32x16_bf16 v[120:135], v[52:55], v[180:183], v[120:135]
    buffer_load_dwordx4 v[160:163], v249, s[32:35], s16 offen offset:2048 sc1
    ds_read_b64_tr_b16 v[48:49], v24 offset:16384
    ds_read_b64_tr_b16 v[50:51], v24 offset:18432
    s_waitcnt lgkmcnt(10)
    v_mfma_f32_32x32x16_bf16 v[136:151], v[28:31], v[180:183], v[136:151]
    ds_read_b64_tr_b16 v[52:53], v25 offset:16384
    ds_read_b64_tr_b16 v[54:55], v25 offset:18432
    s_waitcnt lgkmcnt(10)
    v_mfma_f32_32x32x16_bf16 v[88:103], v[32:35], v[180:183], v[88:103]
    ds_read_b64_tr_b16 v[28:29], v22 offset:16384
    ds_read_b64_tr_b16 v[30:31], v22 offset:18432
    s_waitcnt lgkmcnt(10)
    v_mfma_f32_32x32x16_bf16 v[104:119], v[36:39], v[180:183], v[104:119]
    buffer_load_dwordx4 v[164:167], v249, s[32:35], s16 offen offset:3072 sc1
    ds_read_b64_tr_b16 v[32:33], v23 offset:16384
    ds_read_b64_tr_b16 v[34:35], v23 offset:18432
    s_barrier
    s_waitcnt vmcnt(19)
    s_waitcnt lgkmcnt(10)
    v_mfma_f32_32x32x16_bf16 v[56:71], v[40:43], v[184:187], v[56:71]
    s_add_u32 s16, s16, 16384
    ds_read_b64_tr_b16 v[36:37], v20 offset:17408
    ds_read_b64_tr_b16 v[38:39], v20 offset:19456
    s_waitcnt lgkmcnt(10)
    v_mfma_f32_32x32x16_bf16 v[72:87], v[44:47], v[184:187], v[72:87]
    s_and_b32 s16, s16, 0x3ffff
    ds_read_b64_tr_b16 v[40:41], v21 offset:17408
    ds_read_b64_tr_b16 v[42:43], v21 offset:19456
    s_waitcnt lgkmcnt(10)
    v_mfma_f32_32x32x16_bf16 v[120:135], v[48:51], v[184:187], v[120:135]
    ds_read_b64_tr_b16 v[44:45], v24 offset:17408
    ds_read_b64_tr_b16 v[46:47], v24 offset:19456
    s_waitcnt lgkmcnt(10)
    v_mfma_f32_32x32x16_bf16 v[136:151], v[52:55], v[184:187], v[136:151]
    buffer_load_dwordx4 v[168:171], v249, s[32:35], s16 offen sc1
    ds_read_b64_tr_b16 v[48:49], v25 offset:17408
    ds_read_b64_tr_b16 v[50:51], v25 offset:19456
    s_waitcnt lgkmcnt(10)
    v_mfma_f32_32x32x16_bf16 v[88:103], v[28:31], v[184:187], v[88:103]
    ds_read_b64_tr_b16 v[52:53], v22 offset:17408
    ds_read_b64_tr_b16 v[54:55], v22 offset:19456
    s_waitcnt lgkmcnt(10)
    v_mfma_f32_32x32x16_bf16 v[104:119], v[32:35], v[184:187], v[104:119]
    ds_read_b64_tr_b16 v[28:29], v23 offset:17408
    ds_read_b64_tr_b16 v[30:31], v23 offset:19456
    s_waitcnt vmcnt(19)
    s_waitcnt lgkmcnt(10)
    v_mfma_f32_32x32x16_bf16 v[56:71], v[36:39], v[188:191], v[56:71]
    ds_read_b64_tr_b16 v[32:33], v20 offset:20480
    ds_read_b64_tr_b16 v[34:35], v20 offset:22528
    s_waitcnt lgkmcnt(10)
    v_mfma_f32_32x32x16_bf16 v[72:87], v[40:43], v[188:191], v[72:87]
    buffer_load_dwordx4 v[172:175], v249, s[32:35], s16 offen offset:1024 sc1
    ds_read_b64_tr_b16 v[36:37], v21 offset:20480
    ds_read_b64_tr_b16 v[38:39], v21 offset:22528
    s_waitcnt lgkmcnt(10)
    v_mfma_f32_32x32x16_bf16 v[120:135], v[44:47], v[188:191], v[120:135]
    ds_read_b64_tr_b16 v[40:41], v24 offset:20480
    ds_read_b64_tr_b16 v[42:43], v24 offset:22528
    s_waitcnt lgkmcnt(10)
    v_mfma_f32_32x32x16_bf16 v[136:151], v[48:51], v[188:191], v[136:151]
    ds_read_b64_tr_b16 v[44:45], v25 offset:20480
    ds_read_b64_tr_b16 v[46:47], v25 offset:22528
    s_waitcnt lgkmcnt(10)
    v_mfma_f32_32x32x16_bf16 v[88:103], v[52:55], v[188:191], v[88:103]
    ds_read_b64_tr_b16 v[48:49], v22 offset:20480
    ds_read_b64_tr_b16 v[50:51], v22 offset:22528
    s_waitcnt lgkmcnt(10)
    v_mfma_f32_32x32x16_bf16 v[104:119], v[28:31], v[188:191], v[104:119]
    buffer_load_dwordx4 v[176:179], v249, s[32:35], s16 offen offset:2048 sc1
    ds_read_b64_tr_b16 v[52:53], v23 offset:20480
    ds_read_b64_tr_b16 v[54:55], v23 offset:22528
    s_waitcnt vmcnt(20)
    s_waitcnt lgkmcnt(10)
    v_mfma_f32_32x32x16_bf16 v[56:71], v[32:35], v[192:195], v[56:71]
    ds_read_b64_tr_b16 v[28:29], v20 offset:21504
    ds_read_b64_tr_b16 v[30:31], v20 offset:23552
    s_waitcnt lgkmcnt(10)
    v_mfma_f32_32x32x16_bf16 v[72:87], v[36:39], v[192:195], v[72:87]
    ds_read_b64_tr_b16 v[32:33], v21 offset:21504
    ds_read_b64_tr_b16 v[34:35], v21 offset:23552
    s_waitcnt lgkmcnt(10)
    v_mfma_f32_32x32x16_bf16 v[120:135], v[40:43], v[192:195], v[120:135]
    ds_read_b64_tr_b16 v[36:37], v24 offset:21504
    ds_read_b64_tr_b16 v[38:39], v24 offset:23552
    s_waitcnt lgkmcnt(10)
    v_mfma_f32_32x32x16_bf16 v[136:151], v[44:47], v[192:195], v[136:151]
    buffer_load_dwordx4 v[180:183], v249, s[32:35], s16 offen offset:3072 sc1
    ds_read_b64_tr_b16 v[40:41], v25 offset:21504
    ds_read_b64_tr_b16 v[42:43], v25 offset:23552
    s_waitcnt lgkmcnt(10)
    v_mfma_f32_32x32x16_bf16 v[88:103], v[48:51], v[192:195], v[88:103]
    s_add_u32 s16, s16, 16384
    ds_read_b64_tr_b16 v[44:45], v22 offset:21504
    ds_read_b64_tr_b16 v[46:47], v22 offset:23552
    s_waitcnt lgkmcnt(10)
    v_mfma_f32_32x32x16_bf16 v[104:119], v[52:55], v[192:195], v[104:119]
    s_and_b32 s16, s16, 0x3ffff
    ds_read_b64_tr_b16 v[48:49], v23 offset:21504
    ds_read_b64_tr_b16 v[50:51], v23 offset:23552
    s_waitcnt vmcnt(20)
    s_waitcnt lgkmcnt(10)
    v_mfma_f32_32x32x16_bf16 v[56:71], v[28:31], v[196:199], v[56:71]
    ds_read_b64_tr_b16 v[52:53], v20 offset:24576
L_PAD3:
    s_cbranch_execz L_RET3
    ds_read_b64_tr_b16 v[54:55], v20 offset:26624
    s_waitcnt lgkmcnt(10)
    v_mfma_f32_32x32x16_bf16 v[72:87], v[32:35], v[196:199], v[72:87]
    buffer_load_dwordx4 v[184:187], v249, s[32:35], s16 offen sc1
    ds_read_b64_tr_b16 v[28:29], v21 offset:24576
    ds_read_b64_tr_b16 v[30:31], v21 offset:26624
    s_waitcnt lgkmcnt(10)
    v_mfma_f32_32x32x16_bf16 v[120:135], v[36:39], v[196:199], v[120:135]
    ds_read_b64_tr_b16 v[32:33], v20 offset:25600
    ds_read_b64_tr_b16 v[34:35], v20 offset:27648
    s_waitcnt lgkmcnt(10)
    v_mfma_f32_32x32x16_bf16 v[136:151], v[40:43], v[196:199], v[136:151]
    ds_read_b64_tr_b16 v[36:37], v21 offset:25600
    ds_read_b64_tr_b16 v[38:39], v21 offset:27648
    s_waitcnt lgkmcnt(10)
    v_mfma_f32_32x32x16_bf16 v[88:103], v[44:47], v[196:199], v[88:103]
    ds_read_b64_tr_b16 v[40:41], v20 offset:28672
    ds_read_b64_tr_b16 v[42:43], v20 offset:30720
    s_waitcnt lgkmcnt(10)
    v_mfma_f32_32x32x16_bf16 v[104:119], v[48:51], v[196:199], v[104:119]
    buffer_load_dwordx4 v[188:191], v249, s[32:35], s16 offen offset:1024 sc1
    ds_read_b64_tr_b16 v[44:45], v21 offset:28672
    ds_read_b64_tr_b16 v[46:47], v21 offset:30720
    s_barrier
    s_waitcnt vmcnt(21)
    s_waitcnt lgkmcnt(10)
    v_mfma_f32_32x32x16_bf16 v[56:71], v[52:55], v[200:203], v[56:71]
    ds_read_b64_tr_b16 v[48:49], v20 offset:29696
    ds_read_b64_tr_b16 v[50:51], v20 offset:31744
    s_waitcnt lgkmcnt(10)
    v_mfma_f32_32x32x16_bf16 v[72:87], v[28:31], v[200:203], v[72:87]
    ds_read_b64_tr_b16 v[52:53], v21 offset:29696
    ds_read_b64_tr_b16 v[54:55], v21 offset:31744
    s_waitcnt vmcnt(20)
    s_waitcnt lgkmcnt(10)
    v_mfma_f32_32x32x16_bf16 v[56:71], v[32:35], v[204:207], v[56:71]
    ds_read_b64_tr_b16 v[28:29], v24 offset:24576
    ds_read_b64_tr_b16 v[30:31], v24 offset:26624
    s_waitcnt lgkmcnt(10)
    v_mfma_f32_32x32x16_bf16 v[72:87], v[36:39], v[204:207], v[72:87]
    buffer_load_dwordx4 v[192:195], v249, s[32:35], s16 offen offset:2048 sc1
    ds_read_b64_tr_b16 v[32:33], v25 offset:24576
    ds_read_b64_tr_b16 v[34:35], v25 offset:26624
    s_waitcnt vmcnt(20)
    s_waitcnt lgkmcnt(10)
    v_mfma_f32_32x32x16_bf16 v[56:71], v[40:43], v[208:211], v[56:71]
    ds_read_b64_tr_b16 v[36:37], v22 offset:24576
    ds_read_b64_tr_b16 v[38:39], v22 offset:26624
    s_waitcnt lgkmcnt(10)
    v_mfma_f32_32x32x16_bf16 v[72:87], v[44:47], v[208:211], v[72:87]
    ds_read_b64_tr_b16 v[40:41], v23 offset:24576
    ds_read_b64_tr_b16 v[42:43], v23 offset:26624
    s_waitcnt vmcnt(19)
    s_waitcnt lgkmcnt(10)
    v_mfma_f32_32x32x16_bf16 v[56:71], v[48:51], v[212:215], v[56:71]
    ds_read_b64_tr_b16 v[44:45], v24 offset:25600
    ds_read_b64_tr_b16 v[46:47], v24 offset:27648
    s_waitcnt lgkmcnt(10)
    v_mfma_f32_32x32x16_bf16 v[72:87], v[52:55], v[212:215], v[72:87]
    buffer_load_dwordx4 v[196:199], v249, s[32:35], s16 offen offset:3072 sc1
    ds_read_b64_tr_b16 v[48:49], v25 offset:25600
    ds_read_b64_tr_b16 v[50:51], v25 offset:27648
    s_barrier
    s_waitcnt lgkmcnt(10)
    v_mfma_f32_32x32x16_bf16 v[120:135], v[28:31], v[200:203], v[120:135]
    s_add_u32 s16, s16, 16384
    ds_read_b64_tr_b16 v[52:53], v22 offset:25600
    ds_read_b64_tr_b16 v[54:55], v22 offset:27648
    s_waitcnt lgkmcnt(10)
    v_mfma_f32_32x32x16_bf16 v[136:151], v[32:35], v[200:203], v[136:151]
    s_and_b32 s16, s16, 0x3ffff
    ds_read_b64_tr_b16 v[28:29], v23 offset:25600
    ds_read_b64_tr_b16 v[30:31], v23 offset:27648
    s_waitcnt lgkmcnt(10)
    v_mfma_f32_32x32x16_bf16 v[88:103], v[36:39], v[200:203], v[88:103]
    ds_read_b64_tr_b16 v[32:33], v24 offset:28672
    ds_read_b64_tr_b16 v[34:35], v24 offset:30720
    s_waitcnt lgkmcnt(10)
    v_mfma_f32_32x32x16_bf16 v[104:119], v[40:43], v[200:203], v[104:119]
    buffer_load_dwordx4 v[200:203], v249, s[32:35], s16 offen sc1
    ds_read_b64_tr_b16 v[36:37], v25 offset:28672
    ds_read_b64_tr_b16 v[38:39], v25 offset:30720
    s_waitcnt lgkmcnt(10)
    v_mfma_f32_32x32x16_bf16 v[120:135], v[44:47], v[204:207], v[120:135]
    ds_read_b64_tr_b16 v[40:41], v22 offset:28672
    ds_read_b64_tr_b16 v[42:43], v22 offset:30720
    s_waitcnt lgkmcnt(10)
    v_mfma_f32_32x32x16_bf16 v[136:151], v[48:51], v[204:207], v[136:151]
    ds_read_b64_tr_b16 v[44:45], v23 offset:28672
    ds_read_b64_tr_b16 v[46:47], v23 offset:30720
    s_waitcnt lgkmcnt(10)
    v_mfma_f32_32x32x16_bf16 v[88:103], v[52:55], v[204:207], v[88:103]
    ds_read_b64_tr_b16 v[48:49], v24 offset:29696
    ds_read_b64_tr_b16 v[50:51], v24 offset:31744
    s_waitcnt lgkmcnt(10)
    v_mfma_f32_32x32x16_bf16 v[104:119], v[28:31], v[204:207], v[104:119]
    buffer_load_dwordx4 v[204:207], v249, s[32:35], s16 offen offset:1024 sc1
    ds_read_b64_tr_b16 v[52:53], v25 offset:29696
    ds_read_b64_tr_b16 v[54:55], v25 offset:31744
    s_waitcnt lgkmcnt(10)
    v_mfma_f32_32x32x16_bf16 v[120:135], v[32:35], v[208:211], v[120:135]
    ds_read_b64_tr_b16 v[28:29], v22 offset:29696
    ds_read_b64_tr_b16 v[30:31], v22 offset:31744
    s_waitcnt lgkmcnt(10)
    v_mfma_f32_32x32x16_bf16 v[136:151], v[36:39], v[208:211], v[136:151]
    ds_read_b64_tr_b16 v[32:33], v23 offset:29696
    ds_read_b64_tr_b16 v[34:35], v23 offset:31744
    s_waitcnt lgkmcnt(10)
    v_mfma_f32_32x32x16_bf16 v[88:103], v[40:43], v[208:211], v[88:103]
    ds_read_b64_tr_b16 v[36:37], v20 offset:32768
    ds_read_b64_tr_b16 v[38:39], v20 offset:34816
    s_waitcnt lgkmcnt(10)
    v_mfma_f32_32x32x16_bf16 v[104:119], v[44:47], v[208:211], v[104:119]
    buffer_load_dwordx4 v[208:211], v249, s[32:35], s16 offen offset:2048 sc1
    ds_read_b64_tr_b16 v[40:41], v20 offset:33792
    ds_read_b64_tr_b16 v[42:43], v20 offset:35840
    s_waitcnt lgkmcnt(10)
    v_mfma_f32_32x32x16_bf16 v[120:135], v[48:51], v[212:215], v[120:135]
    ds_read_b64_tr_b16 v[44:45], v20 offset:36864
    ds_read_b64_tr_b16 v[46:47], v20 offset:38912
    s_waitcnt lgkmcnt(10)
    v_mfma_f32_32x32x16_bf16 v[136:151], v[52:55], v[212:215], v[136:151]
    ds_read_b64_tr_b16 v[48:49], v20 offset:37888
    ds_read_b64_tr_b16 v[50:51], v20 offset:39936
    s_waitcnt lgkmcnt(10)
    v_mfma_f32_32x32x16_bf16 v[88:103], v[28:31], v[212:215], v[88:103]
    ds_read_b64_tr_b16 v[52:53], v20 offset:40960
    ds_read_b64_tr_b16 v[54:55], v20 offset:43008
    s_waitcnt lgkmcnt(10)
    v_mfma_f32_32x32x16_bf16 v[104:119], v[32:35], v[212:215], v[104:119]
    buffer_load_dwordx4 v[212:215], v249, s[32:35], s16 offen offset:3072 sc1
    ds_read_b64_tr_b16 v[28:29], v20 offset:41984
    ds_read_b64_tr_b16 v[30:31], v20 offset:44032
    s_barrier
    s_waitcnt vmcnt(23)
    s_waitcnt lgkmcnt(10)
    v_mfma_f32_32x32x16_bf16 v[56:71], v[36:39], v[216:219], v[56:71]
    s_add_u32 s16, s16, 16384
    ds_read_b64_tr_b16 v[32:33], v20 offset:45056
    ds_read_b64_tr_b16 v[34:35], v20 offset:47104
    s_waitcnt vmcnt(22)
    s_waitcnt lgkmcnt(10)
    v_mfma_f32_32x32x16_bf16 v[56:71], v[40:43], v[220:223], v[56:71]
    s_and_b32 s16, s16, 0x3ffff
    ds_read_b64_tr_b16 v[36:37], v20 offset:46080
    ds_read_b64_tr_b16 v[38:39], v20 offset:48128
    s_waitcnt vmcnt(21)
    s_waitcnt lgkmcnt(10)
    v_mfma_f32_32x32x16_bf16 v[56:71], v[44:47], v[224:227], v[56:71]
    ds_read_b64_tr_b16 v[40:41], v20
    ds_read_b64_tr_b16 v[42:43], v20 offset:2048
    s_waitcnt vmcnt(20)
    s_waitcnt lgkmcnt(10)
    v_mfma_f32_32x32x16_bf16 v[56:71], v[48:51], v[228:231], v[56:71]
    ds_read_b64_tr_b16 v[44:45], v20 offset:1024
    ds_read_b64_tr_b16 v[46:47], v20 offset:3072
    s_waitcnt vmcnt(19)
    s_waitcnt lgkmcnt(10)
    v_mfma_f32_32x32x16_bf16 v[56:71], v[52:55], v[232:235], v[56:71]
    ds_read_b64_tr_b16 v[48:49], v20 offset:4096
    ds_read_b64_tr_b16 v[50:51], v20 offset:6144
    s_waitcnt vmcnt(18)
    s_waitcnt lgkmcnt(10)
    v_mfma_f32_32x32x16_bf16 v[56:71], v[28:31], v[236:239], v[56:71]
    ds_read_b64_tr_b16 v[52:53], v20 offset:5120
    ds_read_b64_tr_b16 v[54:55], v20 offset:7168
    s_waitcnt vmcnt(17)
    s_waitcnt lgkmcnt(10)
    v_mfma_f32_32x32x16_bf16 v[56:71], v[32:35], v[240:243], v[56:71]
    ds_read_b64_tr_b16 v[28:29], v20 offset:8192
    ds_read_b64_tr_b16 v[30:31], v20 offset:10240
    s_waitcnt vmcnt(16)
    s_waitcnt lgkmcnt(10)
    v_mfma_f32_32x32x16_bf16 v[56:71], v[36:39], v[244:247], v[56:71]
    ds_read_b64_tr_b16 v[32:33], v20 offset:9216
    ds_read_b64_tr_b16 v[34:35], v20 offset:11264
    s_waitcnt vmcnt(15)
    s_waitcnt lgkmcnt(10)
    v_mfma_f32_32x32x16_bf16 v[56:71], v[40:43], v[152:155], v[56:71]
    ds_read_b64_tr_b16 v[36:37], v20 offset:12288
    ds_read_b64_tr_b16 v[38:39], v20 offset:14336
    s_waitcnt vmcnt(14)
    s_waitcnt lgkmcnt(10)
    v_mfma_f32_32x32x16_bf16 v[56:71], v[44:47], v[156:159], v[56:71]
    ds_read_b64_tr_b16 v[40:41], v20 offset:13312
    ds_read_b64_tr_b16 v[42:43], v20 offset:15360
    s_waitcnt vmcnt(13)
    s_waitcnt lgkmcnt(10)
    v_mfma_f32_32x32x16_bf16 v[56:71], v[48:51], v[160:163], v[56:71]
    ds_read_b64_tr_b16 v[44:45], v20 offset:16384
    ds_read_b64_tr_b16 v[46:47], v20 offset:18432
    s_waitcnt vmcnt(12)
    s_waitcnt lgkmcnt(10)
    v_mfma_f32_32x32x16_bf16 v[56:71], v[52:55], v[164:167], v[56:71]
    ds_read_b64_tr_b16 v[48:49], v20 offset:17408
    ds_read_b64_tr_b16 v[50:51], v20 offset:19456
    s_waitcnt vmcnt(11)
    s_waitcnt lgkmcnt(10)
    v_mfma_f32_32x32x16_bf16 v[56:71], v[28:31], v[168:171], v[56:71]
    ds_read_b64_tr_b16 v[52:53], v20 offset:20480
    ds_read_b64_tr_b16 v[54:55], v20 offset:22528
    s_waitcnt vmcnt(10)
    s_waitcnt lgkmcnt(10)
    v_mfma_f32_32x32x16_bf16 v[56:71], v[32:35], v[172:175], v[56:71]
    ds_read_b64_tr_b16 v[28:29], v20 offset:21504
    ds_read_b64_tr_b16 v[30:31], v20 offset:23552
    s_barrier
    s_waitcnt vmcnt(9)
    s_waitcnt lgkmcnt(10)
    v_mfma_f32_32x32x16_bf16 v[56:71], v[36:39], v[176:179], v[56:71]
    ds_read_b64_tr_b16 v[32:33], v20 offset:24576
    ds_read_b64_tr_b16 v[34:35], v20 offset:26624
    s_waitcnt vmcnt(8)
    s_waitcnt lgkmcnt(10)
    v_mfma_f32_32x32x16_bf16 v[56:71], v[40:43], v[180:183], v[56:71]
    ds_read_b64_tr_b16 v[36:37], v20 offset:25600
    ds_read_b64_tr_b16 v[38:39], v20 offset:27648
    s_waitcnt vmcnt(7)
    s_waitcnt lgkmcnt(10)
    v_mfma_f32_32x32x16_bf16 v[56:71], v[44:47], v[184:187], v[56:71]
    ds_read_b64_tr_b16 v[40:41], v20 offset:28672
    ds_read_b64_tr_b16 v[42:43], v20 offset:30720
    s_waitcnt vmcnt(6)
    s_waitcnt lgkmcnt(10)
    v_mfma_f32_32x32x16_bf16 v[56:71], v[48:51], v[188:191], v[56:71]
    ds_read_b64_tr_b16 v[44:45], v20 offset:29696
    ds_read_b64_tr_b16 v[46:47], v20 offset:31744
    s_waitcnt vmcnt(5)
    s_waitcnt lgkmcnt(10)
    v_mfma_f32_32x32x16_bf16 v[56:71], v[52:55], v[192:195], v[56:71]
    ds_read_b64_tr_b16 v[48:49], v21 offset:32768
    ds_read_b64_tr_b16 v[50:51], v21 offset:34816
    s_waitcnt vmcnt(4)
    s_waitcnt lgkmcnt(10)
    v_mfma_f32_32x32x16_bf16 v[56:71], v[28:31], v[196:199], v[56:71]
    ds_read_b64_tr_b16 v[52:53], v21 offset:33792
    ds_read_b64_tr_b16 v[54:55], v21 offset:35840
    s_waitcnt vmcnt(3)
    s_waitcnt lgkmcnt(10)
    v_mfma_f32_32x32x16_bf16 v[56:71], v[32:35], v[200:203], v[56:71]
    ds_read_b64_tr_b16 v[28:29], v21 offset:36864
    ds_read_b64_tr_b16 v[30:31], v21 offset:38912
    s_waitcnt vmcnt(2)
    s_waitcnt lgkmcnt(10)
    v_mfma_f32_32x32x16_bf16 v[56:71], v[36:39], v[204:207], v[56:71]
    ds_read_b64_tr_b16 v[32:33], v21 offset:37888
    ds_read_b64_tr_b16 v[34:35], v21 offset:39936
    s_waitcnt vmcnt(1)
    s_waitcnt lgkmcnt(10)
    v_mfma_f32_32x32x16_bf16 v[56:71], v[40:43], v[208:211], v[56:71]
    ds_read_b64_tr_b16 v[36:37], v21 offset:40960
    ds_read_b64_tr_b16 v[38:39], v21 offset:43008
    s_waitcnt vmcnt(0)
    s_waitcnt lgkmcnt(10)
    v_mfma_f32_32x32x16_bf16 v[56:71], v[44:47], v[212:215], v[56:71]
    ds_read_b64_tr_b16 v[40:41], v21 offset:41984
    ds_read_b64_tr_b16 v[42:43], v21 offset:44032
    s_waitcnt lgkmcnt(10)
    v_mfma_f32_32x32x16_bf16 v[72:87], v[48:51], v[216:219], v[72:87]
    ds_read_b64_tr_b16 v[44:45], v21 offset:45056
    ds_read_b64_tr_b16 v[46:47], v21 offset:47104
    s_waitcnt lgkmcnt(10)
    v_mfma_f32_32x32x16_bf16 v[72:87], v[52:55], v[220:223], v[72:87]
    s_nop 3
    v_cvt_pk_bf16_f32 v56, v56, v57
    v_cvt_pk_bf16_f32 v57, v58, v59
    ds_read_b64_tr_b16 v[48:49], v21 offset:46080
    ds_read_b64_tr_b16 v[50:51], v21 offset:48128
    s_waitcnt lgkmcnt(10)
    v_mfma_f32_32x32x16_bf16 v[72:87], v[28:31], v[224:227], v[72:87]
    v_cvt_pk_bf16_f32 v58, v60, v61
    v_cvt_pk_bf16_f32 v59, v62, v63
    ds_read_b64_tr_b16 v[52:53], v21
    ds_read_b64_tr_b16 v[54:55], v21 offset:2048
    s_waitcnt lgkmcnt(10)
    v_mfma_f32_32x32x16_bf16 v[72:87], v[32:35], v[228:231], v[72:87]
    ds_write_b128 v0, v[56:59]
    v_cvt_pk_bf16_f32 v60, v64, v65
    ds_read_b64_tr_b16 v[28:29], v21 offset:1024
    ds_read_b64_tr_b16 v[30:31], v21 offset:3072
    s_waitcnt lgkmcnt(11)
    v_mfma_f32_32x32x16_bf16 v[72:87], v[36:39], v[232:235], v[72:87]
    v_cvt_pk_bf16_f32 v61, v66, v67
    v_cvt_pk_bf16_f32 v62, v68, v69
    ds_read_b64_tr_b16 v[32:33], v21 offset:4096
    ds_read_b64_tr_b16 v[34:35], v21 offset:6144
    s_waitcnt lgkmcnt(11)
    v_mfma_f32_32x32x16_bf16 v[72:87], v[40:43], v[236:239], v[72:87]
    v_cvt_pk_bf16_f32 v63, v70, v71
    ds_write_b128 v0, v[60:63] offset:1024
    ds_read_b64_tr_b16 v[36:37], v21 offset:5120
    ds_read_b64_tr_b16 v[38:39], v21 offset:7168
    s_waitcnt lgkmcnt(12)
    v_mfma_f32_32x32x16_bf16 v[72:87], v[44:47], v[240:243], v[72:87]
    v_subrev_u32 v0, 118784, v0
    ds_read_b64_tr_b16 v[40:41], v21 offset:8192
    ds_read_b64_tr_b16 v[42:43], v21 offset:10240
    s_waitcnt lgkmcnt(12)
    v_mfma_f32_32x32x16_bf16 v[72:87], v[48:51], v[244:247], v[72:87]
    ds_read_b64_tr_b16 v[44:45], v21 offset:9216
    ds_read_b64_tr_b16 v[46:47], v21 offset:11264
    s_waitcnt lgkmcnt(6)
    s_barrier
    v_mfma_f32_32x32x16_bf16 v[72:87], v[52:55], v[152:155], v[72:87]
    ds_read_b64_tr_b16 v[48:49], v21 offset:12288
    ds_read_b64_tr_b16 v[50:51], v21 offset:14336
    v_mfma_f32_32x32x16_bf16 v[72:87], v[28:31], v[156:159], v[72:87]
    ds_read_b64_tr_b16 v[52:53], v21 offset:13312
    ds_read_b64_tr_b16 v[54:55], v21 offset:15360
    v_mfma_f32_32x32x16_bf16 v[72:87], v[32:35], v[160:163], v[72:87]
    ds_read_b64_tr_b16 v[28:29], v21 offset:16384
    ds_read_b64_tr_b16 v[30:31], v21 offset:18432
    s_waitcnt lgkmcnt(10)
    v_mfma_f32_32x32x16_bf16 v[72:87], v[36:39], v[164:167], v[72:87]
    ds_read_b64_tr_b16 v[32:33], v21 offset:17408
    ds_read_b64_tr_b16 v[34:35], v21 offset:19456
    s_waitcnt lgkmcnt(10)
    v_mfma_f32_32x32x16_bf16 v[72:87], v[40:43], v[168:171], v[72:87]
    ds_read_b64_tr_b16 v[36:37], v21 offset:20480
    ds_read_b64_tr_b16 v[38:39], v21 offset:22528
    s_waitcnt lgkmcnt(10)
    v_mfma_f32_32x32x16_bf16 v[72:87], v[44:47], v[172:175], v[72:87]
    ds_read_b64_tr_b16 v[40:41], v21 offset:21504
    ds_read_b64_tr_b16 v[42:43], v21 offset:23552
    s_waitcnt lgkmcnt(10)
    v_mfma_f32_32x32x16_bf16 v[72:87], v[48:51], v[176:179], v[72:87]
    ds_read_b64_tr_b16 v[44:45], v21 offset:24576
    ds_read_b64_tr_b16 v[46:47], v21 offset:26624
    s_waitcnt lgkmcnt(10)
    v_mfma_f32_32x32x16_bf16 v[72:87], v[52:55], v[180:183], v[72:87]
    ds_read_b64_tr_b16 v[48:49], v21 offset:25600
    ds_read_b64_tr_b16 v[50:51], v21 offset:27648
    s_waitcnt lgkmcnt(10)
    v_mfma_f32_32x32x16_bf16 v[72:87], v[28:31], v[184:187], v[72:87]
    ds_read_b64_tr_b16 v[52:53], v21 offset:28672
    ds_read_b64_tr_b16 v[54:55], v21 offset:30720
    s_waitcnt lgkmcnt(10)
    v_mfma_f32_32x32x16_bf16 v[72:87], v[32:35], v[188:191], v[72:87]
    ds_read_b64_tr_b16 v[28:29], v21 offset:29696
    ds_read_b64_tr_b16 v[30:31], v21 offset:31744
    s_waitcnt lgkmcnt(10)
    v_mfma_f32_32x32x16_bf16 v[72:87], v[36:39], v[192:195], v[72:87]
    ds_read_b64_tr_b16 v[32:33], v22 offset:32768
    ds_read_b64_tr_b16 v[34:35], v22 offset:34816
    s_waitcnt lgkmcnt(10)
    v_mfma_f32_32x32x16_bf16 v[72:87], v[40:43], v[196:199], v[72:87]
    ds_read_b64_tr_b16 v[36:37], v23 offset:32768
    ds_read_b64_tr_b16 v[38:39], v23 offset:34816
    s_waitcnt lgkmcnt(10)
    v_mfma_f32_32x32x16_bf16 v[72:87], v[44:47], v[200:203], v[72:87]
    ds_read_b64_tr_b16 v[40:41], v22 offset:33792
    ds_read_b64_tr_b16 v[42:43], v22 offset:35840
    s_waitcnt lgkmcnt(10)
    v_mfma_f32_32x32x16_bf16 v[72:87], v[48:51], v[204:207], v[72:87]
    ds_read_b64_tr_b16 v[44:45], v23 offset:33792
    ds_read_b64_tr_b16 v[46:47], v23 offset:35840
    s_waitcnt lgkmcnt(10)
    v_mfma_f32_32x32x16_bf16 v[72:87], v[52:55], v[208:211], v[72:87]
    ds_read_b64_tr_b16 v[48:49], v22 offset:36864
    ds_read_b64_tr_b16 v[50:51], v22 offset:38912
    s_waitcnt lgkmcnt(10)
    v_mfma_f32_32x32x16_bf16 v[72:87], v[28:31], v[212:215], v[72:87]
    ds_read_b64_tr_b16 v[52:53], v23 offset:36864
    ds_read_b64_tr_b16 v[54:55], v23 offset:38912
    s_waitcnt lgkmcnt(10)
    v_mfma_f32_32x32x16_bf16 v[88:103], v[32:35], v[216:219], v[88:103]
    ds_read_b64_tr_b16 v[28:29], v22 offset:37888
    ds_read_b64_tr_b16 v[30:31], v22 offset:39936
    s_waitcnt lgkmcnt(10)
    v_mfma_f32_32x32x16_bf16 v[104:119], v[36:39], v[216:219], v[104:119]
    s_nop 3
    v_cvt_pk_bf16_f32 v72, v72, v73
    v_cvt_pk_bf16_f32 v73, v74, v75
    ds_read_b64_tr_b16 v[32:33], v23 offset:37888
    ds_read_b64_tr_b16 v[34:35], v23 offset:39936
    s_waitcnt lgkmcnt(10)
    v_mfma_f32_32x32x16_bf16 v[88:103], v[40:43], v[220:223], v[88:103]
    v_cvt_pk_bf16_f32 v74, v76, v77
    v_cvt_pk_bf16_f32 v75, v78, v79
    ds_read_b64_tr_b16 v[36:37], v22 offset:40960
    ds_read_b64_tr_b16 v[38:39], v22 offset:43008
    s_waitcnt lgkmcnt(10)
    v_mfma_f32_32x32x16_bf16 v[104:119], v[44:47], v[220:223], v[104:119]
    ds_write_b128 v0, v[72:75]
    v_cvt_pk_bf16_f32 v76, v80, v81
    ds_read_b64_tr_b16 v[40:41], v23 offset:40960
    ds_read_b64_tr_b16 v[42:43], v23 offset:43008
    s_waitcnt lgkmcnt(11)
    v_mfma_f32_32x32x16_bf16 v[88:103], v[48:51], v[224:227], v[88:103]
    v_cvt_pk_bf16_f32 v77, v82, v83
    v_cvt_pk_bf16_f32 v78, v84, v85
    ds_read_b64_tr_b16 v[44:45], v22 offset:41984
    ds_read_b64_tr_b16 v[46:47], v22 offset:44032
    s_waitcnt lgkmcnt(11)
    v_mfma_f32_32x32x16_bf16 v[104:119], v[52:55], v[224:227], v[104:119]
    v_cvt_pk_bf16_f32 v79, v86, v87
    ds_write_b128 v0, v[76:79] offset:1024
    ds_read_b64_tr_b16 v[48:49], v23 offset:41984
    ds_read_b64_tr_b16 v[50:51], v23 offset:44032
    s_waitcnt lgkmcnt(12)
    v_mfma_f32_32x32x16_bf16 v[88:103], v[28:31], v[228:231], v[88:103]
    ds_read_b64_tr_b16 v[52:53], v22 offset:45056
    ds_read_b64_tr_b16 v[54:55], v22 offset:47104
    s_waitcnt lgkmcnt(12)
    v_mfma_f32_32x32x16_bf16 v[104:119], v[32:35], v[228:231], v[104:119]
    ds_read_b64_tr_b16 v[28:29], v23 offset:45056
    ds_read_b64_tr_b16 v[30:31], v23 offset:47104
    s_waitcnt lgkmcnt(6)
    s_barrier
    v_mfma_f32_32x32x16_bf16 v[88:103], v[36:39], v[232:235], v[88:103]
    s_lshl_b32 s96, s77, 11
    s_add_u32 s14, s96, 32768
    v_and_b32 v0, 7, v1
    ds_read_b64_tr_b16 v[32:33], v22 offset:46080
    ds_read_b64_tr_b16 v[34:35], v22 offset:48128
    v_mfma_f32_32x32x16_bf16 v[104:119], v[40:43], v[232:235], v[104:119]
    v_lshl_add_u32 v0, v0, 4, s14
    ds_read_b64_tr_b16 v[36:37], v23 offset:46080
    ds_read_b64_tr_b16 v[38:39], v23 offset:48128
    v_mfma_f32_32x32x16_bf16 v[88:103], v[44:47], v[236:239], v[88:103]
    v_bfe_u32 v4, v1, 3, 2
    ds_read_b64_tr_b16 v[40:41], v22
    ds_read_b64_tr_b16 v[42:43], v22 offset:2048
    s_waitcnt lgkmcnt(10)
    v_mfma_f32_32x32x16_bf16 v[104:119], v[48:51], v[236:239], v[104:119]
    v_lshl_add_u32 v0, v4, 8, v0
    v_lshrrev_b32 v4, 5, v1
    ds_read_b64_tr_b16 v[44:45], v23
    ds_read_b64_tr_b16 v[46:47], v23 offset:2048
    s_waitcnt lgkmcnt(10)
    v_mfma_f32_32x32x16_bf16 v[88:103], v[52:55], v[240:243], v[88:103]
    v_lshl_add_u32 v0, v4, 7, v0
    ds_read_b64_tr_b16 v[48:49], v22 offset:1024
    ds_read_b64_tr_b16 v[50:51], v22 offset:3072
    s_waitcnt lgkmcnt(10)
    v_mfma_f32_32x32x16_bf16 v[104:119], v[28:31], v[240:243], v[104:119]
    ds_read_b64_tr_b16 v[52:53], v23 offset:1024
    ds_read_b64_tr_b16 v[54:55], v23 offset:3072
    s_waitcnt lgkmcnt(10)
    v_mfma_f32_32x32x16_bf16 v[88:103], v[32:35], v[244:247], v[88:103]
    ds_read_b64_tr_b16 v[28:29], v22 offset:4096
    ds_read_b64_tr_b16 v[30:31], v22 offset:6144
    s_waitcnt lgkmcnt(10)
    v_mfma_f32_32x32x16_bf16 v[104:119], v[36:39], v[244:247], v[104:119]
    ds_read_b64_tr_b16 v[32:33], v23 offset:4096
    ds_read_b64_tr_b16 v[34:35], v23 offset:6144
    s_waitcnt lgkmcnt(10)
    v_mfma_f32_32x32x16_bf16 v[88:103], v[40:43], v[152:155], v[88:103]
    ds_read_b64_tr_b16 v[36:37], v22 offset:5120
    ds_read_b64_tr_b16 v[38:39], v22 offset:7168
    s_waitcnt lgkmcnt(10)
    v_mfma_f32_32x32x16_bf16 v[104:119], v[44:47], v[152:155], v[104:119]
    ds_read_b64_tr_b16 v[40:41], v23 offset:5120
    ds_read_b64_tr_b16 v[42:43], v23 offset:7168
    s_waitcnt lgkmcnt(10)
    v_mfma_f32_32x32x16_bf16 v[88:103], v[48:51], v[156:159], v[88:103]
    ds_read_b64_tr_b16 v[44:45], v22 offset:8192
    ds_read_b64_tr_b16 v[46:47], v22 offset:10240
    s_waitcnt lgkmcnt(10)
    v_mfma_f32_32x32x16_bf16 v[104:119], v[52:55], v[156:159], v[104:119]
    ds_read_b64_tr_b16 v[48:49], v23 offset:8192
    ds_read_b64_tr_b16 v[50:51], v23 offset:10240
    s_waitcnt lgkmcnt(10)
    v_mfma_f32_32x32x16_bf16 v[88:103], v[28:31], v[160:163], v[88:103]
    ds_read_b64_tr_b16 v[52:53], v22 offset:9216
    ds_read_b64_tr_b16 v[54:55], v22 offset:11264
    s_waitcnt lgkmcnt(10)
    v_mfma_f32_32x32x16_bf16 v[104:119], v[32:35], v[160:163], v[104:119]
    ds_read_b64_tr_b16 v[28:29], v23 offset:9216
    ds_read_b64_tr_b16 v[30:31], v23 offset:11264
    s_waitcnt lgkmcnt(10)
    v_mfma_f32_32x32x16_bf16 v[88:103], v[36:39], v[164:167], v[88:103]
    ds_read_b64_tr_b16 v[32:33], v22 offset:12288
    ds_read_b64_tr_b16 v[34:35], v22 offset:14336
    s_waitcnt lgkmcnt(10)
    v_mfma_f32_32x32x16_bf16 v[104:119], v[40:43], v[164:167], v[104:119]
    ds_read_b64_tr_b16 v[36:37], v23 offset:12288
    ds_read_b64_tr_b16 v[38:39], v23 offset:14336
    s_waitcnt lgkmcnt(10)
    v_mfma_f32_32x32x16_bf16 v[88:103], v[44:47], v[168:171], v[88:103]
    ds_read_b64_tr_b16 v[40:41], v22 offset:13312
    ds_read_b64_tr_b16 v[42:43], v22 offset:15360
    s_waitcnt lgkmcnt(10)
    v_mfma_f32_32x32x16_bf16 v[104:119], v[48:51], v[168:171], v[104:119]
    ds_read_b64_tr_b16 v[44:45], v23 offset:13312
    ds_read_b64_tr_b16 v[46:47], v23 offset:15360
    s_waitcnt lgkmcnt(10)
    v_mfma_f32_32x32x16_bf16 v[88:103], v[52:55], v[172:175], v[88:103]
    ds_read_b64_tr_b16 v[48:49], v22 offset:16384
    ds_read_b64_tr_b16 v[50:51], v22 offset:18432
    s_waitcnt lgkmcnt(10)
    v_mfma_f32_32x32x16_bf16 v[104:119], v[28:31], v[172:175], v[104:119]
    ds_read_b64_tr_b16 v[52:53], v23 offset:16384
    ds_read_b64_tr_b16 v[54:55], v23 offset:18432
    s_waitcnt lgkmcnt(10)
    v_mfma_f32_32x32x16_bf16 v[88:103], v[32:35], v[176:179], v[88:103]
    ds_read_b64_tr_b16 v[28:29], v22 offset:17408
    ds_read_b64_tr_b16 v[30:31], v22 offset:19456
    s_waitcnt lgkmcnt(10)
    v_mfma_f32_32x32x16_bf16 v[104:119], v[36:39], v[176:179], v[104:119]
    ds_read_b64_tr_b16 v[32:33], v23 offset:17408
    ds_read_b64_tr_b16 v[34:35], v23 offset:19456
    s_waitcnt lgkmcnt(10)
    v_mfma_f32_32x32x16_bf16 v[88:103], v[40:43], v[180:183], v[88:103]
    ds_read_b64_tr_b16 v[36:37], v22 offset:20480
    ds_read_b64_tr_b16 v[38:39], v22 offset:22528
    s_waitcnt lgkmcnt(10)
    v_mfma_f32_32x32x16_bf16 v[104:119], v[44:47], v[180:183], v[104:119]
    ds_read_b64_tr_b16 v[40:41], v23 offset:20480
    ds_read_b64_tr_b16 v[42:43], v23 offset:22528
    s_waitcnt lgkmcnt(10)
    v_mfma_f32_32x32x16_bf16 v[88:103], v[48:51], v[184:187], v[88:103]
    ds_read_b64_tr_b16 v[44:45], v22 offset:21504
    ds_read_b64_tr_b16 v[46:47], v22 offset:23552
    s_waitcnt lgkmcnt(10)
    v_mfma_f32_32x32x16_bf16 v[104:119], v[52:55], v[184:187], v[104:119]
    ds_read_b64_tr_b16 v[48:49], v23 offset:21504
    ds_read_b64_tr_b16 v[50:51], v23 offset:23552
    s_waitcnt lgkmcnt(10)
    v_mfma_f32_32x32x16_bf16 v[88:103], v[28:31], v[188:191], v[88:103]
    ds_read_b64_tr_b16 v[52:53], v22 offset:24576
    ds_read_b64_tr_b16 v[54:55], v22 offset:26624
    s_waitcnt lgkmcnt(10)
    v_mfma_f32_32x32x16_bf16 v[104:119], v[32:35], v[188:191], v[104:119]
    ds_read_b64_tr_b16 v[28:29], v23 offset:24576
    ds_read_b64_tr_b16 v[30:31], v23 offset:26624
    s_waitcnt lgkmcnt(10)
    v_mfma_f32_32x32x16_bf16 v[88:103], v[36:39], v[192:195], v[88:103]
    ds_read_b64_tr_b16 v[32:33], v22 offset:25600
    ds_read_b64_tr_b16 v[34:35], v22 offset:27648
    s_waitcnt lgkmcnt(10)
    v_mfma_f32_32x32x16_bf16 v[104:119], v[40:43], v[192:195], v[104:119]
    ds_read_b64_tr_b16 v[36:37], v23 offset:25600
    ds_read_b64_tr_b16 v[38:39], v23 offset:27648
    s_waitcnt lgkmcnt(10)
    v_mfma_f32_32x32x16_bf16 v[88:103], v[44:47], v[196:199], v[88:103]
    ds_read_b64_tr_b16 v[40:41], v22 offset:28672
    ds_read_b64_tr_b16 v[42:43], v22 offset:30720
    s_waitcnt lgkmcnt(10)
    v_mfma_f32_32x32x16_bf16 v[104:119], v[48:51], v[196:199], v[104:119]
    ds_read_b64_tr_b16 v[44:45], v23 offset:28672
    ds_read_b64_tr_b16 v[46:47], v23 offset:30720
    s_waitcnt lgkmcnt(10)
    v_mfma_f32_32x32x16_bf16 v[88:103], v[52:55], v[200:203], v[88:103]
    ds_read_b64_tr_b16 v[48:49], v22 offset:29696
    ds_read_b64_tr_b16 v[50:51], v22 offset:31744
    s_waitcnt lgkmcnt(10)
    v_mfma_f32_32x32x16_bf16 v[104:119], v[28:31], v[200:203], v[104:119]
    ds_read_b64_tr_b16 v[52:53], v23 offset:29696
    ds_read_b64_tr_b16 v[54:55], v23 offset:31744
    s_waitcnt lgkmcnt(10)
    v_mfma_f32_32x32x16_bf16 v[88:103], v[32:35], v[204:207], v[88:103]
    ds_read_b64_tr_b16 v[28:29], v24 offset:32768
    ds_read_b64_tr_b16 v[30:31], v24 offset:34816
    s_waitcnt lgkmcnt(10)
    v_mfma_f32_32x32x16_bf16 v[104:119], v[36:39], v[204:207], v[104:119]
    ds_read_b64_tr_b16 v[32:33], v25 offset:32768
    ds_read_b64_tr_b16 v[34:35], v25 offset:34816
    s_waitcnt lgkmcnt(10)
    v_mfma_f32_32x32x16_bf16 v[88:103], v[40:43], v[208:211], v[88:103]
    ds_read_b64_tr_b16 v[36:37], v24 offset:33792
    ds_read_b64_tr_b16 v[38:39], v24 offset:35840
    s_waitcnt lgkmcnt(10)
    v_mfma_f32_32x32x16_bf16 v[104:119], v[44:47], v[208:211], v[104:119]
    ds_read_b64_tr_b16 v[40:41], v25 offset:33792
    ds_read_b64_tr_b16 v[42:43], v25 offset:35840
    s_waitcnt lgkmcnt(10)
    v_mfma_f32_32x32x16_bf16 v[88:103], v[48:51], v[212:215], v[88:103]
    ds_read_b64_tr_b16 v[44:45], v24 offset:36864
    ds_read_b64_tr_b16 v[46:47], v24 offset:38912
    s_waitcnt lgkmcnt(10)
    v_mfma_f32_32x32x16_bf16 v[104:119], v[52:55], v[212:215], v[104:119]
    ds_read_b64_tr_b16 v[48:49], v25 offset:36864
    ds_read_b64_tr_b16 v[50:51], v25 offset:38912
    s_barrier
    s_waitcnt lgkmcnt(10)
    v_mfma_f32_32x32x16_bf16 v[120:135], v[28:31], v[216:219], v[120:135]
    ds_read_b64_tr_b16 v[52:53], v24 offset:37888
    ds_read_b64_tr_b16 v[54:55], v24 offset:39936
    s_waitcnt lgkmcnt(10)
    v_mfma_f32_32x32x16_bf16 v[136:151], v[32:35], v[216:219], v[136:151]
    ds_read_b64_tr_b16 v[28:29], v25 offset:37888
    ds_read_b64_tr_b16 v[30:31], v25 offset:39936
    s_waitcnt lgkmcnt(10)
    v_mfma_f32_32x32x16_bf16 v[120:135], v[36:39], v[220:223], v[120:135]
    v_cvt_pk_bf16_f32 v88, v88, v89
    ds_read_b64_tr_b16 v[32:33], v24 offset:40960
    ds_read_b64_tr_b16 v[34:35], v24 offset:43008
    s_waitcnt lgkmcnt(10)
    v_mfma_f32_32x32x16_bf16 v[136:151], v[40:43], v[220:223], v[136:151]
    v_cvt_pk_bf16_f32 v89, v90, v91
    ds_read_b64_tr_b16 v[36:37], v25 offset:40960
    ds_read_b64_tr_b16 v[38:39], v25 offset:43008
    s_waitcnt lgkmcnt(10)
    v_mfma_f32_32x32x16_bf16 v[120:135], v[44:47], v[224:227], v[120:135]
L_PAD4:
    s_cbranch_execz L_RET4
    v_cvt_pk_bf16_f32 v90, v92, v93
    ds_read_b64_tr_b16 v[40:41], v24 offset:41984
    ds_read_b64_tr_b16 v[42:43], v24 offset:44032
    s_waitcnt lgkmcnt(10)
    v_mfma_f32_32x32x16_bf16 v[136:151], v[48:51], v[224:227], v[136:151]
    v_cvt_pk_bf16_f32 v91, v94, v95
    ds_read_b64_tr_b16 v[44:45], v25 offset:41984
    ds_read_b64_tr_b16 v[46:47], v25 offset:44032
    s_waitcnt lgkmcnt(10)
    v_mfma_f32_32x32x16_bf16 v[120:135], v[52:55], v[228:231], v[120:135]
    ds_write_b128 v0, v[88:91]
    ds_read_b64_tr_b16 v[48:49], v24 offset:45056
    ds_read_b64_tr_b16 v[50:51], v24 offset:47104
    s_waitcnt lgkmcnt(11)
    v_mfma_f32_32x32x16_bf16 v[136:151], v[28:31], v[228:231], v[136:151]
    v_cvt_pk_bf16_f32 v92, v96, v97
    ds_read_b64_tr_b16 v[52:53], v25 offset:45056
    ds_read_b64_tr_b16 v[54:55], v25 offset:47104
    s_waitcnt lgkmcnt(11)
    v_mfma_f32_32x32x16_bf16 v[120:135], v[32:35], v[232:235], v[120:135]
    v_cvt_pk_bf16_f32 v93, v98, v99
    ds_read_b64_tr_b16 v[28:29], v24 offset:46080
    ds_read_b64_tr_b16 v[30:31], v24 offset:48128
    s_waitcnt lgkmcnt(11)
    v_mfma_f32_32x32x16_bf16 v[136:151], v[36:39], v[232:235], v[136:151]
    v_cvt_pk_bf16_f32 v94, v100, v101
    ds_read_b64_tr_b16 v[32:33], v25 offset:46080
    ds_read_b64_tr_b16 v[34:35], v25 offset:48128
    s_waitcnt lgkmcnt(11)
    v_mfma_f32_32x32x16_bf16 v[120:135], v[40:43], v[236:239], v[120:135]
    v_cvt_pk_bf16_f32 v95, v102, v103
    ds_read_b64_tr_b16 v[36:37], v24
    ds_read_b64_tr_b16 v[38:39], v24 offset:2048
    s_waitcnt lgkmcnt(11)
    v_mfma_f32_32x32x16_bf16 v[136:151], v[44:47], v[236:239], v[136:151]
    ds_write_b128 v0, v[92:95] offset:1024
    ds_read_b64_tr_b16 v[40:41], v25
    ds_read_b64_tr_b16 v[42:43], v25 offset:2048
    s_waitcnt lgkmcnt(11)
    v_mfma_f32_32x32x16_bf16 v[120:135], v[48:51], v[240:243], v[120:135]
    v_cvt_pk_bf16_f32 v104, v104, v105
    ds_read_b64_tr_b16 v[44:45], v24 offset:1024
    ds_read_b64_tr_b16 v[46:47], v24 offset:3072
    s_waitcnt lgkmcnt(11)
    v_mfma_f32_32x32x16_bf16 v[136:151], v[52:55], v[240:243], v[136:151]
    v_cvt_pk_bf16_f32 v105, v106, v107
    ds_read_b64_tr_b16 v[48:49], v25 offset:1024
    ds_read_b64_tr_b16 v[50:51], v25 offset:3072
    s_waitcnt lgkmcnt(11)
    v_mfma_f32_32x32x16_bf16 v[120:135], v[28:31], v[244:247], v[120:135]
    v_cvt_pk_bf16_f32 v106, v108, v109
    ds_read_b64_tr_b16 v[52:53], v24 offset:4096
    ds_read_b64_tr_b16 v[54:55], v24 offset:6144
    s_waitcnt lgkmcnt(11)
    v_mfma_f32_32x32x16_bf16 v[136:151], v[32:35], v[244:247], v[136:151]
    v_cvt_pk_bf16_f32 v107, v110, v111
    ds_read_b64_tr_b16 v[28:29], v25 offset:4096
    ds_read_b64_tr_b16 v[30:31], v25 offset:6144
    s_waitcnt lgkmcnt(11)
    v_mfma_f32_32x32x16_bf16 v[120:135], v[36:39], v[152:155], v[120:135]
    ds_write_b128 v0, v[104:107] offset:8192
    ds_read_b64_tr_b16 v[32:33], v24 offset:5120
    ds_read_b64_tr_b16 v[34:35], v24 offset:7168
    s_waitcnt lgkmcnt(11)
    v_mfma_f32_32x32x16_bf16 v[136:151], v[40:43], v[152:155], v[136:151]
    v_cvt_pk_bf16_f32 v108, v112, v113
    ds_read_b64_tr_b16 v[36:37], v25 offset:5120
    ds_read_b64_tr_b16 v[38:39], v25 offset:7168
    s_waitcnt lgkmcnt(11)
    v_mfma_f32_32x32x16_bf16 v[120:135], v[44:47], v[156:159], v[120:135]
    v_cvt_pk_bf16_f32 v109, v114, v115
    ds_read_b64_tr_b16 v[40:41], v24 offset:8192
    ds_read_b64_tr_b16 v[42:43], v24 offset:10240
    s_waitcnt lgkmcnt(11)
    v_mfma_f32_32x32x16_bf16 v[136:151], v[48:51], v[156:159], v[136:151]
    v_cvt_pk_bf16_f32 v110, v116, v117
    ds_read_b64_tr_b16 v[44:45], v25 offset:8192
    ds_read_b64_tr_b16 v[46:47], v25 offset:10240
    s_waitcnt lgkmcnt(11)
    v_mfma_f32_32x32x16_bf16 v[120:135], v[52:55], v[160:163], v[120:135]
    v_cvt_pk_bf16_f32 v111, v118, v119
    ds_read_b64_tr_b16 v[48:49], v24 offset:9216
    ds_read_b64_tr_b16 v[50:51], v24 offset:11264
    s_waitcnt lgkmcnt(11)
    v_mfma_f32_32x32x16_bf16 v[136:151], v[28:31], v[160:163], v[136:151]
    ds_write_b128 v0, v[108:111] offset:9216
    ds_read_b64_tr_b16 v[52:53], v25 offset:9216
    ds_read_b64_tr_b16 v[54:55], v25 offset:11264
    s_waitcnt lgkmcnt(11)
    v_mfma_f32_32x32x16_bf16 v[120:135], v[32:35], v[164:167], v[120:135]
    ds_read_b64_tr_b16 v[28:29], v24 offset:12288
    ds_read_b64_tr_b16 v[30:31], v24 offset:14336
    s_waitcnt lgkmcnt(11)
    v_mfma_f32_32x32x16_bf16 v[136:151], v[36:39], v[164:167], v[136:151]
    ds_read_b64_tr_b16 v[32:33], v25 offset:12288
    ds_read_b64_tr_b16 v[34:35], v25 offset:14336
    s_waitcnt lgkmcnt(11)
    v_mfma_f32_32x32x16_bf16 v[120:135], v[40:43], v[168:171], v[120:135]
    ds_read_b64_tr_b16 v[36:37], v24 offset:13312
    ds_read_b64_tr_b16 v[38:39], v24 offset:15360
    s_waitcnt lgkmcnt(11)
    v_mfma_f32_32x32x16_bf16 v[136:151], v[44:47], v[168:171], v[136:151]
    ds_read_b64_tr_b16 v[40:41], v25 offset:13312
    ds_read_b64_tr_b16 v[42:43], v25 offset:15360
    s_waitcnt lgkmcnt(11)
    v_mfma_f32_32x32x16_bf16 v[120:135], v[48:51], v[172:175], v[120:135]
    ds_read_b64_tr_b16 v[44:45], v24 offset:16384
    ds_read_b64_tr_b16 v[46:47], v24 offset:18432
    s_waitcnt lgkmcnt(10)
    v_mfma_f32_32x32x16_bf16 v[136:151], v[52:55], v[172:175], v[136:151]
    ds_read_b64_tr_b16 v[48:49], v25 offset:16384
    ds_read_b64_tr_b16 v[50:51], v25 offset:18432
    s_waitcnt lgkmcnt(10)
    v_mfma_f32_32x32x16_bf16 v[120:135], v[28:31], v[176:179], v[120:135]
    ds_read_b64_tr_b16 v[52:53], v24 offset:17408
    ds_read_b64_tr_b16 v[54:55], v24 offset:19456
    s_waitcnt lgkmcnt(10)
    v_mfma_f32_32x32x16_bf16 v[136:151], v[32:35], v[176:179], v[136:151]
    ds_read_b64_tr_b16 v[28:29], v25 offset:17408
    ds_read_b64_tr_b16 v[30:31], v25 offset:19456
    s_waitcnt lgkmcnt(10)
    v_mfma_f32_32x32x16_bf16 v[120:135], v[36:39], v[180:183], v[120:135]
    ds_read_b64_tr_b16 v[32:33], v24 offset:20480
    ds_read_b64_tr_b16 v[34:35], v24 offset:22528
    s_waitcnt lgkmcnt(10)
    v_mfma_f32_32x32x16_bf16 v[136:151], v[40:43], v[180:183], v[136:151]
    ds_read_b64_tr_b16 v[36:37], v25 offset:20480
    ds_read_b64_tr_b16 v[38:39], v25 offset:22528
    s_waitcnt lgkmcnt(10)
    v_mfma_f32_32x32x16_bf16 v[120:135], v[44:47], v[184:187], v[120:135]
    ds_read_b64_tr_b16 v[40:41], v24 offset:21504
    ds_read_b64_tr_b16 v[42:43], v24 offset:23552
    s_waitcnt lgkmcnt(10)
    v_mfma_f32_32x32x16_bf16 v[136:151], v[48:51], v[184:187], v[136:151]
    ds_read_b64_tr_b16 v[44:45], v25 offset:21504
    ds_read_b64_tr_b16 v[46:47], v25 offset:23552
    s_waitcnt lgkmcnt(10)
    v_mfma_f32_32x32x16_bf16 v[120:135], v[52:55], v[188:191], v[120:135]
    ds_read_b64_tr_b16 v[48:49], v24 offset:24576
    ds_read_b64_tr_b16 v[50:51], v24 offset:26624
    s_waitcnt lgkmcnt(10)
    v_mfma_f32_32x32x16_bf16 v[136:151], v[28:31], v[188:191], v[136:151]
    ds_read_b64_tr_b16 v[52:53], v25 offset:24576
    ds_read_b64_tr_b16 v[54:55], v25 offset:26624
    s_waitcnt lgkmcnt(10)
    v_mfma_f32_32x32x16_bf16 v[120:135], v[32:35], v[192:195], v[120:135]
    ds_read_b64_tr_b16 v[28:29], v24 offset:25600
    ds_read_b64_tr_b16 v[30:31], v24 offset:27648
    s_waitcnt lgkmcnt(10)
    v_mfma_f32_32x32x16_bf16 v[136:151], v[36:39], v[192:195], v[136:151]
    ds_read_b64_tr_b16 v[32:33], v25 offset:25600
    ds_read_b64_tr_b16 v[34:35], v25 offset:27648
    s_waitcnt lgkmcnt(10)
    v_mfma_f32_32x32x16_bf16 v[120:135], v[40:43], v[196:199], v[120:135]
    ds_read_b64_tr_b16 v[36:37], v24 offset:28672
    ds_read_b64_tr_b16 v[38:39], v24 offset:30720
    s_waitcnt lgkmcnt(10)
    v_mfma_f32_32x32x16_bf16 v[136:151], v[44:47], v[196:199], v[136:151]
    ds_read_b64_tr_b16 v[40:41], v25 offset:28672
    ds_read_b64_tr_b16 v[42:43], v25 offset:30720
    s_waitcnt lgkmcnt(10)
    v_mfma_f32_32x32x16_bf16 v[120:135], v[48:51], v[200:203], v[120:135]
    ds_read_b64_tr_b16 v[44:45], v25 offset:29696
    ds_read_b64_tr_b16 v[46:47], v25 offset:31744
    s_waitcnt lgkmcnt(10)
    v_mfma_f32_32x32x16_bf16 v[136:151], v[52:55], v[200:203], v[136:151]
    ds_read_b64_tr_b16 v[48:49], v24 offset:29696
    ds_read_b64_tr_b16 v[50:51], v24 offset:31744
    s_waitcnt lgkmcnt(10)
    v_mfma_f32_32x32x16_bf16 v[120:135], v[28:31], v[204:207], v[120:135]
    s_waitcnt lgkmcnt(8)
    v_mfma_f32_32x32x16_bf16 v[136:151], v[32:35], v[204:207], v[136:151]
    s_waitcnt lgkmcnt(6)
    v_mfma_f32_32x32x16_bf16 v[120:135], v[36:39], v[208:211], v[120:135]
    s_waitcnt lgkmcnt(4)
    v_mfma_f32_32x32x16_bf16 v[136:151], v[40:43], v[208:211], v[136:151]
    s_waitcnt lgkmcnt(2)
    v_mfma_f32_32x32x16_bf16 v[136:151], v[44:47], v[212:215], v[136:151]
    s_waitcnt lgkmcnt(0)
    v_mfma_f32_32x32x16_bf16 v[120:135], v[48:51], v[212:215], v[120:135]
    s_lshl_b32 s96, s77, 11
    s_add_u32 s14, s96, 151552
    v_add_u32 v0, s14, v2
    v_bfe_u32 v4, v1, 2, 2
    v_lshlrev_b32 v4, 6, v4
    v_bfe_u32 v9, v1, 4, 1
    v_lshl_add_u32 v4, v9, 5, v4
    v_and_b32 v9, 3, v1
    v_lshl_add_u32 v4, v9, 3, v4
    v_lshrrev_b32 v9, 5, v1
    v_lshl_add_u32 v4, v9, 8, v4
    v_add_u32 v4, 159744, v4
    ds_read_b64_tr_b16 v[176:177], v4
    ds_read_b64_tr_b16 v[178:179], v4 offset:512
    ds_read_b64_tr_b16 v[180:181], v4 offset:1024
    ds_read_b64_tr_b16 v[182:183], v4 offset:1536
    v_cvt_pk_bf16_f32 v152, v136, v137
    v_cvt_pk_bf16_f32 v153, v138, v139
    v_cvt_pk_bf16_f32 v154, v140, v141
    v_cvt_pk_bf16_f32 v155, v142, v143
    v_cvt_pk_bf16_f32 v156, v144, v145
    v_cvt_pk_bf16_f32 v157, v146, v147
    v_cvt_pk_bf16_f32 v158, v148, v149
    v_cvt_pk_bf16_f32 v159, v150, v151
    ds_write_b128 v0, v[152:155]
    ds_write_b128 v0, v[156:159] offset:1024
    v_cvt_pk_bf16_f32 v168, v120, v121
    v_cvt_pk_bf16_f32 v169, v122, v123
    v_cvt_pk_bf16_f32 v170, v124, v125
    v_cvt_pk_bf16_f32 v171, v126, v127
    v_cvt_pk_bf16_f32 v172, v128, v129
    v_cvt_pk_bf16_f32 v173, v130, v131
    v_cvt_pk_bf16_f32 v174, v132, v133
    v_cvt_pk_bf16_f32 v175, v134, v135
    s_setprio 0
    s_branch L_JOIN
L_HELP:
    s_barrier
    s_add_u32 s96, s84, 4
    s_and_b32 s97, s96, 15
    s_mul_i32 s98, s97, 393216
    s_add_u32 s99, s98, s85
    s_add_u32 s82, s99, 4294772736
    s_add_u32 m0, s83, 28672
    s_nop 0
    buffer_load_dwordx4 v3, s[40:43], s82 offen lds
    s_add_u32 s96, s84, 4
    s_and_b32 s97, s96, 15
    s_mul_i32 s98, s97, 393216
    s_add_u32 s99, s98, s85
    s_add_u32 s82, s99, 2048
    s_add_u32 m0, s83, 32768
    s_nop 0
    buffer_load_dwordx4 v3, s[40:43], s82 offen lds
    s_add_u32 s96, s84, 4
    s_and_b32 s97, s96, 15
    s_mul_i32 s98, s97, 393216
    s_add_u32 s99, s98, s85
    s_add_u32 s82, s99, 4294774784
    s_add_u32 m0, s83, 77824
    s_nop 0
    buffer_load_dwordx4 v3, s[40:43], s82 offen lds
    s_add_u32 s96, s84, 4
    s_and_b32 s97, s96, 15
    s_mul_i32 s98, s97, 393216
    s_add_u32 s99, s98, s85
    s_add_u32 s82, s99, 4096
    s_add_u32 m0, s83, 81920
    s_nop 0
    buffer_load_dwordx4 v3, s[40:43], s82 offen lds
    s_add_u32 s96, s84, 4
    s_and_b32 s97, s96, 15
    s_mul_i32 s98, s97, 393216
    s_add_u32 s99, s98, s85
    s_add_u32 s82, s99, 4294770688
    s_add_u32 m0, s83, 126976
    s_nop 0
    buffer_load_dwordx4 v3, s[40:43], s82 offen lds
    s_add_u32 s96, s84, 4
    s_and_b32 s97, s96, 15
    s_mul_i32 s98, s97, 393216
    s_add_u32 s82, s98, s85
    s_add_u32 m0, s83, 131072
    s_nop 0
    buffer_load_dwordx4 v3, s[40:43], s82 offen lds
    s_add_u32 s96, s84, 5
    s_and_b32 s97, s96, 15
    s_mul_i32 s98, s97, 393216
    s_add_u32 s99, s98, s85
    s_add_u32 s82, s99, 4294772736
    s_add_u32 m0, s83, 36864
    s_nop 0
    buffer_load_dwordx4 v3, s[40:43], s82 offen lds
    s_add_u32 s96, s84, 5
    s_and_b32 s97, s96, 15
    s_mul_i32 s98, s97, 393216
    s_add_u32 s99, s98, s85
    s_add_u32 s82, s99, 2048
    s_add_u32 m0, s83, 40960
    s_nop 0
    buffer_load_dwordx4 v3, s[40:43], s82 offen lds
    s_add_u32 s96, s84, 5
    s_and_b32 s97, s96, 15
    s_mul_i32 s98, s97, 393216
    s_add_u32 s99, s98, s85
    s_add_u32 s82, s99, 4294774784
    s_add_u32 m0, s83, 86016
    s_nop 0
    buffer_load_dwordx4 v3, s[40:43], s82 offen lds
    s_add_u32 s96, s84, 5
    s_and_b32 s97, s96, 15
    s_mul_i32 s98, s97, 393216
    s_add_u32 s99, s98, s85
    s_add_u32 s82, s99, 4096
    s_add_u32 m0, s83, 90112
    s_nop 0
    buffer_load_dwordx4 v3, s[40:43], s82 offen lds
    s_add_u32 s96, s84, 5
    s_and_b32 s97, s96, 15
    s_mul_i32 s98, s97, 393216
    s_add_u32 s99, s98, s85
    s_add_u32 s82, s99, 4294770688
    s_add_u32 m0, s83, 135168
    s_nop 0
    buffer_load_dwordx4 v3, s[40:43], s82 offen lds
    s_add_u32 s96, s84, 5
    s_and_b32 s97, s96, 15
    s_mul_i32 s98, s97, 393216
    s_add_u32 s82, s98, s85
    s_add_u32 m0, s83, 139264
    s_nop 0
    buffer_load_dwordx4 v3, s[40:43], s82 offen lds
    v_bfe_u32 v4, v1, 2, 2
    v_lshlrev_b32 v4, 6, v4
    v_bfe_u32 v9, v1, 4, 1
    v_lshl_add_u32 v4, v9, 5, v4
    v_and_b32 v9, 3, v1
    v_lshl_add_u32 v4, v9, 3, v4
    v_lshrrev_b32 v9, 5, v1
    v_lshl_add_u32 v4, v9, 8, v4
    v_add_u32 v4, 159744, v4
    ds_read_b64_tr_b16 v[168:169], v4
    ds_read_b64_tr_b16 v[170:171], v4 offset:512
    ds_read_b64_tr_b16 v[172:173], v4 offset:1024
    ds_read_b64_tr_b16 v[174:175], v4 offset:1536
    ds_read_b64_tr_b16 v[176:177], v4 offset:2048
    ds_read_b64_tr_b16 v[178:179], v4 offset:2560
    ds_read_b64_tr_b16 v[180:181], v4 offset:3072
    ds_read_b64_tr_b16 v[182:183], v4 offset:3584
    s_lshl_b32 s14, s77, 10
    v_and_b32 v232, 7, v1
    v_lshl_add_u32 v232, v232, 4, s14
    v_bfe_u32 v9, v1, 3, 2
    v_lshl_add_u32 v232, v9, 8, v232
    v_lshrrev_b32 v9, 5, v1
    v_lshl_add_u32 v232, v9, 7, v232
    s_and_b32 s96, s9, 1
    s_lshl1_add_u32 s18, s96, 1
    s_and_b32 s96, s8, 3
    s_lshl2_add_u32 s97, s96, s3
    s_sub_u32 s98, s97, 4
    s_lshl_b32 s82, s98, 7
    v_lshrrev_b32 v136, 3, v1
    v_lshl_add_u32 v136, v136, 1, s82
    global_load_ushort v120, v136, s[86:87] offset:0
    global_load_ushort v121, v136, s[86:87] offset:16
    global_load_ushort v122, v136, s[86:87] offset:32
    global_load_ushort v123, v136, s[86:87] offset:48
    global_load_ushort v124, v136, s[86:87] offset:64
    global_load_ushort v125, v136, s[86:87] offset:80
    global_load_ushort v126, v136, s[86:87] offset:96
    global_load_ushort v127, v136, s[86:87] offset:112
    s_and_b32 s96, s8, 3
    s_lshl2_add_u32 s97, s96, s3
    s_sub_u32 s98, s97, 4
    s_mul_i32 s99, s98, 786432
    s_lshr_b32 s96, s8, 2
    s_lshl1_add_u32 s97, s9, s96
    s_lshl_b32 s98, s97, 7
    s_add_u32 s96, s99, s98
    s_add_u32 s19, s96, 4096
    s_waitcnt vmcnt(23)
    s_barrier
    s_add_u32 s96, s84, 6
    s_and_b32 s97, s96, 15
    s_mul_i32 s98, s97, 393216
    s_add_u32 s99, s98, s85
    s_add_u32 s82, s99, 4294772736
    s_add_u32 m0, s83, 4294963200
    s_nop 0
    buffer_load_dwordx4 v3, s[40:43], s82 offen lds
    s_add_u32 s96, s84, 6
    s_and_b32 s97, s96, 15
    s_mul_i32 s98, s97, 393216
    s_add_u32 s99, s98, s85
    s_add_u32 s82, s99, 2048
    s_mov_b32 m0, s83
    s_nop 0
    buffer_load_dwordx4 v3, s[40:43], s82 offen lds
    s_add_u32 s96, s84, 6
    s_and_b32 s97, s96, 15
    s_mul_i32 s98, s97, 393216
    s_add_u32 s99, s98, s85
    s_add_u32 s82, s99, 4294770688
    s_add_u32 m0, s83, 94208
    s_nop 0
    buffer_load_dwordx4 v3, s[40:43], s82 offen lds
    s_add_u32 s96, s84, 6
    s_and_b32 s97, s96, 15
    s_mul_i32 s98, s97, 393216
    s_add_u32 s82, s98, s85
    s_add_u32 m0, s83, 98304
    s_nop 0
    buffer_load_dwordx4 v3, s[40:43], s82 offen lds
    s_add_u32 s96, s84, 6
    s_and_b32 s97, s96, 15
    s_mul_i32 s98, s97, 393216
    s_add_u32 s99, s98, s85
    s_add_u32 s82, s99, 4294774784
    s_add_u32 m0, s83, 45056
    s_nop 0
    buffer_load_dwordx4 v3, s[40:43], s82 offen lds
    s_add_u32 s96, s84, 6
    s_and_b32 s97, s96, 15
    s_mul_i32 s98, s97, 393216
    s_add_u32 s99, s98, s85
    s_add_u32 s82, s99, 4096
    s_add_u32 m0, s83, 49152
    s_nop 0
    buffer_load_dwordx4 v3, s[40:43], s82 offen lds
    s_cmp_lg_u32 s18, 1
    s_cbranch_scc1 L_NM2_1_0
    s_mov_b32 s82, s19
    buffer_load_dwordx4 v[88:91], v248, s[48:51], s82 offen nt
    s_add_u32 s82, s19, 98304
    buffer_load_dwordx4 v[92:95], v248, s[48:51], s82 offen nt
    s_add_u32 s82, s19, 196608
    buffer_load_dwordx4 v[96:99], v248, s[48:51], s82 offen nt
    s_add_u32 s82, s19, 294912
    buffer_load_dwordx4 v[100:103], v248, s[48:51], s82 offen nt
    s_add_u32 s82, s19, 393216
    buffer_load_dwordx4 v[104:107], v248, s[48:51], s82 offen nt
    s_add_u32 s82, s19, 491520
    buffer_load_dwordx4 v[108:111], v248, s[48:51], s82 offen nt
    s_add_u32 s82, s19, 589824
    buffer_load_dwordx4 v[112:115], v248, s[48:51], s82 offen nt
    s_add_u32 s82, s19, 688128
    buffer_load_dwordx4 v[116:119], v248, s[48:51], s82 offen nt
L_NM2_1_0:
    s_waitcnt lgkmcnt(0)
    s_load_dword s24, s[32:33], s92 offset:512 glc
    s_load_dword s25, s[32:33], s92 offset:256 glc
    s_load_dword s26, s[32:33], s92 offset:3584 glc
    s_load_dword s27, s[32:33], s92 offset:3328 glc
    s_waitcnt vmcnt(26)
    s_barrier
    s_add_u32 s96, s84, 7
    s_and_b32 s97, s96, 15
    s_mul_i32 s98, s97, 393216
    s_add_u32 s99, s98, s85
    s_add_u32 s82, s99, 4294772736
    s_add_u32 m0, s83, 4096
    s_nop 0
    buffer_load_dwordx4 v3, s[40:43], s82 offen lds
    s_add_u32 s96, s84, 7
    s_and_b32 s97, s96, 15
    s_mul_i32 s98, s97, 393216
    s_add_u32 s99, s98, s85
    s_add_u32 s82, s99, 2048
    s_add_u32 m0, s83, 8192
    s_nop 0
    buffer_load_dwordx4 v3, s[40:43], s82 offen lds
    s_add_u32 s96, s84, 7
    s_and_b32 s97, s96, 15
    s_mul_i32 s98, s97, 393216
    s_add_u32 s99, s98, s85
    s_add_u32 s82, s99, 4294770688
    s_add_u32 m0, s83, 102400
    s_nop 0
    buffer_load_dwordx4 v3, s[40:43], s82 offen lds
    s_add_u32 s96, s84, 7
    s_and_b32 s97, s96, 15
    s_mul_i32 s98, s97, 393216
    s_add_u32 s82, s98, s85
    s_add_u32 m0, s83, 106496
    s_nop 0
    buffer_load_dwordx4 v3, s[40:43], s82 offen lds
    s_add_u32 s96, s84, 7
    s_and_b32 s97, s96, 15
    s_mul_i32 s98, s97, 393216
    s_add_u32 s99, s98, s85
    s_add_u32 s82, s99, 4294774784
    s_add_u32 m0, s83, 53248
    s_nop 0
    buffer_load_dwordx4 v3, s[40:43], s82 offen lds
    s_add_u32 s96, s84, 7
    s_and_b32 s97, s96, 15
    s_mul_i32 s98, s97, 393216
    s_add_u32 s99, s98, s85
    s_add_u32 s82, s99, 4096
    s_add_u32 m0, s83, 57344
    s_nop 0
    buffer_load_dwordx4 v3, s[40:43], s82 offen lds
    s_cmp_lg_u32 s18, 2
    s_cbranch_scc1 L_NM2_2_0
    s_mov_b32 s82, s19
    buffer_load_dwordx4 v[88:91], v248, s[48:51], s82 offen nt
    s_add_u32 s82, s19, 98304
    buffer_load_dwordx4 v[92:95], v248, s[48:51], s82 offen nt
    s_add_u32 s82, s19, 196608
    buffer_load_dwordx4 v[96:99], v248, s[48:51], s82 offen nt
    s_add_u32 s82, s19, 294912
    buffer_load_dwordx4 v[100:103], v248, s[48:51], s82 offen nt
    s_add_u32 s82, s19, 393216
    buffer_load_dwordx4 v[104:107], v248, s[48:51], s82 offen nt
    s_add_u32 s82, s19, 491520
    buffer_load_dwordx4 v[108:111], v248, s[48:51], s82 offen nt
    s_add_u32 s82, s19, 589824
    buffer_load_dwordx4 v[112:115], v248, s[48:51], s82 offen nt
    s_add_u32 s82, s19, 688128
    buffer_load_dwordx4 v[116:119], v248, s[48:51], s82 offen nt
L_NM2_2_0:
    s_waitcnt vmcnt(30)
    s_waitcnt vmcnt(26)
    s_barrier
    s_add_u32 s96, s84, 8
    s_and_b32 s97, s96, 15
    s_mul_i32 s98, s97, 393216
    s_add_u32 s99, s98, s85
    s_add_u32 s82, s99, 4294772736
    s_add_u32 m0, s83, 12288
    s_nop 0
    buffer_load_dwordx4 v3, s[40:43], s82 offen lds
    s_add_u32 s96, s84, 8
    s_and_b32 s97, s96, 15
    s_mul_i32 s98, s97, 393216
    s_add_u32 s99, s98, s85
    s_add_u32 s82, s99, 2048
    s_add_u32 m0, s83, 16384
    s_nop 0
    buffer_load_dwordx4 v3, s[40:43], s82 offen lds
    s_add_u32 s96, s84, 8
    s_and_b32 s97, s96, 15
    s_mul_i32 s98, s97, 393216
    s_add_u32 s99, s98, s85
    s_add_u32 s82, s99, 4294770688
    s_add_u32 m0, s83, 110592
    s_nop 0
    buffer_load_dwordx4 v3, s[40:43], s82 offen lds
    s_add_u32 s96, s84, 8
    s_and_b32 s97, s96, 15
    s_mul_i32 s98, s97, 393216
    s_add_u32 s82, s98, s85
    s_add_u32 m0, s83, 114688
    s_nop 0
    buffer_load_dwordx4 v3, s[40:43], s82 offen lds
    s_add_u32 s96, s84, 8
    s_and_b32 s97, s96, 15
    s_mul_i32 s98, s97, 393216
    s_add_u32 s99, s98, s85
    s_add_u32 s82, s99, 4294774784
    s_add_u32 m0, s83, 61440
    s_nop 0
    buffer_load_dwordx4 v3, s[40:43], s82 offen lds
    s_add_u32 s96, s84, 8
    s_and_b32 s97, s96, 15
    s_mul_i32 s98, s97, 393216
    s_add_u32 s99, s98, s85
    s_add_u32 s82, s99, 4096
    s_add_u32 m0, s83, 65536
    s_nop 0
    buffer_load_dwordx4 v3, s[40:43], s82 offen lds
    s_cmp_lg_u32 s18, 3
    s_cbranch_scc1 L_NM2_3_0
    s_mov_b32 s82, s19
    buffer_load_dwordx4 v[88:91], v248, s[48:51], s82 offen nt
    s_add_u32 s82, s19, 98304
    buffer_load_dwordx4 v[92:95], v248, s[48:51], s82 offen nt
    s_add_u32 s82, s19, 196608
    buffer_load_dwordx4 v[96:99], v248, s[48:51], s82 offen nt
    s_add_u32 s82, s19, 294912
    buffer_load_dwordx4 v[100:103], v248, s[48:51], s82 offen nt
    s_add_u32 s82, s19, 393216
    buffer_load_dwordx4 v[104:107], v248, s[48:51], s82 offen nt
    s_add_u32 s82, s19, 491520
    buffer_load_dwordx4 v[108:111], v248, s[48:51], s82 offen nt
    s_add_u32 s82, s19, 589824
    buffer_load_dwordx4 v[112:115], v248, s[48:51], s82 offen nt
    s_add_u32 s82, s19, 688128
    buffer_load_dwordx4 v[116:119], v248, s[48:51], s82 offen nt
L_NM2_3_0:
    s_waitcnt vmcnt(18)
    v_lshlrev_b32 v120, 16, v120
    v_mul_f32 v136, s7, v120
    v_exp_f32 v136, -v136
    s_nop 0
    v_add_f32 v136, 1.0, v136
    v_rcp_f32 v136, v136
    s_nop 0
    v_mul_f32 v120, v120, v136
    v_cvt_pk_bf16_f32 v120, 0, v120
    v_lshlrev_b32 v121, 16, v121
    v_mul_f32 v137, s7, v121
    v_exp_f32 v137, -v137
    s_nop 0
    v_add_f32 v137, 1.0, v137
    v_rcp_f32 v137, v137
    s_nop 0
    v_mul_f32 v121, v121, v137
    v_cvt_pk_bf16_f32 v121, 0, v121
    v_lshlrev_b32 v122, 16, v122
    v_mul_f32 v136, s7, v122
    v_exp_f32 v136, -v136
    s_nop 0
    v_add_f32 v136, 1.0, v136
    v_rcp_f32 v136, v136
    s_nop 0
    v_mul_f32 v122, v122, v136
    v_cvt_pk_bf16_f32 v122, 0, v122
    v_lshlrev_b32 v123, 16, v123
    v_mul_f32 v137, s7, v123
    v_exp_f32 v137, -v137
    s_nop 0
    v_add_f32 v137, 1.0, v137
    v_rcp_f32 v137, v137
    s_nop 0
    v_mul_f32 v123, v123, v137
    v_cvt_pk_bf16_f32 v123, 0, v123
    v_lshlrev_b32 v124, 16, v124
    v_mul_f32 v136, s7, v124
    v_exp_f32 v136, -v136
    s_nop 0
    v_add_f32 v136, 1.0, v136
    v_rcp_f32 v136, v136
    s_nop 0
    v_mul_f32 v124, v124, v136
    v_cvt_pk_bf16_f32 v124, 0, v124
    v_lshlrev_b32 v125, 16, v125
    v_mul_f32 v137, s7, v125
    v_exp_f32 v137, -v137
    s_nop 0
    v_add_f32 v137, 1.0, v137
    v_rcp_f32 v137, v137
    s_nop 0
    v_mul_f32 v125, v125, v137
    v_cvt_pk_bf16_f32 v125, 0, v125
    v_lshlrev_b32 v126, 16, v126
    v_mul_f32 v136, s7, v126
    v_exp_f32 v136, -v136
    s_nop 0
    v_add_f32 v136, 1.0, v136
    v_rcp_f32 v136, v136
    s_nop 0
    v_mul_f32 v126, v126, v136
    v_cvt_pk_bf16_f32 v126, 0, v126
    v_lshlrev_b32 v127, 16, v127
    v_mul_f32 v137, s7, v127
    v_exp_f32 v137, -v137
    s_nop 0
    v_add_f32 v137, 1.0, v137
    v_rcp_f32 v137, v137
    s_nop 0
    v_mul_f32 v127, v127, v137
    v_cvt_pk_bf16_f32 v127, 0, v127
    s_waitcnt lgkmcnt(0)
    s_load_dword s24, s[32:33], s92 offset:1024 glc
    s_load_dword s25, s[32:33], s92 offset:768 glc
    s_load_dword s26, s[32:33], s92 offset:1536 glc
    s_load_dword s27, s[32:33], s92 offset:1280 glc
L_PAD5:
    s_cbranch_execz L_RET5
    s_barrier
    s_add_u32 s96, s84, 9
    s_and_b32 s97, s96, 15
    s_mul_i32 s98, s97, 393216
    s_add_u32 s99, s98, s85
    s_add_u32 s82, s99, 4294772736
    s_add_u32 m0, s83, 20480
    s_nop 0
    buffer_load_dwordx4 v3, s[40:43], s82 offen lds
    s_add_u32 s96, s84, 9
    s_and_b32 s97, s96, 15
    s_mul_i32 s98, s97, 393216
    s_add_u32 s99, s98, s85
    s_add_u32 s82, s99, 2048
    s_add_u32 m0, s83, 24576
    s_nop 0
    buffer_load_dwordx4 v3, s[40:43], s82 offen lds
    s_add_u32 s96, s84, 9
    s_and_b32 s97, s96, 15
    s_mul_i32 s98, s97, 393216
    s_add_u32 s99, s98, s85
    s_add_u32 s82, s99, 4294770688
    s_add_u32 m0, s83, 118784
    s_nop 0
    buffer_load_dwordx4 v3, s[40:43], s82 offen lds
    s_add_u32 s96, s84, 9
    s_and_b32 s97, s96, 15
    s_mul_i32 s98, s97, 393216
    s_add_u32 s82, s98, s85
    s_add_u32 m0, s83, 122880
    s_nop 0
    buffer_load_dwordx4 v3, s[40:43], s82 offen lds
    s_add_u32 s96, s84, 9
    s_and_b32 s97, s96, 15
    s_mul_i32 s98, s97, 393216
    s_add_u32 s99, s98, s85
    s_add_u32 s82, s99, 4294774784
    s_add_u32 m0, s83, 69632
    s_nop 0
    buffer_load_dwordx4 v3, s[40:43], s82 offen lds
    s_add_u32 s96, s84, 9
    s_and_b32 s97, s96, 15
    s_mul_i32 s98, s97, 393216
    s_add_u32 s99, s98, s85
    s_add_u32 s82, s99, 4096
    s_add_u32 m0, s83, 73728
    s_nop 0
    buffer_load_dwordx4 v3, s[40:43], s82 offen lds
    s_waitcnt vmcnt(22)
    s_waitcnt vmcnt(20)
    s_waitcnt vmcnt(18)
    s_barrier
    s_add_u32 s96, s84, 10
    s_and_b32 s97, s96, 15
    s_mul_i32 s98, s97, 393216
    s_add_u32 s99, s98, s85
    s_add_u32 s82, s99, 4294772736
    s_add_u32 m0, s83, 28672
    s_nop 0
    buffer_load_dwordx4 v3, s[40:43], s82 offen lds
    s_add_u32 s96, s84, 10
    s_and_b32 s97, s96, 15
    s_mul_i32 s98, s97, 393216
    s_add_u32 s99, s98, s85
    s_add_u32 s82, s99, 2048
    s_add_u32 m0, s83, 32768
    s_nop 0
    buffer_load_dwordx4 v3, s[40:43], s82 offen lds
    s_add_u32 s96, s84, 10
    s_and_b32 s97, s96, 15
    s_mul_i32 s98, s97, 393216
    s_add_u32 s99, s98, s85
    s_add_u32 s82, s99, 4294774784
    s_add_u32 m0, s83, 77824
    s_nop 0
    buffer_load_dwordx4 v3, s[40:43], s82 offen lds
    s_add_u32 s96, s84, 10
    s_and_b32 s97, s96, 15
    s_mul_i32 s98, s97, 393216
    s_add_u32 s99, s98, s85
    s_add_u32 s82, s99, 4096
    s_add_u32 m0, s83, 81920
    s_nop 0
    buffer_load_dwordx4 v3, s[40:43], s82 offen lds
    s_waitcnt vmcnt(8)
    v_lshlrev_b32 v136, 16, v88
    v_and_b32 v137, s6, v88
    v_mul_f32 v128, v136, v120
    v_mul_f32 v129, v137, v120
    v_lshlrev_b32 v138, 16, v89
    v_and_b32 v139, s6, v89
    v_mul_f32 v130, v138, v120
    v_mul_f32 v131, v139, v120
    v_lshlrev_b32 v136, 16, v90
    v_and_b32 v137, s6, v90
    v_mul_f32 v132, v136, v120
    v_mul_f32 v133, v137, v120
    v_lshlrev_b32 v138, 16, v91
    v_and_b32 v139, s6, v91
    v_mul_f32 v134, v138, v120
    v_mul_f32 v135, v139, v120
    v_lshlrev_b32 v136, 16, v92
    v_and_b32 v137, s6, v92
    v_fmac_f32 v128, v136, v121
    v_fmac_f32 v129, v137, v121
    v_lshlrev_b32 v138, 16, v93
    v_and_b32 v139, s6, v93
    v_fmac_f32 v130, v138, v121
    v_fmac_f32 v131, v139, v121
    v_lshlrev_b32 v136, 16, v94
    v_and_b32 v137, s6, v94
    v_fmac_f32 v132, v136, v121
    v_fmac_f32 v133, v137, v121
    v_lshlrev_b32 v138, 16, v95
    v_and_b32 v139, s6, v95
    v_fmac_f32 v134, v138, v121
    v_fmac_f32 v135, v139, v121
    v_lshlrev_b32 v136, 16, v96
    v_and_b32 v137, s6, v96
    v_fmac_f32 v128, v136, v122
    v_fmac_f32 v129, v137, v122
    v_lshlrev_b32 v138, 16, v97
    v_and_b32 v139, s6, v97
    v_fmac_f32 v130, v138, v122
    v_fmac_f32 v131, v139, v122
    v_lshlrev_b32 v136, 16, v98
    v_and_b32 v137, s6, v98
    v_fmac_f32 v132, v136, v122
    v_fmac_f32 v133, v137, v122
    v_lshlrev_b32 v138, 16, v99
    v_and_b32 v139, s6, v99
    v_fmac_f32 v134, v138, v122
    v_fmac_f32 v135, v139, v122
    s_waitcnt lgkmcnt(0)
    s_load_dword s24, s[32:33], s92 offset:2560 glc
    s_load_dword s25, s[32:33], s92 offset:2304 glc
    s_load_dword s26, s[32:33], s92 offset:3072 glc
    s_load_dword s27, s[32:33], s92 offset:2816 glc
    s_barrier
    s_add_u32 s96, s84, 11
    s_and_b32 s97, s96, 15
    s_mul_i32 s98, s97, 393216
    s_add_u32 s99, s98, s85
    s_add_u32 s82, s99, 4294772736
    s_add_u32 m0, s83, 36864
    s_nop 0
    buffer_load_dwordx4 v3, s[40:43], s82 offen lds
    s_add_u32 s96, s84, 11
    s_and_b32 s97, s96, 15
    s_mul_i32 s98, s97, 393216
    s_add_u32 s99, s98, s85
    s_add_u32 s82, s99, 2048
    s_add_u32 m0, s83, 40960
    s_nop 0
    buffer_load_dwordx4 v3, s[40:43], s82 offen lds
    s_add_u32 s96, s84, 11
    s_and_b32 s97, s96, 15
    s_mul_i32 s98, s97, 393216
    s_add_u32 s99, s98, s85
    s_add_u32 s82, s99, 4294774784
    s_add_u32 m0, s83, 86016
    s_nop 0
    buffer_load_dwordx4 v3, s[40:43], s82 offen lds
    s_add_u32 s96, s84, 11
    s_and_b32 s97, s96, 15
    s_mul_i32 s98, s97, 393216
    s_add_u32 s99, s98, s85
    s_add_u32 s82, s99, 4096
    s_add_u32 m0, s83, 90112
    s_nop 0
    buffer_load_dwordx4 v3, s[40:43], s82 offen lds
    v_lshlrev_b32 v136, 16, v100
    v_and_b32 v137, s6, v100
    v_fmac_f32 v128, v136, v123
    v_fmac_f32 v129, v137, v123
    v_lshlrev_b32 v138, 16, v101
    v_and_b32 v139, s6, v101
    v_fmac_f32 v130, v138, v123
    v_fmac_f32 v131, v139, v123
    v_lshlrev_b32 v136, 16, v102
    v_and_b32 v137, s6, v102
    v_fmac_f32 v132, v136, v123
    v_fmac_f32 v133, v137, v123
    v_lshlrev_b32 v138, 16, v103
    v_and_b32 v139, s6, v103
    v_fmac_f32 v134, v138, v123
    v_fmac_f32 v135, v139, v123
    v_lshlrev_b32 v136, 16, v104
    v_and_b32 v137, s6, v104
    v_fmac_f32 v128, v136, v124
    v_fmac_f32 v129, v137, v124
    v_lshlrev_b32 v138, 16, v105
    v_and_b32 v139, s6, v105
    v_fmac_f32 v130, v138, v124
    v_fmac_f32 v131, v139, v124
    v_lshlrev_b32 v136, 16, v106
    v_and_b32 v137, s6, v106
    v_fmac_f32 v132, v136, v124
    v_fmac_f32 v133, v137, v124
    v_lshlrev_b32 v138, 16, v107
    v_and_b32 v139, s6, v107
    v_fmac_f32 v134, v138, v124
    v_fmac_f32 v135, v139, v124
    v_lshlrev_b32 v136, 16, v108
    v_and_b32 v137, s6, v108
    v_fmac_f32 v128, v136, v125
    v_fmac_f32 v129, v137, v125
    v_lshlrev_b32 v138, 16, v109
    v_and_b32 v139, s6, v109
    v_fmac_f32 v130, v138, v125
    v_fmac_f32 v131, v139, v125
    v_lshlrev_b32 v136, 16, v110
    v_and_b32 v137, s6, v110
    v_fmac_f32 v132, v136, v125
    v_fmac_f32 v133, v137, v125
    v_lshlrev_b32 v138, 16, v111
    v_and_b32 v139, s6, v111
    v_fmac_f32 v134, v138, v125
    v_fmac_f32 v135, v139, v125
    s_barrier
    s_add_u32 s96, s84, 12
    s_and_b32 s97, s96, 15
    s_mul_i32 s98, s97, 393216
    s_add_u32 s99, s98, s85
    s_add_u32 s82, s99, 4294772736
    s_add_u32 m0, s83, 4294963200
    s_nop 0
    buffer_load_dwordx4 v3, s[40:43], s82 offen lds
    s_add_u32 s96, s84, 12
    s_and_b32 s97, s96, 15
    s_mul_i32 s98, s97, 393216
    s_add_u32 s99, s98, s85
    s_add_u32 s82, s99, 2048
    s_mov_b32 m0, s83
    s_nop 0
    buffer_load_dwordx4 v3, s[40:43], s82 offen lds
    s_add_u32 s96, s84, 12
    s_and_b32 s97, s96, 15
    s_mul_i32 s98, s97, 393216
    s_add_u32 s99, s98, s85
    s_add_u32 s82, s99, 4294774784
    s_add_u32 m0, s83, 45056
    s_nop 0
    buffer_load_dwordx4 v3, s[40:43], s82 offen lds
    s_add_u32 s96, s84, 12
    s_and_b32 s97, s96, 15
    s_mul_i32 s98, s97, 393216
    s_add_u32 s99, s98, s85
    s_add_u32 s82, s99, 4096
    s_add_u32 m0, s83, 49152
    s_nop 0
    buffer_load_dwordx4 v3, s[40:43], s82 offen lds
    v_lshlrev_b32 v136, 16, v112
    v_and_b32 v137, s6, v112
    v_fmac_f32 v128, v136, v126
    v_fmac_f32 v129, v137, v126
    v_lshlrev_b32 v138, 16, v113
    v_and_b32 v139, s6, v113
    v_fmac_f32 v130, v138, v126
    v_fmac_f32 v131, v139, v126
    v_lshlrev_b32 v136, 16, v114
    v_and_b32 v137, s6, v114
    v_fmac_f32 v132, v136, v126
    v_fmac_f32 v133, v137, v126
    v_lshlrev_b32 v138, 16, v115
    v_and_b32 v139, s6, v115
    v_fmac_f32 v134, v138, v126
    v_fmac_f32 v135, v139, v126
    v_lshlrev_b32 v136, 16, v116
    v_and_b32 v137, s6, v116
    v_fmac_f32 v128, v136, v127
    v_fmac_f32 v129, v137, v127
    v_lshlrev_b32 v138, 16, v117
    v_and_b32 v139, s6, v117
    v_fmac_f32 v130, v138, v127
    v_fmac_f32 v131, v139, v127
    v_lshlrev_b32 v136, 16, v118
    v_and_b32 v137, s6, v118
    v_fmac_f32 v132, v136, v127
    v_fmac_f32 v133, v137, v127
    v_lshlrev_b32 v138, 16, v119
    v_and_b32 v139, s6, v119
    v_fmac_f32 v134, v138, v127
    v_fmac_f32 v135, v139, v127
    v_permlane32_swap_b32 v128, v132
    v_permlane32_swap_b32 v129, v133
    v_permlane32_swap_b32 v130, v134
    v_permlane32_swap_b32 v131, v135
    v_add_f32 v128, v128, v132
    v_add_f32 v129, v129, v133
    v_add_f32 v130, v130, v134
    v_add_f32 v131, v131, v135
    s_nop 0
    v_permlane16_swap_b32 v128, v130
    v_permlane16_swap_b32 v129, v131
    v_add_f32 v128, v128, v130
    v_add_f32 v129, v129, v131
    s_nop 0
    v_add_f32_dpp v128, v128, v128 row_ror:8 row_mask:0xf bank_mask:0xf
    v_add_f32_dpp v129, v129, v129 row_ror:8 row_mask:0xf bank_mask:0xf
    s_nop 1
    v_mov_b32_dpp v128, v129 quad_perm:[0,1,2,3] row_mask:0xf bank_mask:0xc
    ds_write_b32 v252, v128 offset:9984
    s_waitcnt lgkmcnt(0)
    s_barrier
    s_add_u32 s96, s84, 13
    s_and_b32 s97, s96, 15
    s_mul_i32 s98, s97, 393216
    s_add_u32 s99, s98, s85
    s_add_u32 s82, s99, 4294772736
    s_add_u32 m0, s83, 4096
    s_nop 0
    buffer_load_dwordx4 v3, s[40:43], s82 offen lds
    s_add_u32 s96, s84, 13
    s_and_b32 s97, s96, 15
    s_mul_i32 s98, s97, 393216
    s_add_u32 s99, s98, s85
    s_add_u32 s82, s99, 2048
    s_add_u32 m0, s83, 8192
    s_nop 0
    buffer_load_dwordx4 v3, s[40:43], s82 offen lds
    s_add_u32 s96, s84, 13
    s_and_b32 s97, s96, 15
    s_mul_i32 s98, s97, 393216
    s_add_u32 s99, s98, s85
    s_add_u32 s82, s99, 4294774784
    s_add_u32 m0, s83, 53248
    s_nop 0
    buffer_load_dwordx4 v3, s[40:43], s82 offen lds
    s_add_u32 s96, s84, 13
    s_and_b32 s97, s96, 15
    s_mul_i32 s98, s97, 393216
    s_add_u32 s99, s98, s85
    s_add_u32 s82, s99, 4096
    s_add_u32 m0, s83, 57344
    s_nop 0
    buffer_load_dwordx4 v3, s[40:43], s82 offen lds
    s_cmp_lg_u32 s3, 4
    s_cbranch_scc1 L_M2F
    ds_read_b128 v[128:131], v251 offset:10000
    s_lshr_b32 s96, s8, 2
    s_lshl1_add_u32 s97, s9, s96
    s_and_b32 s98, s8, 3
    s_lshl2_add_u32 s99, s97, s98
    s_lshl_b32 s96, s99, 9
    s_add_u32 s13, s96, 131072
    s_waitcnt lgkmcnt(0)
    v_add_f32 v128, v128, v129
    v_add_f32 v130, v130, v131
    v_mov_b32 v129, s4
    v_add_f32 v128, v128, v130
    buffer_store_dwordx2 v[128:129], v250, s[32:35], s13 offen sc1
L_M2F:
    s_lshl_b32 s96, s74, 13
    s_sub_u32 s97, s3, 4
    s_lshl_b32 s98, s97, 8
    s_add_u32 s99, s96, s98
    s_add_u32 s13, s99, 20971520
    s_waitcnt lgkmcnt(0)
    s_load_dword s24, s[32:33], s13 offset:1276 glc
    s_load_dword s25, s[32:33], s13 offset:3324 glc
    s_load_dword s26, s[32:33], s13 offset:5372 glc
    s_load_dword s27, s[32:33], s13 offset:7420 glc
    s_waitcnt vmcnt(18)
    s_waitcnt vmcnt(16)
    s_barrier
    s_add_u32 s96, s84, 14
    s_and_b32 s97, s96, 15
    s_mul_i32 s98, s97, 393216
    s_add_u32 s99, s98, s85
    s_add_u32 s82, s99, 4294772736
    s_add_u32 m0, s83, 12288
    s_nop 0
    buffer_load_dwordx4 v3, s[40:43], s82 offen lds
    s_add_u32 s96, s84, 14
    s_and_b32 s97, s96, 15
    s_mul_i32 s98, s97, 393216
    s_add_u32 s99, s98, s85
    s_add_u32 s82, s99, 2048
    s_add_u32 m0, s83, 16384
    s_nop 0
    buffer_load_dwordx4 v3, s[40:43], s82 offen lds
    s_waitcnt vmcnt(16)
    s_waitcnt vmcnt(12)
    s_barrier
    s_add_u32 s96, s84, 15
    s_and_b32 s97, s96, 15
    s_mul_i32 s98, s97, 393216
    s_add_u32 s99, s98, s85
    s_add_u32 s82, s99, 4294772736
    s_add_u32 m0, s83, 20480
    s_nop 0
    buffer_load_dwordx4 v3, s[40:43], s82 offen lds
    s_add_u32 s96, s84, 15
    s_and_b32 s97, s96, 15
    s_mul_i32 s98, s97, 393216
    s_add_u32 s99, s98, s85
    s_add_u32 s82, s99, 2048
    s_add_u32 m0, s83, 24576
    s_nop 0
    buffer_load_dwordx4 v3, s[40:43], s82 offen lds
    s_waitcnt vmcnt(10)
    s_waitcnt vmcnt(6)
    s_waitcnt vmcnt(2)
    s_barrier
    s_add_u32 s96, s84, 14
    s_and_b32 s97, s96, 15
    s_mul_i32 s98, s97, 393216
    s_add_u32 s99, s98, s85
    s_add_u32 s82, s99, 4294774784
    s_add_u32 m0, s83, 61440
    s_nop 0
    buffer_load_dwordx4 v3, s[40:43], s82 offen lds
    s_add_u32 s96, s84, 14
    s_and_b32 s97, s96, 15
    s_mul_i32 s98, s97, 393216
    s_add_u32 s99, s98, s85
    s_add_u32 s82, s99, 4096
    s_add_u32 m0, s83, 65536
    s_nop 0
    buffer_load_dwordx4 v3, s[40:43], s82 offen lds
    s_add_u32 s96, s84, 15
    s_and_b32 s97, s96, 15
    s_mul_i32 s98, s97, 393216
    s_add_u32 s99, s98, s85
    s_add_u32 s82, s99, 4294774784
    s_add_u32 m0, s83, 69632
    s_nop 0
    buffer_load_dwordx4 v3, s[40:43], s82 offen lds
    s_add_u32 s96, s84, 15
    s_and_b32 s97, s96, 15
    s_mul_i32 s98, s97, 393216
    s_add_u32 s99, s98, s85
    s_add_u32 s82, s99, 4096
    s_add_u32 m0, s83, 73728
    s_nop 0
    buffer_load_dwordx4 v3, s[40:43], s82 offen lds
    s_waitcnt vmcnt(4)
    s_barrier
    s_add_u32 s96, s84, 10
    s_and_b32 s97, s96, 15
    s_mul_i32 s98, s97, 393216
    s_add_u32 s99, s98, s85
    s_add_u32 s82, s99, 4294770688
    s_add_u32 m0, s83, 126976
    s_nop 0
    buffer_load_dwordx4 v3, s[40:43], s82 offen lds
    s_add_u32 s96, s84, 10
    s_and_b32 s97, s96, 15
    s_mul_i32 s98, s97, 393216
    s_add_u32 s82, s98, s85
    s_add_u32 m0, s83, 131072
    s_nop 0
    buffer_load_dwordx4 v3, s[40:43], s82 offen lds
    s_add_u32 s96, s84, 11
    s_and_b32 s97, s96, 15
    s_mul_i32 s98, s97, 393216
    s_add_u32 s99, s98, s85
    s_add_u32 s82, s99, 4294770688
    s_add_u32 m0, s83, 135168
    s_nop 0
    buffer_load_dwordx4 v3, s[40:43], s82 offen lds
    s_add_u32 s96, s84, 11
    s_and_b32 s97, s96, 15
    s_mul_i32 s98, s97, 393216
    s_add_u32 s82, s98, s85
    s_add_u32 m0, s83, 139264
    s_nop 0
    buffer_load_dwordx4 v3, s[40:43], s82 offen lds
    s_waitcnt lgkmcnt(0)
    s_barrier
    s_add_u32 s96, s84, 12
    s_and_b32 s97, s96, 15
    s_mul_i32 s98, s97, 393216
    s_add_u32 s99, s98, s85
    s_add_u32 s82, s99, 4294770688
    s_add_u32 m0, s83, 94208
    s_nop 0
    buffer_load_dwordx4 v3, s[40:43], s82 offen lds
    s_add_u32 s96, s84, 12
    s_and_b32 s97, s96, 15
    s_mul_i32 s98, s97, 393216
    s_add_u32 s82, s98, s85
    s_add_u32 m0, s83, 98304
    s_nop 0
    buffer_load_dwordx4 v3, s[40:43], s82 offen lds
    s_add_u32 s96, s84, 13
    s_and_b32 s97, s96, 15
    s_mul_i32 s98, s97, 393216
    s_add_u32 s99, s98, s85
    s_add_u32 s82, s99, 4294770688
    s_add_u32 m0, s83, 102400
    s_nop 0
    buffer_load_dwordx4 v3, s[40:43], s82 offen lds
    s_add_u32 s96, s84, 13
    s_and_b32 s97, s96, 15
    s_mul_i32 s98, s97, 393216
    s_add_u32 s82, s98, s85
    s_add_u32 m0, s83, 106496
    s_nop 0
    buffer_load_dwordx4 v3, s[40:43], s82 offen lds
    s_setprio 3
    ds_read_b128 v[152:155], v0
    ds_read_b128 v[156:159], v0 offset:1024
    v_subrev_u32 v0, 118784, v0
    s_waitcnt lgkmcnt(1)
    v_mfma_f32_32x32x16_bf16 v[184:199], v[168:171], v[152:155], 0
    s_waitcnt lgkmcnt(0)
    v_mfma_f32_32x32x16_bf16 v[184:199], v[172:175], v[156:159], v[184:199]
    s_setprio 0
    s_nop 10
    v_cvt_pk_bf16_f32 v184, 0, v184
    v_cvt_pk_bf16_f32 v185, 0, v185
    v_cvt_pk_bf16_f32 v186, 0, v186
    v_cvt_pk_bf16_f32 v187, 0, v187
    v_cvt_pk_bf16_f32 v188, 0, v188
    v_cvt_pk_bf16_f32 v189, 0, v189
    v_cvt_pk_bf16_f32 v190, 0, v190
    v_cvt_pk_bf16_f32 v191, 0, v191
    v_cvt_pk_bf16_f32 v192, 0, v192
    v_cvt_pk_bf16_f32 v193, 0, v193
    v_cvt_pk_bf16_f32 v194, 0, v194
    v_cvt_pk_bf16_f32 v195, 0, v195
    v_cvt_pk_bf16_f32 v196, 0, v196
    v_cvt_pk_bf16_f32 v197, 0, v197
    v_cvt_pk_bf16_f32 v198, 0, v198
    v_cvt_pk_bf16_f32 v199, 0, v199
    v_max3_f32 v4, v184, v185, v186
    v_min3_f32 v5, v184, v185, v186
    v_max3_f32 v4, v4, v187, v188
    v_min3_f32 v5, v5, v187, v188
    v_max3_f32 v4, v4, v189, v190
    v_min3_f32 v5, v5, v189, v190
    v_max3_f32 v4, v4, v191, v192
    v_min3_f32 v5, v5, v191, v192
    v_max3_f32 v4, v4, v193, v194
    v_min3_f32 v5, v5, v193, v194
    v_max3_f32 v4, v4, v195, v196
    v_min3_f32 v5, v5, v195, v196
    v_max3_f32 v4, v4, v197, v198
    v_min3_f32 v5, v5, v197, v198
    v_max_f32 v6, v4, v199
    v_min_f32 v7, v5, v199
    v_max_f32 v4, v4, v199
    v_min_f32 v5, v5, v199
    s_nop 0
    v_permlane32_swap_b32 v4, v6
    v_permlane32_swap_b32 v5, v7
    v_max_f32 v4, v4, v6
    v_min_f32 v5, v5, v7
    v_mul_f32_e64 v4, v4, s7
    v_mul_f32_e64 v5, v5, s7
    v_fma_f32 v216, v184, s7, -v4
    v_fma_f32 v217, v185, s7, -v4
    v_fma_f32 v184, -v184, s7, v5
    v_fma_f32 v185, -v185, s7, v5
    v_fma_f32 v218, v186, s7, -v4
    v_fma_f32 v219, v187, s7, -v4
    v_fma_f32 v186, -v186, s7, v5
    v_fma_f32 v187, -v187, s7, v5
    s_waitcnt vmcnt(10)
    s_waitcnt vmcnt(8)
    s_waitcnt vmcnt(6)
    s_barrier
    s_add_u32 s96, s84, 14
    s_and_b32 s97, s96, 15
    s_mul_i32 s98, s97, 393216
    s_add_u32 s99, s98, s85
    s_add_u32 s82, s99, 4294770688
    s_add_u32 m0, s83, 110592
    s_nop 0
    buffer_load_dwordx4 v3, s[40:43], s82 offen lds
    s_add_u32 s96, s84, 14
    s_and_b32 s97, s96, 15
    s_mul_i32 s98, s97, 393216
    s_add_u32 s82, s98, s85
    s_add_u32 m0, s83, 114688
    s_nop 0
    buffer_load_dwordx4 v3, s[40:43], s82 offen lds
    s_add_u32 s96, s84, 15
    s_and_b32 s97, s96, 15
    s_mul_i32 s98, s97, 393216
    s_add_u32 s99, s98, s85
    s_add_u32 s82, s99, 4294770688
    s_add_u32 m0, s83, 118784
    s_nop 0
    buffer_load_dwordx4 v3, s[40:43], s82 offen lds
    s_add_u32 s96, s84, 15
    s_and_b32 s97, s96, 15
    s_mul_i32 s98, s97, 393216
    s_add_u32 s82, s98, s85
    s_add_u32 m0, s83, 122880
    s_nop 0
    buffer_load_dwordx4 v3, s[40:43], s82 offen lds
    s_setprio 3
    ds_read_b128 v[152:155], v0
    ds_read_b128 v[156:159], v0 offset:1024
    s_waitcnt lgkmcnt(1)
    v_mfma_f32_32x32x16_bf16 v[200:215], v[176:179], v[152:155], 0
    s_waitcnt lgkmcnt(0)
    v_mfma_f32_32x32x16_bf16 v[200:215], v[180:183], v[156:159], v[200:215]
    s_setprio 0
    v_fma_f32 v220, v188, s7, -v4
    v_fma_f32 v221, v189, s7, -v4
    v_fma_f32 v188, -v188, s7, v5
    v_fma_f32 v189, -v189, s7, v5
    v_fma_f32 v222, v190, s7, -v4
    s_mov_b32 s82, s80
    buffer_load_dwordx4 v[56:59], v27, s[52:55], s82 offen nt
    v_fma_f32 v223, v191, s7, -v4
    v_fma_f32 v190, -v190, s7, v5
    v_fma_f32 v191, -v191, s7, v5
    v_fma_f32 v224, v192, s7, -v4
    v_fma_f32 v225, v193, s7, -v4
    v_fma_f32 v192, -v192, s7, v5
    v_fma_f32 v193, -v193, s7, v5
    v_fma_f32 v226, v194, s7, -v4
    v_fma_f32 v227, v195, s7, -v4
    v_fma_f32 v194, -v194, s7, v5
    v_fma_f32 v195, -v195, s7, v5
    v_fma_f32 v228, v196, s7, -v4
    v_fma_f32 v229, v197, s7, -v4
    v_fma_f32 v196, -v196, s7, v5
    v_fma_f32 v197, -v197, s7, v5
    v_fma_f32 v230, v198, s7, -v4
    v_fma_f32 v231, v199, s7, -v4
    v_fma_f32 v198, -v198, s7, v5
    v_fma_f32 v199, -v199, s7, v5
    v_exp_f32 v216, v216
    s_add_u32 s82, s80, 4294049792
    buffer_load_dwordx4 v[60:63], v27, s[52:55], s82 offen nt
    v_exp_f32 v184, v184
    v_exp_f32 v217, v217
    v_exp_f32 v185, v185
    v_exp_f32 v218, v218
    v_exp_f32 v186, v186
    v_exp_f32 v219, v219
    v_exp_f32 v187, v187
    v_exp_f32 v220, v220
    v_exp_f32 v188, v188
    v_exp_f32 v221, v221
    v_exp_f32 v189, v189
    v_exp_f32 v222, v222
    v_exp_f32 v190, v190
    v_exp_f32 v223, v223
    v_exp_f32 v191, v191
    v_exp_f32 v224, v224
    v_exp_f32 v192, v192
    v_exp_f32 v225, v225
    v_exp_f32 v193, v193
    v_exp_f32 v226, v226
    s_add_u32 s82, s80, 57344
    buffer_load_dwordx4 v[64:67], v27, s[52:55], s82 offen nt
    v_exp_f32 v194, v194
    v_exp_f32 v227, v227
    v_exp_f32 v195, v195
    v_exp_f32 v228, v228
    v_exp_f32 v196, v196
    v_exp_f32 v229, v229
    v_exp_f32 v197, v197
    v_exp_f32 v230, v230
    v_exp_f32 v198, v198
    v_exp_f32 v231, v231
    v_exp_f32 v199, v199
    v_add_f32 v8, v216, v218
    v_add_f32 v9, v217, v219
    v_add_f32 v10, v184, v186
    v_add_f32 v11, v185, v187
    v_add_f32 v8, v8, v220
    v_add_f32 v9, v9, v221
    v_add_f32 v10, v10, v188
    v_add_f32 v11, v11, v189
    v_add_f32 v8, v8, v222
    s_add_u32 s82, s80, 4294107136
    buffer_load_dwordx4 v[68:71], v27, s[52:55], s82 offen nt
    v_add_f32 v9, v9, v223
    v_add_f32 v10, v10, v190
    v_add_f32 v11, v11, v191
    v_add_f32 v8, v8, v224
    v_add_f32 v9, v9, v225
    v_add_f32 v10, v10, v192
    v_add_f32 v11, v11, v193
    v_add_f32 v8, v8, v226
    v_add_f32 v9, v9, v227
    v_add_f32 v10, v10, v194
    v_add_f32 v11, v11, v195
    v_add_f32 v8, v8, v228
    v_add_f32 v9, v9, v229
    v_add_f32 v10, v10, v196
    v_add_f32 v11, v11, v197
    v_add_f32 v8, v8, v230
    v_add_f32 v9, v9, v231
    v_add_f32 v10, v10, v198
    v_add_f32 v11, v11, v199
    v_add_f32 v6, v8, v9
    s_add_u32 s82, s80, 114688
    buffer_load_dwordx4 v[72:75], v27, s[52:55], s82 offen nt
    v_add_f32 v7, v10, v11
    v_add_f32 v4, v8, v9
    v_add_f32 v5, v10, v11
    s_nop 0
    v_permlane32_swap_b32 v4, v6
    v_permlane32_swap_b32 v5, v7
    v_add_f32 v4, v4, v6
    v_add_f32 v5, v5, v7
    v_rcp_f32 v4, v4
    v_rcp_f32 v5, v5
    v_mul_f32 v216, v216, v4
    v_mul_f32 v217, v217, v4
    v_mul_f32 v184, v184, v5
    v_mul_f32 v185, v185, v5
    v_mul_f32 v218, v218, v4
    v_mul_f32 v219, v219, v4
    v_mul_f32 v186, v186, v5
    v_mul_f32 v187, v187, v5
    v_mul_f32 v220, v220, v4
    v_mul_f32 v221, v221, v4
    v_mul_f32 v188, v188, v5
    s_add_u32 s82, s80, 4294164480
    buffer_load_dwordx4 v[76:79], v27, s[52:55], s82 offen nt
    v_mul_f32 v189, v189, v5
    v_mul_f32 v222, v222, v4
    v_mul_f32 v223, v223, v4
    v_mul_f32 v190, v190, v5
    v_mul_f32 v191, v191, v5
    v_mul_f32 v224, v224, v4
    v_mul_f32 v225, v225, v4
    v_mul_f32 v192, v192, v5
    v_mul_f32 v193, v193, v5
    v_mul_f32 v226, v226, v4
    v_mul_f32 v227, v227, v4
    v_mul_f32 v194, v194, v5
    v_mul_f32 v195, v195, v5
    v_mul_f32 v228, v228, v4
    v_mul_f32 v229, v229, v4
    v_mul_f32 v196, v196, v5
    v_mul_f32 v197, v197, v5
    v_mul_f32 v230, v230, v4
    v_mul_f32 v231, v231, v4
    v_mul_f32 v198, v198, v5
    s_add_u32 s82, s80, 172032
    buffer_load_dwordx4 v[80:83], v27, s[52:55], s82 offen nt
    v_mul_f32 v199, v199, v5
    v_cvt_pk_bf16_f32 v216, v216, v217
    v_cvt_pk_bf16_f32 v217, v218, v219
    v_cvt_pk_bf16_f32 v218, v220, v221
    v_cvt_pk_bf16_f32 v219, v222, v223
    v_cvt_pk_bf16_f32 v220, v224, v225
    v_cvt_pk_bf16_f32 v221, v226, v227
    v_cvt_pk_bf16_f32 v222, v228, v229
    v_cvt_pk_bf16_f32 v223, v230, v231
    ds_write_b128 v232, v[216:219]
L_PAD6:
    s_cbranch_execz L_RET6
    v_cvt_pk_bf16_f32 v224, v184, v185
    v_cvt_pk_bf16_f32 v225, v186, v187
    v_cvt_pk_bf16_f32 v226, v188, v189
    v_cvt_pk_bf16_f32 v227, v190, v191
    ds_write_b128 v232, v[220:223] offset:4096
    ds_write_b128 v232, v[224:227] offset:8192
    v_cvt_pk_bf16_f32 v228, v192, v193
    v_cvt_pk_bf16_f32 v229, v194, v195
    v_cvt_pk_bf16_f32 v230, v196, v197
    v_cvt_pk_bf16_f32 v231, v198, v199
    s_add_u32 s82, s80, 4294221824
    buffer_load_dwordx4 v[84:87], v27, s[52:55], s82 offen nt
    ds_write_b128 v232, v[228:231] offset:12288
    s_waitcnt vmcnt(16)
    s_waitcnt vmcnt(14)
    s_waitcnt vmcnt(12)
    s_waitcnt vmcnt(10)
    s_waitcnt vmcnt(8)
    s_barrier
    v_cvt_pk_bf16_f32 v200, 0, v200
    v_cvt_pk_bf16_f32 v201, 0, v201
    v_cvt_pk_bf16_f32 v202, 0, v202
    v_cvt_pk_bf16_f32 v203, 0, v203
    s_xor_b32 s96, s95, 786432
    s_add_u32 s97, s96, s90
    s_sub_u32 s82, s97, 65536
    s_add_u32 m0, s83, 45056
    s_nop 0
    buffer_load_dwordx4 v26, s[44:47], s82 offen lds
    v_cvt_pk_bf16_f32 v204, 0, v204
    v_cvt_pk_bf16_f32 v205, 0, v205
    v_cvt_pk_bf16_f32 v206, 0, v206
    v_cvt_pk_bf16_f32 v207, 0, v207
    v_cvt_pk_bf16_f32 v208, 0, v208
    v_cvt_pk_bf16_f32 v209, 0, v209
    v_cvt_pk_bf16_f32 v210, 0, v210
    v_cvt_pk_bf16_f32 v211, 0, v211
    v_cvt_pk_bf16_f32 v212, 0, v212
    v_cvt_pk_bf16_f32 v213, 0, v213
    v_cvt_pk_bf16_f32 v214, 0, v214
    v_cvt_pk_bf16_f32 v215, 0, v215
    v_max3_f32 v4, v200, v201, v202
    v_min3_f32 v5, v200, v201, v202
    s_xor_b32 s96, s95, 786432
    s_add_u32 s82, s96, s90
    s_add_u32 m0, s83, 49152
    s_nop 0
    buffer_load_dwordx4 v26, s[44:47], s82 offen lds
    v_max3_f32 v4, v4, v203, v204
    v_min3_f32 v5, v5, v203, v204
    v_max3_f32 v4, v4, v205, v206
    v_min3_f32 v5, v5, v205, v206
    v_max3_f32 v4, v4, v207, v208
    v_min3_f32 v5, v5, v207, v208
    v_max3_f32 v4, v4, v209, v210
    v_min3_f32 v5, v5, v209, v210
    v_max3_f32 v4, v4, v211, v212
    v_min3_f32 v5, v5, v211, v212
    v_max3_f32 v4, v4, v213, v214
    v_min3_f32 v5, v5, v213, v214
    v_max_f32 v6, v4, v215
    v_min_f32 v7, v5, v215
    s_xor_b32 s96, s95, 917504
    s_add_u32 s97, s96, s90
    s_sub_u32 s82, s97, 65536
    s_add_u32 m0, s83, 53248
    s_nop 0
    buffer_load_dwordx4 v26, s[44:47], s82 offen lds
    v_max_f32 v4, v4, v215
    s_waitcnt lgkmcnt(0)
    v_min_f32 v5, v5, v215
    v_permlane32_swap_b32 v4, v6
    s_nop 0
    v_permlane32_swap_b32 v5, v7
    v_max_f32 v4, v4, v6
    v_min_f32 v5, v5, v7
    v_mul_f32_e64 v4, v4, s7
    v_mul_f32_e64 v5, v5, s7
    v_fma_f32 v216, v200, s7, -v4
    v_fma_f32 v217, v201, s7, -v4
    v_fma_f32 v200, -v200, s7, v5
    v_fma_f32 v201, -v201, s7, v5
    v_fma_f32 v218, v202, s7, -v4
    s_xor_b32 s96, s95, 917504
    s_add_u32 s82, s96, s90
    s_add_u32 m0, s83, 57344
    s_nop 0
    buffer_load_dwordx4 v26, s[44:47], s82 offen lds
    v_fma_f32 v219, v203, s7, -v4
    v_fma_f32 v202, -v202, s7, v5
    v_fma_f32 v203, -v203, s7, v5
    v_fma_f32 v220, v204, s7, -v4
    v_fma_f32 v221, v205, s7, -v4
    v_fma_f32 v204, -v204, s7, v5
    v_fma_f32 v205, -v205, s7, v5
    v_fma_f32 v222, v206, s7, -v4
    v_fma_f32 v223, v207, s7, -v4
    v_fma_f32 v206, -v206, s7, v5
    v_fma_f32 v207, -v207, s7, v5
    v_fma_f32 v224, v208, s7, -v4
    v_fma_f32 v225, v209, s7, -v4
    v_fma_f32 v208, -v208, s7, v5
    s_xor_b32 s96, s95, 1048576
    s_add_u32 s97, s96, s90
    s_sub_u32 s82, s97, 65536
    s_add_u32 m0, s83, 61440
    s_nop 0
    buffer_load_dwordx4 v26, s[44:47], s82 offen lds
    v_fma_f32 v209, -v209, s7, v5
    v_fma_f32 v226, v210, s7, -v4
    v_fma_f32 v227, v211, s7, -v4
    v_fma_f32 v210, -v210, s7, v5
    v_fma_f32 v211, -v211, s7, v5
    v_fma_f32 v228, v212, s7, -v4
    v_fma_f32 v229, v213, s7, -v4
    v_fma_f32 v212, -v212, s7, v5
    v_fma_f32 v213, -v213, s7, v5
    v_fma_f32 v230, v214, s7, -v4
    v_fma_f32 v231, v215, s7, -v4
    v_fma_f32 v214, -v214, s7, v5
    v_fma_f32 v215, -v215, s7, v5
    v_exp_f32 v216, v216
    s_xor_b32 s96, s95, 1048576
    s_add_u32 s82, s96, s90
    s_add_u32 m0, s83, 65536
    s_nop 0
    buffer_load_dwordx4 v26, s[44:47], s82 offen lds
    v_exp_f32 v200, v200
    v_exp_f32 v217, v217
    v_exp_f32 v201, v201
    v_exp_f32 v218, v218
    v_exp_f32 v202, v202
    v_exp_f32 v219, v219
    v_exp_f32 v203, v203
    v_exp_f32 v220, v220
    v_exp_f32 v204, v204
    v_exp_f32 v221, v221
    v_exp_f32 v205, v205
    v_exp_f32 v222, v222
    v_exp_f32 v206, v206
    v_exp_f32 v223, v223
    s_xor_b32 s96, s95, 1179648
    s_add_u32 s97, s96, s90
    s_sub_u32 s82, s97, 65536
    s_add_u32 m0, s83, 69632
    s_nop 0
    buffer_load_dwordx4 v26, s[44:47], s82 offen lds
    v_exp_f32 v207, v207
    v_exp_f32 v224, v224
    v_exp_f32 v208, v208
    v_exp_f32 v225, v225
    v_exp_f32 v209, v209
    v_exp_f32 v226, v226
    v_exp_f32 v210, v210
    v_exp_f32 v227, v227
    v_exp_f32 v211, v211
    v_exp_f32 v228, v228
    v_exp_f32 v212, v212
    v_exp_f32 v229, v229
    v_exp_f32 v213, v213
    v_exp_f32 v230, v230
    s_xor_b32 s96, s95, 1179648
    s_add_u32 s82, s96, s90
    s_add_u32 m0, s83, 73728
    s_nop 0
    buffer_load_dwordx4 v26, s[44:47], s82 offen lds
    v_exp_f32 v214, v214
    v_exp_f32 v231, v231
    v_exp_f32 v215, v215
    v_add_f32 v8, v216, v218
    v_add_f32 v9, v217, v219
    v_add_f32 v10, v200, v202
    v_add_f32 v11, v201, v203
    v_add_f32 v8, v8, v220
    v_add_f32 v9, v9, v221
    v_add_f32 v10, v10, v204
    v_add_f32 v11, v11, v205
    v_add_f32 v8, v8, v222
    v_add_f32 v9, v9, v223
    v_add_f32 v10, v10, v206
    s_xor_b32 s96, s95, 1310720
    s_add_u32 s97, s96, s90
    s_sub_u32 s82, s97, 65536
    s_add_u32 m0, s83, 77824
    s_nop 0
    buffer_load_dwordx4 v26, s[44:47], s82 offen lds
    v_add_f32 v11, v11, v207
    v_add_f32 v8, v8, v224
    v_add_f32 v9, v9, v225
    v_add_f32 v10, v10, v208
    v_add_f32 v11, v11, v209
    v_add_f32 v8, v8, v226
    v_add_f32 v9, v9, v227
    v_add_f32 v10, v10, v210
    v_add_f32 v11, v11, v211
    v_add_f32 v8, v8, v228
    v_add_f32 v9, v9, v229
    v_add_f32 v10, v10, v212
    v_add_f32 v11, v11, v213
    v_add_f32 v8, v8, v230
    s_xor_b32 s96, s95, 1310720
    s_add_u32 s82, s96, s90
    s_add_u32 m0, s83, 81920
    s_nop 0
    buffer_load_dwordx4 v26, s[44:47], s82 offen lds
    v_add_f32 v9, v9, v231
    v_add_f32 v10, v10, v214
    v_add_f32 v11, v11, v215
    v_add_f32 v6, v8, v9
    v_add_f32 v7, v10, v11
    v_add_f32 v4, v8, v9
    v_add_f32 v5, v10, v11
    s_nop 0
    v_permlane32_swap_b32 v4, v6
    v_permlane32_swap_b32 v5, v7
    v_add_f32 v4, v4, v6
    v_add_f32 v5, v5, v7
    v_rcp_f32 v4, v4
    v_rcp_f32 v5, v5
    v_mul_f32 v216, v216, v4
    s_xor_b32 s96, s95, 1441792
    s_add_u32 s97, s96, s90
    s_sub_u32 s82, s97, 65536
    s_add_u32 m0, s83, 86016
    s_nop 0
    buffer_load_dwordx4 v26, s[44:47], s82 offen lds
    v_mul_f32 v217, v217, v4
    v_mul_f32 v200, v200, v5
    v_mul_f32 v201, v201, v5
    v_mul_f32 v218, v218, v4
    v_mul_f32 v219, v219, v4
    v_mul_f32 v202, v202, v5
    v_mul_f32 v203, v203, v5
    v_mul_f32 v220, v220, v4
    v_mul_f32 v221, v221, v4
    v_mul_f32 v204, v204, v5
    v_mul_f32 v205, v205, v5
    v_mul_f32 v222, v222, v4
    v_mul_f32 v223, v223, v4
    v_mul_f32 v206, v206, v5
    s_xor_b32 s96, s95, 1441792
    s_add_u32 s82, s96, s90
    s_add_u32 m0, s83, 90112
    s_nop 0
    buffer_load_dwordx4 v26, s[44:47], s82 offen lds
    v_mul_f32 v207, v207, v5
    v_mul_f32 v224, v224, v4
    v_mul_f32 v225, v225, v4
    v_mul_f32 v208, v208, v5
    v_mul_f32 v209, v209, v5
    v_mul_f32 v226, v226, v4
    v_mul_f32 v227, v227, v4
    v_mul_f32 v210, v210, v5
    v_mul_f32 v211, v211, v5
    v_mul_f32 v228, v228, v4
    v_mul_f32 v229, v229, v4
    v_mul_f32 v212, v212, v5
    v_mul_f32 v213, v213, v5
    v_mul_f32 v230, v230, v4
    v_mul_f32 v231, v231, v4
    v_mul_f32 v214, v214, v5
    v_mul_f32 v215, v215, v5
    v_cvt_pk_bf16_f32 v216, v216, v217
    v_cvt_pk_bf16_f32 v217, v218, v219
    v_cvt_pk_bf16_f32 v218, v220, v221
    v_cvt_pk_bf16_f32 v219, v222, v223
    v_cvt_pk_bf16_f32 v220, v224, v225
    v_cvt_pk_bf16_f32 v221, v226, v227
    v_cvt_pk_bf16_f32 v222, v228, v229
    v_cvt_pk_bf16_f32 v223, v230, v231
    ds_write_b128 v232, v[216:219] offset:16384
    v_cvt_pk_bf16_f32 v224, v200, v201
    v_cvt_pk_bf16_f32 v225, v202, v203
    v_cvt_pk_bf16_f32 v226, v204, v205
    v_cvt_pk_bf16_f32 v227, v206, v207
    ds_write_b128 v232, v[220:223] offset:20480
    ds_write_b128 v232, v[224:227] offset:24576
    v_cvt_pk_bf16_f32 v228, v208, v209
    v_cvt_pk_bf16_f32 v229, v210, v211
    v_cvt_pk_bf16_f32 v230, v212, v213
    v_cvt_pk_bf16_f32 v231, v214, v215
    ds_write_b128 v232, v[228:231] offset:28672
    s_lshl_b32 s96, s77, 11
    s_add_u32 s14, s96, 151552
    v_add_u32 v0, s14, v2
    s_setprio 0
L_JOIN:
    v_and_b32 v45, 1, v1
    v_lshlrev_b32 v45, 3, v45
    v_bfe_u32 v9, v1, 2, 2
    v_lshl_add_u32 v45, v9, 4, v45
    v_bfe_u32 v9, v1, 4, 1
    v_lshl_add_u32 v45, v9, 6, v45
    v_bfe_u32 v9, v1, 1, 1
    v_lshl_add_u32 v45, v9, 7, v45
    v_lshrrev_b32 v9, 5, v1
    v_lshl_add_u32 v45, v9, 8, v45
    s_lshl_b32 s13, s3, 12
    v_add_u32 v44, s13, v45
    s_lshl_b32 s96, s76, 13
    s_add_u32 s13, s96, 32768
    v_add_u32 v45, s13, v45
    v_mov_b32 v244, 0x3f803f80
    v_mov_b32 v245, 0x3f803f80
    v_mov_b32 v246, 0x3f803f80
    v_mov_b32 v247, 0x3f803f80
    s_lshl3_add_u32 s96, s11, s3
    s_lshl_b32 s97, s96, 5
    s_add_u32 s98, s97, s10
    s_lshl_b32 s99, s98, 10
    s_add_u32 s13, s99, 25165824
    s_add_u32 s15, s13, 16384
    s_lshl3_add_u32 s96, s11, s3
    s_lshl_b32 s97, s96, 10
    s_add_u32 s16, s97, 21495808
    s_lshl_b32 s96, s10, 6
    s_add_u32 s14, s96, s16
    s_waitcnt lgkmcnt(0)
    s_barrier
    ds_read_b64_tr_b16 v[184:185], v44
    ds_read_b64_tr_b16 v[186:187], v44 offset:512
    ds_read_b64_tr_b16 v[200:201], v45
    ds_read_b64_tr_b16 v[202:203], v45 offset:512
    ds_read_b64_tr_b16 v[204:205], v45 offset:1024
    ds_read_b64_tr_b16 v[206:207], v45 offset:1536
    ds_read_b64_tr_b16 v[188:189], v44 offset:1024
    ds_read_b64_tr_b16 v[190:191], v44 offset:1536
    ds_read_b64_tr_b16 v[208:209], v45 offset:2048
    ds_read_b64_tr_b16 v[210:211], v45 offset:2560
    ds_read_b64_tr_b16 v[212:213], v45 offset:3072
    ds_read_b64_tr_b16 v[214:215], v45 offset:3584
    ds_read_b64_tr_b16 v[192:193], v44 offset:2048
    ds_read_b64_tr_b16 v[194:195], v44 offset:2560
    ds_read_b64_tr_b16 v[216:217], v45 offset:4096
    ds_read_b64_tr_b16 v[218:219], v45 offset:4608
    ds_read_b64_tr_b16 v[220:221], v45 offset:5120
    ds_read_b64_tr_b16 v[222:223], v45 offset:5632
    s_waitcnt lgkmcnt(12)
    v_mfma_f32_16x16x32_bf16 v[232:235], v[184:187], v[200:203], 0
    v_mfma_f32_16x16x32_bf16 v[236:239], v[184:187], v[204:207], 0
    v_mfma_f32_16x16x32_bf16 v[240:243], v[184:187], v[244:247], 0
    ds_read_b64_tr_b16 v[196:197], v44 offset:3072
    ds_read_b64_tr_b16 v[198:199], v44 offset:3584
    ds_read_b64_tr_b16 v[224:225], v45 offset:6144
    ds_read_b64_tr_b16 v[226:227], v45 offset:6656
    ds_read_b64_tr_b16 v[228:229], v45 offset:7168
    ds_read_b64_tr_b16 v[230:231], v45 offset:7680
    s_waitcnt lgkmcnt(12)
    v_mfma_f32_16x16x32_bf16 v[232:235], v[188:191], v[208:211], v[232:235]
    v_mfma_f32_16x16x32_bf16 v[236:239], v[188:191], v[212:215], v[236:239]
    v_mfma_f32_16x16x32_bf16 v[240:243], v[188:191], v[244:247], v[240:243]
    s_waitcnt lgkmcnt(6)
    v_mfma_f32_16x16x32_bf16 v[232:235], v[192:195], v[216:219], v[232:235]
    v_mfma_f32_16x16x32_bf16 v[236:239], v[192:195], v[220:223], v[236:239]
    v_mfma_f32_16x16x32_bf16 v[240:243], v[192:195], v[244:247], v[240:243]
    s_waitcnt lgkmcnt(0)
    v_mfma_f32_16x16x32_bf16 v[232:235], v[196:199], v[224:227], v[232:235]
    v_mfma_f32_16x16x32_bf16 v[236:239], v[196:199], v[228:231], v[236:239]
    v_mfma_f32_16x16x32_bf16 v[240:243], v[196:199], v[244:247], v[240:243]
    s_cmp_lt_u32 s3, 4
    s_cbranch_scc1 L_NOQX
    ds_read_b128 v[168:171], v0
    ds_read_b128 v[172:175], v0 offset:1024
L_NOQX:
    s_nop 3
    buffer_store_dwordx4 v[232:235], v2, s[32:35], s13 offen sc1
    buffer_store_dwordx4 v[236:239], v2, s[32:35], s15 offen sc1
    s_mov_b32 exec_lo, 0x00010001
    s_mov_b32 exec_hi, 0x00010001
    buffer_store_dwordx4 v[240:243], v1, s[32:35], s14 offen sc1
    s_mov_b64 exec, -1
    s_waitcnt lgkmcnt(0)
    v_mfma_f32_32x32x16_bf16 v[120:135], v[176:179], v[168:171], 0
    v_mfma_f32_32x32x16_bf16 v[120:135], v[180:183], v[172:175], v[120:135]
    v_and_b32 v46, 7, v1
    v_lshlrev_b32 v46, 17, v46
    v_bfe_u32 v9, v1, 3, 1
    v_lshl_add_u32 v46, v9, 14, v46
    s_and_b32 s96, s10, 1
    s_and_b32 s97, s2, 27
    s_lshl_b32 s98, s97, 12
    s_lshr_b32 s99, s10, 1
    s_lshl_b32 s97, s99, 6
    s_add_u32 s99, s98, s97
    s_lshl2_add_u32 s98, s96, s99
    s_add_u32 s97, s98, 1048576
    s_add_u32 s17, s97, 512
    v_lshrrev_b32 v47, 3, v1
    v_lshlrev_b32 v47, 10, v47
    v_and_b32 v9, 7, v1
    v_lshl_add_u32 v47, v9, 4, v47
    v_and_b32 v48, 7, v1
    v_lshlrev_b32 v48, 4, v48
    v_lshrrev_b32 v9, 5, v1
    v_lshl_add_u32 v48, v9, 3, v48
    v_cvt_pk_bf16_f32 v120, 0, v120
    v_cvt_pk_bf16_f32 v121, 0, v121
    v_cvt_pk_bf16_f32 v122, 0, v122
    v_cvt_pk_bf16_f32 v123, 0, v123
    v_cvt_pk_bf16_f32 v124, 0, v124
    v_cvt_pk_bf16_f32 v125, 0, v125
    v_cvt_pk_bf16_f32 v126, 0, v126
    v_cvt_pk_bf16_f32 v127, 0, v127
    v_cvt_pk_bf16_f32 v128, 0, v128
    v_cvt_pk_bf16_f32 v129, 0, v129
    v_cvt_pk_bf16_f32 v130, 0, v130
    v_cvt_pk_bf16_f32 v131, 0, v131
    v_cvt_pk_bf16_f32 v132, 0, v132
    v_cvt_pk_bf16_f32 v133, 0, v133
    v_cvt_pk_bf16_f32 v134, 0, v134
    v_cvt_pk_bf16_f32 v135, 0, v135
    v_max3_f32 v4, v120, v121, v122
    v_min3_f32 v5, v120, v121, v122
    v_max3_f32 v4, v4, v123, v124
    v_min3_f32 v5, v5, v123, v124
    v_max3_f32 v4, v4, v125, v126
    v_min3_f32 v5, v5, v125, v126
    v_max3_f32 v4, v4, v127, v128
    v_min3_f32 v5, v5, v127, v128
    v_max3_f32 v4, v4, v129, v130
    v_min3_f32 v5, v5, v129, v130
    v_max3_f32 v4, v4, v131, v132
    v_min3_f32 v5, v5, v131, v132
    v_max3_f32 v4, v4, v133, v134
    v_min3_f32 v5, v5, v133, v134
    v_max_f32 v6, v4, v135
    v_min_f32 v7, v5, v135
    v_max_f32 v4, v4, v135
    v_min_f32 v5, v5, v135
    s_nop 0
    v_permlane32_swap_b32 v4, v6
    v_permlane32_swap_b32 v5, v7
    v_max_f32 v4, v4, v6
    v_min_f32 v5, v5, v7
    v_pk_mul_f32 v[4:5], v[4:5], s[6:7] op_sel:[0,1]
    v_mov_b32 v6, v5
    v_pk_fma_f32 v[136:137], v[120:121], s[6:7], v[4:5] op_sel:[0,1,0] op_sel_hi:[1,1,0] neg_lo:[0,0,1] neg_hi:[0,0,1]
    v_pk_fma_f32 v[120:121], v[120:121], s[6:7], v[6:7] op_sel:[0,1,0] op_sel_hi:[1,1,0] neg_lo:[1,0,0] neg_hi:[1,0,0]
    v_pk_fma_f32 v[138:139], v[122:123], s[6:7], v[4:5] op_sel:[0,1,0] op_sel_hi:[1,1,0] neg_lo:[0,0,1] neg_hi:[0,0,1]
    v_pk_fma_f32 v[122:123], v[122:123], s[6:7], v[6:7] op_sel:[0,1,0] op_sel_hi:[1,1,0] neg_lo:[1,0,0] neg_hi:[1,0,0]
    v_pk_fma_f32 v[140:141], v[124:125], s[6:7], v[4:5] op_sel:[0,1,0] op_sel_hi:[1,1,0] neg_lo:[0,0,1] neg_hi:[0,0,1]
    v_pk_fma_f32 v[124:125], v[124:125], s[6:7], v[6:7] op_sel:[0,1,0] op_sel_hi:[1,1,0] neg_lo:[1,0,0] neg_hi:[1,0,0]
    v_pk_fma_f32 v[142:143], v[126:127], s[6:7], v[4:5] op_sel:[0,1,0] op_sel_hi:[1,1,0] neg_lo:[0,0,1] neg_hi:[0,0,1]
    v_pk_fma_f32 v[126:127], v[126:127], s[6:7], v[6:7] op_sel:[0,1,0] op_sel_hi:[1,1,0] neg_lo:[1,0,0] neg_hi:[1,0,0]
    v_pk_fma_f32 v[144:145], v[128:129], s[6:7], v[4:5] op_sel:[0,1,0] op_sel_hi:[1,1,0] neg_lo:[0,0,1] neg_hi:[0,0,1]
    v_pk_fma_f32 v[128:129], v[128:129], s[6:7], v[6:7] op_sel:[0,1,0] op_sel_hi:[1,1,0] neg_lo:[1,0,0] neg_hi:[1,0,0]
    v_pk_fma_f32 v[146:147], v[130:131], s[6:7], v[4:5] op_sel:[0,1,0] op_sel_hi:[1,1,0] neg_lo:[0,0,1] neg_hi:[0,0,1]
    v_pk_fma_f32 v[130:131], v[130:131], s[6:7], v[6:7] op_sel:[0,1,0] op_sel_hi:[1,1,0] neg_lo:[1,0,0] neg_hi:[1,0,0]
    v_pk_fma_f32 v[148:149], v[132:133], s[6:7], v[4:5] op_sel:[0,1,0] op_sel_hi:[1,1,0] neg_lo:[0,0,1] neg_hi:[0,0,1]
    v_pk_fma_f32 v[132:133], v[132:133], s[6:7], v[6:7] op_sel:[0,1,0] op_sel_hi:[1,1,0] neg_lo:[1,0,0] neg_hi:[1,0,0]
    v_pk_fma_f32 v[150:151], v[134:135], s[6:7], v[4:5] op_sel:[0,1,0] op_sel_hi:[1,1,0] neg_lo:[0,0,1] neg_hi:[0,0,1]
    v_pk_fma_f32 v[134:135], v[134:135], s[6:7], v[6:7] op_sel:[0,1,0] op_sel_hi:[1,1,0] neg_lo:[1,0,0] neg_hi:[1,0,0]
    v_exp_f32 v136, v136
    v_exp_f32 v120, v120
    v_exp_f32 v137, v137
    v_exp_f32 v121, v121
    v_exp_f32 v138, v138
    v_exp_f32 v122, v122
    v_exp_f32 v139, v139
    v_exp_f32 v123, v123
    v_exp_f32 v140, v140
    v_exp_f32 v124, v124
    v_exp_f32 v141, v141
    v_exp_f32 v125, v125
    v_exp_f32 v142, v142
    v_exp_f32 v126, v126
    v_exp_f32 v143, v143
    v_exp_f32 v127, v127
    s_waitcnt vmcnt(0)
    s_barrier
    s_cmp_lg_u32 s3, 0
    s_cbranch_scc1 L_PC
    v_mov_b32 v45, s4
    s_mov_b32 exec_hi, 0
    s_mov_b32 exec_lo, 65535
    buffer_store_dword v45, v46, s[32:35], s17 offen sc1
    s_mov_b64 exec, -1
L_PC:
    s_xor_b32 s96, s95, 1572864
    s_add_u32 s82, s96, s90
    s_add_u32 m0, s83, 98304
    s_nop 0
    buffer_load_dwordx4 v26, s[44:47], s82 offen lds
    v_exp_f32 v144, v144
    v_exp_f32 v128, v128
    v_exp_f32 v145, v145
    v_exp_f32 v129, v129
    v_exp_f32 v146, v146
    v_exp_f32 v130, v130
    v_exp_f32 v147, v147
    v_exp_f32 v131, v131
    s_xor_b32 s96, s95, 1703936
    s_add_u32 s82, s96, s90
    s_add_u32 m0, s83, 106496
    s_nop 0
    buffer_load_dwordx4 v26, s[44:47], s82 offen lds
    v_exp_f32 v148, v148
    v_exp_f32 v132, v132
    v_exp_f32 v149, v149
    v_exp_f32 v133, v133
    v_exp_f32 v150, v150
    v_exp_f32 v134, v134
    v_exp_f32 v151, v151
    v_exp_f32 v135, v135
    s_lshl4_add_u32 s96, s11, s10
    s_lshl_b32 s97, s96, 14
    s_lshl_b32 s98, s3, 7
    s_add_u32 s99, s97, s98
    s_add_u32 s13, s99, 25165824
    s_add_u32 s14, s13, 8192
    s_lshl4_add_u32 s96, s11, s10
    s_lshl_b32 s97, s96, 10
    s_lshl_b32 s98, s3, 7
    s_add_u32 s99, s97, s98
    s_add_u32 s15, s99, 29360128
    s_add_u32 s17, s17, 3072
    s_load_dwordx2 s[24:25], s[32:33], s92 offset:512 glc
    s_xor_b32 s96, s95, 1835008
    s_add_u32 s82, s96, s90
    s_add_u32 m0, s83, 114688
    s_nop 0
    buffer_load_dwordx4 v26, s[44:47], s82 offen lds
    v_pk_add_f32 v[8:9], v[136:137], v[138:139]
    v_pk_add_f32 v[10:11], v[120:121], v[122:123]
    v_pk_add_f32 v[8:9], v[8:9], v[140:141]
    v_pk_add_f32 v[10:11], v[10:11], v[124:125]
    v_pk_add_f32 v[8:9], v[8:9], v[142:143]
    v_pk_add_f32 v[10:11], v[10:11], v[126:127]
    v_pk_add_f32 v[8:9], v[8:9], v[144:145]
    v_pk_add_f32 v[10:11], v[10:11], v[128:129]
    v_pk_add_f32 v[8:9], v[8:9], v[146:147]
    v_pk_add_f32 v[10:11], v[10:11], v[130:131]
    v_pk_add_f32 v[8:9], v[8:9], v[148:149]
    v_pk_add_f32 v[10:11], v[10:11], v[132:133]
    v_pk_add_f32 v[8:9], v[8:9], v[150:151]
    v_pk_add_f32 v[10:11], v[10:11], v[134:135]
    s_xor_b32 s96, s95, 1966080
    s_add_u32 s82, s96, s90
    s_add_u32 m0, s83, 122880
    s_nop 0
    buffer_load_dwordx4 v26, s[44:47], s82 offen lds
    v_add_f32 v6, v8, v9
    v_add_f32 v7, v10, v11
    v_add_f32 v4, v8, v9
    v_add_f32 v5, v10, v11
    s_nop 0
    v_permlane32_swap_b32 v4, v6
    v_permlane32_swap_b32 v5, v7
    v_pk_add_f32 v[4:5], v[4:5], v[6:7]
    v_rcp_f32 v4, v4
    v_rcp_f32 v5, v5
    s_nop 0
    v_pk_mul_f32 v[136:137], v[136:137], v[4:5] op_sel_hi:[1,0]
    v_pk_mul_f32 v[120:121], v[4:5], v[120:121] op_sel:[1,0]
    v_pk_mul_f32 v[138:139], v[138:139], v[4:5] op_sel_hi:[1,0]
    v_pk_mul_f32 v[122:123], v[4:5], v[122:123] op_sel:[1,0]
    v_pk_mul_f32 v[140:141], v[140:141], v[4:5] op_sel_hi:[1,0]
    s_add_u32 s82, s95, s90
    s_mov_b32 m0, s83
    s_nop 0
    buffer_load_dwordx4 v26, s[44:47], s82 offen lds
    v_pk_mul_f32 v[124:125], v[4:5], v[124:125] op_sel:[1,0]
    v_pk_mul_f32 v[142:143], v[142:143], v[4:5] op_sel_hi:[1,0]
    v_pk_mul_f32 v[126:127], v[4:5], v[126:127] op_sel:[1,0]
    v_pk_mul_f32 v[144:145], v[144:145], v[4:5] op_sel_hi:[1,0]
    v_pk_mul_f32 v[128:129], v[4:5], v[128:129] op_sel:[1,0]
    v_pk_mul_f32 v[146:147], v[146:147], v[4:5] op_sel_hi:[1,0]
    v_pk_mul_f32 v[130:131], v[4:5], v[130:131] op_sel:[1,0]
    v_pk_mul_f32 v[148:149], v[148:149], v[4:5] op_sel_hi:[1,0]
    v_pk_mul_f32 v[132:133], v[4:5], v[132:133] op_sel:[1,0]
    v_pk_mul_f32 v[150:151], v[150:151], v[4:5] op_sel_hi:[1,0]
    v_pk_mul_f32 v[134:135], v[4:5], v[134:135] op_sel:[1,0]
    v_cvt_pk_bf16_f32 v152, v136, v137
    v_cvt_pk_bf16_f32 v153, v138, v139
    v_cvt_pk_bf16_f32 v154, v140, v141
    s_xor_b32 s96, s95, 131072
    s_add_u32 s82, s96, s90
    s_add_u32 m0, s83, 8192
    s_nop 0
    buffer_load_dwordx4 v26, s[44:47], s82 offen lds
    v_cvt_pk_bf16_f32 v155, v142, v143
    v_cvt_pk_bf16_f32 v156, v144, v145
    v_cvt_pk_bf16_f32 v157, v146, v147
    v_cvt_pk_bf16_f32 v158, v148, v149
    v_cvt_pk_bf16_f32 v159, v150, v151
    v_cvt_pk_bf16_f32 v160, v120, v121
    v_cvt_pk_bf16_f32 v161, v122, v123
    v_cvt_pk_bf16_f32 v162, v124, v125
    v_cvt_pk_bf16_f32 v163, v126, v127
    v_cvt_pk_bf16_f32 v164, v128, v129
    v_cvt_pk_bf16_f32 v165, v130, v131
    v_cvt_pk_bf16_f32 v166, v132, v133
    v_cvt_pk_bf16_f32 v167, v134, v135
    s_branch SCHK_17
SPOLL_16:
    s_load_dwordx2 s[24:25], s[32:33], s92 offset:512 glc
SCHK_17:
    s_add_u32 s5, s5, 1
    s_cmp_ge_u32 s5, 200000
    s_waitcnt lgkmcnt(0)
    s_cbranch_scc1 SDONE_18
    s_cmp_lg_u32 s24, s4
    s_cbranch_scc1 SPOLL_16
    s_cmp_lg_u32 s25, s4
    s_cbranch_scc1 SPOLL_16
SDONE_18:
    s_barrier
    buffer_load_dwordx4 v[184:187], v47, s[32:35], s13 offen sc1
    buffer_load_dwordx4 v[188:191], v47, s[32:35], s14 offen sc1
    buffer_load_dwordx4 v[192:195], v2, s[32:35], s16 offen sc1
    s_lshl_b32 s96, s3, 5
    s_add_u32 s14, s96, 155648
    v_and_b32 v6, 3, v1
    v_lshl_add_u32 v6, v6, 3, s14
    v_lshrrev_b32 v9, 5, v1
    v_lshl_add_u32 v6, v9, 2, v6
    s_lshl_b32 s96, s3, 10
    s_add_u32 s14, s96, 147456
    v_and_b32 v5, 15, v1
    v_lshl_add_u32 v5, v5, 4, s14
    v_lshrrev_b32 v9, 5, v1
    v_lshl_add_u32 v5, v9, 9, v5
    v_bfe_u32 v9, v1, 4, 1
    v_lshl_add_u32 v5, v9, 3, v5
    s_lshl_b32 s96, s76, 7
    s_add_u32 s14, s96, 155648
    v_lshrrev_b32 v7, 5, v1
    v_lshl_add_u32 v7, v7, 4, s14
    s_lshl_b32 s96, s76, 12
    s_add_u32 s14, s96, 147456
    v_add_u32 v44, s14, v2
    s_waitcnt vmcnt(1)
    v_pk_add_f32 v[184:185], v[184:185], v[188:189]
    v_pk_add_f32 v[186:187], v[186:187], v[190:191]
    s_nop 1
    v_permlane32_swap_b32 v184, v186
    v_permlane32_swap_b32 v185, v187
    v_pk_add_f32 v[184:185], v[184:185], v[186:187]
    s_nop 1
    v_add_f32_dpp v184, v184, v184 row_ror:8 row_mask:0xf bank_mask:0xf
    v_add_f32_dpp v185, v185, v185 row_ror:8 row_mask:0xf bank_mask:0xf
    v_mov_b32 v186, v184
    v_mov_b32 v187, v185
    s_nop 0
    v_permlane16_swap_b32 v184, v186
    v_permlane16_swap_b32 v185, v187
    v_pk_add_f32 v[184:185], v[184:185], v[186:187]
    v_cvt_pk_bf16_f32 v184, v184, v185
    v_mov_b32 v185, s4
    s_mov_b32 exec_lo, 0xff
    s_mov_b32 exec_hi, 0xff
    buffer_store_dwordx2 v[184:185], v48, s[32:35], s15 offen sc1
    s_mov_b64 exec, -1
    s_barrier
    s_cmp_lg_u32 s3, 0
    s_cbranch_scc1 L_PC2
    v_mov_b32 v45, s4
    s_mov_b32 exec_hi, 0
    s_mov_b32 exec_lo, 65535
    buffer_store_dword v45, v46, s[32:35], s17 offen sc1
    s_mov_b64 exec, -1
L_PC2:
    s_waitcnt vmcnt(1)
    s_xor_b32 s96, s95, 262144
    s_add_u32 s82, s96, s90
    s_add_u32 m0, s83, 16384
    s_nop 0
    buffer_load_dwordx4 v26, s[44:47], s82 offen lds
    v_permlane32_swap_b32 v192, v194
    v_permlane32_swap_b32 v193, v195
    v_pk_add_f32 v[192:193], v[192:193], v[194:195]
    s_nop 1
    v_add_f32_dpp v192, v192, v192 row_ror:4 row_mask:0xf bank_mask:0xf
    s_xor_b32 s96, s95, 393216
L_PAD7:
    s_cbranch_execz L_RET7
    s_add_u32 s82, s96, s90
    s_add_u32 m0, s83, 24576
    s_nop 0
    buffer_load_dwordx4 v26, s[44:47], s82 offen lds
    v_add_f32_dpp v193, v193, v193 row_ror:4 row_mask:0xf bank_mask:0xf
    v_add_f32_dpp v192, v192, v192 row_ror:8 row_mask:0xf bank_mask:0xf
    s_nop 0
    v_add_f32_dpp v193, v193, v193 row_ror:8 row_mask:0xf bank_mask:0xf
    s_xor_b32 s96, s95, 524288
    s_add_u32 s82, s96, s90
    s_add_u32 m0, s83, 32768
    s_nop 0
    buffer_load_dwordx4 v26, s[44:47], s82 offen lds
    v_mov_b32 v194, v192
    v_mov_b32 v195, v193
    s_nop 0
    v_permlane16_swap_b32 v192, v194
    s_xor_b32 s96, s95, 655360
    s_add_u32 s82, s96, s90
    s_add_u32 m0, s83, 40960
    s_nop 0
    buffer_load_dwordx4 v26, s[44:47], s82 offen lds
    v_permlane16_swap_b32 v193, v195
    v_pk_add_f32 v[192:193], v[192:193], v[194:195]
    v_cvt_pk_bf16_f32 v192, v192, v193
    ds_write_b32 v6, v192
    s_waitcnt lgkmcnt(0)
    s_barrier
    ds_read_b128 v[196:199], v7
    ds_read_b128 v[200:203], v7 offset:32
    ds_read_b128 v[204:207], v7 offset:64
    ds_read_b128 v[208:211], v7 offset:96
    s_lshr_b32 s96, s8, 2
    s_lshl1_add_u32 s97, s9, s96
    s_and_b32 s98, s8, 3
    s_lshl2_add_u32 s99, s97, s98
    s_lshl_b32 s96, s99, 9
    s_add_u32 s18, s96, 131072
    s_waitcnt lgkmcnt(0)
    s_lshl3_add_u32 s96, s11, s3
    s_lshl_b32 s97, s96, 11
    s_add_u32 s13, s97, 29360128
    s_load_dwordx2 s[24:25], s[32:33], s92 offset:3584 glc
    v_mfma_f32_32x32x16_bf16 v[136:151], v[196:199], v[152:155], 0
    v_mfma_f32_32x32x16_bf16 v[136:151], v[200:203], v[156:159], v[136:151]
    v_mfma_f32_32x32x16_bf16 v[136:151], v[204:207], v[160:163], v[136:151]
    v_mfma_f32_32x32x16_bf16 v[136:151], v[208:211], v[164:167], v[136:151]
    s_nop 11
    v_cvt_pk_bf16_f32 v136, 0, v136
    v_add_f32 v136, 0x358637bd, v136
    v_cvt_pk_bf16_f32 v136, 0, v136
    v_rcp_f32 v136, v136
    s_branch SCHK_20
SPOLL_19:
    s_load_dwordx2 s[24:25], s[32:33], s92 offset:3584 glc
SCHK_20:
    s_add_u32 s5, s5, 1
    s_cmp_ge_u32 s5, 200000
    s_waitcnt lgkmcnt(0)
    s_cbranch_scc1 SDONE_21
    s_cmp_lg_u32 s24, s4
    s_cbranch_scc1 SPOLL_19
    s_cmp_lg_u32 s25, s4
    s_cbranch_scc1 SPOLL_19
SDONE_21:
    buffer_load_dwordx4 v[228:231], v2, s[32:35], s13 offen sc1
    buffer_load_dwordx4 v[232:235], v2, s[32:35], s13 offen offset:1024 sc1
    s_waitcnt vmcnt(0)
    v_bitop3_b32 v4, v229, v231, s4 bitop3:0x7e
    v_bitop3_b32 v4, v4, v233, s4 bitop3:0xf6
    v_bitop3_b32 v4, v4, v235, s4 bitop3:0xf6
    v_cmp_ne_u32 vcc, 0, v4
    s_cbranch_vccz TOK_23
POLL_24:
    buffer_load_dwordx4 v[228:231], v2, s[32:35], s13 offen sc1
    buffer_load_dwordx4 v[232:235], v2, s[32:35], s13 offen offset:1024 sc1
    s_waitcnt vmcnt(0)
    v_bitop3_b32 v4, v229, v231, s4 bitop3:0x7e
    v_bitop3_b32 v4, v4, v233, s4 bitop3:0xf6
    v_bitop3_b32 v4, v4, v235, s4 bitop3:0xf6
    v_cmp_ne_u32 vcc, 0, v4
    s_cbranch_vccz PDONE_25
    s_add_u32 s5, s5, 1
    s_cmp_lt_u32 s5, 200000
    s_cbranch_scc1 POLL_24
PDONE_25:
TOK_23:
    ds_write2_b32 v5, v228, v230 offset0:0 offset1:1
    ds_write2_b32 v5, v232, v234 offset0:64 offset1:65
    s_waitcnt lgkmcnt(0)
    s_barrier
    ds_read_b128 v[212:215], v44
    ds_read_b128 v[216:219], v44 offset:1024
    ds_read_b128 v[220:223], v44 offset:2048
    ds_read_b128 v[224:227], v44 offset:3072
    s_lshl_b32 s96, s77, 1
    s_lshl3_add_u32 s97, s10, s96
    s_lshl_b32 s98, s97, 5
    s_lshl1_add_u32 s99, s11, s98
    s_add_u32 s96, s99, s76
    s_lshl_b32 s97, s96, 10
    s_add_u32 s13, s97, 8388608
    v_and_b32 v47, 15, v1
    v_lshlrev_b32 v47, 4, v47
    v_bfe_u32 v9, v1, 4, 1
    v_lshl_add_u32 v47, v9, 15, v47
    v_lshrrev_b32 v9, 5, v1
    v_lshl_add_u32 v47, v9, 8, v47
    s_waitcnt lgkmcnt(3)
    v_mfma_f32_32x32x16_bf16 v[120:135], v[212:215], v[152:155], 0
    s_waitcnt lgkmcnt(2)
    v_mfma_f32_32x32x16_bf16 v[120:135], v[216:219], v[156:159], v[120:135]
    s_waitcnt lgkmcnt(1)
    v_mfma_f32_32x32x16_bf16 v[120:135], v[220:223], v[160:163], v[120:135]
    s_waitcnt lgkmcnt(0)
    v_mfma_f32_32x32x16_bf16 v[120:135], v[224:227], v[164:167], v[120:135]
    s_lshr_b32 s96, s3, 1
    s_lshl4_add_u32 s97, s96, s12
    s_lshl_b32 s98, s97, 11
    s_and_b32 s99, s3, 1
    s_lshl_b32 s96, s99, 10
    s_add_u32 s97, s98, s96
    s_add_u32 s18, s97, 131072
    s_lshl_b32 s19, s12, 7
    v_and_b32 v44, 3, v1
    v_lshl_add_u32 v44, v44, 1, s19
    v_lshrrev_b32 v9, 5, v1
    v_lshl_add_u32 v44, v9, 3, v44
    v_bfe_u32 v9, v1, 4, 1
    v_lshl_add_u32 v44, v9, 4, v44
    v_bfe_u32 v9, v1, 2, 2
    v_lshl_add_u32 v44, v9, 5, v44
    global_load_ushort v32, v44, s[78:79]
    buffer_load_dwordx4 v[28:31], v2, s[32:35], s18 offen sc1
    v_cvt_pk_bf16_f32 v120, 0, v120
    v_cvt_pk_bf16_f32 v121, 0, v121
    v_cvt_pk_bf16_f32 v122, 0, v122
    v_cvt_pk_bf16_f32 v123, 0, v123
    v_cvt_pk_bf16_f32 v124, 0, v124
    v_cvt_pk_bf16_f32 v125, 0, v125
    v_cvt_pk_bf16_f32 v126, 0, v126
    v_cvt_pk_bf16_f32 v127, 0, v127
    v_pk_mul_f32 v[120:121], v[120:121], v[136:137] op_sel_hi:[1,0]
    v_pk_mul_f32 v[122:123], v[122:123], v[136:137] op_sel_hi:[1,0]
    v_pk_mul_f32 v[124:125], v[124:125], v[136:137] op_sel_hi:[1,0]
    v_pk_mul_f32 v[126:127], v[126:127], v[136:137] op_sel_hi:[1,0]
    v_cvt_pk_bf16_f32 v168, v120, v121
    v_cvt_pk_bf16_f32 v169, v122, v123
    v_cvt_pk_bf16_f32 v170, v124, v125
    v_cvt_pk_bf16_f32 v171, v126, v127
    buffer_store_dwordx4 v[168:171], v47, s[32:35], s13 offen sc1
    v_cvt_pk_bf16_f32 v128, 0, v128
    v_cvt_pk_bf16_f32 v129, 0, v129
    v_cvt_pk_bf16_f32 v130, 0, v130
    v_cvt_pk_bf16_f32 v131, 0, v131
    v_cvt_pk_bf16_f32 v132, 0, v132
    v_cvt_pk_bf16_f32 v133, 0, v133
    v_cvt_pk_bf16_f32 v134, 0, v134
    v_cvt_pk_bf16_f32 v135, 0, v135
    v_pk_mul_f32 v[128:129], v[128:129], v[136:137] op_sel_hi:[1,0]
    v_pk_mul_f32 v[130:131], v[130:131], v[136:137] op_sel_hi:[1,0]
    v_pk_mul_f32 v[132:133], v[132:133], v[136:137] op_sel_hi:[1,0]
    v_pk_mul_f32 v[134:135], v[134:135], v[136:137] op_sel_hi:[1,0]
    v_cvt_pk_bf16_f32 v172, v128, v129
    v_cvt_pk_bf16_f32 v173, v130, v131
    v_cvt_pk_bf16_f32 v174, v132, v133
    v_cvt_pk_bf16_f32 v175, v134, v135
    buffer_store_dwordx4 v[172:175], v47, s[32:35], s13 offen offset:512 sc1
    v_mov_b32 v50, -1
    v_mov_b32 v51, -1
    v_mov_b32 v52, -1
    v_mov_b32 v53, -1
    s_lshl3_add_u32 s96, s21, s3
    s_lshl4_add_u32 s97, s96, s12
    s_lshl_b32 s98, s97, 8
    s_add_u32 s19, s98, 12582912
    v_lshlrev_b32 v54, 2, v1
    buffer_store_dword v50, v54, s[32:35], s19 offen sc1
    s_lshl_b32 s96, s21, 14
    s_lshl_b32 s97, s12, 9
    s_add_u32 s98, s96, s97
    s_add_u32 s19, s98, 13631488
    v_and_b32 v54, 31, v1
    v_lshlrev_b32 v54, 4, v54
    v_lshrrev_b32 v55, 5, v1
    v_lshl_add_u32 v54, v55, 13, v54
    s_cmp_lg_u32 s3, 5
    s_cbranch_scc1 L_NOPO
    buffer_store_dwordx4 v[50:53], v54, s[32:35], s19 offen sc1
L_NOPO:
    v_bfe_u32 v36, v1, 2, 2
    v_lshlrev_b32 v36, 7, v36
    v_lshrrev_b32 v9, 4, v1
    v_lshl_add_u32 v36, v9, 10, v36
    v_and_b32 v9, 1, v1
    v_lshl_add_u32 v36, v9, 4, v36
    v_bfe_u32 v9, v1, 1, 1
    v_lshl_add_u32 v36, v9, 3, v36
    v_bfe_u32 v9, v1, 3, 2
    v_lshl_add_u32 v36, v9, 5, v36
    s_and_b32 s96, s9, 1
    s_lshl_b32 s97, s96, 2
    s_xor_b32 s98, s3, s97
    s_lshl_b32 s17, s98, 12
    s_lshl_b32 s96, s17, 2
    s_lshr_b32 s97, s95, 4
    s_xor_b32 s14, s96, s97
    v_add_u32 v36, s14, v36
    v_xor_b32 v37, 32, v36
    v_xor_b32 v38, 64, v36
    v_xor_b32 v39, 96, v36
    v_and_b32 v5, 7, v1
    v_lshlrev_b32 v5, 15, v5
    v_bfe_u32 v9, v1, 3, 1
    v_lshl_add_u32 v5, v9, 12, v5
    s_and_b32 s96, s11, 1
    s_lshr_b32 s97, s10, 2
    s_and_b32 s98, s10, 3
    s_lshl_b32 s99, s98, 6
    s_lshl1_add_u32 s98, s97, s99
    s_lshl_b32 s97, s98, 12
    s_lshr_b32 s99, s11, 1
    s_lshl_b32 s98, s99, 6
    s_add_u32 s99, s97, s98
    s_lshl2_add_u32 s97, s96, s99
    s_add_u32 s98, s97, 1048576
    s_add_u32 s15, s98, 1024
    v_lshlrev_b32 v152, 16, v12
    v_and_b32 v153, s6, v12
    v_lshlrev_b32 v154, 16, v13
    v_and_b32 v155, s6, v13
    v_lshlrev_b32 v156, 16, v14
    v_and_b32 v157, s6, v14
    v_lshlrev_b32 v158, 16, v15
    v_and_b32 v159, s6, v15
    v_lshlrev_b32 v160, 16, v16
    v_and_b32 v161, s6, v16
    v_lshlrev_b32 v162, 16, v17
    v_and_b32 v163, s6, v17
    v_lshlrev_b32 v164, 16, v18
    v_and_b32 v165, s6, v18
    v_lshlrev_b32 v166, 16, v19
    v_and_b32 v167, s6, v19
    s_lshl3_add_u32 s96, s21, s3
    s_lshl_b32 s97, s96, 15
    s_add_u32 s19, s97, 8388608
    s_waitcnt vmcnt(3)
    v_bitop3_b32 v4, v29, v31, s4 bitop3:0x7e
    v_cmp_ne_u32 vcc, 0, v4
    s_cbranch_vccz L_MGOK
POLL_26:
    buffer_load_dwordx4 v[28:31], v2, s[32:35], s18 offen sc1
    s_waitcnt vmcnt(0)
    v_bitop3_b32 v4, v29, v31, s4 bitop3:0x7e
    v_cmp_ne_u32 vcc, 0, v4
    s_cbranch_vccz PDONE_27
    s_add_u32 s5, s5, 1
    s_cmp_lt_u32 s5, 200000
    s_cbranch_scc1 POLL_26
PDONE_27:
L_MGOK:
    s_and_b32 s96, s3, 1
    s_lshr_b32 s97, s3, 1
    s_lshl_b32 s98, s97, 10
    s_lshl3_add_u32 s99, s96, s98
    s_add_u32 s14, s99, 159744
    v_and_b32 v4, 31, v1
    v_lshl_add_u32 v4, v4, 5, s14
    v_lshrrev_b32 v9, 5, v1
    v_lshl_add_u32 v4, v9, 2, v4
    ds_write2_b32 v4, v28, v30 offset0:0 offset1:4
    v_and_b32 v7, 3, v1
    v_lshlrev_b32 v7, 4, v7
    v_lshrrev_b32 v9, 5, v1
    v_lshl_add_u32 v7, v9, 6, v7
    v_bfe_u32 v9, v1, 4, 1
    v_lshl_add_u32 v7, v9, 7, v7
    v_bfe_u32 v9, v1, 2, 2
    v_lshl_add_u32 v7, v9, 8, v7
    v_add_u32 v7, 159744, v7
    s_lshl_b32 s96, s2, 12
    s_lshr_b32 s97, s17, 6
    s_add_u32 s98, s96, s97
    s_add_u32 s99, s98, 1048576
    s_add_u32 s18, s99, 1024
    s_waitcnt vmcnt(1)
    s_waitcnt lgkmcnt(0)
    s_barrier
    s_cmp_lg_u32 s3, 0
    s_cbranch_scc1 L_PD
    v_mov_b32 v6, s4
    s_mov_b32 exec_hi, 0
    s_mov_b32 exec_lo, 65535
    buffer_store_dword v6, v5, s[32:35], s15 offen sc1
    s_mov_b64 exec, -1
L_PD:
    ds_read_b128 v[192:195], v7
    ds_read_b128 v[196:199], v7 offset:1024
    ds_read_b128 v[200:203], v7 offset:2048
    ds_read_b128 v[204:207], v7 offset:3072
    v_and_b32 v8, 3, v1
    v_lshlrev_b32 v8, 2, v8
    v_lshrrev_b32 v9, 5, v1
    v_lshl_add_u32 v8, v9, 4, v8
    v_bfe_u32 v9, v1, 4, 1
    v_lshl_add_u32 v8, v9, 5, v8
    v_bfe_u32 v9, v1, 2, 2
    v_lshl_add_u32 v8, v9, 6, v8
    v_add_u32 v8, 157184, v8
    s_lshl4_add_u32 s96, s21, s12
    s_lshl_b32 s97, s96, 6
    s_add_u32 s13, s97, 14155776
    s_waitcnt lgkmcnt(0)
    s_load_dwordx2 s[24:25], s[32:33], s18 offset:0 glc
    v_pk_add_f32 v[192:193], v[192:193], v[194:195]
    v_add_f32 v28, v192, v193
    v_pk_add_f32 v[196:197], v[196:197], v[198:199]
    v_add_f32 v29, v196, v197
    v_pk_add_f32 v[200:201], v[200:201], v[202:203]
    v_add_f32 v30, v200, v201
    v_pk_add_f32 v[204:205], v[204:205], v[206:207]
    v_add_f32 v31, v204, v205
    v_cvt_pk_bf16_f32 v28, 0, v28
    v_cvt_pk_bf16_f32 v29, 0, v29
    v_cvt_pk_bf16_f32 v30, 0, v30
    v_cvt_pk_bf16_f32 v31, 0, v31
    v_add_f32 v30, 1.0, v30
    v_lshlrev_b32 v32, 16, v32
    v_cvt_pk_bf16_f32 v30, 0, v30
    ds_write_b32 v8, v31
    v_mul_f32 v192, v30, v32
    v_cvt_pk_bf16_f32 v193, 0, v192
    v_sub_f32 v194, v192, v193
    v_add_f32_dpp v192, v192, v192 quad_perm:[1,0,3,2] row_mask:0xf bank_mask:0xf
    s_nop 1
    v_add_f32_dpp v192, v192, v192 quad_perm:[2,3,0,1] row_mask:0xf bank_mask:0xf
    s_nop 1
    v_add_f32_dpp v192, v192, v192 row_half_mirror row_mask:0xf bank_mask:0xf
    s_nop 1
    v_add_f32_dpp v192, v192, v192 row_ror:8 row_mask:0xf bank_mask:0xf
    v_mov_b32 v199, v192
    s_nop 1
    v_permlane16_swap_b32 v192, v199
    v_add_f32 v192, v192, v199
    v_mov_b32 v199, v192
    s_nop 1
    v_permlane32_swap_b32 v192, v199
    v_add_f32 v192, v192, v199
    v_mov_b32_dpp v196, v193 row_shl:1 row_mask:0xf bank_mask:0xf
    v_mov_b32_dpp v197, v194 row_shl:1 row_mask:0xf bank_mask:0xf
    v_mov_b32_dpp v198, v32 row_shl:1 row_mask:0xf bank_mask:0xf
    v_cvt_pk_bf16_f32 v196, v193, v196
    v_cvt_pk_bf16_f32 v197, v194, v197
    v_cvt_pk_bf16_f32 v198, v32, v198
    v_mov_b32 v193, s4
    v_mov_b32 v194, 0
    s_cmp_lg_u32 s3, 2
    s_cbranch_scc1 L_NOUP
    s_mov_b64 exec, 1
    buffer_store_dwordx2 v[192:193], v194, s[32:35], s13 offen sc1
    s_mov_b64 exec, -1
L_NOUP:
    v_mov_b32 v184, 0x3f803f80
    s_nop 1
    v_mov_b32_dpp v184, v196 row_newbcast:0 row_mask:0xf bank_mask:0x2
    s_nop 1
    v_mov_b32_dpp v184, v197 row_newbcast:0 row_mask:0xf bank_mask:0x4
    s_nop 1
    v_mov_b32_dpp v184, v198 row_newbcast:0 row_mask:0xf bank_mask:0x8
    v_mov_b32 v185, 0x3f803f80
    s_nop 1
    v_mov_b32_dpp v185, v196 row_newbcast:2 row_mask:0xf bank_mask:0x2
    s_nop 1
    v_mov_b32_dpp v185, v197 row_newbcast:2 row_mask:0xf bank_mask:0x4
    s_nop 1
    v_mov_b32_dpp v185, v198 row_newbcast:2 row_mask:0xf bank_mask:0x8
    v_mov_b32 v186, 0x3f803f80
    s_nop 1
    v_mov_b32_dpp v186, v196 row_newbcast:4 row_mask:0xf bank_mask:0x2
    s_nop 1
    v_mov_b32_dpp v186, v197 row_newbcast:4 row_mask:0xf bank_mask:0x4
    s_nop 1
    v_mov_b32_dpp v186, v198 row_newbcast:4 row_mask:0xf bank_mask:0x8
    v_mov_b32 v187, 0x3f803f80
    s_nop 1
    v_mov_b32_dpp v187, v196 row_newbcast:6 row_mask:0xf bank_mask:0x2
    s_nop 1
    v_mov_b32_dpp v187, v197 row_newbcast:6 row_mask:0xf bank_mask:0x4
    s_nop 1
    v_mov_b32_dpp v187, v198 row_newbcast:6 row_mask:0xf bank_mask:0x8
    v_mov_b32 v188, 0x3f803f80
    s_nop 1
    v_mov_b32_dpp v188, v196 row_newbcast:8 row_mask:0xf bank_mask:0x2
    s_nop 1
    v_mov_b32_dpp v188, v197 row_newbcast:8 row_mask:0xf bank_mask:0x4
    s_nop 1
    v_mov_b32_dpp v188, v198 row_newbcast:8 row_mask:0xf bank_mask:0x8
    v_mov_b32 v189, 0x3f803f80
    s_nop 1
    v_mov_b32_dpp v189, v196 row_newbcast:10 row_mask:0xf bank_mask:0x2
    s_nop 1
    v_mov_b32_dpp v189, v197 row_newbcast:10 row_mask:0xf bank_mask:0x4
    s_nop 1
    v_mov_b32_dpp v189, v198 row_newbcast:10 row_mask:0xf bank_mask:0x8
    v_mov_b32 v190, 0x3f803f80
    s_nop 1
    v_mov_b32_dpp v190, v196 row_newbcast:12 row_mask:0xf bank_mask:0x2
    s_nop 1
    v_mov_b32_dpp v190, v197 row_newbcast:12 row_mask:0xf bank_mask:0x4
    s_nop 1
    v_mov_b32_dpp v190, v198 row_newbcast:12 row_mask:0xf bank_mask:0x8
    v_mov_b32 v191, 0x3f803f80
    s_nop 1
    v_mov_b32_dpp v191, v196 row_newbcast:14 row_mask:0xf bank_mask:0x2
    s_nop 1
    v_mov_b32_dpp v191, v197 row_newbcast:14 row_mask:0xf bank_mask:0x4
    s_nop 1
    v_mov_b32_dpp v191, v198 row_newbcast:14 row_mask:0xf bank_mask:0x8
    v_mov_b32 v42, v29
    v_mov_b32 v43, v31
    v_mov_b32_dpp v136, v28 row_newbcast:0 row_mask:0xf bank_mask:0xf
    v_mov_b32_dpp v137, v28 row_newbcast:1 row_mask:0xf bank_mask:0xf
    v_mov_b32_dpp v138, v28 row_newbcast:2 row_mask:0xf bank_mask:0xf
    v_mov_b32_dpp v139, v28 row_newbcast:3 row_mask:0xf bank_mask:0xf
    v_mov_b32_dpp v140, v28 row_newbcast:4 row_mask:0xf bank_mask:0xf
    v_mov_b32_dpp v141, v28 row_newbcast:5 row_mask:0xf bank_mask:0xf
    v_mov_b32_dpp v142, v28 row_newbcast:6 row_mask:0xf bank_mask:0xf
    v_mov_b32_dpp v143, v28 row_newbcast:7 row_mask:0xf bank_mask:0xf
    v_mov_b32_dpp v144, v28 row_newbcast:8 row_mask:0xf bank_mask:0xf
    v_mov_b32_dpp v145, v28 row_newbcast:9 row_mask:0xf bank_mask:0xf
    v_mov_b32_dpp v146, v28 row_newbcast:10 row_mask:0xf bank_mask:0xf
    v_mov_b32_dpp v147, v28 row_newbcast:11 row_mask:0xf bank_mask:0xf
    v_mov_b32_dpp v148, v28 row_newbcast:12 row_mask:0xf bank_mask:0xf
    v_mov_b32_dpp v149, v28 row_newbcast:13 row_mask:0xf bank_mask:0xf
    v_mov_b32_dpp v150, v28 row_newbcast:14 row_mask:0xf bank_mask:0xf
    v_mov_b32_dpp v151, v28 row_newbcast:15 row_mask:0xf bank_mask:0xf
    v_mov_b32_dpp v168, v30 row_newbcast:0 row_mask:0xf bank_mask:0xf
    v_mov_b32_dpp v169, v30 row_newbcast:1 row_mask:0xf bank_mask:0xf
    v_mov_b32_dpp v170, v30 row_newbcast:2 row_mask:0xf bank_mask:0xf
    v_mov_b32_dpp v171, v30 row_newbcast:3 row_mask:0xf bank_mask:0xf
    v_mov_b32_dpp v172, v30 row_newbcast:4 row_mask:0xf bank_mask:0xf
    v_mov_b32_dpp v173, v30 row_newbcast:5 row_mask:0xf bank_mask:0xf
    v_mov_b32_dpp v174, v30 row_newbcast:6 row_mask:0xf bank_mask:0xf
    v_mov_b32_dpp v175, v30 row_newbcast:7 row_mask:0xf bank_mask:0xf
    v_mov_b32_dpp v176, v30 row_newbcast:8 row_mask:0xf bank_mask:0xf
    v_mov_b32_dpp v177, v30 row_newbcast:9 row_mask:0xf bank_mask:0xf
    v_mov_b32_dpp v178, v30 row_newbcast:10 row_mask:0xf bank_mask:0xf
    v_mov_b32_dpp v179, v30 row_newbcast:11 row_mask:0xf bank_mask:0xf
    v_mov_b32_dpp v180, v30 row_newbcast:12 row_mask:0xf bank_mask:0xf
    v_mov_b32_dpp v181, v30 row_newbcast:13 row_mask:0xf bank_mask:0xf
    v_mov_b32_dpp v182, v30 row_newbcast:14 row_mask:0xf bank_mask:0xf
    v_mov_b32_dpp v183, v30 row_newbcast:15 row_mask:0xf bank_mask:0xf
    s_branch SCHK_29
SPOLL_28:
    s_load_dwordx2 s[24:25], s[32:33], s18 offset:0 glc
SCHK_29:
    s_add_u32 s5, s5, 1
    s_cmp_ge_u32 s5, 200000
    s_waitcnt lgkmcnt(0)
    s_cbranch_scc1 SDONE_30
    s_cmp_lg_u32 s24, s4
    s_cbranch_scc1 SPOLL_28
    s_cmp_lg_u32 s25, s4
    s_cbranch_scc1 SPOLL_28
SDONE_30:
    s_add_u32 s20, s17, s19
    buffer_load_dwordx4 v[224:227], v2, s[32:35], s20 offen sc1
    ds_read_b64_tr_b16 v[192:193], v36
    ds_read_b64_tr_b16 v[194:195], v36 offset:512
    ds_read_b64_tr_b16 v[196:197], v37
    ds_read_b64_tr_b16 v[198:199], v37 offset:512
    ds_read_b64_tr_b16 v[200:201], v38
    ds_read_b64_tr_b16 v[202:203], v38 offset:512
    ds_read_b64_tr_b16 v[204:205], v39
    ds_read_b64_tr_b16 v[206:207], v39 offset:512
    ds_read_b64_tr_b16 v[208:209], v36 offset:4096
    ds_read_b64_tr_b16 v[210:211], v36 offset:4608
    ds_read_b64_tr_b16 v[212:213], v37 offset:4096
    ds_read_b64_tr_b16 v[214:215], v37 offset:4608
    ds_read_b64_tr_b16 v[216:217], v38 offset:4096
    ds_read_b64_tr_b16 v[218:219], v38 offset:4608
    buffer_load_dwordx4 v[228:231], v2, s[32:35], s20 offen offset:1024 sc1
    buffer_load_dwordx4 v[232:235], v2, s[32:35], s20 offen offset:2048 sc1
    buffer_load_dwordx4 v[236:239], v2, s[32:35], s20 offen offset:3072 sc1
    s_barrier
    s_xor_b32 s96, s17, 4096
    s_add_u32 s20, s96, s19
    buffer_load_dwordx4 v[240:243], v2, s[32:35], s20 offen sc1
    buffer_load_dwordx4 v[244:247], v2, s[32:35], s20 offen offset:1024 sc1
    buffer_load_dwordx4 v[44:47], v2, s[32:35], s20 offen offset:2048 sc1
    buffer_load_dwordx4 v[48:51], v2, s[32:35], s20 offen offset:3072 sc1
    s_lshl_b32 s96, s21, 10
    s_add_u32 s13, s96, 14155776
    v_and_b32 v10, 15, v1
    v_lshlrev_b32 v10, 6, v10
    s_cmp_lt_u32 s3, 4
    s_cbranch_scc1 L_G2P0
    s_setprio 1
L_G2P0:
    s_waitcnt vmcnt(7)
    s_waitcnt lgkmcnt(6)
    v_mfma_f32_16x16x32_bf16 v[120:123], v[192:195], v[224:227], 0
    ds_read_b64_tr_b16 v[220:221], v39 offset:4096
    ds_read_b64_tr_b16 v[222:223], v39 offset:4608
    v_mfma_f32_16x16x32_bf16 v[124:127], v[196:199], v[224:227], 0
    ds_read_b64_tr_b16 v[192:193], v36 offset:8192
    ds_read_b64_tr_b16 v[194:195], v36 offset:8704
    v_mfma_f32_16x16x32_bf16 v[128:131], v[200:203], v[224:227], 0
    ds_read_b64_tr_b16 v[196:197], v37 offset:8192
    ds_read_b64_tr_b16 v[198:199], v37 offset:8704
    v_mfma_f32_16x16x32_bf16 v[132:135], v[204:207], v[224:227], 0
    ds_read_b64_tr_b16 v[200:201], v38 offset:8192
    ds_read_b64_tr_b16 v[202:203], v38 offset:8704
    s_xor_b32 s96, s17, 8192
    s_add_u32 s20, s96, s19
    buffer_load_dwordx4 v[224:227], v2, s[32:35], s20 offen sc1
    s_waitcnt vmcnt(7)
    s_waitcnt lgkmcnt(6)
    v_mfma_f32_16x16x32_bf16 v[120:123], v[208:211], v[228:231], v[120:123]
    ds_read_b64_tr_b16 v[204:205], v39 offset:8192
    ds_read_b64_tr_b16 v[206:207], v39 offset:8704
    v_mfma_f32_16x16x32_bf16 v[124:127], v[212:215], v[228:231], v[124:127]
    ds_read_b64_tr_b16 v[208:209], v36 offset:12288
    ds_read_b64_tr_b16 v[210:211], v36 offset:12800
    v_xor_b32 v36, 16384, v36
    v_mfma_f32_16x16x32_bf16 v[128:131], v[216:219], v[228:231], v[128:131]
    ds_read_b64_tr_b16 v[212:213], v37 offset:12288
    ds_read_b64_tr_b16 v[214:215], v37 offset:12800
    v_xor_b32 v37, 16384, v37
    v_mfma_f32_16x16x32_bf16 v[132:135], v[220:223], v[228:231], v[132:135]
    ds_read_b64_tr_b16 v[216:217], v38 offset:12288
    ds_read_b64_tr_b16 v[218:219], v38 offset:12800
    v_xor_b32 v38, 16384, v38
    buffer_load_dwordx4 v[228:231], v2, s[32:35], s20 offen offset:1024 sc1
    s_waitcnt vmcnt(7)
    s_waitcnt lgkmcnt(6)
    v_mfma_f32_16x16x32_bf16 v[120:123], v[192:195], v[232:235], v[120:123]
    ds_read_b64_tr_b16 v[220:221], v39 offset:12288
    ds_read_b64_tr_b16 v[222:223], v39 offset:12800
    v_xor_b32 v39, 16384, v39
    v_mfma_f32_16x16x32_bf16 v[124:127], v[196:199], v[232:235], v[124:127]
    ds_read_b64_tr_b16 v[192:193], v36
    ds_read_b64_tr_b16 v[194:195], v36 offset:512
    v_mfma_f32_16x16x32_bf16 v[128:131], v[200:203], v[232:235], v[128:131]
    ds_read_b64_tr_b16 v[196:197], v37
    ds_read_b64_tr_b16 v[198:199], v37 offset:512
    v_mfma_f32_16x16x32_bf16 v[132:135], v[204:207], v[232:235], v[132:135]
    ds_read_b64_tr_b16 v[200:201], v38
    ds_read_b64_tr_b16 v[202:203], v38 offset:512
    buffer_load_dwordx4 v[232:235], v2, s[32:35], s20 offen offset:2048 sc1
    s_waitcnt vmcnt(7)
    s_waitcnt lgkmcnt(6)
    v_mfma_f32_16x16x32_bf16 v[120:123], v[208:211], v[236:239], v[120:123]
    ds_read_b64_tr_b16 v[204:205], v39
    ds_read_b64_tr_b16 v[206:207], v39 offset:512
    v_mfma_f32_16x16x32_bf16 v[124:127], v[212:215], v[236:239], v[124:127]
    ds_read_b64_tr_b16 v[208:209], v36 offset:4096
    ds_read_b64_tr_b16 v[210:211], v36 offset:4608
    v_mfma_f32_16x16x32_bf16 v[128:131], v[216:219], v[236:239], v[128:131]
    ds_read_b64_tr_b16 v[212:213], v37 offset:4096
    ds_read_b64_tr_b16 v[214:215], v37 offset:4608
    v_mfma_f32_16x16x32_bf16 v[132:135], v[220:223], v[236:239], v[132:135]
    ds_read_b64_tr_b16 v[216:217], v38 offset:4096
    ds_read_b64_tr_b16 v[218:219], v38 offset:4608
    buffer_load_dwordx4 v[236:239], v2, s[32:35], s20 offen offset:3072 sc1
    s_waitcnt vmcnt(7)
    s_waitcnt lgkmcnt(6)
    v_mfma_f32_16x16x32_bf16 v[120:123], v[192:195], v[240:243], v[120:123]
    ds_read_b64_tr_b16 v[220:221], v39 offset:4096
    ds_read_b64_tr_b16 v[222:223], v39 offset:4608
    v_mfma_f32_16x16x32_bf16 v[124:127], v[196:199], v[240:243], v[124:127]
    ds_read_b64_tr_b16 v[192:193], v36 offset:8192
    ds_read_b64_tr_b16 v[194:195], v36 offset:8704
    v_mfma_f32_16x16x32_bf16 v[128:131], v[200:203], v[240:243], v[128:131]
    ds_read_b64_tr_b16 v[196:197], v37 offset:8192
    ds_read_b64_tr_b16 v[198:199], v37 offset:8704
    v_mfma_f32_16x16x32_bf16 v[132:135], v[204:207], v[240:243], v[132:135]
    ds_read_b64_tr_b16 v[200:201], v38 offset:8192
    ds_read_b64_tr_b16 v[202:203], v38 offset:8704
    s_xor_b32 s96, s17, 12288
    s_add_u32 s20, s96, s19
    buffer_load_dwordx4 v[240:243], v2, s[32:35], s20 offen sc1
    s_waitcnt vmcnt(7)
    s_waitcnt lgkmcnt(6)
    v_mfma_f32_16x16x32_bf16 v[120:123], v[208:211], v[244:247], v[120:123]
    ds_read_b64_tr_b16 v[204:205], v39 offset:8192
    ds_read_b64_tr_b16 v[206:207], v39 offset:8704
    v_mfma_f32_16x16x32_bf16 v[124:127], v[212:215], v[244:247], v[124:127]
    ds_read_b64_tr_b16 v[208:209], v36 offset:12288
    ds_read_b64_tr_b16 v[210:211], v36 offset:12800
    v_xor_b32 v36, 49152, v36
    v_mfma_f32_16x16x32_bf16 v[128:131], v[216:219], v[244:247], v[128:131]
    ds_read_b64_tr_b16 v[212:213], v37 offset:12288
    ds_read_b64_tr_b16 v[214:215], v37 offset:12800
    v_xor_b32 v37, 49152, v37
    v_mfma_f32_16x16x32_bf16 v[132:135], v[220:223], v[244:247], v[132:135]
    ds_read_b64_tr_b16 v[216:217], v38 offset:12288
    ds_read_b64_tr_b16 v[218:219], v38 offset:12800
    v_xor_b32 v38, 49152, v38
    buffer_load_dwordx4 v[244:247], v2, s[32:35], s20 offen offset:1024 sc1
    s_waitcnt vmcnt(7)
    s_waitcnt lgkmcnt(6)
    v_mfma_f32_16x16x32_bf16 v[120:123], v[192:195], v[44:47], v[120:123]
    ds_read_b64_tr_b16 v[220:221], v39 offset:12288
    ds_read_b64_tr_b16 v[222:223], v39 offset:12800
    v_xor_b32 v39, 49152, v39
    v_mfma_f32_16x16x32_bf16 v[124:127], v[196:199], v[44:47], v[124:127]
    ds_read_b64_tr_b16 v[192:193], v36
    ds_read_b64_tr_b16 v[194:195], v36 offset:512
    v_mfma_f32_16x16x32_bf16 v[128:131], v[200:203], v[44:47], v[128:131]
    ds_read_b64_tr_b16 v[196:197], v37
    ds_read_b64_tr_b16 v[198:199], v37 offset:512
    v_mfma_f32_16x16x32_bf16 v[132:135], v[204:207], v[44:47], v[132:135]
    ds_read_b64_tr_b16 v[200:201], v38
    ds_read_b64_tr_b16 v[202:203], v38 offset:512
    buffer_load_dwordx4 v[44:47], v2, s[32:35], s20 offen offset:2048 sc1
    s_waitcnt vmcnt(7)
    s_waitcnt lgkmcnt(6)
    v_mfma_f32_16x16x32_bf16 v[120:123], v[208:211], v[48:51], v[120:123]
    ds_read_b64_tr_b16 v[204:205], v39
    ds_read_b64_tr_b16 v[206:207], v39 offset:512
    v_mfma_f32_16x16x32_bf16 v[124:127], v[212:215], v[48:51], v[124:127]
    ds_read_b64_tr_b16 v[208:209], v36 offset:4096
    ds_read_b64_tr_b16 v[210:211], v36 offset:4608
    v_mfma_f32_16x16x32_bf16 v[128:131], v[216:219], v[48:51], v[128:131]
    ds_read_b64_tr_b16 v[212:213], v37 offset:4096
    ds_read_b64_tr_b16 v[214:215], v37 offset:4608
    v_mfma_f32_16x16x32_bf16 v[132:135], v[220:223], v[48:51], v[132:135]
    ds_read_b64_tr_b16 v[216:217], v38 offset:4096
    ds_read_b64_tr_b16 v[218:219], v38 offset:4608
    buffer_load_dwordx4 v[48:51], v2, s[32:35], s20 offen offset:3072 sc1
    s_waitcnt vmcnt(7)
    s_waitcnt lgkmcnt(6)
    v_mfma_f32_16x16x32_bf16 v[120:123], v[192:195], v[224:227], v[120:123]
    ds_read_b64_tr_b16 v[220:221], v39 offset:4096
    ds_read_b64_tr_b16 v[222:223], v39 offset:4608
    v_mfma_f32_16x16x32_bf16 v[124:127], v[196:199], v[224:227], v[124:127]
    ds_read_b64_tr_b16 v[192:193], v36 offset:8192
    ds_read_b64_tr_b16 v[194:195], v36 offset:8704
    v_mfma_f32_16x16x32_bf16 v[128:131], v[200:203], v[224:227], v[128:131]
    ds_read_b64_tr_b16 v[196:197], v37 offset:8192
    ds_read_b64_tr_b16 v[198:199], v37 offset:8704
    v_mfma_f32_16x16x32_bf16 v[132:135], v[204:207], v[224:227], v[132:135]
    ds_read_b64_tr_b16 v[200:201], v38 offset:8192
    ds_read_b64_tr_b16 v[202:203], v38 offset:8704
    s_xor_b32 s96, s17, 16384
    s_add_u32 s20, s96, s19
    buffer_load_dwordx4 v[224:227], v2, s[32:35], s20 offen sc1
    s_waitcnt vmcnt(7)
    s_waitcnt lgkmcnt(6)
    v_mfma_f32_16x16x32_bf16 v[120:123], v[208:211], v[228:231], v[120:123]
L_PAD8:
    s_cbranch_execz L_RET8
    ds_read_b64_tr_b16 v[204:205], v39 offset:8192
    ds_read_b64_tr_b16 v[206:207], v39 offset:8704
    v_mfma_f32_16x16x32_bf16 v[124:127], v[212:215], v[228:231], v[124:127]
    ds_read_b64_tr_b16 v[208:209], v36 offset:12288
    ds_read_b64_tr_b16 v[210:211], v36 offset:12800
    v_xor_b32 v36, 16384, v36
    v_mfma_f32_16x16x32_bf16 v[128:131], v[216:219], v[228:231], v[128:131]
    ds_read_b64_tr_b16 v[212:213], v37 offset:12288
    ds_read_b64_tr_b16 v[214:215], v37 offset:12800
    v_xor_b32 v37, 16384, v37
    v_mfma_f32_16x16x32_bf16 v[132:135], v[220:223], v[228:231], v[132:135]
    ds_read_b64_tr_b16 v[216:217], v38 offset:12288
    ds_read_b64_tr_b16 v[218:219], v38 offset:12800
    v_xor_b32 v38, 16384, v38
    buffer_load_dwordx4 v[228:231], v2, s[32:35], s20 offen offset:1024 sc1
    s_waitcnt vmcnt(7)
    s_waitcnt lgkmcnt(6)
    v_mfma_f32_16x16x32_bf16 v[120:123], v[192:195], v[232:235], v[120:123]
    ds_read_b64_tr_b16 v[220:221], v39 offset:12288
    ds_read_b64_tr_b16 v[222:223], v39 offset:12800
    v_xor_b32 v39, 16384, v39
    v_mfma_f32_16x16x32_bf16 v[124:127], v[196:199], v[232:235], v[124:127]
    ds_read_b64_tr_b16 v[192:193], v36
    ds_read_b64_tr_b16 v[194:195], v36 offset:512
    v_mfma_f32_16x16x32_bf16 v[128:131], v[200:203], v[232:235], v[128:131]
    ds_read_b64_tr_b16 v[196:197], v37
    ds_read_b64_tr_b16 v[198:199], v37 offset:512
    v_mfma_f32_16x16x32_bf16 v[132:135], v[204:207], v[232:235], v[132:135]
    ds_read_b64_tr_b16 v[200:201], v38
    ds_read_b64_tr_b16 v[202:203], v38 offset:512
    buffer_load_dwordx4 v[232:235], v2, s[32:35], s20 offen offset:2048 sc1
    s_waitcnt vmcnt(7)
    s_waitcnt lgkmcnt(6)
    v_mfma_f32_16x16x32_bf16 v[120:123], v[208:211], v[236:239], v[120:123]
    ds_read_b64_tr_b16 v[204:205], v39
    ds_read_b64_tr_b16 v[206:207], v39 offset:512
    v_mfma_f32_16x16x32_bf16 v[124:127], v[212:215], v[236:239], v[124:127]
    ds_read_b64_tr_b16 v[208:209], v36 offset:4096
    ds_read_b64_tr_b16 v[210:211], v36 offset:4608
    v_mfma_f32_16x16x32_bf16 v[128:131], v[216:219], v[236:239], v[128:131]
    ds_read_b64_tr_b16 v[212:213], v37 offset:4096
    ds_read_b64_tr_b16 v[214:215], v37 offset:4608
    v_mfma_f32_16x16x32_bf16 v[132:135], v[220:223], v[236:239], v[132:135]
    ds_read_b64_tr_b16 v[216:217], v38 offset:4096
    ds_read_b64_tr_b16 v[218:219], v38 offset:4608
    buffer_load_dwordx4 v[236:239], v2, s[32:35], s20 offen offset:3072 sc1
    s_waitcnt vmcnt(7)
    s_waitcnt lgkmcnt(6)
    v_mfma_f32_16x16x32_bf16 v[120:123], v[192:195], v[240:243], v[120:123]
    ds_read_b64_tr_b16 v[220:221], v39 offset:4096
    ds_read_b64_tr_b16 v[222:223], v39 offset:4608
    v_mfma_f32_16x16x32_bf16 v[124:127], v[196:199], v[240:243], v[124:127]
    ds_read_b64_tr_b16 v[192:193], v36 offset:8192
    ds_read_b64_tr_b16 v[194:195], v36 offset:8704
    v_mfma_f32_16x16x32_bf16 v[128:131], v[200:203], v[240:243], v[128:131]
    ds_read_b64_tr_b16 v[196:197], v37 offset:8192
    ds_read_b64_tr_b16 v[198:199], v37 offset:8704
    v_mfma_f32_16x16x32_bf16 v[132:135], v[204:207], v[240:243], v[132:135]
    ds_read_b64_tr_b16 v[200:201], v38 offset:8192
    ds_read_b64_tr_b16 v[202:203], v38 offset:8704
    s_xor_b32 s96, s17, 20480
    s_add_u32 s20, s96, s19
    buffer_load_dwordx4 v[240:243], v2, s[32:35], s20 offen sc1
    s_waitcnt vmcnt(7)
    s_waitcnt lgkmcnt(6)
    v_mfma_f32_16x16x32_bf16 v[120:123], v[208:211], v[244:247], v[120:123]
    ds_read_b64_tr_b16 v[204:205], v39 offset:8192
    ds_read_b64_tr_b16 v[206:207], v39 offset:8704
    v_mfma_f32_16x16x32_bf16 v[124:127], v[212:215], v[244:247], v[124:127]
    ds_read_b64_tr_b16 v[208:209], v36 offset:12288
    ds_read_b64_tr_b16 v[210:211], v36 offset:12800
    v_xor_b32 v36, 114688, v36
    v_mfma_f32_16x16x32_bf16 v[128:131], v[216:219], v[244:247], v[128:131]
    ds_read_b64_tr_b16 v[212:213], v37 offset:12288
    ds_read_b64_tr_b16 v[214:215], v37 offset:12800
    v_xor_b32 v37, 114688, v37
    v_mfma_f32_16x16x32_bf16 v[132:135], v[220:223], v[244:247], v[132:135]
    ds_read_b64_tr_b16 v[216:217], v38 offset:12288
    ds_read_b64_tr_b16 v[218:219], v38 offset:12800
    v_xor_b32 v38, 114688, v38
    buffer_load_dwordx4 v[244:247], v2, s[32:35], s20 offen offset:1024 sc1
    s_waitcnt vmcnt(7)
    s_waitcnt lgkmcnt(6)
    v_mfma_f32_16x16x32_bf16 v[120:123], v[192:195], v[44:47], v[120:123]
    ds_read_b64_tr_b16 v[220:221], v39 offset:12288
    ds_read_b64_tr_b16 v[222:223], v39 offset:12800
    v_xor_b32 v39, 114688, v39
    v_mfma_f32_16x16x32_bf16 v[124:127], v[196:199], v[44:47], v[124:127]
    ds_read_b64_tr_b16 v[192:193], v36
    ds_read_b64_tr_b16 v[194:195], v36 offset:512
    v_mfma_f32_16x16x32_bf16 v[128:131], v[200:203], v[44:47], v[128:131]
    ds_read_b64_tr_b16 v[196:197], v37
    ds_read_b64_tr_b16 v[198:199], v37 offset:512
    v_mfma_f32_16x16x32_bf16 v[132:135], v[204:207], v[44:47], v[132:135]
    ds_read_b64_tr_b16 v[200:201], v38
    ds_read_b64_tr_b16 v[202:203], v38 offset:512
    buffer_load_dwordx4 v[44:47], v2, s[32:35], s20 offen offset:2048 sc1
    s_waitcnt vmcnt(7)
    s_waitcnt lgkmcnt(6)
    v_mfma_f32_16x16x32_bf16 v[120:123], v[208:211], v[48:51], v[120:123]
    ds_read_b64_tr_b16 v[204:205], v39
    ds_read_b64_tr_b16 v[206:207], v39 offset:512
    v_mfma_f32_16x16x32_bf16 v[124:127], v[212:215], v[48:51], v[124:127]
    ds_read_b64_tr_b16 v[208:209], v36 offset:4096
    ds_read_b64_tr_b16 v[210:211], v36 offset:4608
    v_mfma_f32_16x16x32_bf16 v[128:131], v[216:219], v[48:51], v[128:131]
    ds_read_b64_tr_b16 v[212:213], v37 offset:4096
    ds_read_b64_tr_b16 v[214:215], v37 offset:4608
    v_mfma_f32_16x16x32_bf16 v[132:135], v[220:223], v[48:51], v[132:135]
    ds_read_b64_tr_b16 v[216:217], v38 offset:4096
    ds_read_b64_tr_b16 v[218:219], v38 offset:4608
    buffer_load_dwordx4 v[48:51], v2, s[32:35], s20 offen offset:3072 sc1
    s_waitcnt vmcnt(7)
    s_waitcnt lgkmcnt(6)
    v_mfma_f32_16x16x32_bf16 v[120:123], v[192:195], v[224:227], v[120:123]
    ds_read_b64_tr_b16 v[220:221], v39 offset:4096
    ds_read_b64_tr_b16 v[222:223], v39 offset:4608
    v_mfma_f32_16x16x32_bf16 v[124:127], v[196:199], v[224:227], v[124:127]
    ds_read_b64_tr_b16 v[192:193], v36 offset:8192
    ds_read_b64_tr_b16 v[194:195], v36 offset:8704
    v_mfma_f32_16x16x32_bf16 v[128:131], v[200:203], v[224:227], v[128:131]
    ds_read_b64_tr_b16 v[196:197], v37 offset:8192
    ds_read_b64_tr_b16 v[198:199], v37 offset:8704
    v_mfma_f32_16x16x32_bf16 v[132:135], v[204:207], v[224:227], v[132:135]
    ds_read_b64_tr_b16 v[200:201], v38 offset:8192
    ds_read_b64_tr_b16 v[202:203], v38 offset:8704
    s_xor_b32 s96, s17, 24576
    s_add_u32 s20, s96, s19
    buffer_load_dwordx4 v[224:227], v2, s[32:35], s20 offen sc1
    s_waitcnt vmcnt(7)
    s_waitcnt lgkmcnt(6)
    v_mfma_f32_16x16x32_bf16 v[120:123], v[208:211], v[228:231], v[120:123]
    ds_read_b64_tr_b16 v[204:205], v39 offset:8192
    ds_read_b64_tr_b16 v[206:207], v39 offset:8704
    v_mfma_f32_16x16x32_bf16 v[124:127], v[212:215], v[228:231], v[124:127]
    ds_read_b64_tr_b16 v[208:209], v36 offset:12288
    ds_read_b64_tr_b16 v[210:211], v36 offset:12800
    v_xor_b32 v36, 16384, v36
    v_mfma_f32_16x16x32_bf16 v[128:131], v[216:219], v[228:231], v[128:131]
    ds_read_b64_tr_b16 v[212:213], v37 offset:12288
    ds_read_b64_tr_b16 v[214:215], v37 offset:12800
    v_xor_b32 v37, 16384, v37
    v_mfma_f32_16x16x32_bf16 v[132:135], v[220:223], v[228:231], v[132:135]
    ds_read_b64_tr_b16 v[216:217], v38 offset:12288
    ds_read_b64_tr_b16 v[218:219], v38 offset:12800
    v_xor_b32 v38, 16384, v38
    buffer_load_dwordx4 v[228:231], v2, s[32:35], s20 offen offset:1024 sc1
    s_waitcnt vmcnt(7)
    s_waitcnt lgkmcnt(6)
    v_mfma_f32_16x16x32_bf16 v[120:123], v[192:195], v[232:235], v[120:123]
    ds_read_b64_tr_b16 v[220:221], v39 offset:12288
    ds_read_b64_tr_b16 v[222:223], v39 offset:12800
    v_xor_b32 v39, 16384, v39
    v_mfma_f32_16x16x32_bf16 v[124:127], v[196:199], v[232:235], v[124:127]
    ds_read_b64_tr_b16 v[192:193], v36
    ds_read_b64_tr_b16 v[194:195], v36 offset:512
    v_mfma_f32_16x16x32_bf16 v[128:131], v[200:203], v[232:235], v[128:131]
    ds_read_b64_tr_b16 v[196:197], v37
    ds_read_b64_tr_b16 v[198:199], v37 offset:512
    v_mfma_f32_16x16x32_bf16 v[132:135], v[204:207], v[232:235], v[132:135]
    ds_read_b64_tr_b16 v[200:201], v38
    ds_read_b64_tr_b16 v[202:203], v38 offset:512
    buffer_load_dwordx4 v[232:235], v2, s[32:35], s20 offen offset:2048 sc1
    s_waitcnt vmcnt(7)
    s_waitcnt lgkmcnt(6)
    v_mfma_f32_16x16x32_bf16 v[120:123], v[208:211], v[236:239], v[120:123]
    ds_read_b64_tr_b16 v[204:205], v39
    ds_read_b64_tr_b16 v[206:207], v39 offset:512
    v_mfma_f32_16x16x32_bf16 v[124:127], v[212:215], v[236:239], v[124:127]
    ds_read_b64_tr_b16 v[208:209], v36 offset:4096
    ds_read_b64_tr_b16 v[210:211], v36 offset:4608
    v_mfma_f32_16x16x32_bf16 v[128:131], v[216:219], v[236:239], v[128:131]
    ds_read_b64_tr_b16 v[212:213], v37 offset:4096
    ds_read_b64_tr_b16 v[214:215], v37 offset:4608
    v_mfma_f32_16x16x32_bf16 v[132:135], v[220:223], v[236:239], v[132:135]
    ds_read_b64_tr_b16 v[216:217], v38 offset:4096
    ds_read_b64_tr_b16 v[218:219], v38 offset:4608
    buffer_load_dwordx4 v[236:239], v2, s[32:35], s20 offen offset:3072 sc1
    s_waitcnt vmcnt(7)
    s_waitcnt lgkmcnt(6)
    v_mfma_f32_16x16x32_bf16 v[120:123], v[192:195], v[240:243], v[120:123]
    ds_read_b64_tr_b16 v[220:221], v39 offset:4096
    ds_read_b64_tr_b16 v[222:223], v39 offset:4608
    v_mfma_f32_16x16x32_bf16 v[124:127], v[196:199], v[240:243], v[124:127]
    ds_read_b64_tr_b16 v[192:193], v36 offset:8192
    ds_read_b64_tr_b16 v[194:195], v36 offset:8704
    v_mfma_f32_16x16x32_bf16 v[128:131], v[200:203], v[240:243], v[128:131]
    ds_read_b64_tr_b16 v[196:197], v37 offset:8192
    ds_read_b64_tr_b16 v[198:199], v37 offset:8704
    v_mfma_f32_16x16x32_bf16 v[132:135], v[204:207], v[240:243], v[132:135]
    ds_read_b64_tr_b16 v[200:201], v38 offset:8192
    ds_read_b64_tr_b16 v[202:203], v38 offset:8704
    s_xor_b32 s96, s17, 28672
    s_add_u32 s20, s96, s19
    buffer_load_dwordx4 v[240:243], v2, s[32:35], s20 offen sc1
    s_waitcnt vmcnt(7)
    s_waitcnt lgkmcnt(6)
    v_mfma_f32_16x16x32_bf16 v[120:123], v[208:211], v[244:247], v[120:123]
    ds_read_b64_tr_b16 v[204:205], v39 offset:8192
    ds_read_b64_tr_b16 v[206:207], v39 offset:8704
    v_mfma_f32_16x16x32_bf16 v[124:127], v[212:215], v[244:247], v[124:127]
    ds_read_b64_tr_b16 v[208:209], v36 offset:12288
    ds_read_b64_tr_b16 v[210:211], v36 offset:12800
    v_xor_b32 v36, 49152, v36
    v_mfma_f32_16x16x32_bf16 v[128:131], v[216:219], v[244:247], v[128:131]
    ds_read_b64_tr_b16 v[212:213], v37 offset:12288
    ds_read_b64_tr_b16 v[214:215], v37 offset:12800
    v_xor_b32 v37, 49152, v37
    v_mfma_f32_16x16x32_bf16 v[132:135], v[220:223], v[244:247], v[132:135]
    ds_read_b64_tr_b16 v[216:217], v38 offset:12288
    ds_read_b64_tr_b16 v[218:219], v38 offset:12800
    v_xor_b32 v38, 49152, v38
    buffer_load_dwordx4 v[244:247], v2, s[32:35], s20 offen offset:1024 sc1
    s_waitcnt vmcnt(7)
    s_waitcnt lgkmcnt(6)
    v_mfma_f32_16x16x32_bf16 v[120:123], v[192:195], v[44:47], v[120:123]
    ds_read_b64_tr_b16 v[220:221], v39 offset:12288
    ds_read_b64_tr_b16 v[222:223], v39 offset:12800
    v_xor_b32 v39, 49152, v39
    v_mfma_f32_16x16x32_bf16 v[124:127], v[196:199], v[44:47], v[124:127]
    ds_read_b64_tr_b16 v[192:193], v36
    ds_read_b64_tr_b16 v[194:195], v36 offset:512
    v_mfma_f32_16x16x32_bf16 v[128:131], v[200:203], v[44:47], v[128:131]
    ds_read_b64_tr_b16 v[196:197], v37
    ds_read_b64_tr_b16 v[198:199], v37 offset:512
    v_mfma_f32_16x16x32_bf16 v[132:135], v[204:207], v[44:47], v[132:135]
    ds_read_b64_tr_b16 v[200:201], v38
    ds_read_b64_tr_b16 v[202:203], v38 offset:512
    buffer_load_dwordx4 v[44:47], v2, s[32:35], s20 offen offset:2048 sc1
    s_waitcnt vmcnt(7)
    s_waitcnt lgkmcnt(6)
    v_mfma_f32_16x16x32_bf16 v[120:123], v[208:211], v[48:51], v[120:123]
    ds_read_b64_tr_b16 v[204:205], v39
    ds_read_b64_tr_b16 v[206:207], v39 offset:512
    v_mfma_f32_16x16x32_bf16 v[124:127], v[212:215], v[48:51], v[124:127]
    ds_read_b64_tr_b16 v[208:209], v36 offset:4096
    ds_read_b64_tr_b16 v[210:211], v36 offset:4608
    v_mfma_f32_16x16x32_bf16 v[128:131], v[216:219], v[48:51], v[128:131]
    ds_read_b64_tr_b16 v[212:213], v37 offset:4096
    ds_read_b64_tr_b16 v[214:215], v37 offset:4608
    v_mfma_f32_16x16x32_bf16 v[132:135], v[220:223], v[48:51], v[132:135]
    ds_read_b64_tr_b16 v[216:217], v38 offset:4096
    ds_read_b64_tr_b16 v[218:219], v38 offset:4608
    buffer_load_dwordx4 v[48:51], v2, s[32:35], s20 offen offset:3072 sc1
    buffer_load_dwordx2 v[40:41], v10, s[32:35], s13 offen sc1
    s_mov_b32 s82, s80
    buffer_load_dwordx4 v[88:91], v27, s[56:59], s82 offen nt
    s_add_u32 s82, s80, 57344
    buffer_load_dwordx4 v[92:95], v27, s[56:59], s82 offen nt
    s_waitcnt vmcnt(10)
    s_waitcnt lgkmcnt(6)
    v_mfma_f32_16x16x32_bf16 v[120:123], v[192:195], v[224:227], v[120:123]
    ds_read_b64_tr_b16 v[220:221], v39 offset:4096
    ds_read_b64_tr_b16 v[222:223], v39 offset:4608
    v_mfma_f32_16x16x32_bf16 v[124:127], v[196:199], v[224:227], v[124:127]
    ds_read_b64_tr_b16 v[192:193], v36 offset:8192
    ds_read_b64_tr_b16 v[194:195], v36 offset:8704
    v_mfma_f32_16x16x32_bf16 v[128:131], v[200:203], v[224:227], v[128:131]
    ds_read_b64_tr_b16 v[196:197], v37 offset:8192
    ds_read_b64_tr_b16 v[198:199], v37 offset:8704
    v_mfma_f32_16x16x32_bf16 v[132:135], v[204:207], v[224:227], v[132:135]
    ds_read_b64_tr_b16 v[200:201], v38 offset:8192
    ds_read_b64_tr_b16 v[202:203], v38 offset:8704
    s_waitcnt vmcnt(9)
    s_waitcnt lgkmcnt(6)
    v_mfma_f32_16x16x32_bf16 v[120:123], v[208:211], v[228:231], v[120:123]
    ds_read_b64_tr_b16 v[204:205], v39 offset:8192
    ds_read_b64_tr_b16 v[206:207], v39 offset:8704
    v_mfma_f32_16x16x32_bf16 v[124:127], v[212:215], v[228:231], v[124:127]
    ds_read_b64_tr_b16 v[208:209], v36 offset:12288
    ds_read_b64_tr_b16 v[210:211], v36 offset:12800
    v_xor_b32 v36, 16384, v36
    v_mfma_f32_16x16x32_bf16 v[128:131], v[216:219], v[228:231], v[128:131]
    ds_read_b64_tr_b16 v[212:213], v37 offset:12288
    ds_read_b64_tr_b16 v[214:215], v37 offset:12800
    v_xor_b32 v37, 16384, v37
    v_mfma_f32_16x16x32_bf16 v[132:135], v[220:223], v[228:231], v[132:135]
    ds_read_b64_tr_b16 v[216:217], v38 offset:12288
    ds_read_b64_tr_b16 v[218:219], v38 offset:12800
    v_xor_b32 v38, 16384, v38
    s_waitcnt vmcnt(8)
    s_waitcnt lgkmcnt(6)
    v_mfma_f32_16x16x32_bf16 v[120:123], v[192:195], v[232:235], v[120:123]
    ds_read_b64_tr_b16 v[220:221], v39 offset:12288
    ds_read_b64_tr_b16 v[222:223], v39 offset:12800
    v_xor_b32 v39, 16384, v39
    v_mfma_f32_16x16x32_bf16 v[124:127], v[196:199], v[232:235], v[124:127]
    ds_read_b64_tr_b16 v[192:193], v36
    ds_read_b64_tr_b16 v[194:195], v36 offset:512
    v_mfma_f32_16x16x32_bf16 v[128:131], v[200:203], v[232:235], v[128:131]
    ds_read_b64_tr_b16 v[196:197], v37
    ds_read_b64_tr_b16 v[198:199], v37 offset:512
    v_mfma_f32_16x16x32_bf16 v[132:135], v[204:207], v[232:235], v[132:135]
    ds_read_b64_tr_b16 v[200:201], v38
    ds_read_b64_tr_b16 v[202:203], v38 offset:512
    s_waitcnt vmcnt(7)
    s_waitcnt lgkmcnt(6)
    v_mfma_f32_16x16x32_bf16 v[120:123], v[208:211], v[236:239], v[120:123]
    ds_read_b64_tr_b16 v[204:205], v39
    ds_read_b64_tr_b16 v[206:207], v39 offset:512
    v_mfma_f32_16x16x32_bf16 v[124:127], v[212:215], v[236:239], v[124:127]
    ds_read_b64_tr_b16 v[208:209], v36 offset:4096
    ds_read_b64_tr_b16 v[210:211], v36 offset:4608
    v_mfma_f32_16x16x32_bf16 v[128:131], v[216:219], v[236:239], v[128:131]
    ds_read_b64_tr_b16 v[212:213], v37 offset:4096
    ds_read_b64_tr_b16 v[214:215], v37 offset:4608
    v_mfma_f32_16x16x32_bf16 v[132:135], v[220:223], v[236:239], v[132:135]
    ds_read_b64_tr_b16 v[216:217], v38 offset:4096
    ds_read_b64_tr_b16 v[218:219], v38 offset:4608
    s_cmp_lt_u32 s3, 4
    s_cbranch_scc1 L_G2P28
    s_setprio 0
L_G2P28:
    s_waitcnt vmcnt(6)
    s_waitcnt lgkmcnt(6)
    v_mfma_f32_16x16x32_bf16 v[120:123], v[192:195], v[240:243], v[120:123]
    ds_read_b64_tr_b16 v[220:221], v39 offset:4096
    ds_read_b64_tr_b16 v[222:223], v39 offset:4608
    v_mfma_f32_16x16x32_bf16 v[124:127], v[196:199], v[240:243], v[124:127]
    ds_read_b64_tr_b16 v[192:193], v36 offset:8192
    ds_read_b64_tr_b16 v[194:195], v36 offset:8704
    v_mfma_f32_16x16x32_bf16 v[128:131], v[200:203], v[240:243], v[128:131]
    ds_read_b64_tr_b16 v[196:197], v37 offset:8192
    ds_read_b64_tr_b16 v[198:199], v37 offset:8704
    v_mfma_f32_16x16x32_bf16 v[132:135], v[204:207], v[240:243], v[132:135]
    ds_read_b64_tr_b16 v[200:201], v38 offset:8192
    ds_read_b64_tr_b16 v[202:203], v38 offset:8704
    s_waitcnt vmcnt(5)
    s_waitcnt lgkmcnt(6)
    v_mfma_f32_16x16x32_bf16 v[120:123], v[208:211], v[244:247], v[120:123]
    ds_read_b64_tr_b16 v[204:205], v39 offset:8192
    ds_read_b64_tr_b16 v[206:207], v39 offset:8704
    v_mfma_f32_16x16x32_bf16 v[124:127], v[212:215], v[244:247], v[124:127]
    ds_read_b64_tr_b16 v[208:209], v36 offset:12288
    ds_read_b64_tr_b16 v[210:211], v36 offset:12800
    v_mfma_f32_16x16x32_bf16 v[128:131], v[216:219], v[244:247], v[128:131]
    ds_read_b64_tr_b16 v[212:213], v37 offset:12288
    ds_read_b64_tr_b16 v[214:215], v37 offset:12800
    v_mfma_f32_16x16x32_bf16 v[132:135], v[220:223], v[244:247], v[132:135]
    ds_read_b64_tr_b16 v[216:217], v38 offset:12288
    ds_read_b64_tr_b16 v[218:219], v38 offset:12800
    s_waitcnt vmcnt(4)
    s_waitcnt lgkmcnt(6)
    v_mfma_f32_16x16x32_bf16 v[120:123], v[192:195], v[44:47], v[120:123]
    ds_read_b64_tr_b16 v[220:221], v39 offset:12288
    ds_read_b64_tr_b16 v[222:223], v39 offset:12800
    v_mfma_f32_16x16x32_bf16 v[124:127], v[196:199], v[44:47], v[124:127]
    v_mfma_f32_16x16x32_bf16 v[128:131], v[200:203], v[44:47], v[128:131]
    v_mfma_f32_16x16x32_bf16 v[132:135], v[204:207], v[44:47], v[132:135]
    s_waitcnt vmcnt(3)
    s_waitcnt lgkmcnt(0)
    v_mfma_f32_16x16x32_bf16 v[120:123], v[208:211], v[48:51], v[120:123]
    v_mfma_f32_16x16x32_bf16 v[124:127], v[212:215], v[48:51], v[124:127]
    v_mfma_f32_16x16x32_bf16 v[128:131], v[216:219], v[48:51], v[128:131]
    v_mfma_f32_16x16x32_bf16 v[132:135], v[220:223], v[48:51], v[132:135]
    s_lshl3_add_u32 s96, s21, s3
    s_lshl4_add_u32 s97, s96, s12
    s_lshl_b32 s98, s97, 8
    s_add_u32 s14, s98, 12582912
    v_and_b32 v28, 15, v1
    v_lshlrev_b32 v28, 4, v28
    v_lshrrev_b32 v9, 4, v1
    v_lshl_add_u32 v28, v9, 2, v28
    v_cvt_pk_bf16_f32 v120, 0, v120
    v_cvt_pk_bf16_f32 v121, 0, v121
    v_cvt_pk_bf16_f32 v122, 0, v122
    v_cvt_pk_bf16_f32 v123, 0, v123
    v_cvt_pk_bf16_f32 v124, 0, v124
    v_cvt_pk_bf16_f32 v125, 0, v125
    v_cvt_pk_bf16_f32 v126, 0, v126
    v_cvt_pk_bf16_f32 v127, 0, v127
    v_pk_mul_f32 v[120:121], v[120:121], v[136:137]
    v_pk_mul_f32 v[122:123], v[122:123], v[138:139]
    v_pk_mul_f32 v[124:125], v[124:125], v[140:141]
    v_pk_mul_f32 v[126:127], v[126:127], v[142:143]
    v_cvt_pk_bf16_f32 v120, 0, v120
    v_cvt_pk_bf16_f32 v121, 0, v121
    v_cvt_pk_bf16_f32 v122, 0, v122
    v_cvt_pk_bf16_f32 v123, 0, v123
    v_cvt_pk_bf16_f32 v124, 0, v124
    v_cvt_pk_bf16_f32 v125, 0, v125
    v_cvt_pk_bf16_f32 v126, 0, v126
    v_cvt_pk_bf16_f32 v127, 0, v127
    v_pk_add_f32 v[120:121], v[120:121], v[152:153]
    v_pk_add_f32 v[122:123], v[122:123], v[154:155]
    v_pk_add_f32 v[124:125], v[124:125], v[156:157]
    v_pk_add_f32 v[126:127], v[126:127], v[158:159]
    v_cvt_pk_bf16_f32 v12, v120, v121
    v_cvt_pk_bf16_f32 v13, v122, v123
    v_cvt_pk_bf16_f32 v14, v124, v125
    v_cvt_pk_bf16_f32 v15, v126, v127
    v_dot2_f32_bf16 v4, v12, v12, 0
    v_dot2_f32_bf16 v5, v13, v13, 0
    v_dot2_f32_bf16 v4, v14, v14, v4
    v_dot2_f32_bf16 v5, v15, v15, v5
    v_mfma_f32_16x16x32_bf16 v[240:243], v[184:187], v[12:15], 0
    v_cvt_pk_bf16_f32 v128, 0, v128
    v_cvt_pk_bf16_f32 v129, 0, v129
    v_cvt_pk_bf16_f32 v130, 0, v130
    v_cvt_pk_bf16_f32 v131, 0, v131
    v_cvt_pk_bf16_f32 v132, 0, v132
    v_cvt_pk_bf16_f32 v133, 0, v133
    v_cvt_pk_bf16_f32 v134, 0, v134
    v_cvt_pk_bf16_f32 v135, 0, v135
    v_pk_mul_f32 v[128:129], v[128:129], v[144:145]
    v_pk_mul_f32 v[130:131], v[130:131], v[146:147]
    v_pk_mul_f32 v[132:133], v[132:133], v[148:149]
    v_pk_mul_f32 v[134:135], v[134:135], v[150:151]
    v_cvt_pk_bf16_f32 v128, 0, v128
    v_cvt_pk_bf16_f32 v129, 0, v129
    v_cvt_pk_bf16_f32 v130, 0, v130
    v_cvt_pk_bf16_f32 v131, 0, v131
    v_cvt_pk_bf16_f32 v132, 0, v132
    v_cvt_pk_bf16_f32 v133, 0, v133
    v_cvt_pk_bf16_f32 v134, 0, v134
    v_cvt_pk_bf16_f32 v135, 0, v135
    v_pk_add_f32 v[128:129], v[128:129], v[160:161]
    v_pk_add_f32 v[130:131], v[130:131], v[162:163]
    v_pk_add_f32 v[132:133], v[132:133], v[164:165]
    v_pk_add_f32 v[134:135], v[134:135], v[166:167]
    v_cvt_pk_bf16_f32 v16, v128, v129
    v_cvt_pk_bf16_f32 v17, v130, v131
    v_cvt_pk_bf16_f32 v18, v132, v133
    v_cvt_pk_bf16_f32 v19, v134, v135
    v_dot2_f32_bf16 v4, v16, v16, v4
    v_dot2_f32_bf16 v5, v17, v17, v5
    v_dot2_f32_bf16 v4, v18, v18, v4
    v_dot2_f32_bf16 v5, v19, v19, v5
    v_mfma_f32_16x16x32_bf16 v[240:243], v[188:191], v[16:19], v[240:243]
    v_and_b32 v7, 7, v1
    v_lshlrev_b32 v7, 15, v7
    v_bfe_u32 v9, v1, 3, 1
    v_lshl_add_u32 v7, v9, 12, v7
    v_add_f32 v4, v4, v5
    v_mov_b32 v5, v4
    s_nop 1
    v_permlane32_swap_b32 v4, v5
    v_add_f32 v4, v4, v5
    v_mov_b32 v5, v4
    s_nop 1
    v_permlane16_swap_b32 v4, v5
    v_add_f32 v4, v4, v5
    s_nop 1
    v_mov_b32_dpp v240, v4 quad_perm:[0,1,2,3] row_mask:0x8 bank_mask:0xf
    buffer_store_dword v240, v28, s[32:35], s14 offen sc1
    s_and_b32 s96, s12, 1
    s_lshr_b32 s97, s21, 2
    s_and_b32 s98, s21, 3
    s_lshl_b32 s99, s98, 6
    s_lshl1_add_u32 s98, s97, s99
    s_lshl_b32 s97, s98, 12
    s_lshr_b32 s99, s12, 1
    s_lshl_b32 s98, s99, 6
    s_add_u32 s99, s97, s98
    s_lshl2_add_u32 s97, s96, s99
    s_add_u32 s98, s97, 1048576
    s_add_u32 s16, s98, 1536
    s_barrier
    s_cmp_lg_u32 s3, 0
    s_cbranch_scc1 L_PE
    v_mov_b32 v6, s4
    s_mov_b32 exec_hi, 0
    s_mov_b32 exec_lo, 65535
    buffer_store_dword v6, v7, s[32:35], s16 offen sc1
    s_mov_b64 exec, -1
L_PE:
    s_add_u32 s82, s80, 114688
    s_lshl2_add_u32 m0, s83, 34816
    s_nop 0
    buffer_load_dwordx4 v27, s[56:59], s82 offen nt lds
    s_add_u32 s82, s80, 172032
    s_lshl2_add_u32 m0, s83, 35840
    s_nop 0
    buffer_load_dwordx4 v27, s[56:59], s82 offen nt lds
    s_lshl_b32 s15, s3, 12
    v_add_u32 v4, s15, v2
    v_add_u32 v7, 65536, v4
    s_waitcnt vmcnt(5)
    v_cmp_ne_u32 vcc, s4, v41
    s_cbranch_vccz L_UPOK
POLL_31:
    buffer_load_dwordx2 v[40:41], v10, s[32:35], s13 offen sc1
    s_waitcnt vmcnt(0)
    v_cmp_ne_u32 vcc, s4, v41
    s_cbranch_vccz PDONE_32
    s_add_u32 s5, s5, 1
    s_cmp_lt_u32 s5, 200000
    s_cbranch_scc1 POLL_31
PDONE_32:
L_UPOK:
    s_lshl3_add_u32 s96, s21, s3
    s_lshl_b32 s97, s96, 12
    s_add_u32 s14, s97, 12582912
    s_load_dwordx2 s[24:25], s[32:33], s92 offset:1536 glc
    v_add_f32_dpp v40, v40, v40 quad_perm:[1,0,3,2] row_mask:0xf bank_mask:0xf
    s_nop 1
    v_add_f32_dpp v40, v40, v40 quad_perm:[2,3,0,1] row_mask:0xf bank_mask:0xf
    s_nop 1
    v_add_f32_dpp v40, v40, v40 row_half_mirror row_mask:0xf bank_mask:0xf
    s_nop 1
    v_add_f32_dpp v40, v40, v40 row_mirror row_mask:0xf bank_mask:0xf
    v_lshlrev_b32 v152, 16, v12
    v_and_b32 v153, s6, v12
    v_lshlrev_b32 v154, 16, v13
    v_and_b32 v155, s6, v13
    v_lshlrev_b32 v156, 16, v14
    v_and_b32 v157, s6, v14
    v_lshlrev_b32 v158, 16, v15
    v_and_b32 v159, s6, v15
    v_lshlrev_b32 v160, 16, v16
    v_and_b32 v161, s6, v16
    v_lshlrev_b32 v162, 16, v17
    v_and_b32 v163, s6, v17
    v_lshlrev_b32 v164, 16, v18
    v_and_b32 v165, s6, v18
    v_lshlrev_b32 v166, 16, v19
    v_and_b32 v167, s6, v19
    s_lshl_b32 s96, s3, 9
    s_lshl1_add_u32 s15, s21, s96
    v_and_b32 v29, 15, v1
    v_lshl_add_u32 v29, v29, 5, s15
    v_xor_b32 v5, 0x4000, v4
    v_xor_b32 v8, 0x4000, v7
    s_waitcnt vmcnt(3)
    ds_write_b128 v4, v[88:91] offset:32768
    ds_write_b128 v4, v[92:95] offset:33792
    s_cmp_lt_u32 s3, 4
    s_cbranch_scc1 L_FW1
    ds_write_b128 v4, v[56:59] offset:0
    ds_write_b128 v5, v[60:63] offset:0
    ds_write_b128 v4, v[64:67] offset:1024
    ds_write_b128 v5, v[68:71] offset:1024
    ds_write_b128 v4, v[72:75] offset:2048
    ds_write_b128 v5, v[76:79] offset:2048
    ds_write_b128 v4, v[80:83] offset:3072
    ds_write_b128 v5, v[84:87] offset:3072
L_FW1:
    s_branch SCHK_34
SPOLL_33:
    s_load_dwordx2 s[24:25], s[32:33], s92 offset:1536 glc
SCHK_34:
    s_add_u32 s5, s5, 1
    s_cmp_ge_u32 s5, 200000
    s_waitcnt lgkmcnt(0)
    s_cbranch_scc1 SDONE_35
    s_cmp_lg_u32 s24, s4
    s_cbranch_scc1 SPOLL_33
    s_cmp_lg_u32 s25, s4
    s_cbranch_scc1 SPOLL_33
SDONE_35:
    s_barrier
    buffer_load_dwordx4 v[192:195], v2, s[32:35], s14 offen sc1
    buffer_load_dwordx4 v[196:199], v2, s[32:35], s14 offen offset:1024 sc1
    buffer_load_dwordx4 v[200:203], v2, s[32:35], s14 offen offset:2048 sc1
    buffer_load_dwordx4 v[204:207], v2, s[32:35], s14 offen offset:3072 sc1
    s_barrier
    s_mov_b32 s82, s81
    s_lshl2_add_u32 m0, s83, 65536
    s_nop 0
    buffer_load_dwordx4 v253, s[60:63], s82 offen nt lds
    s_add_u32 s82, s81, 4096
    s_lshl2_add_u32 m0, s83, 66560
    s_nop 0
    buffer_load_dwordx4 v253, s[60:63], s82 offen nt lds
    s_add_u32 s82, s81, 8192
    s_lshl2_add_u32 m0, s83, 67584
    s_nop 0
    buffer_load_dwordx4 v253, s[60:63], s82 offen nt lds
    s_add_u32 s82, s81, 12288
    s_lshl2_add_u32 m0, s83, 68608
    s_nop 0
    buffer_load_dwordx4 v253, s[60:63], s82 offen nt lds
    v_mov_b32_dpp v88, v42 row_newbcast:0 row_mask:0xf bank_mask:0xf
    v_mov_b32_dpp v89, v42 row_newbcast:1 row_mask:0xf bank_mask:0xf
    v_mov_b32_dpp v90, v42 row_newbcast:2 row_mask:0xf bank_mask:0xf
    v_mov_b32_dpp v91, v42 row_newbcast:3 row_mask:0xf bank_mask:0xf
    v_mov_b32_dpp v92, v42 row_newbcast:4 row_mask:0xf bank_mask:0xf
    v_mov_b32_dpp v93, v42 row_newbcast:5 row_mask:0xf bank_mask:0xf
    v_mov_b32_dpp v94, v42 row_newbcast:6 row_mask:0xf bank_mask:0xf
    v_mov_b32_dpp v95, v42 row_newbcast:7 row_mask:0xf bank_mask:0xf
    v_mov_b32_dpp v96, v42 row_newbcast:8 row_mask:0xf bank_mask:0xf
    v_mov_b32_dpp v97, v42 row_newbcast:9 row_mask:0xf bank_mask:0xf
    v_mov_b32_dpp v98, v42 row_newbcast:10 row_mask:0xf bank_mask:0xf
    v_mov_b32_dpp v99, v42 row_newbcast:11 row_mask:0xf bank_mask:0xf
    v_mov_b32_dpp v100, v42 row_newbcast:12 row_mask:0xf bank_mask:0xf
    v_mov_b32_dpp v101, v42 row_newbcast:13 row_mask:0xf bank_mask:0xf
    v_mov_b32_dpp v102, v42 row_newbcast:14 row_mask:0xf bank_mask:0xf
    v_mov_b32_dpp v103, v42 row_newbcast:15 row_mask:0xf bank_mask:0xf
    v_mov_b32_dpp v104, v43 row_newbcast:0 row_mask:0xf bank_mask:0xf
    v_mov_b32_dpp v105, v43 row_newbcast:1 row_mask:0xf bank_mask:0xf
L_PAD9:
    s_cbranch_execz L_RET9
    v_mov_b32_dpp v106, v43 row_newbcast:2 row_mask:0xf bank_mask:0xf
    v_mov_b32_dpp v107, v43 row_newbcast:3 row_mask:0xf bank_mask:0xf
    v_mov_b32_dpp v108, v43 row_newbcast:4 row_mask:0xf bank_mask:0xf
    v_mov_b32_dpp v109, v43 row_newbcast:5 row_mask:0xf bank_mask:0xf
    v_mov_b32_dpp v110, v43 row_newbcast:6 row_mask:0xf bank_mask:0xf
    v_mov_b32_dpp v111, v43 row_newbcast:7 row_mask:0xf bank_mask:0xf
    v_mov_b32_dpp v112, v43 row_newbcast:8 row_mask:0xf bank_mask:0xf
    v_mov_b32_dpp v113, v43 row_newbcast:9 row_mask:0xf bank_mask:0xf
    v_mov_b32_dpp v114, v43 row_newbcast:10 row_mask:0xf bank_mask:0xf
    v_mov_b32_dpp v115, v43 row_newbcast:11 row_mask:0xf bank_mask:0xf
    v_mov_b32_dpp v116, v43 row_newbcast:12 row_mask:0xf bank_mask:0xf
    v_mov_b32_dpp v117, v43 row_newbcast:13 row_mask:0xf bank_mask:0xf
    v_mov_b32_dpp v118, v43 row_newbcast:14 row_mask:0xf bank_mask:0xf
    v_mov_b32_dpp v119, v43 row_newbcast:15 row_mask:0xf bank_mask:0xf
    s_lshl3_add_u32 s15, s3, 156160
    v_mov_b32 v4, s15
    v_and_b32 v5, 7, v1
    v_lshlrev_b32 v5, 3, v5
    v_add_u32 v5, 156160, v5
    v_and_b32 v6, 3, v1
    v_lshlrev_b32 v6, 18, v6
    v_bfe_u32 v9, v1, 2, 2
    v_lshl_add_u32 v6, v9, 13, v6
    s_and_b32 s96, s21, 1
    s_and_b32 s97, s12, 7
    s_lshr_b32 s98, s12, 3
    s_lshl3_add_u32 s99, s97, s98
    s_lshl_b32 s97, s99, 12
    s_lshr_b32 s98, s21, 1
    s_lshl_b32 s99, s98, 6
    s_add_u32 s98, s97, s99
    s_lshl4_add_u32 s97, s96, s98
    s_add_u32 s99, s97, 1048576
    s_add_u32 s16, s99, 2560
    s_waitcnt vmcnt(4)
    v_pk_add_f32 v[192:193], v[192:193], v[196:197]
    v_pk_add_f32 v[200:201], v[200:201], v[204:205]
    v_pk_add_f32 v[194:195], v[194:195], v[198:199]
    v_pk_add_f32 v[202:203], v[202:203], v[206:207]
    v_pk_add_f32 v[192:193], v[192:193], v[200:201]
    v_pk_add_f32 v[194:195], v[194:195], v[202:203]
    v_add_f32 v193, v193, v194
    v_add_f32 v197, v192, v195
    v_cmp_u_f32 vcc, v193, v197
    s_cbranch_vccz POK_37
PRE_38:
    buffer_load_dwordx4 v[192:195], v2, s[32:35], s14 offen sc1
    buffer_load_dwordx4 v[196:199], v2, s[32:35], s14 offen offset:1024 sc1
    buffer_load_dwordx4 v[200:203], v2, s[32:35], s14 offen offset:2048 sc1
    buffer_load_dwordx4 v[204:207], v2, s[32:35], s14 offen offset:3072 sc1
    s_waitcnt vmcnt(0)
    v_pk_add_f32 v[192:193], v[192:193], v[196:197]
    v_pk_add_f32 v[200:201], v[200:201], v[204:205]
    v_pk_add_f32 v[194:195], v[194:195], v[198:199]
    v_pk_add_f32 v[202:203], v[202:203], v[206:207]
    v_pk_add_f32 v[192:193], v[192:193], v[200:201]
    v_pk_add_f32 v[194:195], v[194:195], v[202:203]
    v_add_f32 v193, v193, v194
    v_add_f32 v197, v192, v195
    v_cmp_u_f32 vcc, v193, v197
    s_cbranch_vccz POK_37
    s_add_u32 s5, s5, 1
    s_cmp_lt_u32 s5, 200000
    s_cbranch_scc1 PRE_38
POK_37:
    v_mov_b32 v196, v195
    s_nop 1
    v_permlane32_swap_b32 v195, v196
    v_permlane32_swap_b32 v192, v193
    v_add_f32 v195, v195, v196
    v_add_f32 v192, v192, v193
    s_nop 1
    v_permlane16_swap_b32 v192, v195
    v_add_f32 v193, v192, v195
    v_add_f32 v195, v192, v195
    s_nop 1
    v_permlane16_swap_b32 v193, v195
    v_mov_b32 v192, v193
    v_mul_f32 v195, 0x3a800000, v195
    s_nop 0
    v_permlane32_swap_b32 v192, v193
    v_mul_f32 v192, 0x3a800000, v192
    v_fma_f32 v31, -v192, v192, v195
    v_cvt_pk_bf16_f32 v30, 0, v192
    v_max_f32 v31, 0, v31
    v_cvt_pk_bf16_f32 v31, 0, v31
    v_fma_f32 v193, -v30, v40, v193
    v_add_f32 v31, 0x3727c5ac, v31
    v_cvt_pk_bf16_f32 v31, 0, v31
    v_sqrt_f32 v31, v31
    s_nop 0
    v_cvt_pk_bf16_f32 v31, 0, v31
    v_rcp_f32 v31, v31
    s_nop 0
    v_mul_f32 v32, v193, v31
    v_ashrrev_i32 v196, 31, v32
    v_or_b32 v196, 0x80000000, v196
    v_xor_b32 v32, v32, v196
    s_mov_b32 s15, 0xfffff000
    v_and_or_b32 v32, v32, s15, v29
    s_nop 1
    v_max_u32_dpp v244, v32, v32 quad_perm:[1,0,3,2] row_mask:0xf bank_mask:0xf
    v_min_u32_dpp v245, v32, v32 quad_perm:[1,0,3,2] row_mask:0xf bank_mask:0xf
    s_nop 0
    v_min_u32_dpp v196, v244, v244 quad_perm:[2,3,0,1] row_mask:0xf bank_mask:0xf
    v_max_u32_dpp v245, v245, v245 quad_perm:[2,3,0,1] row_mask:0xf bank_mask:0xf
    v_max_u32_dpp v244, v244, v244 quad_perm:[2,3,0,1] row_mask:0xf bank_mask:0xf
    v_max_u32 v245, v245, v196
    s_nop 0
    v_min_u32_dpp v196, v244, v244 row_half_mirror row_mask:0xf bank_mask:0xf
    v_max_u32_dpp v245, v245, v245 row_half_mirror row_mask:0xf bank_mask:0xf
    v_max_u32_dpp v244, v244, v244 row_half_mirror row_mask:0xf bank_mask:0xf
    v_max_u32 v245, v245, v196
    s_nop 0
    v_min_u32_dpp v196, v244, v244 row_mirror row_mask:0xf bank_mask:0xf
    v_max_u32_dpp v245, v245, v245 row_mirror row_mask:0xf bank_mask:0xf
    v_max_u32_dpp v244, v244, v244 row_mirror row_mask:0xf bank_mask:0xf
    v_max_u32 v245, v245, v196
    ds_write_b64 v4, v[244:245]
    s_waitcnt lgkmcnt(0)
    s_barrier
    ds_read_b64 v[244:245], v5
    v_pk_add_f32 v[208:209], v[152:153], v[30:31] op_sel_hi:[1,0] neg_lo:[0,1] neg_hi:[0,1]
    v_pk_add_f32 v[210:211], v[154:155], v[30:31] op_sel_hi:[1,0] neg_lo:[0,1] neg_hi:[0,1]
    v_pk_add_f32 v[212:213], v[156:157], v[30:31] op_sel_hi:[1,0] neg_lo:[0,1] neg_hi:[0,1]
    v_pk_add_f32 v[214:215], v[158:159], v[30:31] op_sel_hi:[1,0] neg_lo:[0,1] neg_hi:[0,1]
    v_pk_add_f32 v[216:217], v[160:161], v[30:31] op_sel_hi:[1,0] neg_lo:[0,1] neg_hi:[0,1]
    v_pk_add_f32 v[218:219], v[162:163], v[30:31] op_sel_hi:[1,0] neg_lo:[0,1] neg_hi:[0,1]
    v_pk_add_f32 v[220:221], v[164:165], v[30:31] op_sel_hi:[1,0] neg_lo:[0,1] neg_hi:[0,1]
    v_pk_add_f32 v[222:223], v[166:167], v[30:31] op_sel_hi:[1,0] neg_lo:[0,1] neg_hi:[0,1]
    s_waitcnt lgkmcnt(0)
    v_min_u32_dpp v196, v244, v244 quad_perm:[1,0,3,2] row_mask:0xf bank_mask:0xf
    v_max_u32_dpp v245, v245, v245 quad_perm:[1,0,3,2] row_mask:0xf bank_mask:0xf
    v_max_u32_dpp v244, v244, v244 quad_perm:[1,0,3,2] row_mask:0xf bank_mask:0xf
    v_max_u32 v245, v245, v196
    s_nop 0
    v_min_u32_dpp v196, v244, v244 quad_perm:[2,3,0,1] row_mask:0xf bank_mask:0xf
    v_max_u32_dpp v245, v245, v245 quad_perm:[2,3,0,1] row_mask:0xf bank_mask:0xf
    v_max_u32_dpp v244, v244, v244 quad_perm:[2,3,0,1] row_mask:0xf bank_mask:0xf
    v_max_u32 v245, v245, v196
    s_nop 0
    v_min_u32_dpp v196, v244, v244 row_half_mirror row_mask:0xf bank_mask:0xf
    v_max_u32_dpp v245, v245, v245 row_half_mirror row_mask:0xf bank_mask:0xf
    v_max_u32_dpp v244, v244, v244 row_half_mirror row_mask:0xf bank_mask:0xf
    v_max_u32 v245, v245, v196
    v_cmp_eq_u32 s[88:89], v32, v245
    v_cmp_eq_u32 vcc, v32, v244
    v_or_b32 v246, 1, v245
    v_mov_b32 v245, s4
    v_mov_b32 v247, s4
    s_or_b64 s[84:85], vcc, s[88:89]
    s_cmp_lg_u32 s3, 0
    s_cbranch_scc1 L_NOF
    s_mov_b64 exec, 0xffff
    buffer_store_dwordx4 v[244:247], v6, s[32:35], s16 offen sc1
    s_mov_b64 exec, -1
L_NOF:
    s_cmp_eq_u64 s[84:85], 0
    s_cbranch_scc1 L_NOPR
    s_setprio 1
L_NOPR:
    s_lshl4_add_u32 s13, s3, 156288
    v_mov_b32 v4, s13
    v_and_b32 v5, 7, v1
    v_lshlrev_b32 v5, 4, v5
    v_add_u32 v5, 156288, v5
    s_load_dwordx8 s[24:31], s[32:33], s92 offset:2560 glc
    v_cvt_pk_bf16_f32 v208, 0, v208
    v_cvt_pk_bf16_f32 v209, 0, v209
    v_cvt_pk_bf16_f32 v210, 0, v210
    v_cvt_pk_bf16_f32 v211, 0, v211
    v_cvt_pk_bf16_f32 v212, 0, v212
    v_cvt_pk_bf16_f32 v213, 0, v213
    v_cvt_pk_bf16_f32 v214, 0, v214
    v_cvt_pk_bf16_f32 v215, 0, v215
    v_cvt_pk_bf16_f32 v216, 0, v216
    v_cvt_pk_bf16_f32 v217, 0, v217
    v_cvt_pk_bf16_f32 v218, 0, v218
    v_cvt_pk_bf16_f32 v219, 0, v219
    v_cvt_pk_bf16_f32 v220, 0, v220
    v_cvt_pk_bf16_f32 v221, 0, v221
    v_cvt_pk_bf16_f32 v222, 0, v222
    v_cvt_pk_bf16_f32 v223, 0, v223
    v_pk_mul_f32 v[208:209], v[30:31], v[208:209] op_sel:[1,0]
    v_pk_mul_f32 v[210:211], v[30:31], v[210:211] op_sel:[1,0]
    v_pk_mul_f32 v[212:213], v[30:31], v[212:213] op_sel:[1,0]
    v_pk_mul_f32 v[214:215], v[30:31], v[214:215] op_sel:[1,0]
    v_pk_mul_f32 v[216:217], v[30:31], v[216:217] op_sel:[1,0]
    v_pk_mul_f32 v[218:219], v[30:31], v[218:219] op_sel:[1,0]
    v_pk_mul_f32 v[220:221], v[30:31], v[220:221] op_sel:[1,0]
    v_pk_mul_f32 v[222:223], v[30:31], v[222:223] op_sel:[1,0]
    v_cvt_pk_bf16_f32 v208, 0, v208
    v_cvt_pk_bf16_f32 v209, 0, v209
    v_cvt_pk_bf16_f32 v210, 0, v210
    v_cvt_pk_bf16_f32 v211, 0, v211
    v_cvt_pk_bf16_f32 v212, 0, v212
    v_cvt_pk_bf16_f32 v213, 0, v213
    v_cvt_pk_bf16_f32 v214, 0, v214
    v_cvt_pk_bf16_f32 v215, 0, v215
    v_cvt_pk_bf16_f32 v216, 0, v216
    v_cvt_pk_bf16_f32 v217, 0, v217
    v_cvt_pk_bf16_f32 v218, 0, v218
    v_cvt_pk_bf16_f32 v219, 0, v219
    v_cvt_pk_bf16_f32 v220, 0, v220
    v_cvt_pk_bf16_f32 v221, 0, v221
    v_cvt_pk_bf16_f32 v222, 0, v222
    v_cvt_pk_bf16_f32 v223, 0, v223
    v_pk_mul_f32 v[208:209], v[208:209], v[168:169]
    v_pk_mul_f32 v[210:211], v[210:211], v[170:171]
    v_pk_mul_f32 v[212:213], v[212:213], v[172:173]
    v_pk_mul_f32 v[214:215], v[214:215], v[174:175]
    v_pk_mul_f32 v[216:217], v[216:217], v[176:177]
    v_pk_mul_f32 v[218:219], v[218:219], v[178:179]
    v_pk_mul_f32 v[220:221], v[220:221], v[180:181]
    v_pk_mul_f32 v[222:223], v[222:223], v[182:183]
    v_cvt_pk_bf16_f32 v208, 0, v208
    v_cvt_pk_bf16_f32 v209, 0, v209
    v_cvt_pk_bf16_f32 v210, 0, v210
    v_cvt_pk_bf16_f32 v211, 0, v211
    v_cvt_pk_bf16_f32 v212, 0, v212
    v_cvt_pk_bf16_f32 v213, 0, v213
    v_cvt_pk_bf16_f32 v214, 0, v214
    v_cvt_pk_bf16_f32 v215, 0, v215
    v_cvt_pk_bf16_f32 v216, 0, v216
    v_cvt_pk_bf16_f32 v217, 0, v217
    v_cvt_pk_bf16_f32 v218, 0, v218
    v_cvt_pk_bf16_f32 v219, 0, v219
    v_cvt_pk_bf16_f32 v220, 0, v220
    v_cvt_pk_bf16_f32 v221, 0, v221
    v_cvt_pk_bf16_f32 v222, 0, v222
    v_cvt_pk_bf16_f32 v223, 0, v223
    v_pk_add_f32 v[208:209], v[208:209], v[88:89]
    v_pk_add_f32 v[210:211], v[210:211], v[90:91]
    v_pk_add_f32 v[212:213], v[212:213], v[92:93]
    v_pk_add_f32 v[214:215], v[214:215], v[94:95]
    v_pk_add_f32 v[216:217], v[216:217], v[96:97]
    v_pk_add_f32 v[218:219], v[218:219], v[98:99]
    v_pk_add_f32 v[220:221], v[220:221], v[100:101]
    v_pk_add_f32 v[222:223], v[222:223], v[102:103]
    v_cvt_pk_bf16_f32 v224, v208, v209
    v_cvt_pk_bf16_f32 v225, v210, v211
    v_cvt_pk_bf16_f32 v226, v212, v213
    v_cvt_pk_bf16_f32 v227, v214, v215
    v_cvt_pk_bf16_f32 v228, v216, v217
    v_cvt_pk_bf16_f32 v229, v218, v219
    v_cvt_pk_bf16_f32 v230, v220, v221
    v_cvt_pk_bf16_f32 v231, v222, v223
    s_cmp_eq_u64 s[84:85], 0
    s_cbranch_scc1 L_NOCAND
    v_mfma_f32_16x16x32_bf16 v[240:243], v[184:187], v[224:227], 0
    v_mfma_f32_16x16x32_bf16 v[240:243], v[188:191], v[228:231], v[240:243]
    v_mov_b32 v232, v224
    v_mov_b32 v233, v225
    v_mov_b32 v234, v226
    v_mov_b32 v235, v227
    v_mov_b32 v236, v228
    v_mov_b32 v237, v229
    v_mov_b32 v238, v230
    v_mov_b32 v239, v231
    s_lshl_b32 s96, s21, 14
    s_lshl_b32 s97, s12, 9
    s_add_u32 s98, s96, s97
    s_add_u32 s15, s98, 13631488
    v_lshrrev_b32 v7, 4, v1
    v_lshlrev_b32 v7, 4, v7
    v_add_u32 v8, 8192, v7
    v_permlane32_swap_b32 v232, v234
    v_permlane32_swap_b32 v233, v235
    v_permlane32_swap_b32 v236, v238
    v_permlane32_swap_b32 v237, v239
    v_permlane32_swap_b32 v12, v14
    v_permlane32_swap_b32 v13, v15
    v_permlane32_swap_b32 v16, v18
    v_permlane32_swap_b32 v17, v19
    v_cndmask_b32 v7, v7, v8, s[88:89]
    s_mov_b64 exec, s[84:85]
    buffer_store_dwordx4 v[232:235], v7, s[32:35], s15 offen sc1
    buffer_store_dwordx4 v[236:239], v7, s[32:35], s15 offen offset:64 sc1
    s_mov_b32 exec_lo, 0
    s_and_b32 exec_hi, s85, 0xffff0000
    buffer_store_dword v240, v7, s[32:35], s15 offen offset:208 sc1
    s_mov_b64 exec, s[84:85]
    buffer_store_dwordx4 v[12:15], v7, s[32:35], s15 offen offset:128 sc1
    buffer_store_dwordx4 v[16:19], v7, s[32:35], s15 offen offset:192 sc1
    s_mov_b64 exec, -1
    s_setprio 0
L_NOCAND:
    v_lshlrev_b32 v208, 16, v224
    v_and_b32 v209, s6, v224
    v_lshlrev_b32 v210, 16, v225
    v_and_b32 v211, s6, v225
    v_lshlrev_b32 v212, 16, v226
    v_and_b32 v213, s6, v226
    v_lshlrev_b32 v214, 16, v227
    v_and_b32 v215, s6, v227
    v_lshlrev_b32 v216, 16, v228
    v_and_b32 v217, s6, v228
    v_lshlrev_b32 v218, 16, v229
    v_and_b32 v219, s6, v229
    v_lshlrev_b32 v220, 16, v230
    v_and_b32 v221, s6, v230
    v_lshlrev_b32 v222, 16, v231
    v_and_b32 v223, s6, v231
    v_pk_mul_f32 v[208:209], v[208:209], v[104:105]
    v_pk_mul_f32 v[210:211], v[210:211], v[106:107]
    v_pk_mul_f32 v[212:213], v[212:213], v[108:109]
    v_pk_mul_f32 v[214:215], v[214:215], v[110:111]
    v_pk_mul_f32 v[216:217], v[216:217], v[112:113]
    v_pk_mul_f32 v[218:219], v[218:219], v[114:115]
    v_pk_mul_f32 v[220:221], v[220:221], v[116:117]
    v_pk_mul_f32 v[222:223], v[222:223], v[118:119]
    v_cvt_pk_bf16_f32 v208, 0, v208
    v_cvt_pk_bf16_f32 v209, 0, v209
    v_cvt_pk_bf16_f32 v210, 0, v210
    v_cvt_pk_bf16_f32 v211, 0, v211
    v_cvt_pk_bf16_f32 v212, 0, v212
    v_cvt_pk_bf16_f32 v213, 0, v213
    v_cvt_pk_bf16_f32 v214, 0, v214
    v_cvt_pk_bf16_f32 v215, 0, v215
    v_cvt_pk_bf16_f32 v216, 0, v216
    v_cvt_pk_bf16_f32 v217, 0, v217
    v_cvt_pk_bf16_f32 v218, 0, v218
    v_cvt_pk_bf16_f32 v219, 0, v219
    v_cvt_pk_bf16_f32 v220, 0, v220
    v_cvt_pk_bf16_f32 v221, 0, v221
    v_cvt_pk_bf16_f32 v222, 0, v222
    v_cvt_pk_bf16_f32 v223, 0, v223
    s_lshl_b32 s96, s3, 11
    s_add_u32 s13, s96, 98304
    v_lshrrev_b32 v202, 4, v1
    v_lshlrev_b32 v202, 4, v202
    v_and_b32 v203, 7, v1
    v_lshlrev_b32 v203, 4, v203
    v_xor_b32 v202, v202, v203
    v_and_b32 v204, 15, v1
    v_lshl_add_u32 v204, v204, 7, s13
    v_add_u32 v202, v202, v204
    v_xor_b32 v204, 64, v202
    v_lshrrev_b32 v205, 3, v1
    v_lshlrev_b32 v205, 4, v205
    v_xor_b32 v203, v205, v203
    v_lshrrev_b32 v205, 3, v1
    v_lshl_add_u32 v205, v205, 7, s13
    v_add_u32 v203, v203, v205
    s_lshl_b32 s96, s21, 7
    s_sub_u32 s97, 2047, s96
    s_lshl_b32 s98, s3, 4
    s_sub_u32 s13, s97, s98
    v_lshrrev_b32 v43, 3, v1
    v_sub_u32 v42, s13, v43
    v_subrev_u32 v43, 8, v42
    v_lshrrev_b32 v33, 3, v1
    v_lshlrev_b32 v33, 11, v33
    v_and_b32 v9, 7, v1
    v_lshl_add_u32 v33, v9, 4, v33
    s_lshl3_add_u32 s96, s21, s3
    s_lshl_b32 s97, s96, 15
    s_lshl_b32 s98, s12, 7
    s_add_u32 s16, s97, s98
    s_add_u32 s15, s16, 16384
    s_branch SCHK_40
SPOLL_39:
    s_load_dwordx8 s[24:31], s[32:33], s92 offset:2560 glc
SCHK_40:
    s_add_u32 s5, s5, 1
    s_cmp_ge_u32 s5, 200000
    s_waitcnt lgkmcnt(0)
    s_cbranch_scc1 SDONE_41
    s_cmp_lg_u32 s25, s4
    s_cbranch_scc1 SPOLL_39
    s_cmp_lg_u32 s27, s4
    s_cbranch_scc1 SPOLL_39
    s_cmp_lg_u32 s29, s4
    s_cbranch_scc1 SPOLL_39
    s_cmp_lg_u32 s31, s4
    s_cbranch_scc1 SPOLL_39
SDONE_41:
    s_min_u32 s25, s24, s28
    s_min_u32 s27, s26, s28
    s_min_u32 s29, s24, s30
    s_max_u32 s24, s24, s28
    s_max_u32 s26, s26, s30
    s_max_u32 s27, s27, s29
    s_max_u32 s25, s25, s26
    v_mov_b32 v244, s24
    v_mov_b32 v246, s27
    v_mov_b32 v245, s25
    ds_write_b128 v4, v[244:247]
    s_lshr_b32 s96, s3, 2
    s_lshl_b32 s97, s96, 15
    s_and_b32 s98, s3, 3
    s_lshl_b32 s99, s98, 5
    s_add_u32 s13, s97, s99
    v_lshrrev_b32 v34, 4, v1
    v_lshlrev_b32 v34, 13, v34
    v_bfe_u32 v9, v1, 2, 2
    v_lshl_add_u32 v34, v9, 7, v34
    v_bfe_u32 v9, v1, 3, 2
    v_lshl_add_u32 v34, v9, 5, v34
    v_and_b32 v9, 3, v1
    v_lshl_add_u32 v34, v9, 3, v34
    v_xor_b32 v34, s13, v34
    s_lshl_b32 s96, s75, 11
    s_add_u32 s13, s96, 13631488
    v_and_b32 v36, 7, v1
    v_lshl_add_u32 v36, v36, 4, s13
    v_lshrrev_b32 v9, 4, v1
    v_lshl_add_u32 v36, v9, 9, v36
    v_and_b32 v10, 15, v1
    v_lshlrev_b32 v10, 9, v10
    v_add_u32 v10, 13631744, v10
    s_waitcnt vmcnt(0)
    s_waitcnt lgkmcnt(0)
    s_barrier
    ds_read_b128 v[244:247], v5
    v_and_b32 v8, 8, v1
    v_cmp_eq_u32 s[22:23], 0, v8
    v_cmp_gt_u32 s[24:25], 16, v1
    v_cmp_gt_u32 s[26:27], 32, v1
    s_waitcnt lgkmcnt(0)
    v_min_u32_dpp v192, v244, v244 quad_perm:[1,0,3,2] row_mask:0xf bank_mask:0xf
    v_min_u32_dpp v193, v245, v244 quad_perm:[1,0,3,2] row_mask:0xf bank_mask:0xf
    v_min_u32_dpp v194, v244, v245 quad_perm:[1,0,3,2] row_mask:0xf bank_mask:0xf
    v_max_u32_dpp v246, v246, v246 quad_perm:[1,0,3,2] row_mask:0xf bank_mask:0xf
    v_max_u32_dpp v245, v245, v245 quad_perm:[1,0,3,2] row_mask:0xf bank_mask:0xf
    v_max_u32_dpp v244, v244, v244 quad_perm:[1,0,3,2] row_mask:0xf bank_mask:0xf
    v_max3_u32 v246, v246, v193, v194
    v_max_u32 v245, v245, v192
    v_min_u32_dpp v192, v244, v244 quad_perm:[2,3,0,1] row_mask:0xf bank_mask:0xf
    s_nop 0
    v_min_u32_dpp v193, v245, v244 quad_perm:[2,3,0,1] row_mask:0xf bank_mask:0xf
    v_min_u32_dpp v194, v244, v245 quad_perm:[2,3,0,1] row_mask:0xf bank_mask:0xf
    v_max_u32_dpp v246, v246, v246 quad_perm:[2,3,0,1] row_mask:0xf bank_mask:0xf
    v_max_u32_dpp v245, v245, v245 quad_perm:[2,3,0,1] row_mask:0xf bank_mask:0xf
    v_max_u32_dpp v244, v244, v244 quad_perm:[2,3,0,1] row_mask:0xf bank_mask:0xf
    v_max3_u32 v246, v246, v193, v194
    v_max_u32 v245, v245, v192
    v_min_u32_dpp v192, v244, v244 row_half_mirror row_mask:0xf bank_mask:0xf
    s_nop 0
    v_min_u32_dpp v193, v245, v244 row_half_mirror row_mask:0xf bank_mask:0xf
    v_min_u32_dpp v194, v244, v245 row_half_mirror row_mask:0xf bank_mask:0xf
    v_max_u32_dpp v246, v246, v246 row_half_mirror row_mask:0xf bank_mask:0xf
    v_max_u32_dpp v245, v245, v245 row_half_mirror row_mask:0xf bank_mask:0xf
    v_max_u32_dpp v244, v244, v244 row_half_mirror row_mask:0xf bank_mask:0xf
    v_max3_u32 v246, v246, v193, v194
    v_max_u32 v245, v245, v192
    v_cndmask_b32 v192, v245, v244, s[22:23]
    v_cndmask_b32 v201, v246, v245, s[26:27]
    v_and_b32 v193, 31, v246
    v_and_b32 v192, 31, v192
    v_cndmask_b32 v201, v201, v244, s[24:25]
    v_lshl_add_u32 v4, v192, 13, v36
    v_lshl_add_u32 v5, v193, 13, v36
    v_and_b32 v194, 31, v201
    v_lshl_add_u32 v6, v194, 13, v10
    buffer_load_dwordx4 v[192:195], v4, s[32:35], 0 offen sc1
    buffer_load_dwordx4 v[196:199], v5, s[32:35], 0 offen sc1
    buffer_load_dword v200, v6, s[32:35], 0 offen sc1
    s_barrier
    v_readfirstlane_b32 s91, v244
    v_readfirstlane_b32 s94, v245
    v_readfirstlane_b32 s95, v246
    ds_read_b64_tr_b16 v[56:57], v34
    ds_read_b64_tr_b16 v[58:59], v34 offset:512
    ds_read_b64_tr_b16 v[60:61], v34 offset:1024
    ds_read_b64_tr_b16 v[62:63], v34 offset:1536
    ds_read_b64_tr_b16 v[64:65], v34 offset:2048
    ds_read_b64_tr_b16 v[66:67], v34 offset:2560
    ds_read_b64_tr_b16 v[68:69], v34 offset:3072
    ds_read_b64_tr_b16 v[70:71], v34 offset:3584
    ds_read_b64_tr_b16 v[72:73], v34 offset:4096
    ds_read_b64_tr_b16 v[74:75], v34 offset:4608
    ds_read_b64_tr_b16 v[76:77], v34 offset:5120
    ds_read_b64_tr_b16 v[78:79], v34 offset:5632
    ds_read_b64_tr_b16 v[80:81], v34 offset:6144
    ds_read_b64_tr_b16 v[82:83], v34 offset:6656
    ds_read_b64_tr_b16 v[84:85], v34 offset:7168
    ds_read_b64_tr_b16 v[86:87], v34 offset:7680
    s_bfe_u32 s96, s91, 262145
    s_lshl_b32 s97, s96, 7
    s_bfe_u32 s98, s91, 458757
    s_add_u32 s99, s97, s98
    s_xor_b32 s17, s99, 2047
    s_bfe_u32 s96, s94, 262145
    s_lshl_b32 s97, s96, 7
    s_bfe_u32 s98, s94, 458757
    s_add_u32 s99, s97, s98
    s_xor_b32 s18, s99, 2047
    s_bfe_u32 s96, s95, 262145
    s_lshl_b32 s97, s96, 7
    s_bfe_u32 s98, s95, 458757
    s_add_u32 s99, s97, s98
    s_xor_b32 s19, s99, 2047
    s_waitcnt lgkmcnt(0)
    s_lshl_b32 s13, s3, 6
    v_bfe_u32 v35, v1, 2, 1
    v_lshlrev_b32 v35, 9, v35
    v_bfe_u32 v9, v1, 3, 1
    v_lshl_add_u32 v35, v9, 12, v35
    v_lshrrev_b32 v9, 5, v1
    v_lshl_add_u32 v35, v9, 11, v35
    v_bfe_u32 v9, v1, 2, 2
    v_lshl_add_u32 v35, v9, 6, v35
    v_bfe_u32 v9, v1, 4, 1
    v_lshl_add_u32 v35, v9, 5, v35
    v_and_b32 v9, 3, v1
    v_lshl_add_u32 v35, v9, 3, v35
    v_xor_b32 v35, s13, v35
    v_add_u32 v35, 65536, v35
    v_and_b32 v8, 15, v1
    v_lshlrev_b32 v8, 4, v8
    v_lshrrev_b32 v9, 5, v1
    v_lshl_add_u32 v8, v9, 3, v8
    s_lshl_b32 s96, s74, 13
    s_add_u32 s14, s96, 20971520
    s_lshl3_add_u32 s96, s75, s3
    s_lshl_b32 s97, s96, 8
    s_add_u32 s20, s97, s14
    v_bfe_u32 v7, v201, 1, 4
    v_bfe_u32 v201, v201, 5, 7
    v_lshl_or_b32 v201, v7, 7, v201
    v_xor_b32 v201, 0x7ff, v201
    s_waitcnt vmcnt(0)
    v_max3_u32 v7, v192, v196, v200
    v_cmp_eq_u32 vcc, -1, v7
    s_cbranch_vccz POK_43
PRE_44:
    buffer_load_dwordx4 v[192:195], v4, s[32:35], 0 offen sc1
    buffer_load_dwordx4 v[196:199], v5, s[32:35], 0 offen sc1
    buffer_load_dword v200, v6, s[32:35], 0 offen sc1
    s_waitcnt vmcnt(0)
    v_max3_u32 v7, v192, v196, v200
    v_cmp_eq_u32 vcc, -1, v7
    s_cbranch_vccz POK_43
    s_add_u32 s5, s5, 1
    s_cmp_lt_u32 s5, 200000
    s_cbranch_scc1 PRE_44
POK_43:
    v_add_f32_dpp v200, v200, v200 quad_perm:[1,0,3,2] row_mask:0xf bank_mask:0xf
    s_nop 1
    v_add_f32_dpp v200, v200, v200 quad_perm:[2,3,0,1] row_mask:0xf bank_mask:0xf
    s_nop 1
    v_add_f32_dpp v200, v200, v200 row_half_mirror row_mask:0xf bank_mask:0xf
    s_nop 1
    v_add_f32_dpp v200, v200, v200 row_mirror row_mask:0xf bank_mask:0xf
    v_cvt_pk_bf16_f32 v200, 0, v200
    v_ashrrev_i32 v7, 31, v200
    v_or_b32 v7, 0x80000000, v7
    v_xor_b32 v200, v200, v7
    v_lshrrev_b32 v200, 16, v200
    v_lshl_or_b32 v200, v200, 11, v201
    s_nop 0
    v_readlane_b32 s24, v200, 0
    v_readlane_b32 s25, v200, 16
    v_readlane_b32 s26, v200, 32
    s_not_b64 s[28:29], s[22:23]
    s_cmp_lt_u32 s24, s25
    s_cselect_b64 s[28:29], s[22:23], s[28:29]
    s_cselect_b32 s27, s24, s25
    s_cmp_gt_u32 s26, s27
    s_cselect_b64 vcc, s[28:29], 0
    v_cndmask_b32 v192, v192, v196, vcc
    v_cndmask_b32 v193, v193, v197, vcc
    v_cndmask_b32 v194, v194, v198, vcc
    v_cndmask_b32 v195, v195, v199, vcc
    s_bitcmp1_b32 vcc_lo, 0
    s_cselect_b32 s24, s26, s24
    s_cselect_b32 s19, s17, s19
    s_cselect_b32 s17, s95, s91
    s_bitcmp1_b32 vcc_lo, 8
    s_cselect_b32 s25, s26, s25
    s_cselect_b32 s19, s18, s19
    s_cselect_b32 s18, s95, s94
    s_waitcnt lgkmcnt(0)
    v_mfma_f32_16x16x32_bf16 v[136:139], v[192:195], v[56:59], 0
    v_mfma_f32_16x16x32_bf16 v[140:143], v[192:195], v[60:63], 0
    v_mfma_f32_16x16x32_bf16 v[144:147], v[192:195], v[64:67], 0
    v_mfma_f32_16x16x32_bf16 v[148:151], v[192:195], v[68:71], 0
    v_mfma_f32_16x16x32_bf16 v[168:171], v[192:195], v[72:75], 0
    v_mfma_f32_16x16x32_bf16 v[172:175], v[192:195], v[76:79], 0
    v_mfma_f32_16x16x32_bf16 v[176:179], v[192:195], v[80:83], 0
    v_mfma_f32_16x16x32_bf16 v[180:183], v[192:195], v[84:87], 0
    s_nop 1
    v_add_f32 v196, v136, v141
    s_nop 0
    v_add_f32 v197, v146, v151
    s_nop 0
    v_add_f32 v198, v168, v173
    s_nop 0
    v_add_f32 v199, v178, v183
    v_add_f32 v196, v196, v197
    v_add_f32 v198, v198, v199
    v_mov_b32 v197, s4
    s_nop 0
    v_permlane16_swap_b32 v198, v199
    s_cmp_ge_u32 s9, 28
    s_cbranch_scc1 L_NOHP
    v_add_f32 v196, v196, v199
    s_mov_b32 exec_lo, 0xffff
    s_mov_b32 exec_hi, 0xffff
    buffer_store_dwordx2 v[196:197], v8, s[32:35], s20 offen sc1
    s_mov_b64 exec, -1
L_NOHP:
    ds_read_b64_tr_b16 v[120:121], v35
    ds_read_b64_tr_b16 v[122:123], v35 offset:1024
    ds_read_b64_tr_b16 v[124:125], v35 offset:8192
    ds_read_b64_tr_b16 v[126:127], v35 offset:9216
    ds_read_b64_tr_b16 v[128:129], v35 offset:16384
    ds_read_b64_tr_b16 v[130:131], v35 offset:17408
    ds_read_b64_tr_b16 v[132:133], v35 offset:24576
    ds_read_b64_tr_b16 v[134:135], v35 offset:25600
    s_and_b32 s68, s24, 2047
    s_and_b32 s69, s25, 2047
    s_mov_b32 s70, s16
    s_mov_b32 s71, s15
    v_pk_add_f32 v[208:209], v[208:209], v[152:153]
    v_pk_add_f32 v[210:211], v[210:211], v[154:155]
    v_pk_add_f32 v[212:213], v[212:213], v[156:157]
    v_pk_add_f32 v[214:215], v[214:215], v[158:159]
    v_pk_add_f32 v[216:217], v[216:217], v[160:161]
    v_pk_add_f32 v[218:219], v[218:219], v[162:163]
    v_pk_add_f32 v[220:221], v[220:221], v[164:165]
    v_pk_add_f32 v[222:223], v[222:223], v[166:167]
    v_cvt_pk_bf16_f32 v232, v208, v209
    v_cvt_pk_bf16_f32 v233, v210, v211
    v_cvt_pk_bf16_f32 v234, v212, v213
    v_cvt_pk_bf16_f32 v235, v214, v215
    v_cvt_pk_bf16_f32 v236, v216, v217
    v_cvt_pk_bf16_f32 v237, v218, v219
    v_cvt_pk_bf16_f32 v238, v220, v221
    v_cvt_pk_bf16_f32 v239, v222, v223
    v_permlane32_swap_b32 v232, v234
    v_permlane32_swap_b32 v233, v235
    v_permlane32_swap_b32 v236, v238
    v_permlane32_swap_b32 v237, v239
    ds_write_b128 v202, v[232:235]
    ds_write_b128 v204, v[236:239]
    ds_read_b128 v[232:235], v203
    ds_read_b128 v[236:239], v203 offset:1024
    s_waitcnt lgkmcnt(0)
    s_cmp_lg_u32 s93, 7
    s_cbranch_scc1 L_NONON
    v_mov_b32 v6, s4
    v_mov_b32 v7, 0
    s_mov_b64 exec, 1
    buffer_store_dword v6, v7, s[32:35], 0 offen sc1
    s_mov_b64 exec, -1
L_NONON:
    s_cmp_ge_u32 s9, 28
    s_cbranch_scc1 L_FIN2
    s_cmp_lg_u32 s3, 7
    s_cbranch_scc1 L_NOFZ
    s_bitcmp1_b32 s9, 3
    s_cselect_b32 s15, s25, s24
    s_cselect_b32 s17, s18, s17
    s_andn2_b32 s18, 2047, s15
    s_lshr_b32 s96, s8, 1
    s_lshl2_add_u32 s19, s12, s96
    s_lshr_b32 s96, s19, 1
    s_lshr_b32 s97, s9, 3
    s_lshl_b32 s98, s97, 1
    s_lshl2_add_u32 s99, s96, s98
    s_and_b32 s97, s19, 1
    s_add_u32 s96, s99, s97
    s_mul_i32 s98, s96, 7168
    s_add_u32 s20, s98, 22020096
    s_lshl_b32 s96, s18, 11
    s_lshl_b32 s97, s19, 5
    s_add_u32 s82, s96, s97
    v_and_b32 v10, 7, v1
    v_lshlrev_b32 v10, 2, v10
    s_lshr_b32 s96, s8, 1
    s_lshl_b32 s97, s96, 6
    s_add_u32 s13, s97, 157184
    v_and_b32 v5, 7, v1
    v_lshl_add_u32 v5, v5, 3, s13
    ds_read_b64 v[206:207], v5
    s_and_b32 s96, s17, 31
L_PAD10:
    s_cbranch_execz L_RET10
    s_lshl_b32 s97, s96, 13
    s_lshl_b32 s98, s12, 9
    s_add_u32 s99, s97, s98
    s_lshr_b32 s96, s8, 1
    s_lshl_b32 s97, s96, 5
    s_add_u32 s98, s99, s97
    s_add_u32 s91, s98, 13631488
    s_lshr_b32 s13, s15, 11
    s_lshl_b32 s13, s13, 16
    s_ashr_i32 s15, s13, 31
    s_andn2_b32 s15, 0x7fff0000, s15
    s_or_b32 s15, s15, 0x80000000
    s_xor_b32 s13, s13, s15
    v_mov_b32 v204, s13
    v_mul_f32 v204, s7, v204
    v_exp_f32 v204, -v204
    s_nop 0
    v_add_f32 v204, 1.0, v204
    v_rcp_f32 v204, v204
    s_nop 0
    v_cvt_pk_bf16_f32 v204, 0, v204
L_NOFZ:
    s_cmp_ge_u32 s3, 4
    s_cbranch_scc1 L_NOH
    s_lshl_b32 s96, s3, 8
    s_add_u32 s13, s96, s14
    v_lshrrev_b32 v4, 4, v1
    v_lshlrev_b32 v4, 11, v4
    v_and_b32 v9, 15, v1
    v_lshl_add_u32 v4, v9, 4, v4
    s_lshl_b32 s96, s3, 5
    s_add_u32 s15, s96, 156672
    v_lshrrev_b32 v5, 5, v1
    v_lshl_add_u32 v5, v5, 7, s15
    v_bfe_u32 v9, v1, 2, 1
    v_lshl_add_u32 v5, v9, 4, v5
    v_bfe_u32 v9, v1, 1, 1
    v_lshl_add_u32 v5, v9, 3, v5
    v_bfe_u32 v9, v1, 3, 1
    v_lshl_add_u32 v5, v9, 2, v5
    v_and_b32 v9, 1, v1
    v_lshl_add_u32 v5, v9, 1, v5
SPOLL_45:
    s_load_dword s24, s[32:33], s13 offset:1276 glc
    s_load_dword s25, s[32:33], s13 offset:3324 glc
    s_load_dword s26, s[32:33], s13 offset:5372 glc
    s_load_dword s27, s[32:33], s13 offset:7420 glc
SCHK_46:
    s_add_u32 s5, s5, 1
    s_cmp_ge_u32 s5, 200000
    s_waitcnt lgkmcnt(0)
    s_cbranch_scc1 SDONE_47
    s_cmp_lg_u32 s24, s4
    s_cbranch_scc1 SPOLL_45
    s_cmp_lg_u32 s25, s4
    s_cbranch_scc1 SPOLL_45
    s_cmp_lg_u32 s26, s4
    s_cbranch_scc1 SPOLL_45
    s_cmp_lg_u32 s27, s4
    s_cbranch_scc1 SPOLL_45
SDONE_47:
POLL_48:
    buffer_load_dwordx4 v[88:91], v4, s[32:35], s13 offen sc1
    buffer_load_dwordx4 v[92:95], v4, s[32:35], s13 offen offset:1024 sc1
    s_waitcnt vmcnt(0)
    v_bitop3_b32 v6, v89, v91, s4 bitop3:0x7e
    v_bitop3_b32 v6, v6, v93, s4 bitop3:0xf6
    v_bitop3_b32 v6, v6, v95, s4 bitop3:0xf6
    v_cmp_ne_u32 vcc, 0, v6
    s_cbranch_vccz PDONE_49
    s_add_u32 s5, s5, 1
    s_cmp_lt_u32 s5, 200000
    s_cbranch_scc1 POLL_48
PDONE_49:
    v_permlane32_swap_b32 v88, v90
    v_permlane32_swap_b32 v92, v94
    v_add_f32 v88, v88, v90
    v_add_f32 v92, v92, v94
    v_mov_b32 v90, v88
    v_mov_b32 v94, v92
    s_nop 0
    v_permlane16_swap_b32 v88, v90
    v_permlane16_swap_b32 v92, v94
    v_add_f32 v88, v88, v90
    v_add_f32 v92, v92, v94
    v_cvt_pk_bf16_f32 v88, 0, v88
    v_cvt_pk_bf16_f32 v92, 0, v92
    v_mul_f32 v6, s7, v88
    v_exp_f32 v6, -v6
    s_nop 0
    v_add_f32 v6, 1.0, v6
    v_rcp_f32 v6, v6
    s_nop 0
    v_mul_f32 v88, v88, v6
    v_cvt_pk_bf16_f32 v88, 0, v88
    v_mul_f32 v88, v88, v92
    v_cvt_pk_bf16_f32 v88, v88, v88
    ds_write_b16 v5, v88
L_NOH:
    v_bfe_u32 v4, v1, 2, 1
    v_lshlrev_b32 v4, 7, v4
    v_lshrrev_b32 v9, 5, v1
    v_lshl_add_u32 v4, v9, 4, v4
    v_add_u32 v4, 156672, v4
    v_lshrrev_b32 v5, 4, v1
    v_mul_u32_u24 v5, 7168, v5
    v_and_b32 v9, 15, v1
    v_lshl_add_u32 v5, v9, 3, v5
    s_lshl3_add_u32 s96, s75, s3
    s_mul_i32 s97, s96, 28672
    s_lshl_b32 s98, s74, 7
    s_add_u32 s99, s97, s98
    s_add_u32 s13, s99, 22020096
    v_and_b32 v6, 1, v1
    v_lshlrev_b32 v6, 13, v6
    v_bfe_u32 v9, v1, 1, 1
    v_lshl_add_u32 v6, v9, 18, v6
    s_lshr_b32 s96, s9, 2
    s_and_b32 s97, s75, 1
    s_lshr_b32 s98, s3, 1
    s_lshl2_add_u32 s99, s97, s98
    s_and_b32 s97, s3, 1
    s_lshr_b32 s98, s75, 1
    s_lshl2_add_u32 s97, s97, s98
    s_lshl3_add_u32 s98, s99, s97
    s_lshl_b32 s99, s98, 12
    s_lshl_b32 s97, s8, 6
    s_add_u32 s98, s99, s97
    s_lshl2_add_u32 s99, s96, s98
    s_add_u32 s97, s99, 1048576
    s_add_u32 s14, s97, 3072
    s_waitcnt lgkmcnt(0)
    s_barrier
    ds_read_b128 v[88:91], v4
    ds_read_b128 v[92:95], v4 offset:32
    ds_read_b128 v[96:99], v4 offset:64
    ds_read_b128 v[100:103], v4 offset:96
    s_waitcnt lgkmcnt(3)
    v_mfma_f32_32x32x16_bf16 v[208:223], v[88:91], v[120:123], 0
    s_waitcnt lgkmcnt(2)
    v_mfma_f32_32x32x16_bf16 v[208:223], v[92:95], v[124:127], v[208:223]
    s_waitcnt lgkmcnt(1)
    v_mfma_f32_32x32x16_bf16 v[208:223], v[96:99], v[128:131], v[208:223]
    s_waitcnt lgkmcnt(0)
    v_mfma_f32_32x32x16_bf16 v[208:223], v[100:103], v[132:135], v[208:223]
    s_nop 11
    v_mov_b32 v209, s4
    buffer_store_dwordx2 v[208:209], v5, s[32:35], s13 offen sc1
    s_mov_b64 exec, 15
    buffer_store_dword v209, v6, s[32:35], s14 offen sc1
    s_mov_b64 exec, -1
    s_barrier
L_FIN2:
    v_cmp_ne_u32 vcc, s68, v42
    v_cmp_ne_u32 s[22:23], s69, v42
    s_nop 0
    s_and_b64 exec, vcc, s[22:23]
    buffer_store_dwordx4 v[232:235], v33, s[64:67], s70 offen sc1
    s_mov_b64 exec, -1
    v_cmp_ne_u32 vcc, s68, v43
    v_cmp_ne_u32 s[22:23], s69, v43
    s_nop 0
    s_and_b64 exec, vcc, s[22:23]
    buffer_store_dwordx4 v[236:239], v33, s[64:67], s71 offen sc1
    s_mov_b64 exec, -1
    s_cmp_ge_u32 s9, 16
    s_cbranch_scc1 L_FIN
SPOLL_50:
    s_load_dwordx8 s[24:31], s[32:33], s92 offset:3072 glc
SCHK_51:
    s_add_u32 s5, s5, 1
    s_cmp_ge_u32 s5, 200000
    s_waitcnt lgkmcnt(0)
    s_cbranch_scc1 SDONE_52
    s_cmp_lg_u32 s24, s4
    s_cbranch_scc1 SPOLL_50
    s_cmp_lg_u32 s25, s4
    s_cbranch_scc1 SPOLL_50
    s_cmp_lg_u32 s26, s4
    s_cbranch_scc1 SPOLL_50
    s_cmp_lg_u32 s27, s4
    s_cbranch_scc1 SPOLL_50
    s_cmp_lg_u32 s28, s4
    s_cbranch_scc1 SPOLL_50
    s_cmp_lg_u32 s29, s4
    s_cbranch_scc1 SPOLL_50
    s_cmp_lg_u32 s30, s4
    s_cbranch_scc1 SPOLL_50
SDONE_52:
    s_barrier
    s_cmp_lg_u32 s3, 7
    s_cbranch_scc1 L_FIN
    s_add_u32 s13, s20, 4096
    v_mov_b32 v5, s4
    v_not_b32 v6, v5
POLL_53:
    buffer_load_dwordx4 v[88:91], v2, s[32:35], s20 offen sc1
    buffer_load_dwordx4 v[92:95], v2, s[32:35], s20 offen offset:1024 sc1
    buffer_load_dwordx4 v[96:99], v2, s[32:35], s20 offen offset:2048 sc1
    buffer_load_dwordx4 v[100:103], v2, s[32:35], s20 offen offset:3072 sc1
    buffer_load_dwordx4 v[104:107], v2, s[32:35], s13 offen sc1
    buffer_load_dwordx4 v[108:111], v2, s[32:35], s13 offen offset:1024 sc1
    buffer_load_dwordx4 v[112:115], v2, s[32:35], s13 offen offset:2048 sc1
    buffer_load_dword v244, v10, s[32:35], s91 offen sc1
    buffer_load_dword v245, v10, s[32:35], s91 offen offset:128 sc1
    s_waitcnt vmcnt(0)
    v_max_u32 v246, v244, v245
    v_cmp_ne_u32 vcc, -1, v246
    s_nop 1
    v_cndmask_b32 v246, v6, v5, vcc
    v_bitop3_b32 v4, v89, v91, s4 bitop3:0x7e
    v_bitop3_b32 v4, v4, v93, s4 bitop3:0xf6
    v_bitop3_b32 v4, v4, v95, s4 bitop3:0xf6
    v_bitop3_b32 v4, v4, v97, s4 bitop3:0xf6
    v_bitop3_b32 v4, v4, v99, s4 bitop3:0xf6
    v_bitop3_b32 v4, v4, v101, s4 bitop3:0xf6
    v_bitop3_b32 v4, v4, v103, s4 bitop3:0xf6
    v_bitop3_b32 v4, v4, v105, s4 bitop3:0xf6
    v_bitop3_b32 v4, v4, v107, s4 bitop3:0xf6
    v_bitop3_b32 v4, v4, v109, s4 bitop3:0xf6
    v_bitop3_b32 v4, v4, v111, s4 bitop3:0xf6
    v_bitop3_b32 v4, v4, v113, s4 bitop3:0xf6
    v_bitop3_b32 v4, v4, v115, s4 bitop3:0xf6
    v_bitop3_b32 v4, v4, v246, s4 bitop3:0xf6
    v_cmp_ne_u32 vcc, 0, v4
    s_cbranch_vccz PDONE_54
    s_add_u32 s5, s5, 1
    s_cmp_lt_u32 s5, 200000
    s_cbranch_scc1 POLL_53
PDONE_54:
    v_add_f32 v88, v88, v92
    v_add_f32 v90, v90, v94
    v_add_f32 v88, v88, v96
    v_add_f32 v90, v90, v98
    v_add_f32 v88, v88, v100
    v_add_f32 v90, v90, v102
    v_add_f32 v88, v88, v104
    v_add_f32 v90, v90, v106
    v_add_f32 v88, v88, v108
    v_add_f32 v90, v90, v110
    v_add_f32 v88, v88, v112
    v_add_f32 v90, v90, v114
    v_mov_b32 v89, v90
    v_add_f32_dpp v88, v88, v88 row_ror:8 row_mask:0xf bank_mask:0xf
    s_nop 0
    v_add_f32_dpp v89, v89, v89 row_ror:8 row_mask:0xf bank_mask:0xf
    v_mov_b32 v90, v88
    v_mov_b32 v91, v89
    s_nop 0
    v_permlane16_swap_b32 v88, v90
    v_permlane16_swap_b32 v89, v91
    v_pk_add_f32 v[88:89], v[88:89], v[90:91]
    v_mov_b32 v90, v88
    v_mov_b32 v91, v89
    s_nop 0
    v_permlane32_swap_b32 v88, v90
    v_permlane32_swap_b32 v89, v91
    v_pk_add_f32 v[88:89], v[88:89], v[90:91]
    v_cvt_pk_bf16_f32 v88, 0, v88
    v_cvt_pk_bf16_f32 v89, 0, v89
    v_pk_mul_f32 v[88:89], v[88:89], v[204:205] op_sel_hi:[1,0]
    v_lshlrev_b32 v4, 16, v244
    v_and_b32 v5, s6, v244
    v_cvt_pk_bf16_f32 v88, 0, v88
    v_cvt_pk_bf16_f32 v89, 0, v89
    v_pk_add_f32 v[88:89], v[88:89], v[4:5]
    v_cvt_pk_bf16_f32 v88, 0, v88
    v_cvt_pk_bf16_f32 v89, 0, v89
    v_pk_mul_f32 v[88:89], v[88:89], v[206:207]
    v_lshlrev_b32 v4, 16, v245
    v_and_b32 v5, s6, v245
    v_cvt_pk_bf16_f32 v88, 0, v88
    v_cvt_pk_bf16_f32 v89, 0, v89
    v_pk_add_f32 v[88:89], v[88:89], v[4:5]
    v_cvt_pk_bf16_f32 v88, v88, v89
    s_mov_b64 exec, 0xff
    buffer_store_dword v88, v10, s[64:67], s82 offen
    s_mov_b64 exec, -1
L_FIN:
L_END:
    s_endpgm
.p2align 10
.fill 768, 4, 0xbf800000
.section .rodata,"a"
.p2align 6
.amdhsa_kernel adaLN_cond__linear_kernel_hedgehog__moe_arch_mod__prompt_kernel
  .amdhsa_next_free_vgpr 256
  .amdhsa_next_free_sgpr 102
  .amdhsa_accum_offset 256
  .amdhsa_group_segment_fixed_size 0
  .amdhsa_kernarg_size 112
  .amdhsa_user_sgpr_count 2
  .amdhsa_user_sgpr_kernarg_segment_ptr 1
  .amdhsa_system_sgpr_workgroup_id_x 1
  .amdhsa_float_denorm_mode_32 3
  .amdhsa_float_denorm_mode_16_64 3
.end_amdhsa_kernel
```

```asm
; @launch grid=(256,1,1) block=(512,1,1) lds=163840
.amdgcn_target "amdgcn-amd-amdhsa--gfx950"
.text
.globl adaLN_cond__linear_kernel_hedgehog__moe_arch_mod__prompt_kernel
.p2align 12
.type adaLN_cond__linear_kernel_hedgehog__moe_arch_mod__prompt_kernel,@function
adaLN_cond__linear_kernel_hedgehog__moe_arch_mod__prompt_kernel:
    s_load_dwordx16 s[68:83], s[0:1], 0
    s_load_dwordx8 s[84:91], s[0:1], 64
    s_load_dwordx2 s[32:33], s[0:1], 104
    s_cmp_ge_u32 s2, 256
    s_cbranch_scc1 L_END
    v_lshrrev_b32 v4, 6, v0
    v_and_b32 v1, 63, v0
    s_nop 0
    v_readfirstlane_b32 s3, v4
    v_lshlrev_b32 v2, 4, v1
    s_mov_b32 s38, 4194304
    s_mov_b32 s39, 0x20000
    s_mov_b32 s50, 12582912
    s_mov_b32 s51, 0x20000
    s_mov_b32 s34, 268435456
    s_mov_b32 s35, 0x20000
    s_mov_b32 s42, 6291456
    s_mov_b32 s43, 0x20000
    s_mov_b32 s46, 2097152
    s_mov_b32 s47, 0x20000
    s_mov_b32 s54, 7340032
    s_mov_b32 s55, 0x20000
    s_mov_b32 s58, 7340032
    s_mov_b32 s59, 0x20000
    s_mov_b32 s62, 7340032
    s_mov_b32 s63, 0x20000
    s_mov_b32 s66, 4194304
    s_mov_b32 s67, 0x20000
    s_mov_b32 s5, 0
    s_mov_b32 s6, 0xffff0000
    s_mov_b32 s7, 0x3fb8aa3b
    s_and_b32 s8, s2, 7
    s_lshr_b32 s9, s2, 3
    s_lshl_b32 s96, s8, 5
    s_add_u32 s97, s96, s9
    s_lshl3_add_u32 s93, s97, s3
    s_and_b32 s96, s8, 4
    s_lshr_b32 s97, s9, 2
    s_lshl1_add_u32 s10, s96, s97
    s_and_b32 s96, s8, 3
    s_and_b32 s97, s9, 3
    s_xor_b32 s98, s97, 2
    s_lshl2_add_u32 s11, s96, s98
    s_and_b32 s96, s8, 1
    s_and_b32 s97, s9, 7
    s_lshl3_add_u32 s12, s96, s97
    s_lshr_b32 s96, s8, 1
    s_lshr_b32 s97, s9, 3
    s_lshl2_add_u32 s21, s96, s97
    s_lshl_b32 s96, s2, 6
    s_add_u32 s97, s96, s3
    s_lshl_b32 s98, s97, 6
    s_add_u32 s92, s98, 1048576
    s_lshl_b32 s16, s93, 11
    s_lshl3_add_u32 s96, s8, s3
    s_lshl_b32 s15, s96, 5
    s_mul_i32 s96, s15, 6144
    s_xor_b32 s97, s9, 1
    s_lshl_b32 s98, s97, 7
    s_add_u32 s13, s96, s98
    s_add_u32 s14, s13, 98304
    s_lshl3_add_u32 s96, s21, s3
    s_lshl_b32 s97, s96, 15
    s_lshl_b32 s98, s12, 7
    s_add_u32 s18, s97, s98
    s_lshr_b32 s96, s8, 1
    s_lshl4_add_u32 s97, s96, s12
    s_lshl4_add_u32 s98, s97, s3
    s_lshl_b32 s99, s98, 9
    s_add_u32 s17, s99, 524288
    v_lshrrev_b32 v248, 3, v1
    v_mul_u32_u24 v248, 12288, v248
    v_and_b32 v9, 7, v1
    v_lshl_add_u32 v248, v9, 4, v248
    v_lshrrev_b32 v249, 3, v1
    v_lshl_add_u32 v249, v249, 1, s15
    v_and_b32 v10, 15, v1
    v_lshlrev_b32 v10, 11, v10
    v_lshrrev_b32 v9, 4, v1
    v_lshl_add_u32 v10, v9, 4, v10
    s_waitcnt lgkmcnt(0)
    s_mov_b64 s[48:49], s[88:89]
    buffer_load_dwordx4 v[160:163], v248, s[48:51], s13 offen nt
    buffer_load_dwordx4 v[164:167], v248, s[48:51], s14 offen nt
    s_load_dword s4, s[32:33], 0
    global_load_ushort v168, v249, s[86:87]
    global_load_ushort v169, v249, s[86:87] offset:16
    s_mov_b64 s[36:37], s[68:69]
    s_load_dword s24, s[32:33], s92 offset:0 glc
    s_load_dword s25, s[32:33], s17 offset:508 glc
    s_load_dword s26, s[32:33], s17 offset:4604 glc
    s_barrier
    buffer_load_dwordx4 v[152:155], v2, s[36:39], s16 offen
    buffer_load_dwordx4 v[156:159], v2, s[36:39], s16 offen offset:1024
    s_mov_b64 s[40:41], s[70:71]
    s_mov_b64 s[44:45], s[74:75]
    s_mov_b64 s[52:53], s[80:81]
    s_mov_b64 s[56:57], s[82:83]
    s_mov_b64 s[60:61], s[84:85]
    s_mov_b64 s[64:65], s[90:91]
    s_getpc_b64 s[22:23]
    s_and_b32 s22, s22, 0xfffffc00
    s_lshl3_add_u32 s96, s9, s3
    s_lshl_b32 s19, s96, 7
    v_lshrrev_b32 v4, 5, v1
    v_lshl_add_u32 v4, v4, 15, s19
    v_min_u32 v4, 41984, v4
    global_load_dword v11, v4, s[22:23]
    s_lshr_b32 s76, s3, 2
    s_and_b32 s77, s3, 3
    s_lshl_b32 s83, s3, 10
    s_mul_i32 s96, s8, 7
    s_lshr_b32 s97, s9, 2
    s_add_u32 s74, s96, s97
    s_and_b32 s75, s9, 3
    v_bfe_u32 v6, v1, 4, 1
    v_lshlrev_b32 v6, 6, v6
    v_and_b32 v3, 7, v1
    v_lshlrev_b32 v3, 4, v3
    v_xor_b32 v3, v3, v6
    v_lshrrev_b32 v6, 3, v1
    v_mul_u32_u24 v6, 6144, v6
    v_add_u32 v3, v3, v6
    s_and_b32 s84, s9, 12
    s_mul_i32 s96, s3, 49152
    s_lshl_b32 s97, s11, 7
    s_add_u32 s85, s96, s97
    v_lshlrev_b32 v250, 3, v1
    v_lshlrev_b32 v251, 5, v1
    v_add_u32 v251, 147456, v251
    s_lshl2_add_u32 s13, s3, 147456
    v_lshrrev_b32 v252, 4, v1
    v_lshl_add_u32 v252, v252, 6, s13
    v_and_b32 v9, 7, v1
    v_lshl_add_u32 v252, v9, 8, v252
    v_bfe_u32 v9, v1, 3, 1
    v_lshl_add_u32 v252, v9, 5, v252
    buffer_load_dwordx4 v[12:15], v10, s[36:39], s18 offen
    buffer_load_dwordx4 v[16:19], v10, s[36:39], s18 offen offset:64
    s_lshr_b32 s96, s3, 1
    s_xor_b32 s97, s9, 1
    s_and_b32 s98, s97, 15
    s_lshl4_add_u32 s99, s96, s98
    s_lshr_b32 s97, s9, 4
    s_lshl1_add_u32 s96, s99, s97
    s_lshl3_add_u32 s98, s96, s8
    s_lshl_b32 s99, s98, 9
    s_add_u32 s13, s99, 524288
    s_waitcnt vmcnt(5)
    v_lshlrev_b32 v168, 16, v168
    v_mul_f32 v4, s7, v168
    v_exp_f32 v4, -v4
    s_nop 0
    v_add_f32 v4, 1.0, v4
    v_rcp_f32 v4, v4
    s_nop 0
    v_mul_f32 v168, v168, v4
    v_cvt_pk_bf16_f32 v168, 0, v168
    v_lshlrev_b32 v169, 16, v169
    v_mul_f32 v5, s7, v169
    v_exp_f32 v5, -v5
    s_nop 0
    v_add_f32 v5, 1.0, v5
    v_rcp_f32 v5, v5
    s_nop 0
    v_mul_f32 v169, v169, v5
    v_cvt_pk_bf16_f32 v169, 0, v169
    v_lshlrev_b32 v4, 16, v160
    v_and_b32 v5, s6, v160
    v_pk_mul_f32 v[176:177], v[168:169], v[4:5] op_sel:[0,0] op_sel_hi:[0,1]
    v_lshlrev_b32 v6, 16, v161
    v_and_b32 v7, s6, v161
    v_pk_mul_f32 v[178:179], v[168:169], v[6:7] op_sel:[0,0] op_sel_hi:[0,1]
    v_lshlrev_b32 v4, 16, v162
    v_and_b32 v5, s6, v162
    v_pk_mul_f32 v[180:181], v[168:169], v[4:5] op_sel:[0,0] op_sel_hi:[0,1]
    v_lshlrev_b32 v6, 16, v163
    v_and_b32 v7, s6, v163
    v_pk_mul_f32 v[182:183], v[168:169], v[6:7] op_sel:[0,0] op_sel_hi:[0,1]
    v_lshlrev_b32 v4, 16, v164
    v_and_b32 v5, s6, v164
    v_pk_fma_f32 v[176:177], v[168:169], v[4:5], v[176:177] op_sel:[1,0,0] op_sel_hi:[1,1,1]
    v_lshlrev_b32 v6, 16, v165
    v_and_b32 v7, s6, v165
    v_pk_fma_f32 v[178:179], v[168:169], v[6:7], v[178:179] op_sel:[1,0,0] op_sel_hi:[1,1,1]
    v_lshlrev_b32 v4, 16, v166
    v_and_b32 v5, s6, v166
    v_pk_fma_f32 v[180:181], v[168:169], v[4:5], v[180:181] op_sel:[1,0,0] op_sel_hi:[1,1,1]
    v_lshlrev_b32 v6, 16, v167
    v_and_b32 v7, s6, v167
    v_pk_fma_f32 v[182:183], v[168:169], v[6:7], v[182:183] op_sel:[1,0,0] op_sel_hi:[1,1,1]
    v_permlane32_swap_b32 v176, v180
    v_permlane32_swap_b32 v177, v181
    v_permlane32_swap_b32 v178, v182
    v_permlane32_swap_b32 v179, v183
    v_add_f32 v176, v176, v180
    v_add_f32 v177, v177, v181
    v_add_f32 v178, v178, v182
    v_add_f32 v179, v179, v183
    s_nop 0
    v_permlane16_swap_b32 v176, v178
    v_permlane16_swap_b32 v177, v179
    v_add_f32 v176, v176, v178
    v_add_f32 v177, v177, v179
    s_nop 0
    v_add_f32_dpp v176, v176, v176 row_ror:8 row_mask:0xf bank_mask:0xf
    v_add_f32_dpp v177, v177, v177 row_ror:8 row_mask:0xf bank_mask:0xf
    s_nop 1
    v_mov_b32_dpp v176, v177 quad_perm:[0,1,2,3] row_mask:0xf bank_mask:0xc
    s_waitcnt lgkmcnt(0)
    s_mul_i32 s4, s4, 0x9e3779b1
    s_add_u32 s4, s4, 0x7f4a7c15
    ds_write_b32 v252, v176
    s_waitcnt lgkmcnt(0)
    s_barrier
    ds_read_b128 v[176:179], v251
    ds_read_b128 v[180:183], v251 offset:16
    s_waitcnt lgkmcnt(0)
    v_pk_add_f32 v[176:177], v[176:177], v[178:179]
    v_pk_add_f32 v[180:181], v[180:181], v[182:183]
    v_pk_add_f32 v[176:177], v[176:177], v[180:181]
    v_add_f32 v176, v176, v177
    v_mov_b32 v177, s4
    s_bitcmp1_b32 s3, 0
    s_cselect_b32 exec_lo, 0, -1
    s_cselect_b32 exec_hi, -1, 0
    buffer_store_dwordx2 v[176:177], v250, s[32:35], s13 offen sc1
    s_mov_b64 exec, -1
    s_lshr_b32 s96, s9, 4
    s_lshl_b32 s94, s96, -1
    s_add_u32 s96, s94, s84
    s_and_b32 s97, s96, 15
    s_mul_i32 s98, s97, 393216
    s_add_u32 s91, s98, s85
    s_lshl_b32 s96, s94, 13
    s_add_u32 s94, s96, s83
    s_add_u32 s82, s91, 2048
    s_mov_b32 m0, s94
    s_nop 0
    buffer_load_dwordx4 v3, s[40:43], s82 offen lds
    s_add_u32 s82, s91, 4096
    s_add_u32 m0, s94, 49152
    s_nop 0
    buffer_load_dwordx4 v3, s[40:43], s82 offen lds
    s_waitcnt vmcnt(6)
    v_mov_b32 v8, 0x3f803f80
    v_dot2_f32_bf16 v4, v152, v8, 0
    v_dot2_f32_bf16 v5, v152, v152, 0
    v_dot2_f32_bf16 v6, v153, v8, 0
    v_dot2_f32_bf16 v7, v153, v153, 0
    v_dot2_f32_bf16 v4, v154, v8, v4
    v_dot2_f32_bf16 v5, v154, v154, v5
    v_dot2_f32_bf16 v6, v155, v8, v6
    v_dot2_f32_bf16 v7, v155, v155, v7
    v_dot2_f32_bf16 v4, v156, v8, v4
    v_dot2_f32_bf16 v5, v156, v156, v5
    v_dot2_f32_bf16 v6, v157, v8, v6
    v_dot2_f32_bf16 v7, v157, v157, v7
    v_dot2_f32_bf16 v4, v158, v8, v4
    v_dot2_f32_bf16 v5, v158, v158, v5
    v_dot2_f32_bf16 v6, v159, v8, v6
    v_dot2_f32_bf16 v7, v159, v159, v7
    s_nop 2
    v_pk_add_f32 v[4:5], v[4:5], v[6:7]
    s_nop 1
    v_add_f32_dpp v4, v4, v4 quad_perm:[1,0,3,2] row_mask:0xf bank_mask:0xf
    v_add_f32_dpp v5, v5, v5 quad_perm:[1,0,3,2] row_mask:0xf bank_mask:0xf
    s_nop 0
    v_add_f32_dpp v4, v4, v4 quad_perm:[2,3,0,1] row_mask:0xf bank_mask:0xf
    v_add_f32_dpp v5, v5, v5 quad_perm:[2,3,0,1] row_mask:0xf bank_mask:0xf
    s_nop 0
    v_add_f32_dpp v4, v4, v4 row_half_mirror row_mask:0xf bank_mask:0xf
    v_add_f32_dpp v5, v5, v5 row_half_mirror row_mask:0xf bank_mask:0xf
    s_nop 0
    v_add_f32_dpp v4, v4, v4 row_ror:8 row_mask:0xf bank_mask:0xf
    v_add_f32_dpp v5, v5, v5 row_ror:8 row_mask:0xf bank_mask:0xf
    s_nop 1
    v_permlane16_swap_b32 v4, v5
    v_add_f32 v8, v4, v5
    v_add_f32 v4, v4, v5
    s_nop 1
    v_permlane32_swap_b32 v4, v8
    v_add_f32 v4, v4, v8
    v_mul_f32 v8, 0x3a800000, v4
    v_mul_f32 v4, 0x3a800000, v4
    s_nop 1
    v_permlane16_swap_b32 v4, v8
    v_fma_f32 v173, -v4, v4, v8
    v_cvt_pk_bf16_f32 v172, 0, v4
    v_max_f32 v173, 0, v173
    v_cvt_pk_bf16_f32 v173, 0, v173
    v_add_f32 v173, 0x3727c5ac, v173
    v_cvt_pk_bf16_f32 v173, 0, v173
    v_sqrt_f32 v173, v173
    s_nop 0
    v_cvt_pk_bf16_f32 v173, 0, v173
    s_lshl3_add_u32 s13, s3, 153600
    v_lshrrev_b32 v172, 16, v172
    v_or_b32 v172, v172, v173
    v_mov_b32 v173, s4
    v_mov_b32 v4, s13
    ds_write_b64 v4, v[172:173]
    v_and_b32 v5, 3, v1
    v_lshlrev_b32 v5, 4, v5
    v_add_u32 v5, 153600, v5
    v_and_b32 v4, 3, v1
    v_lshlrev_b32 v4, 4, v4
    v_bfe_u32 v9, v1, 2, 1
    v_lshl_add_u32 v4, v9, 10, v4
    s_and_b32 s96, s8, 6
    s_and_b32 s97, s8, 1
    s_lshr_b32 s98, s9, 4
    s_lshl1_add_u32 s99, s97, s98
    s_lshl_b32 s97, s99, 6
    s_add_u32 s98, s96, s97
    s_lshl3_add_u32 s99, s3, s98
    s_lshl_b32 s96, s99, 10
    s_and_b32 s97, s9, 15
    s_lshl_b32 s98, s97, 6
    s_add_u32 s99, s96, s98
    s_add_u32 s13, s99, 262144
    s_waitcnt lgkmcnt(0)
    s_barrier
    ds_read_b128 v[172:175], v5
    s_waitcnt lgkmcnt(0)
    s_mov_b64 exec, 0xff
    buffer_store_dwordx4 v[172:175], v4, s[32:35], s13 offen sc1
    s_mov_b64 exec, -1
    s_mov_b32 s82, s91
    s_add_u32 m0, s94, 98304
    s_nop 0
    buffer_load_dwordx4 v3, s[40:43], s82 offen lds
    s_load_dword s24, s[32:33], s17 offset:508 glc
    s_load_dword s25, s[32:33], s17 offset:4604 glc
    v_and_b32 v4, 31, v1
    v_lshlrev_b32 v4, 4, v4
    v_lshrrev_b32 v9, 5, v1
    v_lshl_add_u32 v4, v9, 12, v4
    s_lshl2_add_u32 s14, s3, 155648
    v_lshl_add_u32 v5, v1, 6, s14
    v_and_b32 v6, 3, v1
    v_lshlrev_b32 v6, 5, v6
    v_lshrrev_b32 v9, 5, v1
    v_lshl_add_u32 v6, v9, 7, v6
    v_bfe_u32 v9, v1, 4, 1
    v_lshl_add_u32 v6, v9, 8, v6
    v_bfe_u32 v9, v1, 2, 2
    v_lshl_add_u32 v6, v9, 9, v6
    v_add_u32 v6, 155648, v6
    s_lshl3_add_u32 s96, s2, s3
    s_lshl_b32 s97, s96, 7
    s_add_u32 s14, s97, 262144
    v_and_b32 v8, 15, v1
    v_lshlrev_b32 v8, 3, v8
    s_branch SCHK_2
SPOLL_1:
    s_load_dword s24, s[32:33], s17 offset:508 glc
    s_load_dword s25, s[32:33], s17 offset:4604 glc
SCHK_2:
    s_add_u32 s5, s5, 1
    s_cmp_ge_u32 s5, 200000
    s_waitcnt lgkmcnt(0)
    s_cbranch_scc1 SDONE_3
    s_cmp_lg_u32 s24, s4
    s_cbranch_scc1 SPOLL_1
    s_cmp_lg_u32 s25, s4
    s_cbranch_scc1 SPOLL_1
SDONE_3:
    buffer_load_dwordx4 v[176:179], v4, s[32:35], s17 offen sc1
    s_load_dword s24, s[32:33], s14 offset:60 glc
    s_load_dword s25, s[32:33], s14 offset:124 glc
    s_waitcnt vmcnt(6)
    v_permlane32_swap_b32 v12, v14
    v_permlane32_swap_b32 v13, v15
    v_permlane32_swap_b32 v16, v18
    v_permlane32_swap_b32 v17, v19
    v_lshlrev_b32 v184, 16, v12
    v_and_b32 v185, s6, v12
    v_lshlrev_b32 v186, 16, v13
    v_and_b32 v187, s6, v13
    v_lshlrev_b32 v188, 16, v14
    v_and_b32 v189, s6, v14
    v_lshlrev_b32 v190, 16, v15
    v_and_b32 v191, s6, v15
    v_lshlrev_b32 v192, 16, v16
    v_and_b32 v193, s6, v16
    v_lshlrev_b32 v194, 16, v17
    v_and_b32 v195, s6, v17
    v_lshlrev_b32 v196, 16, v18
    v_and_b32 v197, s6, v18
    v_lshlrev_b32 v198, 16, v19
    v_and_b32 v199, s6, v19
    s_branch SCHK_6
SPOLL_5:
    s_load_dword s24, s[32:33], s14 offset:60 glc
    s_load_dword s25, s[32:33], s14 offset:124 glc
SCHK_6:
    s_add_u32 s5, s5, 1
    s_cmp_ge_u32 s5, 200000
    s_waitcnt lgkmcnt(0)
    s_cbranch_scc1 SDONE_7
    s_cmp_lg_u32 s24, s4
    s_cbranch_scc1 SPOLL_5
    s_cmp_lg_u32 s25, s4
    s_cbranch_scc1 SPOLL_5
SDONE_7:
    buffer_load_dwordx2 v[172:173], v8, s[32:35], s14 offen sc1
    s_lshr_b32 s96, s9, 4
    s_lshl_b32 s97, s96, -1
    s_xor_b32 s94, s97, 1
    s_add_u32 s96, s94, s84
    s_and_b32 s97, s96, 15
    s_mul_i32 s98, s97, 393216
    s_add_u32 s91, s98, s85
    s_lshl_b32 s96, s94, 13
    s_add_u32 s94, s96, s83
    s_add_u32 s82, s91, 2048
    s_mov_b32 m0, s94
    s_nop 0
    buffer_load_dwordx4 v3, s[40:43], s82 offen lds
    s_add_u32 s82, s91, 4096
    s_add_u32 m0, s94, 49152
    s_nop 0
    buffer_load_dwordx4 v3, s[40:43], s82 offen lds
    s_mov_b32 s82, s91
    s_add_u32 m0, s94, 98304
    s_nop 0
    buffer_load_dwordx4 v3, s[40:43], s82 offen lds
    s_waitcnt vmcnt(4)
    v_bitop3_b32 v7, v177, v179, s4 bitop3:0x7e
    v_cmp_ne_u32 vcc, 0, v7
    s_cbranch_vccz TOK_8
POLL_9:
    buffer_load_dwordx4 v[176:179], v4, s[32:35], s17 offen sc1
    s_waitcnt vmcnt(0)
    v_bitop3_b32 v7, v177, v179, s4 bitop3:0x7e
    v_cmp_ne_u32 vcc, 0, v7
    s_cbranch_vccz PDONE_10
    s_add_u32 s5, s5, 1
    s_cmp_lt_u32 s5, 200000
    s_cbranch_scc1 POLL_9
PDONE_10:
TOK_8:
    ds_write2_b32 v5, v176, v178 offset0:0 offset1:8
    s_waitcnt lgkmcnt(0)
    s_barrier
    ds_read_b128 v[208:211], v6 offset:2048
    ds_read_b128 v[212:215], v6 offset:2064
    ds_read_b128 v[200:203], v6
    ds_read_b128 v[204:207], v6 offset:16
    s_lshl_b32 s96, s11, 12
    s_lshl_b32 s97, s3, 9
    s_add_u32 s13, s96, s97
    v_add_u32 v4, s13, v2
    s_lshl_b32 s96, s3, 9
    s_add_u32 m0, s96, 159744
    s_mov_b32 exec_hi, 0
    global_load_lds_dwordx4 v4, s[72:73]
    s_mov_b32 exec_hi, -1
    s_lshl4_add_u32 s96, s21, s12
    s_lshr_b32 s97, s3, 1
    s_lshl2_add_u32 s98, s96, s97
    s_lshl_b32 s99, s98, 12
    s_and_b32 s96, s3, 1
    s_lshl_b32 s97, s96, 8
    s_add_u32 s98, s99, s97
    s_add_u32 s13, s98, 4194304
    v_and_b32 v4, 15, v1
    v_lshlrev_b32 v4, 4, v4
    v_bfe_u32 v9, v1, 4, 1
    v_lshl_add_u32 v4, v9, 10, v4
    v_lshrrev_b32 v9, 5, v1
    v_lshl_add_u32 v4, v9, 9, v4
    s_waitcnt lgkmcnt(2)
    v_pk_add_f32 v[208:209], v[208:209], v[210:211]
    v_pk_add_f32 v[212:213], v[212:213], v[214:215]
    v_pk_add_f32 v[208:209], v[208:209], v[212:213]
    v_add_f32 v208, v208, v209
    v_cvt_pk_bf16_f32 v208, 0, v208
    s_waitcnt lgkmcnt(0)
    v_pk_add_f32 v[200:201], v[200:201], v[202:203]
    v_pk_add_f32 v[204:205], v[204:205], v[206:207]
    v_pk_add_f32 v[200:201], v[200:201], v[204:205]
    v_add_f32 v200, v200, v201
    v_add_f32 v208, 1.0, v208
    v_cvt_pk_bf16_f32 v208, 0, v208
    v_cvt_pk_bf16_f32 v200, 0, v200
    s_waitcnt vmcnt(4)
    v_cmp_ne_u32 vcc, s4, v173
    s_cbranch_vccz L_STOK
POLL_11:
    buffer_load_dwordx2 v[172:173], v8, s[32:35], s14 offen sc1
    s_waitcnt vmcnt(0)
    v_cmp_ne_u32 vcc, s4, v173
    s_cbranch_vccz PDONE_12
    s_add_u32 s5, s5, 1
    s_cmp_lt_u32 s5, 200000
    s_cbranch_scc1 POLL_11
PDONE_12:
L_STOK:
    v_lshlrev_b32 v173, 16, v172
    v_and_b32 v172, s6, v172
    v_rcp_f32 v172, v172
    s_nop 0
    v_pk_add_f32 v[184:185], v[172:173], v[184:185] op_sel:[1,0] neg_lo:[1,0] neg_hi:[1,0]
    v_pk_add_f32 v[186:187], v[172:173], v[186:187] op_sel:[1,0] neg_lo:[1,0] neg_hi:[1,0]
    v_pk_add_f32 v[188:189], v[172:173], v[188:189] op_sel:[1,0] neg_lo:[1,0] neg_hi:[1,0]
    v_pk_add_f32 v[190:191], v[172:173], v[190:191] op_sel:[1,0] neg_lo:[1,0] neg_hi:[1,0]
    v_pk_add_f32 v[192:193], v[172:173], v[192:193] op_sel:[1,0] neg_lo:[1,0] neg_hi:[1,0]
    v_pk_add_f32 v[194:195], v[172:173], v[194:195] op_sel:[1,0] neg_lo:[1,0] neg_hi:[1,0]
    v_pk_add_f32 v[196:197], v[172:173], v[196:197] op_sel:[1,0] neg_lo:[1,0] neg_hi:[1,0]
    v_pk_add_f32 v[198:199], v[172:173], v[198:199] op_sel:[1,0] neg_lo:[1,0] neg_hi:[1,0]
    v_cvt_pk_bf16_f32 v184, 0, v184
    v_cvt_pk_bf16_f32 v185, 0, v185
    v_cvt_pk_bf16_f32 v186, 0, v186
    v_cvt_pk_bf16_f32 v187, 0, v187
    v_cvt_pk_bf16_f32 v188, 0, v188
    v_cvt_pk_bf16_f32 v189, 0, v189
    v_cvt_pk_bf16_f32 v190, 0, v190
    v_cvt_pk_bf16_f32 v191, 0, v191
    v_cvt_pk_bf16_f32 v192, 0, v192
    v_cvt_pk_bf16_f32 v193, 0, v193
    v_cvt_pk_bf16_f32 v194, 0, v194
    v_cvt_pk_bf16_f32 v195, 0, v195
    v_cvt_pk_bf16_f32 v196, 0, v196
    v_cvt_pk_bf16_f32 v197, 0, v197
    v_cvt_pk_bf16_f32 v198, 0, v198
    v_cvt_pk_bf16_f32 v199, 0, v199
    v_pk_mul_f32 v[184:185], v[184:185], v[172:173] op_sel_hi:[1,0]
    v_pk_mul_f32 v[186:187], v[186:187], v[172:173] op_sel_hi:[1,0]
    v_pk_mul_f32 v[188:189], v[188:189], v[172:173] op_sel_hi:[1,0]
    v_pk_mul_f32 v[190:191], v[190:191], v[172:173] op_sel_hi:[1,0]
    v_pk_mul_f32 v[192:193], v[192:193], v[172:173] op_sel_hi:[1,0]
    v_pk_mul_f32 v[194:195], v[194:195], v[172:173] op_sel_hi:[1,0]
    v_pk_mul_f32 v[196:197], v[196:197], v[172:173] op_sel_hi:[1,0]
    v_pk_mul_f32 v[198:199], v[198:199], v[172:173] op_sel_hi:[1,0]
    v_cvt_pk_bf16_f32 v184, 0, v184
    v_cvt_pk_bf16_f32 v185, 0, v185
    v_cvt_pk_bf16_f32 v186, 0, v186
    v_cvt_pk_bf16_f32 v187, 0, v187
    v_cvt_pk_bf16_f32 v188, 0, v188
    v_cvt_pk_bf16_f32 v189, 0, v189
    v_cvt_pk_bf16_f32 v190, 0, v190
    v_cvt_pk_bf16_f32 v191, 0, v191
    v_cvt_pk_bf16_f32 v192, 0, v192
    v_cvt_pk_bf16_f32 v193, 0, v193
    v_cvt_pk_bf16_f32 v194, 0, v194
    v_cvt_pk_bf16_f32 v195, 0, v195
    v_cvt_pk_bf16_f32 v196, 0, v196
    v_cvt_pk_bf16_f32 v197, 0, v197
    v_cvt_pk_bf16_f32 v198, 0, v198
    v_cvt_pk_bf16_f32 v199, 0, v199
    v_mul_f32_dpp v184, v208, v184 row_newbcast:0 row_mask:0xf bank_mask:0xf
    v_mul_f32_dpp v185, v208, v185 row_newbcast:1 row_mask:0xf bank_mask:0xf
    v_mul_f32_dpp v186, v208, v186 row_newbcast:2 row_mask:0xf bank_mask:0xf
    v_mul_f32_dpp v187, v208, v187 row_newbcast:3 row_mask:0xf bank_mask:0xf
    v_mul_f32_dpp v188, v208, v188 row_newbcast:4 row_mask:0xf bank_mask:0xf
    v_mul_f32_dpp v189, v208, v189 row_newbcast:5 row_mask:0xf bank_mask:0xf
    v_mul_f32_dpp v190, v208, v190 row_newbcast:6 row_mask:0xf bank_mask:0xf
    v_mul_f32_dpp v191, v208, v191 row_newbcast:7 row_mask:0xf bank_mask:0xf
    v_cvt_pk_bf16_f32 v184, 0, v184
    v_cvt_pk_bf16_f32 v185, 0, v185
    v_cvt_pk_bf16_f32 v186, 0, v186
    v_cvt_pk_bf16_f32 v187, 0, v187
    v_cvt_pk_bf16_f32 v188, 0, v188
    v_cvt_pk_bf16_f32 v189, 0, v189
    v_cvt_pk_bf16_f32 v190, 0, v190
    v_cvt_pk_bf16_f32 v191, 0, v191
    v_add_f32_dpp v184, v200, v184 row_newbcast:0 row_mask:0xf bank_mask:0xf
    v_add_f32_dpp v185, v200, v185 row_newbcast:1 row_mask:0xf bank_mask:0xf
    v_add_f32_dpp v186, v200, v186 row_newbcast:2 row_mask:0xf bank_mask:0xf
    v_add_f32_dpp v187, v200, v187 row_newbcast:3 row_mask:0xf bank_mask:0xf
    v_add_f32_dpp v188, v200, v188 row_newbcast:4 row_mask:0xf bank_mask:0xf
    v_add_f32_dpp v189, v200, v189 row_newbcast:5 row_mask:0xf bank_mask:0xf
    v_add_f32_dpp v190, v200, v190 row_newbcast:6 row_mask:0xf bank_mask:0xf
    v_add_f32_dpp v191, v200, v191 row_newbcast:7 row_mask:0xf bank_mask:0xf
    v_cvt_pk_bf16_f32 v216, v184, v185
    v_cvt_pk_bf16_f32 v217, v186, v187
    v_cvt_pk_bf16_f32 v218, v188, v189
    v_cvt_pk_bf16_f32 v219, v190, v191
    buffer_store_dwordx4 v[216:219], v4, s[32:35], s13 offen sc1
    v_mul_f32_dpp v192, v208, v192 row_newbcast:8 row_mask:0xf bank_mask:0xf
    v_mul_f32_dpp v193, v208, v193 row_newbcast:9 row_mask:0xf bank_mask:0xf
    v_mul_f32_dpp v194, v208, v194 row_newbcast:10 row_mask:0xf bank_mask:0xf
    v_mul_f32_dpp v195, v208, v195 row_newbcast:11 row_mask:0xf bank_mask:0xf
    v_mul_f32_dpp v196, v208, v196 row_newbcast:12 row_mask:0xf bank_mask:0xf
    v_mul_f32_dpp v197, v208, v197 row_newbcast:13 row_mask:0xf bank_mask:0xf
    v_mul_f32_dpp v198, v208, v198 row_newbcast:14 row_mask:0xf bank_mask:0xf
    v_mul_f32_dpp v199, v208, v199 row_newbcast:15 row_mask:0xf bank_mask:0xf
    v_cvt_pk_bf16_f32 v192, 0, v192
    v_cvt_pk_bf16_f32 v193, 0, v193
    v_cvt_pk_bf16_f32 v194, 0, v194
    v_cvt_pk_bf16_f32 v195, 0, v195
    v_cvt_pk_bf16_f32 v196, 0, v196
    v_cvt_pk_bf16_f32 v197, 0, v197
    v_cvt_pk_bf16_f32 v198, 0, v198
    v_cvt_pk_bf16_f32 v199, 0, v199
    v_add_f32_dpp v192, v200, v192 row_newbcast:8 row_mask:0xf bank_mask:0xf
    v_add_f32_dpp v193, v200, v193 row_newbcast:9 row_mask:0xf bank_mask:0xf
    v_add_f32_dpp v194, v200, v194 row_newbcast:10 row_mask:0xf bank_mask:0xf
    v_add_f32_dpp v195, v200, v195 row_newbcast:11 row_mask:0xf bank_mask:0xf
    v_add_f32_dpp v196, v200, v196 row_newbcast:12 row_mask:0xf bank_mask:0xf
    v_add_f32_dpp v197, v200, v197 row_newbcast:13 row_mask:0xf bank_mask:0xf
    v_add_f32_dpp v198, v200, v198 row_newbcast:14 row_mask:0xf bank_mask:0xf
    v_add_f32_dpp v199, v200, v199 row_newbcast:15 row_mask:0xf bank_mask:0xf
    v_cvt_pk_bf16_f32 v220, v192, v193
    v_cvt_pk_bf16_f32 v221, v194, v195
    v_cvt_pk_bf16_f32 v222, v196, v197
    v_cvt_pk_bf16_f32 v223, v198, v199
    buffer_store_dwordx4 v[220:223], v4, s[32:35], s13 offen offset:2048 sc1
    v_bfe_u32 v20, v1, 2, 2
    v_lshlrev_b32 v20, 7, v20
    v_bfe_u32 v9, v1, 3, 1
    v_lshl_add_u32 v20, v9, 6, v20
    v_bfe_u32 v9, v1, 4, 1
    v_lshl_add_u32 v20, v9, 5, v20
    v_and_b32 v9, 3, v1
    v_lshl_add_u32 v20, v9, 3, v20
    v_lshrrev_b32 v9, 5, v1
    v_lshl_add_u32 v20, v9, 9, v20
    v_xor_b32 v21, 64, v20
    v_add_u32 v22, 49152, v20
    v_add_u32 v23, 49152, v21
    v_add_u32 v24, 98304, v20
    v_add_u32 v25, 98304, v21
    v_and_b32 v5, 3, v1
    v_lshlrev_b32 v5, 15, v5
    v_bfe_u32 v9, v1, 2, 2
    v_lshl_add_u32 v5, v9, 12, v5
    s_and_b32 s96, s12, 1
    s_lshr_b32 s97, s21, 3
    s_and_b32 s98, s21, 7
    s_lshl_b32 s99, s98, 5
    s_lshl2_add_u32 s98, s97, s99
    s_lshl_b32 s97, s98, 12
    s_lshr_b32 s99, s12, 1
    s_lshl_b32 s98, s99, 6
    s_add_u32 s99, s97, s98
    s_lshl2_add_u32 s97, s96, s99
    s_add_u32 s13, s97, 1048576
    s_lshl_b32 s96, s10, 18
    s_lshl_b32 s97, s77, 12
    s_add_u32 s98, s96, s97
    s_add_u32 s88, s98, 4194304
    s_cmp_ge_u32 s9, 28
    s_cselect_b32 s54, 0, s54
    s_cselect_b32 s58, 0, s58
    s_cselect_b32 s62, 0, s62
    s_waitcnt vmcnt(0)
    s_barrier
    s_cmp_lg_u32 s3, 0
    s_cbranch_scc1 L_PB
    v_mov_b32 v6, s4
    s_mov_b32 exec_hi, 0
    s_mov_b32 exec_lo, 65535
    buffer_store_dword v6, v5, s[32:35], s13 offen sc1
    s_mov_b64 exec, -1
L_PB:
    s_lshr_b32 s96, s9, 4
    s_lshl_b32 s97, s96, -1
    s_xor_b32 s94, s97, 2
    s_add_u32 s96, s94, s84
    s_and_b32 s97, s96, 15
    s_mul_i32 s98, s97, 393216
    s_add_u32 s91, s98, s85
    s_lshl_b32 s96, s94, 13
    s_add_u32 s94, s96, s83
    s_add_u32 s82, s91, 2048
    s_mov_b32 m0, s94
    s_nop 0
    buffer_load_dwordx4 v3, s[40:43], s82 offen lds
    s_add_u32 s82, s91, 4096
    s_add_u32 m0, s94, 49152
    s_nop 0
    buffer_load_dwordx4 v3, s[40:43], s82 offen lds
    s_mov_b32 s82, s91
    s_add_u32 m0, s94, 98304
    s_nop 0
    buffer_load_dwordx4 v3, s[40:43], s82 offen lds
    s_lshr_b32 s96, s9, 4
    s_lshl_b32 s97, s96, -1
    s_xor_b32 s94, s97, 3
    s_add_u32 s96, s94, s84
    s_and_b32 s97, s96, 15
    s_mul_i32 s98, s97, 393216
    s_add_u32 s91, s98, s85
    s_lshl_b32 s96, s94, 13
    s_add_u32 s94, s96, s83
    s_add_u32 s82, s91, 2048
    s_mov_b32 m0, s94
    s_nop 0
    buffer_load_dwordx4 v3, s[40:43], s82 offen lds
    s_add_u32 s82, s91, 4096
    s_add_u32 m0, s94, 49152
    s_nop 0
    buffer_load_dwordx4 v3, s[40:43], s82 offen lds
    s_mov_b32 s82, s91
    s_add_u32 m0, s94, 98304
    s_nop 0
    buffer_load_dwordx4 v3, s[40:43], s82 offen lds
    s_lshl_b32 s96, s2, 12
    s_add_u32 s19, s96, 1048576
    s_and_b32 s96, s3, 3
    s_lshl_b32 s97, s96, 7
    s_add_u32 s20, s97, s19
    s_lshl_b32 s96, s84, 5
    s_add_u32 s19, s96, s19
    s_cmp_ge_u32 s3, 4
    s_cselect_b32 s19, s20, s19
    s_load_dwordx2 s[24:25], s[32:33], s19 offset:0 glc
    s_load_dwordx2 s[26:27], s[32:33], s19 offset:64 glc
    s_lshl_b32 s96, s3, 14
    s_lshl_b32 s97, s12, 7
    s_add_u32 s90, s96, s97
    s_and_b32 s96, s9, 1
    s_lshr_b32 s97, s9, 3
    s_lshl_b32 s98, s97, 1
    s_lshl3_add_u32 s99, s96, s98
    s_lshl_b32 s95, s99, 17
    s_lshl3_add_u32 s96, s75, s3
    s_mul_i32 s97, s96, 229376
    s_lshl_b32 s98, s74, 7
    s_add_u32 s80, s97, s98
    s_lshl3_add_u32 s96, s74, s3
    s_lshl_b32 s97, s96, 14
    s_lshl_b32 s98, s75, 9
    s_add_u32 s81, s97, s98
    s_and_b32 s96, s8, 3
    s_lshl3_add_u32 s97, s96, s3
    s_mul_i32 s98, s97, 393216
    s_lshr_b32 s99, s8, 2
    s_lshl1_add_u32 s96, s9, s99
    s_lshl_b32 s97, s96, 7
    s_add_u32 s99, s98, s97
    s_add_u32 s89, s99, 4096
    s_and_b32 s96, s3, 1
    s_lshl_b32 s14, s96, 6
    v_bfe_u32 v6, v1, 4, 1
    v_lshl_add_u32 v6, v6, 5, s14
    v_and_b32 v26, 7, v1
    v_lshlrev_b32 v26, 4, v26
    v_xor_b32 v26, v26, v6
    v_lshrrev_b32 v6, 3, v1
    v_lshlrev_b32 v6, 11, v6
    v_add_u32 v26, v26, v6
    s_and_b32 s96, s3, 2
    s_lshl_b32 s14, s96, 5
    v_bfe_u32 v6, v1, 4, 1
    v_lshl_add_u32 v6, v6, 5, s14
    v_and_b32 v27, 7, v1
    v_lshlrev_b32 v27, 4, v27
    v_xor_b32 v27, v27, v6
    v_lshrrev_b32 v6, 3, v1
    v_mul_u32_u24 v6, 7168, v6
    v_add_u32 v27, v27, v6
    s_and_b32 s96, s3, 1
    s_lshl_b32 s14, s96, 7
    v_lshrrev_b32 v6, 5, v1
    v_lshl_add_u32 v6, v6, 6, s14
    v_and_b32 v253, 31, v1
    v_lshlrev_b32 v253, 4, v253
    v_lshrrev_b32 v9, 5, v1
    v_lshl_add_u32 v253, v9, 11, v253
    v_xor_b32 v253, v253, v6
    s_lshl_b32 s16, s84, 14
    v_add_u32 v249, s88, v2
    s_lshl_b32 s96, s77, 11
    s_add_u32 s14, s96, 151552
    v_add_u32 v0, s14, v2
    s_mov_b64 exec, 0
    s_cmp_eq_u32 s3, 4
    s_cbranch_scc1 L_PAD2
    s_cmp_eq_u32 s3, 5
    s_cbranch_scc1 L_PAD3
    s_cmp_eq_u32 s3, 6
    s_cbranch_scc1 L_PAD4
    s_cmp_eq_u32 s3, 7
    s_cbranch_scc1 L_PAD5
    s_branch L_TEND
L_RET2:
    s_branch L_PAD6
L_RET6:
    s_branch L_PAD10
L_RET10:
    s_branch L_TEND
L_RET3:
    s_branch L_PAD7
L_RET7:
    s_branch L_TEND
L_RET4:
    s_branch L_PAD8
L_RET8:
    s_branch L_TEND
L_RET5:
    s_branch L_PAD9
L_RET9:
    s_branch L_TEND
    s_nop 0
    s_nop 0
    s_nop 0
    s_nop 0
    s_nop 0
    s_nop 0
    s_nop 0
    s_nop 0
    s_nop 0
    s_nop 0
    s_nop 0
    s_nop 0
    s_nop 0
    s_nop 0
    s_nop 0
    s_nop 0
    s_nop 0
    s_nop 0
    s_nop 0
    s_nop 0
    s_nop 0
    s_nop 0
    s_nop 0
    s_nop 0
    s_nop 0
    s_nop 0
    s_nop 0
    s_nop 0
L_TEND:
    s_mov_b64 exec, -1
    s_branch SCHK_14
SPOLL_13:
    s_load_dwordx2 s[24:25], s[32:33], s19 offset:0 glc
    s_load_dwordx2 s[26:27], s[32:33], s19 offset:64 glc
SCHK_14:
    s_add_u32 s5, s5, 1
    s_cmp_ge_u32 s5, 200000
    s_waitcnt lgkmcnt(0)
    s_cbranch_scc1 SDONE_15
    s_cmp_lg_u32 s24, s4
    s_cbranch_scc1 SPOLL_13
    s_cmp_lg_u32 s25, s4
    s_cbranch_scc1 SPOLL_13
    s_cmp_lg_u32 s26, s4
    s_cbranch_scc1 SPOLL_13
    s_cmp_lg_u32 s27, s4
    s_cbranch_scc1 SPOLL_13
SDONE_15:
    s_cmp_ge_u32 s3, 4
    s_cbranch_scc1 L_HELP
    s_setprio 2
    buffer_load_dwordx4 v[152:155], v249, s[32:35], s16 offen sc1
    buffer_load_dwordx4 v[156:159], v249, s[32:35], s16 offen offset:1024 sc1
    buffer_load_dwordx4 v[160:163], v249, s[32:35], s16 offen offset:2048 sc1
    buffer_load_dwordx4 v[164:167], v249, s[32:35], s16 offen offset:3072 sc1
    s_add_u32 s16, s16, 16384
    s_and_b32 s16, s16, 0x3ffff
    buffer_load_dwordx4 v[168:171], v249, s[32:35], s16 offen sc1
    buffer_load_dwordx4 v[172:175], v249, s[32:35], s16 offen offset:1024 sc1
    s_barrier
    ds_read_b64_tr_b16 v[28:29], v20
    ds_read_b64_tr_b16 v[30:31], v20 offset:2048
    ds_read_b64_tr_b16 v[32:33], v21
    ds_read_b64_tr_b16 v[34:35], v21 offset:2048
    ds_read_b64_tr_b16 v[36:37], v24
    ds_read_b64_tr_b16 v[38:39], v24 offset:2048
    ds_read_b64_tr_b16 v[40:41], v25
    ds_read_b64_tr_b16 v[42:43], v25 offset:2048
    ds_read_b64_tr_b16 v[44:45], v22
    ds_read_b64_tr_b16 v[46:47], v22 offset:2048
    ds_read_b64_tr_b16 v[48:49], v23
    ds_read_b64_tr_b16 v[50:51], v23 offset:2048
    s_waitcnt vmcnt(5)
    s_waitcnt lgkmcnt(10)
    v_mfma_f32_32x32x16_bf16 v[56:71], v[28:31], v[152:155], 0
    ds_read_b64_tr_b16 v[52:53], v20 offset:1024
    ds_read_b64_tr_b16 v[54:55], v20 offset:3072
    s_waitcnt lgkmcnt(10)
    v_mfma_f32_32x32x16_bf16 v[72:87], v[32:35], v[152:155], 0
    ds_read_b64_tr_b16 v[28:29], v21 offset:1024
    ds_read_b64_tr_b16 v[30:31], v21 offset:3072
    s_waitcnt lgkmcnt(10)
    v_mfma_f32_32x32x16_bf16 v[120:135], v[36:39], v[152:155], 0
    ds_read_b64_tr_b16 v[32:33], v24 offset:1024
    ds_read_b64_tr_b16 v[34:35], v24 offset:3072
    s_waitcnt lgkmcnt(10)
    v_mfma_f32_32x32x16_bf16 v[136:151], v[40:43], v[152:155], 0
    ds_read_b64_tr_b16 v[36:37], v25 offset:1024
    ds_read_b64_tr_b16 v[38:39], v25 offset:3072
    s_waitcnt lgkmcnt(10)
    v_mfma_f32_32x32x16_bf16 v[88:103], v[44:47], v[152:155], 0
    buffer_load_dwordx4 v[176:179], v249, s[32:35], s16 offen offset:2048 sc1
    ds_read_b64_tr_b16 v[40:41], v22 offset:1024
    ds_read_b64_tr_b16 v[42:43], v22 offset:3072
    s_waitcnt lgkmcnt(10)
    v_mfma_f32_32x32x16_bf16 v[104:119], v[48:51], v[152:155], 0
    ds_read_b64_tr_b16 v[44:45], v23 offset:1024
    ds_read_b64_tr_b16 v[46:47], v23 offset:3072
    s_waitcnt vmcnt(5)
    s_waitcnt lgkmcnt(10)
    v_mfma_f32_32x32x16_bf16 v[56:71], v[52:55], v[156:159], v[56:71]
    ds_read_b64_tr_b16 v[48:49], v20 offset:4096
    ds_read_b64_tr_b16 v[50:51], v20 offset:6144
    s_waitcnt lgkmcnt(10)
    v_mfma_f32_32x32x16_bf16 v[72:87], v[28:31], v[156:159], v[72:87]
    ds_read_b64_tr_b16 v[52:53], v21 offset:4096
    ds_read_b64_tr_b16 v[54:55], v21 offset:6144
    s_waitcnt lgkmcnt(10)
    v_mfma_f32_32x32x16_bf16 v[120:135], v[32:35], v[156:159], v[120:135]
    ds_read_b64_tr_b16 v[28:29], v24 offset:4096
    ds_read_b64_tr_b16 v[30:31], v24 offset:6144
    s_waitcnt lgkmcnt(10)
    v_mfma_f32_32x32x16_bf16 v[136:151], v[36:39], v[156:159], v[136:151]
    buffer_load_dwordx4 v[180:183], v249, s[32:35], s16 offen offset:3072 sc1
    ds_read_b64_tr_b16 v[32:33], v25 offset:4096
    ds_read_b64_tr_b16 v[34:35], v25 offset:6144
    s_waitcnt lgkmcnt(10)
    v_mfma_f32_32x32x16_bf16 v[88:103], v[40:43], v[156:159], v[88:103]
    s_add_u32 s16, s16, 16384
    ds_read_b64_tr_b16 v[36:37], v22 offset:4096
    ds_read_b64_tr_b16 v[38:39], v22 offset:6144
    s_waitcnt lgkmcnt(10)
    v_mfma_f32_32x32x16_bf16 v[104:119], v[44:47], v[156:159], v[104:119]
    s_and_b32 s16, s16, 0x3ffff
    ds_read_b64_tr_b16 v[40:41], v23 offset:4096
    ds_read_b64_tr_b16 v[42:43], v23 offset:6144
    s_waitcnt vmcnt(5)
    s_waitcnt lgkmcnt(10)
    v_mfma_f32_32x32x16_bf16 v[56:71], v[48:51], v[160:163], v[56:71]
    ds_read_b64_tr_b16 v[44:45], v20 offset:5120
    ds_read_b64_tr_b16 v[46:47], v20 offset:7168
    s_waitcnt lgkmcnt(10)
    v_mfma_f32_32x32x16_bf16 v[72:87], v[52:55], v[160:163], v[72:87]
    ds_read_b64_tr_b16 v[48:49], v21 offset:5120
    ds_read_b64_tr_b16 v[50:51], v21 offset:7168
    s_waitcnt lgkmcnt(10)
    v_mfma_f32_32x32x16_bf16 v[120:135], v[28:31], v[160:163], v[120:135]
    buffer_load_dwordx4 v[184:187], v249, s[32:35], s16 offen sc1
    ds_read_b64_tr_b16 v[52:53], v24 offset:5120
    ds_read_b64_tr_b16 v[54:55], v24 offset:7168
    s_waitcnt lgkmcnt(10)
    v_mfma_f32_32x32x16_bf16 v[136:151], v[32:35], v[160:163], v[136:151]
    ds_read_b64_tr_b16 v[28:29], v25 offset:5120
    ds_read_b64_tr_b16 v[30:31], v25 offset:7168
    s_waitcnt lgkmcnt(10)
    v_mfma_f32_32x32x16_bf16 v[88:103], v[36:39], v[160:163], v[88:103]
    ds_read_b64_tr_b16 v[32:33], v22 offset:5120
    ds_read_b64_tr_b16 v[34:35], v22 offset:7168
    s_waitcnt lgkmcnt(10)
    v_mfma_f32_32x32x16_bf16 v[104:119], v[40:43], v[160:163], v[104:119]
    ds_read_b64_tr_b16 v[36:37], v23 offset:5120
    ds_read_b64_tr_b16 v[38:39], v23 offset:7168
    s_waitcnt vmcnt(5)
    s_waitcnt lgkmcnt(10)
    v_mfma_f32_32x32x16_bf16 v[56:71], v[44:47], v[164:167], v[56:71]
    ds_read_b64_tr_b16 v[40:41], v20 offset:8192
    ds_read_b64_tr_b16 v[42:43], v20 offset:10240
    s_waitcnt lgkmcnt(10)
    v_mfma_f32_32x32x16_bf16 v[72:87], v[48:51], v[164:167], v[72:87]
    buffer_load_dwordx4 v[188:191], v249, s[32:35], s16 offen offset:1024 sc1
    ds_read_b64_tr_b16 v[44:45], v21 offset:8192
    ds_read_b64_tr_b16 v[46:47], v21 offset:10240
    s_waitcnt lgkmcnt(10)
    v_mfma_f32_32x32x16_bf16 v[120:135], v[52:55], v[164:167], v[120:135]
    ds_read_b64_tr_b16 v[48:49], v24 offset:8192
    ds_read_b64_tr_b16 v[50:51], v24 offset:10240
    s_waitcnt lgkmcnt(10)
    v_mfma_f32_32x32x16_bf16 v[136:151], v[28:31], v[164:167], v[136:151]
    ds_read_b64_tr_b16 v[52:53], v25 offset:8192
    ds_read_b64_tr_b16 v[54:55], v25 offset:10240
    s_waitcnt lgkmcnt(10)
    v_mfma_f32_32x32x16_bf16 v[88:103], v[32:35], v[164:167], v[88:103]
    ds_read_b64_tr_b16 v[28:29], v22 offset:8192
    ds_read_b64_tr_b16 v[30:31], v22 offset:10240
    s_waitcnt lgkmcnt(10)
    v_mfma_f32_32x32x16_bf16 v[104:119], v[36:39], v[164:167], v[104:119]
    buffer_load_dwordx4 v[192:195], v249, s[32:35], s16 offen offset:2048 sc1
    ds_read_b64_tr_b16 v[32:33], v23 offset:8192
    ds_read_b64_tr_b16 v[34:35], v23 offset:10240
    s_barrier
    s_waitcnt vmcnt(6)
    s_waitcnt lgkmcnt(10)
    v_mfma_f32_32x32x16_bf16 v[56:71], v[40:43], v[168:171], v[56:71]
    ds_read_b64_tr_b16 v[36:37], v20 offset:9216
    ds_read_b64_tr_b16 v[38:39], v20 offset:11264
    s_waitcnt lgkmcnt(10)
    v_mfma_f32_32x32x16_bf16 v[72:87], v[44:47], v[168:171], v[72:87]
    ds_read_b64_tr_b16 v[40:41], v21 offset:9216
    ds_read_b64_tr_b16 v[42:43], v21 offset:11264
    s_waitcnt lgkmcnt(10)
    v_mfma_f32_32x32x16_bf16 v[120:135], v[48:51], v[168:171], v[120:135]
    ds_read_b64_tr_b16 v[44:45], v24 offset:9216
    ds_read_b64_tr_b16 v[46:47], v24 offset:11264
    s_waitcnt lgkmcnt(10)
    v_mfma_f32_32x32x16_bf16 v[136:151], v[52:55], v[168:171], v[136:151]
    ds_read_b64_tr_b16 v[48:49], v25 offset:9216
    ds_read_b64_tr_b16 v[50:51], v25 offset:11264
    s_waitcnt lgkmcnt(10)
    v_mfma_f32_32x32x16_bf16 v[88:103], v[28:31], v[168:171], v[88:103]
    buffer_load_dwordx4 v[196:199], v249, s[32:35], s16 offen offset:3072 sc1
    ds_read_b64_tr_b16 v[52:53], v22 offset:9216
    ds_read_b64_tr_b16 v[54:55], v22 offset:11264
    s_waitcnt lgkmcnt(10)
    v_mfma_f32_32x32x16_bf16 v[104:119], v[32:35], v[168:171], v[104:119]
    s_add_u32 s16, s16, 16384
    ds_read_b64_tr_b16 v[28:29], v23 offset:9216
    ds_read_b64_tr_b16 v[30:31], v23 offset:11264
    s_waitcnt vmcnt(6)
    s_waitcnt lgkmcnt(10)
    v_mfma_f32_32x32x16_bf16 v[56:71], v[36:39], v[172:175], v[56:71]
    s_and_b32 s16, s16, 0x3ffff
    ds_read_b64_tr_b16 v[32:33], v20 offset:12288
    ds_read_b64_tr_b16 v[34:35], v20 offset:14336
    s_waitcnt lgkmcnt(10)
    v_mfma_f32_32x32x16_bf16 v[72:87], v[40:43], v[172:175], v[72:87]
    ds_read_b64_tr_b16 v[36:37], v21 offset:12288
    ds_read_b64_tr_b16 v[38:39], v21 offset:14336
    s_waitcnt lgkmcnt(10)
    v_mfma_f32_32x32x16_bf16 v[120:135], v[44:47], v[172:175], v[120:135]
    ds_read_b64_tr_b16 v[40:41], v24 offset:12288
    ds_read_b64_tr_b16 v[42:43], v24 offset:14336
    s_waitcnt lgkmcnt(10)
    v_mfma_f32_32x32x16_bf16 v[136:151], v[48:51], v[172:175], v[136:151]
    buffer_load_dwordx4 v[200:203], v249, s[32:35], s16 offen sc1
    ds_read_b64_tr_b16 v[44:45], v25 offset:12288
    ds_read_b64_tr_b16 v[46:47], v25 offset:14336
    s_waitcnt lgkmcnt(10)
    v_mfma_f32_32x32x16_bf16 v[88:103], v[52:55], v[172:175], v[88:103]
    ds_read_b64_tr_b16 v[48:49], v22 offset:12288
    ds_read_b64_tr_b16 v[50:51], v22 offset:14336
    s_waitcnt lgkmcnt(10)
    v_mfma_f32_32x32x16_bf16 v[104:119], v[28:31], v[172:175], v[104:119]
    ds_read_b64_tr_b16 v[52:53], v23 offset:12288
    ds_read_b64_tr_b16 v[54:55], v23 offset:14336
    s_waitcnt vmcnt(6)
    s_waitcnt lgkmcnt(10)
    v_mfma_f32_32x32x16_bf16 v[56:71], v[32:35], v[176:179], v[56:71]
    ds_read_b64_tr_b16 v[28:29], v20 offset:13312
    ds_read_b64_tr_b16 v[30:31], v20 offset:15360
    s_waitcnt lgkmcnt(10)
    v_mfma_f32_32x32x16_bf16 v[72:87], v[36:39], v[176:179], v[72:87]
    ds_read_b64_tr_b16 v[32:33], v21 offset:13312
    ds_read_b64_tr_b16 v[34:35], v21 offset:15360
    s_waitcnt lgkmcnt(10)
    v_mfma_f32_32x32x16_bf16 v[120:135], v[40:43], v[176:179], v[120:135]
    buffer_load_dwordx4 v[204:207], v249, s[32:35], s16 offen offset:1024 sc1
    ds_read_b64_tr_b16 v[36:37], v24 offset:13312
    ds_read_b64_tr_b16 v[38:39], v24 offset:15360
    s_waitcnt lgkmcnt(10)
    v_mfma_f32_32x32x16_bf16 v[136:151], v[44:47], v[176:179], v[136:151]
    ds_read_b64_tr_b16 v[40:41], v25 offset:13312
    ds_read_b64_tr_b16 v[42:43], v25 offset:15360
    s_waitcnt lgkmcnt(10)
    v_mfma_f32_32x32x16_bf16 v[88:103], v[48:51], v[176:179], v[88:103]
    ds_read_b64_tr_b16 v[44:45], v22 offset:13312
    ds_read_b64_tr_b16 v[46:47], v22 offset:15360
    s_waitcnt lgkmcnt(10)
    v_mfma_f32_32x32x16_bf16 v[104:119], v[52:55], v[176:179], v[104:119]
    ds_read_b64_tr_b16 v[48:49], v23 offset:13312
    ds_read_b64_tr_b16 v[50:51], v23 offset:15360
    s_waitcnt vmcnt(6)
    s_waitcnt lgkmcnt(10)
    v_mfma_f32_32x32x16_bf16 v[56:71], v[28:31], v[180:183], v[56:71]
    ds_read_b64_tr_b16 v[52:53], v20 offset:16384
    ds_read_b64_tr_b16 v[54:55], v20 offset:18432
    s_waitcnt lgkmcnt(10)
    v_mfma_f32_32x32x16_bf16 v[72:87], v[32:35], v[180:183], v[72:87]
    buffer_load_dwordx4 v[208:211], v249, s[32:35], s16 offen offset:2048 sc1
    ds_read_b64_tr_b16 v[28:29], v21 offset:16384
    ds_read_b64_tr_b16 v[30:31], v21 offset:18432
    s_waitcnt lgkmcnt(10)
    v_mfma_f32_32x32x16_bf16 v[120:135], v[36:39], v[180:183], v[120:135]
    ds_read_b64_tr_b16 v[32:33], v24 offset:16384
    ds_read_b64_tr_b16 v[34:35], v24 offset:18432
    s_waitcnt lgkmcnt(10)
    v_mfma_f32_32x32x16_bf16 v[136:151], v[40:43], v[180:183], v[136:151]
    ds_read_b64_tr_b16 v[36:37], v25 offset:16384
    ds_read_b64_tr_b16 v[38:39], v25 offset:18432
    s_waitcnt lgkmcnt(10)
    v_mfma_f32_32x32x16_bf16 v[88:103], v[44:47], v[180:183], v[88:103]
    ds_read_b64_tr_b16 v[40:41], v22 offset:16384
    ds_read_b64_tr_b16 v[42:43], v22 offset:18432
    s_waitcnt lgkmcnt(10)
    v_mfma_f32_32x32x16_bf16 v[104:119], v[48:51], v[180:183], v[104:119]
    buffer_load_dwordx4 v[212:215], v249, s[32:35], s16 offen offset:3072 sc1
    ds_read_b64_tr_b16 v[44:45], v23 offset:16384
    ds_read_b64_tr_b16 v[46:47], v23 offset:18432
    s_barrier
    s_waitcnt vmcnt(7)
    s_waitcnt lgkmcnt(10)
    v_mfma_f32_32x32x16_bf16 v[56:71], v[52:55], v[184:187], v[56:71]
    s_add_u32 s16, s16, 16384
    ds_read_b64_tr_b16 v[48:49], v20 offset:17408
    ds_read_b64_tr_b16 v[50:51], v20 offset:19456
    s_waitcnt lgkmcnt(10)
    v_mfma_f32_32x32x16_bf16 v[72:87], v[28:31], v[184:187], v[72:87]
    s_and_b32 s16, s16, 0x3ffff
    ds_read_b64_tr_b16 v[52:53], v21 offset:17408
    ds_read_b64_tr_b16 v[54:55], v21 offset:19456
    s_waitcnt lgkmcnt(10)
    v_mfma_f32_32x32x16_bf16 v[120:135], v[32:35], v[184:187], v[120:135]
    ds_read_b64_tr_b16 v[28:29], v24 offset:17408
    ds_read_b64_tr_b16 v[30:31], v24 offset:19456
    s_waitcnt lgkmcnt(10)
    v_mfma_f32_32x32x16_bf16 v[136:151], v[36:39], v[184:187], v[136:151]
    ds_read_b64_tr_b16 v[32:33], v25 offset:17408
    ds_read_b64_tr_b16 v[34:35], v25 offset:19456
    s_waitcnt lgkmcnt(10)
    v_mfma_f32_32x32x16_bf16 v[88:103], v[40:43], v[184:187], v[88:103]
    buffer_load_dwordx4 v[216:219], v249, s[32:35], s16 offen sc1
    ds_read_b64_tr_b16 v[36:37], v22 offset:17408
    ds_read_b64_tr_b16 v[38:39], v22 offset:19456
    s_waitcnt lgkmcnt(10)
    v_mfma_f32_32x32x16_bf16 v[104:119], v[44:47], v[184:187], v[104:119]
    ds_read_b64_tr_b16 v[40:41], v23 offset:17408
    ds_read_b64_tr_b16 v[42:43], v23 offset:19456
    s_waitcnt vmcnt(7)
    s_waitcnt lgkmcnt(10)
    v_mfma_f32_32x32x16_bf16 v[56:71], v[48:51], v[188:191], v[56:71]
    ds_read_b64_tr_b16 v[44:45], v20 offset:20480
    ds_read_b64_tr_b16 v[46:47], v20 offset:22528
    s_waitcnt lgkmcnt(10)
    v_mfma_f32_32x32x16_bf16 v[72:87], v[52:55], v[188:191], v[72:87]
    ds_read_b64_tr_b16 v[48:49], v21 offset:20480
    ds_read_b64_tr_b16 v[50:51], v21 offset:22528
    s_waitcnt lgkmcnt(10)
    v_mfma_f32_32x32x16_bf16 v[120:135], v[28:31], v[188:191], v[120:135]
    ds_read_b64_tr_b16 v[52:53], v24 offset:20480
    ds_read_b64_tr_b16 v[54:55], v24 offset:22528
    s_waitcnt lgkmcnt(10)
    v_mfma_f32_32x32x16_bf16 v[136:151], v[32:35], v[188:191], v[136:151]
    buffer_load_dwordx4 v[220:223], v249, s[32:35], s16 offen offset:1024 sc1
    ds_read_b64_tr_b16 v[28:29], v25 offset:20480
    ds_read_b64_tr_b16 v[30:31], v25 offset:22528
    s_waitcnt lgkmcnt(10)
    v_mfma_f32_32x32x16_bf16 v[88:103], v[36:39], v[188:191], v[88:103]
    ds_read_b64_tr_b16 v[32:33], v22 offset:20480
    ds_read_b64_tr_b16 v[34:35], v22 offset:22528
    s_waitcnt lgkmcnt(10)
    v_mfma_f32_32x32x16_bf16 v[104:119], v[40:43], v[188:191], v[104:119]
    ds_read_b64_tr_b16 v[36:37], v23 offset:20480
    ds_read_b64_tr_b16 v[38:39], v23 offset:22528
    s_waitcnt vmcnt(7)
    s_waitcnt lgkmcnt(10)
    v_mfma_f32_32x32x16_bf16 v[56:71], v[44:47], v[192:195], v[56:71]
    ds_read_b64_tr_b16 v[40:41], v20 offset:21504
    ds_read_b64_tr_b16 v[42:43], v20 offset:23552
    s_waitcnt lgkmcnt(10)
    v_mfma_f32_32x32x16_bf16 v[72:87], v[48:51], v[192:195], v[72:87]
    ds_read_b64_tr_b16 v[44:45], v21 offset:21504
    ds_read_b64_tr_b16 v[46:47], v21 offset:23552
    s_waitcnt lgkmcnt(10)
    v_mfma_f32_32x32x16_bf16 v[120:135], v[52:55], v[192:195], v[120:135]
    buffer_load_dwordx4 v[224:227], v249, s[32:35], s16 offen offset:2048 sc1
    ds_read_b64_tr_b16 v[48:49], v24 offset:21504
    ds_read_b64_tr_b16 v[50:51], v24 offset:23552
    s_waitcnt lgkmcnt(10)
    v_mfma_f32_32x32x16_bf16 v[136:151], v[28:31], v[192:195], v[136:151]
    ds_read_b64_tr_b16 v[52:53], v25 offset:21504
    ds_read_b64_tr_b16 v[54:55], v25 offset:23552
    s_waitcnt lgkmcnt(10)
    v_mfma_f32_32x32x16_bf16 v[88:103], v[32:35], v[192:195], v[88:103]
    ds_read_b64_tr_b16 v[28:29], v22 offset:21504
    ds_read_b64_tr_b16 v[30:31], v22 offset:23552
    s_waitcnt lgkmcnt(10)
    v_mfma_f32_32x32x16_bf16 v[104:119], v[36:39], v[192:195], v[104:119]
    ds_read_b64_tr_b16 v[32:33], v23 offset:21504
    ds_read_b64_tr_b16 v[34:35], v23 offset:23552
    s_waitcnt vmcnt(7)
    s_waitcnt lgkmcnt(10)
    v_mfma_f32_32x32x16_bf16 v[56:71], v[40:43], v[196:199], v[56:71]
    ds_read_b64_tr_b16 v[36:37], v20 offset:24576
    ds_read_b64_tr_b16 v[38:39], v20 offset:26624
    s_waitcnt lgkmcnt(10)
    v_mfma_f32_32x32x16_bf16 v[72:87], v[44:47], v[196:199], v[72:87]
    buffer_load_dwordx4 v[228:231], v249, s[32:35], s16 offen offset:3072 sc1
    ds_read_b64_tr_b16 v[40:41], v21 offset:24576
    ds_read_b64_tr_b16 v[42:43], v21 offset:26624
    s_waitcnt lgkmcnt(10)
    v_mfma_f32_32x32x16_bf16 v[120:135], v[48:51], v[196:199], v[120:135]
    s_add_u32 s16, s16, 16384
    ds_read_b64_tr_b16 v[44:45], v24 offset:24576
    ds_read_b64_tr_b16 v[46:47], v24 offset:26624
    s_waitcnt lgkmcnt(10)
    v_mfma_f32_32x32x16_bf16 v[136:151], v[52:55], v[196:199], v[136:151]
    s_and_b32 s16, s16, 0x3ffff
    ds_read_b64_tr_b16 v[48:49], v25 offset:24576
    ds_read_b64_tr_b16 v[50:51], v25 offset:26624
    s_waitcnt lgkmcnt(10)
    v_mfma_f32_32x32x16_bf16 v[88:103], v[28:31], v[196:199], v[88:103]
    ds_read_b64_tr_b16 v[52:53], v22 offset:24576
    ds_read_b64_tr_b16 v[54:55], v22 offset:26624
    s_waitcnt lgkmcnt(10)
    v_mfma_f32_32x32x16_bf16 v[104:119], v[32:35], v[196:199], v[104:119]
    buffer_load_dwordx4 v[232:235], v249, s[32:35], s16 offen sc1
    ds_read_b64_tr_b16 v[28:29], v23 offset:24576
    ds_read_b64_tr_b16 v[30:31], v23 offset:26624
    s_barrier
    s_waitcnt vmcnt(8)
    s_waitcnt lgkmcnt(10)
    v_mfma_f32_32x32x16_bf16 v[56:71], v[36:39], v[200:203], v[56:71]
    ds_read_b64_tr_b16 v[32:33], v20 offset:25600
    ds_read_b64_tr_b16 v[34:35], v20 offset:27648
    s_waitcnt lgkmcnt(10)
    v_mfma_f32_32x32x16_bf16 v[72:87], v[40:43], v[200:203], v[72:87]
    ds_read_b64_tr_b16 v[36:37], v21 offset:25600
    ds_read_b64_tr_b16 v[38:39], v21 offset:27648
    s_waitcnt lgkmcnt(10)
    v_mfma_f32_32x32x16_bf16 v[120:135], v[44:47], v[200:203], v[120:135]
    ds_read_b64_tr_b16 v[40:41], v24 offset:25600
    ds_read_b64_tr_b16 v[42:43], v24 offset:27648
    s_waitcnt lgkmcnt(10)
    v_mfma_f32_32x32x16_bf16 v[136:151], v[48:51], v[200:203], v[136:151]
    ds_read_b64_tr_b16 v[44:45], v25 offset:25600
    ds_read_b64_tr_b16 v[46:47], v25 offset:27648
    s_waitcnt lgkmcnt(10)
    v_mfma_f32_32x32x16_bf16 v[88:103], v[52:55], v[200:203], v[88:103]
    buffer_load_dwordx4 v[236:239], v249, s[32:35], s16 offen offset:1024 sc1
    ds_read_b64_tr_b16 v[48:49], v22 offset:25600
    ds_read_b64_tr_b16 v[50:51], v22 offset:27648
    s_waitcnt lgkmcnt(10)
    v_mfma_f32_32x32x16_bf16 v[104:119], v[28:31], v[200:203], v[104:119]
    ds_read_b64_tr_b16 v[52:53], v23 offset:25600
    ds_read_b64_tr_b16 v[54:55], v23 offset:27648
    s_waitcnt vmcnt(8)
    s_waitcnt lgkmcnt(10)
    v_mfma_f32_32x32x16_bf16 v[56:71], v[32:35], v[204:207], v[56:71]
    ds_read_b64_tr_b16 v[28:29], v20 offset:28672
    ds_read_b64_tr_b16 v[30:31], v20 offset:30720
    s_waitcnt lgkmcnt(10)
    v_mfma_f32_32x32x16_bf16 v[72:87], v[36:39], v[204:207], v[72:87]
    ds_read_b64_tr_b16 v[32:33], v21 offset:28672
    ds_read_b64_tr_b16 v[34:35], v21 offset:30720
    s_waitcnt lgkmcnt(10)
    v_mfma_f32_32x32x16_bf16 v[120:135], v[40:43], v[204:207], v[120:135]
    ds_read_b64_tr_b16 v[36:37], v24 offset:28672
    ds_read_b64_tr_b16 v[38:39], v24 offset:30720
    s_waitcnt lgkmcnt(10)
    v_mfma_f32_32x32x16_bf16 v[136:151], v[44:47], v[204:207], v[136:151]
    buffer_load_dwordx4 v[240:243], v249, s[32:35], s16 offen offset:2048 sc1
    ds_read_b64_tr_b16 v[40:41], v25 offset:28672
    ds_read_b64_tr_b16 v[42:43], v25 offset:30720
    s_waitcnt lgkmcnt(10)
    v_mfma_f32_32x32x16_bf16 v[88:103], v[48:51], v[204:207], v[88:103]
    ds_read_b64_tr_b16 v[44:45], v22 offset:28672
    ds_read_b64_tr_b16 v[46:47], v22 offset:30720
L_PAD2:
    s_cbranch_execz L_RET2
    s_waitcnt lgkmcnt(10)
    v_mfma_f32_32x32x16_bf16 v[104:119], v[52:55], v[204:207], v[104:119]
    ds_read_b64_tr_b16 v[48:49], v23 offset:28672
    ds_read_b64_tr_b16 v[50:51], v23 offset:30720
    s_waitcnt vmcnt(8)
    s_waitcnt lgkmcnt(10)
    v_mfma_f32_32x32x16_bf16 v[56:71], v[28:31], v[208:211], v[56:71]
    ds_read_b64_tr_b16 v[52:53], v20 offset:29696
    ds_read_b64_tr_b16 v[54:55], v20 offset:31744
    s_waitcnt lgkmcnt(10)
    v_mfma_f32_32x32x16_bf16 v[72:87], v[32:35], v[208:211], v[72:87]
    ds_read_b64_tr_b16 v[28:29], v21 offset:29696
    ds_read_b64_tr_b16 v[30:31], v21 offset:31744
    s_waitcnt lgkmcnt(10)
    v_mfma_f32_32x32x16_bf16 v[120:135], v[36:39], v[208:211], v[120:135]
    buffer_load_dwordx4 v[244:247], v249, s[32:35], s16 offen offset:3072 sc1
    ds_read_b64_tr_b16 v[32:33], v24 offset:29696
    ds_read_b64_tr_b16 v[34:35], v24 offset:31744
    s_waitcnt lgkmcnt(10)
    v_mfma_f32_32x32x16_bf16 v[136:151], v[40:43], v[208:211], v[136:151]
    s_add_u32 s16, s16, 16384
    ds_read_b64_tr_b16 v[36:37], v25 offset:29696
    ds_read_b64_tr_b16 v[38:39], v25 offset:31744
    s_waitcnt lgkmcnt(10)
    v_mfma_f32_32x32x16_bf16 v[88:103], v[44:47], v[208:211], v[88:103]
    s_and_b32 s16, s16, 0x3ffff
    ds_read_b64_tr_b16 v[40:41], v22 offset:29696
    ds_read_b64_tr_b16 v[42:43], v22 offset:31744
    s_waitcnt lgkmcnt(10)
    v_mfma_f32_32x32x16_bf16 v[104:119], v[48:51], v[208:211], v[104:119]
    ds_read_b64_tr_b16 v[44:45], v23 offset:29696
    ds_read_b64_tr_b16 v[46:47], v23 offset:31744
    s_waitcnt vmcnt(8)
    s_waitcnt lgkmcnt(10)
    v_mfma_f32_32x32x16_bf16 v[56:71], v[52:55], v[212:215], v[56:71]
    ds_read_b64_tr_b16 v[48:49], v20 offset:32768
    ds_read_b64_tr_b16 v[50:51], v20 offset:34816
    s_waitcnt lgkmcnt(10)
    v_mfma_f32_32x32x16_bf16 v[72:87], v[28:31], v[212:215], v[72:87]
    buffer_load_dwordx4 v[152:155], v249, s[32:35], s16 offen sc1
    ds_read_b64_tr_b16 v[52:53], v21 offset:32768
    ds_read_b64_tr_b16 v[54:55], v21 offset:34816
    s_waitcnt lgkmcnt(10)
    v_mfma_f32_32x32x16_bf16 v[120:135], v[32:35], v[212:215], v[120:135]
    ds_read_b64_tr_b16 v[28:29], v24 offset:32768
    ds_read_b64_tr_b16 v[30:31], v24 offset:34816
    s_waitcnt lgkmcnt(10)
    v_mfma_f32_32x32x16_bf16 v[136:151], v[36:39], v[212:215], v[136:151]
    ds_read_b64_tr_b16 v[32:33], v25 offset:32768
    ds_read_b64_tr_b16 v[34:35], v25 offset:34816
    s_waitcnt lgkmcnt(10)
    v_mfma_f32_32x32x16_bf16 v[88:103], v[40:43], v[212:215], v[88:103]
    ds_read_b64_tr_b16 v[36:37], v22 offset:32768
    ds_read_b64_tr_b16 v[38:39], v22 offset:34816
    s_waitcnt lgkmcnt(10)
    v_mfma_f32_32x32x16_bf16 v[104:119], v[44:47], v[212:215], v[104:119]
    buffer_load_dwordx4 v[156:159], v249, s[32:35], s16 offen offset:1024 sc1
    ds_read_b64_tr_b16 v[40:41], v23 offset:32768
    ds_read_b64_tr_b16 v[42:43], v23 offset:34816
    s_barrier
    s_waitcnt vmcnt(9)
    s_waitcnt lgkmcnt(10)
    v_mfma_f32_32x32x16_bf16 v[56:71], v[48:51], v[216:219], v[56:71]
    ds_read_b64_tr_b16 v[44:45], v20 offset:33792
    ds_read_b64_tr_b16 v[46:47], v20 offset:35840
    s_waitcnt lgkmcnt(10)
    v_mfma_f32_32x32x16_bf16 v[72:87], v[52:55], v[216:219], v[72:87]
    ds_read_b64_tr_b16 v[48:49], v21 offset:33792
    ds_read_b64_tr_b16 v[50:51], v21 offset:35840
    s_waitcnt lgkmcnt(10)
    v_mfma_f32_32x32x16_bf16 v[120:135], v[28:31], v[216:219], v[120:135]
    ds_read_b64_tr_b16 v[52:53], v24 offset:33792
    ds_read_b64_tr_b16 v[54:55], v24 offset:35840
    s_waitcnt lgkmcnt(10)
    v_mfma_f32_32x32x16_bf16 v[136:151], v[32:35], v[216:219], v[136:151]
    ds_read_b64_tr_b16 v[28:29], v25 offset:33792
    ds_read_b64_tr_b16 v[30:31], v25 offset:35840
    s_waitcnt lgkmcnt(10)
    v_mfma_f32_32x32x16_bf16 v[88:103], v[36:39], v[216:219], v[88:103]
    buffer_load_dwordx4 v[160:163], v249, s[32:35], s16 offen offset:2048 sc1
    ds_read_b64_tr_b16 v[32:33], v22 offset:33792
    ds_read_b64_tr_b16 v[34:35], v22 offset:35840
    s_waitcnt lgkmcnt(10)
    v_mfma_f32_32x32x16_bf16 v[104:119], v[40:43], v[216:219], v[104:119]
    ds_read_b64_tr_b16 v[36:37], v23 offset:33792
    ds_read_b64_tr_b16 v[38:39], v23 offset:35840
    s_waitcnt vmcnt(9)
    s_waitcnt lgkmcnt(10)
    v_mfma_f32_32x32x16_bf16 v[56:71], v[44:47], v[220:223], v[56:71]
    ds_read_b64_tr_b16 v[40:41], v20 offset:36864
    ds_read_b64_tr_b16 v[42:43], v20 offset:38912
    s_waitcnt lgkmcnt(10)
    v_mfma_f32_32x32x16_bf16 v[72:87], v[48:51], v[220:223], v[72:87]
    ds_read_b64_tr_b16 v[44:45], v21 offset:36864
    ds_read_b64_tr_b16 v[46:47], v21 offset:38912
    s_waitcnt lgkmcnt(10)
    v_mfma_f32_32x32x16_bf16 v[120:135], v[52:55], v[220:223], v[120:135]
    ds_read_b64_tr_b16 v[48:49], v24 offset:36864
    ds_read_b64_tr_b16 v[50:51], v24 offset:38912
    s_waitcnt lgkmcnt(10)
    v_mfma_f32_32x32x16_bf16 v[136:151], v[28:31], v[220:223], v[136:151]
    buffer_load_dwordx4 v[164:167], v249, s[32:35], s16 offen offset:3072 sc1
    ds_read_b64_tr_b16 v[52:53], v25 offset:36864
    ds_read_b64_tr_b16 v[54:55], v25 offset:38912
    s_waitcnt lgkmcnt(10)
    v_mfma_f32_32x32x16_bf16 v[88:103], v[32:35], v[220:223], v[88:103]
    s_add_u32 s16, s16, 16384
    ds_read_b64_tr_b16 v[28:29], v22 offset:36864
    ds_read_b64_tr_b16 v[30:31], v22 offset:38912
    s_waitcnt lgkmcnt(10)
    v_mfma_f32_32x32x16_bf16 v[104:119], v[36:39], v[220:223], v[104:119]
    s_and_b32 s16, s16, 0x3ffff
    ds_read_b64_tr_b16 v[32:33], v23 offset:36864
    ds_read_b64_tr_b16 v[34:35], v23 offset:38912
    s_waitcnt vmcnt(9)
    s_waitcnt lgkmcnt(10)
    v_mfma_f32_32x32x16_bf16 v[56:71], v[40:43], v[224:227], v[56:71]
    ds_read_b64_tr_b16 v[36:37], v20 offset:37888
    ds_read_b64_tr_b16 v[38:39], v20 offset:39936
    s_waitcnt lgkmcnt(10)
    v_mfma_f32_32x32x16_bf16 v[72:87], v[44:47], v[224:227], v[72:87]
    ds_read_b64_tr_b16 v[40:41], v21 offset:37888
    ds_read_b64_tr_b16 v[42:43], v21 offset:39936
    s_waitcnt lgkmcnt(10)
    v_mfma_f32_32x32x16_bf16 v[120:135], v[48:51], v[224:227], v[120:135]
    buffer_load_dwordx4 v[168:171], v249, s[32:35], s16 offen sc1
    ds_read_b64_tr_b16 v[44:45], v24 offset:37888
    ds_read_b64_tr_b16 v[46:47], v24 offset:39936
    s_waitcnt lgkmcnt(10)
    v_mfma_f32_32x32x16_bf16 v[136:151], v[52:55], v[224:227], v[136:151]
    ds_read_b64_tr_b16 v[48:49], v25 offset:37888
    ds_read_b64_tr_b16 v[50:51], v25 offset:39936
    s_waitcnt lgkmcnt(10)
    v_mfma_f32_32x32x16_bf16 v[88:103], v[28:31], v[224:227], v[88:103]
    ds_read_b64_tr_b16 v[52:53], v22 offset:37888
    ds_read_b64_tr_b16 v[54:55], v22 offset:39936
    s_waitcnt lgkmcnt(10)
    v_mfma_f32_32x32x16_bf16 v[104:119], v[32:35], v[224:227], v[104:119]
    ds_read_b64_tr_b16 v[28:29], v23 offset:37888
    ds_read_b64_tr_b16 v[30:31], v23 offset:39936
    s_waitcnt vmcnt(9)
    s_waitcnt lgkmcnt(10)
    v_mfma_f32_32x32x16_bf16 v[56:71], v[36:39], v[228:231], v[56:71]
    ds_read_b64_tr_b16 v[32:33], v20 offset:40960
    ds_read_b64_tr_b16 v[34:35], v20 offset:43008
    s_waitcnt lgkmcnt(10)
    v_mfma_f32_32x32x16_bf16 v[72:87], v[40:43], v[228:231], v[72:87]
    buffer_load_dwordx4 v[172:175], v249, s[32:35], s16 offen offset:1024 sc1
    ds_read_b64_tr_b16 v[36:37], v21 offset:40960
    ds_read_b64_tr_b16 v[38:39], v21 offset:43008
    s_waitcnt lgkmcnt(10)
    v_mfma_f32_32x32x16_bf16 v[120:135], v[44:47], v[228:231], v[120:135]
    ds_read_b64_tr_b16 v[40:41], v24 offset:40960
    ds_read_b64_tr_b16 v[42:43], v24 offset:43008
    s_waitcnt lgkmcnt(10)
    v_mfma_f32_32x32x16_bf16 v[136:151], v[48:51], v[228:231], v[136:151]
    ds_read_b64_tr_b16 v[44:45], v25 offset:40960
    ds_read_b64_tr_b16 v[46:47], v25 offset:43008
    s_waitcnt lgkmcnt(10)
    v_mfma_f32_32x32x16_bf16 v[88:103], v[52:55], v[228:231], v[88:103]
    ds_read_b64_tr_b16 v[48:49], v22 offset:40960
    ds_read_b64_tr_b16 v[50:51], v22 offset:43008
    s_waitcnt lgkmcnt(10)
    v_mfma_f32_32x32x16_bf16 v[104:119], v[28:31], v[228:231], v[104:119]
    buffer_load_dwordx4 v[176:179], v249, s[32:35], s16 offen offset:2048 sc1
    ds_read_b64_tr_b16 v[52:53], v23 offset:40960
    ds_read_b64_tr_b16 v[54:55], v23 offset:43008
    s_barrier
    s_waitcnt vmcnt(10)
    s_waitcnt lgkmcnt(10)
    v_mfma_f32_32x32x16_bf16 v[56:71], v[32:35], v[232:235], v[56:71]
    ds_read_b64_tr_b16 v[28:29], v20 offset:41984
    ds_read_b64_tr_b16 v[30:31], v20 offset:44032
    s_waitcnt lgkmcnt(10)
    v_mfma_f32_32x32x16_bf16 v[72:87], v[36:39], v[232:235], v[72:87]
    ds_read_b64_tr_b16 v[32:33], v21 offset:41984
    ds_read_b64_tr_b16 v[34:35], v21 offset:44032
    s_waitcnt lgkmcnt(10)
    v_mfma_f32_32x32x16_bf16 v[120:135], v[40:43], v[232:235], v[120:135]
    ds_read_b64_tr_b16 v[36:37], v24 offset:41984
    ds_read_b64_tr_b16 v[38:39], v24 offset:44032
    s_waitcnt lgkmcnt(10)
    v_mfma_f32_32x32x16_bf16 v[136:151], v[44:47], v[232:235], v[136:151]
    buffer_load_dwordx4 v[180:183], v249, s[32:35], s16 offen offset:3072 sc1
    ds_read_b64_tr_b16 v[40:41], v25 offset:41984
    ds_read_b64_tr_b16 v[42:43], v25 offset:44032
    s_waitcnt lgkmcnt(10)
    v_mfma_f32_32x32x16_bf16 v[88:103], v[48:51], v[232:235], v[88:103]
    s_add_u32 s16, s16, 16384
    ds_read_b64_tr_b16 v[44:45], v22 offset:41984
    ds_read_b64_tr_b16 v[46:47], v22 offset:44032
    s_waitcnt lgkmcnt(10)
    v_mfma_f32_32x32x16_bf16 v[104:119], v[52:55], v[232:235], v[104:119]
    s_and_b32 s16, s16, 0x3ffff
    ds_read_b64_tr_b16 v[48:49], v23 offset:41984
    ds_read_b64_tr_b16 v[50:51], v23 offset:44032
    s_waitcnt vmcnt(10)
    s_waitcnt lgkmcnt(10)
    v_mfma_f32_32x32x16_bf16 v[56:71], v[28:31], v[236:239], v[56:71]
    buffer_load_dwordx4 v[184:187], v249, s[32:35], s16 offen sc1
    ds_read_b64_tr_b16 v[52:53], v20 offset:45056
    ds_read_b64_tr_b16 v[54:55], v20 offset:47104
    s_waitcnt lgkmcnt(10)
    v_mfma_f32_32x32x16_bf16 v[72:87], v[32:35], v[236:239], v[72:87]
    ds_read_b64_tr_b16 v[28:29], v21 offset:45056
    ds_read_b64_tr_b16 v[30:31], v21 offset:47104
    s_waitcnt lgkmcnt(10)
    v_mfma_f32_32x32x16_bf16 v[120:135], v[36:39], v[236:239], v[120:135]
    ds_read_b64_tr_b16 v[32:33], v24 offset:45056
    ds_read_b64_tr_b16 v[34:35], v24 offset:47104
    s_waitcnt lgkmcnt(10)
    v_mfma_f32_32x32x16_bf16 v[136:151], v[40:43], v[236:239], v[136:151]
    ds_read_b64_tr_b16 v[36:37], v25 offset:45056
    ds_read_b64_tr_b16 v[38:39], v25 offset:47104
    s_waitcnt lgkmcnt(10)
    v_mfma_f32_32x32x16_bf16 v[88:103], v[44:47], v[236:239], v[88:103]
    buffer_load_dwordx4 v[188:191], v249, s[32:35], s16 offen offset:1024 sc1
    ds_read_b64_tr_b16 v[40:41], v22 offset:45056
    ds_read_b64_tr_b16 v[42:43], v22 offset:47104
    s_waitcnt lgkmcnt(10)
    v_mfma_f32_32x32x16_bf16 v[104:119], v[48:51], v[236:239], v[104:119]
    ds_read_b64_tr_b16 v[44:45], v23 offset:45056
    ds_read_b64_tr_b16 v[46:47], v23 offset:47104
    s_waitcnt vmcnt(11)
    s_waitcnt lgkmcnt(10)
    v_mfma_f32_32x32x16_bf16 v[56:71], v[52:55], v[240:243], v[56:71]
    ds_read_b64_tr_b16 v[48:49], v20 offset:46080
    ds_read_b64_tr_b16 v[50:51], v20 offset:48128
    s_waitcnt lgkmcnt(10)
    v_mfma_f32_32x32x16_bf16 v[72:87], v[28:31], v[240:243], v[72:87]
    buffer_load_dwordx4 v[192:195], v249, s[32:35], s16 offen offset:2048 sc1
    ds_read_b64_tr_b16 v[52:53], v21 offset:46080
    ds_read_b64_tr_b16 v[54:55], v21 offset:48128
    s_waitcnt lgkmcnt(10)
    v_mfma_f32_32x32x16_bf16 v[120:135], v[32:35], v[240:243], v[120:135]
    ds_read_b64_tr_b16 v[28:29], v24 offset:46080
    ds_read_b64_tr_b16 v[30:31], v24 offset:48128
    s_waitcnt lgkmcnt(10)
    v_mfma_f32_32x32x16_bf16 v[136:151], v[36:39], v[240:243], v[136:151]
    ds_read_b64_tr_b16 v[32:33], v25 offset:46080
    ds_read_b64_tr_b16 v[34:35], v25 offset:48128
    s_waitcnt lgkmcnt(10)
    v_mfma_f32_32x32x16_bf16 v[88:103], v[40:43], v[240:243], v[88:103]
    ds_read_b64_tr_b16 v[36:37], v22 offset:46080
    ds_read_b64_tr_b16 v[38:39], v22 offset:48128
    s_waitcnt lgkmcnt(10)
    v_mfma_f32_32x32x16_bf16 v[104:119], v[44:47], v[240:243], v[104:119]
    buffer_load_dwordx4 v[196:199], v249, s[32:35], s16 offen offset:3072 sc1
    ds_read_b64_tr_b16 v[40:41], v23 offset:46080
    ds_read_b64_tr_b16 v[42:43], v23 offset:48128
    s_waitcnt vmcnt(12)
    s_waitcnt lgkmcnt(10)
    v_mfma_f32_32x32x16_bf16 v[56:71], v[48:51], v[244:247], v[56:71]
    s_add_u32 s16, s16, 16384
    ds_read_b64_tr_b16 v[44:45], v20
    ds_read_b64_tr_b16 v[46:47], v20 offset:2048
    s_waitcnt lgkmcnt(10)
    v_mfma_f32_32x32x16_bf16 v[72:87], v[52:55], v[244:247], v[72:87]
    s_and_b32 s16, s16, 0x3ffff
    ds_read_b64_tr_b16 v[48:49], v21
    ds_read_b64_tr_b16 v[50:51], v21 offset:2048
    s_waitcnt lgkmcnt(10)
    v_mfma_f32_32x32x16_bf16 v[120:135], v[28:31], v[244:247], v[120:135]
    buffer_load_dwordx4 v[200:203], v249, s[32:35], s16 offen sc1
    ds_read_b64_tr_b16 v[52:53], v24
    ds_read_b64_tr_b16 v[54:55], v24 offset:2048
    s_waitcnt lgkmcnt(10)
    v_mfma_f32_32x32x16_bf16 v[136:151], v[32:35], v[244:247], v[136:151]
    ds_read_b64_tr_b16 v[28:29], v25
    ds_read_b64_tr_b16 v[30:31], v25 offset:2048
    s_waitcnt lgkmcnt(10)
    v_mfma_f32_32x32x16_bf16 v[88:103], v[36:39], v[244:247], v[88:103]
    ds_read_b64_tr_b16 v[32:33], v22
    ds_read_b64_tr_b16 v[34:35], v22 offset:2048
    s_waitcnt lgkmcnt(10)
    v_mfma_f32_32x32x16_bf16 v[104:119], v[40:43], v[244:247], v[104:119]
    buffer_load_dwordx4 v[204:207], v249, s[32:35], s16 offen offset:1024 sc1
    ds_read_b64_tr_b16 v[36:37], v23
    ds_read_b64_tr_b16 v[38:39], v23 offset:2048
    s_barrier
    s_waitcnt vmcnt(13)
    s_waitcnt lgkmcnt(10)
    v_mfma_f32_32x32x16_bf16 v[56:71], v[44:47], v[152:155], v[56:71]
    ds_read_b64_tr_b16 v[40:41], v20 offset:1024
    ds_read_b64_tr_b16 v[42:43], v20 offset:3072
    s_waitcnt lgkmcnt(10)
    v_mfma_f32_32x32x16_bf16 v[72:87], v[48:51], v[152:155], v[72:87]
    ds_read_b64_tr_b16 v[44:45], v21 offset:1024
    ds_read_b64_tr_b16 v[46:47], v21 offset:3072
    s_waitcnt lgkmcnt(10)
    v_mfma_f32_32x32x16_bf16 v[120:135], v[52:55], v[152:155], v[120:135]
    ds_read_b64_tr_b16 v[48:49], v24 offset:1024
    ds_read_b64_tr_b16 v[50:51], v24 offset:3072
    s_waitcnt lgkmcnt(10)
    v_mfma_f32_32x32x16_bf16 v[136:151], v[28:31], v[152:155], v[136:151]
    buffer_load_dwordx4 v[208:211], v249, s[32:35], s16 offen offset:2048 sc1
    ds_read_b64_tr_b16 v[52:53], v25 offset:1024
    ds_read_b64_tr_b16 v[54:55], v25 offset:3072
    s_waitcnt lgkmcnt(10)
    v_mfma_f32_32x32x16_bf16 v[88:103], v[32:35], v[152:155], v[88:103]
    ds_read_b64_tr_b16 v[28:29], v22 offset:1024
    ds_read_b64_tr_b16 v[30:31], v22 offset:3072
    s_waitcnt lgkmcnt(10)
    v_mfma_f32_32x32x16_bf16 v[104:119], v[36:39], v[152:155], v[104:119]
    ds_read_b64_tr_b16 v[32:33], v23 offset:1024
    ds_read_b64_tr_b16 v[34:35], v23 offset:3072
    s_waitcnt vmcnt(13)
    s_waitcnt lgkmcnt(10)
    v_mfma_f32_32x32x16_bf16 v[56:71], v[40:43], v[156:159], v[56:71]
    buffer_load_dwordx4 v[212:215], v249, s[32:35], s16 offen offset:3072 sc1
    ds_read_b64_tr_b16 v[36:37], v20 offset:4096
    ds_read_b64_tr_b16 v[38:39], v20 offset:6144
    s_waitcnt lgkmcnt(10)
    v_mfma_f32_32x32x16_bf16 v[72:87], v[44:47], v[156:159], v[72:87]
    s_add_u32 s16, s16, 16384
    ds_read_b64_tr_b16 v[40:41], v21 offset:4096
    ds_read_b64_tr_b16 v[42:43], v21 offset:6144
    s_waitcnt lgkmcnt(10)
    v_mfma_f32_32x32x16_bf16 v[120:135], v[48:51], v[156:159], v[120:135]
    s_and_b32 s16, s16, 0x3ffff
    ds_read_b64_tr_b16 v[44:45], v24 offset:4096
    ds_read_b64_tr_b16 v[46:47], v24 offset:6144
    s_waitcnt lgkmcnt(10)
    v_mfma_f32_32x32x16_bf16 v[136:151], v[52:55], v[156:159], v[136:151]
    ds_read_b64_tr_b16 v[48:49], v25 offset:4096
    ds_read_b64_tr_b16 v[50:51], v25 offset:6144
    s_waitcnt lgkmcnt(10)
    v_mfma_f32_32x32x16_bf16 v[88:103], v[28:31], v[156:159], v[88:103]
    buffer_load_dwordx4 v[216:219], v249, s[32:35], s16 offen sc1
    ds_read_b64_tr_b16 v[52:53], v22 offset:4096
    ds_read_b64_tr_b16 v[54:55], v22 offset:6144
    s_waitcnt lgkmcnt(10)
    v_mfma_f32_32x32x16_bf16 v[104:119], v[32:35], v[156:159], v[104:119]
    ds_read_b64_tr_b16 v[28:29], v23 offset:4096
    ds_read_b64_tr_b16 v[30:31], v23 offset:6144
    s_waitcnt vmcnt(14)
    s_waitcnt lgkmcnt(10)
    v_mfma_f32_32x32x16_bf16 v[56:71], v[36:39], v[160:163], v[56:71]
    ds_read_b64_tr_b16 v[32:33], v20 offset:5120
    ds_read_b64_tr_b16 v[34:35], v20 offset:7168
    s_waitcnt lgkmcnt(10)
    v_mfma_f32_32x32x16_bf16 v[72:87], v[40:43], v[160:163], v[72:87]
    buffer_load_dwordx4 v[220:223], v249, s[32:35], s16 offen offset:1024 sc1
    ds_read_b64_tr_b16 v[36:37], v21 offset:5120
    ds_read_b64_tr_b16 v[38:39], v21 offset:7168
    s_waitcnt lgkmcnt(10)
    v_mfma_f32_32x32x16_bf16 v[120:135], v[44:47], v[160:163], v[120:135]
    ds_read_b64_tr_b16 v[40:41], v24 offset:5120
    ds_read_b64_tr_b16 v[42:43], v24 offset:7168
    s_waitcnt lgkmcnt(10)
    v_mfma_f32_32x32x16_bf16 v[136:151], v[48:51], v[160:163], v[136:151]
    ds_read_b64_tr_b16 v[44:45], v25 offset:5120
    ds_read_b64_tr_b16 v[46:47], v25 offset:7168
    s_waitcnt lgkmcnt(10)
    v_mfma_f32_32x32x16_bf16 v[88:103], v[52:55], v[160:163], v[88:103]
    ds_read_b64_tr_b16 v[48:49], v22 offset:5120
    ds_read_b64_tr_b16 v[50:51], v22 offset:7168
    s_waitcnt lgkmcnt(10)
    v_mfma_f32_32x32x16_bf16 v[104:119], v[28:31], v[160:163], v[104:119]
    buffer_load_dwordx4 v[224:227], v249, s[32:35], s16 offen offset:2048 sc1
    ds_read_b64_tr_b16 v[52:53], v23 offset:5120
    ds_read_b64_tr_b16 v[54:55], v23 offset:7168
    s_waitcnt vmcnt(15)
    s_waitcnt lgkmcnt(10)
    v_mfma_f32_32x32x16_bf16 v[56:71], v[32:35], v[164:167], v[56:71]
    ds_read_b64_tr_b16 v[28:29], v20 offset:8192
    ds_read_b64_tr_b16 v[30:31], v20 offset:10240
    s_waitcnt lgkmcnt(10)
    v_mfma_f32_32x32x16_bf16 v[72:87], v[36:39], v[164:167], v[72:87]
    ds_read_b64_tr_b16 v[32:33], v21 offset:8192
    ds_read_b64_tr_b16 v[34:35], v21 offset:10240
    s_waitcnt lgkmcnt(10)
    v_mfma_f32_32x32x16_bf16 v[120:135], v[40:43], v[164:167], v[120:135]
    buffer_load_dwordx4 v[228:231], v249, s[32:35], s16 offen offset:3072 sc1
    ds_read_b64_tr_b16 v[36:37], v24 offset:8192
    ds_read_b64_tr_b16 v[38:39], v24 offset:10240
    s_waitcnt lgkmcnt(10)
    v_mfma_f32_32x32x16_bf16 v[136:151], v[44:47], v[164:167], v[136:151]
    s_add_u32 s16, s16, 16384
    ds_read_b64_tr_b16 v[40:41], v25 offset:8192
    ds_read_b64_tr_b16 v[42:43], v25 offset:10240
    s_waitcnt lgkmcnt(10)
    v_mfma_f32_32x32x16_bf16 v[88:103], v[48:51], v[164:167], v[88:103]
    s_and_b32 s16, s16, 0x3ffff
    ds_read_b64_tr_b16 v[44:45], v22 offset:8192
    ds_read_b64_tr_b16 v[46:47], v22 offset:10240
    s_waitcnt lgkmcnt(10)
    v_mfma_f32_32x32x16_bf16 v[104:119], v[52:55], v[164:167], v[104:119]
    buffer_load_dwordx4 v[232:235], v249, s[32:35], s16 offen sc1
    ds_read_b64_tr_b16 v[48:49], v23 offset:8192
    ds_read_b64_tr_b16 v[50:51], v23 offset:10240
    s_barrier
    s_waitcnt vmcnt(16)
    s_waitcnt lgkmcnt(10)
    v_mfma_f32_32x32x16_bf16 v[56:71], v[28:31], v[168:171], v[56:71]
    ds_read_b64_tr_b16 v[52:53], v20 offset:9216
    ds_read_b64_tr_b16 v[54:55], v20 offset:11264
    s_waitcnt lgkmcnt(10)
    v_mfma_f32_32x32x16_bf16 v[72:87], v[32:35], v[168:171], v[72:87]
    ds_read_b64_tr_b16 v[28:29], v21 offset:9216
    ds_read_b64_tr_b16 v[30:31], v21 offset:11264
    s_waitcnt lgkmcnt(10)
    v_mfma_f32_32x32x16_bf16 v[120:135], v[36:39], v[168:171], v[120:135]
    ds_read_b64_tr_b16 v[32:33], v24 offset:9216
    ds_read_b64_tr_b16 v[34:35], v24 offset:11264
    s_waitcnt lgkmcnt(10)
    v_mfma_f32_32x32x16_bf16 v[136:151], v[40:43], v[168:171], v[136:151]
    buffer_load_dwordx4 v[236:239], v249, s[32:35], s16 offen offset:1024 sc1
    ds_read_b64_tr_b16 v[36:37], v25 offset:9216
    ds_read_b64_tr_b16 v[38:39], v25 offset:11264
    s_waitcnt lgkmcnt(10)
    v_mfma_f32_32x32x16_bf16 v[88:103], v[44:47], v[168:171], v[88:103]
    ds_read_b64_tr_b16 v[40:41], v22 offset:9216
    ds_read_b64_tr_b16 v[42:43], v22 offset:11264
    s_waitcnt lgkmcnt(10)
    v_mfma_f32_32x32x16_bf16 v[104:119], v[48:51], v[168:171], v[104:119]
    ds_read_b64_tr_b16 v[44:45], v23 offset:9216
    ds_read_b64_tr_b16 v[46:47], v23 offset:11264
    s_waitcnt vmcnt(16)
    s_waitcnt lgkmcnt(10)
    v_mfma_f32_32x32x16_bf16 v[56:71], v[52:55], v[172:175], v[56:71]
    buffer_load_dwordx4 v[240:243], v249, s[32:35], s16 offen offset:2048 sc1
    ds_read_b64_tr_b16 v[48:49], v20 offset:12288
    ds_read_b64_tr_b16 v[50:51], v20 offset:14336
    s_waitcnt lgkmcnt(10)
    v_mfma_f32_32x32x16_bf16 v[72:87], v[28:31], v[172:175], v[72:87]
    ds_read_b64_tr_b16 v[52:53], v21 offset:12288
    ds_read_b64_tr_b16 v[54:55], v21 offset:14336
    s_waitcnt lgkmcnt(10)
    v_mfma_f32_32x32x16_bf16 v[120:135], v[32:35], v[172:175], v[120:135]
    ds_read_b64_tr_b16 v[28:29], v24 offset:12288
    ds_read_b64_tr_b16 v[30:31], v24 offset:14336
    s_waitcnt lgkmcnt(10)
    v_mfma_f32_32x32x16_bf16 v[136:151], v[36:39], v[172:175], v[136:151]
    ds_read_b64_tr_b16 v[32:33], v25 offset:12288
    ds_read_b64_tr_b16 v[34:35], v25 offset:14336
    s_waitcnt lgkmcnt(10)
    v_mfma_f32_32x32x16_bf16 v[88:103], v[40:43], v[172:175], v[88:103]
    buffer_load_dwordx4 v[244:247], v249, s[32:35], s16 offen offset:3072 sc1
    ds_read_b64_tr_b16 v[36:37], v22 offset:12288
    ds_read_b64_tr_b16 v[38:39], v22 offset:14336
    s_waitcnt lgkmcnt(10)
    v_mfma_f32_32x32x16_bf16 v[104:119], v[44:47], v[172:175], v[104:119]
    s_add_u32 s16, s16, 16384
    ds_read_b64_tr_b16 v[40:41], v23 offset:12288
    ds_read_b64_tr_b16 v[42:43], v23 offset:14336
    s_waitcnt vmcnt(17)
    s_waitcnt lgkmcnt(10)
    v_mfma_f32_32x32x16_bf16 v[56:71], v[48:51], v[176:179], v[56:71]
    s_and_b32 s16, s16, 0x3ffff
    ds_read_b64_tr_b16 v[44:45], v20 offset:13312
    ds_read_b64_tr_b16 v[46:47], v20 offset:15360
    s_waitcnt lgkmcnt(10)
    v_mfma_f32_32x32x16_bf16 v[72:87], v[52:55], v[176:179], v[72:87]
    buffer_load_dwordx4 v[152:155], v249, s[32:35], s16 offen sc1
    ds_read_b64_tr_b16 v[48:49], v21 offset:13312
    ds_read_b64_tr_b16 v[50:51], v21 offset:15360
    s_waitcnt lgkmcnt(10)
    v_mfma_f32_32x32x16_bf16 v[120:135], v[28:31], v[176:179], v[120:135]
    ds_read_b64_tr_b16 v[52:53], v24 offset:13312
    ds_read_b64_tr_b16 v[54:55], v24 offset:15360
    s_waitcnt lgkmcnt(10)
    v_mfma_f32_32x32x16_bf16 v[136:151], v[32:35], v[176:179], v[136:151]
    ds_read_b64_tr_b16 v[28:29], v25 offset:13312
    ds_read_b64_tr_b16 v[30:31], v25 offset:15360
    s_waitcnt lgkmcnt(10)
    v_mfma_f32_32x32x16_bf16 v[88:103], v[36:39], v[176:179], v[88:103]
    ds_read_b64_tr_b16 v[32:33], v22 offset:13312
    ds_read_b64_tr_b16 v[34:35], v22 offset:15360
    s_waitcnt lgkmcnt(10)
    v_mfma_f32_32x32x16_bf16 v[104:119], v[40:43], v[176:179], v[104:119]
    buffer_load_dwordx4 v[156:159], v249, s[32:35], s16 offen offset:1024 sc1
    ds_read_b64_tr_b16 v[36:37], v23 offset:13312
    ds_read_b64_tr_b16 v[38:39], v23 offset:15360
    s_waitcnt vmcnt(18)
    s_waitcnt lgkmcnt(10)
    v_mfma_f32_32x32x16_bf16 v[56:71], v[44:47], v[180:183], v[56:71]
    ds_read_b64_tr_b16 v[40:41], v20 offset:16384
    ds_read_b64_tr_b16 v[42:43], v20 offset:18432
    s_waitcnt lgkmcnt(10)
    v_mfma_f32_32x32x16_bf16 v[72:87], v[48:51], v[180:183], v[72:87]
    ds_read_b64_tr_b16 v[44:45], v21 offset:16384
    ds_read_b64_tr_b16 v[46:47], v21 offset:18432
    s_waitcnt lgkmcnt(10)
    v_mfma_f32_32x32x16_bf16 v[120:135], v[52:55], v[180:183], v[120:135]
    buffer_load_dwordx4 v[160:163], v249, s[32:35], s16 offen offset:2048 sc1
    ds_read_b64_tr_b16 v[48:49], v24 offset:16384
    ds_read_b64_tr_b16 v[50:51], v24 offset:18432
    s_waitcnt lgkmcnt(10)
    v_mfma_f32_32x32x16_bf16 v[136:151], v[28:31], v[180:183], v[136:151]
    ds_read_b64_tr_b16 v[52:53], v25 offset:16384
    ds_read_b64_tr_b16 v[54:55], v25 offset:18432
    s_waitcnt lgkmcnt(10)
    v_mfma_f32_32x32x16_bf16 v[88:103], v[32:35], v[180:183], v[88:103]
    ds_read_b64_tr_b16 v[28:29], v22 offset:16384
    ds_read_b64_tr_b16 v[30:31], v22 offset:18432
    s_waitcnt lgkmcnt(10)
    v_mfma_f32_32x32x16_bf16 v[104:119], v[36:39], v[180:183], v[104:119]
    buffer_load_dwordx4 v[164:167], v249, s[32:35], s16 offen offset:3072 sc1
    ds_read_b64_tr_b16 v[32:33], v23 offset:16384
    ds_read_b64_tr_b16 v[34:35], v23 offset:18432
    s_barrier
    s_waitcnt vmcnt(19)
    s_waitcnt lgkmcnt(10)
    v_mfma_f32_32x32x16_bf16 v[56:71], v[40:43], v[184:187], v[56:71]
    s_add_u32 s16, s16, 16384
    ds_read_b64_tr_b16 v[36:37], v20 offset:17408
    ds_read_b64_tr_b16 v[38:39], v20 offset:19456
    s_waitcnt lgkmcnt(10)
    v_mfma_f32_32x32x16_bf16 v[72:87], v[44:47], v[184:187], v[72:87]
    s_and_b32 s16, s16, 0x3ffff
    ds_read_b64_tr_b16 v[40:41], v21 offset:17408
    ds_read_b64_tr_b16 v[42:43], v21 offset:19456
    s_waitcnt lgkmcnt(10)
    v_mfma_f32_32x32x16_bf16 v[120:135], v[48:51], v[184:187], v[120:135]
    ds_read_b64_tr_b16 v[44:45], v24 offset:17408
    ds_read_b64_tr_b16 v[46:47], v24 offset:19456
    s_waitcnt lgkmcnt(10)
    v_mfma_f32_32x32x16_bf16 v[136:151], v[52:55], v[184:187], v[136:151]
    buffer_load_dwordx4 v[168:171], v249, s[32:35], s16 offen sc1
    ds_read_b64_tr_b16 v[48:49], v25 offset:17408
    ds_read_b64_tr_b16 v[50:51], v25 offset:19456
    s_waitcnt lgkmcnt(10)
    v_mfma_f32_32x32x16_bf16 v[88:103], v[28:31], v[184:187], v[88:103]
    ds_read_b64_tr_b16 v[52:53], v22 offset:17408
    ds_read_b64_tr_b16 v[54:55], v22 offset:19456
    s_waitcnt lgkmcnt(10)
    v_mfma_f32_32x32x16_bf16 v[104:119], v[32:35], v[184:187], v[104:119]
    ds_read_b64_tr_b16 v[28:29], v23 offset:17408
    ds_read_b64_tr_b16 v[30:31], v23 offset:19456
    s_waitcnt vmcnt(19)
    s_waitcnt lgkmcnt(10)
    v_mfma_f32_32x32x16_bf16 v[56:71], v[36:39], v[188:191], v[56:71]
    ds_read_b64_tr_b16 v[32:33], v20 offset:20480
    ds_read_b64_tr_b16 v[34:35], v20 offset:22528
    s_waitcnt lgkmcnt(10)
    v_mfma_f32_32x32x16_bf16 v[72:87], v[40:43], v[188:191], v[72:87]
    buffer_load_dwordx4 v[172:175], v249, s[32:35], s16 offen offset:1024 sc1
    ds_read_b64_tr_b16 v[36:37], v21 offset:20480
    ds_read_b64_tr_b16 v[38:39], v21 offset:22528
    s_waitcnt lgkmcnt(10)
    v_mfma_f32_32x32x16_bf16 v[120:135], v[44:47], v[188:191], v[120:135]
    ds_read_b64_tr_b16 v[40:41], v24 offset:20480
    ds_read_b64_tr_b16 v[42:43], v24 offset:22528
    s_waitcnt lgkmcnt(10)
    v_mfma_f32_32x32x16_bf16 v[136:151], v[48:51], v[188:191], v[136:151]
    ds_read_b64_tr_b16 v[44:45], v25 offset:20480
    ds_read_b64_tr_b16 v[46:47], v25 offset:22528
    s_waitcnt lgkmcnt(10)
    v_mfma_f32_32x32x16_bf16 v[88:103], v[52:55], v[188:191], v[88:103]
    ds_read_b64_tr_b16 v[48:49], v22 offset:20480
    ds_read_b64_tr_b16 v[50:51], v22 offset:22528
    s_waitcnt lgkmcnt(10)
    v_mfma_f32_32x32x16_bf16 v[104:119], v[28:31], v[188:191], v[104:119]
    buffer_load_dwordx4 v[176:179], v249, s[32:35], s16 offen offset:2048 sc1
    ds_read_b64_tr_b16 v[52:53], v23 offset:20480
    ds_read_b64_tr_b16 v[54:55], v23 offset:22528
    s_waitcnt vmcnt(20)
    s_waitcnt lgkmcnt(10)
    v_mfma_f32_32x32x16_bf16 v[56:71], v[32:35], v[192:195], v[56:71]
    ds_read_b64_tr_b16 v[28:29], v20 offset:21504
    ds_read_b64_tr_b16 v[30:31], v20 offset:23552
    s_waitcnt lgkmcnt(10)
    v_mfma_f32_32x32x16_bf16 v[72:87], v[36:39], v[192:195], v[72:87]
    ds_read_b64_tr_b16 v[32:33], v21 offset:21504
    ds_read_b64_tr_b16 v[34:35], v21 offset:23552
    s_waitcnt lgkmcnt(10)
    v_mfma_f32_32x32x16_bf16 v[120:135], v[40:43], v[192:195], v[120:135]
    ds_read_b64_tr_b16 v[36:37], v24 offset:21504
    ds_read_b64_tr_b16 v[38:39], v24 offset:23552
    s_waitcnt lgkmcnt(10)
    v_mfma_f32_32x32x16_bf16 v[136:151], v[44:47], v[192:195], v[136:151]
    buffer_load_dwordx4 v[180:183], v249, s[32:35], s16 offen offset:3072 sc1
    ds_read_b64_tr_b16 v[40:41], v25 offset:21504
    ds_read_b64_tr_b16 v[42:43], v25 offset:23552
    s_waitcnt lgkmcnt(10)
    v_mfma_f32_32x32x16_bf16 v[88:103], v[48:51], v[192:195], v[88:103]
    s_add_u32 s16, s16, 16384
    ds_read_b64_tr_b16 v[44:45], v22 offset:21504
    ds_read_b64_tr_b16 v[46:47], v22 offset:23552
    s_waitcnt lgkmcnt(10)
    v_mfma_f32_32x32x16_bf16 v[104:119], v[52:55], v[192:195], v[104:119]
    s_and_b32 s16, s16, 0x3ffff
    ds_read_b64_tr_b16 v[48:49], v23 offset:21504
    ds_read_b64_tr_b16 v[50:51], v23 offset:23552
    s_waitcnt vmcnt(20)
    s_waitcnt lgkmcnt(10)
    v_mfma_f32_32x32x16_bf16 v[56:71], v[28:31], v[196:199], v[56:71]
    ds_read_b64_tr_b16 v[52:53], v20 offset:24576
L_PAD3:
    s_cbranch_execz L_RET3
    ds_read_b64_tr_b16 v[54:55], v20 offset:26624
    s_waitcnt lgkmcnt(10)
    v_mfma_f32_32x32x16_bf16 v[72:87], v[32:35], v[196:199], v[72:87]
    buffer_load_dwordx4 v[184:187], v249, s[32:35], s16 offen sc1
    ds_read_b64_tr_b16 v[28:29], v21 offset:24576
    ds_read_b64_tr_b16 v[30:31], v21 offset:26624
    s_waitcnt lgkmcnt(10)
    v_mfma_f32_32x32x16_bf16 v[120:135], v[36:39], v[196:199], v[120:135]
    ds_read_b64_tr_b16 v[32:33], v20 offset:25600
    ds_read_b64_tr_b16 v[34:35], v20 offset:27648
    s_waitcnt lgkmcnt(10)
    v_mfma_f32_32x32x16_bf16 v[136:151], v[40:43], v[196:199], v[136:151]
    ds_read_b64_tr_b16 v[36:37], v21 offset:25600
    ds_read_b64_tr_b16 v[38:39], v21 offset:27648
    s_waitcnt lgkmcnt(10)
    v_mfma_f32_32x32x16_bf16 v[88:103], v[44:47], v[196:199], v[88:103]
    ds_read_b64_tr_b16 v[40:41], v20 offset:28672
    ds_read_b64_tr_b16 v[42:43], v20 offset:30720
    s_waitcnt lgkmcnt(10)
    v_mfma_f32_32x32x16_bf16 v[104:119], v[48:51], v[196:199], v[104:119]
    buffer_load_dwordx4 v[188:191], v249, s[32:35], s16 offen offset:1024 sc1
    ds_read_b64_tr_b16 v[44:45], v21 offset:28672
    ds_read_b64_tr_b16 v[46:47], v21 offset:30720
    s_barrier
    s_waitcnt vmcnt(21)
    s_waitcnt lgkmcnt(10)
    v_mfma_f32_32x32x16_bf16 v[56:71], v[52:55], v[200:203], v[56:71]
    ds_read_b64_tr_b16 v[48:49], v20 offset:29696
    ds_read_b64_tr_b16 v[50:51], v20 offset:31744
    s_waitcnt lgkmcnt(10)
    v_mfma_f32_32x32x16_bf16 v[72:87], v[28:31], v[200:203], v[72:87]
    ds_read_b64_tr_b16 v[52:53], v21 offset:29696
    ds_read_b64_tr_b16 v[54:55], v21 offset:31744
    s_waitcnt vmcnt(20)
    s_waitcnt lgkmcnt(10)
    v_mfma_f32_32x32x16_bf16 v[56:71], v[32:35], v[204:207], v[56:71]
    ds_read_b64_tr_b16 v[28:29], v24 offset:24576
    ds_read_b64_tr_b16 v[30:31], v24 offset:26624
    s_waitcnt lgkmcnt(10)
    v_mfma_f32_32x32x16_bf16 v[72:87], v[36:39], v[204:207], v[72:87]
    buffer_load_dwordx4 v[192:195], v249, s[32:35], s16 offen offset:2048 sc1
    ds_read_b64_tr_b16 v[32:33], v25 offset:24576
    ds_read_b64_tr_b16 v[34:35], v25 offset:26624
    s_waitcnt vmcnt(20)
    s_waitcnt lgkmcnt(10)
    v_mfma_f32_32x32x16_bf16 v[56:71], v[40:43], v[208:211], v[56:71]
    ds_read_b64_tr_b16 v[36:37], v22 offset:24576
    ds_read_b64_tr_b16 v[38:39], v22 offset:26624
    s_waitcnt lgkmcnt(10)
    v_mfma_f32_32x32x16_bf16 v[72:87], v[44:47], v[208:211], v[72:87]
    ds_read_b64_tr_b16 v[40:41], v23 offset:24576
    ds_read_b64_tr_b16 v[42:43], v23 offset:26624
    s_waitcnt vmcnt(19)
    s_waitcnt lgkmcnt(10)
    v_mfma_f32_32x32x16_bf16 v[56:71], v[48:51], v[212:215], v[56:71]
    ds_read_b64_tr_b16 v[44:45], v24 offset:25600
    ds_read_b64_tr_b16 v[46:47], v24 offset:27648
    s_waitcnt lgkmcnt(10)
    v_mfma_f32_32x32x16_bf16 v[72:87], v[52:55], v[212:215], v[72:87]
    buffer_load_dwordx4 v[196:199], v249, s[32:35], s16 offen offset:3072 sc1
    ds_read_b64_tr_b16 v[48:49], v25 offset:25600
    ds_read_b64_tr_b16 v[50:51], v25 offset:27648
    s_barrier
    s_waitcnt lgkmcnt(10)
    v_mfma_f32_32x32x16_bf16 v[120:135], v[28:31], v[200:203], v[120:135]
    s_add_u32 s16, s16, 16384
    ds_read_b64_tr_b16 v[52:53], v22 offset:25600
    ds_read_b64_tr_b16 v[54:55], v22 offset:27648
    s_waitcnt lgkmcnt(10)
    v_mfma_f32_32x32x16_bf16 v[136:151], v[32:35], v[200:203], v[136:151]
    s_and_b32 s16, s16, 0x3ffff
    ds_read_b64_tr_b16 v[28:29], v23 offset:25600
    ds_read_b64_tr_b16 v[30:31], v23 offset:27648
    s_waitcnt lgkmcnt(10)
    v_mfma_f32_32x32x16_bf16 v[88:103], v[36:39], v[200:203], v[88:103]
    ds_read_b64_tr_b16 v[32:33], v24 offset:28672
    ds_read_b64_tr_b16 v[34:35], v24 offset:30720
    s_waitcnt lgkmcnt(10)
    v_mfma_f32_32x32x16_bf16 v[104:119], v[40:43], v[200:203], v[104:119]
    buffer_load_dwordx4 v[200:203], v249, s[32:35], s16 offen sc1
    ds_read_b64_tr_b16 v[36:37], v25 offset:28672
    ds_read_b64_tr_b16 v[38:39], v25 offset:30720
    s_waitcnt lgkmcnt(10)
    v_mfma_f32_32x32x16_bf16 v[120:135], v[44:47], v[204:207], v[120:135]
    ds_read_b64_tr_b16 v[40:41], v22 offset:28672
    ds_read_b64_tr_b16 v[42:43], v22 offset:30720
    s_waitcnt lgkmcnt(10)
    v_mfma_f32_32x32x16_bf16 v[136:151], v[48:51], v[204:207], v[136:151]
    ds_read_b64_tr_b16 v[44:45], v23 offset:28672
    ds_read_b64_tr_b16 v[46:47], v23 offset:30720
    s_waitcnt lgkmcnt(10)
    v_mfma_f32_32x32x16_bf16 v[88:103], v[52:55], v[204:207], v[88:103]
    ds_read_b64_tr_b16 v[48:49], v24 offset:29696
    ds_read_b64_tr_b16 v[50:51], v24 offset:31744
    s_waitcnt lgkmcnt(10)
    v_mfma_f32_32x32x16_bf16 v[104:119], v[28:31], v[204:207], v[104:119]
    buffer_load_dwordx4 v[204:207], v249, s[32:35], s16 offen offset:1024 sc1
    ds_read_b64_tr_b16 v[52:53], v25 offset:29696
    ds_read_b64_tr_b16 v[54:55], v25 offset:31744
    s_waitcnt lgkmcnt(10)
    v_mfma_f32_32x32x16_bf16 v[120:135], v[32:35], v[208:211], v[120:135]
    ds_read_b64_tr_b16 v[28:29], v22 offset:29696
    ds_read_b64_tr_b16 v[30:31], v22 offset:31744
    s_waitcnt lgkmcnt(10)
    v_mfma_f32_32x32x16_bf16 v[136:151], v[36:39], v[208:211], v[136:151]
    ds_read_b64_tr_b16 v[32:33], v23 offset:29696
    ds_read_b64_tr_b16 v[34:35], v23 offset:31744
    s_waitcnt lgkmcnt(10)
    v_mfma_f32_32x32x16_bf16 v[88:103], v[40:43], v[208:211], v[88:103]
    ds_read_b64_tr_b16 v[36:37], v20 offset:32768
    ds_read_b64_tr_b16 v[38:39], v20 offset:34816
    s_waitcnt lgkmcnt(10)
    v_mfma_f32_32x32x16_bf16 v[104:119], v[44:47], v[208:211], v[104:119]
    buffer_load_dwordx4 v[208:211], v249, s[32:35], s16 offen offset:2048 sc1
    ds_read_b64_tr_b16 v[40:41], v20 offset:33792
    ds_read_b64_tr_b16 v[42:43], v20 offset:35840
    s_waitcnt lgkmcnt(10)
    v_mfma_f32_32x32x16_bf16 v[120:135], v[48:51], v[212:215], v[120:135]
    ds_read_b64_tr_b16 v[44:45], v20 offset:36864
    ds_read_b64_tr_b16 v[46:47], v20 offset:38912
    s_waitcnt lgkmcnt(10)
    v_mfma_f32_32x32x16_bf16 v[136:151], v[52:55], v[212:215], v[136:151]
    ds_read_b64_tr_b16 v[48:49], v20 offset:37888
    ds_read_b64_tr_b16 v[50:51], v20 offset:39936
    s_waitcnt lgkmcnt(10)
    v_mfma_f32_32x32x16_bf16 v[88:103], v[28:31], v[212:215], v[88:103]
    ds_read_b64_tr_b16 v[52:53], v20 offset:40960
    ds_read_b64_tr_b16 v[54:55], v20 offset:43008
    s_waitcnt lgkmcnt(10)
    v_mfma_f32_32x32x16_bf16 v[104:119], v[32:35], v[212:215], v[104:119]
    buffer_load_dwordx4 v[212:215], v249, s[32:35], s16 offen offset:3072 sc1
    ds_read_b64_tr_b16 v[28:29], v20 offset:41984
    ds_read_b64_tr_b16 v[30:31], v20 offset:44032
    s_barrier
    s_waitcnt vmcnt(23)
    s_waitcnt lgkmcnt(10)
    v_mfma_f32_32x32x16_bf16 v[56:71], v[36:39], v[216:219], v[56:71]
    s_add_u32 s16, s16, 16384
    ds_read_b64_tr_b16 v[32:33], v20 offset:45056
    ds_read_b64_tr_b16 v[34:35], v20 offset:47104
    s_waitcnt vmcnt(22)
    s_waitcnt lgkmcnt(10)
    v_mfma_f32_32x32x16_bf16 v[56:71], v[40:43], v[220:223], v[56:71]
    s_and_b32 s16, s16, 0x3ffff
    ds_read_b64_tr_b16 v[36:37], v20 offset:46080
    ds_read_b64_tr_b16 v[38:39], v20 offset:48128
    s_waitcnt vmcnt(21)
    s_waitcnt lgkmcnt(10)
    v_mfma_f32_32x32x16_bf16 v[56:71], v[44:47], v[224:227], v[56:71]
    ds_read_b64_tr_b16 v[40:41], v20
    ds_read_b64_tr_b16 v[42:43], v20 offset:2048
    s_waitcnt vmcnt(20)
    s_waitcnt lgkmcnt(10)
    v_mfma_f32_32x32x16_bf16 v[56:71], v[48:51], v[228:231], v[56:71]
    ds_read_b64_tr_b16 v[44:45], v20 offset:1024
    ds_read_b64_tr_b16 v[46:47], v20 offset:3072
    s_waitcnt vmcnt(19)
    s_waitcnt lgkmcnt(10)
    v_mfma_f32_32x32x16_bf16 v[56:71], v[52:55], v[232:235], v[56:71]
    ds_read_b64_tr_b16 v[48:49], v20 offset:4096
    ds_read_b64_tr_b16 v[50:51], v20 offset:6144
    s_waitcnt vmcnt(18)
    s_waitcnt lgkmcnt(10)
    v_mfma_f32_32x32x16_bf16 v[56:71], v[28:31], v[236:239], v[56:71]
    ds_read_b64_tr_b16 v[52:53], v20 offset:5120
    ds_read_b64_tr_b16 v[54:55], v20 offset:7168
    s_waitcnt vmcnt(17)
    s_waitcnt lgkmcnt(10)
    v_mfma_f32_32x32x16_bf16 v[56:71], v[32:35], v[240:243], v[56:71]
    ds_read_b64_tr_b16 v[28:29], v20 offset:8192
    ds_read_b64_tr_b16 v[30:31], v20 offset:10240
    s_waitcnt vmcnt(16)
    s_waitcnt lgkmcnt(10)
    v_mfma_f32_32x32x16_bf16 v[56:71], v[36:39], v[244:247], v[56:71]
    ds_read_b64_tr_b16 v[32:33], v20 offset:9216
    ds_read_b64_tr_b16 v[34:35], v20 offset:11264
    s_waitcnt vmcnt(15)
    s_waitcnt lgkmcnt(10)
    v_mfma_f32_32x32x16_bf16 v[56:71], v[40:43], v[152:155], v[56:71]
    ds_read_b64_tr_b16 v[36:37], v20 offset:12288
    ds_read_b64_tr_b16 v[38:39], v20 offset:14336
    s_waitcnt vmcnt(14)
    s_waitcnt lgkmcnt(10)
    v_mfma_f32_32x32x16_bf16 v[56:71], v[44:47], v[156:159], v[56:71]
    ds_read_b64_tr_b16 v[40:41], v20 offset:13312
    ds_read_b64_tr_b16 v[42:43], v20 offset:15360
    s_waitcnt vmcnt(13)
    s_waitcnt lgkmcnt(10)
    v_mfma_f32_32x32x16_bf16 v[56:71], v[48:51], v[160:163], v[56:71]
    ds_read_b64_tr_b16 v[44:45], v20 offset:16384
    ds_read_b64_tr_b16 v[46:47], v20 offset:18432
    s_waitcnt vmcnt(12)
    s_waitcnt lgkmcnt(10)
    v_mfma_f32_32x32x16_bf16 v[56:71], v[52:55], v[164:167], v[56:71]
    ds_read_b64_tr_b16 v[48:49], v20 offset:17408
    ds_read_b64_tr_b16 v[50:51], v20 offset:19456
    s_waitcnt vmcnt(11)
    s_waitcnt lgkmcnt(10)
    v_mfma_f32_32x32x16_bf16 v[56:71], v[28:31], v[168:171], v[56:71]
    ds_read_b64_tr_b16 v[52:53], v20 offset:20480
    ds_read_b64_tr_b16 v[54:55], v20 offset:22528
    s_waitcnt vmcnt(10)
    s_waitcnt lgkmcnt(10)
    v_mfma_f32_32x32x16_bf16 v[56:71], v[32:35], v[172:175], v[56:71]
    ds_read_b64_tr_b16 v[28:29], v20 offset:21504
    ds_read_b64_tr_b16 v[30:31], v20 offset:23552
    s_barrier
    s_waitcnt vmcnt(9)
    s_waitcnt lgkmcnt(10)
    v_mfma_f32_32x32x16_bf16 v[56:71], v[36:39], v[176:179], v[56:71]
    ds_read_b64_tr_b16 v[32:33], v20 offset:24576
    ds_read_b64_tr_b16 v[34:35], v20 offset:26624
    s_waitcnt vmcnt(8)
    s_waitcnt lgkmcnt(10)
    v_mfma_f32_32x32x16_bf16 v[56:71], v[40:43], v[180:183], v[56:71]
    ds_read_b64_tr_b16 v[36:37], v20 offset:25600
    ds_read_b64_tr_b16 v[38:39], v20 offset:27648
    s_waitcnt vmcnt(7)
    s_waitcnt lgkmcnt(10)
    v_mfma_f32_32x32x16_bf16 v[56:71], v[44:47], v[184:187], v[56:71]
    ds_read_b64_tr_b16 v[40:41], v20 offset:28672
    ds_read_b64_tr_b16 v[42:43], v20 offset:30720
    s_waitcnt vmcnt(6)
    s_waitcnt lgkmcnt(10)
    v_mfma_f32_32x32x16_bf16 v[56:71], v[48:51], v[188:191], v[56:71]
    ds_read_b64_tr_b16 v[44:45], v20 offset:29696
    ds_read_b64_tr_b16 v[46:47], v20 offset:31744
    s_waitcnt vmcnt(5)
    s_waitcnt lgkmcnt(10)
    v_mfma_f32_32x32x16_bf16 v[56:71], v[52:55], v[192:195], v[56:71]
    ds_read_b64_tr_b16 v[48:49], v21 offset:32768
    ds_read_b64_tr_b16 v[50:51], v21 offset:34816
    s_waitcnt vmcnt(4)
    s_waitcnt lgkmcnt(10)
    v_mfma_f32_32x32x16_bf16 v[56:71], v[28:31], v[196:199], v[56:71]
    ds_read_b64_tr_b16 v[52:53], v21 offset:33792
    ds_read_b64_tr_b16 v[54:55], v21 offset:35840
    s_waitcnt vmcnt(3)
    s_waitcnt lgkmcnt(10)
    v_mfma_f32_32x32x16_bf16 v[56:71], v[32:35], v[200:203], v[56:71]
    ds_read_b64_tr_b16 v[28:29], v21 offset:36864
    ds_read_b64_tr_b16 v[30:31], v21 offset:38912
    s_waitcnt vmcnt(2)
    s_waitcnt lgkmcnt(10)
    v_mfma_f32_32x32x16_bf16 v[56:71], v[36:39], v[204:207], v[56:71]
    ds_read_b64_tr_b16 v[32:33], v21 offset:37888
    ds_read_b64_tr_b16 v[34:35], v21 offset:39936
    s_waitcnt vmcnt(1)
    s_waitcnt lgkmcnt(10)
    v_mfma_f32_32x32x16_bf16 v[56:71], v[40:43], v[208:211], v[56:71]
    ds_read_b64_tr_b16 v[36:37], v21 offset:40960
    ds_read_b64_tr_b16 v[38:39], v21 offset:43008
    s_waitcnt vmcnt(0)
    s_waitcnt lgkmcnt(10)
    v_mfma_f32_32x32x16_bf16 v[56:71], v[44:47], v[212:215], v[56:71]
    ds_read_b64_tr_b16 v[40:41], v21 offset:41984
    ds_read_b64_tr_b16 v[42:43], v21 offset:44032
    s_waitcnt lgkmcnt(10)
    v_mfma_f32_32x32x16_bf16 v[72:87], v[48:51], v[216:219], v[72:87]
    ds_read_b64_tr_b16 v[44:45], v21 offset:45056
    ds_read_b64_tr_b16 v[46:47], v21 offset:47104
    s_waitcnt lgkmcnt(10)
    v_mfma_f32_32x32x16_bf16 v[72:87], v[52:55], v[220:223], v[72:87]
    s_nop 3
    v_cvt_pk_bf16_f32 v56, v56, v57
    v_cvt_pk_bf16_f32 v57, v58, v59
    ds_read_b64_tr_b16 v[48:49], v21 offset:46080
    ds_read_b64_tr_b16 v[50:51], v21 offset:48128
    s_waitcnt lgkmcnt(10)
    v_mfma_f32_32x32x16_bf16 v[72:87], v[28:31], v[224:227], v[72:87]
    v_cvt_pk_bf16_f32 v58, v60, v61
    v_cvt_pk_bf16_f32 v59, v62, v63
    ds_read_b64_tr_b16 v[52:53], v21
    ds_read_b64_tr_b16 v[54:55], v21 offset:2048
    s_waitcnt lgkmcnt(10)
    v_mfma_f32_32x32x16_bf16 v[72:87], v[32:35], v[228:231], v[72:87]
    ds_write_b128 v0, v[56:59]
    v_cvt_pk_bf16_f32 v60, v64, v65
    ds_read_b64_tr_b16 v[28:29], v21 offset:1024
    ds_read_b64_tr_b16 v[30:31], v21 offset:3072
    s_waitcnt lgkmcnt(11)
    v_mfma_f32_32x32x16_bf16 v[72:87], v[36:39], v[232:235], v[72:87]
    v_cvt_pk_bf16_f32 v61, v66, v67
    v_cvt_pk_bf16_f32 v62, v68, v69
    ds_read_b64_tr_b16 v[32:33], v21 offset:4096
    ds_read_b64_tr_b16 v[34:35], v21 offset:6144
    s_waitcnt lgkmcnt(11)
    v_mfma_f32_32x32x16_bf16 v[72:87], v[40:43], v[236:239], v[72:87]
    v_cvt_pk_bf16_f32 v63, v70, v71
    ds_write_b128 v0, v[60:63] offset:1024
    ds_read_b64_tr_b16 v[36:37], v21 offset:5120
    ds_read_b64_tr_b16 v[38:39], v21 offset:7168
    s_waitcnt lgkmcnt(12)
    v_mfma_f32_32x32x16_bf16 v[72:87], v[44:47], v[240:243], v[72:87]
    v_subrev_u32 v0, 118784, v0
    ds_read_b64_tr_b16 v[40:41], v21 offset:8192
    ds_read_b64_tr_b16 v[42:43], v21 offset:10240
    s_waitcnt lgkmcnt(12)
    v_mfma_f32_32x32x16_bf16 v[72:87], v[48:51], v[244:247], v[72:87]
    ds_read_b64_tr_b16 v[44:45], v21 offset:9216
    ds_read_b64_tr_b16 v[46:47], v21 offset:11264
    s_waitcnt lgkmcnt(6)
    s_barrier
    v_mfma_f32_32x32x16_bf16 v[72:87], v[52:55], v[152:155], v[72:87]
    ds_read_b64_tr_b16 v[48:49], v21 offset:12288
    ds_read_b64_tr_b16 v[50:51], v21 offset:14336
    v_mfma_f32_32x32x16_bf16 v[72:87], v[28:31], v[156:159], v[72:87]
    ds_read_b64_tr_b16 v[52:53], v21 offset:13312
    ds_read_b64_tr_b16 v[54:55], v21 offset:15360
    v_mfma_f32_32x32x16_bf16 v[72:87], v[32:35], v[160:163], v[72:87]
    ds_read_b64_tr_b16 v[28:29], v21 offset:16384
    ds_read_b64_tr_b16 v[30:31], v21 offset:18432
    s_waitcnt lgkmcnt(10)
    v_mfma_f32_32x32x16_bf16 v[72:87], v[36:39], v[164:167], v[72:87]
    ds_read_b64_tr_b16 v[32:33], v21 offset:17408
    ds_read_b64_tr_b16 v[34:35], v21 offset:19456
    s_waitcnt lgkmcnt(10)
    v_mfma_f32_32x32x16_bf16 v[72:87], v[40:43], v[168:171], v[72:87]
    ds_read_b64_tr_b16 v[36:37], v21 offset:20480
    ds_read_b64_tr_b16 v[38:39], v21 offset:22528
    s_waitcnt lgkmcnt(10)
    v_mfma_f32_32x32x16_bf16 v[72:87], v[44:47], v[172:175], v[72:87]
    ds_read_b64_tr_b16 v[40:41], v21 offset:21504
    ds_read_b64_tr_b16 v[42:43], v21 offset:23552
    s_waitcnt lgkmcnt(10)
    v_mfma_f32_32x32x16_bf16 v[72:87], v[48:51], v[176:179], v[72:87]
    ds_read_b64_tr_b16 v[44:45], v21 offset:24576
    ds_read_b64_tr_b16 v[46:47], v21 offset:26624
    s_waitcnt lgkmcnt(10)
    v_mfma_f32_32x32x16_bf16 v[72:87], v[52:55], v[180:183], v[72:87]
    ds_read_b64_tr_b16 v[48:49], v21 offset:25600
    ds_read_b64_tr_b16 v[50:51], v21 offset:27648
    s_waitcnt lgkmcnt(10)
    v_mfma_f32_32x32x16_bf16 v[72:87], v[28:31], v[184:187], v[72:87]
    ds_read_b64_tr_b16 v[52:53], v21 offset:28672
    ds_read_b64_tr_b16 v[54:55], v21 offset:30720
    s_waitcnt lgkmcnt(10)
    v_mfma_f32_32x32x16_bf16 v[72:87], v[32:35], v[188:191], v[72:87]
    ds_read_b64_tr_b16 v[28:29], v21 offset:29696
    ds_read_b64_tr_b16 v[30:31], v21 offset:31744
    s_waitcnt lgkmcnt(10)
    v_mfma_f32_32x32x16_bf16 v[72:87], v[36:39], v[192:195], v[72:87]
    ds_read_b64_tr_b16 v[32:33], v22 offset:32768
    ds_read_b64_tr_b16 v[34:35], v22 offset:34816
    s_waitcnt lgkmcnt(10)
    v_mfma_f32_32x32x16_bf16 v[72:87], v[40:43], v[196:199], v[72:87]
    ds_read_b64_tr_b16 v[36:37], v23 offset:32768
    ds_read_b64_tr_b16 v[38:39], v23 offset:34816
    s_waitcnt lgkmcnt(10)
    v_mfma_f32_32x32x16_bf16 v[72:87], v[44:47], v[200:203], v[72:87]
    ds_read_b64_tr_b16 v[40:41], v22 offset:33792
    ds_read_b64_tr_b16 v[42:43], v22 offset:35840
    s_waitcnt lgkmcnt(10)
    v_mfma_f32_32x32x16_bf16 v[72:87], v[48:51], v[204:207], v[72:87]
    ds_read_b64_tr_b16 v[44:45], v23 offset:33792
    ds_read_b64_tr_b16 v[46:47], v23 offset:35840
    s_waitcnt lgkmcnt(10)
    v_mfma_f32_32x32x16_bf16 v[72:87], v[52:55], v[208:211], v[72:87]
    ds_read_b64_tr_b16 v[48:49], v22 offset:36864
    ds_read_b64_tr_b16 v[50:51], v22 offset:38912
    s_waitcnt lgkmcnt(10)
    v_mfma_f32_32x32x16_bf16 v[72:87], v[28:31], v[212:215], v[72:87]
    ds_read_b64_tr_b16 v[52:53], v23 offset:36864
    ds_read_b64_tr_b16 v[54:55], v23 offset:38912
    s_waitcnt lgkmcnt(10)
    v_mfma_f32_32x32x16_bf16 v[88:103], v[32:35], v[216:219], v[88:103]
    ds_read_b64_tr_b16 v[28:29], v22 offset:37888
    ds_read_b64_tr_b16 v[30:31], v22 offset:39936
    s_waitcnt lgkmcnt(10)
    v_mfma_f32_32x32x16_bf16 v[104:119], v[36:39], v[216:219], v[104:119]
    s_nop 3
    v_cvt_pk_bf16_f32 v72, v72, v73
    v_cvt_pk_bf16_f32 v73, v74, v75
    ds_read_b64_tr_b16 v[32:33], v23 offset:37888
    ds_read_b64_tr_b16 v[34:35], v23 offset:39936
    s_waitcnt lgkmcnt(10)
    v_mfma_f32_32x32x16_bf16 v[88:103], v[40:43], v[220:223], v[88:103]
    v_cvt_pk_bf16_f32 v74, v76, v77
    v_cvt_pk_bf16_f32 v75, v78, v79
    ds_read_b64_tr_b16 v[36:37], v22 offset:40960
    ds_read_b64_tr_b16 v[38:39], v22 offset:43008
    s_waitcnt lgkmcnt(10)
    v_mfma_f32_32x32x16_bf16 v[104:119], v[44:47], v[220:223], v[104:119]
    ds_write_b128 v0, v[72:75]
    v_cvt_pk_bf16_f32 v76, v80, v81
    ds_read_b64_tr_b16 v[40:41], v23 offset:40960
    ds_read_b64_tr_b16 v[42:43], v23 offset:43008
    s_waitcnt lgkmcnt(11)
    v_mfma_f32_32x32x16_bf16 v[88:103], v[48:51], v[224:227], v[88:103]
    v_cvt_pk_bf16_f32 v77, v82, v83
    v_cvt_pk_bf16_f32 v78, v84, v85
    ds_read_b64_tr_b16 v[44:45], v22 offset:41984
    ds_read_b64_tr_b16 v[46:47], v22 offset:44032
    s_waitcnt lgkmcnt(11)
    v_mfma_f32_32x32x16_bf16 v[104:119], v[52:55], v[224:227], v[104:119]
    v_cvt_pk_bf16_f32 v79, v86, v87
    ds_write_b128 v0, v[76:79] offset:1024
    ds_read_b64_tr_b16 v[48:49], v23 offset:41984
    ds_read_b64_tr_b16 v[50:51], v23 offset:44032
    s_waitcnt lgkmcnt(12)
    v_mfma_f32_32x32x16_bf16 v[88:103], v[28:31], v[228:231], v[88:103]
    ds_read_b64_tr_b16 v[52:53], v22 offset:45056
    ds_read_b64_tr_b16 v[54:55], v22 offset:47104
    s_waitcnt lgkmcnt(12)
    v_mfma_f32_32x32x16_bf16 v[104:119], v[32:35], v[228:231], v[104:119]
    ds_read_b64_tr_b16 v[28:29], v23 offset:45056
    ds_read_b64_tr_b16 v[30:31], v23 offset:47104
    s_waitcnt lgkmcnt(6)
    s_barrier
    v_mfma_f32_32x32x16_bf16 v[88:103], v[36:39], v[232:235], v[88:103]
    s_lshl_b32 s96, s77, 11
    s_add_u32 s14, s96, 32768
    v_and_b32 v0, 7, v1
    ds_read_b64_tr_b16 v[32:33], v22 offset:46080
    ds_read_b64_tr_b16 v[34:35], v22 offset:48128
    v_mfma_f32_32x32x16_bf16 v[104:119], v[40:43], v[232:235], v[104:119]
    v_lshl_add_u32 v0, v0, 4, s14
    ds_read_b64_tr_b16 v[36:37], v23 offset:46080
    ds_read_b64_tr_b16 v[38:39], v23 offset:48128
    v_mfma_f32_32x32x16_bf16 v[88:103], v[44:47], v[236:239], v[88:103]
    v_bfe_u32 v4, v1, 3, 2
    ds_read_b64_tr_b16 v[40:41], v22
    ds_read_b64_tr_b16 v[42:43], v22 offset:2048
    s_waitcnt lgkmcnt(10)
    v_mfma_f32_32x32x16_bf16 v[104:119], v[48:51], v[236:239], v[104:119]
    v_lshl_add_u32 v0, v4, 8, v0
    v_lshrrev_b32 v4, 5, v1
    ds_read_b64_tr_b16 v[44:45], v23
    ds_read_b64_tr_b16 v[46:47], v23 offset:2048
    s_waitcnt lgkmcnt(10)
    v_mfma_f32_32x32x16_bf16 v[88:103], v[52:55], v[240:243], v[88:103]
    v_lshl_add_u32 v0, v4, 7, v0
    ds_read_b64_tr_b16 v[48:49], v22 offset:1024
    ds_read_b64_tr_b16 v[50:51], v22 offset:3072
    s_waitcnt lgkmcnt(10)
    v_mfma_f32_32x32x16_bf16 v[104:119], v[28:31], v[240:243], v[104:119]
    ds_read_b64_tr_b16 v[52:53], v23 offset:1024
    ds_read_b64_tr_b16 v[54:55], v23 offset:3072
    s_waitcnt lgkmcnt(10)
    v_mfma_f32_32x32x16_bf16 v[88:103], v[32:35], v[244:247], v[88:103]
    ds_read_b64_tr_b16 v[28:29], v22 offset:4096
    ds_read_b64_tr_b16 v[30:31], v22 offset:6144
    s_waitcnt lgkmcnt(10)
    v_mfma_f32_32x32x16_bf16 v[104:119], v[36:39], v[244:247], v[104:119]
    ds_read_b64_tr_b16 v[32:33], v23 offset:4096
    ds_read_b64_tr_b16 v[34:35], v23 offset:6144
    s_waitcnt lgkmcnt(10)
    v_mfma_f32_32x32x16_bf16 v[88:103], v[40:43], v[152:155], v[88:103]
    ds_read_b64_tr_b16 v[36:37], v22 offset:5120
    ds_read_b64_tr_b16 v[38:39], v22 offset:7168
    s_waitcnt lgkmcnt(10)
    v_mfma_f32_32x32x16_bf16 v[104:119], v[44:47], v[152:155], v[104:119]
    ds_read_b64_tr_b16 v[40:41], v23 offset:5120
    ds_read_b64_tr_b16 v[42:43], v23 offset:7168
    s_waitcnt lgkmcnt(10)
    v_mfma_f32_32x32x16_bf16 v[88:103], v[48:51], v[156:159], v[88:103]
    ds_read_b64_tr_b16 v[44:45], v22 offset:8192
    ds_read_b64_tr_b16 v[46:47], v22 offset:10240
    s_waitcnt lgkmcnt(10)
    v_mfma_f32_32x32x16_bf16 v[104:119], v[52:55], v[156:159], v[104:119]
    ds_read_b64_tr_b16 v[48:49], v23 offset:8192
    ds_read_b64_tr_b16 v[50:51], v23 offset:10240
    s_waitcnt lgkmcnt(10)
    v_mfma_f32_32x32x16_bf16 v[88:103], v[28:31], v[160:163], v[88:103]
    ds_read_b64_tr_b16 v[52:53], v22 offset:9216
    ds_read_b64_tr_b16 v[54:55], v22 offset:11264
    s_waitcnt lgkmcnt(10)
    v_mfma_f32_32x32x16_bf16 v[104:119], v[32:35], v[160:163], v[104:119]
    ds_read_b64_tr_b16 v[28:29], v23 offset:9216
    ds_read_b64_tr_b16 v[30:31], v23 offset:11264
    s_waitcnt lgkmcnt(10)
    v_mfma_f32_32x32x16_bf16 v[88:103], v[36:39], v[164:167], v[88:103]
    ds_read_b64_tr_b16 v[32:33], v22 offset:12288
    ds_read_b64_tr_b16 v[34:35], v22 offset:14336
    s_waitcnt lgkmcnt(10)
    v_mfma_f32_32x32x16_bf16 v[104:119], v[40:43], v[164:167], v[104:119]
    ds_read_b64_tr_b16 v[36:37], v23 offset:12288
    ds_read_b64_tr_b16 v[38:39], v23 offset:14336
    s_waitcnt lgkmcnt(10)
    v_mfma_f32_32x32x16_bf16 v[88:103], v[44:47], v[168:171], v[88:103]
    ds_read_b64_tr_b16 v[40:41], v22 offset:13312
    ds_read_b64_tr_b16 v[42:43], v22 offset:15360
    s_waitcnt lgkmcnt(10)
    v_mfma_f32_32x32x16_bf16 v[104:119], v[48:51], v[168:171], v[104:119]
    ds_read_b64_tr_b16 v[44:45], v23 offset:13312
    ds_read_b64_tr_b16 v[46:47], v23 offset:15360
    s_waitcnt lgkmcnt(10)
    v_mfma_f32_32x32x16_bf16 v[88:103], v[52:55], v[172:175], v[88:103]
    ds_read_b64_tr_b16 v[48:49], v22 offset:16384
    ds_read_b64_tr_b16 v[50:51], v22 offset:18432
    s_waitcnt lgkmcnt(10)
    v_mfma_f32_32x32x16_bf16 v[104:119], v[28:31], v[172:175], v[104:119]
    ds_read_b64_tr_b16 v[52:53], v23 offset:16384
    ds_read_b64_tr_b16 v[54:55], v23 offset:18432
    s_waitcnt lgkmcnt(10)
    v_mfma_f32_32x32x16_bf16 v[88:103], v[32:35], v[176:179], v[88:103]
    ds_read_b64_tr_b16 v[28:29], v22 offset:17408
    ds_read_b64_tr_b16 v[30:31], v22 offset:19456
    s_waitcnt lgkmcnt(10)
    v_mfma_f32_32x32x16_bf16 v[104:119], v[36:39], v[176:179], v[104:119]
    ds_read_b64_tr_b16 v[32:33], v23 offset:17408
    ds_read_b64_tr_b16 v[34:35], v23 offset:19456
    s_waitcnt lgkmcnt(10)
    v_mfma_f32_32x32x16_bf16 v[88:103], v[40:43], v[180:183], v[88:103]
    ds_read_b64_tr_b16 v[36:37], v22 offset:20480
    ds_read_b64_tr_b16 v[38:39], v22 offset:22528
    s_waitcnt lgkmcnt(10)
    v_mfma_f32_32x32x16_bf16 v[104:119], v[44:47], v[180:183], v[104:119]
    ds_read_b64_tr_b16 v[40:41], v23 offset:20480
    ds_read_b64_tr_b16 v[42:43], v23 offset:22528
    s_waitcnt lgkmcnt(10)
    v_mfma_f32_32x32x16_bf16 v[88:103], v[48:51], v[184:187], v[88:103]
    ds_read_b64_tr_b16 v[44:45], v22 offset:21504
    ds_read_b64_tr_b16 v[46:47], v22 offset:23552
    s_waitcnt lgkmcnt(10)
    v_mfma_f32_32x32x16_bf16 v[104:119], v[52:55], v[184:187], v[104:119]
    ds_read_b64_tr_b16 v[48:49], v23 offset:21504
    ds_read_b64_tr_b16 v[50:51], v23 offset:23552
    s_waitcnt lgkmcnt(10)
    v_mfma_f32_32x32x16_bf16 v[88:103], v[28:31], v[188:191], v[88:103]
    ds_read_b64_tr_b16 v[52:53], v22 offset:24576
    ds_read_b64_tr_b16 v[54:55], v22 offset:26624
    s_waitcnt lgkmcnt(10)
    v_mfma_f32_32x32x16_bf16 v[104:119], v[32:35], v[188:191], v[104:119]
    ds_read_b64_tr_b16 v[28:29], v23 offset:24576
    ds_read_b64_tr_b16 v[30:31], v23 offset:26624
    s_waitcnt lgkmcnt(10)
    v_mfma_f32_32x32x16_bf16 v[88:103], v[36:39], v[192:195], v[88:103]
    ds_read_b64_tr_b16 v[32:33], v22 offset:25600
    ds_read_b64_tr_b16 v[34:35], v22 offset:27648
    s_waitcnt lgkmcnt(10)
    v_mfma_f32_32x32x16_bf16 v[104:119], v[40:43], v[192:195], v[104:119]
    ds_read_b64_tr_b16 v[36:37], v23 offset:25600
    ds_read_b64_tr_b16 v[38:39], v23 offset:27648
    s_waitcnt lgkmcnt(10)
    v_mfma_f32_32x32x16_bf16 v[88:103], v[44:47], v[196:199], v[88:103]
    ds_read_b64_tr_b16 v[40:41], v22 offset:28672
    ds_read_b64_tr_b16 v[42:43], v22 offset:30720
    s_waitcnt lgkmcnt(10)
    v_mfma_f32_32x32x16_bf16 v[104:119], v[48:51], v[196:199], v[104:119]
    ds_read_b64_tr_b16 v[44:45], v23 offset:28672
    ds_read_b64_tr_b16 v[46:47], v23 offset:30720
    s_waitcnt lgkmcnt(10)
    v_mfma_f32_32x32x16_bf16 v[88:103], v[52:55], v[200:203], v[88:103]
    ds_read_b64_tr_b16 v[48:49], v22 offset:29696
    ds_read_b64_tr_b16 v[50:51], v22 offset:31744
    s_waitcnt lgkmcnt(10)
    v_mfma_f32_32x32x16_bf16 v[104:119], v[28:31], v[200:203], v[104:119]
    ds_read_b64_tr_b16 v[52:53], v23 offset:29696
    ds_read_b64_tr_b16 v[54:55], v23 offset:31744
    s_waitcnt lgkmcnt(10)
    v_mfma_f32_32x32x16_bf16 v[88:103], v[32:35], v[204:207], v[88:103]
    ds_read_b64_tr_b16 v[28:29], v24 offset:32768
    ds_read_b64_tr_b16 v[30:31], v24 offset:34816
    s_waitcnt lgkmcnt(10)
    v_mfma_f32_32x32x16_bf16 v[104:119], v[36:39], v[204:207], v[104:119]
    ds_read_b64_tr_b16 v[32:33], v25 offset:32768
    ds_read_b64_tr_b16 v[34:35], v25 offset:34816
    s_waitcnt lgkmcnt(10)
    v_mfma_f32_32x32x16_bf16 v[88:103], v[40:43], v[208:211], v[88:103]
    ds_read_b64_tr_b16 v[36:37], v24 offset:33792
    ds_read_b64_tr_b16 v[38:39], v24 offset:35840
    s_waitcnt lgkmcnt(10)
    v_mfma_f32_32x32x16_bf16 v[104:119], v[44:47], v[208:211], v[104:119]
    ds_read_b64_tr_b16 v[40:41], v25 offset:33792
    ds_read_b64_tr_b16 v[42:43], v25 offset:35840
    s_waitcnt lgkmcnt(10)
    v_mfma_f32_32x32x16_bf16 v[88:103], v[48:51], v[212:215], v[88:103]
    ds_read_b64_tr_b16 v[44:45], v24 offset:36864
    ds_read_b64_tr_b16 v[46:47], v24 offset:38912
    s_waitcnt lgkmcnt(10)
    v_mfma_f32_32x32x16_bf16 v[104:119], v[52:55], v[212:215], v[104:119]
    ds_read_b64_tr_b16 v[48:49], v25 offset:36864
    ds_read_b64_tr_b16 v[50:51], v25 offset:38912
    s_barrier
    s_waitcnt lgkmcnt(10)
    v_mfma_f32_32x32x16_bf16 v[120:135], v[28:31], v[216:219], v[120:135]
    ds_read_b64_tr_b16 v[52:53], v24 offset:37888
    ds_read_b64_tr_b16 v[54:55], v24 offset:39936
    s_waitcnt lgkmcnt(10)
    v_mfma_f32_32x32x16_bf16 v[136:151], v[32:35], v[216:219], v[136:151]
    ds_read_b64_tr_b16 v[28:29], v25 offset:37888
    ds_read_b64_tr_b16 v[30:31], v25 offset:39936
    s_waitcnt lgkmcnt(10)
    v_mfma_f32_32x32x16_bf16 v[120:135], v[36:39], v[220:223], v[120:135]
    v_cvt_pk_bf16_f32 v88, v88, v89
    ds_read_b64_tr_b16 v[32:33], v24 offset:40960
    ds_read_b64_tr_b16 v[34:35], v24 offset:43008
    s_waitcnt lgkmcnt(10)
    v_mfma_f32_32x32x16_bf16 v[136:151], v[40:43], v[220:223], v[136:151]
    v_cvt_pk_bf16_f32 v89, v90, v91
    ds_read_b64_tr_b16 v[36:37], v25 offset:40960
    ds_read_b64_tr_b16 v[38:39], v25 offset:43008
    s_waitcnt lgkmcnt(10)
    v_mfma_f32_32x32x16_bf16 v[120:135], v[44:47], v[224:227], v[120:135]
L_PAD4:
    s_cbranch_execz L_RET4
    v_cvt_pk_bf16_f32 v90, v92, v93
    ds_read_b64_tr_b16 v[40:41], v24 offset:41984
    ds_read_b64_tr_b16 v[42:43], v24 offset:44032
    s_waitcnt lgkmcnt(10)
    v_mfma_f32_32x32x16_bf16 v[136:151], v[48:51], v[224:227], v[136:151]
    v_cvt_pk_bf16_f32 v91, v94, v95
    ds_read_b64_tr_b16 v[44:45], v25 offset:41984
    ds_read_b64_tr_b16 v[46:47], v25 offset:44032
    s_waitcnt lgkmcnt(10)
    v_mfma_f32_32x32x16_bf16 v[120:135], v[52:55], v[228:231], v[120:135]
    ds_write_b128 v0, v[88:91]
    ds_read_b64_tr_b16 v[48:49], v24 offset:45056
    ds_read_b64_tr_b16 v[50:51], v24 offset:47104
    s_waitcnt lgkmcnt(11)
    v_mfma_f32_32x32x16_bf16 v[136:151], v[28:31], v[228:231], v[136:151]
    v_cvt_pk_bf16_f32 v92, v96, v97
    ds_read_b64_tr_b16 v[52:53], v25 offset:45056
    ds_read_b64_tr_b16 v[54:55], v25 offset:47104
    s_waitcnt lgkmcnt(11)
    v_mfma_f32_32x32x16_bf16 v[120:135], v[32:35], v[232:235], v[120:135]
    v_cvt_pk_bf16_f32 v93, v98, v99
    ds_read_b64_tr_b16 v[28:29], v24 offset:46080
    ds_read_b64_tr_b16 v[30:31], v24 offset:48128
    s_waitcnt lgkmcnt(11)
    v_mfma_f32_32x32x16_bf16 v[136:151], v[36:39], v[232:235], v[136:151]
    v_cvt_pk_bf16_f32 v94, v100, v101
    ds_read_b64_tr_b16 v[32:33], v25 offset:46080
    ds_read_b64_tr_b16 v[34:35], v25 offset:48128
    s_waitcnt lgkmcnt(11)
    v_mfma_f32_32x32x16_bf16 v[120:135], v[40:43], v[236:239], v[120:135]
    v_cvt_pk_bf16_f32 v95, v102, v103
    ds_read_b64_tr_b16 v[36:37], v24
    ds_read_b64_tr_b16 v[38:39], v24 offset:2048
    s_waitcnt lgkmcnt(11)
    v_mfma_f32_32x32x16_bf16 v[136:151], v[44:47], v[236:239], v[136:151]
    ds_write_b128 v0, v[92:95] offset:1024
    ds_read_b64_tr_b16 v[40:41], v25
    ds_read_b64_tr_b16 v[42:43], v25 offset:2048
    s_waitcnt lgkmcnt(11)
    v_mfma_f32_32x32x16_bf16 v[120:135], v[48:51], v[240:243], v[120:135]
    v_cvt_pk_bf16_f32 v104, v104, v105
    ds_read_b64_tr_b16 v[44:45], v24 offset:1024
    ds_read_b64_tr_b16 v[46:47], v24 offset:3072
    s_waitcnt lgkmcnt(11)
    v_mfma_f32_32x32x16_bf16 v[136:151], v[52:55], v[240:243], v[136:151]
    v_cvt_pk_bf16_f32 v105, v106, v107
    ds_read_b64_tr_b16 v[48:49], v25 offset:1024
    ds_read_b64_tr_b16 v[50:51], v25 offset:3072
    s_waitcnt lgkmcnt(11)
    v_mfma_f32_32x32x16_bf16 v[120:135], v[28:31], v[244:247], v[120:135]
    v_cvt_pk_bf16_f32 v106, v108, v109
    ds_read_b64_tr_b16 v[52:53], v24 offset:4096
    ds_read_b64_tr_b16 v[54:55], v24 offset:6144
    s_waitcnt lgkmcnt(11)
    v_mfma_f32_32x32x16_bf16 v[136:151], v[32:35], v[244:247], v[136:151]
    v_cvt_pk_bf16_f32 v107, v110, v111
    ds_read_b64_tr_b16 v[28:29], v25 offset:4096
    ds_read_b64_tr_b16 v[30:31], v25 offset:6144
    s_waitcnt lgkmcnt(11)
    v_mfma_f32_32x32x16_bf16 v[120:135], v[36:39], v[152:155], v[120:135]
    ds_write_b128 v0, v[104:107] offset:8192
    ds_read_b64_tr_b16 v[32:33], v24 offset:5120
    ds_read_b64_tr_b16 v[34:35], v24 offset:7168
    s_waitcnt lgkmcnt(11)
    v_mfma_f32_32x32x16_bf16 v[136:151], v[40:43], v[152:155], v[136:151]
    v_cvt_pk_bf16_f32 v108, v112, v113
    ds_read_b64_tr_b16 v[36:37], v25 offset:5120
    ds_read_b64_tr_b16 v[38:39], v25 offset:7168
    s_waitcnt lgkmcnt(11)
    v_mfma_f32_32x32x16_bf16 v[120:135], v[44:47], v[156:159], v[120:135]
    v_cvt_pk_bf16_f32 v109, v114, v115
    ds_read_b64_tr_b16 v[40:41], v24 offset:8192
    ds_read_b64_tr_b16 v[42:43], v24 offset:10240
    s_waitcnt lgkmcnt(11)
    v_mfma_f32_32x32x16_bf16 v[136:151], v[48:51], v[156:159], v[136:151]
    v_cvt_pk_bf16_f32 v110, v116, v117
    ds_read_b64_tr_b16 v[44:45], v25 offset:8192
    ds_read_b64_tr_b16 v[46:47], v25 offset:10240
    s_waitcnt lgkmcnt(11)
    v_mfma_f32_32x32x16_bf16 v[120:135], v[52:55], v[160:163], v[120:135]
    v_cvt_pk_bf16_f32 v111, v118, v119
    ds_read_b64_tr_b16 v[48:49], v24 offset:9216
    ds_read_b64_tr_b16 v[50:51], v24 offset:11264
    s_waitcnt lgkmcnt(11)
    v_mfma_f32_32x32x16_bf16 v[136:151], v[28:31], v[160:163], v[136:151]
    ds_write_b128 v0, v[108:111] offset:9216
    ds_read_b64_tr_b16 v[52:53], v25 offset:9216
    ds_read_b64_tr_b16 v[54:55], v25 offset:11264
    s_waitcnt lgkmcnt(11)
    v_mfma_f32_32x32x16_bf16 v[120:135], v[32:35], v[164:167], v[120:135]
    ds_read_b64_tr_b16 v[28:29], v24 offset:12288
    ds_read_b64_tr_b16 v[30:31], v24 offset:14336
    s_waitcnt lgkmcnt(11)
    v_mfma_f32_32x32x16_bf16 v[136:151], v[36:39], v[164:167], v[136:151]
    ds_read_b64_tr_b16 v[32:33], v25 offset:12288
    ds_read_b64_tr_b16 v[34:35], v25 offset:14336
    s_waitcnt lgkmcnt(11)
    v_mfma_f32_32x32x16_bf16 v[120:135], v[40:43], v[168:171], v[120:135]
    ds_read_b64_tr_b16 v[36:37], v24 offset:13312
    ds_read_b64_tr_b16 v[38:39], v24 offset:15360
    s_waitcnt lgkmcnt(11)
    v_mfma_f32_32x32x16_bf16 v[136:151], v[44:47], v[168:171], v[136:151]
    ds_read_b64_tr_b16 v[40:41], v25 offset:13312
    ds_read_b64_tr_b16 v[42:43], v25 offset:15360
    s_waitcnt lgkmcnt(11)
    v_mfma_f32_32x32x16_bf16 v[120:135], v[48:51], v[172:175], v[120:135]
    ds_read_b64_tr_b16 v[44:45], v24 offset:16384
    ds_read_b64_tr_b16 v[46:47], v24 offset:18432
    s_waitcnt lgkmcnt(10)
    v_mfma_f32_32x32x16_bf16 v[136:151], v[52:55], v[172:175], v[136:151]
    ds_read_b64_tr_b16 v[48:49], v25 offset:16384
    ds_read_b64_tr_b16 v[50:51], v25 offset:18432
    s_waitcnt lgkmcnt(10)
    v_mfma_f32_32x32x16_bf16 v[120:135], v[28:31], v[176:179], v[120:135]
    ds_read_b64_tr_b16 v[52:53], v24 offset:17408
    ds_read_b64_tr_b16 v[54:55], v24 offset:19456
    s_waitcnt lgkmcnt(10)
    v_mfma_f32_32x32x16_bf16 v[136:151], v[32:35], v[176:179], v[136:151]
    ds_read_b64_tr_b16 v[28:29], v25 offset:17408
    ds_read_b64_tr_b16 v[30:31], v25 offset:19456
    s_waitcnt lgkmcnt(10)
    v_mfma_f32_32x32x16_bf16 v[120:135], v[36:39], v[180:183], v[120:135]
    ds_read_b64_tr_b16 v[32:33], v24 offset:20480
    ds_read_b64_tr_b16 v[34:35], v24 offset:22528
    s_waitcnt lgkmcnt(10)
    v_mfma_f32_32x32x16_bf16 v[136:151], v[40:43], v[180:183], v[136:151]
    ds_read_b64_tr_b16 v[36:37], v25 offset:20480
    ds_read_b64_tr_b16 v[38:39], v25 offset:22528
    s_waitcnt lgkmcnt(10)
    v_mfma_f32_32x32x16_bf16 v[120:135], v[44:47], v[184:187], v[120:135]
    ds_read_b64_tr_b16 v[40:41], v24 offset:21504
    ds_read_b64_tr_b16 v[42:43], v24 offset:23552
    s_waitcnt lgkmcnt(10)
    v_mfma_f32_32x32x16_bf16 v[136:151], v[48:51], v[184:187], v[136:151]
    ds_read_b64_tr_b16 v[44:45], v25 offset:21504
    ds_read_b64_tr_b16 v[46:47], v25 offset:23552
    s_waitcnt lgkmcnt(10)
    v_mfma_f32_32x32x16_bf16 v[120:135], v[52:55], v[188:191], v[120:135]
    ds_read_b64_tr_b16 v[48:49], v24 offset:24576
    ds_read_b64_tr_b16 v[50:51], v24 offset:26624
    s_waitcnt lgkmcnt(10)
    v_mfma_f32_32x32x16_bf16 v[136:151], v[28:31], v[188:191], v[136:151]
    ds_read_b64_tr_b16 v[52:53], v25 offset:24576
    ds_read_b64_tr_b16 v[54:55], v25 offset:26624
    s_waitcnt lgkmcnt(10)
    v_mfma_f32_32x32x16_bf16 v[120:135], v[32:35], v[192:195], v[120:135]
    ds_read_b64_tr_b16 v[28:29], v24 offset:25600
    ds_read_b64_tr_b16 v[30:31], v24 offset:27648
    s_waitcnt lgkmcnt(10)
    v_mfma_f32_32x32x16_bf16 v[136:151], v[36:39], v[192:195], v[136:151]
    ds_read_b64_tr_b16 v[32:33], v25 offset:25600
    ds_read_b64_tr_b16 v[34:35], v25 offset:27648
    s_waitcnt lgkmcnt(10)
    v_mfma_f32_32x32x16_bf16 v[120:135], v[40:43], v[196:199], v[120:135]
    ds_read_b64_tr_b16 v[36:37], v24 offset:28672
    ds_read_b64_tr_b16 v[38:39], v24 offset:30720
    s_waitcnt lgkmcnt(10)
    v_mfma_f32_32x32x16_bf16 v[136:151], v[44:47], v[196:199], v[136:151]
    ds_read_b64_tr_b16 v[40:41], v25 offset:28672
    ds_read_b64_tr_b16 v[42:43], v25 offset:30720
    s_waitcnt lgkmcnt(10)
    v_mfma_f32_32x32x16_bf16 v[120:135], v[48:51], v[200:203], v[120:135]
    ds_read_b64_tr_b16 v[44:45], v25 offset:29696
    ds_read_b64_tr_b16 v[46:47], v25 offset:31744
    s_waitcnt lgkmcnt(10)
    v_mfma_f32_32x32x16_bf16 v[136:151], v[52:55], v[200:203], v[136:151]
    ds_read_b64_tr_b16 v[48:49], v24 offset:29696
    ds_read_b64_tr_b16 v[50:51], v24 offset:31744
    s_waitcnt lgkmcnt(10)
    v_mfma_f32_32x32x16_bf16 v[120:135], v[28:31], v[204:207], v[120:135]
    s_waitcnt lgkmcnt(8)
    v_mfma_f32_32x32x16_bf16 v[136:151], v[32:35], v[204:207], v[136:151]
    s_waitcnt lgkmcnt(6)
    v_mfma_f32_32x32x16_bf16 v[120:135], v[36:39], v[208:211], v[120:135]
    s_waitcnt lgkmcnt(4)
    v_mfma_f32_32x32x16_bf16 v[136:151], v[40:43], v[208:211], v[136:151]
    s_waitcnt lgkmcnt(2)
    v_mfma_f32_32x32x16_bf16 v[136:151], v[44:47], v[212:215], v[136:151]
    s_waitcnt lgkmcnt(0)
    v_mfma_f32_32x32x16_bf16 v[120:135], v[48:51], v[212:215], v[120:135]
    s_lshl_b32 s96, s77, 11
    s_add_u32 s14, s96, 151552
    v_add_u32 v0, s14, v2
    v_bfe_u32 v4, v1, 2, 2
    v_lshlrev_b32 v4, 6, v4
    v_bfe_u32 v9, v1, 4, 1
    v_lshl_add_u32 v4, v9, 5, v4
    v_and_b32 v9, 3, v1
    v_lshl_add_u32 v4, v9, 3, v4
    v_lshrrev_b32 v9, 5, v1
    v_lshl_add_u32 v4, v9, 8, v4
    v_add_u32 v4, 159744, v4
    ds_read_b64_tr_b16 v[176:177], v4
    ds_read_b64_tr_b16 v[178:179], v4 offset:512
    ds_read_b64_tr_b16 v[180:181], v4 offset:1024
    ds_read_b64_tr_b16 v[182:183], v4 offset:1536
    v_cvt_pk_bf16_f32 v152, v136, v137
    v_cvt_pk_bf16_f32 v153, v138, v139
    v_cvt_pk_bf16_f32 v154, v140, v141
    v_cvt_pk_bf16_f32 v155, v142, v143
    v_cvt_pk_bf16_f32 v156, v144, v145
    v_cvt_pk_bf16_f32 v157, v146, v147
    v_cvt_pk_bf16_f32 v158, v148, v149
    v_cvt_pk_bf16_f32 v159, v150, v151
    ds_write_b128 v0, v[152:155]
    ds_write_b128 v0, v[156:159] offset:1024
    v_cvt_pk_bf16_f32 v168, v120, v121
    v_cvt_pk_bf16_f32 v169, v122, v123
    v_cvt_pk_bf16_f32 v170, v124, v125
    v_cvt_pk_bf16_f32 v171, v126, v127
    v_cvt_pk_bf16_f32 v172, v128, v129
    v_cvt_pk_bf16_f32 v173, v130, v131
    v_cvt_pk_bf16_f32 v174, v132, v133
    v_cvt_pk_bf16_f32 v175, v134, v135
    s_setprio 0
    s_branch L_JOIN
L_HELP:
    s_barrier
    s_add_u32 s96, s84, 4
    s_and_b32 s97, s96, 15
    s_mul_i32 s98, s97, 393216
    s_add_u32 s99, s98, s85
    s_add_u32 s82, s99, 4294772736
    s_add_u32 m0, s83, 28672
    s_nop 0
    buffer_load_dwordx4 v3, s[40:43], s82 offen lds
    s_add_u32 s96, s84, 4
    s_and_b32 s97, s96, 15
    s_mul_i32 s98, s97, 393216
    s_add_u32 s99, s98, s85
    s_add_u32 s82, s99, 2048
    s_add_u32 m0, s83, 32768
    s_nop 0
    buffer_load_dwordx4 v3, s[40:43], s82 offen lds
    s_add_u32 s96, s84, 4
    s_and_b32 s97, s96, 15
    s_mul_i32 s98, s97, 393216
    s_add_u32 s99, s98, s85
    s_add_u32 s82, s99, 4294774784
    s_add_u32 m0, s83, 77824
    s_nop 0
    buffer_load_dwordx4 v3, s[40:43], s82 offen lds
    s_add_u32 s96, s84, 4
    s_and_b32 s97, s96, 15
    s_mul_i32 s98, s97, 393216
    s_add_u32 s99, s98, s85
    s_add_u32 s82, s99, 4096
    s_add_u32 m0, s83, 81920
    s_nop 0
    buffer_load_dwordx4 v3, s[40:43], s82 offen lds
    s_add_u32 s96, s84, 4
    s_and_b32 s97, s96, 15
    s_mul_i32 s98, s97, 393216
    s_add_u32 s99, s98, s85
    s_add_u32 s82, s99, 4294770688
    s_add_u32 m0, s83, 126976
    s_nop 0
    buffer_load_dwordx4 v3, s[40:43], s82 offen lds
    s_add_u32 s96, s84, 4
    s_and_b32 s97, s96, 15
    s_mul_i32 s98, s97, 393216
    s_add_u32 s82, s98, s85
    s_add_u32 m0, s83, 131072
    s_nop 0
    buffer_load_dwordx4 v3, s[40:43], s82 offen lds
    s_add_u32 s96, s84, 5
    s_and_b32 s97, s96, 15
    s_mul_i32 s98, s97, 393216
    s_add_u32 s99, s98, s85
    s_add_u32 s82, s99, 4294772736
    s_add_u32 m0, s83, 36864
    s_nop 0
    buffer_load_dwordx4 v3, s[40:43], s82 offen lds
    s_add_u32 s96, s84, 5
    s_and_b32 s97, s96, 15
    s_mul_i32 s98, s97, 393216
    s_add_u32 s99, s98, s85
    s_add_u32 s82, s99, 2048
    s_add_u32 m0, s83, 40960
    s_nop 0
    buffer_load_dwordx4 v3, s[40:43], s82 offen lds
    s_add_u32 s96, s84, 5
    s_and_b32 s97, s96, 15
    s_mul_i32 s98, s97, 393216
    s_add_u32 s99, s98, s85
    s_add_u32 s82, s99, 4294774784
    s_add_u32 m0, s83, 86016
    s_nop 0
    buffer_load_dwordx4 v3, s[40:43], s82 offen lds
    s_add_u32 s96, s84, 5
    s_and_b32 s97, s96, 15
    s_mul_i32 s98, s97, 393216
    s_add_u32 s99, s98, s85
    s_add_u32 s82, s99, 4096
    s_add_u32 m0, s83, 90112
    s_nop 0
    buffer_load_dwordx4 v3, s[40:43], s82 offen lds
    s_add_u32 s96, s84, 5
    s_and_b32 s97, s96, 15
    s_mul_i32 s98, s97, 393216
    s_add_u32 s99, s98, s85
    s_add_u32 s82, s99, 4294770688
    s_add_u32 m0, s83, 135168
    s_nop 0
    buffer_load_dwordx4 v3, s[40:43], s82 offen lds
    s_add_u32 s96, s84, 5
    s_and_b32 s97, s96, 15
    s_mul_i32 s98, s97, 393216
    s_add_u32 s82, s98, s85
    s_add_u32 m0, s83, 139264
    s_nop 0
    buffer_load_dwordx4 v3, s[40:43], s82 offen lds
    v_bfe_u32 v4, v1, 2, 2
    v_lshlrev_b32 v4, 6, v4
    v_bfe_u32 v9, v1, 4, 1
    v_lshl_add_u32 v4, v9, 5, v4
    v_and_b32 v9, 3, v1
    v_lshl_add_u32 v4, v9, 3, v4
    v_lshrrev_b32 v9, 5, v1
    v_lshl_add_u32 v4, v9, 8, v4
    v_add_u32 v4, 159744, v4
    ds_read_b64_tr_b16 v[168:169], v4
    ds_read_b64_tr_b16 v[170:171], v4 offset:512
    ds_read_b64_tr_b16 v[172:173], v4 offset:1024
    ds_read_b64_tr_b16 v[174:175], v4 offset:1536
    ds_read_b64_tr_b16 v[176:177], v4 offset:2048
    ds_read_b64_tr_b16 v[178:179], v4 offset:2560
    ds_read_b64_tr_b16 v[180:181], v4 offset:3072
    ds_read_b64_tr_b16 v[182:183], v4 offset:3584
    s_lshl_b32 s14, s77, 10
    v_and_b32 v232, 7, v1
    v_lshl_add_u32 v232, v232, 4, s14
    v_bfe_u32 v9, v1, 3, 2
    v_lshl_add_u32 v232, v9, 8, v232
    v_lshrrev_b32 v9, 5, v1
    v_lshl_add_u32 v232, v9, 7, v232
    s_and_b32 s96, s9, 1
    s_lshl1_add_u32 s18, s96, 1
    s_and_b32 s96, s8, 3
    s_lshl2_add_u32 s97, s96, s3
    s_sub_u32 s98, s97, 4
    s_lshl_b32 s82, s98, 7
    v_lshrrev_b32 v52, 3, v1
    v_lshl_add_u32 v52, v52, 1, s82
    global_load_ushort v72, v52, s[86:87] offset:0
    global_load_ushort v73, v52, s[86:87] offset:16
    global_load_ushort v74, v52, s[86:87] offset:32
    global_load_ushort v75, v52, s[86:87] offset:48
    global_load_ushort v76, v52, s[86:87] offset:64
    global_load_ushort v77, v52, s[86:87] offset:80
    global_load_ushort v78, v52, s[86:87] offset:96
    global_load_ushort v79, v52, s[86:87] offset:112
    s_and_b32 s96, s8, 3
    s_lshl2_add_u32 s97, s96, s3
    s_sub_u32 s98, s97, 4
    s_mul_i32 s99, s98, 786432
    s_lshr_b32 s96, s8, 2
    s_lshl1_add_u32 s97, s9, s96
    s_lshl_b32 s98, s97, 7
    s_add_u32 s96, s99, s98
    s_add_u32 s19, s96, 4096
    s_waitcnt vmcnt(23)
    s_barrier
    s_add_u32 s96, s84, 6
    s_and_b32 s97, s96, 15
    s_mul_i32 s98, s97, 393216
    s_add_u32 s99, s98, s85
    s_add_u32 s82, s99, 4294772736
    s_add_u32 m0, s83, 4294963200
    s_nop 0
    buffer_load_dwordx4 v3, s[40:43], s82 offen lds
    s_add_u32 s96, s84, 6
    s_and_b32 s97, s96, 15
    s_mul_i32 s98, s97, 393216
    s_add_u32 s99, s98, s85
    s_add_u32 s82, s99, 2048
    s_mov_b32 m0, s83
    s_nop 0
    buffer_load_dwordx4 v3, s[40:43], s82 offen lds
    s_add_u32 s96, s84, 6
    s_and_b32 s97, s96, 15
    s_mul_i32 s98, s97, 393216
    s_add_u32 s99, s98, s85
    s_add_u32 s82, s99, 4294770688
    s_add_u32 m0, s83, 94208
    s_nop 0
    buffer_load_dwordx4 v3, s[40:43], s82 offen lds
    s_add_u32 s96, s84, 6
    s_and_b32 s97, s96, 15
    s_mul_i32 s98, s97, 393216
    s_add_u32 s82, s98, s85
    s_add_u32 m0, s83, 98304
    s_nop 0
    buffer_load_dwordx4 v3, s[40:43], s82 offen lds
    s_add_u32 s96, s84, 6
    s_and_b32 s97, s96, 15
    s_mul_i32 s98, s97, 393216
    s_add_u32 s99, s98, s85
    s_add_u32 s82, s99, 4294774784
    s_add_u32 m0, s83, 45056
    s_nop 0
    buffer_load_dwordx4 v3, s[40:43], s82 offen lds
    s_add_u32 s96, s84, 6
    s_and_b32 s97, s96, 15
    s_mul_i32 s98, s97, 393216
    s_add_u32 s99, s98, s85
    s_add_u32 s82, s99, 4096
    s_add_u32 m0, s83, 49152
    s_nop 0
    buffer_load_dwordx4 v3, s[40:43], s82 offen lds
    s_waitcnt lgkmcnt(0)
    s_load_dword s24, s[32:33], s92 offset:512 glc
    s_load_dword s25, s[32:33], s92 offset:256 glc
    s_load_dword s26, s[32:33], s92 offset:3584 glc
    s_load_dword s27, s[32:33], s92 offset:3328 glc
    s_waitcnt vmcnt(26)
    s_barrier
    s_add_u32 s96, s84, 7
    s_and_b32 s97, s96, 15
    s_mul_i32 s98, s97, 393216
    s_add_u32 s99, s98, s85
    s_add_u32 s82, s99, 4294772736
    s_add_u32 m0, s83, 4096
    s_nop 0
    buffer_load_dwordx4 v3, s[40:43], s82 offen lds
    s_add_u32 s96, s84, 7
    s_and_b32 s97, s96, 15
    s_mul_i32 s98, s97, 393216
    s_add_u32 s99, s98, s85
    s_add_u32 s82, s99, 2048
    s_add_u32 m0, s83, 8192
    s_nop 0
    buffer_load_dwordx4 v3, s[40:43], s82 offen lds
    s_add_u32 s96, s84, 7
    s_and_b32 s97, s96, 15
    s_mul_i32 s98, s97, 393216
    s_add_u32 s99, s98, s85
    s_add_u32 s82, s99, 4294770688
    s_add_u32 m0, s83, 102400
    s_nop 0
    buffer_load_dwordx4 v3, s[40:43], s82 offen lds
    s_add_u32 s96, s84, 7
    s_and_b32 s97, s96, 15
    s_mul_i32 s98, s97, 393216
    s_add_u32 s82, s98, s85
    s_add_u32 m0, s83, 106496
    s_nop 0
    buffer_load_dwordx4 v3, s[40:43], s82 offen lds
    s_add_u32 s96, s84, 7
    s_and_b32 s97, s96, 15
    s_mul_i32 s98, s97, 393216
    s_add_u32 s99, s98, s85
    s_add_u32 s82, s99, 4294774784
    s_add_u32 m0, s83, 53248
    s_nop 0
    buffer_load_dwordx4 v3, s[40:43], s82 offen lds
    s_add_u32 s96, s84, 7
    s_and_b32 s97, s96, 15
    s_mul_i32 s98, s97, 393216
    s_add_u32 s99, s98, s85
    s_add_u32 s82, s99, 4096
    s_add_u32 m0, s83, 57344
    s_nop 0
    buffer_load_dwordx4 v3, s[40:43], s82 offen lds
    s_waitcnt vmcnt(30)
    s_waitcnt vmcnt(26)
    s_barrier
    s_add_u32 s96, s84, 8
    s_and_b32 s97, s96, 15
    s_mul_i32 s98, s97, 393216
    s_add_u32 s99, s98, s85
    s_add_u32 s82, s99, 4294772736
    s_add_u32 m0, s83, 12288
    s_nop 0
    buffer_load_dwordx4 v3, s[40:43], s82 offen lds
    s_add_u32 s96, s84, 8
    s_and_b32 s97, s96, 15
    s_mul_i32 s98, s97, 393216
    s_add_u32 s99, s98, s85
    s_add_u32 s82, s99, 2048
    s_add_u32 m0, s83, 16384
    s_nop 0
    buffer_load_dwordx4 v3, s[40:43], s82 offen lds
    s_add_u32 s96, s84, 8
    s_and_b32 s97, s96, 15
    s_mul_i32 s98, s97, 393216
    s_add_u32 s99, s98, s85
    s_add_u32 s82, s99, 4294770688
    s_add_u32 m0, s83, 110592
    s_nop 0
    buffer_load_dwordx4 v3, s[40:43], s82 offen lds
    s_add_u32 s96, s84, 8
    s_and_b32 s97, s96, 15
    s_mul_i32 s98, s97, 393216
    s_add_u32 s82, s98, s85
    s_add_u32 m0, s83, 114688
    s_nop 0
    buffer_load_dwordx4 v3, s[40:43], s82 offen lds
    s_add_u32 s96, s84, 8
    s_and_b32 s97, s96, 15
    s_mul_i32 s98, s97, 393216
    s_add_u32 s99, s98, s85
    s_add_u32 s82, s99, 4294774784
    s_add_u32 m0, s83, 61440
    s_nop 0
    buffer_load_dwordx4 v3, s[40:43], s82 offen lds
    s_add_u32 s96, s84, 8
    s_and_b32 s97, s96, 15
    s_mul_i32 s98, s97, 393216
    s_add_u32 s99, s98, s85
    s_add_u32 s82, s99, 4096
    s_add_u32 m0, s83, 65536
    s_nop 0
    buffer_load_dwordx4 v3, s[40:43], s82 offen lds
    s_waitcnt vmcnt(18)
    v_lshlrev_b32 v72, 16, v72
    v_mul_f32 v52, s7, v72
    v_exp_f32 v52, -v52
    s_nop 0
    v_add_f32 v52, 1.0, v52
    v_rcp_f32 v52, v52
    s_nop 0
    v_mul_f32 v72, v72, v52
    v_cvt_pk_bf16_f32 v72, 0, v72
    v_lshlrev_b32 v73, 16, v73
    v_mul_f32 v53, s7, v73
    v_exp_f32 v53, -v53
    s_nop 0
    v_add_f32 v53, 1.0, v53
    v_rcp_f32 v53, v53
    s_nop 0
    v_mul_f32 v73, v73, v53
    v_cvt_pk_bf16_f32 v73, 0, v73
    v_lshlrev_b32 v74, 16, v74
    v_mul_f32 v52, s7, v74
    v_exp_f32 v52, -v52
    s_nop 0
    v_add_f32 v52, 1.0, v52
    v_rcp_f32 v52, v52
    s_nop 0
    v_mul_f32 v74, v74, v52
    v_cvt_pk_bf16_f32 v74, 0, v74
    v_lshlrev_b32 v75, 16, v75
    v_mul_f32 v53, s7, v75
    v_exp_f32 v53, -v53
    s_nop 0
    v_add_f32 v53, 1.0, v53
    v_rcp_f32 v53, v53
    s_nop 0
    v_mul_f32 v75, v75, v53
    v_cvt_pk_bf16_f32 v75, 0, v75
    v_lshlrev_b32 v76, 16, v76
    v_mul_f32 v52, s7, v76
    v_exp_f32 v52, -v52
    s_nop 0
    v_add_f32 v52, 1.0, v52
    v_rcp_f32 v52, v52
    s_nop 0
    v_mul_f32 v76, v76, v52
    v_cvt_pk_bf16_f32 v76, 0, v76
    v_lshlrev_b32 v77, 16, v77
    v_mul_f32 v53, s7, v77
    v_exp_f32 v53, -v53
    s_nop 0
    v_add_f32 v53, 1.0, v53
    v_rcp_f32 v53, v53
    s_nop 0
    v_mul_f32 v77, v77, v53
    v_cvt_pk_bf16_f32 v77, 0, v77
    v_lshlrev_b32 v78, 16, v78
    v_mul_f32 v52, s7, v78
    v_exp_f32 v52, -v52
    s_nop 0
    v_add_f32 v52, 1.0, v52
    v_rcp_f32 v52, v52
    s_nop 0
    v_mul_f32 v78, v78, v52
    v_cvt_pk_bf16_f32 v78, 0, v78
    v_lshlrev_b32 v79, 16, v79
    v_mul_f32 v53, s7, v79
    v_exp_f32 v53, -v53
    s_nop 0
    v_add_f32 v53, 1.0, v53
    v_rcp_f32 v53, v53
    s_nop 0
    v_mul_f32 v79, v79, v53
    v_cvt_pk_bf16_f32 v79, 0, v79
    s_waitcnt lgkmcnt(0)
    s_load_dword s24, s[32:33], s92 offset:1024 glc
    s_load_dword s25, s[32:33], s92 offset:768 glc
    s_load_dword s26, s[32:33], s92 offset:1536 glc
    s_load_dword s27, s[32:33], s92 offset:1280 glc
    s_barrier
    s_add_u32 s96, s84, 9
    s_and_b32 s97, s96, 15
    s_mul_i32 s98, s97, 393216
    s_add_u32 s99, s98, s85
    s_add_u32 s82, s99, 4294772736
    s_add_u32 m0, s83, 20480
    s_nop 0
    buffer_load_dwordx4 v3, s[40:43], s82 offen lds
    s_add_u32 s96, s84, 9
    s_and_b32 s97, s96, 15
    s_mul_i32 s98, s97, 393216
    s_add_u32 s99, s98, s85
    s_add_u32 s82, s99, 2048
    s_add_u32 m0, s83, 24576
    s_nop 0
    buffer_load_dwordx4 v3, s[40:43], s82 offen lds
    s_add_u32 s96, s84, 9
    s_and_b32 s97, s96, 15
    s_mul_i32 s98, s97, 393216
    s_add_u32 s99, s98, s85
    s_add_u32 s82, s99, 4294770688
    s_add_u32 m0, s83, 118784
    s_nop 0
    buffer_load_dwordx4 v3, s[40:43], s82 offen lds
    s_add_u32 s96, s84, 9
    s_and_b32 s97, s96, 15
    s_mul_i32 s98, s97, 393216
    s_add_u32 s82, s98, s85
    s_add_u32 m0, s83, 122880
    s_nop 0
    buffer_load_dwordx4 v3, s[40:43], s82 offen lds
    s_add_u32 s96, s84, 9
    s_and_b32 s97, s96, 15
    s_mul_i32 s98, s97, 393216
    s_add_u32 s99, s98, s85
    s_add_u32 s82, s99, 4294774784
    s_add_u32 m0, s83, 69632
    s_nop 0
    buffer_load_dwordx4 v3, s[40:43], s82 offen lds
    s_add_u32 s96, s84, 9
    s_and_b32 s97, s96, 15
    s_mul_i32 s98, s97, 393216
    s_add_u32 s99, s98, s85
    s_add_u32 s82, s99, 4096
    s_add_u32 m0, s83, 73728
    s_nop 0
    buffer_load_dwordx4 v3, s[40:43], s82 offen lds
    s_waitcnt vmcnt(22)
    s_waitcnt vmcnt(20)
    s_waitcnt vmcnt(18)
    s_barrier
    s_add_u32 s96, s84, 10
    s_and_b32 s97, s96, 15
    s_mul_i32 s98, s97, 393216
    s_add_u32 s99, s98, s85
    s_add_u32 s82, s99, 4294772736
    s_add_u32 m0, s83, 28672
    s_nop 0
    buffer_load_dwordx4 v3, s[40:43], s82 offen lds
    s_add_u32 s96, s84, 10
    s_and_b32 s97, s96, 15
    s_mul_i32 s98, s97, 393216
    s_add_u32 s99, s98, s85
    s_add_u32 s82, s99, 2048
    s_add_u32 m0, s83, 32768
    s_nop 0
    buffer_load_dwordx4 v3, s[40:43], s82 offen lds
L_PAD5:
    s_cbranch_execz L_RET5
    s_add_u32 s96, s84, 10
    s_and_b32 s97, s96, 15
    s_mul_i32 s98, s97, 393216
    s_add_u32 s99, s98, s85
    s_add_u32 s82, s99, 4294774784
    s_add_u32 m0, s83, 77824
    s_nop 0
    buffer_load_dwordx4 v3, s[40:43], s82 offen lds
    s_add_u32 s96, s84, 10
    s_and_b32 s97, s96, 15
    s_mul_i32 s98, s97, 393216
    s_add_u32 s99, s98, s85
    s_add_u32 s82, s99, 4096
    s_add_u32 m0, s83, 81920
    s_nop 0
    buffer_load_dwordx4 v3, s[40:43], s82 offen lds
    s_waitcnt lgkmcnt(0)
    s_load_dword s24, s[32:33], s92 offset:2560 glc
    s_load_dword s25, s[32:33], s92 offset:2304 glc
    s_load_dword s26, s[32:33], s92 offset:3072 glc
    s_load_dword s27, s[32:33], s92 offset:2816 glc
    s_waitcnt vmcnt(20)
    s_waitcnt vmcnt(18)
    s_waitcnt vmcnt(16)
    s_barrier
    s_add_u32 s96, s84, 11
    s_and_b32 s97, s96, 15
    s_mul_i32 s98, s97, 393216
    s_add_u32 s99, s98, s85
    s_add_u32 s82, s99, 4294772736
    s_add_u32 m0, s83, 36864
    s_nop 0
    buffer_load_dwordx4 v3, s[40:43], s82 offen lds
    s_add_u32 s96, s84, 11
    s_and_b32 s97, s96, 15
    s_mul_i32 s98, s97, 393216
    s_add_u32 s99, s98, s85
    s_add_u32 s82, s99, 2048
    s_add_u32 m0, s83, 40960
    s_nop 0
    buffer_load_dwordx4 v3, s[40:43], s82 offen lds
    s_add_u32 s96, s84, 11
    s_and_b32 s97, s96, 15
    s_mul_i32 s98, s97, 393216
    s_add_u32 s99, s98, s85
    s_add_u32 s82, s99, 4294774784
    s_add_u32 m0, s83, 86016
    s_nop 0
    buffer_load_dwordx4 v3, s[40:43], s82 offen lds
    s_add_u32 s96, s84, 11
    s_and_b32 s97, s96, 15
    s_mul_i32 s98, s97, 393216
    s_add_u32 s99, s98, s85
    s_add_u32 s82, s99, 4096
    s_add_u32 m0, s83, 90112
    s_nop 0
    buffer_load_dwordx4 v3, s[40:43], s82 offen lds
    s_waitcnt vmcnt(18)
    s_waitcnt vmcnt(16)
    s_waitcnt vmcnt(14)
    s_barrier
    s_add_u32 s96, s84, 12
    s_and_b32 s97, s96, 15
    s_mul_i32 s98, s97, 393216
    s_add_u32 s99, s98, s85
    s_add_u32 s82, s99, 4294772736
    s_add_u32 m0, s83, 4294963200
    s_nop 0
    buffer_load_dwordx4 v3, s[40:43], s82 offen lds
    s_add_u32 s96, s84, 12
    s_and_b32 s97, s96, 15
    s_mul_i32 s98, s97, 393216
    s_add_u32 s99, s98, s85
    s_add_u32 s82, s99, 2048
    s_mov_b32 m0, s83
    s_nop 0
    buffer_load_dwordx4 v3, s[40:43], s82 offen lds
    s_add_u32 s96, s84, 12
    s_and_b32 s97, s96, 15
    s_mul_i32 s98, s97, 393216
    s_add_u32 s99, s98, s85
    s_add_u32 s82, s99, 4294774784
    s_add_u32 m0, s83, 45056
    s_nop 0
    buffer_load_dwordx4 v3, s[40:43], s82 offen lds
    s_add_u32 s96, s84, 12
    s_and_b32 s97, s96, 15
    s_mul_i32 s98, s97, 393216
    s_add_u32 s99, s98, s85
    s_add_u32 s82, s99, 4096
    s_add_u32 m0, s83, 49152
    s_nop 0
    buffer_load_dwordx4 v3, s[40:43], s82 offen lds
    s_waitcnt vmcnt(16)
    s_barrier
    s_add_u32 s96, s84, 13
    s_and_b32 s97, s96, 15
    s_mul_i32 s98, s97, 393216
    s_add_u32 s99, s98, s85
    s_add_u32 s82, s99, 4294772736
    s_add_u32 m0, s83, 4096
    s_nop 0
    buffer_load_dwordx4 v3, s[40:43], s82 offen lds
    s_add_u32 s96, s84, 13
    s_and_b32 s97, s96, 15
    s_mul_i32 s98, s97, 393216
    s_add_u32 s99, s98, s85
    s_add_u32 s82, s99, 2048
    s_add_u32 m0, s83, 8192
    s_nop 0
    buffer_load_dwordx4 v3, s[40:43], s82 offen lds
    s_add_u32 s96, s84, 13
    s_and_b32 s97, s96, 15
    s_mul_i32 s98, s97, 393216
    s_add_u32 s99, s98, s85
    s_add_u32 s82, s99, 4294774784
    s_add_u32 m0, s83, 53248
    s_nop 0
    buffer_load_dwordx4 v3, s[40:43], s82 offen lds
    s_add_u32 s96, s84, 13
    s_and_b32 s97, s96, 15
    s_mul_i32 s98, s97, 393216
    s_add_u32 s99, s98, s85
    s_add_u32 s82, s99, 4096
    s_add_u32 m0, s83, 57344
    s_nop 0
    buffer_load_dwordx4 v3, s[40:43], s82 offen lds
    s_lshl_b32 s96, s74, 13
    s_sub_u32 s97, s3, 4
    s_lshl_b32 s98, s97, 8
    s_add_u32 s99, s96, s98
    s_add_u32 s13, s99, 20971520
    s_waitcnt lgkmcnt(0)
    s_load_dword s24, s[32:33], s13 offset:1276 glc
    s_load_dword s25, s[32:33], s13 offset:3324 glc
    s_load_dword s26, s[32:33], s13 offset:5372 glc
    s_load_dword s27, s[32:33], s13 offset:7420 glc
    s_waitcnt vmcnt(18)
    s_waitcnt vmcnt(16)
    s_barrier
    s_add_u32 s96, s84, 14
    s_and_b32 s97, s96, 15
    s_mul_i32 s98, s97, 393216
    s_add_u32 s99, s98, s85
    s_add_u32 s82, s99, 4294772736
    s_add_u32 m0, s83, 12288
    s_nop 0
    buffer_load_dwordx4 v3, s[40:43], s82 offen lds
    s_add_u32 s96, s84, 14
    s_and_b32 s97, s96, 15
    s_mul_i32 s98, s97, 393216
    s_add_u32 s99, s98, s85
    s_add_u32 s82, s99, 2048
    s_add_u32 m0, s83, 16384
    s_nop 0
    buffer_load_dwordx4 v3, s[40:43], s82 offen lds
    s_add_u32 s96, s84, 10
    s_and_b32 s97, s96, 15
    s_mul_i32 s98, s97, 393216
    s_add_u32 s99, s98, s85
    s_add_u32 s82, s99, 4294770688
    s_add_u32 m0, s83, 126976
    s_nop 0
    buffer_load_dwordx4 v3, s[40:43], s82 offen lds
    s_add_u32 s96, s84, 10
    s_and_b32 s97, s96, 15
    s_mul_i32 s98, s97, 393216
    s_add_u32 s82, s98, s85
    s_add_u32 m0, s83, 131072
    s_nop 0
    buffer_load_dwordx4 v3, s[40:43], s82 offen lds
    s_waitcnt vmcnt(18)
    s_waitcnt vmcnt(14)
    s_barrier
    s_add_u32 s96, s84, 15
    s_and_b32 s97, s96, 15
    s_mul_i32 s98, s97, 393216
    s_add_u32 s99, s98, s85
    s_add_u32 s82, s99, 4294772736
    s_add_u32 m0, s83, 20480
    s_nop 0
    buffer_load_dwordx4 v3, s[40:43], s82 offen lds
    s_add_u32 s96, s84, 15
    s_and_b32 s97, s96, 15
    s_mul_i32 s98, s97, 393216
    s_add_u32 s99, s98, s85
    s_add_u32 s82, s99, 2048
    s_add_u32 m0, s83, 24576
    s_nop 0
    buffer_load_dwordx4 v3, s[40:43], s82 offen lds
    s_add_u32 s96, s84, 11
    s_and_b32 s97, s96, 15
    s_mul_i32 s98, s97, 393216
    s_add_u32 s99, s98, s85
    s_add_u32 s82, s99, 4294770688
    s_add_u32 m0, s83, 135168
    s_nop 0
    buffer_load_dwordx4 v3, s[40:43], s82 offen lds
    s_add_u32 s96, s84, 11
    s_and_b32 s97, s96, 15
    s_mul_i32 s98, s97, 393216
    s_add_u32 s82, s98, s85
    s_add_u32 m0, s83, 139264
    s_nop 0
    buffer_load_dwordx4 v3, s[40:43], s82 offen lds
    s_waitcnt vmcnt(14)
    s_waitcnt vmcnt(10)
    s_waitcnt vmcnt(6)
    s_barrier
    s_add_u32 s96, s84, 14
    s_and_b32 s97, s96, 15
    s_mul_i32 s98, s97, 393216
    s_add_u32 s99, s98, s85
    s_add_u32 s82, s99, 4294774784
    s_add_u32 m0, s83, 61440
    s_nop 0
    buffer_load_dwordx4 v3, s[40:43], s82 offen lds
    s_add_u32 s96, s84, 14
    s_and_b32 s97, s96, 15
    s_mul_i32 s98, s97, 393216
    s_add_u32 s99, s98, s85
    s_add_u32 s82, s99, 4096
    s_add_u32 m0, s83, 65536
    s_nop 0
    buffer_load_dwordx4 v3, s[40:43], s82 offen lds
    s_add_u32 s96, s84, 15
    s_and_b32 s97, s96, 15
    s_mul_i32 s98, s97, 393216
    s_add_u32 s99, s98, s85
    s_add_u32 s82, s99, 4294774784
    s_add_u32 m0, s83, 69632
    s_nop 0
    buffer_load_dwordx4 v3, s[40:43], s82 offen lds
    s_add_u32 s96, s84, 15
    s_and_b32 s97, s96, 15
    s_mul_i32 s98, s97, 393216
    s_add_u32 s99, s98, s85
    s_add_u32 s82, s99, 4096
    s_add_u32 m0, s83, 73728
    s_nop 0
    buffer_load_dwordx4 v3, s[40:43], s82 offen lds
    s_add_u32 s96, s84, 12
    s_and_b32 s97, s96, 15
    s_mul_i32 s98, s97, 393216
    s_add_u32 s99, s98, s85
    s_add_u32 s82, s99, 4294770688
    s_add_u32 m0, s83, 94208
    s_nop 0
    buffer_load_dwordx4 v3, s[40:43], s82 offen lds
    s_add_u32 s96, s84, 12
    s_and_b32 s97, s96, 15
    s_mul_i32 s98, s97, 393216
    s_add_u32 s82, s98, s85
    s_add_u32 m0, s83, 98304
    s_nop 0
    buffer_load_dwordx4 v3, s[40:43], s82 offen lds
    s_waitcnt vmcnt(8)
    s_barrier
    s_add_u32 s96, s84, 13
    s_and_b32 s97, s96, 15
    s_mul_i32 s98, s97, 393216
    s_add_u32 s99, s98, s85
    s_add_u32 s82, s99, 4294770688
    s_add_u32 m0, s83, 102400
    s_nop 0
    buffer_load_dwordx4 v3, s[40:43], s82 offen lds
    s_add_u32 s96, s84, 13
    s_and_b32 s97, s96, 15
    s_mul_i32 s98, s97, 393216
    s_add_u32 s82, s98, s85
    s_add_u32 m0, s83, 106496
    s_nop 0
    buffer_load_dwordx4 v3, s[40:43], s82 offen lds
    s_add_u32 s96, s84, 14
    s_and_b32 s97, s96, 15
    s_mul_i32 s98, s97, 393216
    s_add_u32 s99, s98, s85
    s_add_u32 s82, s99, 4294770688
    s_add_u32 m0, s83, 110592
    s_nop 0
    buffer_load_dwordx4 v3, s[40:43], s82 offen lds
    s_add_u32 s96, s84, 14
    s_and_b32 s97, s96, 15
    s_mul_i32 s98, s97, 393216
    s_add_u32 s82, s98, s85
    s_add_u32 m0, s83, 114688
    s_nop 0
    buffer_load_dwordx4 v3, s[40:43], s82 offen lds
    s_add_u32 s96, s84, 15
    s_and_b32 s97, s96, 15
    s_mul_i32 s98, s97, 393216
    s_add_u32 s99, s98, s85
    s_add_u32 s82, s99, 4294770688
    s_add_u32 m0, s83, 118784
    s_nop 0
    buffer_load_dwordx4 v3, s[40:43], s82 offen lds
    s_add_u32 s96, s84, 15
    s_and_b32 s97, s96, 15
    s_mul_i32 s98, s97, 393216
    s_add_u32 s82, s98, s85
    s_add_u32 m0, s83, 122880
    s_nop 0
    buffer_load_dwordx4 v3, s[40:43], s82 offen lds
    s_waitcnt lgkmcnt(0)
    s_barrier
    s_setprio 3
    ds_read_b128 v[152:155], v0
    ds_read_b128 v[156:159], v0 offset:1024
    v_subrev_u32 v0, 118784, v0
    s_waitcnt lgkmcnt(1)
    v_mfma_f32_32x32x16_bf16 v[184:199], v[168:171], v[152:155], 0
    s_waitcnt lgkmcnt(0)
    v_mfma_f32_32x32x16_bf16 v[184:199], v[172:175], v[156:159], v[184:199]
    s_setprio 0
    s_nop 10
    v_cvt_pk_bf16_f32 v184, 0, v184
    v_cvt_pk_bf16_f32 v185, 0, v185
    v_cvt_pk_bf16_f32 v186, 0, v186
    s_mov_b32 s82, s19
    buffer_load_dwordx4 v[88:91], v248, s[48:51], s82 offen nt
    v_cvt_pk_bf16_f32 v187, 0, v187
    v_cvt_pk_bf16_f32 v188, 0, v188
    v_cvt_pk_bf16_f32 v189, 0, v189
    v_cvt_pk_bf16_f32 v190, 0, v190
    v_cvt_pk_bf16_f32 v191, 0, v191
    v_cvt_pk_bf16_f32 v192, 0, v192
    v_cvt_pk_bf16_f32 v193, 0, v193
    v_cvt_pk_bf16_f32 v194, 0, v194
    v_cvt_pk_bf16_f32 v195, 0, v195
    v_cvt_pk_bf16_f32 v196, 0, v196
    s_add_u32 s82, s19, 98304
    buffer_load_dwordx4 v[92:95], v248, s[48:51], s82 offen nt
    v_cvt_pk_bf16_f32 v197, 0, v197
    v_cvt_pk_bf16_f32 v198, 0, v198
    v_cvt_pk_bf16_f32 v199, 0, v199
    v_max3_f32 v4, v184, v185, v186
    v_min3_f32 v5, v184, v185, v186
    v_max3_f32 v4, v4, v187, v188
    v_min3_f32 v5, v5, v187, v188
    v_max3_f32 v4, v4, v189, v190
    v_min3_f32 v5, v5, v189, v190
    v_max3_f32 v4, v4, v191, v192
    s_add_u32 s82, s19, 196608
    buffer_load_dwordx4 v[96:99], v248, s[48:51], s82 offen nt
    v_min3_f32 v5, v5, v191, v192
    v_max3_f32 v4, v4, v193, v194
    v_min3_f32 v5, v5, v193, v194
    v_max3_f32 v4, v4, v195, v196
    v_min3_f32 v5, v5, v195, v196
    v_max3_f32 v4, v4, v197, v198
    v_min3_f32 v5, v5, v197, v198
    v_max_f32 v6, v4, v199
    v_min_f32 v7, v5, v199
    v_max_f32 v4, v4, v199
    s_add_u32 s82, s19, 294912
    buffer_load_dwordx4 v[100:103], v248, s[48:51], s82 offen nt
    v_min_f32 v5, v5, v199
    v_permlane32_swap_b32 v4, v6
    s_nop 0
    v_permlane32_swap_b32 v5, v7
    v_max_f32 v4, v4, v6
    v_min_f32 v5, v5, v7
    v_mul_f32_e64 v4, v4, s7
    v_mul_f32_e64 v5, v5, s7
    v_fma_f32 v216, v184, s7, -v4
    v_fma_f32 v217, v185, s7, -v4
    v_fma_f32 v184, -v184, s7, v5
    s_add_u32 s82, s19, 393216
    buffer_load_dwordx4 v[104:107], v248, s[48:51], s82 offen nt
    v_fma_f32 v185, -v185, s7, v5
    v_fma_f32 v218, v186, s7, -v4
    v_fma_f32 v219, v187, s7, -v4
    v_fma_f32 v186, -v186, s7, v5
    v_fma_f32 v187, -v187, s7, v5
    s_waitcnt vmcnt(15)
    s_waitcnt vmcnt(13)
    s_barrier
    s_setprio 3
    ds_read_b128 v[152:155], v0
    ds_read_b128 v[156:159], v0 offset:1024
    s_waitcnt lgkmcnt(1)
    v_mfma_f32_32x32x16_bf16 v[200:215], v[176:179], v[152:155], 0
    s_waitcnt lgkmcnt(0)
    v_mfma_f32_32x32x16_bf16 v[200:215], v[180:183], v[156:159], v[200:215]
    s_setprio 0
    v_fma_f32 v220, v188, s7, -v4
    v_fma_f32 v221, v189, s7, -v4
    v_fma_f32 v188, -v188, s7, v5
    v_fma_f32 v189, -v189, s7, v5
    v_fma_f32 v222, v190, s7, -v4
    s_add_u32 s82, s19, 491520
    buffer_load_dwordx4 v[108:111], v248, s[48:51], s82 offen nt
    v_fma_f32 v223, v191, s7, -v4
    s_mov_b32 s82, s80
    buffer_load_dwordx4 v[56:59], v27, s[52:55], s82 offen nt
    v_fma_f32 v190, -v190, s7, v5
    v_fma_f32 v191, -v191, s7, v5
    v_fma_f32 v224, v192, s7, -v4
    v_fma_f32 v225, v193, s7, -v4
    v_fma_f32 v192, -v192, s7, v5
    v_fma_f32 v193, -v193, s7, v5
    v_fma_f32 v226, v194, s7, -v4
    v_fma_f32 v227, v195, s7, -v4
    v_fma_f32 v194, -v194, s7, v5
    s_add_u32 s82, s19, 589824
    buffer_load_dwordx4 v[112:115], v248, s[48:51], s82 offen nt
    v_fma_f32 v195, -v195, s7, v5
    v_fma_f32 v228, v196, s7, -v4
    v_fma_f32 v229, v197, s7, -v4
    v_fma_f32 v196, -v196, s7, v5
    v_fma_f32 v197, -v197, s7, v5
    v_fma_f32 v230, v198, s7, -v4
    v_fma_f32 v231, v199, s7, -v4
    v_fma_f32 v198, -v198, s7, v5
    v_fma_f32 v199, -v199, s7, v5
    v_exp_f32 v216, v216
    s_add_u32 s82, s19, 688128
    buffer_load_dwordx4 v[116:119], v248, s[48:51], s82 offen nt
    v_exp_f32 v184, v184
    s_add_u32 s82, s80, 4294049792
    buffer_load_dwordx4 v[60:63], v27, s[52:55], s82 offen nt
    v_exp_f32 v217, v217
    v_exp_f32 v185, v185
    v_exp_f32 v218, v218
    v_exp_f32 v186, v186
    v_exp_f32 v219, v219
    v_exp_f32 v187, v187
    v_exp_f32 v220, v220
    v_exp_f32 v188, v188
    v_exp_f32 v221, v221
    v_exp_f32 v189, v189
    v_exp_f32 v222, v222
    v_exp_f32 v190, v190
    v_exp_f32 v223, v223
    v_exp_f32 v191, v191
    v_exp_f32 v224, v224
    v_exp_f32 v192, v192
    v_exp_f32 v225, v225
    v_exp_f32 v193, v193
    v_exp_f32 v226, v226
    s_add_u32 s82, s80, 57344
    buffer_load_dwordx4 v[64:67], v27, s[52:55], s82 offen nt
    v_exp_f32 v194, v194
    v_exp_f32 v227, v227
    v_exp_f32 v195, v195
    v_exp_f32 v228, v228
    v_exp_f32 v196, v196
    v_exp_f32 v229, v229
    v_exp_f32 v197, v197
    v_exp_f32 v230, v230
    v_exp_f32 v198, v198
    v_exp_f32 v231, v231
    v_exp_f32 v199, v199
    v_add_f32 v8, v216, v218
    v_add_f32 v9, v217, v219
    v_add_f32 v10, v184, v186
    v_add_f32 v11, v185, v187
    v_add_f32 v8, v8, v220
    v_add_f32 v9, v9, v221
    v_add_f32 v10, v10, v188
    v_add_f32 v11, v11, v189
    v_add_f32 v8, v8, v222
    s_add_u32 s82, s80, 4294107136
    buffer_load_dwordx4 v[68:71], v27, s[52:55], s82 offen nt
    v_add_f32 v9, v9, v223
    v_add_f32 v10, v10, v190
    v_add_f32 v11, v11, v191
    v_add_f32 v8, v8, v224
    v_add_f32 v9, v9, v225
    v_add_f32 v10, v10, v192
    v_add_f32 v11, v11, v193
    v_add_f32 v8, v8, v226
    v_add_f32 v9, v9, v227
    v_add_f32 v10, v10, v194
    v_add_f32 v11, v11, v195
    v_add_f32 v8, v8, v228
    v_add_f32 v9, v9, v229
    v_add_f32 v10, v10, v196
    v_add_f32 v11, v11, v197
    v_add_f32 v8, v8, v230
    v_add_f32 v9, v9, v231
    v_add_f32 v10, v10, v198
    v_add_f32 v11, v11, v199
    v_add_f32 v6, v8, v9
    v_add_f32 v7, v10, v11
    v_add_f32 v4, v8, v9
    v_add_f32 v5, v10, v11
    s_nop 0
    v_permlane32_swap_b32 v4, v6
    v_permlane32_swap_b32 v5, v7
    v_add_f32 v4, v4, v6
    v_add_f32 v5, v5, v7
    v_rcp_f32 v4, v4
    v_rcp_f32 v5, v5
    v_mul_f32 v216, v216, v4
    v_mul_f32 v217, v217, v4
    v_mul_f32 v184, v184, v5
    v_mul_f32 v185, v185, v5
    v_mul_f32 v218, v218, v4
    v_mul_f32 v219, v219, v4
    v_mul_f32 v186, v186, v5
    v_mul_f32 v187, v187, v5
    v_mul_f32 v220, v220, v4
    v_mul_f32 v221, v221, v4
    v_mul_f32 v188, v188, v5
    v_mul_f32 v189, v189, v5
    v_mul_f32 v222, v222, v4
    v_mul_f32 v223, v223, v4
    v_mul_f32 v190, v190, v5
    v_mul_f32 v191, v191, v5
    v_mul_f32 v224, v224, v4
    v_mul_f32 v225, v225, v4
    v_mul_f32 v192, v192, v5
    v_mul_f32 v193, v193, v5
    v_mul_f32 v226, v226, v4
    v_mul_f32 v227, v227, v4
    v_mul_f32 v194, v194, v5
    v_mul_f32 v195, v195, v5
    v_mul_f32 v228, v228, v4
    v_mul_f32 v229, v229, v4
    v_mul_f32 v196, v196, v5
    v_mul_f32 v197, v197, v5
    v_mul_f32 v230, v230, v4
    v_mul_f32 v231, v231, v4
    v_mul_f32 v198, v198, v5
    v_mul_f32 v199, v199, v5
    v_cvt_pk_bf16_f32 v216, v216, v217
    v_cvt_pk_bf16_f32 v217, v218, v219
    v_cvt_pk_bf16_f32 v218, v220, v221
    v_cvt_pk_bf16_f32 v219, v222, v223
    v_cvt_pk_bf16_f32 v220, v224, v225
    v_cvt_pk_bf16_f32 v221, v226, v227
    v_cvt_pk_bf16_f32 v222, v228, v229
    v_cvt_pk_bf16_f32 v223, v230, v231
    ds_write_b128 v232, v[216:219]
    v_cvt_pk_bf16_f32 v224, v184, v185
    v_cvt_pk_bf16_f32 v225, v186, v187
    v_cvt_pk_bf16_f32 v226, v188, v189
    v_cvt_pk_bf16_f32 v227, v190, v191
    ds_write_b128 v232, v[220:223] offset:4096
    ds_write_b128 v232, v[224:227] offset:8192
    v_cvt_pk_bf16_f32 v228, v192, v193
    v_cvt_pk_bf16_f32 v229, v194, v195
    v_cvt_pk_bf16_f32 v230, v196, v197
    v_cvt_pk_bf16_f32 v231, v198, v199
    ds_write_b128 v232, v[228:231] offset:12288
    s_waitcnt vmcnt(18)
    s_waitcnt vmcnt(16)
    s_waitcnt vmcnt(14)
    s_waitcnt vmcnt(12)
    s_barrier
    v_cvt_pk_bf16_f32 v200, 0, v200
    v_cvt_pk_bf16_f32 v201, 0, v201
    v_cvt_pk_bf16_f32 v202, 0, v202
    v_cvt_pk_bf16_f32 v203, 0, v203
    s_xor_b32 s96, s95, 786432
    s_add_u32 s97, s96, s90
    s_sub_u32 s82, s97, 65536
    s_add_u32 m0, s83, 45056
    s_nop 0
    buffer_load_dwordx4 v26, s[44:47], s82 offen lds
    v_cvt_pk_bf16_f32 v204, 0, v204
    v_cvt_pk_bf16_f32 v205, 0, v205
    v_cvt_pk_bf16_f32 v206, 0, v206
    v_cvt_pk_bf16_f32 v207, 0, v207
    v_cvt_pk_bf16_f32 v208, 0, v208
    v_cvt_pk_bf16_f32 v209, 0, v209
    v_cvt_pk_bf16_f32 v210, 0, v210
    v_cvt_pk_bf16_f32 v211, 0, v211
    v_cvt_pk_bf16_f32 v212, 0, v212
    v_cvt_pk_bf16_f32 v213, 0, v213
    v_cvt_pk_bf16_f32 v214, 0, v214
    v_cvt_pk_bf16_f32 v215, 0, v215
    v_max3_f32 v4, v200, v201, v202
    v_min3_f32 v5, v200, v201, v202
    s_xor_b32 s96, s95, 786432
    s_add_u32 s82, s96, s90
    s_add_u32 m0, s83, 49152
    s_nop 0
    buffer_load_dwordx4 v26, s[44:47], s82 offen lds
    v_max3_f32 v4, v4, v203, v204
    v_min3_f32 v5, v5, v203, v204
    v_max3_f32 v4, v4, v205, v206
    v_min3_f32 v5, v5, v205, v206
    v_max3_f32 v4, v4, v207, v208
    v_min3_f32 v5, v5, v207, v208
    v_max3_f32 v4, v4, v209, v210
    v_min3_f32 v5, v5, v209, v210
    v_max3_f32 v4, v4, v211, v212
    v_min3_f32 v5, v5, v211, v212
    v_max3_f32 v4, v4, v213, v214
    v_min3_f32 v5, v5, v213, v214
    v_max_f32 v6, v4, v215
    v_min_f32 v7, v5, v215
    s_xor_b32 s96, s95, 917504
    s_add_u32 s97, s96, s90
    s_sub_u32 s82, s97, 65536
    s_add_u32 m0, s83, 53248
    s_nop 0
    buffer_load_dwordx4 v26, s[44:47], s82 offen lds
    v_max_f32 v4, v4, v215
    s_waitcnt lgkmcnt(0)
    v_min_f32 v5, v5, v215
    v_permlane32_swap_b32 v4, v6
    s_nop 0
    v_permlane32_swap_b32 v5, v7
    v_max_f32 v4, v4, v6
    v_min_f32 v5, v5, v7
    v_mul_f32_e64 v4, v4, s7
    v_mul_f32_e64 v5, v5, s7
    v_fma_f32 v216, v200, s7, -v4
    v_fma_f32 v217, v201, s7, -v4
    v_fma_f32 v200, -v200, s7, v5
    v_fma_f32 v201, -v201, s7, v5
    v_fma_f32 v218, v202, s7, -v4
    s_xor_b32 s96, s95, 917504
    s_add_u32 s82, s96, s90
    s_add_u32 m0, s83, 57344
    s_nop 0
    buffer_load_dwordx4 v26, s[44:47], s82 offen lds
    v_fma_f32 v219, v203, s7, -v4
    v_fma_f32 v202, -v202, s7, v5
    v_fma_f32 v203, -v203, s7, v5
    v_fma_f32 v220, v204, s7, -v4
    v_fma_f32 v221, v205, s7, -v4
    v_fma_f32 v204, -v204, s7, v5
    v_fma_f32 v205, -v205, s7, v5
    v_fma_f32 v222, v206, s7, -v4
    v_fma_f32 v223, v207, s7, -v4
    v_fma_f32 v206, -v206, s7, v5
    v_fma_f32 v207, -v207, s7, v5
    v_fma_f32 v224, v208, s7, -v4
    v_fma_f32 v225, v209, s7, -v4
    v_fma_f32 v208, -v208, s7, v5
    s_xor_b32 s96, s95, 1048576
    s_add_u32 s97, s96, s90
    s_sub_u32 s82, s97, 65536
    s_add_u32 m0, s83, 61440
    s_nop 0
    buffer_load_dwordx4 v26, s[44:47], s82 offen lds
    v_fma_f32 v209, -v209, s7, v5
    v_fma_f32 v226, v210, s7, -v4
    v_fma_f32 v227, v211, s7, -v4
    v_fma_f32 v210, -v210, s7, v5
    v_fma_f32 v211, -v211, s7, v5
    v_fma_f32 v228, v212, s7, -v4
    v_fma_f32 v229, v213, s7, -v4
    v_fma_f32 v212, -v212, s7, v5
    v_fma_f32 v213, -v213, s7, v5
    v_fma_f32 v230, v214, s7, -v4
    v_fma_f32 v231, v215, s7, -v4
    v_fma_f32 v214, -v214, s7, v5
    v_fma_f32 v215, -v215, s7, v5
    v_exp_f32 v216, v216
    s_xor_b32 s96, s95, 1048576
    s_add_u32 s82, s96, s90
    s_add_u32 m0, s83, 65536
    s_nop 0
    buffer_load_dwordx4 v26, s[44:47], s82 offen lds
    v_exp_f32 v200, v200
    v_exp_f32 v217, v217
    v_exp_f32 v201, v201
    v_exp_f32 v218, v218
    v_exp_f32 v202, v202
    v_exp_f32 v219, v219
    v_exp_f32 v203, v203
    v_exp_f32 v220, v220
    v_exp_f32 v204, v204
    v_exp_f32 v221, v221
    v_exp_f32 v205, v205
    v_exp_f32 v222, v222
    v_exp_f32 v206, v206
    v_exp_f32 v223, v223
    s_xor_b32 s96, s95, 1179648
    s_add_u32 s97, s96, s90
    s_sub_u32 s82, s97, 65536
    s_add_u32 m0, s83, 69632
    s_nop 0
    buffer_load_dwordx4 v26, s[44:47], s82 offen lds
    v_exp_f32 v207, v207
L_PAD6:
    s_cbranch_execz L_RET6
    v_exp_f32 v224, v224
    v_exp_f32 v208, v208
    v_exp_f32 v225, v225
    v_exp_f32 v209, v209
    v_exp_f32 v226, v226
    v_exp_f32 v210, v210
    v_exp_f32 v227, v227
    v_exp_f32 v211, v211
    v_exp_f32 v228, v228
    v_exp_f32 v212, v212
    v_exp_f32 v229, v229
    v_exp_f32 v213, v213
    v_exp_f32 v230, v230
    s_xor_b32 s96, s95, 1179648
    s_add_u32 s82, s96, s90
    s_add_u32 m0, s83, 73728
    s_nop 0
    buffer_load_dwordx4 v26, s[44:47], s82 offen lds
    v_exp_f32 v214, v214
    v_exp_f32 v231, v231
    v_exp_f32 v215, v215
    v_add_f32 v8, v216, v218
    v_add_f32 v9, v217, v219
    v_add_f32 v10, v200, v202
    v_add_f32 v11, v201, v203
    v_add_f32 v8, v8, v220
    v_add_f32 v9, v9, v221
    v_add_f32 v10, v10, v204
    v_add_f32 v11, v11, v205
    v_add_f32 v8, v8, v222
    v_add_f32 v9, v9, v223
    v_add_f32 v10, v10, v206
    s_xor_b32 s96, s95, 1310720
    s_add_u32 s97, s96, s90
    s_sub_u32 s82, s97, 65536
    s_add_u32 m0, s83, 77824
    s_nop 0
    buffer_load_dwordx4 v26, s[44:47], s82 offen lds
    v_add_f32 v11, v11, v207
    v_add_f32 v8, v8, v224
    v_add_f32 v9, v9, v225
    v_add_f32 v10, v10, v208
    v_add_f32 v11, v11, v209
    v_add_f32 v8, v8, v226
    v_add_f32 v9, v9, v227
    v_add_f32 v10, v10, v210
    v_add_f32 v11, v11, v211
    v_add_f32 v8, v8, v228
    v_add_f32 v9, v9, v229
    v_add_f32 v10, v10, v212
    v_add_f32 v11, v11, v213
    v_add_f32 v8, v8, v230
    s_xor_b32 s96, s95, 1310720
    s_add_u32 s82, s96, s90
    s_add_u32 m0, s83, 81920
    s_nop 0
    buffer_load_dwordx4 v26, s[44:47], s82 offen lds
    v_add_f32 v9, v9, v231
    v_add_f32 v10, v10, v214
    v_add_f32 v11, v11, v215
    v_add_f32 v6, v8, v9
    v_add_f32 v7, v10, v11
    v_add_f32 v4, v8, v9
    v_add_f32 v5, v10, v11
    s_nop 0
    v_permlane32_swap_b32 v4, v6
    v_permlane32_swap_b32 v5, v7
    v_add_f32 v4, v4, v6
    v_add_f32 v5, v5, v7
    v_rcp_f32 v4, v4
    v_rcp_f32 v5, v5
    v_mul_f32 v216, v216, v4
    s_xor_b32 s96, s95, 1441792
    s_add_u32 s97, s96, s90
    s_sub_u32 s82, s97, 65536
    s_add_u32 m0, s83, 86016
    s_nop 0
    buffer_load_dwordx4 v26, s[44:47], s82 offen lds
    v_mul_f32 v217, v217, v4
    v_mul_f32 v200, v200, v5
    v_mul_f32 v201, v201, v5
    v_mul_f32 v218, v218, v4
    v_mul_f32 v219, v219, v4
    v_mul_f32 v202, v202, v5
    v_mul_f32 v203, v203, v5
    v_mul_f32 v220, v220, v4
    v_mul_f32 v221, v221, v4
    v_mul_f32 v204, v204, v5
    v_mul_f32 v205, v205, v5
    v_mul_f32 v222, v222, v4
    v_mul_f32 v223, v223, v4
    v_mul_f32 v206, v206, v5
    s_xor_b32 s96, s95, 1441792
    s_add_u32 s82, s96, s90
    s_add_u32 m0, s83, 90112
    s_nop 0
    buffer_load_dwordx4 v26, s[44:47], s82 offen lds
    v_mul_f32 v207, v207, v5
    v_mul_f32 v224, v224, v4
    v_mul_f32 v225, v225, v4
    v_mul_f32 v208, v208, v5
    v_mul_f32 v209, v209, v5
    v_mul_f32 v226, v226, v4
    v_mul_f32 v227, v227, v4
    v_mul_f32 v210, v210, v5
    v_mul_f32 v211, v211, v5
    v_mul_f32 v228, v228, v4
    v_mul_f32 v229, v229, v4
    v_mul_f32 v212, v212, v5
    v_mul_f32 v213, v213, v5
    v_mul_f32 v230, v230, v4
    v_mul_f32 v231, v231, v4
    v_mul_f32 v214, v214, v5
    v_mul_f32 v215, v215, v5
    v_cvt_pk_bf16_f32 v216, v216, v217
    v_cvt_pk_bf16_f32 v217, v218, v219
    v_cvt_pk_bf16_f32 v218, v220, v221
    v_cvt_pk_bf16_f32 v219, v222, v223
    v_cvt_pk_bf16_f32 v220, v224, v225
    v_cvt_pk_bf16_f32 v221, v226, v227
    v_cvt_pk_bf16_f32 v222, v228, v229
    v_cvt_pk_bf16_f32 v223, v230, v231
    ds_write_b128 v232, v[216:219] offset:16384
    v_cvt_pk_bf16_f32 v224, v200, v201
    v_cvt_pk_bf16_f32 v225, v202, v203
    v_cvt_pk_bf16_f32 v226, v204, v205
    v_cvt_pk_bf16_f32 v227, v206, v207
    ds_write_b128 v232, v[220:223] offset:20480
    ds_write_b128 v232, v[224:227] offset:24576
    v_cvt_pk_bf16_f32 v228, v208, v209
    v_cvt_pk_bf16_f32 v229, v210, v211
    v_cvt_pk_bf16_f32 v230, v212, v213
    v_cvt_pk_bf16_f32 v231, v214, v215
    ds_write_b128 v232, v[228:231] offset:28672
    s_lshl_b32 s96, s77, 11
    s_add_u32 s14, s96, 151552
    v_add_u32 v0, s14, v2
    s_setprio 0
L_JOIN:
    v_and_b32 v45, 1, v1
    v_lshlrev_b32 v45, 3, v45
    v_bfe_u32 v9, v1, 2, 2
    v_lshl_add_u32 v45, v9, 4, v45
    v_bfe_u32 v9, v1, 4, 1
    v_lshl_add_u32 v45, v9, 6, v45
    v_bfe_u32 v9, v1, 1, 1
    v_lshl_add_u32 v45, v9, 7, v45
    v_lshrrev_b32 v9, 5, v1
    v_lshl_add_u32 v45, v9, 8, v45
    s_lshl_b32 s13, s3, 12
    v_add_u32 v44, s13, v45
    s_lshl_b32 s96, s76, 13
    s_add_u32 s13, s96, 32768
    v_add_u32 v45, s13, v45
    v_mov_b32 v244, 0x3f803f80
    v_mov_b32 v245, 0x3f803f80
    v_mov_b32 v246, 0x3f803f80
    v_mov_b32 v247, 0x3f803f80
    s_lshl3_add_u32 s96, s11, s3
    s_lshl_b32 s97, s96, 5
    s_add_u32 s98, s97, s10
    s_lshl_b32 s99, s98, 10
    s_add_u32 s13, s99, 25165824
    s_add_u32 s15, s13, 16384
    s_lshl3_add_u32 s96, s11, s3
    s_lshl_b32 s97, s96, 10
    s_add_u32 s16, s97, 21495808
    s_lshl_b32 s96, s10, 6
    s_add_u32 s14, s96, s16
    s_waitcnt lgkmcnt(0)
    s_barrier
    ds_read_b64_tr_b16 v[184:185], v44
    ds_read_b64_tr_b16 v[186:187], v44 offset:512
    ds_read_b64_tr_b16 v[200:201], v45
    ds_read_b64_tr_b16 v[202:203], v45 offset:512
    ds_read_b64_tr_b16 v[204:205], v45 offset:1024
    ds_read_b64_tr_b16 v[206:207], v45 offset:1536
    ds_read_b64_tr_b16 v[188:189], v44 offset:1024
    ds_read_b64_tr_b16 v[190:191], v44 offset:1536
    ds_read_b64_tr_b16 v[208:209], v45 offset:2048
    ds_read_b64_tr_b16 v[210:211], v45 offset:2560
    ds_read_b64_tr_b16 v[212:213], v45 offset:3072
    ds_read_b64_tr_b16 v[214:215], v45 offset:3584
    ds_read_b64_tr_b16 v[192:193], v44 offset:2048
    ds_read_b64_tr_b16 v[194:195], v44 offset:2560
    ds_read_b64_tr_b16 v[216:217], v45 offset:4096
    ds_read_b64_tr_b16 v[218:219], v45 offset:4608
    ds_read_b64_tr_b16 v[220:221], v45 offset:5120
    ds_read_b64_tr_b16 v[222:223], v45 offset:5632
    s_waitcnt lgkmcnt(12)
    v_mfma_f32_16x16x32_bf16 v[232:235], v[184:187], v[200:203], 0
    v_mfma_f32_16x16x32_bf16 v[236:239], v[184:187], v[204:207], 0
    v_mfma_f32_16x16x32_bf16 v[240:243], v[184:187], v[244:247], 0
    ds_read_b64_tr_b16 v[196:197], v44 offset:3072
    ds_read_b64_tr_b16 v[198:199], v44 offset:3584
    ds_read_b64_tr_b16 v[224:225], v45 offset:6144
    ds_read_b64_tr_b16 v[226:227], v45 offset:6656
    ds_read_b64_tr_b16 v[228:229], v45 offset:7168
    ds_read_b64_tr_b16 v[230:231], v45 offset:7680
    s_waitcnt lgkmcnt(12)
    v_mfma_f32_16x16x32_bf16 v[232:235], v[188:191], v[208:211], v[232:235]
    v_mfma_f32_16x16x32_bf16 v[236:239], v[188:191], v[212:215], v[236:239]
    v_mfma_f32_16x16x32_bf16 v[240:243], v[188:191], v[244:247], v[240:243]
    s_waitcnt lgkmcnt(6)
    v_mfma_f32_16x16x32_bf16 v[232:235], v[192:195], v[216:219], v[232:235]
    v_mfma_f32_16x16x32_bf16 v[236:239], v[192:195], v[220:223], v[236:239]
    v_mfma_f32_16x16x32_bf16 v[240:243], v[192:195], v[244:247], v[240:243]
    s_waitcnt lgkmcnt(0)
    v_mfma_f32_16x16x32_bf16 v[232:235], v[196:199], v[224:227], v[232:235]
    v_mfma_f32_16x16x32_bf16 v[236:239], v[196:199], v[228:231], v[236:239]
    v_mfma_f32_16x16x32_bf16 v[240:243], v[196:199], v[244:247], v[240:243]
    s_cmp_lt_u32 s3, 4
    s_cbranch_scc1 L_NOQX
    ds_read_b128 v[168:171], v0
    ds_read_b128 v[172:175], v0 offset:1024
L_NOQX:
    s_nop 3
    buffer_store_dwordx4 v[232:235], v2, s[32:35], s13 offen sc1
    buffer_store_dwordx4 v[236:239], v2, s[32:35], s15 offen sc1
    s_mov_b32 exec_lo, 0x00010001
    s_mov_b32 exec_hi, 0x00010001
    buffer_store_dwordx4 v[240:243], v1, s[32:35], s14 offen sc1
    s_mov_b64 exec, -1
    s_waitcnt lgkmcnt(0)
    v_mfma_f32_32x32x16_bf16 v[120:135], v[176:179], v[168:171], 0
    v_mfma_f32_32x32x16_bf16 v[120:135], v[180:183], v[172:175], v[120:135]
    v_and_b32 v46, 7, v1
    v_lshlrev_b32 v46, 17, v46
    v_bfe_u32 v9, v1, 3, 1
    v_lshl_add_u32 v46, v9, 14, v46
    s_and_b32 s96, s10, 1
    s_and_b32 s97, s2, 27
    s_lshl_b32 s98, s97, 12
    s_lshr_b32 s99, s10, 1
    s_lshl_b32 s97, s99, 6
    s_add_u32 s99, s98, s97
    s_lshl2_add_u32 s98, s96, s99
    s_add_u32 s97, s98, 1048576
    s_add_u32 s17, s97, 512
    v_lshrrev_b32 v47, 3, v1
    v_lshlrev_b32 v47, 10, v47
    v_and_b32 v9, 7, v1
    v_lshl_add_u32 v47, v9, 4, v47
    v_and_b32 v48, 7, v1
    v_lshlrev_b32 v48, 4, v48
    v_lshrrev_b32 v9, 5, v1
    v_lshl_add_u32 v48, v9, 3, v48
    v_cvt_pk_bf16_f32 v120, 0, v120
    v_cvt_pk_bf16_f32 v121, 0, v121
    v_cvt_pk_bf16_f32 v122, 0, v122
    v_cvt_pk_bf16_f32 v123, 0, v123
    v_cvt_pk_bf16_f32 v124, 0, v124
    v_cvt_pk_bf16_f32 v125, 0, v125
    v_cvt_pk_bf16_f32 v126, 0, v126
    v_cvt_pk_bf16_f32 v127, 0, v127
    v_cvt_pk_bf16_f32 v128, 0, v128
    v_cvt_pk_bf16_f32 v129, 0, v129
    v_cvt_pk_bf16_f32 v130, 0, v130
    v_cvt_pk_bf16_f32 v131, 0, v131
    v_cvt_pk_bf16_f32 v132, 0, v132
    v_cvt_pk_bf16_f32 v133, 0, v133
    v_cvt_pk_bf16_f32 v134, 0, v134
    v_cvt_pk_bf16_f32 v135, 0, v135
    v_max3_f32 v4, v120, v121, v122
    v_min3_f32 v5, v120, v121, v122
    v_max3_f32 v4, v4, v123, v124
    v_min3_f32 v5, v5, v123, v124
    v_max3_f32 v4, v4, v125, v126
    v_min3_f32 v5, v5, v125, v126
    v_max3_f32 v4, v4, v127, v128
    v_min3_f32 v5, v5, v127, v128
    v_max3_f32 v4, v4, v129, v130
    v_min3_f32 v5, v5, v129, v130
    v_max3_f32 v4, v4, v131, v132
    v_min3_f32 v5, v5, v131, v132
    v_max3_f32 v4, v4, v133, v134
    v_min3_f32 v5, v5, v133, v134
    v_max_f32 v6, v4, v135
    v_min_f32 v7, v5, v135
    v_max_f32 v4, v4, v135
    v_min_f32 v5, v5, v135
    s_nop 0
    v_permlane32_swap_b32 v4, v6
    v_permlane32_swap_b32 v5, v7
    v_max_f32 v4, v4, v6
    v_min_f32 v5, v5, v7
    v_pk_mul_f32 v[4:5], v[4:5], s[6:7] op_sel:[0,1]
    v_mov_b32 v6, v5
    v_pk_fma_f32 v[136:137], v[120:121], s[6:7], v[4:5] op_sel:[0,1,0] op_sel_hi:[1,1,0] neg_lo:[0,0,1] neg_hi:[0,0,1]
    v_pk_fma_f32 v[120:121], v[120:121], s[6:7], v[6:7] op_sel:[0,1,0] op_sel_hi:[1,1,0] neg_lo:[1,0,0] neg_hi:[1,0,0]
    v_pk_fma_f32 v[138:139], v[122:123], s[6:7], v[4:5] op_sel:[0,1,0] op_sel_hi:[1,1,0] neg_lo:[0,0,1] neg_hi:[0,0,1]
    v_pk_fma_f32 v[122:123], v[122:123], s[6:7], v[6:7] op_sel:[0,1,0] op_sel_hi:[1,1,0] neg_lo:[1,0,0] neg_hi:[1,0,0]
    v_pk_fma_f32 v[140:141], v[124:125], s[6:7], v[4:5] op_sel:[0,1,0] op_sel_hi:[1,1,0] neg_lo:[0,0,1] neg_hi:[0,0,1]
    v_pk_fma_f32 v[124:125], v[124:125], s[6:7], v[6:7] op_sel:[0,1,0] op_sel_hi:[1,1,0] neg_lo:[1,0,0] neg_hi:[1,0,0]
    v_pk_fma_f32 v[142:143], v[126:127], s[6:7], v[4:5] op_sel:[0,1,0] op_sel_hi:[1,1,0] neg_lo:[0,0,1] neg_hi:[0,0,1]
    v_pk_fma_f32 v[126:127], v[126:127], s[6:7], v[6:7] op_sel:[0,1,0] op_sel_hi:[1,1,0] neg_lo:[1,0,0] neg_hi:[1,0,0]
    v_pk_fma_f32 v[144:145], v[128:129], s[6:7], v[4:5] op_sel:[0,1,0] op_sel_hi:[1,1,0] neg_lo:[0,0,1] neg_hi:[0,0,1]
    v_pk_fma_f32 v[128:129], v[128:129], s[6:7], v[6:7] op_sel:[0,1,0] op_sel_hi:[1,1,0] neg_lo:[1,0,0] neg_hi:[1,0,0]
    v_pk_fma_f32 v[146:147], v[130:131], s[6:7], v[4:5] op_sel:[0,1,0] op_sel_hi:[1,1,0] neg_lo:[0,0,1] neg_hi:[0,0,1]
    v_pk_fma_f32 v[130:131], v[130:131], s[6:7], v[6:7] op_sel:[0,1,0] op_sel_hi:[1,1,0] neg_lo:[1,0,0] neg_hi:[1,0,0]
    v_pk_fma_f32 v[148:149], v[132:133], s[6:7], v[4:5] op_sel:[0,1,0] op_sel_hi:[1,1,0] neg_lo:[0,0,1] neg_hi:[0,0,1]
    v_pk_fma_f32 v[132:133], v[132:133], s[6:7], v[6:7] op_sel:[0,1,0] op_sel_hi:[1,1,0] neg_lo:[1,0,0] neg_hi:[1,0,0]
    v_pk_fma_f32 v[150:151], v[134:135], s[6:7], v[4:5] op_sel:[0,1,0] op_sel_hi:[1,1,0] neg_lo:[0,0,1] neg_hi:[0,0,1]
    v_pk_fma_f32 v[134:135], v[134:135], s[6:7], v[6:7] op_sel:[0,1,0] op_sel_hi:[1,1,0] neg_lo:[1,0,0] neg_hi:[1,0,0]
    v_exp_f32 v136, v136
    v_exp_f32 v120, v120
    v_exp_f32 v137, v137
    v_exp_f32 v121, v121
    v_exp_f32 v138, v138
    v_exp_f32 v122, v122
    v_exp_f32 v139, v139
    v_exp_f32 v123, v123
    v_exp_f32 v140, v140
    v_exp_f32 v124, v124
    v_exp_f32 v141, v141
    v_exp_f32 v125, v125
    v_exp_f32 v142, v142
    v_exp_f32 v126, v126
    v_exp_f32 v143, v143
    v_exp_f32 v127, v127
    s_waitcnt vmcnt(0)
    s_barrier
    s_cmp_lg_u32 s3, 0
    s_cbranch_scc1 L_PC
    v_mov_b32 v45, s4
    s_mov_b32 exec_hi, 0
    s_mov_b32 exec_lo, 65535
    buffer_store_dword v45, v46, s[32:35], s17 offen sc1
    s_mov_b64 exec, -1
L_PC:
    s_xor_b32 s96, s95, 1572864
    s_add_u32 s82, s96, s90
    s_add_u32 m0, s83, 98304
    s_nop 0
    buffer_load_dwordx4 v26, s[44:47], s82 offen lds
    v_exp_f32 v144, v144
    v_exp_f32 v128, v128
    v_exp_f32 v145, v145
    v_exp_f32 v129, v129
    v_exp_f32 v146, v146
    v_exp_f32 v130, v130
    v_exp_f32 v147, v147
    v_exp_f32 v131, v131
    s_xor_b32 s96, s95, 1703936
    s_add_u32 s82, s96, s90
    s_add_u32 m0, s83, 106496
    s_nop 0
    buffer_load_dwordx4 v26, s[44:47], s82 offen lds
    v_exp_f32 v148, v148
    v_exp_f32 v132, v132
    v_exp_f32 v149, v149
    v_exp_f32 v133, v133
    v_exp_f32 v150, v150
    v_exp_f32 v134, v134
    v_exp_f32 v151, v151
    v_exp_f32 v135, v135
    s_lshl4_add_u32 s96, s11, s10
    s_lshl_b32 s97, s96, 14
    s_lshl_b32 s98, s3, 7
    s_add_u32 s99, s97, s98
    s_add_u32 s13, s99, 25165824
    s_add_u32 s14, s13, 8192
    s_lshl4_add_u32 s96, s11, s10
    s_lshl_b32 s97, s96, 10
    s_lshl_b32 s98, s3, 7
    s_add_u32 s99, s97, s98
    s_add_u32 s15, s99, 29360128
    s_add_u32 s17, s17, 3072
    s_load_dwordx2 s[24:25], s[32:33], s92 offset:512 glc
    s_xor_b32 s96, s95, 1835008
    s_add_u32 s82, s96, s90
    s_add_u32 m0, s83, 114688
    s_nop 0
    buffer_load_dwordx4 v26, s[44:47], s82 offen lds
    v_pk_add_f32 v[8:9], v[136:137], v[138:139]
    v_pk_add_f32 v[10:11], v[120:121], v[122:123]
    v_pk_add_f32 v[8:9], v[8:9], v[140:141]
    v_pk_add_f32 v[10:11], v[10:11], v[124:125]
    v_pk_add_f32 v[8:9], v[8:9], v[142:143]
    v_pk_add_f32 v[10:11], v[10:11], v[126:127]
    v_pk_add_f32 v[8:9], v[8:9], v[144:145]
    v_pk_add_f32 v[10:11], v[10:11], v[128:129]
    v_pk_add_f32 v[8:9], v[8:9], v[146:147]
    v_pk_add_f32 v[10:11], v[10:11], v[130:131]
    v_pk_add_f32 v[8:9], v[8:9], v[148:149]
    v_pk_add_f32 v[10:11], v[10:11], v[132:133]
    v_pk_add_f32 v[8:9], v[8:9], v[150:151]
    v_pk_add_f32 v[10:11], v[10:11], v[134:135]
    s_xor_b32 s96, s95, 1966080
    s_add_u32 s82, s96, s90
    s_add_u32 m0, s83, 122880
    s_nop 0
    buffer_load_dwordx4 v26, s[44:47], s82 offen lds
    v_add_f32 v6, v8, v9
    v_add_f32 v7, v10, v11
    v_add_f32 v4, v8, v9
    v_add_f32 v5, v10, v11
    s_nop 0
    v_permlane32_swap_b32 v4, v6
    v_permlane32_swap_b32 v5, v7
    v_pk_add_f32 v[4:5], v[4:5], v[6:7]
    v_rcp_f32 v4, v4
    v_rcp_f32 v5, v5
    s_nop 0
    v_pk_mul_f32 v[136:137], v[136:137], v[4:5] op_sel_hi:[1,0]
    v_pk_mul_f32 v[120:121], v[4:5], v[120:121] op_sel:[1,0]
    v_pk_mul_f32 v[138:139], v[138:139], v[4:5] op_sel_hi:[1,0]
    v_pk_mul_f32 v[122:123], v[4:5], v[122:123] op_sel:[1,0]
    v_pk_mul_f32 v[140:141], v[140:141], v[4:5] op_sel_hi:[1,0]
    s_add_u32 s82, s95, s90
    s_mov_b32 m0, s83
    s_nop 0
    buffer_load_dwordx4 v26, s[44:47], s82 offen lds
    v_pk_mul_f32 v[124:125], v[4:5], v[124:125] op_sel:[1,0]
    v_pk_mul_f32 v[142:143], v[142:143], v[4:5] op_sel_hi:[1,0]
    v_pk_mul_f32 v[126:127], v[4:5], v[126:127] op_sel:[1,0]
    v_pk_mul_f32 v[144:145], v[144:145], v[4:5] op_sel_hi:[1,0]
    v_pk_mul_f32 v[128:129], v[4:5], v[128:129] op_sel:[1,0]
    v_pk_mul_f32 v[146:147], v[146:147], v[4:5] op_sel_hi:[1,0]
    v_pk_mul_f32 v[130:131], v[4:5], v[130:131] op_sel:[1,0]
    v_pk_mul_f32 v[148:149], v[148:149], v[4:5] op_sel_hi:[1,0]
    v_pk_mul_f32 v[132:133], v[4:5], v[132:133] op_sel:[1,0]
    v_pk_mul_f32 v[150:151], v[150:151], v[4:5] op_sel_hi:[1,0]
    v_pk_mul_f32 v[134:135], v[4:5], v[134:135] op_sel:[1,0]
    v_cvt_pk_bf16_f32 v152, v136, v137
    v_cvt_pk_bf16_f32 v153, v138, v139
    v_cvt_pk_bf16_f32 v154, v140, v141
    s_xor_b32 s96, s95, 131072
    s_add_u32 s82, s96, s90
    s_add_u32 m0, s83, 8192
    s_nop 0
    buffer_load_dwordx4 v26, s[44:47], s82 offen lds
    v_cvt_pk_bf16_f32 v155, v142, v143
    v_cvt_pk_bf16_f32 v156, v144, v145
    v_cvt_pk_bf16_f32 v157, v146, v147
    v_cvt_pk_bf16_f32 v158, v148, v149
    v_cvt_pk_bf16_f32 v159, v150, v151
    v_cvt_pk_bf16_f32 v160, v120, v121
    v_cvt_pk_bf16_f32 v161, v122, v123
    v_cvt_pk_bf16_f32 v162, v124, v125
    v_cvt_pk_bf16_f32 v163, v126, v127
    v_cvt_pk_bf16_f32 v164, v128, v129
    v_cvt_pk_bf16_f32 v165, v130, v131
    v_cvt_pk_bf16_f32 v166, v132, v133
    v_cvt_pk_bf16_f32 v167, v134, v135
    s_branch SCHK_17
SPOLL_16:
    s_load_dwordx2 s[24:25], s[32:33], s92 offset:512 glc
SCHK_17:
    s_add_u32 s5, s5, 1
    s_cmp_ge_u32 s5, 200000
    s_waitcnt lgkmcnt(0)
    s_cbranch_scc1 SDONE_18
    s_cmp_lg_u32 s24, s4
    s_cbranch_scc1 SPOLL_16
    s_cmp_lg_u32 s25, s4
    s_cbranch_scc1 SPOLL_16
SDONE_18:
    s_barrier
    buffer_load_dwordx4 v[184:187], v47, s[32:35], s13 offen sc1
    buffer_load_dwordx4 v[188:191], v47, s[32:35], s14 offen sc1
    buffer_load_dwordx4 v[192:195], v2, s[32:35], s16 offen sc1
    s_lshl_b32 s96, s3, 5
    s_add_u32 s14, s96, 155648
    v_and_b32 v6, 3, v1
    v_lshl_add_u32 v6, v6, 3, s14
    v_lshrrev_b32 v9, 5, v1
    v_lshl_add_u32 v6, v9, 2, v6
    s_lshl_b32 s96, s3, 10
    s_add_u32 s14, s96, 147456
    v_and_b32 v5, 15, v1
    v_lshl_add_u32 v5, v5, 4, s14
    v_lshrrev_b32 v9, 5, v1
    v_lshl_add_u32 v5, v9, 9, v5
    v_bfe_u32 v9, v1, 4, 1
    v_lshl_add_u32 v5, v9, 3, v5
    s_lshl_b32 s96, s76, 7
    s_add_u32 s14, s96, 155648
    v_lshrrev_b32 v7, 5, v1
    v_lshl_add_u32 v7, v7, 4, s14
    s_lshl_b32 s96, s76, 12
    s_add_u32 s14, s96, 147456
    v_add_u32 v44, s14, v2
    s_cmp_lt_u32 s3, 4
    s_cbranch_scc1 L_HG1
    v_lshlrev_b32 v52, 16, v88
    v_and_b32 v53, s6, v88
    v_pk_mul_f32 v[80:81], v[72:73], v[52:53] op_sel:[0,0] op_sel_hi:[0,1]
    v_lshlrev_b32 v54, 16, v89
    v_and_b32 v55, s6, v89
    v_pk_mul_f32 v[82:83], v[72:73], v[54:55] op_sel:[0,0] op_sel_hi:[0,1]
    v_lshlrev_b32 v52, 16, v90
    v_and_b32 v53, s6, v90
    v_pk_mul_f32 v[84:85], v[72:73], v[52:53] op_sel:[0,0] op_sel_hi:[0,1]
    v_lshlrev_b32 v54, 16, v91
    v_and_b32 v55, s6, v91
    v_pk_mul_f32 v[86:87], v[72:73], v[54:55] op_sel:[0,0] op_sel_hi:[0,1]
    v_lshlrev_b32 v52, 16, v92
    v_and_b32 v53, s6, v92
    v_pk_fma_f32 v[80:81], v[72:73], v[52:53], v[80:81] op_sel:[1,0,0] op_sel_hi:[1,1,1]
    v_lshlrev_b32 v54, 16, v93
    v_and_b32 v55, s6, v93
    v_pk_fma_f32 v[82:83], v[72:73], v[54:55], v[82:83] op_sel:[1,0,0] op_sel_hi:[1,1,1]
    v_lshlrev_b32 v52, 16, v94
    v_and_b32 v53, s6, v94
    v_pk_fma_f32 v[84:85], v[72:73], v[52:53], v[84:85] op_sel:[1,0,0] op_sel_hi:[1,1,1]
    v_lshlrev_b32 v54, 16, v95
    v_and_b32 v55, s6, v95
    v_pk_fma_f32 v[86:87], v[72:73], v[54:55], v[86:87] op_sel:[1,0,0] op_sel_hi:[1,1,1]
    v_lshlrev_b32 v52, 16, v96
    v_and_b32 v53, s6, v96
    v_pk_fma_f32 v[80:81], v[74:75], v[52:53], v[80:81] op_sel:[0,0,0] op_sel_hi:[0,1,1]
    v_lshlrev_b32 v54, 16, v97
    v_and_b32 v55, s6, v97
    v_pk_fma_f32 v[82:83], v[74:75], v[54:55], v[82:83] op_sel:[0,0,0] op_sel_hi:[0,1,1]
    v_lshlrev_b32 v52, 16, v98
    v_and_b32 v53, s6, v98
    v_pk_fma_f32 v[84:85], v[74:75], v[52:53], v[84:85] op_sel:[0,0,0] op_sel_hi:[0,1,1]
    v_lshlrev_b32 v54, 16, v99
    v_and_b32 v55, s6, v99
    v_pk_fma_f32 v[86:87], v[74:75], v[54:55], v[86:87] op_sel:[0,0,0] op_sel_hi:[0,1,1]
    v_lshlrev_b32 v52, 16, v100
    v_and_b32 v53, s6, v100
    v_pk_fma_f32 v[80:81], v[74:75], v[52:53], v[80:81] op_sel:[1,0,0] op_sel_hi:[1,1,1]
    v_lshlrev_b32 v54, 16, v101
    v_and_b32 v55, s6, v101
    v_pk_fma_f32 v[82:83], v[74:75], v[54:55], v[82:83] op_sel:[1,0,0] op_sel_hi:[1,1,1]
    v_lshlrev_b32 v52, 16, v102
    v_and_b32 v53, s6, v102
    v_pk_fma_f32 v[84:85], v[74:75], v[52:53], v[84:85] op_sel:[1,0,0] op_sel_hi:[1,1,1]
    v_lshlrev_b32 v54, 16, v103
    v_and_b32 v55, s6, v103
    v_pk_fma_f32 v[86:87], v[74:75], v[54:55], v[86:87] op_sel:[1,0,0] op_sel_hi:[1,1,1]
    v_lshlrev_b32 v52, 16, v104
    v_and_b32 v53, s6, v104
    v_pk_fma_f32 v[80:81], v[76:77], v[52:53], v[80:81] op_sel:[0,0,0] op_sel_hi:[0,1,1]
    v_lshlrev_b32 v54, 16, v105
    v_and_b32 v55, s6, v105
    v_pk_fma_f32 v[82:83], v[76:77], v[54:55], v[82:83] op_sel:[0,0,0] op_sel_hi:[0,1,1]
    v_lshlrev_b32 v52, 16, v106
    v_and_b32 v53, s6, v106
    v_pk_fma_f32 v[84:85], v[76:77], v[52:53], v[84:85] op_sel:[0,0,0] op_sel_hi:[0,1,1]
    v_lshlrev_b32 v54, 16, v107
    v_and_b32 v55, s6, v107
    v_pk_fma_f32 v[86:87], v[76:77], v[54:55], v[86:87] op_sel:[0,0,0] op_sel_hi:[0,1,1]
    v_lshlrev_b32 v52, 16, v108
    v_and_b32 v53, s6, v108
    v_pk_fma_f32 v[80:81], v[76:77], v[52:53], v[80:81] op_sel:[1,0,0] op_sel_hi:[1,1,1]
    v_lshlrev_b32 v54, 16, v109
    v_and_b32 v55, s6, v109
    v_pk_fma_f32 v[82:83], v[76:77], v[54:55], v[82:83] op_sel:[1,0,0] op_sel_hi:[1,1,1]
    v_lshlrev_b32 v52, 16, v110
    v_and_b32 v53, s6, v110
    v_pk_fma_f32 v[84:85], v[76:77], v[52:53], v[84:85] op_sel:[1,0,0] op_sel_hi:[1,1,1]
    v_lshlrev_b32 v54, 16, v111
    v_and_b32 v55, s6, v111
    v_pk_fma_f32 v[86:87], v[76:77], v[54:55], v[86:87] op_sel:[1,0,0] op_sel_hi:[1,1,1]
    v_lshlrev_b32 v52, 16, v112
    v_and_b32 v53, s6, v112
    v_pk_fma_f32 v[80:81], v[78:79], v[52:53], v[80:81] op_sel:[0,0,0] op_sel_hi:[0,1,1]
    v_lshlrev_b32 v54, 16, v113
    v_and_b32 v55, s6, v113
    v_pk_fma_f32 v[82:83], v[78:79], v[54:55], v[82:83] op_sel:[0,0,0] op_sel_hi:[0,1,1]
    v_lshlrev_b32 v52, 16, v114
    v_and_b32 v53, s6, v114
    v_pk_fma_f32 v[84:85], v[78:79], v[52:53], v[84:85] op_sel:[0,0,0] op_sel_hi:[0,1,1]
    v_lshlrev_b32 v54, 16, v115
    v_and_b32 v55, s6, v115
    v_pk_fma_f32 v[86:87], v[78:79], v[54:55], v[86:87] op_sel:[0,0,0] op_sel_hi:[0,1,1]
    v_lshlrev_b32 v52, 16, v116
    v_and_b32 v53, s6, v116
    v_pk_fma_f32 v[80:81], v[78:79], v[52:53], v[80:81] op_sel:[1,0,0] op_sel_hi:[1,1,1]
    v_lshlrev_b32 v54, 16, v117
    v_and_b32 v55, s6, v117
    v_pk_fma_f32 v[82:83], v[78:79], v[54:55], v[82:83] op_sel:[1,0,0] op_sel_hi:[1,1,1]
    v_lshlrev_b32 v52, 16, v118
    v_and_b32 v53, s6, v118
    v_pk_fma_f32 v[84:85], v[78:79], v[52:53], v[84:85] op_sel:[1,0,0] op_sel_hi:[1,1,1]
    v_lshlrev_b32 v54, 16, v119
    v_and_b32 v55, s6, v119
    v_pk_fma_f32 v[86:87], v[78:79], v[54:55], v[86:87] op_sel:[1,0,0] op_sel_hi:[1,1,1]
    v_permlane32_swap_b32 v80, v84
    v_permlane32_swap_b32 v81, v85
    v_permlane32_swap_b32 v82, v86
    v_permlane32_swap_b32 v83, v87
    v_add_f32 v80, v80, v84
    v_add_f32 v81, v81, v85
    v_add_f32 v82, v82, v86
    v_add_f32 v83, v83, v87
    s_nop 0
    v_permlane16_swap_b32 v80, v82
    v_permlane16_swap_b32 v81, v83
    v_add_f32 v80, v80, v82
    v_add_f32 v81, v81, v83
    s_nop 0
    v_add_f32_dpp v80, v80, v80 row_ror:8 row_mask:0xf bank_mask:0xf
    v_add_f32_dpp v81, v81, v81 row_ror:8 row_mask:0xf bank_mask:0xf
    s_nop 1
    v_mov_b32_dpp v80, v81 quad_perm:[0,1,2,3] row_mask:0xf bank_mask:0xc
    ds_write_b32 v252, v80 offset:9984
L_HG1:
    s_waitcnt vmcnt(1)
    v_pk_add_f32 v[184:185], v[184:185], v[188:189]
    v_pk_add_f32 v[186:187], v[186:187], v[190:191]
    s_nop 1
    v_permlane32_swap_b32 v184, v186
    v_permlane32_swap_b32 v185, v187
    v_pk_add_f32 v[184:185], v[184:185], v[186:187]
    s_nop 1
    v_add_f32_dpp v184, v184, v184 row_ror:8 row_mask:0xf bank_mask:0xf
    v_add_f32_dpp v185, v185, v185 row_ror:8 row_mask:0xf bank_mask:0xf
    v_mov_b32 v186, v184
    v_mov_b32 v187, v185
    s_nop 0
    v_permlane16_swap_b32 v184, v186
    v_permlane16_swap_b32 v185, v187
    v_pk_add_f32 v[184:185], v[184:185], v[186:187]
    v_cvt_pk_bf16_f32 v184, v184, v185
    v_mov_b32 v185, s4
    s_mov_b32 exec_lo, 0xff
    s_mov_b32 exec_hi, 0xff
    buffer_store_dwordx2 v[184:185], v48, s[32:35], s15 offen sc1
    s_mov_b64 exec, -1
    s_waitcnt lgkmcnt(0)
    s_barrier
    s_cmp_lg_u32 s3, 0
    s_cbranch_scc1 L_PC2
    v_mov_b32 v45, s4
    s_mov_b32 exec_hi, 0
    s_mov_b32 exec_lo, 65535
    buffer_store_dword v45, v46, s[32:35], s17 offen sc1
    s_mov_b64 exec, -1
L_PC2:
    s_cmp_lg_u32 s3, 3
    s_cbranch_scc1 L_M2F
    ds_read_b128 v[80:83], v251 offset:10000
    s_lshr_b32 s96, s8, 2
    s_lshl1_add_u32 s97, s9, s96
    s_and_b32 s98, s8, 3
    s_lshl2_add_u32 s99, s97, s98
    s_lshl_b32 s96, s99, 9
    s_add_u32 s18, s96, 131072
    s_waitcnt lgkmcnt(0)
    v_add_f32 v80, v80, v81
    v_add_f32 v82, v82, v83
    v_mov_b32 v81, s4
    v_add_f32 v80, v80, v82
    buffer_store_dwordx2 v[80:81], v250, s[32:35], s18 offen sc1
L_M2F:
    s_waitcnt vmcnt(1)
    s_xor_b32 s96, s95, 262144
    s_add_u32 s82, s96, s90
    s_add_u32 m0, s83, 16384
    s_nop 0
    buffer_load_dwordx4 v26, s[44:47], s82 offen lds
    v_permlane32_swap_b32 v192, v194
    v_permlane32_swap_b32 v193, v195
    v_pk_add_f32 v[192:193], v[192:193], v[194:195]
    s_nop 1
    v_add_f32_dpp v192, v192, v192 row_ror:4 row_mask:0xf bank_mask:0xf
    s_xor_b32 s96, s95, 393216
    s_add_u32 s82, s96, s90
    s_add_u32 m0, s83, 24576
    s_nop 0
    buffer_load_dwordx4 v26, s[44:47], s82 offen lds
    v_add_f32_dpp v193, v193, v193 row_ror:4 row_mask:0xf bank_mask:0xf
    v_add_f32_dpp v192, v192, v192 row_ror:8 row_mask:0xf bank_mask:0xf
    s_nop 0
    v_add_f32_dpp v193, v193, v193 row_ror:8 row_mask:0xf bank_mask:0xf
    s_xor_b32 s96, s95, 524288
    s_add_u32 s82, s96, s90
    s_add_u32 m0, s83, 32768
    s_nop 0
    buffer_load_dwordx4 v26, s[44:47], s82 offen lds
    v_mov_b32 v194, v192
    v_mov_b32 v195, v193
    s_nop 0
    v_permlane16_swap_b32 v192, v194
    s_xor_b32 s96, s95, 655360
    s_add_u32 s82, s96, s90
    s_add_u32 m0, s83, 40960
    s_nop 0
    buffer_load_dwordx4 v26, s[44:47], s82 offen lds
    v_permlane16_swap_b32 v193, v195
    v_pk_add_f32 v[192:193], v[192:193], v[194:195]
    v_cvt_pk_bf16_f32 v192, v192, v193
    ds_write_b32 v6, v192
    s_waitcnt lgkmcnt(0)
    s_barrier
    ds_read_b128 v[196:199], v7
    ds_read_b128 v[200:203], v7 offset:32
    ds_read_b128 v[204:207], v7 offset:64
    ds_read_b128 v[208:211], v7 offset:96
    s_lshr_b32 s96, s8, 2
    s_lshl1_add_u32 s97, s9, s96
    s_and_b32 s98, s8, 3
    s_lshl2_add_u32 s99, s97, s98
    s_lshl_b32 s96, s99, 9
    s_add_u32 s18, s96, 131072
    s_waitcnt lgkmcnt(0)
    s_lshl3_add_u32 s96, s11, s3
    s_lshl_b32 s97, s96, 11
    s_add_u32 s13, s97, 29360128
    s_load_dwordx2 s[24:25], s[32:33], s92 offset:3584 glc
    v_mfma_f32_32x32x16_bf16 v[136:151], v[196:199], v[152:155], 0
    v_mfma_f32_32x32x16_bf16 v[136:151], v[200:203], v[156:159], v[136:151]
    v_mfma_f32_32x32x16_bf16 v[136:151], v[204:207], v[160:163], v[136:151]
    v_mfma_f32_32x32x16_bf16 v[136:151], v[208:211], v[164:167], v[136:151]
    s_nop 11
    v_cvt_pk_bf16_f32 v136, 0, v136
    v_add_f32 v136, 0x358637bd, v136
L_PAD7:
    s_cbranch_execz L_RET7
    v_cvt_pk_bf16_f32 v136, 0, v136
    v_rcp_f32 v136, v136
    s_branch SCHK_20
SPOLL_19:
    s_load_dwordx2 s[24:25], s[32:33], s92 offset:3584 glc
SCHK_20:
    s_add_u32 s5, s5, 1
    s_cmp_ge_u32 s5, 200000
    s_waitcnt lgkmcnt(0)
    s_cbranch_scc1 SDONE_21
    s_cmp_lg_u32 s24, s4
    s_cbranch_scc1 SPOLL_19
    s_cmp_lg_u32 s25, s4
    s_cbranch_scc1 SPOLL_19
SDONE_21:
    buffer_load_dwordx4 v[228:231], v2, s[32:35], s13 offen sc1
    buffer_load_dwordx4 v[232:235], v2, s[32:35], s13 offen offset:1024 sc1
    s_waitcnt vmcnt(0)
    v_bitop3_b32 v4, v229, v231, s4 bitop3:0x7e
    v_bitop3_b32 v4, v4, v233, s4 bitop3:0xf6
    v_bitop3_b32 v4, v4, v235, s4 bitop3:0xf6
    v_cmp_ne_u32 vcc, 0, v4
    s_cbranch_vccz TOK_23
POLL_24:
    buffer_load_dwordx4 v[228:231], v2, s[32:35], s13 offen sc1
    buffer_load_dwordx4 v[232:235], v2, s[32:35], s13 offen offset:1024 sc1
    s_waitcnt vmcnt(0)
    v_bitop3_b32 v4, v229, v231, s4 bitop3:0x7e
    v_bitop3_b32 v4, v4, v233, s4 bitop3:0xf6
    v_bitop3_b32 v4, v4, v235, s4 bitop3:0xf6
    v_cmp_ne_u32 vcc, 0, v4
    s_cbranch_vccz PDONE_25
    s_add_u32 s5, s5, 1
    s_cmp_lt_u32 s5, 200000
    s_cbranch_scc1 POLL_24
PDONE_25:
TOK_23:
    ds_write2_b32 v5, v228, v230 offset0:0 offset1:1
    ds_write2_b32 v5, v232, v234 offset0:64 offset1:65
    s_waitcnt lgkmcnt(0)
    s_barrier
    ds_read_b128 v[212:215], v44
    ds_read_b128 v[216:219], v44 offset:1024
    ds_read_b128 v[220:223], v44 offset:2048
    ds_read_b128 v[224:227], v44 offset:3072
    s_lshl_b32 s96, s77, 1
    s_lshl3_add_u32 s97, s10, s96
    s_lshl_b32 s98, s97, 5
    s_lshl1_add_u32 s99, s11, s98
    s_add_u32 s96, s99, s76
    s_lshl_b32 s97, s96, 10
    s_add_u32 s13, s97, 8388608
    v_and_b32 v47, 15, v1
    v_lshlrev_b32 v47, 4, v47
    v_bfe_u32 v9, v1, 4, 1
    v_lshl_add_u32 v47, v9, 15, v47
    v_lshrrev_b32 v9, 5, v1
    v_lshl_add_u32 v47, v9, 8, v47
    s_waitcnt lgkmcnt(3)
    v_mfma_f32_32x32x16_bf16 v[120:135], v[212:215], v[152:155], 0
    s_waitcnt lgkmcnt(2)
    v_mfma_f32_32x32x16_bf16 v[120:135], v[216:219], v[156:159], v[120:135]
    s_waitcnt lgkmcnt(1)
    v_mfma_f32_32x32x16_bf16 v[120:135], v[220:223], v[160:163], v[120:135]
    s_waitcnt lgkmcnt(0)
    v_mfma_f32_32x32x16_bf16 v[120:135], v[224:227], v[164:167], v[120:135]
    s_lshr_b32 s96, s3, 1
    s_lshl4_add_u32 s97, s96, s12
    s_lshl_b32 s98, s97, 11
    s_and_b32 s99, s3, 1
    s_lshl_b32 s96, s99, 10
    s_add_u32 s97, s98, s96
    s_add_u32 s18, s97, 131072
    s_lshl_b32 s19, s12, 7
    v_and_b32 v44, 3, v1
    v_lshl_add_u32 v44, v44, 1, s19
    v_lshrrev_b32 v9, 5, v1
    v_lshl_add_u32 v44, v9, 3, v44
    v_bfe_u32 v9, v1, 4, 1
    v_lshl_add_u32 v44, v9, 4, v44
    v_bfe_u32 v9, v1, 2, 2
    v_lshl_add_u32 v44, v9, 5, v44
    global_load_ushort v32, v44, s[78:79]
    buffer_load_dwordx4 v[28:31], v2, s[32:35], s18 offen sc1
    v_cvt_pk_bf16_f32 v120, 0, v120
    v_cvt_pk_bf16_f32 v121, 0, v121
    v_cvt_pk_bf16_f32 v122, 0, v122
    v_cvt_pk_bf16_f32 v123, 0, v123
    v_cvt_pk_bf16_f32 v124, 0, v124
    v_cvt_pk_bf16_f32 v125, 0, v125
    v_cvt_pk_bf16_f32 v126, 0, v126
    v_cvt_pk_bf16_f32 v127, 0, v127
    v_pk_mul_f32 v[120:121], v[120:121], v[136:137] op_sel_hi:[1,0]
    v_pk_mul_f32 v[122:123], v[122:123], v[136:137] op_sel_hi:[1,0]
    v_pk_mul_f32 v[124:125], v[124:125], v[136:137] op_sel_hi:[1,0]
    v_pk_mul_f32 v[126:127], v[126:127], v[136:137] op_sel_hi:[1,0]
    v_cvt_pk_bf16_f32 v168, v120, v121
    v_cvt_pk_bf16_f32 v169, v122, v123
    v_cvt_pk_bf16_f32 v170, v124, v125
    v_cvt_pk_bf16_f32 v171, v126, v127
    buffer_store_dwordx4 v[168:171], v47, s[32:35], s13 offen sc1
    v_cvt_pk_bf16_f32 v128, 0, v128
    v_cvt_pk_bf16_f32 v129, 0, v129
    v_cvt_pk_bf16_f32 v130, 0, v130
    v_cvt_pk_bf16_f32 v131, 0, v131
    v_cvt_pk_bf16_f32 v132, 0, v132
    v_cvt_pk_bf16_f32 v133, 0, v133
    v_cvt_pk_bf16_f32 v134, 0, v134
    v_cvt_pk_bf16_f32 v135, 0, v135
    v_pk_mul_f32 v[128:129], v[128:129], v[136:137] op_sel_hi:[1,0]
    v_pk_mul_f32 v[130:131], v[130:131], v[136:137] op_sel_hi:[1,0]
    v_pk_mul_f32 v[132:133], v[132:133], v[136:137] op_sel_hi:[1,0]
    v_pk_mul_f32 v[134:135], v[134:135], v[136:137] op_sel_hi:[1,0]
    v_cvt_pk_bf16_f32 v172, v128, v129
    v_cvt_pk_bf16_f32 v173, v130, v131
    v_cvt_pk_bf16_f32 v174, v132, v133
    v_cvt_pk_bf16_f32 v175, v134, v135
    buffer_store_dwordx4 v[172:175], v47, s[32:35], s13 offen offset:512 sc1
    v_mov_b32 v50, -1
    v_mov_b32 v51, -1
    v_mov_b32 v52, -1
    v_mov_b32 v53, -1
    s_lshl3_add_u32 s96, s21, s3
    s_lshl4_add_u32 s97, s96, s12
    s_lshl_b32 s98, s97, 8
    s_add_u32 s19, s98, 12582912
    v_lshlrev_b32 v54, 2, v1
    buffer_store_dword v50, v54, s[32:35], s19 offen sc1
    s_lshl_b32 s96, s21, 14
    s_lshl_b32 s97, s12, 9
    s_add_u32 s98, s96, s97
    s_add_u32 s19, s98, 13631488
    v_and_b32 v54, 31, v1
    v_lshlrev_b32 v54, 4, v54
    v_lshrrev_b32 v55, 5, v1
    v_lshl_add_u32 v54, v55, 13, v54
    s_cmp_lg_u32 s3, 5
    s_cbranch_scc1 L_NOPO
    buffer_store_dwordx4 v[50:53], v54, s[32:35], s19 offen sc1
L_NOPO:
    v_bfe_u32 v36, v1, 2, 2
    v_lshlrev_b32 v36, 7, v36
    v_lshrrev_b32 v9, 4, v1
    v_lshl_add_u32 v36, v9, 10, v36
    v_and_b32 v9, 1, v1
    v_lshl_add_u32 v36, v9, 4, v36
    v_bfe_u32 v9, v1, 1, 1
    v_lshl_add_u32 v36, v9, 3, v36
    v_bfe_u32 v9, v1, 3, 2
    v_lshl_add_u32 v36, v9, 5, v36
    s_and_b32 s96, s9, 1
    s_lshl_b32 s97, s96, 2
    s_xor_b32 s98, s3, s97
    s_lshl_b32 s17, s98, 12
    s_lshl_b32 s96, s17, 2
    s_lshr_b32 s97, s95, 4
    s_xor_b32 s14, s96, s97
    v_add_u32 v36, s14, v36
    v_xor_b32 v37, 32, v36
    v_xor_b32 v38, 64, v36
    v_xor_b32 v39, 96, v36
    v_and_b32 v5, 7, v1
    v_lshlrev_b32 v5, 15, v5
    v_bfe_u32 v9, v1, 3, 1
    v_lshl_add_u32 v5, v9, 12, v5
    s_and_b32 s96, s11, 1
    s_lshr_b32 s97, s10, 2
    s_and_b32 s98, s10, 3
    s_lshl_b32 s99, s98, 6
    s_lshl1_add_u32 s98, s97, s99
    s_lshl_b32 s97, s98, 12
    s_lshr_b32 s99, s11, 1
    s_lshl_b32 s98, s99, 6
    s_add_u32 s99, s97, s98
    s_lshl2_add_u32 s97, s96, s99
    s_add_u32 s98, s97, 1048576
    s_add_u32 s15, s98, 1024
    v_lshlrev_b32 v152, 16, v12
    v_and_b32 v153, s6, v12
    v_lshlrev_b32 v154, 16, v13
    v_and_b32 v155, s6, v13
    v_lshlrev_b32 v156, 16, v14
    v_and_b32 v157, s6, v14
    v_lshlrev_b32 v158, 16, v15
    v_and_b32 v159, s6, v15
    v_lshlrev_b32 v160, 16, v16
    v_and_b32 v161, s6, v16
    v_lshlrev_b32 v162, 16, v17
    v_and_b32 v163, s6, v17
    v_lshlrev_b32 v164, 16, v18
    v_and_b32 v165, s6, v18
    v_lshlrev_b32 v166, 16, v19
    v_and_b32 v167, s6, v19
    s_lshl3_add_u32 s96, s21, s3
    s_lshl_b32 s97, s96, 15
    s_add_u32 s19, s97, 8388608
    s_waitcnt vmcnt(3)
    v_bitop3_b32 v4, v29, v31, s4 bitop3:0x7e
    v_cmp_ne_u32 vcc, 0, v4
    s_cbranch_vccz L_MGOK
POLL_26:
    buffer_load_dwordx4 v[28:31], v2, s[32:35], s18 offen sc1
    s_waitcnt vmcnt(0)
    v_bitop3_b32 v4, v29, v31, s4 bitop3:0x7e
    v_cmp_ne_u32 vcc, 0, v4
    s_cbranch_vccz PDONE_27
    s_add_u32 s5, s5, 1
    s_cmp_lt_u32 s5, 200000
    s_cbranch_scc1 POLL_26
PDONE_27:
L_MGOK:
    s_and_b32 s96, s3, 1
    s_lshr_b32 s97, s3, 1
    s_lshl_b32 s98, s97, 10
    s_lshl3_add_u32 s99, s96, s98
    s_add_u32 s14, s99, 159744
    v_and_b32 v4, 31, v1
    v_lshl_add_u32 v4, v4, 5, s14
    v_lshrrev_b32 v9, 5, v1
    v_lshl_add_u32 v4, v9, 2, v4
    ds_write2_b32 v4, v28, v30 offset0:0 offset1:4
    v_and_b32 v7, 3, v1
    v_lshlrev_b32 v7, 4, v7
    v_lshrrev_b32 v9, 5, v1
    v_lshl_add_u32 v7, v9, 6, v7
    v_bfe_u32 v9, v1, 4, 1
    v_lshl_add_u32 v7, v9, 7, v7
    v_bfe_u32 v9, v1, 2, 2
    v_lshl_add_u32 v7, v9, 8, v7
    v_add_u32 v7, 159744, v7
    s_lshl_b32 s96, s2, 12
    s_lshr_b32 s97, s17, 6
    s_add_u32 s98, s96, s97
    s_add_u32 s99, s98, 1048576
    s_add_u32 s18, s99, 1024
    s_waitcnt vmcnt(1)
    s_waitcnt lgkmcnt(0)
    s_barrier
    s_cmp_lg_u32 s3, 0
    s_cbranch_scc1 L_PD
    v_mov_b32 v6, s4
    s_mov_b32 exec_hi, 0
    s_mov_b32 exec_lo, 65535
    buffer_store_dword v6, v5, s[32:35], s15 offen sc1
    s_mov_b64 exec, -1
L_PD:
    ds_read_b128 v[192:195], v7
    ds_read_b128 v[196:199], v7 offset:1024
    ds_read_b128 v[200:203], v7 offset:2048
    ds_read_b128 v[204:207], v7 offset:3072
    v_and_b32 v8, 3, v1
    v_lshlrev_b32 v8, 2, v8
    v_lshrrev_b32 v9, 5, v1
    v_lshl_add_u32 v8, v9, 4, v8
    v_bfe_u32 v9, v1, 4, 1
    v_lshl_add_u32 v8, v9, 5, v8
    v_bfe_u32 v9, v1, 2, 2
    v_lshl_add_u32 v8, v9, 6, v8
    v_add_u32 v8, 157184, v8
    s_lshl4_add_u32 s96, s21, s12
    s_lshl_b32 s97, s96, 6
    s_add_u32 s13, s97, 14155776
    s_waitcnt lgkmcnt(0)
    s_load_dwordx2 s[24:25], s[32:33], s18 offset:0 glc
    v_pk_add_f32 v[192:193], v[192:193], v[194:195]
    v_add_f32 v28, v192, v193
    v_pk_add_f32 v[196:197], v[196:197], v[198:199]
    v_add_f32 v29, v196, v197
    v_pk_add_f32 v[200:201], v[200:201], v[202:203]
    v_add_f32 v30, v200, v201
    v_pk_add_f32 v[204:205], v[204:205], v[206:207]
    v_add_f32 v31, v204, v205
    v_cvt_pk_bf16_f32 v28, 0, v28
    v_cvt_pk_bf16_f32 v29, 0, v29
    v_cvt_pk_bf16_f32 v30, 0, v30
    v_cvt_pk_bf16_f32 v31, 0, v31
    v_add_f32 v30, 1.0, v30
    v_lshlrev_b32 v32, 16, v32
    v_cvt_pk_bf16_f32 v30, 0, v30
    ds_write_b32 v8, v31
    v_mul_f32 v192, v30, v32
    v_cvt_pk_bf16_f32 v193, 0, v192
    v_sub_f32 v194, v192, v193
    v_add_f32_dpp v192, v192, v192 quad_perm:[1,0,3,2] row_mask:0xf bank_mask:0xf
    s_nop 1
    v_add_f32_dpp v192, v192, v192 quad_perm:[2,3,0,1] row_mask:0xf bank_mask:0xf
    s_nop 1
    v_add_f32_dpp v192, v192, v192 row_half_mirror row_mask:0xf bank_mask:0xf
    s_nop 1
    v_add_f32_dpp v192, v192, v192 row_ror:8 row_mask:0xf bank_mask:0xf
    v_mov_b32 v199, v192
    s_nop 1
    v_permlane16_swap_b32 v192, v199
    v_add_f32 v192, v192, v199
    v_mov_b32 v199, v192
    s_nop 1
    v_permlane32_swap_b32 v192, v199
    v_add_f32 v192, v192, v199
    v_mov_b32_dpp v196, v193 row_shl:1 row_mask:0xf bank_mask:0xf
    v_mov_b32_dpp v197, v194 row_shl:1 row_mask:0xf bank_mask:0xf
    v_mov_b32_dpp v198, v32 row_shl:1 row_mask:0xf bank_mask:0xf
    v_cvt_pk_bf16_f32 v196, v193, v196
    v_cvt_pk_bf16_f32 v197, v194, v197
    v_cvt_pk_bf16_f32 v198, v32, v198
    v_mov_b32 v193, s4
    v_mov_b32 v194, 0
    s_cmp_lg_u32 s3, 2
    s_cbranch_scc1 L_NOUP
    s_mov_b64 exec, 1
    buffer_store_dwordx2 v[192:193], v194, s[32:35], s13 offen sc1
    s_mov_b64 exec, -1
L_NOUP:
    v_mov_b32 v184, 0x3f803f80
    s_nop 1
    v_mov_b32_dpp v184, v196 row_newbcast:0 row_mask:0xf bank_mask:0x2
    s_nop 1
    v_mov_b32_dpp v184, v197 row_newbcast:0 row_mask:0xf bank_mask:0x4
    s_nop 1
    v_mov_b32_dpp v184, v198 row_newbcast:0 row_mask:0xf bank_mask:0x8
    v_mov_b32 v185, 0x3f803f80
    s_nop 1
    v_mov_b32_dpp v185, v196 row_newbcast:2 row_mask:0xf bank_mask:0x2
    s_nop 1
    v_mov_b32_dpp v185, v197 row_newbcast:2 row_mask:0xf bank_mask:0x4
    s_nop 1
    v_mov_b32_dpp v185, v198 row_newbcast:2 row_mask:0xf bank_mask:0x8
    v_mov_b32 v186, 0x3f803f80
    s_nop 1
    v_mov_b32_dpp v186, v196 row_newbcast:4 row_mask:0xf bank_mask:0x2
    s_nop 1
    v_mov_b32_dpp v186, v197 row_newbcast:4 row_mask:0xf bank_mask:0x4
    s_nop 1
    v_mov_b32_dpp v186, v198 row_newbcast:4 row_mask:0xf bank_mask:0x8
    v_mov_b32 v187, 0x3f803f80
    s_nop 1
    v_mov_b32_dpp v187, v196 row_newbcast:6 row_mask:0xf bank_mask:0x2
    s_nop 1
    v_mov_b32_dpp v187, v197 row_newbcast:6 row_mask:0xf bank_mask:0x4
    s_nop 1
    v_mov_b32_dpp v187, v198 row_newbcast:6 row_mask:0xf bank_mask:0x8
    v_mov_b32 v188, 0x3f803f80
    s_nop 1
    v_mov_b32_dpp v188, v196 row_newbcast:8 row_mask:0xf bank_mask:0x2
    s_nop 1
    v_mov_b32_dpp v188, v197 row_newbcast:8 row_mask:0xf bank_mask:0x4
    s_nop 1
    v_mov_b32_dpp v188, v198 row_newbcast:8 row_mask:0xf bank_mask:0x8
    v_mov_b32 v189, 0x3f803f80
    s_nop 1
    v_mov_b32_dpp v189, v196 row_newbcast:10 row_mask:0xf bank_mask:0x2
    s_nop 1
    v_mov_b32_dpp v189, v197 row_newbcast:10 row_mask:0xf bank_mask:0x4
    s_nop 1
    v_mov_b32_dpp v189, v198 row_newbcast:10 row_mask:0xf bank_mask:0x8
    v_mov_b32 v190, 0x3f803f80
    s_nop 1
    v_mov_b32_dpp v190, v196 row_newbcast:12 row_mask:0xf bank_mask:0x2
    s_nop 1
    v_mov_b32_dpp v190, v197 row_newbcast:12 row_mask:0xf bank_mask:0x4
    s_nop 1
    v_mov_b32_dpp v190, v198 row_newbcast:12 row_mask:0xf bank_mask:0x8
    v_mov_b32 v191, 0x3f803f80
    s_nop 1
    v_mov_b32_dpp v191, v196 row_newbcast:14 row_mask:0xf bank_mask:0x2
    s_nop 1
    v_mov_b32_dpp v191, v197 row_newbcast:14 row_mask:0xf bank_mask:0x4
    s_nop 1
    v_mov_b32_dpp v191, v198 row_newbcast:14 row_mask:0xf bank_mask:0x8
    v_mov_b32 v42, v29
    v_mov_b32 v43, v31
    v_mov_b32_dpp v136, v28 row_newbcast:0 row_mask:0xf bank_mask:0xf
    v_mov_b32_dpp v137, v28 row_newbcast:1 row_mask:0xf bank_mask:0xf
    v_mov_b32_dpp v138, v28 row_newbcast:2 row_mask:0xf bank_mask:0xf
    v_mov_b32_dpp v139, v28 row_newbcast:3 row_mask:0xf bank_mask:0xf
    v_mov_b32_dpp v140, v28 row_newbcast:4 row_mask:0xf bank_mask:0xf
    v_mov_b32_dpp v141, v28 row_newbcast:5 row_mask:0xf bank_mask:0xf
    v_mov_b32_dpp v142, v28 row_newbcast:6 row_mask:0xf bank_mask:0xf
    v_mov_b32_dpp v143, v28 row_newbcast:7 row_mask:0xf bank_mask:0xf
    v_mov_b32_dpp v144, v28 row_newbcast:8 row_mask:0xf bank_mask:0xf
    v_mov_b32_dpp v145, v28 row_newbcast:9 row_mask:0xf bank_mask:0xf
    v_mov_b32_dpp v146, v28 row_newbcast:10 row_mask:0xf bank_mask:0xf
    v_mov_b32_dpp v147, v28 row_newbcast:11 row_mask:0xf bank_mask:0xf
    v_mov_b32_dpp v148, v28 row_newbcast:12 row_mask:0xf bank_mask:0xf
    v_mov_b32_dpp v149, v28 row_newbcast:13 row_mask:0xf bank_mask:0xf
    v_mov_b32_dpp v150, v28 row_newbcast:14 row_mask:0xf bank_mask:0xf
    v_mov_b32_dpp v151, v28 row_newbcast:15 row_mask:0xf bank_mask:0xf
    v_mov_b32_dpp v168, v30 row_newbcast:0 row_mask:0xf bank_mask:0xf
    v_mov_b32_dpp v169, v30 row_newbcast:1 row_mask:0xf bank_mask:0xf
    v_mov_b32_dpp v170, v30 row_newbcast:2 row_mask:0xf bank_mask:0xf
    v_mov_b32_dpp v171, v30 row_newbcast:3 row_mask:0xf bank_mask:0xf
    v_mov_b32_dpp v172, v30 row_newbcast:4 row_mask:0xf bank_mask:0xf
    v_mov_b32_dpp v173, v30 row_newbcast:5 row_mask:0xf bank_mask:0xf
    v_mov_b32_dpp v174, v30 row_newbcast:6 row_mask:0xf bank_mask:0xf
    v_mov_b32_dpp v175, v30 row_newbcast:7 row_mask:0xf bank_mask:0xf
    v_mov_b32_dpp v176, v30 row_newbcast:8 row_mask:0xf bank_mask:0xf
    v_mov_b32_dpp v177, v30 row_newbcast:9 row_mask:0xf bank_mask:0xf
    v_mov_b32_dpp v178, v30 row_newbcast:10 row_mask:0xf bank_mask:0xf
    v_mov_b32_dpp v179, v30 row_newbcast:11 row_mask:0xf bank_mask:0xf
    v_mov_b32_dpp v180, v30 row_newbcast:12 row_mask:0xf bank_mask:0xf
    v_mov_b32_dpp v181, v30 row_newbcast:13 row_mask:0xf bank_mask:0xf
    v_mov_b32_dpp v182, v30 row_newbcast:14 row_mask:0xf bank_mask:0xf
    v_mov_b32_dpp v183, v30 row_newbcast:15 row_mask:0xf bank_mask:0xf
    s_branch SCHK_29
SPOLL_28:
    s_load_dwordx2 s[24:25], s[32:33], s18 offset:0 glc
SCHK_29:
    s_add_u32 s5, s5, 1
    s_cmp_ge_u32 s5, 200000
    s_waitcnt lgkmcnt(0)
    s_cbranch_scc1 SDONE_30
    s_cmp_lg_u32 s24, s4
    s_cbranch_scc1 SPOLL_28
    s_cmp_lg_u32 s25, s4
    s_cbranch_scc1 SPOLL_28
SDONE_30:
    s_add_u32 s20, s17, s19
    buffer_load_dwordx4 v[224:227], v2, s[32:35], s20 offen sc1
    ds_read_b64_tr_b16 v[192:193], v36
    ds_read_b64_tr_b16 v[194:195], v36 offset:512
    ds_read_b64_tr_b16 v[196:197], v37
    ds_read_b64_tr_b16 v[198:199], v37 offset:512
    ds_read_b64_tr_b16 v[200:201], v38
    ds_read_b64_tr_b16 v[202:203], v38 offset:512
    ds_read_b64_tr_b16 v[204:205], v39
    ds_read_b64_tr_b16 v[206:207], v39 offset:512
    ds_read_b64_tr_b16 v[208:209], v36 offset:4096
    ds_read_b64_tr_b16 v[210:211], v36 offset:4608
    ds_read_b64_tr_b16 v[212:213], v37 offset:4096
    ds_read_b64_tr_b16 v[214:215], v37 offset:4608
    ds_read_b64_tr_b16 v[216:217], v38 offset:4096
    ds_read_b64_tr_b16 v[218:219], v38 offset:4608
    buffer_load_dwordx4 v[228:231], v2, s[32:35], s20 offen offset:1024 sc1
    buffer_load_dwordx4 v[232:235], v2, s[32:35], s20 offen offset:2048 sc1
    buffer_load_dwordx4 v[236:239], v2, s[32:35], s20 offen offset:3072 sc1
    s_barrier
    s_xor_b32 s96, s17, 4096
    s_add_u32 s20, s96, s19
    buffer_load_dwordx4 v[240:243], v2, s[32:35], s20 offen sc1
    buffer_load_dwordx4 v[244:247], v2, s[32:35], s20 offen offset:1024 sc1
    buffer_load_dwordx4 v[44:47], v2, s[32:35], s20 offen offset:2048 sc1
    buffer_load_dwordx4 v[48:51], v2, s[32:35], s20 offen offset:3072 sc1
    s_lshl_b32 s96, s21, 10
    s_add_u32 s13, s96, 14155776
    v_and_b32 v10, 15, v1
    v_lshlrev_b32 v10, 6, v10
    s_cmp_lt_u32 s3, 4
    s_cbranch_scc1 L_G2P0
    s_setprio 1
L_G2P0:
    s_waitcnt vmcnt(7)
    s_waitcnt lgkmcnt(6)
    v_mfma_f32_16x16x32_bf16 v[120:123], v[192:195], v[224:227], 0
    ds_read_b64_tr_b16 v[220:221], v39 offset:4096
    ds_read_b64_tr_b16 v[222:223], v39 offset:4608
    v_mfma_f32_16x16x32_bf16 v[124:127], v[196:199], v[224:227], 0
    ds_read_b64_tr_b16 v[192:193], v36 offset:8192
    ds_read_b64_tr_b16 v[194:195], v36 offset:8704
    v_mfma_f32_16x16x32_bf16 v[128:131], v[200:203], v[224:227], 0
    ds_read_b64_tr_b16 v[196:197], v37 offset:8192
    ds_read_b64_tr_b16 v[198:199], v37 offset:8704
    v_mfma_f32_16x16x32_bf16 v[132:135], v[204:207], v[224:227], 0
    ds_read_b64_tr_b16 v[200:201], v38 offset:8192
    ds_read_b64_tr_b16 v[202:203], v38 offset:8704
    s_xor_b32 s96, s17, 8192
    s_add_u32 s20, s96, s19
    buffer_load_dwordx4 v[224:227], v2, s[32:35], s20 offen sc1
    s_waitcnt vmcnt(7)
    s_waitcnt lgkmcnt(6)
    v_mfma_f32_16x16x32_bf16 v[120:123], v[208:211], v[228:231], v[120:123]
    ds_read_b64_tr_b16 v[204:205], v39 offset:8192
    ds_read_b64_tr_b16 v[206:207], v39 offset:8704
    v_mfma_f32_16x16x32_bf16 v[124:127], v[212:215], v[228:231], v[124:127]
    ds_read_b64_tr_b16 v[208:209], v36 offset:12288
    ds_read_b64_tr_b16 v[210:211], v36 offset:12800
    v_xor_b32 v36, 16384, v36
    v_mfma_f32_16x16x32_bf16 v[128:131], v[216:219], v[228:231], v[128:131]
    ds_read_b64_tr_b16 v[212:213], v37 offset:12288
    ds_read_b64_tr_b16 v[214:215], v37 offset:12800
    v_xor_b32 v37, 16384, v37
    v_mfma_f32_16x16x32_bf16 v[132:135], v[220:223], v[228:231], v[132:135]
    ds_read_b64_tr_b16 v[216:217], v38 offset:12288
    ds_read_b64_tr_b16 v[218:219], v38 offset:12800
    v_xor_b32 v38, 16384, v38
    buffer_load_dwordx4 v[228:231], v2, s[32:35], s20 offen offset:1024 sc1
    s_waitcnt vmcnt(7)
    s_waitcnt lgkmcnt(6)
    v_mfma_f32_16x16x32_bf16 v[120:123], v[192:195], v[232:235], v[120:123]
    ds_read_b64_tr_b16 v[220:221], v39 offset:12288
    ds_read_b64_tr_b16 v[222:223], v39 offset:12800
    v_xor_b32 v39, 16384, v39
    v_mfma_f32_16x16x32_bf16 v[124:127], v[196:199], v[232:235], v[124:127]
    ds_read_b64_tr_b16 v[192:193], v36
    ds_read_b64_tr_b16 v[194:195], v36 offset:512
    v_mfma_f32_16x16x32_bf16 v[128:131], v[200:203], v[232:235], v[128:131]
    ds_read_b64_tr_b16 v[196:197], v37
    ds_read_b64_tr_b16 v[198:199], v37 offset:512
    v_mfma_f32_16x16x32_bf16 v[132:135], v[204:207], v[232:235], v[132:135]
    ds_read_b64_tr_b16 v[200:201], v38
    ds_read_b64_tr_b16 v[202:203], v38 offset:512
    buffer_load_dwordx4 v[232:235], v2, s[32:35], s20 offen offset:2048 sc1
    s_waitcnt vmcnt(7)
    s_waitcnt lgkmcnt(6)
    v_mfma_f32_16x16x32_bf16 v[120:123], v[208:211], v[236:239], v[120:123]
    ds_read_b64_tr_b16 v[204:205], v39
    ds_read_b64_tr_b16 v[206:207], v39 offset:512
    v_mfma_f32_16x16x32_bf16 v[124:127], v[212:215], v[236:239], v[124:127]
    ds_read_b64_tr_b16 v[208:209], v36 offset:4096
    ds_read_b64_tr_b16 v[210:211], v36 offset:4608
    v_mfma_f32_16x16x32_bf16 v[128:131], v[216:219], v[236:239], v[128:131]
    ds_read_b64_tr_b16 v[212:213], v37 offset:4096
    ds_read_b64_tr_b16 v[214:215], v37 offset:4608
    v_mfma_f32_16x16x32_bf16 v[132:135], v[220:223], v[236:239], v[132:135]
    ds_read_b64_tr_b16 v[216:217], v38 offset:4096
    ds_read_b64_tr_b16 v[218:219], v38 offset:4608
    buffer_load_dwordx4 v[236:239], v2, s[32:35], s20 offen offset:3072 sc1
    s_waitcnt vmcnt(7)
    s_waitcnt lgkmcnt(6)
    v_mfma_f32_16x16x32_bf16 v[120:123], v[192:195], v[240:243], v[120:123]
    ds_read_b64_tr_b16 v[220:221], v39 offset:4096
    ds_read_b64_tr_b16 v[222:223], v39 offset:4608
    v_mfma_f32_16x16x32_bf16 v[124:127], v[196:199], v[240:243], v[124:127]
    ds_read_b64_tr_b16 v[192:193], v36 offset:8192
    ds_read_b64_tr_b16 v[194:195], v36 offset:8704
    v_mfma_f32_16x16x32_bf16 v[128:131], v[200:203], v[240:243], v[128:131]
    ds_read_b64_tr_b16 v[196:197], v37 offset:8192
    ds_read_b64_tr_b16 v[198:199], v37 offset:8704
    v_mfma_f32_16x16x32_bf16 v[132:135], v[204:207], v[240:243], v[132:135]
    ds_read_b64_tr_b16 v[200:201], v38 offset:8192
    ds_read_b64_tr_b16 v[202:203], v38 offset:8704
    s_xor_b32 s96, s17, 12288
    s_add_u32 s20, s96, s19
    buffer_load_dwordx4 v[240:243], v2, s[32:35], s20 offen sc1
    s_waitcnt vmcnt(7)
    s_waitcnt lgkmcnt(6)
    v_mfma_f32_16x16x32_bf16 v[120:123], v[208:211], v[244:247], v[120:123]
    ds_read_b64_tr_b16 v[204:205], v39 offset:8192
    ds_read_b64_tr_b16 v[206:207], v39 offset:8704
    v_mfma_f32_16x16x32_bf16 v[124:127], v[212:215], v[244:247], v[124:127]
    ds_read_b64_tr_b16 v[208:209], v36 offset:12288
    ds_read_b64_tr_b16 v[210:211], v36 offset:12800
    v_xor_b32 v36, 49152, v36
    v_mfma_f32_16x16x32_bf16 v[128:131], v[216:219], v[244:247], v[128:131]
    ds_read_b64_tr_b16 v[212:213], v37 offset:12288
    ds_read_b64_tr_b16 v[214:215], v37 offset:12800
    v_xor_b32 v37, 49152, v37
    v_mfma_f32_16x16x32_bf16 v[132:135], v[220:223], v[244:247], v[132:135]
    ds_read_b64_tr_b16 v[216:217], v38 offset:12288
    ds_read_b64_tr_b16 v[218:219], v38 offset:12800
    v_xor_b32 v38, 49152, v38
    buffer_load_dwordx4 v[244:247], v2, s[32:35], s20 offen offset:1024 sc1
    s_waitcnt vmcnt(7)
    s_waitcnt lgkmcnt(6)
    v_mfma_f32_16x16x32_bf16 v[120:123], v[192:195], v[44:47], v[120:123]
    ds_read_b64_tr_b16 v[220:221], v39 offset:12288
    ds_read_b64_tr_b16 v[222:223], v39 offset:12800
    v_xor_b32 v39, 49152, v39
    v_mfma_f32_16x16x32_bf16 v[124:127], v[196:199], v[44:47], v[124:127]
    ds_read_b64_tr_b16 v[192:193], v36
    ds_read_b64_tr_b16 v[194:195], v36 offset:512
    v_mfma_f32_16x16x32_bf16 v[128:131], v[200:203], v[44:47], v[128:131]
    ds_read_b64_tr_b16 v[196:197], v37
    ds_read_b64_tr_b16 v[198:199], v37 offset:512
    v_mfma_f32_16x16x32_bf16 v[132:135], v[204:207], v[44:47], v[132:135]
    ds_read_b64_tr_b16 v[200:201], v38
    ds_read_b64_tr_b16 v[202:203], v38 offset:512
    buffer_load_dwordx4 v[44:47], v2, s[32:35], s20 offen offset:2048 sc1
    s_waitcnt vmcnt(7)
    s_waitcnt lgkmcnt(6)
    v_mfma_f32_16x16x32_bf16 v[120:123], v[208:211], v[48:51], v[120:123]
    ds_read_b64_tr_b16 v[204:205], v39
    ds_read_b64_tr_b16 v[206:207], v39 offset:512
    v_mfma_f32_16x16x32_bf16 v[124:127], v[212:215], v[48:51], v[124:127]
    ds_read_b64_tr_b16 v[208:209], v36 offset:4096
    ds_read_b64_tr_b16 v[210:211], v36 offset:4608
    v_mfma_f32_16x16x32_bf16 v[128:131], v[216:219], v[48:51], v[128:131]
    ds_read_b64_tr_b16 v[212:213], v37 offset:4096
    ds_read_b64_tr_b16 v[214:215], v37 offset:4608
    v_mfma_f32_16x16x32_bf16 v[132:135], v[220:223], v[48:51], v[132:135]
    ds_read_b64_tr_b16 v[216:217], v38 offset:4096
    ds_read_b64_tr_b16 v[218:219], v38 offset:4608
    buffer_load_dwordx4 v[48:51], v2, s[32:35], s20 offen offset:3072 sc1
    s_waitcnt vmcnt(7)
    s_waitcnt lgkmcnt(6)
    v_mfma_f32_16x16x32_bf16 v[120:123], v[192:195], v[224:227], v[120:123]
    ds_read_b64_tr_b16 v[220:221], v39 offset:4096
    ds_read_b64_tr_b16 v[222:223], v39 offset:4608
    v_mfma_f32_16x16x32_bf16 v[124:127], v[196:199], v[224:227], v[124:127]
    ds_read_b64_tr_b16 v[192:193], v36 offset:8192
    ds_read_b64_tr_b16 v[194:195], v36 offset:8704
    v_mfma_f32_16x16x32_bf16 v[128:131], v[200:203], v[224:227], v[128:131]
    ds_read_b64_tr_b16 v[196:197], v37 offset:8192
    ds_read_b64_tr_b16 v[198:199], v37 offset:8704
    v_mfma_f32_16x16x32_bf16 v[132:135], v[204:207], v[224:227], v[132:135]
    ds_read_b64_tr_b16 v[200:201], v38 offset:8192
    ds_read_b64_tr_b16 v[202:203], v38 offset:8704
    s_xor_b32 s96, s17, 16384
    s_add_u32 s20, s96, s19
    buffer_load_dwordx4 v[224:227], v2, s[32:35], s20 offen sc1
    s_waitcnt vmcnt(7)
    s_waitcnt lgkmcnt(6)
    v_mfma_f32_16x16x32_bf16 v[120:123], v[208:211], v[228:231], v[120:123]
    ds_read_b64_tr_b16 v[204:205], v39 offset:8192
    ds_read_b64_tr_b16 v[206:207], v39 offset:8704
    v_mfma_f32_16x16x32_bf16 v[124:127], v[212:215], v[228:231], v[124:127]
    ds_read_b64_tr_b16 v[208:209], v36 offset:12288
    ds_read_b64_tr_b16 v[210:211], v36 offset:12800
    v_xor_b32 v36, 16384, v36
    v_mfma_f32_16x16x32_bf16 v[128:131], v[216:219], v[228:231], v[128:131]
    ds_read_b64_tr_b16 v[212:213], v37 offset:12288
    ds_read_b64_tr_b16 v[214:215], v37 offset:12800
    v_xor_b32 v37, 16384, v37
    v_mfma_f32_16x16x32_bf16 v[132:135], v[220:223], v[228:231], v[132:135]
    ds_read_b64_tr_b16 v[216:217], v38 offset:12288
    ds_read_b64_tr_b16 v[218:219], v38 offset:12800
    v_xor_b32 v38, 16384, v38
    buffer_load_dwordx4 v[228:231], v2, s[32:35], s20 offen offset:1024 sc1
    s_waitcnt vmcnt(7)
    s_waitcnt lgkmcnt(6)
    v_mfma_f32_16x16x32_bf16 v[120:123], v[192:195], v[232:235], v[120:123]
    ds_read_b64_tr_b16 v[220:221], v39 offset:12288
    ds_read_b64_tr_b16 v[222:223], v39 offset:12800
    v_xor_b32 v39, 16384, v39
    v_mfma_f32_16x16x32_bf16 v[124:127], v[196:199], v[232:235], v[124:127]
    ds_read_b64_tr_b16 v[192:193], v36
    ds_read_b64_tr_b16 v[194:195], v36 offset:512
    v_mfma_f32_16x16x32_bf16 v[128:131], v[200:203], v[232:235], v[128:131]
    ds_read_b64_tr_b16 v[196:197], v37
    ds_read_b64_tr_b16 v[198:199], v37 offset:512
    v_mfma_f32_16x16x32_bf16 v[132:135], v[204:207], v[232:235], v[132:135]
    ds_read_b64_tr_b16 v[200:201], v38
    ds_read_b64_tr_b16 v[202:203], v38 offset:512
    buffer_load_dwordx4 v[232:235], v2, s[32:35], s20 offen offset:2048 sc1
    s_waitcnt vmcnt(7)
    s_waitcnt lgkmcnt(6)
    v_mfma_f32_16x16x32_bf16 v[120:123], v[208:211], v[236:239], v[120:123]
    ds_read_b64_tr_b16 v[204:205], v39
    ds_read_b64_tr_b16 v[206:207], v39 offset:512
    v_mfma_f32_16x16x32_bf16 v[124:127], v[212:215], v[236:239], v[124:127]
    ds_read_b64_tr_b16 v[208:209], v36 offset:4096
    ds_read_b64_tr_b16 v[210:211], v36 offset:4608
    v_mfma_f32_16x16x32_bf16 v[128:131], v[216:219], v[236:239], v[128:131]
    ds_read_b64_tr_b16 v[212:213], v37 offset:4096
L_PAD8:
    s_cbranch_execz L_RET8
    ds_read_b64_tr_b16 v[214:215], v37 offset:4608
    v_mfma_f32_16x16x32_bf16 v[132:135], v[220:223], v[236:239], v[132:135]
    ds_read_b64_tr_b16 v[216:217], v38 offset:4096
    ds_read_b64_tr_b16 v[218:219], v38 offset:4608
    buffer_load_dwordx4 v[236:239], v2, s[32:35], s20 offen offset:3072 sc1
    s_waitcnt vmcnt(7)
    s_waitcnt lgkmcnt(6)
    v_mfma_f32_16x16x32_bf16 v[120:123], v[192:195], v[240:243], v[120:123]
    ds_read_b64_tr_b16 v[220:221], v39 offset:4096
    ds_read_b64_tr_b16 v[222:223], v39 offset:4608
    v_mfma_f32_16x16x32_bf16 v[124:127], v[196:199], v[240:243], v[124:127]
    ds_read_b64_tr_b16 v[192:193], v36 offset:8192
    ds_read_b64_tr_b16 v[194:195], v36 offset:8704
    v_mfma_f32_16x16x32_bf16 v[128:131], v[200:203], v[240:243], v[128:131]
    ds_read_b64_tr_b16 v[196:197], v37 offset:8192
    ds_read_b64_tr_b16 v[198:199], v37 offset:8704
    v_mfma_f32_16x16x32_bf16 v[132:135], v[204:207], v[240:243], v[132:135]
    ds_read_b64_tr_b16 v[200:201], v38 offset:8192
    ds_read_b64_tr_b16 v[202:203], v38 offset:8704
    s_xor_b32 s96, s17, 20480
    s_add_u32 s20, s96, s19
    buffer_load_dwordx4 v[240:243], v2, s[32:35], s20 offen sc1
    s_waitcnt vmcnt(7)
    s_waitcnt lgkmcnt(6)
    v_mfma_f32_16x16x32_bf16 v[120:123], v[208:211], v[244:247], v[120:123]
    ds_read_b64_tr_b16 v[204:205], v39 offset:8192
    ds_read_b64_tr_b16 v[206:207], v39 offset:8704
    v_mfma_f32_16x16x32_bf16 v[124:127], v[212:215], v[244:247], v[124:127]
    ds_read_b64_tr_b16 v[208:209], v36 offset:12288
    ds_read_b64_tr_b16 v[210:211], v36 offset:12800
    v_xor_b32 v36, 114688, v36
    v_mfma_f32_16x16x32_bf16 v[128:131], v[216:219], v[244:247], v[128:131]
    ds_read_b64_tr_b16 v[212:213], v37 offset:12288
    ds_read_b64_tr_b16 v[214:215], v37 offset:12800
    v_xor_b32 v37, 114688, v37
    v_mfma_f32_16x16x32_bf16 v[132:135], v[220:223], v[244:247], v[132:135]
    ds_read_b64_tr_b16 v[216:217], v38 offset:12288
    ds_read_b64_tr_b16 v[218:219], v38 offset:12800
    v_xor_b32 v38, 114688, v38
    buffer_load_dwordx4 v[244:247], v2, s[32:35], s20 offen offset:1024 sc1
    s_waitcnt vmcnt(7)
    s_waitcnt lgkmcnt(6)
    v_mfma_f32_16x16x32_bf16 v[120:123], v[192:195], v[44:47], v[120:123]
    ds_read_b64_tr_b16 v[220:221], v39 offset:12288
    ds_read_b64_tr_b16 v[222:223], v39 offset:12800
    v_xor_b32 v39, 114688, v39
    v_mfma_f32_16x16x32_bf16 v[124:127], v[196:199], v[44:47], v[124:127]
    ds_read_b64_tr_b16 v[192:193], v36
    ds_read_b64_tr_b16 v[194:195], v36 offset:512
    v_mfma_f32_16x16x32_bf16 v[128:131], v[200:203], v[44:47], v[128:131]
    ds_read_b64_tr_b16 v[196:197], v37
    ds_read_b64_tr_b16 v[198:199], v37 offset:512
    v_mfma_f32_16x16x32_bf16 v[132:135], v[204:207], v[44:47], v[132:135]
    ds_read_b64_tr_b16 v[200:201], v38
    ds_read_b64_tr_b16 v[202:203], v38 offset:512
    buffer_load_dwordx4 v[44:47], v2, s[32:35], s20 offen offset:2048 sc1
    s_waitcnt vmcnt(7)
    s_waitcnt lgkmcnt(6)
    v_mfma_f32_16x16x32_bf16 v[120:123], v[208:211], v[48:51], v[120:123]
    ds_read_b64_tr_b16 v[204:205], v39
    ds_read_b64_tr_b16 v[206:207], v39 offset:512
    v_mfma_f32_16x16x32_bf16 v[124:127], v[212:215], v[48:51], v[124:127]
    ds_read_b64_tr_b16 v[208:209], v36 offset:4096
    ds_read_b64_tr_b16 v[210:211], v36 offset:4608
    v_mfma_f32_16x16x32_bf16 v[128:131], v[216:219], v[48:51], v[128:131]
    ds_read_b64_tr_b16 v[212:213], v37 offset:4096
    ds_read_b64_tr_b16 v[214:215], v37 offset:4608
    v_mfma_f32_16x16x32_bf16 v[132:135], v[220:223], v[48:51], v[132:135]
    ds_read_b64_tr_b16 v[216:217], v38 offset:4096
    ds_read_b64_tr_b16 v[218:219], v38 offset:4608
    buffer_load_dwordx4 v[48:51], v2, s[32:35], s20 offen offset:3072 sc1
    s_waitcnt vmcnt(7)
    s_waitcnt lgkmcnt(6)
    v_mfma_f32_16x16x32_bf16 v[120:123], v[192:195], v[224:227], v[120:123]
    ds_read_b64_tr_b16 v[220:221], v39 offset:4096
    ds_read_b64_tr_b16 v[222:223], v39 offset:4608
    v_mfma_f32_16x16x32_bf16 v[124:127], v[196:199], v[224:227], v[124:127]
    ds_read_b64_tr_b16 v[192:193], v36 offset:8192
    ds_read_b64_tr_b16 v[194:195], v36 offset:8704
    v_mfma_f32_16x16x32_bf16 v[128:131], v[200:203], v[224:227], v[128:131]
    ds_read_b64_tr_b16 v[196:197], v37 offset:8192
    ds_read_b64_tr_b16 v[198:199], v37 offset:8704
    v_mfma_f32_16x16x32_bf16 v[132:135], v[204:207], v[224:227], v[132:135]
    ds_read_b64_tr_b16 v[200:201], v38 offset:8192
    ds_read_b64_tr_b16 v[202:203], v38 offset:8704
    s_xor_b32 s96, s17, 24576
    s_add_u32 s20, s96, s19
    buffer_load_dwordx4 v[224:227], v2, s[32:35], s20 offen sc1
    s_waitcnt vmcnt(7)
    s_waitcnt lgkmcnt(6)
    v_mfma_f32_16x16x32_bf16 v[120:123], v[208:211], v[228:231], v[120:123]
    ds_read_b64_tr_b16 v[204:205], v39 offset:8192
    ds_read_b64_tr_b16 v[206:207], v39 offset:8704
    v_mfma_f32_16x16x32_bf16 v[124:127], v[212:215], v[228:231], v[124:127]
    ds_read_b64_tr_b16 v[208:209], v36 offset:12288
    ds_read_b64_tr_b16 v[210:211], v36 offset:12800
    v_xor_b32 v36, 16384, v36
    v_mfma_f32_16x16x32_bf16 v[128:131], v[216:219], v[228:231], v[128:131]
    ds_read_b64_tr_b16 v[212:213], v37 offset:12288
    ds_read_b64_tr_b16 v[214:215], v37 offset:12800
    v_xor_b32 v37, 16384, v37
    v_mfma_f32_16x16x32_bf16 v[132:135], v[220:223], v[228:231], v[132:135]
    ds_read_b64_tr_b16 v[216:217], v38 offset:12288
    ds_read_b64_tr_b16 v[218:219], v38 offset:12800
    v_xor_b32 v38, 16384, v38
    buffer_load_dwordx4 v[228:231], v2, s[32:35], s20 offen offset:1024 sc1
    s_waitcnt vmcnt(7)
    s_waitcnt lgkmcnt(6)
    v_mfma_f32_16x16x32_bf16 v[120:123], v[192:195], v[232:235], v[120:123]
    ds_read_b64_tr_b16 v[220:221], v39 offset:12288
    ds_read_b64_tr_b16 v[222:223], v39 offset:12800
    v_xor_b32 v39, 16384, v39
    v_mfma_f32_16x16x32_bf16 v[124:127], v[196:199], v[232:235], v[124:127]
    ds_read_b64_tr_b16 v[192:193], v36
    ds_read_b64_tr_b16 v[194:195], v36 offset:512
    v_mfma_f32_16x16x32_bf16 v[128:131], v[200:203], v[232:235], v[128:131]
    ds_read_b64_tr_b16 v[196:197], v37
    ds_read_b64_tr_b16 v[198:199], v37 offset:512
    v_mfma_f32_16x16x32_bf16 v[132:135], v[204:207], v[232:235], v[132:135]
    ds_read_b64_tr_b16 v[200:201], v38
    ds_read_b64_tr_b16 v[202:203], v38 offset:512
    buffer_load_dwordx4 v[232:235], v2, s[32:35], s20 offen offset:2048 sc1
    s_waitcnt vmcnt(7)
    s_waitcnt lgkmcnt(6)
    v_mfma_f32_16x16x32_bf16 v[120:123], v[208:211], v[236:239], v[120:123]
    ds_read_b64_tr_b16 v[204:205], v39
    ds_read_b64_tr_b16 v[206:207], v39 offset:512
    v_mfma_f32_16x16x32_bf16 v[124:127], v[212:215], v[236:239], v[124:127]
    ds_read_b64_tr_b16 v[208:209], v36 offset:4096
    ds_read_b64_tr_b16 v[210:211], v36 offset:4608
    v_mfma_f32_16x16x32_bf16 v[128:131], v[216:219], v[236:239], v[128:131]
    ds_read_b64_tr_b16 v[212:213], v37 offset:4096
    ds_read_b64_tr_b16 v[214:215], v37 offset:4608
    v_mfma_f32_16x16x32_bf16 v[132:135], v[220:223], v[236:239], v[132:135]
    ds_read_b64_tr_b16 v[216:217], v38 offset:4096
    ds_read_b64_tr_b16 v[218:219], v38 offset:4608
    buffer_load_dwordx4 v[236:239], v2, s[32:35], s20 offen offset:3072 sc1
    s_waitcnt vmcnt(7)
    s_waitcnt lgkmcnt(6)
    v_mfma_f32_16x16x32_bf16 v[120:123], v[192:195], v[240:243], v[120:123]
    ds_read_b64_tr_b16 v[220:221], v39 offset:4096
    ds_read_b64_tr_b16 v[222:223], v39 offset:4608
    v_mfma_f32_16x16x32_bf16 v[124:127], v[196:199], v[240:243], v[124:127]
    ds_read_b64_tr_b16 v[192:193], v36 offset:8192
    ds_read_b64_tr_b16 v[194:195], v36 offset:8704
    v_mfma_f32_16x16x32_bf16 v[128:131], v[200:203], v[240:243], v[128:131]
    ds_read_b64_tr_b16 v[196:197], v37 offset:8192
    ds_read_b64_tr_b16 v[198:199], v37 offset:8704
    v_mfma_f32_16x16x32_bf16 v[132:135], v[204:207], v[240:243], v[132:135]
    ds_read_b64_tr_b16 v[200:201], v38 offset:8192
    ds_read_b64_tr_b16 v[202:203], v38 offset:8704
    s_xor_b32 s96, s17, 28672
    s_add_u32 s20, s96, s19
    buffer_load_dwordx4 v[240:243], v2, s[32:35], s20 offen sc1
    s_waitcnt vmcnt(7)
    s_waitcnt lgkmcnt(6)
    v_mfma_f32_16x16x32_bf16 v[120:123], v[208:211], v[244:247], v[120:123]
    ds_read_b64_tr_b16 v[204:205], v39 offset:8192
    ds_read_b64_tr_b16 v[206:207], v39 offset:8704
    v_mfma_f32_16x16x32_bf16 v[124:127], v[212:215], v[244:247], v[124:127]
    ds_read_b64_tr_b16 v[208:209], v36 offset:12288
    ds_read_b64_tr_b16 v[210:211], v36 offset:12800
    v_xor_b32 v36, 49152, v36
    v_mfma_f32_16x16x32_bf16 v[128:131], v[216:219], v[244:247], v[128:131]
    ds_read_b64_tr_b16 v[212:213], v37 offset:12288
    ds_read_b64_tr_b16 v[214:215], v37 offset:12800
    v_xor_b32 v37, 49152, v37
    v_mfma_f32_16x16x32_bf16 v[132:135], v[220:223], v[244:247], v[132:135]
    ds_read_b64_tr_b16 v[216:217], v38 offset:12288
    ds_read_b64_tr_b16 v[218:219], v38 offset:12800
    v_xor_b32 v38, 49152, v38
    buffer_load_dwordx4 v[244:247], v2, s[32:35], s20 offen offset:1024 sc1
    s_waitcnt vmcnt(7)
    s_waitcnt lgkmcnt(6)
    v_mfma_f32_16x16x32_bf16 v[120:123], v[192:195], v[44:47], v[120:123]
    ds_read_b64_tr_b16 v[220:221], v39 offset:12288
    ds_read_b64_tr_b16 v[222:223], v39 offset:12800
    v_xor_b32 v39, 49152, v39
    v_mfma_f32_16x16x32_bf16 v[124:127], v[196:199], v[44:47], v[124:127]
    ds_read_b64_tr_b16 v[192:193], v36
    ds_read_b64_tr_b16 v[194:195], v36 offset:512
    v_mfma_f32_16x16x32_bf16 v[128:131], v[200:203], v[44:47], v[128:131]
    ds_read_b64_tr_b16 v[196:197], v37
    ds_read_b64_tr_b16 v[198:199], v37 offset:512
    v_mfma_f32_16x16x32_bf16 v[132:135], v[204:207], v[44:47], v[132:135]
    ds_read_b64_tr_b16 v[200:201], v38
    ds_read_b64_tr_b16 v[202:203], v38 offset:512
    buffer_load_dwordx4 v[44:47], v2, s[32:35], s20 offen offset:2048 sc1
    s_waitcnt vmcnt(7)
    s_waitcnt lgkmcnt(6)
    v_mfma_f32_16x16x32_bf16 v[120:123], v[208:211], v[48:51], v[120:123]
    ds_read_b64_tr_b16 v[204:205], v39
    ds_read_b64_tr_b16 v[206:207], v39 offset:512
    v_mfma_f32_16x16x32_bf16 v[124:127], v[212:215], v[48:51], v[124:127]
    ds_read_b64_tr_b16 v[208:209], v36 offset:4096
    ds_read_b64_tr_b16 v[210:211], v36 offset:4608
    v_mfma_f32_16x16x32_bf16 v[128:131], v[216:219], v[48:51], v[128:131]
    ds_read_b64_tr_b16 v[212:213], v37 offset:4096
    ds_read_b64_tr_b16 v[214:215], v37 offset:4608
    v_mfma_f32_16x16x32_bf16 v[132:135], v[220:223], v[48:51], v[132:135]
    ds_read_b64_tr_b16 v[216:217], v38 offset:4096
    ds_read_b64_tr_b16 v[218:219], v38 offset:4608
    buffer_load_dwordx4 v[48:51], v2, s[32:35], s20 offen offset:3072 sc1
    buffer_load_dwordx2 v[40:41], v10, s[32:35], s13 offen sc1
    s_add_u32 s82, s80, 114688
    buffer_load_dwordx4 v[72:75], v27, s[52:55], s82 offen nt
    s_add_u32 s82, s80, 172032
    buffer_load_dwordx4 v[76:79], v27, s[52:55], s82 offen nt
    s_waitcnt vmcnt(10)
    s_waitcnt lgkmcnt(6)
    v_mfma_f32_16x16x32_bf16 v[120:123], v[192:195], v[224:227], v[120:123]
    ds_read_b64_tr_b16 v[220:221], v39 offset:4096
    ds_read_b64_tr_b16 v[222:223], v39 offset:4608
    v_mfma_f32_16x16x32_bf16 v[124:127], v[196:199], v[224:227], v[124:127]
    ds_read_b64_tr_b16 v[192:193], v36 offset:8192
    ds_read_b64_tr_b16 v[194:195], v36 offset:8704
    v_mfma_f32_16x16x32_bf16 v[128:131], v[200:203], v[224:227], v[128:131]
    ds_read_b64_tr_b16 v[196:197], v37 offset:8192
    ds_read_b64_tr_b16 v[198:199], v37 offset:8704
    v_mfma_f32_16x16x32_bf16 v[132:135], v[204:207], v[224:227], v[132:135]
    ds_read_b64_tr_b16 v[200:201], v38 offset:8192
    ds_read_b64_tr_b16 v[202:203], v38 offset:8704
    s_waitcnt vmcnt(9)
    s_waitcnt lgkmcnt(6)
    v_mfma_f32_16x16x32_bf16 v[120:123], v[208:211], v[228:231], v[120:123]
    ds_read_b64_tr_b16 v[204:205], v39 offset:8192
    ds_read_b64_tr_b16 v[206:207], v39 offset:8704
    v_mfma_f32_16x16x32_bf16 v[124:127], v[212:215], v[228:231], v[124:127]
    ds_read_b64_tr_b16 v[208:209], v36 offset:12288
    ds_read_b64_tr_b16 v[210:211], v36 offset:12800
    v_xor_b32 v36, 16384, v36
    v_mfma_f32_16x16x32_bf16 v[128:131], v[216:219], v[228:231], v[128:131]
    ds_read_b64_tr_b16 v[212:213], v37 offset:12288
    ds_read_b64_tr_b16 v[214:215], v37 offset:12800
    v_xor_b32 v37, 16384, v37
    v_mfma_f32_16x16x32_bf16 v[132:135], v[220:223], v[228:231], v[132:135]
    ds_read_b64_tr_b16 v[216:217], v38 offset:12288
    ds_read_b64_tr_b16 v[218:219], v38 offset:12800
    v_xor_b32 v38, 16384, v38
    s_waitcnt vmcnt(8)
    s_waitcnt lgkmcnt(6)
    v_mfma_f32_16x16x32_bf16 v[120:123], v[192:195], v[232:235], v[120:123]
    ds_read_b64_tr_b16 v[220:221], v39 offset:12288
    ds_read_b64_tr_b16 v[222:223], v39 offset:12800
    v_xor_b32 v39, 16384, v39
    v_mfma_f32_16x16x32_bf16 v[124:127], v[196:199], v[232:235], v[124:127]
    ds_read_b64_tr_b16 v[192:193], v36
    ds_read_b64_tr_b16 v[194:195], v36 offset:512
    v_mfma_f32_16x16x32_bf16 v[128:131], v[200:203], v[232:235], v[128:131]
    ds_read_b64_tr_b16 v[196:197], v37
    ds_read_b64_tr_b16 v[198:199], v37 offset:512
    v_mfma_f32_16x16x32_bf16 v[132:135], v[204:207], v[232:235], v[132:135]
    ds_read_b64_tr_b16 v[200:201], v38
    ds_read_b64_tr_b16 v[202:203], v38 offset:512
    s_waitcnt vmcnt(7)
    s_waitcnt lgkmcnt(6)
    v_mfma_f32_16x16x32_bf16 v[120:123], v[208:211], v[236:239], v[120:123]
    ds_read_b64_tr_b16 v[204:205], v39
    ds_read_b64_tr_b16 v[206:207], v39 offset:512
    v_mfma_f32_16x16x32_bf16 v[124:127], v[212:215], v[236:239], v[124:127]
    ds_read_b64_tr_b16 v[208:209], v36 offset:4096
    ds_read_b64_tr_b16 v[210:211], v36 offset:4608
    v_mfma_f32_16x16x32_bf16 v[128:131], v[216:219], v[236:239], v[128:131]
    ds_read_b64_tr_b16 v[212:213], v37 offset:4096
    ds_read_b64_tr_b16 v[214:215], v37 offset:4608
    v_mfma_f32_16x16x32_bf16 v[132:135], v[220:223], v[236:239], v[132:135]
    ds_read_b64_tr_b16 v[216:217], v38 offset:4096
    ds_read_b64_tr_b16 v[218:219], v38 offset:4608
    s_cmp_lt_u32 s3, 4
    s_cbranch_scc1 L_G2P28
    s_setprio 0
L_G2P28:
    s_waitcnt vmcnt(6)
    s_waitcnt lgkmcnt(6)
    v_mfma_f32_16x16x32_bf16 v[120:123], v[192:195], v[240:243], v[120:123]
    ds_read_b64_tr_b16 v[220:221], v39 offset:4096
    ds_read_b64_tr_b16 v[222:223], v39 offset:4608
    v_mfma_f32_16x16x32_bf16 v[124:127], v[196:199], v[240:243], v[124:127]
    ds_read_b64_tr_b16 v[192:193], v36 offset:8192
    ds_read_b64_tr_b16 v[194:195], v36 offset:8704
    v_mfma_f32_16x16x32_bf16 v[128:131], v[200:203], v[240:243], v[128:131]
    ds_read_b64_tr_b16 v[196:197], v37 offset:8192
    ds_read_b64_tr_b16 v[198:199], v37 offset:8704
    v_mfma_f32_16x16x32_bf16 v[132:135], v[204:207], v[240:243], v[132:135]
    ds_read_b64_tr_b16 v[200:201], v38 offset:8192
    ds_read_b64_tr_b16 v[202:203], v38 offset:8704
    s_waitcnt vmcnt(5)
    s_waitcnt lgkmcnt(6)
    v_mfma_f32_16x16x32_bf16 v[120:123], v[208:211], v[244:247], v[120:123]
    ds_read_b64_tr_b16 v[204:205], v39 offset:8192
    ds_read_b64_tr_b16 v[206:207], v39 offset:8704
    v_mfma_f32_16x16x32_bf16 v[124:127], v[212:215], v[244:247], v[124:127]
    ds_read_b64_tr_b16 v[208:209], v36 offset:12288
    ds_read_b64_tr_b16 v[210:211], v36 offset:12800
    v_mfma_f32_16x16x32_bf16 v[128:131], v[216:219], v[244:247], v[128:131]
    ds_read_b64_tr_b16 v[212:213], v37 offset:12288
    ds_read_b64_tr_b16 v[214:215], v37 offset:12800
    v_mfma_f32_16x16x32_bf16 v[132:135], v[220:223], v[244:247], v[132:135]
    ds_read_b64_tr_b16 v[216:217], v38 offset:12288
    ds_read_b64_tr_b16 v[218:219], v38 offset:12800
    s_waitcnt vmcnt(4)
    s_waitcnt lgkmcnt(6)
    v_mfma_f32_16x16x32_bf16 v[120:123], v[192:195], v[44:47], v[120:123]
    ds_read_b64_tr_b16 v[220:221], v39 offset:12288
    ds_read_b64_tr_b16 v[222:223], v39 offset:12800
    v_mfma_f32_16x16x32_bf16 v[124:127], v[196:199], v[44:47], v[124:127]
    v_mfma_f32_16x16x32_bf16 v[128:131], v[200:203], v[44:47], v[128:131]
    v_mfma_f32_16x16x32_bf16 v[132:135], v[204:207], v[44:47], v[132:135]
    s_waitcnt vmcnt(3)
    s_waitcnt lgkmcnt(0)
    v_mfma_f32_16x16x32_bf16 v[120:123], v[208:211], v[48:51], v[120:123]
    v_mfma_f32_16x16x32_bf16 v[124:127], v[212:215], v[48:51], v[124:127]
    v_mfma_f32_16x16x32_bf16 v[128:131], v[216:219], v[48:51], v[128:131]
    v_mfma_f32_16x16x32_bf16 v[132:135], v[220:223], v[48:51], v[132:135]
    s_lshl3_add_u32 s96, s21, s3
    s_lshl4_add_u32 s97, s96, s12
    s_lshl_b32 s98, s97, 8
    s_add_u32 s14, s98, 12582912
    v_and_b32 v28, 15, v1
    v_lshlrev_b32 v28, 4, v28
    v_lshrrev_b32 v9, 4, v1
    v_lshl_add_u32 v28, v9, 2, v28
    v_cvt_pk_bf16_f32 v120, 0, v120
    v_cvt_pk_bf16_f32 v121, 0, v121
    v_cvt_pk_bf16_f32 v122, 0, v122
    v_cvt_pk_bf16_f32 v123, 0, v123
    v_cvt_pk_bf16_f32 v124, 0, v124
    v_cvt_pk_bf16_f32 v125, 0, v125
    v_cvt_pk_bf16_f32 v126, 0, v126
    v_cvt_pk_bf16_f32 v127, 0, v127
    v_pk_mul_f32 v[120:121], v[120:121], v[136:137]
    v_pk_mul_f32 v[122:123], v[122:123], v[138:139]
    v_pk_mul_f32 v[124:125], v[124:125], v[140:141]
    v_pk_mul_f32 v[126:127], v[126:127], v[142:143]
    v_cvt_pk_bf16_f32 v120, 0, v120
    v_cvt_pk_bf16_f32 v121, 0, v121
    v_cvt_pk_bf16_f32 v122, 0, v122
    v_cvt_pk_bf16_f32 v123, 0, v123
    v_cvt_pk_bf16_f32 v124, 0, v124
    v_cvt_pk_bf16_f32 v125, 0, v125
    v_cvt_pk_bf16_f32 v126, 0, v126
    v_cvt_pk_bf16_f32 v127, 0, v127
    v_pk_add_f32 v[120:121], v[120:121], v[152:153]
    v_pk_add_f32 v[122:123], v[122:123], v[154:155]
    v_pk_add_f32 v[124:125], v[124:125], v[156:157]
    v_pk_add_f32 v[126:127], v[126:127], v[158:159]
    v_cvt_pk_bf16_f32 v12, v120, v121
    v_cvt_pk_bf16_f32 v13, v122, v123
    v_cvt_pk_bf16_f32 v14, v124, v125
    v_cvt_pk_bf16_f32 v15, v126, v127
    v_dot2_f32_bf16 v4, v12, v12, 0
    v_dot2_f32_bf16 v5, v13, v13, 0
    v_dot2_f32_bf16 v4, v14, v14, v4
    v_dot2_f32_bf16 v5, v15, v15, v5
    v_mfma_f32_16x16x32_bf16 v[240:243], v[184:187], v[12:15], 0
    v_cvt_pk_bf16_f32 v128, 0, v128
    v_cvt_pk_bf16_f32 v129, 0, v129
    v_cvt_pk_bf16_f32 v130, 0, v130
    v_cvt_pk_bf16_f32 v131, 0, v131
    v_cvt_pk_bf16_f32 v132, 0, v132
    v_cvt_pk_bf16_f32 v133, 0, v133
    v_cvt_pk_bf16_f32 v134, 0, v134
    v_cvt_pk_bf16_f32 v135, 0, v135
    v_pk_mul_f32 v[128:129], v[128:129], v[144:145]
    v_pk_mul_f32 v[130:131], v[130:131], v[146:147]
    v_pk_mul_f32 v[132:133], v[132:133], v[148:149]
    v_pk_mul_f32 v[134:135], v[134:135], v[150:151]
    v_cvt_pk_bf16_f32 v128, 0, v128
    v_cvt_pk_bf16_f32 v129, 0, v129
    v_cvt_pk_bf16_f32 v130, 0, v130
    v_cvt_pk_bf16_f32 v131, 0, v131
    v_cvt_pk_bf16_f32 v132, 0, v132
    v_cvt_pk_bf16_f32 v133, 0, v133
    v_cvt_pk_bf16_f32 v134, 0, v134
    v_cvt_pk_bf16_f32 v135, 0, v135
    v_pk_add_f32 v[128:129], v[128:129], v[160:161]
    v_pk_add_f32 v[130:131], v[130:131], v[162:163]
    v_pk_add_f32 v[132:133], v[132:133], v[164:165]
    v_pk_add_f32 v[134:135], v[134:135], v[166:167]
    v_cvt_pk_bf16_f32 v16, v128, v129
    v_cvt_pk_bf16_f32 v17, v130, v131
    v_cvt_pk_bf16_f32 v18, v132, v133
    v_cvt_pk_bf16_f32 v19, v134, v135
    v_dot2_f32_bf16 v4, v16, v16, v4
    v_dot2_f32_bf16 v5, v17, v17, v5
    v_dot2_f32_bf16 v4, v18, v18, v4
    v_dot2_f32_bf16 v5, v19, v19, v5
    v_mfma_f32_16x16x32_bf16 v[240:243], v[188:191], v[16:19], v[240:243]
    v_and_b32 v7, 7, v1
    v_lshlrev_b32 v7, 15, v7
    v_bfe_u32 v9, v1, 3, 1
    v_lshl_add_u32 v7, v9, 12, v7
    v_add_f32 v4, v4, v5
    v_mov_b32 v5, v4
    s_nop 1
    v_permlane32_swap_b32 v4, v5
    v_add_f32 v4, v4, v5
    v_mov_b32 v5, v4
    s_nop 1
    v_permlane16_swap_b32 v4, v5
    v_add_f32 v4, v4, v5
    s_nop 1
    v_mov_b32_dpp v240, v4 quad_perm:[0,1,2,3] row_mask:0x8 bank_mask:0xf
    buffer_store_dword v240, v28, s[32:35], s14 offen sc1
    s_and_b32 s96, s12, 1
    s_lshr_b32 s97, s21, 2
    s_and_b32 s98, s21, 3
    s_lshl_b32 s99, s98, 6
    s_lshl1_add_u32 s98, s97, s99
    s_lshl_b32 s97, s98, 12
    s_lshr_b32 s99, s12, 1
    s_lshl_b32 s98, s99, 6
    s_add_u32 s99, s97, s98
    s_lshl2_add_u32 s97, s96, s99
    s_add_u32 s98, s97, 1048576
    s_add_u32 s16, s98, 1536
    s_barrier
    s_cmp_lg_u32 s3, 0
    s_cbranch_scc1 L_PE
    v_mov_b32 v6, s4
    s_mov_b32 exec_hi, 0
    s_mov_b32 exec_lo, 65535
    buffer_store_dword v6, v7, s[32:35], s16 offen sc1
    s_mov_b64 exec, -1
L_PE:
    s_mov_b32 s82, s80
    s_lshl2_add_u32 m0, s83, 32768
    s_nop 0
    buffer_load_dwordx4 v27, s[56:59], s82 offen nt lds
    s_add_u32 s82, s80, 57344
    s_lshl2_add_u32 m0, s83, 33792
    s_nop 0
    buffer_load_dwordx4 v27, s[56:59], s82 offen nt lds
    s_lshl_b32 s15, s3, 12
    v_add_u32 v4, s15, v2
    v_add_u32 v7, 65536, v4
    s_waitcnt vmcnt(5)
    v_cmp_ne_u32 vcc, s4, v41
    s_cbranch_vccz L_UPOK
POLL_31:
    buffer_load_dwordx2 v[40:41], v10, s[32:35], s13 offen sc1
    s_waitcnt vmcnt(0)
    v_cmp_ne_u32 vcc, s4, v41
    s_cbranch_vccz PDONE_32
    s_add_u32 s5, s5, 1
    s_cmp_lt_u32 s5, 200000
    s_cbranch_scc1 POLL_31
PDONE_32:
L_UPOK:
    s_lshl3_add_u32 s96, s21, s3
    s_lshl_b32 s97, s96, 12
    s_add_u32 s14, s97, 12582912
    s_load_dwordx2 s[24:25], s[32:33], s92 offset:1536 glc
    v_add_f32_dpp v40, v40, v40 quad_perm:[1,0,3,2] row_mask:0xf bank_mask:0xf
    s_nop 1
    v_add_f32_dpp v40, v40, v40 quad_perm:[2,3,0,1] row_mask:0xf bank_mask:0xf
    s_nop 1
    v_add_f32_dpp v40, v40, v40 row_half_mirror row_mask:0xf bank_mask:0xf
    s_nop 1
    v_add_f32_dpp v40, v40, v40 row_mirror row_mask:0xf bank_mask:0xf
    v_lshlrev_b32 v152, 16, v12
    v_and_b32 v153, s6, v12
    v_lshlrev_b32 v154, 16, v13
    v_and_b32 v155, s6, v13
    v_lshlrev_b32 v156, 16, v14
    v_and_b32 v157, s6, v14
    v_lshlrev_b32 v158, 16, v15
    v_and_b32 v159, s6, v15
    v_lshlrev_b32 v160, 16, v16
    v_and_b32 v161, s6, v16
    v_lshlrev_b32 v162, 16, v17
    v_and_b32 v163, s6, v17
    v_lshlrev_b32 v164, 16, v18
    v_and_b32 v165, s6, v18
    v_lshlrev_b32 v166, 16, v19
    v_and_b32 v167, s6, v19
    s_lshl_b32 s96, s3, 9
    s_lshl1_add_u32 s15, s21, s96
    v_and_b32 v29, 15, v1
    v_lshl_add_u32 v29, v29, 5, s15
    v_xor_b32 v5, 0x4000, v4
    v_xor_b32 v8, 0x4000, v7
    s_waitcnt vmcnt(3)
    ds_write_b128 v4, v[72:75] offset:2048
    ds_write_b128 v4, v[76:79] offset:3072
    s_cmp_lt_u32 s3, 4
    s_cbranch_scc1 L_FW1
    ds_write_b128 v4, v[56:59] offset:0
    ds_write_b128 v5, v[60:63] offset:0
    ds_write_b128 v4, v[64:67] offset:1024
    ds_write_b128 v5, v[68:71] offset:1024
L_FW1:
    s_branch SCHK_34
SPOLL_33:
    s_load_dwordx2 s[24:25], s[32:33], s92 offset:1536 glc
SCHK_34:
    s_add_u32 s5, s5, 1
    s_cmp_ge_u32 s5, 200000
    s_waitcnt lgkmcnt(0)
    s_cbranch_scc1 SDONE_35
    s_cmp_lg_u32 s24, s4
    s_cbranch_scc1 SPOLL_33
    s_cmp_lg_u32 s25, s4
    s_cbranch_scc1 SPOLL_33
SDONE_35:
    s_barrier
    buffer_load_dwordx4 v[192:195], v2, s[32:35], s14 offen sc1
    buffer_load_dwordx4 v[196:199], v2, s[32:35], s14 offen offset:1024 sc1
    buffer_load_dwordx4 v[200:203], v2, s[32:35], s14 offen offset:2048 sc1
    buffer_load_dwordx4 v[204:207], v2, s[32:35], s14 offen offset:3072 sc1
    s_barrier
    s_add_u32 s82, s80, 114688
    s_lshl2_add_u32 m0, s83, 34816
    s_nop 0
    buffer_load_dwordx4 v27, s[56:59], s82 offen nt lds
    s_add_u32 s82, s80, 172032
    s_lshl2_add_u32 m0, s83, 35840
    s_nop 0
    buffer_load_dwordx4 v27, s[56:59], s82 offen nt lds
    s_mov_b32 s82, s81
    s_lshl2_add_u32 m0, s83, 65536
    s_nop 0
    buffer_load_dwordx4 v253, s[60:63], s82 offen nt lds
    s_add_u32 s82, s81, 4096
    s_lshl2_add_u32 m0, s83, 66560
    s_nop 0
    buffer_load_dwordx4 v253, s[60:63], s82 offen nt lds
    v_mov_b32_dpp v88, v42 row_newbcast:0 row_mask:0xf bank_mask:0xf
    v_mov_b32_dpp v89, v42 row_newbcast:1 row_mask:0xf bank_mask:0xf
    v_mov_b32_dpp v90, v42 row_newbcast:2 row_mask:0xf bank_mask:0xf
    v_mov_b32_dpp v91, v42 row_newbcast:3 row_mask:0xf bank_mask:0xf
    v_mov_b32_dpp v92, v42 row_newbcast:4 row_mask:0xf bank_mask:0xf
    v_mov_b32_dpp v93, v42 row_newbcast:5 row_mask:0xf bank_mask:0xf
    v_mov_b32_dpp v94, v42 row_newbcast:6 row_mask:0xf bank_mask:0xf
    v_mov_b32_dpp v95, v42 row_newbcast:7 row_mask:0xf bank_mask:0xf
    v_mov_b32_dpp v96, v42 row_newbcast:8 row_mask:0xf bank_mask:0xf
    v_mov_b32_dpp v97, v42 row_newbcast:9 row_mask:0xf bank_mask:0xf
    v_mov_b32_dpp v98, v42 row_newbcast:10 row_mask:0xf bank_mask:0xf
    v_mov_b32_dpp v99, v42 row_newbcast:11 row_mask:0xf bank_mask:0xf
    v_mov_b32_dpp v100, v42 row_newbcast:12 row_mask:0xf bank_mask:0xf
    v_mov_b32_dpp v101, v42 row_newbcast:13 row_mask:0xf bank_mask:0xf
    v_mov_b32_dpp v102, v42 row_newbcast:14 row_mask:0xf bank_mask:0xf
    v_mov_b32_dpp v103, v42 row_newbcast:15 row_mask:0xf bank_mask:0xf
    v_mov_b32_dpp v104, v43 row_newbcast:0 row_mask:0xf bank_mask:0xf
    v_mov_b32_dpp v105, v43 row_newbcast:1 row_mask:0xf bank_mask:0xf
    v_mov_b32_dpp v106, v43 row_newbcast:2 row_mask:0xf bank_mask:0xf
    v_mov_b32_dpp v107, v43 row_newbcast:3 row_mask:0xf bank_mask:0xf
    v_mov_b32_dpp v108, v43 row_newbcast:4 row_mask:0xf bank_mask:0xf
    v_mov_b32_dpp v109, v43 row_newbcast:5 row_mask:0xf bank_mask:0xf
    v_mov_b32_dpp v110, v43 row_newbcast:6 row_mask:0xf bank_mask:0xf
    v_mov_b32_dpp v111, v43 row_newbcast:7 row_mask:0xf bank_mask:0xf
    v_mov_b32_dpp v112, v43 row_newbcast:8 row_mask:0xf bank_mask:0xf
    v_mov_b32_dpp v113, v43 row_newbcast:9 row_mask:0xf bank_mask:0xf
    v_mov_b32_dpp v114, v43 row_newbcast:10 row_mask:0xf bank_mask:0xf
    v_mov_b32_dpp v115, v43 row_newbcast:11 row_mask:0xf bank_mask:0xf
    v_mov_b32_dpp v116, v43 row_newbcast:12 row_mask:0xf bank_mask:0xf
    v_mov_b32_dpp v117, v43 row_newbcast:13 row_mask:0xf bank_mask:0xf
    v_mov_b32_dpp v118, v43 row_newbcast:14 row_mask:0xf bank_mask:0xf
    v_mov_b32_dpp v119, v43 row_newbcast:15 row_mask:0xf bank_mask:0xf
    s_lshl3_add_u32 s15, s3, 156160
    v_mov_b32 v4, s15
    v_and_b32 v5, 7, v1
    v_lshlrev_b32 v5, 3, v5
    v_add_u32 v5, 156160, v5
    v_and_b32 v6, 3, v1
    v_lshlrev_b32 v6, 18, v6
    v_bfe_u32 v9, v1, 2, 2
    v_lshl_add_u32 v6, v9, 13, v6
    s_and_b32 s96, s21, 1
    s_and_b32 s97, s12, 7
    s_lshr_b32 s98, s12, 3
    s_lshl3_add_u32 s99, s97, s98
    s_lshl_b32 s97, s99, 12
    s_lshr_b32 s98, s21, 1
    s_lshl_b32 s99, s98, 6
    s_add_u32 s98, s97, s99
    s_lshl4_add_u32 s97, s96, s98
    s_add_u32 s99, s97, 1048576
    s_add_u32 s16, s99, 2560
    s_waitcnt vmcnt(4)
    v_pk_add_f32 v[192:193], v[192:193], v[196:197]
    v_pk_add_f32 v[200:201], v[200:201], v[204:205]
    v_pk_add_f32 v[194:195], v[194:195], v[198:199]
    v_pk_add_f32 v[202:203], v[202:203], v[206:207]
    v_pk_add_f32 v[192:193], v[192:193], v[200:201]
    v_pk_add_f32 v[194:195], v[194:195], v[202:203]
    v_add_f32 v193, v193, v194
    v_add_f32 v197, v192, v195
    v_cmp_u_f32 vcc, v193, v197
    s_cbranch_vccz POK_37
PRE_38:
    buffer_load_dwordx4 v[192:195], v2, s[32:35], s14 offen sc1
    buffer_load_dwordx4 v[196:199], v2, s[32:35], s14 offen offset:1024 sc1
    buffer_load_dwordx4 v[200:203], v2, s[32:35], s14 offen offset:2048 sc1
    buffer_load_dwordx4 v[204:207], v2, s[32:35], s14 offen offset:3072 sc1
    s_waitcnt vmcnt(0)
    v_pk_add_f32 v[192:193], v[192:193], v[196:197]
    v_pk_add_f32 v[200:201], v[200:201], v[204:205]
    v_pk_add_f32 v[194:195], v[194:195], v[198:199]
L_PAD9:
    s_cbranch_execz L_RET9
    v_pk_add_f32 v[202:203], v[202:203], v[206:207]
    v_pk_add_f32 v[192:193], v[192:193], v[200:201]
    v_pk_add_f32 v[194:195], v[194:195], v[202:203]
    v_add_f32 v193, v193, v194
    v_add_f32 v197, v192, v195
    v_cmp_u_f32 vcc, v193, v197
    s_cbranch_vccz POK_37
    s_add_u32 s5, s5, 1
    s_cmp_lt_u32 s5, 200000
    s_cbranch_scc1 PRE_38
POK_37:
    v_mov_b32 v196, v195
    s_nop 1
    v_permlane32_swap_b32 v195, v196
    v_permlane32_swap_b32 v192, v193
    v_add_f32 v195, v195, v196
    v_add_f32 v192, v192, v193
    s_nop 1
    v_permlane16_swap_b32 v192, v195
    v_add_f32 v193, v192, v195
    v_add_f32 v195, v192, v195
    s_nop 1
    v_permlane16_swap_b32 v193, v195
    v_mov_b32 v192, v193
    v_mul_f32 v195, 0x3a800000, v195
    s_nop 0
    v_permlane32_swap_b32 v192, v193
    v_mul_f32 v192, 0x3a800000, v192
    v_fma_f32 v31, -v192, v192, v195
    v_cvt_pk_bf16_f32 v30, 0, v192
    v_max_f32 v31, 0, v31
    v_cvt_pk_bf16_f32 v31, 0, v31
    v_fma_f32 v193, -v30, v40, v193
    v_add_f32 v31, 0x3727c5ac, v31
    v_cvt_pk_bf16_f32 v31, 0, v31
    v_sqrt_f32 v31, v31
    s_nop 0
    v_cvt_pk_bf16_f32 v31, 0, v31
    v_rcp_f32 v31, v31
    s_nop 0
    v_mul_f32 v32, v193, v31
    v_ashrrev_i32 v196, 31, v32
    v_or_b32 v196, 0x80000000, v196
    v_xor_b32 v32, v32, v196
    s_mov_b32 s15, 0xfffff000
    v_and_or_b32 v32, v32, s15, v29
    s_nop 1
    v_max_u32_dpp v244, v32, v32 quad_perm:[1,0,3,2] row_mask:0xf bank_mask:0xf
    v_min_u32_dpp v245, v32, v32 quad_perm:[1,0,3,2] row_mask:0xf bank_mask:0xf
    s_nop 0
    v_min_u32_dpp v196, v244, v244 quad_perm:[2,3,0,1] row_mask:0xf bank_mask:0xf
    v_max_u32_dpp v245, v245, v245 quad_perm:[2,3,0,1] row_mask:0xf bank_mask:0xf
    v_max_u32_dpp v244, v244, v244 quad_perm:[2,3,0,1] row_mask:0xf bank_mask:0xf
    v_max_u32 v245, v245, v196
    s_nop 0
    v_min_u32_dpp v196, v244, v244 row_half_mirror row_mask:0xf bank_mask:0xf
    v_max_u32_dpp v245, v245, v245 row_half_mirror row_mask:0xf bank_mask:0xf
    v_max_u32_dpp v244, v244, v244 row_half_mirror row_mask:0xf bank_mask:0xf
    v_max_u32 v245, v245, v196
    s_nop 0
    v_min_u32_dpp v196, v244, v244 row_mirror row_mask:0xf bank_mask:0xf
    v_max_u32_dpp v245, v245, v245 row_mirror row_mask:0xf bank_mask:0xf
    v_max_u32_dpp v244, v244, v244 row_mirror row_mask:0xf bank_mask:0xf
    v_max_u32 v245, v245, v196
    ds_write_b64 v4, v[244:245]
    s_waitcnt lgkmcnt(0)
    s_barrier
    ds_read_b64 v[244:245], v5
    v_pk_add_f32 v[208:209], v[152:153], v[30:31] op_sel_hi:[1,0] neg_lo:[0,1] neg_hi:[0,1]
    v_pk_add_f32 v[210:211], v[154:155], v[30:31] op_sel_hi:[1,0] neg_lo:[0,1] neg_hi:[0,1]
    v_pk_add_f32 v[212:213], v[156:157], v[30:31] op_sel_hi:[1,0] neg_lo:[0,1] neg_hi:[0,1]
    v_pk_add_f32 v[214:215], v[158:159], v[30:31] op_sel_hi:[1,0] neg_lo:[0,1] neg_hi:[0,1]
    v_pk_add_f32 v[216:217], v[160:161], v[30:31] op_sel_hi:[1,0] neg_lo:[0,1] neg_hi:[0,1]
    v_pk_add_f32 v[218:219], v[162:163], v[30:31] op_sel_hi:[1,0] neg_lo:[0,1] neg_hi:[0,1]
    v_pk_add_f32 v[220:221], v[164:165], v[30:31] op_sel_hi:[1,0] neg_lo:[0,1] neg_hi:[0,1]
    v_pk_add_f32 v[222:223], v[166:167], v[30:31] op_sel_hi:[1,0] neg_lo:[0,1] neg_hi:[0,1]
    s_waitcnt lgkmcnt(0)
    v_min_u32_dpp v196, v244, v244 quad_perm:[1,0,3,2] row_mask:0xf bank_mask:0xf
    v_max_u32_dpp v245, v245, v245 quad_perm:[1,0,3,2] row_mask:0xf bank_mask:0xf
    v_max_u32_dpp v244, v244, v244 quad_perm:[1,0,3,2] row_mask:0xf bank_mask:0xf
    v_max_u32 v245, v245, v196
    s_nop 0
    v_min_u32_dpp v196, v244, v244 quad_perm:[2,3,0,1] row_mask:0xf bank_mask:0xf
    v_max_u32_dpp v245, v245, v245 quad_perm:[2,3,0,1] row_mask:0xf bank_mask:0xf
    v_max_u32_dpp v244, v244, v244 quad_perm:[2,3,0,1] row_mask:0xf bank_mask:0xf
    v_max_u32 v245, v245, v196
    s_nop 0
    v_min_u32_dpp v196, v244, v244 row_half_mirror row_mask:0xf bank_mask:0xf
    v_max_u32_dpp v245, v245, v245 row_half_mirror row_mask:0xf bank_mask:0xf
    v_max_u32_dpp v244, v244, v244 row_half_mirror row_mask:0xf bank_mask:0xf
    v_max_u32 v245, v245, v196
    v_cmp_eq_u32 s[88:89], v32, v245
    v_cmp_eq_u32 vcc, v32, v244
    v_or_b32 v246, 1, v245
    v_mov_b32 v245, s4
    v_mov_b32 v247, s4
    s_or_b64 s[84:85], vcc, s[88:89]
    s_cmp_lg_u32 s3, 0
    s_cbranch_scc1 L_NOF
    s_mov_b64 exec, 0xffff
    buffer_store_dwordx4 v[244:247], v6, s[32:35], s16 offen sc1
    s_mov_b64 exec, -1
L_NOF:
    s_cmp_eq_u64 s[84:85], 0
    s_cbranch_scc1 L_NOPR
    s_setprio 1
L_NOPR:
    s_lshl4_add_u32 s13, s3, 156288
    v_mov_b32 v4, s13
    v_and_b32 v5, 7, v1
    v_lshlrev_b32 v5, 4, v5
    v_add_u32 v5, 156288, v5
    s_load_dwordx8 s[24:31], s[32:33], s92 offset:2560 glc
    v_cvt_pk_bf16_f32 v208, 0, v208
    v_cvt_pk_bf16_f32 v209, 0, v209
    v_cvt_pk_bf16_f32 v210, 0, v210
    v_cvt_pk_bf16_f32 v211, 0, v211
    v_cvt_pk_bf16_f32 v212, 0, v212
    v_cvt_pk_bf16_f32 v213, 0, v213
    v_cvt_pk_bf16_f32 v214, 0, v214
    v_cvt_pk_bf16_f32 v215, 0, v215
    v_cvt_pk_bf16_f32 v216, 0, v216
    v_cvt_pk_bf16_f32 v217, 0, v217
    v_cvt_pk_bf16_f32 v218, 0, v218
    v_cvt_pk_bf16_f32 v219, 0, v219
    v_cvt_pk_bf16_f32 v220, 0, v220
    v_cvt_pk_bf16_f32 v221, 0, v221
    v_cvt_pk_bf16_f32 v222, 0, v222
    v_cvt_pk_bf16_f32 v223, 0, v223
    v_pk_mul_f32 v[208:209], v[30:31], v[208:209] op_sel:[1,0]
    v_pk_mul_f32 v[210:211], v[30:31], v[210:211] op_sel:[1,0]
    v_pk_mul_f32 v[212:213], v[30:31], v[212:213] op_sel:[1,0]
    v_pk_mul_f32 v[214:215], v[30:31], v[214:215] op_sel:[1,0]
    v_pk_mul_f32 v[216:217], v[30:31], v[216:217] op_sel:[1,0]
    v_pk_mul_f32 v[218:219], v[30:31], v[218:219] op_sel:[1,0]
    v_pk_mul_f32 v[220:221], v[30:31], v[220:221] op_sel:[1,0]
    v_pk_mul_f32 v[222:223], v[30:31], v[222:223] op_sel:[1,0]
    v_cvt_pk_bf16_f32 v208, 0, v208
    v_cvt_pk_bf16_f32 v209, 0, v209
    v_cvt_pk_bf16_f32 v210, 0, v210
    v_cvt_pk_bf16_f32 v211, 0, v211
    v_cvt_pk_bf16_f32 v212, 0, v212
    v_cvt_pk_bf16_f32 v213, 0, v213
    v_cvt_pk_bf16_f32 v214, 0, v214
    v_cvt_pk_bf16_f32 v215, 0, v215
    v_cvt_pk_bf16_f32 v216, 0, v216
    v_cvt_pk_bf16_f32 v217, 0, v217
    v_cvt_pk_bf16_f32 v218, 0, v218
    v_cvt_pk_bf16_f32 v219, 0, v219
    v_cvt_pk_bf16_f32 v220, 0, v220
    v_cvt_pk_bf16_f32 v221, 0, v221
    v_cvt_pk_bf16_f32 v222, 0, v222
    v_cvt_pk_bf16_f32 v223, 0, v223
    v_pk_mul_f32 v[208:209], v[208:209], v[168:169]
    v_pk_mul_f32 v[210:211], v[210:211], v[170:171]
    v_pk_mul_f32 v[212:213], v[212:213], v[172:173]
    v_pk_mul_f32 v[214:215], v[214:215], v[174:175]
    v_pk_mul_f32 v[216:217], v[216:217], v[176:177]
    v_pk_mul_f32 v[218:219], v[218:219], v[178:179]
    v_pk_mul_f32 v[220:221], v[220:221], v[180:181]
    v_pk_mul_f32 v[222:223], v[222:223], v[182:183]
    v_cvt_pk_bf16_f32 v208, 0, v208
    v_cvt_pk_bf16_f32 v209, 0, v209
    v_cvt_pk_bf16_f32 v210, 0, v210
    v_cvt_pk_bf16_f32 v211, 0, v211
    v_cvt_pk_bf16_f32 v212, 0, v212
    v_cvt_pk_bf16_f32 v213, 0, v213
    v_cvt_pk_bf16_f32 v214, 0, v214
    v_cvt_pk_bf16_f32 v215, 0, v215
    v_cvt_pk_bf16_f32 v216, 0, v216
    v_cvt_pk_bf16_f32 v217, 0, v217
    v_cvt_pk_bf16_f32 v218, 0, v218
    v_cvt_pk_bf16_f32 v219, 0, v219
    v_cvt_pk_bf16_f32 v220, 0, v220
    v_cvt_pk_bf16_f32 v221, 0, v221
    v_cvt_pk_bf16_f32 v222, 0, v222
    v_cvt_pk_bf16_f32 v223, 0, v223
    v_pk_add_f32 v[208:209], v[208:209], v[88:89]
    v_pk_add_f32 v[210:211], v[210:211], v[90:91]
    v_pk_add_f32 v[212:213], v[212:213], v[92:93]
    v_pk_add_f32 v[214:215], v[214:215], v[94:95]
    v_pk_add_f32 v[216:217], v[216:217], v[96:97]
    v_pk_add_f32 v[218:219], v[218:219], v[98:99]
    v_pk_add_f32 v[220:221], v[220:221], v[100:101]
    v_pk_add_f32 v[222:223], v[222:223], v[102:103]
    v_cvt_pk_bf16_f32 v224, v208, v209
    v_cvt_pk_bf16_f32 v225, v210, v211
    v_cvt_pk_bf16_f32 v226, v212, v213
    v_cvt_pk_bf16_f32 v227, v214, v215
    v_cvt_pk_bf16_f32 v228, v216, v217
    v_cvt_pk_bf16_f32 v229, v218, v219
    v_cvt_pk_bf16_f32 v230, v220, v221
    v_cvt_pk_bf16_f32 v231, v222, v223
    s_cmp_eq_u64 s[84:85], 0
    s_cbranch_scc1 L_NOCAND
    v_mfma_f32_16x16x32_bf16 v[240:243], v[184:187], v[224:227], 0
    v_mfma_f32_16x16x32_bf16 v[240:243], v[188:191], v[228:231], v[240:243]
    v_mov_b32 v232, v224
    v_mov_b32 v233, v225
    v_mov_b32 v234, v226
    v_mov_b32 v235, v227
    v_mov_b32 v236, v228
    v_mov_b32 v237, v229
    v_mov_b32 v238, v230
    v_mov_b32 v239, v231
    s_lshl_b32 s96, s21, 14
    s_lshl_b32 s97, s12, 9
    s_add_u32 s98, s96, s97
    s_add_u32 s15, s98, 13631488
    v_lshrrev_b32 v7, 4, v1
    v_lshlrev_b32 v7, 4, v7
    v_add_u32 v8, 8192, v7
    v_permlane32_swap_b32 v232, v234
    v_permlane32_swap_b32 v233, v235
    v_permlane32_swap_b32 v236, v238
    v_permlane32_swap_b32 v237, v239
    v_permlane32_swap_b32 v12, v14
    v_permlane32_swap_b32 v13, v15
    v_permlane32_swap_b32 v16, v18
    v_permlane32_swap_b32 v17, v19
    v_cndmask_b32 v7, v7, v8, s[88:89]
    s_mov_b64 exec, s[84:85]
    buffer_store_dwordx4 v[232:235], v7, s[32:35], s15 offen sc1
    buffer_store_dwordx4 v[236:239], v7, s[32:35], s15 offen offset:64 sc1
    s_mov_b32 exec_lo, 0
    s_and_b32 exec_hi, s85, 0xffff0000
    buffer_store_dword v240, v7, s[32:35], s15 offen offset:208 sc1
    s_mov_b64 exec, s[84:85]
    buffer_store_dwordx4 v[12:15], v7, s[32:35], s15 offen offset:128 sc1
    buffer_store_dwordx4 v[16:19], v7, s[32:35], s15 offen offset:192 sc1
    s_mov_b64 exec, -1
    s_setprio 0
L_NOCAND:
    s_add_u32 s82, s81, 8192
    s_lshl2_add_u32 m0, s83, 67584
    s_nop 0
    buffer_load_dwordx4 v253, s[60:63], s82 offen nt lds
    s_add_u32 s82, s81, 12288
    s_lshl2_add_u32 m0, s83, 68608
    s_nop 0
    buffer_load_dwordx4 v253, s[60:63], s82 offen nt lds
    v_lshlrev_b32 v208, 16, v224
    v_and_b32 v209, s6, v224
    v_lshlrev_b32 v210, 16, v225
    v_and_b32 v211, s6, v225
    v_lshlrev_b32 v212, 16, v226
    v_and_b32 v213, s6, v226
    v_lshlrev_b32 v214, 16, v227
    v_and_b32 v215, s6, v227
    v_lshlrev_b32 v216, 16, v228
    v_and_b32 v217, s6, v228
    v_lshlrev_b32 v218, 16, v229
    v_and_b32 v219, s6, v229
    v_lshlrev_b32 v220, 16, v230
    v_and_b32 v221, s6, v230
    v_lshlrev_b32 v222, 16, v231
    v_and_b32 v223, s6, v231
    v_pk_mul_f32 v[208:209], v[208:209], v[104:105]
    v_pk_mul_f32 v[210:211], v[210:211], v[106:107]
    v_pk_mul_f32 v[212:213], v[212:213], v[108:109]
    v_pk_mul_f32 v[214:215], v[214:215], v[110:111]
    v_pk_mul_f32 v[216:217], v[216:217], v[112:113]
    v_pk_mul_f32 v[218:219], v[218:219], v[114:115]
    v_pk_mul_f32 v[220:221], v[220:221], v[116:117]
    v_pk_mul_f32 v[222:223], v[222:223], v[118:119]
    v_cvt_pk_bf16_f32 v208, 0, v208
    v_cvt_pk_bf16_f32 v209, 0, v209
    v_cvt_pk_bf16_f32 v210, 0, v210
    v_cvt_pk_bf16_f32 v211, 0, v211
    v_cvt_pk_bf16_f32 v212, 0, v212
    v_cvt_pk_bf16_f32 v213, 0, v213
    v_cvt_pk_bf16_f32 v214, 0, v214
    v_cvt_pk_bf16_f32 v215, 0, v215
    v_cvt_pk_bf16_f32 v216, 0, v216
    v_cvt_pk_bf16_f32 v217, 0, v217
    v_cvt_pk_bf16_f32 v218, 0, v218
    v_cvt_pk_bf16_f32 v219, 0, v219
    v_cvt_pk_bf16_f32 v220, 0, v220
    v_cvt_pk_bf16_f32 v221, 0, v221
    v_cvt_pk_bf16_f32 v222, 0, v222
    v_cvt_pk_bf16_f32 v223, 0, v223
    s_lshl_b32 s96, s3, 11
    s_add_u32 s13, s96, 98304
    v_lshrrev_b32 v202, 4, v1
    v_lshlrev_b32 v202, 4, v202
    v_and_b32 v203, 7, v1
    v_lshlrev_b32 v203, 4, v203
    v_xor_b32 v202, v202, v203
    v_and_b32 v204, 15, v1
    v_lshl_add_u32 v204, v204, 7, s13
    v_add_u32 v202, v202, v204
    v_xor_b32 v204, 64, v202
    v_lshrrev_b32 v205, 3, v1
    v_lshlrev_b32 v205, 4, v205
    v_xor_b32 v203, v205, v203
    v_lshrrev_b32 v205, 3, v1
    v_lshl_add_u32 v205, v205, 7, s13
    v_add_u32 v203, v203, v205
    s_lshl_b32 s96, s21, 7
    s_sub_u32 s97, 2047, s96
    s_lshl_b32 s98, s3, 4
    s_sub_u32 s13, s97, s98
    v_lshrrev_b32 v43, 3, v1
    v_sub_u32 v42, s13, v43
    v_subrev_u32 v43, 8, v42
    v_lshrrev_b32 v33, 3, v1
    v_lshlrev_b32 v33, 11, v33
    v_and_b32 v9, 7, v1
    v_lshl_add_u32 v33, v9, 4, v33
    s_lshl3_add_u32 s96, s21, s3
    s_lshl_b32 s97, s96, 15
    s_lshl_b32 s98, s12, 7
    s_add_u32 s16, s97, s98
    s_add_u32 s15, s16, 16384
    s_branch SCHK_40
SPOLL_39:
    s_load_dwordx8 s[24:31], s[32:33], s92 offset:2560 glc
SCHK_40:
    s_add_u32 s5, s5, 1
    s_cmp_ge_u32 s5, 200000
    s_waitcnt lgkmcnt(0)
    s_cbranch_scc1 SDONE_41
    s_cmp_lg_u32 s25, s4
    s_cbranch_scc1 SPOLL_39
    s_cmp_lg_u32 s27, s4
    s_cbranch_scc1 SPOLL_39
    s_cmp_lg_u32 s29, s4
    s_cbranch_scc1 SPOLL_39
    s_cmp_lg_u32 s31, s4
    s_cbranch_scc1 SPOLL_39
SDONE_41:
    s_min_u32 s25, s24, s28
    s_min_u32 s27, s26, s28
    s_min_u32 s29, s24, s30
    s_max_u32 s24, s24, s28
    s_max_u32 s26, s26, s30
    s_max_u32 s27, s27, s29
    s_max_u32 s25, s25, s26
    v_mov_b32 v244, s24
    v_mov_b32 v246, s27
    v_mov_b32 v245, s25
    ds_write_b128 v4, v[244:247]
    s_lshr_b32 s96, s3, 2
    s_lshl_b32 s97, s96, 15
    s_and_b32 s98, s3, 3
    s_lshl_b32 s99, s98, 5
    s_add_u32 s13, s97, s99
    v_lshrrev_b32 v34, 4, v1
    v_lshlrev_b32 v34, 13, v34
    v_bfe_u32 v9, v1, 2, 2
    v_lshl_add_u32 v34, v9, 7, v34
    v_bfe_u32 v9, v1, 3, 2
    v_lshl_add_u32 v34, v9, 5, v34
    v_and_b32 v9, 3, v1
    v_lshl_add_u32 v34, v9, 3, v34
    v_xor_b32 v34, s13, v34
    s_lshl_b32 s96, s75, 11
    s_add_u32 s13, s96, 13631488
    v_and_b32 v36, 7, v1
    v_lshl_add_u32 v36, v36, 4, s13
    v_lshrrev_b32 v9, 4, v1
    v_lshl_add_u32 v36, v9, 9, v36
    v_and_b32 v10, 15, v1
    v_lshlrev_b32 v10, 9, v10
    v_add_u32 v10, 13631744, v10
    s_waitcnt vmcnt(0)
    s_waitcnt lgkmcnt(0)
    s_barrier
    ds_read_b128 v[244:247], v5
    v_and_b32 v8, 8, v1
    v_cmp_eq_u32 s[22:23], 0, v8
    v_cmp_gt_u32 s[24:25], 16, v1
    v_cmp_gt_u32 s[26:27], 32, v1
    s_waitcnt lgkmcnt(0)
    v_min_u32_dpp v192, v244, v244 quad_perm:[1,0,3,2] row_mask:0xf bank_mask:0xf
    v_min_u32_dpp v193, v245, v244 quad_perm:[1,0,3,2] row_mask:0xf bank_mask:0xf
    v_min_u32_dpp v194, v244, v245 quad_perm:[1,0,3,2] row_mask:0xf bank_mask:0xf
    v_max_u32_dpp v246, v246, v246 quad_perm:[1,0,3,2] row_mask:0xf bank_mask:0xf
    v_max_u32_dpp v245, v245, v245 quad_perm:[1,0,3,2] row_mask:0xf bank_mask:0xf
    v_max_u32_dpp v244, v244, v244 quad_perm:[1,0,3,2] row_mask:0xf bank_mask:0xf
    v_max3_u32 v246, v246, v193, v194
    v_max_u32 v245, v245, v192
    v_min_u32_dpp v192, v244, v244 quad_perm:[2,3,0,1] row_mask:0xf bank_mask:0xf
    s_nop 0
    v_min_u32_dpp v193, v245, v244 quad_perm:[2,3,0,1] row_mask:0xf bank_mask:0xf
    v_min_u32_dpp v194, v244, v245 quad_perm:[2,3,0,1] row_mask:0xf bank_mask:0xf
    v_max_u32_dpp v246, v246, v246 quad_perm:[2,3,0,1] row_mask:0xf bank_mask:0xf
    v_max_u32_dpp v245, v245, v245 quad_perm:[2,3,0,1] row_mask:0xf bank_mask:0xf
    v_max_u32_dpp v244, v244, v244 quad_perm:[2,3,0,1] row_mask:0xf bank_mask:0xf
    v_max3_u32 v246, v246, v193, v194
    v_max_u32 v245, v245, v192
    v_min_u32_dpp v192, v244, v244 row_half_mirror row_mask:0xf bank_mask:0xf
    s_nop 0
    v_min_u32_dpp v193, v245, v244 row_half_mirror row_mask:0xf bank_mask:0xf
    v_min_u32_dpp v194, v244, v245 row_half_mirror row_mask:0xf bank_mask:0xf
    v_max_u32_dpp v246, v246, v246 row_half_mirror row_mask:0xf bank_mask:0xf
    v_max_u32_dpp v245, v245, v245 row_half_mirror row_mask:0xf bank_mask:0xf
    v_max_u32_dpp v244, v244, v244 row_half_mirror row_mask:0xf bank_mask:0xf
    v_max3_u32 v246, v246, v193, v194
    v_max_u32 v245, v245, v192
    v_cndmask_b32 v192, v245, v244, s[22:23]
    v_cndmask_b32 v201, v246, v245, s[26:27]
    v_and_b32 v193, 31, v246
    v_and_b32 v192, 31, v192
    v_cndmask_b32 v201, v201, v244, s[24:25]
    v_lshl_add_u32 v4, v192, 13, v36
    v_lshl_add_u32 v5, v193, 13, v36
    v_and_b32 v194, 31, v201
    v_lshl_add_u32 v6, v194, 13, v10
    buffer_load_dwordx4 v[192:195], v4, s[32:35], 0 offen sc1
    buffer_load_dwordx4 v[196:199], v5, s[32:35], 0 offen sc1
    buffer_load_dword v200, v6, s[32:35], 0 offen sc1
    s_barrier
    v_readfirstlane_b32 s91, v244
    v_readfirstlane_b32 s94, v245
    v_readfirstlane_b32 s95, v246
    ds_read_b64_tr_b16 v[56:57], v34
    ds_read_b64_tr_b16 v[58:59], v34 offset:512
    ds_read_b64_tr_b16 v[60:61], v34 offset:1024
    ds_read_b64_tr_b16 v[62:63], v34 offset:1536
    ds_read_b64_tr_b16 v[64:65], v34 offset:2048
    ds_read_b64_tr_b16 v[66:67], v34 offset:2560
    ds_read_b64_tr_b16 v[68:69], v34 offset:3072
    ds_read_b64_tr_b16 v[70:71], v34 offset:3584
    ds_read_b64_tr_b16 v[72:73], v34 offset:4096
    ds_read_b64_tr_b16 v[74:75], v34 offset:4608
    ds_read_b64_tr_b16 v[76:77], v34 offset:5120
    ds_read_b64_tr_b16 v[78:79], v34 offset:5632
    ds_read_b64_tr_b16 v[80:81], v34 offset:6144
    ds_read_b64_tr_b16 v[82:83], v34 offset:6656
    ds_read_b64_tr_b16 v[84:85], v34 offset:7168
    ds_read_b64_tr_b16 v[86:87], v34 offset:7680
    s_bfe_u32 s96, s91, 262145
    s_lshl_b32 s97, s96, 7
    s_bfe_u32 s98, s91, 458757
    s_add_u32 s99, s97, s98
    s_xor_b32 s17, s99, 2047
    s_bfe_u32 s96, s94, 262145
    s_lshl_b32 s97, s96, 7
    s_bfe_u32 s98, s94, 458757
    s_add_u32 s99, s97, s98
    s_xor_b32 s18, s99, 2047
    s_bfe_u32 s96, s95, 262145
    s_lshl_b32 s97, s96, 7
    s_bfe_u32 s98, s95, 458757
    s_add_u32 s99, s97, s98
    s_xor_b32 s19, s99, 2047
    s_waitcnt lgkmcnt(0)
    s_lshl_b32 s13, s3, 6
    v_bfe_u32 v35, v1, 2, 1
    v_lshlrev_b32 v35, 9, v35
    v_bfe_u32 v9, v1, 3, 1
    v_lshl_add_u32 v35, v9, 12, v35
    v_lshrrev_b32 v9, 5, v1
    v_lshl_add_u32 v35, v9, 11, v35
    v_bfe_u32 v9, v1, 2, 2
    v_lshl_add_u32 v35, v9, 6, v35
    v_bfe_u32 v9, v1, 4, 1
    v_lshl_add_u32 v35, v9, 5, v35
    v_and_b32 v9, 3, v1
    v_lshl_add_u32 v35, v9, 3, v35
    v_xor_b32 v35, s13, v35
    v_add_u32 v35, 65536, v35
    v_and_b32 v8, 15, v1
    v_lshlrev_b32 v8, 4, v8
    v_lshrrev_b32 v9, 5, v1
    v_lshl_add_u32 v8, v9, 3, v8
    s_lshl_b32 s96, s74, 13
    s_add_u32 s14, s96, 20971520
    s_lshl3_add_u32 s96, s75, s3
    s_lshl_b32 s97, s96, 8
    s_add_u32 s20, s97, s14
    v_bfe_u32 v7, v201, 1, 4
    v_bfe_u32 v201, v201, 5, 7
    v_lshl_or_b32 v201, v7, 7, v201
    v_xor_b32 v201, 0x7ff, v201
    s_waitcnt vmcnt(0)
    v_max3_u32 v7, v192, v196, v200
    v_cmp_eq_u32 vcc, -1, v7
    s_cbranch_vccz POK_43
PRE_44:
    buffer_load_dwordx4 v[192:195], v4, s[32:35], 0 offen sc1
    buffer_load_dwordx4 v[196:199], v5, s[32:35], 0 offen sc1
    buffer_load_dword v200, v6, s[32:35], 0 offen sc1
    s_waitcnt vmcnt(0)
    v_max3_u32 v7, v192, v196, v200
    v_cmp_eq_u32 vcc, -1, v7
    s_cbranch_vccz POK_43
    s_add_u32 s5, s5, 1
    s_cmp_lt_u32 s5, 200000
    s_cbranch_scc1 PRE_44
POK_43:
    v_add_f32_dpp v200, v200, v200 quad_perm:[1,0,3,2] row_mask:0xf bank_mask:0xf
    s_nop 1
    v_add_f32_dpp v200, v200, v200 quad_perm:[2,3,0,1] row_mask:0xf bank_mask:0xf
    s_nop 1
    v_add_f32_dpp v200, v200, v200 row_half_mirror row_mask:0xf bank_mask:0xf
    s_nop 1
    v_add_f32_dpp v200, v200, v200 row_mirror row_mask:0xf bank_mask:0xf
    v_cvt_pk_bf16_f32 v200, 0, v200
    v_ashrrev_i32 v7, 31, v200
    v_or_b32 v7, 0x80000000, v7
    v_xor_b32 v200, v200, v7
    v_lshrrev_b32 v200, 16, v200
    v_lshl_or_b32 v200, v200, 11, v201
    s_nop 0
    v_readlane_b32 s24, v200, 0
    v_readlane_b32 s25, v200, 16
    v_readlane_b32 s26, v200, 32
    s_not_b64 s[28:29], s[22:23]
    s_cmp_lt_u32 s24, s25
    s_cselect_b64 s[28:29], s[22:23], s[28:29]
    s_cselect_b32 s27, s24, s25
    s_cmp_gt_u32 s26, s27
    s_cselect_b64 vcc, s[28:29], 0
    v_cndmask_b32 v192, v192, v196, vcc
    v_cndmask_b32 v193, v193, v197, vcc
    v_cndmask_b32 v194, v194, v198, vcc
    v_cndmask_b32 v195, v195, v199, vcc
    s_bitcmp1_b32 vcc_lo, 0
    s_cselect_b32 s24, s26, s24
    s_cselect_b32 s19, s17, s19
    s_cselect_b32 s17, s95, s91
    s_bitcmp1_b32 vcc_lo, 8
    s_cselect_b32 s25, s26, s25
    s_cselect_b32 s19, s18, s19
    s_cselect_b32 s18, s95, s94
    s_waitcnt lgkmcnt(0)
    v_mfma_f32_16x16x32_bf16 v[136:139], v[192:195], v[56:59], 0
    v_mfma_f32_16x16x32_bf16 v[140:143], v[192:195], v[60:63], 0
    v_mfma_f32_16x16x32_bf16 v[144:147], v[192:195], v[64:67], 0
    v_mfma_f32_16x16x32_bf16 v[148:151], v[192:195], v[68:71], 0
    v_mfma_f32_16x16x32_bf16 v[168:171], v[192:195], v[72:75], 0
    v_mfma_f32_16x16x32_bf16 v[172:175], v[192:195], v[76:79], 0
    v_mfma_f32_16x16x32_bf16 v[176:179], v[192:195], v[80:83], 0
    v_mfma_f32_16x16x32_bf16 v[180:183], v[192:195], v[84:87], 0
    s_nop 1
    v_add_f32 v196, v136, v141
    s_nop 0
    v_add_f32 v197, v146, v151
    s_nop 0
    v_add_f32 v198, v168, v173
    s_nop 0
    v_add_f32 v199, v178, v183
    v_add_f32 v196, v196, v197
    v_add_f32 v198, v198, v199
    v_mov_b32 v197, s4
    s_nop 0
    v_permlane16_swap_b32 v198, v199
    s_cmp_ge_u32 s9, 28
    s_cbranch_scc1 L_NOHP
    v_add_f32 v196, v196, v199
    s_mov_b32 exec_lo, 0xffff
    s_mov_b32 exec_hi, 0xffff
    buffer_store_dwordx2 v[196:197], v8, s[32:35], s20 offen sc1
    s_mov_b64 exec, -1
L_NOHP:
    ds_read_b64_tr_b16 v[120:121], v35
    ds_read_b64_tr_b16 v[122:123], v35 offset:1024
    ds_read_b64_tr_b16 v[124:125], v35 offset:8192
    ds_read_b64_tr_b16 v[126:127], v35 offset:9216
    ds_read_b64_tr_b16 v[128:129], v35 offset:16384
    ds_read_b64_tr_b16 v[130:131], v35 offset:17408
    ds_read_b64_tr_b16 v[132:133], v35 offset:24576
    ds_read_b64_tr_b16 v[134:135], v35 offset:25600
    s_and_b32 s68, s24, 2047
    s_and_b32 s69, s25, 2047
    s_mov_b32 s70, s16
    s_mov_b32 s71, s15
    v_pk_add_f32 v[208:209], v[208:209], v[152:153]
    v_pk_add_f32 v[210:211], v[210:211], v[154:155]
    v_pk_add_f32 v[212:213], v[212:213], v[156:157]
    v_pk_add_f32 v[214:215], v[214:215], v[158:159]
    v_pk_add_f32 v[216:217], v[216:217], v[160:161]
    v_pk_add_f32 v[218:219], v[218:219], v[162:163]
    v_pk_add_f32 v[220:221], v[220:221], v[164:165]
    v_pk_add_f32 v[222:223], v[222:223], v[166:167]
    v_cvt_pk_bf16_f32 v232, v208, v209
    v_cvt_pk_bf16_f32 v233, v210, v211
    v_cvt_pk_bf16_f32 v234, v212, v213
    v_cvt_pk_bf16_f32 v235, v214, v215
    v_cvt_pk_bf16_f32 v236, v216, v217
    v_cvt_pk_bf16_f32 v237, v218, v219
    v_cvt_pk_bf16_f32 v238, v220, v221
    v_cvt_pk_bf16_f32 v239, v222, v223
    v_permlane32_swap_b32 v232, v234
    v_permlane32_swap_b32 v233, v235
    v_permlane32_swap_b32 v236, v238
    v_permlane32_swap_b32 v237, v239
    ds_write_b128 v202, v[232:235]
    ds_write_b128 v204, v[236:239]
    ds_read_b128 v[232:235], v203
    ds_read_b128 v[236:239], v203 offset:1024
    s_waitcnt lgkmcnt(0)
    s_cmp_lg_u32 s93, 7
    s_cbranch_scc1 L_NONON
    v_mov_b32 v6, s4
    v_mov_b32 v7, 0
    s_mov_b64 exec, 1
    buffer_store_dword v6, v7, s[32:35], 0 offen sc1
    s_mov_b64 exec, -1
L_NONON:
    s_cmp_ge_u32 s9, 28
    s_cbranch_scc1 L_FIN2
    s_cmp_lg_u32 s3, 7
    s_cbranch_scc1 L_NOFZ
    s_bitcmp1_b32 s9, 3
    s_cselect_b32 s15, s25, s24
    s_cselect_b32 s17, s18, s17
    s_andn2_b32 s18, 2047, s15
    s_lshr_b32 s96, s8, 1
    s_lshl2_add_u32 s19, s12, s96
    s_lshr_b32 s96, s19, 1
    s_lshr_b32 s97, s9, 3
    s_lshl_b32 s98, s97, 1
    s_lshl2_add_u32 s99, s96, s98
    s_and_b32 s97, s19, 1
    s_add_u32 s96, s99, s97
    s_mul_i32 s98, s96, 7168
    s_add_u32 s20, s98, 22020096
    s_lshl_b32 s96, s18, 11
    s_lshl_b32 s97, s19, 5
    s_add_u32 s82, s96, s97
    v_and_b32 v10, 7, v1
    v_lshlrev_b32 v10, 2, v10
    s_lshr_b32 s96, s8, 1
    s_lshl_b32 s97, s96, 6
    s_add_u32 s13, s97, 157184
    v_and_b32 v5, 7, v1
    v_lshl_add_u32 v5, v5, 3, s13
    ds_read_b64 v[206:207], v5
    s_and_b32 s96, s17, 31
    s_lshl_b32 s97, s96, 13
    s_lshl_b32 s98, s12, 9
    s_add_u32 s99, s97, s98
    s_lshr_b32 s96, s8, 1
    s_lshl_b32 s97, s96, 5
    s_add_u32 s98, s99, s97
    s_add_u32 s91, s98, 13631488
    s_lshr_b32 s13, s15, 11
    s_lshl_b32 s13, s13, 16
    s_ashr_i32 s15, s13, 31
    s_andn2_b32 s15, 0x7fff0000, s15
    s_or_b32 s15, s15, 0x80000000
    s_xor_b32 s13, s13, s15
    v_mov_b32 v204, s13
    v_mul_f32 v204, s7, v204
    v_exp_f32 v204, -v204
    s_nop 0
    v_add_f32 v204, 1.0, v204
    v_rcp_f32 v204, v204
    s_nop 0
    v_cvt_pk_bf16_f32 v204, 0, v204
L_NOFZ:
    s_cmp_ge_u32 s3, 4
    s_cbranch_scc1 L_NOH
    s_lshl_b32 s96, s3, 8
    s_add_u32 s13, s96, s14
    v_lshrrev_b32 v4, 4, v1
    v_lshlrev_b32 v4, 11, v4
    v_and_b32 v9, 15, v1
    v_lshl_add_u32 v4, v9, 4, v4
    s_lshl_b32 s96, s3, 5
    s_add_u32 s15, s96, 156672
    v_lshrrev_b32 v5, 5, v1
    v_lshl_add_u32 v5, v5, 7, s15
    v_bfe_u32 v9, v1, 2, 1
    v_lshl_add_u32 v5, v9, 4, v5
    v_bfe_u32 v9, v1, 1, 1
    v_lshl_add_u32 v5, v9, 3, v5
    v_bfe_u32 v9, v1, 3, 1
    v_lshl_add_u32 v5, v9, 2, v5
    v_and_b32 v9, 1, v1
    v_lshl_add_u32 v5, v9, 1, v5
SPOLL_45:
    s_load_dword s24, s[32:33], s13 offset:1276 glc
    s_load_dword s25, s[32:33], s13 offset:3324 glc
    s_load_dword s26, s[32:33], s13 offset:5372 glc
    s_load_dword s27, s[32:33], s13 offset:7420 glc
SCHK_46:
    s_add_u32 s5, s5, 1
    s_cmp_ge_u32 s5, 200000
    s_waitcnt lgkmcnt(0)
    s_cbranch_scc1 SDONE_47
    s_cmp_lg_u32 s24, s4
    s_cbranch_scc1 SPOLL_45
    s_cmp_lg_u32 s25, s4
L_PAD10:
    s_cbranch_execz L_RET10
    s_cbranch_scc1 SPOLL_45
    s_cmp_lg_u32 s26, s4
    s_cbranch_scc1 SPOLL_45
    s_cmp_lg_u32 s27, s4
    s_cbranch_scc1 SPOLL_45
SDONE_47:
POLL_48:
    buffer_load_dwordx4 v[88:91], v4, s[32:35], s13 offen sc1
    buffer_load_dwordx4 v[92:95], v4, s[32:35], s13 offen offset:1024 sc1
    s_waitcnt vmcnt(0)
    v_bitop3_b32 v6, v89, v91, s4 bitop3:0x7e
    v_bitop3_b32 v6, v6, v93, s4 bitop3:0xf6
    v_bitop3_b32 v6, v6, v95, s4 bitop3:0xf6
    v_cmp_ne_u32 vcc, 0, v6
    s_cbranch_vccz PDONE_49
    s_add_u32 s5, s5, 1
    s_cmp_lt_u32 s5, 200000
    s_cbranch_scc1 POLL_48
PDONE_49:
    v_permlane32_swap_b32 v88, v90
    v_permlane32_swap_b32 v92, v94
    v_add_f32 v88, v88, v90
    v_add_f32 v92, v92, v94
    v_mov_b32 v90, v88
    v_mov_b32 v94, v92
    s_nop 0
    v_permlane16_swap_b32 v88, v90
    v_permlane16_swap_b32 v92, v94
    v_add_f32 v88, v88, v90
    v_add_f32 v92, v92, v94
    v_cvt_pk_bf16_f32 v88, 0, v88
    v_cvt_pk_bf16_f32 v92, 0, v92
    v_mul_f32 v6, s7, v88
    v_exp_f32 v6, -v6
    s_nop 0
    v_add_f32 v6, 1.0, v6
    v_rcp_f32 v6, v6
    s_nop 0
    v_mul_f32 v88, v88, v6
    v_cvt_pk_bf16_f32 v88, 0, v88
    v_mul_f32 v88, v88, v92
    v_cvt_pk_bf16_f32 v88, v88, v88
    ds_write_b16 v5, v88
L_NOH:
    v_bfe_u32 v4, v1, 2, 1
    v_lshlrev_b32 v4, 7, v4
    v_lshrrev_b32 v9, 5, v1
    v_lshl_add_u32 v4, v9, 4, v4
    v_add_u32 v4, 156672, v4
    v_lshrrev_b32 v5, 4, v1
    v_mul_u32_u24 v5, 7168, v5
    v_and_b32 v9, 15, v1
    v_lshl_add_u32 v5, v9, 3, v5
    s_lshl3_add_u32 s96, s75, s3
    s_mul_i32 s97, s96, 28672
    s_lshl_b32 s98, s74, 7
    s_add_u32 s99, s97, s98
    s_add_u32 s13, s99, 22020096
    v_and_b32 v6, 1, v1
    v_lshlrev_b32 v6, 13, v6
    v_bfe_u32 v9, v1, 1, 1
    v_lshl_add_u32 v6, v9, 18, v6
    s_lshr_b32 s96, s9, 2
    s_and_b32 s97, s75, 1
    s_lshr_b32 s98, s3, 1
    s_lshl2_add_u32 s99, s97, s98
    s_and_b32 s97, s3, 1
    s_lshr_b32 s98, s75, 1
    s_lshl2_add_u32 s97, s97, s98
    s_lshl3_add_u32 s98, s99, s97
    s_lshl_b32 s99, s98, 12
    s_lshl_b32 s97, s8, 6
    s_add_u32 s98, s99, s97
    s_lshl2_add_u32 s99, s96, s98
    s_add_u32 s97, s99, 1048576
    s_add_u32 s14, s97, 3072
    s_waitcnt lgkmcnt(0)
    s_barrier
    ds_read_b128 v[88:91], v4
    ds_read_b128 v[92:95], v4 offset:32
    ds_read_b128 v[96:99], v4 offset:64
    ds_read_b128 v[100:103], v4 offset:96
    s_waitcnt lgkmcnt(3)
    v_mfma_f32_32x32x16_bf16 v[208:223], v[88:91], v[120:123], 0
    s_waitcnt lgkmcnt(2)
    v_mfma_f32_32x32x16_bf16 v[208:223], v[92:95], v[124:127], v[208:223]
    s_waitcnt lgkmcnt(1)
    v_mfma_f32_32x32x16_bf16 v[208:223], v[96:99], v[128:131], v[208:223]
    s_waitcnt lgkmcnt(0)
    v_mfma_f32_32x32x16_bf16 v[208:223], v[100:103], v[132:135], v[208:223]
    s_nop 11
    v_mov_b32 v209, s4
    buffer_store_dwordx2 v[208:209], v5, s[32:35], s13 offen sc1
    s_mov_b64 exec, 15
    buffer_store_dword v209, v6, s[32:35], s14 offen sc1
    s_mov_b64 exec, -1
    s_barrier
L_FIN2:
    v_cmp_ne_u32 vcc, s68, v42
    v_cmp_ne_u32 s[22:23], s69, v42
    s_nop 0
    s_and_b64 exec, vcc, s[22:23]
    buffer_store_dwordx4 v[232:235], v33, s[64:67], s70 offen sc1
    s_mov_b64 exec, -1
    v_cmp_ne_u32 vcc, s68, v43
    v_cmp_ne_u32 s[22:23], s69, v43
    s_nop 0
    s_and_b64 exec, vcc, s[22:23]
    buffer_store_dwordx4 v[236:239], v33, s[64:67], s71 offen sc1
    s_mov_b64 exec, -1
    s_cmp_ge_u32 s9, 16
    s_cbranch_scc1 L_FIN
SPOLL_50:
    s_load_dwordx8 s[24:31], s[32:33], s92 offset:3072 glc
SCHK_51:
    s_add_u32 s5, s5, 1
    s_cmp_ge_u32 s5, 200000
    s_waitcnt lgkmcnt(0)
    s_cbranch_scc1 SDONE_52
    s_cmp_lg_u32 s24, s4
    s_cbranch_scc1 SPOLL_50
    s_cmp_lg_u32 s25, s4
    s_cbranch_scc1 SPOLL_50
    s_cmp_lg_u32 s26, s4
    s_cbranch_scc1 SPOLL_50
    s_cmp_lg_u32 s27, s4
    s_cbranch_scc1 SPOLL_50
    s_cmp_lg_u32 s28, s4
    s_cbranch_scc1 SPOLL_50
    s_cmp_lg_u32 s29, s4
    s_cbranch_scc1 SPOLL_50
    s_cmp_lg_u32 s30, s4
    s_cbranch_scc1 SPOLL_50
SDONE_52:
    s_barrier
    s_cmp_lg_u32 s3, 7
    s_cbranch_scc1 L_FIN
    s_add_u32 s13, s20, 4096
    v_mov_b32 v5, s4
    v_not_b32 v6, v5
POLL_53:
    buffer_load_dwordx4 v[88:91], v2, s[32:35], s20 offen sc1
    buffer_load_dwordx4 v[92:95], v2, s[32:35], s20 offen offset:1024 sc1
    buffer_load_dwordx4 v[96:99], v2, s[32:35], s20 offen offset:2048 sc1
    buffer_load_dwordx4 v[100:103], v2, s[32:35], s20 offen offset:3072 sc1
    buffer_load_dwordx4 v[104:107], v2, s[32:35], s13 offen sc1
    buffer_load_dwordx4 v[108:111], v2, s[32:35], s13 offen offset:1024 sc1
    buffer_load_dwordx4 v[112:115], v2, s[32:35], s13 offen offset:2048 sc1
    buffer_load_dword v244, v10, s[32:35], s91 offen sc1
    buffer_load_dword v245, v10, s[32:35], s91 offen offset:128 sc1
    s_waitcnt vmcnt(0)
    v_max_u32 v246, v244, v245
    v_cmp_ne_u32 vcc, -1, v246
    s_nop 1
    v_cndmask_b32 v246, v6, v5, vcc
    v_bitop3_b32 v4, v89, v91, s4 bitop3:0x7e
    v_bitop3_b32 v4, v4, v93, s4 bitop3:0xf6
    v_bitop3_b32 v4, v4, v95, s4 bitop3:0xf6
    v_bitop3_b32 v4, v4, v97, s4 bitop3:0xf6
    v_bitop3_b32 v4, v4, v99, s4 bitop3:0xf6
    v_bitop3_b32 v4, v4, v101, s4 bitop3:0xf6
    v_bitop3_b32 v4, v4, v103, s4 bitop3:0xf6
    v_bitop3_b32 v4, v4, v105, s4 bitop3:0xf6
    v_bitop3_b32 v4, v4, v107, s4 bitop3:0xf6
    v_bitop3_b32 v4, v4, v109, s4 bitop3:0xf6
    v_bitop3_b32 v4, v4, v111, s4 bitop3:0xf6
    v_bitop3_b32 v4, v4, v113, s4 bitop3:0xf6
    v_bitop3_b32 v4, v4, v115, s4 bitop3:0xf6
    v_bitop3_b32 v4, v4, v246, s4 bitop3:0xf6
    v_cmp_ne_u32 vcc, 0, v4
    s_cbranch_vccz PDONE_54
    s_add_u32 s5, s5, 1
    s_cmp_lt_u32 s5, 200000
    s_cbranch_scc1 POLL_53
PDONE_54:
    v_add_f32 v88, v88, v92
    v_add_f32 v90, v90, v94
    v_add_f32 v88, v88, v96
    v_add_f32 v90, v90, v98
    v_add_f32 v88, v88, v100
    v_add_f32 v90, v90, v102
    v_add_f32 v88, v88, v104
    v_add_f32 v90, v90, v106
    v_add_f32 v88, v88, v108
    v_add_f32 v90, v90, v110
    v_add_f32 v88, v88, v112
    v_add_f32 v90, v90, v114
    v_mov_b32 v89, v90
    v_add_f32_dpp v88, v88, v88 row_ror:8 row_mask:0xf bank_mask:0xf
    s_nop 0
    v_add_f32_dpp v89, v89, v89 row_ror:8 row_mask:0xf bank_mask:0xf
    v_mov_b32 v90, v88
    v_mov_b32 v91, v89
    s_nop 0
    v_permlane16_swap_b32 v88, v90
    v_permlane16_swap_b32 v89, v91
    v_pk_add_f32 v[88:89], v[88:89], v[90:91]
    v_mov_b32 v90, v88
    v_mov_b32 v91, v89
    s_nop 0
    v_permlane32_swap_b32 v88, v90
    v_permlane32_swap_b32 v89, v91
    v_pk_add_f32 v[88:89], v[88:89], v[90:91]
    v_cvt_pk_bf16_f32 v88, 0, v88
    v_cvt_pk_bf16_f32 v89, 0, v89
    v_pk_mul_f32 v[88:89], v[88:89], v[204:205] op_sel_hi:[1,0]
    v_lshlrev_b32 v4, 16, v244
    v_and_b32 v5, s6, v244
    v_cvt_pk_bf16_f32 v88, 0, v88
    v_cvt_pk_bf16_f32 v89, 0, v89
    v_pk_add_f32 v[88:89], v[88:89], v[4:5]
    v_cvt_pk_bf16_f32 v88, 0, v88
    v_cvt_pk_bf16_f32 v89, 0, v89
    v_pk_mul_f32 v[88:89], v[88:89], v[206:207]
    v_lshlrev_b32 v4, 16, v245
    v_and_b32 v5, s6, v245
    v_cvt_pk_bf16_f32 v88, 0, v88
    v_cvt_pk_bf16_f32 v89, 0, v89
    v_pk_add_f32 v[88:89], v[88:89], v[4:5]
    v_cvt_pk_bf16_f32 v88, v88, v89
    s_mov_b64 exec, 0xff
    buffer_store_dword v88, v10, s[64:67], s82 offen
    s_mov_b64 exec, -1
L_FIN:
L_END:
    s_endpgm
.p2align 10
.fill 768, 4, 0xbf800000
.section .rodata,"a"
.p2align 6
.amdhsa_kernel adaLN_cond__linear_kernel_hedgehog__moe_arch_mod__prompt_kernel
  .amdhsa_next_free_vgpr 256
  .amdhsa_next_free_sgpr 102
  .amdhsa_accum_offset 256
  .amdhsa_group_segment_fixed_size 0
  .amdhsa_kernarg_size 112
  .amdhsa_user_sgpr_count 2
  .amdhsa_user_sgpr_kernarg_segment_ptr 1
  .amdhsa_system_sgpr_workgroup_id_x 1
  .amdhsa_float_denorm_mode_32 3
  .amdhsa_float_denorm_mode_16_64 3
.end_amdhsa_kernel
```

```asm
; @launch grid=(256,1,1) block=(512,1,1) lds=163840
.amdgcn_target "amdgcn-amd-amdhsa--gfx950"
.text
.globl adaLN_cond__linear_kernel_hedgehog__moe_arch_mod__prompt_kernel
.p2align 12
.type adaLN_cond__linear_kernel_hedgehog__moe_arch_mod__prompt_kernel,@function
adaLN_cond__linear_kernel_hedgehog__moe_arch_mod__prompt_kernel:
    s_load_dwordx16 s[68:83], s[0:1], 0
    s_load_dwordx8 s[84:91], s[0:1], 64
    s_load_dwordx2 s[32:33], s[0:1], 104
    s_cmp_ge_u32 s2, 256
    s_cbranch_scc1 L_END
    v_lshrrev_b32 v4, 6, v0
    v_and_b32 v1, 63, v0
    s_nop 0
    v_readfirstlane_b32 s3, v4
    v_lshlrev_b32 v2, 4, v1
    s_mov_b32 s38, 4194304
    s_mov_b32 s39, 0x20000
    s_mov_b32 s50, 12582912
    s_mov_b32 s51, 0x20000
    s_mov_b32 s34, 268435456
    s_mov_b32 s35, 0x20000
    s_mov_b32 s42, 6291456
    s_mov_b32 s43, 0x20000
    s_mov_b32 s46, 2097152
    s_mov_b32 s47, 0x20000
    s_mov_b32 s54, 7340032
    s_mov_b32 s55, 0x20000
    s_mov_b32 s58, 7340032
    s_mov_b32 s59, 0x20000
    s_mov_b32 s62, 7340032
    s_mov_b32 s63, 0x20000
    s_mov_b32 s66, 4194304
    s_mov_b32 s67, 0x20000
    s_mov_b32 s5, 0
    s_mov_b32 s6, 0xffff0000
    s_mov_b32 s7, 0x3fb8aa3b
    s_and_b32 s8, s2, 7
    s_lshr_b32 s9, s2, 3
    s_lshl_b32 s96, s8, 5
    s_add_u32 s97, s96, s9
    s_lshl3_add_u32 s93, s97, s3
    s_and_b32 s96, s8, 4
    s_lshr_b32 s97, s9, 2
    s_lshl1_add_u32 s10, s96, s97
    s_and_b32 s96, s8, 3
    s_and_b32 s97, s9, 3
    s_xor_b32 s98, s97, 2
    s_lshl2_add_u32 s11, s96, s98
    s_and_b32 s96, s8, 1
    s_and_b32 s97, s9, 7
    s_lshl3_add_u32 s12, s96, s97
    s_lshr_b32 s96, s8, 1
    s_lshr_b32 s97, s9, 3
    s_lshl2_add_u32 s21, s96, s97
    s_lshl_b32 s96, s2, 6
    s_add_u32 s97, s96, s3
    s_lshl_b32 s98, s97, 6
    s_add_u32 s92, s98, 1048576
    s_lshl_b32 s16, s93, 11
    s_lshl3_add_u32 s96, s8, s3
    s_lshl_b32 s15, s96, 5
    s_mul_i32 s96, s15, 6144
    s_xor_b32 s97, s9, 1
    s_lshl_b32 s98, s97, 7
    s_add_u32 s13, s96, s98
    s_add_u32 s14, s13, 98304
    s_lshl3_add_u32 s96, s21, s3
    s_lshl_b32 s97, s96, 15
    s_lshl_b32 s98, s12, 7
    s_add_u32 s18, s97, s98
    s_lshr_b32 s96, s8, 1
    s_lshl4_add_u32 s97, s96, s12
    s_lshl4_add_u32 s98, s97, s3
    s_lshl_b32 s99, s98, 9
    s_add_u32 s17, s99, 524288
    v_lshrrev_b32 v248, 3, v1
    v_mul_u32_u24 v248, 12288, v248
    v_and_b32 v9, 7, v1
    v_lshl_add_u32 v248, v9, 4, v248
    v_lshrrev_b32 v249, 3, v1
    v_lshl_add_u32 v249, v249, 1, s15
    v_and_b32 v10, 15, v1
    v_lshlrev_b32 v10, 11, v10
    v_lshrrev_b32 v9, 4, v1
    v_lshl_add_u32 v10, v9, 4, v10
    s_waitcnt lgkmcnt(0)
    s_mov_b64 s[48:49], s[88:89]
    buffer_load_dwordx4 v[160:163], v248, s[48:51], s13 offen nt
    buffer_load_dwordx4 v[164:167], v248, s[48:51], s14 offen nt
    s_load_dword s4, s[32:33], 0
    global_load_ushort v168, v249, s[86:87]
    global_load_ushort v169, v249, s[86:87] offset:16
    s_mov_b64 s[36:37], s[68:69]
    s_load_dword s24, s[32:33], s92 offset:0 glc
    s_load_dword s25, s[32:33], s17 offset:508 glc
    s_load_dword s26, s[32:33], s17 offset:4604 glc
    s_barrier
    buffer_load_dwordx4 v[152:155], v2, s[36:39], s16 offen
    buffer_load_dwordx4 v[156:159], v2, s[36:39], s16 offen offset:1024
    s_mov_b64 s[40:41], s[70:71]
    s_mov_b64 s[44:45], s[74:75]
    s_mov_b64 s[52:53], s[80:81]
    s_mov_b64 s[56:57], s[82:83]
    s_mov_b64 s[60:61], s[84:85]
    s_mov_b64 s[64:65], s[90:91]
    s_getpc_b64 s[22:23]
    s_and_b32 s22, s22, 0xfffffc00
    s_lshl3_add_u32 s96, s9, s3
    s_lshl_b32 s19, s96, 7
    v_lshrrev_b32 v4, 5, v1
    v_lshl_add_u32 v4, v4, 15, s19
    v_min_u32 v4, 41984, v4
    global_load_dword v11, v4, s[22:23]
    s_lshr_b32 s76, s3, 2
    s_and_b32 s77, s3, 3
    s_lshl_b32 s83, s3, 10
    s_mul_i32 s96, s8, 7
    s_lshr_b32 s97, s9, 2
    s_add_u32 s74, s96, s97
    s_and_b32 s75, s9, 3
    v_bfe_u32 v6, v1, 4, 1
    v_lshlrev_b32 v6, 6, v6
    v_and_b32 v3, 7, v1
    v_lshlrev_b32 v3, 4, v3
    v_xor_b32 v3, v3, v6
    v_lshrrev_b32 v6, 3, v1
    v_mul_u32_u24 v6, 6144, v6
    v_add_u32 v3, v3, v6
    s_and_b32 s84, s9, 12
    s_mul_i32 s96, s3, 49152
    s_lshl_b32 s97, s11, 7
    s_add_u32 s85, s96, s97
    v_lshlrev_b32 v250, 3, v1
    v_lshlrev_b32 v251, 5, v1
    v_add_u32 v251, 147456, v251
    s_lshl2_add_u32 s13, s3, 147456
    v_lshrrev_b32 v252, 4, v1
    v_lshl_add_u32 v252, v252, 6, s13
    v_and_b32 v9, 7, v1
    v_lshl_add_u32 v252, v9, 8, v252
    v_bfe_u32 v9, v1, 3, 1
    v_lshl_add_u32 v252, v9, 5, v252
    buffer_load_dwordx4 v[12:15], v10, s[36:39], s18 offen
    buffer_load_dwordx4 v[16:19], v10, s[36:39], s18 offen offset:64
    s_lshr_b32 s96, s3, 1
    s_xor_b32 s97, s9, 1
    s_and_b32 s98, s97, 15
    s_lshl4_add_u32 s99, s96, s98
    s_lshr_b32 s97, s9, 4
    s_lshl1_add_u32 s96, s99, s97
    s_lshl3_add_u32 s98, s96, s8
    s_lshl_b32 s99, s98, 9
    s_add_u32 s13, s99, 524288
    s_waitcnt vmcnt(5)
    v_lshlrev_b32 v168, 16, v168
    v_mul_f32 v4, s7, v168
    v_exp_f32 v4, -v4
    s_nop 0
    v_add_f32 v4, 1.0, v4
    v_rcp_f32 v4, v4
    s_nop 0
    v_mul_f32 v168, v168, v4
    v_cvt_pk_bf16_f32 v168, 0, v168
    v_lshlrev_b32 v169, 16, v169
    v_mul_f32 v5, s7, v169
    v_exp_f32 v5, -v5
    s_nop 0
    v_add_f32 v5, 1.0, v5
    v_rcp_f32 v5, v5
    s_nop 0
    v_mul_f32 v169, v169, v5
    v_cvt_pk_bf16_f32 v169, 0, v169
    v_lshlrev_b32 v4, 16, v160
    v_and_b32 v5, s6, v160
    v_pk_mul_f32 v[176:177], v[168:169], v[4:5] op_sel:[0,0] op_sel_hi:[0,1]
    v_lshlrev_b32 v6, 16, v161
    v_and_b32 v7, s6, v161
    v_pk_mul_f32 v[178:179], v[168:169], v[6:7] op_sel:[0,0] op_sel_hi:[0,1]
    v_lshlrev_b32 v4, 16, v162
    v_and_b32 v5, s6, v162
    v_pk_mul_f32 v[180:181], v[168:169], v[4:5] op_sel:[0,0] op_sel_hi:[0,1]
    v_lshlrev_b32 v6, 16, v163
    v_and_b32 v7, s6, v163
    v_pk_mul_f32 v[182:183], v[168:169], v[6:7] op_sel:[0,0] op_sel_hi:[0,1]
    v_lshlrev_b32 v4, 16, v164
    v_and_b32 v5, s6, v164
    v_pk_fma_f32 v[176:177], v[168:169], v[4:5], v[176:177] op_sel:[1,0,0] op_sel_hi:[1,1,1]
    v_lshlrev_b32 v6, 16, v165
    v_and_b32 v7, s6, v165
    v_pk_fma_f32 v[178:179], v[168:169], v[6:7], v[178:179] op_sel:[1,0,0] op_sel_hi:[1,1,1]
    v_lshlrev_b32 v4, 16, v166
    v_and_b32 v5, s6, v166
    v_pk_fma_f32 v[180:181], v[168:169], v[4:5], v[180:181] op_sel:[1,0,0] op_sel_hi:[1,1,1]
    v_lshlrev_b32 v6, 16, v167
    v_and_b32 v7, s6, v167
    v_pk_fma_f32 v[182:183], v[168:169], v[6:7], v[182:183] op_sel:[1,0,0] op_sel_hi:[1,1,1]
    v_permlane32_swap_b32 v176, v180
    v_permlane32_swap_b32 v177, v181
    v_permlane32_swap_b32 v178, v182
    v_permlane32_swap_b32 v179, v183
    v_add_f32 v176, v176, v180
    v_add_f32 v177, v177, v181
    v_add_f32 v178, v178, v182
    v_add_f32 v179, v179, v183
    s_nop 0
    v_permlane16_swap_b32 v176, v178
    v_permlane16_swap_b32 v177, v179
    v_add_f32 v176, v176, v178
    v_add_f32 v177, v177, v179
    s_nop 0
    v_add_f32_dpp v176, v176, v176 row_ror:8 row_mask:0xf bank_mask:0xf
    v_add_f32_dpp v177, v177, v177 row_ror:8 row_mask:0xf bank_mask:0xf
    s_nop 1
    v_mov_b32_dpp v176, v177 quad_perm:[0,1,2,3] row_mask:0xf bank_mask:0xc
    s_waitcnt lgkmcnt(0)
    s_mul_i32 s4, s4, 0x9e3779b1
    s_add_u32 s4, s4, 0x7f4a7c15
    ds_write_b32 v252, v176
    s_waitcnt lgkmcnt(0)
    s_barrier
    ds_read_b128 v[176:179], v251
    ds_read_b128 v[180:183], v251 offset:16
    s_waitcnt lgkmcnt(0)
    v_pk_add_f32 v[176:177], v[176:177], v[178:179]
    v_pk_add_f32 v[180:181], v[180:181], v[182:183]
    v_pk_add_f32 v[176:177], v[176:177], v[180:181]
    v_add_f32 v176, v176, v177
    v_mov_b32 v177, s4
    s_bitcmp1_b32 s3, 0
    s_cselect_b32 exec_lo, 0, -1
    s_cselect_b32 exec_hi, -1, 0
    buffer_store_dwordx2 v[176:177], v250, s[32:35], s13 offen sc1
    s_mov_b64 exec, -1
    s_lshr_b32 s96, s9, 4
    s_lshl_b32 s94, s96, 1
    s_add_u32 s96, s94, s84
    s_and_b32 s97, s96, 15
    s_mul_i32 s98, s97, 393216
    s_add_u32 s91, s98, s85
    s_lshl_b32 s96, s94, 13
    s_add_u32 s94, s96, s83
    s_add_u32 s82, s91, 2048
    s_mov_b32 m0, s94
    s_nop 0
    buffer_load_dwordx4 v3, s[40:43], s82 offen lds
    s_add_u32 s82, s91, 4096
    s_add_u32 m0, s94, 49152
    s_nop 0
    buffer_load_dwordx4 v3, s[40:43], s82 offen lds
    s_waitcnt vmcnt(6)
    v_mov_b32 v8, 0x3f803f80
    v_dot2_f32_bf16 v4, v152, v8, 0
    v_dot2_f32_bf16 v5, v152, v152, 0
    v_dot2_f32_bf16 v6, v153, v8, 0
    v_dot2_f32_bf16 v7, v153, v153, 0
    v_dot2_f32_bf16 v4, v154, v8, v4
    v_dot2_f32_bf16 v5, v154, v154, v5
    v_dot2_f32_bf16 v6, v155, v8, v6
    v_dot2_f32_bf16 v7, v155, v155, v7
    v_dot2_f32_bf16 v4, v156, v8, v4
    v_dot2_f32_bf16 v5, v156, v156, v5
    v_dot2_f32_bf16 v6, v157, v8, v6
    v_dot2_f32_bf16 v7, v157, v157, v7
    v_dot2_f32_bf16 v4, v158, v8, v4
    v_dot2_f32_bf16 v5, v158, v158, v5
    v_dot2_f32_bf16 v6, v159, v8, v6
    v_dot2_f32_bf16 v7, v159, v159, v7
    s_nop 2
    v_pk_add_f32 v[4:5], v[4:5], v[6:7]
    s_nop 1
    v_add_f32_dpp v4, v4, v4 quad_perm:[1,0,3,2] row_mask:0xf bank_mask:0xf
    v_add_f32_dpp v5, v5, v5 quad_perm:[1,0,3,2] row_mask:0xf bank_mask:0xf
    s_nop 0
    v_add_f32_dpp v4, v4, v4 quad_perm:[2,3,0,1] row_mask:0xf bank_mask:0xf
    v_add_f32_dpp v5, v5, v5 quad_perm:[2,3,0,1] row_mask:0xf bank_mask:0xf
    s_nop 0
    v_add_f32_dpp v4, v4, v4 row_half_mirror row_mask:0xf bank_mask:0xf
    v_add_f32_dpp v5, v5, v5 row_half_mirror row_mask:0xf bank_mask:0xf
    s_nop 0
    v_add_f32_dpp v4, v4, v4 row_ror:8 row_mask:0xf bank_mask:0xf
    v_add_f32_dpp v5, v5, v5 row_ror:8 row_mask:0xf bank_mask:0xf
    s_nop 1
    v_permlane16_swap_b32 v4, v5
    v_add_f32 v8, v4, v5
    v_add_f32 v4, v4, v5
    s_nop 1
    v_permlane32_swap_b32 v4, v8
    v_add_f32 v4, v4, v8
    v_mul_f32 v8, 0x3a800000, v4
    v_mul_f32 v4, 0x3a800000, v4
    s_nop 1
    v_permlane16_swap_b32 v4, v8
    v_fma_f32 v173, -v4, v4, v8
    v_cvt_pk_bf16_f32 v172, 0, v4
    v_max_f32 v173, 0, v173
    v_cvt_pk_bf16_f32 v173, 0, v173
    v_add_f32 v173, 0x3727c5ac, v173
    v_cvt_pk_bf16_f32 v173, 0, v173
    v_sqrt_f32 v173, v173
    s_nop 0
    v_cvt_pk_bf16_f32 v173, 0, v173
    s_lshl3_add_u32 s13, s3, 153600
    v_lshrrev_b32 v172, 16, v172
    v_or_b32 v172, v172, v173
    v_mov_b32 v173, s4
    v_mov_b32 v4, s13
    ds_write_b64 v4, v[172:173]
    v_and_b32 v5, 3, v1
    v_lshlrev_b32 v5, 4, v5
    v_add_u32 v5, 153600, v5
    v_and_b32 v4, 3, v1
    v_lshlrev_b32 v4, 4, v4
    v_bfe_u32 v9, v1, 2, 1
    v_lshl_add_u32 v4, v9, 10, v4
    s_and_b32 s96, s8, 6
    s_and_b32 s97, s8, 1
    s_lshr_b32 s98, s9, 4
    s_lshl1_add_u32 s99, s97, s98
    s_lshl_b32 s97, s99, 6
    s_add_u32 s98, s96, s97
    s_lshl3_add_u32 s99, s3, s98
    s_lshl_b32 s96, s99, 10
    s_and_b32 s97, s9, 15
    s_lshl_b32 s98, s97, 6
    s_add_u32 s99, s96, s98
    s_add_u32 s13, s99, 262144
    s_waitcnt lgkmcnt(0)
    s_barrier
    ds_read_b128 v[172:175], v5
    s_waitcnt lgkmcnt(0)
    s_mov_b64 exec, 0xff
    buffer_store_dwordx4 v[172:175], v4, s[32:35], s13 offen sc1
    s_mov_b64 exec, -1
    s_mov_b32 s82, s91
    s_add_u32 m0, s94, 98304
    s_nop 0
    buffer_load_dwordx4 v3, s[40:43], s82 offen lds
    s_load_dword s24, s[32:33], s17 offset:508 glc
    s_load_dword s25, s[32:33], s17 offset:4604 glc
    v_and_b32 v4, 31, v1
    v_lshlrev_b32 v4, 4, v4
    v_lshrrev_b32 v9, 5, v1
    v_lshl_add_u32 v4, v9, 12, v4
    s_lshl2_add_u32 s14, s3, 155648
    v_lshl_add_u32 v5, v1, 6, s14
    v_and_b32 v6, 3, v1
    v_lshlrev_b32 v6, 5, v6
    v_lshrrev_b32 v9, 5, v1
    v_lshl_add_u32 v6, v9, 7, v6
    v_bfe_u32 v9, v1, 4, 1
    v_lshl_add_u32 v6, v9, 8, v6
    v_bfe_u32 v9, v1, 2, 2
    v_lshl_add_u32 v6, v9, 9, v6
    v_add_u32 v6, 155648, v6
    s_lshl3_add_u32 s96, s2, s3
    s_lshl_b32 s97, s96, 7
    s_add_u32 s14, s97, 262144
    v_and_b32 v8, 15, v1
    v_lshlrev_b32 v8, 3, v8
    s_branch SCHK_2
SPOLL_1:
    s_load_dword s24, s[32:33], s17 offset:508 glc
    s_load_dword s25, s[32:33], s17 offset:4604 glc
SCHK_2:
    s_add_u32 s5, s5, 1
    s_cmp_ge_u32 s5, 200000
    s_waitcnt lgkmcnt(0)
    s_cbranch_scc1 SDONE_3
    s_cmp_lg_u32 s24, s4
    s_cbranch_scc1 SPOLL_1
    s_cmp_lg_u32 s25, s4
    s_cbranch_scc1 SPOLL_1
SDONE_3:
    buffer_load_dwordx4 v[176:179], v4, s[32:35], s17 offen sc1
    s_load_dword s24, s[32:33], s14 offset:60 glc
    s_load_dword s25, s[32:33], s14 offset:124 glc
    s_waitcnt vmcnt(6)
    v_permlane32_swap_b32 v12, v14
    v_permlane32_swap_b32 v13, v15
    v_permlane32_swap_b32 v16, v18
    v_permlane32_swap_b32 v17, v19
    v_lshlrev_b32 v184, 16, v12
    v_and_b32 v185, s6, v12
    v_lshlrev_b32 v186, 16, v13
    v_and_b32 v187, s6, v13
    v_lshlrev_b32 v188, 16, v14
    v_and_b32 v189, s6, v14
    v_lshlrev_b32 v190, 16, v15
    v_and_b32 v191, s6, v15
    v_lshlrev_b32 v192, 16, v16
    v_and_b32 v193, s6, v16
    v_lshlrev_b32 v194, 16, v17
    v_and_b32 v195, s6, v17
    v_lshlrev_b32 v196, 16, v18
    v_and_b32 v197, s6, v18
    v_lshlrev_b32 v198, 16, v19
    v_and_b32 v199, s6, v19
    s_branch SCHK_6
SPOLL_5:
    s_load_dword s24, s[32:33], s14 offset:60 glc
    s_load_dword s25, s[32:33], s14 offset:124 glc
SCHK_6:
    s_add_u32 s5, s5, 1
    s_cmp_ge_u32 s5, 200000
    s_waitcnt lgkmcnt(0)
    s_cbranch_scc1 SDONE_7
    s_cmp_lg_u32 s24, s4
    s_cbranch_scc1 SPOLL_5
    s_cmp_lg_u32 s25, s4
    s_cbranch_scc1 SPOLL_5
SDONE_7:
    buffer_load_dwordx2 v[172:173], v8, s[32:35], s14 offen sc1
    s_lshr_b32 s96, s9, 4
    s_lshl_b32 s97, s96, 1
    s_xor_b32 s94, s97, 1
    s_add_u32 s96, s94, s84
    s_and_b32 s97, s96, 15
    s_mul_i32 s98, s97, 393216
    s_add_u32 s91, s98, s85
    s_lshl_b32 s96, s94, 13
    s_add_u32 s94, s96, s83
    s_add_u32 s82, s91, 2048
    s_mov_b32 m0, s94
    s_nop 0
    buffer_load_dwordx4 v3, s[40:43], s82 offen lds
    s_add_u32 s82, s91, 4096
    s_add_u32 m0, s94, 49152
    s_nop 0
    buffer_load_dwordx4 v3, s[40:43], s82 offen lds
    s_mov_b32 s82, s91
    s_add_u32 m0, s94, 98304
    s_nop 0
    buffer_load_dwordx4 v3, s[40:43], s82 offen lds
    s_waitcnt vmcnt(4)
    v_bitop3_b32 v7, v177, v179, s4 bitop3:0x7e
    v_cmp_ne_u32 vcc, 0, v7
    s_cbranch_vccz TOK_8
POLL_9:
    buffer_load_dwordx4 v[176:179], v4, s[32:35], s17 offen sc1
    s_waitcnt vmcnt(0)
    v_bitop3_b32 v7, v177, v179, s4 bitop3:0x7e
    v_cmp_ne_u32 vcc, 0, v7
    s_cbranch_vccz PDONE_10
    s_add_u32 s5, s5, 1
    s_cmp_lt_u32 s5, 200000
    s_cbranch_scc1 POLL_9
PDONE_10:
TOK_8:
    ds_write2_b32 v5, v176, v178 offset0:0 offset1:8
    s_waitcnt lgkmcnt(0)
    s_barrier
    ds_read_b128 v[208:211], v6 offset:2048
    ds_read_b128 v[212:215], v6 offset:2064
    ds_read_b128 v[200:203], v6
    ds_read_b128 v[204:207], v6 offset:16
    s_lshl_b32 s96, s11, 12
    s_lshl_b32 s97, s3, 9
    s_add_u32 s13, s96, s97
    v_add_u32 v4, s13, v2
    s_lshl_b32 s96, s3, 9
    s_add_u32 m0, s96, 159744
    s_mov_b32 exec_hi, 0
    global_load_lds_dwordx4 v4, s[72:73]
    s_mov_b32 exec_hi, -1
    s_lshl4_add_u32 s96, s21, s12
    s_lshr_b32 s97, s3, 1
    s_lshl2_add_u32 s98, s96, s97
    s_lshl_b32 s99, s98, 12
    s_and_b32 s96, s3, 1
    s_lshl_b32 s97, s96, 8
    s_add_u32 s98, s99, s97
    s_add_u32 s13, s98, 4194304
    v_and_b32 v4, 15, v1
    v_lshlrev_b32 v4, 4, v4
    v_bfe_u32 v9, v1, 4, 1
    v_lshl_add_u32 v4, v9, 10, v4
    v_lshrrev_b32 v9, 5, v1
    v_lshl_add_u32 v4, v9, 9, v4
    s_waitcnt lgkmcnt(2)
    v_pk_add_f32 v[208:209], v[208:209], v[210:211]
    v_pk_add_f32 v[212:213], v[212:213], v[214:215]
    v_pk_add_f32 v[208:209], v[208:209], v[212:213]
    v_add_f32 v208, v208, v209
    v_cvt_pk_bf16_f32 v208, 0, v208
    s_waitcnt lgkmcnt(0)
    v_pk_add_f32 v[200:201], v[200:201], v[202:203]
    v_pk_add_f32 v[204:205], v[204:205], v[206:207]
    v_pk_add_f32 v[200:201], v[200:201], v[204:205]
    v_add_f32 v200, v200, v201
    v_add_f32 v208, 1.0, v208
    v_cvt_pk_bf16_f32 v208, 0, v208
    v_cvt_pk_bf16_f32 v200, 0, v200
    s_waitcnt vmcnt(4)
    v_cmp_ne_u32 vcc, s4, v173
    s_cbranch_vccz L_STOK
POLL_11:
    buffer_load_dwordx2 v[172:173], v8, s[32:35], s14 offen sc1
    s_waitcnt vmcnt(0)
    v_cmp_ne_u32 vcc, s4, v173
    s_cbranch_vccz PDONE_12
    s_add_u32 s5, s5, 1
    s_cmp_lt_u32 s5, 200000
    s_cbranch_scc1 POLL_11
PDONE_12:
L_STOK:
    v_lshlrev_b32 v173, 16, v172
    v_and_b32 v172, s6, v172
    v_rcp_f32 v172, v172
    s_nop 0
    v_pk_add_f32 v[184:185], v[172:173], v[184:185] op_sel:[1,0] neg_lo:[1,0] neg_hi:[1,0]
    v_pk_add_f32 v[186:187], v[172:173], v[186:187] op_sel:[1,0] neg_lo:[1,0] neg_hi:[1,0]
    v_pk_add_f32 v[188:189], v[172:173], v[188:189] op_sel:[1,0] neg_lo:[1,0] neg_hi:[1,0]
    v_pk_add_f32 v[190:191], v[172:173], v[190:191] op_sel:[1,0] neg_lo:[1,0] neg_hi:[1,0]
    v_pk_add_f32 v[192:193], v[172:173], v[192:193] op_sel:[1,0] neg_lo:[1,0] neg_hi:[1,0]
    v_pk_add_f32 v[194:195], v[172:173], v[194:195] op_sel:[1,0] neg_lo:[1,0] neg_hi:[1,0]
    v_pk_add_f32 v[196:197], v[172:173], v[196:197] op_sel:[1,0] neg_lo:[1,0] neg_hi:[1,0]
    v_pk_add_f32 v[198:199], v[172:173], v[198:199] op_sel:[1,0] neg_lo:[1,0] neg_hi:[1,0]
    v_cvt_pk_bf16_f32 v184, 0, v184
    v_cvt_pk_bf16_f32 v185, 0, v185
    v_cvt_pk_bf16_f32 v186, 0, v186
    v_cvt_pk_bf16_f32 v187, 0, v187
    v_cvt_pk_bf16_f32 v188, 0, v188
    v_cvt_pk_bf16_f32 v189, 0, v189
    v_cvt_pk_bf16_f32 v190, 0, v190
    v_cvt_pk_bf16_f32 v191, 0, v191
    v_cvt_pk_bf16_f32 v192, 0, v192
    v_cvt_pk_bf16_f32 v193, 0, v193
    v_cvt_pk_bf16_f32 v194, 0, v194
    v_cvt_pk_bf16_f32 v195, 0, v195
    v_cvt_pk_bf16_f32 v196, 0, v196
    v_cvt_pk_bf16_f32 v197, 0, v197
    v_cvt_pk_bf16_f32 v198, 0, v198
    v_cvt_pk_bf16_f32 v199, 0, v199
    v_pk_mul_f32 v[184:185], v[184:185], v[172:173] op_sel_hi:[1,0]
    v_pk_mul_f32 v[186:187], v[186:187], v[172:173] op_sel_hi:[1,0]
    v_pk_mul_f32 v[188:189], v[188:189], v[172:173] op_sel_hi:[1,0]
    v_pk_mul_f32 v[190:191], v[190:191], v[172:173] op_sel_hi:[1,0]
    v_pk_mul_f32 v[192:193], v[192:193], v[172:173] op_sel_hi:[1,0]
    v_pk_mul_f32 v[194:195], v[194:195], v[172:173] op_sel_hi:[1,0]
    v_pk_mul_f32 v[196:197], v[196:197], v[172:173] op_sel_hi:[1,0]
    v_pk_mul_f32 v[198:199], v[198:199], v[172:173] op_sel_hi:[1,0]
    v_cvt_pk_bf16_f32 v184, 0, v184
    v_cvt_pk_bf16_f32 v185, 0, v185
    v_cvt_pk_bf16_f32 v186, 0, v186
    v_cvt_pk_bf16_f32 v187, 0, v187
    v_cvt_pk_bf16_f32 v188, 0, v188
    v_cvt_pk_bf16_f32 v189, 0, v189
    v_cvt_pk_bf16_f32 v190, 0, v190
    v_cvt_pk_bf16_f32 v191, 0, v191
    v_cvt_pk_bf16_f32 v192, 0, v192
    v_cvt_pk_bf16_f32 v193, 0, v193
    v_cvt_pk_bf16_f32 v194, 0, v194
    v_cvt_pk_bf16_f32 v195, 0, v195
    v_cvt_pk_bf16_f32 v196, 0, v196
    v_cvt_pk_bf16_f32 v197, 0, v197
    v_cvt_pk_bf16_f32 v198, 0, v198
    v_cvt_pk_bf16_f32 v199, 0, v199
    v_mul_f32_dpp v184, v208, v184 row_newbcast:0 row_mask:0xf bank_mask:0xf
    v_mul_f32_dpp v185, v208, v185 row_newbcast:1 row_mask:0xf bank_mask:0xf
    v_mul_f32_dpp v186, v208, v186 row_newbcast:2 row_mask:0xf bank_mask:0xf
    v_mul_f32_dpp v187, v208, v187 row_newbcast:3 row_mask:0xf bank_mask:0xf
    v_mul_f32_dpp v188, v208, v188 row_newbcast:4 row_mask:0xf bank_mask:0xf
    v_mul_f32_dpp v189, v208, v189 row_newbcast:5 row_mask:0xf bank_mask:0xf
    v_mul_f32_dpp v190, v208, v190 row_newbcast:6 row_mask:0xf bank_mask:0xf
    v_mul_f32_dpp v191, v208, v191 row_newbcast:7 row_mask:0xf bank_mask:0xf
    v_cvt_pk_bf16_f32 v184, 0, v184
    v_cvt_pk_bf16_f32 v185, 0, v185
    v_cvt_pk_bf16_f32 v186, 0, v186
    v_cvt_pk_bf16_f32 v187, 0, v187
    v_cvt_pk_bf16_f32 v188, 0, v188
    v_cvt_pk_bf16_f32 v189, 0, v189
    v_cvt_pk_bf16_f32 v190, 0, v190
    v_cvt_pk_bf16_f32 v191, 0, v191
    v_add_f32_dpp v184, v200, v184 row_newbcast:0 row_mask:0xf bank_mask:0xf
    v_add_f32_dpp v185, v200, v185 row_newbcast:1 row_mask:0xf bank_mask:0xf
    v_add_f32_dpp v186, v200, v186 row_newbcast:2 row_mask:0xf bank_mask:0xf
    v_add_f32_dpp v187, v200, v187 row_newbcast:3 row_mask:0xf bank_mask:0xf
    v_add_f32_dpp v188, v200, v188 row_newbcast:4 row_mask:0xf bank_mask:0xf
    v_add_f32_dpp v189, v200, v189 row_newbcast:5 row_mask:0xf bank_mask:0xf
    v_add_f32_dpp v190, v200, v190 row_newbcast:6 row_mask:0xf bank_mask:0xf
    v_add_f32_dpp v191, v200, v191 row_newbcast:7 row_mask:0xf bank_mask:0xf
    v_cvt_pk_bf16_f32 v216, v184, v185
    v_cvt_pk_bf16_f32 v217, v186, v187
    v_cvt_pk_bf16_f32 v218, v188, v189
    v_cvt_pk_bf16_f32 v219, v190, v191
    buffer_store_dwordx4 v[216:219], v4, s[32:35], s13 offen sc1
    v_mul_f32_dpp v192, v208, v192 row_newbcast:8 row_mask:0xf bank_mask:0xf
    v_mul_f32_dpp v193, v208, v193 row_newbcast:9 row_mask:0xf bank_mask:0xf
    v_mul_f32_dpp v194, v208, v194 row_newbcast:10 row_mask:0xf bank_mask:0xf
    v_mul_f32_dpp v195, v208, v195 row_newbcast:11 row_mask:0xf bank_mask:0xf
    v_mul_f32_dpp v196, v208, v196 row_newbcast:12 row_mask:0xf bank_mask:0xf
    v_mul_f32_dpp v197, v208, v197 row_newbcast:13 row_mask:0xf bank_mask:0xf
    v_mul_f32_dpp v198, v208, v198 row_newbcast:14 row_mask:0xf bank_mask:0xf
    v_mul_f32_dpp v199, v208, v199 row_newbcast:15 row_mask:0xf bank_mask:0xf
    v_cvt_pk_bf16_f32 v192, 0, v192
    v_cvt_pk_bf16_f32 v193, 0, v193
    v_cvt_pk_bf16_f32 v194, 0, v194
    v_cvt_pk_bf16_f32 v195, 0, v195
    v_cvt_pk_bf16_f32 v196, 0, v196
    v_cvt_pk_bf16_f32 v197, 0, v197
    v_cvt_pk_bf16_f32 v198, 0, v198
    v_cvt_pk_bf16_f32 v199, 0, v199
    v_add_f32_dpp v192, v200, v192 row_newbcast:8 row_mask:0xf bank_mask:0xf
    v_add_f32_dpp v193, v200, v193 row_newbcast:9 row_mask:0xf bank_mask:0xf
    v_add_f32_dpp v194, v200, v194 row_newbcast:10 row_mask:0xf bank_mask:0xf
    v_add_f32_dpp v195, v200, v195 row_newbcast:11 row_mask:0xf bank_mask:0xf
    v_add_f32_dpp v196, v200, v196 row_newbcast:12 row_mask:0xf bank_mask:0xf
    v_add_f32_dpp v197, v200, v197 row_newbcast:13 row_mask:0xf bank_mask:0xf
    v_add_f32_dpp v198, v200, v198 row_newbcast:14 row_mask:0xf bank_mask:0xf
    v_add_f32_dpp v199, v200, v199 row_newbcast:15 row_mask:0xf bank_mask:0xf
    v_cvt_pk_bf16_f32 v220, v192, v193
    v_cvt_pk_bf16_f32 v221, v194, v195
    v_cvt_pk_bf16_f32 v222, v196, v197
    v_cvt_pk_bf16_f32 v223, v198, v199
    buffer_store_dwordx4 v[220:223], v4, s[32:35], s13 offen offset:2048 sc1
    v_bfe_u32 v20, v1, 2, 2
    v_lshlrev_b32 v20, 7, v20
    v_bfe_u32 v9, v1, 3, 1
    v_lshl_add_u32 v20, v9, 6, v20
    v_bfe_u32 v9, v1, 4, 1
    v_lshl_add_u32 v20, v9, 5, v20
    v_and_b32 v9, 3, v1
    v_lshl_add_u32 v20, v9, 3, v20
    v_lshrrev_b32 v9, 5, v1
    v_lshl_add_u32 v20, v9, 9, v20
    v_xor_b32 v21, 64, v20
    v_add_u32 v22, 49152, v20
    v_add_u32 v23, 49152, v21
    v_add_u32 v24, 98304, v20
    v_add_u32 v25, 98304, v21
    v_and_b32 v5, 3, v1
    v_lshlrev_b32 v5, 15, v5
    v_bfe_u32 v9, v1, 2, 2
    v_lshl_add_u32 v5, v9, 12, v5
    s_and_b32 s96, s12, 1
    s_lshr_b32 s97, s21, 3
    s_and_b32 s98, s21, 7
    s_lshl_b32 s99, s98, 5
    s_lshl2_add_u32 s98, s97, s99
    s_lshl_b32 s97, s98, 12
    s_lshr_b32 s99, s12, 1
    s_lshl_b32 s98, s99, 6
    s_add_u32 s99, s97, s98
    s_lshl2_add_u32 s97, s96, s99
    s_add_u32 s13, s97, 1048576
    s_lshl_b32 s96, s10, 18
    s_lshl_b32 s97, s77, 12
    s_add_u32 s98, s96, s97
    s_add_u32 s88, s98, 4194304
    s_cmp_ge_u32 s9, 28
    s_cselect_b32 s54, 0, s54
    s_cselect_b32 s58, 0, s58
    s_cselect_b32 s62, 0, s62
    s_waitcnt vmcnt(0)
    s_barrier
    s_cmp_lg_u32 s3, 0
    s_cbranch_scc1 L_PB
    v_mov_b32 v6, s4
    s_mov_b32 exec_hi, 0
    s_mov_b32 exec_lo, 65535
    buffer_store_dword v6, v5, s[32:35], s13 offen sc1
    s_mov_b64 exec, -1
L_PB:
    s_lshr_b32 s96, s9, 4
    s_lshl_b32 s97, s96, 1
    s_xor_b32 s94, s97, 2
    s_add_u32 s96, s94, s84
    s_and_b32 s97, s96, 15
    s_mul_i32 s98, s97, 393216
    s_add_u32 s91, s98, s85
    s_lshl_b32 s96, s94, 13
    s_add_u32 s94, s96, s83
    s_add_u32 s82, s91, 2048
    s_mov_b32 m0, s94
    s_nop 0
    buffer_load_dwordx4 v3, s[40:43], s82 offen lds
    s_add_u32 s82, s91, 4096
    s_add_u32 m0, s94, 49152
    s_nop 0
    buffer_load_dwordx4 v3, s[40:43], s82 offen lds
    s_mov_b32 s82, s91
    s_add_u32 m0, s94, 98304
    s_nop 0
    buffer_load_dwordx4 v3, s[40:43], s82 offen lds
    s_lshr_b32 s96, s9, 4
    s_lshl_b32 s97, s96, 1
    s_xor_b32 s94, s97, 3
    s_add_u32 s96, s94, s84
    s_and_b32 s97, s96, 15
    s_mul_i32 s98, s97, 393216
    s_add_u32 s91, s98, s85
    s_lshl_b32 s96, s94, 13
    s_add_u32 s94, s96, s83
    s_add_u32 s82, s91, 2048
    s_mov_b32 m0, s94
    s_nop 0
    buffer_load_dwordx4 v3, s[40:43], s82 offen lds
    s_add_u32 s82, s91, 4096
    s_add_u32 m0, s94, 49152
    s_nop 0
    buffer_load_dwordx4 v3, s[40:43], s82 offen lds
    s_mov_b32 s82, s91
    s_add_u32 m0, s94, 98304
    s_nop 0
    buffer_load_dwordx4 v3, s[40:43], s82 offen lds
    s_lshl_b32 s96, s2, 12
    s_add_u32 s19, s96, 1048576
    s_and_b32 s96, s3, 3
    s_lshl_b32 s97, s96, 7
    s_add_u32 s20, s97, s19
    s_lshl_b32 s96, s84, 5
    s_add_u32 s19, s96, s19
    s_cmp_ge_u32 s3, 4
    s_cselect_b32 s19, s20, s19
    s_load_dwordx2 s[24:25], s[32:33], s19 offset:0 glc
    s_load_dwordx2 s[26:27], s[32:33], s19 offset:64 glc
    s_add_u32 s96, s84, 4
    s_and_b32 s97, s96, 15
    s_mul_i32 s98, s97, 393216
    s_add_u32 s91, s98, s85
    s_add_u32 s94, s83, 32768
    s_add_u32 s82, s91, 2048
    s_mov_b32 m0, s94
    s_nop 0
    buffer_load_dwordx4 v3, s[40:43], s82 offen lds
    s_add_u32 s82, s91, 4096
    s_add_u32 m0, s94, 49152
    s_nop 0
    buffer_load_dwordx4 v3, s[40:43], s82 offen lds
    s_mov_b32 s82, s91
    s_add_u32 m0, s94, 98304
    s_nop 0
    buffer_load_dwordx4 v3, s[40:43], s82 offen lds
    s_lshl_b32 s96, s3, 14
    s_lshl_b32 s97, s12, 7
    s_add_u32 s90, s96, s97
    s_and_b32 s96, s9, 1
    s_lshr_b32 s97, s9, 3
    s_lshl_b32 s98, s97, 1
    s_lshl3_add_u32 s99, s96, s98
    s_lshl_b32 s95, s99, 17
    s_lshl3_add_u32 s96, s75, s3
    s_mul_i32 s97, s96, 229376
    s_lshl_b32 s98, s74, 7
    s_add_u32 s80, s97, s98
    s_lshl3_add_u32 s96, s74, s3
    s_lshl_b32 s97, s96, 14
    s_lshl_b32 s98, s75, 9
    s_add_u32 s81, s97, s98
    s_and_b32 s96, s8, 3
    s_lshl3_add_u32 s97, s96, s3
    s_mul_i32 s98, s97, 393216
    s_lshr_b32 s99, s8, 2
    s_lshl1_add_u32 s96, s9, s99
    s_lshl_b32 s97, s96, 7
    s_add_u32 s99, s98, s97
    s_add_u32 s89, s99, 4096
    s_and_b32 s96, s3, 1
    s_lshl_b32 s14, s96, 6
    v_bfe_u32 v6, v1, 4, 1
    v_lshl_add_u32 v6, v6, 5, s14
    v_and_b32 v26, 7, v1
    v_lshlrev_b32 v26, 4, v26
    v_xor_b32 v26, v26, v6
    v_lshrrev_b32 v6, 3, v1
    v_lshlrev_b32 v6, 11, v6
    v_add_u32 v26, v26, v6
    s_and_b32 s96, s3, 2
    s_lshl_b32 s14, s96, 5
    v_bfe_u32 v6, v1, 4, 1
    v_lshl_add_u32 v6, v6, 5, s14
    v_and_b32 v27, 7, v1
    v_lshlrev_b32 v27, 4, v27
    v_xor_b32 v27, v27, v6
    v_lshrrev_b32 v6, 3, v1
    v_mul_u32_u24 v6, 7168, v6
    v_add_u32 v27, v27, v6
    s_and_b32 s96, s3, 1
    s_lshl_b32 s14, s96, 7
    v_lshrrev_b32 v6, 5, v1
    v_lshl_add_u32 v6, v6, 6, s14
    v_and_b32 v253, 31, v1
    v_lshlrev_b32 v253, 4, v253
    v_lshrrev_b32 v9, 5, v1
    v_lshl_add_u32 v253, v9, 11, v253
    v_xor_b32 v253, v253, v6
    s_lshl_b32 s16, s84, 14
    v_add_u32 v249, s88, v2
    s_lshl_b32 s96, s77, 11
    s_add_u32 s14, s96, 151552
    v_add_u32 v0, s14, v2
    s_mov_b64 exec, 0
    s_cmp_eq_u32 s3, 4
    s_cbranch_scc1 L_PAD2
    s_cmp_eq_u32 s3, 5
    s_cbranch_scc1 L_PAD3
    s_cmp_eq_u32 s3, 6
    s_cbranch_scc1 L_PAD4
    s_cmp_eq_u32 s3, 7
    s_cbranch_scc1 L_PAD5
    s_branch L_TEND
L_RET2:
    s_branch L_PAD6
L_RET6:
    s_branch L_PAD10
L_RET10:
    s_branch L_TEND
L_RET3:
    s_branch L_PAD7
L_RET7:
    s_branch L_TEND
L_RET4:
    s_branch L_PAD8
L_RET8:
    s_branch L_TEND
L_RET5:
    s_branch L_PAD9
L_RET9:
    s_branch L_TEND
    s_nop 0
    s_nop 0
    s_nop 0
    s_nop 0
    s_nop 0
    s_nop 0
    s_nop 0
    s_nop 0
    s_nop 0
    s_nop 0
    s_nop 0
    s_nop 0
    s_nop 0
    s_nop 0
    s_nop 0
    s_nop 0
    s_nop 0
    s_nop 0
    s_nop 0
    s_nop 0
    s_nop 0
    s_nop 0
    s_nop 0
    s_nop 0
    s_nop 0
    s_nop 0
    s_nop 0
    s_nop 0
L_TEND:
    s_mov_b64 exec, -1
    s_branch SCHK_14
SPOLL_13:
    s_load_dwordx2 s[24:25], s[32:33], s19 offset:0 glc
    s_load_dwordx2 s[26:27], s[32:33], s19 offset:64 glc
SCHK_14:
    s_add_u32 s5, s5, 1
    s_cmp_ge_u32 s5, 200000
    s_waitcnt lgkmcnt(0)
    s_cbranch_scc1 SDONE_15
    s_cmp_lg_u32 s24, s4
    s_cbranch_scc1 SPOLL_13
    s_cmp_lg_u32 s25, s4
    s_cbranch_scc1 SPOLL_13
    s_cmp_lg_u32 s26, s4
    s_cbranch_scc1 SPOLL_13
    s_cmp_lg_u32 s27, s4
    s_cbranch_scc1 SPOLL_13
SDONE_15:
    s_cmp_ge_u32 s3, 4
    s_cbranch_scc1 L_HELP
    s_setprio 2
    buffer_load_dwordx4 v[152:155], v249, s[32:35], s16 offen sc1
    buffer_load_dwordx4 v[156:159], v249, s[32:35], s16 offen offset:1024 sc1
    buffer_load_dwordx4 v[160:163], v249, s[32:35], s16 offen offset:2048 sc1
    buffer_load_dwordx4 v[164:167], v249, s[32:35], s16 offen offset:3072 sc1
    s_add_u32 s16, s16, 16384
    s_and_b32 s16, s16, 0x3ffff
    buffer_load_dwordx4 v[168:171], v249, s[32:35], s16 offen sc1
    buffer_load_dwordx4 v[172:175], v249, s[32:35], s16 offen offset:1024 sc1
    s_waitcnt vmcnt(9)
    s_barrier
    ds_read_b64_tr_b16 v[28:29], v20
    ds_read_b64_tr_b16 v[30:31], v20 offset:2048
    ds_read_b64_tr_b16 v[32:33], v21
    ds_read_b64_tr_b16 v[34:35], v21 offset:2048
    ds_read_b64_tr_b16 v[36:37], v24
    ds_read_b64_tr_b16 v[38:39], v24 offset:2048
    ds_read_b64_tr_b16 v[40:41], v25
    ds_read_b64_tr_b16 v[42:43], v25 offset:2048
    ds_read_b64_tr_b16 v[44:45], v22
    ds_read_b64_tr_b16 v[46:47], v22 offset:2048
    ds_read_b64_tr_b16 v[48:49], v23
    ds_read_b64_tr_b16 v[50:51], v23 offset:2048
    s_waitcnt vmcnt(5)
    s_waitcnt lgkmcnt(10)
    v_mfma_f32_32x32x16_bf16 v[56:71], v[28:31], v[152:155], 0
    ds_read_b64_tr_b16 v[52:53], v20 offset:1024
    ds_read_b64_tr_b16 v[54:55], v20 offset:3072
    s_waitcnt lgkmcnt(10)
    v_mfma_f32_32x32x16_bf16 v[72:87], v[32:35], v[152:155], 0
    ds_read_b64_tr_b16 v[28:29], v21 offset:1024
    ds_read_b64_tr_b16 v[30:31], v21 offset:3072
    s_waitcnt lgkmcnt(10)
    v_mfma_f32_32x32x16_bf16 v[120:135], v[36:39], v[152:155], 0
    ds_read_b64_tr_b16 v[32:33], v24 offset:1024
    ds_read_b64_tr_b16 v[34:35], v24 offset:3072
    s_waitcnt lgkmcnt(10)
    v_mfma_f32_32x32x16_bf16 v[136:151], v[40:43], v[152:155], 0
    ds_read_b64_tr_b16 v[36:37], v25 offset:1024
    ds_read_b64_tr_b16 v[38:39], v25 offset:3072
    s_waitcnt lgkmcnt(10)
    v_mfma_f32_32x32x16_bf16 v[88:103], v[44:47], v[152:155], 0
    buffer_load_dwordx4 v[176:179], v249, s[32:35], s16 offen offset:2048 sc1
    ds_read_b64_tr_b16 v[40:41], v22 offset:1024
    ds_read_b64_tr_b16 v[42:43], v22 offset:3072
    s_waitcnt lgkmcnt(10)
    v_mfma_f32_32x32x16_bf16 v[104:119], v[48:51], v[152:155], 0
    ds_read_b64_tr_b16 v[44:45], v23 offset:1024
    ds_read_b64_tr_b16 v[46:47], v23 offset:3072
    s_waitcnt vmcnt(5)
    s_waitcnt lgkmcnt(10)
    v_mfma_f32_32x32x16_bf16 v[56:71], v[52:55], v[156:159], v[56:71]
    ds_read_b64_tr_b16 v[48:49], v20 offset:4096
    ds_read_b64_tr_b16 v[50:51], v20 offset:6144
    s_waitcnt lgkmcnt(10)
    v_mfma_f32_32x32x16_bf16 v[72:87], v[28:31], v[156:159], v[72:87]
    ds_read_b64_tr_b16 v[52:53], v21 offset:4096
    ds_read_b64_tr_b16 v[54:55], v21 offset:6144
    s_waitcnt lgkmcnt(10)
    v_mfma_f32_32x32x16_bf16 v[120:135], v[32:35], v[156:159], v[120:135]
    ds_read_b64_tr_b16 v[28:29], v24 offset:4096
    ds_read_b64_tr_b16 v[30:31], v24 offset:6144
    s_waitcnt lgkmcnt(10)
    v_mfma_f32_32x32x16_bf16 v[136:151], v[36:39], v[156:159], v[136:151]
    buffer_load_dwordx4 v[180:183], v249, s[32:35], s16 offen offset:3072 sc1
    ds_read_b64_tr_b16 v[32:33], v25 offset:4096
    ds_read_b64_tr_b16 v[34:35], v25 offset:6144
    s_waitcnt lgkmcnt(10)
    v_mfma_f32_32x32x16_bf16 v[88:103], v[40:43], v[156:159], v[88:103]
    s_add_u32 s16, s16, 16384
    ds_read_b64_tr_b16 v[36:37], v22 offset:4096
    ds_read_b64_tr_b16 v[38:39], v22 offset:6144
    s_waitcnt lgkmcnt(10)
    v_mfma_f32_32x32x16_bf16 v[104:119], v[44:47], v[156:159], v[104:119]
    s_and_b32 s16, s16, 0x3ffff
    ds_read_b64_tr_b16 v[40:41], v23 offset:4096
    ds_read_b64_tr_b16 v[42:43], v23 offset:6144
    s_waitcnt vmcnt(5)
    s_waitcnt lgkmcnt(10)
    v_mfma_f32_32x32x16_bf16 v[56:71], v[48:51], v[160:163], v[56:71]
    ds_read_b64_tr_b16 v[44:45], v20 offset:5120
    ds_read_b64_tr_b16 v[46:47], v20 offset:7168
    s_waitcnt lgkmcnt(10)
    v_mfma_f32_32x32x16_bf16 v[72:87], v[52:55], v[160:163], v[72:87]
    ds_read_b64_tr_b16 v[48:49], v21 offset:5120
    ds_read_b64_tr_b16 v[50:51], v21 offset:7168
    s_waitcnt lgkmcnt(10)
    v_mfma_f32_32x32x16_bf16 v[120:135], v[28:31], v[160:163], v[120:135]
    buffer_load_dwordx4 v[184:187], v249, s[32:35], s16 offen sc1
    ds_read_b64_tr_b16 v[52:53], v24 offset:5120
    ds_read_b64_tr_b16 v[54:55], v24 offset:7168
    s_waitcnt lgkmcnt(10)
    v_mfma_f32_32x32x16_bf16 v[136:151], v[32:35], v[160:163], v[136:151]
    ds_read_b64_tr_b16 v[28:29], v25 offset:5120
    ds_read_b64_tr_b16 v[30:31], v25 offset:7168
    s_waitcnt lgkmcnt(10)
    v_mfma_f32_32x32x16_bf16 v[88:103], v[36:39], v[160:163], v[88:103]
    ds_read_b64_tr_b16 v[32:33], v22 offset:5120
    ds_read_b64_tr_b16 v[34:35], v22 offset:7168
    s_waitcnt lgkmcnt(10)
    v_mfma_f32_32x32x16_bf16 v[104:119], v[40:43], v[160:163], v[104:119]
    ds_read_b64_tr_b16 v[36:37], v23 offset:5120
    ds_read_b64_tr_b16 v[38:39], v23 offset:7168
    s_waitcnt vmcnt(5)
    s_waitcnt lgkmcnt(10)
    v_mfma_f32_32x32x16_bf16 v[56:71], v[44:47], v[164:167], v[56:71]
    ds_read_b64_tr_b16 v[40:41], v20 offset:8192
    ds_read_b64_tr_b16 v[42:43], v20 offset:10240
    s_waitcnt lgkmcnt(10)
    v_mfma_f32_32x32x16_bf16 v[72:87], v[48:51], v[164:167], v[72:87]
    buffer_load_dwordx4 v[188:191], v249, s[32:35], s16 offen offset:1024 sc1
    ds_read_b64_tr_b16 v[44:45], v21 offset:8192
    ds_read_b64_tr_b16 v[46:47], v21 offset:10240
    s_waitcnt lgkmcnt(10)
    v_mfma_f32_32x32x16_bf16 v[120:135], v[52:55], v[164:167], v[120:135]
    ds_read_b64_tr_b16 v[48:49], v24 offset:8192
    ds_read_b64_tr_b16 v[50:51], v24 offset:10240
    s_waitcnt lgkmcnt(10)
    v_mfma_f32_32x32x16_bf16 v[136:151], v[28:31], v[164:167], v[136:151]
    ds_read_b64_tr_b16 v[52:53], v25 offset:8192
    ds_read_b64_tr_b16 v[54:55], v25 offset:10240
    s_waitcnt lgkmcnt(10)
    v_mfma_f32_32x32x16_bf16 v[88:103], v[32:35], v[164:167], v[88:103]
    ds_read_b64_tr_b16 v[28:29], v22 offset:8192
    ds_read_b64_tr_b16 v[30:31], v22 offset:10240
    s_waitcnt lgkmcnt(10)
    v_mfma_f32_32x32x16_bf16 v[104:119], v[36:39], v[164:167], v[104:119]
    buffer_load_dwordx4 v[192:195], v249, s[32:35], s16 offen offset:2048 sc1
    ds_read_b64_tr_b16 v[32:33], v23 offset:8192
    ds_read_b64_tr_b16 v[34:35], v23 offset:10240
    s_barrier
    s_waitcnt vmcnt(6)
    s_waitcnt lgkmcnt(10)
    v_mfma_f32_32x32x16_bf16 v[56:71], v[40:43], v[168:171], v[56:71]
    ds_read_b64_tr_b16 v[36:37], v20 offset:9216
    ds_read_b64_tr_b16 v[38:39], v20 offset:11264
    s_waitcnt lgkmcnt(10)
    v_mfma_f32_32x32x16_bf16 v[72:87], v[44:47], v[168:171], v[72:87]
    ds_read_b64_tr_b16 v[40:41], v21 offset:9216
    ds_read_b64_tr_b16 v[42:43], v21 offset:11264
    s_waitcnt lgkmcnt(10)
    v_mfma_f32_32x32x16_bf16 v[120:135], v[48:51], v[168:171], v[120:135]
    ds_read_b64_tr_b16 v[44:45], v24 offset:9216
    ds_read_b64_tr_b16 v[46:47], v24 offset:11264
    s_waitcnt lgkmcnt(10)
    v_mfma_f32_32x32x16_bf16 v[136:151], v[52:55], v[168:171], v[136:151]
    ds_read_b64_tr_b16 v[48:49], v25 offset:9216
    ds_read_b64_tr_b16 v[50:51], v25 offset:11264
    s_waitcnt lgkmcnt(10)
    v_mfma_f32_32x32x16_bf16 v[88:103], v[28:31], v[168:171], v[88:103]
    buffer_load_dwordx4 v[196:199], v249, s[32:35], s16 offen offset:3072 sc1
    ds_read_b64_tr_b16 v[52:53], v22 offset:9216
    ds_read_b64_tr_b16 v[54:55], v22 offset:11264
    s_waitcnt lgkmcnt(10)
    v_mfma_f32_32x32x16_bf16 v[104:119], v[32:35], v[168:171], v[104:119]
    s_add_u32 s16, s16, 16384
    ds_read_b64_tr_b16 v[28:29], v23 offset:9216
    ds_read_b64_tr_b16 v[30:31], v23 offset:11264
    s_waitcnt vmcnt(6)
    s_waitcnt lgkmcnt(10)
    v_mfma_f32_32x32x16_bf16 v[56:71], v[36:39], v[172:175], v[56:71]
    s_and_b32 s16, s16, 0x3ffff
    ds_read_b64_tr_b16 v[32:33], v20 offset:12288
    ds_read_b64_tr_b16 v[34:35], v20 offset:14336
    s_waitcnt lgkmcnt(10)
    v_mfma_f32_32x32x16_bf16 v[72:87], v[40:43], v[172:175], v[72:87]
    ds_read_b64_tr_b16 v[36:37], v21 offset:12288
    ds_read_b64_tr_b16 v[38:39], v21 offset:14336
    s_waitcnt lgkmcnt(10)
    v_mfma_f32_32x32x16_bf16 v[120:135], v[44:47], v[172:175], v[120:135]
    ds_read_b64_tr_b16 v[40:41], v24 offset:12288
    ds_read_b64_tr_b16 v[42:43], v24 offset:14336
    s_waitcnt lgkmcnt(10)
    v_mfma_f32_32x32x16_bf16 v[136:151], v[48:51], v[172:175], v[136:151]
    buffer_load_dwordx4 v[200:203], v249, s[32:35], s16 offen sc1
    ds_read_b64_tr_b16 v[44:45], v25 offset:12288
    ds_read_b64_tr_b16 v[46:47], v25 offset:14336
    s_waitcnt lgkmcnt(10)
    v_mfma_f32_32x32x16_bf16 v[88:103], v[52:55], v[172:175], v[88:103]
    ds_read_b64_tr_b16 v[48:49], v22 offset:12288
    ds_read_b64_tr_b16 v[50:51], v22 offset:14336
    s_waitcnt lgkmcnt(10)
    v_mfma_f32_32x32x16_bf16 v[104:119], v[28:31], v[172:175], v[104:119]
    ds_read_b64_tr_b16 v[52:53], v23 offset:12288
    ds_read_b64_tr_b16 v[54:55], v23 offset:14336
    s_waitcnt vmcnt(6)
    s_waitcnt lgkmcnt(10)
    v_mfma_f32_32x32x16_bf16 v[56:71], v[32:35], v[176:179], v[56:71]
    ds_read_b64_tr_b16 v[28:29], v20 offset:13312
    ds_read_b64_tr_b16 v[30:31], v20 offset:15360
    s_waitcnt lgkmcnt(10)
    v_mfma_f32_32x32x16_bf16 v[72:87], v[36:39], v[176:179], v[72:87]
    ds_read_b64_tr_b16 v[32:33], v21 offset:13312
    ds_read_b64_tr_b16 v[34:35], v21 offset:15360
    s_waitcnt lgkmcnt(10)
    v_mfma_f32_32x32x16_bf16 v[120:135], v[40:43], v[176:179], v[120:135]
    buffer_load_dwordx4 v[204:207], v249, s[32:35], s16 offen offset:1024 sc1
    ds_read_b64_tr_b16 v[36:37], v24 offset:13312
    ds_read_b64_tr_b16 v[38:39], v24 offset:15360
    s_waitcnt lgkmcnt(10)
    v_mfma_f32_32x32x16_bf16 v[136:151], v[44:47], v[176:179], v[136:151]
    ds_read_b64_tr_b16 v[40:41], v25 offset:13312
    ds_read_b64_tr_b16 v[42:43], v25 offset:15360
    s_waitcnt lgkmcnt(10)
    v_mfma_f32_32x32x16_bf16 v[88:103], v[48:51], v[176:179], v[88:103]
    ds_read_b64_tr_b16 v[44:45], v22 offset:13312
    ds_read_b64_tr_b16 v[46:47], v22 offset:15360
    s_waitcnt lgkmcnt(10)
    v_mfma_f32_32x32x16_bf16 v[104:119], v[52:55], v[176:179], v[104:119]
    ds_read_b64_tr_b16 v[48:49], v23 offset:13312
    ds_read_b64_tr_b16 v[50:51], v23 offset:15360
    s_waitcnt vmcnt(6)
    s_waitcnt lgkmcnt(10)
    v_mfma_f32_32x32x16_bf16 v[56:71], v[28:31], v[180:183], v[56:71]
    ds_read_b64_tr_b16 v[52:53], v20 offset:16384
    ds_read_b64_tr_b16 v[54:55], v20 offset:18432
    s_waitcnt lgkmcnt(10)
    v_mfma_f32_32x32x16_bf16 v[72:87], v[32:35], v[180:183], v[72:87]
    buffer_load_dwordx4 v[208:211], v249, s[32:35], s16 offen offset:2048 sc1
    ds_read_b64_tr_b16 v[28:29], v21 offset:16384
    ds_read_b64_tr_b16 v[30:31], v21 offset:18432
    s_waitcnt lgkmcnt(10)
    v_mfma_f32_32x32x16_bf16 v[120:135], v[36:39], v[180:183], v[120:135]
    ds_read_b64_tr_b16 v[32:33], v24 offset:16384
    ds_read_b64_tr_b16 v[34:35], v24 offset:18432
    s_waitcnt lgkmcnt(10)
    v_mfma_f32_32x32x16_bf16 v[136:151], v[40:43], v[180:183], v[136:151]
    ds_read_b64_tr_b16 v[36:37], v25 offset:16384
    ds_read_b64_tr_b16 v[38:39], v25 offset:18432
    s_waitcnt lgkmcnt(10)
    v_mfma_f32_32x32x16_bf16 v[88:103], v[44:47], v[180:183], v[88:103]
    ds_read_b64_tr_b16 v[40:41], v22 offset:16384
    ds_read_b64_tr_b16 v[42:43], v22 offset:18432
    s_waitcnt lgkmcnt(10)
    v_mfma_f32_32x32x16_bf16 v[104:119], v[48:51], v[180:183], v[104:119]
    buffer_load_dwordx4 v[212:215], v249, s[32:35], s16 offen offset:3072 sc1
    ds_read_b64_tr_b16 v[44:45], v23 offset:16384
    ds_read_b64_tr_b16 v[46:47], v23 offset:18432
    s_barrier
    s_waitcnt vmcnt(7)
    s_waitcnt lgkmcnt(10)
    v_mfma_f32_32x32x16_bf16 v[56:71], v[52:55], v[184:187], v[56:71]
    s_add_u32 s16, s16, 16384
    ds_read_b64_tr_b16 v[48:49], v20 offset:17408
    ds_read_b64_tr_b16 v[50:51], v20 offset:19456
    s_waitcnt lgkmcnt(10)
    v_mfma_f32_32x32x16_bf16 v[72:87], v[28:31], v[184:187], v[72:87]
    s_and_b32 s16, s16, 0x3ffff
    ds_read_b64_tr_b16 v[52:53], v21 offset:17408
    ds_read_b64_tr_b16 v[54:55], v21 offset:19456
    s_waitcnt lgkmcnt(10)
    v_mfma_f32_32x32x16_bf16 v[120:135], v[32:35], v[184:187], v[120:135]
    ds_read_b64_tr_b16 v[28:29], v24 offset:17408
    ds_read_b64_tr_b16 v[30:31], v24 offset:19456
    s_waitcnt lgkmcnt(10)
    v_mfma_f32_32x32x16_bf16 v[136:151], v[36:39], v[184:187], v[136:151]
    ds_read_b64_tr_b16 v[32:33], v25 offset:17408
    ds_read_b64_tr_b16 v[34:35], v25 offset:19456
    s_waitcnt lgkmcnt(10)
    v_mfma_f32_32x32x16_bf16 v[88:103], v[40:43], v[184:187], v[88:103]
    buffer_load_dwordx4 v[216:219], v249, s[32:35], s16 offen sc1
    ds_read_b64_tr_b16 v[36:37], v22 offset:17408
    ds_read_b64_tr_b16 v[38:39], v22 offset:19456
    s_waitcnt lgkmcnt(10)
    v_mfma_f32_32x32x16_bf16 v[104:119], v[44:47], v[184:187], v[104:119]
    ds_read_b64_tr_b16 v[40:41], v23 offset:17408
    ds_read_b64_tr_b16 v[42:43], v23 offset:19456
    s_waitcnt vmcnt(7)
    s_waitcnt lgkmcnt(10)
    v_mfma_f32_32x32x16_bf16 v[56:71], v[48:51], v[188:191], v[56:71]
    ds_read_b64_tr_b16 v[44:45], v20 offset:20480
    ds_read_b64_tr_b16 v[46:47], v20 offset:22528
    s_waitcnt lgkmcnt(10)
    v_mfma_f32_32x32x16_bf16 v[72:87], v[52:55], v[188:191], v[72:87]
    ds_read_b64_tr_b16 v[48:49], v21 offset:20480
    ds_read_b64_tr_b16 v[50:51], v21 offset:22528
    s_waitcnt lgkmcnt(10)
    v_mfma_f32_32x32x16_bf16 v[120:135], v[28:31], v[188:191], v[120:135]
    ds_read_b64_tr_b16 v[52:53], v24 offset:20480
    ds_read_b64_tr_b16 v[54:55], v24 offset:22528
    s_waitcnt lgkmcnt(10)
    v_mfma_f32_32x32x16_bf16 v[136:151], v[32:35], v[188:191], v[136:151]
    buffer_load_dwordx4 v[220:223], v249, s[32:35], s16 offen offset:1024 sc1
    ds_read_b64_tr_b16 v[28:29], v25 offset:20480
    ds_read_b64_tr_b16 v[30:31], v25 offset:22528
    s_waitcnt lgkmcnt(10)
    v_mfma_f32_32x32x16_bf16 v[88:103], v[36:39], v[188:191], v[88:103]
    ds_read_b64_tr_b16 v[32:33], v22 offset:20480
    ds_read_b64_tr_b16 v[34:35], v22 offset:22528
    s_waitcnt lgkmcnt(10)
    v_mfma_f32_32x32x16_bf16 v[104:119], v[40:43], v[188:191], v[104:119]
    ds_read_b64_tr_b16 v[36:37], v23 offset:20480
    ds_read_b64_tr_b16 v[38:39], v23 offset:22528
    s_waitcnt vmcnt(7)
    s_waitcnt lgkmcnt(10)
    v_mfma_f32_32x32x16_bf16 v[56:71], v[44:47], v[192:195], v[56:71]
    ds_read_b64_tr_b16 v[40:41], v20 offset:21504
    ds_read_b64_tr_b16 v[42:43], v20 offset:23552
    s_waitcnt lgkmcnt(10)
    v_mfma_f32_32x32x16_bf16 v[72:87], v[48:51], v[192:195], v[72:87]
    ds_read_b64_tr_b16 v[44:45], v21 offset:21504
    ds_read_b64_tr_b16 v[46:47], v21 offset:23552
    s_waitcnt lgkmcnt(10)
    v_mfma_f32_32x32x16_bf16 v[120:135], v[52:55], v[192:195], v[120:135]
    buffer_load_dwordx4 v[224:227], v249, s[32:35], s16 offen offset:2048 sc1
    ds_read_b64_tr_b16 v[48:49], v24 offset:21504
    ds_read_b64_tr_b16 v[50:51], v24 offset:23552
    s_waitcnt lgkmcnt(10)
    v_mfma_f32_32x32x16_bf16 v[136:151], v[28:31], v[192:195], v[136:151]
    ds_read_b64_tr_b16 v[52:53], v25 offset:21504
    ds_read_b64_tr_b16 v[54:55], v25 offset:23552
    s_waitcnt lgkmcnt(10)
    v_mfma_f32_32x32x16_bf16 v[88:103], v[32:35], v[192:195], v[88:103]
    ds_read_b64_tr_b16 v[28:29], v22 offset:21504
    ds_read_b64_tr_b16 v[30:31], v22 offset:23552
    s_waitcnt lgkmcnt(10)
    v_mfma_f32_32x32x16_bf16 v[104:119], v[36:39], v[192:195], v[104:119]
    ds_read_b64_tr_b16 v[32:33], v23 offset:21504
    ds_read_b64_tr_b16 v[34:35], v23 offset:23552
    s_waitcnt vmcnt(7)
    s_waitcnt lgkmcnt(10)
    v_mfma_f32_32x32x16_bf16 v[56:71], v[40:43], v[196:199], v[56:71]
    ds_read_b64_tr_b16 v[36:37], v20 offset:24576
    ds_read_b64_tr_b16 v[38:39], v20 offset:26624
    s_waitcnt lgkmcnt(10)
    v_mfma_f32_32x32x16_bf16 v[72:87], v[44:47], v[196:199], v[72:87]
    buffer_load_dwordx4 v[228:231], v249, s[32:35], s16 offen offset:3072 sc1
    ds_read_b64_tr_b16 v[40:41], v21 offset:24576
    ds_read_b64_tr_b16 v[42:43], v21 offset:26624
    s_waitcnt lgkmcnt(10)
    v_mfma_f32_32x32x16_bf16 v[120:135], v[48:51], v[196:199], v[120:135]
    s_add_u32 s16, s16, 16384
    ds_read_b64_tr_b16 v[44:45], v24 offset:24576
    ds_read_b64_tr_b16 v[46:47], v24 offset:26624
    s_waitcnt lgkmcnt(10)
    v_mfma_f32_32x32x16_bf16 v[136:151], v[52:55], v[196:199], v[136:151]
    s_and_b32 s16, s16, 0x3ffff
    ds_read_b64_tr_b16 v[48:49], v25 offset:24576
    ds_read_b64_tr_b16 v[50:51], v25 offset:26624
    s_waitcnt lgkmcnt(10)
    v_mfma_f32_32x32x16_bf16 v[88:103], v[28:31], v[196:199], v[88:103]
    ds_read_b64_tr_b16 v[52:53], v22 offset:24576
    ds_read_b64_tr_b16 v[54:55], v22 offset:26624
    s_waitcnt lgkmcnt(10)
    v_mfma_f32_32x32x16_bf16 v[104:119], v[32:35], v[196:199], v[104:119]
    buffer_load_dwordx4 v[232:235], v249, s[32:35], s16 offen sc1
    ds_read_b64_tr_b16 v[28:29], v23 offset:24576
    ds_read_b64_tr_b16 v[30:31], v23 offset:26624
    s_barrier
    s_waitcnt vmcnt(8)
    s_waitcnt lgkmcnt(10)
    v_mfma_f32_32x32x16_bf16 v[56:71], v[36:39], v[200:203], v[56:71]
    ds_read_b64_tr_b16 v[32:33], v20 offset:25600
    ds_read_b64_tr_b16 v[34:35], v20 offset:27648
    s_waitcnt lgkmcnt(10)
    v_mfma_f32_32x32x16_bf16 v[72:87], v[40:43], v[200:203], v[72:87]
    ds_read_b64_tr_b16 v[36:37], v21 offset:25600
    ds_read_b64_tr_b16 v[38:39], v21 offset:27648
    s_waitcnt lgkmcnt(10)
    v_mfma_f32_32x32x16_bf16 v[120:135], v[44:47], v[200:203], v[120:135]
    ds_read_b64_tr_b16 v[40:41], v24 offset:25600
    ds_read_b64_tr_b16 v[42:43], v24 offset:27648
    s_waitcnt lgkmcnt(10)
    v_mfma_f32_32x32x16_bf16 v[136:151], v[48:51], v[200:203], v[136:151]
    ds_read_b64_tr_b16 v[44:45], v25 offset:25600
    ds_read_b64_tr_b16 v[46:47], v25 offset:27648
    s_waitcnt lgkmcnt(10)
    v_mfma_f32_32x32x16_bf16 v[88:103], v[52:55], v[200:203], v[88:103]
    buffer_load_dwordx4 v[236:239], v249, s[32:35], s16 offen offset:1024 sc1
    ds_read_b64_tr_b16 v[48:49], v22 offset:25600
    ds_read_b64_tr_b16 v[50:51], v22 offset:27648
    s_waitcnt lgkmcnt(10)
    v_mfma_f32_32x32x16_bf16 v[104:119], v[28:31], v[200:203], v[104:119]
    ds_read_b64_tr_b16 v[52:53], v23 offset:25600
    ds_read_b64_tr_b16 v[54:55], v23 offset:27648
    s_waitcnt vmcnt(8)
    s_waitcnt lgkmcnt(10)
    v_mfma_f32_32x32x16_bf16 v[56:71], v[32:35], v[204:207], v[56:71]
    ds_read_b64_tr_b16 v[28:29], v20 offset:28672
    ds_read_b64_tr_b16 v[30:31], v20 offset:30720
    s_waitcnt lgkmcnt(10)
    v_mfma_f32_32x32x16_bf16 v[72:87], v[36:39], v[204:207], v[72:87]
L_PAD2:
    s_cbranch_execz L_RET2
    ds_read_b64_tr_b16 v[32:33], v21 offset:28672
    ds_read_b64_tr_b16 v[34:35], v21 offset:30720
    s_waitcnt lgkmcnt(10)
    v_mfma_f32_32x32x16_bf16 v[120:135], v[40:43], v[204:207], v[120:135]
    ds_read_b64_tr_b16 v[36:37], v24 offset:28672
    ds_read_b64_tr_b16 v[38:39], v24 offset:30720
    s_waitcnt lgkmcnt(10)
    v_mfma_f32_32x32x16_bf16 v[136:151], v[44:47], v[204:207], v[136:151]
    buffer_load_dwordx4 v[240:243], v249, s[32:35], s16 offen offset:2048 sc1
    ds_read_b64_tr_b16 v[40:41], v25 offset:28672
    ds_read_b64_tr_b16 v[42:43], v25 offset:30720
    s_waitcnt lgkmcnt(10)
    v_mfma_f32_32x32x16_bf16 v[88:103], v[48:51], v[204:207], v[88:103]
    ds_read_b64_tr_b16 v[44:45], v22 offset:28672
    ds_read_b64_tr_b16 v[46:47], v22 offset:30720
    s_waitcnt lgkmcnt(10)
    v_mfma_f32_32x32x16_bf16 v[104:119], v[52:55], v[204:207], v[104:119]
    ds_read_b64_tr_b16 v[48:49], v23 offset:28672
    ds_read_b64_tr_b16 v[50:51], v23 offset:30720
    s_waitcnt vmcnt(8)
    s_waitcnt lgkmcnt(10)
    v_mfma_f32_32x32x16_bf16 v[56:71], v[28:31], v[208:211], v[56:71]
    ds_read_b64_tr_b16 v[52:53], v20 offset:29696
    ds_read_b64_tr_b16 v[54:55], v20 offset:31744
    s_waitcnt lgkmcnt(10)
    v_mfma_f32_32x32x16_bf16 v[72:87], v[32:35], v[208:211], v[72:87]
    ds_read_b64_tr_b16 v[28:29], v21 offset:29696
    ds_read_b64_tr_b16 v[30:31], v21 offset:31744
    s_waitcnt lgkmcnt(10)
    v_mfma_f32_32x32x16_bf16 v[120:135], v[36:39], v[208:211], v[120:135]
    buffer_load_dwordx4 v[244:247], v249, s[32:35], s16 offen offset:3072 sc1
    ds_read_b64_tr_b16 v[32:33], v24 offset:29696
    ds_read_b64_tr_b16 v[34:35], v24 offset:31744
    s_waitcnt lgkmcnt(10)
    v_mfma_f32_32x32x16_bf16 v[136:151], v[40:43], v[208:211], v[136:151]
    s_add_u32 s16, s16, 16384
    ds_read_b64_tr_b16 v[36:37], v25 offset:29696
    ds_read_b64_tr_b16 v[38:39], v25 offset:31744
    s_waitcnt lgkmcnt(10)
    v_mfma_f32_32x32x16_bf16 v[88:103], v[44:47], v[208:211], v[88:103]
    s_and_b32 s16, s16, 0x3ffff
    ds_read_b64_tr_b16 v[40:41], v22 offset:29696
    ds_read_b64_tr_b16 v[42:43], v22 offset:31744
    s_waitcnt lgkmcnt(10)
    v_mfma_f32_32x32x16_bf16 v[104:119], v[48:51], v[208:211], v[104:119]
    ds_read_b64_tr_b16 v[44:45], v23 offset:29696
    ds_read_b64_tr_b16 v[46:47], v23 offset:31744
    s_waitcnt vmcnt(8)
    s_waitcnt lgkmcnt(10)
    v_mfma_f32_32x32x16_bf16 v[56:71], v[52:55], v[212:215], v[56:71]
    ds_read_b64_tr_b16 v[48:49], v20 offset:32768
    ds_read_b64_tr_b16 v[50:51], v20 offset:34816
    s_waitcnt lgkmcnt(10)
    v_mfma_f32_32x32x16_bf16 v[72:87], v[28:31], v[212:215], v[72:87]
    buffer_load_dwordx4 v[152:155], v249, s[32:35], s16 offen sc1
    ds_read_b64_tr_b16 v[52:53], v21 offset:32768
    ds_read_b64_tr_b16 v[54:55], v21 offset:34816
    s_waitcnt lgkmcnt(10)
    v_mfma_f32_32x32x16_bf16 v[120:135], v[32:35], v[212:215], v[120:135]
    ds_read_b64_tr_b16 v[28:29], v24 offset:32768
    ds_read_b64_tr_b16 v[30:31], v24 offset:34816
    s_waitcnt lgkmcnt(10)
    v_mfma_f32_32x32x16_bf16 v[136:151], v[36:39], v[212:215], v[136:151]
    ds_read_b64_tr_b16 v[32:33], v25 offset:32768
    ds_read_b64_tr_b16 v[34:35], v25 offset:34816
    s_waitcnt lgkmcnt(10)
    v_mfma_f32_32x32x16_bf16 v[88:103], v[40:43], v[212:215], v[88:103]
    ds_read_b64_tr_b16 v[36:37], v22 offset:32768
    ds_read_b64_tr_b16 v[38:39], v22 offset:34816
    s_waitcnt lgkmcnt(10)
    v_mfma_f32_32x32x16_bf16 v[104:119], v[44:47], v[212:215], v[104:119]
    buffer_load_dwordx4 v[156:159], v249, s[32:35], s16 offen offset:1024 sc1
    ds_read_b64_tr_b16 v[40:41], v23 offset:32768
    ds_read_b64_tr_b16 v[42:43], v23 offset:34816
    s_barrier
    s_waitcnt vmcnt(9)
    s_waitcnt lgkmcnt(10)
    v_mfma_f32_32x32x16_bf16 v[56:71], v[48:51], v[216:219], v[56:71]
    ds_read_b64_tr_b16 v[44:45], v20 offset:33792
    ds_read_b64_tr_b16 v[46:47], v20 offset:35840
    s_waitcnt lgkmcnt(10)
    v_mfma_f32_32x32x16_bf16 v[72:87], v[52:55], v[216:219], v[72:87]
    ds_read_b64_tr_b16 v[48:49], v21 offset:33792
    ds_read_b64_tr_b16 v[50:51], v21 offset:35840
    s_waitcnt lgkmcnt(10)
    v_mfma_f32_32x32x16_bf16 v[120:135], v[28:31], v[216:219], v[120:135]
    ds_read_b64_tr_b16 v[52:53], v24 offset:33792
    ds_read_b64_tr_b16 v[54:55], v24 offset:35840
    s_waitcnt lgkmcnt(10)
    v_mfma_f32_32x32x16_bf16 v[136:151], v[32:35], v[216:219], v[136:151]
    ds_read_b64_tr_b16 v[28:29], v25 offset:33792
    ds_read_b64_tr_b16 v[30:31], v25 offset:35840
    s_waitcnt lgkmcnt(10)
    v_mfma_f32_32x32x16_bf16 v[88:103], v[36:39], v[216:219], v[88:103]
    buffer_load_dwordx4 v[160:163], v249, s[32:35], s16 offen offset:2048 sc1
    ds_read_b64_tr_b16 v[32:33], v22 offset:33792
    ds_read_b64_tr_b16 v[34:35], v22 offset:35840
    s_waitcnt lgkmcnt(10)
    v_mfma_f32_32x32x16_bf16 v[104:119], v[40:43], v[216:219], v[104:119]
    ds_read_b64_tr_b16 v[36:37], v23 offset:33792
    ds_read_b64_tr_b16 v[38:39], v23 offset:35840
    s_waitcnt vmcnt(9)
    s_waitcnt lgkmcnt(10)
    v_mfma_f32_32x32x16_bf16 v[56:71], v[44:47], v[220:223], v[56:71]
    ds_read_b64_tr_b16 v[40:41], v20 offset:36864
    ds_read_b64_tr_b16 v[42:43], v20 offset:38912
    s_waitcnt lgkmcnt(10)
    v_mfma_f32_32x32x16_bf16 v[72:87], v[48:51], v[220:223], v[72:87]
    ds_read_b64_tr_b16 v[44:45], v21 offset:36864
    ds_read_b64_tr_b16 v[46:47], v21 offset:38912
    s_waitcnt lgkmcnt(10)
    v_mfma_f32_32x32x16_bf16 v[120:135], v[52:55], v[220:223], v[120:135]
    ds_read_b64_tr_b16 v[48:49], v24 offset:36864
    ds_read_b64_tr_b16 v[50:51], v24 offset:38912
    s_waitcnt lgkmcnt(10)
    v_mfma_f32_32x32x16_bf16 v[136:151], v[28:31], v[220:223], v[136:151]
    buffer_load_dwordx4 v[164:167], v249, s[32:35], s16 offen offset:3072 sc1
    ds_read_b64_tr_b16 v[52:53], v25 offset:36864
    ds_read_b64_tr_b16 v[54:55], v25 offset:38912
    s_waitcnt lgkmcnt(10)
    v_mfma_f32_32x32x16_bf16 v[88:103], v[32:35], v[220:223], v[88:103]
    s_add_u32 s16, s16, 16384
    ds_read_b64_tr_b16 v[28:29], v22 offset:36864
    ds_read_b64_tr_b16 v[30:31], v22 offset:38912
    s_waitcnt lgkmcnt(10)
    v_mfma_f32_32x32x16_bf16 v[104:119], v[36:39], v[220:223], v[104:119]
    s_and_b32 s16, s16, 0x3ffff
    ds_read_b64_tr_b16 v[32:33], v23 offset:36864
    ds_read_b64_tr_b16 v[34:35], v23 offset:38912
    s_waitcnt vmcnt(9)
    s_waitcnt lgkmcnt(10)
    v_mfma_f32_32x32x16_bf16 v[56:71], v[40:43], v[224:227], v[56:71]
    ds_read_b64_tr_b16 v[36:37], v20 offset:37888
    ds_read_b64_tr_b16 v[38:39], v20 offset:39936
    s_waitcnt lgkmcnt(10)
    v_mfma_f32_32x32x16_bf16 v[72:87], v[44:47], v[224:227], v[72:87]
    ds_read_b64_tr_b16 v[40:41], v21 offset:37888
    ds_read_b64_tr_b16 v[42:43], v21 offset:39936
    s_waitcnt lgkmcnt(10)
    v_mfma_f32_32x32x16_bf16 v[120:135], v[48:51], v[224:227], v[120:135]
    buffer_load_dwordx4 v[168:171], v249, s[32:35], s16 offen sc1
    ds_read_b64_tr_b16 v[44:45], v24 offset:37888
    ds_read_b64_tr_b16 v[46:47], v24 offset:39936
    s_waitcnt lgkmcnt(10)
    v_mfma_f32_32x32x16_bf16 v[136:151], v[52:55], v[224:227], v[136:151]
    ds_read_b64_tr_b16 v[48:49], v25 offset:37888
    ds_read_b64_tr_b16 v[50:51], v25 offset:39936
    s_waitcnt lgkmcnt(10)
    v_mfma_f32_32x32x16_bf16 v[88:103], v[28:31], v[224:227], v[88:103]
    ds_read_b64_tr_b16 v[52:53], v22 offset:37888
    ds_read_b64_tr_b16 v[54:55], v22 offset:39936
    s_waitcnt lgkmcnt(10)
    v_mfma_f32_32x32x16_bf16 v[104:119], v[32:35], v[224:227], v[104:119]
    ds_read_b64_tr_b16 v[28:29], v23 offset:37888
    ds_read_b64_tr_b16 v[30:31], v23 offset:39936
    s_waitcnt vmcnt(9)
    s_waitcnt lgkmcnt(10)
    v_mfma_f32_32x32x16_bf16 v[56:71], v[36:39], v[228:231], v[56:71]
    ds_read_b64_tr_b16 v[32:33], v20 offset:40960
    ds_read_b64_tr_b16 v[34:35], v20 offset:43008
    s_waitcnt lgkmcnt(10)
    v_mfma_f32_32x32x16_bf16 v[72:87], v[40:43], v[228:231], v[72:87]
    buffer_load_dwordx4 v[172:175], v249, s[32:35], s16 offen offset:1024 sc1
    ds_read_b64_tr_b16 v[36:37], v21 offset:40960
    ds_read_b64_tr_b16 v[38:39], v21 offset:43008
    s_waitcnt lgkmcnt(10)
    v_mfma_f32_32x32x16_bf16 v[120:135], v[44:47], v[228:231], v[120:135]
    ds_read_b64_tr_b16 v[40:41], v24 offset:40960
    ds_read_b64_tr_b16 v[42:43], v24 offset:43008
    s_waitcnt lgkmcnt(10)
    v_mfma_f32_32x32x16_bf16 v[136:151], v[48:51], v[228:231], v[136:151]
    ds_read_b64_tr_b16 v[44:45], v25 offset:40960
    ds_read_b64_tr_b16 v[46:47], v25 offset:43008
    s_waitcnt lgkmcnt(10)
    v_mfma_f32_32x32x16_bf16 v[88:103], v[52:55], v[228:231], v[88:103]
    ds_read_b64_tr_b16 v[48:49], v22 offset:40960
    ds_read_b64_tr_b16 v[50:51], v22 offset:43008
    s_waitcnt lgkmcnt(10)
    v_mfma_f32_32x32x16_bf16 v[104:119], v[28:31], v[228:231], v[104:119]
    buffer_load_dwordx4 v[176:179], v249, s[32:35], s16 offen offset:2048 sc1
    ds_read_b64_tr_b16 v[52:53], v23 offset:40960
    ds_read_b64_tr_b16 v[54:55], v23 offset:43008
    s_barrier
    s_waitcnt vmcnt(10)
    s_waitcnt lgkmcnt(10)
    v_mfma_f32_32x32x16_bf16 v[56:71], v[32:35], v[232:235], v[56:71]
    ds_read_b64_tr_b16 v[28:29], v20 offset:41984
    ds_read_b64_tr_b16 v[30:31], v20 offset:44032
    s_waitcnt lgkmcnt(10)
    v_mfma_f32_32x32x16_bf16 v[72:87], v[36:39], v[232:235], v[72:87]
    ds_read_b64_tr_b16 v[32:33], v21 offset:41984
    ds_read_b64_tr_b16 v[34:35], v21 offset:44032
    s_waitcnt lgkmcnt(10)
    v_mfma_f32_32x32x16_bf16 v[120:135], v[40:43], v[232:235], v[120:135]
    ds_read_b64_tr_b16 v[36:37], v24 offset:41984
    ds_read_b64_tr_b16 v[38:39], v24 offset:44032
    s_waitcnt lgkmcnt(10)
    v_mfma_f32_32x32x16_bf16 v[136:151], v[44:47], v[232:235], v[136:151]
    buffer_load_dwordx4 v[180:183], v249, s[32:35], s16 offen offset:3072 sc1
    ds_read_b64_tr_b16 v[40:41], v25 offset:41984
    ds_read_b64_tr_b16 v[42:43], v25 offset:44032
    s_waitcnt lgkmcnt(10)
    v_mfma_f32_32x32x16_bf16 v[88:103], v[48:51], v[232:235], v[88:103]
    s_add_u32 s16, s16, 16384
    ds_read_b64_tr_b16 v[44:45], v22 offset:41984
    ds_read_b64_tr_b16 v[46:47], v22 offset:44032
    s_waitcnt lgkmcnt(10)
    v_mfma_f32_32x32x16_bf16 v[104:119], v[52:55], v[232:235], v[104:119]
    s_and_b32 s16, s16, 0x3ffff
    ds_read_b64_tr_b16 v[48:49], v23 offset:41984
    ds_read_b64_tr_b16 v[50:51], v23 offset:44032
    s_waitcnt vmcnt(10)
    s_waitcnt lgkmcnt(10)
    v_mfma_f32_32x32x16_bf16 v[56:71], v[28:31], v[236:239], v[56:71]
    buffer_load_dwordx4 v[184:187], v249, s[32:35], s16 offen sc1
    ds_read_b64_tr_b16 v[52:53], v20 offset:45056
    ds_read_b64_tr_b16 v[54:55], v20 offset:47104
    s_waitcnt lgkmcnt(10)
    v_mfma_f32_32x32x16_bf16 v[72:87], v[32:35], v[236:239], v[72:87]
    ds_read_b64_tr_b16 v[28:29], v21 offset:45056
    ds_read_b64_tr_b16 v[30:31], v21 offset:47104
    s_waitcnt lgkmcnt(10)
    v_mfma_f32_32x32x16_bf16 v[120:135], v[36:39], v[236:239], v[120:135]
    ds_read_b64_tr_b16 v[32:33], v24 offset:45056
    ds_read_b64_tr_b16 v[34:35], v24 offset:47104
    s_waitcnt lgkmcnt(10)
    v_mfma_f32_32x32x16_bf16 v[136:151], v[40:43], v[236:239], v[136:151]
    ds_read_b64_tr_b16 v[36:37], v25 offset:45056
    ds_read_b64_tr_b16 v[38:39], v25 offset:47104
    s_waitcnt lgkmcnt(10)
    v_mfma_f32_32x32x16_bf16 v[88:103], v[44:47], v[236:239], v[88:103]
    buffer_load_dwordx4 v[188:191], v249, s[32:35], s16 offen offset:1024 sc1
    ds_read_b64_tr_b16 v[40:41], v22 offset:45056
    ds_read_b64_tr_b16 v[42:43], v22 offset:47104
    s_waitcnt lgkmcnt(10)
    v_mfma_f32_32x32x16_bf16 v[104:119], v[48:51], v[236:239], v[104:119]
    ds_read_b64_tr_b16 v[44:45], v23 offset:45056
    ds_read_b64_tr_b16 v[46:47], v23 offset:47104
    s_waitcnt vmcnt(11)
    s_waitcnt lgkmcnt(10)
    v_mfma_f32_32x32x16_bf16 v[56:71], v[52:55], v[240:243], v[56:71]
    ds_read_b64_tr_b16 v[48:49], v20 offset:46080
    ds_read_b64_tr_b16 v[50:51], v20 offset:48128
    s_waitcnt lgkmcnt(10)
    v_mfma_f32_32x32x16_bf16 v[72:87], v[28:31], v[240:243], v[72:87]
    buffer_load_dwordx4 v[192:195], v249, s[32:35], s16 offen offset:2048 sc1
    ds_read_b64_tr_b16 v[52:53], v21 offset:46080
    ds_read_b64_tr_b16 v[54:55], v21 offset:48128
    s_waitcnt lgkmcnt(10)
    v_mfma_f32_32x32x16_bf16 v[120:135], v[32:35], v[240:243], v[120:135]
    ds_read_b64_tr_b16 v[28:29], v24 offset:46080
    ds_read_b64_tr_b16 v[30:31], v24 offset:48128
    s_waitcnt lgkmcnt(10)
    v_mfma_f32_32x32x16_bf16 v[136:151], v[36:39], v[240:243], v[136:151]
    ds_read_b64_tr_b16 v[32:33], v25 offset:46080
    ds_read_b64_tr_b16 v[34:35], v25 offset:48128
    s_waitcnt lgkmcnt(10)
    v_mfma_f32_32x32x16_bf16 v[88:103], v[40:43], v[240:243], v[88:103]
    ds_read_b64_tr_b16 v[36:37], v22 offset:46080
    ds_read_b64_tr_b16 v[38:39], v22 offset:48128
    s_waitcnt lgkmcnt(10)
    v_mfma_f32_32x32x16_bf16 v[104:119], v[44:47], v[240:243], v[104:119]
    buffer_load_dwordx4 v[196:199], v249, s[32:35], s16 offen offset:3072 sc1
    ds_read_b64_tr_b16 v[40:41], v23 offset:46080
    ds_read_b64_tr_b16 v[42:43], v23 offset:48128
    s_waitcnt vmcnt(12)
    s_waitcnt lgkmcnt(10)
    v_mfma_f32_32x32x16_bf16 v[56:71], v[48:51], v[244:247], v[56:71]
    s_add_u32 s16, s16, 16384
    ds_read_b64_tr_b16 v[44:45], v20
    ds_read_b64_tr_b16 v[46:47], v20 offset:2048
    s_waitcnt lgkmcnt(10)
    v_mfma_f32_32x32x16_bf16 v[72:87], v[52:55], v[244:247], v[72:87]
    s_and_b32 s16, s16, 0x3ffff
    ds_read_b64_tr_b16 v[48:49], v21
    ds_read_b64_tr_b16 v[50:51], v21 offset:2048
    s_waitcnt lgkmcnt(10)
    v_mfma_f32_32x32x16_bf16 v[120:135], v[28:31], v[244:247], v[120:135]
    buffer_load_dwordx4 v[200:203], v249, s[32:35], s16 offen sc1
    ds_read_b64_tr_b16 v[52:53], v24
    ds_read_b64_tr_b16 v[54:55], v24 offset:2048
    s_waitcnt lgkmcnt(10)
    v_mfma_f32_32x32x16_bf16 v[136:151], v[32:35], v[244:247], v[136:151]
    ds_read_b64_tr_b16 v[28:29], v25
    ds_read_b64_tr_b16 v[30:31], v25 offset:2048
    s_waitcnt lgkmcnt(10)
    v_mfma_f32_32x32x16_bf16 v[88:103], v[36:39], v[244:247], v[88:103]
    ds_read_b64_tr_b16 v[32:33], v22
    ds_read_b64_tr_b16 v[34:35], v22 offset:2048
    s_waitcnt lgkmcnt(10)
    v_mfma_f32_32x32x16_bf16 v[104:119], v[40:43], v[244:247], v[104:119]
    buffer_load_dwordx4 v[204:207], v249, s[32:35], s16 offen offset:1024 sc1
    ds_read_b64_tr_b16 v[36:37], v23
    ds_read_b64_tr_b16 v[38:39], v23 offset:2048
    s_barrier
    s_waitcnt vmcnt(13)
    s_waitcnt lgkmcnt(10)
    v_mfma_f32_32x32x16_bf16 v[56:71], v[44:47], v[152:155], v[56:71]
    ds_read_b64_tr_b16 v[40:41], v20 offset:1024
    ds_read_b64_tr_b16 v[42:43], v20 offset:3072
    s_waitcnt lgkmcnt(10)
    v_mfma_f32_32x32x16_bf16 v[72:87], v[48:51], v[152:155], v[72:87]
    ds_read_b64_tr_b16 v[44:45], v21 offset:1024
    ds_read_b64_tr_b16 v[46:47], v21 offset:3072
    s_waitcnt lgkmcnt(10)
    v_mfma_f32_32x32x16_bf16 v[120:135], v[52:55], v[152:155], v[120:135]
    ds_read_b64_tr_b16 v[48:49], v24 offset:1024
    ds_read_b64_tr_b16 v[50:51], v24 offset:3072
    s_waitcnt lgkmcnt(10)
    v_mfma_f32_32x32x16_bf16 v[136:151], v[28:31], v[152:155], v[136:151]
    buffer_load_dwordx4 v[208:211], v249, s[32:35], s16 offen offset:2048 sc1
    ds_read_b64_tr_b16 v[52:53], v25 offset:1024
    ds_read_b64_tr_b16 v[54:55], v25 offset:3072
    s_waitcnt lgkmcnt(10)
    v_mfma_f32_32x32x16_bf16 v[88:103], v[32:35], v[152:155], v[88:103]
    ds_read_b64_tr_b16 v[28:29], v22 offset:1024
    ds_read_b64_tr_b16 v[30:31], v22 offset:3072
    s_waitcnt lgkmcnt(10)
    v_mfma_f32_32x32x16_bf16 v[104:119], v[36:39], v[152:155], v[104:119]
    ds_read_b64_tr_b16 v[32:33], v23 offset:1024
    ds_read_b64_tr_b16 v[34:35], v23 offset:3072
    s_waitcnt vmcnt(13)
    s_waitcnt lgkmcnt(10)
    v_mfma_f32_32x32x16_bf16 v[56:71], v[40:43], v[156:159], v[56:71]
    buffer_load_dwordx4 v[212:215], v249, s[32:35], s16 offen offset:3072 sc1
    ds_read_b64_tr_b16 v[36:37], v20 offset:4096
    ds_read_b64_tr_b16 v[38:39], v20 offset:6144
    s_waitcnt lgkmcnt(10)
    v_mfma_f32_32x32x16_bf16 v[72:87], v[44:47], v[156:159], v[72:87]
    s_add_u32 s16, s16, 16384
    ds_read_b64_tr_b16 v[40:41], v21 offset:4096
    ds_read_b64_tr_b16 v[42:43], v21 offset:6144
    s_waitcnt lgkmcnt(10)
    v_mfma_f32_32x32x16_bf16 v[120:135], v[48:51], v[156:159], v[120:135]
    s_and_b32 s16, s16, 0x3ffff
    ds_read_b64_tr_b16 v[44:45], v24 offset:4096
    ds_read_b64_tr_b16 v[46:47], v24 offset:6144
    s_waitcnt lgkmcnt(10)
    v_mfma_f32_32x32x16_bf16 v[136:151], v[52:55], v[156:159], v[136:151]
    ds_read_b64_tr_b16 v[48:49], v25 offset:4096
    ds_read_b64_tr_b16 v[50:51], v25 offset:6144
    s_waitcnt lgkmcnt(10)
    v_mfma_f32_32x32x16_bf16 v[88:103], v[28:31], v[156:159], v[88:103]
    buffer_load_dwordx4 v[216:219], v249, s[32:35], s16 offen sc1
    ds_read_b64_tr_b16 v[52:53], v22 offset:4096
    ds_read_b64_tr_b16 v[54:55], v22 offset:6144
    s_waitcnt lgkmcnt(10)
    v_mfma_f32_32x32x16_bf16 v[104:119], v[32:35], v[156:159], v[104:119]
    ds_read_b64_tr_b16 v[28:29], v23 offset:4096
    ds_read_b64_tr_b16 v[30:31], v23 offset:6144
    s_waitcnt vmcnt(14)
    s_waitcnt lgkmcnt(10)
    v_mfma_f32_32x32x16_bf16 v[56:71], v[36:39], v[160:163], v[56:71]
    ds_read_b64_tr_b16 v[32:33], v20 offset:5120
    ds_read_b64_tr_b16 v[34:35], v20 offset:7168
    s_waitcnt lgkmcnt(10)
    v_mfma_f32_32x32x16_bf16 v[72:87], v[40:43], v[160:163], v[72:87]
    buffer_load_dwordx4 v[220:223], v249, s[32:35], s16 offen offset:1024 sc1
    ds_read_b64_tr_b16 v[36:37], v21 offset:5120
    ds_read_b64_tr_b16 v[38:39], v21 offset:7168
    s_waitcnt lgkmcnt(10)
    v_mfma_f32_32x32x16_bf16 v[120:135], v[44:47], v[160:163], v[120:135]
    ds_read_b64_tr_b16 v[40:41], v24 offset:5120
    ds_read_b64_tr_b16 v[42:43], v24 offset:7168
    s_waitcnt lgkmcnt(10)
    v_mfma_f32_32x32x16_bf16 v[136:151], v[48:51], v[160:163], v[136:151]
    ds_read_b64_tr_b16 v[44:45], v25 offset:5120
    ds_read_b64_tr_b16 v[46:47], v25 offset:7168
    s_waitcnt lgkmcnt(10)
    v_mfma_f32_32x32x16_bf16 v[88:103], v[52:55], v[160:163], v[88:103]
    ds_read_b64_tr_b16 v[48:49], v22 offset:5120
    ds_read_b64_tr_b16 v[50:51], v22 offset:7168
    s_waitcnt lgkmcnt(10)
    v_mfma_f32_32x32x16_bf16 v[104:119], v[28:31], v[160:163], v[104:119]
    buffer_load_dwordx4 v[224:227], v249, s[32:35], s16 offen offset:2048 sc1
    ds_read_b64_tr_b16 v[52:53], v23 offset:5120
    ds_read_b64_tr_b16 v[54:55], v23 offset:7168
    s_waitcnt vmcnt(15)
    s_waitcnt lgkmcnt(10)
    v_mfma_f32_32x32x16_bf16 v[56:71], v[32:35], v[164:167], v[56:71]
    ds_read_b64_tr_b16 v[28:29], v20 offset:8192
    ds_read_b64_tr_b16 v[30:31], v20 offset:10240
    s_waitcnt lgkmcnt(10)
    v_mfma_f32_32x32x16_bf16 v[72:87], v[36:39], v[164:167], v[72:87]
    ds_read_b64_tr_b16 v[32:33], v21 offset:8192
    ds_read_b64_tr_b16 v[34:35], v21 offset:10240
    s_waitcnt lgkmcnt(10)
    v_mfma_f32_32x32x16_bf16 v[120:135], v[40:43], v[164:167], v[120:135]
    buffer_load_dwordx4 v[228:231], v249, s[32:35], s16 offen offset:3072 sc1
    ds_read_b64_tr_b16 v[36:37], v24 offset:8192
    ds_read_b64_tr_b16 v[38:39], v24 offset:10240
    s_waitcnt lgkmcnt(10)
    v_mfma_f32_32x32x16_bf16 v[136:151], v[44:47], v[164:167], v[136:151]
    s_add_u32 s16, s16, 16384
    ds_read_b64_tr_b16 v[40:41], v25 offset:8192
    ds_read_b64_tr_b16 v[42:43], v25 offset:10240
    s_waitcnt lgkmcnt(10)
    v_mfma_f32_32x32x16_bf16 v[88:103], v[48:51], v[164:167], v[88:103]
    s_and_b32 s16, s16, 0x3ffff
    ds_read_b64_tr_b16 v[44:45], v22 offset:8192
    ds_read_b64_tr_b16 v[46:47], v22 offset:10240
    s_waitcnt lgkmcnt(10)
    v_mfma_f32_32x32x16_bf16 v[104:119], v[52:55], v[164:167], v[104:119]
    buffer_load_dwordx4 v[232:235], v249, s[32:35], s16 offen sc1
    ds_read_b64_tr_b16 v[48:49], v23 offset:8192
    ds_read_b64_tr_b16 v[50:51], v23 offset:10240
    s_barrier
    s_waitcnt vmcnt(16)
    s_waitcnt lgkmcnt(10)
    v_mfma_f32_32x32x16_bf16 v[56:71], v[28:31], v[168:171], v[56:71]
    ds_read_b64_tr_b16 v[52:53], v20 offset:9216
    ds_read_b64_tr_b16 v[54:55], v20 offset:11264
    s_waitcnt lgkmcnt(10)
    v_mfma_f32_32x32x16_bf16 v[72:87], v[32:35], v[168:171], v[72:87]
    ds_read_b64_tr_b16 v[28:29], v21 offset:9216
    ds_read_b64_tr_b16 v[30:31], v21 offset:11264
    s_waitcnt lgkmcnt(10)
    v_mfma_f32_32x32x16_bf16 v[120:135], v[36:39], v[168:171], v[120:135]
    ds_read_b64_tr_b16 v[32:33], v24 offset:9216
    ds_read_b64_tr_b16 v[34:35], v24 offset:11264
    s_waitcnt lgkmcnt(10)
    v_mfma_f32_32x32x16_bf16 v[136:151], v[40:43], v[168:171], v[136:151]
    buffer_load_dwordx4 v[236:239], v249, s[32:35], s16 offen offset:1024 sc1
    ds_read_b64_tr_b16 v[36:37], v25 offset:9216
    ds_read_b64_tr_b16 v[38:39], v25 offset:11264
    s_waitcnt lgkmcnt(10)
    v_mfma_f32_32x32x16_bf16 v[88:103], v[44:47], v[168:171], v[88:103]
    ds_read_b64_tr_b16 v[40:41], v22 offset:9216
    ds_read_b64_tr_b16 v[42:43], v22 offset:11264
    s_waitcnt lgkmcnt(10)
    v_mfma_f32_32x32x16_bf16 v[104:119], v[48:51], v[168:171], v[104:119]
    ds_read_b64_tr_b16 v[44:45], v23 offset:9216
    ds_read_b64_tr_b16 v[46:47], v23 offset:11264
    s_waitcnt vmcnt(16)
    s_waitcnt lgkmcnt(10)
    v_mfma_f32_32x32x16_bf16 v[56:71], v[52:55], v[172:175], v[56:71]
    buffer_load_dwordx4 v[240:243], v249, s[32:35], s16 offen offset:2048 sc1
    ds_read_b64_tr_b16 v[48:49], v20 offset:12288
    ds_read_b64_tr_b16 v[50:51], v20 offset:14336
    s_waitcnt lgkmcnt(10)
    v_mfma_f32_32x32x16_bf16 v[72:87], v[28:31], v[172:175], v[72:87]
    ds_read_b64_tr_b16 v[52:53], v21 offset:12288
    ds_read_b64_tr_b16 v[54:55], v21 offset:14336
    s_waitcnt lgkmcnt(10)
    v_mfma_f32_32x32x16_bf16 v[120:135], v[32:35], v[172:175], v[120:135]
    ds_read_b64_tr_b16 v[28:29], v24 offset:12288
    ds_read_b64_tr_b16 v[30:31], v24 offset:14336
    s_waitcnt lgkmcnt(10)
    v_mfma_f32_32x32x16_bf16 v[136:151], v[36:39], v[172:175], v[136:151]
    ds_read_b64_tr_b16 v[32:33], v25 offset:12288
    ds_read_b64_tr_b16 v[34:35], v25 offset:14336
    s_waitcnt lgkmcnt(10)
    v_mfma_f32_32x32x16_bf16 v[88:103], v[40:43], v[172:175], v[88:103]
    buffer_load_dwordx4 v[244:247], v249, s[32:35], s16 offen offset:3072 sc1
    ds_read_b64_tr_b16 v[36:37], v22 offset:12288
    ds_read_b64_tr_b16 v[38:39], v22 offset:14336
    s_waitcnt lgkmcnt(10)
    v_mfma_f32_32x32x16_bf16 v[104:119], v[44:47], v[172:175], v[104:119]
    s_add_u32 s16, s16, 16384
    ds_read_b64_tr_b16 v[40:41], v23 offset:12288
    ds_read_b64_tr_b16 v[42:43], v23 offset:14336
    s_waitcnt vmcnt(17)
    s_waitcnt lgkmcnt(10)
    v_mfma_f32_32x32x16_bf16 v[56:71], v[48:51], v[176:179], v[56:71]
    s_and_b32 s16, s16, 0x3ffff
    ds_read_b64_tr_b16 v[44:45], v20 offset:13312
    ds_read_b64_tr_b16 v[46:47], v20 offset:15360
    s_waitcnt lgkmcnt(10)
    v_mfma_f32_32x32x16_bf16 v[72:87], v[52:55], v[176:179], v[72:87]
    buffer_load_dwordx4 v[152:155], v249, s[32:35], s16 offen sc1
    ds_read_b64_tr_b16 v[48:49], v21 offset:13312
    ds_read_b64_tr_b16 v[50:51], v21 offset:15360
    s_waitcnt lgkmcnt(10)
    v_mfma_f32_32x32x16_bf16 v[120:135], v[28:31], v[176:179], v[120:135]
    ds_read_b64_tr_b16 v[52:53], v24 offset:13312
    ds_read_b64_tr_b16 v[54:55], v24 offset:15360
    s_waitcnt lgkmcnt(10)
    v_mfma_f32_32x32x16_bf16 v[136:151], v[32:35], v[176:179], v[136:151]
    ds_read_b64_tr_b16 v[28:29], v25 offset:13312
    ds_read_b64_tr_b16 v[30:31], v25 offset:15360
    s_waitcnt lgkmcnt(10)
    v_mfma_f32_32x32x16_bf16 v[88:103], v[36:39], v[176:179], v[88:103]
    ds_read_b64_tr_b16 v[32:33], v22 offset:13312
    ds_read_b64_tr_b16 v[34:35], v22 offset:15360
    s_waitcnt lgkmcnt(10)
    v_mfma_f32_32x32x16_bf16 v[104:119], v[40:43], v[176:179], v[104:119]
    buffer_load_dwordx4 v[156:159], v249, s[32:35], s16 offen offset:1024 sc1
    ds_read_b64_tr_b16 v[36:37], v23 offset:13312
    ds_read_b64_tr_b16 v[38:39], v23 offset:15360
    s_waitcnt vmcnt(18)
    s_waitcnt lgkmcnt(10)
    v_mfma_f32_32x32x16_bf16 v[56:71], v[44:47], v[180:183], v[56:71]
    ds_read_b64_tr_b16 v[40:41], v20 offset:16384
    ds_read_b64_tr_b16 v[42:43], v20 offset:18432
    s_waitcnt lgkmcnt(10)
    v_mfma_f32_32x32x16_bf16 v[72:87], v[48:51], v[180:183], v[72:87]
    ds_read_b64_tr_b16 v[44:45], v21 offset:16384
    ds_read_b64_tr_b16 v[46:47], v21 offset:18432
    s_waitcnt lgkmcnt(10)
    v_mfma_f32_32x32x16_bf16 v[120:135], v[52:55], v[180:183], v[120:135]
    buffer_load_dwordx4 v[160:163], v249, s[32:35], s16 offen offset:2048 sc1
    ds_read_b64_tr_b16 v[48:49], v24 offset:16384
    ds_read_b64_tr_b16 v[50:51], v24 offset:18432
    s_waitcnt lgkmcnt(10)
    v_mfma_f32_32x32x16_bf16 v[136:151], v[28:31], v[180:183], v[136:151]
    ds_read_b64_tr_b16 v[52:53], v25 offset:16384
    ds_read_b64_tr_b16 v[54:55], v25 offset:18432
    s_waitcnt lgkmcnt(10)
    v_mfma_f32_32x32x16_bf16 v[88:103], v[32:35], v[180:183], v[88:103]
    ds_read_b64_tr_b16 v[28:29], v22 offset:16384
    ds_read_b64_tr_b16 v[30:31], v22 offset:18432
    s_waitcnt lgkmcnt(10)
    v_mfma_f32_32x32x16_bf16 v[104:119], v[36:39], v[180:183], v[104:119]
    buffer_load_dwordx4 v[164:167], v249, s[32:35], s16 offen offset:3072 sc1
    ds_read_b64_tr_b16 v[32:33], v23 offset:16384
    ds_read_b64_tr_b16 v[34:35], v23 offset:18432
    s_barrier
    s_waitcnt vmcnt(19)
    s_waitcnt lgkmcnt(10)
    v_mfma_f32_32x32x16_bf16 v[56:71], v[40:43], v[184:187], v[56:71]
    s_add_u32 s16, s16, 16384
    ds_read_b64_tr_b16 v[36:37], v20 offset:17408
    ds_read_b64_tr_b16 v[38:39], v20 offset:19456
    s_waitcnt lgkmcnt(10)
    v_mfma_f32_32x32x16_bf16 v[72:87], v[44:47], v[184:187], v[72:87]
    s_and_b32 s16, s16, 0x3ffff
    ds_read_b64_tr_b16 v[40:41], v21 offset:17408
    ds_read_b64_tr_b16 v[42:43], v21 offset:19456
    s_waitcnt lgkmcnt(10)
    v_mfma_f32_32x32x16_bf16 v[120:135], v[48:51], v[184:187], v[120:135]
    ds_read_b64_tr_b16 v[44:45], v24 offset:17408
    ds_read_b64_tr_b16 v[46:47], v24 offset:19456
    s_waitcnt lgkmcnt(10)
    v_mfma_f32_32x32x16_bf16 v[136:151], v[52:55], v[184:187], v[136:151]
    buffer_load_dwordx4 v[168:171], v249, s[32:35], s16 offen sc1
    ds_read_b64_tr_b16 v[48:49], v25 offset:17408
    ds_read_b64_tr_b16 v[50:51], v25 offset:19456
    s_waitcnt lgkmcnt(10)
    v_mfma_f32_32x32x16_bf16 v[88:103], v[28:31], v[184:187], v[88:103]
    ds_read_b64_tr_b16 v[52:53], v22 offset:17408
    ds_read_b64_tr_b16 v[54:55], v22 offset:19456
    s_waitcnt lgkmcnt(10)
    v_mfma_f32_32x32x16_bf16 v[104:119], v[32:35], v[184:187], v[104:119]
    ds_read_b64_tr_b16 v[28:29], v23 offset:17408
    ds_read_b64_tr_b16 v[30:31], v23 offset:19456
    s_waitcnt vmcnt(19)
    s_waitcnt lgkmcnt(10)
    v_mfma_f32_32x32x16_bf16 v[56:71], v[36:39], v[188:191], v[56:71]
    ds_read_b64_tr_b16 v[32:33], v20 offset:20480
    ds_read_b64_tr_b16 v[34:35], v20 offset:22528
    s_waitcnt lgkmcnt(10)
    v_mfma_f32_32x32x16_bf16 v[72:87], v[40:43], v[188:191], v[72:87]
    buffer_load_dwordx4 v[172:175], v249, s[32:35], s16 offen offset:1024 sc1
    ds_read_b64_tr_b16 v[36:37], v21 offset:20480
    ds_read_b64_tr_b16 v[38:39], v21 offset:22528
    s_waitcnt lgkmcnt(10)
    v_mfma_f32_32x32x16_bf16 v[120:135], v[44:47], v[188:191], v[120:135]
    ds_read_b64_tr_b16 v[40:41], v24 offset:20480
    ds_read_b64_tr_b16 v[42:43], v24 offset:22528
    s_waitcnt lgkmcnt(10)
    v_mfma_f32_32x32x16_bf16 v[136:151], v[48:51], v[188:191], v[136:151]
    ds_read_b64_tr_b16 v[44:45], v25 offset:20480
    ds_read_b64_tr_b16 v[46:47], v25 offset:22528
    s_waitcnt lgkmcnt(10)
    v_mfma_f32_32x32x16_bf16 v[88:103], v[52:55], v[188:191], v[88:103]
    ds_read_b64_tr_b16 v[48:49], v22 offset:20480
    ds_read_b64_tr_b16 v[50:51], v22 offset:22528
    s_waitcnt lgkmcnt(10)
    v_mfma_f32_32x32x16_bf16 v[104:119], v[28:31], v[188:191], v[104:119]
    buffer_load_dwordx4 v[176:179], v249, s[32:35], s16 offen offset:2048 sc1
    ds_read_b64_tr_b16 v[52:53], v23 offset:20480
    ds_read_b64_tr_b16 v[54:55], v23 offset:22528
    s_waitcnt vmcnt(20)
    s_waitcnt lgkmcnt(10)
    v_mfma_f32_32x32x16_bf16 v[56:71], v[32:35], v[192:195], v[56:71]
    ds_read_b64_tr_b16 v[28:29], v20 offset:21504
    ds_read_b64_tr_b16 v[30:31], v20 offset:23552
    s_waitcnt lgkmcnt(10)
    v_mfma_f32_32x32x16_bf16 v[72:87], v[36:39], v[192:195], v[72:87]
    ds_read_b64_tr_b16 v[32:33], v21 offset:21504
    ds_read_b64_tr_b16 v[34:35], v21 offset:23552
    s_waitcnt lgkmcnt(10)
    v_mfma_f32_32x32x16_bf16 v[120:135], v[40:43], v[192:195], v[120:135]
    ds_read_b64_tr_b16 v[36:37], v24 offset:21504
    ds_read_b64_tr_b16 v[38:39], v24 offset:23552
    s_waitcnt lgkmcnt(10)
    v_mfma_f32_32x32x16_bf16 v[136:151], v[44:47], v[192:195], v[136:151]
    buffer_load_dwordx4 v[180:183], v249, s[32:35], s16 offen offset:3072 sc1
    ds_read_b64_tr_b16 v[40:41], v25 offset:21504
L_PAD3:
    s_cbranch_execz L_RET3
    ds_read_b64_tr_b16 v[42:43], v25 offset:23552
    s_waitcnt lgkmcnt(10)
    v_mfma_f32_32x32x16_bf16 v[88:103], v[48:51], v[192:195], v[88:103]
    s_add_u32 s16, s16, 16384
    ds_read_b64_tr_b16 v[44:45], v22 offset:21504
    ds_read_b64_tr_b16 v[46:47], v22 offset:23552
    s_waitcnt lgkmcnt(10)
    v_mfma_f32_32x32x16_bf16 v[104:119], v[52:55], v[192:195], v[104:119]
    s_and_b32 s16, s16, 0x3ffff
    ds_read_b64_tr_b16 v[48:49], v23 offset:21504
    ds_read_b64_tr_b16 v[50:51], v23 offset:23552
    s_waitcnt vmcnt(20)
    s_waitcnt lgkmcnt(10)
    v_mfma_f32_32x32x16_bf16 v[56:71], v[28:31], v[196:199], v[56:71]
    ds_read_b64_tr_b16 v[52:53], v20 offset:24576
    ds_read_b64_tr_b16 v[54:55], v20 offset:26624
    s_waitcnt lgkmcnt(10)
    v_mfma_f32_32x32x16_bf16 v[72:87], v[32:35], v[196:199], v[72:87]
    buffer_load_dwordx4 v[184:187], v249, s[32:35], s16 offen sc1
    ds_read_b64_tr_b16 v[28:29], v21 offset:24576
    ds_read_b64_tr_b16 v[30:31], v21 offset:26624
    s_waitcnt lgkmcnt(10)
    v_mfma_f32_32x32x16_bf16 v[120:135], v[36:39], v[196:199], v[120:135]
    ds_read_b64_tr_b16 v[32:33], v20 offset:25600
    ds_read_b64_tr_b16 v[34:35], v20 offset:27648
    s_waitcnt lgkmcnt(10)
    v_mfma_f32_32x32x16_bf16 v[136:151], v[40:43], v[196:199], v[136:151]
    ds_read_b64_tr_b16 v[36:37], v21 offset:25600
    ds_read_b64_tr_b16 v[38:39], v21 offset:27648
    s_waitcnt lgkmcnt(10)
    v_mfma_f32_32x32x16_bf16 v[88:103], v[44:47], v[196:199], v[88:103]
    ds_read_b64_tr_b16 v[40:41], v20 offset:28672
    ds_read_b64_tr_b16 v[42:43], v20 offset:30720
    s_waitcnt lgkmcnt(10)
    v_mfma_f32_32x32x16_bf16 v[104:119], v[48:51], v[196:199], v[104:119]
    buffer_load_dwordx4 v[188:191], v249, s[32:35], s16 offen offset:1024 sc1
    ds_read_b64_tr_b16 v[44:45], v21 offset:28672
    ds_read_b64_tr_b16 v[46:47], v21 offset:30720
    s_barrier
    s_waitcnt vmcnt(21)
    s_waitcnt lgkmcnt(10)
    v_mfma_f32_32x32x16_bf16 v[56:71], v[52:55], v[200:203], v[56:71]
    ds_read_b64_tr_b16 v[48:49], v20 offset:29696
    ds_read_b64_tr_b16 v[50:51], v20 offset:31744
    s_waitcnt lgkmcnt(10)
    v_mfma_f32_32x32x16_bf16 v[72:87], v[28:31], v[200:203], v[72:87]
    ds_read_b64_tr_b16 v[52:53], v21 offset:29696
    ds_read_b64_tr_b16 v[54:55], v21 offset:31744
    s_waitcnt vmcnt(20)
    s_waitcnt lgkmcnt(10)
    v_mfma_f32_32x32x16_bf16 v[56:71], v[32:35], v[204:207], v[56:71]
    ds_read_b64_tr_b16 v[28:29], v24 offset:24576
    ds_read_b64_tr_b16 v[30:31], v24 offset:26624
    s_waitcnt lgkmcnt(10)
    v_mfma_f32_32x32x16_bf16 v[72:87], v[36:39], v[204:207], v[72:87]
    buffer_load_dwordx4 v[192:195], v249, s[32:35], s16 offen offset:2048 sc1
    ds_read_b64_tr_b16 v[32:33], v25 offset:24576
    ds_read_b64_tr_b16 v[34:35], v25 offset:26624
    s_waitcnt vmcnt(20)
    s_waitcnt lgkmcnt(10)
    v_mfma_f32_32x32x16_bf16 v[56:71], v[40:43], v[208:211], v[56:71]
    ds_read_b64_tr_b16 v[36:37], v22 offset:24576
    ds_read_b64_tr_b16 v[38:39], v22 offset:26624
    s_waitcnt lgkmcnt(10)
    v_mfma_f32_32x32x16_bf16 v[72:87], v[44:47], v[208:211], v[72:87]
    ds_read_b64_tr_b16 v[40:41], v23 offset:24576
    ds_read_b64_tr_b16 v[42:43], v23 offset:26624
    s_waitcnt vmcnt(19)
    s_waitcnt lgkmcnt(10)
    v_mfma_f32_32x32x16_bf16 v[56:71], v[48:51], v[212:215], v[56:71]
    ds_read_b64_tr_b16 v[44:45], v24 offset:25600
    ds_read_b64_tr_b16 v[46:47], v24 offset:27648
    s_waitcnt lgkmcnt(10)
    v_mfma_f32_32x32x16_bf16 v[72:87], v[52:55], v[212:215], v[72:87]
    buffer_load_dwordx4 v[196:199], v249, s[32:35], s16 offen offset:3072 sc1
    ds_read_b64_tr_b16 v[48:49], v25 offset:25600
    ds_read_b64_tr_b16 v[50:51], v25 offset:27648
    s_barrier
    s_waitcnt lgkmcnt(10)
    v_mfma_f32_32x32x16_bf16 v[120:135], v[28:31], v[200:203], v[120:135]
    s_add_u32 s16, s16, 16384
    ds_read_b64_tr_b16 v[52:53], v22 offset:25600
    ds_read_b64_tr_b16 v[54:55], v22 offset:27648
    s_waitcnt lgkmcnt(10)
    v_mfma_f32_32x32x16_bf16 v[136:151], v[32:35], v[200:203], v[136:151]
    s_and_b32 s16, s16, 0x3ffff
    ds_read_b64_tr_b16 v[28:29], v23 offset:25600
    ds_read_b64_tr_b16 v[30:31], v23 offset:27648
    s_waitcnt lgkmcnt(10)
    v_mfma_f32_32x32x16_bf16 v[88:103], v[36:39], v[200:203], v[88:103]
    ds_read_b64_tr_b16 v[32:33], v24 offset:28672
    ds_read_b64_tr_b16 v[34:35], v24 offset:30720
    s_waitcnt lgkmcnt(10)
    v_mfma_f32_32x32x16_bf16 v[104:119], v[40:43], v[200:203], v[104:119]
    buffer_load_dwordx4 v[200:203], v249, s[32:35], s16 offen sc1
    ds_read_b64_tr_b16 v[36:37], v25 offset:28672
    ds_read_b64_tr_b16 v[38:39], v25 offset:30720
    s_waitcnt lgkmcnt(10)
    v_mfma_f32_32x32x16_bf16 v[120:135], v[44:47], v[204:207], v[120:135]
    ds_read_b64_tr_b16 v[40:41], v22 offset:28672
    ds_read_b64_tr_b16 v[42:43], v22 offset:30720
    s_waitcnt lgkmcnt(10)
    v_mfma_f32_32x32x16_bf16 v[136:151], v[48:51], v[204:207], v[136:151]
    ds_read_b64_tr_b16 v[44:45], v23 offset:28672
    ds_read_b64_tr_b16 v[46:47], v23 offset:30720
    s_waitcnt lgkmcnt(10)
    v_mfma_f32_32x32x16_bf16 v[88:103], v[52:55], v[204:207], v[88:103]
    ds_read_b64_tr_b16 v[48:49], v24 offset:29696
    ds_read_b64_tr_b16 v[50:51], v24 offset:31744
    s_waitcnt lgkmcnt(10)
    v_mfma_f32_32x32x16_bf16 v[104:119], v[28:31], v[204:207], v[104:119]
    buffer_load_dwordx4 v[204:207], v249, s[32:35], s16 offen offset:1024 sc1
    ds_read_b64_tr_b16 v[52:53], v25 offset:29696
    ds_read_b64_tr_b16 v[54:55], v25 offset:31744
    s_waitcnt lgkmcnt(10)
    v_mfma_f32_32x32x16_bf16 v[120:135], v[32:35], v[208:211], v[120:135]
    ds_read_b64_tr_b16 v[28:29], v22 offset:29696
    ds_read_b64_tr_b16 v[30:31], v22 offset:31744
    s_waitcnt lgkmcnt(10)
    v_mfma_f32_32x32x16_bf16 v[136:151], v[36:39], v[208:211], v[136:151]
    ds_read_b64_tr_b16 v[32:33], v23 offset:29696
    ds_read_b64_tr_b16 v[34:35], v23 offset:31744
    s_waitcnt lgkmcnt(10)
    v_mfma_f32_32x32x16_bf16 v[88:103], v[40:43], v[208:211], v[88:103]
    ds_read_b64_tr_b16 v[36:37], v20 offset:32768
    ds_read_b64_tr_b16 v[38:39], v20 offset:34816
    s_waitcnt lgkmcnt(10)
    v_mfma_f32_32x32x16_bf16 v[104:119], v[44:47], v[208:211], v[104:119]
    buffer_load_dwordx4 v[208:211], v249, s[32:35], s16 offen offset:2048 sc1
    ds_read_b64_tr_b16 v[40:41], v20 offset:33792
    ds_read_b64_tr_b16 v[42:43], v20 offset:35840
    s_waitcnt lgkmcnt(10)
    v_mfma_f32_32x32x16_bf16 v[120:135], v[48:51], v[212:215], v[120:135]
    ds_read_b64_tr_b16 v[44:45], v20 offset:36864
    ds_read_b64_tr_b16 v[46:47], v20 offset:38912
    s_waitcnt lgkmcnt(10)
    v_mfma_f32_32x32x16_bf16 v[136:151], v[52:55], v[212:215], v[136:151]
    ds_read_b64_tr_b16 v[48:49], v20 offset:37888
    ds_read_b64_tr_b16 v[50:51], v20 offset:39936
    s_waitcnt lgkmcnt(10)
    v_mfma_f32_32x32x16_bf16 v[88:103], v[28:31], v[212:215], v[88:103]
    ds_read_b64_tr_b16 v[52:53], v20 offset:40960
    ds_read_b64_tr_b16 v[54:55], v20 offset:43008
    s_waitcnt lgkmcnt(10)
    v_mfma_f32_32x32x16_bf16 v[104:119], v[32:35], v[212:215], v[104:119]
    buffer_load_dwordx4 v[212:215], v249, s[32:35], s16 offen offset:3072 sc1
    ds_read_b64_tr_b16 v[28:29], v20 offset:41984
    ds_read_b64_tr_b16 v[30:31], v20 offset:44032
    s_barrier
    s_waitcnt vmcnt(23)
    s_waitcnt lgkmcnt(10)
    v_mfma_f32_32x32x16_bf16 v[56:71], v[36:39], v[216:219], v[56:71]
    s_add_u32 s16, s16, 16384
    ds_read_b64_tr_b16 v[32:33], v20 offset:45056
    ds_read_b64_tr_b16 v[34:35], v20 offset:47104
    s_waitcnt vmcnt(22)
    s_waitcnt lgkmcnt(10)
    v_mfma_f32_32x32x16_bf16 v[56:71], v[40:43], v[220:223], v[56:71]
    s_and_b32 s16, s16, 0x3ffff
    ds_read_b64_tr_b16 v[36:37], v20 offset:46080
    ds_read_b64_tr_b16 v[38:39], v20 offset:48128
    s_waitcnt vmcnt(21)
    s_waitcnt lgkmcnt(10)
    v_mfma_f32_32x32x16_bf16 v[56:71], v[44:47], v[224:227], v[56:71]
    ds_read_b64_tr_b16 v[40:41], v20
    ds_read_b64_tr_b16 v[42:43], v20 offset:2048
    s_waitcnt vmcnt(20)
    s_waitcnt lgkmcnt(10)
    v_mfma_f32_32x32x16_bf16 v[56:71], v[48:51], v[228:231], v[56:71]
    ds_read_b64_tr_b16 v[44:45], v20 offset:1024
    ds_read_b64_tr_b16 v[46:47], v20 offset:3072
    s_waitcnt vmcnt(19)
    s_waitcnt lgkmcnt(10)
    v_mfma_f32_32x32x16_bf16 v[56:71], v[52:55], v[232:235], v[56:71]
    ds_read_b64_tr_b16 v[48:49], v20 offset:4096
    ds_read_b64_tr_b16 v[50:51], v20 offset:6144
    s_waitcnt vmcnt(18)
    s_waitcnt lgkmcnt(10)
    v_mfma_f32_32x32x16_bf16 v[56:71], v[28:31], v[236:239], v[56:71]
    ds_read_b64_tr_b16 v[52:53], v20 offset:5120
    ds_read_b64_tr_b16 v[54:55], v20 offset:7168
    s_waitcnt vmcnt(17)
    s_waitcnt lgkmcnt(10)
    v_mfma_f32_32x32x16_bf16 v[56:71], v[32:35], v[240:243], v[56:71]
    ds_read_b64_tr_b16 v[28:29], v20 offset:8192
    ds_read_b64_tr_b16 v[30:31], v20 offset:10240
    s_waitcnt vmcnt(16)
    s_waitcnt lgkmcnt(10)
    v_mfma_f32_32x32x16_bf16 v[56:71], v[36:39], v[244:247], v[56:71]
    ds_read_b64_tr_b16 v[32:33], v20 offset:9216
    ds_read_b64_tr_b16 v[34:35], v20 offset:11264
    s_waitcnt vmcnt(15)
    s_waitcnt lgkmcnt(10)
    v_mfma_f32_32x32x16_bf16 v[56:71], v[40:43], v[152:155], v[56:71]
    ds_read_b64_tr_b16 v[36:37], v20 offset:12288
    ds_read_b64_tr_b16 v[38:39], v20 offset:14336
    s_waitcnt vmcnt(14)
    s_waitcnt lgkmcnt(10)
    v_mfma_f32_32x32x16_bf16 v[56:71], v[44:47], v[156:159], v[56:71]
    ds_read_b64_tr_b16 v[40:41], v20 offset:13312
    ds_read_b64_tr_b16 v[42:43], v20 offset:15360
    s_waitcnt vmcnt(13)
    s_waitcnt lgkmcnt(10)
    v_mfma_f32_32x32x16_bf16 v[56:71], v[48:51], v[160:163], v[56:71]
    ds_read_b64_tr_b16 v[44:45], v20 offset:16384
    ds_read_b64_tr_b16 v[46:47], v20 offset:18432
    s_waitcnt vmcnt(12)
    s_waitcnt lgkmcnt(10)
    v_mfma_f32_32x32x16_bf16 v[56:71], v[52:55], v[164:167], v[56:71]
    ds_read_b64_tr_b16 v[48:49], v20 offset:17408
    ds_read_b64_tr_b16 v[50:51], v20 offset:19456
    s_waitcnt vmcnt(11)
    s_waitcnt lgkmcnt(10)
    v_mfma_f32_32x32x16_bf16 v[56:71], v[28:31], v[168:171], v[56:71]
    ds_read_b64_tr_b16 v[52:53], v20 offset:20480
    ds_read_b64_tr_b16 v[54:55], v20 offset:22528
    s_waitcnt vmcnt(10)
    s_waitcnt lgkmcnt(10)
    v_mfma_f32_32x32x16_bf16 v[56:71], v[32:35], v[172:175], v[56:71]
    ds_read_b64_tr_b16 v[28:29], v20 offset:21504
    ds_read_b64_tr_b16 v[30:31], v20 offset:23552
    s_barrier
    s_waitcnt vmcnt(9)
    s_waitcnt lgkmcnt(10)
    v_mfma_f32_32x32x16_bf16 v[56:71], v[36:39], v[176:179], v[56:71]
    ds_read_b64_tr_b16 v[32:33], v20 offset:24576
    ds_read_b64_tr_b16 v[34:35], v20 offset:26624
    s_waitcnt vmcnt(8)
    s_waitcnt lgkmcnt(10)
    v_mfma_f32_32x32x16_bf16 v[56:71], v[40:43], v[180:183], v[56:71]
    ds_read_b64_tr_b16 v[36:37], v20 offset:25600
    ds_read_b64_tr_b16 v[38:39], v20 offset:27648
    s_waitcnt vmcnt(7)
    s_waitcnt lgkmcnt(10)
    v_mfma_f32_32x32x16_bf16 v[56:71], v[44:47], v[184:187], v[56:71]
    ds_read_b64_tr_b16 v[40:41], v20 offset:28672
    ds_read_b64_tr_b16 v[42:43], v20 offset:30720
    s_waitcnt vmcnt(6)
    s_waitcnt lgkmcnt(10)
    v_mfma_f32_32x32x16_bf16 v[56:71], v[48:51], v[188:191], v[56:71]
    ds_read_b64_tr_b16 v[44:45], v20 offset:29696
    ds_read_b64_tr_b16 v[46:47], v20 offset:31744
    s_waitcnt vmcnt(5)
    s_waitcnt lgkmcnt(10)
    v_mfma_f32_32x32x16_bf16 v[56:71], v[52:55], v[192:195], v[56:71]
    ds_read_b64_tr_b16 v[48:49], v21 offset:32768
    ds_read_b64_tr_b16 v[50:51], v21 offset:34816
    s_waitcnt vmcnt(4)
    s_waitcnt lgkmcnt(10)
    v_mfma_f32_32x32x16_bf16 v[56:71], v[28:31], v[196:199], v[56:71]
    ds_read_b64_tr_b16 v[52:53], v21 offset:33792
    ds_read_b64_tr_b16 v[54:55], v21 offset:35840
    s_waitcnt vmcnt(3)
    s_waitcnt lgkmcnt(10)
    v_mfma_f32_32x32x16_bf16 v[56:71], v[32:35], v[200:203], v[56:71]
    ds_read_b64_tr_b16 v[28:29], v21 offset:36864
    ds_read_b64_tr_b16 v[30:31], v21 offset:38912
    s_waitcnt vmcnt(2)
    s_waitcnt lgkmcnt(10)
    v_mfma_f32_32x32x16_bf16 v[56:71], v[36:39], v[204:207], v[56:71]
    ds_read_b64_tr_b16 v[32:33], v21 offset:37888
    ds_read_b64_tr_b16 v[34:35], v21 offset:39936
    s_waitcnt vmcnt(1)
    s_waitcnt lgkmcnt(10)
    v_mfma_f32_32x32x16_bf16 v[56:71], v[40:43], v[208:211], v[56:71]
    ds_read_b64_tr_b16 v[36:37], v21 offset:40960
    ds_read_b64_tr_b16 v[38:39], v21 offset:43008
    s_waitcnt vmcnt(0)
    s_waitcnt lgkmcnt(10)
    v_mfma_f32_32x32x16_bf16 v[56:71], v[44:47], v[212:215], v[56:71]
    ds_read_b64_tr_b16 v[40:41], v21 offset:41984
    ds_read_b64_tr_b16 v[42:43], v21 offset:44032
    s_waitcnt lgkmcnt(10)
    v_mfma_f32_32x32x16_bf16 v[72:87], v[48:51], v[216:219], v[72:87]
    ds_read_b64_tr_b16 v[44:45], v21 offset:45056
    ds_read_b64_tr_b16 v[46:47], v21 offset:47104
    s_waitcnt lgkmcnt(10)
    v_mfma_f32_32x32x16_bf16 v[72:87], v[52:55], v[220:223], v[72:87]
    s_nop 3
    v_cvt_pk_bf16_f32 v56, v56, v57
    v_cvt_pk_bf16_f32 v57, v58, v59
    ds_read_b64_tr_b16 v[48:49], v21 offset:46080
    ds_read_b64_tr_b16 v[50:51], v21 offset:48128
    s_waitcnt lgkmcnt(10)
    v_mfma_f32_32x32x16_bf16 v[72:87], v[28:31], v[224:227], v[72:87]
    v_cvt_pk_bf16_f32 v58, v60, v61
    v_cvt_pk_bf16_f32 v59, v62, v63
    ds_read_b64_tr_b16 v[52:53], v21
    ds_read_b64_tr_b16 v[54:55], v21 offset:2048
    s_waitcnt lgkmcnt(10)
    v_mfma_f32_32x32x16_bf16 v[72:87], v[32:35], v[228:231], v[72:87]
    ds_write_b128 v0, v[56:59]
    v_cvt_pk_bf16_f32 v60, v64, v65
    ds_read_b64_tr_b16 v[28:29], v21 offset:1024
    ds_read_b64_tr_b16 v[30:31], v21 offset:3072
    s_waitcnt lgkmcnt(11)
    v_mfma_f32_32x32x16_bf16 v[72:87], v[36:39], v[232:235], v[72:87]
    v_cvt_pk_bf16_f32 v61, v66, v67
    v_cvt_pk_bf16_f32 v62, v68, v69
    ds_read_b64_tr_b16 v[32:33], v21 offset:4096
    ds_read_b64_tr_b16 v[34:35], v21 offset:6144
    s_waitcnt lgkmcnt(11)
    v_mfma_f32_32x32x16_bf16 v[72:87], v[40:43], v[236:239], v[72:87]
    v_cvt_pk_bf16_f32 v63, v70, v71
    ds_write_b128 v0, v[60:63] offset:1024
    ds_read_b64_tr_b16 v[36:37], v21 offset:5120
    ds_read_b64_tr_b16 v[38:39], v21 offset:7168
    s_waitcnt lgkmcnt(12)
    v_mfma_f32_32x32x16_bf16 v[72:87], v[44:47], v[240:243], v[72:87]
    v_subrev_u32 v0, 118784, v0
    ds_read_b64_tr_b16 v[40:41], v21 offset:8192
    ds_read_b64_tr_b16 v[42:43], v21 offset:10240
    s_waitcnt lgkmcnt(12)
    v_mfma_f32_32x32x16_bf16 v[72:87], v[48:51], v[244:247], v[72:87]
    ds_read_b64_tr_b16 v[44:45], v21 offset:9216
    ds_read_b64_tr_b16 v[46:47], v21 offset:11264
    s_waitcnt lgkmcnt(6)
    s_barrier
    v_mfma_f32_32x32x16_bf16 v[72:87], v[52:55], v[152:155], v[72:87]
    ds_read_b64_tr_b16 v[48:49], v21 offset:12288
    ds_read_b64_tr_b16 v[50:51], v21 offset:14336
    v_mfma_f32_32x32x16_bf16 v[72:87], v[28:31], v[156:159], v[72:87]
    ds_read_b64_tr_b16 v[52:53], v21 offset:13312
    ds_read_b64_tr_b16 v[54:55], v21 offset:15360
    v_mfma_f32_32x32x16_bf16 v[72:87], v[32:35], v[160:163], v[72:87]
    ds_read_b64_tr_b16 v[28:29], v21 offset:16384
    ds_read_b64_tr_b16 v[30:31], v21 offset:18432
    s_waitcnt lgkmcnt(10)
    v_mfma_f32_32x32x16_bf16 v[72:87], v[36:39], v[164:167], v[72:87]
    ds_read_b64_tr_b16 v[32:33], v21 offset:17408
    ds_read_b64_tr_b16 v[34:35], v21 offset:19456
    s_waitcnt lgkmcnt(10)
    v_mfma_f32_32x32x16_bf16 v[72:87], v[40:43], v[168:171], v[72:87]
    ds_read_b64_tr_b16 v[36:37], v21 offset:20480
    ds_read_b64_tr_b16 v[38:39], v21 offset:22528
    s_waitcnt lgkmcnt(10)
    v_mfma_f32_32x32x16_bf16 v[72:87], v[44:47], v[172:175], v[72:87]
    ds_read_b64_tr_b16 v[40:41], v21 offset:21504
    ds_read_b64_tr_b16 v[42:43], v21 offset:23552
    s_waitcnt lgkmcnt(10)
    v_mfma_f32_32x32x16_bf16 v[72:87], v[48:51], v[176:179], v[72:87]
    ds_read_b64_tr_b16 v[44:45], v21 offset:24576
    ds_read_b64_tr_b16 v[46:47], v21 offset:26624
    s_waitcnt lgkmcnt(10)
    v_mfma_f32_32x32x16_bf16 v[72:87], v[52:55], v[180:183], v[72:87]
    ds_read_b64_tr_b16 v[48:49], v21 offset:25600
    ds_read_b64_tr_b16 v[50:51], v21 offset:27648
    s_waitcnt lgkmcnt(10)
    v_mfma_f32_32x32x16_bf16 v[72:87], v[28:31], v[184:187], v[72:87]
    ds_read_b64_tr_b16 v[52:53], v21 offset:28672
    ds_read_b64_tr_b16 v[54:55], v21 offset:30720
    s_waitcnt lgkmcnt(10)
    v_mfma_f32_32x32x16_bf16 v[72:87], v[32:35], v[188:191], v[72:87]
    ds_read_b64_tr_b16 v[28:29], v21 offset:29696
    ds_read_b64_tr_b16 v[30:31], v21 offset:31744
    s_waitcnt lgkmcnt(10)
    v_mfma_f32_32x32x16_bf16 v[72:87], v[36:39], v[192:195], v[72:87]
    ds_read_b64_tr_b16 v[32:33], v22 offset:32768
    ds_read_b64_tr_b16 v[34:35], v22 offset:34816
    s_waitcnt lgkmcnt(10)
    v_mfma_f32_32x32x16_bf16 v[72:87], v[40:43], v[196:199], v[72:87]
    ds_read_b64_tr_b16 v[36:37], v23 offset:32768
    ds_read_b64_tr_b16 v[38:39], v23 offset:34816
    s_waitcnt lgkmcnt(10)
    v_mfma_f32_32x32x16_bf16 v[72:87], v[44:47], v[200:203], v[72:87]
    ds_read_b64_tr_b16 v[40:41], v22 offset:33792
    ds_read_b64_tr_b16 v[42:43], v22 offset:35840
    s_waitcnt lgkmcnt(10)
    v_mfma_f32_32x32x16_bf16 v[72:87], v[48:51], v[204:207], v[72:87]
    ds_read_b64_tr_b16 v[44:45], v23 offset:33792
    ds_read_b64_tr_b16 v[46:47], v23 offset:35840
    s_waitcnt lgkmcnt(10)
    v_mfma_f32_32x32x16_bf16 v[72:87], v[52:55], v[208:211], v[72:87]
    ds_read_b64_tr_b16 v[48:49], v22 offset:36864
    ds_read_b64_tr_b16 v[50:51], v22 offset:38912
    s_waitcnt lgkmcnt(10)
    v_mfma_f32_32x32x16_bf16 v[72:87], v[28:31], v[212:215], v[72:87]
    ds_read_b64_tr_b16 v[52:53], v23 offset:36864
    ds_read_b64_tr_b16 v[54:55], v23 offset:38912
    s_waitcnt lgkmcnt(10)
    v_mfma_f32_32x32x16_bf16 v[88:103], v[32:35], v[216:219], v[88:103]
    ds_read_b64_tr_b16 v[28:29], v22 offset:37888
    ds_read_b64_tr_b16 v[30:31], v22 offset:39936
    s_waitcnt lgkmcnt(10)
    v_mfma_f32_32x32x16_bf16 v[104:119], v[36:39], v[216:219], v[104:119]
    s_nop 3
    v_cvt_pk_bf16_f32 v72, v72, v73
    v_cvt_pk_bf16_f32 v73, v74, v75
    ds_read_b64_tr_b16 v[32:33], v23 offset:37888
    ds_read_b64_tr_b16 v[34:35], v23 offset:39936
    s_waitcnt lgkmcnt(10)
    v_mfma_f32_32x32x16_bf16 v[88:103], v[40:43], v[220:223], v[88:103]
    v_cvt_pk_bf16_f32 v74, v76, v77
    v_cvt_pk_bf16_f32 v75, v78, v79
    ds_read_b64_tr_b16 v[36:37], v22 offset:40960
    ds_read_b64_tr_b16 v[38:39], v22 offset:43008
    s_waitcnt lgkmcnt(10)
    v_mfma_f32_32x32x16_bf16 v[104:119], v[44:47], v[220:223], v[104:119]
    ds_write_b128 v0, v[72:75]
    v_cvt_pk_bf16_f32 v76, v80, v81
    ds_read_b64_tr_b16 v[40:41], v23 offset:40960
    ds_read_b64_tr_b16 v[42:43], v23 offset:43008
    s_waitcnt lgkmcnt(11)
    v_mfma_f32_32x32x16_bf16 v[88:103], v[48:51], v[224:227], v[88:103]
    v_cvt_pk_bf16_f32 v77, v82, v83
    v_cvt_pk_bf16_f32 v78, v84, v85
    ds_read_b64_tr_b16 v[44:45], v22 offset:41984
    ds_read_b64_tr_b16 v[46:47], v22 offset:44032
    s_waitcnt lgkmcnt(11)
    v_mfma_f32_32x32x16_bf16 v[104:119], v[52:55], v[224:227], v[104:119]
    v_cvt_pk_bf16_f32 v79, v86, v87
    ds_write_b128 v0, v[76:79] offset:1024
    ds_read_b64_tr_b16 v[48:49], v23 offset:41984
    ds_read_b64_tr_b16 v[50:51], v23 offset:44032
    s_waitcnt lgkmcnt(12)
    v_mfma_f32_32x32x16_bf16 v[88:103], v[28:31], v[228:231], v[88:103]
    ds_read_b64_tr_b16 v[52:53], v22 offset:45056
    ds_read_b64_tr_b16 v[54:55], v22 offset:47104
    s_waitcnt lgkmcnt(12)
    v_mfma_f32_32x32x16_bf16 v[104:119], v[32:35], v[228:231], v[104:119]
    ds_read_b64_tr_b16 v[28:29], v23 offset:45056
    ds_read_b64_tr_b16 v[30:31], v23 offset:47104
    s_waitcnt lgkmcnt(6)
    s_barrier
    v_mfma_f32_32x32x16_bf16 v[88:103], v[36:39], v[232:235], v[88:103]
    s_lshl_b32 s96, s77, 11
    s_add_u32 s14, s96, 32768
    v_and_b32 v0, 7, v1
    ds_read_b64_tr_b16 v[32:33], v22 offset:46080
    ds_read_b64_tr_b16 v[34:35], v22 offset:48128
    v_mfma_f32_32x32x16_bf16 v[104:119], v[40:43], v[232:235], v[104:119]
    v_lshl_add_u32 v0, v0, 4, s14
    ds_read_b64_tr_b16 v[36:37], v23 offset:46080
    ds_read_b64_tr_b16 v[38:39], v23 offset:48128
    v_mfma_f32_32x32x16_bf16 v[88:103], v[44:47], v[236:239], v[88:103]
    v_bfe_u32 v4, v1, 3, 2
    ds_read_b64_tr_b16 v[40:41], v22
    ds_read_b64_tr_b16 v[42:43], v22 offset:2048
    s_waitcnt lgkmcnt(10)
    v_mfma_f32_32x32x16_bf16 v[104:119], v[48:51], v[236:239], v[104:119]
    v_lshl_add_u32 v0, v4, 8, v0
    v_lshrrev_b32 v4, 5, v1
    ds_read_b64_tr_b16 v[44:45], v23
    ds_read_b64_tr_b16 v[46:47], v23 offset:2048
    s_waitcnt lgkmcnt(10)
    v_mfma_f32_32x32x16_bf16 v[88:103], v[52:55], v[240:243], v[88:103]
    v_lshl_add_u32 v0, v4, 7, v0
    ds_read_b64_tr_b16 v[48:49], v22 offset:1024
    ds_read_b64_tr_b16 v[50:51], v22 offset:3072
    s_waitcnt lgkmcnt(10)
    v_mfma_f32_32x32x16_bf16 v[104:119], v[28:31], v[240:243], v[104:119]
    ds_read_b64_tr_b16 v[52:53], v23 offset:1024
    ds_read_b64_tr_b16 v[54:55], v23 offset:3072
    s_waitcnt lgkmcnt(10)
    v_mfma_f32_32x32x16_bf16 v[88:103], v[32:35], v[244:247], v[88:103]
    ds_read_b64_tr_b16 v[28:29], v22 offset:4096
    ds_read_b64_tr_b16 v[30:31], v22 offset:6144
    s_waitcnt lgkmcnt(10)
    v_mfma_f32_32x32x16_bf16 v[104:119], v[36:39], v[244:247], v[104:119]
    ds_read_b64_tr_b16 v[32:33], v23 offset:4096
    ds_read_b64_tr_b16 v[34:35], v23 offset:6144
    s_waitcnt lgkmcnt(10)
    v_mfma_f32_32x32x16_bf16 v[88:103], v[40:43], v[152:155], v[88:103]
    ds_read_b64_tr_b16 v[36:37], v22 offset:5120
    ds_read_b64_tr_b16 v[38:39], v22 offset:7168
    s_waitcnt lgkmcnt(10)
    v_mfma_f32_32x32x16_bf16 v[104:119], v[44:47], v[152:155], v[104:119]
    ds_read_b64_tr_b16 v[40:41], v23 offset:5120
    ds_read_b64_tr_b16 v[42:43], v23 offset:7168
    s_waitcnt lgkmcnt(10)
    v_mfma_f32_32x32x16_bf16 v[88:103], v[48:51], v[156:159], v[88:103]
    ds_read_b64_tr_b16 v[44:45], v22 offset:8192
    ds_read_b64_tr_b16 v[46:47], v22 offset:10240
    s_waitcnt lgkmcnt(10)
    v_mfma_f32_32x32x16_bf16 v[104:119], v[52:55], v[156:159], v[104:119]
    ds_read_b64_tr_b16 v[48:49], v23 offset:8192
    ds_read_b64_tr_b16 v[50:51], v23 offset:10240
    s_waitcnt lgkmcnt(10)
    v_mfma_f32_32x32x16_bf16 v[88:103], v[28:31], v[160:163], v[88:103]
    ds_read_b64_tr_b16 v[52:53], v22 offset:9216
    ds_read_b64_tr_b16 v[54:55], v22 offset:11264
    s_waitcnt lgkmcnt(10)
    v_mfma_f32_32x32x16_bf16 v[104:119], v[32:35], v[160:163], v[104:119]
    ds_read_b64_tr_b16 v[28:29], v23 offset:9216
    ds_read_b64_tr_b16 v[30:31], v23 offset:11264
    s_waitcnt lgkmcnt(10)
    v_mfma_f32_32x32x16_bf16 v[88:103], v[36:39], v[164:167], v[88:103]
    ds_read_b64_tr_b16 v[32:33], v22 offset:12288
    ds_read_b64_tr_b16 v[34:35], v22 offset:14336
    s_waitcnt lgkmcnt(10)
    v_mfma_f32_32x32x16_bf16 v[104:119], v[40:43], v[164:167], v[104:119]
    ds_read_b64_tr_b16 v[36:37], v23 offset:12288
    ds_read_b64_tr_b16 v[38:39], v23 offset:14336
    s_waitcnt lgkmcnt(10)
    v_mfma_f32_32x32x16_bf16 v[88:103], v[44:47], v[168:171], v[88:103]
    ds_read_b64_tr_b16 v[40:41], v22 offset:13312
    ds_read_b64_tr_b16 v[42:43], v22 offset:15360
    s_waitcnt lgkmcnt(10)
    v_mfma_f32_32x32x16_bf16 v[104:119], v[48:51], v[168:171], v[104:119]
    ds_read_b64_tr_b16 v[44:45], v23 offset:13312
    ds_read_b64_tr_b16 v[46:47], v23 offset:15360
    s_waitcnt lgkmcnt(10)
    v_mfma_f32_32x32x16_bf16 v[88:103], v[52:55], v[172:175], v[88:103]
    ds_read_b64_tr_b16 v[48:49], v22 offset:16384
    ds_read_b64_tr_b16 v[50:51], v22 offset:18432
    s_waitcnt lgkmcnt(10)
    v_mfma_f32_32x32x16_bf16 v[104:119], v[28:31], v[172:175], v[104:119]
    ds_read_b64_tr_b16 v[52:53], v23 offset:16384
    ds_read_b64_tr_b16 v[54:55], v23 offset:18432
    s_waitcnt lgkmcnt(10)
    v_mfma_f32_32x32x16_bf16 v[88:103], v[32:35], v[176:179], v[88:103]
    ds_read_b64_tr_b16 v[28:29], v22 offset:17408
    ds_read_b64_tr_b16 v[30:31], v22 offset:19456
    s_waitcnt lgkmcnt(10)
    v_mfma_f32_32x32x16_bf16 v[104:119], v[36:39], v[176:179], v[104:119]
    ds_read_b64_tr_b16 v[32:33], v23 offset:17408
    ds_read_b64_tr_b16 v[34:35], v23 offset:19456
    s_waitcnt lgkmcnt(10)
    v_mfma_f32_32x32x16_bf16 v[88:103], v[40:43], v[180:183], v[88:103]
    ds_read_b64_tr_b16 v[36:37], v22 offset:20480
    ds_read_b64_tr_b16 v[38:39], v22 offset:22528
    s_waitcnt lgkmcnt(10)
    v_mfma_f32_32x32x16_bf16 v[104:119], v[44:47], v[180:183], v[104:119]
    ds_read_b64_tr_b16 v[40:41], v23 offset:20480
    ds_read_b64_tr_b16 v[42:43], v23 offset:22528
    s_waitcnt lgkmcnt(10)
    v_mfma_f32_32x32x16_bf16 v[88:103], v[48:51], v[184:187], v[88:103]
    ds_read_b64_tr_b16 v[44:45], v22 offset:21504
    ds_read_b64_tr_b16 v[46:47], v22 offset:23552
    s_waitcnt lgkmcnt(10)
    v_mfma_f32_32x32x16_bf16 v[104:119], v[52:55], v[184:187], v[104:119]
    ds_read_b64_tr_b16 v[48:49], v23 offset:21504
    ds_read_b64_tr_b16 v[50:51], v23 offset:23552
    s_waitcnt lgkmcnt(10)
    v_mfma_f32_32x32x16_bf16 v[88:103], v[28:31], v[188:191], v[88:103]
    ds_read_b64_tr_b16 v[52:53], v22 offset:24576
    ds_read_b64_tr_b16 v[54:55], v22 offset:26624
    s_waitcnt lgkmcnt(10)
    v_mfma_f32_32x32x16_bf16 v[104:119], v[32:35], v[188:191], v[104:119]
    ds_read_b64_tr_b16 v[28:29], v23 offset:24576
    ds_read_b64_tr_b16 v[30:31], v23 offset:26624
    s_waitcnt lgkmcnt(10)
    v_mfma_f32_32x32x16_bf16 v[88:103], v[36:39], v[192:195], v[88:103]
    ds_read_b64_tr_b16 v[32:33], v22 offset:25600
    ds_read_b64_tr_b16 v[34:35], v22 offset:27648
    s_waitcnt lgkmcnt(10)
    v_mfma_f32_32x32x16_bf16 v[104:119], v[40:43], v[192:195], v[104:119]
    ds_read_b64_tr_b16 v[36:37], v23 offset:25600
    ds_read_b64_tr_b16 v[38:39], v23 offset:27648
    s_waitcnt lgkmcnt(10)
    v_mfma_f32_32x32x16_bf16 v[88:103], v[44:47], v[196:199], v[88:103]
    ds_read_b64_tr_b16 v[40:41], v22 offset:28672
    ds_read_b64_tr_b16 v[42:43], v22 offset:30720
    s_waitcnt lgkmcnt(10)
    v_mfma_f32_32x32x16_bf16 v[104:119], v[48:51], v[196:199], v[104:119]
    ds_read_b64_tr_b16 v[44:45], v23 offset:28672
    ds_read_b64_tr_b16 v[46:47], v23 offset:30720
    s_waitcnt lgkmcnt(10)
    v_mfma_f32_32x32x16_bf16 v[88:103], v[52:55], v[200:203], v[88:103]
    ds_read_b64_tr_b16 v[48:49], v22 offset:29696
    ds_read_b64_tr_b16 v[50:51], v22 offset:31744
    s_waitcnt lgkmcnt(10)
    v_mfma_f32_32x32x16_bf16 v[104:119], v[28:31], v[200:203], v[104:119]
    ds_read_b64_tr_b16 v[52:53], v23 offset:29696
    ds_read_b64_tr_b16 v[54:55], v23 offset:31744
    s_waitcnt lgkmcnt(10)
    v_mfma_f32_32x32x16_bf16 v[88:103], v[32:35], v[204:207], v[88:103]
    ds_read_b64_tr_b16 v[28:29], v24 offset:32768
    ds_read_b64_tr_b16 v[30:31], v24 offset:34816
    s_waitcnt lgkmcnt(10)
    v_mfma_f32_32x32x16_bf16 v[104:119], v[36:39], v[204:207], v[104:119]
    ds_read_b64_tr_b16 v[32:33], v25 offset:32768
    ds_read_b64_tr_b16 v[34:35], v25 offset:34816
    s_waitcnt lgkmcnt(10)
    v_mfma_f32_32x32x16_bf16 v[88:103], v[40:43], v[208:211], v[88:103]
    ds_read_b64_tr_b16 v[36:37], v24 offset:33792
    ds_read_b64_tr_b16 v[38:39], v24 offset:35840
    s_waitcnt lgkmcnt(10)
    v_mfma_f32_32x32x16_bf16 v[104:119], v[44:47], v[208:211], v[104:119]
    ds_read_b64_tr_b16 v[40:41], v25 offset:33792
    ds_read_b64_tr_b16 v[42:43], v25 offset:35840
    s_waitcnt lgkmcnt(10)
    v_mfma_f32_32x32x16_bf16 v[88:103], v[48:51], v[212:215], v[88:103]
    ds_read_b64_tr_b16 v[44:45], v24 offset:36864
    ds_read_b64_tr_b16 v[46:47], v24 offset:38912
    s_waitcnt lgkmcnt(10)
    v_mfma_f32_32x32x16_bf16 v[104:119], v[52:55], v[212:215], v[104:119]
    ds_read_b64_tr_b16 v[48:49], v25 offset:36864
    ds_read_b64_tr_b16 v[50:51], v25 offset:38912
    s_barrier
    s_waitcnt lgkmcnt(10)
    v_mfma_f32_32x32x16_bf16 v[120:135], v[28:31], v[216:219], v[120:135]
    ds_read_b64_tr_b16 v[52:53], v24 offset:37888
    ds_read_b64_tr_b16 v[54:55], v24 offset:39936
L_PAD4:
    s_cbranch_execz L_RET4
    s_waitcnt lgkmcnt(10)
    v_mfma_f32_32x32x16_bf16 v[136:151], v[32:35], v[216:219], v[136:151]
    ds_read_b64_tr_b16 v[28:29], v25 offset:37888
    ds_read_b64_tr_b16 v[30:31], v25 offset:39936
    s_waitcnt lgkmcnt(10)
    v_mfma_f32_32x32x16_bf16 v[120:135], v[36:39], v[220:223], v[120:135]
    v_cvt_pk_bf16_f32 v88, v88, v89
    ds_read_b64_tr_b16 v[32:33], v24 offset:40960
    ds_read_b64_tr_b16 v[34:35], v24 offset:43008
    s_waitcnt lgkmcnt(10)
    v_mfma_f32_32x32x16_bf16 v[136:151], v[40:43], v[220:223], v[136:151]
    v_cvt_pk_bf16_f32 v89, v90, v91
    ds_read_b64_tr_b16 v[36:37], v25 offset:40960
    ds_read_b64_tr_b16 v[38:39], v25 offset:43008
    s_waitcnt lgkmcnt(10)
    v_mfma_f32_32x32x16_bf16 v[120:135], v[44:47], v[224:227], v[120:135]
    v_cvt_pk_bf16_f32 v90, v92, v93
    ds_read_b64_tr_b16 v[40:41], v24 offset:41984
    ds_read_b64_tr_b16 v[42:43], v24 offset:44032
    s_waitcnt lgkmcnt(10)
    v_mfma_f32_32x32x16_bf16 v[136:151], v[48:51], v[224:227], v[136:151]
    v_cvt_pk_bf16_f32 v91, v94, v95
    ds_read_b64_tr_b16 v[44:45], v25 offset:41984
    ds_read_b64_tr_b16 v[46:47], v25 offset:44032
    s_waitcnt lgkmcnt(10)
    v_mfma_f32_32x32x16_bf16 v[120:135], v[52:55], v[228:231], v[120:135]
    ds_write_b128 v0, v[88:91]
    ds_read_b64_tr_b16 v[48:49], v24 offset:45056
    ds_read_b64_tr_b16 v[50:51], v24 offset:47104
    s_waitcnt lgkmcnt(11)
    v_mfma_f32_32x32x16_bf16 v[136:151], v[28:31], v[228:231], v[136:151]
    v_cvt_pk_bf16_f32 v92, v96, v97
    ds_read_b64_tr_b16 v[52:53], v25 offset:45056
    ds_read_b64_tr_b16 v[54:55], v25 offset:47104
    s_waitcnt lgkmcnt(11)
    v_mfma_f32_32x32x16_bf16 v[120:135], v[32:35], v[232:235], v[120:135]
    v_cvt_pk_bf16_f32 v93, v98, v99
    ds_read_b64_tr_b16 v[28:29], v24 offset:46080
    ds_read_b64_tr_b16 v[30:31], v24 offset:48128
    s_waitcnt lgkmcnt(11)
    v_mfma_f32_32x32x16_bf16 v[136:151], v[36:39], v[232:235], v[136:151]
    v_cvt_pk_bf16_f32 v94, v100, v101
    ds_read_b64_tr_b16 v[32:33], v25 offset:46080
    ds_read_b64_tr_b16 v[34:35], v25 offset:48128
    s_waitcnt lgkmcnt(11)
    v_mfma_f32_32x32x16_bf16 v[120:135], v[40:43], v[236:239], v[120:135]
    v_cvt_pk_bf16_f32 v95, v102, v103
    ds_read_b64_tr_b16 v[36:37], v24
    ds_read_b64_tr_b16 v[38:39], v24 offset:2048
    s_waitcnt lgkmcnt(11)
    v_mfma_f32_32x32x16_bf16 v[136:151], v[44:47], v[236:239], v[136:151]
    ds_write_b128 v0, v[92:95] offset:1024
    ds_read_b64_tr_b16 v[40:41], v25
    ds_read_b64_tr_b16 v[42:43], v25 offset:2048
    s_waitcnt lgkmcnt(11)
    v_mfma_f32_32x32x16_bf16 v[120:135], v[48:51], v[240:243], v[120:135]
    v_cvt_pk_bf16_f32 v104, v104, v105
    ds_read_b64_tr_b16 v[44:45], v24 offset:1024
    ds_read_b64_tr_b16 v[46:47], v24 offset:3072
    s_waitcnt lgkmcnt(11)
    v_mfma_f32_32x32x16_bf16 v[136:151], v[52:55], v[240:243], v[136:151]
    v_cvt_pk_bf16_f32 v105, v106, v107
    ds_read_b64_tr_b16 v[48:49], v25 offset:1024
    ds_read_b64_tr_b16 v[50:51], v25 offset:3072
    s_waitcnt lgkmcnt(11)
    v_mfma_f32_32x32x16_bf16 v[120:135], v[28:31], v[244:247], v[120:135]
    v_cvt_pk_bf16_f32 v106, v108, v109
    ds_read_b64_tr_b16 v[52:53], v24 offset:4096
    ds_read_b64_tr_b16 v[54:55], v24 offset:6144
    s_waitcnt lgkmcnt(11)
    v_mfma_f32_32x32x16_bf16 v[136:151], v[32:35], v[244:247], v[136:151]
    v_cvt_pk_bf16_f32 v107, v110, v111
    ds_read_b64_tr_b16 v[28:29], v25 offset:4096
    ds_read_b64_tr_b16 v[30:31], v25 offset:6144
    s_waitcnt lgkmcnt(11)
    v_mfma_f32_32x32x16_bf16 v[120:135], v[36:39], v[152:155], v[120:135]
    ds_write_b128 v0, v[104:107] offset:8192
    ds_read_b64_tr_b16 v[32:33], v24 offset:5120
    ds_read_b64_tr_b16 v[34:35], v24 offset:7168
    s_waitcnt lgkmcnt(11)
    v_mfma_f32_32x32x16_bf16 v[136:151], v[40:43], v[152:155], v[136:151]
    v_cvt_pk_bf16_f32 v108, v112, v113
    ds_read_b64_tr_b16 v[36:37], v25 offset:5120
    ds_read_b64_tr_b16 v[38:39], v25 offset:7168
    s_waitcnt lgkmcnt(11)
    v_mfma_f32_32x32x16_bf16 v[120:135], v[44:47], v[156:159], v[120:135]
    v_cvt_pk_bf16_f32 v109, v114, v115
    ds_read_b64_tr_b16 v[40:41], v24 offset:8192
    ds_read_b64_tr_b16 v[42:43], v24 offset:10240
    s_waitcnt lgkmcnt(11)
    v_mfma_f32_32x32x16_bf16 v[136:151], v[48:51], v[156:159], v[136:151]
    v_cvt_pk_bf16_f32 v110, v116, v117
    ds_read_b64_tr_b16 v[44:45], v25 offset:8192
    ds_read_b64_tr_b16 v[46:47], v25 offset:10240
    s_waitcnt lgkmcnt(11)
    v_mfma_f32_32x32x16_bf16 v[120:135], v[52:55], v[160:163], v[120:135]
    v_cvt_pk_bf16_f32 v111, v118, v119
    ds_read_b64_tr_b16 v[48:49], v24 offset:9216
    ds_read_b64_tr_b16 v[50:51], v24 offset:11264
    s_waitcnt lgkmcnt(11)
    v_mfma_f32_32x32x16_bf16 v[136:151], v[28:31], v[160:163], v[136:151]
    ds_write_b128 v0, v[108:111] offset:9216
    ds_read_b64_tr_b16 v[52:53], v25 offset:9216
    ds_read_b64_tr_b16 v[54:55], v25 offset:11264
    s_waitcnt lgkmcnt(11)
    v_mfma_f32_32x32x16_bf16 v[120:135], v[32:35], v[164:167], v[120:135]
    ds_read_b64_tr_b16 v[28:29], v24 offset:12288
    ds_read_b64_tr_b16 v[30:31], v24 offset:14336
    s_waitcnt lgkmcnt(11)
    v_mfma_f32_32x32x16_bf16 v[136:151], v[36:39], v[164:167], v[136:151]
    ds_read_b64_tr_b16 v[32:33], v25 offset:12288
    ds_read_b64_tr_b16 v[34:35], v25 offset:14336
    s_waitcnt lgkmcnt(11)
    v_mfma_f32_32x32x16_bf16 v[120:135], v[40:43], v[168:171], v[120:135]
    ds_read_b64_tr_b16 v[36:37], v24 offset:13312
    ds_read_b64_tr_b16 v[38:39], v24 offset:15360
    s_waitcnt lgkmcnt(11)
    v_mfma_f32_32x32x16_bf16 v[136:151], v[44:47], v[168:171], v[136:151]
    ds_read_b64_tr_b16 v[40:41], v25 offset:13312
    ds_read_b64_tr_b16 v[42:43], v25 offset:15360
    s_waitcnt lgkmcnt(11)
    v_mfma_f32_32x32x16_bf16 v[120:135], v[48:51], v[172:175], v[120:135]
    ds_read_b64_tr_b16 v[44:45], v24 offset:16384
    ds_read_b64_tr_b16 v[46:47], v24 offset:18432
    s_waitcnt lgkmcnt(10)
    v_mfma_f32_32x32x16_bf16 v[136:151], v[52:55], v[172:175], v[136:151]
    ds_read_b64_tr_b16 v[48:49], v25 offset:16384
    ds_read_b64_tr_b16 v[50:51], v25 offset:18432
    s_waitcnt lgkmcnt(10)
    v_mfma_f32_32x32x16_bf16 v[120:135], v[28:31], v[176:179], v[120:135]
    ds_read_b64_tr_b16 v[52:53], v24 offset:17408
    ds_read_b64_tr_b16 v[54:55], v24 offset:19456
    s_waitcnt lgkmcnt(10)
    v_mfma_f32_32x32x16_bf16 v[136:151], v[32:35], v[176:179], v[136:151]
    ds_read_b64_tr_b16 v[28:29], v25 offset:17408
    ds_read_b64_tr_b16 v[30:31], v25 offset:19456
    s_waitcnt lgkmcnt(10)
    v_mfma_f32_32x32x16_bf16 v[120:135], v[36:39], v[180:183], v[120:135]
    ds_read_b64_tr_b16 v[32:33], v24 offset:20480
    ds_read_b64_tr_b16 v[34:35], v24 offset:22528
    s_waitcnt lgkmcnt(10)
    v_mfma_f32_32x32x16_bf16 v[136:151], v[40:43], v[180:183], v[136:151]
    ds_read_b64_tr_b16 v[36:37], v25 offset:20480
    ds_read_b64_tr_b16 v[38:39], v25 offset:22528
    s_waitcnt lgkmcnt(10)
    v_mfma_f32_32x32x16_bf16 v[120:135], v[44:47], v[184:187], v[120:135]
    ds_read_b64_tr_b16 v[40:41], v24 offset:21504
    ds_read_b64_tr_b16 v[42:43], v24 offset:23552
    s_waitcnt lgkmcnt(10)
    v_mfma_f32_32x32x16_bf16 v[136:151], v[48:51], v[184:187], v[136:151]
    ds_read_b64_tr_b16 v[44:45], v25 offset:21504
    ds_read_b64_tr_b16 v[46:47], v25 offset:23552
    s_waitcnt lgkmcnt(10)
    v_mfma_f32_32x32x16_bf16 v[120:135], v[52:55], v[188:191], v[120:135]
    ds_read_b64_tr_b16 v[48:49], v24 offset:24576
    ds_read_b64_tr_b16 v[50:51], v24 offset:26624
    s_waitcnt lgkmcnt(10)
    v_mfma_f32_32x32x16_bf16 v[136:151], v[28:31], v[188:191], v[136:151]
    ds_read_b64_tr_b16 v[52:53], v25 offset:24576
    ds_read_b64_tr_b16 v[54:55], v25 offset:26624
    s_waitcnt lgkmcnt(10)
    v_mfma_f32_32x32x16_bf16 v[120:135], v[32:35], v[192:195], v[120:135]
    ds_read_b64_tr_b16 v[28:29], v24 offset:25600
    ds_read_b64_tr_b16 v[30:31], v24 offset:27648
    s_waitcnt lgkmcnt(10)
    v_mfma_f32_32x32x16_bf16 v[136:151], v[36:39], v[192:195], v[136:151]
    ds_read_b64_tr_b16 v[32:33], v25 offset:25600
    ds_read_b64_tr_b16 v[34:35], v25 offset:27648
    s_waitcnt lgkmcnt(10)
    v_mfma_f32_32x32x16_bf16 v[120:135], v[40:43], v[196:199], v[120:135]
    ds_read_b64_tr_b16 v[36:37], v24 offset:28672
    ds_read_b64_tr_b16 v[38:39], v24 offset:30720
    s_waitcnt lgkmcnt(10)
    v_mfma_f32_32x32x16_bf16 v[136:151], v[44:47], v[196:199], v[136:151]
    ds_read_b64_tr_b16 v[40:41], v25 offset:28672
    ds_read_b64_tr_b16 v[42:43], v25 offset:30720
    s_waitcnt lgkmcnt(10)
    v_mfma_f32_32x32x16_bf16 v[120:135], v[48:51], v[200:203], v[120:135]
    ds_read_b64_tr_b16 v[44:45], v25 offset:29696
    ds_read_b64_tr_b16 v[46:47], v25 offset:31744
    s_waitcnt lgkmcnt(10)
    v_mfma_f32_32x32x16_bf16 v[136:151], v[52:55], v[200:203], v[136:151]
    ds_read_b64_tr_b16 v[48:49], v24 offset:29696
    ds_read_b64_tr_b16 v[50:51], v24 offset:31744
    s_waitcnt lgkmcnt(10)
    v_mfma_f32_32x32x16_bf16 v[120:135], v[28:31], v[204:207], v[120:135]
    s_waitcnt lgkmcnt(8)
    v_mfma_f32_32x32x16_bf16 v[136:151], v[32:35], v[204:207], v[136:151]
    s_waitcnt lgkmcnt(6)
    v_mfma_f32_32x32x16_bf16 v[120:135], v[36:39], v[208:211], v[120:135]
    s_waitcnt lgkmcnt(4)
    v_mfma_f32_32x32x16_bf16 v[136:151], v[40:43], v[208:211], v[136:151]
    s_waitcnt lgkmcnt(2)
    v_mfma_f32_32x32x16_bf16 v[136:151], v[44:47], v[212:215], v[136:151]
    s_waitcnt lgkmcnt(0)
    v_mfma_f32_32x32x16_bf16 v[120:135], v[48:51], v[212:215], v[120:135]
    s_lshl_b32 s96, s77, 11
    s_add_u32 s14, s96, 151552
    v_add_u32 v0, s14, v2
    v_bfe_u32 v4, v1, 2, 2
    v_lshlrev_b32 v4, 6, v4
    v_bfe_u32 v9, v1, 4, 1
    v_lshl_add_u32 v4, v9, 5, v4
    v_and_b32 v9, 3, v1
    v_lshl_add_u32 v4, v9, 3, v4
    v_lshrrev_b32 v9, 5, v1
    v_lshl_add_u32 v4, v9, 8, v4
    v_add_u32 v4, 159744, v4
    ds_read_b64_tr_b16 v[176:177], v4
    ds_read_b64_tr_b16 v[178:179], v4 offset:512
    ds_read_b64_tr_b16 v[180:181], v4 offset:1024
    ds_read_b64_tr_b16 v[182:183], v4 offset:1536
    v_cvt_pk_bf16_f32 v152, v136, v137
    v_cvt_pk_bf16_f32 v153, v138, v139
    v_cvt_pk_bf16_f32 v154, v140, v141
    v_cvt_pk_bf16_f32 v155, v142, v143
    v_cvt_pk_bf16_f32 v156, v144, v145
    v_cvt_pk_bf16_f32 v157, v146, v147
    v_cvt_pk_bf16_f32 v158, v148, v149
    v_cvt_pk_bf16_f32 v159, v150, v151
    ds_write_b128 v0, v[152:155]
    ds_write_b128 v0, v[156:159] offset:1024
    v_cvt_pk_bf16_f32 v168, v120, v121
    v_cvt_pk_bf16_f32 v169, v122, v123
    v_cvt_pk_bf16_f32 v170, v124, v125
    v_cvt_pk_bf16_f32 v171, v126, v127
    v_cvt_pk_bf16_f32 v172, v128, v129
    v_cvt_pk_bf16_f32 v173, v130, v131
    v_cvt_pk_bf16_f32 v174, v132, v133
    v_cvt_pk_bf16_f32 v175, v134, v135
    s_setprio 0
    s_branch L_JOIN
L_HELP:
    s_waitcnt vmcnt(3)
    s_barrier
    s_add_u32 s96, s84, 5
    s_and_b32 s97, s96, 15
    s_mul_i32 s98, s97, 393216
    s_add_u32 s99, s98, s85
    s_add_u32 s82, s99, 4294772736
    s_add_u32 m0, s83, 36864
    s_nop 0
    buffer_load_dwordx4 v3, s[40:43], s82 offen lds
    s_add_u32 s96, s84, 5
    s_and_b32 s97, s96, 15
    s_mul_i32 s98, s97, 393216
    s_add_u32 s99, s98, s85
    s_add_u32 s82, s99, 2048
    s_add_u32 m0, s83, 40960
    s_nop 0
    buffer_load_dwordx4 v3, s[40:43], s82 offen lds
    s_add_u32 s96, s84, 5
    s_and_b32 s97, s96, 15
    s_mul_i32 s98, s97, 393216
    s_add_u32 s99, s98, s85
    s_add_u32 s82, s99, 4294774784
    s_add_u32 m0, s83, 86016
    s_nop 0
    buffer_load_dwordx4 v3, s[40:43], s82 offen lds
    s_add_u32 s96, s84, 5
    s_and_b32 s97, s96, 15
    s_mul_i32 s98, s97, 393216
    s_add_u32 s99, s98, s85
    s_add_u32 s82, s99, 4096
    s_add_u32 m0, s83, 90112
    s_nop 0
    buffer_load_dwordx4 v3, s[40:43], s82 offen lds
    s_add_u32 s96, s84, 5
    s_and_b32 s97, s96, 15
    s_mul_i32 s98, s97, 393216
    s_add_u32 s99, s98, s85
    s_add_u32 s82, s99, 4294770688
    s_add_u32 m0, s83, 135168
    s_nop 0
    buffer_load_dwordx4 v3, s[40:43], s82 offen lds
    s_add_u32 s96, s84, 5
    s_and_b32 s97, s96, 15
    s_mul_i32 s98, s97, 393216
    s_add_u32 s82, s98, s85
    s_add_u32 m0, s83, 139264
    s_nop 0
    buffer_load_dwordx4 v3, s[40:43], s82 offen lds
    v_bfe_u32 v4, v1, 2, 2
    v_lshlrev_b32 v4, 6, v4
    v_bfe_u32 v9, v1, 4, 1
    v_lshl_add_u32 v4, v9, 5, v4
    v_and_b32 v9, 3, v1
    v_lshl_add_u32 v4, v9, 3, v4
    v_lshrrev_b32 v9, 5, v1
    v_lshl_add_u32 v4, v9, 8, v4
    v_add_u32 v4, 159744, v4
    ds_read_b64_tr_b16 v[168:169], v4
    ds_read_b64_tr_b16 v[170:171], v4 offset:512
    ds_read_b64_tr_b16 v[172:173], v4 offset:1024
    ds_read_b64_tr_b16 v[174:175], v4 offset:1536
    ds_read_b64_tr_b16 v[176:177], v4 offset:2048
    ds_read_b64_tr_b16 v[178:179], v4 offset:2560
    ds_read_b64_tr_b16 v[180:181], v4 offset:3072
    ds_read_b64_tr_b16 v[182:183], v4 offset:3584
    s_lshl_b32 s14, s77, 10
    v_and_b32 v232, 7, v1
    v_lshl_add_u32 v232, v232, 4, s14
    v_bfe_u32 v9, v1, 3, 2
    v_lshl_add_u32 v232, v9, 8, v232
    v_lshrrev_b32 v9, 5, v1
    v_lshl_add_u32 v232, v9, 7, v232
    s_and_b32 s96, s9, 1
    s_lshl1_add_u32 s18, s96, 1
    s_and_b32 s96, s8, 3
    s_lshl2_add_u32 s97, s96, s3
    s_sub_u32 s98, s97, 4
    s_lshl_b32 s82, s98, 7
    v_lshrrev_b32 v52, 3, v1
    v_lshl_add_u32 v52, v52, 1, s82
    global_load_ushort v72, v52, s[86:87] offset:0
    global_load_ushort v73, v52, s[86:87] offset:16
    global_load_ushort v74, v52, s[86:87] offset:32
    global_load_ushort v75, v52, s[86:87] offset:48
    global_load_ushort v76, v52, s[86:87] offset:64
    global_load_ushort v77, v52, s[86:87] offset:80
    global_load_ushort v78, v52, s[86:87] offset:96
    global_load_ushort v79, v52, s[86:87] offset:112
    s_and_b32 s96, s8, 3
    s_lshl2_add_u32 s97, s96, s3
    s_sub_u32 s98, s97, 4
    s_mul_i32 s99, s98, 786432
    s_lshr_b32 s96, s8, 2
    s_lshl1_add_u32 s97, s9, s96
    s_lshl_b32 s98, s97, 7
    s_add_u32 s96, s99, s98
    s_add_u32 s19, s96, 4096
    s_barrier
    s_add_u32 s96, s84, 6
    s_and_b32 s97, s96, 15
    s_mul_i32 s98, s97, 393216
    s_add_u32 s99, s98, s85
    s_add_u32 s82, s99, 4294772736
    s_add_u32 m0, s83, 4294963200
    s_nop 0
    buffer_load_dwordx4 v3, s[40:43], s82 offen lds
    s_add_u32 s96, s84, 6
    s_and_b32 s97, s96, 15
    s_mul_i32 s98, s97, 393216
    s_add_u32 s99, s98, s85
    s_add_u32 s82, s99, 2048
    s_mov_b32 m0, s83
    s_nop 0
    buffer_load_dwordx4 v3, s[40:43], s82 offen lds
    s_add_u32 s96, s84, 6
    s_and_b32 s97, s96, 15
    s_mul_i32 s98, s97, 393216
    s_add_u32 s99, s98, s85
    s_add_u32 s82, s99, 4294770688
    s_add_u32 m0, s83, 94208
    s_nop 0
    buffer_load_dwordx4 v3, s[40:43], s82 offen lds
    s_add_u32 s96, s84, 6
    s_and_b32 s97, s96, 15
    s_mul_i32 s98, s97, 393216
    s_add_u32 s82, s98, s85
    s_add_u32 m0, s83, 98304
    s_nop 0
    buffer_load_dwordx4 v3, s[40:43], s82 offen lds
    s_add_u32 s96, s84, 6
    s_and_b32 s97, s96, 15
    s_mul_i32 s98, s97, 393216
    s_add_u32 s99, s98, s85
    s_add_u32 s82, s99, 4294774784
    s_add_u32 m0, s83, 45056
    s_nop 0
    buffer_load_dwordx4 v3, s[40:43], s82 offen lds
    s_add_u32 s96, s84, 6
    s_and_b32 s97, s96, 15
    s_mul_i32 s98, s97, 393216
    s_add_u32 s99, s98, s85
    s_add_u32 s82, s99, 4096
    s_add_u32 m0, s83, 49152
    s_nop 0
    buffer_load_dwordx4 v3, s[40:43], s82 offen lds
    s_waitcnt lgkmcnt(0)
    s_load_dword s24, s[32:33], s92 offset:512 glc
    s_load_dword s25, s[32:33], s92 offset:256 glc
    s_load_dword s26, s[32:33], s92 offset:3584 glc
    s_load_dword s27, s[32:33], s92 offset:3328 glc
    s_barrier
    s_add_u32 s96, s84, 7
    s_and_b32 s97, s96, 15
    s_mul_i32 s98, s97, 393216
    s_add_u32 s99, s98, s85
    s_add_u32 s82, s99, 4294772736
    s_add_u32 m0, s83, 4096
    s_nop 0
    buffer_load_dwordx4 v3, s[40:43], s82 offen lds
    s_add_u32 s96, s84, 7
    s_and_b32 s97, s96, 15
    s_mul_i32 s98, s97, 393216
    s_add_u32 s99, s98, s85
    s_add_u32 s82, s99, 2048
    s_add_u32 m0, s83, 8192
    s_nop 0
    buffer_load_dwordx4 v3, s[40:43], s82 offen lds
    s_add_u32 s96, s84, 7
    s_and_b32 s97, s96, 15
    s_mul_i32 s98, s97, 393216
    s_add_u32 s99, s98, s85
    s_add_u32 s82, s99, 4294770688
    s_add_u32 m0, s83, 102400
    s_nop 0
    buffer_load_dwordx4 v3, s[40:43], s82 offen lds
    s_add_u32 s96, s84, 7
    s_and_b32 s97, s96, 15
    s_mul_i32 s98, s97, 393216
    s_add_u32 s82, s98, s85
    s_add_u32 m0, s83, 106496
    s_nop 0
    buffer_load_dwordx4 v3, s[40:43], s82 offen lds
    s_add_u32 s96, s84, 7
    s_and_b32 s97, s96, 15
    s_mul_i32 s98, s97, 393216
    s_add_u32 s99, s98, s85
    s_add_u32 s82, s99, 4294774784
    s_add_u32 m0, s83, 53248
    s_nop 0
    buffer_load_dwordx4 v3, s[40:43], s82 offen lds
    s_add_u32 s96, s84, 7
    s_and_b32 s97, s96, 15
    s_mul_i32 s98, s97, 393216
    s_add_u32 s99, s98, s85
    s_add_u32 s82, s99, 4096
    s_add_u32 m0, s83, 57344
    s_nop 0
    buffer_load_dwordx4 v3, s[40:43], s82 offen lds
    s_waitcnt vmcnt(26)
    s_barrier
    s_add_u32 s96, s84, 8
    s_and_b32 s97, s96, 15
    s_mul_i32 s98, s97, 393216
    s_add_u32 s99, s98, s85
    s_add_u32 s82, s99, 4294772736
    s_add_u32 m0, s83, 12288
    s_nop 0
    buffer_load_dwordx4 v3, s[40:43], s82 offen lds
    s_add_u32 s96, s84, 8
    s_and_b32 s97, s96, 15
    s_mul_i32 s98, s97, 393216
    s_add_u32 s99, s98, s85
    s_add_u32 s82, s99, 2048
    s_add_u32 m0, s83, 16384
    s_nop 0
    buffer_load_dwordx4 v3, s[40:43], s82 offen lds
    s_add_u32 s96, s84, 8
    s_and_b32 s97, s96, 15
    s_mul_i32 s98, s97, 393216
    s_add_u32 s99, s98, s85
    s_add_u32 s82, s99, 4294770688
    s_add_u32 m0, s83, 110592
    s_nop 0
    buffer_load_dwordx4 v3, s[40:43], s82 offen lds
    s_add_u32 s96, s84, 8
    s_and_b32 s97, s96, 15
    s_mul_i32 s98, s97, 393216
    s_add_u32 s82, s98, s85
    s_add_u32 m0, s83, 114688
    s_nop 0
    buffer_load_dwordx4 v3, s[40:43], s82 offen lds
    s_add_u32 s96, s84, 8
    s_and_b32 s97, s96, 15
    s_mul_i32 s98, s97, 393216
    s_add_u32 s99, s98, s85
    s_add_u32 s82, s99, 4294774784
    s_add_u32 m0, s83, 61440
    s_nop 0
    buffer_load_dwordx4 v3, s[40:43], s82 offen lds
    s_add_u32 s96, s84, 8
    s_and_b32 s97, s96, 15
    s_mul_i32 s98, s97, 393216
    s_add_u32 s99, s98, s85
    s_add_u32 s82, s99, 4096
    s_add_u32 m0, s83, 65536
    s_nop 0
    buffer_load_dwordx4 v3, s[40:43], s82 offen lds
    s_waitcnt vmcnt(18)
    v_lshlrev_b32 v72, 16, v72
    v_mul_f32 v52, s7, v72
    v_exp_f32 v52, -v52
    s_nop 0
    v_add_f32 v52, 1.0, v52
    v_rcp_f32 v52, v52
    s_nop 0
    v_mul_f32 v72, v72, v52
    v_cvt_pk_bf16_f32 v72, 0, v72
    v_lshlrev_b32 v73, 16, v73
    v_mul_f32 v53, s7, v73
    v_exp_f32 v53, -v53
    s_nop 0
    v_add_f32 v53, 1.0, v53
    v_rcp_f32 v53, v53
    s_nop 0
    v_mul_f32 v73, v73, v53
    v_cvt_pk_bf16_f32 v73, 0, v73
    v_lshlrev_b32 v74, 16, v74
    v_mul_f32 v52, s7, v74
    v_exp_f32 v52, -v52
    s_nop 0
    v_add_f32 v52, 1.0, v52
    v_rcp_f32 v52, v52
    s_nop 0
    v_mul_f32 v74, v74, v52
    v_cvt_pk_bf16_f32 v74, 0, v74
    v_lshlrev_b32 v75, 16, v75
    v_mul_f32 v53, s7, v75
    v_exp_f32 v53, -v53
    s_nop 0
    v_add_f32 v53, 1.0, v53
    v_rcp_f32 v53, v53
    s_nop 0
    v_mul_f32 v75, v75, v53
    v_cvt_pk_bf16_f32 v75, 0, v75
    v_lshlrev_b32 v76, 16, v76
    v_mul_f32 v52, s7, v76
    v_exp_f32 v52, -v52
    s_nop 0
    v_add_f32 v52, 1.0, v52
    v_rcp_f32 v52, v52
    s_nop 0
    v_mul_f32 v76, v76, v52
    v_cvt_pk_bf16_f32 v76, 0, v76
    v_lshlrev_b32 v77, 16, v77
    v_mul_f32 v53, s7, v77
    v_exp_f32 v53, -v53
    s_nop 0
    v_add_f32 v53, 1.0, v53
    v_rcp_f32 v53, v53
    s_nop 0
    v_mul_f32 v77, v77, v53
    v_cvt_pk_bf16_f32 v77, 0, v77
    v_lshlrev_b32 v78, 16, v78
    v_mul_f32 v52, s7, v78
    v_exp_f32 v52, -v52
    s_nop 0
    v_add_f32 v52, 1.0, v52
    v_rcp_f32 v52, v52
    s_nop 0
    v_mul_f32 v78, v78, v52
    v_cvt_pk_bf16_f32 v78, 0, v78
    v_lshlrev_b32 v79, 16, v79
    v_mul_f32 v53, s7, v79
    v_exp_f32 v53, -v53
    s_nop 0
    v_add_f32 v53, 1.0, v53
    v_rcp_f32 v53, v53
    s_nop 0
    v_mul_f32 v79, v79, v53
    v_cvt_pk_bf16_f32 v79, 0, v79
    s_waitcnt lgkmcnt(0)
    s_load_dword s24, s[32:33], s92 offset:1024 glc
    s_load_dword s25, s[32:33], s92 offset:768 glc
    s_load_dword s26, s[32:33], s92 offset:1536 glc
    s_load_dword s27, s[32:33], s92 offset:1280 glc
    s_barrier
    s_add_u32 s96, s84, 9
    s_and_b32 s97, s96, 15
    s_mul_i32 s98, s97, 393216
    s_add_u32 s99, s98, s85
    s_add_u32 s82, s99, 4294772736
    s_add_u32 m0, s83, 20480
    s_nop 0
    buffer_load_dwordx4 v3, s[40:43], s82 offen lds
    s_add_u32 s96, s84, 9
    s_and_b32 s97, s96, 15
    s_mul_i32 s98, s97, 393216
    s_add_u32 s99, s98, s85
    s_add_u32 s82, s99, 2048
    s_add_u32 m0, s83, 24576
    s_nop 0
    buffer_load_dwordx4 v3, s[40:43], s82 offen lds
    s_add_u32 s96, s84, 9
    s_and_b32 s97, s96, 15
    s_mul_i32 s98, s97, 393216
    s_add_u32 s99, s98, s85
    s_add_u32 s82, s99, 4294770688
    s_add_u32 m0, s83, 118784
    s_nop 0
    buffer_load_dwordx4 v3, s[40:43], s82 offen lds
    s_add_u32 s96, s84, 9
    s_and_b32 s97, s96, 15
    s_mul_i32 s98, s97, 393216
    s_add_u32 s82, s98, s85
    s_add_u32 m0, s83, 122880
    s_nop 0
    buffer_load_dwordx4 v3, s[40:43], s82 offen lds
    s_add_u32 s96, s84, 9
    s_and_b32 s97, s96, 15
    s_mul_i32 s98, s97, 393216
    s_add_u32 s99, s98, s85
    s_add_u32 s82, s99, 4294774784
    s_add_u32 m0, s83, 69632
    s_nop 0
    buffer_load_dwordx4 v3, s[40:43], s82 offen lds
    s_add_u32 s96, s84, 9
    s_and_b32 s97, s96, 15
    s_mul_i32 s98, s97, 393216
    s_add_u32 s99, s98, s85
    s_add_u32 s82, s99, 4096
    s_add_u32 m0, s83, 73728
    s_nop 0
    buffer_load_dwordx4 v3, s[40:43], s82 offen lds
    s_waitcnt vmcnt(22)
    s_waitcnt vmcnt(20)
    s_waitcnt vmcnt(18)
    s_barrier
    s_add_u32 s96, s84, 10
    s_and_b32 s97, s96, 15
    s_mul_i32 s98, s97, 393216
    s_add_u32 s99, s98, s85
    s_add_u32 s82, s99, 4294772736
    s_add_u32 m0, s83, 28672
    s_nop 0
    buffer_load_dwordx4 v3, s[40:43], s82 offen lds
    s_add_u32 s96, s84, 10
    s_and_b32 s97, s96, 15
    s_mul_i32 s98, s97, 393216
    s_add_u32 s99, s98, s85
    s_add_u32 s82, s99, 2048
    s_add_u32 m0, s83, 32768
    s_nop 0
    buffer_load_dwordx4 v3, s[40:43], s82 offen lds
    s_add_u32 s96, s84, 10
    s_and_b32 s97, s96, 15
    s_mul_i32 s98, s97, 393216
    s_add_u32 s99, s98, s85
    s_add_u32 s82, s99, 4294774784
    s_add_u32 m0, s83, 77824
    s_nop 0
    buffer_load_dwordx4 v3, s[40:43], s82 offen lds
    s_add_u32 s96, s84, 10
    s_and_b32 s97, s96, 15
    s_mul_i32 s98, s97, 393216
    s_add_u32 s99, s98, s85
    s_add_u32 s82, s99, 4096
    s_add_u32 m0, s83, 81920
    s_nop 0
    buffer_load_dwordx4 v3, s[40:43], s82 offen lds
    s_waitcnt lgkmcnt(0)
    s_load_dword s24, s[32:33], s92 offset:2560 glc
    s_load_dword s25, s[32:33], s92 offset:2304 glc
    s_load_dword s26, s[32:33], s92 offset:3072 glc
    s_load_dword s27, s[32:33], s92 offset:2816 glc
    s_waitcnt vmcnt(20)
    s_waitcnt vmcnt(18)
    s_waitcnt vmcnt(16)
    s_barrier
    s_add_u32 s96, s84, 11
    s_and_b32 s97, s96, 15
    s_mul_i32 s98, s97, 393216
    s_add_u32 s99, s98, s85
    s_add_u32 s82, s99, 4294772736
L_PAD5:
    s_cbranch_execz L_RET5
    s_add_u32 m0, s83, 36864
    s_nop 0
    buffer_load_dwordx4 v3, s[40:43], s82 offen lds
    s_add_u32 s96, s84, 11
    s_and_b32 s97, s96, 15
    s_mul_i32 s98, s97, 393216
    s_add_u32 s99, s98, s85
    s_add_u32 s82, s99, 2048
    s_add_u32 m0, s83, 40960
    s_nop 0
    buffer_load_dwordx4 v3, s[40:43], s82 offen lds
    s_add_u32 s96, s84, 11
    s_and_b32 s97, s96, 15
    s_mul_i32 s98, s97, 393216
    s_add_u32 s99, s98, s85
    s_add_u32 s82, s99, 4294774784
    s_add_u32 m0, s83, 86016
    s_nop 0
    buffer_load_dwordx4 v3, s[40:43], s82 offen lds
    s_add_u32 s96, s84, 11
    s_and_b32 s97, s96, 15
    s_mul_i32 s98, s97, 393216
    s_add_u32 s99, s98, s85
    s_add_u32 s82, s99, 4096
    s_add_u32 m0, s83, 90112
    s_nop 0
    buffer_load_dwordx4 v3, s[40:43], s82 offen lds
    s_waitcnt vmcnt(18)
    s_waitcnt vmcnt(16)
    s_waitcnt vmcnt(14)
    s_barrier
    s_add_u32 s96, s84, 12
    s_and_b32 s97, s96, 15
    s_mul_i32 s98, s97, 393216
    s_add_u32 s99, s98, s85
    s_add_u32 s82, s99, 4294772736
    s_add_u32 m0, s83, 4294963200
    s_nop 0
    buffer_load_dwordx4 v3, s[40:43], s82 offen lds
    s_add_u32 s96, s84, 12
    s_and_b32 s97, s96, 15
    s_mul_i32 s98, s97, 393216
    s_add_u32 s99, s98, s85
    s_add_u32 s82, s99, 2048
    s_mov_b32 m0, s83
    s_nop 0
    buffer_load_dwordx4 v3, s[40:43], s82 offen lds
    s_add_u32 s96, s84, 12
    s_and_b32 s97, s96, 15
    s_mul_i32 s98, s97, 393216
    s_add_u32 s99, s98, s85
    s_add_u32 s82, s99, 4294774784
    s_add_u32 m0, s83, 45056
    s_nop 0
    buffer_load_dwordx4 v3, s[40:43], s82 offen lds
    s_add_u32 s96, s84, 12
    s_and_b32 s97, s96, 15
    s_mul_i32 s98, s97, 393216
    s_add_u32 s99, s98, s85
    s_add_u32 s82, s99, 4096
    s_add_u32 m0, s83, 49152
    s_nop 0
    buffer_load_dwordx4 v3, s[40:43], s82 offen lds
    s_waitcnt vmcnt(16)
    s_barrier
    s_add_u32 s96, s84, 13
    s_and_b32 s97, s96, 15
    s_mul_i32 s98, s97, 393216
    s_add_u32 s99, s98, s85
    s_add_u32 s82, s99, 4294772736
    s_add_u32 m0, s83, 4096
    s_nop 0
    buffer_load_dwordx4 v3, s[40:43], s82 offen lds
    s_add_u32 s96, s84, 13
    s_and_b32 s97, s96, 15
    s_mul_i32 s98, s97, 393216
    s_add_u32 s99, s98, s85
    s_add_u32 s82, s99, 2048
    s_add_u32 m0, s83, 8192
    s_nop 0
    buffer_load_dwordx4 v3, s[40:43], s82 offen lds
    s_add_u32 s96, s84, 13
    s_and_b32 s97, s96, 15
    s_mul_i32 s98, s97, 393216
    s_add_u32 s99, s98, s85
    s_add_u32 s82, s99, 4294774784
    s_add_u32 m0, s83, 53248
    s_nop 0
    buffer_load_dwordx4 v3, s[40:43], s82 offen lds
    s_add_u32 s96, s84, 13
    s_and_b32 s97, s96, 15
    s_mul_i32 s98, s97, 393216
    s_add_u32 s99, s98, s85
    s_add_u32 s82, s99, 4096
    s_add_u32 m0, s83, 57344
    s_nop 0
    buffer_load_dwordx4 v3, s[40:43], s82 offen lds
    s_lshl_b32 s96, s74, 13
    s_sub_u32 s97, s3, 4
    s_lshl_b32 s98, s97, 8
    s_add_u32 s99, s96, s98
    s_add_u32 s13, s99, 20971520
    s_waitcnt lgkmcnt(0)
    s_load_dword s24, s[32:33], s13 offset:1276 glc
    s_load_dword s25, s[32:33], s13 offset:3324 glc
    s_load_dword s26, s[32:33], s13 offset:5372 glc
    s_load_dword s27, s[32:33], s13 offset:7420 glc
    s_waitcnt vmcnt(18)
    s_waitcnt vmcnt(16)
    s_barrier
    s_add_u32 s96, s84, 14
    s_and_b32 s97, s96, 15
    s_mul_i32 s98, s97, 393216
    s_add_u32 s99, s98, s85
    s_add_u32 s82, s99, 4294772736
    s_add_u32 m0, s83, 12288
    s_nop 0
    buffer_load_dwordx4 v3, s[40:43], s82 offen lds
    s_add_u32 s96, s84, 14
    s_and_b32 s97, s96, 15
    s_mul_i32 s98, s97, 393216
    s_add_u32 s99, s98, s85
    s_add_u32 s82, s99, 2048
    s_add_u32 m0, s83, 16384
    s_nop 0
    buffer_load_dwordx4 v3, s[40:43], s82 offen lds
    s_add_u32 s96, s84, 10
    s_and_b32 s97, s96, 15
    s_mul_i32 s98, s97, 393216
    s_add_u32 s99, s98, s85
    s_add_u32 s82, s99, 4294770688
    s_add_u32 m0, s83, 126976
    s_nop 0
    buffer_load_dwordx4 v3, s[40:43], s82 offen lds
    s_add_u32 s96, s84, 10
    s_and_b32 s97, s96, 15
    s_mul_i32 s98, s97, 393216
    s_add_u32 s82, s98, s85
    s_add_u32 m0, s83, 131072
    s_nop 0
    buffer_load_dwordx4 v3, s[40:43], s82 offen lds
    s_waitcnt vmcnt(18)
    s_waitcnt vmcnt(14)
    s_barrier
    s_add_u32 s96, s84, 15
    s_and_b32 s97, s96, 15
    s_mul_i32 s98, s97, 393216
    s_add_u32 s99, s98, s85
    s_add_u32 s82, s99, 4294772736
    s_add_u32 m0, s83, 20480
    s_nop 0
    buffer_load_dwordx4 v3, s[40:43], s82 offen lds
    s_add_u32 s96, s84, 15
    s_and_b32 s97, s96, 15
    s_mul_i32 s98, s97, 393216
    s_add_u32 s99, s98, s85
    s_add_u32 s82, s99, 2048
    s_add_u32 m0, s83, 24576
    s_nop 0
    buffer_load_dwordx4 v3, s[40:43], s82 offen lds
    s_add_u32 s96, s84, 11
    s_and_b32 s97, s96, 15
    s_mul_i32 s98, s97, 393216
    s_add_u32 s99, s98, s85
    s_add_u32 s82, s99, 4294770688
    s_add_u32 m0, s83, 135168
    s_nop 0
    buffer_load_dwordx4 v3, s[40:43], s82 offen lds
    s_add_u32 s96, s84, 11
    s_and_b32 s97, s96, 15
    s_mul_i32 s98, s97, 393216
    s_add_u32 s82, s98, s85
    s_add_u32 m0, s83, 139264
    s_nop 0
    buffer_load_dwordx4 v3, s[40:43], s82 offen lds
    s_waitcnt vmcnt(14)
    s_waitcnt vmcnt(10)
    s_waitcnt vmcnt(6)
    s_barrier
    s_add_u32 s96, s84, 14
    s_and_b32 s97, s96, 15
    s_mul_i32 s98, s97, 393216
    s_add_u32 s99, s98, s85
    s_add_u32 s82, s99, 4294774784
    s_add_u32 m0, s83, 61440
    s_nop 0
    buffer_load_dwordx4 v3, s[40:43], s82 offen lds
    s_add_u32 s96, s84, 14
    s_and_b32 s97, s96, 15
    s_mul_i32 s98, s97, 393216
    s_add_u32 s99, s98, s85
    s_add_u32 s82, s99, 4096
    s_add_u32 m0, s83, 65536
    s_nop 0
    buffer_load_dwordx4 v3, s[40:43], s82 offen lds
    s_add_u32 s96, s84, 15
    s_and_b32 s97, s96, 15
    s_mul_i32 s98, s97, 393216
    s_add_u32 s99, s98, s85
    s_add_u32 s82, s99, 4294774784
    s_add_u32 m0, s83, 69632
    s_nop 0
    buffer_load_dwordx4 v3, s[40:43], s82 offen lds
    s_add_u32 s96, s84, 15
    s_and_b32 s97, s96, 15
    s_mul_i32 s98, s97, 393216
    s_add_u32 s99, s98, s85
    s_add_u32 s82, s99, 4096
    s_add_u32 m0, s83, 73728
    s_nop 0
    buffer_load_dwordx4 v3, s[40:43], s82 offen lds
    s_add_u32 s96, s84, 12
    s_and_b32 s97, s96, 15
    s_mul_i32 s98, s97, 393216
    s_add_u32 s99, s98, s85
    s_add_u32 s82, s99, 4294770688
    s_add_u32 m0, s83, 94208
    s_nop 0
    buffer_load_dwordx4 v3, s[40:43], s82 offen lds
    s_add_u32 s96, s84, 12
    s_and_b32 s97, s96, 15
    s_mul_i32 s98, s97, 393216
    s_add_u32 s82, s98, s85
    s_add_u32 m0, s83, 98304
    s_nop 0
    buffer_load_dwordx4 v3, s[40:43], s82 offen lds
    s_waitcnt vmcnt(8)
    s_barrier
    s_add_u32 s96, s84, 13
    s_and_b32 s97, s96, 15
    s_mul_i32 s98, s97, 393216
    s_add_u32 s99, s98, s85
    s_add_u32 s82, s99, 4294770688
    s_add_u32 m0, s83, 102400
    s_nop 0
    buffer_load_dwordx4 v3, s[40:43], s82 offen lds
    s_add_u32 s96, s84, 13
    s_and_b32 s97, s96, 15
    s_mul_i32 s98, s97, 393216
    s_add_u32 s82, s98, s85
    s_add_u32 m0, s83, 106496
    s_nop 0
    buffer_load_dwordx4 v3, s[40:43], s82 offen lds
    s_add_u32 s96, s84, 14
    s_and_b32 s97, s96, 15
    s_mul_i32 s98, s97, 393216
    s_add_u32 s99, s98, s85
    s_add_u32 s82, s99, 4294770688
    s_add_u32 m0, s83, 110592
    s_nop 0
    buffer_load_dwordx4 v3, s[40:43], s82 offen lds
    s_add_u32 s96, s84, 14
    s_and_b32 s97, s96, 15
    s_mul_i32 s98, s97, 393216
    s_add_u32 s82, s98, s85
    s_add_u32 m0, s83, 114688
    s_nop 0
    buffer_load_dwordx4 v3, s[40:43], s82 offen lds
    s_add_u32 s96, s84, 15
    s_and_b32 s97, s96, 15
    s_mul_i32 s98, s97, 393216
    s_add_u32 s99, s98, s85
    s_add_u32 s82, s99, 4294770688
    s_add_u32 m0, s83, 118784
    s_nop 0
    buffer_load_dwordx4 v3, s[40:43], s82 offen lds
    s_add_u32 s96, s84, 15
    s_and_b32 s97, s96, 15
    s_mul_i32 s98, s97, 393216
    s_add_u32 s82, s98, s85
    s_add_u32 m0, s83, 122880
    s_nop 0
    buffer_load_dwordx4 v3, s[40:43], s82 offen lds
    s_waitcnt lgkmcnt(0)
    s_barrier
    s_setprio 3
    ds_read_b128 v[152:155], v0
    ds_read_b128 v[156:159], v0 offset:1024
    v_subrev_u32 v0, 118784, v0
    s_waitcnt lgkmcnt(1)
    v_mfma_f32_32x32x16_bf16 v[184:199], v[168:171], v[152:155], 0
    s_waitcnt lgkmcnt(0)
    v_mfma_f32_32x32x16_bf16 v[184:199], v[172:175], v[156:159], v[184:199]
    s_setprio 0
    s_nop 10
    v_cvt_pk_bf16_f32 v184, 0, v184
    v_cvt_pk_bf16_f32 v185, 0, v185
    v_cvt_pk_bf16_f32 v186, 0, v186
    s_mov_b32 s82, s19
    buffer_load_dwordx4 v[88:91], v248, s[48:51], s82 offen nt
    v_cvt_pk_bf16_f32 v187, 0, v187
    v_cvt_pk_bf16_f32 v188, 0, v188
    v_cvt_pk_bf16_f32 v189, 0, v189
    v_cvt_pk_bf16_f32 v190, 0, v190
    v_cvt_pk_bf16_f32 v191, 0, v191
    v_cvt_pk_bf16_f32 v192, 0, v192
    v_cvt_pk_bf16_f32 v193, 0, v193
    v_cvt_pk_bf16_f32 v194, 0, v194
    v_cvt_pk_bf16_f32 v195, 0, v195
    v_cvt_pk_bf16_f32 v196, 0, v196
    s_add_u32 s82, s19, 98304
    buffer_load_dwordx4 v[92:95], v248, s[48:51], s82 offen nt
    v_cvt_pk_bf16_f32 v197, 0, v197
    v_cvt_pk_bf16_f32 v198, 0, v198
    v_cvt_pk_bf16_f32 v199, 0, v199
    v_max3_f32 v4, v184, v185, v186
    v_min3_f32 v5, v184, v185, v186
    v_max3_f32 v4, v4, v187, v188
    v_min3_f32 v5, v5, v187, v188
    v_max3_f32 v4, v4, v189, v190
    v_min3_f32 v5, v5, v189, v190
    v_max3_f32 v4, v4, v191, v192
    s_add_u32 s82, s19, 196608
    buffer_load_dwordx4 v[96:99], v248, s[48:51], s82 offen nt
    v_min3_f32 v5, v5, v191, v192
    v_max3_f32 v4, v4, v193, v194
    v_min3_f32 v5, v5, v193, v194
    v_max3_f32 v4, v4, v195, v196
    v_min3_f32 v5, v5, v195, v196
    v_max3_f32 v4, v4, v197, v198
    v_min3_f32 v5, v5, v197, v198
    v_max_f32 v6, v4, v199
    v_min_f32 v7, v5, v199
    v_max_f32 v4, v4, v199
    s_add_u32 s82, s19, 294912
    buffer_load_dwordx4 v[100:103], v248, s[48:51], s82 offen nt
    v_min_f32 v5, v5, v199
    v_permlane32_swap_b32 v4, v6
    s_nop 0
    v_permlane32_swap_b32 v5, v7
    v_max_f32 v4, v4, v6
    v_min_f32 v5, v5, v7
    v_mul_f32_e64 v4, v4, s7
    v_mul_f32_e64 v5, v5, s7
    v_fma_f32 v216, v184, s7, -v4
    v_fma_f32 v217, v185, s7, -v4
    v_fma_f32 v184, -v184, s7, v5
    s_add_u32 s82, s19, 393216
    buffer_load_dwordx4 v[104:107], v248, s[48:51], s82 offen nt
    v_fma_f32 v185, -v185, s7, v5
    v_fma_f32 v218, v186, s7, -v4
    v_fma_f32 v219, v187, s7, -v4
    v_fma_f32 v186, -v186, s7, v5
    v_fma_f32 v187, -v187, s7, v5
    s_waitcnt vmcnt(15)
    s_waitcnt vmcnt(13)
    s_barrier
    s_setprio 3
    ds_read_b128 v[152:155], v0
    ds_read_b128 v[156:159], v0 offset:1024
    s_waitcnt lgkmcnt(1)
    v_mfma_f32_32x32x16_bf16 v[200:215], v[176:179], v[152:155], 0
    s_waitcnt lgkmcnt(0)
    v_mfma_f32_32x32x16_bf16 v[200:215], v[180:183], v[156:159], v[200:215]
    s_setprio 0
    v_fma_f32 v220, v188, s7, -v4
    v_fma_f32 v221, v189, s7, -v4
    v_fma_f32 v188, -v188, s7, v5
    v_fma_f32 v189, -v189, s7, v5
    v_fma_f32 v222, v190, s7, -v4
    s_add_u32 s82, s19, 491520
    buffer_load_dwordx4 v[108:111], v248, s[48:51], s82 offen nt
    v_fma_f32 v223, v191, s7, -v4
    s_mov_b32 s82, s80
    buffer_load_dwordx4 v[56:59], v27, s[52:55], s82 offen nt
    v_fma_f32 v190, -v190, s7, v5
    v_fma_f32 v191, -v191, s7, v5
    v_fma_f32 v224, v192, s7, -v4
    v_fma_f32 v225, v193, s7, -v4
    v_fma_f32 v192, -v192, s7, v5
    v_fma_f32 v193, -v193, s7, v5
    v_fma_f32 v226, v194, s7, -v4
    v_fma_f32 v227, v195, s7, -v4
    v_fma_f32 v194, -v194, s7, v5
    s_add_u32 s82, s19, 589824
    buffer_load_dwordx4 v[112:115], v248, s[48:51], s82 offen nt
    v_fma_f32 v195, -v195, s7, v5
    v_fma_f32 v228, v196, s7, -v4
    v_fma_f32 v229, v197, s7, -v4
    v_fma_f32 v196, -v196, s7, v5
    v_fma_f32 v197, -v197, s7, v5
    v_fma_f32 v230, v198, s7, -v4
    v_fma_f32 v231, v199, s7, -v4
    v_fma_f32 v198, -v198, s7, v5
    v_fma_f32 v199, -v199, s7, v5
    v_exp_f32 v216, v216
    s_add_u32 s82, s19, 688128
    buffer_load_dwordx4 v[116:119], v248, s[48:51], s82 offen nt
    v_exp_f32 v184, v184
    s_add_u32 s82, s80, 4294049792
    buffer_load_dwordx4 v[60:63], v27, s[52:55], s82 offen nt
    v_exp_f32 v217, v217
    v_exp_f32 v185, v185
    v_exp_f32 v218, v218
    v_exp_f32 v186, v186
    v_exp_f32 v219, v219
    v_exp_f32 v187, v187
    v_exp_f32 v220, v220
    v_exp_f32 v188, v188
    v_exp_f32 v221, v221
    v_exp_f32 v189, v189
    v_exp_f32 v222, v222
    v_exp_f32 v190, v190
    v_exp_f32 v223, v223
    v_exp_f32 v191, v191
    v_exp_f32 v224, v224
    v_exp_f32 v192, v192
    v_exp_f32 v225, v225
    v_exp_f32 v193, v193
    v_exp_f32 v226, v226
    s_add_u32 s82, s80, 57344
    buffer_load_dwordx4 v[64:67], v27, s[52:55], s82 offen nt
    v_exp_f32 v194, v194
    v_exp_f32 v227, v227
    v_exp_f32 v195, v195
    v_exp_f32 v228, v228
    v_exp_f32 v196, v196
    v_exp_f32 v229, v229
    v_exp_f32 v197, v197
    v_exp_f32 v230, v230
    v_exp_f32 v198, v198
    v_exp_f32 v231, v231
    v_exp_f32 v199, v199
    v_add_f32 v8, v216, v218
    v_add_f32 v9, v217, v219
    v_add_f32 v10, v184, v186
    v_add_f32 v11, v185, v187
    v_add_f32 v8, v8, v220
    v_add_f32 v9, v9, v221
    v_add_f32 v10, v10, v188
    v_add_f32 v11, v11, v189
    v_add_f32 v8, v8, v222
    s_add_u32 s82, s80, 4294107136
    buffer_load_dwordx4 v[68:71], v27, s[52:55], s82 offen nt
    v_add_f32 v9, v9, v223
    v_add_f32 v10, v10, v190
    v_add_f32 v11, v11, v191
    v_add_f32 v8, v8, v224
    v_add_f32 v9, v9, v225
    v_add_f32 v10, v10, v192
    v_add_f32 v11, v11, v193
    v_add_f32 v8, v8, v226
    v_add_f32 v9, v9, v227
    v_add_f32 v10, v10, v194
    v_add_f32 v11, v11, v195
    v_add_f32 v8, v8, v228
    v_add_f32 v9, v9, v229
    v_add_f32 v10, v10, v196
    v_add_f32 v11, v11, v197
    v_add_f32 v8, v8, v230
    v_add_f32 v9, v9, v231
    v_add_f32 v10, v10, v198
    v_add_f32 v11, v11, v199
    v_add_f32 v6, v8, v9
    v_add_f32 v7, v10, v11
    v_add_f32 v4, v8, v9
    v_add_f32 v5, v10, v11
    s_nop 0
    v_permlane32_swap_b32 v4, v6
    v_permlane32_swap_b32 v5, v7
    v_add_f32 v4, v4, v6
    v_add_f32 v5, v5, v7
    v_rcp_f32 v4, v4
    v_rcp_f32 v5, v5
    v_mul_f32 v216, v216, v4
    v_mul_f32 v217, v217, v4
    v_mul_f32 v184, v184, v5
    v_mul_f32 v185, v185, v5
    v_mul_f32 v218, v218, v4
    v_mul_f32 v219, v219, v4
    v_mul_f32 v186, v186, v5
    v_mul_f32 v187, v187, v5
    v_mul_f32 v220, v220, v4
    v_mul_f32 v221, v221, v4
    v_mul_f32 v188, v188, v5
    v_mul_f32 v189, v189, v5
    v_mul_f32 v222, v222, v4
    v_mul_f32 v223, v223, v4
    v_mul_f32 v190, v190, v5
    v_mul_f32 v191, v191, v5
    v_mul_f32 v224, v224, v4
    v_mul_f32 v225, v225, v4
    v_mul_f32 v192, v192, v5
    v_mul_f32 v193, v193, v5
    v_mul_f32 v226, v226, v4
    v_mul_f32 v227, v227, v4
    v_mul_f32 v194, v194, v5
    v_mul_f32 v195, v195, v5
    v_mul_f32 v228, v228, v4
    v_mul_f32 v229, v229, v4
    v_mul_f32 v196, v196, v5
    v_mul_f32 v197, v197, v5
    v_mul_f32 v230, v230, v4
    v_mul_f32 v231, v231, v4
    v_mul_f32 v198, v198, v5
    v_mul_f32 v199, v199, v5
    v_cvt_pk_bf16_f32 v216, v216, v217
    v_cvt_pk_bf16_f32 v217, v218, v219
    v_cvt_pk_bf16_f32 v218, v220, v221
    v_cvt_pk_bf16_f32 v219, v222, v223
    v_cvt_pk_bf16_f32 v220, v224, v225
    v_cvt_pk_bf16_f32 v221, v226, v227
    v_cvt_pk_bf16_f32 v222, v228, v229
    v_cvt_pk_bf16_f32 v223, v230, v231
    ds_write_b128 v232, v[216:219]
    v_cvt_pk_bf16_f32 v224, v184, v185
    v_cvt_pk_bf16_f32 v225, v186, v187
    v_cvt_pk_bf16_f32 v226, v188, v189
    v_cvt_pk_bf16_f32 v227, v190, v191
    ds_write_b128 v232, v[220:223] offset:4096
    ds_write_b128 v232, v[224:227] offset:8192
    v_cvt_pk_bf16_f32 v228, v192, v193
    v_cvt_pk_bf16_f32 v229, v194, v195
    v_cvt_pk_bf16_f32 v230, v196, v197
    v_cvt_pk_bf16_f32 v231, v198, v199
    ds_write_b128 v232, v[228:231] offset:12288
    s_waitcnt vmcnt(18)
    s_waitcnt vmcnt(16)
    s_waitcnt vmcnt(14)
    s_waitcnt vmcnt(12)
    s_barrier
    v_cvt_pk_bf16_f32 v200, 0, v200
    v_cvt_pk_bf16_f32 v201, 0, v201
    v_cvt_pk_bf16_f32 v202, 0, v202
    v_cvt_pk_bf16_f32 v203, 0, v203
    s_xor_b32 s96, s95, 786432
    s_add_u32 s97, s96, s90
    s_sub_u32 s82, s97, 65536
    s_add_u32 m0, s83, 45056
    s_nop 0
    buffer_load_dwordx4 v26, s[44:47], s82 offen lds
    v_cvt_pk_bf16_f32 v204, 0, v204
    v_cvt_pk_bf16_f32 v205, 0, v205
    v_cvt_pk_bf16_f32 v206, 0, v206
    v_cvt_pk_bf16_f32 v207, 0, v207
    v_cvt_pk_bf16_f32 v208, 0, v208
    v_cvt_pk_bf16_f32 v209, 0, v209
    v_cvt_pk_bf16_f32 v210, 0, v210
    v_cvt_pk_bf16_f32 v211, 0, v211
    v_cvt_pk_bf16_f32 v212, 0, v212
    v_cvt_pk_bf16_f32 v213, 0, v213
    v_cvt_pk_bf16_f32 v214, 0, v214
    v_cvt_pk_bf16_f32 v215, 0, v215
    v_max3_f32 v4, v200, v201, v202
    v_min3_f32 v5, v200, v201, v202
    s_xor_b32 s96, s95, 786432
    s_add_u32 s82, s96, s90
    s_add_u32 m0, s83, 49152
    s_nop 0
    buffer_load_dwordx4 v26, s[44:47], s82 offen lds
    v_max3_f32 v4, v4, v203, v204
    v_min3_f32 v5, v5, v203, v204
    v_max3_f32 v4, v4, v205, v206
    v_min3_f32 v5, v5, v205, v206
    v_max3_f32 v4, v4, v207, v208
    v_min3_f32 v5, v5, v207, v208
    v_max3_f32 v4, v4, v209, v210
    v_min3_f32 v5, v5, v209, v210
    v_max3_f32 v4, v4, v211, v212
    v_min3_f32 v5, v5, v211, v212
    v_max3_f32 v4, v4, v213, v214
    v_min3_f32 v5, v5, v213, v214
    v_max_f32 v6, v4, v215
    v_min_f32 v7, v5, v215
    s_xor_b32 s96, s95, 917504
    s_add_u32 s97, s96, s90
    s_sub_u32 s82, s97, 65536
    s_add_u32 m0, s83, 53248
    s_nop 0
    buffer_load_dwordx4 v26, s[44:47], s82 offen lds
    v_max_f32 v4, v4, v215
    s_waitcnt lgkmcnt(0)
    v_min_f32 v5, v5, v215
    v_permlane32_swap_b32 v4, v6
    s_nop 0
    v_permlane32_swap_b32 v5, v7
    v_max_f32 v4, v4, v6
    v_min_f32 v5, v5, v7
    v_mul_f32_e64 v4, v4, s7
    v_mul_f32_e64 v5, v5, s7
    v_fma_f32 v216, v200, s7, -v4
    v_fma_f32 v217, v201, s7, -v4
    v_fma_f32 v200, -v200, s7, v5
    v_fma_f32 v201, -v201, s7, v5
    v_fma_f32 v218, v202, s7, -v4
    s_xor_b32 s96, s95, 917504
    s_add_u32 s82, s96, s90
    s_add_u32 m0, s83, 57344
    s_nop 0
    buffer_load_dwordx4 v26, s[44:47], s82 offen lds
    v_fma_f32 v219, v203, s7, -v4
    v_fma_f32 v202, -v202, s7, v5
    v_fma_f32 v203, -v203, s7, v5
    v_fma_f32 v220, v204, s7, -v4
    v_fma_f32 v221, v205, s7, -v4
    v_fma_f32 v204, -v204, s7, v5
    v_fma_f32 v205, -v205, s7, v5
    v_fma_f32 v222, v206, s7, -v4
    v_fma_f32 v223, v207, s7, -v4
    v_fma_f32 v206, -v206, s7, v5
    v_fma_f32 v207, -v207, s7, v5
    v_fma_f32 v224, v208, s7, -v4
    v_fma_f32 v225, v209, s7, -v4
    v_fma_f32 v208, -v208, s7, v5
    s_xor_b32 s96, s95, 1048576
    s_add_u32 s97, s96, s90
    s_sub_u32 s82, s97, 65536
    s_add_u32 m0, s83, 61440
    s_nop 0
    buffer_load_dwordx4 v26, s[44:47], s82 offen lds
    v_fma_f32 v209, -v209, s7, v5
    v_fma_f32 v226, v210, s7, -v4
    v_fma_f32 v227, v211, s7, -v4
    v_fma_f32 v210, -v210, s7, v5
    v_fma_f32 v211, -v211, s7, v5
    v_fma_f32 v228, v212, s7, -v4
    v_fma_f32 v229, v213, s7, -v4
    v_fma_f32 v212, -v212, s7, v5
    v_fma_f32 v213, -v213, s7, v5
    v_fma_f32 v230, v214, s7, -v4
    v_fma_f32 v231, v215, s7, -v4
    v_fma_f32 v214, -v214, s7, v5
    v_fma_f32 v215, -v215, s7, v5
    v_exp_f32 v216, v216
    s_xor_b32 s96, s95, 1048576
    s_add_u32 s82, s96, s90
    s_add_u32 m0, s83, 65536
    s_nop 0
    buffer_load_dwordx4 v26, s[44:47], s82 offen lds
    v_exp_f32 v200, v200
    v_exp_f32 v217, v217
    v_exp_f32 v201, v201
    v_exp_f32 v218, v218
    v_exp_f32 v202, v202
    v_exp_f32 v219, v219
    v_exp_f32 v203, v203
    v_exp_f32 v220, v220
    v_exp_f32 v204, v204
    v_exp_f32 v221, v221
    v_exp_f32 v205, v205
    v_exp_f32 v222, v222
    v_exp_f32 v206, v206
    v_exp_f32 v223, v223
    s_xor_b32 s96, s95, 1179648
    s_add_u32 s97, s96, s90
    s_sub_u32 s82, s97, 65536
    s_add_u32 m0, s83, 69632
    s_nop 0
    buffer_load_dwordx4 v26, s[44:47], s82 offen lds
    v_exp_f32 v207, v207
    v_exp_f32 v224, v224
    v_exp_f32 v208, v208
    v_exp_f32 v225, v225
    v_exp_f32 v209, v209
    v_exp_f32 v226, v226
    v_exp_f32 v210, v210
    v_exp_f32 v227, v227
    v_exp_f32 v211, v211
    v_exp_f32 v228, v228
    v_exp_f32 v212, v212
    v_exp_f32 v229, v229
    v_exp_f32 v213, v213
    v_exp_f32 v230, v230
    s_xor_b32 s96, s95, 1179648
    s_add_u32 s82, s96, s90
    s_add_u32 m0, s83, 73728
    s_nop 0
    buffer_load_dwordx4 v26, s[44:47], s82 offen lds
    v_exp_f32 v214, v214
    v_exp_f32 v231, v231
    v_exp_f32 v215, v215
    v_add_f32 v8, v216, v218
    v_add_f32 v9, v217, v219
    v_add_f32 v10, v200, v202
    v_add_f32 v11, v201, v203
    v_add_f32 v8, v8, v220
    v_add_f32 v9, v9, v221
    v_add_f32 v10, v10, v204
    v_add_f32 v11, v11, v205
    v_add_f32 v8, v8, v222
    v_add_f32 v9, v9, v223
    v_add_f32 v10, v10, v206
    s_xor_b32 s96, s95, 1310720
    s_add_u32 s97, s96, s90
    s_sub_u32 s82, s97, 65536
    s_add_u32 m0, s83, 77824
    s_nop 0
    buffer_load_dwordx4 v26, s[44:47], s82 offen lds
L_PAD6:
    s_cbranch_execz L_RET6
    v_add_f32 v11, v11, v207
    v_add_f32 v8, v8, v224
    v_add_f32 v9, v9, v225
    v_add_f32 v10, v10, v208
    v_add_f32 v11, v11, v209
    v_add_f32 v8, v8, v226
    v_add_f32 v9, v9, v227
    v_add_f32 v10, v10, v210
    v_add_f32 v11, v11, v211
    v_add_f32 v8, v8, v228
    v_add_f32 v9, v9, v229
    v_add_f32 v10, v10, v212
    v_add_f32 v11, v11, v213
    v_add_f32 v8, v8, v230
    s_xor_b32 s96, s95, 1310720
    s_add_u32 s82, s96, s90
    s_add_u32 m0, s83, 81920
    s_nop 0
    buffer_load_dwordx4 v26, s[44:47], s82 offen lds
    v_add_f32 v9, v9, v231
    v_add_f32 v10, v10, v214
    v_add_f32 v11, v11, v215
    v_add_f32 v6, v8, v9
    v_add_f32 v7, v10, v11
    v_add_f32 v4, v8, v9
    v_add_f32 v5, v10, v11
    s_nop 0
    v_permlane32_swap_b32 v4, v6
    v_permlane32_swap_b32 v5, v7
    v_add_f32 v4, v4, v6
    v_add_f32 v5, v5, v7
    v_rcp_f32 v4, v4
    v_rcp_f32 v5, v5
    v_mul_f32 v216, v216, v4
    s_xor_b32 s96, s95, 1441792
    s_add_u32 s97, s96, s90
    s_sub_u32 s82, s97, 65536
    s_add_u32 m0, s83, 86016
    s_nop 0
    buffer_load_dwordx4 v26, s[44:47], s82 offen lds
    v_mul_f32 v217, v217, v4
    v_mul_f32 v200, v200, v5
    v_mul_f32 v201, v201, v5
    v_mul_f32 v218, v218, v4
    v_mul_f32 v219, v219, v4
    v_mul_f32 v202, v202, v5
    v_mul_f32 v203, v203, v5
    v_mul_f32 v220, v220, v4
    v_mul_f32 v221, v221, v4
    v_mul_f32 v204, v204, v5
    v_mul_f32 v205, v205, v5
    v_mul_f32 v222, v222, v4
    v_mul_f32 v223, v223, v4
    v_mul_f32 v206, v206, v5
    s_xor_b32 s96, s95, 1441792
    s_add_u32 s82, s96, s90
    s_add_u32 m0, s83, 90112
    s_nop 0
    buffer_load_dwordx4 v26, s[44:47], s82 offen lds
    v_mul_f32 v207, v207, v5
    v_mul_f32 v224, v224, v4
    v_mul_f32 v225, v225, v4
    v_mul_f32 v208, v208, v5
    v_mul_f32 v209, v209, v5
    v_mul_f32 v226, v226, v4
    v_mul_f32 v227, v227, v4
    v_mul_f32 v210, v210, v5
    v_mul_f32 v211, v211, v5
    v_mul_f32 v228, v228, v4
    v_mul_f32 v229, v229, v4
    v_mul_f32 v212, v212, v5
    v_mul_f32 v213, v213, v5
    v_mul_f32 v230, v230, v4
    v_mul_f32 v231, v231, v4
    v_mul_f32 v214, v214, v5
    v_mul_f32 v215, v215, v5
    v_cvt_pk_bf16_f32 v216, v216, v217
    v_cvt_pk_bf16_f32 v217, v218, v219
    v_cvt_pk_bf16_f32 v218, v220, v221
    v_cvt_pk_bf16_f32 v219, v222, v223
    v_cvt_pk_bf16_f32 v220, v224, v225
    v_cvt_pk_bf16_f32 v221, v226, v227
    v_cvt_pk_bf16_f32 v222, v228, v229
    v_cvt_pk_bf16_f32 v223, v230, v231
    ds_write_b128 v232, v[216:219] offset:16384
    v_cvt_pk_bf16_f32 v224, v200, v201
    v_cvt_pk_bf16_f32 v225, v202, v203
    v_cvt_pk_bf16_f32 v226, v204, v205
    v_cvt_pk_bf16_f32 v227, v206, v207
    ds_write_b128 v232, v[220:223] offset:20480
    ds_write_b128 v232, v[224:227] offset:24576
    v_cvt_pk_bf16_f32 v228, v208, v209
    v_cvt_pk_bf16_f32 v229, v210, v211
    v_cvt_pk_bf16_f32 v230, v212, v213
    v_cvt_pk_bf16_f32 v231, v214, v215
    ds_write_b128 v232, v[228:231] offset:28672
    s_lshl_b32 s96, s77, 11
    s_add_u32 s14, s96, 151552
    v_add_u32 v0, s14, v2
    s_setprio 0
L_JOIN:
    v_and_b32 v45, 1, v1
    v_lshlrev_b32 v45, 3, v45
    v_bfe_u32 v9, v1, 2, 2
    v_lshl_add_u32 v45, v9, 4, v45
    v_bfe_u32 v9, v1, 4, 1
    v_lshl_add_u32 v45, v9, 6, v45
    v_bfe_u32 v9, v1, 1, 1
    v_lshl_add_u32 v45, v9, 7, v45
    v_lshrrev_b32 v9, 5, v1
    v_lshl_add_u32 v45, v9, 8, v45
    s_lshl_b32 s13, s3, 12
    v_add_u32 v44, s13, v45
    s_lshl_b32 s96, s76, 13
    s_add_u32 s13, s96, 32768
    v_add_u32 v45, s13, v45
    v_mov_b32 v244, 0x3f803f80
    v_mov_b32 v245, 0x3f803f80
    v_mov_b32 v246, 0x3f803f80
    v_mov_b32 v247, 0x3f803f80
    s_lshl3_add_u32 s96, s11, s3
    s_lshl_b32 s97, s96, 5
    s_add_u32 s98, s97, s10
    s_lshl_b32 s99, s98, 10
    s_add_u32 s13, s99, 25165824
    s_add_u32 s15, s13, 16384
    s_lshl3_add_u32 s96, s11, s3
    s_lshl_b32 s97, s96, 10
    s_add_u32 s16, s97, 21495808
    s_lshl_b32 s96, s10, 6
    s_add_u32 s14, s96, s16
    s_waitcnt lgkmcnt(0)
    s_barrier
    ds_read_b64_tr_b16 v[184:185], v44
    ds_read_b64_tr_b16 v[186:187], v44 offset:512
    ds_read_b64_tr_b16 v[200:201], v45
    ds_read_b64_tr_b16 v[202:203], v45 offset:512
    ds_read_b64_tr_b16 v[204:205], v45 offset:1024
    ds_read_b64_tr_b16 v[206:207], v45 offset:1536
    ds_read_b64_tr_b16 v[188:189], v44 offset:1024
    ds_read_b64_tr_b16 v[190:191], v44 offset:1536
    ds_read_b64_tr_b16 v[208:209], v45 offset:2048
    ds_read_b64_tr_b16 v[210:211], v45 offset:2560
    ds_read_b64_tr_b16 v[212:213], v45 offset:3072
    ds_read_b64_tr_b16 v[214:215], v45 offset:3584
    ds_read_b64_tr_b16 v[192:193], v44 offset:2048
    ds_read_b64_tr_b16 v[194:195], v44 offset:2560
    ds_read_b64_tr_b16 v[216:217], v45 offset:4096
    ds_read_b64_tr_b16 v[218:219], v45 offset:4608
    ds_read_b64_tr_b16 v[220:221], v45 offset:5120
    ds_read_b64_tr_b16 v[222:223], v45 offset:5632
    s_waitcnt lgkmcnt(12)
    v_mfma_f32_16x16x32_bf16 v[232:235], v[184:187], v[200:203], 0
    v_mfma_f32_16x16x32_bf16 v[236:239], v[184:187], v[204:207], 0
    v_mfma_f32_16x16x32_bf16 v[240:243], v[184:187], v[244:247], 0
    ds_read_b64_tr_b16 v[196:197], v44 offset:3072
    ds_read_b64_tr_b16 v[198:199], v44 offset:3584
    ds_read_b64_tr_b16 v[224:225], v45 offset:6144
    ds_read_b64_tr_b16 v[226:227], v45 offset:6656
    ds_read_b64_tr_b16 v[228:229], v45 offset:7168
    ds_read_b64_tr_b16 v[230:231], v45 offset:7680
    s_waitcnt lgkmcnt(12)
    v_mfma_f32_16x16x32_bf16 v[232:235], v[188:191], v[208:211], v[232:235]
    v_mfma_f32_16x16x32_bf16 v[236:239], v[188:191], v[212:215], v[236:239]
    v_mfma_f32_16x16x32_bf16 v[240:243], v[188:191], v[244:247], v[240:243]
    s_waitcnt lgkmcnt(6)
    v_mfma_f32_16x16x32_bf16 v[232:235], v[192:195], v[216:219], v[232:235]
    v_mfma_f32_16x16x32_bf16 v[236:239], v[192:195], v[220:223], v[236:239]
    v_mfma_f32_16x16x32_bf16 v[240:243], v[192:195], v[244:247], v[240:243]
    s_waitcnt lgkmcnt(0)
    v_mfma_f32_16x16x32_bf16 v[232:235], v[196:199], v[224:227], v[232:235]
    v_mfma_f32_16x16x32_bf16 v[236:239], v[196:199], v[228:231], v[236:239]
    v_mfma_f32_16x16x32_bf16 v[240:243], v[196:199], v[244:247], v[240:243]
    s_cmp_lt_u32 s3, 4
    s_cbranch_scc1 L_NOQX
    ds_read_b128 v[168:171], v0
    ds_read_b128 v[172:175], v0 offset:1024
L_NOQX:
    s_nop 3
    buffer_store_dwordx4 v[232:235], v2, s[32:35], s13 offen sc1
    buffer_store_dwordx4 v[236:239], v2, s[32:35], s15 offen sc1
    s_mov_b32 exec_lo, 0x00010001
    s_mov_b32 exec_hi, 0x00010001
    buffer_store_dwordx4 v[240:243], v1, s[32:35], s14 offen sc1
    s_mov_b64 exec, -1
    s_waitcnt lgkmcnt(0)
    v_mfma_f32_32x32x16_bf16 v[120:135], v[176:179], v[168:171], 0
    v_mfma_f32_32x32x16_bf16 v[120:135], v[180:183], v[172:175], v[120:135]
    v_and_b32 v46, 7, v1
    v_lshlrev_b32 v46, 17, v46
    v_bfe_u32 v9, v1, 3, 1
    v_lshl_add_u32 v46, v9, 14, v46
    s_and_b32 s96, s10, 1
    s_and_b32 s97, s2, 27
    s_lshl_b32 s98, s97, 12
    s_lshr_b32 s99, s10, 1
    s_lshl_b32 s97, s99, 6
    s_add_u32 s99, s98, s97
    s_lshl2_add_u32 s98, s96, s99
    s_add_u32 s97, s98, 1048576
    s_add_u32 s17, s97, 512
    v_lshrrev_b32 v47, 3, v1
    v_lshlrev_b32 v47, 10, v47
    v_and_b32 v9, 7, v1
    v_lshl_add_u32 v47, v9, 4, v47
    v_and_b32 v48, 7, v1
    v_lshlrev_b32 v48, 4, v48
    v_lshrrev_b32 v9, 5, v1
    v_lshl_add_u32 v48, v9, 3, v48
    v_cvt_pk_bf16_f32 v120, 0, v120
    v_cvt_pk_bf16_f32 v121, 0, v121
    v_cvt_pk_bf16_f32 v122, 0, v122
    v_cvt_pk_bf16_f32 v123, 0, v123
    v_cvt_pk_bf16_f32 v124, 0, v124
    v_cvt_pk_bf16_f32 v125, 0, v125
    v_cvt_pk_bf16_f32 v126, 0, v126
    v_cvt_pk_bf16_f32 v127, 0, v127
    v_cvt_pk_bf16_f32 v128, 0, v128
    v_cvt_pk_bf16_f32 v129, 0, v129
    v_cvt_pk_bf16_f32 v130, 0, v130
    v_cvt_pk_bf16_f32 v131, 0, v131
    v_cvt_pk_bf16_f32 v132, 0, v132
    v_cvt_pk_bf16_f32 v133, 0, v133
    v_cvt_pk_bf16_f32 v134, 0, v134
    v_cvt_pk_bf16_f32 v135, 0, v135
    v_max3_f32 v4, v120, v121, v122
    v_min3_f32 v5, v120, v121, v122
    v_max3_f32 v4, v4, v123, v124
    v_min3_f32 v5, v5, v123, v124
    v_max3_f32 v4, v4, v125, v126
    v_min3_f32 v5, v5, v125, v126
    v_max3_f32 v4, v4, v127, v128
    v_min3_f32 v5, v5, v127, v128
    v_max3_f32 v4, v4, v129, v130
    v_min3_f32 v5, v5, v129, v130
    v_max3_f32 v4, v4, v131, v132
    v_min3_f32 v5, v5, v131, v132
    v_max3_f32 v4, v4, v133, v134
    v_min3_f32 v5, v5, v133, v134
    v_max_f32 v6, v4, v135
    v_min_f32 v7, v5, v135
    v_max_f32 v4, v4, v135
    v_min_f32 v5, v5, v135
    s_nop 0
    v_permlane32_swap_b32 v4, v6
    v_permlane32_swap_b32 v5, v7
    v_max_f32 v4, v4, v6
    v_min_f32 v5, v5, v7
    v_pk_mul_f32 v[4:5], v[4:5], s[6:7] op_sel:[0,1]
    v_mov_b32 v6, v5
    v_pk_fma_f32 v[136:137], v[120:121], s[6:7], v[4:5] op_sel:[0,1,0] op_sel_hi:[1,1,0] neg_lo:[0,0,1] neg_hi:[0,0,1]
    v_pk_fma_f32 v[120:121], v[120:121], s[6:7], v[6:7] op_sel:[0,1,0] op_sel_hi:[1,1,0] neg_lo:[1,0,0] neg_hi:[1,0,0]
    v_pk_fma_f32 v[138:139], v[122:123], s[6:7], v[4:5] op_sel:[0,1,0] op_sel_hi:[1,1,0] neg_lo:[0,0,1] neg_hi:[0,0,1]
    v_pk_fma_f32 v[122:123], v[122:123], s[6:7], v[6:7] op_sel:[0,1,0] op_sel_hi:[1,1,0] neg_lo:[1,0,0] neg_hi:[1,0,0]
    v_pk_fma_f32 v[140:141], v[124:125], s[6:7], v[4:5] op_sel:[0,1,0] op_sel_hi:[1,1,0] neg_lo:[0,0,1] neg_hi:[0,0,1]
    v_pk_fma_f32 v[124:125], v[124:125], s[6:7], v[6:7] op_sel:[0,1,0] op_sel_hi:[1,1,0] neg_lo:[1,0,0] neg_hi:[1,0,0]
    v_pk_fma_f32 v[142:143], v[126:127], s[6:7], v[4:5] op_sel:[0,1,0] op_sel_hi:[1,1,0] neg_lo:[0,0,1] neg_hi:[0,0,1]
    v_pk_fma_f32 v[126:127], v[126:127], s[6:7], v[6:7] op_sel:[0,1,0] op_sel_hi:[1,1,0] neg_lo:[1,0,0] neg_hi:[1,0,0]
    v_pk_fma_f32 v[144:145], v[128:129], s[6:7], v[4:5] op_sel:[0,1,0] op_sel_hi:[1,1,0] neg_lo:[0,0,1] neg_hi:[0,0,1]
    v_pk_fma_f32 v[128:129], v[128:129], s[6:7], v[6:7] op_sel:[0,1,0] op_sel_hi:[1,1,0] neg_lo:[1,0,0] neg_hi:[1,0,0]
    v_pk_fma_f32 v[146:147], v[130:131], s[6:7], v[4:5] op_sel:[0,1,0] op_sel_hi:[1,1,0] neg_lo:[0,0,1] neg_hi:[0,0,1]
    v_pk_fma_f32 v[130:131], v[130:131], s[6:7], v[6:7] op_sel:[0,1,0] op_sel_hi:[1,1,0] neg_lo:[1,0,0] neg_hi:[1,0,0]
    v_pk_fma_f32 v[148:149], v[132:133], s[6:7], v[4:5] op_sel:[0,1,0] op_sel_hi:[1,1,0] neg_lo:[0,0,1] neg_hi:[0,0,1]
    v_pk_fma_f32 v[132:133], v[132:133], s[6:7], v[6:7] op_sel:[0,1,0] op_sel_hi:[1,1,0] neg_lo:[1,0,0] neg_hi:[1,0,0]
    v_pk_fma_f32 v[150:151], v[134:135], s[6:7], v[4:5] op_sel:[0,1,0] op_sel_hi:[1,1,0] neg_lo:[0,0,1] neg_hi:[0,0,1]
    v_pk_fma_f32 v[134:135], v[134:135], s[6:7], v[6:7] op_sel:[0,1,0] op_sel_hi:[1,1,0] neg_lo:[1,0,0] neg_hi:[1,0,0]
    v_exp_f32 v136, v136
    v_exp_f32 v120, v120
    v_exp_f32 v137, v137
    v_exp_f32 v121, v121
    v_exp_f32 v138, v138
    v_exp_f32 v122, v122
    v_exp_f32 v139, v139
    v_exp_f32 v123, v123
    v_exp_f32 v140, v140
    v_exp_f32 v124, v124
    v_exp_f32 v141, v141
    v_exp_f32 v125, v125
    v_exp_f32 v142, v142
    v_exp_f32 v126, v126
    v_exp_f32 v143, v143
    v_exp_f32 v127, v127
    s_waitcnt vmcnt(0)
    s_barrier
    s_cmp_lg_u32 s3, 0
    s_cbranch_scc1 L_PC
    v_mov_b32 v45, s4
    s_mov_b32 exec_hi, 0
    s_mov_b32 exec_lo, 65535
    buffer_store_dword v45, v46, s[32:35], s17 offen sc1
    s_mov_b64 exec, -1
L_PC:
    s_xor_b32 s96, s95, 1572864
    s_add_u32 s82, s96, s90
    s_add_u32 m0, s83, 98304
    s_nop 0
    buffer_load_dwordx4 v26, s[44:47], s82 offen lds
    v_exp_f32 v144, v144
    v_exp_f32 v128, v128
    v_exp_f32 v145, v145
    v_exp_f32 v129, v129
    v_exp_f32 v146, v146
    v_exp_f32 v130, v130
    v_exp_f32 v147, v147
    v_exp_f32 v131, v131
    s_xor_b32 s96, s95, 1703936
    s_add_u32 s82, s96, s90
    s_add_u32 m0, s83, 106496
    s_nop 0
    buffer_load_dwordx4 v26, s[44:47], s82 offen lds
    v_exp_f32 v148, v148
    v_exp_f32 v132, v132
    v_exp_f32 v149, v149
    v_exp_f32 v133, v133
    v_exp_f32 v150, v150
    v_exp_f32 v134, v134
    v_exp_f32 v151, v151
    v_exp_f32 v135, v135
    s_lshl4_add_u32 s96, s11, s10
    s_lshl_b32 s97, s96, 14
    s_lshl_b32 s98, s3, 7
    s_add_u32 s99, s97, s98
    s_add_u32 s13, s99, 25165824
    s_add_u32 s14, s13, 8192
    s_lshl4_add_u32 s96, s11, s10
    s_lshl_b32 s97, s96, 10
    s_lshl_b32 s98, s3, 7
    s_add_u32 s99, s97, s98
    s_add_u32 s15, s99, 29360128
    s_add_u32 s17, s17, 3072
    s_load_dwordx2 s[24:25], s[32:33], s92 offset:512 glc
    s_xor_b32 s96, s95, 1835008
    s_add_u32 s82, s96, s90
    s_add_u32 m0, s83, 114688
    s_nop 0
    buffer_load_dwordx4 v26, s[44:47], s82 offen lds
    v_pk_add_f32 v[8:9], v[136:137], v[138:139]
    v_pk_add_f32 v[10:11], v[120:121], v[122:123]
    v_pk_add_f32 v[8:9], v[8:9], v[140:141]
    v_pk_add_f32 v[10:11], v[10:11], v[124:125]
    v_pk_add_f32 v[8:9], v[8:9], v[142:143]
    v_pk_add_f32 v[10:11], v[10:11], v[126:127]
    v_pk_add_f32 v[8:9], v[8:9], v[144:145]
    v_pk_add_f32 v[10:11], v[10:11], v[128:129]
    v_pk_add_f32 v[8:9], v[8:9], v[146:147]
    v_pk_add_f32 v[10:11], v[10:11], v[130:131]
    v_pk_add_f32 v[8:9], v[8:9], v[148:149]
    v_pk_add_f32 v[10:11], v[10:11], v[132:133]
    v_pk_add_f32 v[8:9], v[8:9], v[150:151]
    v_pk_add_f32 v[10:11], v[10:11], v[134:135]
    s_xor_b32 s96, s95, 1966080
    s_add_u32 s82, s96, s90
    s_add_u32 m0, s83, 122880
    s_nop 0
    buffer_load_dwordx4 v26, s[44:47], s82 offen lds
    v_add_f32 v6, v8, v9
    v_add_f32 v7, v10, v11
    v_add_f32 v4, v8, v9
    v_add_f32 v5, v10, v11
    s_nop 0
    v_permlane32_swap_b32 v4, v6
    v_permlane32_swap_b32 v5, v7
    v_pk_add_f32 v[4:5], v[4:5], v[6:7]
    v_rcp_f32 v4, v4
    v_rcp_f32 v5, v5
    s_nop 0
    v_pk_mul_f32 v[136:137], v[136:137], v[4:5] op_sel_hi:[1,0]
    v_pk_mul_f32 v[120:121], v[4:5], v[120:121] op_sel:[1,0]
    v_pk_mul_f32 v[138:139], v[138:139], v[4:5] op_sel_hi:[1,0]
    v_pk_mul_f32 v[122:123], v[4:5], v[122:123] op_sel:[1,0]
    v_pk_mul_f32 v[140:141], v[140:141], v[4:5] op_sel_hi:[1,0]
    s_add_u32 s82, s95, s90
    s_mov_b32 m0, s83
    s_nop 0
    buffer_load_dwordx4 v26, s[44:47], s82 offen lds
    v_pk_mul_f32 v[124:125], v[4:5], v[124:125] op_sel:[1,0]
    v_pk_mul_f32 v[142:143], v[142:143], v[4:5] op_sel_hi:[1,0]
    v_pk_mul_f32 v[126:127], v[4:5], v[126:127] op_sel:[1,0]
    v_pk_mul_f32 v[144:145], v[144:145], v[4:5] op_sel_hi:[1,0]
    v_pk_mul_f32 v[128:129], v[4:5], v[128:129] op_sel:[1,0]
    v_pk_mul_f32 v[146:147], v[146:147], v[4:5] op_sel_hi:[1,0]
    v_pk_mul_f32 v[130:131], v[4:5], v[130:131] op_sel:[1,0]
    v_pk_mul_f32 v[148:149], v[148:149], v[4:5] op_sel_hi:[1,0]
    v_pk_mul_f32 v[132:133], v[4:5], v[132:133] op_sel:[1,0]
    v_pk_mul_f32 v[150:151], v[150:151], v[4:5] op_sel_hi:[1,0]
    v_pk_mul_f32 v[134:135], v[4:5], v[134:135] op_sel:[1,0]
    v_cvt_pk_bf16_f32 v152, v136, v137
    v_cvt_pk_bf16_f32 v153, v138, v139
    v_cvt_pk_bf16_f32 v154, v140, v141
    s_xor_b32 s96, s95, 131072
    s_add_u32 s82, s96, s90
    s_add_u32 m0, s83, 8192
    s_nop 0
    buffer_load_dwordx4 v26, s[44:47], s82 offen lds
    v_cvt_pk_bf16_f32 v155, v142, v143
    v_cvt_pk_bf16_f32 v156, v144, v145
    v_cvt_pk_bf16_f32 v157, v146, v147
    v_cvt_pk_bf16_f32 v158, v148, v149
    v_cvt_pk_bf16_f32 v159, v150, v151
    v_cvt_pk_bf16_f32 v160, v120, v121
    v_cvt_pk_bf16_f32 v161, v122, v123
    v_cvt_pk_bf16_f32 v162, v124, v125
    v_cvt_pk_bf16_f32 v163, v126, v127
    v_cvt_pk_bf16_f32 v164, v128, v129
    v_cvt_pk_bf16_f32 v165, v130, v131
    v_cvt_pk_bf16_f32 v166, v132, v133
    v_cvt_pk_bf16_f32 v167, v134, v135
    s_branch SCHK_17
SPOLL_16:
    s_load_dwordx2 s[24:25], s[32:33], s92 offset:512 glc
SCHK_17:
    s_add_u32 s5, s5, 1
    s_cmp_ge_u32 s5, 200000
    s_waitcnt lgkmcnt(0)
    s_cbranch_scc1 SDONE_18
    s_cmp_lg_u32 s24, s4
    s_cbranch_scc1 SPOLL_16
    s_cmp_lg_u32 s25, s4
    s_cbranch_scc1 SPOLL_16
SDONE_18:
    s_barrier
    buffer_load_dwordx4 v[184:187], v47, s[32:35], s13 offen sc1
    buffer_load_dwordx4 v[188:191], v47, s[32:35], s14 offen sc1
    buffer_load_dwordx4 v[192:195], v2, s[32:35], s16 offen sc1
    s_lshl_b32 s96, s3, 5
    s_add_u32 s14, s96, 155648
    v_and_b32 v6, 3, v1
    v_lshl_add_u32 v6, v6, 3, s14
    v_lshrrev_b32 v9, 5, v1
    v_lshl_add_u32 v6, v9, 2, v6
    s_lshl_b32 s96, s3, 10
    s_add_u32 s14, s96, 147456
    v_and_b32 v5, 15, v1
    v_lshl_add_u32 v5, v5, 4, s14
    v_lshrrev_b32 v9, 5, v1
    v_lshl_add_u32 v5, v9, 9, v5
    v_bfe_u32 v9, v1, 4, 1
    v_lshl_add_u32 v5, v9, 3, v5
    s_lshl_b32 s96, s76, 7
    s_add_u32 s14, s96, 155648
    v_lshrrev_b32 v7, 5, v1
    v_lshl_add_u32 v7, v7, 4, s14
    s_lshl_b32 s96, s76, 12
    s_add_u32 s14, s96, 147456
    v_add_u32 v44, s14, v2
    s_cmp_lt_u32 s3, 4
    s_cbranch_scc1 L_HG1
    v_lshlrev_b32 v52, 16, v88
    v_and_b32 v53, s6, v88
    v_pk_mul_f32 v[80:81], v[72:73], v[52:53] op_sel:[0,0] op_sel_hi:[0,1]
    v_lshlrev_b32 v54, 16, v89
    v_and_b32 v55, s6, v89
    v_pk_mul_f32 v[82:83], v[72:73], v[54:55] op_sel:[0,0] op_sel_hi:[0,1]
    v_lshlrev_b32 v52, 16, v90
    v_and_b32 v53, s6, v90
    v_pk_mul_f32 v[84:85], v[72:73], v[52:53] op_sel:[0,0] op_sel_hi:[0,1]
    v_lshlrev_b32 v54, 16, v91
    v_and_b32 v55, s6, v91
    v_pk_mul_f32 v[86:87], v[72:73], v[54:55] op_sel:[0,0] op_sel_hi:[0,1]
    v_lshlrev_b32 v52, 16, v92
    v_and_b32 v53, s6, v92
    v_pk_fma_f32 v[80:81], v[72:73], v[52:53], v[80:81] op_sel:[1,0,0] op_sel_hi:[1,1,1]
    v_lshlrev_b32 v54, 16, v93
    v_and_b32 v55, s6, v93
    v_pk_fma_f32 v[82:83], v[72:73], v[54:55], v[82:83] op_sel:[1,0,0] op_sel_hi:[1,1,1]
    v_lshlrev_b32 v52, 16, v94
    v_and_b32 v53, s6, v94
    v_pk_fma_f32 v[84:85], v[72:73], v[52:53], v[84:85] op_sel:[1,0,0] op_sel_hi:[1,1,1]
    v_lshlrev_b32 v54, 16, v95
    v_and_b32 v55, s6, v95
    v_pk_fma_f32 v[86:87], v[72:73], v[54:55], v[86:87] op_sel:[1,0,0] op_sel_hi:[1,1,1]
    v_lshlrev_b32 v52, 16, v96
    v_and_b32 v53, s6, v96
    v_pk_fma_f32 v[80:81], v[74:75], v[52:53], v[80:81] op_sel:[0,0,0] op_sel_hi:[0,1,1]
    v_lshlrev_b32 v54, 16, v97
    v_and_b32 v55, s6, v97
    v_pk_fma_f32 v[82:83], v[74:75], v[54:55], v[82:83] op_sel:[0,0,0] op_sel_hi:[0,1,1]
    v_lshlrev_b32 v52, 16, v98
    v_and_b32 v53, s6, v98
    v_pk_fma_f32 v[84:85], v[74:75], v[52:53], v[84:85] op_sel:[0,0,0] op_sel_hi:[0,1,1]
    v_lshlrev_b32 v54, 16, v99
    v_and_b32 v55, s6, v99
    v_pk_fma_f32 v[86:87], v[74:75], v[54:55], v[86:87] op_sel:[0,0,0] op_sel_hi:[0,1,1]
    v_lshlrev_b32 v52, 16, v100
    v_and_b32 v53, s6, v100
    v_pk_fma_f32 v[80:81], v[74:75], v[52:53], v[80:81] op_sel:[1,0,0] op_sel_hi:[1,1,1]
    v_lshlrev_b32 v54, 16, v101
    v_and_b32 v55, s6, v101
    v_pk_fma_f32 v[82:83], v[74:75], v[54:55], v[82:83] op_sel:[1,0,0] op_sel_hi:[1,1,1]
    v_lshlrev_b32 v52, 16, v102
    v_and_b32 v53, s6, v102
    v_pk_fma_f32 v[84:85], v[74:75], v[52:53], v[84:85] op_sel:[1,0,0] op_sel_hi:[1,1,1]
    v_lshlrev_b32 v54, 16, v103
    v_and_b32 v55, s6, v103
    v_pk_fma_f32 v[86:87], v[74:75], v[54:55], v[86:87] op_sel:[1,0,0] op_sel_hi:[1,1,1]
    v_lshlrev_b32 v52, 16, v104
    v_and_b32 v53, s6, v104
    v_pk_fma_f32 v[80:81], v[76:77], v[52:53], v[80:81] op_sel:[0,0,0] op_sel_hi:[0,1,1]
    v_lshlrev_b32 v54, 16, v105
    v_and_b32 v55, s6, v105
    v_pk_fma_f32 v[82:83], v[76:77], v[54:55], v[82:83] op_sel:[0,0,0] op_sel_hi:[0,1,1]
    v_lshlrev_b32 v52, 16, v106
    v_and_b32 v53, s6, v106
    v_pk_fma_f32 v[84:85], v[76:77], v[52:53], v[84:85] op_sel:[0,0,0] op_sel_hi:[0,1,1]
    v_lshlrev_b32 v54, 16, v107
    v_and_b32 v55, s6, v107
    v_pk_fma_f32 v[86:87], v[76:77], v[54:55], v[86:87] op_sel:[0,0,0] op_sel_hi:[0,1,1]
    v_lshlrev_b32 v52, 16, v108
    v_and_b32 v53, s6, v108
    v_pk_fma_f32 v[80:81], v[76:77], v[52:53], v[80:81] op_sel:[1,0,0] op_sel_hi:[1,1,1]
    v_lshlrev_b32 v54, 16, v109
    v_and_b32 v55, s6, v109
    v_pk_fma_f32 v[82:83], v[76:77], v[54:55], v[82:83] op_sel:[1,0,0] op_sel_hi:[1,1,1]
    v_lshlrev_b32 v52, 16, v110
    v_and_b32 v53, s6, v110
    v_pk_fma_f32 v[84:85], v[76:77], v[52:53], v[84:85] op_sel:[1,0,0] op_sel_hi:[1,1,1]
    v_lshlrev_b32 v54, 16, v111
    v_and_b32 v55, s6, v111
    v_pk_fma_f32 v[86:87], v[76:77], v[54:55], v[86:87] op_sel:[1,0,0] op_sel_hi:[1,1,1]
    v_lshlrev_b32 v52, 16, v112
    v_and_b32 v53, s6, v112
    v_pk_fma_f32 v[80:81], v[78:79], v[52:53], v[80:81] op_sel:[0,0,0] op_sel_hi:[0,1,1]
    v_lshlrev_b32 v54, 16, v113
    v_and_b32 v55, s6, v113
    v_pk_fma_f32 v[82:83], v[78:79], v[54:55], v[82:83] op_sel:[0,0,0] op_sel_hi:[0,1,1]
    v_lshlrev_b32 v52, 16, v114
    v_and_b32 v53, s6, v114
    v_pk_fma_f32 v[84:85], v[78:79], v[52:53], v[84:85] op_sel:[0,0,0] op_sel_hi:[0,1,1]
    v_lshlrev_b32 v54, 16, v115
    v_and_b32 v55, s6, v115
    v_pk_fma_f32 v[86:87], v[78:79], v[54:55], v[86:87] op_sel:[0,0,0] op_sel_hi:[0,1,1]
    v_lshlrev_b32 v52, 16, v116
    v_and_b32 v53, s6, v116
    v_pk_fma_f32 v[80:81], v[78:79], v[52:53], v[80:81] op_sel:[1,0,0] op_sel_hi:[1,1,1]
    v_lshlrev_b32 v54, 16, v117
    v_and_b32 v55, s6, v117
    v_pk_fma_f32 v[82:83], v[78:79], v[54:55], v[82:83] op_sel:[1,0,0] op_sel_hi:[1,1,1]
    v_lshlrev_b32 v52, 16, v118
    v_and_b32 v53, s6, v118
    v_pk_fma_f32 v[84:85], v[78:79], v[52:53], v[84:85] op_sel:[1,0,0] op_sel_hi:[1,1,1]
    v_lshlrev_b32 v54, 16, v119
    v_and_b32 v55, s6, v119
    v_pk_fma_f32 v[86:87], v[78:79], v[54:55], v[86:87] op_sel:[1,0,0] op_sel_hi:[1,1,1]
    v_permlane32_swap_b32 v80, v84
    v_permlane32_swap_b32 v81, v85
    v_permlane32_swap_b32 v82, v86
    v_permlane32_swap_b32 v83, v87
    v_add_f32 v80, v80, v84
    v_add_f32 v81, v81, v85
    v_add_f32 v82, v82, v86
    v_add_f32 v83, v83, v87
    s_nop 0
    v_permlane16_swap_b32 v80, v82
    v_permlane16_swap_b32 v81, v83
    v_add_f32 v80, v80, v82
    v_add_f32 v81, v81, v83
    s_nop 0
    v_add_f32_dpp v80, v80, v80 row_ror:8 row_mask:0xf bank_mask:0xf
    v_add_f32_dpp v81, v81, v81 row_ror:8 row_mask:0xf bank_mask:0xf
    s_nop 1
    v_mov_b32_dpp v80, v81 quad_perm:[0,1,2,3] row_mask:0xf bank_mask:0xc
    ds_write_b32 v252, v80 offset:9984
L_HG1:
    s_waitcnt vmcnt(1)
    v_pk_add_f32 v[184:185], v[184:185], v[188:189]
    v_pk_add_f32 v[186:187], v[186:187], v[190:191]
    s_nop 1
    v_permlane32_swap_b32 v184, v186
    v_permlane32_swap_b32 v185, v187
    v_pk_add_f32 v[184:185], v[184:185], v[186:187]
    s_nop 1
    v_add_f32_dpp v184, v184, v184 row_ror:8 row_mask:0xf bank_mask:0xf
    v_add_f32_dpp v185, v185, v185 row_ror:8 row_mask:0xf bank_mask:0xf
    v_mov_b32 v186, v184
    v_mov_b32 v187, v185
    s_nop 0
    v_permlane16_swap_b32 v184, v186
    v_permlane16_swap_b32 v185, v187
    v_pk_add_f32 v[184:185], v[184:185], v[186:187]
    v_cvt_pk_bf16_f32 v184, v184, v185
    v_mov_b32 v185, s4
    s_mov_b32 exec_lo, 0xff
    s_mov_b32 exec_hi, 0xff
    buffer_store_dwordx2 v[184:185], v48, s[32:35], s15 offen sc1
    s_mov_b64 exec, -1
    s_waitcnt lgkmcnt(0)
    s_barrier
    s_cmp_lg_u32 s3, 0
    s_cbranch_scc1 L_PC2
    v_mov_b32 v45, s4
    s_mov_b32 exec_hi, 0
    s_mov_b32 exec_lo, 65535
    buffer_store_dword v45, v46, s[32:35], s17 offen sc1
    s_mov_b64 exec, -1
L_PC2:
    s_cmp_lg_u32 s3, 3
    s_cbranch_scc1 L_M2F
    ds_read_b128 v[80:83], v251 offset:10000
    s_lshr_b32 s96, s8, 2
    s_lshl1_add_u32 s97, s9, s96
    s_and_b32 s98, s8, 3
    s_lshl2_add_u32 s99, s97, s98
    s_lshl_b32 s96, s99, 9
    s_add_u32 s18, s96, 131072
    s_waitcnt lgkmcnt(0)
    v_add_f32 v80, v80, v81
    v_add_f32 v82, v82, v83
    v_mov_b32 v81, s4
    v_add_f32 v80, v80, v82
    buffer_store_dwordx2 v[80:81], v250, s[32:35], s18 offen sc1
L_M2F:
    s_waitcnt vmcnt(1)
    s_xor_b32 s96, s95, 262144
    s_add_u32 s82, s96, s90
    s_add_u32 m0, s83, 16384
    s_nop 0
    buffer_load_dwordx4 v26, s[44:47], s82 offen lds
    v_permlane32_swap_b32 v192, v194
    v_permlane32_swap_b32 v193, v195
    v_pk_add_f32 v[192:193], v[192:193], v[194:195]
    s_nop 1
    v_add_f32_dpp v192, v192, v192 row_ror:4 row_mask:0xf bank_mask:0xf
    s_xor_b32 s96, s95, 393216
    s_add_u32 s82, s96, s90
    s_add_u32 m0, s83, 24576
    s_nop 0
    buffer_load_dwordx4 v26, s[44:47], s82 offen lds
    v_add_f32_dpp v193, v193, v193 row_ror:4 row_mask:0xf bank_mask:0xf
    v_add_f32_dpp v192, v192, v192 row_ror:8 row_mask:0xf bank_mask:0xf
    s_nop 0
    v_add_f32_dpp v193, v193, v193 row_ror:8 row_mask:0xf bank_mask:0xf
    s_xor_b32 s96, s95, 524288
    s_add_u32 s82, s96, s90
    s_add_u32 m0, s83, 32768
    s_nop 0
    buffer_load_dwordx4 v26, s[44:47], s82 offen lds
    v_mov_b32 v194, v192
    v_mov_b32 v195, v193
    s_nop 0
    v_permlane16_swap_b32 v192, v194
    s_xor_b32 s96, s95, 655360
    s_add_u32 s82, s96, s90
    s_add_u32 m0, s83, 40960
    s_nop 0
    buffer_load_dwordx4 v26, s[44:47], s82 offen lds
    v_permlane16_swap_b32 v193, v195
    v_pk_add_f32 v[192:193], v[192:193], v[194:195]
    v_cvt_pk_bf16_f32 v192, v192, v193
    ds_write_b32 v6, v192
    s_waitcnt lgkmcnt(0)
    s_barrier
    ds_read_b128 v[196:199], v7
    ds_read_b128 v[200:203], v7 offset:32
    ds_read_b128 v[204:207], v7 offset:64
    ds_read_b128 v[208:211], v7 offset:96
    s_lshr_b32 s96, s8, 2
    s_lshl1_add_u32 s97, s9, s96
    s_and_b32 s98, s8, 3
    s_lshl2_add_u32 s99, s97, s98
    s_lshl_b32 s96, s99, 9
    s_add_u32 s18, s96, 131072
    s_waitcnt lgkmcnt(0)
    s_lshl3_add_u32 s96, s11, s3
    s_lshl_b32 s97, s96, 11
    s_add_u32 s13, s97, 29360128
    s_load_dwordx2 s[24:25], s[32:33], s92 offset:3584 glc
    v_mfma_f32_32x32x16_bf16 v[136:151], v[196:199], v[152:155], 0
    v_mfma_f32_32x32x16_bf16 v[136:151], v[200:203], v[156:159], v[136:151]
    v_mfma_f32_32x32x16_bf16 v[136:151], v[204:207], v[160:163], v[136:151]
    v_mfma_f32_32x32x16_bf16 v[136:151], v[208:211], v[164:167], v[136:151]
    s_nop 11
    v_cvt_pk_bf16_f32 v136, 0, v136
    v_add_f32 v136, 0x358637bd, v136
    v_cvt_pk_bf16_f32 v136, 0, v136
    v_rcp_f32 v136, v136
    s_branch SCHK_20
SPOLL_19:
    s_load_dwordx2 s[24:25], s[32:33], s92 offset:3584 glc
SCHK_20:
    s_add_u32 s5, s5, 1
    s_cmp_ge_u32 s5, 200000
    s_waitcnt lgkmcnt(0)
    s_cbranch_scc1 SDONE_21
    s_cmp_lg_u32 s24, s4
    s_cbranch_scc1 SPOLL_19
    s_cmp_lg_u32 s25, s4
    s_cbranch_scc1 SPOLL_19
SDONE_21:
    buffer_load_dwordx4 v[228:231], v2, s[32:35], s13 offen sc1
    buffer_load_dwordx4 v[232:235], v2, s[32:35], s13 offen offset:1024 sc1
    s_waitcnt vmcnt(0)
    v_bitop3_b32 v4, v229, v231, s4 bitop3:0x7e
    v_bitop3_b32 v4, v4, v233, s4 bitop3:0xf6
    v_bitop3_b32 v4, v4, v235, s4 bitop3:0xf6
    v_cmp_ne_u32 vcc, 0, v4
    s_cbranch_vccz TOK_23
POLL_24:
    buffer_load_dwordx4 v[228:231], v2, s[32:35], s13 offen sc1
    buffer_load_dwordx4 v[232:235], v2, s[32:35], s13 offen offset:1024 sc1
    s_waitcnt vmcnt(0)
    v_bitop3_b32 v4, v229, v231, s4 bitop3:0x7e
    v_bitop3_b32 v4, v4, v233, s4 bitop3:0xf6
    v_bitop3_b32 v4, v4, v235, s4 bitop3:0xf6
    v_cmp_ne_u32 vcc, 0, v4
    s_cbranch_vccz PDONE_25
    s_add_u32 s5, s5, 1
    s_cmp_lt_u32 s5, 200000
    s_cbranch_scc1 POLL_24
PDONE_25:
TOK_23:
L_PAD7:
    s_cbranch_execz L_RET7
    ds_write2_b32 v5, v228, v230 offset0:0 offset1:1
    ds_write2_b32 v5, v232, v234 offset0:64 offset1:65
    s_waitcnt lgkmcnt(0)
    s_barrier
    ds_read_b128 v[212:215], v44
    ds_read_b128 v[216:219], v44 offset:1024
    ds_read_b128 v[220:223], v44 offset:2048
    ds_read_b128 v[224:227], v44 offset:3072
    s_lshl_b32 s96, s77, 1
    s_lshl3_add_u32 s97, s10, s96
    s_lshl_b32 s98, s97, 5
    s_lshl1_add_u32 s99, s11, s98
    s_add_u32 s96, s99, s76
    s_lshl_b32 s97, s96, 10
    s_add_u32 s13, s97, 8388608
    v_and_b32 v47, 15, v1
    v_lshlrev_b32 v47, 4, v47
    v_bfe_u32 v9, v1, 4, 1
    v_lshl_add_u32 v47, v9, 15, v47
    v_lshrrev_b32 v9, 5, v1
    v_lshl_add_u32 v47, v9, 8, v47
    s_waitcnt lgkmcnt(3)
    v_mfma_f32_32x32x16_bf16 v[120:135], v[212:215], v[152:155], 0
    s_waitcnt lgkmcnt(2)
    v_mfma_f32_32x32x16_bf16 v[120:135], v[216:219], v[156:159], v[120:135]
    s_waitcnt lgkmcnt(1)
    v_mfma_f32_32x32x16_bf16 v[120:135], v[220:223], v[160:163], v[120:135]
    s_waitcnt lgkmcnt(0)
    v_mfma_f32_32x32x16_bf16 v[120:135], v[224:227], v[164:167], v[120:135]
    s_lshr_b32 s96, s3, 1
    s_lshl4_add_u32 s97, s96, s12
    s_lshl_b32 s98, s97, 11
    s_and_b32 s99, s3, 1
    s_lshl_b32 s96, s99, 10
    s_add_u32 s97, s98, s96
    s_add_u32 s18, s97, 131072
    s_lshl_b32 s19, s12, 7
    v_and_b32 v44, 3, v1
    v_lshl_add_u32 v44, v44, 1, s19
    v_lshrrev_b32 v9, 5, v1
    v_lshl_add_u32 v44, v9, 3, v44
    v_bfe_u32 v9, v1, 4, 1
    v_lshl_add_u32 v44, v9, 4, v44
    v_bfe_u32 v9, v1, 2, 2
    v_lshl_add_u32 v44, v9, 5, v44
    global_load_ushort v32, v44, s[78:79]
    v_cvt_pk_bf16_f32 v120, 0, v120
    v_cvt_pk_bf16_f32 v121, 0, v121
    v_cvt_pk_bf16_f32 v122, 0, v122
    v_cvt_pk_bf16_f32 v123, 0, v123
    v_cvt_pk_bf16_f32 v124, 0, v124
    v_cvt_pk_bf16_f32 v125, 0, v125
    v_cvt_pk_bf16_f32 v126, 0, v126
    v_cvt_pk_bf16_f32 v127, 0, v127
    v_pk_mul_f32 v[120:121], v[120:121], v[136:137] op_sel_hi:[1,0]
    v_pk_mul_f32 v[122:123], v[122:123], v[136:137] op_sel_hi:[1,0]
    v_pk_mul_f32 v[124:125], v[124:125], v[136:137] op_sel_hi:[1,0]
    v_pk_mul_f32 v[126:127], v[126:127], v[136:137] op_sel_hi:[1,0]
    v_cvt_pk_bf16_f32 v168, v120, v121
    v_cvt_pk_bf16_f32 v169, v122, v123
    v_cvt_pk_bf16_f32 v170, v124, v125
    v_cvt_pk_bf16_f32 v171, v126, v127
    buffer_store_dwordx4 v[168:171], v47, s[32:35], s13 offen sc1
    v_cvt_pk_bf16_f32 v128, 0, v128
    v_cvt_pk_bf16_f32 v129, 0, v129
    v_cvt_pk_bf16_f32 v130, 0, v130
    v_cvt_pk_bf16_f32 v131, 0, v131
    v_cvt_pk_bf16_f32 v132, 0, v132
    v_cvt_pk_bf16_f32 v133, 0, v133
    v_cvt_pk_bf16_f32 v134, 0, v134
    v_cvt_pk_bf16_f32 v135, 0, v135
    v_pk_mul_f32 v[128:129], v[128:129], v[136:137] op_sel_hi:[1,0]
    v_pk_mul_f32 v[130:131], v[130:131], v[136:137] op_sel_hi:[1,0]
    v_pk_mul_f32 v[132:133], v[132:133], v[136:137] op_sel_hi:[1,0]
    v_pk_mul_f32 v[134:135], v[134:135], v[136:137] op_sel_hi:[1,0]
    v_cvt_pk_bf16_f32 v172, v128, v129
    v_cvt_pk_bf16_f32 v173, v130, v131
    v_cvt_pk_bf16_f32 v174, v132, v133
    v_cvt_pk_bf16_f32 v175, v134, v135
    buffer_store_dwordx4 v[172:175], v47, s[32:35], s13 offen offset:512 sc1
    buffer_load_dwordx4 v[28:31], v2, s[32:35], s18 offen sc1
    v_mov_b32 v50, -1
    v_mov_b32 v51, -1
    v_mov_b32 v52, -1
    v_mov_b32 v53, -1
    s_lshl3_add_u32 s96, s21, s3
    s_lshl4_add_u32 s97, s96, s12
    s_lshl_b32 s98, s97, 8
    s_add_u32 s19, s98, 12582912
    v_lshlrev_b32 v54, 2, v1
    buffer_store_dword v50, v54, s[32:35], s19 offen sc1
    s_lshl_b32 s96, s21, 14
    s_lshl_b32 s97, s12, 9
    s_add_u32 s98, s96, s97
    s_add_u32 s19, s98, 13631488
    v_and_b32 v54, 31, v1
    v_lshlrev_b32 v54, 4, v54
    v_lshrrev_b32 v55, 5, v1
    v_lshl_add_u32 v54, v55, 13, v54
    s_cmp_lg_u32 s3, 5
    s_cbranch_scc1 L_NOPO
    buffer_store_dwordx4 v[50:53], v54, s[32:35], s19 offen sc1
L_NOPO:
    v_bfe_u32 v36, v1, 2, 2
    v_lshlrev_b32 v36, 7, v36
    v_lshrrev_b32 v9, 4, v1
    v_lshl_add_u32 v36, v9, 10, v36
    v_and_b32 v9, 1, v1
    v_lshl_add_u32 v36, v9, 4, v36
    v_bfe_u32 v9, v1, 1, 1
    v_lshl_add_u32 v36, v9, 3, v36
    v_bfe_u32 v9, v1, 3, 2
    v_lshl_add_u32 v36, v9, 5, v36
    s_and_b32 s96, s9, 1
    s_lshl_b32 s97, s96, 2
    s_xor_b32 s98, s3, s97
    s_lshl_b32 s17, s98, 12
    s_lshl_b32 s96, s17, 2
    s_lshr_b32 s97, s95, 4
    s_xor_b32 s14, s96, s97
    v_add_u32 v36, s14, v36
    v_xor_b32 v37, 32, v36
    v_xor_b32 v38, 64, v36
    v_xor_b32 v39, 96, v36
    v_and_b32 v5, 7, v1
    v_lshlrev_b32 v5, 15, v5
    v_bfe_u32 v9, v1, 3, 1
    v_lshl_add_u32 v5, v9, 12, v5
    s_and_b32 s96, s11, 1
    s_lshr_b32 s97, s10, 2
    s_and_b32 s98, s10, 3
    s_lshl_b32 s99, s98, 6
    s_lshl1_add_u32 s98, s97, s99
    s_lshl_b32 s97, s98, 12
    s_lshr_b32 s99, s11, 1
    s_lshl_b32 s98, s99, 6
    s_add_u32 s99, s97, s98
    s_lshl2_add_u32 s97, s96, s99
    s_add_u32 s98, s97, 1048576
    s_add_u32 s15, s98, 1024
    v_lshlrev_b32 v152, 16, v12
    v_and_b32 v153, s6, v12
    v_lshlrev_b32 v154, 16, v13
    v_and_b32 v155, s6, v13
    v_lshlrev_b32 v156, 16, v14
    v_and_b32 v157, s6, v14
    v_lshlrev_b32 v158, 16, v15
    v_and_b32 v159, s6, v15
    v_lshlrev_b32 v160, 16, v16
    v_and_b32 v161, s6, v16
    v_lshlrev_b32 v162, 16, v17
    v_and_b32 v163, s6, v17
    v_lshlrev_b32 v164, 16, v18
    v_and_b32 v165, s6, v18
    v_lshlrev_b32 v166, 16, v19
    v_and_b32 v167, s6, v19
    s_lshl3_add_u32 s96, s21, s3
    s_lshl_b32 s97, s96, 15
    s_add_u32 s19, s97, 8388608
    s_and_b32 s96, s3, 1
    s_lshr_b32 s97, s3, 1
    s_lshl_b32 s98, s97, 10
    s_lshl3_add_u32 s99, s96, s98
    s_add_u32 s14, s99, 159744
    v_and_b32 v4, 31, v1
    v_lshl_add_u32 v4, v4, 5, s14
    v_lshrrev_b32 v9, 5, v1
    v_lshl_add_u32 v4, v9, 2, v4
    v_and_b32 v7, 3, v1
    v_lshlrev_b32 v7, 4, v7
    v_lshrrev_b32 v9, 5, v1
    v_lshl_add_u32 v7, v9, 6, v7
    v_bfe_u32 v9, v1, 4, 1
    v_lshl_add_u32 v7, v9, 7, v7
    v_bfe_u32 v9, v1, 2, 2
    v_lshl_add_u32 v7, v9, 8, v7
    v_add_u32 v7, 159744, v7
    s_waitcnt vmcnt(2)
    s_waitcnt lgkmcnt(0)
    s_barrier
    s_cmp_lg_u32 s3, 0
    s_cbranch_scc1 L_PD
    v_mov_b32 v6, s4
    s_mov_b32 exec_hi, 0
    s_mov_b32 exec_lo, 65535
    buffer_store_dword v6, v5, s[32:35], s15 offen sc1
    s_mov_b64 exec, -1
L_PD:
    s_waitcnt vmcnt(1)
    v_bitop3_b32 v6, v29, v31, s4 bitop3:0x7e
    v_cmp_ne_u32 vcc, 0, v6
    s_cbranch_vccz L_MGOK
POLL_26:
    buffer_load_dwordx4 v[28:31], v2, s[32:35], s18 offen sc1
    s_waitcnt vmcnt(0)
    v_bitop3_b32 v6, v29, v31, s4 bitop3:0x7e
    v_cmp_ne_u32 vcc, 0, v6
    s_cbranch_vccz PDONE_27
    s_add_u32 s5, s5, 1
    s_cmp_lt_u32 s5, 200000
    s_cbranch_scc1 POLL_26
PDONE_27:
L_MGOK:
    ds_write2_b32 v4, v28, v30 offset0:0 offset1:4
    s_waitcnt lgkmcnt(0)
    s_barrier
    s_lshl_b32 s96, s2, 12
    s_lshr_b32 s97, s17, 6
    s_add_u32 s98, s96, s97
    s_add_u32 s99, s98, 1048576
    s_add_u32 s18, s99, 1024
    ds_read_b128 v[192:195], v7
    ds_read_b128 v[196:199], v7 offset:1024
    ds_read_b128 v[200:203], v7 offset:2048
    ds_read_b128 v[204:207], v7 offset:3072
    v_and_b32 v8, 3, v1
    v_lshlrev_b32 v8, 2, v8
    v_lshrrev_b32 v9, 5, v1
    v_lshl_add_u32 v8, v9, 4, v8
    v_bfe_u32 v9, v1, 4, 1
    v_lshl_add_u32 v8, v9, 5, v8
    v_bfe_u32 v9, v1, 2, 2
    v_lshl_add_u32 v8, v9, 6, v8
    v_add_u32 v8, 157184, v8
    s_lshl4_add_u32 s96, s21, s12
    s_lshl_b32 s97, s96, 6
    s_add_u32 s13, s97, 14155776
    s_waitcnt lgkmcnt(0)
    s_load_dwordx2 s[24:25], s[32:33], s18 offset:0 glc
    v_pk_add_f32 v[192:193], v[192:193], v[194:195]
    v_add_f32 v28, v192, v193
    v_pk_add_f32 v[196:197], v[196:197], v[198:199]
    v_add_f32 v29, v196, v197
    v_pk_add_f32 v[200:201], v[200:201], v[202:203]
    v_add_f32 v30, v200, v201
    v_pk_add_f32 v[204:205], v[204:205], v[206:207]
    v_add_f32 v31, v204, v205
    v_cvt_pk_bf16_f32 v28, 0, v28
    v_cvt_pk_bf16_f32 v29, 0, v29
    v_cvt_pk_bf16_f32 v30, 0, v30
    v_cvt_pk_bf16_f32 v31, 0, v31
    v_add_f32 v30, 1.0, v30
    v_lshlrev_b32 v32, 16, v32
    v_cvt_pk_bf16_f32 v30, 0, v30
    ds_write_b32 v8, v31
    v_mul_f32 v192, v30, v32
    v_cvt_pk_bf16_f32 v193, 0, v192
    v_sub_f32 v194, v192, v193
    v_add_f32_dpp v192, v192, v192 quad_perm:[1,0,3,2] row_mask:0xf bank_mask:0xf
    s_nop 1
    v_add_f32_dpp v192, v192, v192 quad_perm:[2,3,0,1] row_mask:0xf bank_mask:0xf
    s_nop 1
    v_add_f32_dpp v192, v192, v192 row_half_mirror row_mask:0xf bank_mask:0xf
    s_nop 1
    v_add_f32_dpp v192, v192, v192 row_ror:8 row_mask:0xf bank_mask:0xf
    v_mov_b32 v199, v192
    s_nop 1
    v_permlane16_swap_b32 v192, v199
    v_add_f32 v192, v192, v199
    v_mov_b32 v199, v192
    s_nop 1
    v_permlane32_swap_b32 v192, v199
    v_add_f32 v192, v192, v199
    v_mov_b32_dpp v196, v193 row_shl:1 row_mask:0xf bank_mask:0xf
    v_mov_b32_dpp v197, v194 row_shl:1 row_mask:0xf bank_mask:0xf
    v_mov_b32_dpp v198, v32 row_shl:1 row_mask:0xf bank_mask:0xf
    v_cvt_pk_bf16_f32 v196, v193, v196
    v_cvt_pk_bf16_f32 v197, v194, v197
    v_cvt_pk_bf16_f32 v198, v32, v198
    v_mov_b32 v193, s4
    v_mov_b32 v194, 0
    s_cmp_lg_u32 s3, 2
    s_cbranch_scc1 L_NOUP
    s_mov_b64 exec, 1
    buffer_store_dwordx2 v[192:193], v194, s[32:35], s13 offen sc1
    s_mov_b64 exec, -1
L_NOUP:
    v_mov_b32 v184, 0x3f803f80
    s_nop 1
    v_mov_b32_dpp v184, v196 row_newbcast:0 row_mask:0xf bank_mask:0x2
    s_nop 1
    v_mov_b32_dpp v184, v197 row_newbcast:0 row_mask:0xf bank_mask:0x4
    s_nop 1
    v_mov_b32_dpp v184, v198 row_newbcast:0 row_mask:0xf bank_mask:0x8
    v_mov_b32 v185, 0x3f803f80
    s_nop 1
    v_mov_b32_dpp v185, v196 row_newbcast:2 row_mask:0xf bank_mask:0x2
    s_nop 1
    v_mov_b32_dpp v185, v197 row_newbcast:2 row_mask:0xf bank_mask:0x4
    s_nop 1
    v_mov_b32_dpp v185, v198 row_newbcast:2 row_mask:0xf bank_mask:0x8
    v_mov_b32 v186, 0x3f803f80
    s_nop 1
    v_mov_b32_dpp v186, v196 row_newbcast:4 row_mask:0xf bank_mask:0x2
    s_nop 1
    v_mov_b32_dpp v186, v197 row_newbcast:4 row_mask:0xf bank_mask:0x4
    s_nop 1
    v_mov_b32_dpp v186, v198 row_newbcast:4 row_mask:0xf bank_mask:0x8
    v_mov_b32 v187, 0x3f803f80
    s_nop 1
    v_mov_b32_dpp v187, v196 row_newbcast:6 row_mask:0xf bank_mask:0x2
    s_nop 1
    v_mov_b32_dpp v187, v197 row_newbcast:6 row_mask:0xf bank_mask:0x4
    s_nop 1
    v_mov_b32_dpp v187, v198 row_newbcast:6 row_mask:0xf bank_mask:0x8
    v_mov_b32 v188, 0x3f803f80
    s_nop 1
    v_mov_b32_dpp v188, v196 row_newbcast:8 row_mask:0xf bank_mask:0x2
    s_nop 1
    v_mov_b32_dpp v188, v197 row_newbcast:8 row_mask:0xf bank_mask:0x4
    s_nop 1
    v_mov_b32_dpp v188, v198 row_newbcast:8 row_mask:0xf bank_mask:0x8
    v_mov_b32 v189, 0x3f803f80
    s_nop 1
    v_mov_b32_dpp v189, v196 row_newbcast:10 row_mask:0xf bank_mask:0x2
    s_nop 1
    v_mov_b32_dpp v189, v197 row_newbcast:10 row_mask:0xf bank_mask:0x4
    s_nop 1
    v_mov_b32_dpp v189, v198 row_newbcast:10 row_mask:0xf bank_mask:0x8
    v_mov_b32 v190, 0x3f803f80
    s_nop 1
    v_mov_b32_dpp v190, v196 row_newbcast:12 row_mask:0xf bank_mask:0x2
    s_nop 1
    v_mov_b32_dpp v190, v197 row_newbcast:12 row_mask:0xf bank_mask:0x4
    s_nop 1
    v_mov_b32_dpp v190, v198 row_newbcast:12 row_mask:0xf bank_mask:0x8
    v_mov_b32 v191, 0x3f803f80
    s_nop 1
    v_mov_b32_dpp v191, v196 row_newbcast:14 row_mask:0xf bank_mask:0x2
    s_nop 1
    v_mov_b32_dpp v191, v197 row_newbcast:14 row_mask:0xf bank_mask:0x4
    s_nop 1
    v_mov_b32_dpp v191, v198 row_newbcast:14 row_mask:0xf bank_mask:0x8
    v_mov_b32 v42, v29
    v_mov_b32 v43, v31
    v_mov_b32 v33, v30
    v_mov_b32_dpp v136, v28 row_newbcast:0 row_mask:0xf bank_mask:0xf
    v_mov_b32_dpp v137, v28 row_newbcast:1 row_mask:0xf bank_mask:0xf
    v_mov_b32_dpp v138, v28 row_newbcast:2 row_mask:0xf bank_mask:0xf
    v_mov_b32_dpp v139, v28 row_newbcast:3 row_mask:0xf bank_mask:0xf
    v_mov_b32_dpp v140, v28 row_newbcast:4 row_mask:0xf bank_mask:0xf
    v_mov_b32_dpp v141, v28 row_newbcast:5 row_mask:0xf bank_mask:0xf
    v_mov_b32_dpp v142, v28 row_newbcast:6 row_mask:0xf bank_mask:0xf
    v_mov_b32_dpp v143, v28 row_newbcast:7 row_mask:0xf bank_mask:0xf
    v_mov_b32_dpp v144, v28 row_newbcast:8 row_mask:0xf bank_mask:0xf
    v_mov_b32_dpp v145, v28 row_newbcast:9 row_mask:0xf bank_mask:0xf
    v_mov_b32_dpp v146, v28 row_newbcast:10 row_mask:0xf bank_mask:0xf
    v_mov_b32_dpp v147, v28 row_newbcast:11 row_mask:0xf bank_mask:0xf
    v_mov_b32_dpp v148, v28 row_newbcast:12 row_mask:0xf bank_mask:0xf
    v_mov_b32_dpp v149, v28 row_newbcast:13 row_mask:0xf bank_mask:0xf
    v_mov_b32_dpp v150, v28 row_newbcast:14 row_mask:0xf bank_mask:0xf
    v_mov_b32_dpp v151, v28 row_newbcast:15 row_mask:0xf bank_mask:0xf
    s_branch SCHK_29
SPOLL_28:
    s_load_dwordx2 s[24:25], s[32:33], s18 offset:0 glc
SCHK_29:
    s_add_u32 s5, s5, 1
    s_cmp_ge_u32 s5, 200000
    s_waitcnt lgkmcnt(0)
    s_cbranch_scc1 SDONE_30
    s_cmp_lg_u32 s24, s4
    s_cbranch_scc1 SPOLL_28
    s_cmp_lg_u32 s25, s4
    s_cbranch_scc1 SPOLL_28
SDONE_30:
    s_add_u32 s20, s17, s19
    buffer_load_dwordx4 v[224:227], v2, s[32:35], s20 offen sc1
    ds_read_b64_tr_b16 v[192:193], v36
    ds_read_b64_tr_b16 v[194:195], v36 offset:512
    ds_read_b64_tr_b16 v[196:197], v37
    ds_read_b64_tr_b16 v[198:199], v37 offset:512
    ds_read_b64_tr_b16 v[200:201], v38
    ds_read_b64_tr_b16 v[202:203], v38 offset:512
    ds_read_b64_tr_b16 v[204:205], v39
    ds_read_b64_tr_b16 v[206:207], v39 offset:512
    ds_read_b64_tr_b16 v[208:209], v36 offset:4096
    ds_read_b64_tr_b16 v[210:211], v36 offset:4608
    ds_read_b64_tr_b16 v[212:213], v37 offset:4096
    ds_read_b64_tr_b16 v[214:215], v37 offset:4608
    ds_read_b64_tr_b16 v[216:217], v38 offset:4096
    ds_read_b64_tr_b16 v[218:219], v38 offset:4608
    buffer_load_dwordx4 v[228:231], v2, s[32:35], s20 offen offset:1024 sc1
    buffer_load_dwordx4 v[232:235], v2, s[32:35], s20 offen offset:2048 sc1
    buffer_load_dwordx4 v[236:239], v2, s[32:35], s20 offen offset:3072 sc1
    s_barrier
    s_xor_b32 s96, s17, 4096
    s_add_u32 s20, s96, s19
    buffer_load_dwordx4 v[240:243], v2, s[32:35], s20 offen sc1
    buffer_load_dwordx4 v[244:247], v2, s[32:35], s20 offen offset:1024 sc1
    buffer_load_dwordx4 v[44:47], v2, s[32:35], s20 offen offset:2048 sc1
    buffer_load_dwordx4 v[48:51], v2, s[32:35], s20 offen offset:3072 sc1
    s_lshl_b32 s96, s21, 10
    s_add_u32 s13, s96, 14155776
    v_and_b32 v10, 15, v1
    v_lshlrev_b32 v10, 6, v10
    s_cmp_lt_u32 s3, 4
    s_cbranch_scc1 L_G2P0
    s_setprio 1
L_G2P0:
    s_waitcnt vmcnt(7)
    s_waitcnt lgkmcnt(6)
    v_mfma_f32_16x16x32_bf16 v[120:123], v[192:195], v[224:227], 0
    ds_read_b64_tr_b16 v[220:221], v39 offset:4096
    ds_read_b64_tr_b16 v[222:223], v39 offset:4608
    v_mfma_f32_16x16x32_bf16 v[124:127], v[196:199], v[224:227], 0
    ds_read_b64_tr_b16 v[192:193], v36 offset:8192
    ds_read_b64_tr_b16 v[194:195], v36 offset:8704
    v_mfma_f32_16x16x32_bf16 v[128:131], v[200:203], v[224:227], 0
    ds_read_b64_tr_b16 v[196:197], v37 offset:8192
    ds_read_b64_tr_b16 v[198:199], v37 offset:8704
    v_mfma_f32_16x16x32_bf16 v[132:135], v[204:207], v[224:227], 0
    ds_read_b64_tr_b16 v[200:201], v38 offset:8192
    ds_read_b64_tr_b16 v[202:203], v38 offset:8704
    s_xor_b32 s96, s17, 8192
    s_add_u32 s20, s96, s19
    buffer_load_dwordx4 v[224:227], v2, s[32:35], s20 offen sc1
    s_waitcnt vmcnt(7)
    s_waitcnt lgkmcnt(6)
    v_mfma_f32_16x16x32_bf16 v[120:123], v[208:211], v[228:231], v[120:123]
    ds_read_b64_tr_b16 v[204:205], v39 offset:8192
    ds_read_b64_tr_b16 v[206:207], v39 offset:8704
    v_mfma_f32_16x16x32_bf16 v[124:127], v[212:215], v[228:231], v[124:127]
    ds_read_b64_tr_b16 v[208:209], v36 offset:12288
    ds_read_b64_tr_b16 v[210:211], v36 offset:12800
    v_xor_b32 v36, 16384, v36
    v_mfma_f32_16x16x32_bf16 v[128:131], v[216:219], v[228:231], v[128:131]
    ds_read_b64_tr_b16 v[212:213], v37 offset:12288
    ds_read_b64_tr_b16 v[214:215], v37 offset:12800
    v_xor_b32 v37, 16384, v37
    v_mfma_f32_16x16x32_bf16 v[132:135], v[220:223], v[228:231], v[132:135]
    ds_read_b64_tr_b16 v[216:217], v38 offset:12288
    ds_read_b64_tr_b16 v[218:219], v38 offset:12800
    v_xor_b32 v38, 16384, v38
    buffer_load_dwordx4 v[228:231], v2, s[32:35], s20 offen offset:1024 sc1
    s_waitcnt vmcnt(7)
    s_waitcnt lgkmcnt(6)
    v_mfma_f32_16x16x32_bf16 v[120:123], v[192:195], v[232:235], v[120:123]
    ds_read_b64_tr_b16 v[220:221], v39 offset:12288
    ds_read_b64_tr_b16 v[222:223], v39 offset:12800
    v_xor_b32 v39, 16384, v39
    v_mfma_f32_16x16x32_bf16 v[124:127], v[196:199], v[232:235], v[124:127]
    ds_read_b64_tr_b16 v[192:193], v36
    ds_read_b64_tr_b16 v[194:195], v36 offset:512
    v_mfma_f32_16x16x32_bf16 v[128:131], v[200:203], v[232:235], v[128:131]
    ds_read_b64_tr_b16 v[196:197], v37
    ds_read_b64_tr_b16 v[198:199], v37 offset:512
    v_mfma_f32_16x16x32_bf16 v[132:135], v[204:207], v[232:235], v[132:135]
    ds_read_b64_tr_b16 v[200:201], v38
    ds_read_b64_tr_b16 v[202:203], v38 offset:512
    buffer_load_dwordx4 v[232:235], v2, s[32:35], s20 offen offset:2048 sc1
    s_waitcnt vmcnt(7)
    s_waitcnt lgkmcnt(6)
    v_mfma_f32_16x16x32_bf16 v[120:123], v[208:211], v[236:239], v[120:123]
    ds_read_b64_tr_b16 v[204:205], v39
    ds_read_b64_tr_b16 v[206:207], v39 offset:512
    v_mfma_f32_16x16x32_bf16 v[124:127], v[212:215], v[236:239], v[124:127]
    ds_read_b64_tr_b16 v[208:209], v36 offset:4096
    ds_read_b64_tr_b16 v[210:211], v36 offset:4608
    v_mfma_f32_16x16x32_bf16 v[128:131], v[216:219], v[236:239], v[128:131]
    ds_read_b64_tr_b16 v[212:213], v37 offset:4096
    ds_read_b64_tr_b16 v[214:215], v37 offset:4608
    v_mfma_f32_16x16x32_bf16 v[132:135], v[220:223], v[236:239], v[132:135]
    ds_read_b64_tr_b16 v[216:217], v38 offset:4096
    ds_read_b64_tr_b16 v[218:219], v38 offset:4608
    buffer_load_dwordx4 v[236:239], v2, s[32:35], s20 offen offset:3072 sc1
    s_waitcnt vmcnt(7)
    s_waitcnt lgkmcnt(6)
    v_mfma_f32_16x16x32_bf16 v[120:123], v[192:195], v[240:243], v[120:123]
    ds_read_b64_tr_b16 v[220:221], v39 offset:4096
    ds_read_b64_tr_b16 v[222:223], v39 offset:4608
    v_mfma_f32_16x16x32_bf16 v[124:127], v[196:199], v[240:243], v[124:127]
    ds_read_b64_tr_b16 v[192:193], v36 offset:8192
    ds_read_b64_tr_b16 v[194:195], v36 offset:8704
    v_mfma_f32_16x16x32_bf16 v[128:131], v[200:203], v[240:243], v[128:131]
    ds_read_b64_tr_b16 v[196:197], v37 offset:8192
    ds_read_b64_tr_b16 v[198:199], v37 offset:8704
    v_mfma_f32_16x16x32_bf16 v[132:135], v[204:207], v[240:243], v[132:135]
    ds_read_b64_tr_b16 v[200:201], v38 offset:8192
    ds_read_b64_tr_b16 v[202:203], v38 offset:8704
    s_xor_b32 s96, s17, 12288
    s_add_u32 s20, s96, s19
    buffer_load_dwordx4 v[240:243], v2, s[32:35], s20 offen sc1
    s_waitcnt vmcnt(7)
    s_waitcnt lgkmcnt(6)
    v_mfma_f32_16x16x32_bf16 v[120:123], v[208:211], v[244:247], v[120:123]
    ds_read_b64_tr_b16 v[204:205], v39 offset:8192
    ds_read_b64_tr_b16 v[206:207], v39 offset:8704
    v_mfma_f32_16x16x32_bf16 v[124:127], v[212:215], v[244:247], v[124:127]
    ds_read_b64_tr_b16 v[208:209], v36 offset:12288
    ds_read_b64_tr_b16 v[210:211], v36 offset:12800
    v_xor_b32 v36, 49152, v36
    v_mfma_f32_16x16x32_bf16 v[128:131], v[216:219], v[244:247], v[128:131]
    ds_read_b64_tr_b16 v[212:213], v37 offset:12288
    ds_read_b64_tr_b16 v[214:215], v37 offset:12800
    v_xor_b32 v37, 49152, v37
    v_mfma_f32_16x16x32_bf16 v[132:135], v[220:223], v[244:247], v[132:135]
    ds_read_b64_tr_b16 v[216:217], v38 offset:12288
    ds_read_b64_tr_b16 v[218:219], v38 offset:12800
    v_xor_b32 v38, 49152, v38
    buffer_load_dwordx4 v[244:247], v2, s[32:35], s20 offen offset:1024 sc1
    s_waitcnt vmcnt(7)
    s_waitcnt lgkmcnt(6)
    v_mfma_f32_16x16x32_bf16 v[120:123], v[192:195], v[44:47], v[120:123]
    ds_read_b64_tr_b16 v[220:221], v39 offset:12288
    ds_read_b64_tr_b16 v[222:223], v39 offset:12800
    v_xor_b32 v39, 49152, v39
    v_mfma_f32_16x16x32_bf16 v[124:127], v[196:199], v[44:47], v[124:127]
    ds_read_b64_tr_b16 v[192:193], v36
    ds_read_b64_tr_b16 v[194:195], v36 offset:512
    v_mfma_f32_16x16x32_bf16 v[128:131], v[200:203], v[44:47], v[128:131]
    ds_read_b64_tr_b16 v[196:197], v37
    ds_read_b64_tr_b16 v[198:199], v37 offset:512
    v_mfma_f32_16x16x32_bf16 v[132:135], v[204:207], v[44:47], v[132:135]
    ds_read_b64_tr_b16 v[200:201], v38
    ds_read_b64_tr_b16 v[202:203], v38 offset:512
    buffer_load_dwordx4 v[44:47], v2, s[32:35], s20 offen offset:2048 sc1
    s_waitcnt vmcnt(7)
    s_waitcnt lgkmcnt(6)
    v_mfma_f32_16x16x32_bf16 v[120:123], v[208:211], v[48:51], v[120:123]
    ds_read_b64_tr_b16 v[204:205], v39
    ds_read_b64_tr_b16 v[206:207], v39 offset:512
    v_mfma_f32_16x16x32_bf16 v[124:127], v[212:215], v[48:51], v[124:127]
    ds_read_b64_tr_b16 v[208:209], v36 offset:4096
    ds_read_b64_tr_b16 v[210:211], v36 offset:4608
    v_mfma_f32_16x16x32_bf16 v[128:131], v[216:219], v[48:51], v[128:131]
    ds_read_b64_tr_b16 v[212:213], v37 offset:4096
    ds_read_b64_tr_b16 v[214:215], v37 offset:4608
    v_mfma_f32_16x16x32_bf16 v[132:135], v[220:223], v[48:51], v[132:135]
    ds_read_b64_tr_b16 v[216:217], v38 offset:4096
    ds_read_b64_tr_b16 v[218:219], v38 offset:4608
    buffer_load_dwordx4 v[48:51], v2, s[32:35], s20 offen offset:3072 sc1
    s_waitcnt vmcnt(7)
    s_waitcnt lgkmcnt(6)
    v_mfma_f32_16x16x32_bf16 v[120:123], v[192:195], v[224:227], v[120:123]
    ds_read_b64_tr_b16 v[220:221], v39 offset:4096
    ds_read_b64_tr_b16 v[222:223], v39 offset:4608
    v_mfma_f32_16x16x32_bf16 v[124:127], v[196:199], v[224:227], v[124:127]
    ds_read_b64_tr_b16 v[192:193], v36 offset:8192
    ds_read_b64_tr_b16 v[194:195], v36 offset:8704
    v_mfma_f32_16x16x32_bf16 v[128:131], v[200:203], v[224:227], v[128:131]
    ds_read_b64_tr_b16 v[196:197], v37 offset:8192
    ds_read_b64_tr_b16 v[198:199], v37 offset:8704
    v_mfma_f32_16x16x32_bf16 v[132:135], v[204:207], v[224:227], v[132:135]
    ds_read_b64_tr_b16 v[200:201], v38 offset:8192
    ds_read_b64_tr_b16 v[202:203], v38 offset:8704
    s_xor_b32 s96, s17, 16384
    s_add_u32 s20, s96, s19
    buffer_load_dwordx4 v[224:227], v2, s[32:35], s20 offen sc1
    s_waitcnt vmcnt(7)
    s_waitcnt lgkmcnt(6)
    v_mfma_f32_16x16x32_bf16 v[120:123], v[208:211], v[228:231], v[120:123]
    ds_read_b64_tr_b16 v[204:205], v39 offset:8192
    ds_read_b64_tr_b16 v[206:207], v39 offset:8704
    v_mfma_f32_16x16x32_bf16 v[124:127], v[212:215], v[228:231], v[124:127]
    ds_read_b64_tr_b16 v[208:209], v36 offset:12288
    ds_read_b64_tr_b16 v[210:211], v36 offset:12800
    v_xor_b32 v36, 16384, v36
    v_mfma_f32_16x16x32_bf16 v[128:131], v[216:219], v[228:231], v[128:131]
    ds_read_b64_tr_b16 v[212:213], v37 offset:12288
    ds_read_b64_tr_b16 v[214:215], v37 offset:12800
    v_xor_b32 v37, 16384, v37
    v_mfma_f32_16x16x32_bf16 v[132:135], v[220:223], v[228:231], v[132:135]
    ds_read_b64_tr_b16 v[216:217], v38 offset:12288
    ds_read_b64_tr_b16 v[218:219], v38 offset:12800
    v_xor_b32 v38, 16384, v38
    buffer_load_dwordx4 v[228:231], v2, s[32:35], s20 offen offset:1024 sc1
    s_waitcnt vmcnt(7)
    s_waitcnt lgkmcnt(6)
    v_mfma_f32_16x16x32_bf16 v[120:123], v[192:195], v[232:235], v[120:123]
    ds_read_b64_tr_b16 v[220:221], v39 offset:12288
    ds_read_b64_tr_b16 v[222:223], v39 offset:12800
    v_xor_b32 v39, 16384, v39
    v_mfma_f32_16x16x32_bf16 v[124:127], v[196:199], v[232:235], v[124:127]
    ds_read_b64_tr_b16 v[192:193], v36
    ds_read_b64_tr_b16 v[194:195], v36 offset:512
    v_mfma_f32_16x16x32_bf16 v[128:131], v[200:203], v[232:235], v[128:131]
    ds_read_b64_tr_b16 v[196:197], v37
    ds_read_b64_tr_b16 v[198:199], v37 offset:512
    v_mfma_f32_16x16x32_bf16 v[132:135], v[204:207], v[232:235], v[132:135]
    ds_read_b64_tr_b16 v[200:201], v38
    ds_read_b64_tr_b16 v[202:203], v38 offset:512
    buffer_load_dwordx4 v[232:235], v2, s[32:35], s20 offen offset:2048 sc1
    s_waitcnt vmcnt(7)
    s_waitcnt lgkmcnt(6)
    v_mfma_f32_16x16x32_bf16 v[120:123], v[208:211], v[236:239], v[120:123]
    ds_read_b64_tr_b16 v[204:205], v39
    ds_read_b64_tr_b16 v[206:207], v39 offset:512
    v_mfma_f32_16x16x32_bf16 v[124:127], v[212:215], v[236:239], v[124:127]
    ds_read_b64_tr_b16 v[208:209], v36 offset:4096
    ds_read_b64_tr_b16 v[210:211], v36 offset:4608
    v_mfma_f32_16x16x32_bf16 v[128:131], v[216:219], v[236:239], v[128:131]
    ds_read_b64_tr_b16 v[212:213], v37 offset:4096
    ds_read_b64_tr_b16 v[214:215], v37 offset:4608
    v_mfma_f32_16x16x32_bf16 v[132:135], v[220:223], v[236:239], v[132:135]
    ds_read_b64_tr_b16 v[216:217], v38 offset:4096
    ds_read_b64_tr_b16 v[218:219], v38 offset:4608
    buffer_load_dwordx4 v[236:239], v2, s[32:35], s20 offen offset:3072 sc1
    s_waitcnt vmcnt(7)
    s_waitcnt lgkmcnt(6)
    v_mfma_f32_16x16x32_bf16 v[120:123], v[192:195], v[240:243], v[120:123]
    ds_read_b64_tr_b16 v[220:221], v39 offset:4096
    ds_read_b64_tr_b16 v[222:223], v39 offset:4608
    v_mfma_f32_16x16x32_bf16 v[124:127], v[196:199], v[240:243], v[124:127]
    ds_read_b64_tr_b16 v[192:193], v36 offset:8192
    ds_read_b64_tr_b16 v[194:195], v36 offset:8704
    v_mfma_f32_16x16x32_bf16 v[128:131], v[200:203], v[240:243], v[128:131]
    ds_read_b64_tr_b16 v[196:197], v37 offset:8192
    ds_read_b64_tr_b16 v[198:199], v37 offset:8704
    v_mfma_f32_16x16x32_bf16 v[132:135], v[204:207], v[240:243], v[132:135]
    ds_read_b64_tr_b16 v[200:201], v38 offset:8192
    ds_read_b64_tr_b16 v[202:203], v38 offset:8704
    s_xor_b32 s96, s17, 20480
    s_add_u32 s20, s96, s19
    buffer_load_dwordx4 v[240:243], v2, s[32:35], s20 offen sc1
    s_waitcnt vmcnt(7)
    s_waitcnt lgkmcnt(6)
    v_mfma_f32_16x16x32_bf16 v[120:123], v[208:211], v[244:247], v[120:123]
    ds_read_b64_tr_b16 v[204:205], v39 offset:8192
    ds_read_b64_tr_b16 v[206:207], v39 offset:8704
    v_mfma_f32_16x16x32_bf16 v[124:127], v[212:215], v[244:247], v[124:127]
    ds_read_b64_tr_b16 v[208:209], v36 offset:12288
    ds_read_b64_tr_b16 v[210:211], v36 offset:12800
    v_xor_b32 v36, 114688, v36
    v_mfma_f32_16x16x32_bf16 v[128:131], v[216:219], v[244:247], v[128:131]
    ds_read_b64_tr_b16 v[212:213], v37 offset:12288
    ds_read_b64_tr_b16 v[214:215], v37 offset:12800
    v_xor_b32 v37, 114688, v37
    v_mfma_f32_16x16x32_bf16 v[132:135], v[220:223], v[244:247], v[132:135]
    ds_read_b64_tr_b16 v[216:217], v38 offset:12288
    ds_read_b64_tr_b16 v[218:219], v38 offset:12800
    v_xor_b32 v38, 114688, v38
    buffer_load_dwordx4 v[244:247], v2, s[32:35], s20 offen offset:1024 sc1
L_PAD8:
    s_cbranch_execz L_RET8
    s_waitcnt vmcnt(7)
    s_waitcnt lgkmcnt(6)
    v_mfma_f32_16x16x32_bf16 v[120:123], v[192:195], v[44:47], v[120:123]
    ds_read_b64_tr_b16 v[220:221], v39 offset:12288
    ds_read_b64_tr_b16 v[222:223], v39 offset:12800
    v_xor_b32 v39, 114688, v39
    v_mfma_f32_16x16x32_bf16 v[124:127], v[196:199], v[44:47], v[124:127]
    ds_read_b64_tr_b16 v[192:193], v36
    ds_read_b64_tr_b16 v[194:195], v36 offset:512
    v_mfma_f32_16x16x32_bf16 v[128:131], v[200:203], v[44:47], v[128:131]
    ds_read_b64_tr_b16 v[196:197], v37
    ds_read_b64_tr_b16 v[198:199], v37 offset:512
    v_mfma_f32_16x16x32_bf16 v[132:135], v[204:207], v[44:47], v[132:135]
    ds_read_b64_tr_b16 v[200:201], v38
    ds_read_b64_tr_b16 v[202:203], v38 offset:512
    buffer_load_dwordx4 v[44:47], v2, s[32:35], s20 offen offset:2048 sc1
    s_waitcnt vmcnt(7)
    s_waitcnt lgkmcnt(6)
    v_mfma_f32_16x16x32_bf16 v[120:123], v[208:211], v[48:51], v[120:123]
    ds_read_b64_tr_b16 v[204:205], v39
    ds_read_b64_tr_b16 v[206:207], v39 offset:512
    v_mfma_f32_16x16x32_bf16 v[124:127], v[212:215], v[48:51], v[124:127]
    ds_read_b64_tr_b16 v[208:209], v36 offset:4096
    ds_read_b64_tr_b16 v[210:211], v36 offset:4608
    v_mfma_f32_16x16x32_bf16 v[128:131], v[216:219], v[48:51], v[128:131]
    ds_read_b64_tr_b16 v[212:213], v37 offset:4096
    ds_read_b64_tr_b16 v[214:215], v37 offset:4608
    v_mfma_f32_16x16x32_bf16 v[132:135], v[220:223], v[48:51], v[132:135]
    ds_read_b64_tr_b16 v[216:217], v38 offset:4096
    ds_read_b64_tr_b16 v[218:219], v38 offset:4608
    buffer_load_dwordx4 v[48:51], v2, s[32:35], s20 offen offset:3072 sc1
    s_waitcnt vmcnt(7)
    s_waitcnt lgkmcnt(6)
    v_mfma_f32_16x16x32_bf16 v[120:123], v[192:195], v[224:227], v[120:123]
    ds_read_b64_tr_b16 v[220:221], v39 offset:4096
    ds_read_b64_tr_b16 v[222:223], v39 offset:4608
    v_mfma_f32_16x16x32_bf16 v[124:127], v[196:199], v[224:227], v[124:127]
    ds_read_b64_tr_b16 v[192:193], v36 offset:8192
    ds_read_b64_tr_b16 v[194:195], v36 offset:8704
    v_mfma_f32_16x16x32_bf16 v[128:131], v[200:203], v[224:227], v[128:131]
    ds_read_b64_tr_b16 v[196:197], v37 offset:8192
    ds_read_b64_tr_b16 v[198:199], v37 offset:8704
    v_mfma_f32_16x16x32_bf16 v[132:135], v[204:207], v[224:227], v[132:135]
    ds_read_b64_tr_b16 v[200:201], v38 offset:8192
    ds_read_b64_tr_b16 v[202:203], v38 offset:8704
    s_xor_b32 s96, s17, 24576
    s_add_u32 s20, s96, s19
    buffer_load_dwordx4 v[224:227], v2, s[32:35], s20 offen sc1
    s_waitcnt vmcnt(7)
    s_waitcnt lgkmcnt(6)
    v_mfma_f32_16x16x32_bf16 v[120:123], v[208:211], v[228:231], v[120:123]
    ds_read_b64_tr_b16 v[204:205], v39 offset:8192
    ds_read_b64_tr_b16 v[206:207], v39 offset:8704
    v_mfma_f32_16x16x32_bf16 v[124:127], v[212:215], v[228:231], v[124:127]
    ds_read_b64_tr_b16 v[208:209], v36 offset:12288
    ds_read_b64_tr_b16 v[210:211], v36 offset:12800
    v_xor_b32 v36, 16384, v36
    v_mfma_f32_16x16x32_bf16 v[128:131], v[216:219], v[228:231], v[128:131]
    ds_read_b64_tr_b16 v[212:213], v37 offset:12288
    ds_read_b64_tr_b16 v[214:215], v37 offset:12800
    v_xor_b32 v37, 16384, v37
    v_mfma_f32_16x16x32_bf16 v[132:135], v[220:223], v[228:231], v[132:135]
    ds_read_b64_tr_b16 v[216:217], v38 offset:12288
    ds_read_b64_tr_b16 v[218:219], v38 offset:12800
    v_xor_b32 v38, 16384, v38
    buffer_load_dwordx4 v[228:231], v2, s[32:35], s20 offen offset:1024 sc1
    s_waitcnt vmcnt(7)
    s_waitcnt lgkmcnt(6)
    v_mfma_f32_16x16x32_bf16 v[120:123], v[192:195], v[232:235], v[120:123]
    ds_read_b64_tr_b16 v[220:221], v39 offset:12288
    ds_read_b64_tr_b16 v[222:223], v39 offset:12800
    v_xor_b32 v39, 16384, v39
    v_mfma_f32_16x16x32_bf16 v[124:127], v[196:199], v[232:235], v[124:127]
    ds_read_b64_tr_b16 v[192:193], v36
    ds_read_b64_tr_b16 v[194:195], v36 offset:512
    v_mfma_f32_16x16x32_bf16 v[128:131], v[200:203], v[232:235], v[128:131]
    ds_read_b64_tr_b16 v[196:197], v37
    ds_read_b64_tr_b16 v[198:199], v37 offset:512
    v_mfma_f32_16x16x32_bf16 v[132:135], v[204:207], v[232:235], v[132:135]
    ds_read_b64_tr_b16 v[200:201], v38
    ds_read_b64_tr_b16 v[202:203], v38 offset:512
    buffer_load_dwordx4 v[232:235], v2, s[32:35], s20 offen offset:2048 sc1
    s_waitcnt vmcnt(7)
    s_waitcnt lgkmcnt(6)
    v_mfma_f32_16x16x32_bf16 v[120:123], v[208:211], v[236:239], v[120:123]
    ds_read_b64_tr_b16 v[204:205], v39
    ds_read_b64_tr_b16 v[206:207], v39 offset:512
    v_mfma_f32_16x16x32_bf16 v[124:127], v[212:215], v[236:239], v[124:127]
    ds_read_b64_tr_b16 v[208:209], v36 offset:4096
    ds_read_b64_tr_b16 v[210:211], v36 offset:4608
    v_mfma_f32_16x16x32_bf16 v[128:131], v[216:219], v[236:239], v[128:131]
    ds_read_b64_tr_b16 v[212:213], v37 offset:4096
    ds_read_b64_tr_b16 v[214:215], v37 offset:4608
    v_mfma_f32_16x16x32_bf16 v[132:135], v[220:223], v[236:239], v[132:135]
    ds_read_b64_tr_b16 v[216:217], v38 offset:4096
    ds_read_b64_tr_b16 v[218:219], v38 offset:4608
    buffer_load_dwordx4 v[236:239], v2, s[32:35], s20 offen offset:3072 sc1
    s_waitcnt vmcnt(7)
    s_waitcnt lgkmcnt(6)
    v_mfma_f32_16x16x32_bf16 v[120:123], v[192:195], v[240:243], v[120:123]
    ds_read_b64_tr_b16 v[220:221], v39 offset:4096
    ds_read_b64_tr_b16 v[222:223], v39 offset:4608
    v_mfma_f32_16x16x32_bf16 v[124:127], v[196:199], v[240:243], v[124:127]
    ds_read_b64_tr_b16 v[192:193], v36 offset:8192
    ds_read_b64_tr_b16 v[194:195], v36 offset:8704
    v_mfma_f32_16x16x32_bf16 v[128:131], v[200:203], v[240:243], v[128:131]
    ds_read_b64_tr_b16 v[196:197], v37 offset:8192
    ds_read_b64_tr_b16 v[198:199], v37 offset:8704
    v_mfma_f32_16x16x32_bf16 v[132:135], v[204:207], v[240:243], v[132:135]
    ds_read_b64_tr_b16 v[200:201], v38 offset:8192
    ds_read_b64_tr_b16 v[202:203], v38 offset:8704
    s_xor_b32 s96, s17, 28672
    s_add_u32 s20, s96, s19
    buffer_load_dwordx4 v[240:243], v2, s[32:35], s20 offen sc1
    s_waitcnt vmcnt(7)
    s_waitcnt lgkmcnt(6)
    v_mfma_f32_16x16x32_bf16 v[120:123], v[208:211], v[244:247], v[120:123]
    ds_read_b64_tr_b16 v[204:205], v39 offset:8192
    ds_read_b64_tr_b16 v[206:207], v39 offset:8704
    v_mfma_f32_16x16x32_bf16 v[124:127], v[212:215], v[244:247], v[124:127]
    ds_read_b64_tr_b16 v[208:209], v36 offset:12288
    ds_read_b64_tr_b16 v[210:211], v36 offset:12800
    v_xor_b32 v36, 49152, v36
    v_mfma_f32_16x16x32_bf16 v[128:131], v[216:219], v[244:247], v[128:131]
    ds_read_b64_tr_b16 v[212:213], v37 offset:12288
    ds_read_b64_tr_b16 v[214:215], v37 offset:12800
    v_xor_b32 v37, 49152, v37
    v_mfma_f32_16x16x32_bf16 v[132:135], v[220:223], v[244:247], v[132:135]
    ds_read_b64_tr_b16 v[216:217], v38 offset:12288
    ds_read_b64_tr_b16 v[218:219], v38 offset:12800
    v_xor_b32 v38, 49152, v38
    buffer_load_dwordx4 v[244:247], v2, s[32:35], s20 offen offset:1024 sc1
    s_waitcnt vmcnt(7)
    s_waitcnt lgkmcnt(6)
    v_mfma_f32_16x16x32_bf16 v[120:123], v[192:195], v[44:47], v[120:123]
    ds_read_b64_tr_b16 v[220:221], v39 offset:12288
    ds_read_b64_tr_b16 v[222:223], v39 offset:12800
    v_xor_b32 v39, 49152, v39
    v_mfma_f32_16x16x32_bf16 v[124:127], v[196:199], v[44:47], v[124:127]
    ds_read_b64_tr_b16 v[192:193], v36
    ds_read_b64_tr_b16 v[194:195], v36 offset:512
    v_mfma_f32_16x16x32_bf16 v[128:131], v[200:203], v[44:47], v[128:131]
    ds_read_b64_tr_b16 v[196:197], v37
    ds_read_b64_tr_b16 v[198:199], v37 offset:512
    v_mfma_f32_16x16x32_bf16 v[132:135], v[204:207], v[44:47], v[132:135]
    ds_read_b64_tr_b16 v[200:201], v38
    ds_read_b64_tr_b16 v[202:203], v38 offset:512
    buffer_load_dwordx4 v[44:47], v2, s[32:35], s20 offen offset:2048 sc1
    s_waitcnt vmcnt(7)
    s_waitcnt lgkmcnt(6)
    v_mfma_f32_16x16x32_bf16 v[120:123], v[208:211], v[48:51], v[120:123]
    ds_read_b64_tr_b16 v[204:205], v39
    ds_read_b64_tr_b16 v[206:207], v39 offset:512
    v_mfma_f32_16x16x32_bf16 v[124:127], v[212:215], v[48:51], v[124:127]
    ds_read_b64_tr_b16 v[208:209], v36 offset:4096
    ds_read_b64_tr_b16 v[210:211], v36 offset:4608
    v_mfma_f32_16x16x32_bf16 v[128:131], v[216:219], v[48:51], v[128:131]
    ds_read_b64_tr_b16 v[212:213], v37 offset:4096
    ds_read_b64_tr_b16 v[214:215], v37 offset:4608
    v_mfma_f32_16x16x32_bf16 v[132:135], v[220:223], v[48:51], v[132:135]
    ds_read_b64_tr_b16 v[216:217], v38 offset:4096
    ds_read_b64_tr_b16 v[218:219], v38 offset:4608
    buffer_load_dwordx4 v[48:51], v2, s[32:35], s20 offen offset:3072 sc1
    buffer_load_dwordx2 v[40:41], v10, s[32:35], s13 offen sc1
    s_add_u32 s82, s80, 114688
    buffer_load_dwordx4 v[72:75], v27, s[52:55], s82 offen nt
    s_add_u32 s82, s80, 172032
    buffer_load_dwordx4 v[76:79], v27, s[52:55], s82 offen nt
    s_waitcnt vmcnt(10)
    s_waitcnt lgkmcnt(6)
    v_mfma_f32_16x16x32_bf16 v[120:123], v[192:195], v[224:227], v[120:123]
    ds_read_b64_tr_b16 v[220:221], v39 offset:4096
    ds_read_b64_tr_b16 v[222:223], v39 offset:4608
    v_mfma_f32_16x16x32_bf16 v[124:127], v[196:199], v[224:227], v[124:127]
    ds_read_b64_tr_b16 v[192:193], v36 offset:8192
    ds_read_b64_tr_b16 v[194:195], v36 offset:8704
    v_mfma_f32_16x16x32_bf16 v[128:131], v[200:203], v[224:227], v[128:131]
    ds_read_b64_tr_b16 v[196:197], v37 offset:8192
    ds_read_b64_tr_b16 v[198:199], v37 offset:8704
    v_mfma_f32_16x16x32_bf16 v[132:135], v[204:207], v[224:227], v[132:135]
    ds_read_b64_tr_b16 v[200:201], v38 offset:8192
    ds_read_b64_tr_b16 v[202:203], v38 offset:8704
    s_waitcnt vmcnt(9)
    s_waitcnt lgkmcnt(6)
    v_mfma_f32_16x16x32_bf16 v[120:123], v[208:211], v[228:231], v[120:123]
    ds_read_b64_tr_b16 v[204:205], v39 offset:8192
    ds_read_b64_tr_b16 v[206:207], v39 offset:8704
    v_mfma_f32_16x16x32_bf16 v[124:127], v[212:215], v[228:231], v[124:127]
    ds_read_b64_tr_b16 v[208:209], v36 offset:12288
    ds_read_b64_tr_b16 v[210:211], v36 offset:12800
    v_xor_b32 v36, 16384, v36
    v_mfma_f32_16x16x32_bf16 v[128:131], v[216:219], v[228:231], v[128:131]
    ds_read_b64_tr_b16 v[212:213], v37 offset:12288
    ds_read_b64_tr_b16 v[214:215], v37 offset:12800
    v_xor_b32 v37, 16384, v37
    v_mfma_f32_16x16x32_bf16 v[132:135], v[220:223], v[228:231], v[132:135]
    ds_read_b64_tr_b16 v[216:217], v38 offset:12288
    ds_read_b64_tr_b16 v[218:219], v38 offset:12800
    v_xor_b32 v38, 16384, v38
    s_waitcnt vmcnt(8)
    s_waitcnt lgkmcnt(6)
    v_mfma_f32_16x16x32_bf16 v[120:123], v[192:195], v[232:235], v[120:123]
    ds_read_b64_tr_b16 v[220:221], v39 offset:12288
    ds_read_b64_tr_b16 v[222:223], v39 offset:12800
    v_xor_b32 v39, 16384, v39
    v_mfma_f32_16x16x32_bf16 v[124:127], v[196:199], v[232:235], v[124:127]
    ds_read_b64_tr_b16 v[192:193], v36
    ds_read_b64_tr_b16 v[194:195], v36 offset:512
    v_mfma_f32_16x16x32_bf16 v[128:131], v[200:203], v[232:235], v[128:131]
    ds_read_b64_tr_b16 v[196:197], v37
    ds_read_b64_tr_b16 v[198:199], v37 offset:512
    v_mfma_f32_16x16x32_bf16 v[132:135], v[204:207], v[232:235], v[132:135]
    ds_read_b64_tr_b16 v[200:201], v38
    ds_read_b64_tr_b16 v[202:203], v38 offset:512
    s_waitcnt vmcnt(7)
    s_waitcnt lgkmcnt(6)
    v_mfma_f32_16x16x32_bf16 v[120:123], v[208:211], v[236:239], v[120:123]
    ds_read_b64_tr_b16 v[204:205], v39
    ds_read_b64_tr_b16 v[206:207], v39 offset:512
    v_mfma_f32_16x16x32_bf16 v[124:127], v[212:215], v[236:239], v[124:127]
    ds_read_b64_tr_b16 v[208:209], v36 offset:4096
    ds_read_b64_tr_b16 v[210:211], v36 offset:4608
    v_mfma_f32_16x16x32_bf16 v[128:131], v[216:219], v[236:239], v[128:131]
    ds_read_b64_tr_b16 v[212:213], v37 offset:4096
    ds_read_b64_tr_b16 v[214:215], v37 offset:4608
    v_mfma_f32_16x16x32_bf16 v[132:135], v[220:223], v[236:239], v[132:135]
    ds_read_b64_tr_b16 v[216:217], v38 offset:4096
    ds_read_b64_tr_b16 v[218:219], v38 offset:4608
    s_cmp_lt_u32 s3, 4
    s_cbranch_scc1 L_G2P28
    s_setprio 0
L_G2P28:
    s_waitcnt vmcnt(6)
    s_waitcnt lgkmcnt(6)
    v_mfma_f32_16x16x32_bf16 v[120:123], v[192:195], v[240:243], v[120:123]
    ds_read_b64_tr_b16 v[220:221], v39 offset:4096
    ds_read_b64_tr_b16 v[222:223], v39 offset:4608
    v_mfma_f32_16x16x32_bf16 v[124:127], v[196:199], v[240:243], v[124:127]
    ds_read_b64_tr_b16 v[192:193], v36 offset:8192
    ds_read_b64_tr_b16 v[194:195], v36 offset:8704
    v_mfma_f32_16x16x32_bf16 v[128:131], v[200:203], v[240:243], v[128:131]
    ds_read_b64_tr_b16 v[196:197], v37 offset:8192
    ds_read_b64_tr_b16 v[198:199], v37 offset:8704
    v_mfma_f32_16x16x32_bf16 v[132:135], v[204:207], v[240:243], v[132:135]
    ds_read_b64_tr_b16 v[200:201], v38 offset:8192
    ds_read_b64_tr_b16 v[202:203], v38 offset:8704
    s_waitcnt vmcnt(5)
    s_waitcnt lgkmcnt(6)
    v_mfma_f32_16x16x32_bf16 v[120:123], v[208:211], v[244:247], v[120:123]
    ds_read_b64_tr_b16 v[204:205], v39 offset:8192
    ds_read_b64_tr_b16 v[206:207], v39 offset:8704
    v_mfma_f32_16x16x32_bf16 v[124:127], v[212:215], v[244:247], v[124:127]
    ds_read_b64_tr_b16 v[208:209], v36 offset:12288
    ds_read_b64_tr_b16 v[210:211], v36 offset:12800
    v_mfma_f32_16x16x32_bf16 v[128:131], v[216:219], v[244:247], v[128:131]
    ds_read_b64_tr_b16 v[212:213], v37 offset:12288
    ds_read_b64_tr_b16 v[214:215], v37 offset:12800
    v_mfma_f32_16x16x32_bf16 v[132:135], v[220:223], v[244:247], v[132:135]
    ds_read_b64_tr_b16 v[216:217], v38 offset:12288
    ds_read_b64_tr_b16 v[218:219], v38 offset:12800
    s_waitcnt vmcnt(4)
    s_waitcnt lgkmcnt(6)
    v_mfma_f32_16x16x32_bf16 v[120:123], v[192:195], v[44:47], v[120:123]
    ds_read_b64_tr_b16 v[220:221], v39 offset:12288
    ds_read_b64_tr_b16 v[222:223], v39 offset:12800
    v_mfma_f32_16x16x32_bf16 v[124:127], v[196:199], v[44:47], v[124:127]
    v_mfma_f32_16x16x32_bf16 v[128:131], v[200:203], v[44:47], v[128:131]
    v_mfma_f32_16x16x32_bf16 v[132:135], v[204:207], v[44:47], v[132:135]
    s_waitcnt vmcnt(3)
    s_waitcnt lgkmcnt(0)
    v_mfma_f32_16x16x32_bf16 v[120:123], v[208:211], v[48:51], v[120:123]
    v_mfma_f32_16x16x32_bf16 v[124:127], v[212:215], v[48:51], v[124:127]
    v_mfma_f32_16x16x32_bf16 v[128:131], v[216:219], v[48:51], v[128:131]
    v_mfma_f32_16x16x32_bf16 v[132:135], v[220:223], v[48:51], v[132:135]
    s_lshl3_add_u32 s96, s21, s3
    s_lshl4_add_u32 s97, s96, s12
    s_lshl_b32 s98, s97, 8
    s_add_u32 s14, s98, 12582912
    v_and_b32 v28, 15, v1
    v_lshlrev_b32 v28, 4, v28
    v_lshrrev_b32 v9, 4, v1
    v_lshl_add_u32 v28, v9, 2, v28
    v_cvt_pk_bf16_f32 v120, 0, v120
    v_cvt_pk_bf16_f32 v121, 0, v121
    v_cvt_pk_bf16_f32 v122, 0, v122
    v_cvt_pk_bf16_f32 v123, 0, v123
    v_cvt_pk_bf16_f32 v124, 0, v124
    v_cvt_pk_bf16_f32 v125, 0, v125
    v_cvt_pk_bf16_f32 v126, 0, v126
    v_cvt_pk_bf16_f32 v127, 0, v127
    v_pk_mul_f32 v[120:121], v[120:121], v[136:137]
    v_pk_mul_f32 v[122:123], v[122:123], v[138:139]
    v_pk_mul_f32 v[124:125], v[124:125], v[140:141]
    v_pk_mul_f32 v[126:127], v[126:127], v[142:143]
    v_cvt_pk_bf16_f32 v120, 0, v120
    v_cvt_pk_bf16_f32 v121, 0, v121
    v_cvt_pk_bf16_f32 v122, 0, v122
    v_cvt_pk_bf16_f32 v123, 0, v123
    v_cvt_pk_bf16_f32 v124, 0, v124
    v_cvt_pk_bf16_f32 v125, 0, v125
    v_cvt_pk_bf16_f32 v126, 0, v126
    v_cvt_pk_bf16_f32 v127, 0, v127
    v_pk_add_f32 v[120:121], v[120:121], v[152:153]
    v_pk_add_f32 v[122:123], v[122:123], v[154:155]
    v_pk_add_f32 v[124:125], v[124:125], v[156:157]
    v_pk_add_f32 v[126:127], v[126:127], v[158:159]
    v_cvt_pk_bf16_f32 v12, v120, v121
    v_cvt_pk_bf16_f32 v13, v122, v123
    v_cvt_pk_bf16_f32 v14, v124, v125
    v_cvt_pk_bf16_f32 v15, v126, v127
    v_dot2_f32_bf16 v4, v12, v12, 0
    v_dot2_f32_bf16 v5, v13, v13, 0
    v_dot2_f32_bf16 v4, v14, v14, v4
    v_dot2_f32_bf16 v5, v15, v15, v5
    v_mfma_f32_16x16x32_bf16 v[240:243], v[184:187], v[12:15], 0
    v_cvt_pk_bf16_f32 v128, 0, v128
    v_cvt_pk_bf16_f32 v129, 0, v129
    v_cvt_pk_bf16_f32 v130, 0, v130
    v_cvt_pk_bf16_f32 v131, 0, v131
    v_cvt_pk_bf16_f32 v132, 0, v132
    v_cvt_pk_bf16_f32 v133, 0, v133
    v_cvt_pk_bf16_f32 v134, 0, v134
    v_cvt_pk_bf16_f32 v135, 0, v135
    v_pk_mul_f32 v[128:129], v[128:129], v[144:145]
    v_pk_mul_f32 v[130:131], v[130:131], v[146:147]
    v_pk_mul_f32 v[132:133], v[132:133], v[148:149]
    v_pk_mul_f32 v[134:135], v[134:135], v[150:151]
    v_cvt_pk_bf16_f32 v128, 0, v128
    v_cvt_pk_bf16_f32 v129, 0, v129
    v_cvt_pk_bf16_f32 v130, 0, v130
    v_cvt_pk_bf16_f32 v131, 0, v131
    v_cvt_pk_bf16_f32 v132, 0, v132
    v_cvt_pk_bf16_f32 v133, 0, v133
    v_cvt_pk_bf16_f32 v134, 0, v134
    v_cvt_pk_bf16_f32 v135, 0, v135
    v_pk_add_f32 v[128:129], v[128:129], v[160:161]
    v_pk_add_f32 v[130:131], v[130:131], v[162:163]
    v_pk_add_f32 v[132:133], v[132:133], v[164:165]
    v_pk_add_f32 v[134:135], v[134:135], v[166:167]
    v_cvt_pk_bf16_f32 v16, v128, v129
    v_cvt_pk_bf16_f32 v17, v130, v131
    v_cvt_pk_bf16_f32 v18, v132, v133
    v_cvt_pk_bf16_f32 v19, v134, v135
    v_dot2_f32_bf16 v4, v16, v16, v4
    v_dot2_f32_bf16 v5, v17, v17, v5
    v_dot2_f32_bf16 v4, v18, v18, v4
    v_dot2_f32_bf16 v5, v19, v19, v5
    v_mfma_f32_16x16x32_bf16 v[240:243], v[188:191], v[16:19], v[240:243]
    v_and_b32 v7, 7, v1
    v_lshlrev_b32 v7, 15, v7
    v_bfe_u32 v9, v1, 3, 1
    v_lshl_add_u32 v7, v9, 12, v7
    v_add_f32 v4, v4, v5
    v_mov_b32 v5, v4
    s_nop 1
    v_permlane32_swap_b32 v4, v5
    v_add_f32 v4, v4, v5
    v_mov_b32 v5, v4
    s_nop 1
    v_permlane16_swap_b32 v4, v5
    v_add_f32 v4, v4, v5
    s_nop 1
    v_mov_b32_dpp v240, v4 quad_perm:[0,1,2,3] row_mask:0x8 bank_mask:0xf
    buffer_store_dword v240, v28, s[32:35], s14 offen sc1
    s_and_b32 s96, s12, 1
    s_lshr_b32 s97, s21, 2
    s_and_b32 s98, s21, 3
    s_lshl_b32 s99, s98, 6
    s_lshl1_add_u32 s98, s97, s99
    s_lshl_b32 s97, s98, 12
    s_lshr_b32 s99, s12, 1
    s_lshl_b32 s98, s99, 6
    s_add_u32 s99, s97, s98
    s_lshl2_add_u32 s97, s96, s99
    s_add_u32 s98, s97, 1048576
    s_add_u32 s16, s98, 1536
    s_barrier
    s_cmp_lg_u32 s3, 0
    s_cbranch_scc1 L_PE
    v_mov_b32 v6, s4
    s_mov_b32 exec_hi, 0
    s_mov_b32 exec_lo, 65535
    buffer_store_dword v6, v7, s[32:35], s16 offen sc1
    s_mov_b64 exec, -1
L_PE:
    s_mov_b32 s82, s80
    s_lshl2_add_u32 m0, s83, 32768
    s_nop 0
    buffer_load_dwordx4 v27, s[56:59], s82 offen nt lds
    s_add_u32 s82, s80, 57344
    s_lshl2_add_u32 m0, s83, 33792
    s_nop 0
    buffer_load_dwordx4 v27, s[56:59], s82 offen nt lds
    s_lshl_b32 s15, s3, 12
    v_add_u32 v4, s15, v2
    v_add_u32 v7, 65536, v4
    s_waitcnt vmcnt(5)
    v_cmp_ne_u32 vcc, s4, v41
    s_cbranch_vccz L_UPOK
POLL_31:
    buffer_load_dwordx2 v[40:41], v10, s[32:35], s13 offen sc1
    s_waitcnt vmcnt(0)
    v_cmp_ne_u32 vcc, s4, v41
    s_cbranch_vccz PDONE_32
    s_add_u32 s5, s5, 1
    s_cmp_lt_u32 s5, 200000
    s_cbranch_scc1 POLL_31
PDONE_32:
L_UPOK:
    s_lshl3_add_u32 s96, s21, s3
    s_lshl_b32 s97, s96, 12
    s_add_u32 s14, s97, 12582912
    s_load_dwordx2 s[24:25], s[32:33], s92 offset:1536 glc
    v_add_f32_dpp v40, v40, v40 quad_perm:[1,0,3,2] row_mask:0xf bank_mask:0xf
    s_nop 1
    v_add_f32_dpp v40, v40, v40 quad_perm:[2,3,0,1] row_mask:0xf bank_mask:0xf
    s_nop 1
    v_add_f32_dpp v40, v40, v40 row_half_mirror row_mask:0xf bank_mask:0xf
    s_nop 1
    v_add_f32_dpp v40, v40, v40 row_mirror row_mask:0xf bank_mask:0xf
    v_lshlrev_b32 v152, 16, v12
    v_and_b32 v153, s6, v12
    v_lshlrev_b32 v154, 16, v13
    v_and_b32 v155, s6, v13
    v_lshlrev_b32 v156, 16, v14
    v_and_b32 v157, s6, v14
    v_lshlrev_b32 v158, 16, v15
    v_and_b32 v159, s6, v15
    v_lshlrev_b32 v160, 16, v16
    v_and_b32 v161, s6, v16
    v_lshlrev_b32 v162, 16, v17
    v_and_b32 v163, s6, v17
    v_lshlrev_b32 v164, 16, v18
    v_and_b32 v165, s6, v18
    v_lshlrev_b32 v166, 16, v19
    v_and_b32 v167, s6, v19
    s_lshl_b32 s96, s3, 9
    s_lshl1_add_u32 s15, s21, s96
    v_and_b32 v29, 15, v1
    v_lshl_add_u32 v29, v29, 5, s15
    v_xor_b32 v5, 0x4000, v4
    v_xor_b32 v8, 0x4000, v7
    s_waitcnt vmcnt(3)
    ds_write_b128 v4, v[72:75] offset:2048
    ds_write_b128 v4, v[76:79] offset:3072
    s_cmp_lt_u32 s3, 4
    s_cbranch_scc1 L_FW1
    ds_write_b128 v4, v[56:59] offset:0
    ds_write_b128 v5, v[60:63] offset:0
    ds_write_b128 v4, v[64:67] offset:1024
    ds_write_b128 v5, v[68:71] offset:1024
L_FW1:
    s_branch SCHK_34
SPOLL_33:
    s_load_dwordx2 s[24:25], s[32:33], s92 offset:1536 glc
SCHK_34:
    s_add_u32 s5, s5, 1
    s_cmp_ge_u32 s5, 200000
    s_waitcnt lgkmcnt(0)
    s_cbranch_scc1 SDONE_35
    s_cmp_lg_u32 s24, s4
    s_cbranch_scc1 SPOLL_33
    s_cmp_lg_u32 s25, s4
    s_cbranch_scc1 SPOLL_33
SDONE_35:
    s_barrier
    buffer_load_dwordx4 v[192:195], v2, s[32:35], s14 offen sc1
    buffer_load_dwordx4 v[196:199], v2, s[32:35], s14 offen offset:1024 sc1
    buffer_load_dwordx4 v[200:203], v2, s[32:35], s14 offen offset:2048 sc1
    buffer_load_dwordx4 v[204:207], v2, s[32:35], s14 offen offset:3072 sc1
    s_barrier
    s_add_u32 s82, s80, 114688
    s_lshl2_add_u32 m0, s83, 34816
    s_nop 0
    buffer_load_dwordx4 v27, s[56:59], s82 offen nt lds
    s_add_u32 s82, s80, 172032
    s_lshl2_add_u32 m0, s83, 35840
    s_nop 0
    buffer_load_dwordx4 v27, s[56:59], s82 offen nt lds
    s_mov_b32 s82, s81
    s_lshl2_add_u32 m0, s83, 65536
    s_nop 0
    buffer_load_dwordx4 v253, s[60:63], s82 offen nt lds
    s_add_u32 s82, s81, 4096
    s_lshl2_add_u32 m0, s83, 66560
    s_nop 0
    buffer_load_dwordx4 v253, s[60:63], s82 offen nt lds
    v_mov_b32_dpp v168, v33 row_newbcast:0 row_mask:0xf bank_mask:0xf
    v_mov_b32_dpp v169, v33 row_newbcast:1 row_mask:0xf bank_mask:0xf
    v_mov_b32_dpp v170, v33 row_newbcast:2 row_mask:0xf bank_mask:0xf
    v_mov_b32_dpp v171, v33 row_newbcast:3 row_mask:0xf bank_mask:0xf
    v_mov_b32_dpp v172, v33 row_newbcast:4 row_mask:0xf bank_mask:0xf
    v_mov_b32_dpp v173, v33 row_newbcast:5 row_mask:0xf bank_mask:0xf
    v_mov_b32_dpp v174, v33 row_newbcast:6 row_mask:0xf bank_mask:0xf
    v_mov_b32_dpp v175, v33 row_newbcast:7 row_mask:0xf bank_mask:0xf
    v_mov_b32_dpp v176, v33 row_newbcast:8 row_mask:0xf bank_mask:0xf
    v_mov_b32_dpp v177, v33 row_newbcast:9 row_mask:0xf bank_mask:0xf
    v_mov_b32_dpp v178, v33 row_newbcast:10 row_mask:0xf bank_mask:0xf
    v_mov_b32_dpp v179, v33 row_newbcast:11 row_mask:0xf bank_mask:0xf
    v_mov_b32_dpp v180, v33 row_newbcast:12 row_mask:0xf bank_mask:0xf
    v_mov_b32_dpp v181, v33 row_newbcast:13 row_mask:0xf bank_mask:0xf
    v_mov_b32_dpp v182, v33 row_newbcast:14 row_mask:0xf bank_mask:0xf
    v_mov_b32_dpp v183, v33 row_newbcast:15 row_mask:0xf bank_mask:0xf
    v_mov_b32_dpp v88, v42 row_newbcast:0 row_mask:0xf bank_mask:0xf
    v_mov_b32_dpp v89, v42 row_newbcast:1 row_mask:0xf bank_mask:0xf
    v_mov_b32_dpp v90, v42 row_newbcast:2 row_mask:0xf bank_mask:0xf
    v_mov_b32_dpp v91, v42 row_newbcast:3 row_mask:0xf bank_mask:0xf
    v_mov_b32_dpp v92, v42 row_newbcast:4 row_mask:0xf bank_mask:0xf
    v_mov_b32_dpp v93, v42 row_newbcast:5 row_mask:0xf bank_mask:0xf
    v_mov_b32_dpp v94, v42 row_newbcast:6 row_mask:0xf bank_mask:0xf
    v_mov_b32_dpp v95, v42 row_newbcast:7 row_mask:0xf bank_mask:0xf
    v_mov_b32_dpp v96, v42 row_newbcast:8 row_mask:0xf bank_mask:0xf
    v_mov_b32_dpp v97, v42 row_newbcast:9 row_mask:0xf bank_mask:0xf
    v_mov_b32_dpp v98, v42 row_newbcast:10 row_mask:0xf bank_mask:0xf
    v_mov_b32_dpp v99, v42 row_newbcast:11 row_mask:0xf bank_mask:0xf
    v_mov_b32_dpp v100, v42 row_newbcast:12 row_mask:0xf bank_mask:0xf
    v_mov_b32_dpp v101, v42 row_newbcast:13 row_mask:0xf bank_mask:0xf
    v_mov_b32_dpp v102, v42 row_newbcast:14 row_mask:0xf bank_mask:0xf
    v_mov_b32_dpp v103, v42 row_newbcast:15 row_mask:0xf bank_mask:0xf
    v_mov_b32_dpp v104, v43 row_newbcast:0 row_mask:0xf bank_mask:0xf
    v_mov_b32_dpp v105, v43 row_newbcast:1 row_mask:0xf bank_mask:0xf
    v_mov_b32_dpp v106, v43 row_newbcast:2 row_mask:0xf bank_mask:0xf
    v_mov_b32_dpp v107, v43 row_newbcast:3 row_mask:0xf bank_mask:0xf
    v_mov_b32_dpp v108, v43 row_newbcast:4 row_mask:0xf bank_mask:0xf
    v_mov_b32_dpp v109, v43 row_newbcast:5 row_mask:0xf bank_mask:0xf
    v_mov_b32_dpp v110, v43 row_newbcast:6 row_mask:0xf bank_mask:0xf
    v_mov_b32_dpp v111, v43 row_newbcast:7 row_mask:0xf bank_mask:0xf
    v_mov_b32_dpp v112, v43 row_newbcast:8 row_mask:0xf bank_mask:0xf
    v_mov_b32_dpp v113, v43 row_newbcast:9 row_mask:0xf bank_mask:0xf
    v_mov_b32_dpp v114, v43 row_newbcast:10 row_mask:0xf bank_mask:0xf
    v_mov_b32_dpp v115, v43 row_newbcast:11 row_mask:0xf bank_mask:0xf
    v_mov_b32_dpp v116, v43 row_newbcast:12 row_mask:0xf bank_mask:0xf
    v_mov_b32_dpp v117, v43 row_newbcast:13 row_mask:0xf bank_mask:0xf
    v_mov_b32_dpp v118, v43 row_newbcast:14 row_mask:0xf bank_mask:0xf
    v_mov_b32_dpp v119, v43 row_newbcast:15 row_mask:0xf bank_mask:0xf
    s_lshl3_add_u32 s15, s3, 156160
    v_mov_b32 v4, s15
    v_and_b32 v5, 7, v1
    v_lshlrev_b32 v5, 3, v5
    v_add_u32 v5, 156160, v5
    v_and_b32 v6, 3, v1
    v_lshlrev_b32 v6, 18, v6
    v_bfe_u32 v9, v1, 2, 2
    v_lshl_add_u32 v6, v9, 13, v6
    s_and_b32 s96, s21, 1
    s_and_b32 s97, s12, 7
    s_lshr_b32 s98, s12, 3
    s_lshl3_add_u32 s99, s97, s98
    s_lshl_b32 s97, s99, 12
    s_lshr_b32 s98, s21, 1
    s_lshl_b32 s99, s98, 6
    s_add_u32 s98, s97, s99
    s_lshl4_add_u32 s97, s96, s98
    s_add_u32 s99, s97, 1048576
    s_add_u32 s16, s99, 2560
    s_waitcnt vmcnt(4)
    v_pk_add_f32 v[192:193], v[192:193], v[196:197]
    v_pk_add_f32 v[200:201], v[200:201], v[204:205]
    v_pk_add_f32 v[194:195], v[194:195], v[198:199]
    v_pk_add_f32 v[202:203], v[202:203], v[206:207]
    v_pk_add_f32 v[192:193], v[192:193], v[200:201]
    v_pk_add_f32 v[194:195], v[194:195], v[202:203]
    v_add_f32 v193, v193, v194
    v_add_f32 v197, v192, v195
    v_cmp_u_f32 vcc, v193, v197
    s_cbranch_vccz POK_37
PRE_38:
    buffer_load_dwordx4 v[192:195], v2, s[32:35], s14 offen sc1
    buffer_load_dwordx4 v[196:199], v2, s[32:35], s14 offen offset:1024 sc1
    buffer_load_dwordx4 v[200:203], v2, s[32:35], s14 offen offset:2048 sc1
    buffer_load_dwordx4 v[204:207], v2, s[32:35], s14 offen offset:3072 sc1
    s_waitcnt vmcnt(0)
    v_pk_add_f32 v[192:193], v[192:193], v[196:197]
    v_pk_add_f32 v[200:201], v[200:201], v[204:205]
    v_pk_add_f32 v[194:195], v[194:195], v[198:199]
    v_pk_add_f32 v[202:203], v[202:203], v[206:207]
    v_pk_add_f32 v[192:193], v[192:193], v[200:201]
    v_pk_add_f32 v[194:195], v[194:195], v[202:203]
    v_add_f32 v193, v193, v194
    v_add_f32 v197, v192, v195
    v_cmp_u_f32 vcc, v193, v197
    s_cbranch_vccz POK_37
    s_add_u32 s5, s5, 1
    s_cmp_lt_u32 s5, 200000
    s_cbranch_scc1 PRE_38
POK_37:
    v_mov_b32 v196, v195
    s_nop 1
    v_permlane32_swap_b32 v195, v196
    v_permlane32_swap_b32 v192, v193
    v_add_f32 v195, v195, v196
    v_add_f32 v192, v192, v193
    s_nop 1
    v_permlane16_swap_b32 v192, v195
    v_add_f32 v193, v192, v195
    v_add_f32 v195, v192, v195
    s_nop 1
    v_permlane16_swap_b32 v193, v195
    v_mov_b32 v192, v193
    v_mul_f32 v195, 0x3a800000, v195
    s_nop 0
    v_permlane32_swap_b32 v192, v193
    v_mul_f32 v192, 0x3a800000, v192
    v_fma_f32 v31, -v192, v192, v195
    v_cvt_pk_bf16_f32 v30, 0, v192
    v_max_f32 v31, 0, v31
    v_cvt_pk_bf16_f32 v31, 0, v31
    v_fma_f32 v193, -v30, v40, v193
L_PAD9:
    s_cbranch_execz L_RET9
    v_add_f32 v31, 0x3727c5ac, v31
    v_cvt_pk_bf16_f32 v31, 0, v31
    v_sqrt_f32 v31, v31
    s_nop 0
    v_cvt_pk_bf16_f32 v31, 0, v31
    v_rcp_f32 v31, v31
    s_nop 0
    v_mul_f32 v32, v193, v31
    v_ashrrev_i32 v196, 31, v32
    v_or_b32 v196, 0x80000000, v196
    v_xor_b32 v32, v32, v196
    s_mov_b32 s15, 0xfffff000
    v_and_or_b32 v32, v32, s15, v29
    s_nop 1
    v_max_u32_dpp v244, v32, v32 quad_perm:[1,0,3,2] row_mask:0xf bank_mask:0xf
    v_min_u32_dpp v245, v32, v32 quad_perm:[1,0,3,2] row_mask:0xf bank_mask:0xf
    s_nop 0
    v_min_u32_dpp v196, v244, v244 quad_perm:[2,3,0,1] row_mask:0xf bank_mask:0xf
    v_max_u32_dpp v245, v245, v245 quad_perm:[2,3,0,1] row_mask:0xf bank_mask:0xf
    v_max_u32_dpp v244, v244, v244 quad_perm:[2,3,0,1] row_mask:0xf bank_mask:0xf
    v_max_u32 v245, v245, v196
    s_nop 0
    v_min_u32_dpp v196, v244, v244 row_half_mirror row_mask:0xf bank_mask:0xf
    v_max_u32_dpp v245, v245, v245 row_half_mirror row_mask:0xf bank_mask:0xf
    v_max_u32_dpp v244, v244, v244 row_half_mirror row_mask:0xf bank_mask:0xf
    v_max_u32 v245, v245, v196
    s_nop 0
    v_min_u32_dpp v196, v244, v244 row_mirror row_mask:0xf bank_mask:0xf
    v_max_u32_dpp v245, v245, v245 row_mirror row_mask:0xf bank_mask:0xf
    v_max_u32_dpp v244, v244, v244 row_mirror row_mask:0xf bank_mask:0xf
    v_max_u32 v245, v245, v196
    ds_write_b64 v4, v[244:245]
    s_waitcnt lgkmcnt(0)
    s_barrier
    ds_read_b64 v[244:245], v5
    v_pk_add_f32 v[208:209], v[152:153], v[30:31] op_sel_hi:[1,0] neg_lo:[0,1] neg_hi:[0,1]
    v_pk_add_f32 v[210:211], v[154:155], v[30:31] op_sel_hi:[1,0] neg_lo:[0,1] neg_hi:[0,1]
    v_pk_add_f32 v[212:213], v[156:157], v[30:31] op_sel_hi:[1,0] neg_lo:[0,1] neg_hi:[0,1]
    v_pk_add_f32 v[214:215], v[158:159], v[30:31] op_sel_hi:[1,0] neg_lo:[0,1] neg_hi:[0,1]
    v_pk_add_f32 v[216:217], v[160:161], v[30:31] op_sel_hi:[1,0] neg_lo:[0,1] neg_hi:[0,1]
    v_pk_add_f32 v[218:219], v[162:163], v[30:31] op_sel_hi:[1,0] neg_lo:[0,1] neg_hi:[0,1]
    v_pk_add_f32 v[220:221], v[164:165], v[30:31] op_sel_hi:[1,0] neg_lo:[0,1] neg_hi:[0,1]
    v_pk_add_f32 v[222:223], v[166:167], v[30:31] op_sel_hi:[1,0] neg_lo:[0,1] neg_hi:[0,1]
    s_waitcnt lgkmcnt(0)
    v_min_u32_dpp v196, v244, v244 quad_perm:[1,0,3,2] row_mask:0xf bank_mask:0xf
    v_max_u32_dpp v245, v245, v245 quad_perm:[1,0,3,2] row_mask:0xf bank_mask:0xf
    v_max_u32_dpp v244, v244, v244 quad_perm:[1,0,3,2] row_mask:0xf bank_mask:0xf
    v_max_u32 v245, v245, v196
    s_nop 0
    v_min_u32_dpp v196, v244, v244 quad_perm:[2,3,0,1] row_mask:0xf bank_mask:0xf
    v_max_u32_dpp v245, v245, v245 quad_perm:[2,3,0,1] row_mask:0xf bank_mask:0xf
    v_max_u32_dpp v244, v244, v244 quad_perm:[2,3,0,1] row_mask:0xf bank_mask:0xf
    v_max_u32 v245, v245, v196
    s_nop 0
    v_min_u32_dpp v196, v244, v244 row_half_mirror row_mask:0xf bank_mask:0xf
    v_max_u32_dpp v245, v245, v245 row_half_mirror row_mask:0xf bank_mask:0xf
    v_max_u32_dpp v244, v244, v244 row_half_mirror row_mask:0xf bank_mask:0xf
    v_max_u32 v245, v245, v196
    v_cmp_eq_u32 s[88:89], v32, v245
    v_cmp_eq_u32 vcc, v32, v244
    v_or_b32 v246, 1, v245
    v_mov_b32 v245, s4
    v_mov_b32 v247, s4
    s_or_b64 s[84:85], vcc, s[88:89]
    s_cmp_lg_u32 s3, 0
    s_cbranch_scc1 L_NOF
    s_mov_b64 exec, 0xffff
    buffer_store_dwordx4 v[244:247], v6, s[32:35], s16 offen sc1
    s_mov_b64 exec, -1
L_NOF:
    s_cmp_eq_u64 s[84:85], 0
    s_cbranch_scc1 L_NOPR
    s_setprio 1
L_NOPR:
    s_lshl4_add_u32 s13, s3, 156288
    v_mov_b32 v4, s13
    v_and_b32 v5, 7, v1
    v_lshlrev_b32 v5, 4, v5
    v_add_u32 v5, 156288, v5
    s_load_dwordx8 s[24:31], s[32:33], s92 offset:2560 glc
    v_cvt_pk_bf16_f32 v208, 0, v208
    v_cvt_pk_bf16_f32 v209, 0, v209
    v_cvt_pk_bf16_f32 v210, 0, v210
    v_cvt_pk_bf16_f32 v211, 0, v211
    v_cvt_pk_bf16_f32 v212, 0, v212
    v_cvt_pk_bf16_f32 v213, 0, v213
    v_cvt_pk_bf16_f32 v214, 0, v214
    v_cvt_pk_bf16_f32 v215, 0, v215
    v_cvt_pk_bf16_f32 v216, 0, v216
    v_cvt_pk_bf16_f32 v217, 0, v217
    v_cvt_pk_bf16_f32 v218, 0, v218
    v_cvt_pk_bf16_f32 v219, 0, v219
    v_cvt_pk_bf16_f32 v220, 0, v220
    v_cvt_pk_bf16_f32 v221, 0, v221
    v_cvt_pk_bf16_f32 v222, 0, v222
    v_cvt_pk_bf16_f32 v223, 0, v223
    v_pk_mul_f32 v[208:209], v[30:31], v[208:209] op_sel:[1,0]
    v_pk_mul_f32 v[210:211], v[30:31], v[210:211] op_sel:[1,0]
    v_pk_mul_f32 v[212:213], v[30:31], v[212:213] op_sel:[1,0]
    v_pk_mul_f32 v[214:215], v[30:31], v[214:215] op_sel:[1,0]
    v_pk_mul_f32 v[216:217], v[30:31], v[216:217] op_sel:[1,0]
    v_pk_mul_f32 v[218:219], v[30:31], v[218:219] op_sel:[1,0]
    v_pk_mul_f32 v[220:221], v[30:31], v[220:221] op_sel:[1,0]
    v_pk_mul_f32 v[222:223], v[30:31], v[222:223] op_sel:[1,0]
    v_cvt_pk_bf16_f32 v208, 0, v208
    v_cvt_pk_bf16_f32 v209, 0, v209
    v_cvt_pk_bf16_f32 v210, 0, v210
    v_cvt_pk_bf16_f32 v211, 0, v211
    v_cvt_pk_bf16_f32 v212, 0, v212
    v_cvt_pk_bf16_f32 v213, 0, v213
    v_cvt_pk_bf16_f32 v214, 0, v214
    v_cvt_pk_bf16_f32 v215, 0, v215
    v_cvt_pk_bf16_f32 v216, 0, v216
    v_cvt_pk_bf16_f32 v217, 0, v217
    v_cvt_pk_bf16_f32 v218, 0, v218
    v_cvt_pk_bf16_f32 v219, 0, v219
    v_cvt_pk_bf16_f32 v220, 0, v220
    v_cvt_pk_bf16_f32 v221, 0, v221
    v_cvt_pk_bf16_f32 v222, 0, v222
    v_cvt_pk_bf16_f32 v223, 0, v223
    v_pk_mul_f32 v[208:209], v[208:209], v[168:169]
    v_pk_mul_f32 v[210:211], v[210:211], v[170:171]
    v_pk_mul_f32 v[212:213], v[212:213], v[172:173]
    v_pk_mul_f32 v[214:215], v[214:215], v[174:175]
    v_pk_mul_f32 v[216:217], v[216:217], v[176:177]
    v_pk_mul_f32 v[218:219], v[218:219], v[178:179]
    v_pk_mul_f32 v[220:221], v[220:221], v[180:181]
    v_pk_mul_f32 v[222:223], v[222:223], v[182:183]
    v_cvt_pk_bf16_f32 v208, 0, v208
    v_cvt_pk_bf16_f32 v209, 0, v209
    v_cvt_pk_bf16_f32 v210, 0, v210
    v_cvt_pk_bf16_f32 v211, 0, v211
    v_cvt_pk_bf16_f32 v212, 0, v212
    v_cvt_pk_bf16_f32 v213, 0, v213
    v_cvt_pk_bf16_f32 v214, 0, v214
    v_cvt_pk_bf16_f32 v215, 0, v215
    v_cvt_pk_bf16_f32 v216, 0, v216
    v_cvt_pk_bf16_f32 v217, 0, v217
    v_cvt_pk_bf16_f32 v218, 0, v218
    v_cvt_pk_bf16_f32 v219, 0, v219
    v_cvt_pk_bf16_f32 v220, 0, v220
    v_cvt_pk_bf16_f32 v221, 0, v221
    v_cvt_pk_bf16_f32 v222, 0, v222
    v_cvt_pk_bf16_f32 v223, 0, v223
    v_pk_add_f32 v[208:209], v[208:209], v[88:89]
    v_pk_add_f32 v[210:211], v[210:211], v[90:91]
    v_pk_add_f32 v[212:213], v[212:213], v[92:93]
    v_pk_add_f32 v[214:215], v[214:215], v[94:95]
    v_pk_add_f32 v[216:217], v[216:217], v[96:97]
    v_pk_add_f32 v[218:219], v[218:219], v[98:99]
    v_pk_add_f32 v[220:221], v[220:221], v[100:101]
    v_pk_add_f32 v[222:223], v[222:223], v[102:103]
    v_cvt_pk_bf16_f32 v224, v208, v209
    v_cvt_pk_bf16_f32 v225, v210, v211
    v_cvt_pk_bf16_f32 v226, v212, v213
    v_cvt_pk_bf16_f32 v227, v214, v215
    v_cvt_pk_bf16_f32 v228, v216, v217
    v_cvt_pk_bf16_f32 v229, v218, v219
    v_cvt_pk_bf16_f32 v230, v220, v221
    v_cvt_pk_bf16_f32 v231, v222, v223
    s_cmp_eq_u64 s[84:85], 0
    s_cbranch_scc1 L_NOCAND
    v_mfma_f32_16x16x32_bf16 v[240:243], v[184:187], v[224:227], 0
    v_mfma_f32_16x16x32_bf16 v[240:243], v[188:191], v[228:231], v[240:243]
    v_mov_b32 v232, v224
    v_mov_b32 v233, v225
    v_mov_b32 v234, v226
    v_mov_b32 v235, v227
    v_mov_b32 v236, v228
    v_mov_b32 v237, v229
    v_mov_b32 v238, v230
    v_mov_b32 v239, v231
    s_lshl_b32 s96, s21, 14
    s_lshl_b32 s97, s12, 9
    s_add_u32 s98, s96, s97
    s_add_u32 s15, s98, 13631488
    v_lshrrev_b32 v7, 4, v1
    v_lshlrev_b32 v7, 4, v7
    v_add_u32 v8, 8192, v7
    v_permlane32_swap_b32 v232, v234
    v_permlane32_swap_b32 v233, v235
    v_permlane32_swap_b32 v236, v238
    v_permlane32_swap_b32 v237, v239
    v_permlane32_swap_b32 v12, v14
    v_permlane32_swap_b32 v13, v15
    v_permlane32_swap_b32 v16, v18
    v_permlane32_swap_b32 v17, v19
    v_cndmask_b32 v7, v7, v8, s[88:89]
    s_mov_b64 exec, s[84:85]
    buffer_store_dwordx4 v[232:235], v7, s[32:35], s15 offen sc1
    buffer_store_dwordx4 v[236:239], v7, s[32:35], s15 offen offset:64 sc1
    s_mov_b32 exec_lo, 0
    s_and_b32 exec_hi, s85, 0xffff0000
    buffer_store_dword v240, v7, s[32:35], s15 offen offset:208 sc1
    s_mov_b64 exec, s[84:85]
    buffer_store_dwordx4 v[12:15], v7, s[32:35], s15 offen offset:128 sc1
    buffer_store_dwordx4 v[16:19], v7, s[32:35], s15 offen offset:192 sc1
    s_mov_b64 exec, -1
    s_setprio 0
L_NOCAND:
    s_add_u32 s82, s81, 8192
    s_lshl2_add_u32 m0, s83, 67584
    s_nop 0
    buffer_load_dwordx4 v253, s[60:63], s82 offen nt lds
    v_lshlrev_b32 v208, 16, v224
    v_and_b32 v209, s6, v224
    v_lshlrev_b32 v210, 16, v225
    v_and_b32 v211, s6, v225
    v_lshlrev_b32 v212, 16, v226
    v_and_b32 v213, s6, v226
    v_lshlrev_b32 v214, 16, v227
    v_and_b32 v215, s6, v227
    v_lshlrev_b32 v216, 16, v228
    v_and_b32 v217, s6, v228
    v_lshlrev_b32 v218, 16, v229
    v_and_b32 v219, s6, v229
    v_lshlrev_b32 v220, 16, v230
    v_and_b32 v221, s6, v230
    v_lshlrev_b32 v222, 16, v231
    v_and_b32 v223, s6, v231
    v_pk_mul_f32 v[208:209], v[208:209], v[104:105]
    v_pk_mul_f32 v[210:211], v[210:211], v[106:107]
    v_pk_mul_f32 v[212:213], v[212:213], v[108:109]
    v_pk_mul_f32 v[214:215], v[214:215], v[110:111]
    v_pk_mul_f32 v[216:217], v[216:217], v[112:113]
    v_pk_mul_f32 v[218:219], v[218:219], v[114:115]
    v_pk_mul_f32 v[220:221], v[220:221], v[116:117]
    v_pk_mul_f32 v[222:223], v[222:223], v[118:119]
    v_cvt_pk_bf16_f32 v208, 0, v208
    v_cvt_pk_bf16_f32 v209, 0, v209
    v_cvt_pk_bf16_f32 v210, 0, v210
    v_cvt_pk_bf16_f32 v211, 0, v211
    v_cvt_pk_bf16_f32 v212, 0, v212
    v_cvt_pk_bf16_f32 v213, 0, v213
    v_cvt_pk_bf16_f32 v214, 0, v214
    v_cvt_pk_bf16_f32 v215, 0, v215
    v_cvt_pk_bf16_f32 v216, 0, v216
    v_cvt_pk_bf16_f32 v217, 0, v217
    v_cvt_pk_bf16_f32 v218, 0, v218
    v_cvt_pk_bf16_f32 v219, 0, v219
    v_cvt_pk_bf16_f32 v220, 0, v220
    v_cvt_pk_bf16_f32 v221, 0, v221
    v_cvt_pk_bf16_f32 v222, 0, v222
    v_cvt_pk_bf16_f32 v223, 0, v223
    s_lshl_b32 s96, s3, 11
    s_add_u32 s13, s96, 98304
    v_lshrrev_b32 v202, 4, v1
    v_lshlrev_b32 v202, 4, v202
    v_and_b32 v203, 7, v1
    v_lshlrev_b32 v203, 4, v203
    v_xor_b32 v202, v202, v203
    v_and_b32 v204, 15, v1
    v_lshl_add_u32 v204, v204, 7, s13
    v_add_u32 v202, v202, v204
    v_xor_b32 v204, 64, v202
    v_lshrrev_b32 v205, 3, v1
    v_lshlrev_b32 v205, 4, v205
    v_xor_b32 v203, v205, v203
    v_lshrrev_b32 v205, 3, v1
    v_lshl_add_u32 v205, v205, 7, s13
    v_add_u32 v203, v203, v205
    s_lshl_b32 s96, s21, 7
    s_sub_u32 s97, 2047, s96
    s_lshl_b32 s98, s3, 4
    s_sub_u32 s13, s97, s98
    v_lshrrev_b32 v43, 3, v1
    v_sub_u32 v42, s13, v43
    v_subrev_u32 v43, 8, v42
    v_lshrrev_b32 v33, 3, v1
    v_lshlrev_b32 v33, 11, v33
    v_and_b32 v9, 7, v1
    v_lshl_add_u32 v33, v9, 4, v33
    s_lshl3_add_u32 s96, s21, s3
    s_lshl_b32 s97, s96, 15
    s_lshl_b32 s98, s12, 7
    s_add_u32 s16, s97, s98
    s_add_u32 s15, s16, 16384
    s_branch SCHK_40
SPOLL_39:
    s_load_dwordx8 s[24:31], s[32:33], s92 offset:2560 glc
SCHK_40:
    s_add_u32 s5, s5, 1
    s_cmp_ge_u32 s5, 200000
    s_waitcnt lgkmcnt(0)
    s_cbranch_scc1 SDONE_41
    s_cmp_lg_u32 s25, s4
    s_cbranch_scc1 SPOLL_39
    s_cmp_lg_u32 s27, s4
    s_cbranch_scc1 SPOLL_39
    s_cmp_lg_u32 s29, s4
    s_cbranch_scc1 SPOLL_39
    s_cmp_lg_u32 s31, s4
    s_cbranch_scc1 SPOLL_39
SDONE_41:
    s_min_u32 s25, s24, s28
    s_min_u32 s27, s26, s28
    s_min_u32 s29, s24, s30
    s_max_u32 s24, s24, s28
    s_max_u32 s26, s26, s30
    s_max_u32 s27, s27, s29
    s_max_u32 s25, s25, s26
    v_mov_b32 v244, s24
    v_mov_b32 v246, s27
    v_mov_b32 v245, s25
    ds_write_b128 v4, v[244:247]
    s_lshr_b32 s96, s3, 2
    s_lshl_b32 s97, s96, 15
    s_and_b32 s98, s3, 3
    s_lshl_b32 s99, s98, 5
    s_add_u32 s13, s97, s99
    v_lshrrev_b32 v34, 4, v1
    v_lshlrev_b32 v34, 13, v34
    v_bfe_u32 v9, v1, 2, 2
    v_lshl_add_u32 v34, v9, 7, v34
    v_bfe_u32 v9, v1, 3, 2
    v_lshl_add_u32 v34, v9, 5, v34
    v_and_b32 v9, 3, v1
    v_lshl_add_u32 v34, v9, 3, v34
    v_xor_b32 v34, s13, v34
    s_lshl_b32 s96, s75, 11
    s_add_u32 s13, s96, 13631488
    v_and_b32 v36, 7, v1
    v_lshl_add_u32 v36, v36, 4, s13
    v_lshrrev_b32 v9, 4, v1
    v_lshl_add_u32 v36, v9, 9, v36
    v_and_b32 v10, 15, v1
    v_lshlrev_b32 v10, 9, v10
    v_add_u32 v10, 13631744, v10
    s_waitcnt vmcnt(0)
    s_waitcnt lgkmcnt(0)
    s_barrier
    ds_read_b128 v[244:247], v5
    v_and_b32 v8, 8, v1
    v_cmp_eq_u32 s[22:23], 0, v8
    v_cmp_gt_u32 s[24:25], 16, v1
    v_cmp_gt_u32 s[26:27], 32, v1
    s_waitcnt lgkmcnt(0)
    v_min_u32_dpp v192, v244, v244 quad_perm:[1,0,3,2] row_mask:0xf bank_mask:0xf
    v_min_u32_dpp v193, v245, v244 quad_perm:[1,0,3,2] row_mask:0xf bank_mask:0xf
    v_min_u32_dpp v194, v244, v245 quad_perm:[1,0,3,2] row_mask:0xf bank_mask:0xf
    v_max_u32_dpp v246, v246, v246 quad_perm:[1,0,3,2] row_mask:0xf bank_mask:0xf
    v_max_u32_dpp v245, v245, v245 quad_perm:[1,0,3,2] row_mask:0xf bank_mask:0xf
    v_max_u32_dpp v244, v244, v244 quad_perm:[1,0,3,2] row_mask:0xf bank_mask:0xf
    v_max3_u32 v246, v246, v193, v194
    v_max_u32 v245, v245, v192
    v_min_u32_dpp v192, v244, v244 quad_perm:[2,3,0,1] row_mask:0xf bank_mask:0xf
    s_nop 0
    v_min_u32_dpp v193, v245, v244 quad_perm:[2,3,0,1] row_mask:0xf bank_mask:0xf
    v_min_u32_dpp v194, v244, v245 quad_perm:[2,3,0,1] row_mask:0xf bank_mask:0xf
    v_max_u32_dpp v246, v246, v246 quad_perm:[2,3,0,1] row_mask:0xf bank_mask:0xf
    v_max_u32_dpp v245, v245, v245 quad_perm:[2,3,0,1] row_mask:0xf bank_mask:0xf
    v_max_u32_dpp v244, v244, v244 quad_perm:[2,3,0,1] row_mask:0xf bank_mask:0xf
    v_max3_u32 v246, v246, v193, v194
    v_max_u32 v245, v245, v192
    v_min_u32_dpp v192, v244, v244 row_half_mirror row_mask:0xf bank_mask:0xf
    s_nop 0
    v_min_u32_dpp v193, v245, v244 row_half_mirror row_mask:0xf bank_mask:0xf
    v_min_u32_dpp v194, v244, v245 row_half_mirror row_mask:0xf bank_mask:0xf
    v_max_u32_dpp v246, v246, v246 row_half_mirror row_mask:0xf bank_mask:0xf
    v_max_u32_dpp v245, v245, v245 row_half_mirror row_mask:0xf bank_mask:0xf
    v_max_u32_dpp v244, v244, v244 row_half_mirror row_mask:0xf bank_mask:0xf
    v_max3_u32 v246, v246, v193, v194
    v_max_u32 v245, v245, v192
    v_cndmask_b32 v192, v245, v244, s[22:23]
    v_cndmask_b32 v201, v246, v245, s[26:27]
    v_and_b32 v193, 31, v246
    v_and_b32 v192, 31, v192
    v_cndmask_b32 v201, v201, v244, s[24:25]
    v_lshl_add_u32 v4, v192, 13, v36
    v_lshl_add_u32 v5, v193, 13, v36
    v_and_b32 v194, 31, v201
    v_lshl_add_u32 v6, v194, 13, v10
    buffer_load_dwordx4 v[192:195], v4, s[32:35], 0 offen sc1
    buffer_load_dwordx4 v[196:199], v5, s[32:35], 0 offen sc1
    buffer_load_dword v200, v6, s[32:35], 0 offen sc1
    s_barrier
    s_add_u32 s82, s81, 12288
    s_lshl2_add_u32 m0, s83, 68608
    s_nop 0
    buffer_load_dwordx4 v253, s[60:63], s82 offen nt lds
    v_readfirstlane_b32 s91, v244
    v_readfirstlane_b32 s94, v245
    v_readfirstlane_b32 s95, v246
    ds_read_b64_tr_b16 v[56:57], v34
    ds_read_b64_tr_b16 v[58:59], v34 offset:512
    ds_read_b64_tr_b16 v[60:61], v34 offset:1024
    ds_read_b64_tr_b16 v[62:63], v34 offset:1536
    ds_read_b64_tr_b16 v[64:65], v34 offset:2048
    ds_read_b64_tr_b16 v[66:67], v34 offset:2560
    ds_read_b64_tr_b16 v[68:69], v34 offset:3072
    ds_read_b64_tr_b16 v[70:71], v34 offset:3584
    ds_read_b64_tr_b16 v[72:73], v34 offset:4096
    ds_read_b64_tr_b16 v[74:75], v34 offset:4608
    ds_read_b64_tr_b16 v[76:77], v34 offset:5120
    ds_read_b64_tr_b16 v[78:79], v34 offset:5632
    ds_read_b64_tr_b16 v[80:81], v34 offset:6144
    ds_read_b64_tr_b16 v[82:83], v34 offset:6656
    ds_read_b64_tr_b16 v[84:85], v34 offset:7168
    ds_read_b64_tr_b16 v[86:87], v34 offset:7680
    s_bfe_u32 s96, s91, 262145
    s_lshl_b32 s97, s96, 7
    s_bfe_u32 s98, s91, 458757
    s_add_u32 s99, s97, s98
    s_xor_b32 s17, s99, 2047
    s_bfe_u32 s96, s94, 262145
    s_lshl_b32 s97, s96, 7
    s_bfe_u32 s98, s94, 458757
    s_add_u32 s99, s97, s98
    s_xor_b32 s18, s99, 2047
    s_bfe_u32 s96, s95, 262145
    s_lshl_b32 s97, s96, 7
    s_bfe_u32 s98, s95, 458757
    s_add_u32 s99, s97, s98
    s_xor_b32 s19, s99, 2047
    s_waitcnt lgkmcnt(0)
    s_lshl_b32 s13, s3, 6
    v_bfe_u32 v35, v1, 2, 1
    v_lshlrev_b32 v35, 9, v35
    v_bfe_u32 v9, v1, 3, 1
    v_lshl_add_u32 v35, v9, 12, v35
    v_lshrrev_b32 v9, 5, v1
    v_lshl_add_u32 v35, v9, 11, v35
    v_bfe_u32 v9, v1, 2, 2
    v_lshl_add_u32 v35, v9, 6, v35
    v_bfe_u32 v9, v1, 4, 1
    v_lshl_add_u32 v35, v9, 5, v35
    v_and_b32 v9, 3, v1
    v_lshl_add_u32 v35, v9, 3, v35
    v_xor_b32 v35, s13, v35
    v_add_u32 v35, 65536, v35
    v_and_b32 v8, 15, v1
    v_lshlrev_b32 v8, 4, v8
    v_lshrrev_b32 v9, 5, v1
    v_lshl_add_u32 v8, v9, 3, v8
    s_lshl_b32 s96, s74, 13
    s_add_u32 s14, s96, 20971520
    s_lshl3_add_u32 s96, s75, s3
    s_lshl_b32 s97, s96, 8
    s_add_u32 s20, s97, s14
    v_bfe_u32 v7, v201, 1, 4
    v_bfe_u32 v201, v201, 5, 7
    v_lshl_or_b32 v201, v7, 7, v201
    v_xor_b32 v201, 0x7ff, v201
    s_waitcnt vmcnt(1)
    v_max3_u32 v7, v192, v196, v200
    v_cmp_eq_u32 vcc, -1, v7
    s_cbranch_vccz POK_43
PRE_44:
    buffer_load_dwordx4 v[192:195], v4, s[32:35], 0 offen sc1
    buffer_load_dwordx4 v[196:199], v5, s[32:35], 0 offen sc1
    buffer_load_dword v200, v6, s[32:35], 0 offen sc1
    s_waitcnt vmcnt(0)
    v_max3_u32 v7, v192, v196, v200
    v_cmp_eq_u32 vcc, -1, v7
    s_cbranch_vccz POK_43
    s_add_u32 s5, s5, 1
    s_cmp_lt_u32 s5, 200000
    s_cbranch_scc1 PRE_44
POK_43:
    v_add_f32_dpp v200, v200, v200 quad_perm:[1,0,3,2] row_mask:0xf bank_mask:0xf
    s_nop 1
    v_add_f32_dpp v200, v200, v200 quad_perm:[2,3,0,1] row_mask:0xf bank_mask:0xf
    s_nop 1
    v_add_f32_dpp v200, v200, v200 row_half_mirror row_mask:0xf bank_mask:0xf
    s_nop 1
    v_add_f32_dpp v200, v200, v200 row_mirror row_mask:0xf bank_mask:0xf
    v_cvt_pk_bf16_f32 v200, 0, v200
    v_ashrrev_i32 v7, 31, v200
    v_or_b32 v7, 0x80000000, v7
    v_xor_b32 v200, v200, v7
    v_lshrrev_b32 v200, 16, v200
    v_lshl_or_b32 v200, v200, 11, v201
    s_nop 0
    v_readlane_b32 s24, v200, 0
    v_readlane_b32 s25, v200, 16
    v_readlane_b32 s26, v200, 32
    s_not_b64 s[28:29], s[22:23]
    s_cmp_lt_u32 s24, s25
    s_cselect_b64 s[28:29], s[22:23], s[28:29]
    s_cselect_b32 s27, s24, s25
    s_cmp_gt_u32 s26, s27
    s_cselect_b64 vcc, s[28:29], 0
    v_cndmask_b32 v192, v192, v196, vcc
    v_cndmask_b32 v193, v193, v197, vcc
    v_cndmask_b32 v194, v194, v198, vcc
    v_cndmask_b32 v195, v195, v199, vcc
    s_bitcmp1_b32 vcc_lo, 0
    s_cselect_b32 s24, s26, s24
    s_cselect_b32 s19, s17, s19
    s_cselect_b32 s17, s95, s91
    s_bitcmp1_b32 vcc_lo, 8
    s_cselect_b32 s25, s26, s25
    s_cselect_b32 s19, s18, s19
    s_cselect_b32 s18, s95, s94
    s_waitcnt lgkmcnt(0)
    v_mfma_f32_16x16x32_bf16 v[136:139], v[192:195], v[56:59], 0
    v_mfma_f32_16x16x32_bf16 v[140:143], v[192:195], v[60:63], 0
    v_mfma_f32_16x16x32_bf16 v[144:147], v[192:195], v[64:67], 0
    v_mfma_f32_16x16x32_bf16 v[148:151], v[192:195], v[68:71], 0
    v_mfma_f32_16x16x32_bf16 v[168:171], v[192:195], v[72:75], 0
    v_mfma_f32_16x16x32_bf16 v[172:175], v[192:195], v[76:79], 0
    v_mfma_f32_16x16x32_bf16 v[176:179], v[192:195], v[80:83], 0
    v_mfma_f32_16x16x32_bf16 v[180:183], v[192:195], v[84:87], 0
    s_nop 1
    v_add_f32 v196, v136, v141
    s_nop 0
    v_add_f32 v197, v146, v151
    s_nop 0
    v_add_f32 v198, v168, v173
    s_nop 0
    v_add_f32 v199, v178, v183
    v_add_f32 v196, v196, v197
    v_add_f32 v198, v198, v199
    v_mov_b32 v197, s4
    s_nop 0
    v_permlane16_swap_b32 v198, v199
    s_cmp_ge_u32 s9, 28
    s_cbranch_scc1 L_NOHP
    v_add_f32 v196, v196, v199
    s_mov_b32 exec_lo, 0xffff
    s_mov_b32 exec_hi, 0xffff
    buffer_store_dwordx2 v[196:197], v8, s[32:35], s20 offen sc1
    s_mov_b64 exec, -1
L_NOHP:
    s_and_b32 s68, s24, 2047
    s_and_b32 s69, s25, 2047
    s_mov_b32 s70, s16
    s_mov_b32 s71, s15
    v_pk_add_f32 v[208:209], v[208:209], v[152:153]
    v_pk_add_f32 v[210:211], v[210:211], v[154:155]
    v_pk_add_f32 v[212:213], v[212:213], v[156:157]
    v_pk_add_f32 v[214:215], v[214:215], v[158:159]
    v_pk_add_f32 v[216:217], v[216:217], v[160:161]
    v_pk_add_f32 v[218:219], v[218:219], v[162:163]
    v_pk_add_f32 v[220:221], v[220:221], v[164:165]
    v_pk_add_f32 v[222:223], v[222:223], v[166:167]
    v_cvt_pk_bf16_f32 v232, v208, v209
    v_cvt_pk_bf16_f32 v233, v210, v211
    v_cvt_pk_bf16_f32 v234, v212, v213
    v_cvt_pk_bf16_f32 v235, v214, v215
    v_cvt_pk_bf16_f32 v236, v216, v217
    v_cvt_pk_bf16_f32 v237, v218, v219
    v_cvt_pk_bf16_f32 v238, v220, v221
    v_cvt_pk_bf16_f32 v239, v222, v223
    v_permlane32_swap_b32 v232, v234
    v_permlane32_swap_b32 v233, v235
    v_permlane32_swap_b32 v236, v238
    v_permlane32_swap_b32 v237, v239
    ds_write_b128 v202, v[232:235]
    ds_write_b128 v204, v[236:239]
    ds_read_b128 v[232:235], v203
    ds_read_b128 v[236:239], v203 offset:1024
    s_waitcnt lgkmcnt(0)
    s_cmp_lg_u32 s93, 7
    s_cbranch_scc1 L_NONON
    v_mov_b32 v6, s4
    v_mov_b32 v7, 0
    s_mov_b64 exec, 1
    buffer_store_dword v6, v7, s[32:35], 0 offen sc1
    s_mov_b64 exec, -1
L_NONON:
    s_cmp_ge_u32 s9, 28
    s_cbranch_scc1 L_FIN2
    s_cmp_lg_u32 s3, 7
    s_cbranch_scc1 L_NOFZ
    s_bitcmp1_b32 s9, 3
    s_cselect_b32 s15, s25, s24
    s_cselect_b32 s17, s18, s17
    s_andn2_b32 s18, 2047, s15
    s_lshr_b32 s96, s8, 1
    s_lshl2_add_u32 s19, s12, s96
    s_lshr_b32 s96, s19, 1
    s_lshr_b32 s97, s9, 3
    s_lshl_b32 s98, s97, 1
    s_lshl2_add_u32 s99, s96, s98
    s_and_b32 s97, s19, 1
    s_add_u32 s96, s99, s97
    s_mul_i32 s98, s96, 7168
    s_add_u32 s20, s98, 22020096
    s_lshl_b32 s96, s18, 11
    s_lshl_b32 s97, s19, 5
    s_add_u32 s82, s96, s97
    v_and_b32 v10, 7, v1
    v_lshlrev_b32 v10, 2, v10
    s_lshr_b32 s96, s8, 1
    s_lshl_b32 s97, s96, 6
    s_add_u32 s13, s97, 157184
    v_and_b32 v5, 7, v1
    v_lshl_add_u32 v5, v5, 3, s13
    ds_read_b64 v[206:207], v5
    s_and_b32 s96, s17, 31
    s_lshl_b32 s97, s96, 13
    s_lshl_b32 s98, s12, 9
    s_add_u32 s99, s97, s98
    s_lshr_b32 s96, s8, 1
    s_lshl_b32 s97, s96, 5
    s_add_u32 s98, s99, s97
    s_add_u32 s91, s98, 13631488
    s_lshr_b32 s13, s15, 11
    s_lshl_b32 s13, s13, 16
    s_ashr_i32 s15, s13, 31
    s_andn2_b32 s15, 0x7fff0000, s15
    s_or_b32 s15, s15, 0x80000000
    s_xor_b32 s13, s13, s15
    v_mov_b32 v204, s13
    v_mul_f32 v204, s7, v204
    v_exp_f32 v204, -v204
    s_nop 0
    v_add_f32 v204, 1.0, v204
    v_rcp_f32 v204, v204
    s_nop 0
    v_cvt_pk_bf16_f32 v204, 0, v204
L_NOFZ:
    s_cmp_ge_u32 s3, 4
    s_cbranch_scc1 L_NOH
    s_lshl_b32 s96, s3, 8
    s_add_u32 s13, s96, s14
    v_lshrrev_b32 v4, 4, v1
    v_lshlrev_b32 v4, 11, v4
    v_and_b32 v9, 15, v1
    v_lshl_add_u32 v4, v9, 4, v4
    s_lshl_b32 s96, s3, 5
    s_add_u32 s15, s96, 156672
    v_lshrrev_b32 v5, 5, v1
    v_lshl_add_u32 v5, v5, 7, s15
    v_bfe_u32 v9, v1, 2, 1
    v_lshl_add_u32 v5, v9, 4, v5
    v_bfe_u32 v9, v1, 1, 1
    v_lshl_add_u32 v5, v9, 3, v5
    v_bfe_u32 v9, v1, 3, 1
    v_lshl_add_u32 v5, v9, 2, v5
    v_and_b32 v9, 1, v1
    v_lshl_add_u32 v5, v9, 1, v5
SPOLL_45:
    s_load_dword s24, s[32:33], s13 offset:1276 glc
    s_load_dword s25, s[32:33], s13 offset:3324 glc
    s_load_dword s26, s[32:33], s13 offset:5372 glc
    s_load_dword s27, s[32:33], s13 offset:7420 glc
SCHK_46:
    s_add_u32 s5, s5, 1
    s_cmp_ge_u32 s5, 200000
    s_waitcnt lgkmcnt(0)
    s_cbranch_scc1 SDONE_47
    s_cmp_lg_u32 s24, s4
    s_cbranch_scc1 SPOLL_45
    s_cmp_lg_u32 s25, s4
    s_cbranch_scc1 SPOLL_45
    s_cmp_lg_u32 s26, s4
    s_cbranch_scc1 SPOLL_45
    s_cmp_lg_u32 s27, s4
    s_cbranch_scc1 SPOLL_45
SDONE_47:
POLL_48:
    buffer_load_dwordx4 v[88:91], v4, s[32:35], s13 offen sc1
    buffer_load_dwordx4 v[92:95], v4, s[32:35], s13 offen offset:1024 sc1
    s_waitcnt vmcnt(0)
    v_bitop3_b32 v6, v89, v91, s4 bitop3:0x7e
    v_bitop3_b32 v6, v6, v93, s4 bitop3:0xf6
    v_bitop3_b32 v6, v6, v95, s4 bitop3:0xf6
    v_cmp_ne_u32 vcc, 0, v6
    s_cbranch_vccz PDONE_49
    s_add_u32 s5, s5, 1
    s_cmp_lt_u32 s5, 200000
    s_cbranch_scc1 POLL_48
PDONE_49:
    v_permlane32_swap_b32 v88, v90
    v_permlane32_swap_b32 v92, v94
    v_add_f32 v88, v88, v90
    v_add_f32 v92, v92, v94
    v_mov_b32 v90, v88
    v_mov_b32 v94, v92
    s_nop 0
    v_permlane16_swap_b32 v88, v90
    v_permlane16_swap_b32 v92, v94
    v_add_f32 v88, v88, v90
    v_add_f32 v92, v92, v94
    v_cvt_pk_bf16_f32 v88, 0, v88
    v_cvt_pk_bf16_f32 v92, 0, v92
    v_mul_f32 v6, s7, v88
    v_exp_f32 v6, -v6
    s_nop 0
    v_add_f32 v6, 1.0, v6
    v_rcp_f32 v6, v6
    s_nop 0
    v_mul_f32 v88, v88, v6
    v_cvt_pk_bf16_f32 v88, 0, v88
    v_mul_f32 v88, v88, v92
    v_cvt_pk_bf16_f32 v88, v88, v88
    ds_write_b16 v5, v88
L_NOH:
    v_bfe_u32 v4, v1, 2, 1
    v_lshlrev_b32 v4, 7, v4
    v_lshrrev_b32 v9, 5, v1
    v_lshl_add_u32 v4, v9, 4, v4
L_PAD10:
    s_cbranch_execz L_RET10
    v_add_u32 v4, 156672, v4
    v_lshrrev_b32 v5, 4, v1
    v_mul_u32_u24 v5, 7168, v5
    v_and_b32 v9, 15, v1
    v_lshl_add_u32 v5, v9, 3, v5
    s_lshl3_add_u32 s96, s75, s3
    s_mul_i32 s97, s96, 28672
    s_lshl_b32 s98, s74, 7
    s_add_u32 s99, s97, s98
    s_add_u32 s13, s99, 22020096
    v_and_b32 v6, 1, v1
    v_lshlrev_b32 v6, 13, v6
    v_bfe_u32 v9, v1, 1, 1
    v_lshl_add_u32 v6, v9, 18, v6
    s_lshr_b32 s96, s9, 2
    s_and_b32 s97, s75, 1
    s_lshr_b32 s98, s3, 1
    s_lshl2_add_u32 s99, s97, s98
    s_and_b32 s97, s3, 1
    s_lshr_b32 s98, s75, 1
    s_lshl2_add_u32 s97, s97, s98
    s_lshl3_add_u32 s98, s99, s97
    s_lshl_b32 s99, s98, 12
    s_lshl_b32 s97, s8, 6
    s_add_u32 s98, s99, s97
    s_lshl2_add_u32 s99, s96, s98
    s_add_u32 s97, s99, 1048576
    s_add_u32 s14, s97, 3072
    s_waitcnt vmcnt(0)
    s_waitcnt lgkmcnt(0)
    s_barrier
    ds_read_b128 v[88:91], v4
    ds_read_b64_tr_b16 v[120:121], v35
    ds_read_b64_tr_b16 v[122:123], v35 offset:1024
    ds_read_b128 v[92:95], v4 offset:32
    ds_read_b64_tr_b16 v[124:125], v35 offset:8192
    ds_read_b64_tr_b16 v[126:127], v35 offset:9216
    ds_read_b128 v[96:99], v4 offset:64
    ds_read_b64_tr_b16 v[128:129], v35 offset:16384
    ds_read_b64_tr_b16 v[130:131], v35 offset:17408
    ds_read_b128 v[100:103], v4 offset:96
    ds_read_b64_tr_b16 v[132:133], v35 offset:24576
    ds_read_b64_tr_b16 v[134:135], v35 offset:25600
    s_waitcnt lgkmcnt(9)
    v_mfma_f32_32x32x16_bf16 v[208:223], v[88:91], v[120:123], 0
    s_waitcnt lgkmcnt(6)
    v_mfma_f32_32x32x16_bf16 v[208:223], v[92:95], v[124:127], v[208:223]
    s_waitcnt lgkmcnt(3)
    v_mfma_f32_32x32x16_bf16 v[208:223], v[96:99], v[128:131], v[208:223]
    s_waitcnt lgkmcnt(0)
    v_mfma_f32_32x32x16_bf16 v[208:223], v[100:103], v[132:135], v[208:223]
    s_nop 11
    v_mov_b32 v209, s4
    buffer_store_dwordx2 v[208:209], v5, s[32:35], s13 offen sc1
    s_mov_b64 exec, 15
    buffer_store_dword v209, v6, s[32:35], s14 offen sc1
    s_mov_b64 exec, -1
    s_barrier
L_FIN2:
    v_cmp_ne_u32 vcc, s68, v42
    v_cmp_ne_u32 s[22:23], s69, v42
    s_nop 0
    s_and_b64 exec, vcc, s[22:23]
    buffer_store_dwordx4 v[232:235], v33, s[64:67], s70 offen sc1
    s_mov_b64 exec, -1
    v_cmp_ne_u32 vcc, s68, v43
    v_cmp_ne_u32 s[22:23], s69, v43
    s_nop 0
    s_and_b64 exec, vcc, s[22:23]
    buffer_store_dwordx4 v[236:239], v33, s[64:67], s71 offen sc1
    s_mov_b64 exec, -1
    s_cmp_ge_u32 s9, 16
    s_cbranch_scc1 L_FIN
SPOLL_50:
    s_load_dwordx8 s[24:31], s[32:33], s92 offset:3072 glc
SCHK_51:
    s_add_u32 s5, s5, 1
    s_cmp_ge_u32 s5, 200000
    s_waitcnt lgkmcnt(0)
    s_cbranch_scc1 SDONE_52
    s_cmp_lg_u32 s24, s4
    s_cbranch_scc1 SPOLL_50
    s_cmp_lg_u32 s25, s4
    s_cbranch_scc1 SPOLL_50
    s_cmp_lg_u32 s26, s4
    s_cbranch_scc1 SPOLL_50
    s_cmp_lg_u32 s27, s4
    s_cbranch_scc1 SPOLL_50
    s_cmp_lg_u32 s28, s4
    s_cbranch_scc1 SPOLL_50
    s_cmp_lg_u32 s29, s4
    s_cbranch_scc1 SPOLL_50
    s_cmp_lg_u32 s30, s4
    s_cbranch_scc1 SPOLL_50
SDONE_52:
    s_barrier
    s_cmp_lg_u32 s3, 7
    s_cbranch_scc1 L_FIN
    s_add_u32 s13, s20, 4096
    v_mov_b32 v5, s4
    v_not_b32 v6, v5
POLL_53:
    buffer_load_dwordx4 v[88:91], v2, s[32:35], s20 offen sc1
    buffer_load_dwordx4 v[92:95], v2, s[32:35], s20 offen offset:1024 sc1
    buffer_load_dwordx4 v[96:99], v2, s[32:35], s20 offen offset:2048 sc1
    buffer_load_dwordx4 v[100:103], v2, s[32:35], s20 offen offset:3072 sc1
    buffer_load_dwordx4 v[104:107], v2, s[32:35], s13 offen sc1
    buffer_load_dwordx4 v[108:111], v2, s[32:35], s13 offen offset:1024 sc1
    buffer_load_dwordx4 v[112:115], v2, s[32:35], s13 offen offset:2048 sc1
    buffer_load_dword v244, v10, s[32:35], s91 offen sc1
    buffer_load_dword v245, v10, s[32:35], s91 offen offset:128 sc1
    s_waitcnt vmcnt(0)
    v_max_u32 v246, v244, v245
    v_cmp_ne_u32 vcc, -1, v246
    s_nop 1
    v_cndmask_b32 v246, v6, v5, vcc
    v_bitop3_b32 v4, v89, v91, s4 bitop3:0x7e
    v_bitop3_b32 v4, v4, v93, s4 bitop3:0xf6
    v_bitop3_b32 v4, v4, v95, s4 bitop3:0xf6
    v_bitop3_b32 v4, v4, v97, s4 bitop3:0xf6
    v_bitop3_b32 v4, v4, v99, s4 bitop3:0xf6
    v_bitop3_b32 v4, v4, v101, s4 bitop3:0xf6
    v_bitop3_b32 v4, v4, v103, s4 bitop3:0xf6
    v_bitop3_b32 v4, v4, v105, s4 bitop3:0xf6
    v_bitop3_b32 v4, v4, v107, s4 bitop3:0xf6
    v_bitop3_b32 v4, v4, v109, s4 bitop3:0xf6
    v_bitop3_b32 v4, v4, v111, s4 bitop3:0xf6
    v_bitop3_b32 v4, v4, v113, s4 bitop3:0xf6
    v_bitop3_b32 v4, v4, v115, s4 bitop3:0xf6
    v_bitop3_b32 v4, v4, v246, s4 bitop3:0xf6
    v_cmp_ne_u32 vcc, 0, v4
    s_cbranch_vccz PDONE_54
    s_add_u32 s5, s5, 1
    s_cmp_lt_u32 s5, 200000
    s_cbranch_scc1 POLL_53
PDONE_54:
    v_add_f32 v88, v88, v92
    v_add_f32 v90, v90, v94
    v_add_f32 v88, v88, v96
    v_add_f32 v90, v90, v98
    v_add_f32 v88, v88, v100
    v_add_f32 v90, v90, v102
    v_add_f32 v88, v88, v104
    v_add_f32 v90, v90, v106
    v_add_f32 v88, v88, v108
    v_add_f32 v90, v90, v110
    v_add_f32 v88, v88, v112
    v_add_f32 v90, v90, v114
    v_mov_b32 v89, v90
    v_add_f32_dpp v88, v88, v88 row_ror:8 row_mask:0xf bank_mask:0xf
    s_nop 0
    v_add_f32_dpp v89, v89, v89 row_ror:8 row_mask:0xf bank_mask:0xf
    v_mov_b32 v90, v88
    v_mov_b32 v91, v89
    s_nop 0
    v_permlane16_swap_b32 v88, v90
    v_permlane16_swap_b32 v89, v91
    v_pk_add_f32 v[88:89], v[88:89], v[90:91]
    v_mov_b32 v90, v88
    v_mov_b32 v91, v89
    s_nop 0
    v_permlane32_swap_b32 v88, v90
    v_permlane32_swap_b32 v89, v91
    v_pk_add_f32 v[88:89], v[88:89], v[90:91]
    v_cvt_pk_bf16_f32 v88, 0, v88
    v_cvt_pk_bf16_f32 v89, 0, v89
    v_pk_mul_f32 v[88:89], v[88:89], v[204:205] op_sel_hi:[1,0]
    v_lshlrev_b32 v4, 16, v244
    v_and_b32 v5, s6, v244
    v_cvt_pk_bf16_f32 v88, 0, v88
    v_cvt_pk_bf16_f32 v89, 0, v89
    v_pk_add_f32 v[88:89], v[88:89], v[4:5]
    v_cvt_pk_bf16_f32 v88, 0, v88
    v_cvt_pk_bf16_f32 v89, 0, v89
    v_pk_mul_f32 v[88:89], v[88:89], v[206:207]
    v_lshlrev_b32 v4, 16, v245
    v_and_b32 v5, s6, v245
    v_cvt_pk_bf16_f32 v88, 0, v88
    v_cvt_pk_bf16_f32 v89, 0, v89
    v_pk_add_f32 v[88:89], v[88:89], v[4:5]
    v_cvt_pk_bf16_f32 v88, v88, v89
    s_mov_b64 exec, 0xff
    buffer_store_dword v88, v10, s[64:67], s82 offen
    s_mov_b64 exec, -1
L_FIN:
L_END:
    s_endpgm
.p2align 10
.fill 768, 4, 0xbf800000
.section .rodata,"a"
.p2align 6
.amdhsa_kernel adaLN_cond__linear_kernel_hedgehog__moe_arch_mod__prompt_kernel
  .amdhsa_next_free_vgpr 256
  .amdhsa_next_free_sgpr 102
  .amdhsa_accum_offset 256
  .amdhsa_group_segment_fixed_size 0
  .amdhsa_kernarg_size 112
  .amdhsa_user_sgpr_count 2
  .amdhsa_user_sgpr_kernarg_segment_ptr 1
  .amdhsa_system_sgpr_workgroup_id_x 1
  .amdhsa_float_denorm_mode_32 3
  .amdhsa_float_denorm_mode_16_64 3
.end_amdhsa_kernel
```

```asm
; @launch grid=(256,1,1) block=(512,1,1) lds=163840
.amdgcn_target "amdgcn-amd-amdhsa--gfx950"
.text
.globl adaLN_cond__linear_kernel_hedgehog__moe_arch_mod__prompt_kernel
.p2align 12
.type adaLN_cond__linear_kernel_hedgehog__moe_arch_mod__prompt_kernel,@function
adaLN_cond__linear_kernel_hedgehog__moe_arch_mod__prompt_kernel:
    s_load_dwordx16 s[68:83], s[0:1], 0
    s_load_dwordx8 s[84:91], s[0:1], 64
    s_load_dwordx2 s[32:33], s[0:1], 104
    s_cmp_ge_u32 s2, 256
    s_cbranch_scc1 L_END
    v_lshrrev_b32 v4, 6, v0
    v_and_b32 v1, 63, v0
    s_nop 0
    v_readfirstlane_b32 s3, v4
    v_lshlrev_b32 v2, 4, v1
    s_mov_b32 s38, 4194304
    s_mov_b32 s39, 0x20000
    s_mov_b32 s50, 12582912
    s_mov_b32 s51, 0x20000
    s_mov_b32 s34, 268435456
    s_mov_b32 s35, 0x20000
    s_mov_b32 s42, 6291456
    s_mov_b32 s43, 0x20000
    s_mov_b32 s46, 2097152
    s_mov_b32 s47, 0x20000
    s_mov_b32 s54, 7340032
    s_mov_b32 s55, 0x20000
    s_mov_b32 s58, 7340032
    s_mov_b32 s59, 0x20000
    s_mov_b32 s62, 7340032
    s_mov_b32 s63, 0x20000
    s_mov_b32 s66, 4194304
    s_mov_b32 s67, 0x20000
    s_mov_b32 s5, 0
    s_mov_b32 s6, 0xffff0000
    s_mov_b32 s7, 0x3fb8aa3b
    s_and_b32 s8, s2, 7
    s_lshr_b32 s9, s2, 3
    s_lshl_b32 s96, s8, 5
    s_add_u32 s97, s96, s9
    s_lshl3_add_u32 s93, s97, s3
    s_and_b32 s96, s8, 4
    s_lshr_b32 s97, s9, 2
    s_lshl1_add_u32 s10, s96, s97
    s_and_b32 s96, s8, 3
    s_and_b32 s97, s9, 3
    s_xor_b32 s98, s97, 2
    s_lshl2_add_u32 s11, s96, s98
    s_and_b32 s96, s8, 1
    s_and_b32 s97, s9, 7
    s_lshl3_add_u32 s12, s96, s97
    s_lshr_b32 s96, s8, 1
    s_lshr_b32 s97, s9, 3
    s_lshl2_add_u32 s21, s96, s97
    s_lshl_b32 s96, s2, 6
    s_add_u32 s97, s96, s3
    s_lshl_b32 s98, s97, 6
    s_add_u32 s92, s98, 1048576
    s_lshl_b32 s16, s93, 11
    s_lshl3_add_u32 s96, s8, s3
    s_lshl_b32 s15, s96, 5
    s_mul_i32 s96, s15, 6144
    s_xor_b32 s97, s9, 1
    s_lshl_b32 s98, s97, 7
    s_add_u32 s13, s96, s98
    s_add_u32 s14, s13, 98304
    s_lshl3_add_u32 s96, s21, s3
    s_lshl_b32 s97, s96, 15
    s_lshl_b32 s98, s12, 7
    s_add_u32 s18, s97, s98
    s_lshr_b32 s96, s8, 1
    s_lshl4_add_u32 s97, s96, s12
    s_lshl4_add_u32 s98, s97, s3
    s_lshl_b32 s99, s98, 9
    s_add_u32 s17, s99, 524288
    v_lshrrev_b32 v248, 3, v1
    v_mul_u32_u24 v248, 12288, v248
    v_and_b32 v9, 7, v1
    v_lshl_add_u32 v248, v9, 4, v248
    v_lshrrev_b32 v249, 3, v1
    v_lshl_add_u32 v249, v249, 1, s15
    v_and_b32 v10, 15, v1
    v_lshlrev_b32 v10, 11, v10
    v_lshrrev_b32 v9, 4, v1
    v_lshl_add_u32 v10, v9, 4, v10
    s_waitcnt lgkmcnt(0)
    s_mov_b64 s[48:49], s[88:89]
    buffer_load_dwordx4 v[160:163], v248, s[48:51], s13 offen nt
    buffer_load_dwordx4 v[164:167], v248, s[48:51], s14 offen nt
    s_load_dword s4, s[32:33], 0
    global_load_ushort v168, v249, s[86:87]
    global_load_ushort v169, v249, s[86:87] offset:16
    s_mov_b64 s[36:37], s[68:69]
    s_load_dword s24, s[32:33], s92 offset:0 glc
    s_load_dword s25, s[32:33], s17 offset:508 glc
    s_load_dword s26, s[32:33], s17 offset:4604 glc
    s_barrier
    buffer_load_dwordx4 v[152:155], v2, s[36:39], s16 offen
    buffer_load_dwordx4 v[156:159], v2, s[36:39], s16 offen offset:1024
    s_mov_b64 s[40:41], s[70:71]
    s_mov_b64 s[44:45], s[74:75]
    s_mov_b64 s[52:53], s[80:81]
    s_mov_b64 s[56:57], s[82:83]
    s_mov_b64 s[60:61], s[84:85]
    s_mov_b64 s[64:65], s[90:91]
    s_getpc_b64 s[22:23]
    s_and_b32 s22, s22, 0xfffffc00
    s_lshl3_add_u32 s96, s9, s3
    s_lshl_b32 s19, s96, 7
    v_lshrrev_b32 v4, 5, v1
    v_lshl_add_u32 v4, v4, 15, s19
    v_min_u32 v4, 41984, v4
    global_load_dword v11, v4, s[22:23]
    s_lshr_b32 s76, s3, 2
    s_and_b32 s77, s3, 3
    s_lshl_b32 s83, s3, 10
    s_mul_i32 s96, s8, 7
    s_lshr_b32 s97, s9, 2
    s_add_u32 s74, s96, s97
    s_and_b32 s75, s9, 3
    v_bfe_u32 v6, v1, 4, 1
    v_lshlrev_b32 v6, 6, v6
    v_and_b32 v3, 7, v1
    v_lshlrev_b32 v3, 4, v3
    v_xor_b32 v3, v3, v6
    v_lshrrev_b32 v6, 3, v1
    v_mul_u32_u24 v6, 6144, v6
    v_add_u32 v3, v3, v6
    s_and_b32 s84, s9, 12
    s_mul_i32 s96, s3, 49152
    s_lshl_b32 s97, s11, 7
    s_add_u32 s85, s96, s97
    v_lshlrev_b32 v250, 3, v1
    v_lshlrev_b32 v251, 5, v1
    v_add_u32 v251, 147456, v251
    s_lshl2_add_u32 s13, s3, 147456
    v_lshrrev_b32 v252, 4, v1
    v_lshl_add_u32 v252, v252, 6, s13
    v_and_b32 v9, 7, v1
    v_lshl_add_u32 v252, v9, 8, v252
    v_bfe_u32 v9, v1, 3, 1
    v_lshl_add_u32 v252, v9, 5, v252
    buffer_load_dwordx4 v[12:15], v10, s[36:39], s18 offen
    buffer_load_dwordx4 v[16:19], v10, s[36:39], s18 offen offset:64
    s_lshr_b32 s96, s3, 1
    s_xor_b32 s97, s9, 1
    s_and_b32 s98, s97, 15
    s_lshl4_add_u32 s99, s96, s98
    s_lshr_b32 s97, s9, 4
    s_lshl1_add_u32 s96, s99, s97
    s_lshl3_add_u32 s98, s96, s8
    s_lshl_b32 s99, s98, 9
    s_add_u32 s13, s99, 524288
    s_waitcnt vmcnt(5)
    v_lshlrev_b32 v168, 16, v168
    v_mul_f32 v4, s7, v168
    v_exp_f32 v4, -v4
    s_nop 0
    v_add_f32 v4, 1.0, v4
    v_rcp_f32 v4, v4
    s_nop 0
    v_mul_f32 v168, v168, v4
    v_cvt_pk_bf16_f32 v168, 0, v168
    v_lshlrev_b32 v169, 16, v169
    v_mul_f32 v5, s7, v169
    v_exp_f32 v5, -v5
    s_nop 0
    v_add_f32 v5, 1.0, v5
    v_rcp_f32 v5, v5
    s_nop 0
    v_mul_f32 v169, v169, v5
    v_cvt_pk_bf16_f32 v169, 0, v169
    v_lshlrev_b32 v4, 16, v160
    v_and_b32 v5, s6, v160
    v_pk_mul_f32 v[176:177], v[168:169], v[4:5] op_sel:[0,0] op_sel_hi:[0,1]
    v_lshlrev_b32 v6, 16, v161
    v_and_b32 v7, s6, v161
    v_pk_mul_f32 v[178:179], v[168:169], v[6:7] op_sel:[0,0] op_sel_hi:[0,1]
    v_lshlrev_b32 v4, 16, v162
    v_and_b32 v5, s6, v162
    v_pk_mul_f32 v[180:181], v[168:169], v[4:5] op_sel:[0,0] op_sel_hi:[0,1]
    v_lshlrev_b32 v6, 16, v163
    v_and_b32 v7, s6, v163
    v_pk_mul_f32 v[182:183], v[168:169], v[6:7] op_sel:[0,0] op_sel_hi:[0,1]
    v_lshlrev_b32 v4, 16, v164
    v_and_b32 v5, s6, v164
    v_pk_fma_f32 v[176:177], v[168:169], v[4:5], v[176:177] op_sel:[1,0,0] op_sel_hi:[1,1,1]
    v_lshlrev_b32 v6, 16, v165
    v_and_b32 v7, s6, v165
    v_pk_fma_f32 v[178:179], v[168:169], v[6:7], v[178:179] op_sel:[1,0,0] op_sel_hi:[1,1,1]
    v_lshlrev_b32 v4, 16, v166
    v_and_b32 v5, s6, v166
    v_pk_fma_f32 v[180:181], v[168:169], v[4:5], v[180:181] op_sel:[1,0,0] op_sel_hi:[1,1,1]
    v_lshlrev_b32 v6, 16, v167
    v_and_b32 v7, s6, v167
    v_pk_fma_f32 v[182:183], v[168:169], v[6:7], v[182:183] op_sel:[1,0,0] op_sel_hi:[1,1,1]
    v_permlane32_swap_b32 v176, v180
    v_permlane32_swap_b32 v177, v181
    v_permlane32_swap_b32 v178, v182
    v_permlane32_swap_b32 v179, v183
    v_add_f32 v176, v176, v180
    v_add_f32 v177, v177, v181
    v_add_f32 v178, v178, v182
    v_add_f32 v179, v179, v183
    s_nop 0
    v_permlane16_swap_b32 v176, v178
    v_permlane16_swap_b32 v177, v179
    v_add_f32 v176, v176, v178
    v_add_f32 v177, v177, v179
    s_nop 0
    v_add_f32_dpp v176, v176, v176 row_ror:8 row_mask:0xf bank_mask:0xf
    v_add_f32_dpp v177, v177, v177 row_ror:8 row_mask:0xf bank_mask:0xf
    s_nop 1
    v_mov_b32_dpp v176, v177 quad_perm:[0,1,2,3] row_mask:0xf bank_mask:0xc
    s_waitcnt lgkmcnt(0)
    s_mul_i32 s4, s4, 0x9e3779b1
    s_add_u32 s4, s4, 0x7f4a7c15
    ds_write_b32 v252, v176
    s_waitcnt lgkmcnt(0)
    s_barrier
    ds_read_b128 v[176:179], v251
    ds_read_b128 v[180:183], v251 offset:16
    s_waitcnt lgkmcnt(0)
    v_pk_add_f32 v[176:177], v[176:177], v[178:179]
    v_pk_add_f32 v[180:181], v[180:181], v[182:183]
    v_pk_add_f32 v[176:177], v[176:177], v[180:181]
    v_add_f32 v176, v176, v177
    v_mov_b32 v177, s4
    s_bitcmp1_b32 s3, 0
    s_cselect_b32 exec_lo, 0, -1
    s_cselect_b32 exec_hi, -1, 0
    buffer_store_dwordx2 v[176:177], v250, s[32:35], s13 offen sc1
    s_mov_b64 exec, -1
    s_lshr_b32 s96, s9, 4
    s_lshl_b32 s94, s96, 1
    s_add_u32 s96, s94, s84
    s_and_b32 s97, s96, 15
    s_mul_i32 s98, s97, 393216
    s_add_u32 s91, s98, s85
    s_lshl_b32 s96, s94, 13
    s_add_u32 s94, s96, s83
    s_add_u32 s82, s91, 2048
    s_mov_b32 m0, s94
    s_nop 0
    buffer_load_dwordx4 v3, s[40:43], s82 offen lds
    s_add_u32 s82, s91, 4096
    s_add_u32 m0, s94, 49152
    s_nop 0
    buffer_load_dwordx4 v3, s[40:43], s82 offen lds
    s_waitcnt vmcnt(6)
    v_mov_b32 v8, 0x3f803f80
    v_dot2_f32_bf16 v4, v152, v8, 0
    v_dot2_f32_bf16 v5, v152, v152, 0
    v_dot2_f32_bf16 v6, v153, v8, 0
    v_dot2_f32_bf16 v7, v153, v153, 0
    v_dot2_f32_bf16 v4, v154, v8, v4
    v_dot2_f32_bf16 v5, v154, v154, v5
    v_dot2_f32_bf16 v6, v155, v8, v6
    v_dot2_f32_bf16 v7, v155, v155, v7
    v_dot2_f32_bf16 v4, v156, v8, v4
    v_dot2_f32_bf16 v5, v156, v156, v5
    v_dot2_f32_bf16 v6, v157, v8, v6
    v_dot2_f32_bf16 v7, v157, v157, v7
    v_dot2_f32_bf16 v4, v158, v8, v4
    v_dot2_f32_bf16 v5, v158, v158, v5
    v_dot2_f32_bf16 v6, v159, v8, v6
    v_dot2_f32_bf16 v7, v159, v159, v7
    s_nop 2
    v_pk_add_f32 v[4:5], v[4:5], v[6:7]
    s_nop 1
    v_add_f32_dpp v4, v4, v4 quad_perm:[1,0,3,2] row_mask:0xf bank_mask:0xf
    v_add_f32_dpp v5, v5, v5 quad_perm:[1,0,3,2] row_mask:0xf bank_mask:0xf
    s_nop 0
    v_add_f32_dpp v4, v4, v4 quad_perm:[2,3,0,1] row_mask:0xf bank_mask:0xf
    v_add_f32_dpp v5, v5, v5 quad_perm:[2,3,0,1] row_mask:0xf bank_mask:0xf
    s_nop 0
    v_add_f32_dpp v4, v4, v4 row_half_mirror row_mask:0xf bank_mask:0xf
    v_add_f32_dpp v5, v5, v5 row_half_mirror row_mask:0xf bank_mask:0xf
    s_nop 0
    v_add_f32_dpp v4, v4, v4 row_ror:8 row_mask:0xf bank_mask:0xf
    v_add_f32_dpp v5, v5, v5 row_ror:8 row_mask:0xf bank_mask:0xf
    s_nop 1
    v_permlane16_swap_b32 v4, v5
    v_add_f32 v8, v4, v5
    v_add_f32 v4, v4, v5
    s_nop 1
    v_permlane32_swap_b32 v4, v8
    v_add_f32 v4, v4, v8
    v_mul_f32 v8, 0x3a800000, v4
    v_mul_f32 v4, 0x3a800000, v4
    s_nop 1
    v_permlane16_swap_b32 v4, v8
    v_fma_f32 v173, -v4, v4, v8
    v_cvt_pk_bf16_f32 v172, 0, v4
    v_max_f32 v173, 0, v173
    v_cvt_pk_bf16_f32 v173, 0, v173
    v_add_f32 v173, 0x3727c5ac, v173
    v_cvt_pk_bf16_f32 v173, 0, v173
    v_sqrt_f32 v173, v173
    s_nop 0
    v_cvt_pk_bf16_f32 v173, 0, v173
    s_lshl3_add_u32 s13, s3, 153600
    v_lshrrev_b32 v172, 16, v172
    v_or_b32 v172, v172, v173
    v_mov_b32 v173, s4
    v_mov_b32 v4, s13
    ds_write_b64 v4, v[172:173]
    v_and_b32 v5, 3, v1
    v_lshlrev_b32 v5, 4, v5
    v_add_u32 v5, 153600, v5
    v_and_b32 v4, 3, v1
    v_lshlrev_b32 v4, 4, v4
    v_bfe_u32 v9, v1, 2, 1
    v_lshl_add_u32 v4, v9, 10, v4
    s_and_b32 s96, s8, 6
    s_and_b32 s97, s8, 1
    s_lshr_b32 s98, s9, 4
    s_lshl1_add_u32 s99, s97, s98
    s_lshl_b32 s97, s99, 6
    s_add_u32 s98, s96, s97
    s_lshl3_add_u32 s99, s3, s98
    s_lshl_b32 s96, s99, 10
    s_and_b32 s97, s9, 15
    s_lshl_b32 s98, s97, 6
    s_add_u32 s99, s96, s98
    s_add_u32 s13, s99, 262144
    s_waitcnt lgkmcnt(0)
    s_barrier
    ds_read_b128 v[172:175], v5
    s_waitcnt lgkmcnt(0)
    s_mov_b64 exec, 0xff
    buffer_store_dwordx4 v[172:175], v4, s[32:35], s13 offen sc1
    s_mov_b64 exec, -1
    s_mov_b32 s82, s91
    s_add_u32 m0, s94, 98304
    s_nop 0
    buffer_load_dwordx4 v3, s[40:43], s82 offen lds
    s_load_dword s24, s[32:33], s17 offset:508 glc
    s_load_dword s25, s[32:33], s17 offset:4604 glc
    v_and_b32 v4, 31, v1
    v_lshlrev_b32 v4, 4, v4
    v_lshrrev_b32 v9, 5, v1
    v_lshl_add_u32 v4, v9, 12, v4
    s_lshl2_add_u32 s14, s3, 155648
    v_lshl_add_u32 v5, v1, 6, s14
    v_and_b32 v6, 3, v1
    v_lshlrev_b32 v6, 5, v6
    v_lshrrev_b32 v9, 5, v1
    v_lshl_add_u32 v6, v9, 7, v6
    v_bfe_u32 v9, v1, 4, 1
    v_lshl_add_u32 v6, v9, 8, v6
    v_bfe_u32 v9, v1, 2, 2
    v_lshl_add_u32 v6, v9, 9, v6
    v_add_u32 v6, 155648, v6
    s_lshl3_add_u32 s96, s2, s3
    s_lshl_b32 s97, s96, 7
    s_add_u32 s14, s97, 262144
    v_and_b32 v8, 15, v1
    v_lshlrev_b32 v8, 3, v8
    s_branch SCHK_2
SPOLL_1:
    s_load_dword s24, s[32:33], s17 offset:508 glc
    s_load_dword s25, s[32:33], s17 offset:4604 glc
SCHK_2:
    s_add_u32 s5, s5, 1
    s_cmp_ge_u32 s5, 200000
    s_waitcnt lgkmcnt(0)
    s_cbranch_scc1 SDONE_3
    s_cmp_lg_u32 s24, s4
    s_cbranch_scc1 SPOLL_1
    s_cmp_lg_u32 s25, s4
    s_cbranch_scc1 SPOLL_1
SDONE_3:
    buffer_load_dwordx4 v[176:179], v4, s[32:35], s17 offen sc1
    s_load_dword s24, s[32:33], s14 offset:60 glc
    s_load_dword s25, s[32:33], s14 offset:124 glc
    s_waitcnt vmcnt(6)
    v_permlane32_swap_b32 v12, v14
    v_permlane32_swap_b32 v13, v15
    v_permlane32_swap_b32 v16, v18
    v_permlane32_swap_b32 v17, v19
    v_lshlrev_b32 v184, 16, v12
    v_and_b32 v185, s6, v12
    v_lshlrev_b32 v186, 16, v13
    v_and_b32 v187, s6, v13
    v_lshlrev_b32 v188, 16, v14
    v_and_b32 v189, s6, v14
    v_lshlrev_b32 v190, 16, v15
    v_and_b32 v191, s6, v15
    v_lshlrev_b32 v192, 16, v16
    v_and_b32 v193, s6, v16
    v_lshlrev_b32 v194, 16, v17
    v_and_b32 v195, s6, v17
    v_lshlrev_b32 v196, 16, v18
    v_and_b32 v197, s6, v18
    v_lshlrev_b32 v198, 16, v19
    v_and_b32 v199, s6, v19
    s_branch SCHK_6
SPOLL_5:
    s_load_dword s24, s[32:33], s14 offset:60 glc
    s_load_dword s25, s[32:33], s14 offset:124 glc
SCHK_6:
    s_add_u32 s5, s5, 1
    s_cmp_ge_u32 s5, 200000
    s_waitcnt lgkmcnt(0)
    s_cbranch_scc1 SDONE_7
    s_cmp_lg_u32 s24, s4
    s_cbranch_scc1 SPOLL_5
    s_cmp_lg_u32 s25, s4
    s_cbranch_scc1 SPOLL_5
SDONE_7:
    buffer_load_dwordx2 v[172:173], v8, s[32:35], s14 offen sc1
    s_lshr_b32 s96, s9, 4
    s_lshl_b32 s97, s96, 1
    s_xor_b32 s94, s97, 1
    s_add_u32 s96, s94, s84
    s_and_b32 s97, s96, 15
    s_mul_i32 s98, s97, 393216
    s_add_u32 s91, s98, s85
    s_lshl_b32 s96, s94, 13
    s_add_u32 s94, s96, s83
    s_add_u32 s82, s91, 2048
    s_mov_b32 m0, s94
    s_nop 0
    buffer_load_dwordx4 v3, s[40:43], s82 offen lds
    s_add_u32 s82, s91, 4096
    s_add_u32 m0, s94, 49152
    s_nop 0
    buffer_load_dwordx4 v3, s[40:43], s82 offen lds
    s_mov_b32 s82, s91
    s_add_u32 m0, s94, 98304
    s_nop 0
    buffer_load_dwordx4 v3, s[40:43], s82 offen lds
    s_waitcnt vmcnt(4)
    v_bitop3_b32 v7, v177, v179, s4 bitop3:0x7e
    v_cmp_ne_u32 vcc, 0, v7
    s_cbranch_vccz TOK_8
POLL_9:
    buffer_load_dwordx4 v[176:179], v4, s[32:35], s17 offen sc1
    s_waitcnt vmcnt(0)
    v_bitop3_b32 v7, v177, v179, s4 bitop3:0x7e
    v_cmp_ne_u32 vcc, 0, v7
    s_cbranch_vccz PDONE_10
    s_add_u32 s5, s5, 1
    s_cmp_lt_u32 s5, 200000
    s_cbranch_scc1 POLL_9
PDONE_10:
TOK_8:
    ds_write2_b32 v5, v176, v178 offset0:0 offset1:8
    s_waitcnt lgkmcnt(0)
    s_barrier
    ds_read_b128 v[208:211], v6 offset:2048
    ds_read_b128 v[212:215], v6 offset:2064
    ds_read_b128 v[200:203], v6
    ds_read_b128 v[204:207], v6 offset:16
    s_lshl_b32 s96, s11, 12
    s_lshl_b32 s97, s3, 9
    s_add_u32 s13, s96, s97
    v_add_u32 v4, s13, v2
    s_lshl_b32 s96, s3, 9
    s_add_u32 m0, s96, 159744
    s_mov_b32 exec_hi, 0
    global_load_lds_dwordx4 v4, s[72:73]
    s_mov_b32 exec_hi, -1
    s_lshl4_add_u32 s96, s21, s12
    s_lshr_b32 s97, s3, 1
    s_lshl2_add_u32 s98, s96, s97
    s_lshl_b32 s99, s98, 12
    s_and_b32 s96, s3, 1
    s_lshl_b32 s97, s96, 8
    s_add_u32 s98, s99, s97
    s_add_u32 s13, s98, 4194304
    v_and_b32 v4, 15, v1
    v_lshlrev_b32 v4, 4, v4
    v_bfe_u32 v9, v1, 4, 1
    v_lshl_add_u32 v4, v9, 10, v4
    v_lshrrev_b32 v9, 5, v1
    v_lshl_add_u32 v4, v9, 9, v4
    s_waitcnt lgkmcnt(2)
    v_pk_add_f32 v[208:209], v[208:209], v[210:211]
    v_pk_add_f32 v[212:213], v[212:213], v[214:215]
    v_pk_add_f32 v[208:209], v[208:209], v[212:213]
    v_add_f32 v208, v208, v209
    v_cvt_pk_bf16_f32 v208, 0, v208
    s_waitcnt lgkmcnt(0)
    v_pk_add_f32 v[200:201], v[200:201], v[202:203]
    v_pk_add_f32 v[204:205], v[204:205], v[206:207]
    v_pk_add_f32 v[200:201], v[200:201], v[204:205]
    v_add_f32 v200, v200, v201
    v_add_f32 v208, 1.0, v208
    v_cvt_pk_bf16_f32 v208, 0, v208
    v_cvt_pk_bf16_f32 v200, 0, v200
    s_waitcnt vmcnt(4)
    v_cmp_ne_u32 vcc, s4, v173
    s_cbranch_vccz L_STOK
POLL_11:
    buffer_load_dwordx2 v[172:173], v8, s[32:35], s14 offen sc1
    s_waitcnt vmcnt(0)
    v_cmp_ne_u32 vcc, s4, v173
    s_cbranch_vccz PDONE_12
    s_add_u32 s5, s5, 1
    s_cmp_lt_u32 s5, 200000
    s_cbranch_scc1 POLL_11
PDONE_12:
L_STOK:
    v_lshlrev_b32 v173, 16, v172
    v_and_b32 v172, s6, v172
    v_rcp_f32 v172, v172
    s_nop 0
    v_pk_add_f32 v[184:185], v[172:173], v[184:185] op_sel:[1,0] neg_lo:[1,0] neg_hi:[1,0]
    v_pk_add_f32 v[186:187], v[172:173], v[186:187] op_sel:[1,0] neg_lo:[1,0] neg_hi:[1,0]
    v_pk_add_f32 v[188:189], v[172:173], v[188:189] op_sel:[1,0] neg_lo:[1,0] neg_hi:[1,0]
    v_pk_add_f32 v[190:191], v[172:173], v[190:191] op_sel:[1,0] neg_lo:[1,0] neg_hi:[1,0]
    v_pk_add_f32 v[192:193], v[172:173], v[192:193] op_sel:[1,0] neg_lo:[1,0] neg_hi:[1,0]
    v_pk_add_f32 v[194:195], v[172:173], v[194:195] op_sel:[1,0] neg_lo:[1,0] neg_hi:[1,0]
    v_pk_add_f32 v[196:197], v[172:173], v[196:197] op_sel:[1,0] neg_lo:[1,0] neg_hi:[1,0]
    v_pk_add_f32 v[198:199], v[172:173], v[198:199] op_sel:[1,0] neg_lo:[1,0] neg_hi:[1,0]
    v_cvt_pk_bf16_f32 v184, 0, v184
    v_cvt_pk_bf16_f32 v185, 0, v185
    v_cvt_pk_bf16_f32 v186, 0, v186
    v_cvt_pk_bf16_f32 v187, 0, v187
    v_cvt_pk_bf16_f32 v188, 0, v188
    v_cvt_pk_bf16_f32 v189, 0, v189
    v_cvt_pk_bf16_f32 v190, 0, v190
    v_cvt_pk_bf16_f32 v191, 0, v191
    v_cvt_pk_bf16_f32 v192, 0, v192
    v_cvt_pk_bf16_f32 v193, 0, v193
    v_cvt_pk_bf16_f32 v194, 0, v194
    v_cvt_pk_bf16_f32 v195, 0, v195
    v_cvt_pk_bf16_f32 v196, 0, v196
    v_cvt_pk_bf16_f32 v197, 0, v197
    v_cvt_pk_bf16_f32 v198, 0, v198
    v_cvt_pk_bf16_f32 v199, 0, v199
    v_pk_mul_f32 v[184:185], v[184:185], v[172:173] op_sel_hi:[1,0]
    v_pk_mul_f32 v[186:187], v[186:187], v[172:173] op_sel_hi:[1,0]
    v_pk_mul_f32 v[188:189], v[188:189], v[172:173] op_sel_hi:[1,0]
    v_pk_mul_f32 v[190:191], v[190:191], v[172:173] op_sel_hi:[1,0]
    v_pk_mul_f32 v[192:193], v[192:193], v[172:173] op_sel_hi:[1,0]
    v_pk_mul_f32 v[194:195], v[194:195], v[172:173] op_sel_hi:[1,0]
    v_pk_mul_f32 v[196:197], v[196:197], v[172:173] op_sel_hi:[1,0]
    v_pk_mul_f32 v[198:199], v[198:199], v[172:173] op_sel_hi:[1,0]
    v_cvt_pk_bf16_f32 v184, 0, v184
    v_cvt_pk_bf16_f32 v185, 0, v185
    v_cvt_pk_bf16_f32 v186, 0, v186
    v_cvt_pk_bf16_f32 v187, 0, v187
    v_cvt_pk_bf16_f32 v188, 0, v188
    v_cvt_pk_bf16_f32 v189, 0, v189
    v_cvt_pk_bf16_f32 v190, 0, v190
    v_cvt_pk_bf16_f32 v191, 0, v191
    v_cvt_pk_bf16_f32 v192, 0, v192
    v_cvt_pk_bf16_f32 v193, 0, v193
    v_cvt_pk_bf16_f32 v194, 0, v194
    v_cvt_pk_bf16_f32 v195, 0, v195
    v_cvt_pk_bf16_f32 v196, 0, v196
    v_cvt_pk_bf16_f32 v197, 0, v197
    v_cvt_pk_bf16_f32 v198, 0, v198
    v_cvt_pk_bf16_f32 v199, 0, v199
    v_mul_f32_dpp v184, v208, v184 row_newbcast:0 row_mask:0xf bank_mask:0xf
    v_mul_f32_dpp v185, v208, v185 row_newbcast:1 row_mask:0xf bank_mask:0xf
    v_mul_f32_dpp v186, v208, v186 row_newbcast:2 row_mask:0xf bank_mask:0xf
    v_mul_f32_dpp v187, v208, v187 row_newbcast:3 row_mask:0xf bank_mask:0xf
    v_mul_f32_dpp v188, v208, v188 row_newbcast:4 row_mask:0xf bank_mask:0xf
    v_mul_f32_dpp v189, v208, v189 row_newbcast:5 row_mask:0xf bank_mask:0xf
    v_mul_f32_dpp v190, v208, v190 row_newbcast:6 row_mask:0xf bank_mask:0xf
    v_mul_f32_dpp v191, v208, v191 row_newbcast:7 row_mask:0xf bank_mask:0xf
    v_cvt_pk_bf16_f32 v184, 0, v184
    v_cvt_pk_bf16_f32 v185, 0, v185
    v_cvt_pk_bf16_f32 v186, 0, v186
    v_cvt_pk_bf16_f32 v187, 0, v187
    v_cvt_pk_bf16_f32 v188, 0, v188
    v_cvt_pk_bf16_f32 v189, 0, v189
    v_cvt_pk_bf16_f32 v190, 0, v190
    v_cvt_pk_bf16_f32 v191, 0, v191
    v_add_f32_dpp v184, v200, v184 row_newbcast:0 row_mask:0xf bank_mask:0xf
    v_add_f32_dpp v185, v200, v185 row_newbcast:1 row_mask:0xf bank_mask:0xf
    v_add_f32_dpp v186, v200, v186 row_newbcast:2 row_mask:0xf bank_mask:0xf
    v_add_f32_dpp v187, v200, v187 row_newbcast:3 row_mask:0xf bank_mask:0xf
    v_add_f32_dpp v188, v200, v188 row_newbcast:4 row_mask:0xf bank_mask:0xf
    v_add_f32_dpp v189, v200, v189 row_newbcast:5 row_mask:0xf bank_mask:0xf
    v_add_f32_dpp v190, v200, v190 row_newbcast:6 row_mask:0xf bank_mask:0xf
    v_add_f32_dpp v191, v200, v191 row_newbcast:7 row_mask:0xf bank_mask:0xf
    v_cvt_pk_bf16_f32 v216, v184, v185
    v_cvt_pk_bf16_f32 v217, v186, v187
    v_cvt_pk_bf16_f32 v218, v188, v189
    v_cvt_pk_bf16_f32 v219, v190, v191
    buffer_store_dwordx4 v[216:219], v4, s[32:35], s13 offen sc1
    v_mul_f32_dpp v192, v208, v192 row_newbcast:8 row_mask:0xf bank_mask:0xf
    v_mul_f32_dpp v193, v208, v193 row_newbcast:9 row_mask:0xf bank_mask:0xf
    v_mul_f32_dpp v194, v208, v194 row_newbcast:10 row_mask:0xf bank_mask:0xf
    v_mul_f32_dpp v195, v208, v195 row_newbcast:11 row_mask:0xf bank_mask:0xf
    v_mul_f32_dpp v196, v208, v196 row_newbcast:12 row_mask:0xf bank_mask:0xf
    v_mul_f32_dpp v197, v208, v197 row_newbcast:13 row_mask:0xf bank_mask:0xf
    v_mul_f32_dpp v198, v208, v198 row_newbcast:14 row_mask:0xf bank_mask:0xf
    v_mul_f32_dpp v199, v208, v199 row_newbcast:15 row_mask:0xf bank_mask:0xf
    v_cvt_pk_bf16_f32 v192, 0, v192
    v_cvt_pk_bf16_f32 v193, 0, v193
    v_cvt_pk_bf16_f32 v194, 0, v194
    v_cvt_pk_bf16_f32 v195, 0, v195
    v_cvt_pk_bf16_f32 v196, 0, v196
    v_cvt_pk_bf16_f32 v197, 0, v197
    v_cvt_pk_bf16_f32 v198, 0, v198
    v_cvt_pk_bf16_f32 v199, 0, v199
    v_add_f32_dpp v192, v200, v192 row_newbcast:8 row_mask:0xf bank_mask:0xf
    v_add_f32_dpp v193, v200, v193 row_newbcast:9 row_mask:0xf bank_mask:0xf
    v_add_f32_dpp v194, v200, v194 row_newbcast:10 row_mask:0xf bank_mask:0xf
    v_add_f32_dpp v195, v200, v195 row_newbcast:11 row_mask:0xf bank_mask:0xf
    v_add_f32_dpp v196, v200, v196 row_newbcast:12 row_mask:0xf bank_mask:0xf
    v_add_f32_dpp v197, v200, v197 row_newbcast:13 row_mask:0xf bank_mask:0xf
    v_add_f32_dpp v198, v200, v198 row_newbcast:14 row_mask:0xf bank_mask:0xf
    v_add_f32_dpp v199, v200, v199 row_newbcast:15 row_mask:0xf bank_mask:0xf
    v_cvt_pk_bf16_f32 v220, v192, v193
    v_cvt_pk_bf16_f32 v221, v194, v195
    v_cvt_pk_bf16_f32 v222, v196, v197
    v_cvt_pk_bf16_f32 v223, v198, v199
    buffer_store_dwordx4 v[220:223], v4, s[32:35], s13 offen offset:2048 sc1
    v_bfe_u32 v20, v1, 2, 2
    v_lshlrev_b32 v20, 7, v20
    v_bfe_u32 v9, v1, 3, 1
    v_lshl_add_u32 v20, v9, 6, v20
    v_bfe_u32 v9, v1, 4, 1
    v_lshl_add_u32 v20, v9, 5, v20
    v_and_b32 v9, 3, v1
    v_lshl_add_u32 v20, v9, 3, v20
    v_lshrrev_b32 v9, 5, v1
    v_lshl_add_u32 v20, v9, 9, v20
    v_xor_b32 v21, 64, v20
    v_add_u32 v22, 49152, v20
    v_add_u32 v23, 49152, v21
    v_add_u32 v24, 98304, v20
    v_add_u32 v25, 98304, v21
    v_and_b32 v5, 3, v1
    v_lshlrev_b32 v5, 15, v5
    v_bfe_u32 v9, v1, 2, 2
    v_lshl_add_u32 v5, v9, 12, v5
    s_and_b32 s96, s12, 1
    s_lshr_b32 s97, s21, 3
    s_and_b32 s98, s21, 7
    s_lshl_b32 s99, s98, 5
    s_lshl2_add_u32 s98, s97, s99
    s_lshl_b32 s97, s98, 12
    s_lshr_b32 s99, s12, 1
    s_lshl_b32 s98, s99, 6
    s_add_u32 s99, s97, s98
    s_lshl2_add_u32 s97, s96, s99
    s_add_u32 s13, s97, 1048576
    s_lshl_b32 s96, s10, 18
    s_lshl_b32 s97, s77, 12
    s_add_u32 s98, s96, s97
    s_add_u32 s88, s98, 4194304
    s_cmp_ge_u32 s9, 28
    s_cselect_b32 s54, 0, s54
    s_cselect_b32 s58, 0, s58
    s_cselect_b32 s62, 0, s62
    s_waitcnt vmcnt(0)
    s_barrier
    s_cmp_lg_u32 s3, 0
    s_cbranch_scc1 L_PB
    v_mov_b32 v6, s4
    s_mov_b32 exec_hi, 0
    s_mov_b32 exec_lo, 65535
    buffer_store_dword v6, v5, s[32:35], s13 offen sc1
    s_mov_b64 exec, -1
L_PB:
    s_lshr_b32 s96, s9, 4
    s_lshl_b32 s97, s96, 1
    s_xor_b32 s94, s97, 2
    s_add_u32 s96, s94, s84
    s_and_b32 s97, s96, 15
    s_mul_i32 s98, s97, 393216
    s_add_u32 s91, s98, s85
    s_lshl_b32 s96, s94, 13
    s_add_u32 s94, s96, s83
    s_add_u32 s82, s91, 2048
    s_mov_b32 m0, s94
    s_nop 0
    buffer_load_dwordx4 v3, s[40:43], s82 offen lds
    s_add_u32 s82, s91, 4096
    s_add_u32 m0, s94, 49152
    s_nop 0
    buffer_load_dwordx4 v3, s[40:43], s82 offen lds
    s_mov_b32 s82, s91
    s_add_u32 m0, s94, 98304
    s_nop 0
    buffer_load_dwordx4 v3, s[40:43], s82 offen lds
    s_lshr_b32 s96, s9, 4
    s_lshl_b32 s97, s96, 1
    s_xor_b32 s94, s97, 3
    s_add_u32 s96, s94, s84
    s_and_b32 s97, s96, 15
    s_mul_i32 s98, s97, 393216
    s_add_u32 s91, s98, s85
    s_lshl_b32 s96, s94, 13
    s_add_u32 s94, s96, s83
    s_add_u32 s82, s91, 2048
    s_mov_b32 m0, s94
    s_nop 0
    buffer_load_dwordx4 v3, s[40:43], s82 offen lds
    s_add_u32 s82, s91, 4096
    s_add_u32 m0, s94, 49152
    s_nop 0
    buffer_load_dwordx4 v3, s[40:43], s82 offen lds
    s_mov_b32 s82, s91
    s_add_u32 m0, s94, 98304
    s_nop 0
    buffer_load_dwordx4 v3, s[40:43], s82 offen lds
    s_lshl_b32 s96, s2, 12
    s_add_u32 s19, s96, 1048576
    s_and_b32 s96, s3, 3
    s_lshl_b32 s97, s96, 7
    s_add_u32 s20, s97, s19
    s_lshl_b32 s96, s84, 5
    s_add_u32 s19, s96, s19
    s_cmp_ge_u32 s3, 4
    s_cselect_b32 s19, s20, s19
    s_load_dwordx2 s[24:25], s[32:33], s19 offset:0 glc
    s_load_dwordx2 s[26:27], s[32:33], s19 offset:64 glc
    s_add_u32 s96, s84, 4
    s_and_b32 s97, s96, 15
    s_mul_i32 s98, s97, 393216
    s_add_u32 s91, s98, s85
    s_add_u32 s94, s83, 32768
    s_add_u32 s82, s91, 2048
    s_mov_b32 m0, s94
    s_nop 0
    buffer_load_dwordx4 v3, s[40:43], s82 offen lds
    s_add_u32 s82, s91, 4096
    s_add_u32 m0, s94, 49152
    s_nop 0
    buffer_load_dwordx4 v3, s[40:43], s82 offen lds
    s_mov_b32 s82, s91
    s_add_u32 m0, s94, 98304
    s_nop 0
    buffer_load_dwordx4 v3, s[40:43], s82 offen lds
    s_lshl_b32 s96, s3, 14
    s_lshl_b32 s97, s12, 7
    s_add_u32 s90, s96, s97
    s_and_b32 s96, s9, 1
    s_lshr_b32 s97, s9, 3
    s_lshl_b32 s98, s97, 1
    s_lshl3_add_u32 s99, s96, s98
    s_lshl_b32 s95, s99, 17
    s_lshl3_add_u32 s96, s75, s3
    s_mul_i32 s97, s96, 229376
    s_lshl_b32 s98, s74, 7
    s_add_u32 s80, s97, s98
    s_lshl3_add_u32 s96, s74, s3
    s_lshl_b32 s97, s96, 14
    s_lshl_b32 s98, s75, 9
    s_add_u32 s81, s97, s98
    s_and_b32 s96, s8, 3
    s_lshl3_add_u32 s97, s96, s3
    s_mul_i32 s98, s97, 393216
    s_lshr_b32 s99, s8, 2
    s_lshl1_add_u32 s96, s9, s99
    s_lshl_b32 s97, s96, 7
    s_add_u32 s99, s98, s97
    s_add_u32 s89, s99, 4096
    s_and_b32 s96, s3, 1
    s_lshl_b32 s14, s96, 6
    v_bfe_u32 v6, v1, 4, 1
    v_lshl_add_u32 v6, v6, 5, s14
    v_and_b32 v26, 7, v1
    v_lshlrev_b32 v26, 4, v26
    v_xor_b32 v26, v26, v6
    v_lshrrev_b32 v6, 3, v1
    v_lshlrev_b32 v6, 11, v6
    v_add_u32 v26, v26, v6
    s_and_b32 s96, s3, 2
    s_lshl_b32 s14, s96, 5
    v_bfe_u32 v6, v1, 4, 1
    v_lshl_add_u32 v6, v6, 5, s14
    v_and_b32 v27, 7, v1
    v_lshlrev_b32 v27, 4, v27
    v_xor_b32 v27, v27, v6
    v_lshrrev_b32 v6, 3, v1
    v_mul_u32_u24 v6, 7168, v6
    v_add_u32 v27, v27, v6
    s_and_b32 s96, s3, 1
    s_lshl_b32 s14, s96, 7
    v_lshrrev_b32 v6, 5, v1
    v_lshl_add_u32 v6, v6, 6, s14
    v_and_b32 v253, 31, v1
    v_lshlrev_b32 v253, 4, v253
    v_lshrrev_b32 v9, 5, v1
    v_lshl_add_u32 v253, v9, 11, v253
    v_xor_b32 v253, v253, v6
    s_lshl_b32 s16, s84, 14
    v_add_u32 v249, s88, v2
    s_lshl_b32 s96, s77, 11
    s_add_u32 s14, s96, 151552
    v_add_u32 v0, s14, v2
    s_mov_b64 exec, 0
    s_cmp_eq_u32 s3, 4
    s_cbranch_scc1 L_PAD2
    s_cmp_eq_u32 s3, 5
    s_cbranch_scc1 L_PAD3
    s_cmp_eq_u32 s3, 6
    s_cbranch_scc1 L_PAD4
    s_cmp_eq_u32 s3, 7
    s_cbranch_scc1 L_PAD5
    s_branch L_TEND
L_RET2:
    s_branch L_PAD6
L_RET6:
    s_branch L_PAD10
L_RET10:
    s_branch L_TEND
L_RET3:
    s_branch L_PAD7
L_RET7:
    s_branch L_TEND
L_RET4:
    s_branch L_PAD8
L_RET8:
    s_branch L_TEND
L_RET5:
    s_branch L_PAD9
L_RET9:
    s_branch L_TEND
    s_nop 0
    s_nop 0
    s_nop 0
    s_nop 0
    s_nop 0
    s_nop 0
    s_nop 0
    s_nop 0
    s_nop 0
    s_nop 0
    s_nop 0
    s_nop 0
    s_nop 0
    s_nop 0
    s_nop 0
    s_nop 0
    s_nop 0
    s_nop 0
    s_nop 0
    s_nop 0
    s_nop 0
    s_nop 0
    s_nop 0
    s_nop 0
    s_nop 0
    s_nop 0
    s_nop 0
    s_nop 0
L_TEND:
    s_mov_b64 exec, -1
    s_branch SCHK_14
SPOLL_13:
    s_load_dwordx2 s[24:25], s[32:33], s19 offset:0 glc
    s_load_dwordx2 s[26:27], s[32:33], s19 offset:64 glc
SCHK_14:
    s_add_u32 s5, s5, 1
    s_cmp_ge_u32 s5, 200000
    s_waitcnt lgkmcnt(0)
    s_cbranch_scc1 SDONE_15
    s_cmp_lg_u32 s24, s4
    s_cbranch_scc1 SPOLL_13
    s_cmp_lg_u32 s25, s4
    s_cbranch_scc1 SPOLL_13
    s_cmp_lg_u32 s26, s4
    s_cbranch_scc1 SPOLL_13
    s_cmp_lg_u32 s27, s4
    s_cbranch_scc1 SPOLL_13
SDONE_15:
    s_cmp_ge_u32 s3, 4
    s_cbranch_scc1 L_HELP
    s_setprio 2
    buffer_load_dwordx4 v[152:155], v249, s[32:35], s16 offen sc1
    buffer_load_dwordx4 v[156:159], v249, s[32:35], s16 offen offset:1024 sc1
    buffer_load_dwordx4 v[160:163], v249, s[32:35], s16 offen offset:2048 sc1
    buffer_load_dwordx4 v[164:167], v249, s[32:35], s16 offen offset:3072 sc1
    s_add_u32 s16, s16, 16384
    s_and_b32 s16, s16, 0x3ffff
    buffer_load_dwordx4 v[168:171], v249, s[32:35], s16 offen sc1
    buffer_load_dwordx4 v[172:175], v249, s[32:35], s16 offen offset:1024 sc1
    s_waitcnt vmcnt(9)
    s_barrier
    ds_read_b64_tr_b16 v[28:29], v20
    ds_read_b64_tr_b16 v[30:31], v20 offset:2048
    ds_read_b64_tr_b16 v[32:33], v21
    ds_read_b64_tr_b16 v[34:35], v21 offset:2048
    ds_read_b64_tr_b16 v[36:37], v24
    ds_read_b64_tr_b16 v[38:39], v24 offset:2048
    ds_read_b64_tr_b16 v[40:41], v25
    ds_read_b64_tr_b16 v[42:43], v25 offset:2048
    ds_read_b64_tr_b16 v[44:45], v22
    ds_read_b64_tr_b16 v[46:47], v22 offset:2048
    ds_read_b64_tr_b16 v[48:49], v23
    ds_read_b64_tr_b16 v[50:51], v23 offset:2048
    s_waitcnt vmcnt(5)
    s_waitcnt lgkmcnt(10)
    v_mfma_f32_32x32x16_bf16 v[56:71], v[28:31], v[152:155], 0
    ds_read_b64_tr_b16 v[52:53], v20 offset:1024
    ds_read_b64_tr_b16 v[54:55], v20 offset:3072
    s_waitcnt lgkmcnt(10)
    v_mfma_f32_32x32x16_bf16 v[72:87], v[32:35], v[152:155], 0
    ds_read_b64_tr_b16 v[28:29], v21 offset:1024
    ds_read_b64_tr_b16 v[30:31], v21 offset:3072
    s_waitcnt lgkmcnt(10)
    v_mfma_f32_32x32x16_bf16 v[120:135], v[36:39], v[152:155], 0
    ds_read_b64_tr_b16 v[32:33], v24 offset:1024
    ds_read_b64_tr_b16 v[34:35], v24 offset:3072
    s_waitcnt lgkmcnt(10)
    v_mfma_f32_32x32x16_bf16 v[136:151], v[40:43], v[152:155], 0
    ds_read_b64_tr_b16 v[36:37], v25 offset:1024
    ds_read_b64_tr_b16 v[38:39], v25 offset:3072
    s_waitcnt lgkmcnt(10)
    v_mfma_f32_32x32x16_bf16 v[88:103], v[44:47], v[152:155], 0
    buffer_load_dwordx4 v[176:179], v249, s[32:35], s16 offen offset:2048 sc1
    ds_read_b64_tr_b16 v[40:41], v22 offset:1024
    ds_read_b64_tr_b16 v[42:43], v22 offset:3072
    s_waitcnt lgkmcnt(10)
    v_mfma_f32_32x32x16_bf16 v[104:119], v[48:51], v[152:155], 0
    ds_read_b64_tr_b16 v[44:45], v23 offset:1024
    ds_read_b64_tr_b16 v[46:47], v23 offset:3072
    s_waitcnt vmcnt(5)
    s_waitcnt lgkmcnt(10)
    v_mfma_f32_32x32x16_bf16 v[56:71], v[52:55], v[156:159], v[56:71]
    ds_read_b64_tr_b16 v[48:49], v20 offset:4096
    ds_read_b64_tr_b16 v[50:51], v20 offset:6144
    s_waitcnt lgkmcnt(10)
    v_mfma_f32_32x32x16_bf16 v[72:87], v[28:31], v[156:159], v[72:87]
    ds_read_b64_tr_b16 v[52:53], v21 offset:4096
    ds_read_b64_tr_b16 v[54:55], v21 offset:6144
    s_waitcnt lgkmcnt(10)
    v_mfma_f32_32x32x16_bf16 v[120:135], v[32:35], v[156:159], v[120:135]
    ds_read_b64_tr_b16 v[28:29], v24 offset:4096
    ds_read_b64_tr_b16 v[30:31], v24 offset:6144
    s_waitcnt lgkmcnt(10)
    v_mfma_f32_32x32x16_bf16 v[136:151], v[36:39], v[156:159], v[136:151]
    buffer_load_dwordx4 v[180:183], v249, s[32:35], s16 offen offset:3072 sc1
    ds_read_b64_tr_b16 v[32:33], v25 offset:4096
    ds_read_b64_tr_b16 v[34:35], v25 offset:6144
    s_waitcnt lgkmcnt(10)
    v_mfma_f32_32x32x16_bf16 v[88:103], v[40:43], v[156:159], v[88:103]
    s_add_u32 s16, s16, 16384
    ds_read_b64_tr_b16 v[36:37], v22 offset:4096
    ds_read_b64_tr_b16 v[38:39], v22 offset:6144
    s_waitcnt lgkmcnt(10)
    v_mfma_f32_32x32x16_bf16 v[104:119], v[44:47], v[156:159], v[104:119]
    s_and_b32 s16, s16, 0x3ffff
    ds_read_b64_tr_b16 v[40:41], v23 offset:4096
    ds_read_b64_tr_b16 v[42:43], v23 offset:6144
    s_waitcnt vmcnt(5)
    s_waitcnt lgkmcnt(10)
    v_mfma_f32_32x32x16_bf16 v[56:71], v[48:51], v[160:163], v[56:71]
    ds_read_b64_tr_b16 v[44:45], v20 offset:5120
    ds_read_b64_tr_b16 v[46:47], v20 offset:7168
    s_waitcnt lgkmcnt(10)
    v_mfma_f32_32x32x16_bf16 v[72:87], v[52:55], v[160:163], v[72:87]
    ds_read_b64_tr_b16 v[48:49], v21 offset:5120
    ds_read_b64_tr_b16 v[50:51], v21 offset:7168
    s_waitcnt lgkmcnt(10)
    v_mfma_f32_32x32x16_bf16 v[120:135], v[28:31], v[160:163], v[120:135]
    buffer_load_dwordx4 v[184:187], v249, s[32:35], s16 offen sc1
    ds_read_b64_tr_b16 v[52:53], v24 offset:5120
    ds_read_b64_tr_b16 v[54:55], v24 offset:7168
    s_waitcnt lgkmcnt(10)
    v_mfma_f32_32x32x16_bf16 v[136:151], v[32:35], v[160:163], v[136:151]
    ds_read_b64_tr_b16 v[28:29], v25 offset:5120
    ds_read_b64_tr_b16 v[30:31], v25 offset:7168
    s_waitcnt lgkmcnt(10)
    v_mfma_f32_32x32x16_bf16 v[88:103], v[36:39], v[160:163], v[88:103]
    ds_read_b64_tr_b16 v[32:33], v22 offset:5120
    ds_read_b64_tr_b16 v[34:35], v22 offset:7168
    s_waitcnt lgkmcnt(10)
    v_mfma_f32_32x32x16_bf16 v[104:119], v[40:43], v[160:163], v[104:119]
    ds_read_b64_tr_b16 v[36:37], v23 offset:5120
    ds_read_b64_tr_b16 v[38:39], v23 offset:7168
    s_waitcnt vmcnt(5)
    s_waitcnt lgkmcnt(10)
    v_mfma_f32_32x32x16_bf16 v[56:71], v[44:47], v[164:167], v[56:71]
    ds_read_b64_tr_b16 v[40:41], v20 offset:8192
    ds_read_b64_tr_b16 v[42:43], v20 offset:10240
    s_waitcnt lgkmcnt(10)
    v_mfma_f32_32x32x16_bf16 v[72:87], v[48:51], v[164:167], v[72:87]
    buffer_load_dwordx4 v[188:191], v249, s[32:35], s16 offen offset:1024 sc1
    ds_read_b64_tr_b16 v[44:45], v21 offset:8192
    ds_read_b64_tr_b16 v[46:47], v21 offset:10240
    s_waitcnt lgkmcnt(10)
    v_mfma_f32_32x32x16_bf16 v[120:135], v[52:55], v[164:167], v[120:135]
    ds_read_b64_tr_b16 v[48:49], v24 offset:8192
    ds_read_b64_tr_b16 v[50:51], v24 offset:10240
    s_waitcnt lgkmcnt(10)
    v_mfma_f32_32x32x16_bf16 v[136:151], v[28:31], v[164:167], v[136:151]
    ds_read_b64_tr_b16 v[52:53], v25 offset:8192
    ds_read_b64_tr_b16 v[54:55], v25 offset:10240
    s_waitcnt lgkmcnt(10)
    v_mfma_f32_32x32x16_bf16 v[88:103], v[32:35], v[164:167], v[88:103]
    ds_read_b64_tr_b16 v[28:29], v22 offset:8192
    ds_read_b64_tr_b16 v[30:31], v22 offset:10240
    s_waitcnt lgkmcnt(10)
    v_mfma_f32_32x32x16_bf16 v[104:119], v[36:39], v[164:167], v[104:119]
    buffer_load_dwordx4 v[192:195], v249, s[32:35], s16 offen offset:2048 sc1
    ds_read_b64_tr_b16 v[32:33], v23 offset:8192
    ds_read_b64_tr_b16 v[34:35], v23 offset:10240
    s_barrier
    s_waitcnt vmcnt(6)
    s_waitcnt lgkmcnt(10)
    v_mfma_f32_32x32x16_bf16 v[56:71], v[40:43], v[168:171], v[56:71]
    ds_read_b64_tr_b16 v[36:37], v20 offset:9216
    ds_read_b64_tr_b16 v[38:39], v20 offset:11264
    s_waitcnt lgkmcnt(10)
    v_mfma_f32_32x32x16_bf16 v[72:87], v[44:47], v[168:171], v[72:87]
    ds_read_b64_tr_b16 v[40:41], v21 offset:9216
    ds_read_b64_tr_b16 v[42:43], v21 offset:11264
    s_waitcnt lgkmcnt(10)
    v_mfma_f32_32x32x16_bf16 v[120:135], v[48:51], v[168:171], v[120:135]
    ds_read_b64_tr_b16 v[44:45], v24 offset:9216
    ds_read_b64_tr_b16 v[46:47], v24 offset:11264
    s_waitcnt lgkmcnt(10)
    v_mfma_f32_32x32x16_bf16 v[136:151], v[52:55], v[168:171], v[136:151]
    ds_read_b64_tr_b16 v[48:49], v25 offset:9216
    ds_read_b64_tr_b16 v[50:51], v25 offset:11264
    s_waitcnt lgkmcnt(10)
    v_mfma_f32_32x32x16_bf16 v[88:103], v[28:31], v[168:171], v[88:103]
    buffer_load_dwordx4 v[196:199], v249, s[32:35], s16 offen offset:3072 sc1
    ds_read_b64_tr_b16 v[52:53], v22 offset:9216
    ds_read_b64_tr_b16 v[54:55], v22 offset:11264
    s_waitcnt lgkmcnt(10)
    v_mfma_f32_32x32x16_bf16 v[104:119], v[32:35], v[168:171], v[104:119]
    s_add_u32 s16, s16, 16384
    ds_read_b64_tr_b16 v[28:29], v23 offset:9216
    ds_read_b64_tr_b16 v[30:31], v23 offset:11264
    s_waitcnt vmcnt(6)
    s_waitcnt lgkmcnt(10)
    v_mfma_f32_32x32x16_bf16 v[56:71], v[36:39], v[172:175], v[56:71]
    s_and_b32 s16, s16, 0x3ffff
    ds_read_b64_tr_b16 v[32:33], v20 offset:12288
    ds_read_b64_tr_b16 v[34:35], v20 offset:14336
    s_waitcnt lgkmcnt(10)
    v_mfma_f32_32x32x16_bf16 v[72:87], v[40:43], v[172:175], v[72:87]
    ds_read_b64_tr_b16 v[36:37], v21 offset:12288
    ds_read_b64_tr_b16 v[38:39], v21 offset:14336
    s_waitcnt lgkmcnt(10)
    v_mfma_f32_32x32x16_bf16 v[120:135], v[44:47], v[172:175], v[120:135]
    ds_read_b64_tr_b16 v[40:41], v24 offset:12288
    ds_read_b64_tr_b16 v[42:43], v24 offset:14336
    s_waitcnt lgkmcnt(10)
    v_mfma_f32_32x32x16_bf16 v[136:151], v[48:51], v[172:175], v[136:151]
    buffer_load_dwordx4 v[200:203], v249, s[32:35], s16 offen sc1
    ds_read_b64_tr_b16 v[44:45], v25 offset:12288
    ds_read_b64_tr_b16 v[46:47], v25 offset:14336
    s_waitcnt lgkmcnt(10)
    v_mfma_f32_32x32x16_bf16 v[88:103], v[52:55], v[172:175], v[88:103]
    ds_read_b64_tr_b16 v[48:49], v22 offset:12288
    ds_read_b64_tr_b16 v[50:51], v22 offset:14336
    s_waitcnt lgkmcnt(10)
    v_mfma_f32_32x32x16_bf16 v[104:119], v[28:31], v[172:175], v[104:119]
    ds_read_b64_tr_b16 v[52:53], v23 offset:12288
    ds_read_b64_tr_b16 v[54:55], v23 offset:14336
    s_waitcnt vmcnt(6)
    s_waitcnt lgkmcnt(10)
    v_mfma_f32_32x32x16_bf16 v[56:71], v[32:35], v[176:179], v[56:71]
    ds_read_b64_tr_b16 v[28:29], v20 offset:13312
    ds_read_b64_tr_b16 v[30:31], v20 offset:15360
    s_waitcnt lgkmcnt(10)
    v_mfma_f32_32x32x16_bf16 v[72:87], v[36:39], v[176:179], v[72:87]
    ds_read_b64_tr_b16 v[32:33], v21 offset:13312
    ds_read_b64_tr_b16 v[34:35], v21 offset:15360
    s_waitcnt lgkmcnt(10)
    v_mfma_f32_32x32x16_bf16 v[120:135], v[40:43], v[176:179], v[120:135]
    buffer_load_dwordx4 v[204:207], v249, s[32:35], s16 offen offset:1024 sc1
    ds_read_b64_tr_b16 v[36:37], v24 offset:13312
    ds_read_b64_tr_b16 v[38:39], v24 offset:15360
    s_waitcnt lgkmcnt(10)
    v_mfma_f32_32x32x16_bf16 v[136:151], v[44:47], v[176:179], v[136:151]
    ds_read_b64_tr_b16 v[40:41], v25 offset:13312
    ds_read_b64_tr_b16 v[42:43], v25 offset:15360
    s_waitcnt lgkmcnt(10)
    v_mfma_f32_32x32x16_bf16 v[88:103], v[48:51], v[176:179], v[88:103]
    ds_read_b64_tr_b16 v[44:45], v22 offset:13312
    ds_read_b64_tr_b16 v[46:47], v22 offset:15360
    s_waitcnt lgkmcnt(10)
    v_mfma_f32_32x32x16_bf16 v[104:119], v[52:55], v[176:179], v[104:119]
    ds_read_b64_tr_b16 v[48:49], v23 offset:13312
    ds_read_b64_tr_b16 v[50:51], v23 offset:15360
    s_waitcnt vmcnt(6)
    s_waitcnt lgkmcnt(10)
    v_mfma_f32_32x32x16_bf16 v[56:71], v[28:31], v[180:183], v[56:71]
    ds_read_b64_tr_b16 v[52:53], v20 offset:16384
    ds_read_b64_tr_b16 v[54:55], v20 offset:18432
    s_waitcnt lgkmcnt(10)
    v_mfma_f32_32x32x16_bf16 v[72:87], v[32:35], v[180:183], v[72:87]
    buffer_load_dwordx4 v[208:211], v249, s[32:35], s16 offen offset:2048 sc1
    ds_read_b64_tr_b16 v[28:29], v21 offset:16384
    ds_read_b64_tr_b16 v[30:31], v21 offset:18432
    s_waitcnt lgkmcnt(10)
    v_mfma_f32_32x32x16_bf16 v[120:135], v[36:39], v[180:183], v[120:135]
    ds_read_b64_tr_b16 v[32:33], v24 offset:16384
    ds_read_b64_tr_b16 v[34:35], v24 offset:18432
    s_waitcnt lgkmcnt(10)
    v_mfma_f32_32x32x16_bf16 v[136:151], v[40:43], v[180:183], v[136:151]
    ds_read_b64_tr_b16 v[36:37], v25 offset:16384
    ds_read_b64_tr_b16 v[38:39], v25 offset:18432
    s_waitcnt lgkmcnt(10)
    v_mfma_f32_32x32x16_bf16 v[88:103], v[44:47], v[180:183], v[88:103]
    ds_read_b64_tr_b16 v[40:41], v22 offset:16384
    ds_read_b64_tr_b16 v[42:43], v22 offset:18432
    s_waitcnt lgkmcnt(10)
    v_mfma_f32_32x32x16_bf16 v[104:119], v[48:51], v[180:183], v[104:119]
    buffer_load_dwordx4 v[212:215], v249, s[32:35], s16 offen offset:3072 sc1
    ds_read_b64_tr_b16 v[44:45], v23 offset:16384
    ds_read_b64_tr_b16 v[46:47], v23 offset:18432
    s_barrier
    s_waitcnt vmcnt(7)
    s_waitcnt lgkmcnt(10)
    v_mfma_f32_32x32x16_bf16 v[56:71], v[52:55], v[184:187], v[56:71]
    s_add_u32 s16, s16, 16384
    ds_read_b64_tr_b16 v[48:49], v20 offset:17408
    ds_read_b64_tr_b16 v[50:51], v20 offset:19456
    s_waitcnt lgkmcnt(10)
    v_mfma_f32_32x32x16_bf16 v[72:87], v[28:31], v[184:187], v[72:87]
    s_and_b32 s16, s16, 0x3ffff
    ds_read_b64_tr_b16 v[52:53], v21 offset:17408
    ds_read_b64_tr_b16 v[54:55], v21 offset:19456
    s_waitcnt lgkmcnt(10)
    v_mfma_f32_32x32x16_bf16 v[120:135], v[32:35], v[184:187], v[120:135]
    ds_read_b64_tr_b16 v[28:29], v24 offset:17408
    ds_read_b64_tr_b16 v[30:31], v24 offset:19456
    s_waitcnt lgkmcnt(10)
    v_mfma_f32_32x32x16_bf16 v[136:151], v[36:39], v[184:187], v[136:151]
    ds_read_b64_tr_b16 v[32:33], v25 offset:17408
    ds_read_b64_tr_b16 v[34:35], v25 offset:19456
    s_waitcnt lgkmcnt(10)
    v_mfma_f32_32x32x16_bf16 v[88:103], v[40:43], v[184:187], v[88:103]
    buffer_load_dwordx4 v[216:219], v249, s[32:35], s16 offen sc1
    ds_read_b64_tr_b16 v[36:37], v22 offset:17408
    ds_read_b64_tr_b16 v[38:39], v22 offset:19456
    s_waitcnt lgkmcnt(10)
    v_mfma_f32_32x32x16_bf16 v[104:119], v[44:47], v[184:187], v[104:119]
    ds_read_b64_tr_b16 v[40:41], v23 offset:17408
    ds_read_b64_tr_b16 v[42:43], v23 offset:19456
    s_waitcnt vmcnt(7)
    s_waitcnt lgkmcnt(10)
    v_mfma_f32_32x32x16_bf16 v[56:71], v[48:51], v[188:191], v[56:71]
    ds_read_b64_tr_b16 v[44:45], v20 offset:20480
    ds_read_b64_tr_b16 v[46:47], v20 offset:22528
    s_waitcnt lgkmcnt(10)
    v_mfma_f32_32x32x16_bf16 v[72:87], v[52:55], v[188:191], v[72:87]
    ds_read_b64_tr_b16 v[48:49], v21 offset:20480
    ds_read_b64_tr_b16 v[50:51], v21 offset:22528
    s_waitcnt lgkmcnt(10)
    v_mfma_f32_32x32x16_bf16 v[120:135], v[28:31], v[188:191], v[120:135]
    ds_read_b64_tr_b16 v[52:53], v24 offset:20480
    ds_read_b64_tr_b16 v[54:55], v24 offset:22528
    s_waitcnt lgkmcnt(10)
    v_mfma_f32_32x32x16_bf16 v[136:151], v[32:35], v[188:191], v[136:151]
    buffer_load_dwordx4 v[220:223], v249, s[32:35], s16 offen offset:1024 sc1
    ds_read_b64_tr_b16 v[28:29], v25 offset:20480
    ds_read_b64_tr_b16 v[30:31], v25 offset:22528
    s_waitcnt lgkmcnt(10)
    v_mfma_f32_32x32x16_bf16 v[88:103], v[36:39], v[188:191], v[88:103]
    ds_read_b64_tr_b16 v[32:33], v22 offset:20480
    ds_read_b64_tr_b16 v[34:35], v22 offset:22528
    s_waitcnt lgkmcnt(10)
    v_mfma_f32_32x32x16_bf16 v[104:119], v[40:43], v[188:191], v[104:119]
    ds_read_b64_tr_b16 v[36:37], v23 offset:20480
    ds_read_b64_tr_b16 v[38:39], v23 offset:22528
    s_waitcnt vmcnt(7)
    s_waitcnt lgkmcnt(10)
    v_mfma_f32_32x32x16_bf16 v[56:71], v[44:47], v[192:195], v[56:71]
    ds_read_b64_tr_b16 v[40:41], v20 offset:21504
    ds_read_b64_tr_b16 v[42:43], v20 offset:23552
    s_waitcnt lgkmcnt(10)
    v_mfma_f32_32x32x16_bf16 v[72:87], v[48:51], v[192:195], v[72:87]
    ds_read_b64_tr_b16 v[44:45], v21 offset:21504
    ds_read_b64_tr_b16 v[46:47], v21 offset:23552
    s_waitcnt lgkmcnt(10)
    v_mfma_f32_32x32x16_bf16 v[120:135], v[52:55], v[192:195], v[120:135]
    buffer_load_dwordx4 v[224:227], v249, s[32:35], s16 offen offset:2048 sc1
    ds_read_b64_tr_b16 v[48:49], v24 offset:21504
    ds_read_b64_tr_b16 v[50:51], v24 offset:23552
    s_waitcnt lgkmcnt(10)
    v_mfma_f32_32x32x16_bf16 v[136:151], v[28:31], v[192:195], v[136:151]
    ds_read_b64_tr_b16 v[52:53], v25 offset:21504
    ds_read_b64_tr_b16 v[54:55], v25 offset:23552
    s_waitcnt lgkmcnt(10)
    v_mfma_f32_32x32x16_bf16 v[88:103], v[32:35], v[192:195], v[88:103]
    ds_read_b64_tr_b16 v[28:29], v22 offset:21504
    ds_read_b64_tr_b16 v[30:31], v22 offset:23552
    s_waitcnt lgkmcnt(10)
    v_mfma_f32_32x32x16_bf16 v[104:119], v[36:39], v[192:195], v[104:119]
    ds_read_b64_tr_b16 v[32:33], v23 offset:21504
    ds_read_b64_tr_b16 v[34:35], v23 offset:23552
    s_waitcnt vmcnt(7)
    s_waitcnt lgkmcnt(10)
    v_mfma_f32_32x32x16_bf16 v[56:71], v[40:43], v[196:199], v[56:71]
    ds_read_b64_tr_b16 v[36:37], v20 offset:24576
    ds_read_b64_tr_b16 v[38:39], v20 offset:26624
    s_waitcnt lgkmcnt(10)
    v_mfma_f32_32x32x16_bf16 v[72:87], v[44:47], v[196:199], v[72:87]
    buffer_load_dwordx4 v[228:231], v249, s[32:35], s16 offen offset:3072 sc1
    ds_read_b64_tr_b16 v[40:41], v21 offset:24576
    ds_read_b64_tr_b16 v[42:43], v21 offset:26624
    s_waitcnt lgkmcnt(10)
    v_mfma_f32_32x32x16_bf16 v[120:135], v[48:51], v[196:199], v[120:135]
    s_add_u32 s16, s16, 16384
    ds_read_b64_tr_b16 v[44:45], v24 offset:24576
    ds_read_b64_tr_b16 v[46:47], v24 offset:26624
    s_waitcnt lgkmcnt(10)
    v_mfma_f32_32x32x16_bf16 v[136:151], v[52:55], v[196:199], v[136:151]
    s_and_b32 s16, s16, 0x3ffff
    ds_read_b64_tr_b16 v[48:49], v25 offset:24576
    ds_read_b64_tr_b16 v[50:51], v25 offset:26624
    s_waitcnt lgkmcnt(10)
    v_mfma_f32_32x32x16_bf16 v[88:103], v[28:31], v[196:199], v[88:103]
    ds_read_b64_tr_b16 v[52:53], v22 offset:24576
    ds_read_b64_tr_b16 v[54:55], v22 offset:26624
    s_waitcnt lgkmcnt(10)
    v_mfma_f32_32x32x16_bf16 v[104:119], v[32:35], v[196:199], v[104:119]
    buffer_load_dwordx4 v[232:235], v249, s[32:35], s16 offen sc1
    ds_read_b64_tr_b16 v[28:29], v23 offset:24576
    ds_read_b64_tr_b16 v[30:31], v23 offset:26624
    s_barrier
    s_waitcnt vmcnt(8)
    s_waitcnt lgkmcnt(10)
    v_mfma_f32_32x32x16_bf16 v[56:71], v[36:39], v[200:203], v[56:71]
    ds_read_b64_tr_b16 v[32:33], v20 offset:25600
    ds_read_b64_tr_b16 v[34:35], v20 offset:27648
    s_waitcnt lgkmcnt(10)
    v_mfma_f32_32x32x16_bf16 v[72:87], v[40:43], v[200:203], v[72:87]
    ds_read_b64_tr_b16 v[36:37], v21 offset:25600
    ds_read_b64_tr_b16 v[38:39], v21 offset:27648
    s_waitcnt lgkmcnt(10)
    v_mfma_f32_32x32x16_bf16 v[120:135], v[44:47], v[200:203], v[120:135]
    ds_read_b64_tr_b16 v[40:41], v24 offset:25600
    ds_read_b64_tr_b16 v[42:43], v24 offset:27648
    s_waitcnt lgkmcnt(10)
    v_mfma_f32_32x32x16_bf16 v[136:151], v[48:51], v[200:203], v[136:151]
    ds_read_b64_tr_b16 v[44:45], v25 offset:25600
    ds_read_b64_tr_b16 v[46:47], v25 offset:27648
    s_waitcnt lgkmcnt(10)
    v_mfma_f32_32x32x16_bf16 v[88:103], v[52:55], v[200:203], v[88:103]
    buffer_load_dwordx4 v[236:239], v249, s[32:35], s16 offen offset:1024 sc1
    ds_read_b64_tr_b16 v[48:49], v22 offset:25600
    ds_read_b64_tr_b16 v[50:51], v22 offset:27648
    s_waitcnt lgkmcnt(10)
    v_mfma_f32_32x32x16_bf16 v[104:119], v[28:31], v[200:203], v[104:119]
    ds_read_b64_tr_b16 v[52:53], v23 offset:25600
    ds_read_b64_tr_b16 v[54:55], v23 offset:27648
    s_waitcnt vmcnt(8)
    s_waitcnt lgkmcnt(10)
    v_mfma_f32_32x32x16_bf16 v[56:71], v[32:35], v[204:207], v[56:71]
    ds_read_b64_tr_b16 v[28:29], v20 offset:28672
    ds_read_b64_tr_b16 v[30:31], v20 offset:30720
    s_waitcnt lgkmcnt(10)
    v_mfma_f32_32x32x16_bf16 v[72:87], v[36:39], v[204:207], v[72:87]
L_PAD2:
    s_cbranch_execz L_RET2
    ds_read_b64_tr_b16 v[32:33], v21 offset:28672
    ds_read_b64_tr_b16 v[34:35], v21 offset:30720
    s_waitcnt lgkmcnt(10)
    v_mfma_f32_32x32x16_bf16 v[120:135], v[40:43], v[204:207], v[120:135]
    ds_read_b64_tr_b16 v[36:37], v24 offset:28672
    ds_read_b64_tr_b16 v[38:39], v24 offset:30720
    s_waitcnt lgkmcnt(10)
    v_mfma_f32_32x32x16_bf16 v[136:151], v[44:47], v[204:207], v[136:151]
    buffer_load_dwordx4 v[240:243], v249, s[32:35], s16 offen offset:2048 sc1
    ds_read_b64_tr_b16 v[40:41], v25 offset:28672
    ds_read_b64_tr_b16 v[42:43], v25 offset:30720
    s_waitcnt lgkmcnt(10)
    v_mfma_f32_32x32x16_bf16 v[88:103], v[48:51], v[204:207], v[88:103]
    ds_read_b64_tr_b16 v[44:45], v22 offset:28672
    ds_read_b64_tr_b16 v[46:47], v22 offset:30720
    s_waitcnt lgkmcnt(10)
    v_mfma_f32_32x32x16_bf16 v[104:119], v[52:55], v[204:207], v[104:119]
    ds_read_b64_tr_b16 v[48:49], v23 offset:28672
    ds_read_b64_tr_b16 v[50:51], v23 offset:30720
    s_waitcnt vmcnt(8)
    s_waitcnt lgkmcnt(10)
    v_mfma_f32_32x32x16_bf16 v[56:71], v[28:31], v[208:211], v[56:71]
    ds_read_b64_tr_b16 v[52:53], v20 offset:29696
    ds_read_b64_tr_b16 v[54:55], v20 offset:31744
    s_waitcnt lgkmcnt(10)
    v_mfma_f32_32x32x16_bf16 v[72:87], v[32:35], v[208:211], v[72:87]
    ds_read_b64_tr_b16 v[28:29], v21 offset:29696
    ds_read_b64_tr_b16 v[30:31], v21 offset:31744
    s_waitcnt lgkmcnt(10)
    v_mfma_f32_32x32x16_bf16 v[120:135], v[36:39], v[208:211], v[120:135]
    buffer_load_dwordx4 v[244:247], v249, s[32:35], s16 offen offset:3072 sc1
    ds_read_b64_tr_b16 v[32:33], v24 offset:29696
    ds_read_b64_tr_b16 v[34:35], v24 offset:31744
    s_waitcnt lgkmcnt(10)
    v_mfma_f32_32x32x16_bf16 v[136:151], v[40:43], v[208:211], v[136:151]
    s_add_u32 s16, s16, 16384
    ds_read_b64_tr_b16 v[36:37], v25 offset:29696
    ds_read_b64_tr_b16 v[38:39], v25 offset:31744
    s_waitcnt lgkmcnt(10)
    v_mfma_f32_32x32x16_bf16 v[88:103], v[44:47], v[208:211], v[88:103]
    s_and_b32 s16, s16, 0x3ffff
    ds_read_b64_tr_b16 v[40:41], v22 offset:29696
    ds_read_b64_tr_b16 v[42:43], v22 offset:31744
    s_waitcnt lgkmcnt(10)
    v_mfma_f32_32x32x16_bf16 v[104:119], v[48:51], v[208:211], v[104:119]
    ds_read_b64_tr_b16 v[44:45], v23 offset:29696
    ds_read_b64_tr_b16 v[46:47], v23 offset:31744
    s_waitcnt vmcnt(8)
    s_waitcnt lgkmcnt(10)
    v_mfma_f32_32x32x16_bf16 v[56:71], v[52:55], v[212:215], v[56:71]
    ds_read_b64_tr_b16 v[48:49], v20 offset:32768
    ds_read_b64_tr_b16 v[50:51], v20 offset:34816
    s_waitcnt lgkmcnt(10)
    v_mfma_f32_32x32x16_bf16 v[72:87], v[28:31], v[212:215], v[72:87]
    buffer_load_dwordx4 v[152:155], v249, s[32:35], s16 offen sc1
    ds_read_b64_tr_b16 v[52:53], v21 offset:32768
    ds_read_b64_tr_b16 v[54:55], v21 offset:34816
    s_waitcnt lgkmcnt(10)
    v_mfma_f32_32x32x16_bf16 v[120:135], v[32:35], v[212:215], v[120:135]
    ds_read_b64_tr_b16 v[28:29], v24 offset:32768
    ds_read_b64_tr_b16 v[30:31], v24 offset:34816
    s_waitcnt lgkmcnt(10)
    v_mfma_f32_32x32x16_bf16 v[136:151], v[36:39], v[212:215], v[136:151]
    ds_read_b64_tr_b16 v[32:33], v25 offset:32768
    ds_read_b64_tr_b16 v[34:35], v25 offset:34816
    s_waitcnt lgkmcnt(10)
    v_mfma_f32_32x32x16_bf16 v[88:103], v[40:43], v[212:215], v[88:103]
    ds_read_b64_tr_b16 v[36:37], v22 offset:32768
    ds_read_b64_tr_b16 v[38:39], v22 offset:34816
    s_waitcnt lgkmcnt(10)
    v_mfma_f32_32x32x16_bf16 v[104:119], v[44:47], v[212:215], v[104:119]
    buffer_load_dwordx4 v[156:159], v249, s[32:35], s16 offen offset:1024 sc1
    ds_read_b64_tr_b16 v[40:41], v23 offset:32768
    ds_read_b64_tr_b16 v[42:43], v23 offset:34816
    s_barrier
    s_waitcnt vmcnt(9)
    s_waitcnt lgkmcnt(10)
    v_mfma_f32_32x32x16_bf16 v[56:71], v[48:51], v[216:219], v[56:71]
    ds_read_b64_tr_b16 v[44:45], v20 offset:33792
    ds_read_b64_tr_b16 v[46:47], v20 offset:35840
    s_waitcnt lgkmcnt(10)
    v_mfma_f32_32x32x16_bf16 v[72:87], v[52:55], v[216:219], v[72:87]
    ds_read_b64_tr_b16 v[48:49], v21 offset:33792
    ds_read_b64_tr_b16 v[50:51], v21 offset:35840
    s_waitcnt lgkmcnt(10)
    v_mfma_f32_32x32x16_bf16 v[120:135], v[28:31], v[216:219], v[120:135]
    ds_read_b64_tr_b16 v[52:53], v24 offset:33792
    ds_read_b64_tr_b16 v[54:55], v24 offset:35840
    s_waitcnt lgkmcnt(10)
    v_mfma_f32_32x32x16_bf16 v[136:151], v[32:35], v[216:219], v[136:151]
    ds_read_b64_tr_b16 v[28:29], v25 offset:33792
    ds_read_b64_tr_b16 v[30:31], v25 offset:35840
    s_waitcnt lgkmcnt(10)
    v_mfma_f32_32x32x16_bf16 v[88:103], v[36:39], v[216:219], v[88:103]
    buffer_load_dwordx4 v[160:163], v249, s[32:35], s16 offen offset:2048 sc1
    ds_read_b64_tr_b16 v[32:33], v22 offset:33792
    ds_read_b64_tr_b16 v[34:35], v22 offset:35840
    s_waitcnt lgkmcnt(10)
    v_mfma_f32_32x32x16_bf16 v[104:119], v[40:43], v[216:219], v[104:119]
    ds_read_b64_tr_b16 v[36:37], v23 offset:33792
    ds_read_b64_tr_b16 v[38:39], v23 offset:35840
    s_waitcnt vmcnt(9)
    s_waitcnt lgkmcnt(10)
    v_mfma_f32_32x32x16_bf16 v[56:71], v[44:47], v[220:223], v[56:71]
    ds_read_b64_tr_b16 v[40:41], v20 offset:36864
    ds_read_b64_tr_b16 v[42:43], v20 offset:38912
    s_waitcnt lgkmcnt(10)
    v_mfma_f32_32x32x16_bf16 v[72:87], v[48:51], v[220:223], v[72:87]
    ds_read_b64_tr_b16 v[44:45], v21 offset:36864
    ds_read_b64_tr_b16 v[46:47], v21 offset:38912
    s_waitcnt lgkmcnt(10)
    v_mfma_f32_32x32x16_bf16 v[120:135], v[52:55], v[220:223], v[120:135]
    ds_read_b64_tr_b16 v[48:49], v24 offset:36864
    ds_read_b64_tr_b16 v[50:51], v24 offset:38912
    s_waitcnt lgkmcnt(10)
    v_mfma_f32_32x32x16_bf16 v[136:151], v[28:31], v[220:223], v[136:151]
    buffer_load_dwordx4 v[164:167], v249, s[32:35], s16 offen offset:3072 sc1
    ds_read_b64_tr_b16 v[52:53], v25 offset:36864
    ds_read_b64_tr_b16 v[54:55], v25 offset:38912
    s_waitcnt lgkmcnt(10)
    v_mfma_f32_32x32x16_bf16 v[88:103], v[32:35], v[220:223], v[88:103]
    s_add_u32 s16, s16, 16384
    ds_read_b64_tr_b16 v[28:29], v22 offset:36864
    ds_read_b64_tr_b16 v[30:31], v22 offset:38912
    s_waitcnt lgkmcnt(10)
    v_mfma_f32_32x32x16_bf16 v[104:119], v[36:39], v[220:223], v[104:119]
    s_and_b32 s16, s16, 0x3ffff
    ds_read_b64_tr_b16 v[32:33], v23 offset:36864
    ds_read_b64_tr_b16 v[34:35], v23 offset:38912
    s_waitcnt vmcnt(9)
    s_waitcnt lgkmcnt(10)
    v_mfma_f32_32x32x16_bf16 v[56:71], v[40:43], v[224:227], v[56:71]
    ds_read_b64_tr_b16 v[36:37], v20 offset:37888
    ds_read_b64_tr_b16 v[38:39], v20 offset:39936
    s_waitcnt lgkmcnt(10)
    v_mfma_f32_32x32x16_bf16 v[72:87], v[44:47], v[224:227], v[72:87]
    ds_read_b64_tr_b16 v[40:41], v21 offset:37888
    ds_read_b64_tr_b16 v[42:43], v21 offset:39936
    s_waitcnt lgkmcnt(10)
    v_mfma_f32_32x32x16_bf16 v[120:135], v[48:51], v[224:227], v[120:135]
    buffer_load_dwordx4 v[168:171], v249, s[32:35], s16 offen sc1
    ds_read_b64_tr_b16 v[44:45], v24 offset:37888
    ds_read_b64_tr_b16 v[46:47], v24 offset:39936
    s_waitcnt lgkmcnt(10)
    v_mfma_f32_32x32x16_bf16 v[136:151], v[52:55], v[224:227], v[136:151]
    ds_read_b64_tr_b16 v[48:49], v25 offset:37888
    ds_read_b64_tr_b16 v[50:51], v25 offset:39936
    s_waitcnt lgkmcnt(10)
    v_mfma_f32_32x32x16_bf16 v[88:103], v[28:31], v[224:227], v[88:103]
    ds_read_b64_tr_b16 v[52:53], v22 offset:37888
    ds_read_b64_tr_b16 v[54:55], v22 offset:39936
    s_waitcnt lgkmcnt(10)
    v_mfma_f32_32x32x16_bf16 v[104:119], v[32:35], v[224:227], v[104:119]
    ds_read_b64_tr_b16 v[28:29], v23 offset:37888
    ds_read_b64_tr_b16 v[30:31], v23 offset:39936
    s_waitcnt vmcnt(9)
    s_waitcnt lgkmcnt(10)
    v_mfma_f32_32x32x16_bf16 v[56:71], v[36:39], v[228:231], v[56:71]
    ds_read_b64_tr_b16 v[32:33], v20 offset:40960
    ds_read_b64_tr_b16 v[34:35], v20 offset:43008
    s_waitcnt lgkmcnt(10)
    v_mfma_f32_32x32x16_bf16 v[72:87], v[40:43], v[228:231], v[72:87]
    buffer_load_dwordx4 v[172:175], v249, s[32:35], s16 offen offset:1024 sc1
    ds_read_b64_tr_b16 v[36:37], v21 offset:40960
    ds_read_b64_tr_b16 v[38:39], v21 offset:43008
    s_waitcnt lgkmcnt(10)
    v_mfma_f32_32x32x16_bf16 v[120:135], v[44:47], v[228:231], v[120:135]
    ds_read_b64_tr_b16 v[40:41], v24 offset:40960
    ds_read_b64_tr_b16 v[42:43], v24 offset:43008
    s_waitcnt lgkmcnt(10)
    v_mfma_f32_32x32x16_bf16 v[136:151], v[48:51], v[228:231], v[136:151]
    ds_read_b64_tr_b16 v[44:45], v25 offset:40960
    ds_read_b64_tr_b16 v[46:47], v25 offset:43008
    s_waitcnt lgkmcnt(10)
    v_mfma_f32_32x32x16_bf16 v[88:103], v[52:55], v[228:231], v[88:103]
    ds_read_b64_tr_b16 v[48:49], v22 offset:40960
    ds_read_b64_tr_b16 v[50:51], v22 offset:43008
    s_waitcnt lgkmcnt(10)
    v_mfma_f32_32x32x16_bf16 v[104:119], v[28:31], v[228:231], v[104:119]
    buffer_load_dwordx4 v[176:179], v249, s[32:35], s16 offen offset:2048 sc1
    ds_read_b64_tr_b16 v[52:53], v23 offset:40960
    ds_read_b64_tr_b16 v[54:55], v23 offset:43008
    s_barrier
    s_waitcnt vmcnt(10)
    s_waitcnt lgkmcnt(10)
    v_mfma_f32_32x32x16_bf16 v[56:71], v[32:35], v[232:235], v[56:71]
    ds_read_b64_tr_b16 v[28:29], v20 offset:41984
    ds_read_b64_tr_b16 v[30:31], v20 offset:44032
    s_waitcnt lgkmcnt(10)
    v_mfma_f32_32x32x16_bf16 v[72:87], v[36:39], v[232:235], v[72:87]
    ds_read_b64_tr_b16 v[32:33], v21 offset:41984
    ds_read_b64_tr_b16 v[34:35], v21 offset:44032
    s_waitcnt lgkmcnt(10)
    v_mfma_f32_32x32x16_bf16 v[120:135], v[40:43], v[232:235], v[120:135]
    ds_read_b64_tr_b16 v[36:37], v24 offset:41984
    ds_read_b64_tr_b16 v[38:39], v24 offset:44032
    s_waitcnt lgkmcnt(10)
    v_mfma_f32_32x32x16_bf16 v[136:151], v[44:47], v[232:235], v[136:151]
    buffer_load_dwordx4 v[180:183], v249, s[32:35], s16 offen offset:3072 sc1
    ds_read_b64_tr_b16 v[40:41], v25 offset:41984
    ds_read_b64_tr_b16 v[42:43], v25 offset:44032
    s_waitcnt lgkmcnt(10)
    v_mfma_f32_32x32x16_bf16 v[88:103], v[48:51], v[232:235], v[88:103]
    s_add_u32 s16, s16, 16384
    ds_read_b64_tr_b16 v[44:45], v22 offset:41984
    ds_read_b64_tr_b16 v[46:47], v22 offset:44032
    s_waitcnt lgkmcnt(10)
    v_mfma_f32_32x32x16_bf16 v[104:119], v[52:55], v[232:235], v[104:119]
    s_and_b32 s16, s16, 0x3ffff
    ds_read_b64_tr_b16 v[48:49], v23 offset:41984
    ds_read_b64_tr_b16 v[50:51], v23 offset:44032
    s_waitcnt vmcnt(10)
    s_waitcnt lgkmcnt(10)
    v_mfma_f32_32x32x16_bf16 v[56:71], v[28:31], v[236:239], v[56:71]
    buffer_load_dwordx4 v[184:187], v249, s[32:35], s16 offen sc1
    ds_read_b64_tr_b16 v[52:53], v20 offset:45056
    ds_read_b64_tr_b16 v[54:55], v20 offset:47104
    s_waitcnt lgkmcnt(10)
    v_mfma_f32_32x32x16_bf16 v[72:87], v[32:35], v[236:239], v[72:87]
    ds_read_b64_tr_b16 v[28:29], v21 offset:45056
    ds_read_b64_tr_b16 v[30:31], v21 offset:47104
    s_waitcnt lgkmcnt(10)
    v_mfma_f32_32x32x16_bf16 v[120:135], v[36:39], v[236:239], v[120:135]
    ds_read_b64_tr_b16 v[32:33], v24 offset:45056
    ds_read_b64_tr_b16 v[34:35], v24 offset:47104
    s_waitcnt lgkmcnt(10)
    v_mfma_f32_32x32x16_bf16 v[136:151], v[40:43], v[236:239], v[136:151]
    ds_read_b64_tr_b16 v[36:37], v25 offset:45056
    ds_read_b64_tr_b16 v[38:39], v25 offset:47104
    s_waitcnt lgkmcnt(10)
    v_mfma_f32_32x32x16_bf16 v[88:103], v[44:47], v[236:239], v[88:103]
    buffer_load_dwordx4 v[188:191], v249, s[32:35], s16 offen offset:1024 sc1
    ds_read_b64_tr_b16 v[40:41], v22 offset:45056
    ds_read_b64_tr_b16 v[42:43], v22 offset:47104
    s_waitcnt lgkmcnt(10)
    v_mfma_f32_32x32x16_bf16 v[104:119], v[48:51], v[236:239], v[104:119]
    ds_read_b64_tr_b16 v[44:45], v23 offset:45056
    ds_read_b64_tr_b16 v[46:47], v23 offset:47104
    s_waitcnt vmcnt(11)
    s_waitcnt lgkmcnt(10)
    v_mfma_f32_32x32x16_bf16 v[56:71], v[52:55], v[240:243], v[56:71]
    ds_read_b64_tr_b16 v[48:49], v20 offset:46080
    ds_read_b64_tr_b16 v[50:51], v20 offset:48128
    s_waitcnt lgkmcnt(10)
    v_mfma_f32_32x32x16_bf16 v[72:87], v[28:31], v[240:243], v[72:87]
    buffer_load_dwordx4 v[192:195], v249, s[32:35], s16 offen offset:2048 sc1
    ds_read_b64_tr_b16 v[52:53], v21 offset:46080
    ds_read_b64_tr_b16 v[54:55], v21 offset:48128
    s_waitcnt lgkmcnt(10)
    v_mfma_f32_32x32x16_bf16 v[120:135], v[32:35], v[240:243], v[120:135]
    ds_read_b64_tr_b16 v[28:29], v24 offset:46080
    ds_read_b64_tr_b16 v[30:31], v24 offset:48128
    s_waitcnt lgkmcnt(10)
    v_mfma_f32_32x32x16_bf16 v[136:151], v[36:39], v[240:243], v[136:151]
    ds_read_b64_tr_b16 v[32:33], v25 offset:46080
    ds_read_b64_tr_b16 v[34:35], v25 offset:48128
    s_waitcnt lgkmcnt(10)
    v_mfma_f32_32x32x16_bf16 v[88:103], v[40:43], v[240:243], v[88:103]
    ds_read_b64_tr_b16 v[36:37], v22 offset:46080
    ds_read_b64_tr_b16 v[38:39], v22 offset:48128
    s_waitcnt lgkmcnt(10)
    v_mfma_f32_32x32x16_bf16 v[104:119], v[44:47], v[240:243], v[104:119]
    buffer_load_dwordx4 v[196:199], v249, s[32:35], s16 offen offset:3072 sc1
    ds_read_b64_tr_b16 v[40:41], v23 offset:46080
    ds_read_b64_tr_b16 v[42:43], v23 offset:48128
    s_waitcnt vmcnt(12)
    s_waitcnt lgkmcnt(10)
    v_mfma_f32_32x32x16_bf16 v[56:71], v[48:51], v[244:247], v[56:71]
    s_add_u32 s16, s16, 16384
    ds_read_b64_tr_b16 v[44:45], v20
    ds_read_b64_tr_b16 v[46:47], v20 offset:2048
    s_waitcnt lgkmcnt(10)
    v_mfma_f32_32x32x16_bf16 v[72:87], v[52:55], v[244:247], v[72:87]
    s_and_b32 s16, s16, 0x3ffff
    ds_read_b64_tr_b16 v[48:49], v21
    ds_read_b64_tr_b16 v[50:51], v21 offset:2048
    s_waitcnt lgkmcnt(10)
    v_mfma_f32_32x32x16_bf16 v[120:135], v[28:31], v[244:247], v[120:135]
    buffer_load_dwordx4 v[200:203], v249, s[32:35], s16 offen sc1
    ds_read_b64_tr_b16 v[52:53], v24
    ds_read_b64_tr_b16 v[54:55], v24 offset:2048
    s_waitcnt lgkmcnt(10)
    v_mfma_f32_32x32x16_bf16 v[136:151], v[32:35], v[244:247], v[136:151]
    ds_read_b64_tr_b16 v[28:29], v25
    ds_read_b64_tr_b16 v[30:31], v25 offset:2048
    s_waitcnt lgkmcnt(10)
    v_mfma_f32_32x32x16_bf16 v[88:103], v[36:39], v[244:247], v[88:103]
    ds_read_b64_tr_b16 v[32:33], v22
    ds_read_b64_tr_b16 v[34:35], v22 offset:2048
    s_waitcnt lgkmcnt(10)
    v_mfma_f32_32x32x16_bf16 v[104:119], v[40:43], v[244:247], v[104:119]
    buffer_load_dwordx4 v[204:207], v249, s[32:35], s16 offen offset:1024 sc1
    ds_read_b64_tr_b16 v[36:37], v23
    ds_read_b64_tr_b16 v[38:39], v23 offset:2048
    s_barrier
    s_waitcnt vmcnt(13)
    s_waitcnt lgkmcnt(10)
    v_mfma_f32_32x32x16_bf16 v[56:71], v[44:47], v[152:155], v[56:71]
    ds_read_b64_tr_b16 v[40:41], v20 offset:1024
    ds_read_b64_tr_b16 v[42:43], v20 offset:3072
    s_waitcnt lgkmcnt(10)
    v_mfma_f32_32x32x16_bf16 v[72:87], v[48:51], v[152:155], v[72:87]
    ds_read_b64_tr_b16 v[44:45], v21 offset:1024
    ds_read_b64_tr_b16 v[46:47], v21 offset:3072
    s_waitcnt lgkmcnt(10)
    v_mfma_f32_32x32x16_bf16 v[120:135], v[52:55], v[152:155], v[120:135]
    ds_read_b64_tr_b16 v[48:49], v24 offset:1024
    ds_read_b64_tr_b16 v[50:51], v24 offset:3072
    s_waitcnt lgkmcnt(10)
    v_mfma_f32_32x32x16_bf16 v[136:151], v[28:31], v[152:155], v[136:151]
    buffer_load_dwordx4 v[208:211], v249, s[32:35], s16 offen offset:2048 sc1
    ds_read_b64_tr_b16 v[52:53], v25 offset:1024
    ds_read_b64_tr_b16 v[54:55], v25 offset:3072
    s_waitcnt lgkmcnt(10)
    v_mfma_f32_32x32x16_bf16 v[88:103], v[32:35], v[152:155], v[88:103]
    ds_read_b64_tr_b16 v[28:29], v22 offset:1024
    ds_read_b64_tr_b16 v[30:31], v22 offset:3072
    s_waitcnt lgkmcnt(10)
    v_mfma_f32_32x32x16_bf16 v[104:119], v[36:39], v[152:155], v[104:119]
    ds_read_b64_tr_b16 v[32:33], v23 offset:1024
    ds_read_b64_tr_b16 v[34:35], v23 offset:3072
    s_waitcnt vmcnt(13)
    s_waitcnt lgkmcnt(10)
    v_mfma_f32_32x32x16_bf16 v[56:71], v[40:43], v[156:159], v[56:71]
    buffer_load_dwordx4 v[212:215], v249, s[32:35], s16 offen offset:3072 sc1
    ds_read_b64_tr_b16 v[36:37], v20 offset:4096
    ds_read_b64_tr_b16 v[38:39], v20 offset:6144
    s_waitcnt lgkmcnt(10)
    v_mfma_f32_32x32x16_bf16 v[72:87], v[44:47], v[156:159], v[72:87]
    s_add_u32 s16, s16, 16384
    ds_read_b64_tr_b16 v[40:41], v21 offset:4096
    ds_read_b64_tr_b16 v[42:43], v21 offset:6144
    s_waitcnt lgkmcnt(10)
    v_mfma_f32_32x32x16_bf16 v[120:135], v[48:51], v[156:159], v[120:135]
    s_and_b32 s16, s16, 0x3ffff
    ds_read_b64_tr_b16 v[44:45], v24 offset:4096
    ds_read_b64_tr_b16 v[46:47], v24 offset:6144
    s_waitcnt lgkmcnt(10)
    v_mfma_f32_32x32x16_bf16 v[136:151], v[52:55], v[156:159], v[136:151]
    ds_read_b64_tr_b16 v[48:49], v25 offset:4096
    ds_read_b64_tr_b16 v[50:51], v25 offset:6144
    s_waitcnt lgkmcnt(10)
    v_mfma_f32_32x32x16_bf16 v[88:103], v[28:31], v[156:159], v[88:103]
    buffer_load_dwordx4 v[216:219], v249, s[32:35], s16 offen sc1
    ds_read_b64_tr_b16 v[52:53], v22 offset:4096
    ds_read_b64_tr_b16 v[54:55], v22 offset:6144
    s_waitcnt lgkmcnt(10)
    v_mfma_f32_32x32x16_bf16 v[104:119], v[32:35], v[156:159], v[104:119]
    ds_read_b64_tr_b16 v[28:29], v23 offset:4096
    ds_read_b64_tr_b16 v[30:31], v23 offset:6144
    s_waitcnt vmcnt(14)
    s_waitcnt lgkmcnt(10)
    v_mfma_f32_32x32x16_bf16 v[56:71], v[36:39], v[160:163], v[56:71]
    ds_read_b64_tr_b16 v[32:33], v20 offset:5120
    ds_read_b64_tr_b16 v[34:35], v20 offset:7168
    s_waitcnt lgkmcnt(10)
    v_mfma_f32_32x32x16_bf16 v[72:87], v[40:43], v[160:163], v[72:87]
    buffer_load_dwordx4 v[220:223], v249, s[32:35], s16 offen offset:1024 sc1
    ds_read_b64_tr_b16 v[36:37], v21 offset:5120
    ds_read_b64_tr_b16 v[38:39], v21 offset:7168
    s_waitcnt lgkmcnt(10)
    v_mfma_f32_32x32x16_bf16 v[120:135], v[44:47], v[160:163], v[120:135]
    ds_read_b64_tr_b16 v[40:41], v24 offset:5120
    ds_read_b64_tr_b16 v[42:43], v24 offset:7168
    s_waitcnt lgkmcnt(10)
    v_mfma_f32_32x32x16_bf16 v[136:151], v[48:51], v[160:163], v[136:151]
    ds_read_b64_tr_b16 v[44:45], v25 offset:5120
    ds_read_b64_tr_b16 v[46:47], v25 offset:7168
    s_waitcnt lgkmcnt(10)
    v_mfma_f32_32x32x16_bf16 v[88:103], v[52:55], v[160:163], v[88:103]
    ds_read_b64_tr_b16 v[48:49], v22 offset:5120
    ds_read_b64_tr_b16 v[50:51], v22 offset:7168
    s_waitcnt lgkmcnt(10)
    v_mfma_f32_32x32x16_bf16 v[104:119], v[28:31], v[160:163], v[104:119]
    buffer_load_dwordx4 v[224:227], v249, s[32:35], s16 offen offset:2048 sc1
    ds_read_b64_tr_b16 v[52:53], v23 offset:5120
    ds_read_b64_tr_b16 v[54:55], v23 offset:7168
    s_waitcnt vmcnt(15)
    s_waitcnt lgkmcnt(10)
    v_mfma_f32_32x32x16_bf16 v[56:71], v[32:35], v[164:167], v[56:71]
    ds_read_b64_tr_b16 v[28:29], v20 offset:8192
    ds_read_b64_tr_b16 v[30:31], v20 offset:10240
    s_waitcnt lgkmcnt(10)
    v_mfma_f32_32x32x16_bf16 v[72:87], v[36:39], v[164:167], v[72:87]
    ds_read_b64_tr_b16 v[32:33], v21 offset:8192
    ds_read_b64_tr_b16 v[34:35], v21 offset:10240
    s_waitcnt lgkmcnt(10)
    v_mfma_f32_32x32x16_bf16 v[120:135], v[40:43], v[164:167], v[120:135]
    buffer_load_dwordx4 v[228:231], v249, s[32:35], s16 offen offset:3072 sc1
    ds_read_b64_tr_b16 v[36:37], v24 offset:8192
    ds_read_b64_tr_b16 v[38:39], v24 offset:10240
    s_waitcnt lgkmcnt(10)
    v_mfma_f32_32x32x16_bf16 v[136:151], v[44:47], v[164:167], v[136:151]
    s_add_u32 s16, s16, 16384
    ds_read_b64_tr_b16 v[40:41], v25 offset:8192
    ds_read_b64_tr_b16 v[42:43], v25 offset:10240
    s_waitcnt lgkmcnt(10)
    v_mfma_f32_32x32x16_bf16 v[88:103], v[48:51], v[164:167], v[88:103]
    s_and_b32 s16, s16, 0x3ffff
    ds_read_b64_tr_b16 v[44:45], v22 offset:8192
    ds_read_b64_tr_b16 v[46:47], v22 offset:10240
    s_waitcnt lgkmcnt(10)
    v_mfma_f32_32x32x16_bf16 v[104:119], v[52:55], v[164:167], v[104:119]
    buffer_load_dwordx4 v[232:235], v249, s[32:35], s16 offen sc1
    ds_read_b64_tr_b16 v[48:49], v23 offset:8192
    ds_read_b64_tr_b16 v[50:51], v23 offset:10240
    s_barrier
    s_waitcnt vmcnt(16)
    s_waitcnt lgkmcnt(10)
    v_mfma_f32_32x32x16_bf16 v[56:71], v[28:31], v[168:171], v[56:71]
    ds_read_b64_tr_b16 v[52:53], v20 offset:9216
    ds_read_b64_tr_b16 v[54:55], v20 offset:11264
    s_waitcnt lgkmcnt(10)
    v_mfma_f32_32x32x16_bf16 v[72:87], v[32:35], v[168:171], v[72:87]
    ds_read_b64_tr_b16 v[28:29], v21 offset:9216
    ds_read_b64_tr_b16 v[30:31], v21 offset:11264
    s_waitcnt lgkmcnt(10)
    v_mfma_f32_32x32x16_bf16 v[120:135], v[36:39], v[168:171], v[120:135]
    ds_read_b64_tr_b16 v[32:33], v24 offset:9216
    ds_read_b64_tr_b16 v[34:35], v24 offset:11264
    s_waitcnt lgkmcnt(10)
    v_mfma_f32_32x32x16_bf16 v[136:151], v[40:43], v[168:171], v[136:151]
    buffer_load_dwordx4 v[236:239], v249, s[32:35], s16 offen offset:1024 sc1
    ds_read_b64_tr_b16 v[36:37], v25 offset:9216
    ds_read_b64_tr_b16 v[38:39], v25 offset:11264
    s_waitcnt lgkmcnt(10)
    v_mfma_f32_32x32x16_bf16 v[88:103], v[44:47], v[168:171], v[88:103]
    ds_read_b64_tr_b16 v[40:41], v22 offset:9216
    ds_read_b64_tr_b16 v[42:43], v22 offset:11264
    s_waitcnt lgkmcnt(10)
    v_mfma_f32_32x32x16_bf16 v[104:119], v[48:51], v[168:171], v[104:119]
    ds_read_b64_tr_b16 v[44:45], v23 offset:9216
    ds_read_b64_tr_b16 v[46:47], v23 offset:11264
    s_waitcnt vmcnt(16)
    s_waitcnt lgkmcnt(10)
    v_mfma_f32_32x32x16_bf16 v[56:71], v[52:55], v[172:175], v[56:71]
    buffer_load_dwordx4 v[240:243], v249, s[32:35], s16 offen offset:2048 sc1
    ds_read_b64_tr_b16 v[48:49], v20 offset:12288
    ds_read_b64_tr_b16 v[50:51], v20 offset:14336
    s_waitcnt lgkmcnt(10)
    v_mfma_f32_32x32x16_bf16 v[72:87], v[28:31], v[172:175], v[72:87]
    ds_read_b64_tr_b16 v[52:53], v21 offset:12288
    ds_read_b64_tr_b16 v[54:55], v21 offset:14336
    s_waitcnt lgkmcnt(10)
    v_mfma_f32_32x32x16_bf16 v[120:135], v[32:35], v[172:175], v[120:135]
    ds_read_b64_tr_b16 v[28:29], v24 offset:12288
    ds_read_b64_tr_b16 v[30:31], v24 offset:14336
    s_waitcnt lgkmcnt(10)
    v_mfma_f32_32x32x16_bf16 v[136:151], v[36:39], v[172:175], v[136:151]
    ds_read_b64_tr_b16 v[32:33], v25 offset:12288
    ds_read_b64_tr_b16 v[34:35], v25 offset:14336
    s_waitcnt lgkmcnt(10)
    v_mfma_f32_32x32x16_bf16 v[88:103], v[40:43], v[172:175], v[88:103]
    buffer_load_dwordx4 v[244:247], v249, s[32:35], s16 offen offset:3072 sc1
    ds_read_b64_tr_b16 v[36:37], v22 offset:12288
    ds_read_b64_tr_b16 v[38:39], v22 offset:14336
    s_waitcnt lgkmcnt(10)
    v_mfma_f32_32x32x16_bf16 v[104:119], v[44:47], v[172:175], v[104:119]
    s_add_u32 s16, s16, 16384
    ds_read_b64_tr_b16 v[40:41], v23 offset:12288
    ds_read_b64_tr_b16 v[42:43], v23 offset:14336
    s_waitcnt vmcnt(17)
    s_waitcnt lgkmcnt(10)
    v_mfma_f32_32x32x16_bf16 v[56:71], v[48:51], v[176:179], v[56:71]
    s_and_b32 s16, s16, 0x3ffff
    ds_read_b64_tr_b16 v[44:45], v20 offset:13312
    ds_read_b64_tr_b16 v[46:47], v20 offset:15360
    s_waitcnt lgkmcnt(10)
    v_mfma_f32_32x32x16_bf16 v[72:87], v[52:55], v[176:179], v[72:87]
    buffer_load_dwordx4 v[152:155], v249, s[32:35], s16 offen sc1
    ds_read_b64_tr_b16 v[48:49], v21 offset:13312
    ds_read_b64_tr_b16 v[50:51], v21 offset:15360
    s_waitcnt lgkmcnt(10)
    v_mfma_f32_32x32x16_bf16 v[120:135], v[28:31], v[176:179], v[120:135]
    ds_read_b64_tr_b16 v[52:53], v24 offset:13312
    ds_read_b64_tr_b16 v[54:55], v24 offset:15360
    s_waitcnt lgkmcnt(10)
    v_mfma_f32_32x32x16_bf16 v[136:151], v[32:35], v[176:179], v[136:151]
    ds_read_b64_tr_b16 v[28:29], v25 offset:13312
    ds_read_b64_tr_b16 v[30:31], v25 offset:15360
    s_waitcnt lgkmcnt(10)
    v_mfma_f32_32x32x16_bf16 v[88:103], v[36:39], v[176:179], v[88:103]
    ds_read_b64_tr_b16 v[32:33], v22 offset:13312
    ds_read_b64_tr_b16 v[34:35], v22 offset:15360
    s_waitcnt lgkmcnt(10)
    v_mfma_f32_32x32x16_bf16 v[104:119], v[40:43], v[176:179], v[104:119]
    buffer_load_dwordx4 v[156:159], v249, s[32:35], s16 offen offset:1024 sc1
    ds_read_b64_tr_b16 v[36:37], v23 offset:13312
    ds_read_b64_tr_b16 v[38:39], v23 offset:15360
    s_waitcnt vmcnt(18)
    s_waitcnt lgkmcnt(10)
    v_mfma_f32_32x32x16_bf16 v[56:71], v[44:47], v[180:183], v[56:71]
    ds_read_b64_tr_b16 v[40:41], v20 offset:16384
    ds_read_b64_tr_b16 v[42:43], v20 offset:18432
    s_waitcnt lgkmcnt(10)
    v_mfma_f32_32x32x16_bf16 v[72:87], v[48:51], v[180:183], v[72:87]
    ds_read_b64_tr_b16 v[44:45], v21 offset:16384
    ds_read_b64_tr_b16 v[46:47], v21 offset:18432
    s_waitcnt lgkmcnt(10)
    v_mfma_f32_32x32x16_bf16 v[120:135], v[52:55], v[180:183], v[120:135]
    buffer_load_dwordx4 v[160:163], v249, s[32:35], s16 offen offset:2048 sc1
    ds_read_b64_tr_b16 v[48:49], v24 offset:16384
    ds_read_b64_tr_b16 v[50:51], v24 offset:18432
    s_waitcnt lgkmcnt(10)
    v_mfma_f32_32x32x16_bf16 v[136:151], v[28:31], v[180:183], v[136:151]
    ds_read_b64_tr_b16 v[52:53], v25 offset:16384
    ds_read_b64_tr_b16 v[54:55], v25 offset:18432
    s_waitcnt lgkmcnt(10)
    v_mfma_f32_32x32x16_bf16 v[88:103], v[32:35], v[180:183], v[88:103]
    ds_read_b64_tr_b16 v[28:29], v22 offset:16384
    ds_read_b64_tr_b16 v[30:31], v22 offset:18432
    s_waitcnt lgkmcnt(10)
    v_mfma_f32_32x32x16_bf16 v[104:119], v[36:39], v[180:183], v[104:119]
    buffer_load_dwordx4 v[164:167], v249, s[32:35], s16 offen offset:3072 sc1
    ds_read_b64_tr_b16 v[32:33], v23 offset:16384
    ds_read_b64_tr_b16 v[34:35], v23 offset:18432
    s_barrier
    s_waitcnt vmcnt(19)
    s_waitcnt lgkmcnt(10)
    v_mfma_f32_32x32x16_bf16 v[56:71], v[40:43], v[184:187], v[56:71]
    s_add_u32 s16, s16, 16384
    ds_read_b64_tr_b16 v[36:37], v20 offset:17408
    ds_read_b64_tr_b16 v[38:39], v20 offset:19456
    s_waitcnt lgkmcnt(10)
    v_mfma_f32_32x32x16_bf16 v[72:87], v[44:47], v[184:187], v[72:87]
    s_and_b32 s16, s16, 0x3ffff
    ds_read_b64_tr_b16 v[40:41], v21 offset:17408
    ds_read_b64_tr_b16 v[42:43], v21 offset:19456
    s_waitcnt lgkmcnt(10)
    v_mfma_f32_32x32x16_bf16 v[120:135], v[48:51], v[184:187], v[120:135]
    ds_read_b64_tr_b16 v[44:45], v24 offset:17408
    ds_read_b64_tr_b16 v[46:47], v24 offset:19456
    s_waitcnt lgkmcnt(10)
    v_mfma_f32_32x32x16_bf16 v[136:151], v[52:55], v[184:187], v[136:151]
    buffer_load_dwordx4 v[168:171], v249, s[32:35], s16 offen sc1
    ds_read_b64_tr_b16 v[48:49], v25 offset:17408
    ds_read_b64_tr_b16 v[50:51], v25 offset:19456
    s_waitcnt lgkmcnt(10)
    v_mfma_f32_32x32x16_bf16 v[88:103], v[28:31], v[184:187], v[88:103]
    ds_read_b64_tr_b16 v[52:53], v22 offset:17408
    ds_read_b64_tr_b16 v[54:55], v22 offset:19456
    s_waitcnt lgkmcnt(10)
    v_mfma_f32_32x32x16_bf16 v[104:119], v[32:35], v[184:187], v[104:119]
    ds_read_b64_tr_b16 v[28:29], v23 offset:17408
    ds_read_b64_tr_b16 v[30:31], v23 offset:19456
    s_waitcnt vmcnt(19)
    s_waitcnt lgkmcnt(10)
    v_mfma_f32_32x32x16_bf16 v[56:71], v[36:39], v[188:191], v[56:71]
    ds_read_b64_tr_b16 v[32:33], v20 offset:20480
    ds_read_b64_tr_b16 v[34:35], v20 offset:22528
    s_waitcnt lgkmcnt(10)
    v_mfma_f32_32x32x16_bf16 v[72:87], v[40:43], v[188:191], v[72:87]
    buffer_load_dwordx4 v[172:175], v249, s[32:35], s16 offen offset:1024 sc1
    ds_read_b64_tr_b16 v[36:37], v21 offset:20480
    ds_read_b64_tr_b16 v[38:39], v21 offset:22528
    s_waitcnt lgkmcnt(10)
    v_mfma_f32_32x32x16_bf16 v[120:135], v[44:47], v[188:191], v[120:135]
    ds_read_b64_tr_b16 v[40:41], v24 offset:20480
    ds_read_b64_tr_b16 v[42:43], v24 offset:22528
    s_waitcnt lgkmcnt(10)
    v_mfma_f32_32x32x16_bf16 v[136:151], v[48:51], v[188:191], v[136:151]
    ds_read_b64_tr_b16 v[44:45], v25 offset:20480
    ds_read_b64_tr_b16 v[46:47], v25 offset:22528
    s_waitcnt lgkmcnt(10)
    v_mfma_f32_32x32x16_bf16 v[88:103], v[52:55], v[188:191], v[88:103]
    ds_read_b64_tr_b16 v[48:49], v22 offset:20480
    ds_read_b64_tr_b16 v[50:51], v22 offset:22528
    s_waitcnt lgkmcnt(10)
    v_mfma_f32_32x32x16_bf16 v[104:119], v[28:31], v[188:191], v[104:119]
    buffer_load_dwordx4 v[176:179], v249, s[32:35], s16 offen offset:2048 sc1
    ds_read_b64_tr_b16 v[52:53], v23 offset:20480
    ds_read_b64_tr_b16 v[54:55], v23 offset:22528
    s_waitcnt vmcnt(20)
    s_waitcnt lgkmcnt(10)
    v_mfma_f32_32x32x16_bf16 v[56:71], v[32:35], v[192:195], v[56:71]
    ds_read_b64_tr_b16 v[28:29], v20 offset:21504
    ds_read_b64_tr_b16 v[30:31], v20 offset:23552
    s_waitcnt lgkmcnt(10)
    v_mfma_f32_32x32x16_bf16 v[72:87], v[36:39], v[192:195], v[72:87]
    ds_read_b64_tr_b16 v[32:33], v21 offset:21504
    ds_read_b64_tr_b16 v[34:35], v21 offset:23552
    s_waitcnt lgkmcnt(10)
    v_mfma_f32_32x32x16_bf16 v[120:135], v[40:43], v[192:195], v[120:135]
    ds_read_b64_tr_b16 v[36:37], v24 offset:21504
    ds_read_b64_tr_b16 v[38:39], v24 offset:23552
    s_waitcnt lgkmcnt(10)
    v_mfma_f32_32x32x16_bf16 v[136:151], v[44:47], v[192:195], v[136:151]
    buffer_load_dwordx4 v[180:183], v249, s[32:35], s16 offen offset:3072 sc1
    ds_read_b64_tr_b16 v[40:41], v25 offset:21504
L_PAD3:
    s_cbranch_execz L_RET3
    ds_read_b64_tr_b16 v[42:43], v25 offset:23552
    s_waitcnt lgkmcnt(10)
    v_mfma_f32_32x32x16_bf16 v[88:103], v[48:51], v[192:195], v[88:103]
    s_add_u32 s16, s16, 16384
    ds_read_b64_tr_b16 v[44:45], v22 offset:21504
    ds_read_b64_tr_b16 v[46:47], v22 offset:23552
    s_waitcnt lgkmcnt(10)
    v_mfma_f32_32x32x16_bf16 v[104:119], v[52:55], v[192:195], v[104:119]
    s_and_b32 s16, s16, 0x3ffff
    ds_read_b64_tr_b16 v[48:49], v23 offset:21504
    ds_read_b64_tr_b16 v[50:51], v23 offset:23552
    s_waitcnt vmcnt(20)
    s_waitcnt lgkmcnt(10)
    v_mfma_f32_32x32x16_bf16 v[56:71], v[28:31], v[196:199], v[56:71]
    ds_read_b64_tr_b16 v[52:53], v20 offset:24576
    ds_read_b64_tr_b16 v[54:55], v20 offset:26624
    s_waitcnt lgkmcnt(10)
    v_mfma_f32_32x32x16_bf16 v[72:87], v[32:35], v[196:199], v[72:87]
    buffer_load_dwordx4 v[184:187], v249, s[32:35], s16 offen sc1
    ds_read_b64_tr_b16 v[28:29], v21 offset:24576
    ds_read_b64_tr_b16 v[30:31], v21 offset:26624
    s_waitcnt lgkmcnt(10)
    v_mfma_f32_32x32x16_bf16 v[120:135], v[36:39], v[196:199], v[120:135]
    ds_read_b64_tr_b16 v[32:33], v20 offset:25600
    ds_read_b64_tr_b16 v[34:35], v20 offset:27648
    s_waitcnt lgkmcnt(10)
    v_mfma_f32_32x32x16_bf16 v[136:151], v[40:43], v[196:199], v[136:151]
    ds_read_b64_tr_b16 v[36:37], v21 offset:25600
    ds_read_b64_tr_b16 v[38:39], v21 offset:27648
    s_waitcnt lgkmcnt(10)
    v_mfma_f32_32x32x16_bf16 v[88:103], v[44:47], v[196:199], v[88:103]
    ds_read_b64_tr_b16 v[40:41], v20 offset:28672
    ds_read_b64_tr_b16 v[42:43], v20 offset:30720
    s_waitcnt lgkmcnt(10)
    v_mfma_f32_32x32x16_bf16 v[104:119], v[48:51], v[196:199], v[104:119]
    buffer_load_dwordx4 v[188:191], v249, s[32:35], s16 offen offset:1024 sc1
    ds_read_b64_tr_b16 v[44:45], v21 offset:28672
    ds_read_b64_tr_b16 v[46:47], v21 offset:30720
    s_barrier
    s_waitcnt vmcnt(21)
    s_waitcnt lgkmcnt(10)
    v_mfma_f32_32x32x16_bf16 v[56:71], v[52:55], v[200:203], v[56:71]
    ds_read_b64_tr_b16 v[48:49], v20 offset:29696
    ds_read_b64_tr_b16 v[50:51], v20 offset:31744
    s_waitcnt lgkmcnt(10)
    v_mfma_f32_32x32x16_bf16 v[72:87], v[28:31], v[200:203], v[72:87]
    ds_read_b64_tr_b16 v[52:53], v21 offset:29696
    ds_read_b64_tr_b16 v[54:55], v21 offset:31744
    s_waitcnt vmcnt(20)
    s_waitcnt lgkmcnt(10)
    v_mfma_f32_32x32x16_bf16 v[56:71], v[32:35], v[204:207], v[56:71]
    ds_read_b64_tr_b16 v[28:29], v24 offset:24576
    ds_read_b64_tr_b16 v[30:31], v24 offset:26624
    s_waitcnt lgkmcnt(10)
    v_mfma_f32_32x32x16_bf16 v[72:87], v[36:39], v[204:207], v[72:87]
    buffer_load_dwordx4 v[192:195], v249, s[32:35], s16 offen offset:2048 sc1
    ds_read_b64_tr_b16 v[32:33], v25 offset:24576
    ds_read_b64_tr_b16 v[34:35], v25 offset:26624
    s_waitcnt vmcnt(20)
    s_waitcnt lgkmcnt(10)
    v_mfma_f32_32x32x16_bf16 v[56:71], v[40:43], v[208:211], v[56:71]
    ds_read_b64_tr_b16 v[36:37], v22 offset:24576
    ds_read_b64_tr_b16 v[38:39], v22 offset:26624
    s_waitcnt lgkmcnt(10)
    v_mfma_f32_32x32x16_bf16 v[72:87], v[44:47], v[208:211], v[72:87]
    ds_read_b64_tr_b16 v[40:41], v23 offset:24576
    ds_read_b64_tr_b16 v[42:43], v23 offset:26624
    s_waitcnt vmcnt(19)
    s_waitcnt lgkmcnt(10)
    v_mfma_f32_32x32x16_bf16 v[56:71], v[48:51], v[212:215], v[56:71]
    ds_read_b64_tr_b16 v[44:45], v24 offset:25600
    ds_read_b64_tr_b16 v[46:47], v24 offset:27648
    s_waitcnt lgkmcnt(10)
    v_mfma_f32_32x32x16_bf16 v[72:87], v[52:55], v[212:215], v[72:87]
    buffer_load_dwordx4 v[196:199], v249, s[32:35], s16 offen offset:3072 sc1
    ds_read_b64_tr_b16 v[48:49], v25 offset:25600
    ds_read_b64_tr_b16 v[50:51], v25 offset:27648
    s_barrier
    s_waitcnt lgkmcnt(10)
    v_mfma_f32_32x32x16_bf16 v[120:135], v[28:31], v[200:203], v[120:135]
    s_add_u32 s16, s16, 16384
    ds_read_b64_tr_b16 v[52:53], v22 offset:25600
    ds_read_b64_tr_b16 v[54:55], v22 offset:27648
    s_waitcnt lgkmcnt(10)
    v_mfma_f32_32x32x16_bf16 v[136:151], v[32:35], v[200:203], v[136:151]
    s_and_b32 s16, s16, 0x3ffff
    ds_read_b64_tr_b16 v[28:29], v23 offset:25600
    ds_read_b64_tr_b16 v[30:31], v23 offset:27648
    s_waitcnt lgkmcnt(10)
    v_mfma_f32_32x32x16_bf16 v[88:103], v[36:39], v[200:203], v[88:103]
    ds_read_b64_tr_b16 v[32:33], v24 offset:28672
    ds_read_b64_tr_b16 v[34:35], v24 offset:30720
    s_waitcnt lgkmcnt(10)
    v_mfma_f32_32x32x16_bf16 v[104:119], v[40:43], v[200:203], v[104:119]
    buffer_load_dwordx4 v[200:203], v249, s[32:35], s16 offen sc1
    ds_read_b64_tr_b16 v[36:37], v25 offset:28672
    ds_read_b64_tr_b16 v[38:39], v25 offset:30720
    s_waitcnt lgkmcnt(10)
    v_mfma_f32_32x32x16_bf16 v[120:135], v[44:47], v[204:207], v[120:135]
    ds_read_b64_tr_b16 v[40:41], v22 offset:28672
    ds_read_b64_tr_b16 v[42:43], v22 offset:30720
    s_waitcnt lgkmcnt(10)
    v_mfma_f32_32x32x16_bf16 v[136:151], v[48:51], v[204:207], v[136:151]
    ds_read_b64_tr_b16 v[44:45], v23 offset:28672
    ds_read_b64_tr_b16 v[46:47], v23 offset:30720
    s_waitcnt lgkmcnt(10)
    v_mfma_f32_32x32x16_bf16 v[88:103], v[52:55], v[204:207], v[88:103]
    ds_read_b64_tr_b16 v[48:49], v24 offset:29696
    ds_read_b64_tr_b16 v[50:51], v24 offset:31744
    s_waitcnt lgkmcnt(10)
    v_mfma_f32_32x32x16_bf16 v[104:119], v[28:31], v[204:207], v[104:119]
    buffer_load_dwordx4 v[204:207], v249, s[32:35], s16 offen offset:1024 sc1
    ds_read_b64_tr_b16 v[52:53], v25 offset:29696
    ds_read_b64_tr_b16 v[54:55], v25 offset:31744
    s_waitcnt lgkmcnt(10)
    v_mfma_f32_32x32x16_bf16 v[120:135], v[32:35], v[208:211], v[120:135]
    ds_read_b64_tr_b16 v[28:29], v22 offset:29696
    ds_read_b64_tr_b16 v[30:31], v22 offset:31744
    s_waitcnt lgkmcnt(10)
    v_mfma_f32_32x32x16_bf16 v[136:151], v[36:39], v[208:211], v[136:151]
    ds_read_b64_tr_b16 v[32:33], v23 offset:29696
    ds_read_b64_tr_b16 v[34:35], v23 offset:31744
    s_waitcnt lgkmcnt(10)
    v_mfma_f32_32x32x16_bf16 v[88:103], v[40:43], v[208:211], v[88:103]
    ds_read_b64_tr_b16 v[36:37], v20 offset:32768
    ds_read_b64_tr_b16 v[38:39], v20 offset:34816
    s_waitcnt lgkmcnt(10)
    v_mfma_f32_32x32x16_bf16 v[104:119], v[44:47], v[208:211], v[104:119]
    buffer_load_dwordx4 v[208:211], v249, s[32:35], s16 offen offset:2048 sc1
    ds_read_b64_tr_b16 v[40:41], v20 offset:33792
    ds_read_b64_tr_b16 v[42:43], v20 offset:35840
    s_waitcnt lgkmcnt(10)
    v_mfma_f32_32x32x16_bf16 v[120:135], v[48:51], v[212:215], v[120:135]
    ds_read_b64_tr_b16 v[44:45], v20 offset:36864
    ds_read_b64_tr_b16 v[46:47], v20 offset:38912
    s_waitcnt lgkmcnt(10)
    v_mfma_f32_32x32x16_bf16 v[136:151], v[52:55], v[212:215], v[136:151]
    ds_read_b64_tr_b16 v[48:49], v20 offset:37888
    ds_read_b64_tr_b16 v[50:51], v20 offset:39936
    s_waitcnt lgkmcnt(10)
    v_mfma_f32_32x32x16_bf16 v[88:103], v[28:31], v[212:215], v[88:103]
    ds_read_b64_tr_b16 v[52:53], v20 offset:40960
    ds_read_b64_tr_b16 v[54:55], v20 offset:43008
    s_waitcnt lgkmcnt(10)
    v_mfma_f32_32x32x16_bf16 v[104:119], v[32:35], v[212:215], v[104:119]
    buffer_load_dwordx4 v[212:215], v249, s[32:35], s16 offen offset:3072 sc1
    ds_read_b64_tr_b16 v[28:29], v20 offset:41984
    ds_read_b64_tr_b16 v[30:31], v20 offset:44032
    s_barrier
    s_waitcnt vmcnt(23)
    s_waitcnt lgkmcnt(10)
    v_mfma_f32_32x32x16_bf16 v[56:71], v[36:39], v[216:219], v[56:71]
    s_add_u32 s16, s16, 16384
    ds_read_b64_tr_b16 v[32:33], v20 offset:45056
    ds_read_b64_tr_b16 v[34:35], v20 offset:47104
    s_waitcnt vmcnt(22)
    s_waitcnt lgkmcnt(10)
    v_mfma_f32_32x32x16_bf16 v[56:71], v[40:43], v[220:223], v[56:71]
    s_and_b32 s16, s16, 0x3ffff
    ds_read_b64_tr_b16 v[36:37], v20 offset:46080
    ds_read_b64_tr_b16 v[38:39], v20 offset:48128
    s_waitcnt vmcnt(21)
    s_waitcnt lgkmcnt(10)
    v_mfma_f32_32x32x16_bf16 v[56:71], v[44:47], v[224:227], v[56:71]
    ds_read_b64_tr_b16 v[40:41], v20
    ds_read_b64_tr_b16 v[42:43], v20 offset:2048
    s_waitcnt vmcnt(20)
    s_waitcnt lgkmcnt(10)
    v_mfma_f32_32x32x16_bf16 v[56:71], v[48:51], v[228:231], v[56:71]
    ds_read_b64_tr_b16 v[44:45], v20 offset:1024
    ds_read_b64_tr_b16 v[46:47], v20 offset:3072
    s_waitcnt vmcnt(19)
    s_waitcnt lgkmcnt(10)
    v_mfma_f32_32x32x16_bf16 v[56:71], v[52:55], v[232:235], v[56:71]
    ds_read_b64_tr_b16 v[48:49], v20 offset:4096
    ds_read_b64_tr_b16 v[50:51], v20 offset:6144
    s_waitcnt vmcnt(18)
    s_waitcnt lgkmcnt(10)
    v_mfma_f32_32x32x16_bf16 v[56:71], v[28:31], v[236:239], v[56:71]
    ds_read_b64_tr_b16 v[52:53], v20 offset:5120
    ds_read_b64_tr_b16 v[54:55], v20 offset:7168
    s_waitcnt vmcnt(17)
    s_waitcnt lgkmcnt(10)
    v_mfma_f32_32x32x16_bf16 v[56:71], v[32:35], v[240:243], v[56:71]
    ds_read_b64_tr_b16 v[28:29], v20 offset:8192
    ds_read_b64_tr_b16 v[30:31], v20 offset:10240
    s_waitcnt vmcnt(16)
    s_waitcnt lgkmcnt(10)
    v_mfma_f32_32x32x16_bf16 v[56:71], v[36:39], v[244:247], v[56:71]
    ds_read_b64_tr_b16 v[32:33], v20 offset:9216
    ds_read_b64_tr_b16 v[34:35], v20 offset:11264
    s_waitcnt vmcnt(15)
    s_waitcnt lgkmcnt(10)
    v_mfma_f32_32x32x16_bf16 v[56:71], v[40:43], v[152:155], v[56:71]
    ds_read_b64_tr_b16 v[36:37], v20 offset:12288
    ds_read_b64_tr_b16 v[38:39], v20 offset:14336
    s_waitcnt vmcnt(14)
    s_waitcnt lgkmcnt(10)
    v_mfma_f32_32x32x16_bf16 v[56:71], v[44:47], v[156:159], v[56:71]
    ds_read_b64_tr_b16 v[40:41], v20 offset:13312
    ds_read_b64_tr_b16 v[42:43], v20 offset:15360
    s_waitcnt vmcnt(13)
    s_waitcnt lgkmcnt(10)
    v_mfma_f32_32x32x16_bf16 v[56:71], v[48:51], v[160:163], v[56:71]
    ds_read_b64_tr_b16 v[44:45], v20 offset:16384
    ds_read_b64_tr_b16 v[46:47], v20 offset:18432
    s_waitcnt vmcnt(12)
    s_waitcnt lgkmcnt(10)
    v_mfma_f32_32x32x16_bf16 v[56:71], v[52:55], v[164:167], v[56:71]
    ds_read_b64_tr_b16 v[48:49], v20 offset:17408
    ds_read_b64_tr_b16 v[50:51], v20 offset:19456
    s_waitcnt vmcnt(11)
    s_waitcnt lgkmcnt(10)
    v_mfma_f32_32x32x16_bf16 v[56:71], v[28:31], v[168:171], v[56:71]
    ds_read_b64_tr_b16 v[52:53], v20 offset:20480
    ds_read_b64_tr_b16 v[54:55], v20 offset:22528
    s_waitcnt vmcnt(10)
    s_waitcnt lgkmcnt(10)
    v_mfma_f32_32x32x16_bf16 v[56:71], v[32:35], v[172:175], v[56:71]
    ds_read_b64_tr_b16 v[28:29], v20 offset:21504
    ds_read_b64_tr_b16 v[30:31], v20 offset:23552
    s_barrier
    s_waitcnt vmcnt(9)
    s_waitcnt lgkmcnt(10)
    v_mfma_f32_32x32x16_bf16 v[56:71], v[36:39], v[176:179], v[56:71]
    ds_read_b64_tr_b16 v[32:33], v20 offset:24576
    ds_read_b64_tr_b16 v[34:35], v20 offset:26624
    s_waitcnt vmcnt(8)
    s_waitcnt lgkmcnt(10)
    v_mfma_f32_32x32x16_bf16 v[56:71], v[40:43], v[180:183], v[56:71]
    ds_read_b64_tr_b16 v[36:37], v20 offset:25600
    ds_read_b64_tr_b16 v[38:39], v20 offset:27648
    s_waitcnt vmcnt(7)
    s_waitcnt lgkmcnt(10)
    v_mfma_f32_32x32x16_bf16 v[56:71], v[44:47], v[184:187], v[56:71]
    ds_read_b64_tr_b16 v[40:41], v20 offset:28672
    ds_read_b64_tr_b16 v[42:43], v20 offset:30720
    s_waitcnt vmcnt(6)
    s_waitcnt lgkmcnt(10)
    v_mfma_f32_32x32x16_bf16 v[56:71], v[48:51], v[188:191], v[56:71]
    ds_read_b64_tr_b16 v[44:45], v20 offset:29696
    ds_read_b64_tr_b16 v[46:47], v20 offset:31744
    s_waitcnt vmcnt(5)
    s_waitcnt lgkmcnt(10)
    v_mfma_f32_32x32x16_bf16 v[56:71], v[52:55], v[192:195], v[56:71]
    ds_read_b64_tr_b16 v[48:49], v21 offset:32768
    ds_read_b64_tr_b16 v[50:51], v21 offset:34816
    s_waitcnt vmcnt(4)
    s_waitcnt lgkmcnt(10)
    v_mfma_f32_32x32x16_bf16 v[56:71], v[28:31], v[196:199], v[56:71]
    ds_read_b64_tr_b16 v[52:53], v21 offset:33792
    ds_read_b64_tr_b16 v[54:55], v21 offset:35840
    s_waitcnt vmcnt(3)
    s_waitcnt lgkmcnt(10)
    v_mfma_f32_32x32x16_bf16 v[56:71], v[32:35], v[200:203], v[56:71]
    ds_read_b64_tr_b16 v[28:29], v21 offset:36864
    ds_read_b64_tr_b16 v[30:31], v21 offset:38912
    s_waitcnt vmcnt(2)
    s_waitcnt lgkmcnt(10)
    v_mfma_f32_32x32x16_bf16 v[56:71], v[36:39], v[204:207], v[56:71]
    ds_read_b64_tr_b16 v[32:33], v21 offset:37888
    ds_read_b64_tr_b16 v[34:35], v21 offset:39936
    s_waitcnt vmcnt(1)
    s_waitcnt lgkmcnt(10)
    v_mfma_f32_32x32x16_bf16 v[56:71], v[40:43], v[208:211], v[56:71]
    ds_read_b64_tr_b16 v[36:37], v21 offset:40960
    ds_read_b64_tr_b16 v[38:39], v21 offset:43008
    s_waitcnt vmcnt(0)
    s_waitcnt lgkmcnt(10)
    v_mfma_f32_32x32x16_bf16 v[56:71], v[44:47], v[212:215], v[56:71]
    ds_read_b64_tr_b16 v[40:41], v21 offset:41984
    ds_read_b64_tr_b16 v[42:43], v21 offset:44032
    s_waitcnt lgkmcnt(10)
    v_mfma_f32_32x32x16_bf16 v[72:87], v[48:51], v[216:219], v[72:87]
    ds_read_b64_tr_b16 v[44:45], v21 offset:45056
    ds_read_b64_tr_b16 v[46:47], v21 offset:47104
    s_waitcnt lgkmcnt(10)
    v_mfma_f32_32x32x16_bf16 v[72:87], v[52:55], v[220:223], v[72:87]
    s_nop 3
    v_cvt_pk_bf16_f32 v56, v56, v57
    v_cvt_pk_bf16_f32 v57, v58, v59
    ds_read_b64_tr_b16 v[48:49], v21 offset:46080
    ds_read_b64_tr_b16 v[50:51], v21 offset:48128
    s_waitcnt lgkmcnt(10)
    v_mfma_f32_32x32x16_bf16 v[72:87], v[28:31], v[224:227], v[72:87]
    v_cvt_pk_bf16_f32 v58, v60, v61
    v_cvt_pk_bf16_f32 v59, v62, v63
    ds_read_b64_tr_b16 v[52:53], v21
    ds_read_b64_tr_b16 v[54:55], v21 offset:2048
    s_waitcnt lgkmcnt(10)
    v_mfma_f32_32x32x16_bf16 v[72:87], v[32:35], v[228:231], v[72:87]
    ds_write_b128 v0, v[56:59]
    v_cvt_pk_bf16_f32 v60, v64, v65
    ds_read_b64_tr_b16 v[28:29], v21 offset:1024
    ds_read_b64_tr_b16 v[30:31], v21 offset:3072
    s_waitcnt lgkmcnt(11)
    v_mfma_f32_32x32x16_bf16 v[72:87], v[36:39], v[232:235], v[72:87]
    v_cvt_pk_bf16_f32 v61, v66, v67
    v_cvt_pk_bf16_f32 v62, v68, v69
    ds_read_b64_tr_b16 v[32:33], v21 offset:4096
    ds_read_b64_tr_b16 v[34:35], v21 offset:6144
    s_waitcnt lgkmcnt(11)
    v_mfma_f32_32x32x16_bf16 v[72:87], v[40:43], v[236:239], v[72:87]
    v_cvt_pk_bf16_f32 v63, v70, v71
    ds_write_b128 v0, v[60:63] offset:1024
    ds_read_b64_tr_b16 v[36:37], v21 offset:5120
    ds_read_b64_tr_b16 v[38:39], v21 offset:7168
    s_waitcnt lgkmcnt(12)
    v_mfma_f32_32x32x16_bf16 v[72:87], v[44:47], v[240:243], v[72:87]
    v_subrev_u32 v0, 118784, v0
    ds_read_b64_tr_b16 v[40:41], v21 offset:8192
    ds_read_b64_tr_b16 v[42:43], v21 offset:10240
    s_waitcnt lgkmcnt(12)
    v_mfma_f32_32x32x16_bf16 v[72:87], v[48:51], v[244:247], v[72:87]
    ds_read_b64_tr_b16 v[44:45], v21 offset:9216
    ds_read_b64_tr_b16 v[46:47], v21 offset:11264
    s_waitcnt lgkmcnt(6)
    s_barrier
    v_mfma_f32_32x32x16_bf16 v[72:87], v[52:55], v[152:155], v[72:87]
    ds_read_b64_tr_b16 v[48:49], v21 offset:12288
    ds_read_b64_tr_b16 v[50:51], v21 offset:14336
    v_mfma_f32_32x32x16_bf16 v[72:87], v[28:31], v[156:159], v[72:87]
    ds_read_b64_tr_b16 v[52:53], v21 offset:13312
    ds_read_b64_tr_b16 v[54:55], v21 offset:15360
    v_mfma_f32_32x32x16_bf16 v[72:87], v[32:35], v[160:163], v[72:87]
    ds_read_b64_tr_b16 v[28:29], v21 offset:16384
    ds_read_b64_tr_b16 v[30:31], v21 offset:18432
    s_waitcnt lgkmcnt(10)
    v_mfma_f32_32x32x16_bf16 v[72:87], v[36:39], v[164:167], v[72:87]
    ds_read_b64_tr_b16 v[32:33], v21 offset:17408
    ds_read_b64_tr_b16 v[34:35], v21 offset:19456
    s_waitcnt lgkmcnt(10)
    v_mfma_f32_32x32x16_bf16 v[72:87], v[40:43], v[168:171], v[72:87]
    ds_read_b64_tr_b16 v[36:37], v21 offset:20480
    ds_read_b64_tr_b16 v[38:39], v21 offset:22528
    s_waitcnt lgkmcnt(10)
    v_mfma_f32_32x32x16_bf16 v[72:87], v[44:47], v[172:175], v[72:87]
    ds_read_b64_tr_b16 v[40:41], v21 offset:21504
    ds_read_b64_tr_b16 v[42:43], v21 offset:23552
    s_waitcnt lgkmcnt(10)
    v_mfma_f32_32x32x16_bf16 v[72:87], v[48:51], v[176:179], v[72:87]
    ds_read_b64_tr_b16 v[44:45], v21 offset:24576
    ds_read_b64_tr_b16 v[46:47], v21 offset:26624
    s_waitcnt lgkmcnt(10)
    v_mfma_f32_32x32x16_bf16 v[72:87], v[52:55], v[180:183], v[72:87]
    ds_read_b64_tr_b16 v[48:49], v21 offset:25600
    ds_read_b64_tr_b16 v[50:51], v21 offset:27648
    s_waitcnt lgkmcnt(10)
    v_mfma_f32_32x32x16_bf16 v[72:87], v[28:31], v[184:187], v[72:87]
    ds_read_b64_tr_b16 v[52:53], v21 offset:28672
    ds_read_b64_tr_b16 v[54:55], v21 offset:30720
    s_waitcnt lgkmcnt(10)
    v_mfma_f32_32x32x16_bf16 v[72:87], v[32:35], v[188:191], v[72:87]
    ds_read_b64_tr_b16 v[28:29], v21 offset:29696
    ds_read_b64_tr_b16 v[30:31], v21 offset:31744
    s_waitcnt lgkmcnt(10)
    v_mfma_f32_32x32x16_bf16 v[72:87], v[36:39], v[192:195], v[72:87]
    ds_read_b64_tr_b16 v[32:33], v22 offset:32768
    ds_read_b64_tr_b16 v[34:35], v22 offset:34816
    s_waitcnt lgkmcnt(10)
    v_mfma_f32_32x32x16_bf16 v[72:87], v[40:43], v[196:199], v[72:87]
    ds_read_b64_tr_b16 v[36:37], v23 offset:32768
    ds_read_b64_tr_b16 v[38:39], v23 offset:34816
    s_waitcnt lgkmcnt(10)
    v_mfma_f32_32x32x16_bf16 v[72:87], v[44:47], v[200:203], v[72:87]
    ds_read_b64_tr_b16 v[40:41], v22 offset:33792
    ds_read_b64_tr_b16 v[42:43], v22 offset:35840
    s_waitcnt lgkmcnt(10)
    v_mfma_f32_32x32x16_bf16 v[72:87], v[48:51], v[204:207], v[72:87]
    ds_read_b64_tr_b16 v[44:45], v23 offset:33792
    ds_read_b64_tr_b16 v[46:47], v23 offset:35840
    s_waitcnt lgkmcnt(10)
    v_mfma_f32_32x32x16_bf16 v[72:87], v[52:55], v[208:211], v[72:87]
    ds_read_b64_tr_b16 v[48:49], v22 offset:36864
    ds_read_b64_tr_b16 v[50:51], v22 offset:38912
    s_waitcnt lgkmcnt(10)
    v_mfma_f32_32x32x16_bf16 v[72:87], v[28:31], v[212:215], v[72:87]
    ds_read_b64_tr_b16 v[52:53], v23 offset:36864
    ds_read_b64_tr_b16 v[54:55], v23 offset:38912
    s_waitcnt lgkmcnt(10)
    v_mfma_f32_32x32x16_bf16 v[88:103], v[32:35], v[216:219], v[88:103]
    ds_read_b64_tr_b16 v[28:29], v22 offset:37888
    ds_read_b64_tr_b16 v[30:31], v22 offset:39936
    s_waitcnt lgkmcnt(10)
    v_mfma_f32_32x32x16_bf16 v[104:119], v[36:39], v[216:219], v[104:119]
    s_nop 3
    v_cvt_pk_bf16_f32 v72, v72, v73
    v_cvt_pk_bf16_f32 v73, v74, v75
    ds_read_b64_tr_b16 v[32:33], v23 offset:37888
    ds_read_b64_tr_b16 v[34:35], v23 offset:39936
    s_waitcnt lgkmcnt(10)
    v_mfma_f32_32x32x16_bf16 v[88:103], v[40:43], v[220:223], v[88:103]
    v_cvt_pk_bf16_f32 v74, v76, v77
    v_cvt_pk_bf16_f32 v75, v78, v79
    ds_read_b64_tr_b16 v[36:37], v22 offset:40960
    ds_read_b64_tr_b16 v[38:39], v22 offset:43008
    s_waitcnt lgkmcnt(10)
    v_mfma_f32_32x32x16_bf16 v[104:119], v[44:47], v[220:223], v[104:119]
    ds_write_b128 v0, v[72:75]
    v_cvt_pk_bf16_f32 v76, v80, v81
    ds_read_b64_tr_b16 v[40:41], v23 offset:40960
    ds_read_b64_tr_b16 v[42:43], v23 offset:43008
    s_waitcnt lgkmcnt(11)
    v_mfma_f32_32x32x16_bf16 v[88:103], v[48:51], v[224:227], v[88:103]
    v_cvt_pk_bf16_f32 v77, v82, v83
    v_cvt_pk_bf16_f32 v78, v84, v85
    ds_read_b64_tr_b16 v[44:45], v22 offset:41984
    ds_read_b64_tr_b16 v[46:47], v22 offset:44032
    s_waitcnt lgkmcnt(11)
    v_mfma_f32_32x32x16_bf16 v[104:119], v[52:55], v[224:227], v[104:119]
    v_cvt_pk_bf16_f32 v79, v86, v87
    ds_write_b128 v0, v[76:79] offset:1024
    ds_read_b64_tr_b16 v[48:49], v23 offset:41984
    ds_read_b64_tr_b16 v[50:51], v23 offset:44032
    s_waitcnt lgkmcnt(12)
    v_mfma_f32_32x32x16_bf16 v[88:103], v[28:31], v[228:231], v[88:103]
    ds_read_b64_tr_b16 v[52:53], v22 offset:45056
    ds_read_b64_tr_b16 v[54:55], v22 offset:47104
    s_waitcnt lgkmcnt(12)
    v_mfma_f32_32x32x16_bf16 v[104:119], v[32:35], v[228:231], v[104:119]
    ds_read_b64_tr_b16 v[28:29], v23 offset:45056
    ds_read_b64_tr_b16 v[30:31], v23 offset:47104
    s_waitcnt lgkmcnt(6)
    s_barrier
    v_mfma_f32_32x32x16_bf16 v[88:103], v[36:39], v[232:235], v[88:103]
    s_lshl_b32 s96, s77, 11
    s_add_u32 s14, s96, 32768
    v_and_b32 v0, 7, v1
    ds_read_b64_tr_b16 v[32:33], v22 offset:46080
    ds_read_b64_tr_b16 v[34:35], v22 offset:48128
    v_mfma_f32_32x32x16_bf16 v[104:119], v[40:43], v[232:235], v[104:119]
    v_lshl_add_u32 v0, v0, 4, s14
    ds_read_b64_tr_b16 v[36:37], v23 offset:46080
    ds_read_b64_tr_b16 v[38:39], v23 offset:48128
    v_mfma_f32_32x32x16_bf16 v[88:103], v[44:47], v[236:239], v[88:103]
    v_bfe_u32 v4, v1, 3, 2
    ds_read_b64_tr_b16 v[40:41], v22
    ds_read_b64_tr_b16 v[42:43], v22 offset:2048
    s_waitcnt lgkmcnt(10)
    v_mfma_f32_32x32x16_bf16 v[104:119], v[48:51], v[236:239], v[104:119]
    v_lshl_add_u32 v0, v4, 8, v0
    v_lshrrev_b32 v4, 5, v1
    ds_read_b64_tr_b16 v[44:45], v23
    ds_read_b64_tr_b16 v[46:47], v23 offset:2048
    s_waitcnt lgkmcnt(10)
    v_mfma_f32_32x32x16_bf16 v[88:103], v[52:55], v[240:243], v[88:103]
    v_lshl_add_u32 v0, v4, 7, v0
    ds_read_b64_tr_b16 v[48:49], v22 offset:1024
    ds_read_b64_tr_b16 v[50:51], v22 offset:3072
    s_waitcnt lgkmcnt(10)
    v_mfma_f32_32x32x16_bf16 v[104:119], v[28:31], v[240:243], v[104:119]
    ds_read_b64_tr_b16 v[52:53], v23 offset:1024
    ds_read_b64_tr_b16 v[54:55], v23 offset:3072
    s_waitcnt lgkmcnt(10)
    v_mfma_f32_32x32x16_bf16 v[88:103], v[32:35], v[244:247], v[88:103]
    ds_read_b64_tr_b16 v[28:29], v22 offset:4096
    ds_read_b64_tr_b16 v[30:31], v22 offset:6144
    s_waitcnt lgkmcnt(10)
    v_mfma_f32_32x32x16_bf16 v[104:119], v[36:39], v[244:247], v[104:119]
    ds_read_b64_tr_b16 v[32:33], v23 offset:4096
    ds_read_b64_tr_b16 v[34:35], v23 offset:6144
    s_waitcnt lgkmcnt(10)
    v_mfma_f32_32x32x16_bf16 v[88:103], v[40:43], v[152:155], v[88:103]
    ds_read_b64_tr_b16 v[36:37], v22 offset:5120
    ds_read_b64_tr_b16 v[38:39], v22 offset:7168
    s_waitcnt lgkmcnt(10)
    v_mfma_f32_32x32x16_bf16 v[104:119], v[44:47], v[152:155], v[104:119]
    ds_read_b64_tr_b16 v[40:41], v23 offset:5120
    ds_read_b64_tr_b16 v[42:43], v23 offset:7168
    s_waitcnt lgkmcnt(10)
    v_mfma_f32_32x32x16_bf16 v[88:103], v[48:51], v[156:159], v[88:103]
    ds_read_b64_tr_b16 v[44:45], v22 offset:8192
    ds_read_b64_tr_b16 v[46:47], v22 offset:10240
    s_waitcnt lgkmcnt(10)
    v_mfma_f32_32x32x16_bf16 v[104:119], v[52:55], v[156:159], v[104:119]
    ds_read_b64_tr_b16 v[48:49], v23 offset:8192
    ds_read_b64_tr_b16 v[50:51], v23 offset:10240
    s_waitcnt lgkmcnt(10)
    v_mfma_f32_32x32x16_bf16 v[88:103], v[28:31], v[160:163], v[88:103]
    ds_read_b64_tr_b16 v[52:53], v22 offset:9216
    ds_read_b64_tr_b16 v[54:55], v22 offset:11264
    s_waitcnt lgkmcnt(10)
    v_mfma_f32_32x32x16_bf16 v[104:119], v[32:35], v[160:163], v[104:119]
    ds_read_b64_tr_b16 v[28:29], v23 offset:9216
    ds_read_b64_tr_b16 v[30:31], v23 offset:11264
    s_waitcnt lgkmcnt(10)
    v_mfma_f32_32x32x16_bf16 v[88:103], v[36:39], v[164:167], v[88:103]
    ds_read_b64_tr_b16 v[32:33], v22 offset:12288
    ds_read_b64_tr_b16 v[34:35], v22 offset:14336
    s_waitcnt lgkmcnt(10)
    v_mfma_f32_32x32x16_bf16 v[104:119], v[40:43], v[164:167], v[104:119]
    ds_read_b64_tr_b16 v[36:37], v23 offset:12288
    ds_read_b64_tr_b16 v[38:39], v23 offset:14336
    s_waitcnt lgkmcnt(10)
    v_mfma_f32_32x32x16_bf16 v[88:103], v[44:47], v[168:171], v[88:103]
    ds_read_b64_tr_b16 v[40:41], v22 offset:13312
    ds_read_b64_tr_b16 v[42:43], v22 offset:15360
    s_waitcnt lgkmcnt(10)
    v_mfma_f32_32x32x16_bf16 v[104:119], v[48:51], v[168:171], v[104:119]
    ds_read_b64_tr_b16 v[44:45], v23 offset:13312
    ds_read_b64_tr_b16 v[46:47], v23 offset:15360
    s_waitcnt lgkmcnt(10)
    v_mfma_f32_32x32x16_bf16 v[88:103], v[52:55], v[172:175], v[88:103]
    ds_read_b64_tr_b16 v[48:49], v22 offset:16384
    ds_read_b64_tr_b16 v[50:51], v22 offset:18432
    s_waitcnt lgkmcnt(10)
    v_mfma_f32_32x32x16_bf16 v[104:119], v[28:31], v[172:175], v[104:119]
    ds_read_b64_tr_b16 v[52:53], v23 offset:16384
    ds_read_b64_tr_b16 v[54:55], v23 offset:18432
    s_waitcnt lgkmcnt(10)
    v_mfma_f32_32x32x16_bf16 v[88:103], v[32:35], v[176:179], v[88:103]
    ds_read_b64_tr_b16 v[28:29], v22 offset:17408
    ds_read_b64_tr_b16 v[30:31], v22 offset:19456
    s_waitcnt lgkmcnt(10)
    v_mfma_f32_32x32x16_bf16 v[104:119], v[36:39], v[176:179], v[104:119]
    ds_read_b64_tr_b16 v[32:33], v23 offset:17408
    ds_read_b64_tr_b16 v[34:35], v23 offset:19456
    s_waitcnt lgkmcnt(10)
    v_mfma_f32_32x32x16_bf16 v[88:103], v[40:43], v[180:183], v[88:103]
    ds_read_b64_tr_b16 v[36:37], v22 offset:20480
    ds_read_b64_tr_b16 v[38:39], v22 offset:22528
    s_waitcnt lgkmcnt(10)
    v_mfma_f32_32x32x16_bf16 v[104:119], v[44:47], v[180:183], v[104:119]
    ds_read_b64_tr_b16 v[40:41], v23 offset:20480
    ds_read_b64_tr_b16 v[42:43], v23 offset:22528
    s_waitcnt lgkmcnt(10)
    v_mfma_f32_32x32x16_bf16 v[88:103], v[48:51], v[184:187], v[88:103]
    ds_read_b64_tr_b16 v[44:45], v22 offset:21504
    ds_read_b64_tr_b16 v[46:47], v22 offset:23552
    s_waitcnt lgkmcnt(10)
    v_mfma_f32_32x32x16_bf16 v[104:119], v[52:55], v[184:187], v[104:119]
    ds_read_b64_tr_b16 v[48:49], v23 offset:21504
    ds_read_b64_tr_b16 v[50:51], v23 offset:23552
    s_waitcnt lgkmcnt(10)
    v_mfma_f32_32x32x16_bf16 v[88:103], v[28:31], v[188:191], v[88:103]
    ds_read_b64_tr_b16 v[52:53], v22 offset:24576
    ds_read_b64_tr_b16 v[54:55], v22 offset:26624
    s_waitcnt lgkmcnt(10)
    v_mfma_f32_32x32x16_bf16 v[104:119], v[32:35], v[188:191], v[104:119]
    ds_read_b64_tr_b16 v[28:29], v23 offset:24576
    ds_read_b64_tr_b16 v[30:31], v23 offset:26624
    s_waitcnt lgkmcnt(10)
    v_mfma_f32_32x32x16_bf16 v[88:103], v[36:39], v[192:195], v[88:103]
    ds_read_b64_tr_b16 v[32:33], v22 offset:25600
    ds_read_b64_tr_b16 v[34:35], v22 offset:27648
    s_waitcnt lgkmcnt(10)
    v_mfma_f32_32x32x16_bf16 v[104:119], v[40:43], v[192:195], v[104:119]
    ds_read_b64_tr_b16 v[36:37], v23 offset:25600
    ds_read_b64_tr_b16 v[38:39], v23 offset:27648
    s_waitcnt lgkmcnt(10)
    v_mfma_f32_32x32x16_bf16 v[88:103], v[44:47], v[196:199], v[88:103]
    ds_read_b64_tr_b16 v[40:41], v22 offset:28672
    ds_read_b64_tr_b16 v[42:43], v22 offset:30720
    s_waitcnt lgkmcnt(10)
    v_mfma_f32_32x32x16_bf16 v[104:119], v[48:51], v[196:199], v[104:119]
    ds_read_b64_tr_b16 v[44:45], v23 offset:28672
    ds_read_b64_tr_b16 v[46:47], v23 offset:30720
    s_waitcnt lgkmcnt(10)
    v_mfma_f32_32x32x16_bf16 v[88:103], v[52:55], v[200:203], v[88:103]
    ds_read_b64_tr_b16 v[48:49], v22 offset:29696
    ds_read_b64_tr_b16 v[50:51], v22 offset:31744
    s_waitcnt lgkmcnt(10)
    v_mfma_f32_32x32x16_bf16 v[104:119], v[28:31], v[200:203], v[104:119]
    ds_read_b64_tr_b16 v[52:53], v23 offset:29696
    ds_read_b64_tr_b16 v[54:55], v23 offset:31744
    s_waitcnt lgkmcnt(10)
    v_mfma_f32_32x32x16_bf16 v[88:103], v[32:35], v[204:207], v[88:103]
    ds_read_b64_tr_b16 v[28:29], v24 offset:32768
    ds_read_b64_tr_b16 v[30:31], v24 offset:34816
    s_waitcnt lgkmcnt(10)
    v_mfma_f32_32x32x16_bf16 v[104:119], v[36:39], v[204:207], v[104:119]
    ds_read_b64_tr_b16 v[32:33], v25 offset:32768
    ds_read_b64_tr_b16 v[34:35], v25 offset:34816
    s_waitcnt lgkmcnt(10)
    v_mfma_f32_32x32x16_bf16 v[88:103], v[40:43], v[208:211], v[88:103]
    ds_read_b64_tr_b16 v[36:37], v24 offset:33792
    ds_read_b64_tr_b16 v[38:39], v24 offset:35840
    s_waitcnt lgkmcnt(10)
    v_mfma_f32_32x32x16_bf16 v[104:119], v[44:47], v[208:211], v[104:119]
    ds_read_b64_tr_b16 v[40:41], v25 offset:33792
    ds_read_b64_tr_b16 v[42:43], v25 offset:35840
    s_waitcnt lgkmcnt(10)
    v_mfma_f32_32x32x16_bf16 v[88:103], v[48:51], v[212:215], v[88:103]
    ds_read_b64_tr_b16 v[44:45], v24 offset:36864
    ds_read_b64_tr_b16 v[46:47], v24 offset:38912
    s_waitcnt lgkmcnt(10)
    v_mfma_f32_32x32x16_bf16 v[104:119], v[52:55], v[212:215], v[104:119]
    ds_read_b64_tr_b16 v[48:49], v25 offset:36864
    ds_read_b64_tr_b16 v[50:51], v25 offset:38912
    s_barrier
    s_waitcnt lgkmcnt(10)
    v_mfma_f32_32x32x16_bf16 v[120:135], v[28:31], v[216:219], v[120:135]
    ds_read_b64_tr_b16 v[52:53], v24 offset:37888
    ds_read_b64_tr_b16 v[54:55], v24 offset:39936
L_PAD4:
    s_cbranch_execz L_RET4
    s_waitcnt lgkmcnt(10)
    v_mfma_f32_32x32x16_bf16 v[136:151], v[32:35], v[216:219], v[136:151]
    ds_read_b64_tr_b16 v[28:29], v25 offset:37888
    ds_read_b64_tr_b16 v[30:31], v25 offset:39936
    s_waitcnt lgkmcnt(10)
    v_mfma_f32_32x32x16_bf16 v[120:135], v[36:39], v[220:223], v[120:135]
    v_cvt_pk_bf16_f32 v88, v88, v89
    ds_read_b64_tr_b16 v[32:33], v24 offset:40960
    ds_read_b64_tr_b16 v[34:35], v24 offset:43008
    s_waitcnt lgkmcnt(10)
    v_mfma_f32_32x32x16_bf16 v[136:151], v[40:43], v[220:223], v[136:151]
    v_cvt_pk_bf16_f32 v89, v90, v91
    ds_read_b64_tr_b16 v[36:37], v25 offset:40960
    ds_read_b64_tr_b16 v[38:39], v25 offset:43008
    s_waitcnt lgkmcnt(10)
    v_mfma_f32_32x32x16_bf16 v[120:135], v[44:47], v[224:227], v[120:135]
    v_cvt_pk_bf16_f32 v90, v92, v93
    ds_read_b64_tr_b16 v[40:41], v24 offset:41984
    ds_read_b64_tr_b16 v[42:43], v24 offset:44032
    s_waitcnt lgkmcnt(10)
    v_mfma_f32_32x32x16_bf16 v[136:151], v[48:51], v[224:227], v[136:151]
    v_cvt_pk_bf16_f32 v91, v94, v95
    ds_read_b64_tr_b16 v[44:45], v25 offset:41984
    ds_read_b64_tr_b16 v[46:47], v25 offset:44032
    s_waitcnt lgkmcnt(10)
    v_mfma_f32_32x32x16_bf16 v[120:135], v[52:55], v[228:231], v[120:135]
    ds_write_b128 v0, v[88:91]
    ds_read_b64_tr_b16 v[48:49], v24 offset:45056
    ds_read_b64_tr_b16 v[50:51], v24 offset:47104
    s_waitcnt lgkmcnt(11)
    v_mfma_f32_32x32x16_bf16 v[136:151], v[28:31], v[228:231], v[136:151]
    v_cvt_pk_bf16_f32 v92, v96, v97
    ds_read_b64_tr_b16 v[52:53], v25 offset:45056
    ds_read_b64_tr_b16 v[54:55], v25 offset:47104
    s_waitcnt lgkmcnt(11)
    v_mfma_f32_32x32x16_bf16 v[120:135], v[32:35], v[232:235], v[120:135]
    v_cvt_pk_bf16_f32 v93, v98, v99
    ds_read_b64_tr_b16 v[28:29], v24 offset:46080
    ds_read_b64_tr_b16 v[30:31], v24 offset:48128
    s_waitcnt lgkmcnt(11)
    v_mfma_f32_32x32x16_bf16 v[136:151], v[36:39], v[232:235], v[136:151]
    v_cvt_pk_bf16_f32 v94, v100, v101
    ds_read_b64_tr_b16 v[32:33], v25 offset:46080
    ds_read_b64_tr_b16 v[34:35], v25 offset:48128
    s_waitcnt lgkmcnt(11)
    v_mfma_f32_32x32x16_bf16 v[120:135], v[40:43], v[236:239], v[120:135]
    v_cvt_pk_bf16_f32 v95, v102, v103
    ds_read_b64_tr_b16 v[36:37], v24
    ds_read_b64_tr_b16 v[38:39], v24 offset:2048
    s_waitcnt lgkmcnt(11)
    v_mfma_f32_32x32x16_bf16 v[136:151], v[44:47], v[236:239], v[136:151]
    ds_write_b128 v0, v[92:95] offset:1024
    ds_read_b64_tr_b16 v[40:41], v25
    ds_read_b64_tr_b16 v[42:43], v25 offset:2048
    s_waitcnt lgkmcnt(11)
    v_mfma_f32_32x32x16_bf16 v[120:135], v[48:51], v[240:243], v[120:135]
    v_cvt_pk_bf16_f32 v104, v104, v105
    ds_read_b64_tr_b16 v[44:45], v24 offset:1024
    ds_read_b64_tr_b16 v[46:47], v24 offset:3072
    s_waitcnt lgkmcnt(11)
    v_mfma_f32_32x32x16_bf16 v[136:151], v[52:55], v[240:243], v[136:151]
    v_cvt_pk_bf16_f32 v105, v106, v107
    ds_read_b64_tr_b16 v[48:49], v25 offset:1024
    ds_read_b64_tr_b16 v[50:51], v25 offset:3072
    s_waitcnt lgkmcnt(11)
    v_mfma_f32_32x32x16_bf16 v[120:135], v[28:31], v[244:247], v[120:135]
    v_cvt_pk_bf16_f32 v106, v108, v109
    ds_read_b64_tr_b16 v[52:53], v24 offset:4096
    ds_read_b64_tr_b16 v[54:55], v24 offset:6144
    s_waitcnt lgkmcnt(11)
    v_mfma_f32_32x32x16_bf16 v[136:151], v[32:35], v[244:247], v[136:151]
    v_cvt_pk_bf16_f32 v107, v110, v111
    ds_read_b64_tr_b16 v[28:29], v25 offset:4096
    ds_read_b64_tr_b16 v[30:31], v25 offset:6144
    s_waitcnt lgkmcnt(11)
    v_mfma_f32_32x32x16_bf16 v[120:135], v[36:39], v[152:155], v[120:135]
    ds_write_b128 v0, v[104:107] offset:8192
    ds_read_b64_tr_b16 v[32:33], v24 offset:5120
    ds_read_b64_tr_b16 v[34:35], v24 offset:7168
    s_waitcnt lgkmcnt(11)
    v_mfma_f32_32x32x16_bf16 v[136:151], v[40:43], v[152:155], v[136:151]
    v_cvt_pk_bf16_f32 v108, v112, v113
    ds_read_b64_tr_b16 v[36:37], v25 offset:5120
    ds_read_b64_tr_b16 v[38:39], v25 offset:7168
    s_waitcnt lgkmcnt(11)
    v_mfma_f32_32x32x16_bf16 v[120:135], v[44:47], v[156:159], v[120:135]
    v_cvt_pk_bf16_f32 v109, v114, v115
    ds_read_b64_tr_b16 v[40:41], v24 offset:8192
    ds_read_b64_tr_b16 v[42:43], v24 offset:10240
    s_waitcnt lgkmcnt(11)
    v_mfma_f32_32x32x16_bf16 v[136:151], v[48:51], v[156:159], v[136:151]
    v_cvt_pk_bf16_f32 v110, v116, v117
    ds_read_b64_tr_b16 v[44:45], v25 offset:8192
    ds_read_b64_tr_b16 v[46:47], v25 offset:10240
    s_waitcnt lgkmcnt(11)
    v_mfma_f32_32x32x16_bf16 v[120:135], v[52:55], v[160:163], v[120:135]
    v_cvt_pk_bf16_f32 v111, v118, v119
    ds_read_b64_tr_b16 v[48:49], v24 offset:9216
    ds_read_b64_tr_b16 v[50:51], v24 offset:11264
    s_waitcnt lgkmcnt(11)
    v_mfma_f32_32x32x16_bf16 v[136:151], v[28:31], v[160:163], v[136:151]
    ds_write_b128 v0, v[108:111] offset:9216
    ds_read_b64_tr_b16 v[52:53], v25 offset:9216
    ds_read_b64_tr_b16 v[54:55], v25 offset:11264
    s_waitcnt lgkmcnt(11)
    v_mfma_f32_32x32x16_bf16 v[120:135], v[32:35], v[164:167], v[120:135]
    ds_read_b64_tr_b16 v[28:29], v24 offset:12288
    ds_read_b64_tr_b16 v[30:31], v24 offset:14336
    s_waitcnt lgkmcnt(11)
    v_mfma_f32_32x32x16_bf16 v[136:151], v[36:39], v[164:167], v[136:151]
    ds_read_b64_tr_b16 v[32:33], v25 offset:12288
    ds_read_b64_tr_b16 v[34:35], v25 offset:14336
    s_waitcnt lgkmcnt(11)
    v_mfma_f32_32x32x16_bf16 v[120:135], v[40:43], v[168:171], v[120:135]
    ds_read_b64_tr_b16 v[36:37], v24 offset:13312
    ds_read_b64_tr_b16 v[38:39], v24 offset:15360
    s_waitcnt lgkmcnt(11)
    v_mfma_f32_32x32x16_bf16 v[136:151], v[44:47], v[168:171], v[136:151]
    ds_read_b64_tr_b16 v[40:41], v25 offset:13312
    ds_read_b64_tr_b16 v[42:43], v25 offset:15360
    s_waitcnt lgkmcnt(11)
    v_mfma_f32_32x32x16_bf16 v[120:135], v[48:51], v[172:175], v[120:135]
    ds_read_b64_tr_b16 v[44:45], v24 offset:16384
    ds_read_b64_tr_b16 v[46:47], v24 offset:18432
    s_waitcnt lgkmcnt(10)
    v_mfma_f32_32x32x16_bf16 v[136:151], v[52:55], v[172:175], v[136:151]
    ds_read_b64_tr_b16 v[48:49], v25 offset:16384
    ds_read_b64_tr_b16 v[50:51], v25 offset:18432
    s_waitcnt lgkmcnt(10)
    v_mfma_f32_32x32x16_bf16 v[120:135], v[28:31], v[176:179], v[120:135]
    ds_read_b64_tr_b16 v[52:53], v24 offset:17408
    ds_read_b64_tr_b16 v[54:55], v24 offset:19456
    s_waitcnt lgkmcnt(10)
    v_mfma_f32_32x32x16_bf16 v[136:151], v[32:35], v[176:179], v[136:151]
    ds_read_b64_tr_b16 v[28:29], v25 offset:17408
    ds_read_b64_tr_b16 v[30:31], v25 offset:19456
    s_waitcnt lgkmcnt(10)
    v_mfma_f32_32x32x16_bf16 v[120:135], v[36:39], v[180:183], v[120:135]
    ds_read_b64_tr_b16 v[32:33], v24 offset:20480
    ds_read_b64_tr_b16 v[34:35], v24 offset:22528
    s_waitcnt lgkmcnt(10)
    v_mfma_f32_32x32x16_bf16 v[136:151], v[40:43], v[180:183], v[136:151]
    ds_read_b64_tr_b16 v[36:37], v25 offset:20480
    ds_read_b64_tr_b16 v[38:39], v25 offset:22528
    s_waitcnt lgkmcnt(10)
    v_mfma_f32_32x32x16_bf16 v[120:135], v[44:47], v[184:187], v[120:135]
    ds_read_b64_tr_b16 v[40:41], v24 offset:21504
    ds_read_b64_tr_b16 v[42:43], v24 offset:23552
    s_waitcnt lgkmcnt(10)
    v_mfma_f32_32x32x16_bf16 v[136:151], v[48:51], v[184:187], v[136:151]
    ds_read_b64_tr_b16 v[44:45], v25 offset:21504
    ds_read_b64_tr_b16 v[46:47], v25 offset:23552
    s_waitcnt lgkmcnt(10)
    v_mfma_f32_32x32x16_bf16 v[120:135], v[52:55], v[188:191], v[120:135]
    ds_read_b64_tr_b16 v[48:49], v24 offset:24576
    ds_read_b64_tr_b16 v[50:51], v24 offset:26624
    s_waitcnt lgkmcnt(10)
    v_mfma_f32_32x32x16_bf16 v[136:151], v[28:31], v[188:191], v[136:151]
    ds_read_b64_tr_b16 v[52:53], v25 offset:24576
    ds_read_b64_tr_b16 v[54:55], v25 offset:26624
    s_waitcnt lgkmcnt(10)
    v_mfma_f32_32x32x16_bf16 v[120:135], v[32:35], v[192:195], v[120:135]
    ds_read_b64_tr_b16 v[28:29], v24 offset:25600
    ds_read_b64_tr_b16 v[30:31], v24 offset:27648
    s_waitcnt lgkmcnt(10)
    v_mfma_f32_32x32x16_bf16 v[136:151], v[36:39], v[192:195], v[136:151]
    ds_read_b64_tr_b16 v[32:33], v25 offset:25600
    ds_read_b64_tr_b16 v[34:35], v25 offset:27648
    s_waitcnt lgkmcnt(10)
    v_mfma_f32_32x32x16_bf16 v[120:135], v[40:43], v[196:199], v[120:135]
    ds_read_b64_tr_b16 v[36:37], v24 offset:28672
    ds_read_b64_tr_b16 v[38:39], v24 offset:30720
    s_waitcnt lgkmcnt(10)
    v_mfma_f32_32x32x16_bf16 v[136:151], v[44:47], v[196:199], v[136:151]
    ds_read_b64_tr_b16 v[40:41], v25 offset:28672
    ds_read_b64_tr_b16 v[42:43], v25 offset:30720
    s_waitcnt lgkmcnt(10)
    v_mfma_f32_32x32x16_bf16 v[120:135], v[48:51], v[200:203], v[120:135]
    ds_read_b64_tr_b16 v[44:45], v25 offset:29696
    ds_read_b64_tr_b16 v[46:47], v25 offset:31744
    s_waitcnt lgkmcnt(10)
    v_mfma_f32_32x32x16_bf16 v[136:151], v[52:55], v[200:203], v[136:151]
    ds_read_b64_tr_b16 v[48:49], v24 offset:29696
    ds_read_b64_tr_b16 v[50:51], v24 offset:31744
    s_waitcnt lgkmcnt(10)
    v_mfma_f32_32x32x16_bf16 v[120:135], v[28:31], v[204:207], v[120:135]
    s_waitcnt lgkmcnt(8)
    v_mfma_f32_32x32x16_bf16 v[136:151], v[32:35], v[204:207], v[136:151]
    s_waitcnt lgkmcnt(6)
    v_mfma_f32_32x32x16_bf16 v[120:135], v[36:39], v[208:211], v[120:135]
    s_waitcnt lgkmcnt(4)
    v_mfma_f32_32x32x16_bf16 v[136:151], v[40:43], v[208:211], v[136:151]
    s_waitcnt lgkmcnt(2)
    v_mfma_f32_32x32x16_bf16 v[136:151], v[44:47], v[212:215], v[136:151]
    s_waitcnt lgkmcnt(0)
    v_mfma_f32_32x32x16_bf16 v[120:135], v[48:51], v[212:215], v[120:135]
    s_lshl_b32 s96, s77, 11
    s_add_u32 s14, s96, 151552
    v_add_u32 v0, s14, v2
    v_bfe_u32 v4, v1, 2, 2
    v_lshlrev_b32 v4, 6, v4
    v_bfe_u32 v9, v1, 4, 1
    v_lshl_add_u32 v4, v9, 5, v4
    v_and_b32 v9, 3, v1
    v_lshl_add_u32 v4, v9, 3, v4
    v_lshrrev_b32 v9, 5, v1
    v_lshl_add_u32 v4, v9, 8, v4
    v_add_u32 v4, 159744, v4
    ds_read_b64_tr_b16 v[176:177], v4
    ds_read_b64_tr_b16 v[178:179], v4 offset:512
    ds_read_b64_tr_b16 v[180:181], v4 offset:1024
    ds_read_b64_tr_b16 v[182:183], v4 offset:1536
    v_cvt_pk_bf16_f32 v152, v136, v137
    v_cvt_pk_bf16_f32 v153, v138, v139
    v_cvt_pk_bf16_f32 v154, v140, v141
    v_cvt_pk_bf16_f32 v155, v142, v143
    v_cvt_pk_bf16_f32 v156, v144, v145
    v_cvt_pk_bf16_f32 v157, v146, v147
    v_cvt_pk_bf16_f32 v158, v148, v149
    v_cvt_pk_bf16_f32 v159, v150, v151
    ds_write_b128 v0, v[152:155]
    ds_write_b128 v0, v[156:159] offset:1024
    v_cvt_pk_bf16_f32 v168, v120, v121
    v_cvt_pk_bf16_f32 v169, v122, v123
    v_cvt_pk_bf16_f32 v170, v124, v125
    v_cvt_pk_bf16_f32 v171, v126, v127
    v_cvt_pk_bf16_f32 v172, v128, v129
    v_cvt_pk_bf16_f32 v173, v130, v131
    v_cvt_pk_bf16_f32 v174, v132, v133
    v_cvt_pk_bf16_f32 v175, v134, v135
    s_setprio 0
    s_branch L_JOIN
L_HELP:
    s_waitcnt vmcnt(3)
    s_barrier
    s_add_u32 s96, s84, 5
    s_and_b32 s97, s96, 15
    s_mul_i32 s98, s97, 393216
    s_add_u32 s99, s98, s85
    s_add_u32 s82, s99, 4294772736
    s_add_u32 m0, s83, 36864
    s_nop 0
    buffer_load_dwordx4 v3, s[40:43], s82 offen lds
    s_add_u32 s96, s84, 5
    s_and_b32 s97, s96, 15
    s_mul_i32 s98, s97, 393216
    s_add_u32 s99, s98, s85
    s_add_u32 s82, s99, 2048
    s_add_u32 m0, s83, 40960
    s_nop 0
    buffer_load_dwordx4 v3, s[40:43], s82 offen lds
    s_add_u32 s96, s84, 5
    s_and_b32 s97, s96, 15
    s_mul_i32 s98, s97, 393216
    s_add_u32 s99, s98, s85
    s_add_u32 s82, s99, 4294774784
    s_add_u32 m0, s83, 86016
    s_nop 0
    buffer_load_dwordx4 v3, s[40:43], s82 offen lds
    s_add_u32 s96, s84, 5
    s_and_b32 s97, s96, 15
    s_mul_i32 s98, s97, 393216
    s_add_u32 s99, s98, s85
    s_add_u32 s82, s99, 4096
    s_add_u32 m0, s83, 90112
    s_nop 0
    buffer_load_dwordx4 v3, s[40:43], s82 offen lds
    s_add_u32 s96, s84, 5
    s_and_b32 s97, s96, 15
    s_mul_i32 s98, s97, 393216
    s_add_u32 s99, s98, s85
    s_add_u32 s82, s99, 4294770688
    s_add_u32 m0, s83, 135168
    s_nop 0
    buffer_load_dwordx4 v3, s[40:43], s82 offen lds
    s_add_u32 s96, s84, 5
    s_and_b32 s97, s96, 15
    s_mul_i32 s98, s97, 393216
    s_add_u32 s82, s98, s85
    s_add_u32 m0, s83, 139264
    s_nop 0
    buffer_load_dwordx4 v3, s[40:43], s82 offen lds
    v_bfe_u32 v4, v1, 2, 2
    v_lshlrev_b32 v4, 6, v4
    v_bfe_u32 v9, v1, 4, 1
    v_lshl_add_u32 v4, v9, 5, v4
    v_and_b32 v9, 3, v1
    v_lshl_add_u32 v4, v9, 3, v4
    v_lshrrev_b32 v9, 5, v1
    v_lshl_add_u32 v4, v9, 8, v4
    v_add_u32 v4, 159744, v4
    ds_read_b64_tr_b16 v[168:169], v4
    ds_read_b64_tr_b16 v[170:171], v4 offset:512
    ds_read_b64_tr_b16 v[172:173], v4 offset:1024
    ds_read_b64_tr_b16 v[174:175], v4 offset:1536
    ds_read_b64_tr_b16 v[176:177], v4 offset:2048
    ds_read_b64_tr_b16 v[178:179], v4 offset:2560
    ds_read_b64_tr_b16 v[180:181], v4 offset:3072
    ds_read_b64_tr_b16 v[182:183], v4 offset:3584
    s_lshl_b32 s14, s77, 10
    v_and_b32 v232, 7, v1
    v_lshl_add_u32 v232, v232, 4, s14
    v_bfe_u32 v9, v1, 3, 2
    v_lshl_add_u32 v232, v9, 8, v232
    v_lshrrev_b32 v9, 5, v1
    v_lshl_add_u32 v232, v9, 7, v232
    s_and_b32 s96, s9, 1
    s_lshl1_add_u32 s18, s96, 1
    s_and_b32 s96, s8, 3
    s_lshl2_add_u32 s97, s96, s3
    s_sub_u32 s98, s97, 4
    s_lshl_b32 s82, s98, 7
    v_lshrrev_b32 v52, 3, v1
    v_lshl_add_u32 v52, v52, 1, s82
    global_load_ushort v36, v52, s[86:87] offset:0
    global_load_ushort v37, v52, s[86:87] offset:16
    global_load_ushort v38, v52, s[86:87] offset:32
    global_load_ushort v39, v52, s[86:87] offset:48
    global_load_ushort v40, v52, s[86:87] offset:64
    global_load_ushort v41, v52, s[86:87] offset:80
    global_load_ushort v42, v52, s[86:87] offset:96
    global_load_ushort v43, v52, s[86:87] offset:112
    s_and_b32 s96, s8, 3
    s_lshl2_add_u32 s97, s96, s3
    s_sub_u32 s98, s97, 4
    s_mul_i32 s99, s98, 786432
    s_lshr_b32 s96, s8, 2
    s_lshl1_add_u32 s97, s9, s96
    s_lshl_b32 s98, s97, 7
    s_add_u32 s96, s99, s98
    s_add_u32 s19, s96, 4096
    s_barrier
    s_add_u32 s96, s84, 6
    s_and_b32 s97, s96, 15
    s_mul_i32 s98, s97, 393216
    s_add_u32 s99, s98, s85
    s_add_u32 s82, s99, 4294772736
    s_add_u32 m0, s83, 4294963200
    s_nop 0
    buffer_load_dwordx4 v3, s[40:43], s82 offen lds
    s_add_u32 s96, s84, 6
    s_and_b32 s97, s96, 15
    s_mul_i32 s98, s97, 393216
    s_add_u32 s99, s98, s85
    s_add_u32 s82, s99, 2048
    s_mov_b32 m0, s83
    s_nop 0
    buffer_load_dwordx4 v3, s[40:43], s82 offen lds
    s_add_u32 s96, s84, 6
    s_and_b32 s97, s96, 15
    s_mul_i32 s98, s97, 393216
    s_add_u32 s99, s98, s85
    s_add_u32 s82, s99, 4294770688
    s_add_u32 m0, s83, 94208
    s_nop 0
    buffer_load_dwordx4 v3, s[40:43], s82 offen lds
    s_add_u32 s96, s84, 6
    s_and_b32 s97, s96, 15
    s_mul_i32 s98, s97, 393216
    s_add_u32 s82, s98, s85
    s_add_u32 m0, s83, 98304
    s_nop 0
    buffer_load_dwordx4 v3, s[40:43], s82 offen lds
    s_add_u32 s96, s84, 6
    s_and_b32 s97, s96, 15
    s_mul_i32 s98, s97, 393216
    s_add_u32 s99, s98, s85
    s_add_u32 s82, s99, 4294774784
    s_add_u32 m0, s83, 45056
    s_nop 0
    buffer_load_dwordx4 v3, s[40:43], s82 offen lds
    s_add_u32 s96, s84, 6
    s_and_b32 s97, s96, 15
    s_mul_i32 s98, s97, 393216
    s_add_u32 s99, s98, s85
    s_add_u32 s82, s99, 4096
    s_add_u32 m0, s83, 49152
    s_nop 0
    buffer_load_dwordx4 v3, s[40:43], s82 offen lds
    s_waitcnt lgkmcnt(0)
    s_load_dword s24, s[32:33], s92 offset:512 glc
    s_load_dword s25, s[32:33], s92 offset:256 glc
    s_load_dword s26, s[32:33], s92 offset:3584 glc
    s_load_dword s27, s[32:33], s92 offset:3328 glc
    s_barrier
    s_add_u32 s96, s84, 7
    s_and_b32 s97, s96, 15
    s_mul_i32 s98, s97, 393216
    s_add_u32 s99, s98, s85
    s_add_u32 s82, s99, 4294772736
    s_add_u32 m0, s83, 4096
    s_nop 0
    buffer_load_dwordx4 v3, s[40:43], s82 offen lds
    s_add_u32 s96, s84, 7
    s_and_b32 s97, s96, 15
    s_mul_i32 s98, s97, 393216
    s_add_u32 s99, s98, s85
    s_add_u32 s82, s99, 2048
    s_add_u32 m0, s83, 8192
    s_nop 0
    buffer_load_dwordx4 v3, s[40:43], s82 offen lds
    s_add_u32 s96, s84, 7
    s_and_b32 s97, s96, 15
    s_mul_i32 s98, s97, 393216
    s_add_u32 s99, s98, s85
    s_add_u32 s82, s99, 4294770688
    s_add_u32 m0, s83, 102400
    s_nop 0
    buffer_load_dwordx4 v3, s[40:43], s82 offen lds
    s_add_u32 s96, s84, 7
    s_and_b32 s97, s96, 15
    s_mul_i32 s98, s97, 393216
    s_add_u32 s82, s98, s85
    s_add_u32 m0, s83, 106496
    s_nop 0
    buffer_load_dwordx4 v3, s[40:43], s82 offen lds
    s_add_u32 s96, s84, 7
    s_and_b32 s97, s96, 15
    s_mul_i32 s98, s97, 393216
    s_add_u32 s99, s98, s85
    s_add_u32 s82, s99, 4294774784
    s_add_u32 m0, s83, 53248
    s_nop 0
    buffer_load_dwordx4 v3, s[40:43], s82 offen lds
    s_add_u32 s96, s84, 7
    s_and_b32 s97, s96, 15
    s_mul_i32 s98, s97, 393216
    s_add_u32 s99, s98, s85
    s_add_u32 s82, s99, 4096
    s_add_u32 m0, s83, 57344
    s_nop 0
    buffer_load_dwordx4 v3, s[40:43], s82 offen lds
    s_waitcnt vmcnt(26)
    s_barrier
    s_add_u32 s96, s84, 8
    s_and_b32 s97, s96, 15
    s_mul_i32 s98, s97, 393216
    s_add_u32 s99, s98, s85
    s_add_u32 s82, s99, 4294772736
    s_add_u32 m0, s83, 12288
    s_nop 0
    buffer_load_dwordx4 v3, s[40:43], s82 offen lds
    s_add_u32 s96, s84, 8
    s_and_b32 s97, s96, 15
    s_mul_i32 s98, s97, 393216
    s_add_u32 s99, s98, s85
    s_add_u32 s82, s99, 2048
    s_add_u32 m0, s83, 16384
    s_nop 0
    buffer_load_dwordx4 v3, s[40:43], s82 offen lds
    s_add_u32 s96, s84, 8
    s_and_b32 s97, s96, 15
    s_mul_i32 s98, s97, 393216
    s_add_u32 s99, s98, s85
    s_add_u32 s82, s99, 4294770688
    s_add_u32 m0, s83, 110592
    s_nop 0
    buffer_load_dwordx4 v3, s[40:43], s82 offen lds
    s_add_u32 s96, s84, 8
    s_and_b32 s97, s96, 15
    s_mul_i32 s98, s97, 393216
    s_add_u32 s82, s98, s85
    s_add_u32 m0, s83, 114688
    s_nop 0
    buffer_load_dwordx4 v3, s[40:43], s82 offen lds
    s_add_u32 s96, s84, 8
    s_and_b32 s97, s96, 15
    s_mul_i32 s98, s97, 393216
    s_add_u32 s99, s98, s85
    s_add_u32 s82, s99, 4294774784
    s_add_u32 m0, s83, 61440
    s_nop 0
    buffer_load_dwordx4 v3, s[40:43], s82 offen lds
    s_add_u32 s96, s84, 8
    s_and_b32 s97, s96, 15
    s_mul_i32 s98, s97, 393216
    s_add_u32 s99, s98, s85
    s_add_u32 s82, s99, 4096
    s_add_u32 m0, s83, 65536
    s_nop 0
    buffer_load_dwordx4 v3, s[40:43], s82 offen lds
    s_waitcnt vmcnt(18)
    v_lshlrev_b32 v36, 16, v36
    v_mul_f32 v52, s7, v36
    v_exp_f32 v52, -v52
    s_nop 0
    v_add_f32 v52, 1.0, v52
    v_rcp_f32 v52, v52
    s_nop 0
    v_mul_f32 v36, v36, v52
    v_cvt_pk_bf16_f32 v36, 0, v36
    v_lshlrev_b32 v37, 16, v37
    v_mul_f32 v53, s7, v37
    v_exp_f32 v53, -v53
    s_nop 0
    v_add_f32 v53, 1.0, v53
    v_rcp_f32 v53, v53
    s_nop 0
    v_mul_f32 v37, v37, v53
    v_cvt_pk_bf16_f32 v37, 0, v37
    v_lshlrev_b32 v38, 16, v38
    v_mul_f32 v52, s7, v38
    v_exp_f32 v52, -v52
    s_nop 0
    v_add_f32 v52, 1.0, v52
    v_rcp_f32 v52, v52
    s_nop 0
    v_mul_f32 v38, v38, v52
    v_cvt_pk_bf16_f32 v38, 0, v38
    v_lshlrev_b32 v39, 16, v39
    v_mul_f32 v53, s7, v39
    v_exp_f32 v53, -v53
    s_nop 0
    v_add_f32 v53, 1.0, v53
    v_rcp_f32 v53, v53
    s_nop 0
    v_mul_f32 v39, v39, v53
    v_cvt_pk_bf16_f32 v39, 0, v39
    v_lshlrev_b32 v40, 16, v40
    v_mul_f32 v52, s7, v40
    v_exp_f32 v52, -v52
    s_nop 0
    v_add_f32 v52, 1.0, v52
    v_rcp_f32 v52, v52
    s_nop 0
    v_mul_f32 v40, v40, v52
    v_cvt_pk_bf16_f32 v40, 0, v40
    v_lshlrev_b32 v41, 16, v41
    v_mul_f32 v53, s7, v41
    v_exp_f32 v53, -v53
    s_nop 0
    v_add_f32 v53, 1.0, v53
    v_rcp_f32 v53, v53
    s_nop 0
    v_mul_f32 v41, v41, v53
    v_cvt_pk_bf16_f32 v41, 0, v41
    v_lshlrev_b32 v42, 16, v42
    v_mul_f32 v52, s7, v42
    v_exp_f32 v52, -v52
    s_nop 0
    v_add_f32 v52, 1.0, v52
    v_rcp_f32 v52, v52
    s_nop 0
    v_mul_f32 v42, v42, v52
    v_cvt_pk_bf16_f32 v42, 0, v42
    v_lshlrev_b32 v43, 16, v43
    v_mul_f32 v53, s7, v43
    v_exp_f32 v53, -v53
    s_nop 0
    v_add_f32 v53, 1.0, v53
    v_rcp_f32 v53, v53
    s_nop 0
    v_mul_f32 v43, v43, v53
    v_cvt_pk_bf16_f32 v43, 0, v43
    s_waitcnt lgkmcnt(0)
    s_load_dword s24, s[32:33], s92 offset:1024 glc
    s_load_dword s25, s[32:33], s92 offset:768 glc
    s_load_dword s26, s[32:33], s92 offset:1536 glc
    s_load_dword s27, s[32:33], s92 offset:1280 glc
    s_barrier
    s_add_u32 s96, s84, 9
    s_and_b32 s97, s96, 15
    s_mul_i32 s98, s97, 393216
    s_add_u32 s99, s98, s85
    s_add_u32 s82, s99, 4294772736
    s_add_u32 m0, s83, 20480
    s_nop 0
    buffer_load_dwordx4 v3, s[40:43], s82 offen lds
    s_add_u32 s96, s84, 9
    s_and_b32 s97, s96, 15
    s_mul_i32 s98, s97, 393216
    s_add_u32 s99, s98, s85
    s_add_u32 s82, s99, 2048
    s_add_u32 m0, s83, 24576
    s_nop 0
    buffer_load_dwordx4 v3, s[40:43], s82 offen lds
    s_add_u32 s96, s84, 9
    s_and_b32 s97, s96, 15
    s_mul_i32 s98, s97, 393216
    s_add_u32 s99, s98, s85
    s_add_u32 s82, s99, 4294770688
    s_add_u32 m0, s83, 118784
    s_nop 0
    buffer_load_dwordx4 v3, s[40:43], s82 offen lds
    s_add_u32 s96, s84, 9
    s_and_b32 s97, s96, 15
    s_mul_i32 s98, s97, 393216
    s_add_u32 s82, s98, s85
    s_add_u32 m0, s83, 122880
    s_nop 0
    buffer_load_dwordx4 v3, s[40:43], s82 offen lds
    s_add_u32 s96, s84, 9
    s_and_b32 s97, s96, 15
    s_mul_i32 s98, s97, 393216
    s_add_u32 s99, s98, s85
    s_add_u32 s82, s99, 4294774784
    s_add_u32 m0, s83, 69632
    s_nop 0
    buffer_load_dwordx4 v3, s[40:43], s82 offen lds
    s_add_u32 s96, s84, 9
    s_and_b32 s97, s96, 15
    s_mul_i32 s98, s97, 393216
    s_add_u32 s99, s98, s85
    s_add_u32 s82, s99, 4096
    s_add_u32 m0, s83, 73728
    s_nop 0
    buffer_load_dwordx4 v3, s[40:43], s82 offen lds
    s_waitcnt vmcnt(22)
    s_waitcnt vmcnt(20)
    s_waitcnt vmcnt(18)
    s_barrier
    s_add_u32 s96, s84, 10
    s_and_b32 s97, s96, 15
    s_mul_i32 s98, s97, 393216
    s_add_u32 s99, s98, s85
    s_add_u32 s82, s99, 4294772736
    s_add_u32 m0, s83, 28672
    s_nop 0
    buffer_load_dwordx4 v3, s[40:43], s82 offen lds
    s_add_u32 s96, s84, 10
    s_and_b32 s97, s96, 15
    s_mul_i32 s98, s97, 393216
    s_add_u32 s99, s98, s85
    s_add_u32 s82, s99, 2048
    s_add_u32 m0, s83, 32768
    s_nop 0
    buffer_load_dwordx4 v3, s[40:43], s82 offen lds
    s_add_u32 s96, s84, 10
    s_and_b32 s97, s96, 15
    s_mul_i32 s98, s97, 393216
    s_add_u32 s99, s98, s85
    s_add_u32 s82, s99, 4294774784
    s_add_u32 m0, s83, 77824
    s_nop 0
    buffer_load_dwordx4 v3, s[40:43], s82 offen lds
    s_add_u32 s96, s84, 10
    s_and_b32 s97, s96, 15
    s_mul_i32 s98, s97, 393216
    s_add_u32 s99, s98, s85
    s_add_u32 s82, s99, 4096
    s_add_u32 m0, s83, 81920
    s_nop 0
    buffer_load_dwordx4 v3, s[40:43], s82 offen lds
    s_waitcnt lgkmcnt(0)
    s_load_dword s24, s[32:33], s92 offset:2560 glc
    s_load_dword s25, s[32:33], s92 offset:2304 glc
    s_load_dword s26, s[32:33], s92 offset:3072 glc
    s_load_dword s27, s[32:33], s92 offset:2816 glc
    s_waitcnt vmcnt(20)
    s_waitcnt vmcnt(18)
    s_waitcnt vmcnt(16)
    s_barrier
    s_add_u32 s96, s84, 11
    s_and_b32 s97, s96, 15
    s_mul_i32 s98, s97, 393216
    s_add_u32 s99, s98, s85
    s_add_u32 s82, s99, 4294772736
L_PAD5:
    s_cbranch_execz L_RET5
    s_add_u32 m0, s83, 36864
    s_nop 0
    buffer_load_dwordx4 v3, s[40:43], s82 offen lds
    s_add_u32 s96, s84, 11
    s_and_b32 s97, s96, 15
    s_mul_i32 s98, s97, 393216
    s_add_u32 s99, s98, s85
    s_add_u32 s82, s99, 2048
    s_add_u32 m0, s83, 40960
    s_nop 0
    buffer_load_dwordx4 v3, s[40:43], s82 offen lds
    s_add_u32 s96, s84, 11
    s_and_b32 s97, s96, 15
    s_mul_i32 s98, s97, 393216
    s_add_u32 s99, s98, s85
    s_add_u32 s82, s99, 4294774784
    s_add_u32 m0, s83, 86016
    s_nop 0
    buffer_load_dwordx4 v3, s[40:43], s82 offen lds
    s_add_u32 s96, s84, 11
    s_and_b32 s97, s96, 15
    s_mul_i32 s98, s97, 393216
    s_add_u32 s99, s98, s85
    s_add_u32 s82, s99, 4096
    s_add_u32 m0, s83, 90112
    s_nop 0
    buffer_load_dwordx4 v3, s[40:43], s82 offen lds
    s_waitcnt vmcnt(18)
    s_waitcnt vmcnt(16)
    s_waitcnt vmcnt(14)
    s_barrier
    s_add_u32 s96, s84, 12
    s_and_b32 s97, s96, 15
    s_mul_i32 s98, s97, 393216
    s_add_u32 s99, s98, s85
    s_add_u32 s82, s99, 4294772736
    s_add_u32 m0, s83, 4294963200
    s_nop 0
    buffer_load_dwordx4 v3, s[40:43], s82 offen lds
    s_add_u32 s96, s84, 12
    s_and_b32 s97, s96, 15
    s_mul_i32 s98, s97, 393216
    s_add_u32 s99, s98, s85
    s_add_u32 s82, s99, 2048
    s_mov_b32 m0, s83
    s_nop 0
    buffer_load_dwordx4 v3, s[40:43], s82 offen lds
    s_add_u32 s96, s84, 12
    s_and_b32 s97, s96, 15
    s_mul_i32 s98, s97, 393216
    s_add_u32 s99, s98, s85
    s_add_u32 s82, s99, 4294774784
    s_add_u32 m0, s83, 45056
    s_nop 0
    buffer_load_dwordx4 v3, s[40:43], s82 offen lds
    s_add_u32 s96, s84, 12
    s_and_b32 s97, s96, 15
    s_mul_i32 s98, s97, 393216
    s_add_u32 s99, s98, s85
    s_add_u32 s82, s99, 4096
    s_add_u32 m0, s83, 49152
    s_nop 0
    buffer_load_dwordx4 v3, s[40:43], s82 offen lds
    s_waitcnt vmcnt(16)
    s_barrier
    s_add_u32 s96, s84, 13
    s_and_b32 s97, s96, 15
    s_mul_i32 s98, s97, 393216
    s_add_u32 s99, s98, s85
    s_add_u32 s82, s99, 4294772736
    s_add_u32 m0, s83, 4096
    s_nop 0
    buffer_load_dwordx4 v3, s[40:43], s82 offen lds
    s_add_u32 s96, s84, 13
    s_and_b32 s97, s96, 15
    s_mul_i32 s98, s97, 393216
    s_add_u32 s99, s98, s85
    s_add_u32 s82, s99, 2048
    s_add_u32 m0, s83, 8192
    s_nop 0
    buffer_load_dwordx4 v3, s[40:43], s82 offen lds
    s_add_u32 s96, s84, 13
    s_and_b32 s97, s96, 15
    s_mul_i32 s98, s97, 393216
    s_add_u32 s99, s98, s85
    s_add_u32 s82, s99, 4294774784
    s_add_u32 m0, s83, 53248
    s_nop 0
    buffer_load_dwordx4 v3, s[40:43], s82 offen lds
    s_add_u32 s96, s84, 13
    s_and_b32 s97, s96, 15
    s_mul_i32 s98, s97, 393216
    s_add_u32 s99, s98, s85
    s_add_u32 s82, s99, 4096
    s_add_u32 m0, s83, 57344
    s_nop 0
    buffer_load_dwordx4 v3, s[40:43], s82 offen lds
    s_lshl_b32 s96, s74, 13
    s_sub_u32 s97, s3, 4
    s_lshl_b32 s98, s97, 8
    s_add_u32 s99, s96, s98
    s_add_u32 s13, s99, 20971520
    s_waitcnt lgkmcnt(0)
    s_load_dword s24, s[32:33], s13 offset:1276 glc
    s_load_dword s25, s[32:33], s13 offset:3324 glc
    s_load_dword s26, s[32:33], s13 offset:5372 glc
    s_load_dword s27, s[32:33], s13 offset:7420 glc
    s_waitcnt vmcnt(18)
    s_waitcnt vmcnt(16)
    s_barrier
    s_add_u32 s96, s84, 14
    s_and_b32 s97, s96, 15
    s_mul_i32 s98, s97, 393216
    s_add_u32 s99, s98, s85
    s_add_u32 s82, s99, 4294772736
    s_add_u32 m0, s83, 12288
    s_nop 0
    buffer_load_dwordx4 v3, s[40:43], s82 offen lds
    s_add_u32 s96, s84, 14
    s_and_b32 s97, s96, 15
    s_mul_i32 s98, s97, 393216
    s_add_u32 s99, s98, s85
    s_add_u32 s82, s99, 2048
    s_add_u32 m0, s83, 16384
    s_nop 0
    buffer_load_dwordx4 v3, s[40:43], s82 offen lds
    s_add_u32 s96, s84, 10
    s_and_b32 s97, s96, 15
    s_mul_i32 s98, s97, 393216
    s_add_u32 s99, s98, s85
    s_add_u32 s82, s99, 4294770688
    s_add_u32 m0, s83, 126976
    s_nop 0
    buffer_load_dwordx4 v3, s[40:43], s82 offen lds
    s_add_u32 s96, s84, 10
    s_and_b32 s97, s96, 15
    s_mul_i32 s98, s97, 393216
    s_add_u32 s82, s98, s85
    s_add_u32 m0, s83, 131072
    s_nop 0
    buffer_load_dwordx4 v3, s[40:43], s82 offen lds
    s_waitcnt vmcnt(18)
    s_waitcnt vmcnt(14)
    s_barrier
    s_add_u32 s96, s84, 15
    s_and_b32 s97, s96, 15
    s_mul_i32 s98, s97, 393216
    s_add_u32 s99, s98, s85
    s_add_u32 s82, s99, 4294772736
    s_add_u32 m0, s83, 20480
    s_nop 0
    buffer_load_dwordx4 v3, s[40:43], s82 offen lds
    s_add_u32 s96, s84, 15
    s_and_b32 s97, s96, 15
    s_mul_i32 s98, s97, 393216
    s_add_u32 s99, s98, s85
    s_add_u32 s82, s99, 2048
    s_add_u32 m0, s83, 24576
    s_nop 0
    buffer_load_dwordx4 v3, s[40:43], s82 offen lds
    s_add_u32 s96, s84, 11
    s_and_b32 s97, s96, 15
    s_mul_i32 s98, s97, 393216
    s_add_u32 s99, s98, s85
    s_add_u32 s82, s99, 4294770688
    s_add_u32 m0, s83, 135168
    s_nop 0
    buffer_load_dwordx4 v3, s[40:43], s82 offen lds
    s_add_u32 s96, s84, 11
    s_and_b32 s97, s96, 15
    s_mul_i32 s98, s97, 393216
    s_add_u32 s82, s98, s85
    s_add_u32 m0, s83, 139264
    s_nop 0
    buffer_load_dwordx4 v3, s[40:43], s82 offen lds
    s_waitcnt vmcnt(14)
    s_waitcnt vmcnt(10)
    s_waitcnt vmcnt(6)
    s_barrier
    s_add_u32 s96, s84, 14
    s_and_b32 s97, s96, 15
    s_mul_i32 s98, s97, 393216
    s_add_u32 s99, s98, s85
    s_add_u32 s82, s99, 4294774784
    s_add_u32 m0, s83, 61440
    s_nop 0
    buffer_load_dwordx4 v3, s[40:43], s82 offen lds
    s_add_u32 s96, s84, 14
    s_and_b32 s97, s96, 15
    s_mul_i32 s98, s97, 393216
    s_add_u32 s99, s98, s85
    s_add_u32 s82, s99, 4096
    s_add_u32 m0, s83, 65536
    s_nop 0
    buffer_load_dwordx4 v3, s[40:43], s82 offen lds
    s_add_u32 s96, s84, 15
    s_and_b32 s97, s96, 15
    s_mul_i32 s98, s97, 393216
    s_add_u32 s99, s98, s85
    s_add_u32 s82, s99, 4294774784
    s_add_u32 m0, s83, 69632
    s_nop 0
    buffer_load_dwordx4 v3, s[40:43], s82 offen lds
    s_add_u32 s96, s84, 15
    s_and_b32 s97, s96, 15
    s_mul_i32 s98, s97, 393216
    s_add_u32 s99, s98, s85
    s_add_u32 s82, s99, 4096
    s_add_u32 m0, s83, 73728
    s_nop 0
    buffer_load_dwordx4 v3, s[40:43], s82 offen lds
    s_add_u32 s96, s84, 12
    s_and_b32 s97, s96, 15
    s_mul_i32 s98, s97, 393216
    s_add_u32 s99, s98, s85
    s_add_u32 s82, s99, 4294770688
    s_add_u32 m0, s83, 94208
    s_nop 0
    buffer_load_dwordx4 v3, s[40:43], s82 offen lds
    s_add_u32 s96, s84, 12
    s_and_b32 s97, s96, 15
    s_mul_i32 s98, s97, 393216
    s_add_u32 s82, s98, s85
    s_add_u32 m0, s83, 98304
    s_nop 0
    buffer_load_dwordx4 v3, s[40:43], s82 offen lds
    s_waitcnt vmcnt(8)
    s_barrier
    s_add_u32 s96, s84, 13
    s_and_b32 s97, s96, 15
    s_mul_i32 s98, s97, 393216
    s_add_u32 s99, s98, s85
    s_add_u32 s82, s99, 4294770688
    s_add_u32 m0, s83, 102400
    s_nop 0
    buffer_load_dwordx4 v3, s[40:43], s82 offen lds
    s_add_u32 s96, s84, 13
    s_and_b32 s97, s96, 15
    s_mul_i32 s98, s97, 393216
    s_add_u32 s82, s98, s85
    s_add_u32 m0, s83, 106496
    s_nop 0
    buffer_load_dwordx4 v3, s[40:43], s82 offen lds
    s_add_u32 s96, s84, 14
    s_and_b32 s97, s96, 15
    s_mul_i32 s98, s97, 393216
    s_add_u32 s99, s98, s85
    s_add_u32 s82, s99, 4294770688
    s_add_u32 m0, s83, 110592
    s_nop 0
    buffer_load_dwordx4 v3, s[40:43], s82 offen lds
    s_add_u32 s96, s84, 14
    s_and_b32 s97, s96, 15
    s_mul_i32 s98, s97, 393216
    s_add_u32 s82, s98, s85
    s_add_u32 m0, s83, 114688
    s_nop 0
    buffer_load_dwordx4 v3, s[40:43], s82 offen lds
    s_add_u32 s96, s84, 15
    s_and_b32 s97, s96, 15
    s_mul_i32 s98, s97, 393216
    s_add_u32 s99, s98, s85
    s_add_u32 s82, s99, 4294770688
    s_add_u32 m0, s83, 118784
    s_nop 0
    buffer_load_dwordx4 v3, s[40:43], s82 offen lds
    s_add_u32 s96, s84, 15
    s_and_b32 s97, s96, 15
    s_mul_i32 s98, s97, 393216
    s_add_u32 s82, s98, s85
    s_add_u32 m0, s83, 122880
    s_nop 0
    buffer_load_dwordx4 v3, s[40:43], s82 offen lds
    s_waitcnt lgkmcnt(0)
    s_barrier
    s_setprio 3
    ds_read_b128 v[152:155], v0
    ds_read_b128 v[156:159], v0 offset:1024
    v_subrev_u32 v0, 118784, v0
    s_waitcnt lgkmcnt(1)
    v_mfma_f32_32x32x16_bf16 v[184:199], v[168:171], v[152:155], 0
    s_waitcnt lgkmcnt(0)
    v_mfma_f32_32x32x16_bf16 v[184:199], v[172:175], v[156:159], v[184:199]
    s_setprio 0
    s_nop 10
    v_cvt_pk_bf16_f32 v184, 0, v184
    v_cvt_pk_bf16_f32 v185, 0, v185
    v_cvt_pk_bf16_f32 v186, 0, v186
    s_mov_b32 s82, s19
    buffer_load_dwordx4 v[88:91], v248, s[48:51], s82 offen nt
    v_cvt_pk_bf16_f32 v187, 0, v187
    v_cvt_pk_bf16_f32 v188, 0, v188
    v_cvt_pk_bf16_f32 v189, 0, v189
    v_cvt_pk_bf16_f32 v190, 0, v190
    v_cvt_pk_bf16_f32 v191, 0, v191
    v_cvt_pk_bf16_f32 v192, 0, v192
    v_cvt_pk_bf16_f32 v193, 0, v193
    v_cvt_pk_bf16_f32 v194, 0, v194
    v_cvt_pk_bf16_f32 v195, 0, v195
    v_cvt_pk_bf16_f32 v196, 0, v196
    s_add_u32 s82, s19, 98304
    buffer_load_dwordx4 v[92:95], v248, s[48:51], s82 offen nt
    v_cvt_pk_bf16_f32 v197, 0, v197
    v_cvt_pk_bf16_f32 v198, 0, v198
    v_cvt_pk_bf16_f32 v199, 0, v199
    v_max3_f32 v4, v184, v185, v186
    v_min3_f32 v5, v184, v185, v186
    v_max3_f32 v4, v4, v187, v188
    v_min3_f32 v5, v5, v187, v188
    v_max3_f32 v4, v4, v189, v190
    v_min3_f32 v5, v5, v189, v190
    v_max3_f32 v4, v4, v191, v192
    s_add_u32 s82, s19, 196608
    buffer_load_dwordx4 v[96:99], v248, s[48:51], s82 offen nt
    v_min3_f32 v5, v5, v191, v192
    v_max3_f32 v4, v4, v193, v194
    v_min3_f32 v5, v5, v193, v194
    v_max3_f32 v4, v4, v195, v196
    v_min3_f32 v5, v5, v195, v196
    v_max3_f32 v4, v4, v197, v198
    v_min3_f32 v5, v5, v197, v198
    v_max_f32 v6, v4, v199
    v_min_f32 v7, v5, v199
    v_max_f32 v4, v4, v199
    s_add_u32 s82, s19, 294912
    buffer_load_dwordx4 v[100:103], v248, s[48:51], s82 offen nt
    v_min_f32 v5, v5, v199
    v_permlane32_swap_b32 v4, v6
    s_nop 0
    v_permlane32_swap_b32 v5, v7
    v_max_f32 v4, v4, v6
    v_min_f32 v5, v5, v7
    v_mul_f32_e64 v4, v4, s7
    v_mul_f32_e64 v5, v5, s7
    v_fma_f32 v216, v184, s7, -v4
    v_fma_f32 v217, v185, s7, -v4
    v_fma_f32 v184, -v184, s7, v5
    s_add_u32 s82, s19, 393216
    buffer_load_dwordx4 v[104:107], v248, s[48:51], s82 offen nt
    v_fma_f32 v185, -v185, s7, v5
    v_fma_f32 v218, v186, s7, -v4
    v_fma_f32 v219, v187, s7, -v4
    v_fma_f32 v186, -v186, s7, v5
    v_fma_f32 v187, -v187, s7, v5
    s_waitcnt vmcnt(15)
    s_waitcnt vmcnt(13)
    s_barrier
    s_setprio 3
    ds_read_b128 v[152:155], v0
    ds_read_b128 v[156:159], v0 offset:1024
    s_waitcnt lgkmcnt(1)
    v_mfma_f32_32x32x16_bf16 v[200:215], v[176:179], v[152:155], 0
    s_waitcnt lgkmcnt(0)
    v_mfma_f32_32x32x16_bf16 v[200:215], v[180:183], v[156:159], v[200:215]
    s_setprio 0
    v_fma_f32 v220, v188, s7, -v4
    v_fma_f32 v221, v189, s7, -v4
    v_fma_f32 v188, -v188, s7, v5
    v_fma_f32 v189, -v189, s7, v5
    v_fma_f32 v222, v190, s7, -v4
    s_add_u32 s82, s19, 491520
    buffer_load_dwordx4 v[108:111], v248, s[48:51], s82 offen nt
    v_fma_f32 v223, v191, s7, -v4
    s_mov_b32 s82, s80
    buffer_load_dwordx4 v[56:59], v27, s[52:55], s82 offen nt
    v_fma_f32 v190, -v190, s7, v5
    v_fma_f32 v191, -v191, s7, v5
    v_fma_f32 v224, v192, s7, -v4
    v_fma_f32 v225, v193, s7, -v4
    v_fma_f32 v192, -v192, s7, v5
    v_fma_f32 v193, -v193, s7, v5
    v_fma_f32 v226, v194, s7, -v4
    v_fma_f32 v227, v195, s7, -v4
    v_fma_f32 v194, -v194, s7, v5
    s_add_u32 s82, s19, 589824
    buffer_load_dwordx4 v[112:115], v248, s[48:51], s82 offen nt
    v_fma_f32 v195, -v195, s7, v5
    v_fma_f32 v228, v196, s7, -v4
    v_fma_f32 v229, v197, s7, -v4
    v_fma_f32 v196, -v196, s7, v5
    v_fma_f32 v197, -v197, s7, v5
    v_fma_f32 v230, v198, s7, -v4
    v_fma_f32 v231, v199, s7, -v4
    v_fma_f32 v198, -v198, s7, v5
    v_fma_f32 v199, -v199, s7, v5
    v_exp_f32 v216, v216
    s_add_u32 s82, s19, 688128
    buffer_load_dwordx4 v[116:119], v248, s[48:51], s82 offen nt
    v_exp_f32 v184, v184
    s_add_u32 s82, s80, 4294049792
    buffer_load_dwordx4 v[60:63], v27, s[52:55], s82 offen nt
    v_exp_f32 v217, v217
    v_exp_f32 v185, v185
    v_exp_f32 v218, v218
    v_exp_f32 v186, v186
    v_exp_f32 v219, v219
    v_exp_f32 v187, v187
    v_exp_f32 v220, v220
    v_exp_f32 v188, v188
    v_exp_f32 v221, v221
    v_exp_f32 v189, v189
    v_exp_f32 v222, v222
    v_exp_f32 v190, v190
    v_exp_f32 v223, v223
    v_exp_f32 v191, v191
    v_exp_f32 v224, v224
    v_exp_f32 v192, v192
    v_exp_f32 v225, v225
    v_exp_f32 v193, v193
    v_exp_f32 v226, v226
    s_add_u32 s82, s80, 57344
    buffer_load_dwordx4 v[64:67], v27, s[52:55], s82 offen nt
    v_exp_f32 v194, v194
    v_exp_f32 v227, v227
    v_exp_f32 v195, v195
    v_exp_f32 v228, v228
    v_exp_f32 v196, v196
    v_exp_f32 v229, v229
    v_exp_f32 v197, v197
    v_exp_f32 v230, v230
    v_exp_f32 v198, v198
    v_exp_f32 v231, v231
    v_exp_f32 v199, v199
    v_add_f32 v8, v216, v218
    v_add_f32 v9, v217, v219
    v_add_f32 v10, v184, v186
    v_add_f32 v11, v185, v187
    v_add_f32 v8, v8, v220
    v_add_f32 v9, v9, v221
    v_add_f32 v10, v10, v188
    v_add_f32 v11, v11, v189
    v_add_f32 v8, v8, v222
    s_add_u32 s82, s80, 4294107136
    buffer_load_dwordx4 v[68:71], v27, s[52:55], s82 offen nt
    v_add_f32 v9, v9, v223
    v_add_f32 v10, v10, v190
    v_add_f32 v11, v11, v191
    v_add_f32 v8, v8, v224
    v_add_f32 v9, v9, v225
    v_add_f32 v10, v10, v192
    v_add_f32 v11, v11, v193
    v_add_f32 v8, v8, v226
    v_add_f32 v9, v9, v227
    v_add_f32 v10, v10, v194
    v_add_f32 v11, v11, v195
    v_add_f32 v8, v8, v228
    v_add_f32 v9, v9, v229
    v_add_f32 v10, v10, v196
    v_add_f32 v11, v11, v197
    v_add_f32 v8, v8, v230
    v_add_f32 v9, v9, v231
    v_add_f32 v10, v10, v198
    v_add_f32 v11, v11, v199
    v_add_f32 v6, v8, v9
    v_add_f32 v7, v10, v11
    v_add_f32 v4, v8, v9
    v_add_f32 v5, v10, v11
    s_nop 0
    v_permlane32_swap_b32 v4, v6
    v_permlane32_swap_b32 v5, v7
    v_add_f32 v4, v4, v6
    v_add_f32 v5, v5, v7
    v_rcp_f32 v4, v4
    v_rcp_f32 v5, v5
    v_mul_f32 v216, v216, v4
    v_mul_f32 v217, v217, v4
    v_mul_f32 v184, v184, v5
    v_mul_f32 v185, v185, v5
    v_mul_f32 v218, v218, v4
    v_mul_f32 v219, v219, v4
    v_mul_f32 v186, v186, v5
    v_mul_f32 v187, v187, v5
    v_mul_f32 v220, v220, v4
    v_mul_f32 v221, v221, v4
    v_mul_f32 v188, v188, v5
    v_mul_f32 v189, v189, v5
    v_mul_f32 v222, v222, v4
    v_mul_f32 v223, v223, v4
    v_mul_f32 v190, v190, v5
    v_mul_f32 v191, v191, v5
    v_mul_f32 v224, v224, v4
    v_mul_f32 v225, v225, v4
    v_mul_f32 v192, v192, v5
    v_mul_f32 v193, v193, v5
    v_mul_f32 v226, v226, v4
    v_mul_f32 v227, v227, v4
    v_mul_f32 v194, v194, v5
    v_mul_f32 v195, v195, v5
    v_mul_f32 v228, v228, v4
    v_mul_f32 v229, v229, v4
    v_mul_f32 v196, v196, v5
    v_mul_f32 v197, v197, v5
    v_mul_f32 v230, v230, v4
    v_mul_f32 v231, v231, v4
    v_mul_f32 v198, v198, v5
    v_mul_f32 v199, v199, v5
    v_cvt_pk_bf16_f32 v216, v216, v217
    v_cvt_pk_bf16_f32 v217, v218, v219
    v_cvt_pk_bf16_f32 v218, v220, v221
    v_cvt_pk_bf16_f32 v219, v222, v223
    v_cvt_pk_bf16_f32 v220, v224, v225
    v_cvt_pk_bf16_f32 v221, v226, v227
    v_cvt_pk_bf16_f32 v222, v228, v229
    v_cvt_pk_bf16_f32 v223, v230, v231
    ds_write_b128 v232, v[216:219]
    v_cvt_pk_bf16_f32 v224, v184, v185
    v_cvt_pk_bf16_f32 v225, v186, v187
    v_cvt_pk_bf16_f32 v226, v188, v189
    v_cvt_pk_bf16_f32 v227, v190, v191
    ds_write_b128 v232, v[220:223] offset:4096
    ds_write_b128 v232, v[224:227] offset:8192
    v_cvt_pk_bf16_f32 v228, v192, v193
    v_cvt_pk_bf16_f32 v229, v194, v195
    v_cvt_pk_bf16_f32 v230, v196, v197
    v_cvt_pk_bf16_f32 v231, v198, v199
    ds_write_b128 v232, v[228:231] offset:12288
    s_waitcnt vmcnt(18)
    s_waitcnt vmcnt(16)
    s_waitcnt vmcnt(14)
    s_waitcnt vmcnt(12)
    s_barrier
    v_cvt_pk_bf16_f32 v200, 0, v200
    v_cvt_pk_bf16_f32 v201, 0, v201
    v_cvt_pk_bf16_f32 v202, 0, v202
    v_cvt_pk_bf16_f32 v203, 0, v203
    s_xor_b32 s96, s95, 786432
    s_add_u32 s97, s96, s90
    s_sub_u32 s82, s97, 65536
    s_add_u32 m0, s83, 45056
    s_nop 0
    buffer_load_dwordx4 v26, s[44:47], s82 offen lds
    v_cvt_pk_bf16_f32 v204, 0, v204
    v_cvt_pk_bf16_f32 v205, 0, v205
    v_cvt_pk_bf16_f32 v206, 0, v206
    v_cvt_pk_bf16_f32 v207, 0, v207
    v_cvt_pk_bf16_f32 v208, 0, v208
    v_cvt_pk_bf16_f32 v209, 0, v209
    v_cvt_pk_bf16_f32 v210, 0, v210
    v_cvt_pk_bf16_f32 v211, 0, v211
    v_cvt_pk_bf16_f32 v212, 0, v212
    v_cvt_pk_bf16_f32 v213, 0, v213
    v_cvt_pk_bf16_f32 v214, 0, v214
    v_cvt_pk_bf16_f32 v215, 0, v215
    v_max3_f32 v4, v200, v201, v202
    v_min3_f32 v5, v200, v201, v202
    s_xor_b32 s96, s95, 786432
    s_add_u32 s82, s96, s90
    s_add_u32 m0, s83, 49152
    s_nop 0
    buffer_load_dwordx4 v26, s[44:47], s82 offen lds
    v_max3_f32 v4, v4, v203, v204
    v_min3_f32 v5, v5, v203, v204
    v_max3_f32 v4, v4, v205, v206
    v_min3_f32 v5, v5, v205, v206
    v_max3_f32 v4, v4, v207, v208
    v_min3_f32 v5, v5, v207, v208
    v_max3_f32 v4, v4, v209, v210
    v_min3_f32 v5, v5, v209, v210
    v_max3_f32 v4, v4, v211, v212
    v_min3_f32 v5, v5, v211, v212
    v_max3_f32 v4, v4, v213, v214
    v_min3_f32 v5, v5, v213, v214
    v_max_f32 v6, v4, v215
    v_min_f32 v7, v5, v215
    s_xor_b32 s96, s95, 917504
    s_add_u32 s97, s96, s90
    s_sub_u32 s82, s97, 65536
    s_add_u32 m0, s83, 53248
    s_nop 0
    buffer_load_dwordx4 v26, s[44:47], s82 offen lds
    v_max_f32 v4, v4, v215
    s_waitcnt lgkmcnt(0)
    v_min_f32 v5, v5, v215
    v_permlane32_swap_b32 v4, v6
    s_nop 0
    v_permlane32_swap_b32 v5, v7
    v_max_f32 v4, v4, v6
    v_min_f32 v5, v5, v7
    v_mul_f32_e64 v4, v4, s7
    v_mul_f32_e64 v5, v5, s7
    v_fma_f32 v216, v200, s7, -v4
    v_fma_f32 v217, v201, s7, -v4
    v_fma_f32 v200, -v200, s7, v5
    v_fma_f32 v201, -v201, s7, v5
    v_fma_f32 v218, v202, s7, -v4
    s_xor_b32 s96, s95, 917504
    s_add_u32 s82, s96, s90
    s_add_u32 m0, s83, 57344
    s_nop 0
    buffer_load_dwordx4 v26, s[44:47], s82 offen lds
    v_fma_f32 v219, v203, s7, -v4
    v_fma_f32 v202, -v202, s7, v5
    v_fma_f32 v203, -v203, s7, v5
    v_fma_f32 v220, v204, s7, -v4
    v_fma_f32 v221, v205, s7, -v4
    v_fma_f32 v204, -v204, s7, v5
    v_fma_f32 v205, -v205, s7, v5
    v_fma_f32 v222, v206, s7, -v4
    v_fma_f32 v223, v207, s7, -v4
    v_fma_f32 v206, -v206, s7, v5
    v_fma_f32 v207, -v207, s7, v5
    v_fma_f32 v224, v208, s7, -v4
    v_fma_f32 v225, v209, s7, -v4
    v_fma_f32 v208, -v208, s7, v5
    s_xor_b32 s96, s95, 1048576
    s_add_u32 s97, s96, s90
    s_sub_u32 s82, s97, 65536
    s_add_u32 m0, s83, 61440
    s_nop 0
    buffer_load_dwordx4 v26, s[44:47], s82 offen lds
    v_fma_f32 v209, -v209, s7, v5
    v_fma_f32 v226, v210, s7, -v4
    v_fma_f32 v227, v211, s7, -v4
    v_fma_f32 v210, -v210, s7, v5
    v_fma_f32 v211, -v211, s7, v5
    v_fma_f32 v228, v212, s7, -v4
    v_fma_f32 v229, v213, s7, -v4
    v_fma_f32 v212, -v212, s7, v5
    v_fma_f32 v213, -v213, s7, v5
    v_fma_f32 v230, v214, s7, -v4
    v_fma_f32 v231, v215, s7, -v4
    v_fma_f32 v214, -v214, s7, v5
    v_fma_f32 v215, -v215, s7, v5
    v_exp_f32 v216, v216
    s_xor_b32 s96, s95, 1048576
    s_add_u32 s82, s96, s90
    s_add_u32 m0, s83, 65536
    s_nop 0
    buffer_load_dwordx4 v26, s[44:47], s82 offen lds
    v_exp_f32 v200, v200
    v_exp_f32 v217, v217
    v_exp_f32 v201, v201
    v_exp_f32 v218, v218
    v_exp_f32 v202, v202
    v_exp_f32 v219, v219
    v_exp_f32 v203, v203
    v_exp_f32 v220, v220
    v_exp_f32 v204, v204
    v_exp_f32 v221, v221
    v_exp_f32 v205, v205
    v_exp_f32 v222, v222
    v_exp_f32 v206, v206
    v_exp_f32 v223, v223
    s_xor_b32 s96, s95, 1179648
    s_add_u32 s97, s96, s90
    s_sub_u32 s82, s97, 65536
    s_add_u32 m0, s83, 69632
    s_nop 0
    buffer_load_dwordx4 v26, s[44:47], s82 offen lds
    v_exp_f32 v207, v207
    v_exp_f32 v224, v224
    v_exp_f32 v208, v208
    v_exp_f32 v225, v225
    v_exp_f32 v209, v209
    v_exp_f32 v226, v226
    v_exp_f32 v210, v210
    v_exp_f32 v227, v227
    v_exp_f32 v211, v211
    v_exp_f32 v228, v228
    v_exp_f32 v212, v212
    v_exp_f32 v229, v229
    v_exp_f32 v213, v213
    v_exp_f32 v230, v230
    s_xor_b32 s96, s95, 1179648
    s_add_u32 s82, s96, s90
    s_add_u32 m0, s83, 73728
    s_nop 0
    buffer_load_dwordx4 v26, s[44:47], s82 offen lds
    v_exp_f32 v214, v214
    v_exp_f32 v231, v231
    v_exp_f32 v215, v215
    v_add_f32 v8, v216, v218
    v_add_f32 v9, v217, v219
    v_add_f32 v10, v200, v202
    v_add_f32 v11, v201, v203
    v_add_f32 v8, v8, v220
    v_add_f32 v9, v9, v221
    v_add_f32 v10, v10, v204
    v_add_f32 v11, v11, v205
    v_add_f32 v8, v8, v222
    v_add_f32 v9, v9, v223
    v_add_f32 v10, v10, v206
    s_xor_b32 s96, s95, 1310720
    s_add_u32 s97, s96, s90
    s_sub_u32 s82, s97, 65536
    s_add_u32 m0, s83, 77824
    s_nop 0
    buffer_load_dwordx4 v26, s[44:47], s82 offen lds
L_PAD6:
    s_cbranch_execz L_RET6
    v_add_f32 v11, v11, v207
    v_add_f32 v8, v8, v224
    v_add_f32 v9, v9, v225
    v_add_f32 v10, v10, v208
    v_add_f32 v11, v11, v209
    v_add_f32 v8, v8, v226
    v_add_f32 v9, v9, v227
    v_add_f32 v10, v10, v210
    v_add_f32 v11, v11, v211
    v_add_f32 v8, v8, v228
    v_add_f32 v9, v9, v229
    v_add_f32 v10, v10, v212
    v_add_f32 v11, v11, v213
    v_add_f32 v8, v8, v230
    s_xor_b32 s96, s95, 1310720
    s_add_u32 s82, s96, s90
    s_add_u32 m0, s83, 81920
    s_nop 0
    buffer_load_dwordx4 v26, s[44:47], s82 offen lds
    v_add_f32 v9, v9, v231
    v_add_f32 v10, v10, v214
    v_add_f32 v11, v11, v215
    v_add_f32 v6, v8, v9
    v_add_f32 v7, v10, v11
    v_add_f32 v4, v8, v9
    v_add_f32 v5, v10, v11
    s_nop 0
    v_permlane32_swap_b32 v4, v6
    v_permlane32_swap_b32 v5, v7
    v_add_f32 v4, v4, v6
    v_add_f32 v5, v5, v7
    v_rcp_f32 v4, v4
    v_rcp_f32 v5, v5
    v_mul_f32 v216, v216, v4
    s_xor_b32 s96, s95, 1441792
    s_add_u32 s97, s96, s90
    s_sub_u32 s82, s97, 65536
    s_add_u32 m0, s83, 86016
    s_nop 0
    buffer_load_dwordx4 v26, s[44:47], s82 offen lds
    v_mul_f32 v217, v217, v4
    v_mul_f32 v200, v200, v5
    v_mul_f32 v201, v201, v5
    v_mul_f32 v218, v218, v4
    v_mul_f32 v219, v219, v4
    v_mul_f32 v202, v202, v5
    v_mul_f32 v203, v203, v5
    v_mul_f32 v220, v220, v4
    v_mul_f32 v221, v221, v4
    v_mul_f32 v204, v204, v5
    v_mul_f32 v205, v205, v5
    v_mul_f32 v222, v222, v4
    v_mul_f32 v223, v223, v4
    v_mul_f32 v206, v206, v5
    s_xor_b32 s96, s95, 1441792
    s_add_u32 s82, s96, s90
    s_add_u32 m0, s83, 90112
    s_nop 0
    buffer_load_dwordx4 v26, s[44:47], s82 offen lds
    v_mul_f32 v207, v207, v5
    v_mul_f32 v224, v224, v4
    v_mul_f32 v225, v225, v4
    v_mul_f32 v208, v208, v5
    v_mul_f32 v209, v209, v5
    v_mul_f32 v226, v226, v4
    v_mul_f32 v227, v227, v4
    v_mul_f32 v210, v210, v5
    v_mul_f32 v211, v211, v5
    v_mul_f32 v228, v228, v4
    v_mul_f32 v229, v229, v4
    v_mul_f32 v212, v212, v5
    v_mul_f32 v213, v213, v5
    v_mul_f32 v230, v230, v4
    v_mul_f32 v231, v231, v4
    v_mul_f32 v214, v214, v5
    v_mul_f32 v215, v215, v5
    v_cvt_pk_bf16_f32 v216, v216, v217
    v_cvt_pk_bf16_f32 v217, v218, v219
    v_cvt_pk_bf16_f32 v218, v220, v221
    v_cvt_pk_bf16_f32 v219, v222, v223
    v_cvt_pk_bf16_f32 v220, v224, v225
    v_cvt_pk_bf16_f32 v221, v226, v227
    v_cvt_pk_bf16_f32 v222, v228, v229
    v_cvt_pk_bf16_f32 v223, v230, v231
    ds_write_b128 v232, v[216:219] offset:16384
    v_cvt_pk_bf16_f32 v224, v200, v201
    v_cvt_pk_bf16_f32 v225, v202, v203
    v_cvt_pk_bf16_f32 v226, v204, v205
    v_cvt_pk_bf16_f32 v227, v206, v207
    ds_write_b128 v232, v[220:223] offset:20480
    ds_write_b128 v232, v[224:227] offset:24576
    v_cvt_pk_bf16_f32 v228, v208, v209
    v_cvt_pk_bf16_f32 v229, v210, v211
    v_cvt_pk_bf16_f32 v230, v212, v213
    v_cvt_pk_bf16_f32 v231, v214, v215
    ds_write_b128 v232, v[228:231] offset:28672
    s_lshl_b32 s96, s77, 11
    s_add_u32 s14, s96, 151552
    v_add_u32 v0, s14, v2
    s_setprio 0
L_JOIN:
    v_and_b32 v45, 1, v1
    v_lshlrev_b32 v45, 3, v45
    v_bfe_u32 v9, v1, 2, 2
    v_lshl_add_u32 v45, v9, 4, v45
    v_bfe_u32 v9, v1, 4, 1
    v_lshl_add_u32 v45, v9, 6, v45
    v_bfe_u32 v9, v1, 1, 1
    v_lshl_add_u32 v45, v9, 7, v45
    v_lshrrev_b32 v9, 5, v1
    v_lshl_add_u32 v45, v9, 8, v45
    s_lshl_b32 s13, s3, 12
    v_add_u32 v44, s13, v45
    s_lshl_b32 s96, s76, 13
    s_add_u32 s13, s96, 32768
    v_add_u32 v45, s13, v45
    v_mov_b32 v244, 0x3f803f80
    v_mov_b32 v245, 0x3f803f80
    v_mov_b32 v246, 0x3f803f80
    v_mov_b32 v247, 0x3f803f80
    s_lshl3_add_u32 s96, s11, s3
    s_lshl_b32 s97, s96, 5
    s_add_u32 s98, s97, s10
    s_lshl_b32 s99, s98, 10
    s_add_u32 s13, s99, 25165824
    s_add_u32 s15, s13, 16384
    s_lshl3_add_u32 s96, s11, s3
    s_lshl_b32 s97, s96, 10
    s_add_u32 s16, s97, 21495808
    s_lshl_b32 s96, s10, 6
    s_add_u32 s14, s96, s16
    s_waitcnt lgkmcnt(0)
    s_barrier
    ds_read_b64_tr_b16 v[184:185], v44
    ds_read_b64_tr_b16 v[186:187], v44 offset:512
    ds_read_b64_tr_b16 v[200:201], v45
    ds_read_b64_tr_b16 v[202:203], v45 offset:512
    ds_read_b64_tr_b16 v[204:205], v45 offset:1024
    ds_read_b64_tr_b16 v[206:207], v45 offset:1536
    ds_read_b64_tr_b16 v[188:189], v44 offset:1024
    ds_read_b64_tr_b16 v[190:191], v44 offset:1536
    ds_read_b64_tr_b16 v[208:209], v45 offset:2048
    ds_read_b64_tr_b16 v[210:211], v45 offset:2560
    ds_read_b64_tr_b16 v[212:213], v45 offset:3072
    ds_read_b64_tr_b16 v[214:215], v45 offset:3584
    ds_read_b64_tr_b16 v[192:193], v44 offset:2048
    ds_read_b64_tr_b16 v[194:195], v44 offset:2560
    ds_read_b64_tr_b16 v[216:217], v45 offset:4096
    ds_read_b64_tr_b16 v[218:219], v45 offset:4608
    ds_read_b64_tr_b16 v[220:221], v45 offset:5120
    ds_read_b64_tr_b16 v[222:223], v45 offset:5632
    s_waitcnt lgkmcnt(12)
    v_mfma_f32_16x16x32_bf16 v[232:235], v[184:187], v[200:203], 0
    v_mfma_f32_16x16x32_bf16 v[236:239], v[184:187], v[204:207], 0
    v_mfma_f32_16x16x32_bf16 v[240:243], v[184:187], v[244:247], 0
    ds_read_b64_tr_b16 v[196:197], v44 offset:3072
    ds_read_b64_tr_b16 v[198:199], v44 offset:3584
    ds_read_b64_tr_b16 v[224:225], v45 offset:6144
    ds_read_b64_tr_b16 v[226:227], v45 offset:6656
    ds_read_b64_tr_b16 v[228:229], v45 offset:7168
    ds_read_b64_tr_b16 v[230:231], v45 offset:7680
    s_waitcnt lgkmcnt(12)
    v_mfma_f32_16x16x32_bf16 v[232:235], v[188:191], v[208:211], v[232:235]
    v_mfma_f32_16x16x32_bf16 v[236:239], v[188:191], v[212:215], v[236:239]
    v_mfma_f32_16x16x32_bf16 v[240:243], v[188:191], v[244:247], v[240:243]
    s_waitcnt lgkmcnt(6)
    v_mfma_f32_16x16x32_bf16 v[232:235], v[192:195], v[216:219], v[232:235]
    v_mfma_f32_16x16x32_bf16 v[236:239], v[192:195], v[220:223], v[236:239]
    v_mfma_f32_16x16x32_bf16 v[240:243], v[192:195], v[244:247], v[240:243]
    s_waitcnt lgkmcnt(0)
    v_mfma_f32_16x16x32_bf16 v[232:235], v[196:199], v[224:227], v[232:235]
    v_mfma_f32_16x16x32_bf16 v[236:239], v[196:199], v[228:231], v[236:239]
    v_mfma_f32_16x16x32_bf16 v[240:243], v[196:199], v[244:247], v[240:243]
    s_cmp_lt_u32 s3, 4
    s_cbranch_scc1 L_NOQX
    ds_read_b128 v[168:171], v0
    ds_read_b128 v[172:175], v0 offset:1024
L_NOQX:
    s_nop 3
    buffer_store_dwordx4 v[232:235], v2, s[32:35], s13 offen sc1
    buffer_store_dwordx4 v[236:239], v2, s[32:35], s15 offen sc1
    s_mov_b32 exec_lo, 0x00010001
    s_mov_b32 exec_hi, 0x00010001
    buffer_store_dwordx4 v[240:243], v1, s[32:35], s14 offen sc1
    s_mov_b64 exec, -1
    s_waitcnt lgkmcnt(0)
    v_mfma_f32_32x32x16_bf16 v[120:135], v[176:179], v[168:171], 0
    v_mfma_f32_32x32x16_bf16 v[120:135], v[180:183], v[172:175], v[120:135]
    v_and_b32 v46, 7, v1
    v_lshlrev_b32 v46, 17, v46
    v_bfe_u32 v9, v1, 3, 1
    v_lshl_add_u32 v46, v9, 14, v46
    s_and_b32 s96, s10, 1
    s_and_b32 s97, s2, 27
    s_lshl_b32 s98, s97, 12
    s_lshr_b32 s99, s10, 1
    s_lshl_b32 s97, s99, 6
    s_add_u32 s99, s98, s97
    s_lshl2_add_u32 s98, s96, s99
    s_add_u32 s97, s98, 1048576
    s_add_u32 s17, s97, 512
    v_lshrrev_b32 v47, 3, v1
    v_lshlrev_b32 v47, 10, v47
    v_and_b32 v9, 7, v1
    v_lshl_add_u32 v47, v9, 4, v47
    v_and_b32 v48, 7, v1
    v_lshlrev_b32 v48, 4, v48
    v_lshrrev_b32 v9, 5, v1
    v_lshl_add_u32 v48, v9, 3, v48
    v_cvt_pk_bf16_f32 v120, 0, v120
    v_cvt_pk_bf16_f32 v121, 0, v121
    v_cvt_pk_bf16_f32 v122, 0, v122
    v_cvt_pk_bf16_f32 v123, 0, v123
    v_cvt_pk_bf16_f32 v124, 0, v124
    v_cvt_pk_bf16_f32 v125, 0, v125
    v_cvt_pk_bf16_f32 v126, 0, v126
    v_cvt_pk_bf16_f32 v127, 0, v127
    v_cvt_pk_bf16_f32 v128, 0, v128
    v_cvt_pk_bf16_f32 v129, 0, v129
    v_cvt_pk_bf16_f32 v130, 0, v130
    v_cvt_pk_bf16_f32 v131, 0, v131
    v_cvt_pk_bf16_f32 v132, 0, v132
    v_cvt_pk_bf16_f32 v133, 0, v133
    v_cvt_pk_bf16_f32 v134, 0, v134
    v_cvt_pk_bf16_f32 v135, 0, v135
    v_max3_f32 v4, v120, v121, v122
    v_min3_f32 v5, v120, v121, v122
    v_max3_f32 v4, v4, v123, v124
    v_min3_f32 v5, v5, v123, v124
    v_max3_f32 v4, v4, v125, v126
    v_min3_f32 v5, v5, v125, v126
    v_max3_f32 v4, v4, v127, v128
    v_min3_f32 v5, v5, v127, v128
    v_max3_f32 v4, v4, v129, v130
    v_min3_f32 v5, v5, v129, v130
    v_max3_f32 v4, v4, v131, v132
    v_min3_f32 v5, v5, v131, v132
    v_max3_f32 v4, v4, v133, v134
    v_min3_f32 v5, v5, v133, v134
    v_max_f32 v6, v4, v135
    v_min_f32 v7, v5, v135
    v_max_f32 v4, v4, v135
    v_min_f32 v5, v5, v135
    s_nop 0
    v_permlane32_swap_b32 v4, v6
    v_permlane32_swap_b32 v5, v7
    v_max_f32 v4, v4, v6
    v_min_f32 v5, v5, v7
    v_pk_mul_f32 v[4:5], v[4:5], s[6:7] op_sel:[0,1]
    v_mov_b32 v6, v5
    v_pk_fma_f32 v[136:137], v[120:121], s[6:7], v[4:5] op_sel:[0,1,0] op_sel_hi:[1,1,0] neg_lo:[0,0,1] neg_hi:[0,0,1]
    v_pk_fma_f32 v[120:121], v[120:121], s[6:7], v[6:7] op_sel:[0,1,0] op_sel_hi:[1,1,0] neg_lo:[1,0,0] neg_hi:[1,0,0]
    v_pk_fma_f32 v[138:139], v[122:123], s[6:7], v[4:5] op_sel:[0,1,0] op_sel_hi:[1,1,0] neg_lo:[0,0,1] neg_hi:[0,0,1]
    v_pk_fma_f32 v[122:123], v[122:123], s[6:7], v[6:7] op_sel:[0,1,0] op_sel_hi:[1,1,0] neg_lo:[1,0,0] neg_hi:[1,0,0]
    v_pk_fma_f32 v[140:141], v[124:125], s[6:7], v[4:5] op_sel:[0,1,0] op_sel_hi:[1,1,0] neg_lo:[0,0,1] neg_hi:[0,0,1]
    v_pk_fma_f32 v[124:125], v[124:125], s[6:7], v[6:7] op_sel:[0,1,0] op_sel_hi:[1,1,0] neg_lo:[1,0,0] neg_hi:[1,0,0]
    v_pk_fma_f32 v[142:143], v[126:127], s[6:7], v[4:5] op_sel:[0,1,0] op_sel_hi:[1,1,0] neg_lo:[0,0,1] neg_hi:[0,0,1]
    v_pk_fma_f32 v[126:127], v[126:127], s[6:7], v[6:7] op_sel:[0,1,0] op_sel_hi:[1,1,0] neg_lo:[1,0,0] neg_hi:[1,0,0]
    v_pk_fma_f32 v[144:145], v[128:129], s[6:7], v[4:5] op_sel:[0,1,0] op_sel_hi:[1,1,0] neg_lo:[0,0,1] neg_hi:[0,0,1]
    v_pk_fma_f32 v[128:129], v[128:129], s[6:7], v[6:7] op_sel:[0,1,0] op_sel_hi:[1,1,0] neg_lo:[1,0,0] neg_hi:[1,0,0]
    v_pk_fma_f32 v[146:147], v[130:131], s[6:7], v[4:5] op_sel:[0,1,0] op_sel_hi:[1,1,0] neg_lo:[0,0,1] neg_hi:[0,0,1]
    v_pk_fma_f32 v[130:131], v[130:131], s[6:7], v[6:7] op_sel:[0,1,0] op_sel_hi:[1,1,0] neg_lo:[1,0,0] neg_hi:[1,0,0]
    v_pk_fma_f32 v[148:149], v[132:133], s[6:7], v[4:5] op_sel:[0,1,0] op_sel_hi:[1,1,0] neg_lo:[0,0,1] neg_hi:[0,0,1]
    v_pk_fma_f32 v[132:133], v[132:133], s[6:7], v[6:7] op_sel:[0,1,0] op_sel_hi:[1,1,0] neg_lo:[1,0,0] neg_hi:[1,0,0]
    v_pk_fma_f32 v[150:151], v[134:135], s[6:7], v[4:5] op_sel:[0,1,0] op_sel_hi:[1,1,0] neg_lo:[0,0,1] neg_hi:[0,0,1]
    v_pk_fma_f32 v[134:135], v[134:135], s[6:7], v[6:7] op_sel:[0,1,0] op_sel_hi:[1,1,0] neg_lo:[1,0,0] neg_hi:[1,0,0]
    v_exp_f32 v136, v136
    v_exp_f32 v120, v120
    v_exp_f32 v137, v137
    v_exp_f32 v121, v121
    v_exp_f32 v138, v138
    v_exp_f32 v122, v122
    v_exp_f32 v139, v139
    v_exp_f32 v123, v123
    v_exp_f32 v140, v140
    v_exp_f32 v124, v124
    v_exp_f32 v141, v141
    v_exp_f32 v125, v125
    v_exp_f32 v142, v142
    v_exp_f32 v126, v126
    v_exp_f32 v143, v143
    v_exp_f32 v127, v127
    s_waitcnt vmcnt(0)
    s_barrier
    s_cmp_lg_u32 s3, 0
    s_cbranch_scc1 L_PC
    v_mov_b32 v45, s4
    s_mov_b32 exec_hi, 0
    s_mov_b32 exec_lo, 65535
    buffer_store_dword v45, v46, s[32:35], s17 offen sc1
    s_mov_b64 exec, -1
L_PC:
    s_xor_b32 s96, s95, 1572864
    s_add_u32 s82, s96, s90
    s_add_u32 m0, s83, 98304
    s_nop 0
    buffer_load_dwordx4 v26, s[44:47], s82 offen lds
    v_exp_f32 v144, v144
    v_exp_f32 v128, v128
    v_exp_f32 v145, v145
    v_exp_f32 v129, v129
    v_exp_f32 v146, v146
    v_exp_f32 v130, v130
    v_exp_f32 v147, v147
    v_exp_f32 v131, v131
    s_xor_b32 s96, s95, 1703936
    s_add_u32 s82, s96, s90
    s_add_u32 m0, s83, 106496
    s_nop 0
    buffer_load_dwordx4 v26, s[44:47], s82 offen lds
    v_exp_f32 v148, v148
    v_exp_f32 v132, v132
    v_exp_f32 v149, v149
    v_exp_f32 v133, v133
    v_exp_f32 v150, v150
    v_exp_f32 v134, v134
    v_exp_f32 v151, v151
    v_exp_f32 v135, v135
    s_lshl4_add_u32 s96, s11, s10
    s_lshl_b32 s97, s96, 14
    s_lshl_b32 s98, s3, 7
    s_add_u32 s99, s97, s98
    s_add_u32 s13, s99, 25165824
    s_add_u32 s14, s13, 8192
    s_lshl4_add_u32 s96, s11, s10
    s_lshl_b32 s97, s96, 10
    s_lshl_b32 s98, s3, 7
    s_add_u32 s99, s97, s98
    s_add_u32 s15, s99, 29360128
    s_add_u32 s17, s17, 3072
    s_load_dwordx2 s[24:25], s[32:33], s92 offset:512 glc
    s_xor_b32 s96, s95, 1835008
    s_add_u32 s82, s96, s90
    s_add_u32 m0, s83, 114688
    s_nop 0
    buffer_load_dwordx4 v26, s[44:47], s82 offen lds
    v_pk_add_f32 v[8:9], v[136:137], v[138:139]
    v_pk_add_f32 v[10:11], v[120:121], v[122:123]
    v_pk_add_f32 v[8:9], v[8:9], v[140:141]
    v_pk_add_f32 v[10:11], v[10:11], v[124:125]
    v_pk_add_f32 v[8:9], v[8:9], v[142:143]
    v_pk_add_f32 v[10:11], v[10:11], v[126:127]
    v_pk_add_f32 v[8:9], v[8:9], v[144:145]
    v_pk_add_f32 v[10:11], v[10:11], v[128:129]
    v_pk_add_f32 v[8:9], v[8:9], v[146:147]
    v_pk_add_f32 v[10:11], v[10:11], v[130:131]
    v_pk_add_f32 v[8:9], v[8:9], v[148:149]
    v_pk_add_f32 v[10:11], v[10:11], v[132:133]
    v_pk_add_f32 v[8:9], v[8:9], v[150:151]
    v_pk_add_f32 v[10:11], v[10:11], v[134:135]
    s_xor_b32 s96, s95, 1966080
    s_add_u32 s82, s96, s90
    s_add_u32 m0, s83, 122880
    s_nop 0
    buffer_load_dwordx4 v26, s[44:47], s82 offen lds
    v_add_f32 v6, v8, v9
    v_add_f32 v7, v10, v11
    v_add_f32 v4, v8, v9
    v_add_f32 v5, v10, v11
    s_nop 0
    v_permlane32_swap_b32 v4, v6
    v_permlane32_swap_b32 v5, v7
    v_pk_add_f32 v[4:5], v[4:5], v[6:7]
    v_rcp_f32 v4, v4
    v_rcp_f32 v5, v5
    s_nop 0
    v_pk_mul_f32 v[136:137], v[136:137], v[4:5] op_sel_hi:[1,0]
    v_pk_mul_f32 v[120:121], v[4:5], v[120:121] op_sel:[1,0]
    v_pk_mul_f32 v[138:139], v[138:139], v[4:5] op_sel_hi:[1,0]
    v_pk_mul_f32 v[122:123], v[4:5], v[122:123] op_sel:[1,0]
    v_pk_mul_f32 v[140:141], v[140:141], v[4:5] op_sel_hi:[1,0]
    s_add_u32 s82, s95, s90
    s_mov_b32 m0, s83
    s_nop 0
    buffer_load_dwordx4 v26, s[44:47], s82 offen lds
    v_pk_mul_f32 v[124:125], v[4:5], v[124:125] op_sel:[1,0]
    v_pk_mul_f32 v[142:143], v[142:143], v[4:5] op_sel_hi:[1,0]
    v_pk_mul_f32 v[126:127], v[4:5], v[126:127] op_sel:[1,0]
    v_pk_mul_f32 v[144:145], v[144:145], v[4:5] op_sel_hi:[1,0]
    v_pk_mul_f32 v[128:129], v[4:5], v[128:129] op_sel:[1,0]
    v_pk_mul_f32 v[146:147], v[146:147], v[4:5] op_sel_hi:[1,0]
    v_pk_mul_f32 v[130:131], v[4:5], v[130:131] op_sel:[1,0]
    v_pk_mul_f32 v[148:149], v[148:149], v[4:5] op_sel_hi:[1,0]
    v_pk_mul_f32 v[132:133], v[4:5], v[132:133] op_sel:[1,0]
    v_pk_mul_f32 v[150:151], v[150:151], v[4:5] op_sel_hi:[1,0]
    v_pk_mul_f32 v[134:135], v[4:5], v[134:135] op_sel:[1,0]
    v_cvt_pk_bf16_f32 v152, v136, v137
    v_cvt_pk_bf16_f32 v153, v138, v139
    v_cvt_pk_bf16_f32 v154, v140, v141
    s_xor_b32 s96, s95, 131072
    s_add_u32 s82, s96, s90
    s_add_u32 m0, s83, 8192
    s_nop 0
    buffer_load_dwordx4 v26, s[44:47], s82 offen lds
    v_cvt_pk_bf16_f32 v155, v142, v143
    v_cvt_pk_bf16_f32 v156, v144, v145
    v_cvt_pk_bf16_f32 v157, v146, v147
    v_cvt_pk_bf16_f32 v158, v148, v149
    v_cvt_pk_bf16_f32 v159, v150, v151
    v_cvt_pk_bf16_f32 v160, v120, v121
    v_cvt_pk_bf16_f32 v161, v122, v123
    v_cvt_pk_bf16_f32 v162, v124, v125
    v_cvt_pk_bf16_f32 v163, v126, v127
    v_cvt_pk_bf16_f32 v164, v128, v129
    v_cvt_pk_bf16_f32 v165, v130, v131
    v_cvt_pk_bf16_f32 v166, v132, v133
    v_cvt_pk_bf16_f32 v167, v134, v135
    s_branch SCHK_17
SPOLL_16:
    s_load_dwordx2 s[24:25], s[32:33], s92 offset:512 glc
SCHK_17:
    s_add_u32 s5, s5, 1
    s_cmp_ge_u32 s5, 200000
    s_waitcnt lgkmcnt(0)
    s_cbranch_scc1 SDONE_18
    s_cmp_lg_u32 s24, s4
    s_cbranch_scc1 SPOLL_16
    s_cmp_lg_u32 s25, s4
    s_cbranch_scc1 SPOLL_16
SDONE_18:
    s_barrier
    buffer_load_dwordx4 v[184:187], v47, s[32:35], s13 offen sc1
    buffer_load_dwordx4 v[188:191], v47, s[32:35], s14 offen sc1
    buffer_load_dwordx4 v[192:195], v2, s[32:35], s16 offen sc1
    s_lshl_b32 s96, s3, 5
    s_add_u32 s14, s96, 155648
    v_and_b32 v6, 3, v1
    v_lshl_add_u32 v6, v6, 3, s14
    v_lshrrev_b32 v9, 5, v1
    v_lshl_add_u32 v6, v9, 2, v6
    s_lshl_b32 s96, s3, 10
    s_add_u32 s14, s96, 147456
    v_and_b32 v5, 15, v1
    v_lshl_add_u32 v5, v5, 4, s14
    v_lshrrev_b32 v9, 5, v1
    v_lshl_add_u32 v5, v9, 9, v5
    v_bfe_u32 v9, v1, 4, 1
    v_lshl_add_u32 v5, v9, 3, v5
    s_lshl_b32 s96, s76, 7
    s_add_u32 s14, s96, 155648
    v_lshrrev_b32 v7, 5, v1
    v_lshl_add_u32 v7, v7, 4, s14
    s_lshl_b32 s96, s76, 12
    s_add_u32 s14, s96, 147456
    v_add_u32 v44, s14, v2
    s_cmp_lt_u32 s3, 4
    s_cbranch_scc1 L_HG1
    v_lshlrev_b32 v52, 16, v88
    v_and_b32 v53, s6, v88
    v_pk_mul_f32 v[196:197], v[36:37], v[52:53] op_sel:[0,0] op_sel_hi:[0,1]
    v_lshlrev_b32 v54, 16, v89
    v_and_b32 v55, s6, v89
    v_pk_mul_f32 v[198:199], v[36:37], v[54:55] op_sel:[0,0] op_sel_hi:[0,1]
    v_lshlrev_b32 v52, 16, v90
    v_and_b32 v53, s6, v90
    v_pk_mul_f32 v[200:201], v[36:37], v[52:53] op_sel:[0,0] op_sel_hi:[0,1]
    v_lshlrev_b32 v54, 16, v91
    v_and_b32 v55, s6, v91
    v_pk_mul_f32 v[202:203], v[36:37], v[54:55] op_sel:[0,0] op_sel_hi:[0,1]
    v_lshlrev_b32 v52, 16, v92
    v_and_b32 v53, s6, v92
    v_pk_fma_f32 v[196:197], v[36:37], v[52:53], v[196:197] op_sel:[1,0,0] op_sel_hi:[1,1,1]
    v_lshlrev_b32 v54, 16, v93
    v_and_b32 v55, s6, v93
    v_pk_fma_f32 v[198:199], v[36:37], v[54:55], v[198:199] op_sel:[1,0,0] op_sel_hi:[1,1,1]
    v_lshlrev_b32 v52, 16, v94
    v_and_b32 v53, s6, v94
    v_pk_fma_f32 v[200:201], v[36:37], v[52:53], v[200:201] op_sel:[1,0,0] op_sel_hi:[1,1,1]
    v_lshlrev_b32 v54, 16, v95
    v_and_b32 v55, s6, v95
    v_pk_fma_f32 v[202:203], v[36:37], v[54:55], v[202:203] op_sel:[1,0,0] op_sel_hi:[1,1,1]
    v_lshlrev_b32 v52, 16, v96
    v_and_b32 v53, s6, v96
    v_pk_fma_f32 v[196:197], v[38:39], v[52:53], v[196:197] op_sel:[0,0,0] op_sel_hi:[0,1,1]
    v_lshlrev_b32 v54, 16, v97
    v_and_b32 v55, s6, v97
    v_pk_fma_f32 v[198:199], v[38:39], v[54:55], v[198:199] op_sel:[0,0,0] op_sel_hi:[0,1,1]
    v_lshlrev_b32 v52, 16, v98
    v_and_b32 v53, s6, v98
    v_pk_fma_f32 v[200:201], v[38:39], v[52:53], v[200:201] op_sel:[0,0,0] op_sel_hi:[0,1,1]
    v_lshlrev_b32 v54, 16, v99
    v_and_b32 v55, s6, v99
    v_pk_fma_f32 v[202:203], v[38:39], v[54:55], v[202:203] op_sel:[0,0,0] op_sel_hi:[0,1,1]
    v_lshlrev_b32 v52, 16, v100
    v_and_b32 v53, s6, v100
    v_pk_fma_f32 v[196:197], v[38:39], v[52:53], v[196:197] op_sel:[1,0,0] op_sel_hi:[1,1,1]
    v_lshlrev_b32 v54, 16, v101
    v_and_b32 v55, s6, v101
    v_pk_fma_f32 v[198:199], v[38:39], v[54:55], v[198:199] op_sel:[1,0,0] op_sel_hi:[1,1,1]
    v_lshlrev_b32 v52, 16, v102
    v_and_b32 v53, s6, v102
    v_pk_fma_f32 v[200:201], v[38:39], v[52:53], v[200:201] op_sel:[1,0,0] op_sel_hi:[1,1,1]
    v_lshlrev_b32 v54, 16, v103
    v_and_b32 v55, s6, v103
    v_pk_fma_f32 v[202:203], v[38:39], v[54:55], v[202:203] op_sel:[1,0,0] op_sel_hi:[1,1,1]
    v_lshlrev_b32 v52, 16, v104
    v_and_b32 v53, s6, v104
    v_pk_fma_f32 v[196:197], v[40:41], v[52:53], v[196:197] op_sel:[0,0,0] op_sel_hi:[0,1,1]
    v_lshlrev_b32 v54, 16, v105
    v_and_b32 v55, s6, v105
    v_pk_fma_f32 v[198:199], v[40:41], v[54:55], v[198:199] op_sel:[0,0,0] op_sel_hi:[0,1,1]
    v_lshlrev_b32 v52, 16, v106
    v_and_b32 v53, s6, v106
    v_pk_fma_f32 v[200:201], v[40:41], v[52:53], v[200:201] op_sel:[0,0,0] op_sel_hi:[0,1,1]
    v_lshlrev_b32 v54, 16, v107
    v_and_b32 v55, s6, v107
    v_pk_fma_f32 v[202:203], v[40:41], v[54:55], v[202:203] op_sel:[0,0,0] op_sel_hi:[0,1,1]
    v_lshlrev_b32 v52, 16, v108
    v_and_b32 v53, s6, v108
    v_pk_fma_f32 v[196:197], v[40:41], v[52:53], v[196:197] op_sel:[1,0,0] op_sel_hi:[1,1,1]
    v_lshlrev_b32 v54, 16, v109
    v_and_b32 v55, s6, v109
    v_pk_fma_f32 v[198:199], v[40:41], v[54:55], v[198:199] op_sel:[1,0,0] op_sel_hi:[1,1,1]
    v_lshlrev_b32 v52, 16, v110
    v_and_b32 v53, s6, v110
    v_pk_fma_f32 v[200:201], v[40:41], v[52:53], v[200:201] op_sel:[1,0,0] op_sel_hi:[1,1,1]
    v_lshlrev_b32 v54, 16, v111
    v_and_b32 v55, s6, v111
    v_pk_fma_f32 v[202:203], v[40:41], v[54:55], v[202:203] op_sel:[1,0,0] op_sel_hi:[1,1,1]
    v_lshlrev_b32 v52, 16, v112
    v_and_b32 v53, s6, v112
    v_pk_fma_f32 v[196:197], v[42:43], v[52:53], v[196:197] op_sel:[0,0,0] op_sel_hi:[0,1,1]
    v_lshlrev_b32 v54, 16, v113
    v_and_b32 v55, s6, v113
    v_pk_fma_f32 v[198:199], v[42:43], v[54:55], v[198:199] op_sel:[0,0,0] op_sel_hi:[0,1,1]
    v_lshlrev_b32 v52, 16, v114
    v_and_b32 v53, s6, v114
    v_pk_fma_f32 v[200:201], v[42:43], v[52:53], v[200:201] op_sel:[0,0,0] op_sel_hi:[0,1,1]
    v_lshlrev_b32 v54, 16, v115
    v_and_b32 v55, s6, v115
    v_pk_fma_f32 v[202:203], v[42:43], v[54:55], v[202:203] op_sel:[0,0,0] op_sel_hi:[0,1,1]
    v_lshlrev_b32 v52, 16, v116
    v_and_b32 v53, s6, v116
    v_pk_fma_f32 v[196:197], v[42:43], v[52:53], v[196:197] op_sel:[1,0,0] op_sel_hi:[1,1,1]
    v_lshlrev_b32 v54, 16, v117
    v_and_b32 v55, s6, v117
    v_pk_fma_f32 v[198:199], v[42:43], v[54:55], v[198:199] op_sel:[1,0,0] op_sel_hi:[1,1,1]
    v_lshlrev_b32 v52, 16, v118
    v_and_b32 v53, s6, v118
    v_pk_fma_f32 v[200:201], v[42:43], v[52:53], v[200:201] op_sel:[1,0,0] op_sel_hi:[1,1,1]
    v_lshlrev_b32 v54, 16, v119
    v_and_b32 v55, s6, v119
    v_pk_fma_f32 v[202:203], v[42:43], v[54:55], v[202:203] op_sel:[1,0,0] op_sel_hi:[1,1,1]
    v_permlane32_swap_b32 v196, v200
    v_permlane32_swap_b32 v197, v201
    v_permlane32_swap_b32 v198, v202
    v_permlane32_swap_b32 v199, v203
    v_add_f32 v196, v196, v200
    v_add_f32 v197, v197, v201
    v_add_f32 v198, v198, v202
    v_add_f32 v199, v199, v203
    s_nop 0
    v_permlane16_swap_b32 v196, v198
    v_permlane16_swap_b32 v197, v199
    v_add_f32 v196, v196, v198
    v_add_f32 v197, v197, v199
    s_nop 0
    v_add_f32_dpp v196, v196, v196 row_ror:8 row_mask:0xf bank_mask:0xf
    v_add_f32_dpp v197, v197, v197 row_ror:8 row_mask:0xf bank_mask:0xf
    s_nop 1
    v_mov_b32_dpp v196, v197 quad_perm:[0,1,2,3] row_mask:0xf bank_mask:0xc
    ds_write_b32 v252, v196 offset:9984
L_HG1:
    s_waitcnt vmcnt(1)
    v_pk_add_f32 v[184:185], v[184:185], v[188:189]
    v_pk_add_f32 v[186:187], v[186:187], v[190:191]
    s_nop 1
    v_permlane32_swap_b32 v184, v186
    v_permlane32_swap_b32 v185, v187
    v_pk_add_f32 v[184:185], v[184:185], v[186:187]
    s_nop 1
    v_add_f32_dpp v184, v184, v184 row_ror:8 row_mask:0xf bank_mask:0xf
    v_add_f32_dpp v185, v185, v185 row_ror:8 row_mask:0xf bank_mask:0xf
    v_mov_b32 v186, v184
    v_mov_b32 v187, v185
    s_nop 0
    v_permlane16_swap_b32 v184, v186
    v_permlane16_swap_b32 v185, v187
    v_pk_add_f32 v[184:185], v[184:185], v[186:187]
    v_cvt_pk_bf16_f32 v184, v184, v185
    v_mov_b32 v185, s4
    s_mov_b32 exec_lo, 0xff
    s_mov_b32 exec_hi, 0xff
    buffer_store_dwordx2 v[184:185], v48, s[32:35], s15 offen sc1
    s_mov_b64 exec, -1
    s_waitcnt lgkmcnt(0)
    s_barrier
    s_cmp_lg_u32 s3, 0
    s_cbranch_scc1 L_PC2
    v_mov_b32 v45, s4
    s_mov_b32 exec_hi, 0
    s_mov_b32 exec_lo, 65535
    buffer_store_dword v45, v46, s[32:35], s17 offen sc1
    s_mov_b64 exec, -1
L_PC2:
    s_cmp_lg_u32 s3, 3
    s_cbranch_scc1 L_M2F
    ds_read_b128 v[196:199], v251 offset:10000
    s_lshr_b32 s96, s8, 2
    s_lshl1_add_u32 s97, s9, s96
    s_and_b32 s98, s8, 3
    s_lshl2_add_u32 s99, s97, s98
    s_lshl_b32 s96, s99, 9
    s_add_u32 s18, s96, 131072
    s_waitcnt lgkmcnt(0)
    v_add_f32 v196, v196, v197
    v_add_f32 v198, v198, v199
    v_mov_b32 v197, s4
    v_add_f32 v196, v196, v198
    buffer_store_dwordx2 v[196:197], v250, s[32:35], s18 offen sc1
L_M2F:
    s_waitcnt vmcnt(1)
    s_xor_b32 s96, s95, 262144
    s_add_u32 s82, s96, s90
    s_add_u32 m0, s83, 16384
    s_nop 0
    buffer_load_dwordx4 v26, s[44:47], s82 offen lds
    v_permlane32_swap_b32 v192, v194
    v_permlane32_swap_b32 v193, v195
    v_pk_add_f32 v[192:193], v[192:193], v[194:195]
    s_nop 1
    v_add_f32_dpp v192, v192, v192 row_ror:4 row_mask:0xf bank_mask:0xf
    s_xor_b32 s96, s95, 393216
    s_add_u32 s82, s96, s90
    s_add_u32 m0, s83, 24576
    s_nop 0
    buffer_load_dwordx4 v26, s[44:47], s82 offen lds
    v_add_f32_dpp v193, v193, v193 row_ror:4 row_mask:0xf bank_mask:0xf
    v_add_f32_dpp v192, v192, v192 row_ror:8 row_mask:0xf bank_mask:0xf
    s_nop 0
    v_add_f32_dpp v193, v193, v193 row_ror:8 row_mask:0xf bank_mask:0xf
    s_xor_b32 s96, s95, 524288
    s_add_u32 s82, s96, s90
    s_add_u32 m0, s83, 32768
    s_nop 0
    buffer_load_dwordx4 v26, s[44:47], s82 offen lds
    v_mov_b32 v194, v192
    v_mov_b32 v195, v193
    s_nop 0
    v_permlane16_swap_b32 v192, v194
    s_xor_b32 s96, s95, 655360
    s_add_u32 s82, s96, s90
    s_add_u32 m0, s83, 40960
    s_nop 0
    buffer_load_dwordx4 v26, s[44:47], s82 offen lds
    v_permlane16_swap_b32 v193, v195
    v_pk_add_f32 v[192:193], v[192:193], v[194:195]
    v_cvt_pk_bf16_f32 v192, v192, v193
    ds_write_b32 v6, v192
    s_waitcnt lgkmcnt(0)
    s_barrier
    ds_read_b128 v[196:199], v7
    ds_read_b128 v[200:203], v7 offset:32
    ds_read_b128 v[204:207], v7 offset:64
    ds_read_b128 v[208:211], v7 offset:96
    s_lshr_b32 s96, s8, 2
    s_lshl1_add_u32 s97, s9, s96
    s_and_b32 s98, s8, 3
    s_lshl2_add_u32 s99, s97, s98
    s_lshl_b32 s96, s99, 9
    s_add_u32 s18, s96, 131072
    s_waitcnt lgkmcnt(0)
    s_lshl3_add_u32 s96, s11, s3
    s_lshl_b32 s97, s96, 11
    s_add_u32 s13, s97, 29360128
    s_load_dwordx2 s[24:25], s[32:33], s92 offset:3584 glc
    v_mfma_f32_32x32x16_bf16 v[136:151], v[196:199], v[152:155], 0
    v_mfma_f32_32x32x16_bf16 v[136:151], v[200:203], v[156:159], v[136:151]
    v_mfma_f32_32x32x16_bf16 v[136:151], v[204:207], v[160:163], v[136:151]
    v_mfma_f32_32x32x16_bf16 v[136:151], v[208:211], v[164:167], v[136:151]
    s_nop 11
    v_cvt_pk_bf16_f32 v136, 0, v136
    v_add_f32 v136, 0x358637bd, v136
    v_cvt_pk_bf16_f32 v136, 0, v136
    v_rcp_f32 v136, v136
    s_branch SCHK_20
SPOLL_19:
    s_load_dwordx2 s[24:25], s[32:33], s92 offset:3584 glc
SCHK_20:
    s_add_u32 s5, s5, 1
    s_cmp_ge_u32 s5, 200000
    s_waitcnt lgkmcnt(0)
    s_cbranch_scc1 SDONE_21
    s_cmp_lg_u32 s24, s4
    s_cbranch_scc1 SPOLL_19
    s_cmp_lg_u32 s25, s4
    s_cbranch_scc1 SPOLL_19
SDONE_21:
    buffer_load_dwordx4 v[228:231], v2, s[32:35], s13 offen sc1
    buffer_load_dwordx4 v[232:235], v2, s[32:35], s13 offen offset:1024 sc1
    s_waitcnt vmcnt(0)
    v_bitop3_b32 v4, v229, v231, s4 bitop3:0x7e
    v_bitop3_b32 v4, v4, v233, s4 bitop3:0xf6
    v_bitop3_b32 v4, v4, v235, s4 bitop3:0xf6
    v_cmp_ne_u32 vcc, 0, v4
    s_cbranch_vccz TOK_23
POLL_24:
    buffer_load_dwordx4 v[228:231], v2, s[32:35], s13 offen sc1
    buffer_load_dwordx4 v[232:235], v2, s[32:35], s13 offen offset:1024 sc1
    s_waitcnt vmcnt(0)
    v_bitop3_b32 v4, v229, v231, s4 bitop3:0x7e
    v_bitop3_b32 v4, v4, v233, s4 bitop3:0xf6
    v_bitop3_b32 v4, v4, v235, s4 bitop3:0xf6
    v_cmp_ne_u32 vcc, 0, v4
    s_cbranch_vccz PDONE_25
    s_add_u32 s5, s5, 1
    s_cmp_lt_u32 s5, 200000
    s_cbranch_scc1 POLL_24
PDONE_25:
TOK_23:
L_PAD7:
    s_cbranch_execz L_RET7
    ds_write2_b32 v5, v228, v230 offset0:0 offset1:1
    ds_write2_b32 v5, v232, v234 offset0:64 offset1:65
    s_waitcnt lgkmcnt(0)
    s_barrier
    ds_read_b128 v[212:215], v44
    ds_read_b128 v[216:219], v44 offset:1024
    ds_read_b128 v[220:223], v44 offset:2048
    ds_read_b128 v[224:227], v44 offset:3072
    s_lshl_b32 s96, s77, 1
    s_lshl3_add_u32 s97, s10, s96
    s_lshl_b32 s98, s97, 5
    s_lshl1_add_u32 s99, s11, s98
    s_add_u32 s96, s99, s76
    s_lshl_b32 s97, s96, 10
    s_add_u32 s13, s97, 8388608
    v_and_b32 v47, 15, v1
    v_lshlrev_b32 v47, 4, v47
    v_bfe_u32 v9, v1, 4, 1
    v_lshl_add_u32 v47, v9, 15, v47
    v_lshrrev_b32 v9, 5, v1
    v_lshl_add_u32 v47, v9, 8, v47
    s_waitcnt lgkmcnt(3)
    v_mfma_f32_32x32x16_bf16 v[120:135], v[212:215], v[152:155], 0
    s_waitcnt lgkmcnt(2)
    v_mfma_f32_32x32x16_bf16 v[120:135], v[216:219], v[156:159], v[120:135]
    s_waitcnt lgkmcnt(1)
    v_mfma_f32_32x32x16_bf16 v[120:135], v[220:223], v[160:163], v[120:135]
    s_waitcnt lgkmcnt(0)
    v_mfma_f32_32x32x16_bf16 v[120:135], v[224:227], v[164:167], v[120:135]
    s_lshr_b32 s96, s3, 1
    s_lshl4_add_u32 s97, s96, s12
    s_lshl_b32 s98, s97, 11
    s_and_b32 s99, s3, 1
    s_lshl_b32 s96, s99, 10
    s_add_u32 s97, s98, s96
    s_add_u32 s18, s97, 131072
    s_lshl_b32 s19, s12, 7
    v_and_b32 v44, 3, v1
    v_lshl_add_u32 v44, v44, 1, s19
    v_lshrrev_b32 v9, 5, v1
    v_lshl_add_u32 v44, v9, 3, v44
    v_bfe_u32 v9, v1, 4, 1
    v_lshl_add_u32 v44, v9, 4, v44
    v_bfe_u32 v9, v1, 2, 2
    v_lshl_add_u32 v44, v9, 5, v44
    global_load_ushort v32, v44, s[78:79]
    v_cvt_pk_bf16_f32 v120, 0, v120
    v_cvt_pk_bf16_f32 v121, 0, v121
    v_cvt_pk_bf16_f32 v122, 0, v122
    v_cvt_pk_bf16_f32 v123, 0, v123
    v_cvt_pk_bf16_f32 v124, 0, v124
    v_cvt_pk_bf16_f32 v125, 0, v125
    v_cvt_pk_bf16_f32 v126, 0, v126
    v_cvt_pk_bf16_f32 v127, 0, v127
    v_pk_mul_f32 v[120:121], v[120:121], v[136:137] op_sel_hi:[1,0]
    v_pk_mul_f32 v[122:123], v[122:123], v[136:137] op_sel_hi:[1,0]
    v_pk_mul_f32 v[124:125], v[124:125], v[136:137] op_sel_hi:[1,0]
    v_pk_mul_f32 v[126:127], v[126:127], v[136:137] op_sel_hi:[1,0]
    v_cvt_pk_bf16_f32 v168, v120, v121
    v_cvt_pk_bf16_f32 v169, v122, v123
    v_cvt_pk_bf16_f32 v170, v124, v125
    v_cvt_pk_bf16_f32 v171, v126, v127
    buffer_store_dwordx4 v[168:171], v47, s[32:35], s13 offen sc1
    v_cvt_pk_bf16_f32 v128, 0, v128
    v_cvt_pk_bf16_f32 v129, 0, v129
    v_cvt_pk_bf16_f32 v130, 0, v130
    v_cvt_pk_bf16_f32 v131, 0, v131
    v_cvt_pk_bf16_f32 v132, 0, v132
    v_cvt_pk_bf16_f32 v133, 0, v133
    v_cvt_pk_bf16_f32 v134, 0, v134
    v_cvt_pk_bf16_f32 v135, 0, v135
    v_pk_mul_f32 v[128:129], v[128:129], v[136:137] op_sel_hi:[1,0]
    v_pk_mul_f32 v[130:131], v[130:131], v[136:137] op_sel_hi:[1,0]
    v_pk_mul_f32 v[132:133], v[132:133], v[136:137] op_sel_hi:[1,0]
    v_pk_mul_f32 v[134:135], v[134:135], v[136:137] op_sel_hi:[1,0]
    v_cvt_pk_bf16_f32 v172, v128, v129
    v_cvt_pk_bf16_f32 v173, v130, v131
    v_cvt_pk_bf16_f32 v174, v132, v133
    v_cvt_pk_bf16_f32 v175, v134, v135
    buffer_store_dwordx4 v[172:175], v47, s[32:35], s13 offen offset:512 sc1
    buffer_load_dwordx4 v[28:31], v2, s[32:35], s18 offen sc1
    v_mov_b32 v50, -1
    v_mov_b32 v51, -1
    v_mov_b32 v52, -1
    v_mov_b32 v53, -1
    s_lshl3_add_u32 s96, s21, s3
    s_lshl4_add_u32 s97, s96, s12
    s_lshl_b32 s98, s97, 8
    s_add_u32 s19, s98, 12582912
    v_lshlrev_b32 v54, 2, v1
    buffer_store_dword v50, v54, s[32:35], s19 offen sc1
    s_lshl_b32 s96, s21, 14
    s_lshl_b32 s97, s12, 9
    s_add_u32 s98, s96, s97
    s_add_u32 s19, s98, 13631488
    v_and_b32 v54, 31, v1
    v_lshlrev_b32 v54, 4, v54
    v_lshrrev_b32 v55, 5, v1
    v_lshl_add_u32 v54, v55, 13, v54
    s_cmp_lg_u32 s3, 5
    s_cbranch_scc1 L_NOPO
    buffer_store_dwordx4 v[50:53], v54, s[32:35], s19 offen sc1
L_NOPO:
    v_bfe_u32 v36, v1, 2, 2
    v_lshlrev_b32 v36, 7, v36
    v_lshrrev_b32 v9, 4, v1
    v_lshl_add_u32 v36, v9, 10, v36
    v_and_b32 v9, 1, v1
    v_lshl_add_u32 v36, v9, 4, v36
    v_bfe_u32 v9, v1, 1, 1
    v_lshl_add_u32 v36, v9, 3, v36
    v_bfe_u32 v9, v1, 3, 2
    v_lshl_add_u32 v36, v9, 5, v36
    s_and_b32 s96, s9, 1
    s_lshl_b32 s97, s96, 2
    s_xor_b32 s98, s3, s97
    s_lshl_b32 s17, s98, 12
    s_lshl_b32 s96, s17, 2
    s_lshr_b32 s97, s95, 4
    s_xor_b32 s14, s96, s97
    v_add_u32 v36, s14, v36
    v_xor_b32 v37, 32, v36
    v_xor_b32 v38, 64, v36
    v_xor_b32 v39, 96, v36
    v_and_b32 v5, 7, v1
    v_lshlrev_b32 v5, 15, v5
    v_bfe_u32 v9, v1, 3, 1
    v_lshl_add_u32 v5, v9, 12, v5
    s_and_b32 s96, s11, 1
    s_lshr_b32 s97, s10, 2
    s_and_b32 s98, s10, 3
    s_lshl_b32 s99, s98, 6
    s_lshl1_add_u32 s98, s97, s99
    s_lshl_b32 s97, s98, 12
    s_lshr_b32 s99, s11, 1
    s_lshl_b32 s98, s99, 6
    s_add_u32 s99, s97, s98
    s_lshl2_add_u32 s97, s96, s99
    s_add_u32 s98, s97, 1048576
    s_add_u32 s15, s98, 1024
    v_lshlrev_b32 v152, 16, v12
    v_and_b32 v153, s6, v12
    v_lshlrev_b32 v154, 16, v13
    v_and_b32 v155, s6, v13
    v_lshlrev_b32 v156, 16, v14
    v_and_b32 v157, s6, v14
    v_lshlrev_b32 v158, 16, v15
    v_and_b32 v159, s6, v15
    v_lshlrev_b32 v160, 16, v16
    v_and_b32 v161, s6, v16
    v_lshlrev_b32 v162, 16, v17
    v_and_b32 v163, s6, v17
    v_lshlrev_b32 v164, 16, v18
    v_and_b32 v165, s6, v18
    v_lshlrev_b32 v166, 16, v19
    v_and_b32 v167, s6, v19
    s_lshl3_add_u32 s96, s21, s3
    s_lshl_b32 s97, s96, 15
    s_add_u32 s19, s97, 8388608
    s_and_b32 s96, s3, 1
    s_lshr_b32 s97, s3, 1
    s_lshl_b32 s98, s97, 10
    s_lshl3_add_u32 s99, s96, s98
    s_add_u32 s14, s99, 159744
    v_and_b32 v4, 31, v1
    v_lshl_add_u32 v4, v4, 5, s14
    v_lshrrev_b32 v9, 5, v1
    v_lshl_add_u32 v4, v9, 2, v4
    v_and_b32 v7, 3, v1
    v_lshlrev_b32 v7, 4, v7
    v_lshrrev_b32 v9, 5, v1
    v_lshl_add_u32 v7, v9, 6, v7
    v_bfe_u32 v9, v1, 4, 1
    v_lshl_add_u32 v7, v9, 7, v7
    v_bfe_u32 v9, v1, 2, 2
    v_lshl_add_u32 v7, v9, 8, v7
    v_add_u32 v7, 159744, v7
    s_waitcnt vmcnt(2)
    s_waitcnt lgkmcnt(0)
    s_barrier
    s_cmp_lg_u32 s3, 0
    s_cbranch_scc1 L_PD
    v_mov_b32 v6, s4
    s_mov_b32 exec_hi, 0
    s_mov_b32 exec_lo, 65535
    buffer_store_dword v6, v5, s[32:35], s15 offen sc1
    s_mov_b64 exec, -1
L_PD:
    s_waitcnt vmcnt(1)
    v_bitop3_b32 v6, v29, v31, s4 bitop3:0x7e
    v_cmp_ne_u32 vcc, 0, v6
    s_cbranch_vccz L_MGOK
POLL_26:
    buffer_load_dwordx4 v[28:31], v2, s[32:35], s18 offen sc1
    s_waitcnt vmcnt(0)
    v_bitop3_b32 v6, v29, v31, s4 bitop3:0x7e
    v_cmp_ne_u32 vcc, 0, v6
    s_cbranch_vccz PDONE_27
    s_add_u32 s5, s5, 1
    s_cmp_lt_u32 s5, 200000
    s_cbranch_scc1 POLL_26
PDONE_27:
L_MGOK:
    ds_write2_b32 v4, v28, v30 offset0:0 offset1:4
    s_waitcnt lgkmcnt(0)
    s_barrier
    s_lshl_b32 s96, s2, 12
    s_lshr_b32 s97, s17, 6
    s_add_u32 s98, s96, s97
    s_add_u32 s99, s98, 1048576
    s_add_u32 s18, s99, 1024
    ds_read_b128 v[192:195], v7
    ds_read_b128 v[196:199], v7 offset:1024
    ds_read_b128 v[200:203], v7 offset:2048
    ds_read_b128 v[204:207], v7 offset:3072
    v_and_b32 v8, 3, v1
    v_lshlrev_b32 v8, 2, v8
    v_lshrrev_b32 v9, 5, v1
    v_lshl_add_u32 v8, v9, 4, v8
    v_bfe_u32 v9, v1, 4, 1
    v_lshl_add_u32 v8, v9, 5, v8
    v_bfe_u32 v9, v1, 2, 2
    v_lshl_add_u32 v8, v9, 6, v8
    v_add_u32 v8, 157184, v8
    s_lshl4_add_u32 s96, s21, s12
    s_lshl_b32 s97, s96, 6
    s_add_u32 s13, s97, 14155776
    s_waitcnt lgkmcnt(0)
    s_load_dwordx2 s[24:25], s[32:33], s18 offset:0 glc
    v_pk_add_f32 v[192:193], v[192:193], v[194:195]
    v_add_f32 v28, v192, v193
    v_pk_add_f32 v[196:197], v[196:197], v[198:199]
    v_add_f32 v29, v196, v197
    v_pk_add_f32 v[200:201], v[200:201], v[202:203]
    v_add_f32 v30, v200, v201
    v_pk_add_f32 v[204:205], v[204:205], v[206:207]
    v_add_f32 v31, v204, v205
    v_cvt_pk_bf16_f32 v28, 0, v28
    v_cvt_pk_bf16_f32 v29, 0, v29
    v_cvt_pk_bf16_f32 v30, 0, v30
    v_cvt_pk_bf16_f32 v31, 0, v31
    v_add_f32 v30, 1.0, v30
    v_lshlrev_b32 v32, 16, v32
    v_cvt_pk_bf16_f32 v30, 0, v30
    ds_write_b32 v8, v31
    v_mul_f32 v192, v30, v32
    v_cvt_pk_bf16_f32 v193, 0, v192
    v_sub_f32 v194, v192, v193
    v_add_f32_dpp v192, v192, v192 quad_perm:[1,0,3,2] row_mask:0xf bank_mask:0xf
    s_nop 1
    v_add_f32_dpp v192, v192, v192 quad_perm:[2,3,0,1] row_mask:0xf bank_mask:0xf
    s_nop 1
    v_add_f32_dpp v192, v192, v192 row_half_mirror row_mask:0xf bank_mask:0xf
    s_nop 1
    v_add_f32_dpp v192, v192, v192 row_ror:8 row_mask:0xf bank_mask:0xf
    v_mov_b32 v199, v192
    s_nop 1
    v_permlane16_swap_b32 v192, v199
    v_add_f32 v192, v192, v199
    v_mov_b32 v199, v192
    s_nop 1
    v_permlane32_swap_b32 v192, v199
    v_add_f32 v192, v192, v199
    v_mov_b32_dpp v196, v193 row_shl:1 row_mask:0xf bank_mask:0xf
    v_mov_b32_dpp v197, v194 row_shl:1 row_mask:0xf bank_mask:0xf
    v_mov_b32_dpp v198, v32 row_shl:1 row_mask:0xf bank_mask:0xf
    v_cvt_pk_bf16_f32 v196, v193, v196
    v_cvt_pk_bf16_f32 v197, v194, v197
    v_cvt_pk_bf16_f32 v198, v32, v198
    v_mov_b32 v193, s4
    v_mov_b32 v194, 0
    s_cmp_lg_u32 s3, 2
    s_cbranch_scc1 L_NOUP
    s_mov_b64 exec, 1
    buffer_store_dwordx2 v[192:193], v194, s[32:35], s13 offen sc1
    s_mov_b64 exec, -1
L_NOUP:
    v_mov_b32 v184, 0x3f803f80
    s_nop 1
    v_mov_b32_dpp v184, v196 row_newbcast:0 row_mask:0xf bank_mask:0x2
    s_nop 1
    v_mov_b32_dpp v184, v197 row_newbcast:0 row_mask:0xf bank_mask:0x4
    s_nop 1
    v_mov_b32_dpp v184, v198 row_newbcast:0 row_mask:0xf bank_mask:0x8
    v_mov_b32 v185, 0x3f803f80
    s_nop 1
    v_mov_b32_dpp v185, v196 row_newbcast:2 row_mask:0xf bank_mask:0x2
    s_nop 1
    v_mov_b32_dpp v185, v197 row_newbcast:2 row_mask:0xf bank_mask:0x4
    s_nop 1
    v_mov_b32_dpp v185, v198 row_newbcast:2 row_mask:0xf bank_mask:0x8
    v_mov_b32 v186, 0x3f803f80
    s_nop 1
    v_mov_b32_dpp v186, v196 row_newbcast:4 row_mask:0xf bank_mask:0x2
    s_nop 1
    v_mov_b32_dpp v186, v197 row_newbcast:4 row_mask:0xf bank_mask:0x4
    s_nop 1
    v_mov_b32_dpp v186, v198 row_newbcast:4 row_mask:0xf bank_mask:0x8
    v_mov_b32 v187, 0x3f803f80
    s_nop 1
    v_mov_b32_dpp v187, v196 row_newbcast:6 row_mask:0xf bank_mask:0x2
    s_nop 1
    v_mov_b32_dpp v187, v197 row_newbcast:6 row_mask:0xf bank_mask:0x4
    s_nop 1
    v_mov_b32_dpp v187, v198 row_newbcast:6 row_mask:0xf bank_mask:0x8
    v_mov_b32 v188, 0x3f803f80
    s_nop 1
    v_mov_b32_dpp v188, v196 row_newbcast:8 row_mask:0xf bank_mask:0x2
    s_nop 1
    v_mov_b32_dpp v188, v197 row_newbcast:8 row_mask:0xf bank_mask:0x4
    s_nop 1
    v_mov_b32_dpp v188, v198 row_newbcast:8 row_mask:0xf bank_mask:0x8
    v_mov_b32 v189, 0x3f803f80
    s_nop 1
    v_mov_b32_dpp v189, v196 row_newbcast:10 row_mask:0xf bank_mask:0x2
    s_nop 1
    v_mov_b32_dpp v189, v197 row_newbcast:10 row_mask:0xf bank_mask:0x4
    s_nop 1
    v_mov_b32_dpp v189, v198 row_newbcast:10 row_mask:0xf bank_mask:0x8
    v_mov_b32 v190, 0x3f803f80
    s_nop 1
    v_mov_b32_dpp v190, v196 row_newbcast:12 row_mask:0xf bank_mask:0x2
    s_nop 1
    v_mov_b32_dpp v190, v197 row_newbcast:12 row_mask:0xf bank_mask:0x4
    s_nop 1
    v_mov_b32_dpp v190, v198 row_newbcast:12 row_mask:0xf bank_mask:0x8
    v_mov_b32 v191, 0x3f803f80
    s_nop 1
    v_mov_b32_dpp v191, v196 row_newbcast:14 row_mask:0xf bank_mask:0x2
    s_nop 1
    v_mov_b32_dpp v191, v197 row_newbcast:14 row_mask:0xf bank_mask:0x4
    s_nop 1
    v_mov_b32_dpp v191, v198 row_newbcast:14 row_mask:0xf bank_mask:0x8
    v_mov_b32 v42, v29
    v_mov_b32 v43, v31
    v_mov_b32 v33, v30
    v_mov_b32_dpp v136, v28 row_newbcast:0 row_mask:0xf bank_mask:0xf
    v_mov_b32_dpp v137, v28 row_newbcast:1 row_mask:0xf bank_mask:0xf
    v_mov_b32_dpp v138, v28 row_newbcast:2 row_mask:0xf bank_mask:0xf
    v_mov_b32_dpp v139, v28 row_newbcast:3 row_mask:0xf bank_mask:0xf
    v_mov_b32_dpp v140, v28 row_newbcast:4 row_mask:0xf bank_mask:0xf
    v_mov_b32_dpp v141, v28 row_newbcast:5 row_mask:0xf bank_mask:0xf
    v_mov_b32_dpp v142, v28 row_newbcast:6 row_mask:0xf bank_mask:0xf
    v_mov_b32_dpp v143, v28 row_newbcast:7 row_mask:0xf bank_mask:0xf
    v_mov_b32_dpp v144, v28 row_newbcast:8 row_mask:0xf bank_mask:0xf
    v_mov_b32_dpp v145, v28 row_newbcast:9 row_mask:0xf bank_mask:0xf
    v_mov_b32_dpp v146, v28 row_newbcast:10 row_mask:0xf bank_mask:0xf
    v_mov_b32_dpp v147, v28 row_newbcast:11 row_mask:0xf bank_mask:0xf
    v_mov_b32_dpp v148, v28 row_newbcast:12 row_mask:0xf bank_mask:0xf
    v_mov_b32_dpp v149, v28 row_newbcast:13 row_mask:0xf bank_mask:0xf
    v_mov_b32_dpp v150, v28 row_newbcast:14 row_mask:0xf bank_mask:0xf
    v_mov_b32_dpp v151, v28 row_newbcast:15 row_mask:0xf bank_mask:0xf
    s_branch SCHK_29
SPOLL_28:
    s_load_dwordx2 s[24:25], s[32:33], s18 offset:0 glc
SCHK_29:
    s_add_u32 s5, s5, 1
    s_cmp_ge_u32 s5, 200000
    s_waitcnt lgkmcnt(0)
    s_cbranch_scc1 SDONE_30
    s_cmp_lg_u32 s24, s4
    s_cbranch_scc1 SPOLL_28
    s_cmp_lg_u32 s25, s4
    s_cbranch_scc1 SPOLL_28
SDONE_30:
    s_add_u32 s20, s17, s19
    buffer_load_dwordx4 v[224:227], v2, s[32:35], s20 offen sc1
    ds_read_b64_tr_b16 v[192:193], v36
    ds_read_b64_tr_b16 v[194:195], v36 offset:512
    ds_read_b64_tr_b16 v[196:197], v37
    ds_read_b64_tr_b16 v[198:199], v37 offset:512
    ds_read_b64_tr_b16 v[200:201], v38
    ds_read_b64_tr_b16 v[202:203], v38 offset:512
    ds_read_b64_tr_b16 v[204:205], v39
    ds_read_b64_tr_b16 v[206:207], v39 offset:512
    ds_read_b64_tr_b16 v[208:209], v36 offset:4096
    ds_read_b64_tr_b16 v[210:211], v36 offset:4608
    ds_read_b64_tr_b16 v[212:213], v37 offset:4096
    ds_read_b64_tr_b16 v[214:215], v37 offset:4608
    ds_read_b64_tr_b16 v[216:217], v38 offset:4096
    ds_read_b64_tr_b16 v[218:219], v38 offset:4608
    buffer_load_dwordx4 v[228:231], v2, s[32:35], s20 offen offset:1024 sc1
    buffer_load_dwordx4 v[232:235], v2, s[32:35], s20 offen offset:2048 sc1
    buffer_load_dwordx4 v[236:239], v2, s[32:35], s20 offen offset:3072 sc1
    s_barrier
    s_xor_b32 s96, s17, 4096
    s_add_u32 s20, s96, s19
    buffer_load_dwordx4 v[240:243], v2, s[32:35], s20 offen sc1
    buffer_load_dwordx4 v[244:247], v2, s[32:35], s20 offen offset:1024 sc1
    buffer_load_dwordx4 v[44:47], v2, s[32:35], s20 offen offset:2048 sc1
    buffer_load_dwordx4 v[48:51], v2, s[32:35], s20 offen offset:3072 sc1
    s_lshl_b32 s96, s21, 10
    s_add_u32 s13, s96, 14155776
    v_and_b32 v10, 15, v1
    v_lshlrev_b32 v10, 6, v10
    s_cmp_lt_u32 s3, 4
    s_cbranch_scc1 L_G2P0
    s_setprio 1
L_G2P0:
    s_waitcnt vmcnt(7)
    s_waitcnt lgkmcnt(6)
    v_mfma_f32_16x16x32_bf16 v[120:123], v[192:195], v[224:227], 0
    ds_read_b64_tr_b16 v[220:221], v39 offset:4096
    ds_read_b64_tr_b16 v[222:223], v39 offset:4608
    v_mfma_f32_16x16x32_bf16 v[124:127], v[196:199], v[224:227], 0
    ds_read_b64_tr_b16 v[192:193], v36 offset:8192
    ds_read_b64_tr_b16 v[194:195], v36 offset:8704
    v_mfma_f32_16x16x32_bf16 v[128:131], v[200:203], v[224:227], 0
    ds_read_b64_tr_b16 v[196:197], v37 offset:8192
    ds_read_b64_tr_b16 v[198:199], v37 offset:8704
    v_mfma_f32_16x16x32_bf16 v[132:135], v[204:207], v[224:227], 0
    ds_read_b64_tr_b16 v[200:201], v38 offset:8192
    ds_read_b64_tr_b16 v[202:203], v38 offset:8704
    s_xor_b32 s96, s17, 8192
    s_add_u32 s20, s96, s19
    buffer_load_dwordx4 v[224:227], v2, s[32:35], s20 offen sc1
    s_waitcnt vmcnt(7)
    s_waitcnt lgkmcnt(6)
    v_mfma_f32_16x16x32_bf16 v[120:123], v[208:211], v[228:231], v[120:123]
    ds_read_b64_tr_b16 v[204:205], v39 offset:8192
    ds_read_b64_tr_b16 v[206:207], v39 offset:8704
    v_mfma_f32_16x16x32_bf16 v[124:127], v[212:215], v[228:231], v[124:127]
    ds_read_b64_tr_b16 v[208:209], v36 offset:12288
    ds_read_b64_tr_b16 v[210:211], v36 offset:12800
    v_xor_b32 v36, 16384, v36
    v_mfma_f32_16x16x32_bf16 v[128:131], v[216:219], v[228:231], v[128:131]
    ds_read_b64_tr_b16 v[212:213], v37 offset:12288
    ds_read_b64_tr_b16 v[214:215], v37 offset:12800
    v_xor_b32 v37, 16384, v37
    v_mfma_f32_16x16x32_bf16 v[132:135], v[220:223], v[228:231], v[132:135]
    ds_read_b64_tr_b16 v[216:217], v38 offset:12288
    ds_read_b64_tr_b16 v[218:219], v38 offset:12800
    v_xor_b32 v38, 16384, v38
    buffer_load_dwordx4 v[228:231], v2, s[32:35], s20 offen offset:1024 sc1
    s_waitcnt vmcnt(7)
    s_waitcnt lgkmcnt(6)
    v_mfma_f32_16x16x32_bf16 v[120:123], v[192:195], v[232:235], v[120:123]
    ds_read_b64_tr_b16 v[220:221], v39 offset:12288
    ds_read_b64_tr_b16 v[222:223], v39 offset:12800
    v_xor_b32 v39, 16384, v39
    v_mfma_f32_16x16x32_bf16 v[124:127], v[196:199], v[232:235], v[124:127]
    ds_read_b64_tr_b16 v[192:193], v36
    ds_read_b64_tr_b16 v[194:195], v36 offset:512
    v_mfma_f32_16x16x32_bf16 v[128:131], v[200:203], v[232:235], v[128:131]
    ds_read_b64_tr_b16 v[196:197], v37
    ds_read_b64_tr_b16 v[198:199], v37 offset:512
    v_mfma_f32_16x16x32_bf16 v[132:135], v[204:207], v[232:235], v[132:135]
    ds_read_b64_tr_b16 v[200:201], v38
    ds_read_b64_tr_b16 v[202:203], v38 offset:512
    buffer_load_dwordx4 v[232:235], v2, s[32:35], s20 offen offset:2048 sc1
    s_waitcnt vmcnt(7)
    s_waitcnt lgkmcnt(6)
    v_mfma_f32_16x16x32_bf16 v[120:123], v[208:211], v[236:239], v[120:123]
    ds_read_b64_tr_b16 v[204:205], v39
    ds_read_b64_tr_b16 v[206:207], v39 offset:512
    v_mfma_f32_16x16x32_bf16 v[124:127], v[212:215], v[236:239], v[124:127]
    ds_read_b64_tr_b16 v[208:209], v36 offset:4096
    ds_read_b64_tr_b16 v[210:211], v36 offset:4608
    v_mfma_f32_16x16x32_bf16 v[128:131], v[216:219], v[236:239], v[128:131]
    ds_read_b64_tr_b16 v[212:213], v37 offset:4096
    ds_read_b64_tr_b16 v[214:215], v37 offset:4608
    v_mfma_f32_16x16x32_bf16 v[132:135], v[220:223], v[236:239], v[132:135]
    ds_read_b64_tr_b16 v[216:217], v38 offset:4096
    ds_read_b64_tr_b16 v[218:219], v38 offset:4608
    buffer_load_dwordx4 v[236:239], v2, s[32:35], s20 offen offset:3072 sc1
    s_waitcnt vmcnt(7)
    s_waitcnt lgkmcnt(6)
    v_mfma_f32_16x16x32_bf16 v[120:123], v[192:195], v[240:243], v[120:123]
    ds_read_b64_tr_b16 v[220:221], v39 offset:4096
    ds_read_b64_tr_b16 v[222:223], v39 offset:4608
    v_mfma_f32_16x16x32_bf16 v[124:127], v[196:199], v[240:243], v[124:127]
    ds_read_b64_tr_b16 v[192:193], v36 offset:8192
    ds_read_b64_tr_b16 v[194:195], v36 offset:8704
    v_mfma_f32_16x16x32_bf16 v[128:131], v[200:203], v[240:243], v[128:131]
    ds_read_b64_tr_b16 v[196:197], v37 offset:8192
    ds_read_b64_tr_b16 v[198:199], v37 offset:8704
    v_mfma_f32_16x16x32_bf16 v[132:135], v[204:207], v[240:243], v[132:135]
    ds_read_b64_tr_b16 v[200:201], v38 offset:8192
    ds_read_b64_tr_b16 v[202:203], v38 offset:8704
    s_xor_b32 s96, s17, 12288
    s_add_u32 s20, s96, s19
    buffer_load_dwordx4 v[240:243], v2, s[32:35], s20 offen sc1
    s_waitcnt vmcnt(7)
    s_waitcnt lgkmcnt(6)
    v_mfma_f32_16x16x32_bf16 v[120:123], v[208:211], v[244:247], v[120:123]
    ds_read_b64_tr_b16 v[204:205], v39 offset:8192
    ds_read_b64_tr_b16 v[206:207], v39 offset:8704
    v_mfma_f32_16x16x32_bf16 v[124:127], v[212:215], v[244:247], v[124:127]
    ds_read_b64_tr_b16 v[208:209], v36 offset:12288
    ds_read_b64_tr_b16 v[210:211], v36 offset:12800
    v_xor_b32 v36, 49152, v36
    v_mfma_f32_16x16x32_bf16 v[128:131], v[216:219], v[244:247], v[128:131]
    ds_read_b64_tr_b16 v[212:213], v37 offset:12288
    ds_read_b64_tr_b16 v[214:215], v37 offset:12800
    v_xor_b32 v37, 49152, v37
    v_mfma_f32_16x16x32_bf16 v[132:135], v[220:223], v[244:247], v[132:135]
    ds_read_b64_tr_b16 v[216:217], v38 offset:12288
    ds_read_b64_tr_b16 v[218:219], v38 offset:12800
    v_xor_b32 v38, 49152, v38
    buffer_load_dwordx4 v[244:247], v2, s[32:35], s20 offen offset:1024 sc1
    s_waitcnt vmcnt(7)
    s_waitcnt lgkmcnt(6)
    v_mfma_f32_16x16x32_bf16 v[120:123], v[192:195], v[44:47], v[120:123]
    ds_read_b64_tr_b16 v[220:221], v39 offset:12288
    ds_read_b64_tr_b16 v[222:223], v39 offset:12800
    v_xor_b32 v39, 49152, v39
    v_mfma_f32_16x16x32_bf16 v[124:127], v[196:199], v[44:47], v[124:127]
    ds_read_b64_tr_b16 v[192:193], v36
    ds_read_b64_tr_b16 v[194:195], v36 offset:512
    v_mfma_f32_16x16x32_bf16 v[128:131], v[200:203], v[44:47], v[128:131]
    ds_read_b64_tr_b16 v[196:197], v37
    ds_read_b64_tr_b16 v[198:199], v37 offset:512
    v_mfma_f32_16x16x32_bf16 v[132:135], v[204:207], v[44:47], v[132:135]
    ds_read_b64_tr_b16 v[200:201], v38
    ds_read_b64_tr_b16 v[202:203], v38 offset:512
    buffer_load_dwordx4 v[44:47], v2, s[32:35], s20 offen offset:2048 sc1
    s_waitcnt vmcnt(7)
    s_waitcnt lgkmcnt(6)
    v_mfma_f32_16x16x32_bf16 v[120:123], v[208:211], v[48:51], v[120:123]
    ds_read_b64_tr_b16 v[204:205], v39
    ds_read_b64_tr_b16 v[206:207], v39 offset:512
    v_mfma_f32_16x16x32_bf16 v[124:127], v[212:215], v[48:51], v[124:127]
    ds_read_b64_tr_b16 v[208:209], v36 offset:4096
    ds_read_b64_tr_b16 v[210:211], v36 offset:4608
    v_mfma_f32_16x16x32_bf16 v[128:131], v[216:219], v[48:51], v[128:131]
    ds_read_b64_tr_b16 v[212:213], v37 offset:4096
    ds_read_b64_tr_b16 v[214:215], v37 offset:4608
    v_mfma_f32_16x16x32_bf16 v[132:135], v[220:223], v[48:51], v[132:135]
    ds_read_b64_tr_b16 v[216:217], v38 offset:4096
    ds_read_b64_tr_b16 v[218:219], v38 offset:4608
    buffer_load_dwordx4 v[48:51], v2, s[32:35], s20 offen offset:3072 sc1
    s_waitcnt vmcnt(7)
    s_waitcnt lgkmcnt(6)
    v_mfma_f32_16x16x32_bf16 v[120:123], v[192:195], v[224:227], v[120:123]
    ds_read_b64_tr_b16 v[220:221], v39 offset:4096
    ds_read_b64_tr_b16 v[222:223], v39 offset:4608
    v_mfma_f32_16x16x32_bf16 v[124:127], v[196:199], v[224:227], v[124:127]
    ds_read_b64_tr_b16 v[192:193], v36 offset:8192
    ds_read_b64_tr_b16 v[194:195], v36 offset:8704
    v_mfma_f32_16x16x32_bf16 v[128:131], v[200:203], v[224:227], v[128:131]
    ds_read_b64_tr_b16 v[196:197], v37 offset:8192
    ds_read_b64_tr_b16 v[198:199], v37 offset:8704
    v_mfma_f32_16x16x32_bf16 v[132:135], v[204:207], v[224:227], v[132:135]
    ds_read_b64_tr_b16 v[200:201], v38 offset:8192
    ds_read_b64_tr_b16 v[202:203], v38 offset:8704
    s_xor_b32 s96, s17, 16384
    s_add_u32 s20, s96, s19
    buffer_load_dwordx4 v[224:227], v2, s[32:35], s20 offen sc1
    s_waitcnt vmcnt(7)
    s_waitcnt lgkmcnt(6)
    v_mfma_f32_16x16x32_bf16 v[120:123], v[208:211], v[228:231], v[120:123]
    ds_read_b64_tr_b16 v[204:205], v39 offset:8192
    ds_read_b64_tr_b16 v[206:207], v39 offset:8704
    v_mfma_f32_16x16x32_bf16 v[124:127], v[212:215], v[228:231], v[124:127]
    ds_read_b64_tr_b16 v[208:209], v36 offset:12288
    ds_read_b64_tr_b16 v[210:211], v36 offset:12800
    v_xor_b32 v36, 16384, v36
    v_mfma_f32_16x16x32_bf16 v[128:131], v[216:219], v[228:231], v[128:131]
    ds_read_b64_tr_b16 v[212:213], v37 offset:12288
    ds_read_b64_tr_b16 v[214:215], v37 offset:12800
    v_xor_b32 v37, 16384, v37
    v_mfma_f32_16x16x32_bf16 v[132:135], v[220:223], v[228:231], v[132:135]
    ds_read_b64_tr_b16 v[216:217], v38 offset:12288
    ds_read_b64_tr_b16 v[218:219], v38 offset:12800
    v_xor_b32 v38, 16384, v38
    buffer_load_dwordx4 v[228:231], v2, s[32:35], s20 offen offset:1024 sc1
    s_waitcnt vmcnt(7)
    s_waitcnt lgkmcnt(6)
    v_mfma_f32_16x16x32_bf16 v[120:123], v[192:195], v[232:235], v[120:123]
    ds_read_b64_tr_b16 v[220:221], v39 offset:12288
    ds_read_b64_tr_b16 v[222:223], v39 offset:12800
    v_xor_b32 v39, 16384, v39
    v_mfma_f32_16x16x32_bf16 v[124:127], v[196:199], v[232:235], v[124:127]
    ds_read_b64_tr_b16 v[192:193], v36
    ds_read_b64_tr_b16 v[194:195], v36 offset:512
    v_mfma_f32_16x16x32_bf16 v[128:131], v[200:203], v[232:235], v[128:131]
    ds_read_b64_tr_b16 v[196:197], v37
    ds_read_b64_tr_b16 v[198:199], v37 offset:512
    v_mfma_f32_16x16x32_bf16 v[132:135], v[204:207], v[232:235], v[132:135]
    ds_read_b64_tr_b16 v[200:201], v38
    ds_read_b64_tr_b16 v[202:203], v38 offset:512
    buffer_load_dwordx4 v[232:235], v2, s[32:35], s20 offen offset:2048 sc1
    s_waitcnt vmcnt(7)
    s_waitcnt lgkmcnt(6)
    v_mfma_f32_16x16x32_bf16 v[120:123], v[208:211], v[236:239], v[120:123]
    ds_read_b64_tr_b16 v[204:205], v39
    ds_read_b64_tr_b16 v[206:207], v39 offset:512
    v_mfma_f32_16x16x32_bf16 v[124:127], v[212:215], v[236:239], v[124:127]
    ds_read_b64_tr_b16 v[208:209], v36 offset:4096
    ds_read_b64_tr_b16 v[210:211], v36 offset:4608
    v_mfma_f32_16x16x32_bf16 v[128:131], v[216:219], v[236:239], v[128:131]
    ds_read_b64_tr_b16 v[212:213], v37 offset:4096
    ds_read_b64_tr_b16 v[214:215], v37 offset:4608
    v_mfma_f32_16x16x32_bf16 v[132:135], v[220:223], v[236:239], v[132:135]
    ds_read_b64_tr_b16 v[216:217], v38 offset:4096
    ds_read_b64_tr_b16 v[218:219], v38 offset:4608
    buffer_load_dwordx4 v[236:239], v2, s[32:35], s20 offen offset:3072 sc1
    s_waitcnt vmcnt(7)
    s_waitcnt lgkmcnt(6)
    v_mfma_f32_16x16x32_bf16 v[120:123], v[192:195], v[240:243], v[120:123]
    ds_read_b64_tr_b16 v[220:221], v39 offset:4096
    ds_read_b64_tr_b16 v[222:223], v39 offset:4608
    v_mfma_f32_16x16x32_bf16 v[124:127], v[196:199], v[240:243], v[124:127]
    ds_read_b64_tr_b16 v[192:193], v36 offset:8192
    ds_read_b64_tr_b16 v[194:195], v36 offset:8704
    v_mfma_f32_16x16x32_bf16 v[128:131], v[200:203], v[240:243], v[128:131]
    ds_read_b64_tr_b16 v[196:197], v37 offset:8192
    ds_read_b64_tr_b16 v[198:199], v37 offset:8704
    v_mfma_f32_16x16x32_bf16 v[132:135], v[204:207], v[240:243], v[132:135]
    ds_read_b64_tr_b16 v[200:201], v38 offset:8192
    ds_read_b64_tr_b16 v[202:203], v38 offset:8704
    s_xor_b32 s96, s17, 20480
    s_add_u32 s20, s96, s19
    buffer_load_dwordx4 v[240:243], v2, s[32:35], s20 offen sc1
    s_waitcnt vmcnt(7)
    s_waitcnt lgkmcnt(6)
    v_mfma_f32_16x16x32_bf16 v[120:123], v[208:211], v[244:247], v[120:123]
    ds_read_b64_tr_b16 v[204:205], v39 offset:8192
    ds_read_b64_tr_b16 v[206:207], v39 offset:8704
    v_mfma_f32_16x16x32_bf16 v[124:127], v[212:215], v[244:247], v[124:127]
    ds_read_b64_tr_b16 v[208:209], v36 offset:12288
    ds_read_b64_tr_b16 v[210:211], v36 offset:12800
    v_xor_b32 v36, 114688, v36
    v_mfma_f32_16x16x32_bf16 v[128:131], v[216:219], v[244:247], v[128:131]
    ds_read_b64_tr_b16 v[212:213], v37 offset:12288
    ds_read_b64_tr_b16 v[214:215], v37 offset:12800
    v_xor_b32 v37, 114688, v37
    v_mfma_f32_16x16x32_bf16 v[132:135], v[220:223], v[244:247], v[132:135]
    ds_read_b64_tr_b16 v[216:217], v38 offset:12288
    ds_read_b64_tr_b16 v[218:219], v38 offset:12800
    v_xor_b32 v38, 114688, v38
    buffer_load_dwordx4 v[244:247], v2, s[32:35], s20 offen offset:1024 sc1
L_PAD8:
    s_cbranch_execz L_RET8
    s_waitcnt vmcnt(7)
    s_waitcnt lgkmcnt(6)
    v_mfma_f32_16x16x32_bf16 v[120:123], v[192:195], v[44:47], v[120:123]
    ds_read_b64_tr_b16 v[220:221], v39 offset:12288
    ds_read_b64_tr_b16 v[222:223], v39 offset:12800
    v_xor_b32 v39, 114688, v39
    v_mfma_f32_16x16x32_bf16 v[124:127], v[196:199], v[44:47], v[124:127]
    ds_read_b64_tr_b16 v[192:193], v36
    ds_read_b64_tr_b16 v[194:195], v36 offset:512
    v_mfma_f32_16x16x32_bf16 v[128:131], v[200:203], v[44:47], v[128:131]
    ds_read_b64_tr_b16 v[196:197], v37
    ds_read_b64_tr_b16 v[198:199], v37 offset:512
    v_mfma_f32_16x16x32_bf16 v[132:135], v[204:207], v[44:47], v[132:135]
    ds_read_b64_tr_b16 v[200:201], v38
    ds_read_b64_tr_b16 v[202:203], v38 offset:512
    buffer_load_dwordx4 v[44:47], v2, s[32:35], s20 offen offset:2048 sc1
    s_waitcnt vmcnt(7)
    s_waitcnt lgkmcnt(6)
    v_mfma_f32_16x16x32_bf16 v[120:123], v[208:211], v[48:51], v[120:123]
    ds_read_b64_tr_b16 v[204:205], v39
    ds_read_b64_tr_b16 v[206:207], v39 offset:512
    v_mfma_f32_16x16x32_bf16 v[124:127], v[212:215], v[48:51], v[124:127]
    ds_read_b64_tr_b16 v[208:209], v36 offset:4096
    ds_read_b64_tr_b16 v[210:211], v36 offset:4608
    v_mfma_f32_16x16x32_bf16 v[128:131], v[216:219], v[48:51], v[128:131]
    ds_read_b64_tr_b16 v[212:213], v37 offset:4096
    ds_read_b64_tr_b16 v[214:215], v37 offset:4608
    v_mfma_f32_16x16x32_bf16 v[132:135], v[220:223], v[48:51], v[132:135]
    ds_read_b64_tr_b16 v[216:217], v38 offset:4096
    ds_read_b64_tr_b16 v[218:219], v38 offset:4608
    buffer_load_dwordx4 v[48:51], v2, s[32:35], s20 offen offset:3072 sc1
    s_waitcnt vmcnt(7)
    s_waitcnt lgkmcnt(6)
    v_mfma_f32_16x16x32_bf16 v[120:123], v[192:195], v[224:227], v[120:123]
    ds_read_b64_tr_b16 v[220:221], v39 offset:4096
    ds_read_b64_tr_b16 v[222:223], v39 offset:4608
    v_mfma_f32_16x16x32_bf16 v[124:127], v[196:199], v[224:227], v[124:127]
    ds_read_b64_tr_b16 v[192:193], v36 offset:8192
    ds_read_b64_tr_b16 v[194:195], v36 offset:8704
    v_mfma_f32_16x16x32_bf16 v[128:131], v[200:203], v[224:227], v[128:131]
    ds_read_b64_tr_b16 v[196:197], v37 offset:8192
    ds_read_b64_tr_b16 v[198:199], v37 offset:8704
    v_mfma_f32_16x16x32_bf16 v[132:135], v[204:207], v[224:227], v[132:135]
    ds_read_b64_tr_b16 v[200:201], v38 offset:8192
    ds_read_b64_tr_b16 v[202:203], v38 offset:8704
    s_xor_b32 s96, s17, 24576
    s_add_u32 s20, s96, s19
    buffer_load_dwordx4 v[224:227], v2, s[32:35], s20 offen sc1
    s_waitcnt vmcnt(7)
    s_waitcnt lgkmcnt(6)
    v_mfma_f32_16x16x32_bf16 v[120:123], v[208:211], v[228:231], v[120:123]
    ds_read_b64_tr_b16 v[204:205], v39 offset:8192
    ds_read_b64_tr_b16 v[206:207], v39 offset:8704
    v_mfma_f32_16x16x32_bf16 v[124:127], v[212:215], v[228:231], v[124:127]
    ds_read_b64_tr_b16 v[208:209], v36 offset:12288
    ds_read_b64_tr_b16 v[210:211], v36 offset:12800
    v_xor_b32 v36, 16384, v36
    v_mfma_f32_16x16x32_bf16 v[128:131], v[216:219], v[228:231], v[128:131]
    ds_read_b64_tr_b16 v[212:213], v37 offset:12288
    ds_read_b64_tr_b16 v[214:215], v37 offset:12800
    v_xor_b32 v37, 16384, v37
    v_mfma_f32_16x16x32_bf16 v[132:135], v[220:223], v[228:231], v[132:135]
    ds_read_b64_tr_b16 v[216:217], v38 offset:12288
    ds_read_b64_tr_b16 v[218:219], v38 offset:12800
    v_xor_b32 v38, 16384, v38
    buffer_load_dwordx4 v[228:231], v2, s[32:35], s20 offen offset:1024 sc1
    s_waitcnt vmcnt(7)
    s_waitcnt lgkmcnt(6)
    v_mfma_f32_16x16x32_bf16 v[120:123], v[192:195], v[232:235], v[120:123]
    ds_read_b64_tr_b16 v[220:221], v39 offset:12288
    ds_read_b64_tr_b16 v[222:223], v39 offset:12800
    v_xor_b32 v39, 16384, v39
    v_mfma_f32_16x16x32_bf16 v[124:127], v[196:199], v[232:235], v[124:127]
    ds_read_b64_tr_b16 v[192:193], v36
    ds_read_b64_tr_b16 v[194:195], v36 offset:512
    v_mfma_f32_16x16x32_bf16 v[128:131], v[200:203], v[232:235], v[128:131]
    ds_read_b64_tr_b16 v[196:197], v37
    ds_read_b64_tr_b16 v[198:199], v37 offset:512
    v_mfma_f32_16x16x32_bf16 v[132:135], v[204:207], v[232:235], v[132:135]
    ds_read_b64_tr_b16 v[200:201], v38
    ds_read_b64_tr_b16 v[202:203], v38 offset:512
    buffer_load_dwordx4 v[232:235], v2, s[32:35], s20 offen offset:2048 sc1
    s_waitcnt vmcnt(7)
    s_waitcnt lgkmcnt(6)
    v_mfma_f32_16x16x32_bf16 v[120:123], v[208:211], v[236:239], v[120:123]
    ds_read_b64_tr_b16 v[204:205], v39
    ds_read_b64_tr_b16 v[206:207], v39 offset:512
    v_mfma_f32_16x16x32_bf16 v[124:127], v[212:215], v[236:239], v[124:127]
    ds_read_b64_tr_b16 v[208:209], v36 offset:4096
    ds_read_b64_tr_b16 v[210:211], v36 offset:4608
    v_mfma_f32_16x16x32_bf16 v[128:131], v[216:219], v[236:239], v[128:131]
    ds_read_b64_tr_b16 v[212:213], v37 offset:4096
    ds_read_b64_tr_b16 v[214:215], v37 offset:4608
    v_mfma_f32_16x16x32_bf16 v[132:135], v[220:223], v[236:239], v[132:135]
    ds_read_b64_tr_b16 v[216:217], v38 offset:4096
    ds_read_b64_tr_b16 v[218:219], v38 offset:4608
    buffer_load_dwordx4 v[236:239], v2, s[32:35], s20 offen offset:3072 sc1
    s_waitcnt vmcnt(7)
    s_waitcnt lgkmcnt(6)
    v_mfma_f32_16x16x32_bf16 v[120:123], v[192:195], v[240:243], v[120:123]
    ds_read_b64_tr_b16 v[220:221], v39 offset:4096
    ds_read_b64_tr_b16 v[222:223], v39 offset:4608
    v_mfma_f32_16x16x32_bf16 v[124:127], v[196:199], v[240:243], v[124:127]
    ds_read_b64_tr_b16 v[192:193], v36 offset:8192
    ds_read_b64_tr_b16 v[194:195], v36 offset:8704
    v_mfma_f32_16x16x32_bf16 v[128:131], v[200:203], v[240:243], v[128:131]
    ds_read_b64_tr_b16 v[196:197], v37 offset:8192
    ds_read_b64_tr_b16 v[198:199], v37 offset:8704
    v_mfma_f32_16x16x32_bf16 v[132:135], v[204:207], v[240:243], v[132:135]
    ds_read_b64_tr_b16 v[200:201], v38 offset:8192
    ds_read_b64_tr_b16 v[202:203], v38 offset:8704
    s_xor_b32 s96, s17, 28672
    s_add_u32 s20, s96, s19
    buffer_load_dwordx4 v[240:243], v2, s[32:35], s20 offen sc1
    s_waitcnt vmcnt(7)
    s_waitcnt lgkmcnt(6)
    v_mfma_f32_16x16x32_bf16 v[120:123], v[208:211], v[244:247], v[120:123]
    ds_read_b64_tr_b16 v[204:205], v39 offset:8192
    ds_read_b64_tr_b16 v[206:207], v39 offset:8704
    v_mfma_f32_16x16x32_bf16 v[124:127], v[212:215], v[244:247], v[124:127]
    ds_read_b64_tr_b16 v[208:209], v36 offset:12288
    ds_read_b64_tr_b16 v[210:211], v36 offset:12800
    v_xor_b32 v36, 49152, v36
    v_mfma_f32_16x16x32_bf16 v[128:131], v[216:219], v[244:247], v[128:131]
    ds_read_b64_tr_b16 v[212:213], v37 offset:12288
    ds_read_b64_tr_b16 v[214:215], v37 offset:12800
    v_xor_b32 v37, 49152, v37
    v_mfma_f32_16x16x32_bf16 v[132:135], v[220:223], v[244:247], v[132:135]
    ds_read_b64_tr_b16 v[216:217], v38 offset:12288
    ds_read_b64_tr_b16 v[218:219], v38 offset:12800
    v_xor_b32 v38, 49152, v38
    buffer_load_dwordx4 v[244:247], v2, s[32:35], s20 offen offset:1024 sc1
    s_waitcnt vmcnt(7)
    s_waitcnt lgkmcnt(6)
    v_mfma_f32_16x16x32_bf16 v[120:123], v[192:195], v[44:47], v[120:123]
    ds_read_b64_tr_b16 v[220:221], v39 offset:12288
    ds_read_b64_tr_b16 v[222:223], v39 offset:12800
    v_xor_b32 v39, 49152, v39
    v_mfma_f32_16x16x32_bf16 v[124:127], v[196:199], v[44:47], v[124:127]
    ds_read_b64_tr_b16 v[192:193], v36
    ds_read_b64_tr_b16 v[194:195], v36 offset:512
    v_mfma_f32_16x16x32_bf16 v[128:131], v[200:203], v[44:47], v[128:131]
    ds_read_b64_tr_b16 v[196:197], v37
    ds_read_b64_tr_b16 v[198:199], v37 offset:512
    v_mfma_f32_16x16x32_bf16 v[132:135], v[204:207], v[44:47], v[132:135]
    ds_read_b64_tr_b16 v[200:201], v38
    ds_read_b64_tr_b16 v[202:203], v38 offset:512
    buffer_load_dwordx4 v[44:47], v2, s[32:35], s20 offen offset:2048 sc1
    s_waitcnt vmcnt(7)
    s_waitcnt lgkmcnt(6)
    v_mfma_f32_16x16x32_bf16 v[120:123], v[208:211], v[48:51], v[120:123]
    ds_read_b64_tr_b16 v[204:205], v39
    ds_read_b64_tr_b16 v[206:207], v39 offset:512
    v_mfma_f32_16x16x32_bf16 v[124:127], v[212:215], v[48:51], v[124:127]
    ds_read_b64_tr_b16 v[208:209], v36 offset:4096
    ds_read_b64_tr_b16 v[210:211], v36 offset:4608
    v_mfma_f32_16x16x32_bf16 v[128:131], v[216:219], v[48:51], v[128:131]
    ds_read_b64_tr_b16 v[212:213], v37 offset:4096
    ds_read_b64_tr_b16 v[214:215], v37 offset:4608
    v_mfma_f32_16x16x32_bf16 v[132:135], v[220:223], v[48:51], v[132:135]
    ds_read_b64_tr_b16 v[216:217], v38 offset:4096
    ds_read_b64_tr_b16 v[218:219], v38 offset:4608
    buffer_load_dwordx4 v[48:51], v2, s[32:35], s20 offen offset:3072 sc1
    buffer_load_dwordx2 v[40:41], v10, s[32:35], s13 offen sc1
    s_add_u32 s82, s80, 114688
    buffer_load_dwordx4 v[72:75], v27, s[52:55], s82 offen nt
    s_add_u32 s82, s80, 172032
    buffer_load_dwordx4 v[76:79], v27, s[52:55], s82 offen nt
    s_waitcnt vmcnt(10)
    s_waitcnt lgkmcnt(6)
    v_mfma_f32_16x16x32_bf16 v[120:123], v[192:195], v[224:227], v[120:123]
    ds_read_b64_tr_b16 v[220:221], v39 offset:4096
    ds_read_b64_tr_b16 v[222:223], v39 offset:4608
    v_mfma_f32_16x16x32_bf16 v[124:127], v[196:199], v[224:227], v[124:127]
    ds_read_b64_tr_b16 v[192:193], v36 offset:8192
    ds_read_b64_tr_b16 v[194:195], v36 offset:8704
    v_mfma_f32_16x16x32_bf16 v[128:131], v[200:203], v[224:227], v[128:131]
    ds_read_b64_tr_b16 v[196:197], v37 offset:8192
    ds_read_b64_tr_b16 v[198:199], v37 offset:8704
    v_mfma_f32_16x16x32_bf16 v[132:135], v[204:207], v[224:227], v[132:135]
    ds_read_b64_tr_b16 v[200:201], v38 offset:8192
    ds_read_b64_tr_b16 v[202:203], v38 offset:8704
    s_waitcnt vmcnt(9)
    s_waitcnt lgkmcnt(6)
    v_mfma_f32_16x16x32_bf16 v[120:123], v[208:211], v[228:231], v[120:123]
    ds_read_b64_tr_b16 v[204:205], v39 offset:8192
    ds_read_b64_tr_b16 v[206:207], v39 offset:8704
    v_mfma_f32_16x16x32_bf16 v[124:127], v[212:215], v[228:231], v[124:127]
    ds_read_b64_tr_b16 v[208:209], v36 offset:12288
    ds_read_b64_tr_b16 v[210:211], v36 offset:12800
    v_xor_b32 v36, 16384, v36
    v_mfma_f32_16x16x32_bf16 v[128:131], v[216:219], v[228:231], v[128:131]
    ds_read_b64_tr_b16 v[212:213], v37 offset:12288
    ds_read_b64_tr_b16 v[214:215], v37 offset:12800
    v_xor_b32 v37, 16384, v37
    v_mfma_f32_16x16x32_bf16 v[132:135], v[220:223], v[228:231], v[132:135]
    ds_read_b64_tr_b16 v[216:217], v38 offset:12288
    ds_read_b64_tr_b16 v[218:219], v38 offset:12800
    v_xor_b32 v38, 16384, v38
    s_waitcnt vmcnt(8)
    s_waitcnt lgkmcnt(6)
    v_mfma_f32_16x16x32_bf16 v[120:123], v[192:195], v[232:235], v[120:123]
    ds_read_b64_tr_b16 v[220:221], v39 offset:12288
    ds_read_b64_tr_b16 v[222:223], v39 offset:12800
    v_xor_b32 v39, 16384, v39
    v_mfma_f32_16x16x32_bf16 v[124:127], v[196:199], v[232:235], v[124:127]
    ds_read_b64_tr_b16 v[192:193], v36
    ds_read_b64_tr_b16 v[194:195], v36 offset:512
    v_mfma_f32_16x16x32_bf16 v[128:131], v[200:203], v[232:235], v[128:131]
    ds_read_b64_tr_b16 v[196:197], v37
    ds_read_b64_tr_b16 v[198:199], v37 offset:512
    v_mfma_f32_16x16x32_bf16 v[132:135], v[204:207], v[232:235], v[132:135]
    ds_read_b64_tr_b16 v[200:201], v38
    ds_read_b64_tr_b16 v[202:203], v38 offset:512
    s_waitcnt vmcnt(7)
    s_waitcnt lgkmcnt(6)
    v_mfma_f32_16x16x32_bf16 v[120:123], v[208:211], v[236:239], v[120:123]
    ds_read_b64_tr_b16 v[204:205], v39
    ds_read_b64_tr_b16 v[206:207], v39 offset:512
    v_mfma_f32_16x16x32_bf16 v[124:127], v[212:215], v[236:239], v[124:127]
    ds_read_b64_tr_b16 v[208:209], v36 offset:4096
    ds_read_b64_tr_b16 v[210:211], v36 offset:4608
    v_mfma_f32_16x16x32_bf16 v[128:131], v[216:219], v[236:239], v[128:131]
    ds_read_b64_tr_b16 v[212:213], v37 offset:4096
    ds_read_b64_tr_b16 v[214:215], v37 offset:4608
    v_mfma_f32_16x16x32_bf16 v[132:135], v[220:223], v[236:239], v[132:135]
    ds_read_b64_tr_b16 v[216:217], v38 offset:4096
    ds_read_b64_tr_b16 v[218:219], v38 offset:4608
    s_cmp_lt_u32 s3, 4
    s_cbranch_scc1 L_G2P28
    s_setprio 0
L_G2P28:
    s_waitcnt vmcnt(6)
    s_waitcnt lgkmcnt(6)
    v_mfma_f32_16x16x32_bf16 v[120:123], v[192:195], v[240:243], v[120:123]
    ds_read_b64_tr_b16 v[220:221], v39 offset:4096
    ds_read_b64_tr_b16 v[222:223], v39 offset:4608
    v_mfma_f32_16x16x32_bf16 v[124:127], v[196:199], v[240:243], v[124:127]
    ds_read_b64_tr_b16 v[192:193], v36 offset:8192
    ds_read_b64_tr_b16 v[194:195], v36 offset:8704
    v_mfma_f32_16x16x32_bf16 v[128:131], v[200:203], v[240:243], v[128:131]
    ds_read_b64_tr_b16 v[196:197], v37 offset:8192
    ds_read_b64_tr_b16 v[198:199], v37 offset:8704
    v_mfma_f32_16x16x32_bf16 v[132:135], v[204:207], v[240:243], v[132:135]
    ds_read_b64_tr_b16 v[200:201], v38 offset:8192
    ds_read_b64_tr_b16 v[202:203], v38 offset:8704
    s_waitcnt vmcnt(5)
    s_waitcnt lgkmcnt(6)
    v_mfma_f32_16x16x32_bf16 v[120:123], v[208:211], v[244:247], v[120:123]
    ds_read_b64_tr_b16 v[204:205], v39 offset:8192
    ds_read_b64_tr_b16 v[206:207], v39 offset:8704
    v_mfma_f32_16x16x32_bf16 v[124:127], v[212:215], v[244:247], v[124:127]
    ds_read_b64_tr_b16 v[208:209], v36 offset:12288
    ds_read_b64_tr_b16 v[210:211], v36 offset:12800
    v_mfma_f32_16x16x32_bf16 v[128:131], v[216:219], v[244:247], v[128:131]
    ds_read_b64_tr_b16 v[212:213], v37 offset:12288
    ds_read_b64_tr_b16 v[214:215], v37 offset:12800
    v_mfma_f32_16x16x32_bf16 v[132:135], v[220:223], v[244:247], v[132:135]
    ds_read_b64_tr_b16 v[216:217], v38 offset:12288
    ds_read_b64_tr_b16 v[218:219], v38 offset:12800
    s_waitcnt vmcnt(4)
    s_waitcnt lgkmcnt(6)
    v_mfma_f32_16x16x32_bf16 v[120:123], v[192:195], v[44:47], v[120:123]
    ds_read_b64_tr_b16 v[220:221], v39 offset:12288
    ds_read_b64_tr_b16 v[222:223], v39 offset:12800
    v_mfma_f32_16x16x32_bf16 v[124:127], v[196:199], v[44:47], v[124:127]
    v_mfma_f32_16x16x32_bf16 v[128:131], v[200:203], v[44:47], v[128:131]
    v_mfma_f32_16x16x32_bf16 v[132:135], v[204:207], v[44:47], v[132:135]
    s_waitcnt vmcnt(3)
    s_waitcnt lgkmcnt(0)
    v_mfma_f32_16x16x32_bf16 v[120:123], v[208:211], v[48:51], v[120:123]
    v_mfma_f32_16x16x32_bf16 v[124:127], v[212:215], v[48:51], v[124:127]
    v_mfma_f32_16x16x32_bf16 v[128:131], v[216:219], v[48:51], v[128:131]
    v_mfma_f32_16x16x32_bf16 v[132:135], v[220:223], v[48:51], v[132:135]
    s_lshl3_add_u32 s96, s21, s3
    s_lshl4_add_u32 s97, s96, s12
    s_lshl_b32 s98, s97, 8
    s_add_u32 s14, s98, 12582912
    v_and_b32 v28, 15, v1
    v_lshlrev_b32 v28, 4, v28
    v_lshrrev_b32 v9, 4, v1
    v_lshl_add_u32 v28, v9, 2, v28
    v_cvt_pk_bf16_f32 v120, 0, v120
    v_cvt_pk_bf16_f32 v121, 0, v121
    v_cvt_pk_bf16_f32 v122, 0, v122
    v_cvt_pk_bf16_f32 v123, 0, v123
    v_cvt_pk_bf16_f32 v124, 0, v124
    v_cvt_pk_bf16_f32 v125, 0, v125
    v_cvt_pk_bf16_f32 v126, 0, v126
    v_cvt_pk_bf16_f32 v127, 0, v127
    v_pk_mul_f32 v[120:121], v[120:121], v[136:137]
    v_pk_mul_f32 v[122:123], v[122:123], v[138:139]
    v_pk_mul_f32 v[124:125], v[124:125], v[140:141]
    v_pk_mul_f32 v[126:127], v[126:127], v[142:143]
    v_cvt_pk_bf16_f32 v120, 0, v120
    v_cvt_pk_bf16_f32 v121, 0, v121
    v_cvt_pk_bf16_f32 v122, 0, v122
    v_cvt_pk_bf16_f32 v123, 0, v123
    v_cvt_pk_bf16_f32 v124, 0, v124
    v_cvt_pk_bf16_f32 v125, 0, v125
    v_cvt_pk_bf16_f32 v126, 0, v126
    v_cvt_pk_bf16_f32 v127, 0, v127
    v_pk_add_f32 v[120:121], v[120:121], v[152:153]
    v_pk_add_f32 v[122:123], v[122:123], v[154:155]
    v_pk_add_f32 v[124:125], v[124:125], v[156:157]
    v_pk_add_f32 v[126:127], v[126:127], v[158:159]
    v_cvt_pk_bf16_f32 v12, v120, v121
    v_cvt_pk_bf16_f32 v13, v122, v123
    v_cvt_pk_bf16_f32 v14, v124, v125
    v_cvt_pk_bf16_f32 v15, v126, v127
    v_dot2_f32_bf16 v4, v12, v12, 0
    v_dot2_f32_bf16 v5, v13, v13, 0
    v_dot2_f32_bf16 v4, v14, v14, v4
    v_dot2_f32_bf16 v5, v15, v15, v5
    v_mfma_f32_16x16x32_bf16 v[240:243], v[184:187], v[12:15], 0
    v_cvt_pk_bf16_f32 v128, 0, v128
    v_cvt_pk_bf16_f32 v129, 0, v129
    v_cvt_pk_bf16_f32 v130, 0, v130
    v_cvt_pk_bf16_f32 v131, 0, v131
    v_cvt_pk_bf16_f32 v132, 0, v132
    v_cvt_pk_bf16_f32 v133, 0, v133
    v_cvt_pk_bf16_f32 v134, 0, v134
    v_cvt_pk_bf16_f32 v135, 0, v135
    v_pk_mul_f32 v[128:129], v[128:129], v[144:145]
    v_pk_mul_f32 v[130:131], v[130:131], v[146:147]
    v_pk_mul_f32 v[132:133], v[132:133], v[148:149]
    v_pk_mul_f32 v[134:135], v[134:135], v[150:151]
    v_cvt_pk_bf16_f32 v128, 0, v128
    v_cvt_pk_bf16_f32 v129, 0, v129
    v_cvt_pk_bf16_f32 v130, 0, v130
    v_cvt_pk_bf16_f32 v131, 0, v131
    v_cvt_pk_bf16_f32 v132, 0, v132
    v_cvt_pk_bf16_f32 v133, 0, v133
    v_cvt_pk_bf16_f32 v134, 0, v134
    v_cvt_pk_bf16_f32 v135, 0, v135
    v_pk_add_f32 v[128:129], v[128:129], v[160:161]
    v_pk_add_f32 v[130:131], v[130:131], v[162:163]
    v_pk_add_f32 v[132:133], v[132:133], v[164:165]
    v_pk_add_f32 v[134:135], v[134:135], v[166:167]
    v_cvt_pk_bf16_f32 v16, v128, v129
    v_cvt_pk_bf16_f32 v17, v130, v131
    v_cvt_pk_bf16_f32 v18, v132, v133
    v_cvt_pk_bf16_f32 v19, v134, v135
    v_dot2_f32_bf16 v4, v16, v16, v4
    v_dot2_f32_bf16 v5, v17, v17, v5
    v_dot2_f32_bf16 v4, v18, v18, v4
    v_dot2_f32_bf16 v5, v19, v19, v5
    v_mfma_f32_16x16x32_bf16 v[240:243], v[188:191], v[16:19], v[240:243]
    v_and_b32 v7, 7, v1
    v_lshlrev_b32 v7, 15, v7
    v_bfe_u32 v9, v1, 3, 1
    v_lshl_add_u32 v7, v9, 12, v7
    v_add_f32 v4, v4, v5
    v_mov_b32 v5, v4
    s_nop 1
    v_permlane32_swap_b32 v4, v5
    v_add_f32 v4, v4, v5
    v_mov_b32 v5, v4
    s_nop 1
    v_permlane16_swap_b32 v4, v5
    v_add_f32 v4, v4, v5
    s_nop 1
    v_mov_b32_dpp v240, v4 quad_perm:[0,1,2,3] row_mask:0x8 bank_mask:0xf
    buffer_store_dword v240, v28, s[32:35], s14 offen sc1
    s_and_b32 s96, s12, 1
    s_lshr_b32 s97, s21, 2
    s_and_b32 s98, s21, 3
    s_lshl_b32 s99, s98, 6
    s_lshl1_add_u32 s98, s97, s99
    s_lshl_b32 s97, s98, 12
    s_lshr_b32 s99, s12, 1
    s_lshl_b32 s98, s99, 6
    s_add_u32 s99, s97, s98
    s_lshl2_add_u32 s97, s96, s99
    s_add_u32 s98, s97, 1048576
    s_add_u32 s16, s98, 1536
    s_barrier
    s_cmp_lg_u32 s3, 0
    s_cbranch_scc1 L_PE
    v_mov_b32 v6, s4
    s_mov_b32 exec_hi, 0
    s_mov_b32 exec_lo, 65535
    buffer_store_dword v6, v7, s[32:35], s16 offen sc1
    s_mov_b64 exec, -1
L_PE:
    s_mov_b32 s82, s80
    s_lshl2_add_u32 m0, s83, 32768
    s_nop 0
    buffer_load_dwordx4 v27, s[56:59], s82 offen nt lds
    s_add_u32 s82, s80, 57344
    s_lshl2_add_u32 m0, s83, 33792
    s_nop 0
    buffer_load_dwordx4 v27, s[56:59], s82 offen nt lds
    s_lshl_b32 s15, s3, 12
    v_add_u32 v4, s15, v2
    v_add_u32 v7, 65536, v4
    s_waitcnt vmcnt(5)
    v_cmp_ne_u32 vcc, s4, v41
    s_cbranch_vccz L_UPOK
POLL_31:
    buffer_load_dwordx2 v[40:41], v10, s[32:35], s13 offen sc1
    s_waitcnt vmcnt(0)
    v_cmp_ne_u32 vcc, s4, v41
    s_cbranch_vccz PDONE_32
    s_add_u32 s5, s5, 1
    s_cmp_lt_u32 s5, 200000
    s_cbranch_scc1 POLL_31
PDONE_32:
L_UPOK:
    s_lshl3_add_u32 s96, s21, s3
    s_lshl_b32 s97, s96, 12
    s_add_u32 s14, s97, 12582912
    s_load_dwordx2 s[24:25], s[32:33], s92 offset:1536 glc
    v_add_f32_dpp v40, v40, v40 quad_perm:[1,0,3,2] row_mask:0xf bank_mask:0xf
    s_nop 1
    v_add_f32_dpp v40, v40, v40 quad_perm:[2,3,0,1] row_mask:0xf bank_mask:0xf
    s_nop 1
    v_add_f32_dpp v40, v40, v40 row_half_mirror row_mask:0xf bank_mask:0xf
    s_nop 1
    v_add_f32_dpp v40, v40, v40 row_mirror row_mask:0xf bank_mask:0xf
    v_lshlrev_b32 v152, 16, v12
    v_and_b32 v153, s6, v12
    v_lshlrev_b32 v154, 16, v13
    v_and_b32 v155, s6, v13
    v_lshlrev_b32 v156, 16, v14
    v_and_b32 v157, s6, v14
    v_lshlrev_b32 v158, 16, v15
    v_and_b32 v159, s6, v15
    v_lshlrev_b32 v160, 16, v16
    v_and_b32 v161, s6, v16
    v_lshlrev_b32 v162, 16, v17
    v_and_b32 v163, s6, v17
    v_lshlrev_b32 v164, 16, v18
    v_and_b32 v165, s6, v18
    v_lshlrev_b32 v166, 16, v19
    v_and_b32 v167, s6, v19
    s_lshl_b32 s96, s3, 9
    s_lshl1_add_u32 s15, s21, s96
    v_and_b32 v29, 15, v1
    v_lshl_add_u32 v29, v29, 5, s15
    v_xor_b32 v5, 0x4000, v4
    v_xor_b32 v8, 0x4000, v7
    s_waitcnt vmcnt(3)
    ds_write_b128 v4, v[72:75] offset:2048
    ds_write_b128 v4, v[76:79] offset:3072
    s_cmp_lt_u32 s3, 4
    s_cbranch_scc1 L_FW1
    ds_write_b128 v4, v[56:59] offset:0
    ds_write_b128 v5, v[60:63] offset:0
    ds_write_b128 v4, v[64:67] offset:1024
    ds_write_b128 v5, v[68:71] offset:1024
L_FW1:
    s_branch SCHK_34
SPOLL_33:
    s_load_dwordx2 s[24:25], s[32:33], s92 offset:1536 glc
SCHK_34:
    s_add_u32 s5, s5, 1
    s_cmp_ge_u32 s5, 200000
    s_waitcnt lgkmcnt(0)
    s_cbranch_scc1 SDONE_35
    s_cmp_lg_u32 s24, s4
    s_cbranch_scc1 SPOLL_33
    s_cmp_lg_u32 s25, s4
    s_cbranch_scc1 SPOLL_33
SDONE_35:
    s_barrier
    buffer_load_dwordx4 v[192:195], v2, s[32:35], s14 offen sc1
    buffer_load_dwordx4 v[196:199], v2, s[32:35], s14 offen offset:1024 sc1
    buffer_load_dwordx4 v[200:203], v2, s[32:35], s14 offen offset:2048 sc1
    buffer_load_dwordx4 v[204:207], v2, s[32:35], s14 offen offset:3072 sc1
    s_barrier
    s_add_u32 s82, s80, 114688
    s_lshl2_add_u32 m0, s83, 34816
    s_nop 0
    buffer_load_dwordx4 v27, s[56:59], s82 offen nt lds
    s_add_u32 s82, s80, 172032
    s_lshl2_add_u32 m0, s83, 35840
    s_nop 0
    buffer_load_dwordx4 v27, s[56:59], s82 offen nt lds
    s_mov_b32 s82, s81
    s_lshl2_add_u32 m0, s83, 65536
    s_nop 0
    buffer_load_dwordx4 v253, s[60:63], s82 offen nt lds
    v_mov_b32_dpp v168, v33 row_newbcast:0 row_mask:0xf bank_mask:0xf
    v_mov_b32_dpp v169, v33 row_newbcast:1 row_mask:0xf bank_mask:0xf
    v_mov_b32_dpp v170, v33 row_newbcast:2 row_mask:0xf bank_mask:0xf
    v_mov_b32_dpp v171, v33 row_newbcast:3 row_mask:0xf bank_mask:0xf
    v_mov_b32_dpp v172, v33 row_newbcast:4 row_mask:0xf bank_mask:0xf
    v_mov_b32_dpp v173, v33 row_newbcast:5 row_mask:0xf bank_mask:0xf
    v_mov_b32_dpp v174, v33 row_newbcast:6 row_mask:0xf bank_mask:0xf
    v_mov_b32_dpp v175, v33 row_newbcast:7 row_mask:0xf bank_mask:0xf
    v_mov_b32_dpp v176, v33 row_newbcast:8 row_mask:0xf bank_mask:0xf
    v_mov_b32_dpp v177, v33 row_newbcast:9 row_mask:0xf bank_mask:0xf
    v_mov_b32_dpp v178, v33 row_newbcast:10 row_mask:0xf bank_mask:0xf
    v_mov_b32_dpp v179, v33 row_newbcast:11 row_mask:0xf bank_mask:0xf
    v_mov_b32_dpp v180, v33 row_newbcast:12 row_mask:0xf bank_mask:0xf
    v_mov_b32_dpp v181, v33 row_newbcast:13 row_mask:0xf bank_mask:0xf
    v_mov_b32_dpp v182, v33 row_newbcast:14 row_mask:0xf bank_mask:0xf
    v_mov_b32_dpp v183, v33 row_newbcast:15 row_mask:0xf bank_mask:0xf
    v_mov_b32_dpp v88, v42 row_newbcast:0 row_mask:0xf bank_mask:0xf
    v_mov_b32_dpp v89, v42 row_newbcast:1 row_mask:0xf bank_mask:0xf
    v_mov_b32_dpp v90, v42 row_newbcast:2 row_mask:0xf bank_mask:0xf
    v_mov_b32_dpp v91, v42 row_newbcast:3 row_mask:0xf bank_mask:0xf
    v_mov_b32_dpp v92, v42 row_newbcast:4 row_mask:0xf bank_mask:0xf
    v_mov_b32_dpp v93, v42 row_newbcast:5 row_mask:0xf bank_mask:0xf
    v_mov_b32_dpp v94, v42 row_newbcast:6 row_mask:0xf bank_mask:0xf
    v_mov_b32_dpp v95, v42 row_newbcast:7 row_mask:0xf bank_mask:0xf
    v_mov_b32_dpp v96, v42 row_newbcast:8 row_mask:0xf bank_mask:0xf
    v_mov_b32_dpp v97, v42 row_newbcast:9 row_mask:0xf bank_mask:0xf
    v_mov_b32_dpp v98, v42 row_newbcast:10 row_mask:0xf bank_mask:0xf
    v_mov_b32_dpp v99, v42 row_newbcast:11 row_mask:0xf bank_mask:0xf
    v_mov_b32_dpp v100, v42 row_newbcast:12 row_mask:0xf bank_mask:0xf
    v_mov_b32_dpp v101, v42 row_newbcast:13 row_mask:0xf bank_mask:0xf
    v_mov_b32_dpp v102, v42 row_newbcast:14 row_mask:0xf bank_mask:0xf
    v_mov_b32_dpp v103, v42 row_newbcast:15 row_mask:0xf bank_mask:0xf
    v_mov_b32_dpp v104, v43 row_newbcast:0 row_mask:0xf bank_mask:0xf
    v_mov_b32_dpp v105, v43 row_newbcast:1 row_mask:0xf bank_mask:0xf
    v_mov_b32_dpp v106, v43 row_newbcast:2 row_mask:0xf bank_mask:0xf
    v_mov_b32_dpp v107, v43 row_newbcast:3 row_mask:0xf bank_mask:0xf
    v_mov_b32_dpp v108, v43 row_newbcast:4 row_mask:0xf bank_mask:0xf
    v_mov_b32_dpp v109, v43 row_newbcast:5 row_mask:0xf bank_mask:0xf
    v_mov_b32_dpp v110, v43 row_newbcast:6 row_mask:0xf bank_mask:0xf
    v_mov_b32_dpp v111, v43 row_newbcast:7 row_mask:0xf bank_mask:0xf
    v_mov_b32_dpp v112, v43 row_newbcast:8 row_mask:0xf bank_mask:0xf
    v_mov_b32_dpp v113, v43 row_newbcast:9 row_mask:0xf bank_mask:0xf
    v_mov_b32_dpp v114, v43 row_newbcast:10 row_mask:0xf bank_mask:0xf
    v_mov_b32_dpp v115, v43 row_newbcast:11 row_mask:0xf bank_mask:0xf
    v_mov_b32_dpp v116, v43 row_newbcast:12 row_mask:0xf bank_mask:0xf
    v_mov_b32_dpp v117, v43 row_newbcast:13 row_mask:0xf bank_mask:0xf
    v_mov_b32_dpp v118, v43 row_newbcast:14 row_mask:0xf bank_mask:0xf
    v_mov_b32_dpp v119, v43 row_newbcast:15 row_mask:0xf bank_mask:0xf
    s_lshl3_add_u32 s15, s3, 156160
    v_mov_b32 v4, s15
    v_and_b32 v5, 7, v1
    v_lshlrev_b32 v5, 3, v5
    v_add_u32 v5, 156160, v5
    v_and_b32 v6, 3, v1
    v_lshlrev_b32 v6, 18, v6
    v_bfe_u32 v9, v1, 2, 2
    v_lshl_add_u32 v6, v9, 13, v6
    s_and_b32 s96, s21, 1
    s_and_b32 s97, s12, 7
    s_lshr_b32 s98, s12, 3
    s_lshl3_add_u32 s99, s97, s98
    s_lshl_b32 s97, s99, 12
    s_lshr_b32 s98, s21, 1
    s_lshl_b32 s99, s98, 6
    s_add_u32 s98, s97, s99
    s_lshl4_add_u32 s97, s96, s98
    s_add_u32 s99, s97, 1048576
    s_add_u32 s16, s99, 2560
    s_waitcnt vmcnt(3)
    v_pk_add_f32 v[192:193], v[192:193], v[196:197]
    v_pk_add_f32 v[200:201], v[200:201], v[204:205]
    v_pk_add_f32 v[194:195], v[194:195], v[198:199]
    v_pk_add_f32 v[202:203], v[202:203], v[206:207]
    v_pk_add_f32 v[192:193], v[192:193], v[200:201]
    v_pk_add_f32 v[194:195], v[194:195], v[202:203]
    v_add_f32 v193, v193, v194
    v_add_f32 v197, v192, v195
    v_cmp_u_f32 vcc, v193, v197
    s_cbranch_vccz POK_37
PRE_38:
    buffer_load_dwordx4 v[192:195], v2, s[32:35], s14 offen sc1
    buffer_load_dwordx4 v[196:199], v2, s[32:35], s14 offen offset:1024 sc1
    buffer_load_dwordx4 v[200:203], v2, s[32:35], s14 offen offset:2048 sc1
    buffer_load_dwordx4 v[204:207], v2, s[32:35], s14 offen offset:3072 sc1
    s_waitcnt vmcnt(0)
    v_pk_add_f32 v[192:193], v[192:193], v[196:197]
    v_pk_add_f32 v[200:201], v[200:201], v[204:205]
    v_pk_add_f32 v[194:195], v[194:195], v[198:199]
    v_pk_add_f32 v[202:203], v[202:203], v[206:207]
    v_pk_add_f32 v[192:193], v[192:193], v[200:201]
    v_pk_add_f32 v[194:195], v[194:195], v[202:203]
    v_add_f32 v193, v193, v194
    v_add_f32 v197, v192, v195
    v_cmp_u_f32 vcc, v193, v197
    s_cbranch_vccz POK_37
    s_add_u32 s5, s5, 1
    s_cmp_lt_u32 s5, 200000
    s_cbranch_scc1 PRE_38
POK_37:
    v_mov_b32 v196, v195
    s_nop 1
    v_permlane32_swap_b32 v195, v196
    v_permlane32_swap_b32 v192, v193
    v_add_f32 v195, v195, v196
    v_add_f32 v192, v192, v193
    s_nop 1
    v_permlane16_swap_b32 v192, v195
    v_add_f32 v193, v192, v195
    v_add_f32 v195, v192, v195
    s_nop 1
    v_permlane16_swap_b32 v193, v195
    v_mov_b32 v192, v193
    v_mul_f32 v195, 0x3a800000, v195
    s_nop 0
    v_permlane32_swap_b32 v192, v193
    v_mul_f32 v192, 0x3a800000, v192
    v_fma_f32 v31, -v192, v192, v195
    v_cvt_pk_bf16_f32 v30, 0, v192
    v_max_f32 v31, 0, v31
    v_cvt_pk_bf16_f32 v31, 0, v31
    v_fma_f32 v193, -v30, v40, v193
    v_add_f32 v31, 0x3727c5ac, v31
    v_cvt_pk_bf16_f32 v31, 0, v31
    v_sqrt_f32 v31, v31
    s_nop 0
    v_cvt_pk_bf16_f32 v31, 0, v31
L_PAD9:
    s_cbranch_execz L_RET9
    v_rcp_f32 v31, v31
    s_nop 0
    v_mul_f32 v32, v193, v31
    v_ashrrev_i32 v196, 31, v32
    v_or_b32 v196, 0x80000000, v196
    v_xor_b32 v32, v32, v196
    s_mov_b32 s15, 0xfffff000
    v_and_or_b32 v32, v32, s15, v29
    s_nop 1
    v_max_u32_dpp v244, v32, v32 quad_perm:[1,0,3,2] row_mask:0xf bank_mask:0xf
    v_min_u32_dpp v245, v32, v32 quad_perm:[1,0,3,2] row_mask:0xf bank_mask:0xf
    s_nop 0
    v_min_u32_dpp v196, v244, v244 quad_perm:[2,3,0,1] row_mask:0xf bank_mask:0xf
    v_max_u32_dpp v245, v245, v245 quad_perm:[2,3,0,1] row_mask:0xf bank_mask:0xf
    v_max_u32_dpp v244, v244, v244 quad_perm:[2,3,0,1] row_mask:0xf bank_mask:0xf
    v_max_u32 v245, v245, v196
    s_nop 0
    v_min_u32_dpp v196, v244, v244 row_half_mirror row_mask:0xf bank_mask:0xf
    v_max_u32_dpp v245, v245, v245 row_half_mirror row_mask:0xf bank_mask:0xf
    v_max_u32_dpp v244, v244, v244 row_half_mirror row_mask:0xf bank_mask:0xf
    v_max_u32 v245, v245, v196
    s_nop 0
    v_min_u32_dpp v196, v244, v244 row_mirror row_mask:0xf bank_mask:0xf
    v_max_u32_dpp v245, v245, v245 row_mirror row_mask:0xf bank_mask:0xf
    v_max_u32_dpp v244, v244, v244 row_mirror row_mask:0xf bank_mask:0xf
    v_max_u32 v245, v245, v196
    ds_write_b64 v4, v[244:245]
    s_waitcnt lgkmcnt(0)
    s_barrier
    ds_read_b64 v[244:245], v5
    v_pk_add_f32 v[208:209], v[152:153], v[30:31] op_sel_hi:[1,0] neg_lo:[0,1] neg_hi:[0,1]
    v_pk_add_f32 v[210:211], v[154:155], v[30:31] op_sel_hi:[1,0] neg_lo:[0,1] neg_hi:[0,1]
    v_pk_add_f32 v[212:213], v[156:157], v[30:31] op_sel_hi:[1,0] neg_lo:[0,1] neg_hi:[0,1]
    v_pk_add_f32 v[214:215], v[158:159], v[30:31] op_sel_hi:[1,0] neg_lo:[0,1] neg_hi:[0,1]
    v_pk_add_f32 v[216:217], v[160:161], v[30:31] op_sel_hi:[1,0] neg_lo:[0,1] neg_hi:[0,1]
    v_pk_add_f32 v[218:219], v[162:163], v[30:31] op_sel_hi:[1,0] neg_lo:[0,1] neg_hi:[0,1]
    v_pk_add_f32 v[220:221], v[164:165], v[30:31] op_sel_hi:[1,0] neg_lo:[0,1] neg_hi:[0,1]
    v_pk_add_f32 v[222:223], v[166:167], v[30:31] op_sel_hi:[1,0] neg_lo:[0,1] neg_hi:[0,1]
    s_waitcnt lgkmcnt(0)
    v_min_u32_dpp v196, v244, v244 quad_perm:[1,0,3,2] row_mask:0xf bank_mask:0xf
    v_max_u32_dpp v245, v245, v245 quad_perm:[1,0,3,2] row_mask:0xf bank_mask:0xf
    v_max_u32_dpp v244, v244, v244 quad_perm:[1,0,3,2] row_mask:0xf bank_mask:0xf
    v_max_u32 v245, v245, v196
    s_nop 0
    v_min_u32_dpp v196, v244, v244 quad_perm:[2,3,0,1] row_mask:0xf bank_mask:0xf
    v_max_u32_dpp v245, v245, v245 quad_perm:[2,3,0,1] row_mask:0xf bank_mask:0xf
    v_max_u32_dpp v244, v244, v244 quad_perm:[2,3,0,1] row_mask:0xf bank_mask:0xf
    v_max_u32 v245, v245, v196
    s_nop 0
    v_min_u32_dpp v196, v244, v244 row_half_mirror row_mask:0xf bank_mask:0xf
    v_max_u32_dpp v245, v245, v245 row_half_mirror row_mask:0xf bank_mask:0xf
    v_max_u32_dpp v244, v244, v244 row_half_mirror row_mask:0xf bank_mask:0xf
    v_max_u32 v245, v245, v196
    v_cmp_eq_u32 s[88:89], v32, v245
    v_cmp_eq_u32 vcc, v32, v244
    v_or_b32 v246, 1, v245
    v_mov_b32 v245, s4
    v_mov_b32 v247, s4
    s_or_b64 s[84:85], vcc, s[88:89]
    s_cmp_lg_u32 s3, 0
    s_cbranch_scc1 L_NOF
    s_mov_b64 exec, 0xffff
    buffer_store_dwordx4 v[244:247], v6, s[32:35], s16 offen sc1
    s_mov_b64 exec, -1
L_NOF:
    s_cmp_eq_u64 s[84:85], 0
    s_cbranch_scc1 L_NOPR
    s_setprio 1
L_NOPR:
    s_lshl4_add_u32 s13, s3, 156288
    v_mov_b32 v4, s13
    v_and_b32 v5, 7, v1
    v_lshlrev_b32 v5, 4, v5
    v_add_u32 v5, 156288, v5
    s_load_dwordx8 s[24:31], s[32:33], s92 offset:2560 glc
    v_cvt_pk_bf16_f32 v208, 0, v208
    v_cvt_pk_bf16_f32 v209, 0, v209
    v_cvt_pk_bf16_f32 v210, 0, v210
    v_cvt_pk_bf16_f32 v211, 0, v211
    v_cvt_pk_bf16_f32 v212, 0, v212
    v_cvt_pk_bf16_f32 v213, 0, v213
    v_cvt_pk_bf16_f32 v214, 0, v214
    v_cvt_pk_bf16_f32 v215, 0, v215
    v_cvt_pk_bf16_f32 v216, 0, v216
    v_cvt_pk_bf16_f32 v217, 0, v217
    v_cvt_pk_bf16_f32 v218, 0, v218
    v_cvt_pk_bf16_f32 v219, 0, v219
    v_cvt_pk_bf16_f32 v220, 0, v220
    v_cvt_pk_bf16_f32 v221, 0, v221
    v_cvt_pk_bf16_f32 v222, 0, v222
    v_cvt_pk_bf16_f32 v223, 0, v223
    v_pk_mul_f32 v[208:209], v[30:31], v[208:209] op_sel:[1,0]
    v_pk_mul_f32 v[210:211], v[30:31], v[210:211] op_sel:[1,0]
    v_pk_mul_f32 v[212:213], v[30:31], v[212:213] op_sel:[1,0]
    v_pk_mul_f32 v[214:215], v[30:31], v[214:215] op_sel:[1,0]
    v_pk_mul_f32 v[216:217], v[30:31], v[216:217] op_sel:[1,0]
    v_pk_mul_f32 v[218:219], v[30:31], v[218:219] op_sel:[1,0]
    v_pk_mul_f32 v[220:221], v[30:31], v[220:221] op_sel:[1,0]
    v_pk_mul_f32 v[222:223], v[30:31], v[222:223] op_sel:[1,0]
    v_cvt_pk_bf16_f32 v208, 0, v208
    v_cvt_pk_bf16_f32 v209, 0, v209
    v_cvt_pk_bf16_f32 v210, 0, v210
    v_cvt_pk_bf16_f32 v211, 0, v211
    v_cvt_pk_bf16_f32 v212, 0, v212
    v_cvt_pk_bf16_f32 v213, 0, v213
    v_cvt_pk_bf16_f32 v214, 0, v214
    v_cvt_pk_bf16_f32 v215, 0, v215
    v_cvt_pk_bf16_f32 v216, 0, v216
    v_cvt_pk_bf16_f32 v217, 0, v217
    v_cvt_pk_bf16_f32 v218, 0, v218
    v_cvt_pk_bf16_f32 v219, 0, v219
    v_cvt_pk_bf16_f32 v220, 0, v220
    v_cvt_pk_bf16_f32 v221, 0, v221
    v_cvt_pk_bf16_f32 v222, 0, v222
    v_cvt_pk_bf16_f32 v223, 0, v223
    v_pk_mul_f32 v[208:209], v[208:209], v[168:169]
    v_pk_mul_f32 v[210:211], v[210:211], v[170:171]
    v_pk_mul_f32 v[212:213], v[212:213], v[172:173]
    v_pk_mul_f32 v[214:215], v[214:215], v[174:175]
    v_pk_mul_f32 v[216:217], v[216:217], v[176:177]
    v_pk_mul_f32 v[218:219], v[218:219], v[178:179]
    v_pk_mul_f32 v[220:221], v[220:221], v[180:181]
    v_pk_mul_f32 v[222:223], v[222:223], v[182:183]
    v_cvt_pk_bf16_f32 v208, 0, v208
    v_cvt_pk_bf16_f32 v209, 0, v209
    v_cvt_pk_bf16_f32 v210, 0, v210
    v_cvt_pk_bf16_f32 v211, 0, v211
    v_cvt_pk_bf16_f32 v212, 0, v212
    v_cvt_pk_bf16_f32 v213, 0, v213
    v_cvt_pk_bf16_f32 v214, 0, v214
    v_cvt_pk_bf16_f32 v215, 0, v215
    v_cvt_pk_bf16_f32 v216, 0, v216
    v_cvt_pk_bf16_f32 v217, 0, v217
    v_cvt_pk_bf16_f32 v218, 0, v218
    v_cvt_pk_bf16_f32 v219, 0, v219
    v_cvt_pk_bf16_f32 v220, 0, v220
    v_cvt_pk_bf16_f32 v221, 0, v221
    v_cvt_pk_bf16_f32 v222, 0, v222
    v_cvt_pk_bf16_f32 v223, 0, v223
    v_pk_add_f32 v[208:209], v[208:209], v[88:89]
    v_pk_add_f32 v[210:211], v[210:211], v[90:91]
    v_pk_add_f32 v[212:213], v[212:213], v[92:93]
    v_pk_add_f32 v[214:215], v[214:215], v[94:95]
    v_pk_add_f32 v[216:217], v[216:217], v[96:97]
    v_pk_add_f32 v[218:219], v[218:219], v[98:99]
    v_pk_add_f32 v[220:221], v[220:221], v[100:101]
    v_pk_add_f32 v[222:223], v[222:223], v[102:103]
    v_cvt_pk_bf16_f32 v224, v208, v209
    v_cvt_pk_bf16_f32 v225, v210, v211
    v_cvt_pk_bf16_f32 v226, v212, v213
    v_cvt_pk_bf16_f32 v227, v214, v215
    v_cvt_pk_bf16_f32 v228, v216, v217
    v_cvt_pk_bf16_f32 v229, v218, v219
    v_cvt_pk_bf16_f32 v230, v220, v221
    v_cvt_pk_bf16_f32 v231, v222, v223
    s_cmp_eq_u64 s[84:85], 0
    s_cbranch_scc1 L_NOCAND
    v_mfma_f32_16x16x32_bf16 v[240:243], v[184:187], v[224:227], 0
    v_mfma_f32_16x16x32_bf16 v[240:243], v[188:191], v[228:231], v[240:243]
    v_mov_b32 v232, v224
    v_mov_b32 v233, v225
    v_mov_b32 v234, v226
    v_mov_b32 v235, v227
    v_mov_b32 v236, v228
    v_mov_b32 v237, v229
    v_mov_b32 v238, v230
    v_mov_b32 v239, v231
    s_lshl_b32 s96, s21, 14
    s_lshl_b32 s97, s12, 9
    s_add_u32 s98, s96, s97
    s_add_u32 s15, s98, 13631488
    v_lshrrev_b32 v7, 4, v1
    v_lshlrev_b32 v7, 4, v7
    v_add_u32 v8, 8192, v7
    v_permlane32_swap_b32 v232, v234
    v_permlane32_swap_b32 v233, v235
    v_permlane32_swap_b32 v236, v238
    v_permlane32_swap_b32 v237, v239
    v_permlane32_swap_b32 v12, v14
    v_permlane32_swap_b32 v13, v15
    v_permlane32_swap_b32 v16, v18
    v_permlane32_swap_b32 v17, v19
    v_cndmask_b32 v7, v7, v8, s[88:89]
    s_mov_b64 exec, s[84:85]
    buffer_store_dwordx4 v[232:235], v7, s[32:35], s15 offen sc1
    buffer_store_dwordx4 v[236:239], v7, s[32:35], s15 offen offset:64 sc1
    s_mov_b32 exec_lo, 0
    s_and_b32 exec_hi, s85, 0xffff0000
    buffer_store_dword v240, v7, s[32:35], s15 offen offset:208 sc1
    s_mov_b64 exec, s[84:85]
    buffer_store_dwordx4 v[12:15], v7, s[32:35], s15 offen offset:128 sc1
    buffer_store_dwordx4 v[16:19], v7, s[32:35], s15 offen offset:192 sc1
    s_mov_b64 exec, -1
    s_setprio 0
L_NOCAND:
    s_add_u32 s82, s81, 4096
    s_lshl2_add_u32 m0, s83, 66560
    s_nop 0
    buffer_load_dwordx4 v253, s[60:63], s82 offen nt lds
    s_add_u32 s82, s81, 8192
    s_lshl2_add_u32 m0, s83, 67584
    s_nop 0
    buffer_load_dwordx4 v253, s[60:63], s82 offen nt lds
    v_lshlrev_b32 v208, 16, v224
    v_and_b32 v209, s6, v224
    v_lshlrev_b32 v210, 16, v225
    v_and_b32 v211, s6, v225
    v_lshlrev_b32 v212, 16, v226
    v_and_b32 v213, s6, v226
    v_lshlrev_b32 v214, 16, v227
    v_and_b32 v215, s6, v227
    v_lshlrev_b32 v216, 16, v228
    v_and_b32 v217, s6, v228
    v_lshlrev_b32 v218, 16, v229
    v_and_b32 v219, s6, v229
    v_lshlrev_b32 v220, 16, v230
    v_and_b32 v221, s6, v230
    v_lshlrev_b32 v222, 16, v231
    v_and_b32 v223, s6, v231
    v_pk_mul_f32 v[208:209], v[208:209], v[104:105]
    v_pk_mul_f32 v[210:211], v[210:211], v[106:107]
    v_pk_mul_f32 v[212:213], v[212:213], v[108:109]
    v_pk_mul_f32 v[214:215], v[214:215], v[110:111]
    v_pk_mul_f32 v[216:217], v[216:217], v[112:113]
    v_pk_mul_f32 v[218:219], v[218:219], v[114:115]
    v_pk_mul_f32 v[220:221], v[220:221], v[116:117]
    v_pk_mul_f32 v[222:223], v[222:223], v[118:119]
    v_cvt_pk_bf16_f32 v208, 0, v208
    v_cvt_pk_bf16_f32 v209, 0, v209
    v_cvt_pk_bf16_f32 v210, 0, v210
    v_cvt_pk_bf16_f32 v211, 0, v211
    v_cvt_pk_bf16_f32 v212, 0, v212
    v_cvt_pk_bf16_f32 v213, 0, v213
    v_cvt_pk_bf16_f32 v214, 0, v214
    v_cvt_pk_bf16_f32 v215, 0, v215
    v_cvt_pk_bf16_f32 v216, 0, v216
    v_cvt_pk_bf16_f32 v217, 0, v217
    v_cvt_pk_bf16_f32 v218, 0, v218
    v_cvt_pk_bf16_f32 v219, 0, v219
    v_cvt_pk_bf16_f32 v220, 0, v220
    v_cvt_pk_bf16_f32 v221, 0, v221
    v_cvt_pk_bf16_f32 v222, 0, v222
    v_cvt_pk_bf16_f32 v223, 0, v223
    s_lshl_b32 s96, s3, 11
    s_add_u32 s13, s96, 98304
    v_lshrrev_b32 v202, 4, v1
    v_lshlrev_b32 v202, 4, v202
    v_and_b32 v203, 7, v1
    v_lshlrev_b32 v203, 4, v203
    v_xor_b32 v202, v202, v203
    v_and_b32 v204, 15, v1
    v_lshl_add_u32 v204, v204, 7, s13
    v_add_u32 v202, v202, v204
    v_xor_b32 v204, 64, v202
    v_lshrrev_b32 v205, 3, v1
    v_lshlrev_b32 v205, 4, v205
    v_xor_b32 v203, v205, v203
    v_lshrrev_b32 v205, 3, v1
    v_lshl_add_u32 v205, v205, 7, s13
    v_add_u32 v203, v203, v205
    s_lshl_b32 s96, s21, 7
    s_sub_u32 s97, 2047, s96
    s_lshl_b32 s98, s3, 4
    s_sub_u32 s13, s97, s98
    v_lshrrev_b32 v43, 3, v1
    v_sub_u32 v42, s13, v43
    v_subrev_u32 v43, 8, v42
    v_lshrrev_b32 v33, 3, v1
    v_lshlrev_b32 v33, 11, v33
    v_and_b32 v9, 7, v1
    v_lshl_add_u32 v33, v9, 4, v33
    s_lshl3_add_u32 s96, s21, s3
    s_lshl_b32 s97, s96, 15
    s_lshl_b32 s98, s12, 7
    s_add_u32 s16, s97, s98
    s_add_u32 s15, s16, 16384
    s_branch SCHK_40
SPOLL_39:
    s_load_dwordx8 s[24:31], s[32:33], s92 offset:2560 glc
SCHK_40:
    s_add_u32 s5, s5, 1
    s_cmp_ge_u32 s5, 200000
    s_waitcnt lgkmcnt(0)
    s_cbranch_scc1 SDONE_41
    s_cmp_lg_u32 s25, s4
    s_cbranch_scc1 SPOLL_39
    s_cmp_lg_u32 s27, s4
    s_cbranch_scc1 SPOLL_39
    s_cmp_lg_u32 s29, s4
    s_cbranch_scc1 SPOLL_39
    s_cmp_lg_u32 s31, s4
    s_cbranch_scc1 SPOLL_39
SDONE_41:
    s_min_u32 s25, s24, s28
    s_min_u32 s27, s26, s28
    s_min_u32 s29, s24, s30
    s_max_u32 s24, s24, s28
    s_max_u32 s26, s26, s30
    s_max_u32 s27, s27, s29
    s_max_u32 s25, s25, s26
    v_mov_b32 v244, s24
    v_mov_b32 v246, s27
    v_mov_b32 v245, s25
    ds_write_b128 v4, v[244:247]
    s_lshr_b32 s96, s3, 2
    s_lshl_b32 s97, s96, 15
    s_and_b32 s98, s3, 3
    s_lshl_b32 s99, s98, 5
    s_add_u32 s13, s97, s99
    v_lshrrev_b32 v34, 4, v1
    v_lshlrev_b32 v34, 13, v34
    v_bfe_u32 v9, v1, 2, 2
    v_lshl_add_u32 v34, v9, 7, v34
    v_bfe_u32 v9, v1, 3, 2
    v_lshl_add_u32 v34, v9, 5, v34
    v_and_b32 v9, 3, v1
    v_lshl_add_u32 v34, v9, 3, v34
    v_xor_b32 v34, s13, v34
    s_lshl_b32 s96, s75, 11
    s_add_u32 s13, s96, 13631488
    v_and_b32 v36, 7, v1
    v_lshl_add_u32 v36, v36, 4, s13
    v_lshrrev_b32 v9, 4, v1
    v_lshl_add_u32 v36, v9, 9, v36
    v_and_b32 v10, 15, v1
    v_lshlrev_b32 v10, 9, v10
    v_add_u32 v10, 13631744, v10
    s_waitcnt vmcnt(0)
    s_waitcnt lgkmcnt(0)
    s_barrier
    ds_read_b128 v[244:247], v5
    v_and_b32 v8, 8, v1
    v_cmp_eq_u32 s[22:23], 0, v8
    v_cmp_gt_u32 s[24:25], 16, v1
    v_cmp_gt_u32 s[26:27], 32, v1
    s_waitcnt lgkmcnt(0)
    v_min_u32_dpp v192, v244, v244 quad_perm:[1,0,3,2] row_mask:0xf bank_mask:0xf
    v_min_u32_dpp v193, v245, v244 quad_perm:[1,0,3,2] row_mask:0xf bank_mask:0xf
    v_min_u32_dpp v194, v244, v245 quad_perm:[1,0,3,2] row_mask:0xf bank_mask:0xf
    v_max_u32_dpp v246, v246, v246 quad_perm:[1,0,3,2] row_mask:0xf bank_mask:0xf
    v_max_u32_dpp v245, v245, v245 quad_perm:[1,0,3,2] row_mask:0xf bank_mask:0xf
    v_max_u32_dpp v244, v244, v244 quad_perm:[1,0,3,2] row_mask:0xf bank_mask:0xf
    v_max3_u32 v246, v246, v193, v194
    v_max_u32 v245, v245, v192
    v_min_u32_dpp v192, v244, v244 quad_perm:[2,3,0,1] row_mask:0xf bank_mask:0xf
    s_nop 0
    v_min_u32_dpp v193, v245, v244 quad_perm:[2,3,0,1] row_mask:0xf bank_mask:0xf
    v_min_u32_dpp v194, v244, v245 quad_perm:[2,3,0,1] row_mask:0xf bank_mask:0xf
    v_max_u32_dpp v246, v246, v246 quad_perm:[2,3,0,1] row_mask:0xf bank_mask:0xf
    v_max_u32_dpp v245, v245, v245 quad_perm:[2,3,0,1] row_mask:0xf bank_mask:0xf
    v_max_u32_dpp v244, v244, v244 quad_perm:[2,3,0,1] row_mask:0xf bank_mask:0xf
    v_max3_u32 v246, v246, v193, v194
    v_max_u32 v245, v245, v192
    v_min_u32_dpp v192, v244, v244 row_half_mirror row_mask:0xf bank_mask:0xf
    s_nop 0
    v_min_u32_dpp v193, v245, v244 row_half_mirror row_mask:0xf bank_mask:0xf
    v_min_u32_dpp v194, v244, v245 row_half_mirror row_mask:0xf bank_mask:0xf
    v_max_u32_dpp v246, v246, v246 row_half_mirror row_mask:0xf bank_mask:0xf
    v_max_u32_dpp v245, v245, v245 row_half_mirror row_mask:0xf bank_mask:0xf
    v_max_u32_dpp v244, v244, v244 row_half_mirror row_mask:0xf bank_mask:0xf
    v_max3_u32 v246, v246, v193, v194
    v_max_u32 v245, v245, v192
    v_cndmask_b32 v192, v245, v244, s[22:23]
    v_cndmask_b32 v201, v246, v245, s[26:27]
    v_and_b32 v193, 31, v246
    v_and_b32 v192, 31, v192
    v_cndmask_b32 v201, v201, v244, s[24:25]
    v_lshl_add_u32 v4, v192, 13, v36
    v_lshl_add_u32 v5, v193, 13, v36
    v_and_b32 v194, 31, v201
    v_lshl_add_u32 v6, v194, 13, v10
    buffer_load_dwordx4 v[192:195], v4, s[32:35], 0 offen sc1
    buffer_load_dwordx4 v[196:199], v5, s[32:35], 0 offen sc1
    buffer_load_dword v200, v6, s[32:35], 0 offen sc1
    s_barrier
    s_add_u32 s82, s81, 12288
    s_lshl2_add_u32 m0, s83, 68608
    s_nop 0
    buffer_load_dwordx4 v253, s[60:63], s82 offen nt lds
    v_readfirstlane_b32 s91, v244
    v_readfirstlane_b32 s94, v245
    v_readfirstlane_b32 s95, v246
    ds_read_b64_tr_b16 v[56:57], v34
    ds_read_b64_tr_b16 v[58:59], v34 offset:512
    ds_read_b64_tr_b16 v[60:61], v34 offset:1024
    ds_read_b64_tr_b16 v[62:63], v34 offset:1536
    ds_read_b64_tr_b16 v[64:65], v34 offset:2048
    ds_read_b64_tr_b16 v[66:67], v34 offset:2560
    ds_read_b64_tr_b16 v[68:69], v34 offset:3072
    ds_read_b64_tr_b16 v[70:71], v34 offset:3584
    ds_read_b64_tr_b16 v[72:73], v34 offset:4096
    ds_read_b64_tr_b16 v[74:75], v34 offset:4608
    ds_read_b64_tr_b16 v[76:77], v34 offset:5120
    ds_read_b64_tr_b16 v[78:79], v34 offset:5632
    ds_read_b64_tr_b16 v[80:81], v34 offset:6144
    ds_read_b64_tr_b16 v[82:83], v34 offset:6656
    ds_read_b64_tr_b16 v[84:85], v34 offset:7168
    ds_read_b64_tr_b16 v[86:87], v34 offset:7680
    s_bfe_u32 s96, s91, 262145
    s_lshl_b32 s97, s96, 7
    s_bfe_u32 s98, s91, 458757
    s_add_u32 s99, s97, s98
    s_xor_b32 s17, s99, 2047
    s_bfe_u32 s96, s94, 262145
    s_lshl_b32 s97, s96, 7
    s_bfe_u32 s98, s94, 458757
    s_add_u32 s99, s97, s98
    s_xor_b32 s18, s99, 2047
    s_bfe_u32 s96, s95, 262145
    s_lshl_b32 s97, s96, 7
    s_bfe_u32 s98, s95, 458757
    s_add_u32 s99, s97, s98
    s_xor_b32 s19, s99, 2047
    s_waitcnt lgkmcnt(0)
    s_lshl_b32 s13, s3, 6
    v_bfe_u32 v35, v1, 2, 1
    v_lshlrev_b32 v35, 9, v35
    v_bfe_u32 v9, v1, 3, 1
    v_lshl_add_u32 v35, v9, 12, v35
    v_lshrrev_b32 v9, 5, v1
    v_lshl_add_u32 v35, v9, 11, v35
    v_bfe_u32 v9, v1, 2, 2
    v_lshl_add_u32 v35, v9, 6, v35
    v_bfe_u32 v9, v1, 4, 1
    v_lshl_add_u32 v35, v9, 5, v35
    v_and_b32 v9, 3, v1
    v_lshl_add_u32 v35, v9, 3, v35
    v_xor_b32 v35, s13, v35
    v_add_u32 v35, 65536, v35
    v_and_b32 v8, 15, v1
    v_lshlrev_b32 v8, 4, v8
    v_lshrrev_b32 v9, 5, v1
    v_lshl_add_u32 v8, v9, 3, v8
    s_lshl_b32 s96, s74, 13
    s_add_u32 s14, s96, 20971520
    s_lshl3_add_u32 s96, s75, s3
    s_lshl_b32 s97, s96, 8
    s_add_u32 s20, s97, s14
    v_bfe_u32 v7, v201, 1, 4
    v_bfe_u32 v201, v201, 5, 7
    v_lshl_or_b32 v201, v7, 7, v201
    v_xor_b32 v201, 0x7ff, v201
    s_waitcnt vmcnt(1)
    v_max3_u32 v7, v192, v196, v200
    v_cmp_eq_u32 vcc, -1, v7
    s_cbranch_vccz POK_43
PRE_44:
    buffer_load_dwordx4 v[192:195], v4, s[32:35], 0 offen sc1
    buffer_load_dwordx4 v[196:199], v5, s[32:35], 0 offen sc1
    buffer_load_dword v200, v6, s[32:35], 0 offen sc1
    s_waitcnt vmcnt(0)
    v_max3_u32 v7, v192, v196, v200
    v_cmp_eq_u32 vcc, -1, v7
    s_cbranch_vccz POK_43
    s_add_u32 s5, s5, 1
    s_cmp_lt_u32 s5, 200000
    s_cbranch_scc1 PRE_44
POK_43:
    v_add_f32_dpp v200, v200, v200 quad_perm:[1,0,3,2] row_mask:0xf bank_mask:0xf
    s_nop 1
    v_add_f32_dpp v200, v200, v200 quad_perm:[2,3,0,1] row_mask:0xf bank_mask:0xf
    s_nop 1
    v_add_f32_dpp v200, v200, v200 row_half_mirror row_mask:0xf bank_mask:0xf
    s_nop 1
    v_add_f32_dpp v200, v200, v200 row_mirror row_mask:0xf bank_mask:0xf
    v_cvt_pk_bf16_f32 v200, 0, v200
    v_ashrrev_i32 v7, 31, v200
    v_or_b32 v7, 0x80000000, v7
    v_xor_b32 v200, v200, v7
    v_lshrrev_b32 v200, 16, v200
    v_lshl_or_b32 v200, v200, 11, v201
    s_nop 0
    v_readlane_b32 s24, v200, 0
    v_readlane_b32 s25, v200, 16
    v_readlane_b32 s26, v200, 32
    s_not_b64 s[28:29], s[22:23]
    s_cmp_lt_u32 s24, s25
    s_cselect_b64 s[28:29], s[22:23], s[28:29]
    s_cselect_b32 s27, s24, s25
    s_cmp_gt_u32 s26, s27
    s_cselect_b64 vcc, s[28:29], 0
    v_cndmask_b32 v192, v192, v196, vcc
    v_cndmask_b32 v193, v193, v197, vcc
    v_cndmask_b32 v194, v194, v198, vcc
    v_cndmask_b32 v195, v195, v199, vcc
    s_bitcmp1_b32 vcc_lo, 0
    s_cselect_b32 s24, s26, s24
    s_cselect_b32 s19, s17, s19
    s_cselect_b32 s17, s95, s91
    s_bitcmp1_b32 vcc_lo, 8
    s_cselect_b32 s25, s26, s25
    s_cselect_b32 s19, s18, s19
    s_cselect_b32 s18, s95, s94
    s_waitcnt lgkmcnt(0)
    v_mfma_f32_16x16x32_bf16 v[136:139], v[192:195], v[56:59], 0
    v_mfma_f32_16x16x32_bf16 v[140:143], v[192:195], v[60:63], 0
    v_mfma_f32_16x16x32_bf16 v[144:147], v[192:195], v[64:67], 0
    v_mfma_f32_16x16x32_bf16 v[148:151], v[192:195], v[68:71], 0
    v_mfma_f32_16x16x32_bf16 v[168:171], v[192:195], v[72:75], 0
    v_mfma_f32_16x16x32_bf16 v[172:175], v[192:195], v[76:79], 0
    v_mfma_f32_16x16x32_bf16 v[176:179], v[192:195], v[80:83], 0
    v_mfma_f32_16x16x32_bf16 v[180:183], v[192:195], v[84:87], 0
    s_nop 1
    v_add_f32 v196, v136, v141
    s_nop 0
    v_add_f32 v197, v146, v151
    s_nop 0
    v_add_f32 v198, v168, v173
    s_nop 0
    v_add_f32 v199, v178, v183
    v_add_f32 v196, v196, v197
    v_add_f32 v198, v198, v199
    v_mov_b32 v197, s4
    s_nop 0
    v_permlane16_swap_b32 v198, v199
    s_cmp_ge_u32 s9, 28
    s_cbranch_scc1 L_NOHP
    v_add_f32 v196, v196, v199
    s_mov_b32 exec_lo, 0xffff
    s_mov_b32 exec_hi, 0xffff
    buffer_store_dwordx2 v[196:197], v8, s[32:35], s20 offen sc1
    s_mov_b64 exec, -1
L_NOHP:
    s_and_b32 s68, s24, 2047
    s_and_b32 s69, s25, 2047
    s_mov_b32 s70, s16
    s_mov_b32 s71, s15
    v_pk_add_f32 v[208:209], v[208:209], v[152:153]
    v_pk_add_f32 v[210:211], v[210:211], v[154:155]
    v_pk_add_f32 v[212:213], v[212:213], v[156:157]
    v_pk_add_f32 v[214:215], v[214:215], v[158:159]
    v_pk_add_f32 v[216:217], v[216:217], v[160:161]
    v_pk_add_f32 v[218:219], v[218:219], v[162:163]
    v_pk_add_f32 v[220:221], v[220:221], v[164:165]
    v_pk_add_f32 v[222:223], v[222:223], v[166:167]
    v_cvt_pk_bf16_f32 v232, v208, v209
    v_cvt_pk_bf16_f32 v233, v210, v211
    v_cvt_pk_bf16_f32 v234, v212, v213
    v_cvt_pk_bf16_f32 v235, v214, v215
    v_cvt_pk_bf16_f32 v236, v216, v217
    v_cvt_pk_bf16_f32 v237, v218, v219
    v_cvt_pk_bf16_f32 v238, v220, v221
    v_cvt_pk_bf16_f32 v239, v222, v223
    v_permlane32_swap_b32 v232, v234
    v_permlane32_swap_b32 v233, v235
    v_permlane32_swap_b32 v236, v238
    v_permlane32_swap_b32 v237, v239
    ds_write_b128 v202, v[232:235]
    ds_write_b128 v204, v[236:239]
    ds_read_b128 v[232:235], v203
    ds_read_b128 v[236:239], v203 offset:1024
    s_waitcnt lgkmcnt(0)
    s_cmp_lg_u32 s93, 7
    s_cbranch_scc1 L_NONON
    v_mov_b32 v6, s4
    v_mov_b32 v7, 0
    s_mov_b64 exec, 1
    buffer_store_dword v6, v7, s[32:35], 0 offen sc1
    s_mov_b64 exec, -1
L_NONON:
    s_cmp_ge_u32 s9, 28
    s_cbranch_scc1 L_FIN2
    s_cmp_lg_u32 s3, 7
    s_cbranch_scc1 L_NOFZ
    s_bitcmp1_b32 s9, 3
    s_cselect_b32 s15, s25, s24
    s_cselect_b32 s17, s18, s17
    s_andn2_b32 s18, 2047, s15
    s_lshr_b32 s96, s8, 1
    s_lshl2_add_u32 s19, s12, s96
    s_lshr_b32 s96, s19, 1
    s_lshr_b32 s97, s9, 3
    s_lshl_b32 s98, s97, 1
    s_lshl2_add_u32 s99, s96, s98
    s_and_b32 s97, s19, 1
    s_add_u32 s96, s99, s97
    s_mul_i32 s98, s96, 7168
    s_add_u32 s20, s98, 22020096
    s_lshl_b32 s96, s18, 11
    s_lshl_b32 s97, s19, 5
    s_add_u32 s82, s96, s97
    v_and_b32 v10, 7, v1
    v_lshlrev_b32 v10, 2, v10
    s_lshr_b32 s96, s8, 1
    s_lshl_b32 s97, s96, 6
    s_add_u32 s13, s97, 157184
    v_and_b32 v5, 7, v1
    v_lshl_add_u32 v5, v5, 3, s13
    ds_read_b64 v[206:207], v5
    s_and_b32 s96, s17, 31
    s_lshl_b32 s97, s96, 13
    s_lshl_b32 s98, s12, 9
    s_add_u32 s99, s97, s98
    s_lshr_b32 s96, s8, 1
    s_lshl_b32 s97, s96, 5
    s_add_u32 s98, s99, s97
    s_add_u32 s91, s98, 13631488
    s_lshr_b32 s13, s15, 11
    s_lshl_b32 s13, s13, 16
    s_ashr_i32 s15, s13, 31
    s_andn2_b32 s15, 0x7fff0000, s15
    s_or_b32 s15, s15, 0x80000000
    s_xor_b32 s13, s13, s15
    v_mov_b32 v204, s13
    v_mul_f32 v204, s7, v204
    v_exp_f32 v204, -v204
    s_nop 0
    v_add_f32 v204, 1.0, v204
    v_rcp_f32 v204, v204
    s_nop 0
    v_cvt_pk_bf16_f32 v204, 0, v204
L_NOFZ:
    s_cmp_ge_u32 s3, 4
    s_cbranch_scc1 L_NOH
    s_lshl_b32 s96, s3, 8
    s_add_u32 s13, s96, s14
    v_lshrrev_b32 v4, 4, v1
    v_lshlrev_b32 v4, 11, v4
    v_and_b32 v9, 15, v1
    v_lshl_add_u32 v4, v9, 4, v4
    s_lshl_b32 s96, s3, 5
    s_add_u32 s15, s96, 156672
    v_lshrrev_b32 v5, 5, v1
    v_lshl_add_u32 v5, v5, 7, s15
    v_bfe_u32 v9, v1, 2, 1
    v_lshl_add_u32 v5, v9, 4, v5
    v_bfe_u32 v9, v1, 1, 1
    v_lshl_add_u32 v5, v9, 3, v5
    v_bfe_u32 v9, v1, 3, 1
    v_lshl_add_u32 v5, v9, 2, v5
    v_and_b32 v9, 1, v1
    v_lshl_add_u32 v5, v9, 1, v5
SPOLL_45:
    s_load_dword s24, s[32:33], s13 offset:1276 glc
    s_load_dword s25, s[32:33], s13 offset:3324 glc
    s_load_dword s26, s[32:33], s13 offset:5372 glc
    s_load_dword s27, s[32:33], s13 offset:7420 glc
SCHK_46:
    s_add_u32 s5, s5, 1
    s_cmp_ge_u32 s5, 200000
    s_waitcnt lgkmcnt(0)
    s_cbranch_scc1 SDONE_47
    s_cmp_lg_u32 s24, s4
    s_cbranch_scc1 SPOLL_45
    s_cmp_lg_u32 s25, s4
    s_cbranch_scc1 SPOLL_45
    s_cmp_lg_u32 s26, s4
    s_cbranch_scc1 SPOLL_45
    s_cmp_lg_u32 s27, s4
    s_cbranch_scc1 SPOLL_45
SDONE_47:
POLL_48:
    buffer_load_dwordx4 v[88:91], v4, s[32:35], s13 offen sc1
    buffer_load_dwordx4 v[92:95], v4, s[32:35], s13 offen offset:1024 sc1
    s_waitcnt vmcnt(0)
    v_bitop3_b32 v6, v89, v91, s4 bitop3:0x7e
    v_bitop3_b32 v6, v6, v93, s4 bitop3:0xf6
    v_bitop3_b32 v6, v6, v95, s4 bitop3:0xf6
    v_cmp_ne_u32 vcc, 0, v6
    s_cbranch_vccz PDONE_49
    s_add_u32 s5, s5, 1
    s_cmp_lt_u32 s5, 200000
    s_cbranch_scc1 POLL_48
PDONE_49:
    v_permlane32_swap_b32 v88, v90
    v_permlane32_swap_b32 v92, v94
    v_add_f32 v88, v88, v90
    v_add_f32 v92, v92, v94
    v_mov_b32 v90, v88
    v_mov_b32 v94, v92
    s_nop 0
    v_permlane16_swap_b32 v88, v90
    v_permlane16_swap_b32 v92, v94
    v_add_f32 v88, v88, v90
    v_add_f32 v92, v92, v94
    v_cvt_pk_bf16_f32 v88, 0, v88
    v_cvt_pk_bf16_f32 v92, 0, v92
    v_mul_f32 v6, s7, v88
    v_exp_f32 v6, -v6
    s_nop 0
    v_add_f32 v6, 1.0, v6
    v_rcp_f32 v6, v6
    s_nop 0
    v_mul_f32 v88, v88, v6
    v_cvt_pk_bf16_f32 v88, 0, v88
    v_mul_f32 v88, v88, v92
    v_cvt_pk_bf16_f32 v88, v88, v88
    ds_write_b16 v5, v88
L_NOH:
    v_bfe_u32 v4, v1, 2, 1
    v_lshlrev_b32 v4, 7, v4
    v_lshrrev_b32 v9, 5, v1
    v_lshl_add_u32 v4, v9, 4, v4
L_PAD10:
    s_cbranch_execz L_RET10
    v_add_u32 v4, 156672, v4
    v_lshrrev_b32 v5, 4, v1
    v_mul_u32_u24 v5, 7168, v5
    v_and_b32 v9, 15, v1
    v_lshl_add_u32 v5, v9, 3, v5
    s_lshl3_add_u32 s96, s75, s3
    s_mul_i32 s97, s96, 28672
    s_lshl_b32 s98, s74, 7
    s_add_u32 s99, s97, s98
    s_add_u32 s13, s99, 22020096
    v_and_b32 v6, 1, v1
    v_lshlrev_b32 v6, 13, v6
    v_bfe_u32 v9, v1, 1, 1
    v_lshl_add_u32 v6, v9, 18, v6
    s_lshr_b32 s96, s9, 2
    s_and_b32 s97, s75, 1
    s_lshr_b32 s98, s3, 1
    s_lshl2_add_u32 s99, s97, s98
    s_and_b32 s97, s3, 1
    s_lshr_b32 s98, s75, 1
    s_lshl2_add_u32 s97, s97, s98
    s_lshl3_add_u32 s98, s99, s97
    s_lshl_b32 s99, s98, 12
    s_lshl_b32 s97, s8, 6
    s_add_u32 s98, s99, s97
    s_lshl2_add_u32 s99, s96, s98
    s_add_u32 s97, s99, 1048576
    s_add_u32 s14, s97, 3072
    s_waitcnt vmcnt(0)
    s_waitcnt lgkmcnt(0)
    s_barrier
    ds_read_b128 v[88:91], v4
    ds_read_b64_tr_b16 v[120:121], v35
    ds_read_b64_tr_b16 v[122:123], v35 offset:1024
    ds_read_b128 v[92:95], v4 offset:32
    ds_read_b64_tr_b16 v[124:125], v35 offset:8192
    ds_read_b64_tr_b16 v[126:127], v35 offset:9216
    ds_read_b128 v[96:99], v4 offset:64
    ds_read_b64_tr_b16 v[128:129], v35 offset:16384
    ds_read_b64_tr_b16 v[130:131], v35 offset:17408
    ds_read_b128 v[100:103], v4 offset:96
    ds_read_b64_tr_b16 v[132:133], v35 offset:24576
    ds_read_b64_tr_b16 v[134:135], v35 offset:25600
    s_waitcnt lgkmcnt(9)
    v_mfma_f32_32x32x16_bf16 v[208:223], v[88:91], v[120:123], 0
    s_waitcnt lgkmcnt(6)
    v_mfma_f32_32x32x16_bf16 v[208:223], v[92:95], v[124:127], v[208:223]
    s_waitcnt lgkmcnt(3)
    v_mfma_f32_32x32x16_bf16 v[208:223], v[96:99], v[128:131], v[208:223]
    s_waitcnt lgkmcnt(0)
    v_mfma_f32_32x32x16_bf16 v[208:223], v[100:103], v[132:135], v[208:223]
    s_nop 11
    v_mov_b32 v209, s4
    buffer_store_dwordx2 v[208:209], v5, s[32:35], s13 offen sc1
    s_mov_b64 exec, 15
    buffer_store_dword v209, v6, s[32:35], s14 offen sc1
    s_mov_b64 exec, -1
    s_barrier
L_FIN2:
    v_cmp_ne_u32 vcc, s68, v42
    v_cmp_ne_u32 s[22:23], s69, v42
    s_nop 0
    s_and_b64 exec, vcc, s[22:23]
    buffer_store_dwordx4 v[232:235], v33, s[64:67], s70 offen sc1
    s_mov_b64 exec, -1
    v_cmp_ne_u32 vcc, s68, v43
    v_cmp_ne_u32 s[22:23], s69, v43
    s_nop 0
    s_and_b64 exec, vcc, s[22:23]
    buffer_store_dwordx4 v[236:239], v33, s[64:67], s71 offen sc1
    s_mov_b64 exec, -1
    s_cmp_ge_u32 s9, 16
    s_cbranch_scc1 L_FIN
SPOLL_50:
    s_load_dwordx8 s[24:31], s[32:33], s92 offset:3072 glc
SCHK_51:
    s_add_u32 s5, s5, 1
    s_cmp_ge_u32 s5, 200000
    s_waitcnt lgkmcnt(0)
    s_cbranch_scc1 SDONE_52
    s_cmp_lg_u32 s24, s4
    s_cbranch_scc1 SPOLL_50
    s_cmp_lg_u32 s25, s4
    s_cbranch_scc1 SPOLL_50
    s_cmp_lg_u32 s26, s4
    s_cbranch_scc1 SPOLL_50
    s_cmp_lg_u32 s27, s4
    s_cbranch_scc1 SPOLL_50
    s_cmp_lg_u32 s28, s4
    s_cbranch_scc1 SPOLL_50
    s_cmp_lg_u32 s29, s4
    s_cbranch_scc1 SPOLL_50
    s_cmp_lg_u32 s30, s4
    s_cbranch_scc1 SPOLL_50
SDONE_52:
    s_barrier
    s_cmp_lg_u32 s3, 7
    s_cbranch_scc1 L_FIN
    s_add_u32 s13, s20, 4096
    v_mov_b32 v5, s4
    v_not_b32 v6, v5
POLL_53:
    buffer_load_dwordx4 v[88:91], v2, s[32:35], s20 offen sc1
    buffer_load_dwordx4 v[92:95], v2, s[32:35], s20 offen offset:1024 sc1
    buffer_load_dwordx4 v[96:99], v2, s[32:35], s20 offen offset:2048 sc1
    buffer_load_dwordx4 v[100:103], v2, s[32:35], s20 offen offset:3072 sc1
    buffer_load_dwordx4 v[104:107], v2, s[32:35], s13 offen sc1
    buffer_load_dwordx4 v[108:111], v2, s[32:35], s13 offen offset:1024 sc1
    buffer_load_dwordx4 v[112:115], v2, s[32:35], s13 offen offset:2048 sc1
    buffer_load_dword v244, v10, s[32:35], s91 offen sc1
    buffer_load_dword v245, v10, s[32:35], s91 offen offset:128 sc1
    s_waitcnt vmcnt(0)
    v_max_u32 v246, v244, v245
    v_cmp_ne_u32 vcc, -1, v246
    s_nop 1
    v_cndmask_b32 v246, v6, v5, vcc
    v_bitop3_b32 v4, v89, v91, s4 bitop3:0x7e
    v_bitop3_b32 v4, v4, v93, s4 bitop3:0xf6
    v_bitop3_b32 v4, v4, v95, s4 bitop3:0xf6
    v_bitop3_b32 v4, v4, v97, s4 bitop3:0xf6
    v_bitop3_b32 v4, v4, v99, s4 bitop3:0xf6
    v_bitop3_b32 v4, v4, v101, s4 bitop3:0xf6
    v_bitop3_b32 v4, v4, v103, s4 bitop3:0xf6
    v_bitop3_b32 v4, v4, v105, s4 bitop3:0xf6
    v_bitop3_b32 v4, v4, v107, s4 bitop3:0xf6
    v_bitop3_b32 v4, v4, v109, s4 bitop3:0xf6
    v_bitop3_b32 v4, v4, v111, s4 bitop3:0xf6
    v_bitop3_b32 v4, v4, v113, s4 bitop3:0xf6
    v_bitop3_b32 v4, v4, v115, s4 bitop3:0xf6
    v_bitop3_b32 v4, v4, v246, s4 bitop3:0xf6
    v_cmp_ne_u32 vcc, 0, v4
    s_cbranch_vccz PDONE_54
    s_add_u32 s5, s5, 1
    s_cmp_lt_u32 s5, 200000
    s_cbranch_scc1 POLL_53
PDONE_54:
    v_add_f32 v88, v88, v92
    v_add_f32 v90, v90, v94
    v_add_f32 v88, v88, v96
    v_add_f32 v90, v90, v98
    v_add_f32 v88, v88, v100
    v_add_f32 v90, v90, v102
    v_add_f32 v88, v88, v104
    v_add_f32 v90, v90, v106
    v_add_f32 v88, v88, v108
    v_add_f32 v90, v90, v110
    v_add_f32 v88, v88, v112
    v_add_f32 v90, v90, v114
    v_mov_b32 v89, v90
    v_add_f32_dpp v88, v88, v88 row_ror:8 row_mask:0xf bank_mask:0xf
    s_nop 0
    v_add_f32_dpp v89, v89, v89 row_ror:8 row_mask:0xf bank_mask:0xf
    v_mov_b32 v90, v88
    v_mov_b32 v91, v89
    s_nop 0
    v_permlane16_swap_b32 v88, v90
    v_permlane16_swap_b32 v89, v91
    v_pk_add_f32 v[88:89], v[88:89], v[90:91]
    v_mov_b32 v90, v88
    v_mov_b32 v91, v89
    s_nop 0
    v_permlane32_swap_b32 v88, v90
    v_permlane32_swap_b32 v89, v91
    v_pk_add_f32 v[88:89], v[88:89], v[90:91]
    v_cvt_pk_bf16_f32 v88, 0, v88
    v_cvt_pk_bf16_f32 v89, 0, v89
    v_pk_mul_f32 v[88:89], v[88:89], v[204:205] op_sel_hi:[1,0]
    v_lshlrev_b32 v4, 16, v244
    v_and_b32 v5, s6, v244
    v_cvt_pk_bf16_f32 v88, 0, v88
    v_cvt_pk_bf16_f32 v89, 0, v89
    v_pk_add_f32 v[88:89], v[88:89], v[4:5]
    v_cvt_pk_bf16_f32 v88, 0, v88
    v_cvt_pk_bf16_f32 v89, 0, v89
    v_pk_mul_f32 v[88:89], v[88:89], v[206:207]
    v_lshlrev_b32 v4, 16, v245
    v_and_b32 v5, s6, v245
    v_cvt_pk_bf16_f32 v88, 0, v88
    v_cvt_pk_bf16_f32 v89, 0, v89
    v_pk_add_f32 v[88:89], v[88:89], v[4:5]
    v_cvt_pk_bf16_f32 v88, v88, v89
    s_mov_b64 exec, 0xff
    buffer_store_dword v88, v10, s[64:67], s82 offen
    s_mov_b64 exec, -1
L_FIN:
L_END:
    s_endpgm
.p2align 10
.fill 768, 4, 0xbf800000
.section .rodata,"a"
.p2align 6
.amdhsa_kernel adaLN_cond__linear_kernel_hedgehog__moe_arch_mod__prompt_kernel
  .amdhsa_next_free_vgpr 256
  .amdhsa_next_free_sgpr 102
  .amdhsa_accum_offset 256
  .amdhsa_group_segment_fixed_size 0
  .amdhsa_kernarg_size 112
  .amdhsa_user_sgpr_count 2
  .amdhsa_user_sgpr_kernarg_segment_ptr 1
  .amdhsa_system_sgpr_workgroup_id_x 1
  .amdhsa_float_denorm_mode_32 3
  .amdhsa_float_denorm_mode_16_64 3
.end_amdhsa_kernel
```

```asm
; @launch grid=(256,1,1) block=(512,1,1) lds=163840
.amdgcn_target "amdgcn-amd-amdhsa--gfx950"
.text
.globl adaLN_cond__linear_kernel_hedgehog__moe_arch_mod__prompt_kernel
.p2align 12
.type adaLN_cond__linear_kernel_hedgehog__moe_arch_mod__prompt_kernel,@function
adaLN_cond__linear_kernel_hedgehog__moe_arch_mod__prompt_kernel:
    s_load_dwordx16 s[68:83], s[0:1], 0
    s_load_dwordx8 s[84:91], s[0:1], 64
    s_load_dwordx2 s[32:33], s[0:1], 104
    s_cmp_ge_u32 s2, 256
    s_cbranch_scc1 L_END
    v_lshrrev_b32 v4, 6, v0
    v_and_b32 v1, 63, v0
    s_nop 0
    v_readfirstlane_b32 s3, v4
    v_lshlrev_b32 v2, 4, v1
    s_mov_b32 s38, 4194304
    s_mov_b32 s39, 0x20000
    s_mov_b32 s50, 12582912
    s_mov_b32 s51, 0x20000
    s_mov_b32 s34, 268435456
    s_mov_b32 s35, 0x20000
    s_mov_b32 s42, 6291456
    s_mov_b32 s43, 0x20000
    s_mov_b32 s46, 2097152
    s_mov_b32 s47, 0x20000
    s_mov_b32 s54, 7340032
    s_mov_b32 s55, 0x20000
    s_mov_b32 s58, 7340032
    s_mov_b32 s59, 0x20000
    s_mov_b32 s62, 7340032
    s_mov_b32 s63, 0x20000
    s_mov_b32 s66, 4194304
    s_mov_b32 s67, 0x20000
    s_mov_b32 s5, 0
    s_mov_b32 s6, 0xffff0000
    s_mov_b32 s7, 0x3fb8aa3b
    s_and_b32 s8, s2, 7
    s_lshr_b32 s9, s2, 3
    s_lshl_b32 s96, s8, 5
    s_add_u32 s97, s96, s9
    s_lshl3_add_u32 s93, s97, s3
    s_and_b32 s96, s8, 4
    s_lshr_b32 s97, s9, 2
    s_lshl1_add_u32 s10, s96, s97
    s_and_b32 s96, s8, 3
    s_and_b32 s97, s9, 3
    s_xor_b32 s98, s97, 2
    s_lshl2_add_u32 s11, s96, s98
    s_and_b32 s96, s8, 1
    s_and_b32 s97, s9, 7
    s_lshl3_add_u32 s12, s96, s97
    s_lshr_b32 s96, s8, 1
    s_lshr_b32 s97, s9, 3
    s_lshl2_add_u32 s21, s96, s97
    s_lshl_b32 s96, s2, 6
    s_add_u32 s97, s96, s3
    s_lshl_b32 s98, s97, 6
    s_add_u32 s92, s98, 1048576
    s_lshl_b32 s16, s93, 11
    s_lshl3_add_u32 s96, s8, s3
    s_lshl_b32 s15, s96, 5
    s_mul_i32 s96, s15, 6144
    s_xor_b32 s97, s9, 1
    s_lshl_b32 s98, s97, 7
    s_add_u32 s13, s96, s98
    s_add_u32 s14, s13, 98304
    s_lshl3_add_u32 s96, s21, s3
    s_lshl_b32 s97, s96, 15
    s_lshl_b32 s98, s12, 7
    s_add_u32 s18, s97, s98
    s_lshr_b32 s96, s8, 1
    s_lshl4_add_u32 s97, s96, s12
    s_lshl4_add_u32 s98, s97, s3
    s_lshl_b32 s99, s98, 9
    s_add_u32 s17, s99, 524288
    v_lshrrev_b32 v248, 3, v1
    v_mul_u32_u24 v248, 12288, v248
    v_and_b32 v9, 7, v1
    v_lshl_add_u32 v248, v9, 4, v248
    v_lshrrev_b32 v249, 3, v1
    v_lshl_add_u32 v249, v249, 1, s15
    v_and_b32 v10, 15, v1
    v_lshlrev_b32 v10, 11, v10
    v_lshrrev_b32 v9, 4, v1
    v_lshl_add_u32 v10, v9, 4, v10
    s_waitcnt lgkmcnt(0)
    s_mov_b64 s[48:49], s[88:89]
    buffer_load_dwordx4 v[160:163], v248, s[48:51], s13 offen nt
    buffer_load_dwordx4 v[164:167], v248, s[48:51], s14 offen nt
    s_load_dword s4, s[32:33], 0
    global_load_ushort v168, v249, s[86:87]
    global_load_ushort v169, v249, s[86:87] offset:16
    s_mov_b64 s[36:37], s[68:69]
    s_load_dword s24, s[32:33], s92 offset:0 glc
    s_load_dword s25, s[32:33], s17 offset:508 glc
    s_load_dword s26, s[32:33], s17 offset:4604 glc
    s_barrier
    buffer_load_dwordx4 v[152:155], v2, s[36:39], s16 offen
    buffer_load_dwordx4 v[156:159], v2, s[36:39], s16 offen offset:1024
    s_mov_b64 s[40:41], s[70:71]
    s_mov_b64 s[44:45], s[74:75]
    s_mov_b64 s[52:53], s[80:81]
    s_mov_b64 s[56:57], s[82:83]
    s_mov_b64 s[60:61], s[84:85]
    s_mov_b64 s[64:65], s[90:91]
    s_getpc_b64 s[22:23]
    s_and_b32 s22, s22, 0xfffffc00
    s_lshl3_add_u32 s96, s9, s3
    s_lshl_b32 s19, s96, 7
    v_lshrrev_b32 v4, 5, v1
    v_lshl_add_u32 v4, v4, 15, s19
    v_min_u32 v4, 41984, v4
    global_load_dword v11, v4, s[22:23]
    s_lshr_b32 s76, s3, 2
    s_and_b32 s77, s3, 3
    s_lshl_b32 s83, s3, 10
    s_mul_i32 s96, s8, 7
    s_lshr_b32 s97, s9, 2
    s_add_u32 s74, s96, s97
    s_and_b32 s75, s9, 3
    v_bfe_u32 v6, v1, 4, 1
    v_lshlrev_b32 v6, 6, v6
    v_and_b32 v3, 7, v1
    v_lshlrev_b32 v3, 4, v3
    v_xor_b32 v3, v3, v6
    v_lshrrev_b32 v6, 3, v1
    v_mul_u32_u24 v6, 6144, v6
    v_add_u32 v3, v3, v6
    s_and_b32 s84, s9, 12
    s_mul_i32 s96, s3, 49152
    s_lshl_b32 s97, s11, 7
    s_add_u32 s85, s96, s97
    v_lshlrev_b32 v250, 3, v1
    v_lshlrev_b32 v251, 5, v1
    v_add_u32 v251, 147456, v251
    s_lshl2_add_u32 s13, s3, 147456
    v_lshrrev_b32 v252, 4, v1
    v_lshl_add_u32 v252, v252, 6, s13
    v_and_b32 v9, 7, v1
    v_lshl_add_u32 v252, v9, 8, v252
    v_bfe_u32 v9, v1, 3, 1
    v_lshl_add_u32 v252, v9, 5, v252
    buffer_load_dwordx4 v[12:15], v10, s[36:39], s18 offen
    buffer_load_dwordx4 v[16:19], v10, s[36:39], s18 offen offset:64
    s_lshr_b32 s96, s3, 1
    s_xor_b32 s97, s9, 1
    s_and_b32 s98, s97, 15
    s_lshl4_add_u32 s99, s96, s98
    s_lshr_b32 s97, s9, 4
    s_lshl1_add_u32 s96, s99, s97
    s_lshl3_add_u32 s98, s96, s8
    s_lshl_b32 s99, s98, 9
    s_add_u32 s13, s99, 524288
    s_waitcnt vmcnt(5)
    v_lshlrev_b32 v168, 16, v168
    v_mul_f32 v4, s7, v168
    v_exp_f32 v4, -v4
    s_nop 0
    v_add_f32 v4, 1.0, v4
    v_rcp_f32 v4, v4
    s_nop 0
    v_mul_f32 v168, v168, v4
    v_cvt_pk_bf16_f32 v168, 0, v168
    v_lshlrev_b32 v169, 16, v169
    v_mul_f32 v5, s7, v169
    v_exp_f32 v5, -v5
    s_nop 0
    v_add_f32 v5, 1.0, v5
    v_rcp_f32 v5, v5
    s_nop 0
    v_mul_f32 v169, v169, v5
    v_cvt_pk_bf16_f32 v169, 0, v169
    v_lshlrev_b32 v4, 16, v160
    v_and_b32 v5, s6, v160
    v_pk_mul_f32 v[176:177], v[168:169], v[4:5] op_sel:[0,0] op_sel_hi:[0,1]
    v_lshlrev_b32 v6, 16, v161
    v_and_b32 v7, s6, v161
    v_pk_mul_f32 v[178:179], v[168:169], v[6:7] op_sel:[0,0] op_sel_hi:[0,1]
    v_lshlrev_b32 v4, 16, v162
    v_and_b32 v5, s6, v162
    v_pk_mul_f32 v[180:181], v[168:169], v[4:5] op_sel:[0,0] op_sel_hi:[0,1]
    v_lshlrev_b32 v6, 16, v163
    v_and_b32 v7, s6, v163
    v_pk_mul_f32 v[182:183], v[168:169], v[6:7] op_sel:[0,0] op_sel_hi:[0,1]
    v_lshlrev_b32 v4, 16, v164
    v_and_b32 v5, s6, v164
    v_pk_fma_f32 v[176:177], v[168:169], v[4:5], v[176:177] op_sel:[1,0,0] op_sel_hi:[1,1,1]
    v_lshlrev_b32 v6, 16, v165
    v_and_b32 v7, s6, v165
    v_pk_fma_f32 v[178:179], v[168:169], v[6:7], v[178:179] op_sel:[1,0,0] op_sel_hi:[1,1,1]
    v_lshlrev_b32 v4, 16, v166
    v_and_b32 v5, s6, v166
    v_pk_fma_f32 v[180:181], v[168:169], v[4:5], v[180:181] op_sel:[1,0,0] op_sel_hi:[1,1,1]
    v_lshlrev_b32 v6, 16, v167
    v_and_b32 v7, s6, v167
    v_pk_fma_f32 v[182:183], v[168:169], v[6:7], v[182:183] op_sel:[1,0,0] op_sel_hi:[1,1,1]
    v_permlane32_swap_b32 v176, v180
    v_permlane32_swap_b32 v177, v181
    v_permlane32_swap_b32 v178, v182
    v_permlane32_swap_b32 v179, v183
    v_add_f32 v176, v176, v180
    v_add_f32 v177, v177, v181
    v_add_f32 v178, v178, v182
    v_add_f32 v179, v179, v183
    s_nop 0
    v_permlane16_swap_b32 v176, v178
    v_permlane16_swap_b32 v177, v179
    v_add_f32 v176, v176, v178
    v_add_f32 v177, v177, v179
    s_nop 0
    v_add_f32_dpp v176, v176, v176 row_ror:8 row_mask:0xf bank_mask:0xf
    v_add_f32_dpp v177, v177, v177 row_ror:8 row_mask:0xf bank_mask:0xf
    s_nop 1
    v_mov_b32_dpp v176, v177 quad_perm:[0,1,2,3] row_mask:0xf bank_mask:0xc
    s_waitcnt lgkmcnt(0)
    s_mul_i32 s4, s4, 0x9e3779b1
    s_add_u32 s4, s4, 0x7f4a7c15
    ds_write_b32 v252, v176
    s_waitcnt lgkmcnt(0)
    s_barrier
    ds_read_b128 v[176:179], v251
    ds_read_b128 v[180:183], v251 offset:16
    s_waitcnt lgkmcnt(0)
    v_pk_add_f32 v[176:177], v[176:177], v[178:179]
    v_pk_add_f32 v[180:181], v[180:181], v[182:183]
    v_pk_add_f32 v[176:177], v[176:177], v[180:181]
    v_add_f32 v176, v176, v177
    v_mov_b32 v177, s4
    s_bitcmp1_b32 s3, 0
    s_cselect_b32 exec_lo, 0, -1
    s_cselect_b32 exec_hi, -1, 0
    buffer_store_dwordx2 v[176:177], v250, s[32:35], s13 offen sc1
    s_mov_b64 exec, -1
    s_lshr_b32 s96, s9, 4
    s_lshl_b32 s94, s96, 1
    s_add_u32 s96, s94, s84
    s_and_b32 s97, s96, 15
    s_mul_i32 s98, s97, 393216
    s_add_u32 s91, s98, s85
    s_lshl_b32 s96, s94, 13
    s_add_u32 s94, s96, s83
    s_add_u32 s82, s91, 2048
    s_mov_b32 m0, s94
    s_nop 0
    buffer_load_dwordx4 v3, s[40:43], s82 offen lds
    s_add_u32 s82, s91, 4096
    s_add_u32 m0, s94, 49152
    s_nop 0
    buffer_load_dwordx4 v3, s[40:43], s82 offen lds
    s_waitcnt vmcnt(6)
    v_mov_b32 v8, 0x3f803f80
    v_dot2_f32_bf16 v4, v152, v8, 0
    v_dot2_f32_bf16 v5, v152, v152, 0
    v_dot2_f32_bf16 v6, v153, v8, 0
    v_dot2_f32_bf16 v7, v153, v153, 0
    v_dot2_f32_bf16 v4, v154, v8, v4
    v_dot2_f32_bf16 v5, v154, v154, v5
    v_dot2_f32_bf16 v6, v155, v8, v6
    v_dot2_f32_bf16 v7, v155, v155, v7
    v_dot2_f32_bf16 v4, v156, v8, v4
    v_dot2_f32_bf16 v5, v156, v156, v5
    v_dot2_f32_bf16 v6, v157, v8, v6
    v_dot2_f32_bf16 v7, v157, v157, v7
    v_dot2_f32_bf16 v4, v158, v8, v4
    v_dot2_f32_bf16 v5, v158, v158, v5
    v_dot2_f32_bf16 v6, v159, v8, v6
    v_dot2_f32_bf16 v7, v159, v159, v7
    s_nop 2
    v_pk_add_f32 v[4:5], v[4:5], v[6:7]
    s_nop 1
    v_add_f32_dpp v4, v4, v4 quad_perm:[1,0,3,2] row_mask:0xf bank_mask:0xf
    v_add_f32_dpp v5, v5, v5 quad_perm:[1,0,3,2] row_mask:0xf bank_mask:0xf
    s_nop 0
    v_add_f32_dpp v4, v4, v4 quad_perm:[2,3,0,1] row_mask:0xf bank_mask:0xf
    v_add_f32_dpp v5, v5, v5 quad_perm:[2,3,0,1] row_mask:0xf bank_mask:0xf
    s_nop 0
    v_add_f32_dpp v4, v4, v4 row_half_mirror row_mask:0xf bank_mask:0xf
    v_add_f32_dpp v5, v5, v5 row_half_mirror row_mask:0xf bank_mask:0xf
    s_nop 0
    v_add_f32_dpp v4, v4, v4 row_ror:8 row_mask:0xf bank_mask:0xf
    v_add_f32_dpp v5, v5, v5 row_ror:8 row_mask:0xf bank_mask:0xf
    s_nop 1
    v_permlane16_swap_b32 v4, v5
    v_add_f32 v8, v4, v5
    v_add_f32 v4, v4, v5
    s_nop 1
    v_permlane32_swap_b32 v4, v8
    v_add_f32 v4, v4, v8
    v_mul_f32 v8, 0x3a800000, v4
    v_mul_f32 v4, 0x3a800000, v4
    s_nop 1
    v_permlane16_swap_b32 v4, v8
    v_fma_f32 v173, -v4, v4, v8
    v_cvt_pk_bf16_f32 v172, 0, v4
    v_max_f32 v173, 0, v173
    v_cvt_pk_bf16_f32 v173, 0, v173
    v_add_f32 v173, 0x3727c5ac, v173
    v_cvt_pk_bf16_f32 v173, 0, v173
    v_sqrt_f32 v173, v173
    s_nop 0
    v_cvt_pk_bf16_f32 v173, 0, v173
    s_lshl3_add_u32 s13, s3, 153600
    v_lshrrev_b32 v172, 16, v172
    v_or_b32 v172, v172, v173
    v_mov_b32 v173, s4
    v_mov_b32 v4, s13
    ds_write_b64 v4, v[172:173]
    v_and_b32 v5, 3, v1
    v_lshlrev_b32 v5, 4, v5
    v_add_u32 v5, 153600, v5
    v_and_b32 v4, 3, v1
    v_lshlrev_b32 v4, 4, v4
    v_bfe_u32 v9, v1, 2, 1
    v_lshl_add_u32 v4, v9, 10, v4
    s_and_b32 s96, s8, 6
    s_and_b32 s97, s8, 1
    s_lshr_b32 s98, s9, 4
    s_lshl1_add_u32 s99, s97, s98
    s_lshl_b32 s97, s99, 6
    s_add_u32 s98, s96, s97
    s_lshl3_add_u32 s99, s3, s98
    s_lshl_b32 s96, s99, 10
    s_and_b32 s97, s9, 15
    s_lshl_b32 s98, s97, 6
    s_add_u32 s99, s96, s98
    s_add_u32 s13, s99, 262144
    s_waitcnt lgkmcnt(0)
    s_barrier
    ds_read_b128 v[172:175], v5
    s_waitcnt lgkmcnt(0)
    s_mov_b64 exec, 0xff
    buffer_store_dwordx4 v[172:175], v4, s[32:35], s13 offen sc1
    s_mov_b64 exec, -1
    s_mov_b32 s82, s91
    s_add_u32 m0, s94, 98304
    s_nop 0
    buffer_load_dwordx4 v3, s[40:43], s82 offen lds
    s_load_dword s24, s[32:33], s17 offset:508 glc
    s_load_dword s25, s[32:33], s17 offset:4604 glc
    v_and_b32 v4, 31, v1
    v_lshlrev_b32 v4, 4, v4
    v_lshrrev_b32 v9, 5, v1
    v_lshl_add_u32 v4, v9, 12, v4
    s_lshl2_add_u32 s14, s3, 155648
    v_lshl_add_u32 v5, v1, 6, s14
    v_and_b32 v6, 3, v1
    v_lshlrev_b32 v6, 5, v6
    v_lshrrev_b32 v9, 5, v1
    v_lshl_add_u32 v6, v9, 7, v6
    v_bfe_u32 v9, v1, 4, 1
    v_lshl_add_u32 v6, v9, 8, v6
    v_bfe_u32 v9, v1, 2, 2
    v_lshl_add_u32 v6, v9, 9, v6
    v_add_u32 v6, 155648, v6
    s_lshl3_add_u32 s96, s2, s3
    s_lshl_b32 s97, s96, 7
    s_add_u32 s14, s97, 262144
    v_and_b32 v8, 15, v1
    v_lshlrev_b32 v8, 3, v8
    s_branch SCHK_2
SPOLL_1:
    s_load_dword s24, s[32:33], s17 offset:508 glc
    s_load_dword s25, s[32:33], s17 offset:4604 glc
SCHK_2:
    s_add_u32 s5, s5, 1
    s_cmp_ge_u32 s5, 200000
    s_waitcnt lgkmcnt(0)
    s_cbranch_scc1 SDONE_3
    s_cmp_lg_u32 s24, s4
    s_cbranch_scc1 SPOLL_1
    s_cmp_lg_u32 s25, s4
    s_cbranch_scc1 SPOLL_1
SDONE_3:
    buffer_load_dwordx4 v[176:179], v4, s[32:35], s17 offen sc1
    s_load_dword s24, s[32:33], s14 offset:60 glc
    s_load_dword s25, s[32:33], s14 offset:124 glc
    s_waitcnt vmcnt(6)
    v_permlane32_swap_b32 v12, v14
    v_permlane32_swap_b32 v13, v15
    v_permlane32_swap_b32 v16, v18
    v_permlane32_swap_b32 v17, v19
    v_lshlrev_b32 v184, 16, v12
    v_and_b32 v185, s6, v12
    v_lshlrev_b32 v186, 16, v13
    v_and_b32 v187, s6, v13
    v_lshlrev_b32 v188, 16, v14
    v_and_b32 v189, s6, v14
    v_lshlrev_b32 v190, 16, v15
    v_and_b32 v191, s6, v15
    v_lshlrev_b32 v192, 16, v16
    v_and_b32 v193, s6, v16
    v_lshlrev_b32 v194, 16, v17
    v_and_b32 v195, s6, v17
    v_lshlrev_b32 v196, 16, v18
    v_and_b32 v197, s6, v18
    v_lshlrev_b32 v198, 16, v19
    v_and_b32 v199, s6, v19
    s_branch SCHK_6
SPOLL_5:
    s_load_dword s24, s[32:33], s14 offset:60 glc
    s_load_dword s25, s[32:33], s14 offset:124 glc
SCHK_6:
    s_add_u32 s5, s5, 1
    s_cmp_ge_u32 s5, 200000
    s_waitcnt lgkmcnt(0)
    s_cbranch_scc1 SDONE_7
    s_cmp_lg_u32 s24, s4
    s_cbranch_scc1 SPOLL_5
    s_cmp_lg_u32 s25, s4
    s_cbranch_scc1 SPOLL_5
SDONE_7:
    buffer_load_dwordx2 v[172:173], v8, s[32:35], s14 offen sc1
    s_lshr_b32 s96, s9, 4
    s_lshl_b32 s97, s96, 1
    s_xor_b32 s94, s97, 1
    s_add_u32 s96, s94, s84
    s_and_b32 s97, s96, 15
    s_mul_i32 s98, s97, 393216
    s_add_u32 s91, s98, s85
    s_lshl_b32 s96, s94, 13
    s_add_u32 s94, s96, s83
    s_add_u32 s82, s91, 2048
    s_mov_b32 m0, s94
    s_nop 0
    buffer_load_dwordx4 v3, s[40:43], s82 offen lds
    s_add_u32 s82, s91, 4096
    s_add_u32 m0, s94, 49152
    s_nop 0
    buffer_load_dwordx4 v3, s[40:43], s82 offen lds
    s_mov_b32 s82, s91
    s_add_u32 m0, s94, 98304
    s_nop 0
    buffer_load_dwordx4 v3, s[40:43], s82 offen lds
    s_waitcnt vmcnt(4)
    v_bitop3_b32 v7, v177, v179, s4 bitop3:0x7e
    v_cmp_ne_u32 vcc, 0, v7
    s_cbranch_vccz TOK_8
POLL_9:
    buffer_load_dwordx4 v[176:179], v4, s[32:35], s17 offen sc1
    s_waitcnt vmcnt(0)
    v_bitop3_b32 v7, v177, v179, s4 bitop3:0x7e
    v_cmp_ne_u32 vcc, 0, v7
    s_cbranch_vccz PDONE_10
    s_add_u32 s5, s5, 1
    s_cmp_lt_u32 s5, 200000
    s_cbranch_scc1 POLL_9
PDONE_10:
TOK_8:
    ds_write2_b32 v5, v176, v178 offset0:0 offset1:8
    s_waitcnt lgkmcnt(0)
    s_barrier
    ds_read_b128 v[208:211], v6 offset:2048
    ds_read_b128 v[212:215], v6 offset:2064
    ds_read_b128 v[200:203], v6
    ds_read_b128 v[204:207], v6 offset:16
    s_lshl_b32 s96, s11, 12
    s_lshl_b32 s97, s3, 9
    s_add_u32 s13, s96, s97
    v_add_u32 v4, s13, v2
    s_lshl_b32 s96, s3, 9
    s_add_u32 m0, s96, 159744
    s_mov_b32 exec_hi, 0
    global_load_lds_dwordx4 v4, s[72:73]
    s_mov_b32 exec_hi, -1
    s_lshl4_add_u32 s96, s21, s12
    s_lshr_b32 s97, s3, 1
    s_lshl2_add_u32 s98, s96, s97
    s_lshl_b32 s99, s98, 12
    s_and_b32 s96, s3, 1
    s_lshl_b32 s97, s96, 8
    s_add_u32 s98, s99, s97
    s_add_u32 s13, s98, 4194304
    v_and_b32 v4, 15, v1
    v_lshlrev_b32 v4, 4, v4
    v_bfe_u32 v9, v1, 4, 1
    v_lshl_add_u32 v4, v9, 10, v4
    v_lshrrev_b32 v9, 5, v1
    v_lshl_add_u32 v4, v9, 9, v4
    s_waitcnt lgkmcnt(2)
    v_pk_add_f32 v[208:209], v[208:209], v[210:211]
    v_pk_add_f32 v[212:213], v[212:213], v[214:215]
    v_pk_add_f32 v[208:209], v[208:209], v[212:213]
    v_add_f32 v208, v208, v209
    v_cvt_pk_bf16_f32 v208, 0, v208
    s_waitcnt lgkmcnt(0)
    v_pk_add_f32 v[200:201], v[200:201], v[202:203]
    v_pk_add_f32 v[204:205], v[204:205], v[206:207]
    v_pk_add_f32 v[200:201], v[200:201], v[204:205]
    v_add_f32 v200, v200, v201
    v_add_f32 v208, 1.0, v208
    v_cvt_pk_bf16_f32 v208, 0, v208
    v_cvt_pk_bf16_f32 v200, 0, v200
    s_waitcnt vmcnt(4)
    v_cmp_ne_u32 vcc, s4, v173
    s_cbranch_vccz L_STOK
POLL_11:
    buffer_load_dwordx2 v[172:173], v8, s[32:35], s14 offen sc1
    s_waitcnt vmcnt(0)
    v_cmp_ne_u32 vcc, s4, v173
    s_cbranch_vccz PDONE_12
    s_add_u32 s5, s5, 1
    s_cmp_lt_u32 s5, 200000
    s_cbranch_scc1 POLL_11
PDONE_12:
L_STOK:
    v_lshlrev_b32 v173, 16, v172
    v_and_b32 v172, s6, v172
    v_rcp_f32 v172, v172
    s_nop 0
    v_pk_add_f32 v[184:185], v[172:173], v[184:185] op_sel:[1,0] neg_lo:[1,0] neg_hi:[1,0]
    v_pk_add_f32 v[186:187], v[172:173], v[186:187] op_sel:[1,0] neg_lo:[1,0] neg_hi:[1,0]
    v_pk_add_f32 v[188:189], v[172:173], v[188:189] op_sel:[1,0] neg_lo:[1,0] neg_hi:[1,0]
    v_pk_add_f32 v[190:191], v[172:173], v[190:191] op_sel:[1,0] neg_lo:[1,0] neg_hi:[1,0]
    v_pk_add_f32 v[192:193], v[172:173], v[192:193] op_sel:[1,0] neg_lo:[1,0] neg_hi:[1,0]
    v_pk_add_f32 v[194:195], v[172:173], v[194:195] op_sel:[1,0] neg_lo:[1,0] neg_hi:[1,0]
    v_pk_add_f32 v[196:197], v[172:173], v[196:197] op_sel:[1,0] neg_lo:[1,0] neg_hi:[1,0]
    v_pk_add_f32 v[198:199], v[172:173], v[198:199] op_sel:[1,0] neg_lo:[1,0] neg_hi:[1,0]
    v_cvt_pk_bf16_f32 v184, 0, v184
    v_cvt_pk_bf16_f32 v185, 0, v185
    v_cvt_pk_bf16_f32 v186, 0, v186
    v_cvt_pk_bf16_f32 v187, 0, v187
    v_cvt_pk_bf16_f32 v188, 0, v188
    v_cvt_pk_bf16_f32 v189, 0, v189
    v_cvt_pk_bf16_f32 v190, 0, v190
    v_cvt_pk_bf16_f32 v191, 0, v191
    v_cvt_pk_bf16_f32 v192, 0, v192
    v_cvt_pk_bf16_f32 v193, 0, v193
    v_cvt_pk_bf16_f32 v194, 0, v194
    v_cvt_pk_bf16_f32 v195, 0, v195
    v_cvt_pk_bf16_f32 v196, 0, v196
    v_cvt_pk_bf16_f32 v197, 0, v197
    v_cvt_pk_bf16_f32 v198, 0, v198
    v_cvt_pk_bf16_f32 v199, 0, v199
    v_pk_mul_f32 v[184:185], v[184:185], v[172:173] op_sel_hi:[1,0]
    v_pk_mul_f32 v[186:187], v[186:187], v[172:173] op_sel_hi:[1,0]
    v_pk_mul_f32 v[188:189], v[188:189], v[172:173] op_sel_hi:[1,0]
    v_pk_mul_f32 v[190:191], v[190:191], v[172:173] op_sel_hi:[1,0]
    v_pk_mul_f32 v[192:193], v[192:193], v[172:173] op_sel_hi:[1,0]
    v_pk_mul_f32 v[194:195], v[194:195], v[172:173] op_sel_hi:[1,0]
    v_pk_mul_f32 v[196:197], v[196:197], v[172:173] op_sel_hi:[1,0]
    v_pk_mul_f32 v[198:199], v[198:199], v[172:173] op_sel_hi:[1,0]
    v_cvt_pk_bf16_f32 v184, 0, v184
    v_cvt_pk_bf16_f32 v185, 0, v185
    v_cvt_pk_bf16_f32 v186, 0, v186
    v_cvt_pk_bf16_f32 v187, 0, v187
    v_cvt_pk_bf16_f32 v188, 0, v188
    v_cvt_pk_bf16_f32 v189, 0, v189
    v_cvt_pk_bf16_f32 v190, 0, v190
    v_cvt_pk_bf16_f32 v191, 0, v191
    v_cvt_pk_bf16_f32 v192, 0, v192
    v_cvt_pk_bf16_f32 v193, 0, v193
    v_cvt_pk_bf16_f32 v194, 0, v194
    v_cvt_pk_bf16_f32 v195, 0, v195
    v_cvt_pk_bf16_f32 v196, 0, v196
    v_cvt_pk_bf16_f32 v197, 0, v197
    v_cvt_pk_bf16_f32 v198, 0, v198
    v_cvt_pk_bf16_f32 v199, 0, v199
    v_mul_f32_dpp v184, v208, v184 row_newbcast:0 row_mask:0xf bank_mask:0xf
    v_mul_f32_dpp v185, v208, v185 row_newbcast:1 row_mask:0xf bank_mask:0xf
    v_mul_f32_dpp v186, v208, v186 row_newbcast:2 row_mask:0xf bank_mask:0xf
    v_mul_f32_dpp v187, v208, v187 row_newbcast:3 row_mask:0xf bank_mask:0xf
    v_mul_f32_dpp v188, v208, v188 row_newbcast:4 row_mask:0xf bank_mask:0xf
    v_mul_f32_dpp v189, v208, v189 row_newbcast:5 row_mask:0xf bank_mask:0xf
    v_mul_f32_dpp v190, v208, v190 row_newbcast:6 row_mask:0xf bank_mask:0xf
    v_mul_f32_dpp v191, v208, v191 row_newbcast:7 row_mask:0xf bank_mask:0xf
    v_cvt_pk_bf16_f32 v184, 0, v184
    v_cvt_pk_bf16_f32 v185, 0, v185
    v_cvt_pk_bf16_f32 v186, 0, v186
    v_cvt_pk_bf16_f32 v187, 0, v187
    v_cvt_pk_bf16_f32 v188, 0, v188
    v_cvt_pk_bf16_f32 v189, 0, v189
    v_cvt_pk_bf16_f32 v190, 0, v190
    v_cvt_pk_bf16_f32 v191, 0, v191
    v_add_f32_dpp v184, v200, v184 row_newbcast:0 row_mask:0xf bank_mask:0xf
    v_add_f32_dpp v185, v200, v185 row_newbcast:1 row_mask:0xf bank_mask:0xf
    v_add_f32_dpp v186, v200, v186 row_newbcast:2 row_mask:0xf bank_mask:0xf
    v_add_f32_dpp v187, v200, v187 row_newbcast:3 row_mask:0xf bank_mask:0xf
    v_add_f32_dpp v188, v200, v188 row_newbcast:4 row_mask:0xf bank_mask:0xf
    v_add_f32_dpp v189, v200, v189 row_newbcast:5 row_mask:0xf bank_mask:0xf
    v_add_f32_dpp v190, v200, v190 row_newbcast:6 row_mask:0xf bank_mask:0xf
    v_add_f32_dpp v191, v200, v191 row_newbcast:7 row_mask:0xf bank_mask:0xf
    v_cvt_pk_bf16_f32 v216, v184, v185
    v_cvt_pk_bf16_f32 v217, v186, v187
    v_cvt_pk_bf16_f32 v218, v188, v189
    v_cvt_pk_bf16_f32 v219, v190, v191
    buffer_store_dwordx4 v[216:219], v4, s[32:35], s13 offen sc1
    v_mul_f32_dpp v192, v208, v192 row_newbcast:8 row_mask:0xf bank_mask:0xf
    v_mul_f32_dpp v193, v208, v193 row_newbcast:9 row_mask:0xf bank_mask:0xf
    v_mul_f32_dpp v194, v208, v194 row_newbcast:10 row_mask:0xf bank_mask:0xf
    v_mul_f32_dpp v195, v208, v195 row_newbcast:11 row_mask:0xf bank_mask:0xf
    v_mul_f32_dpp v196, v208, v196 row_newbcast:12 row_mask:0xf bank_mask:0xf
    v_mul_f32_dpp v197, v208, v197 row_newbcast:13 row_mask:0xf bank_mask:0xf
    v_mul_f32_dpp v198, v208, v198 row_newbcast:14 row_mask:0xf bank_mask:0xf
    v_mul_f32_dpp v199, v208, v199 row_newbcast:15 row_mask:0xf bank_mask:0xf
    v_cvt_pk_bf16_f32 v192, 0, v192
    v_cvt_pk_bf16_f32 v193, 0, v193
    v_cvt_pk_bf16_f32 v194, 0, v194
    v_cvt_pk_bf16_f32 v195, 0, v195
    v_cvt_pk_bf16_f32 v196, 0, v196
    v_cvt_pk_bf16_f32 v197, 0, v197
    v_cvt_pk_bf16_f32 v198, 0, v198
    v_cvt_pk_bf16_f32 v199, 0, v199
    v_add_f32_dpp v192, v200, v192 row_newbcast:8 row_mask:0xf bank_mask:0xf
    v_add_f32_dpp v193, v200, v193 row_newbcast:9 row_mask:0xf bank_mask:0xf
    v_add_f32_dpp v194, v200, v194 row_newbcast:10 row_mask:0xf bank_mask:0xf
    v_add_f32_dpp v195, v200, v195 row_newbcast:11 row_mask:0xf bank_mask:0xf
    v_add_f32_dpp v196, v200, v196 row_newbcast:12 row_mask:0xf bank_mask:0xf
    v_add_f32_dpp v197, v200, v197 row_newbcast:13 row_mask:0xf bank_mask:0xf
    v_add_f32_dpp v198, v200, v198 row_newbcast:14 row_mask:0xf bank_mask:0xf
    v_add_f32_dpp v199, v200, v199 row_newbcast:15 row_mask:0xf bank_mask:0xf
    v_cvt_pk_bf16_f32 v220, v192, v193
    v_cvt_pk_bf16_f32 v221, v194, v195
    v_cvt_pk_bf16_f32 v222, v196, v197
    v_cvt_pk_bf16_f32 v223, v198, v199
    buffer_store_dwordx4 v[220:223], v4, s[32:35], s13 offen offset:2048 sc1
    v_bfe_u32 v20, v1, 2, 2
    v_lshlrev_b32 v20, 7, v20
    v_bfe_u32 v9, v1, 3, 1
    v_lshl_add_u32 v20, v9, 6, v20
    v_bfe_u32 v9, v1, 4, 1
    v_lshl_add_u32 v20, v9, 5, v20
    v_and_b32 v9, 3, v1
    v_lshl_add_u32 v20, v9, 3, v20
    v_lshrrev_b32 v9, 5, v1
    v_lshl_add_u32 v20, v9, 9, v20
    v_xor_b32 v21, 64, v20
    v_add_u32 v22, 49152, v20
    v_add_u32 v23, 49152, v21
    v_add_u32 v24, 98304, v20
    v_add_u32 v25, 98304, v21
    v_and_b32 v5, 3, v1
    v_lshlrev_b32 v5, 15, v5
    v_bfe_u32 v9, v1, 2, 2
    v_lshl_add_u32 v5, v9, 12, v5
    s_and_b32 s96, s12, 1
    s_lshr_b32 s97, s21, 3
    s_and_b32 s98, s21, 7
    s_lshl_b32 s99, s98, 5
    s_lshl2_add_u32 s98, s97, s99
    s_lshl_b32 s97, s98, 12
    s_lshr_b32 s99, s12, 1
    s_lshl_b32 s98, s99, 6
    s_add_u32 s99, s97, s98
    s_lshl2_add_u32 s97, s96, s99
    s_add_u32 s13, s97, 1048576
    s_lshl_b32 s96, s10, 18
    s_lshl_b32 s97, s77, 12
    s_add_u32 s98, s96, s97
    s_add_u32 s88, s98, 4194304
    s_cmp_ge_u32 s9, 28
    s_cselect_b32 s54, 0, s54
    s_cselect_b32 s58, 0, s58
    s_cselect_b32 s62, 0, s62
    s_waitcnt vmcnt(0)
    s_barrier
    s_cmp_lg_u32 s3, 0
    s_cbranch_scc1 L_PB
    v_mov_b32 v6, s4
    s_mov_b32 exec_hi, 0
    s_mov_b32 exec_lo, 65535
    buffer_store_dword v6, v5, s[32:35], s13 offen sc1
    s_mov_b64 exec, -1
L_PB:
    s_lshr_b32 s96, s9, 4
    s_lshl_b32 s97, s96, 1
    s_xor_b32 s94, s97, 2
    s_add_u32 s96, s94, s84
    s_and_b32 s97, s96, 15
    s_mul_i32 s98, s97, 393216
    s_add_u32 s91, s98, s85
    s_lshl_b32 s96, s94, 13
    s_add_u32 s94, s96, s83
    s_add_u32 s82, s91, 2048
    s_mov_b32 m0, s94
    s_nop 0
    buffer_load_dwordx4 v3, s[40:43], s82 offen lds
    s_add_u32 s82, s91, 4096
    s_add_u32 m0, s94, 49152
    s_nop 0
    buffer_load_dwordx4 v3, s[40:43], s82 offen lds
    s_mov_b32 s82, s91
    s_add_u32 m0, s94, 98304
    s_nop 0
    buffer_load_dwordx4 v3, s[40:43], s82 offen lds
    s_lshr_b32 s96, s9, 4
    s_lshl_b32 s97, s96, 1
    s_xor_b32 s94, s97, 3
    s_add_u32 s96, s94, s84
    s_and_b32 s97, s96, 15
    s_mul_i32 s98, s97, 393216
    s_add_u32 s91, s98, s85
    s_lshl_b32 s96, s94, 13
    s_add_u32 s94, s96, s83
    s_add_u32 s82, s91, 2048
    s_mov_b32 m0, s94
    s_nop 0
    buffer_load_dwordx4 v3, s[40:43], s82 offen lds
    s_add_u32 s82, s91, 4096
    s_add_u32 m0, s94, 49152
    s_nop 0
    buffer_load_dwordx4 v3, s[40:43], s82 offen lds
    s_mov_b32 s82, s91
    s_add_u32 m0, s94, 98304
    s_nop 0
    buffer_load_dwordx4 v3, s[40:43], s82 offen lds
    s_lshl_b32 s96, s2, 12
    s_add_u32 s19, s96, 1048576
    s_and_b32 s96, s3, 3
    s_lshl_b32 s97, s96, 7
    s_add_u32 s20, s97, s19
    s_lshl_b32 s96, s84, 5
    s_add_u32 s19, s96, s19
    s_cmp_ge_u32 s3, 4
    s_cselect_b32 s19, s20, s19
    s_load_dwordx2 s[24:25], s[32:33], s19 offset:0 glc
    s_load_dwordx2 s[26:27], s[32:33], s19 offset:64 glc
    s_add_u32 s96, s84, 4
    s_and_b32 s97, s96, 15
    s_mul_i32 s98, s97, 393216
    s_add_u32 s91, s98, s85
    s_add_u32 s94, s83, 32768
    s_add_u32 s82, s91, 2048
    s_mov_b32 m0, s94
    s_nop 0
    buffer_load_dwordx4 v3, s[40:43], s82 offen lds
    s_add_u32 s82, s91, 4096
    s_add_u32 m0, s94, 49152
    s_nop 0
    buffer_load_dwordx4 v3, s[40:43], s82 offen lds
    s_mov_b32 s82, s91
    s_add_u32 m0, s94, 98304
    s_nop 0
    buffer_load_dwordx4 v3, s[40:43], s82 offen lds
    s_lshl_b32 s96, s3, 14
    s_lshl_b32 s97, s12, 7
    s_add_u32 s90, s96, s97
    s_and_b32 s96, s9, 1
    s_lshr_b32 s97, s9, 3
    s_lshl_b32 s98, s97, 1
    s_lshl3_add_u32 s99, s96, s98
    s_lshl_b32 s95, s99, 17
    s_lshl3_add_u32 s96, s75, s3
    s_mul_i32 s97, s96, 229376
    s_lshl_b32 s98, s74, 7
    s_add_u32 s80, s97, s98
    s_lshl3_add_u32 s96, s74, s3
    s_lshl_b32 s97, s96, 14
    s_lshl_b32 s98, s75, 9
    s_add_u32 s81, s97, s98
    s_and_b32 s96, s8, 3
    s_lshl3_add_u32 s97, s96, s3
    s_mul_i32 s98, s97, 393216
    s_lshr_b32 s99, s8, 2
    s_lshl1_add_u32 s96, s9, s99
    s_lshl_b32 s97, s96, 7
    s_add_u32 s99, s98, s97
    s_add_u32 s89, s99, 4096
    s_and_b32 s96, s3, 1
    s_lshl_b32 s14, s96, 6
    v_bfe_u32 v6, v1, 4, 1
    v_lshl_add_u32 v6, v6, 5, s14
    v_and_b32 v26, 7, v1
    v_lshlrev_b32 v26, 4, v26
    v_xor_b32 v26, v26, v6
    v_lshrrev_b32 v6, 3, v1
    v_lshlrev_b32 v6, 11, v6
    v_add_u32 v26, v26, v6
    s_and_b32 s96, s3, 2
    s_lshl_b32 s14, s96, 5
    v_bfe_u32 v6, v1, 4, 1
    v_lshl_add_u32 v6, v6, 5, s14
    v_and_b32 v27, 7, v1
    v_lshlrev_b32 v27, 4, v27
    v_xor_b32 v27, v27, v6
    v_lshrrev_b32 v6, 3, v1
    v_mul_u32_u24 v6, 7168, v6
    v_add_u32 v27, v27, v6
    s_and_b32 s96, s3, 1
    s_lshl_b32 s14, s96, 7
    v_lshrrev_b32 v6, 5, v1
    v_lshl_add_u32 v6, v6, 6, s14
    v_and_b32 v253, 31, v1
    v_lshlrev_b32 v253, 4, v253
    v_lshrrev_b32 v9, 5, v1
    v_lshl_add_u32 v253, v9, 11, v253
    v_xor_b32 v253, v253, v6
    s_lshl_b32 s16, s84, 14
    v_add_u32 v249, s88, v2
    s_lshl_b32 s96, s77, 11
    s_add_u32 s14, s96, 151552
    v_add_u32 v0, s14, v2
    s_mov_b64 exec, 0
    s_cmp_eq_u32 s3, 4
    s_cbranch_scc1 L_PAD2
    s_cmp_eq_u32 s3, 5
    s_cbranch_scc1 L_PAD3
    s_cmp_eq_u32 s3, 6
    s_cbranch_scc1 L_PAD4
    s_cmp_eq_u32 s3, 7
    s_cbranch_scc1 L_PAD5
    s_branch L_TEND
L_RET2:
    s_branch L_PAD6
L_RET6:
    s_branch L_PAD10
L_RET10:
    s_branch L_TEND
L_RET3:
    s_branch L_PAD7
L_RET7:
    s_branch L_TEND
L_RET4:
    s_branch L_PAD8
L_RET8:
    s_branch L_TEND
L_RET5:
    s_branch L_PAD9
L_RET9:
    s_branch L_TEND
    s_nop 0
    s_nop 0
    s_nop 0
    s_nop 0
    s_nop 0
    s_nop 0
    s_nop 0
    s_nop 0
    s_nop 0
    s_nop 0
    s_nop 0
    s_nop 0
    s_nop 0
    s_nop 0
    s_nop 0
    s_nop 0
    s_nop 0
    s_nop 0
    s_nop 0
    s_nop 0
    s_nop 0
    s_nop 0
    s_nop 0
    s_nop 0
    s_nop 0
    s_nop 0
    s_nop 0
    s_nop 0
L_TEND:
    s_mov_b64 exec, -1
    s_branch SCHK_14
SPOLL_13:
    s_load_dwordx2 s[24:25], s[32:33], s19 offset:0 glc
    s_load_dwordx2 s[26:27], s[32:33], s19 offset:64 glc
SCHK_14:
    s_add_u32 s5, s5, 1
    s_cmp_ge_u32 s5, 200000
    s_waitcnt lgkmcnt(0)
    s_cbranch_scc1 SDONE_15
    s_cmp_lg_u32 s24, s4
    s_cbranch_scc1 SPOLL_13
    s_cmp_lg_u32 s25, s4
    s_cbranch_scc1 SPOLL_13
    s_cmp_lg_u32 s26, s4
    s_cbranch_scc1 SPOLL_13
    s_cmp_lg_u32 s27, s4
    s_cbranch_scc1 SPOLL_13
SDONE_15:
    s_cmp_ge_u32 s3, 4
    s_cbranch_scc1 L_HELP
    s_setprio 2
    buffer_load_dwordx4 v[152:155], v249, s[32:35], s16 offen sc1
    buffer_load_dwordx4 v[156:159], v249, s[32:35], s16 offen offset:1024 sc1
    buffer_load_dwordx4 v[160:163], v249, s[32:35], s16 offen offset:2048 sc1
    buffer_load_dwordx4 v[164:167], v249, s[32:35], s16 offen offset:3072 sc1
    s_add_u32 s16, s16, 16384
    s_and_b32 s16, s16, 0x3ffff
    buffer_load_dwordx4 v[168:171], v249, s[32:35], s16 offen sc1
    buffer_load_dwordx4 v[172:175], v249, s[32:35], s16 offen offset:1024 sc1
    s_waitcnt vmcnt(9)
    s_barrier
    ds_read_b64_tr_b16 v[28:29], v20
    ds_read_b64_tr_b16 v[30:31], v20 offset:2048
    ds_read_b64_tr_b16 v[32:33], v21
    ds_read_b64_tr_b16 v[34:35], v21 offset:2048
    ds_read_b64_tr_b16 v[36:37], v24
    ds_read_b64_tr_b16 v[38:39], v24 offset:2048
    ds_read_b64_tr_b16 v[40:41], v25
    ds_read_b64_tr_b16 v[42:43], v25 offset:2048
    ds_read_b64_tr_b16 v[44:45], v22
    ds_read_b64_tr_b16 v[46:47], v22 offset:2048
    ds_read_b64_tr_b16 v[48:49], v23
    ds_read_b64_tr_b16 v[50:51], v23 offset:2048
    s_waitcnt vmcnt(5)
    s_waitcnt lgkmcnt(10)
    v_mfma_f32_32x32x16_bf16 v[56:71], v[28:31], v[152:155], 0
    ds_read_b64_tr_b16 v[52:53], v20 offset:1024
    ds_read_b64_tr_b16 v[54:55], v20 offset:3072
    s_waitcnt lgkmcnt(10)
    v_mfma_f32_32x32x16_bf16 v[72:87], v[32:35], v[152:155], 0
    ds_read_b64_tr_b16 v[28:29], v21 offset:1024
    ds_read_b64_tr_b16 v[30:31], v21 offset:3072
    s_waitcnt lgkmcnt(10)
    v_mfma_f32_32x32x16_bf16 v[120:135], v[36:39], v[152:155], 0
    ds_read_b64_tr_b16 v[32:33], v24 offset:1024
    ds_read_b64_tr_b16 v[34:35], v24 offset:3072
    s_waitcnt lgkmcnt(10)
    v_mfma_f32_32x32x16_bf16 v[136:151], v[40:43], v[152:155], 0
    ds_read_b64_tr_b16 v[36:37], v25 offset:1024
    ds_read_b64_tr_b16 v[38:39], v25 offset:3072
    s_waitcnt lgkmcnt(10)
    v_mfma_f32_32x32x16_bf16 v[88:103], v[44:47], v[152:155], 0
    buffer_load_dwordx4 v[176:179], v249, s[32:35], s16 offen offset:2048 sc1
    ds_read_b64_tr_b16 v[40:41], v22 offset:1024
    ds_read_b64_tr_b16 v[42:43], v22 offset:3072
    s_waitcnt lgkmcnt(10)
    v_mfma_f32_32x32x16_bf16 v[104:119], v[48:51], v[152:155], 0
    ds_read_b64_tr_b16 v[44:45], v23 offset:1024
    ds_read_b64_tr_b16 v[46:47], v23 offset:3072
    s_waitcnt vmcnt(5)
    s_waitcnt lgkmcnt(10)
    v_mfma_f32_32x32x16_bf16 v[56:71], v[52:55], v[156:159], v[56:71]
    ds_read_b64_tr_b16 v[48:49], v20 offset:4096
    ds_read_b64_tr_b16 v[50:51], v20 offset:6144
    s_waitcnt lgkmcnt(10)
    v_mfma_f32_32x32x16_bf16 v[72:87], v[28:31], v[156:159], v[72:87]
    ds_read_b64_tr_b16 v[52:53], v21 offset:4096
    ds_read_b64_tr_b16 v[54:55], v21 offset:6144
    s_waitcnt lgkmcnt(10)
    v_mfma_f32_32x32x16_bf16 v[120:135], v[32:35], v[156:159], v[120:135]
    ds_read_b64_tr_b16 v[28:29], v24 offset:4096
    ds_read_b64_tr_b16 v[30:31], v24 offset:6144
    s_waitcnt lgkmcnt(10)
    v_mfma_f32_32x32x16_bf16 v[136:151], v[36:39], v[156:159], v[136:151]
    buffer_load_dwordx4 v[180:183], v249, s[32:35], s16 offen offset:3072 sc1
    ds_read_b64_tr_b16 v[32:33], v25 offset:4096
    ds_read_b64_tr_b16 v[34:35], v25 offset:6144
    s_waitcnt lgkmcnt(10)
    v_mfma_f32_32x32x16_bf16 v[88:103], v[40:43], v[156:159], v[88:103]
    s_add_u32 s16, s16, 16384
    ds_read_b64_tr_b16 v[36:37], v22 offset:4096
    ds_read_b64_tr_b16 v[38:39], v22 offset:6144
    s_waitcnt lgkmcnt(10)
    v_mfma_f32_32x32x16_bf16 v[104:119], v[44:47], v[156:159], v[104:119]
    s_and_b32 s16, s16, 0x3ffff
    ds_read_b64_tr_b16 v[40:41], v23 offset:4096
    ds_read_b64_tr_b16 v[42:43], v23 offset:6144
    s_waitcnt vmcnt(5)
    s_waitcnt lgkmcnt(10)
    v_mfma_f32_32x32x16_bf16 v[56:71], v[48:51], v[160:163], v[56:71]
    ds_read_b64_tr_b16 v[44:45], v20 offset:5120
    ds_read_b64_tr_b16 v[46:47], v20 offset:7168
    s_waitcnt lgkmcnt(10)
    v_mfma_f32_32x32x16_bf16 v[72:87], v[52:55], v[160:163], v[72:87]
    ds_read_b64_tr_b16 v[48:49], v21 offset:5120
    ds_read_b64_tr_b16 v[50:51], v21 offset:7168
    s_waitcnt lgkmcnt(10)
    v_mfma_f32_32x32x16_bf16 v[120:135], v[28:31], v[160:163], v[120:135]
    buffer_load_dwordx4 v[184:187], v249, s[32:35], s16 offen sc1
    ds_read_b64_tr_b16 v[52:53], v24 offset:5120
    ds_read_b64_tr_b16 v[54:55], v24 offset:7168
    s_waitcnt lgkmcnt(10)
    v_mfma_f32_32x32x16_bf16 v[136:151], v[32:35], v[160:163], v[136:151]
    ds_read_b64_tr_b16 v[28:29], v25 offset:5120
    ds_read_b64_tr_b16 v[30:31], v25 offset:7168
    s_waitcnt lgkmcnt(10)
    v_mfma_f32_32x32x16_bf16 v[88:103], v[36:39], v[160:163], v[88:103]
    ds_read_b64_tr_b16 v[32:33], v22 offset:5120
    ds_read_b64_tr_b16 v[34:35], v22 offset:7168
    s_waitcnt lgkmcnt(10)
    v_mfma_f32_32x32x16_bf16 v[104:119], v[40:43], v[160:163], v[104:119]
    ds_read_b64_tr_b16 v[36:37], v23 offset:5120
    ds_read_b64_tr_b16 v[38:39], v23 offset:7168
    s_waitcnt vmcnt(5)
    s_waitcnt lgkmcnt(10)
    v_mfma_f32_32x32x16_bf16 v[56:71], v[44:47], v[164:167], v[56:71]
    ds_read_b64_tr_b16 v[40:41], v20 offset:8192
    ds_read_b64_tr_b16 v[42:43], v20 offset:10240
    s_waitcnt lgkmcnt(10)
    v_mfma_f32_32x32x16_bf16 v[72:87], v[48:51], v[164:167], v[72:87]
    buffer_load_dwordx4 v[188:191], v249, s[32:35], s16 offen offset:1024 sc1
    ds_read_b64_tr_b16 v[44:45], v21 offset:8192
    ds_read_b64_tr_b16 v[46:47], v21 offset:10240
    s_waitcnt lgkmcnt(10)
    v_mfma_f32_32x32x16_bf16 v[120:135], v[52:55], v[164:167], v[120:135]
    ds_read_b64_tr_b16 v[48:49], v24 offset:8192
    ds_read_b64_tr_b16 v[50:51], v24 offset:10240
    s_waitcnt lgkmcnt(10)
    v_mfma_f32_32x32x16_bf16 v[136:151], v[28:31], v[164:167], v[136:151]
    ds_read_b64_tr_b16 v[52:53], v25 offset:8192
    ds_read_b64_tr_b16 v[54:55], v25 offset:10240
    s_waitcnt lgkmcnt(10)
    v_mfma_f32_32x32x16_bf16 v[88:103], v[32:35], v[164:167], v[88:103]
    ds_read_b64_tr_b16 v[28:29], v22 offset:8192
    ds_read_b64_tr_b16 v[30:31], v22 offset:10240
    s_waitcnt lgkmcnt(10)
    v_mfma_f32_32x32x16_bf16 v[104:119], v[36:39], v[164:167], v[104:119]
    buffer_load_dwordx4 v[192:195], v249, s[32:35], s16 offen offset:2048 sc1
    ds_read_b64_tr_b16 v[32:33], v23 offset:8192
    ds_read_b64_tr_b16 v[34:35], v23 offset:10240
    s_barrier
    s_waitcnt vmcnt(6)
    s_waitcnt lgkmcnt(10)
    v_mfma_f32_32x32x16_bf16 v[56:71], v[40:43], v[168:171], v[56:71]
    ds_read_b64_tr_b16 v[36:37], v20 offset:9216
    ds_read_b64_tr_b16 v[38:39], v20 offset:11264
    s_waitcnt lgkmcnt(10)
    v_mfma_f32_32x32x16_bf16 v[72:87], v[44:47], v[168:171], v[72:87]
    ds_read_b64_tr_b16 v[40:41], v21 offset:9216
    ds_read_b64_tr_b16 v[42:43], v21 offset:11264
    s_waitcnt lgkmcnt(10)
    v_mfma_f32_32x32x16_bf16 v[120:135], v[48:51], v[168:171], v[120:135]
    ds_read_b64_tr_b16 v[44:45], v24 offset:9216
    ds_read_b64_tr_b16 v[46:47], v24 offset:11264
    s_waitcnt lgkmcnt(10)
    v_mfma_f32_32x32x16_bf16 v[136:151], v[52:55], v[168:171], v[136:151]
    ds_read_b64_tr_b16 v[48:49], v25 offset:9216
    ds_read_b64_tr_b16 v[50:51], v25 offset:11264
    s_waitcnt lgkmcnt(10)
    v_mfma_f32_32x32x16_bf16 v[88:103], v[28:31], v[168:171], v[88:103]
    buffer_load_dwordx4 v[196:199], v249, s[32:35], s16 offen offset:3072 sc1
    ds_read_b64_tr_b16 v[52:53], v22 offset:9216
    ds_read_b64_tr_b16 v[54:55], v22 offset:11264
    s_waitcnt lgkmcnt(10)
    v_mfma_f32_32x32x16_bf16 v[104:119], v[32:35], v[168:171], v[104:119]
    s_add_u32 s16, s16, 16384
    ds_read_b64_tr_b16 v[28:29], v23 offset:9216
    ds_read_b64_tr_b16 v[30:31], v23 offset:11264
    s_waitcnt vmcnt(6)
    s_waitcnt lgkmcnt(10)
    v_mfma_f32_32x32x16_bf16 v[56:71], v[36:39], v[172:175], v[56:71]
    s_and_b32 s16, s16, 0x3ffff
    ds_read_b64_tr_b16 v[32:33], v20 offset:12288
    ds_read_b64_tr_b16 v[34:35], v20 offset:14336
    s_waitcnt lgkmcnt(10)
    v_mfma_f32_32x32x16_bf16 v[72:87], v[40:43], v[172:175], v[72:87]
    ds_read_b64_tr_b16 v[36:37], v21 offset:12288
    ds_read_b64_tr_b16 v[38:39], v21 offset:14336
    s_waitcnt lgkmcnt(10)
    v_mfma_f32_32x32x16_bf16 v[120:135], v[44:47], v[172:175], v[120:135]
    ds_read_b64_tr_b16 v[40:41], v24 offset:12288
    ds_read_b64_tr_b16 v[42:43], v24 offset:14336
    s_waitcnt lgkmcnt(10)
    v_mfma_f32_32x32x16_bf16 v[136:151], v[48:51], v[172:175], v[136:151]
    buffer_load_dwordx4 v[200:203], v249, s[32:35], s16 offen sc1
    ds_read_b64_tr_b16 v[44:45], v25 offset:12288
    ds_read_b64_tr_b16 v[46:47], v25 offset:14336
    s_waitcnt lgkmcnt(10)
    v_mfma_f32_32x32x16_bf16 v[88:103], v[52:55], v[172:175], v[88:103]
    ds_read_b64_tr_b16 v[48:49], v22 offset:12288
    ds_read_b64_tr_b16 v[50:51], v22 offset:14336
    s_waitcnt lgkmcnt(10)
    v_mfma_f32_32x32x16_bf16 v[104:119], v[28:31], v[172:175], v[104:119]
    ds_read_b64_tr_b16 v[52:53], v23 offset:12288
    ds_read_b64_tr_b16 v[54:55], v23 offset:14336
    s_waitcnt vmcnt(6)
    s_waitcnt lgkmcnt(10)
    v_mfma_f32_32x32x16_bf16 v[56:71], v[32:35], v[176:179], v[56:71]
    ds_read_b64_tr_b16 v[28:29], v20 offset:13312
    ds_read_b64_tr_b16 v[30:31], v20 offset:15360
    s_waitcnt lgkmcnt(10)
    v_mfma_f32_32x32x16_bf16 v[72:87], v[36:39], v[176:179], v[72:87]
    ds_read_b64_tr_b16 v[32:33], v21 offset:13312
    ds_read_b64_tr_b16 v[34:35], v21 offset:15360
    s_waitcnt lgkmcnt(10)
    v_mfma_f32_32x32x16_bf16 v[120:135], v[40:43], v[176:179], v[120:135]
    buffer_load_dwordx4 v[204:207], v249, s[32:35], s16 offen offset:1024 sc1
    ds_read_b64_tr_b16 v[36:37], v24 offset:13312
    ds_read_b64_tr_b16 v[38:39], v24 offset:15360
    s_waitcnt lgkmcnt(10)
    v_mfma_f32_32x32x16_bf16 v[136:151], v[44:47], v[176:179], v[136:151]
    ds_read_b64_tr_b16 v[40:41], v25 offset:13312
    ds_read_b64_tr_b16 v[42:43], v25 offset:15360
    s_waitcnt lgkmcnt(10)
    v_mfma_f32_32x32x16_bf16 v[88:103], v[48:51], v[176:179], v[88:103]
    ds_read_b64_tr_b16 v[44:45], v22 offset:13312
    ds_read_b64_tr_b16 v[46:47], v22 offset:15360
    s_waitcnt lgkmcnt(10)
    v_mfma_f32_32x32x16_bf16 v[104:119], v[52:55], v[176:179], v[104:119]
    ds_read_b64_tr_b16 v[48:49], v23 offset:13312
    ds_read_b64_tr_b16 v[50:51], v23 offset:15360
    s_waitcnt vmcnt(6)
    s_waitcnt lgkmcnt(10)
    v_mfma_f32_32x32x16_bf16 v[56:71], v[28:31], v[180:183], v[56:71]
    ds_read_b64_tr_b16 v[52:53], v20 offset:16384
    ds_read_b64_tr_b16 v[54:55], v20 offset:18432
    s_waitcnt lgkmcnt(10)
    v_mfma_f32_32x32x16_bf16 v[72:87], v[32:35], v[180:183], v[72:87]
    buffer_load_dwordx4 v[208:211], v249, s[32:35], s16 offen offset:2048 sc1
    ds_read_b64_tr_b16 v[28:29], v21 offset:16384
    ds_read_b64_tr_b16 v[30:31], v21 offset:18432
    s_waitcnt lgkmcnt(10)
    v_mfma_f32_32x32x16_bf16 v[120:135], v[36:39], v[180:183], v[120:135]
    ds_read_b64_tr_b16 v[32:33], v24 offset:16384
    ds_read_b64_tr_b16 v[34:35], v24 offset:18432
    s_waitcnt lgkmcnt(10)
    v_mfma_f32_32x32x16_bf16 v[136:151], v[40:43], v[180:183], v[136:151]
    ds_read_b64_tr_b16 v[36:37], v25 offset:16384
    ds_read_b64_tr_b16 v[38:39], v25 offset:18432
    s_waitcnt lgkmcnt(10)
    v_mfma_f32_32x32x16_bf16 v[88:103], v[44:47], v[180:183], v[88:103]
    ds_read_b64_tr_b16 v[40:41], v22 offset:16384
    ds_read_b64_tr_b16 v[42:43], v22 offset:18432
    s_waitcnt lgkmcnt(10)
    v_mfma_f32_32x32x16_bf16 v[104:119], v[48:51], v[180:183], v[104:119]
    buffer_load_dwordx4 v[212:215], v249, s[32:35], s16 offen offset:3072 sc1
    ds_read_b64_tr_b16 v[44:45], v23 offset:16384
    ds_read_b64_tr_b16 v[46:47], v23 offset:18432
    s_barrier
    s_waitcnt vmcnt(7)
    s_waitcnt lgkmcnt(10)
    v_mfma_f32_32x32x16_bf16 v[56:71], v[52:55], v[184:187], v[56:71]
    s_add_u32 s16, s16, 16384
    ds_read_b64_tr_b16 v[48:49], v20 offset:17408
    ds_read_b64_tr_b16 v[50:51], v20 offset:19456
    s_waitcnt lgkmcnt(10)
    v_mfma_f32_32x32x16_bf16 v[72:87], v[28:31], v[184:187], v[72:87]
    s_and_b32 s16, s16, 0x3ffff
    ds_read_b64_tr_b16 v[52:53], v21 offset:17408
    ds_read_b64_tr_b16 v[54:55], v21 offset:19456
    s_waitcnt lgkmcnt(10)
    v_mfma_f32_32x32x16_bf16 v[120:135], v[32:35], v[184:187], v[120:135]
    ds_read_b64_tr_b16 v[28:29], v24 offset:17408
    ds_read_b64_tr_b16 v[30:31], v24 offset:19456
    s_waitcnt lgkmcnt(10)
    v_mfma_f32_32x32x16_bf16 v[136:151], v[36:39], v[184:187], v[136:151]
    ds_read_b64_tr_b16 v[32:33], v25 offset:17408
    ds_read_b64_tr_b16 v[34:35], v25 offset:19456
    s_waitcnt lgkmcnt(10)
    v_mfma_f32_32x32x16_bf16 v[88:103], v[40:43], v[184:187], v[88:103]
    buffer_load_dwordx4 v[216:219], v249, s[32:35], s16 offen sc1
    ds_read_b64_tr_b16 v[36:37], v22 offset:17408
    ds_read_b64_tr_b16 v[38:39], v22 offset:19456
    s_waitcnt lgkmcnt(10)
    v_mfma_f32_32x32x16_bf16 v[104:119], v[44:47], v[184:187], v[104:119]
    ds_read_b64_tr_b16 v[40:41], v23 offset:17408
    ds_read_b64_tr_b16 v[42:43], v23 offset:19456
    s_waitcnt vmcnt(7)
    s_waitcnt lgkmcnt(10)
    v_mfma_f32_32x32x16_bf16 v[56:71], v[48:51], v[188:191], v[56:71]
    ds_read_b64_tr_b16 v[44:45], v20 offset:20480
    ds_read_b64_tr_b16 v[46:47], v20 offset:22528
    s_waitcnt lgkmcnt(10)
    v_mfma_f32_32x32x16_bf16 v[72:87], v[52:55], v[188:191], v[72:87]
    ds_read_b64_tr_b16 v[48:49], v21 offset:20480
    ds_read_b64_tr_b16 v[50:51], v21 offset:22528
    s_waitcnt lgkmcnt(10)
    v_mfma_f32_32x32x16_bf16 v[120:135], v[28:31], v[188:191], v[120:135]
    ds_read_b64_tr_b16 v[52:53], v24 offset:20480
    ds_read_b64_tr_b16 v[54:55], v24 offset:22528
    s_waitcnt lgkmcnt(10)
    v_mfma_f32_32x32x16_bf16 v[136:151], v[32:35], v[188:191], v[136:151]
    buffer_load_dwordx4 v[220:223], v249, s[32:35], s16 offen offset:1024 sc1
    ds_read_b64_tr_b16 v[28:29], v25 offset:20480
    ds_read_b64_tr_b16 v[30:31], v25 offset:22528
    s_waitcnt lgkmcnt(10)
    v_mfma_f32_32x32x16_bf16 v[88:103], v[36:39], v[188:191], v[88:103]
    ds_read_b64_tr_b16 v[32:33], v22 offset:20480
    ds_read_b64_tr_b16 v[34:35], v22 offset:22528
    s_waitcnt lgkmcnt(10)
    v_mfma_f32_32x32x16_bf16 v[104:119], v[40:43], v[188:191], v[104:119]
    ds_read_b64_tr_b16 v[36:37], v23 offset:20480
    ds_read_b64_tr_b16 v[38:39], v23 offset:22528
    s_waitcnt vmcnt(7)
    s_waitcnt lgkmcnt(10)
    v_mfma_f32_32x32x16_bf16 v[56:71], v[44:47], v[192:195], v[56:71]
    ds_read_b64_tr_b16 v[40:41], v20 offset:21504
    ds_read_b64_tr_b16 v[42:43], v20 offset:23552
    s_waitcnt lgkmcnt(10)
    v_mfma_f32_32x32x16_bf16 v[72:87], v[48:51], v[192:195], v[72:87]
    ds_read_b64_tr_b16 v[44:45], v21 offset:21504
    ds_read_b64_tr_b16 v[46:47], v21 offset:23552
    s_waitcnt lgkmcnt(10)
    v_mfma_f32_32x32x16_bf16 v[120:135], v[52:55], v[192:195], v[120:135]
    buffer_load_dwordx4 v[224:227], v249, s[32:35], s16 offen offset:2048 sc1
    ds_read_b64_tr_b16 v[48:49], v24 offset:21504
    ds_read_b64_tr_b16 v[50:51], v24 offset:23552
    s_waitcnt lgkmcnt(10)
    v_mfma_f32_32x32x16_bf16 v[136:151], v[28:31], v[192:195], v[136:151]
    ds_read_b64_tr_b16 v[52:53], v25 offset:21504
    ds_read_b64_tr_b16 v[54:55], v25 offset:23552
    s_waitcnt lgkmcnt(10)
    v_mfma_f32_32x32x16_bf16 v[88:103], v[32:35], v[192:195], v[88:103]
    ds_read_b64_tr_b16 v[28:29], v22 offset:21504
    ds_read_b64_tr_b16 v[30:31], v22 offset:23552
    s_waitcnt lgkmcnt(10)
    v_mfma_f32_32x32x16_bf16 v[104:119], v[36:39], v[192:195], v[104:119]
    ds_read_b64_tr_b16 v[32:33], v23 offset:21504
    ds_read_b64_tr_b16 v[34:35], v23 offset:23552
    s_waitcnt vmcnt(7)
    s_waitcnt lgkmcnt(10)
    v_mfma_f32_32x32x16_bf16 v[56:71], v[40:43], v[196:199], v[56:71]
    ds_read_b64_tr_b16 v[36:37], v20 offset:24576
    ds_read_b64_tr_b16 v[38:39], v20 offset:26624
    s_waitcnt lgkmcnt(10)
    v_mfma_f32_32x32x16_bf16 v[72:87], v[44:47], v[196:199], v[72:87]
    buffer_load_dwordx4 v[228:231], v249, s[32:35], s16 offen offset:3072 sc1
    ds_read_b64_tr_b16 v[40:41], v21 offset:24576
    ds_read_b64_tr_b16 v[42:43], v21 offset:26624
    s_waitcnt lgkmcnt(10)
    v_mfma_f32_32x32x16_bf16 v[120:135], v[48:51], v[196:199], v[120:135]
    s_add_u32 s16, s16, 16384
    ds_read_b64_tr_b16 v[44:45], v24 offset:24576
    ds_read_b64_tr_b16 v[46:47], v24 offset:26624
    s_waitcnt lgkmcnt(10)
    v_mfma_f32_32x32x16_bf16 v[136:151], v[52:55], v[196:199], v[136:151]
    s_and_b32 s16, s16, 0x3ffff
    ds_read_b64_tr_b16 v[48:49], v25 offset:24576
    ds_read_b64_tr_b16 v[50:51], v25 offset:26624
    s_waitcnt lgkmcnt(10)
    v_mfma_f32_32x32x16_bf16 v[88:103], v[28:31], v[196:199], v[88:103]
    ds_read_b64_tr_b16 v[52:53], v22 offset:24576
    ds_read_b64_tr_b16 v[54:55], v22 offset:26624
    s_waitcnt lgkmcnt(10)
    v_mfma_f32_32x32x16_bf16 v[104:119], v[32:35], v[196:199], v[104:119]
    buffer_load_dwordx4 v[232:235], v249, s[32:35], s16 offen sc1
    ds_read_b64_tr_b16 v[28:29], v23 offset:24576
    ds_read_b64_tr_b16 v[30:31], v23 offset:26624
    s_barrier
    s_waitcnt vmcnt(8)
    s_waitcnt lgkmcnt(10)
    v_mfma_f32_32x32x16_bf16 v[56:71], v[36:39], v[200:203], v[56:71]
    ds_read_b64_tr_b16 v[32:33], v20 offset:25600
    ds_read_b64_tr_b16 v[34:35], v20 offset:27648
    s_waitcnt lgkmcnt(10)
    v_mfma_f32_32x32x16_bf16 v[72:87], v[40:43], v[200:203], v[72:87]
    ds_read_b64_tr_b16 v[36:37], v21 offset:25600
    ds_read_b64_tr_b16 v[38:39], v21 offset:27648
    s_waitcnt lgkmcnt(10)
    v_mfma_f32_32x32x16_bf16 v[120:135], v[44:47], v[200:203], v[120:135]
    ds_read_b64_tr_b16 v[40:41], v24 offset:25600
    ds_read_b64_tr_b16 v[42:43], v24 offset:27648
    s_waitcnt lgkmcnt(10)
    v_mfma_f32_32x32x16_bf16 v[136:151], v[48:51], v[200:203], v[136:151]
    ds_read_b64_tr_b16 v[44:45], v25 offset:25600
    ds_read_b64_tr_b16 v[46:47], v25 offset:27648
    s_waitcnt lgkmcnt(10)
    v_mfma_f32_32x32x16_bf16 v[88:103], v[52:55], v[200:203], v[88:103]
    buffer_load_dwordx4 v[236:239], v249, s[32:35], s16 offen offset:1024 sc1
    ds_read_b64_tr_b16 v[48:49], v22 offset:25600
    ds_read_b64_tr_b16 v[50:51], v22 offset:27648
    s_waitcnt lgkmcnt(10)
    v_mfma_f32_32x32x16_bf16 v[104:119], v[28:31], v[200:203], v[104:119]
    ds_read_b64_tr_b16 v[52:53], v23 offset:25600
    ds_read_b64_tr_b16 v[54:55], v23 offset:27648
    s_waitcnt vmcnt(8)
    s_waitcnt lgkmcnt(10)
    v_mfma_f32_32x32x16_bf16 v[56:71], v[32:35], v[204:207], v[56:71]
    ds_read_b64_tr_b16 v[28:29], v20 offset:28672
    ds_read_b64_tr_b16 v[30:31], v20 offset:30720
    s_waitcnt lgkmcnt(10)
    v_mfma_f32_32x32x16_bf16 v[72:87], v[36:39], v[204:207], v[72:87]
L_PAD2:
    s_cbranch_execz L_RET2
    ds_read_b64_tr_b16 v[32:33], v21 offset:28672
    ds_read_b64_tr_b16 v[34:35], v21 offset:30720
    s_waitcnt lgkmcnt(10)
    v_mfma_f32_32x32x16_bf16 v[120:135], v[40:43], v[204:207], v[120:135]
    ds_read_b64_tr_b16 v[36:37], v24 offset:28672
    ds_read_b64_tr_b16 v[38:39], v24 offset:30720
    s_waitcnt lgkmcnt(10)
    v_mfma_f32_32x32x16_bf16 v[136:151], v[44:47], v[204:207], v[136:151]
    buffer_load_dwordx4 v[240:243], v249, s[32:35], s16 offen offset:2048 sc1
    ds_read_b64_tr_b16 v[40:41], v25 offset:28672
    ds_read_b64_tr_b16 v[42:43], v25 offset:30720
    s_waitcnt lgkmcnt(10)
    v_mfma_f32_32x32x16_bf16 v[88:103], v[48:51], v[204:207], v[88:103]
    ds_read_b64_tr_b16 v[44:45], v22 offset:28672
    ds_read_b64_tr_b16 v[46:47], v22 offset:30720
    s_waitcnt lgkmcnt(10)
    v_mfma_f32_32x32x16_bf16 v[104:119], v[52:55], v[204:207], v[104:119]
    ds_read_b64_tr_b16 v[48:49], v23 offset:28672
    ds_read_b64_tr_b16 v[50:51], v23 offset:30720
    s_waitcnt vmcnt(8)
    s_waitcnt lgkmcnt(10)
    v_mfma_f32_32x32x16_bf16 v[56:71], v[28:31], v[208:211], v[56:71]
    ds_read_b64_tr_b16 v[52:53], v20 offset:29696
    ds_read_b64_tr_b16 v[54:55], v20 offset:31744
    s_waitcnt lgkmcnt(10)
    v_mfma_f32_32x32x16_bf16 v[72:87], v[32:35], v[208:211], v[72:87]
    ds_read_b64_tr_b16 v[28:29], v21 offset:29696
    ds_read_b64_tr_b16 v[30:31], v21 offset:31744
    s_waitcnt lgkmcnt(10)
    v_mfma_f32_32x32x16_bf16 v[120:135], v[36:39], v[208:211], v[120:135]
    buffer_load_dwordx4 v[244:247], v249, s[32:35], s16 offen offset:3072 sc1
    ds_read_b64_tr_b16 v[32:33], v24 offset:29696
    ds_read_b64_tr_b16 v[34:35], v24 offset:31744
    s_waitcnt lgkmcnt(10)
    v_mfma_f32_32x32x16_bf16 v[136:151], v[40:43], v[208:211], v[136:151]
    s_add_u32 s16, s16, 16384
    ds_read_b64_tr_b16 v[36:37], v25 offset:29696
    ds_read_b64_tr_b16 v[38:39], v25 offset:31744
    s_waitcnt lgkmcnt(10)
    v_mfma_f32_32x32x16_bf16 v[88:103], v[44:47], v[208:211], v[88:103]
    s_and_b32 s16, s16, 0x3ffff
    ds_read_b64_tr_b16 v[40:41], v22 offset:29696
    ds_read_b64_tr_b16 v[42:43], v22 offset:31744
    s_waitcnt lgkmcnt(10)
    v_mfma_f32_32x32x16_bf16 v[104:119], v[48:51], v[208:211], v[104:119]
    ds_read_b64_tr_b16 v[44:45], v23 offset:29696
    ds_read_b64_tr_b16 v[46:47], v23 offset:31744
    s_waitcnt vmcnt(8)
    s_waitcnt lgkmcnt(10)
    v_mfma_f32_32x32x16_bf16 v[56:71], v[52:55], v[212:215], v[56:71]
    ds_read_b64_tr_b16 v[48:49], v20 offset:32768
    ds_read_b64_tr_b16 v[50:51], v20 offset:34816
    s_waitcnt lgkmcnt(10)
    v_mfma_f32_32x32x16_bf16 v[72:87], v[28:31], v[212:215], v[72:87]
    buffer_load_dwordx4 v[152:155], v249, s[32:35], s16 offen sc1
    ds_read_b64_tr_b16 v[52:53], v21 offset:32768
    ds_read_b64_tr_b16 v[54:55], v21 offset:34816
    s_waitcnt lgkmcnt(10)
    v_mfma_f32_32x32x16_bf16 v[120:135], v[32:35], v[212:215], v[120:135]
    ds_read_b64_tr_b16 v[28:29], v24 offset:32768
    ds_read_b64_tr_b16 v[30:31], v24 offset:34816
    s_waitcnt lgkmcnt(10)
    v_mfma_f32_32x32x16_bf16 v[136:151], v[36:39], v[212:215], v[136:151]
    ds_read_b64_tr_b16 v[32:33], v25 offset:32768
    ds_read_b64_tr_b16 v[34:35], v25 offset:34816
    s_waitcnt lgkmcnt(10)
    v_mfma_f32_32x32x16_bf16 v[88:103], v[40:43], v[212:215], v[88:103]
    ds_read_b64_tr_b16 v[36:37], v22 offset:32768
    ds_read_b64_tr_b16 v[38:39], v22 offset:34816
    s_waitcnt lgkmcnt(10)
    v_mfma_f32_32x32x16_bf16 v[104:119], v[44:47], v[212:215], v[104:119]
    buffer_load_dwordx4 v[156:159], v249, s[32:35], s16 offen offset:1024 sc1
    ds_read_b64_tr_b16 v[40:41], v23 offset:32768
    ds_read_b64_tr_b16 v[42:43], v23 offset:34816
    s_barrier
    s_waitcnt vmcnt(9)
    s_waitcnt lgkmcnt(10)
    v_mfma_f32_32x32x16_bf16 v[56:71], v[48:51], v[216:219], v[56:71]
    ds_read_b64_tr_b16 v[44:45], v20 offset:33792
    ds_read_b64_tr_b16 v[46:47], v20 offset:35840
    s_waitcnt lgkmcnt(10)
    v_mfma_f32_32x32x16_bf16 v[72:87], v[52:55], v[216:219], v[72:87]
    ds_read_b64_tr_b16 v[48:49], v21 offset:33792
    ds_read_b64_tr_b16 v[50:51], v21 offset:35840
    s_waitcnt lgkmcnt(10)
    v_mfma_f32_32x32x16_bf16 v[120:135], v[28:31], v[216:219], v[120:135]
    ds_read_b64_tr_b16 v[52:53], v24 offset:33792
    ds_read_b64_tr_b16 v[54:55], v24 offset:35840
    s_waitcnt lgkmcnt(10)
    v_mfma_f32_32x32x16_bf16 v[136:151], v[32:35], v[216:219], v[136:151]
    ds_read_b64_tr_b16 v[28:29], v25 offset:33792
    ds_read_b64_tr_b16 v[30:31], v25 offset:35840
    s_waitcnt lgkmcnt(10)
    v_mfma_f32_32x32x16_bf16 v[88:103], v[36:39], v[216:219], v[88:103]
    buffer_load_dwordx4 v[160:163], v249, s[32:35], s16 offen offset:2048 sc1
    ds_read_b64_tr_b16 v[32:33], v22 offset:33792
    ds_read_b64_tr_b16 v[34:35], v22 offset:35840
    s_waitcnt lgkmcnt(10)
    v_mfma_f32_32x32x16_bf16 v[104:119], v[40:43], v[216:219], v[104:119]
    ds_read_b64_tr_b16 v[36:37], v23 offset:33792
    ds_read_b64_tr_b16 v[38:39], v23 offset:35840
    s_waitcnt vmcnt(9)
    s_waitcnt lgkmcnt(10)
    v_mfma_f32_32x32x16_bf16 v[56:71], v[44:47], v[220:223], v[56:71]
    ds_read_b64_tr_b16 v[40:41], v20 offset:36864
    ds_read_b64_tr_b16 v[42:43], v20 offset:38912
    s_waitcnt lgkmcnt(10)
    v_mfma_f32_32x32x16_bf16 v[72:87], v[48:51], v[220:223], v[72:87]
    ds_read_b64_tr_b16 v[44:45], v21 offset:36864
    ds_read_b64_tr_b16 v[46:47], v21 offset:38912
    s_waitcnt lgkmcnt(10)
    v_mfma_f32_32x32x16_bf16 v[120:135], v[52:55], v[220:223], v[120:135]
    ds_read_b64_tr_b16 v[48:49], v24 offset:36864
    ds_read_b64_tr_b16 v[50:51], v24 offset:38912
    s_waitcnt lgkmcnt(10)
    v_mfma_f32_32x32x16_bf16 v[136:151], v[28:31], v[220:223], v[136:151]
    buffer_load_dwordx4 v[164:167], v249, s[32:35], s16 offen offset:3072 sc1
    ds_read_b64_tr_b16 v[52:53], v25 offset:36864
    ds_read_b64_tr_b16 v[54:55], v25 offset:38912
    s_waitcnt lgkmcnt(10)
    v_mfma_f32_32x32x16_bf16 v[88:103], v[32:35], v[220:223], v[88:103]
    s_add_u32 s16, s16, 16384
    ds_read_b64_tr_b16 v[28:29], v22 offset:36864
    ds_read_b64_tr_b16 v[30:31], v22 offset:38912
    s_waitcnt lgkmcnt(10)
    v_mfma_f32_32x32x16_bf16 v[104:119], v[36:39], v[220:223], v[104:119]
    s_and_b32 s16, s16, 0x3ffff
    ds_read_b64_tr_b16 v[32:33], v23 offset:36864
    ds_read_b64_tr_b16 v[34:35], v23 offset:38912
    s_waitcnt vmcnt(9)
    s_waitcnt lgkmcnt(10)
    v_mfma_f32_32x32x16_bf16 v[56:71], v[40:43], v[224:227], v[56:71]
    ds_read_b64_tr_b16 v[36:37], v20 offset:37888
    ds_read_b64_tr_b16 v[38:39], v20 offset:39936
    s_waitcnt lgkmcnt(10)
    v_mfma_f32_32x32x16_bf16 v[72:87], v[44:47], v[224:227], v[72:87]
    ds_read_b64_tr_b16 v[40:41], v21 offset:37888
    ds_read_b64_tr_b16 v[42:43], v21 offset:39936
    s_waitcnt lgkmcnt(10)
    v_mfma_f32_32x32x16_bf16 v[120:135], v[48:51], v[224:227], v[120:135]
    buffer_load_dwordx4 v[168:171], v249, s[32:35], s16 offen sc1
    ds_read_b64_tr_b16 v[44:45], v24 offset:37888
    ds_read_b64_tr_b16 v[46:47], v24 offset:39936
    s_waitcnt lgkmcnt(10)
    v_mfma_f32_32x32x16_bf16 v[136:151], v[52:55], v[224:227], v[136:151]
    ds_read_b64_tr_b16 v[48:49], v25 offset:37888
    ds_read_b64_tr_b16 v[50:51], v25 offset:39936
    s_waitcnt lgkmcnt(10)
    v_mfma_f32_32x32x16_bf16 v[88:103], v[28:31], v[224:227], v[88:103]
    ds_read_b64_tr_b16 v[52:53], v22 offset:37888
    ds_read_b64_tr_b16 v[54:55], v22 offset:39936
    s_waitcnt lgkmcnt(10)
    v_mfma_f32_32x32x16_bf16 v[104:119], v[32:35], v[224:227], v[104:119]
    ds_read_b64_tr_b16 v[28:29], v23 offset:37888
    ds_read_b64_tr_b16 v[30:31], v23 offset:39936
    s_waitcnt vmcnt(9)
    s_waitcnt lgkmcnt(10)
    v_mfma_f32_32x32x16_bf16 v[56:71], v[36:39], v[228:231], v[56:71]
    ds_read_b64_tr_b16 v[32:33], v20 offset:40960
    ds_read_b64_tr_b16 v[34:35], v20 offset:43008
    s_waitcnt lgkmcnt(10)
    v_mfma_f32_32x32x16_bf16 v[72:87], v[40:43], v[228:231], v[72:87]
    buffer_load_dwordx4 v[172:175], v249, s[32:35], s16 offen offset:1024 sc1
    ds_read_b64_tr_b16 v[36:37], v21 offset:40960
    ds_read_b64_tr_b16 v[38:39], v21 offset:43008
    s_waitcnt lgkmcnt(10)
    v_mfma_f32_32x32x16_bf16 v[120:135], v[44:47], v[228:231], v[120:135]
    ds_read_b64_tr_b16 v[40:41], v24 offset:40960
    ds_read_b64_tr_b16 v[42:43], v24 offset:43008
    s_waitcnt lgkmcnt(10)
    v_mfma_f32_32x32x16_bf16 v[136:151], v[48:51], v[228:231], v[136:151]
    ds_read_b64_tr_b16 v[44:45], v25 offset:40960
    ds_read_b64_tr_b16 v[46:47], v25 offset:43008
    s_waitcnt lgkmcnt(10)
    v_mfma_f32_32x32x16_bf16 v[88:103], v[52:55], v[228:231], v[88:103]
    ds_read_b64_tr_b16 v[48:49], v22 offset:40960
    ds_read_b64_tr_b16 v[50:51], v22 offset:43008
    s_waitcnt lgkmcnt(10)
    v_mfma_f32_32x32x16_bf16 v[104:119], v[28:31], v[228:231], v[104:119]
    buffer_load_dwordx4 v[176:179], v249, s[32:35], s16 offen offset:2048 sc1
    ds_read_b64_tr_b16 v[52:53], v23 offset:40960
    ds_read_b64_tr_b16 v[54:55], v23 offset:43008
    s_barrier
    s_waitcnt vmcnt(10)
    s_waitcnt lgkmcnt(10)
    v_mfma_f32_32x32x16_bf16 v[56:71], v[32:35], v[232:235], v[56:71]
    ds_read_b64_tr_b16 v[28:29], v20 offset:41984
    ds_read_b64_tr_b16 v[30:31], v20 offset:44032
    s_waitcnt lgkmcnt(10)
    v_mfma_f32_32x32x16_bf16 v[72:87], v[36:39], v[232:235], v[72:87]
    ds_read_b64_tr_b16 v[32:33], v21 offset:41984
    ds_read_b64_tr_b16 v[34:35], v21 offset:44032
    s_waitcnt lgkmcnt(10)
    v_mfma_f32_32x32x16_bf16 v[120:135], v[40:43], v[232:235], v[120:135]
    ds_read_b64_tr_b16 v[36:37], v24 offset:41984
    ds_read_b64_tr_b16 v[38:39], v24 offset:44032
    s_waitcnt lgkmcnt(10)
    v_mfma_f32_32x32x16_bf16 v[136:151], v[44:47], v[232:235], v[136:151]
    buffer_load_dwordx4 v[180:183], v249, s[32:35], s16 offen offset:3072 sc1
    ds_read_b64_tr_b16 v[40:41], v25 offset:41984
    ds_read_b64_tr_b16 v[42:43], v25 offset:44032
    s_waitcnt lgkmcnt(10)
    v_mfma_f32_32x32x16_bf16 v[88:103], v[48:51], v[232:235], v[88:103]
    s_add_u32 s16, s16, 16384
    ds_read_b64_tr_b16 v[44:45], v22 offset:41984
    ds_read_b64_tr_b16 v[46:47], v22 offset:44032
    s_waitcnt lgkmcnt(10)
    v_mfma_f32_32x32x16_bf16 v[104:119], v[52:55], v[232:235], v[104:119]
    s_and_b32 s16, s16, 0x3ffff
    ds_read_b64_tr_b16 v[48:49], v23 offset:41984
    ds_read_b64_tr_b16 v[50:51], v23 offset:44032
    s_waitcnt vmcnt(10)
    s_waitcnt lgkmcnt(10)
    v_mfma_f32_32x32x16_bf16 v[56:71], v[28:31], v[236:239], v[56:71]
    buffer_load_dwordx4 v[184:187], v249, s[32:35], s16 offen sc1
    ds_read_b64_tr_b16 v[52:53], v20 offset:45056
    ds_read_b64_tr_b16 v[54:55], v20 offset:47104
    s_waitcnt lgkmcnt(10)
    v_mfma_f32_32x32x16_bf16 v[72:87], v[32:35], v[236:239], v[72:87]
    ds_read_b64_tr_b16 v[28:29], v21 offset:45056
    ds_read_b64_tr_b16 v[30:31], v21 offset:47104
    s_waitcnt lgkmcnt(10)
    v_mfma_f32_32x32x16_bf16 v[120:135], v[36:39], v[236:239], v[120:135]
    ds_read_b64_tr_b16 v[32:33], v24 offset:45056
    ds_read_b64_tr_b16 v[34:35], v24 offset:47104
    s_waitcnt lgkmcnt(10)
    v_mfma_f32_32x32x16_bf16 v[136:151], v[40:43], v[236:239], v[136:151]
    ds_read_b64_tr_b16 v[36:37], v25 offset:45056
    ds_read_b64_tr_b16 v[38:39], v25 offset:47104
    s_waitcnt lgkmcnt(10)
    v_mfma_f32_32x32x16_bf16 v[88:103], v[44:47], v[236:239], v[88:103]
    buffer_load_dwordx4 v[188:191], v249, s[32:35], s16 offen offset:1024 sc1
    ds_read_b64_tr_b16 v[40:41], v22 offset:45056
    ds_read_b64_tr_b16 v[42:43], v22 offset:47104
    s_waitcnt lgkmcnt(10)
    v_mfma_f32_32x32x16_bf16 v[104:119], v[48:51], v[236:239], v[104:119]
    ds_read_b64_tr_b16 v[44:45], v23 offset:45056
    ds_read_b64_tr_b16 v[46:47], v23 offset:47104
    s_waitcnt vmcnt(11)
    s_waitcnt lgkmcnt(10)
    v_mfma_f32_32x32x16_bf16 v[56:71], v[52:55], v[240:243], v[56:71]
    ds_read_b64_tr_b16 v[48:49], v20 offset:46080
    ds_read_b64_tr_b16 v[50:51], v20 offset:48128
    s_waitcnt lgkmcnt(10)
    v_mfma_f32_32x32x16_bf16 v[72:87], v[28:31], v[240:243], v[72:87]
    buffer_load_dwordx4 v[192:195], v249, s[32:35], s16 offen offset:2048 sc1
    ds_read_b64_tr_b16 v[52:53], v21 offset:46080
    ds_read_b64_tr_b16 v[54:55], v21 offset:48128
    s_waitcnt lgkmcnt(10)
    v_mfma_f32_32x32x16_bf16 v[120:135], v[32:35], v[240:243], v[120:135]
    ds_read_b64_tr_b16 v[28:29], v24 offset:46080
    ds_read_b64_tr_b16 v[30:31], v24 offset:48128
    s_waitcnt lgkmcnt(10)
    v_mfma_f32_32x32x16_bf16 v[136:151], v[36:39], v[240:243], v[136:151]
    ds_read_b64_tr_b16 v[32:33], v25 offset:46080
    ds_read_b64_tr_b16 v[34:35], v25 offset:48128
    s_waitcnt lgkmcnt(10)
    v_mfma_f32_32x32x16_bf16 v[88:103], v[40:43], v[240:243], v[88:103]
    ds_read_b64_tr_b16 v[36:37], v22 offset:46080
    ds_read_b64_tr_b16 v[38:39], v22 offset:48128
    s_waitcnt lgkmcnt(10)
    v_mfma_f32_32x32x16_bf16 v[104:119], v[44:47], v[240:243], v[104:119]
    buffer_load_dwordx4 v[196:199], v249, s[32:35], s16 offen offset:3072 sc1
    ds_read_b64_tr_b16 v[40:41], v23 offset:46080
    ds_read_b64_tr_b16 v[42:43], v23 offset:48128
    s_waitcnt vmcnt(12)
    s_waitcnt lgkmcnt(10)
    v_mfma_f32_32x32x16_bf16 v[56:71], v[48:51], v[244:247], v[56:71]
    s_add_u32 s16, s16, 16384
    ds_read_b64_tr_b16 v[44:45], v20
    ds_read_b64_tr_b16 v[46:47], v20 offset:2048
    s_waitcnt lgkmcnt(10)
    v_mfma_f32_32x32x16_bf16 v[72:87], v[52:55], v[244:247], v[72:87]
    s_and_b32 s16, s16, 0x3ffff
    ds_read_b64_tr_b16 v[48:49], v21
    ds_read_b64_tr_b16 v[50:51], v21 offset:2048
    s_waitcnt lgkmcnt(10)
    v_mfma_f32_32x32x16_bf16 v[120:135], v[28:31], v[244:247], v[120:135]
    buffer_load_dwordx4 v[200:203], v249, s[32:35], s16 offen sc1
    ds_read_b64_tr_b16 v[52:53], v24
    ds_read_b64_tr_b16 v[54:55], v24 offset:2048
    s_waitcnt lgkmcnt(10)
    v_mfma_f32_32x32x16_bf16 v[136:151], v[32:35], v[244:247], v[136:151]
    ds_read_b64_tr_b16 v[28:29], v25
    ds_read_b64_tr_b16 v[30:31], v25 offset:2048
    s_waitcnt lgkmcnt(10)
    v_mfma_f32_32x32x16_bf16 v[88:103], v[36:39], v[244:247], v[88:103]
    ds_read_b64_tr_b16 v[32:33], v22
    ds_read_b64_tr_b16 v[34:35], v22 offset:2048
    s_waitcnt lgkmcnt(10)
    v_mfma_f32_32x32x16_bf16 v[104:119], v[40:43], v[244:247], v[104:119]
    buffer_load_dwordx4 v[204:207], v249, s[32:35], s16 offen offset:1024 sc1
    ds_read_b64_tr_b16 v[36:37], v23
    ds_read_b64_tr_b16 v[38:39], v23 offset:2048
    s_barrier
    s_waitcnt vmcnt(13)
    s_waitcnt lgkmcnt(10)
    v_mfma_f32_32x32x16_bf16 v[56:71], v[44:47], v[152:155], v[56:71]
    ds_read_b64_tr_b16 v[40:41], v20 offset:1024
    ds_read_b64_tr_b16 v[42:43], v20 offset:3072
    s_waitcnt lgkmcnt(10)
    v_mfma_f32_32x32x16_bf16 v[72:87], v[48:51], v[152:155], v[72:87]
    ds_read_b64_tr_b16 v[44:45], v21 offset:1024
    ds_read_b64_tr_b16 v[46:47], v21 offset:3072
    s_waitcnt lgkmcnt(10)
    v_mfma_f32_32x32x16_bf16 v[120:135], v[52:55], v[152:155], v[120:135]
    ds_read_b64_tr_b16 v[48:49], v24 offset:1024
    ds_read_b64_tr_b16 v[50:51], v24 offset:3072
    s_waitcnt lgkmcnt(10)
    v_mfma_f32_32x32x16_bf16 v[136:151], v[28:31], v[152:155], v[136:151]
    buffer_load_dwordx4 v[208:211], v249, s[32:35], s16 offen offset:2048 sc1
    ds_read_b64_tr_b16 v[52:53], v25 offset:1024
    ds_read_b64_tr_b16 v[54:55], v25 offset:3072
    s_waitcnt lgkmcnt(10)
    v_mfma_f32_32x32x16_bf16 v[88:103], v[32:35], v[152:155], v[88:103]
    ds_read_b64_tr_b16 v[28:29], v22 offset:1024
    ds_read_b64_tr_b16 v[30:31], v22 offset:3072
    s_waitcnt lgkmcnt(10)
    v_mfma_f32_32x32x16_bf16 v[104:119], v[36:39], v[152:155], v[104:119]
    ds_read_b64_tr_b16 v[32:33], v23 offset:1024
    ds_read_b64_tr_b16 v[34:35], v23 offset:3072
    s_waitcnt vmcnt(13)
    s_waitcnt lgkmcnt(10)
    v_mfma_f32_32x32x16_bf16 v[56:71], v[40:43], v[156:159], v[56:71]
    buffer_load_dwordx4 v[212:215], v249, s[32:35], s16 offen offset:3072 sc1
    ds_read_b64_tr_b16 v[36:37], v20 offset:4096
    ds_read_b64_tr_b16 v[38:39], v20 offset:6144
    s_waitcnt lgkmcnt(10)
    v_mfma_f32_32x32x16_bf16 v[72:87], v[44:47], v[156:159], v[72:87]
    s_add_u32 s16, s16, 16384
    ds_read_b64_tr_b16 v[40:41], v21 offset:4096
    ds_read_b64_tr_b16 v[42:43], v21 offset:6144
    s_waitcnt lgkmcnt(10)
    v_mfma_f32_32x32x16_bf16 v[120:135], v[48:51], v[156:159], v[120:135]
    s_and_b32 s16, s16, 0x3ffff
    ds_read_b64_tr_b16 v[44:45], v24 offset:4096
    ds_read_b64_tr_b16 v[46:47], v24 offset:6144
    s_waitcnt lgkmcnt(10)
    v_mfma_f32_32x32x16_bf16 v[136:151], v[52:55], v[156:159], v[136:151]
    ds_read_b64_tr_b16 v[48:49], v25 offset:4096
    ds_read_b64_tr_b16 v[50:51], v25 offset:6144
    s_waitcnt lgkmcnt(10)
    v_mfma_f32_32x32x16_bf16 v[88:103], v[28:31], v[156:159], v[88:103]
    buffer_load_dwordx4 v[216:219], v249, s[32:35], s16 offen sc1
    ds_read_b64_tr_b16 v[52:53], v22 offset:4096
    ds_read_b64_tr_b16 v[54:55], v22 offset:6144
    s_waitcnt lgkmcnt(10)
    v_mfma_f32_32x32x16_bf16 v[104:119], v[32:35], v[156:159], v[104:119]
    ds_read_b64_tr_b16 v[28:29], v23 offset:4096
    ds_read_b64_tr_b16 v[30:31], v23 offset:6144
    s_waitcnt vmcnt(14)
    s_waitcnt lgkmcnt(10)
    v_mfma_f32_32x32x16_bf16 v[56:71], v[36:39], v[160:163], v[56:71]
    ds_read_b64_tr_b16 v[32:33], v20 offset:5120
    ds_read_b64_tr_b16 v[34:35], v20 offset:7168
    s_waitcnt lgkmcnt(10)
    v_mfma_f32_32x32x16_bf16 v[72:87], v[40:43], v[160:163], v[72:87]
    buffer_load_dwordx4 v[220:223], v249, s[32:35], s16 offen offset:1024 sc1
    ds_read_b64_tr_b16 v[36:37], v21 offset:5120
    ds_read_b64_tr_b16 v[38:39], v21 offset:7168
    s_waitcnt lgkmcnt(10)
    v_mfma_f32_32x32x16_bf16 v[120:135], v[44:47], v[160:163], v[120:135]
    ds_read_b64_tr_b16 v[40:41], v24 offset:5120
    ds_read_b64_tr_b16 v[42:43], v24 offset:7168
    s_waitcnt lgkmcnt(10)
    v_mfma_f32_32x32x16_bf16 v[136:151], v[48:51], v[160:163], v[136:151]
    ds_read_b64_tr_b16 v[44:45], v25 offset:5120
    ds_read_b64_tr_b16 v[46:47], v25 offset:7168
    s_waitcnt lgkmcnt(10)
    v_mfma_f32_32x32x16_bf16 v[88:103], v[52:55], v[160:163], v[88:103]
    ds_read_b64_tr_b16 v[48:49], v22 offset:5120
    ds_read_b64_tr_b16 v[50:51], v22 offset:7168
    s_waitcnt lgkmcnt(10)
    v_mfma_f32_32x32x16_bf16 v[104:119], v[28:31], v[160:163], v[104:119]
    buffer_load_dwordx4 v[224:227], v249, s[32:35], s16 offen offset:2048 sc1
    ds_read_b64_tr_b16 v[52:53], v23 offset:5120
    ds_read_b64_tr_b16 v[54:55], v23 offset:7168
    s_waitcnt vmcnt(15)
    s_waitcnt lgkmcnt(10)
    v_mfma_f32_32x32x16_bf16 v[56:71], v[32:35], v[164:167], v[56:71]
    ds_read_b64_tr_b16 v[28:29], v20 offset:8192
    ds_read_b64_tr_b16 v[30:31], v20 offset:10240
    s_waitcnt lgkmcnt(10)
    v_mfma_f32_32x32x16_bf16 v[72:87], v[36:39], v[164:167], v[72:87]
    ds_read_b64_tr_b16 v[32:33], v21 offset:8192
    ds_read_b64_tr_b16 v[34:35], v21 offset:10240
    s_waitcnt lgkmcnt(10)
    v_mfma_f32_32x32x16_bf16 v[120:135], v[40:43], v[164:167], v[120:135]
    buffer_load_dwordx4 v[228:231], v249, s[32:35], s16 offen offset:3072 sc1
    ds_read_b64_tr_b16 v[36:37], v24 offset:8192
    ds_read_b64_tr_b16 v[38:39], v24 offset:10240
    s_waitcnt lgkmcnt(10)
    v_mfma_f32_32x32x16_bf16 v[136:151], v[44:47], v[164:167], v[136:151]
    s_add_u32 s16, s16, 16384
    ds_read_b64_tr_b16 v[40:41], v25 offset:8192
    ds_read_b64_tr_b16 v[42:43], v25 offset:10240
    s_waitcnt lgkmcnt(10)
    v_mfma_f32_32x32x16_bf16 v[88:103], v[48:51], v[164:167], v[88:103]
    s_and_b32 s16, s16, 0x3ffff
    ds_read_b64_tr_b16 v[44:45], v22 offset:8192
    ds_read_b64_tr_b16 v[46:47], v22 offset:10240
    s_waitcnt lgkmcnt(10)
    v_mfma_f32_32x32x16_bf16 v[104:119], v[52:55], v[164:167], v[104:119]
    buffer_load_dwordx4 v[232:235], v249, s[32:35], s16 offen sc1
    ds_read_b64_tr_b16 v[48:49], v23 offset:8192
    ds_read_b64_tr_b16 v[50:51], v23 offset:10240
    s_barrier
    s_waitcnt vmcnt(16)
    s_waitcnt lgkmcnt(10)
    v_mfma_f32_32x32x16_bf16 v[56:71], v[28:31], v[168:171], v[56:71]
    ds_read_b64_tr_b16 v[52:53], v20 offset:9216
    ds_read_b64_tr_b16 v[54:55], v20 offset:11264
    s_waitcnt lgkmcnt(10)
    v_mfma_f32_32x32x16_bf16 v[72:87], v[32:35], v[168:171], v[72:87]
    ds_read_b64_tr_b16 v[28:29], v21 offset:9216
    ds_read_b64_tr_b16 v[30:31], v21 offset:11264
    s_waitcnt lgkmcnt(10)
    v_mfma_f32_32x32x16_bf16 v[120:135], v[36:39], v[168:171], v[120:135]
    ds_read_b64_tr_b16 v[32:33], v24 offset:9216
    ds_read_b64_tr_b16 v[34:35], v24 offset:11264
    s_waitcnt lgkmcnt(10)
    v_mfma_f32_32x32x16_bf16 v[136:151], v[40:43], v[168:171], v[136:151]
    buffer_load_dwordx4 v[236:239], v249, s[32:35], s16 offen offset:1024 sc1
    ds_read_b64_tr_b16 v[36:37], v25 offset:9216
    ds_read_b64_tr_b16 v[38:39], v25 offset:11264
    s_waitcnt lgkmcnt(10)
    v_mfma_f32_32x32x16_bf16 v[88:103], v[44:47], v[168:171], v[88:103]
    ds_read_b64_tr_b16 v[40:41], v22 offset:9216
    ds_read_b64_tr_b16 v[42:43], v22 offset:11264
    s_waitcnt lgkmcnt(10)
    v_mfma_f32_32x32x16_bf16 v[104:119], v[48:51], v[168:171], v[104:119]
    ds_read_b64_tr_b16 v[44:45], v23 offset:9216
    ds_read_b64_tr_b16 v[46:47], v23 offset:11264
    s_waitcnt vmcnt(16)
    s_waitcnt lgkmcnt(10)
    v_mfma_f32_32x32x16_bf16 v[56:71], v[52:55], v[172:175], v[56:71]
    buffer_load_dwordx4 v[240:243], v249, s[32:35], s16 offen offset:2048 sc1
    ds_read_b64_tr_b16 v[48:49], v20 offset:12288
    ds_read_b64_tr_b16 v[50:51], v20 offset:14336
    s_waitcnt lgkmcnt(10)
    v_mfma_f32_32x32x16_bf16 v[72:87], v[28:31], v[172:175], v[72:87]
    ds_read_b64_tr_b16 v[52:53], v21 offset:12288
    ds_read_b64_tr_b16 v[54:55], v21 offset:14336
    s_waitcnt lgkmcnt(10)
    v_mfma_f32_32x32x16_bf16 v[120:135], v[32:35], v[172:175], v[120:135]
    ds_read_b64_tr_b16 v[28:29], v24 offset:12288
    ds_read_b64_tr_b16 v[30:31], v24 offset:14336
    s_waitcnt lgkmcnt(10)
    v_mfma_f32_32x32x16_bf16 v[136:151], v[36:39], v[172:175], v[136:151]
    ds_read_b64_tr_b16 v[32:33], v25 offset:12288
    ds_read_b64_tr_b16 v[34:35], v25 offset:14336
    s_waitcnt lgkmcnt(10)
    v_mfma_f32_32x32x16_bf16 v[88:103], v[40:43], v[172:175], v[88:103]
    buffer_load_dwordx4 v[244:247], v249, s[32:35], s16 offen offset:3072 sc1
    ds_read_b64_tr_b16 v[36:37], v22 offset:12288
    ds_read_b64_tr_b16 v[38:39], v22 offset:14336
    s_waitcnt lgkmcnt(10)
    v_mfma_f32_32x32x16_bf16 v[104:119], v[44:47], v[172:175], v[104:119]
    s_add_u32 s16, s16, 16384
    ds_read_b64_tr_b16 v[40:41], v23 offset:12288
    ds_read_b64_tr_b16 v[42:43], v23 offset:14336
    s_waitcnt vmcnt(17)
    s_waitcnt lgkmcnt(10)
    v_mfma_f32_32x32x16_bf16 v[56:71], v[48:51], v[176:179], v[56:71]
    s_and_b32 s16, s16, 0x3ffff
    ds_read_b64_tr_b16 v[44:45], v20 offset:13312
    ds_read_b64_tr_b16 v[46:47], v20 offset:15360
    s_waitcnt lgkmcnt(10)
    v_mfma_f32_32x32x16_bf16 v[72:87], v[52:55], v[176:179], v[72:87]
    buffer_load_dwordx4 v[152:155], v249, s[32:35], s16 offen sc1
    ds_read_b64_tr_b16 v[48:49], v21 offset:13312
    ds_read_b64_tr_b16 v[50:51], v21 offset:15360
    s_waitcnt lgkmcnt(10)
    v_mfma_f32_32x32x16_bf16 v[120:135], v[28:31], v[176:179], v[120:135]
    ds_read_b64_tr_b16 v[52:53], v24 offset:13312
    ds_read_b64_tr_b16 v[54:55], v24 offset:15360
    s_waitcnt lgkmcnt(10)
    v_mfma_f32_32x32x16_bf16 v[136:151], v[32:35], v[176:179], v[136:151]
    ds_read_b64_tr_b16 v[28:29], v25 offset:13312
    ds_read_b64_tr_b16 v[30:31], v25 offset:15360
    s_waitcnt lgkmcnt(10)
    v_mfma_f32_32x32x16_bf16 v[88:103], v[36:39], v[176:179], v[88:103]
    ds_read_b64_tr_b16 v[32:33], v22 offset:13312
    ds_read_b64_tr_b16 v[34:35], v22 offset:15360
    s_waitcnt lgkmcnt(10)
    v_mfma_f32_32x32x16_bf16 v[104:119], v[40:43], v[176:179], v[104:119]
    buffer_load_dwordx4 v[156:159], v249, s[32:35], s16 offen offset:1024 sc1
    ds_read_b64_tr_b16 v[36:37], v23 offset:13312
    ds_read_b64_tr_b16 v[38:39], v23 offset:15360
    s_waitcnt vmcnt(18)
    s_waitcnt lgkmcnt(10)
    v_mfma_f32_32x32x16_bf16 v[56:71], v[44:47], v[180:183], v[56:71]
    ds_read_b64_tr_b16 v[40:41], v20 offset:16384
    ds_read_b64_tr_b16 v[42:43], v20 offset:18432
    s_waitcnt lgkmcnt(10)
    v_mfma_f32_32x32x16_bf16 v[72:87], v[48:51], v[180:183], v[72:87]
    ds_read_b64_tr_b16 v[44:45], v21 offset:16384
    ds_read_b64_tr_b16 v[46:47], v21 offset:18432
    s_waitcnt lgkmcnt(10)
    v_mfma_f32_32x32x16_bf16 v[120:135], v[52:55], v[180:183], v[120:135]
    buffer_load_dwordx4 v[160:163], v249, s[32:35], s16 offen offset:2048 sc1
    ds_read_b64_tr_b16 v[48:49], v24 offset:16384
    ds_read_b64_tr_b16 v[50:51], v24 offset:18432
    s_waitcnt lgkmcnt(10)
    v_mfma_f32_32x32x16_bf16 v[136:151], v[28:31], v[180:183], v[136:151]
    ds_read_b64_tr_b16 v[52:53], v25 offset:16384
    ds_read_b64_tr_b16 v[54:55], v25 offset:18432
    s_waitcnt lgkmcnt(10)
    v_mfma_f32_32x32x16_bf16 v[88:103], v[32:35], v[180:183], v[88:103]
    ds_read_b64_tr_b16 v[28:29], v22 offset:16384
    ds_read_b64_tr_b16 v[30:31], v22 offset:18432
    s_waitcnt lgkmcnt(10)
    v_mfma_f32_32x32x16_bf16 v[104:119], v[36:39], v[180:183], v[104:119]
    buffer_load_dwordx4 v[164:167], v249, s[32:35], s16 offen offset:3072 sc1
    ds_read_b64_tr_b16 v[32:33], v23 offset:16384
    ds_read_b64_tr_b16 v[34:35], v23 offset:18432
    s_barrier
    s_waitcnt vmcnt(19)
    s_waitcnt lgkmcnt(10)
    v_mfma_f32_32x32x16_bf16 v[56:71], v[40:43], v[184:187], v[56:71]
    s_add_u32 s16, s16, 16384
    ds_read_b64_tr_b16 v[36:37], v20 offset:17408
    ds_read_b64_tr_b16 v[38:39], v20 offset:19456
    s_waitcnt lgkmcnt(10)
    v_mfma_f32_32x32x16_bf16 v[72:87], v[44:47], v[184:187], v[72:87]
    s_and_b32 s16, s16, 0x3ffff
    ds_read_b64_tr_b16 v[40:41], v21 offset:17408
    ds_read_b64_tr_b16 v[42:43], v21 offset:19456
    s_waitcnt lgkmcnt(10)
    v_mfma_f32_32x32x16_bf16 v[120:135], v[48:51], v[184:187], v[120:135]
    ds_read_b64_tr_b16 v[44:45], v24 offset:17408
    ds_read_b64_tr_b16 v[46:47], v24 offset:19456
    s_waitcnt lgkmcnt(10)
    v_mfma_f32_32x32x16_bf16 v[136:151], v[52:55], v[184:187], v[136:151]
    buffer_load_dwordx4 v[168:171], v249, s[32:35], s16 offen sc1
    ds_read_b64_tr_b16 v[48:49], v25 offset:17408
    ds_read_b64_tr_b16 v[50:51], v25 offset:19456
    s_waitcnt lgkmcnt(10)
    v_mfma_f32_32x32x16_bf16 v[88:103], v[28:31], v[184:187], v[88:103]
    ds_read_b64_tr_b16 v[52:53], v22 offset:17408
    ds_read_b64_tr_b16 v[54:55], v22 offset:19456
    s_waitcnt lgkmcnt(10)
    v_mfma_f32_32x32x16_bf16 v[104:119], v[32:35], v[184:187], v[104:119]
    ds_read_b64_tr_b16 v[28:29], v23 offset:17408
    ds_read_b64_tr_b16 v[30:31], v23 offset:19456
    s_waitcnt vmcnt(19)
    s_waitcnt lgkmcnt(10)
    v_mfma_f32_32x32x16_bf16 v[56:71], v[36:39], v[188:191], v[56:71]
    ds_read_b64_tr_b16 v[32:33], v20 offset:20480
    ds_read_b64_tr_b16 v[34:35], v20 offset:22528
    s_waitcnt lgkmcnt(10)
    v_mfma_f32_32x32x16_bf16 v[72:87], v[40:43], v[188:191], v[72:87]
    buffer_load_dwordx4 v[172:175], v249, s[32:35], s16 offen offset:1024 sc1
    ds_read_b64_tr_b16 v[36:37], v21 offset:20480
    ds_read_b64_tr_b16 v[38:39], v21 offset:22528
    s_waitcnt lgkmcnt(10)
    v_mfma_f32_32x32x16_bf16 v[120:135], v[44:47], v[188:191], v[120:135]
    ds_read_b64_tr_b16 v[40:41], v24 offset:20480
    ds_read_b64_tr_b16 v[42:43], v24 offset:22528
    s_waitcnt lgkmcnt(10)
    v_mfma_f32_32x32x16_bf16 v[136:151], v[48:51], v[188:191], v[136:151]
    ds_read_b64_tr_b16 v[44:45], v25 offset:20480
    ds_read_b64_tr_b16 v[46:47], v25 offset:22528
    s_waitcnt lgkmcnt(10)
    v_mfma_f32_32x32x16_bf16 v[88:103], v[52:55], v[188:191], v[88:103]
    ds_read_b64_tr_b16 v[48:49], v22 offset:20480
    ds_read_b64_tr_b16 v[50:51], v22 offset:22528
    s_waitcnt lgkmcnt(10)
    v_mfma_f32_32x32x16_bf16 v[104:119], v[28:31], v[188:191], v[104:119]
    buffer_load_dwordx4 v[176:179], v249, s[32:35], s16 offen offset:2048 sc1
    ds_read_b64_tr_b16 v[52:53], v23 offset:20480
    ds_read_b64_tr_b16 v[54:55], v23 offset:22528
    s_waitcnt vmcnt(20)
    s_waitcnt lgkmcnt(10)
    v_mfma_f32_32x32x16_bf16 v[56:71], v[32:35], v[192:195], v[56:71]
    ds_read_b64_tr_b16 v[28:29], v20 offset:21504
    ds_read_b64_tr_b16 v[30:31], v20 offset:23552
    s_waitcnt lgkmcnt(10)
    v_mfma_f32_32x32x16_bf16 v[72:87], v[36:39], v[192:195], v[72:87]
    ds_read_b64_tr_b16 v[32:33], v21 offset:21504
    ds_read_b64_tr_b16 v[34:35], v21 offset:23552
    s_waitcnt lgkmcnt(10)
    v_mfma_f32_32x32x16_bf16 v[120:135], v[40:43], v[192:195], v[120:135]
    ds_read_b64_tr_b16 v[36:37], v24 offset:21504
    ds_read_b64_tr_b16 v[38:39], v24 offset:23552
    s_waitcnt lgkmcnt(10)
    v_mfma_f32_32x32x16_bf16 v[136:151], v[44:47], v[192:195], v[136:151]
    buffer_load_dwordx4 v[180:183], v249, s[32:35], s16 offen offset:3072 sc1
    ds_read_b64_tr_b16 v[40:41], v25 offset:21504
L_PAD3:
    s_cbranch_execz L_RET3
    ds_read_b64_tr_b16 v[42:43], v25 offset:23552
    s_waitcnt lgkmcnt(10)
    v_mfma_f32_32x32x16_bf16 v[88:103], v[48:51], v[192:195], v[88:103]
    s_add_u32 s16, s16, 16384
    ds_read_b64_tr_b16 v[44:45], v22 offset:21504
    ds_read_b64_tr_b16 v[46:47], v22 offset:23552
    s_waitcnt lgkmcnt(10)
    v_mfma_f32_32x32x16_bf16 v[104:119], v[52:55], v[192:195], v[104:119]
    s_and_b32 s16, s16, 0x3ffff
    ds_read_b64_tr_b16 v[48:49], v23 offset:21504
    ds_read_b64_tr_b16 v[50:51], v23 offset:23552
    s_waitcnt vmcnt(20)
    s_waitcnt lgkmcnt(10)
    v_mfma_f32_32x32x16_bf16 v[56:71], v[28:31], v[196:199], v[56:71]
    ds_read_b64_tr_b16 v[52:53], v20 offset:24576
    ds_read_b64_tr_b16 v[54:55], v20 offset:26624
    s_waitcnt lgkmcnt(10)
    v_mfma_f32_32x32x16_bf16 v[72:87], v[32:35], v[196:199], v[72:87]
    buffer_load_dwordx4 v[184:187], v249, s[32:35], s16 offen sc1
    ds_read_b64_tr_b16 v[28:29], v21 offset:24576
    ds_read_b64_tr_b16 v[30:31], v21 offset:26624
    s_waitcnt lgkmcnt(10)
    v_mfma_f32_32x32x16_bf16 v[120:135], v[36:39], v[196:199], v[120:135]
    ds_read_b64_tr_b16 v[32:33], v20 offset:25600
    ds_read_b64_tr_b16 v[34:35], v20 offset:27648
    s_waitcnt lgkmcnt(10)
    v_mfma_f32_32x32x16_bf16 v[136:151], v[40:43], v[196:199], v[136:151]
    ds_read_b64_tr_b16 v[36:37], v21 offset:25600
    ds_read_b64_tr_b16 v[38:39], v21 offset:27648
    s_waitcnt lgkmcnt(10)
    v_mfma_f32_32x32x16_bf16 v[88:103], v[44:47], v[196:199], v[88:103]
    ds_read_b64_tr_b16 v[40:41], v20 offset:28672
    ds_read_b64_tr_b16 v[42:43], v20 offset:30720
    s_waitcnt lgkmcnt(10)
    v_mfma_f32_32x32x16_bf16 v[104:119], v[48:51], v[196:199], v[104:119]
    buffer_load_dwordx4 v[188:191], v249, s[32:35], s16 offen offset:1024 sc1
    ds_read_b64_tr_b16 v[44:45], v21 offset:28672
    ds_read_b64_tr_b16 v[46:47], v21 offset:30720
    s_barrier
    s_waitcnt vmcnt(21)
    s_waitcnt lgkmcnt(10)
    v_mfma_f32_32x32x16_bf16 v[56:71], v[52:55], v[200:203], v[56:71]
    ds_read_b64_tr_b16 v[48:49], v20 offset:29696
    ds_read_b64_tr_b16 v[50:51], v20 offset:31744
    s_waitcnt lgkmcnt(10)
    v_mfma_f32_32x32x16_bf16 v[72:87], v[28:31], v[200:203], v[72:87]
    ds_read_b64_tr_b16 v[52:53], v21 offset:29696
    ds_read_b64_tr_b16 v[54:55], v21 offset:31744
    s_waitcnt vmcnt(20)
    s_waitcnt lgkmcnt(10)
    v_mfma_f32_32x32x16_bf16 v[56:71], v[32:35], v[204:207], v[56:71]
    ds_read_b64_tr_b16 v[28:29], v24 offset:24576
    ds_read_b64_tr_b16 v[30:31], v24 offset:26624
    s_waitcnt lgkmcnt(10)
    v_mfma_f32_32x32x16_bf16 v[72:87], v[36:39], v[204:207], v[72:87]
    buffer_load_dwordx4 v[192:195], v249, s[32:35], s16 offen offset:2048 sc1
    ds_read_b64_tr_b16 v[32:33], v25 offset:24576
    ds_read_b64_tr_b16 v[34:35], v25 offset:26624
    s_waitcnt vmcnt(20)
    s_waitcnt lgkmcnt(10)
    v_mfma_f32_32x32x16_bf16 v[56:71], v[40:43], v[208:211], v[56:71]
    ds_read_b64_tr_b16 v[36:37], v22 offset:24576
    ds_read_b64_tr_b16 v[38:39], v22 offset:26624
    s_waitcnt lgkmcnt(10)
    v_mfma_f32_32x32x16_bf16 v[72:87], v[44:47], v[208:211], v[72:87]
    ds_read_b64_tr_b16 v[40:41], v23 offset:24576
    ds_read_b64_tr_b16 v[42:43], v23 offset:26624
    s_waitcnt vmcnt(19)
    s_waitcnt lgkmcnt(10)
    v_mfma_f32_32x32x16_bf16 v[56:71], v[48:51], v[212:215], v[56:71]
    ds_read_b64_tr_b16 v[44:45], v24 offset:25600
    ds_read_b64_tr_b16 v[46:47], v24 offset:27648
    s_waitcnt lgkmcnt(10)
    v_mfma_f32_32x32x16_bf16 v[72:87], v[52:55], v[212:215], v[72:87]
    buffer_load_dwordx4 v[196:199], v249, s[32:35], s16 offen offset:3072 sc1
    ds_read_b64_tr_b16 v[48:49], v25 offset:25600
    ds_read_b64_tr_b16 v[50:51], v25 offset:27648
    s_barrier
    s_waitcnt lgkmcnt(10)
    v_mfma_f32_32x32x16_bf16 v[120:135], v[28:31], v[200:203], v[120:135]
    s_add_u32 s16, s16, 16384
    ds_read_b64_tr_b16 v[52:53], v22 offset:25600
    ds_read_b64_tr_b16 v[54:55], v22 offset:27648
    s_waitcnt lgkmcnt(10)
    v_mfma_f32_32x32x16_bf16 v[136:151], v[32:35], v[200:203], v[136:151]
    s_and_b32 s16, s16, 0x3ffff
    ds_read_b64_tr_b16 v[28:29], v23 offset:25600
    ds_read_b64_tr_b16 v[30:31], v23 offset:27648
    s_waitcnt lgkmcnt(10)
    v_mfma_f32_32x32x16_bf16 v[88:103], v[36:39], v[200:203], v[88:103]
    ds_read_b64_tr_b16 v[32:33], v24 offset:28672
    ds_read_b64_tr_b16 v[34:35], v24 offset:30720
    s_waitcnt lgkmcnt(10)
    v_mfma_f32_32x32x16_bf16 v[104:119], v[40:43], v[200:203], v[104:119]
    buffer_load_dwordx4 v[200:203], v249, s[32:35], s16 offen sc1
    ds_read_b64_tr_b16 v[36:37], v25 offset:28672
    ds_read_b64_tr_b16 v[38:39], v25 offset:30720
    s_waitcnt lgkmcnt(10)
    v_mfma_f32_32x32x16_bf16 v[120:135], v[44:47], v[204:207], v[120:135]
    ds_read_b64_tr_b16 v[40:41], v22 offset:28672
    ds_read_b64_tr_b16 v[42:43], v22 offset:30720
    s_waitcnt lgkmcnt(10)
    v_mfma_f32_32x32x16_bf16 v[136:151], v[48:51], v[204:207], v[136:151]
    ds_read_b64_tr_b16 v[44:45], v23 offset:28672
    ds_read_b64_tr_b16 v[46:47], v23 offset:30720
    s_waitcnt lgkmcnt(10)
    v_mfma_f32_32x32x16_bf16 v[88:103], v[52:55], v[204:207], v[88:103]
    ds_read_b64_tr_b16 v[48:49], v24 offset:29696
    ds_read_b64_tr_b16 v[50:51], v24 offset:31744
    s_waitcnt lgkmcnt(10)
    v_mfma_f32_32x32x16_bf16 v[104:119], v[28:31], v[204:207], v[104:119]
    buffer_load_dwordx4 v[204:207], v249, s[32:35], s16 offen offset:1024 sc1
    ds_read_b64_tr_b16 v[52:53], v25 offset:29696
    ds_read_b64_tr_b16 v[54:55], v25 offset:31744
    s_waitcnt lgkmcnt(10)
    v_mfma_f32_32x32x16_bf16 v[120:135], v[32:35], v[208:211], v[120:135]
    ds_read_b64_tr_b16 v[28:29], v22 offset:29696
    ds_read_b64_tr_b16 v[30:31], v22 offset:31744
    s_waitcnt lgkmcnt(10)
    v_mfma_f32_32x32x16_bf16 v[136:151], v[36:39], v[208:211], v[136:151]
    ds_read_b64_tr_b16 v[32:33], v23 offset:29696
    ds_read_b64_tr_b16 v[34:35], v23 offset:31744
    s_waitcnt lgkmcnt(10)
    v_mfma_f32_32x32x16_bf16 v[88:103], v[40:43], v[208:211], v[88:103]
    ds_read_b64_tr_b16 v[36:37], v20 offset:32768
    ds_read_b64_tr_b16 v[38:39], v20 offset:34816
    s_waitcnt lgkmcnt(10)
    v_mfma_f32_32x32x16_bf16 v[104:119], v[44:47], v[208:211], v[104:119]
    buffer_load_dwordx4 v[208:211], v249, s[32:35], s16 offen offset:2048 sc1
    ds_read_b64_tr_b16 v[40:41], v20 offset:33792
    ds_read_b64_tr_b16 v[42:43], v20 offset:35840
    s_waitcnt lgkmcnt(10)
    v_mfma_f32_32x32x16_bf16 v[120:135], v[48:51], v[212:215], v[120:135]
    ds_read_b64_tr_b16 v[44:45], v20 offset:36864
    ds_read_b64_tr_b16 v[46:47], v20 offset:38912
    s_waitcnt lgkmcnt(10)
    v_mfma_f32_32x32x16_bf16 v[136:151], v[52:55], v[212:215], v[136:151]
    ds_read_b64_tr_b16 v[48:49], v20 offset:37888
    ds_read_b64_tr_b16 v[50:51], v20 offset:39936
    s_waitcnt lgkmcnt(10)
    v_mfma_f32_32x32x16_bf16 v[88:103], v[28:31], v[212:215], v[88:103]
    ds_read_b64_tr_b16 v[52:53], v20 offset:40960
    ds_read_b64_tr_b16 v[54:55], v20 offset:43008
    s_waitcnt lgkmcnt(10)
    v_mfma_f32_32x32x16_bf16 v[104:119], v[32:35], v[212:215], v[104:119]
    buffer_load_dwordx4 v[212:215], v249, s[32:35], s16 offen offset:3072 sc1
    ds_read_b64_tr_b16 v[28:29], v20 offset:41984
    ds_read_b64_tr_b16 v[30:31], v20 offset:44032
    s_barrier
    s_waitcnt vmcnt(23)
    s_waitcnt lgkmcnt(10)
    v_mfma_f32_32x32x16_bf16 v[56:71], v[36:39], v[216:219], v[56:71]
    s_add_u32 s16, s16, 16384
    ds_read_b64_tr_b16 v[32:33], v20 offset:45056
    ds_read_b64_tr_b16 v[34:35], v20 offset:47104
    s_waitcnt vmcnt(22)
    s_waitcnt lgkmcnt(10)
    v_mfma_f32_32x32x16_bf16 v[56:71], v[40:43], v[220:223], v[56:71]
    s_and_b32 s16, s16, 0x3ffff
    ds_read_b64_tr_b16 v[36:37], v20 offset:46080
    ds_read_b64_tr_b16 v[38:39], v20 offset:48128
    s_waitcnt vmcnt(21)
    s_waitcnt lgkmcnt(10)
    v_mfma_f32_32x32x16_bf16 v[56:71], v[44:47], v[224:227], v[56:71]
    ds_read_b64_tr_b16 v[40:41], v20
    ds_read_b64_tr_b16 v[42:43], v20 offset:2048
    s_waitcnt vmcnt(20)
    s_waitcnt lgkmcnt(10)
    v_mfma_f32_32x32x16_bf16 v[56:71], v[48:51], v[228:231], v[56:71]
    ds_read_b64_tr_b16 v[44:45], v20 offset:1024
    ds_read_b64_tr_b16 v[46:47], v20 offset:3072
    s_waitcnt vmcnt(19)
    s_waitcnt lgkmcnt(10)
    v_mfma_f32_32x32x16_bf16 v[56:71], v[52:55], v[232:235], v[56:71]
    ds_read_b64_tr_b16 v[48:49], v20 offset:4096
    ds_read_b64_tr_b16 v[50:51], v20 offset:6144
    s_waitcnt vmcnt(18)
    s_waitcnt lgkmcnt(10)
    v_mfma_f32_32x32x16_bf16 v[56:71], v[28:31], v[236:239], v[56:71]
    ds_read_b64_tr_b16 v[52:53], v20 offset:5120
    ds_read_b64_tr_b16 v[54:55], v20 offset:7168
    s_waitcnt vmcnt(17)
    s_waitcnt lgkmcnt(10)
    v_mfma_f32_32x32x16_bf16 v[56:71], v[32:35], v[240:243], v[56:71]
    ds_read_b64_tr_b16 v[28:29], v20 offset:8192
    ds_read_b64_tr_b16 v[30:31], v20 offset:10240
    s_waitcnt vmcnt(16)
    s_waitcnt lgkmcnt(10)
    v_mfma_f32_32x32x16_bf16 v[56:71], v[36:39], v[244:247], v[56:71]
    ds_read_b64_tr_b16 v[32:33], v20 offset:9216
    ds_read_b64_tr_b16 v[34:35], v20 offset:11264
    s_waitcnt vmcnt(15)
    s_waitcnt lgkmcnt(10)
    v_mfma_f32_32x32x16_bf16 v[56:71], v[40:43], v[152:155], v[56:71]
    ds_read_b64_tr_b16 v[36:37], v20 offset:12288
    ds_read_b64_tr_b16 v[38:39], v20 offset:14336
    s_waitcnt vmcnt(14)
    s_waitcnt lgkmcnt(10)
    v_mfma_f32_32x32x16_bf16 v[56:71], v[44:47], v[156:159], v[56:71]
    ds_read_b64_tr_b16 v[40:41], v20 offset:13312
    ds_read_b64_tr_b16 v[42:43], v20 offset:15360
    s_waitcnt vmcnt(13)
    s_waitcnt lgkmcnt(10)
    v_mfma_f32_32x32x16_bf16 v[56:71], v[48:51], v[160:163], v[56:71]
    ds_read_b64_tr_b16 v[44:45], v20 offset:16384
    ds_read_b64_tr_b16 v[46:47], v20 offset:18432
    s_waitcnt vmcnt(12)
    s_waitcnt lgkmcnt(10)
    v_mfma_f32_32x32x16_bf16 v[56:71], v[52:55], v[164:167], v[56:71]
    ds_read_b64_tr_b16 v[48:49], v20 offset:17408
    ds_read_b64_tr_b16 v[50:51], v20 offset:19456
    s_waitcnt vmcnt(11)
    s_waitcnt lgkmcnt(10)
    v_mfma_f32_32x32x16_bf16 v[56:71], v[28:31], v[168:171], v[56:71]
    ds_read_b64_tr_b16 v[52:53], v20 offset:20480
    ds_read_b64_tr_b16 v[54:55], v20 offset:22528
    s_waitcnt vmcnt(10)
    s_waitcnt lgkmcnt(10)
    v_mfma_f32_32x32x16_bf16 v[56:71], v[32:35], v[172:175], v[56:71]
    ds_read_b64_tr_b16 v[28:29], v20 offset:21504
    ds_read_b64_tr_b16 v[30:31], v20 offset:23552
    s_barrier
    s_waitcnt vmcnt(9)
    s_waitcnt lgkmcnt(10)
    v_mfma_f32_32x32x16_bf16 v[56:71], v[36:39], v[176:179], v[56:71]
    ds_read_b64_tr_b16 v[32:33], v20 offset:24576
    ds_read_b64_tr_b16 v[34:35], v20 offset:26624
    s_waitcnt vmcnt(8)
    s_waitcnt lgkmcnt(10)
    v_mfma_f32_32x32x16_bf16 v[56:71], v[40:43], v[180:183], v[56:71]
    ds_read_b64_tr_b16 v[36:37], v20 offset:25600
    ds_read_b64_tr_b16 v[38:39], v20 offset:27648
    s_waitcnt vmcnt(7)
    s_waitcnt lgkmcnt(10)
    v_mfma_f32_32x32x16_bf16 v[56:71], v[44:47], v[184:187], v[56:71]
    ds_read_b64_tr_b16 v[40:41], v20 offset:28672
    ds_read_b64_tr_b16 v[42:43], v20 offset:30720
    s_waitcnt vmcnt(6)
    s_waitcnt lgkmcnt(10)
    v_mfma_f32_32x32x16_bf16 v[56:71], v[48:51], v[188:191], v[56:71]
    ds_read_b64_tr_b16 v[44:45], v20 offset:29696
    ds_read_b64_tr_b16 v[46:47], v20 offset:31744
    s_waitcnt vmcnt(5)
    s_waitcnt lgkmcnt(10)
    v_mfma_f32_32x32x16_bf16 v[56:71], v[52:55], v[192:195], v[56:71]
    ds_read_b64_tr_b16 v[48:49], v21 offset:32768
    ds_read_b64_tr_b16 v[50:51], v21 offset:34816
    s_waitcnt vmcnt(4)
    s_waitcnt lgkmcnt(10)
    v_mfma_f32_32x32x16_bf16 v[56:71], v[28:31], v[196:199], v[56:71]
    ds_read_b64_tr_b16 v[52:53], v21 offset:33792
    ds_read_b64_tr_b16 v[54:55], v21 offset:35840
    s_waitcnt vmcnt(3)
    s_waitcnt lgkmcnt(10)
    v_mfma_f32_32x32x16_bf16 v[56:71], v[32:35], v[200:203], v[56:71]
    ds_read_b64_tr_b16 v[28:29], v21 offset:36864
    ds_read_b64_tr_b16 v[30:31], v21 offset:38912
    s_waitcnt vmcnt(2)
    s_waitcnt lgkmcnt(10)
    v_mfma_f32_32x32x16_bf16 v[56:71], v[36:39], v[204:207], v[56:71]
    ds_read_b64_tr_b16 v[32:33], v21 offset:37888
    ds_read_b64_tr_b16 v[34:35], v21 offset:39936
    s_waitcnt vmcnt(1)
    s_waitcnt lgkmcnt(10)
    v_mfma_f32_32x32x16_bf16 v[56:71], v[40:43], v[208:211], v[56:71]
    ds_read_b64_tr_b16 v[36:37], v21 offset:40960
    ds_read_b64_tr_b16 v[38:39], v21 offset:43008
    s_waitcnt vmcnt(0)
    s_waitcnt lgkmcnt(10)
    v_mfma_f32_32x32x16_bf16 v[56:71], v[44:47], v[212:215], v[56:71]
    ds_read_b64_tr_b16 v[40:41], v21 offset:41984
    ds_read_b64_tr_b16 v[42:43], v21 offset:44032
    s_waitcnt lgkmcnt(10)
    v_mfma_f32_32x32x16_bf16 v[72:87], v[48:51], v[216:219], v[72:87]
    ds_read_b64_tr_b16 v[44:45], v21 offset:45056
    ds_read_b64_tr_b16 v[46:47], v21 offset:47104
    s_waitcnt lgkmcnt(10)
    v_mfma_f32_32x32x16_bf16 v[72:87], v[52:55], v[220:223], v[72:87]
    s_nop 3
    v_cvt_pk_bf16_f32 v56, v56, v57
    v_cvt_pk_bf16_f32 v57, v58, v59
    ds_read_b64_tr_b16 v[48:49], v21 offset:46080
    ds_read_b64_tr_b16 v[50:51], v21 offset:48128
    s_waitcnt lgkmcnt(10)
    v_mfma_f32_32x32x16_bf16 v[72:87], v[28:31], v[224:227], v[72:87]
    v_cvt_pk_bf16_f32 v58, v60, v61
    v_cvt_pk_bf16_f32 v59, v62, v63
    ds_read_b64_tr_b16 v[52:53], v21
    ds_read_b64_tr_b16 v[54:55], v21 offset:2048
    s_waitcnt lgkmcnt(10)
    v_mfma_f32_32x32x16_bf16 v[72:87], v[32:35], v[228:231], v[72:87]
    ds_write_b128 v0, v[56:59]
    v_cvt_pk_bf16_f32 v60, v64, v65
    ds_read_b64_tr_b16 v[28:29], v21 offset:1024
    ds_read_b64_tr_b16 v[30:31], v21 offset:3072
    s_waitcnt lgkmcnt(11)
    v_mfma_f32_32x32x16_bf16 v[72:87], v[36:39], v[232:235], v[72:87]
    v_cvt_pk_bf16_f32 v61, v66, v67
    v_cvt_pk_bf16_f32 v62, v68, v69
    ds_read_b64_tr_b16 v[32:33], v21 offset:4096
    ds_read_b64_tr_b16 v[34:35], v21 offset:6144
    s_waitcnt lgkmcnt(11)
    v_mfma_f32_32x32x16_bf16 v[72:87], v[40:43], v[236:239], v[72:87]
    v_cvt_pk_bf16_f32 v63, v70, v71
    ds_write_b128 v0, v[60:63] offset:1024
    ds_read_b64_tr_b16 v[36:37], v21 offset:5120
    ds_read_b64_tr_b16 v[38:39], v21 offset:7168
    s_waitcnt lgkmcnt(12)
    v_mfma_f32_32x32x16_bf16 v[72:87], v[44:47], v[240:243], v[72:87]
    v_subrev_u32 v0, 118784, v0
    ds_read_b64_tr_b16 v[40:41], v21 offset:8192
    ds_read_b64_tr_b16 v[42:43], v21 offset:10240
    s_waitcnt lgkmcnt(12)
    v_mfma_f32_32x32x16_bf16 v[72:87], v[48:51], v[244:247], v[72:87]
    ds_read_b64_tr_b16 v[44:45], v21 offset:9216
    ds_read_b64_tr_b16 v[46:47], v21 offset:11264
    s_waitcnt lgkmcnt(6)
    s_barrier
    v_mfma_f32_32x32x16_bf16 v[72:87], v[52:55], v[152:155], v[72:87]
    ds_read_b64_tr_b16 v[48:49], v21 offset:12288
    ds_read_b64_tr_b16 v[50:51], v21 offset:14336
    v_mfma_f32_32x32x16_bf16 v[72:87], v[28:31], v[156:159], v[72:87]
    ds_read_b64_tr_b16 v[52:53], v21 offset:13312
    ds_read_b64_tr_b16 v[54:55], v21 offset:15360
    v_mfma_f32_32x32x16_bf16 v[72:87], v[32:35], v[160:163], v[72:87]
    ds_read_b64_tr_b16 v[28:29], v21 offset:16384
    ds_read_b64_tr_b16 v[30:31], v21 offset:18432
    s_waitcnt lgkmcnt(10)
    v_mfma_f32_32x32x16_bf16 v[72:87], v[36:39], v[164:167], v[72:87]
    ds_read_b64_tr_b16 v[32:33], v21 offset:17408
    ds_read_b64_tr_b16 v[34:35], v21 offset:19456
    s_waitcnt lgkmcnt(10)
    v_mfma_f32_32x32x16_bf16 v[72:87], v[40:43], v[168:171], v[72:87]
    ds_read_b64_tr_b16 v[36:37], v21 offset:20480
    ds_read_b64_tr_b16 v[38:39], v21 offset:22528
    s_waitcnt lgkmcnt(10)
    v_mfma_f32_32x32x16_bf16 v[72:87], v[44:47], v[172:175], v[72:87]
    ds_read_b64_tr_b16 v[40:41], v21 offset:21504
    ds_read_b64_tr_b16 v[42:43], v21 offset:23552
    s_waitcnt lgkmcnt(10)
    v_mfma_f32_32x32x16_bf16 v[72:87], v[48:51], v[176:179], v[72:87]
    ds_read_b64_tr_b16 v[44:45], v21 offset:24576
    ds_read_b64_tr_b16 v[46:47], v21 offset:26624
    s_waitcnt lgkmcnt(10)
    v_mfma_f32_32x32x16_bf16 v[72:87], v[52:55], v[180:183], v[72:87]
    ds_read_b64_tr_b16 v[48:49], v21 offset:25600
    ds_read_b64_tr_b16 v[50:51], v21 offset:27648
    s_waitcnt lgkmcnt(10)
    v_mfma_f32_32x32x16_bf16 v[72:87], v[28:31], v[184:187], v[72:87]
    ds_read_b64_tr_b16 v[52:53], v21 offset:28672
    ds_read_b64_tr_b16 v[54:55], v21 offset:30720
    s_waitcnt lgkmcnt(10)
    v_mfma_f32_32x32x16_bf16 v[72:87], v[32:35], v[188:191], v[72:87]
    ds_read_b64_tr_b16 v[28:29], v21 offset:29696
    ds_read_b64_tr_b16 v[30:31], v21 offset:31744
    s_waitcnt lgkmcnt(10)
    v_mfma_f32_32x32x16_bf16 v[72:87], v[36:39], v[192:195], v[72:87]
    ds_read_b64_tr_b16 v[32:33], v22 offset:32768
    ds_read_b64_tr_b16 v[34:35], v22 offset:34816
    s_waitcnt lgkmcnt(10)
    v_mfma_f32_32x32x16_bf16 v[72:87], v[40:43], v[196:199], v[72:87]
    ds_read_b64_tr_b16 v[36:37], v23 offset:32768
    ds_read_b64_tr_b16 v[38:39], v23 offset:34816
    s_waitcnt lgkmcnt(10)
    v_mfma_f32_32x32x16_bf16 v[72:87], v[44:47], v[200:203], v[72:87]
    ds_read_b64_tr_b16 v[40:41], v22 offset:33792
    ds_read_b64_tr_b16 v[42:43], v22 offset:35840
    s_waitcnt lgkmcnt(10)
    v_mfma_f32_32x32x16_bf16 v[72:87], v[48:51], v[204:207], v[72:87]
    ds_read_b64_tr_b16 v[44:45], v23 offset:33792
    ds_read_b64_tr_b16 v[46:47], v23 offset:35840
    s_waitcnt lgkmcnt(10)
    v_mfma_f32_32x32x16_bf16 v[72:87], v[52:55], v[208:211], v[72:87]
    ds_read_b64_tr_b16 v[48:49], v22 offset:36864
    ds_read_b64_tr_b16 v[50:51], v22 offset:38912
    s_waitcnt lgkmcnt(10)
    v_mfma_f32_32x32x16_bf16 v[72:87], v[28:31], v[212:215], v[72:87]
    ds_read_b64_tr_b16 v[52:53], v23 offset:36864
    ds_read_b64_tr_b16 v[54:55], v23 offset:38912
    s_waitcnt lgkmcnt(10)
    v_mfma_f32_32x32x16_bf16 v[88:103], v[32:35], v[216:219], v[88:103]
    ds_read_b64_tr_b16 v[28:29], v22 offset:37888
    ds_read_b64_tr_b16 v[30:31], v22 offset:39936
    s_waitcnt lgkmcnt(10)
    v_mfma_f32_32x32x16_bf16 v[104:119], v[36:39], v[216:219], v[104:119]
    s_nop 3
    v_cvt_pk_bf16_f32 v72, v72, v73
    v_cvt_pk_bf16_f32 v73, v74, v75
    ds_read_b64_tr_b16 v[32:33], v23 offset:37888
    ds_read_b64_tr_b16 v[34:35], v23 offset:39936
    s_waitcnt lgkmcnt(10)
    v_mfma_f32_32x32x16_bf16 v[88:103], v[40:43], v[220:223], v[88:103]
    v_cvt_pk_bf16_f32 v74, v76, v77
    v_cvt_pk_bf16_f32 v75, v78, v79
    ds_read_b64_tr_b16 v[36:37], v22 offset:40960
    ds_read_b64_tr_b16 v[38:39], v22 offset:43008
    s_waitcnt lgkmcnt(10)
    v_mfma_f32_32x32x16_bf16 v[104:119], v[44:47], v[220:223], v[104:119]
    ds_write_b128 v0, v[72:75]
    v_cvt_pk_bf16_f32 v76, v80, v81
    ds_read_b64_tr_b16 v[40:41], v23 offset:40960
    ds_read_b64_tr_b16 v[42:43], v23 offset:43008
    s_waitcnt lgkmcnt(11)
    v_mfma_f32_32x32x16_bf16 v[88:103], v[48:51], v[224:227], v[88:103]
    v_cvt_pk_bf16_f32 v77, v82, v83
    v_cvt_pk_bf16_f32 v78, v84, v85
    ds_read_b64_tr_b16 v[44:45], v22 offset:41984
    ds_read_b64_tr_b16 v[46:47], v22 offset:44032
    s_waitcnt lgkmcnt(11)
    v_mfma_f32_32x32x16_bf16 v[104:119], v[52:55], v[224:227], v[104:119]
    v_cvt_pk_bf16_f32 v79, v86, v87
    ds_write_b128 v0, v[76:79] offset:1024
    ds_read_b64_tr_b16 v[48:49], v23 offset:41984
    ds_read_b64_tr_b16 v[50:51], v23 offset:44032
    s_waitcnt lgkmcnt(12)
    v_mfma_f32_32x32x16_bf16 v[88:103], v[28:31], v[228:231], v[88:103]
    ds_read_b64_tr_b16 v[52:53], v22 offset:45056
    ds_read_b64_tr_b16 v[54:55], v22 offset:47104
    s_waitcnt lgkmcnt(12)
    v_mfma_f32_32x32x16_bf16 v[104:119], v[32:35], v[228:231], v[104:119]
    ds_read_b64_tr_b16 v[28:29], v23 offset:45056
    ds_read_b64_tr_b16 v[30:31], v23 offset:47104
    s_waitcnt lgkmcnt(6)
    s_barrier
    v_mfma_f32_32x32x16_bf16 v[88:103], v[36:39], v[232:235], v[88:103]
    s_lshl_b32 s96, s77, 11
    s_add_u32 s14, s96, 32768
    v_and_b32 v0, 7, v1
    ds_read_b64_tr_b16 v[32:33], v22 offset:46080
    ds_read_b64_tr_b16 v[34:35], v22 offset:48128
    v_mfma_f32_32x32x16_bf16 v[104:119], v[40:43], v[232:235], v[104:119]
    v_lshl_add_u32 v0, v0, 4, s14
    ds_read_b64_tr_b16 v[36:37], v23 offset:46080
    ds_read_b64_tr_b16 v[38:39], v23 offset:48128
    v_mfma_f32_32x32x16_bf16 v[88:103], v[44:47], v[236:239], v[88:103]
    v_bfe_u32 v4, v1, 3, 2
    ds_read_b64_tr_b16 v[40:41], v22
    ds_read_b64_tr_b16 v[42:43], v22 offset:2048
    s_waitcnt lgkmcnt(10)
    v_mfma_f32_32x32x16_bf16 v[104:119], v[48:51], v[236:239], v[104:119]
    v_lshl_add_u32 v0, v4, 8, v0
    v_lshrrev_b32 v4, 5, v1
    ds_read_b64_tr_b16 v[44:45], v23
    ds_read_b64_tr_b16 v[46:47], v23 offset:2048
    s_waitcnt lgkmcnt(10)
    v_mfma_f32_32x32x16_bf16 v[88:103], v[52:55], v[240:243], v[88:103]
    v_lshl_add_u32 v0, v4, 7, v0
    ds_read_b64_tr_b16 v[48:49], v22 offset:1024
    ds_read_b64_tr_b16 v[50:51], v22 offset:3072
    s_waitcnt lgkmcnt(10)
    v_mfma_f32_32x32x16_bf16 v[104:119], v[28:31], v[240:243], v[104:119]
    ds_read_b64_tr_b16 v[52:53], v23 offset:1024
    ds_read_b64_tr_b16 v[54:55], v23 offset:3072
    s_waitcnt lgkmcnt(10)
    v_mfma_f32_32x32x16_bf16 v[88:103], v[32:35], v[244:247], v[88:103]
    ds_read_b64_tr_b16 v[28:29], v22 offset:4096
    ds_read_b64_tr_b16 v[30:31], v22 offset:6144
    s_waitcnt lgkmcnt(10)
    v_mfma_f32_32x32x16_bf16 v[104:119], v[36:39], v[244:247], v[104:119]
    ds_read_b64_tr_b16 v[32:33], v23 offset:4096
    ds_read_b64_tr_b16 v[34:35], v23 offset:6144
    s_waitcnt lgkmcnt(10)
    v_mfma_f32_32x32x16_bf16 v[88:103], v[40:43], v[152:155], v[88:103]
    ds_read_b64_tr_b16 v[36:37], v22 offset:5120
    ds_read_b64_tr_b16 v[38:39], v22 offset:7168
    s_waitcnt lgkmcnt(10)
    v_mfma_f32_32x32x16_bf16 v[104:119], v[44:47], v[152:155], v[104:119]
    ds_read_b64_tr_b16 v[40:41], v23 offset:5120
    ds_read_b64_tr_b16 v[42:43], v23 offset:7168
    s_waitcnt lgkmcnt(10)
    v_mfma_f32_32x32x16_bf16 v[88:103], v[48:51], v[156:159], v[88:103]
    ds_read_b64_tr_b16 v[44:45], v22 offset:8192
    ds_read_b64_tr_b16 v[46:47], v22 offset:10240
    s_waitcnt lgkmcnt(10)
    v_mfma_f32_32x32x16_bf16 v[104:119], v[52:55], v[156:159], v[104:119]
    ds_read_b64_tr_b16 v[48:49], v23 offset:8192
    ds_read_b64_tr_b16 v[50:51], v23 offset:10240
    s_waitcnt lgkmcnt(10)
    v_mfma_f32_32x32x16_bf16 v[88:103], v[28:31], v[160:163], v[88:103]
    ds_read_b64_tr_b16 v[52:53], v22 offset:9216
    ds_read_b64_tr_b16 v[54:55], v22 offset:11264
    s_waitcnt lgkmcnt(10)
    v_mfma_f32_32x32x16_bf16 v[104:119], v[32:35], v[160:163], v[104:119]
    ds_read_b64_tr_b16 v[28:29], v23 offset:9216
    ds_read_b64_tr_b16 v[30:31], v23 offset:11264
    s_waitcnt lgkmcnt(10)
    v_mfma_f32_32x32x16_bf16 v[88:103], v[36:39], v[164:167], v[88:103]
    ds_read_b64_tr_b16 v[32:33], v22 offset:12288
    ds_read_b64_tr_b16 v[34:35], v22 offset:14336
    s_waitcnt lgkmcnt(10)
    v_mfma_f32_32x32x16_bf16 v[104:119], v[40:43], v[164:167], v[104:119]
    ds_read_b64_tr_b16 v[36:37], v23 offset:12288
    ds_read_b64_tr_b16 v[38:39], v23 offset:14336
    s_waitcnt lgkmcnt(10)
    v_mfma_f32_32x32x16_bf16 v[88:103], v[44:47], v[168:171], v[88:103]
    ds_read_b64_tr_b16 v[40:41], v22 offset:13312
    ds_read_b64_tr_b16 v[42:43], v22 offset:15360
    s_waitcnt lgkmcnt(10)
    v_mfma_f32_32x32x16_bf16 v[104:119], v[48:51], v[168:171], v[104:119]
    ds_read_b64_tr_b16 v[44:45], v23 offset:13312
    ds_read_b64_tr_b16 v[46:47], v23 offset:15360
    s_waitcnt lgkmcnt(10)
    v_mfma_f32_32x32x16_bf16 v[88:103], v[52:55], v[172:175], v[88:103]
    ds_read_b64_tr_b16 v[48:49], v22 offset:16384
    ds_read_b64_tr_b16 v[50:51], v22 offset:18432
    s_waitcnt lgkmcnt(10)
    v_mfma_f32_32x32x16_bf16 v[104:119], v[28:31], v[172:175], v[104:119]
    ds_read_b64_tr_b16 v[52:53], v23 offset:16384
    ds_read_b64_tr_b16 v[54:55], v23 offset:18432
    s_waitcnt lgkmcnt(10)
    v_mfma_f32_32x32x16_bf16 v[88:103], v[32:35], v[176:179], v[88:103]
    ds_read_b64_tr_b16 v[28:29], v22 offset:17408
    ds_read_b64_tr_b16 v[30:31], v22 offset:19456
    s_waitcnt lgkmcnt(10)
    v_mfma_f32_32x32x16_bf16 v[104:119], v[36:39], v[176:179], v[104:119]
    ds_read_b64_tr_b16 v[32:33], v23 offset:17408
    ds_read_b64_tr_b16 v[34:35], v23 offset:19456
    s_waitcnt lgkmcnt(10)
    v_mfma_f32_32x32x16_bf16 v[88:103], v[40:43], v[180:183], v[88:103]
    ds_read_b64_tr_b16 v[36:37], v22 offset:20480
    ds_read_b64_tr_b16 v[38:39], v22 offset:22528
    s_waitcnt lgkmcnt(10)
    v_mfma_f32_32x32x16_bf16 v[104:119], v[44:47], v[180:183], v[104:119]
    ds_read_b64_tr_b16 v[40:41], v23 offset:20480
    ds_read_b64_tr_b16 v[42:43], v23 offset:22528
    s_waitcnt lgkmcnt(10)
    v_mfma_f32_32x32x16_bf16 v[88:103], v[48:51], v[184:187], v[88:103]
    ds_read_b64_tr_b16 v[44:45], v22 offset:21504
    ds_read_b64_tr_b16 v[46:47], v22 offset:23552
    s_waitcnt lgkmcnt(10)
    v_mfma_f32_32x32x16_bf16 v[104:119], v[52:55], v[184:187], v[104:119]
    ds_read_b64_tr_b16 v[48:49], v23 offset:21504
    ds_read_b64_tr_b16 v[50:51], v23 offset:23552
    s_waitcnt lgkmcnt(10)
    v_mfma_f32_32x32x16_bf16 v[88:103], v[28:31], v[188:191], v[88:103]
    ds_read_b64_tr_b16 v[52:53], v22 offset:24576
    ds_read_b64_tr_b16 v[54:55], v22 offset:26624
    s_waitcnt lgkmcnt(10)
    v_mfma_f32_32x32x16_bf16 v[104:119], v[32:35], v[188:191], v[104:119]
    ds_read_b64_tr_b16 v[28:29], v23 offset:24576
    ds_read_b64_tr_b16 v[30:31], v23 offset:26624
    s_waitcnt lgkmcnt(10)
    v_mfma_f32_32x32x16_bf16 v[88:103], v[36:39], v[192:195], v[88:103]
    ds_read_b64_tr_b16 v[32:33], v22 offset:25600
    ds_read_b64_tr_b16 v[34:35], v22 offset:27648
    s_waitcnt lgkmcnt(10)
    v_mfma_f32_32x32x16_bf16 v[104:119], v[40:43], v[192:195], v[104:119]
    ds_read_b64_tr_b16 v[36:37], v23 offset:25600
    ds_read_b64_tr_b16 v[38:39], v23 offset:27648
    s_waitcnt lgkmcnt(10)
    v_mfma_f32_32x32x16_bf16 v[88:103], v[44:47], v[196:199], v[88:103]
    ds_read_b64_tr_b16 v[40:41], v22 offset:28672
    ds_read_b64_tr_b16 v[42:43], v22 offset:30720
    s_waitcnt lgkmcnt(10)
    v_mfma_f32_32x32x16_bf16 v[104:119], v[48:51], v[196:199], v[104:119]
    ds_read_b64_tr_b16 v[44:45], v23 offset:28672
    ds_read_b64_tr_b16 v[46:47], v23 offset:30720
    s_waitcnt lgkmcnt(10)
    v_mfma_f32_32x32x16_bf16 v[88:103], v[52:55], v[200:203], v[88:103]
    ds_read_b64_tr_b16 v[48:49], v22 offset:29696
    ds_read_b64_tr_b16 v[50:51], v22 offset:31744
    s_waitcnt lgkmcnt(10)
    v_mfma_f32_32x32x16_bf16 v[104:119], v[28:31], v[200:203], v[104:119]
    ds_read_b64_tr_b16 v[52:53], v23 offset:29696
    ds_read_b64_tr_b16 v[54:55], v23 offset:31744
    s_waitcnt lgkmcnt(10)
    v_mfma_f32_32x32x16_bf16 v[88:103], v[32:35], v[204:207], v[88:103]
    ds_read_b64_tr_b16 v[28:29], v24 offset:32768
    ds_read_b64_tr_b16 v[30:31], v24 offset:34816
    s_waitcnt lgkmcnt(10)
    v_mfma_f32_32x32x16_bf16 v[104:119], v[36:39], v[204:207], v[104:119]
    ds_read_b64_tr_b16 v[32:33], v25 offset:32768
    ds_read_b64_tr_b16 v[34:35], v25 offset:34816
    s_waitcnt lgkmcnt(10)
    v_mfma_f32_32x32x16_bf16 v[88:103], v[40:43], v[208:211], v[88:103]
    ds_read_b64_tr_b16 v[36:37], v24 offset:33792
    ds_read_b64_tr_b16 v[38:39], v24 offset:35840
    s_waitcnt lgkmcnt(10)
    v_mfma_f32_32x32x16_bf16 v[104:119], v[44:47], v[208:211], v[104:119]
    ds_read_b64_tr_b16 v[40:41], v25 offset:33792
    ds_read_b64_tr_b16 v[42:43], v25 offset:35840
    s_waitcnt lgkmcnt(10)
    v_mfma_f32_32x32x16_bf16 v[88:103], v[48:51], v[212:215], v[88:103]
    ds_read_b64_tr_b16 v[44:45], v24 offset:36864
    ds_read_b64_tr_b16 v[46:47], v24 offset:38912
    s_waitcnt lgkmcnt(10)
    v_mfma_f32_32x32x16_bf16 v[104:119], v[52:55], v[212:215], v[104:119]
    ds_read_b64_tr_b16 v[48:49], v25 offset:36864
    ds_read_b64_tr_b16 v[50:51], v25 offset:38912
    s_barrier
    s_waitcnt lgkmcnt(10)
    v_mfma_f32_32x32x16_bf16 v[120:135], v[28:31], v[216:219], v[120:135]
    ds_read_b64_tr_b16 v[52:53], v24 offset:37888
    ds_read_b64_tr_b16 v[54:55], v24 offset:39936
L_PAD4:
    s_cbranch_execz L_RET4
    s_waitcnt lgkmcnt(10)
    v_mfma_f32_32x32x16_bf16 v[136:151], v[32:35], v[216:219], v[136:151]
    ds_read_b64_tr_b16 v[28:29], v25 offset:37888
    ds_read_b64_tr_b16 v[30:31], v25 offset:39936
    s_waitcnt lgkmcnt(10)
    v_mfma_f32_32x32x16_bf16 v[120:135], v[36:39], v[220:223], v[120:135]
    v_cvt_pk_bf16_f32 v88, v88, v89
    ds_read_b64_tr_b16 v[32:33], v24 offset:40960
    ds_read_b64_tr_b16 v[34:35], v24 offset:43008
    s_waitcnt lgkmcnt(10)
    v_mfma_f32_32x32x16_bf16 v[136:151], v[40:43], v[220:223], v[136:151]
    v_cvt_pk_bf16_f32 v89, v90, v91
    ds_read_b64_tr_b16 v[36:37], v25 offset:40960
    ds_read_b64_tr_b16 v[38:39], v25 offset:43008
    s_waitcnt lgkmcnt(10)
    v_mfma_f32_32x32x16_bf16 v[120:135], v[44:47], v[224:227], v[120:135]
    v_cvt_pk_bf16_f32 v90, v92, v93
    ds_read_b64_tr_b16 v[40:41], v24 offset:41984
    ds_read_b64_tr_b16 v[42:43], v24 offset:44032
    s_waitcnt lgkmcnt(10)
    v_mfma_f32_32x32x16_bf16 v[136:151], v[48:51], v[224:227], v[136:151]
    v_cvt_pk_bf16_f32 v91, v94, v95
    ds_read_b64_tr_b16 v[44:45], v25 offset:41984
    ds_read_b64_tr_b16 v[46:47], v25 offset:44032
    s_waitcnt lgkmcnt(10)
    v_mfma_f32_32x32x16_bf16 v[120:135], v[52:55], v[228:231], v[120:135]
    ds_write_b128 v0, v[88:91]
    ds_read_b64_tr_b16 v[48:49], v24 offset:45056
    ds_read_b64_tr_b16 v[50:51], v24 offset:47104
    s_waitcnt lgkmcnt(11)
    v_mfma_f32_32x32x16_bf16 v[136:151], v[28:31], v[228:231], v[136:151]
    v_cvt_pk_bf16_f32 v92, v96, v97
    ds_read_b64_tr_b16 v[52:53], v25 offset:45056
    ds_read_b64_tr_b16 v[54:55], v25 offset:47104
    s_waitcnt lgkmcnt(11)
    v_mfma_f32_32x32x16_bf16 v[120:135], v[32:35], v[232:235], v[120:135]
    v_cvt_pk_bf16_f32 v93, v98, v99
    ds_read_b64_tr_b16 v[28:29], v24 offset:46080
    ds_read_b64_tr_b16 v[30:31], v24 offset:48128
    s_waitcnt lgkmcnt(11)
    v_mfma_f32_32x32x16_bf16 v[136:151], v[36:39], v[232:235], v[136:151]
    v_cvt_pk_bf16_f32 v94, v100, v101
    ds_read_b64_tr_b16 v[32:33], v25 offset:46080
    ds_read_b64_tr_b16 v[34:35], v25 offset:48128
    s_waitcnt lgkmcnt(11)
    v_mfma_f32_32x32x16_bf16 v[120:135], v[40:43], v[236:239], v[120:135]
    v_cvt_pk_bf16_f32 v95, v102, v103
    ds_read_b64_tr_b16 v[36:37], v24
    ds_read_b64_tr_b16 v[38:39], v24 offset:2048
    s_waitcnt lgkmcnt(11)
    v_mfma_f32_32x32x16_bf16 v[136:151], v[44:47], v[236:239], v[136:151]
    ds_write_b128 v0, v[92:95] offset:1024
    ds_read_b64_tr_b16 v[40:41], v25
    ds_read_b64_tr_b16 v[42:43], v25 offset:2048
    s_waitcnt lgkmcnt(11)
    v_mfma_f32_32x32x16_bf16 v[120:135], v[48:51], v[240:243], v[120:135]
    v_cvt_pk_bf16_f32 v104, v104, v105
    ds_read_b64_tr_b16 v[44:45], v24 offset:1024
    ds_read_b64_tr_b16 v[46:47], v24 offset:3072
    s_waitcnt lgkmcnt(11)
    v_mfma_f32_32x32x16_bf16 v[136:151], v[52:55], v[240:243], v[136:151]
    v_cvt_pk_bf16_f32 v105, v106, v107
    ds_read_b64_tr_b16 v[48:49], v25 offset:1024
    ds_read_b64_tr_b16 v[50:51], v25 offset:3072
    s_waitcnt lgkmcnt(11)
    v_mfma_f32_32x32x16_bf16 v[120:135], v[28:31], v[244:247], v[120:135]
    v_cvt_pk_bf16_f32 v106, v108, v109
    ds_read_b64_tr_b16 v[52:53], v24 offset:4096
    ds_read_b64_tr_b16 v[54:55], v24 offset:6144
    s_waitcnt lgkmcnt(11)
    v_mfma_f32_32x32x16_bf16 v[136:151], v[32:35], v[244:247], v[136:151]
    v_cvt_pk_bf16_f32 v107, v110, v111
    ds_read_b64_tr_b16 v[28:29], v25 offset:4096
    ds_read_b64_tr_b16 v[30:31], v25 offset:6144
    s_waitcnt lgkmcnt(11)
    v_mfma_f32_32x32x16_bf16 v[120:135], v[36:39], v[152:155], v[120:135]
    ds_write_b128 v0, v[104:107] offset:8192
    ds_read_b64_tr_b16 v[32:33], v24 offset:5120
    ds_read_b64_tr_b16 v[34:35], v24 offset:7168
    s_waitcnt lgkmcnt(11)
    v_mfma_f32_32x32x16_bf16 v[136:151], v[40:43], v[152:155], v[136:151]
    v_cvt_pk_bf16_f32 v108, v112, v113
    ds_read_b64_tr_b16 v[36:37], v25 offset:5120
    ds_read_b64_tr_b16 v[38:39], v25 offset:7168
    s_waitcnt lgkmcnt(11)
    v_mfma_f32_32x32x16_bf16 v[120:135], v[44:47], v[156:159], v[120:135]
    v_cvt_pk_bf16_f32 v109, v114, v115
    ds_read_b64_tr_b16 v[40:41], v24 offset:8192
    ds_read_b64_tr_b16 v[42:43], v24 offset:10240
    s_waitcnt lgkmcnt(11)
    v_mfma_f32_32x32x16_bf16 v[136:151], v[48:51], v[156:159], v[136:151]
    v_cvt_pk_bf16_f32 v110, v116, v117
    ds_read_b64_tr_b16 v[44:45], v25 offset:8192
    ds_read_b64_tr_b16 v[46:47], v25 offset:10240
    s_waitcnt lgkmcnt(11)
    v_mfma_f32_32x32x16_bf16 v[120:135], v[52:55], v[160:163], v[120:135]
    v_cvt_pk_bf16_f32 v111, v118, v119
    ds_read_b64_tr_b16 v[48:49], v24 offset:9216
    ds_read_b64_tr_b16 v[50:51], v24 offset:11264
    s_waitcnt lgkmcnt(11)
    v_mfma_f32_32x32x16_bf16 v[136:151], v[28:31], v[160:163], v[136:151]
    ds_write_b128 v0, v[108:111] offset:9216
    ds_read_b64_tr_b16 v[52:53], v25 offset:9216
    ds_read_b64_tr_b16 v[54:55], v25 offset:11264
    s_waitcnt lgkmcnt(11)
    v_mfma_f32_32x32x16_bf16 v[120:135], v[32:35], v[164:167], v[120:135]
    ds_read_b64_tr_b16 v[28:29], v24 offset:12288
    ds_read_b64_tr_b16 v[30:31], v24 offset:14336
    s_waitcnt lgkmcnt(11)
    v_mfma_f32_32x32x16_bf16 v[136:151], v[36:39], v[164:167], v[136:151]
    ds_read_b64_tr_b16 v[32:33], v25 offset:12288
    ds_read_b64_tr_b16 v[34:35], v25 offset:14336
    s_waitcnt lgkmcnt(11)
    v_mfma_f32_32x32x16_bf16 v[120:135], v[40:43], v[168:171], v[120:135]
    ds_read_b64_tr_b16 v[36:37], v24 offset:13312
    ds_read_b64_tr_b16 v[38:39], v24 offset:15360
    s_waitcnt lgkmcnt(11)
    v_mfma_f32_32x32x16_bf16 v[136:151], v[44:47], v[168:171], v[136:151]
    ds_read_b64_tr_b16 v[40:41], v25 offset:13312
    ds_read_b64_tr_b16 v[42:43], v25 offset:15360
    s_waitcnt lgkmcnt(11)
    v_mfma_f32_32x32x16_bf16 v[120:135], v[48:51], v[172:175], v[120:135]
    ds_read_b64_tr_b16 v[44:45], v24 offset:16384
    ds_read_b64_tr_b16 v[46:47], v24 offset:18432
    s_waitcnt lgkmcnt(10)
    v_mfma_f32_32x32x16_bf16 v[136:151], v[52:55], v[172:175], v[136:151]
    ds_read_b64_tr_b16 v[48:49], v25 offset:16384
    ds_read_b64_tr_b16 v[50:51], v25 offset:18432
    s_waitcnt lgkmcnt(10)
    v_mfma_f32_32x32x16_bf16 v[120:135], v[28:31], v[176:179], v[120:135]
    ds_read_b64_tr_b16 v[52:53], v24 offset:17408
    ds_read_b64_tr_b16 v[54:55], v24 offset:19456
    s_waitcnt lgkmcnt(10)
    v_mfma_f32_32x32x16_bf16 v[136:151], v[32:35], v[176:179], v[136:151]
    ds_read_b64_tr_b16 v[28:29], v25 offset:17408
    ds_read_b64_tr_b16 v[30:31], v25 offset:19456
    s_waitcnt lgkmcnt(10)
    v_mfma_f32_32x32x16_bf16 v[120:135], v[36:39], v[180:183], v[120:135]
    ds_read_b64_tr_b16 v[32:33], v24 offset:20480
    ds_read_b64_tr_b16 v[34:35], v24 offset:22528
    s_waitcnt lgkmcnt(10)
    v_mfma_f32_32x32x16_bf16 v[136:151], v[40:43], v[180:183], v[136:151]
    ds_read_b64_tr_b16 v[36:37], v25 offset:20480
    ds_read_b64_tr_b16 v[38:39], v25 offset:22528
    s_waitcnt lgkmcnt(10)
    v_mfma_f32_32x32x16_bf16 v[120:135], v[44:47], v[184:187], v[120:135]
    ds_read_b64_tr_b16 v[40:41], v24 offset:21504
    ds_read_b64_tr_b16 v[42:43], v24 offset:23552
    s_waitcnt lgkmcnt(10)
    v_mfma_f32_32x32x16_bf16 v[136:151], v[48:51], v[184:187], v[136:151]
    ds_read_b64_tr_b16 v[44:45], v25 offset:21504
    ds_read_b64_tr_b16 v[46:47], v25 offset:23552
    s_waitcnt lgkmcnt(10)
    v_mfma_f32_32x32x16_bf16 v[120:135], v[52:55], v[188:191], v[120:135]
    ds_read_b64_tr_b16 v[48:49], v24 offset:24576
    ds_read_b64_tr_b16 v[50:51], v24 offset:26624
    s_waitcnt lgkmcnt(10)
    v_mfma_f32_32x32x16_bf16 v[136:151], v[28:31], v[188:191], v[136:151]
    ds_read_b64_tr_b16 v[52:53], v25 offset:24576
    ds_read_b64_tr_b16 v[54:55], v25 offset:26624
    s_waitcnt lgkmcnt(10)
    v_mfma_f32_32x32x16_bf16 v[120:135], v[32:35], v[192:195], v[120:135]
    ds_read_b64_tr_b16 v[28:29], v24 offset:25600
    ds_read_b64_tr_b16 v[30:31], v24 offset:27648
    s_waitcnt lgkmcnt(10)
    v_mfma_f32_32x32x16_bf16 v[136:151], v[36:39], v[192:195], v[136:151]
    ds_read_b64_tr_b16 v[32:33], v25 offset:25600
    ds_read_b64_tr_b16 v[34:35], v25 offset:27648
    s_waitcnt lgkmcnt(10)
    v_mfma_f32_32x32x16_bf16 v[120:135], v[40:43], v[196:199], v[120:135]
    ds_read_b64_tr_b16 v[36:37], v24 offset:28672
    ds_read_b64_tr_b16 v[38:39], v24 offset:30720
    s_waitcnt lgkmcnt(10)
    v_mfma_f32_32x32x16_bf16 v[136:151], v[44:47], v[196:199], v[136:151]
    ds_read_b64_tr_b16 v[40:41], v25 offset:28672
    ds_read_b64_tr_b16 v[42:43], v25 offset:30720
    s_waitcnt lgkmcnt(10)
    v_mfma_f32_32x32x16_bf16 v[120:135], v[48:51], v[200:203], v[120:135]
    ds_read_b64_tr_b16 v[44:45], v25 offset:29696
    ds_read_b64_tr_b16 v[46:47], v25 offset:31744
    s_waitcnt lgkmcnt(10)
    v_mfma_f32_32x32x16_bf16 v[136:151], v[52:55], v[200:203], v[136:151]
    ds_read_b64_tr_b16 v[48:49], v24 offset:29696
    ds_read_b64_tr_b16 v[50:51], v24 offset:31744
    s_waitcnt lgkmcnt(10)
    v_mfma_f32_32x32x16_bf16 v[120:135], v[28:31], v[204:207], v[120:135]
    s_waitcnt lgkmcnt(8)
    v_mfma_f32_32x32x16_bf16 v[136:151], v[32:35], v[204:207], v[136:151]
    s_waitcnt lgkmcnt(6)
    v_mfma_f32_32x32x16_bf16 v[120:135], v[36:39], v[208:211], v[120:135]
    s_waitcnt lgkmcnt(4)
    v_mfma_f32_32x32x16_bf16 v[136:151], v[40:43], v[208:211], v[136:151]
    s_waitcnt lgkmcnt(2)
    v_mfma_f32_32x32x16_bf16 v[136:151], v[44:47], v[212:215], v[136:151]
    s_waitcnt lgkmcnt(0)
    v_mfma_f32_32x32x16_bf16 v[120:135], v[48:51], v[212:215], v[120:135]
    s_lshl_b32 s96, s77, 11
    s_add_u32 s14, s96, 151552
    v_add_u32 v0, s14, v2
    v_bfe_u32 v4, v1, 2, 2
    v_lshlrev_b32 v4, 6, v4
    v_bfe_u32 v9, v1, 4, 1
    v_lshl_add_u32 v4, v9, 5, v4
    v_and_b32 v9, 3, v1
    v_lshl_add_u32 v4, v9, 3, v4
    v_lshrrev_b32 v9, 5, v1
    v_lshl_add_u32 v4, v9, 8, v4
    v_add_u32 v4, 159744, v4
    ds_read_b64_tr_b16 v[176:177], v4
    ds_read_b64_tr_b16 v[178:179], v4 offset:512
    ds_read_b64_tr_b16 v[180:181], v4 offset:1024
    ds_read_b64_tr_b16 v[182:183], v4 offset:1536
    v_cvt_pk_bf16_f32 v152, v136, v137
    v_cvt_pk_bf16_f32 v153, v138, v139
    v_cvt_pk_bf16_f32 v154, v140, v141
    v_cvt_pk_bf16_f32 v155, v142, v143
    v_cvt_pk_bf16_f32 v156, v144, v145
    v_cvt_pk_bf16_f32 v157, v146, v147
    v_cvt_pk_bf16_f32 v158, v148, v149
    v_cvt_pk_bf16_f32 v159, v150, v151
    ds_write_b128 v0, v[152:155]
    ds_write_b128 v0, v[156:159] offset:1024
    v_cvt_pk_bf16_f32 v168, v120, v121
    v_cvt_pk_bf16_f32 v169, v122, v123
    v_cvt_pk_bf16_f32 v170, v124, v125
    v_cvt_pk_bf16_f32 v171, v126, v127
    v_cvt_pk_bf16_f32 v172, v128, v129
    v_cvt_pk_bf16_f32 v173, v130, v131
    v_cvt_pk_bf16_f32 v174, v132, v133
    v_cvt_pk_bf16_f32 v175, v134, v135
    s_setprio 0
    s_branch L_JOIN
L_HELP:
    s_waitcnt vmcnt(3)
    s_barrier
    s_add_u32 s96, s84, 5
    s_and_b32 s97, s96, 15
    s_mul_i32 s98, s97, 393216
    s_add_u32 s99, s98, s85
    s_add_u32 s82, s99, 4294772736
    s_add_u32 m0, s83, 36864
    s_nop 0
    buffer_load_dwordx4 v3, s[40:43], s82 offen lds
    s_add_u32 s96, s84, 5
    s_and_b32 s97, s96, 15
    s_mul_i32 s98, s97, 393216
    s_add_u32 s99, s98, s85
    s_add_u32 s82, s99, 2048
    s_add_u32 m0, s83, 40960
    s_nop 0
    buffer_load_dwordx4 v3, s[40:43], s82 offen lds
    s_add_u32 s96, s84, 5
    s_and_b32 s97, s96, 15
    s_mul_i32 s98, s97, 393216
    s_add_u32 s99, s98, s85
    s_add_u32 s82, s99, 4294774784
    s_add_u32 m0, s83, 86016
    s_nop 0
    buffer_load_dwordx4 v3, s[40:43], s82 offen lds
    s_add_u32 s96, s84, 5
    s_and_b32 s97, s96, 15
    s_mul_i32 s98, s97, 393216
    s_add_u32 s99, s98, s85
    s_add_u32 s82, s99, 4096
    s_add_u32 m0, s83, 90112
    s_nop 0
    buffer_load_dwordx4 v3, s[40:43], s82 offen lds
    s_add_u32 s96, s84, 5
    s_and_b32 s97, s96, 15
    s_mul_i32 s98, s97, 393216
    s_add_u32 s99, s98, s85
    s_add_u32 s82, s99, 4294770688
    s_add_u32 m0, s83, 135168
    s_nop 0
    buffer_load_dwordx4 v3, s[40:43], s82 offen lds
    s_add_u32 s96, s84, 5
    s_and_b32 s97, s96, 15
    s_mul_i32 s98, s97, 393216
    s_add_u32 s82, s98, s85
    s_add_u32 m0, s83, 139264
    s_nop 0
    buffer_load_dwordx4 v3, s[40:43], s82 offen lds
    v_bfe_u32 v4, v1, 2, 2
    v_lshlrev_b32 v4, 6, v4
    v_bfe_u32 v9, v1, 4, 1
    v_lshl_add_u32 v4, v9, 5, v4
    v_and_b32 v9, 3, v1
    v_lshl_add_u32 v4, v9, 3, v4
    v_lshrrev_b32 v9, 5, v1
    v_lshl_add_u32 v4, v9, 8, v4
    v_add_u32 v4, 159744, v4
    ds_read_b64_tr_b16 v[168:169], v4
    ds_read_b64_tr_b16 v[170:171], v4 offset:512
    ds_read_b64_tr_b16 v[172:173], v4 offset:1024
    ds_read_b64_tr_b16 v[174:175], v4 offset:1536
    ds_read_b64_tr_b16 v[176:177], v4 offset:2048
    ds_read_b64_tr_b16 v[178:179], v4 offset:2560
    ds_read_b64_tr_b16 v[180:181], v4 offset:3072
    ds_read_b64_tr_b16 v[182:183], v4 offset:3584
    s_lshl_b32 s14, s77, 10
    v_and_b32 v232, 7, v1
    v_lshl_add_u32 v232, v232, 4, s14
    v_bfe_u32 v9, v1, 3, 2
    v_lshl_add_u32 v232, v9, 8, v232
    v_lshrrev_b32 v9, 5, v1
    v_lshl_add_u32 v232, v9, 7, v232
    s_and_b32 s96, s9, 1
    s_lshl1_add_u32 s18, s96, 1
    s_and_b32 s96, s8, 3
    s_lshl2_add_u32 s97, s96, s3
    s_sub_u32 s98, s97, 4
    s_lshl_b32 s82, s98, 7
    v_lshrrev_b32 v52, 3, v1
    v_lshl_add_u32 v52, v52, 1, s82
    global_load_ushort v36, v52, s[86:87] offset:0
    global_load_ushort v37, v52, s[86:87] offset:16
    global_load_ushort v38, v52, s[86:87] offset:32
    global_load_ushort v39, v52, s[86:87] offset:48
    global_load_ushort v40, v52, s[86:87] offset:64
    global_load_ushort v41, v52, s[86:87] offset:80
    global_load_ushort v42, v52, s[86:87] offset:96
    global_load_ushort v43, v52, s[86:87] offset:112
    s_and_b32 s96, s8, 3
    s_lshl2_add_u32 s97, s96, s3
    s_sub_u32 s98, s97, 4
    s_mul_i32 s99, s98, 786432
    s_lshr_b32 s96, s8, 2
    s_lshl1_add_u32 s97, s9, s96
    s_lshl_b32 s98, s97, 7
    s_add_u32 s96, s99, s98
    s_add_u32 s19, s96, 4096
    s_barrier
    s_add_u32 s96, s84, 6
    s_and_b32 s97, s96, 15
    s_mul_i32 s98, s97, 393216
    s_add_u32 s99, s98, s85
    s_add_u32 s82, s99, 4294772736
    s_add_u32 m0, s83, 4294963200
    s_nop 0
    buffer_load_dwordx4 v3, s[40:43], s82 offen lds
    s_add_u32 s96, s84, 6
    s_and_b32 s97, s96, 15
    s_mul_i32 s98, s97, 393216
    s_add_u32 s99, s98, s85
    s_add_u32 s82, s99, 2048
    s_mov_b32 m0, s83
    s_nop 0
    buffer_load_dwordx4 v3, s[40:43], s82 offen lds
    s_add_u32 s96, s84, 6
    s_and_b32 s97, s96, 15
    s_mul_i32 s98, s97, 393216
    s_add_u32 s99, s98, s85
    s_add_u32 s82, s99, 4294770688
    s_add_u32 m0, s83, 94208
    s_nop 0
    buffer_load_dwordx4 v3, s[40:43], s82 offen lds
    s_add_u32 s96, s84, 6
    s_and_b32 s97, s96, 15
    s_mul_i32 s98, s97, 393216
    s_add_u32 s82, s98, s85
    s_add_u32 m0, s83, 98304
    s_nop 0
    buffer_load_dwordx4 v3, s[40:43], s82 offen lds
    s_add_u32 s96, s84, 6
    s_and_b32 s97, s96, 15
    s_mul_i32 s98, s97, 393216
    s_add_u32 s99, s98, s85
    s_add_u32 s82, s99, 4294774784
    s_add_u32 m0, s83, 45056
    s_nop 0
    buffer_load_dwordx4 v3, s[40:43], s82 offen lds
    s_add_u32 s96, s84, 6
    s_and_b32 s97, s96, 15
    s_mul_i32 s98, s97, 393216
    s_add_u32 s99, s98, s85
    s_add_u32 s82, s99, 4096
    s_add_u32 m0, s83, 49152
    s_nop 0
    buffer_load_dwordx4 v3, s[40:43], s82 offen lds
    s_waitcnt lgkmcnt(0)
    s_load_dword s24, s[32:33], s92 offset:512 glc
    s_load_dword s25, s[32:33], s92 offset:256 glc
    s_load_dword s26, s[32:33], s92 offset:3584 glc
    s_load_dword s27, s[32:33], s92 offset:3328 glc
    s_barrier
    s_add_u32 s96, s84, 7
    s_and_b32 s97, s96, 15
    s_mul_i32 s98, s97, 393216
    s_add_u32 s99, s98, s85
    s_add_u32 s82, s99, 4294772736
    s_add_u32 m0, s83, 4096
    s_nop 0
    buffer_load_dwordx4 v3, s[40:43], s82 offen lds
    s_add_u32 s96, s84, 7
    s_and_b32 s97, s96, 15
    s_mul_i32 s98, s97, 393216
    s_add_u32 s99, s98, s85
    s_add_u32 s82, s99, 2048
    s_add_u32 m0, s83, 8192
    s_nop 0
    buffer_load_dwordx4 v3, s[40:43], s82 offen lds
    s_add_u32 s96, s84, 7
    s_and_b32 s97, s96, 15
    s_mul_i32 s98, s97, 393216
    s_add_u32 s99, s98, s85
    s_add_u32 s82, s99, 4294770688
    s_add_u32 m0, s83, 102400
    s_nop 0
    buffer_load_dwordx4 v3, s[40:43], s82 offen lds
    s_add_u32 s96, s84, 7
    s_and_b32 s97, s96, 15
    s_mul_i32 s98, s97, 393216
    s_add_u32 s82, s98, s85
    s_add_u32 m0, s83, 106496
    s_nop 0
    buffer_load_dwordx4 v3, s[40:43], s82 offen lds
    s_add_u32 s96, s84, 7
    s_and_b32 s97, s96, 15
    s_mul_i32 s98, s97, 393216
    s_add_u32 s99, s98, s85
    s_add_u32 s82, s99, 4294774784
    s_add_u32 m0, s83, 53248
    s_nop 0
    buffer_load_dwordx4 v3, s[40:43], s82 offen lds
    s_add_u32 s96, s84, 7
    s_and_b32 s97, s96, 15
    s_mul_i32 s98, s97, 393216
    s_add_u32 s99, s98, s85
    s_add_u32 s82, s99, 4096
    s_add_u32 m0, s83, 57344
    s_nop 0
    buffer_load_dwordx4 v3, s[40:43], s82 offen lds
    s_waitcnt vmcnt(26)
    s_barrier
    s_add_u32 s96, s84, 8
    s_and_b32 s97, s96, 15
    s_mul_i32 s98, s97, 393216
    s_add_u32 s99, s98, s85
    s_add_u32 s82, s99, 4294772736
    s_add_u32 m0, s83, 12288
    s_nop 0
    buffer_load_dwordx4 v3, s[40:43], s82 offen lds
    s_add_u32 s96, s84, 8
    s_and_b32 s97, s96, 15
    s_mul_i32 s98, s97, 393216
    s_add_u32 s99, s98, s85
    s_add_u32 s82, s99, 2048
    s_add_u32 m0, s83, 16384
    s_nop 0
    buffer_load_dwordx4 v3, s[40:43], s82 offen lds
    s_add_u32 s96, s84, 8
    s_and_b32 s97, s96, 15
    s_mul_i32 s98, s97, 393216
    s_add_u32 s99, s98, s85
    s_add_u32 s82, s99, 4294770688
    s_add_u32 m0, s83, 110592
    s_nop 0
    buffer_load_dwordx4 v3, s[40:43], s82 offen lds
    s_add_u32 s96, s84, 8
    s_and_b32 s97, s96, 15
    s_mul_i32 s98, s97, 393216
    s_add_u32 s82, s98, s85
    s_add_u32 m0, s83, 114688
    s_nop 0
    buffer_load_dwordx4 v3, s[40:43], s82 offen lds
    s_add_u32 s96, s84, 8
    s_and_b32 s97, s96, 15
    s_mul_i32 s98, s97, 393216
    s_add_u32 s99, s98, s85
    s_add_u32 s82, s99, 4294774784
    s_add_u32 m0, s83, 61440
    s_nop 0
    buffer_load_dwordx4 v3, s[40:43], s82 offen lds
    s_add_u32 s96, s84, 8
    s_and_b32 s97, s96, 15
    s_mul_i32 s98, s97, 393216
    s_add_u32 s99, s98, s85
    s_add_u32 s82, s99, 4096
    s_add_u32 m0, s83, 65536
    s_nop 0
    buffer_load_dwordx4 v3, s[40:43], s82 offen lds
    s_waitcnt vmcnt(18)
    v_lshlrev_b32 v36, 16, v36
    v_mul_f32 v52, s7, v36
    v_exp_f32 v52, -v52
    s_nop 0
    v_add_f32 v52, 1.0, v52
    v_rcp_f32 v52, v52
    s_nop 0
    v_mul_f32 v36, v36, v52
    v_cvt_pk_bf16_f32 v36, 0, v36
    v_lshlrev_b32 v37, 16, v37
    v_mul_f32 v53, s7, v37
    v_exp_f32 v53, -v53
    s_nop 0
    v_add_f32 v53, 1.0, v53
    v_rcp_f32 v53, v53
    s_nop 0
    v_mul_f32 v37, v37, v53
    v_cvt_pk_bf16_f32 v37, 0, v37
    v_lshlrev_b32 v38, 16, v38
    v_mul_f32 v52, s7, v38
    v_exp_f32 v52, -v52
    s_nop 0
    v_add_f32 v52, 1.0, v52
    v_rcp_f32 v52, v52
    s_nop 0
    v_mul_f32 v38, v38, v52
    v_cvt_pk_bf16_f32 v38, 0, v38
    v_lshlrev_b32 v39, 16, v39
    v_mul_f32 v53, s7, v39
    v_exp_f32 v53, -v53
    s_nop 0
    v_add_f32 v53, 1.0, v53
    v_rcp_f32 v53, v53
    s_nop 0
    v_mul_f32 v39, v39, v53
    v_cvt_pk_bf16_f32 v39, 0, v39
    v_lshlrev_b32 v40, 16, v40
    v_mul_f32 v52, s7, v40
    v_exp_f32 v52, -v52
    s_nop 0
    v_add_f32 v52, 1.0, v52
    v_rcp_f32 v52, v52
    s_nop 0
    v_mul_f32 v40, v40, v52
    v_cvt_pk_bf16_f32 v40, 0, v40
    v_lshlrev_b32 v41, 16, v41
    v_mul_f32 v53, s7, v41
    v_exp_f32 v53, -v53
    s_nop 0
    v_add_f32 v53, 1.0, v53
    v_rcp_f32 v53, v53
    s_nop 0
    v_mul_f32 v41, v41, v53
    v_cvt_pk_bf16_f32 v41, 0, v41
    v_lshlrev_b32 v42, 16, v42
    v_mul_f32 v52, s7, v42
    v_exp_f32 v52, -v52
    s_nop 0
    v_add_f32 v52, 1.0, v52
    v_rcp_f32 v52, v52
    s_nop 0
    v_mul_f32 v42, v42, v52
    v_cvt_pk_bf16_f32 v42, 0, v42
    v_lshlrev_b32 v43, 16, v43
    v_mul_f32 v53, s7, v43
    v_exp_f32 v53, -v53
    s_nop 0
    v_add_f32 v53, 1.0, v53
    v_rcp_f32 v53, v53
    s_nop 0
    v_mul_f32 v43, v43, v53
    v_cvt_pk_bf16_f32 v43, 0, v43
    s_waitcnt lgkmcnt(0)
    s_load_dword s24, s[32:33], s92 offset:1024 glc
    s_load_dword s25, s[32:33], s92 offset:768 glc
    s_load_dword s26, s[32:33], s92 offset:1536 glc
    s_load_dword s27, s[32:33], s92 offset:1280 glc
    s_barrier
    s_add_u32 s96, s84, 9
    s_and_b32 s97, s96, 15
    s_mul_i32 s98, s97, 393216
    s_add_u32 s99, s98, s85
    s_add_u32 s82, s99, 4294772736
    s_add_u32 m0, s83, 20480
    s_nop 0
    buffer_load_dwordx4 v3, s[40:43], s82 offen lds
    s_add_u32 s96, s84, 9
    s_and_b32 s97, s96, 15
    s_mul_i32 s98, s97, 393216
    s_add_u32 s99, s98, s85
    s_add_u32 s82, s99, 2048
    s_add_u32 m0, s83, 24576
    s_nop 0
    buffer_load_dwordx4 v3, s[40:43], s82 offen lds
    s_add_u32 s96, s84, 9
    s_and_b32 s97, s96, 15
    s_mul_i32 s98, s97, 393216
    s_add_u32 s99, s98, s85
    s_add_u32 s82, s99, 4294770688
    s_add_u32 m0, s83, 118784
    s_nop 0
    buffer_load_dwordx4 v3, s[40:43], s82 offen lds
    s_add_u32 s96, s84, 9
    s_and_b32 s97, s96, 15
    s_mul_i32 s98, s97, 393216
    s_add_u32 s82, s98, s85
    s_add_u32 m0, s83, 122880
    s_nop 0
    buffer_load_dwordx4 v3, s[40:43], s82 offen lds
    s_add_u32 s96, s84, 9
    s_and_b32 s97, s96, 15
    s_mul_i32 s98, s97, 393216
    s_add_u32 s99, s98, s85
    s_add_u32 s82, s99, 4294774784
    s_add_u32 m0, s83, 69632
    s_nop 0
    buffer_load_dwordx4 v3, s[40:43], s82 offen lds
    s_add_u32 s96, s84, 9
    s_and_b32 s97, s96, 15
    s_mul_i32 s98, s97, 393216
    s_add_u32 s99, s98, s85
    s_add_u32 s82, s99, 4096
    s_add_u32 m0, s83, 73728
    s_nop 0
    buffer_load_dwordx4 v3, s[40:43], s82 offen lds
    s_waitcnt vmcnt(22)
    s_waitcnt vmcnt(20)
    s_waitcnt vmcnt(18)
    s_barrier
    s_add_u32 s96, s84, 10
    s_and_b32 s97, s96, 15
    s_mul_i32 s98, s97, 393216
    s_add_u32 s99, s98, s85
    s_add_u32 s82, s99, 4294772736
    s_add_u32 m0, s83, 28672
    s_nop 0
    buffer_load_dwordx4 v3, s[40:43], s82 offen lds
    s_add_u32 s96, s84, 10
    s_and_b32 s97, s96, 15
    s_mul_i32 s98, s97, 393216
    s_add_u32 s99, s98, s85
    s_add_u32 s82, s99, 2048
    s_add_u32 m0, s83, 32768
    s_nop 0
    buffer_load_dwordx4 v3, s[40:43], s82 offen lds
    s_add_u32 s96, s84, 10
    s_and_b32 s97, s96, 15
    s_mul_i32 s98, s97, 393216
    s_add_u32 s99, s98, s85
    s_add_u32 s82, s99, 4294774784
    s_add_u32 m0, s83, 77824
    s_nop 0
    buffer_load_dwordx4 v3, s[40:43], s82 offen lds
    s_add_u32 s96, s84, 10
    s_and_b32 s97, s96, 15
    s_mul_i32 s98, s97, 393216
    s_add_u32 s99, s98, s85
    s_add_u32 s82, s99, 4096
    s_add_u32 m0, s83, 81920
    s_nop 0
    buffer_load_dwordx4 v3, s[40:43], s82 offen lds
    s_waitcnt lgkmcnt(0)
    s_load_dword s24, s[32:33], s92 offset:2560 glc
    s_load_dword s25, s[32:33], s92 offset:2304 glc
    s_load_dword s26, s[32:33], s92 offset:3072 glc
    s_load_dword s27, s[32:33], s92 offset:2816 glc
    s_waitcnt vmcnt(20)
    s_waitcnt vmcnt(18)
    s_waitcnt vmcnt(16)
    s_barrier
    s_add_u32 s96, s84, 11
    s_and_b32 s97, s96, 15
    s_mul_i32 s98, s97, 393216
    s_add_u32 s99, s98, s85
    s_add_u32 s82, s99, 4294772736
L_PAD5:
    s_cbranch_execz L_RET5
    s_add_u32 m0, s83, 36864
    s_nop 0
    buffer_load_dwordx4 v3, s[40:43], s82 offen lds
    s_add_u32 s96, s84, 11
    s_and_b32 s97, s96, 15
    s_mul_i32 s98, s97, 393216
    s_add_u32 s99, s98, s85
    s_add_u32 s82, s99, 2048
    s_add_u32 m0, s83, 40960
    s_nop 0
    buffer_load_dwordx4 v3, s[40:43], s82 offen lds
    s_add_u32 s96, s84, 11
    s_and_b32 s97, s96, 15
    s_mul_i32 s98, s97, 393216
    s_add_u32 s99, s98, s85
    s_add_u32 s82, s99, 4294774784
    s_add_u32 m0, s83, 86016
    s_nop 0
    buffer_load_dwordx4 v3, s[40:43], s82 offen lds
    s_add_u32 s96, s84, 11
    s_and_b32 s97, s96, 15
    s_mul_i32 s98, s97, 393216
    s_add_u32 s99, s98, s85
    s_add_u32 s82, s99, 4096
    s_add_u32 m0, s83, 90112
    s_nop 0
    buffer_load_dwordx4 v3, s[40:43], s82 offen lds
    s_waitcnt vmcnt(18)
    s_waitcnt vmcnt(16)
    s_waitcnt vmcnt(14)
    s_barrier
    s_add_u32 s96, s84, 12
    s_and_b32 s97, s96, 15
    s_mul_i32 s98, s97, 393216
    s_add_u32 s99, s98, s85
    s_add_u32 s82, s99, 4294772736
    s_add_u32 m0, s83, 4294963200
    s_nop 0
    buffer_load_dwordx4 v3, s[40:43], s82 offen lds
    s_add_u32 s96, s84, 12
    s_and_b32 s97, s96, 15
    s_mul_i32 s98, s97, 393216
    s_add_u32 s99, s98, s85
    s_add_u32 s82, s99, 2048
    s_mov_b32 m0, s83
    s_nop 0
    buffer_load_dwordx4 v3, s[40:43], s82 offen lds
    s_add_u32 s96, s84, 12
    s_and_b32 s97, s96, 15
    s_mul_i32 s98, s97, 393216
    s_add_u32 s99, s98, s85
    s_add_u32 s82, s99, 4294774784
    s_add_u32 m0, s83, 45056
    s_nop 0
    buffer_load_dwordx4 v3, s[40:43], s82 offen lds
    s_add_u32 s96, s84, 12
    s_and_b32 s97, s96, 15
    s_mul_i32 s98, s97, 393216
    s_add_u32 s99, s98, s85
    s_add_u32 s82, s99, 4096
    s_add_u32 m0, s83, 49152
    s_nop 0
    buffer_load_dwordx4 v3, s[40:43], s82 offen lds
    s_waitcnt vmcnt(16)
    s_barrier
    s_add_u32 s96, s84, 13
    s_and_b32 s97, s96, 15
    s_mul_i32 s98, s97, 393216
    s_add_u32 s99, s98, s85
    s_add_u32 s82, s99, 4294772736
    s_add_u32 m0, s83, 4096
    s_nop 0
    buffer_load_dwordx4 v3, s[40:43], s82 offen lds
    s_add_u32 s96, s84, 13
    s_and_b32 s97, s96, 15
    s_mul_i32 s98, s97, 393216
    s_add_u32 s99, s98, s85
    s_add_u32 s82, s99, 2048
    s_add_u32 m0, s83, 8192
    s_nop 0
    buffer_load_dwordx4 v3, s[40:43], s82 offen lds
    s_add_u32 s96, s84, 13
    s_and_b32 s97, s96, 15
    s_mul_i32 s98, s97, 393216
    s_add_u32 s99, s98, s85
    s_add_u32 s82, s99, 4294774784
    s_add_u32 m0, s83, 53248
    s_nop 0
    buffer_load_dwordx4 v3, s[40:43], s82 offen lds
    s_add_u32 s96, s84, 13
    s_and_b32 s97, s96, 15
    s_mul_i32 s98, s97, 393216
    s_add_u32 s99, s98, s85
    s_add_u32 s82, s99, 4096
    s_add_u32 m0, s83, 57344
    s_nop 0
    buffer_load_dwordx4 v3, s[40:43], s82 offen lds
    s_lshl_b32 s96, s74, 13
    s_sub_u32 s97, s3, 4
    s_lshl_b32 s98, s97, 8
    s_add_u32 s99, s96, s98
    s_add_u32 s13, s99, 20971520
    s_waitcnt lgkmcnt(0)
    s_load_dword s24, s[32:33], s13 offset:1276 glc
    s_load_dword s25, s[32:33], s13 offset:3324 glc
    s_load_dword s26, s[32:33], s13 offset:5372 glc
    s_load_dword s27, s[32:33], s13 offset:7420 glc
    s_waitcnt vmcnt(18)
    s_waitcnt vmcnt(16)
    s_barrier
    s_add_u32 s96, s84, 14
    s_and_b32 s97, s96, 15
    s_mul_i32 s98, s97, 393216
    s_add_u32 s99, s98, s85
    s_add_u32 s82, s99, 4294772736
    s_add_u32 m0, s83, 12288
    s_nop 0
    buffer_load_dwordx4 v3, s[40:43], s82 offen lds
    s_add_u32 s96, s84, 14
    s_and_b32 s97, s96, 15
    s_mul_i32 s98, s97, 393216
    s_add_u32 s99, s98, s85
    s_add_u32 s82, s99, 2048
    s_add_u32 m0, s83, 16384
    s_nop 0
    buffer_load_dwordx4 v3, s[40:43], s82 offen lds
    s_add_u32 s96, s84, 10
    s_and_b32 s97, s96, 15
    s_mul_i32 s98, s97, 393216
    s_add_u32 s99, s98, s85
    s_add_u32 s82, s99, 4294770688
    s_add_u32 m0, s83, 126976
    s_nop 0
    buffer_load_dwordx4 v3, s[40:43], s82 offen lds
    s_add_u32 s96, s84, 10
    s_and_b32 s97, s96, 15
    s_mul_i32 s98, s97, 393216
    s_add_u32 s82, s98, s85
    s_add_u32 m0, s83, 131072
    s_nop 0
    buffer_load_dwordx4 v3, s[40:43], s82 offen lds
    s_waitcnt vmcnt(18)
    s_waitcnt vmcnt(14)
    s_barrier
    s_add_u32 s96, s84, 15
    s_and_b32 s97, s96, 15
    s_mul_i32 s98, s97, 393216
    s_add_u32 s99, s98, s85
    s_add_u32 s82, s99, 4294772736
    s_add_u32 m0, s83, 20480
    s_nop 0
    buffer_load_dwordx4 v3, s[40:43], s82 offen lds
    s_add_u32 s96, s84, 15
    s_and_b32 s97, s96, 15
    s_mul_i32 s98, s97, 393216
    s_add_u32 s99, s98, s85
    s_add_u32 s82, s99, 2048
    s_add_u32 m0, s83, 24576
    s_nop 0
    buffer_load_dwordx4 v3, s[40:43], s82 offen lds
    s_add_u32 s96, s84, 11
    s_and_b32 s97, s96, 15
    s_mul_i32 s98, s97, 393216
    s_add_u32 s99, s98, s85
    s_add_u32 s82, s99, 4294770688
    s_add_u32 m0, s83, 135168
    s_nop 0
    buffer_load_dwordx4 v3, s[40:43], s82 offen lds
    s_add_u32 s96, s84, 11
    s_and_b32 s97, s96, 15
    s_mul_i32 s98, s97, 393216
    s_add_u32 s82, s98, s85
    s_add_u32 m0, s83, 139264
    s_nop 0
    buffer_load_dwordx4 v3, s[40:43], s82 offen lds
    s_waitcnt vmcnt(14)
    s_waitcnt vmcnt(10)
    s_waitcnt vmcnt(6)
    s_barrier
    s_add_u32 s96, s84, 14
    s_and_b32 s97, s96, 15
    s_mul_i32 s98, s97, 393216
    s_add_u32 s99, s98, s85
    s_add_u32 s82, s99, 4294774784
    s_add_u32 m0, s83, 61440
    s_nop 0
    buffer_load_dwordx4 v3, s[40:43], s82 offen lds
    s_add_u32 s96, s84, 14
    s_and_b32 s97, s96, 15
    s_mul_i32 s98, s97, 393216
    s_add_u32 s99, s98, s85
    s_add_u32 s82, s99, 4096
    s_add_u32 m0, s83, 65536
    s_nop 0
    buffer_load_dwordx4 v3, s[40:43], s82 offen lds
    s_add_u32 s96, s84, 15
    s_and_b32 s97, s96, 15
    s_mul_i32 s98, s97, 393216
    s_add_u32 s99, s98, s85
    s_add_u32 s82, s99, 4294774784
    s_add_u32 m0, s83, 69632
    s_nop 0
    buffer_load_dwordx4 v3, s[40:43], s82 offen lds
    s_add_u32 s96, s84, 15
    s_and_b32 s97, s96, 15
    s_mul_i32 s98, s97, 393216
    s_add_u32 s99, s98, s85
    s_add_u32 s82, s99, 4096
    s_add_u32 m0, s83, 73728
    s_nop 0
    buffer_load_dwordx4 v3, s[40:43], s82 offen lds
    s_add_u32 s96, s84, 12
    s_and_b32 s97, s96, 15
    s_mul_i32 s98, s97, 393216
    s_add_u32 s99, s98, s85
    s_add_u32 s82, s99, 4294770688
    s_add_u32 m0, s83, 94208
    s_nop 0
    buffer_load_dwordx4 v3, s[40:43], s82 offen lds
    s_add_u32 s96, s84, 12
    s_and_b32 s97, s96, 15
    s_mul_i32 s98, s97, 393216
    s_add_u32 s82, s98, s85
    s_add_u32 m0, s83, 98304
    s_nop 0
    buffer_load_dwordx4 v3, s[40:43], s82 offen lds
    s_waitcnt vmcnt(8)
    s_barrier
    s_add_u32 s96, s84, 13
    s_and_b32 s97, s96, 15
    s_mul_i32 s98, s97, 393216
    s_add_u32 s99, s98, s85
    s_add_u32 s82, s99, 4294770688
    s_add_u32 m0, s83, 102400
    s_nop 0
    buffer_load_dwordx4 v3, s[40:43], s82 offen lds
    s_add_u32 s96, s84, 13
    s_and_b32 s97, s96, 15
    s_mul_i32 s98, s97, 393216
    s_add_u32 s82, s98, s85
    s_add_u32 m0, s83, 106496
    s_nop 0
    buffer_load_dwordx4 v3, s[40:43], s82 offen lds
    s_add_u32 s96, s84, 14
    s_and_b32 s97, s96, 15
    s_mul_i32 s98, s97, 393216
    s_add_u32 s99, s98, s85
    s_add_u32 s82, s99, 4294770688
    s_add_u32 m0, s83, 110592
    s_nop 0
    buffer_load_dwordx4 v3, s[40:43], s82 offen lds
    s_add_u32 s96, s84, 14
    s_and_b32 s97, s96, 15
    s_mul_i32 s98, s97, 393216
    s_add_u32 s82, s98, s85
    s_add_u32 m0, s83, 114688
    s_nop 0
    buffer_load_dwordx4 v3, s[40:43], s82 offen lds
    s_add_u32 s96, s84, 15
    s_and_b32 s97, s96, 15
    s_mul_i32 s98, s97, 393216
    s_add_u32 s99, s98, s85
    s_add_u32 s82, s99, 4294770688
    s_add_u32 m0, s83, 118784
    s_nop 0
    buffer_load_dwordx4 v3, s[40:43], s82 offen lds
    s_add_u32 s96, s84, 15
    s_and_b32 s97, s96, 15
    s_mul_i32 s98, s97, 393216
    s_add_u32 s82, s98, s85
    s_add_u32 m0, s83, 122880
    s_nop 0
    buffer_load_dwordx4 v3, s[40:43], s82 offen lds
    s_waitcnt lgkmcnt(0)
    s_barrier
    s_setprio 3
    ds_read_b128 v[152:155], v0
    ds_read_b128 v[156:159], v0 offset:1024
    v_subrev_u32 v0, 118784, v0
    s_waitcnt lgkmcnt(1)
    v_mfma_f32_32x32x16_bf16 v[184:199], v[168:171], v[152:155], 0
    s_waitcnt lgkmcnt(0)
    v_mfma_f32_32x32x16_bf16 v[184:199], v[172:175], v[156:159], v[184:199]
    s_setprio 0
    s_nop 10
    v_cvt_pk_bf16_f32 v184, 0, v184
    v_cvt_pk_bf16_f32 v185, 0, v185
    v_cvt_pk_bf16_f32 v186, 0, v186
    s_mov_b32 s82, s19
    buffer_load_dwordx4 v[88:91], v248, s[48:51], s82 offen nt
    v_cvt_pk_bf16_f32 v187, 0, v187
    v_cvt_pk_bf16_f32 v188, 0, v188
    v_cvt_pk_bf16_f32 v189, 0, v189
    v_cvt_pk_bf16_f32 v190, 0, v190
    v_cvt_pk_bf16_f32 v191, 0, v191
    v_cvt_pk_bf16_f32 v192, 0, v192
    v_cvt_pk_bf16_f32 v193, 0, v193
    v_cvt_pk_bf16_f32 v194, 0, v194
    v_cvt_pk_bf16_f32 v195, 0, v195
    v_cvt_pk_bf16_f32 v196, 0, v196
    s_add_u32 s82, s19, 98304
    buffer_load_dwordx4 v[92:95], v248, s[48:51], s82 offen nt
    v_cvt_pk_bf16_f32 v197, 0, v197
    v_cvt_pk_bf16_f32 v198, 0, v198
    v_cvt_pk_bf16_f32 v199, 0, v199
    v_max3_f32 v4, v184, v185, v186
    v_min3_f32 v5, v184, v185, v186
    v_max3_f32 v4, v4, v187, v188
    v_min3_f32 v5, v5, v187, v188
    v_max3_f32 v4, v4, v189, v190
    v_min3_f32 v5, v5, v189, v190
    v_max3_f32 v4, v4, v191, v192
    s_add_u32 s82, s19, 196608
    buffer_load_dwordx4 v[96:99], v248, s[48:51], s82 offen nt
    v_min3_f32 v5, v5, v191, v192
    v_max3_f32 v4, v4, v193, v194
    v_min3_f32 v5, v5, v193, v194
    v_max3_f32 v4, v4, v195, v196
    v_min3_f32 v5, v5, v195, v196
    v_max3_f32 v4, v4, v197, v198
    v_min3_f32 v5, v5, v197, v198
    v_max_f32 v6, v4, v199
    v_min_f32 v7, v5, v199
    v_max_f32 v4, v4, v199
    s_add_u32 s82, s19, 294912
    buffer_load_dwordx4 v[100:103], v248, s[48:51], s82 offen nt
    v_min_f32 v5, v5, v199
    v_permlane32_swap_b32 v4, v6
    s_nop 0
    v_permlane32_swap_b32 v5, v7
    v_max_f32 v4, v4, v6
    v_min_f32 v5, v5, v7
    v_mul_f32_e64 v4, v4, s7
    v_mul_f32_e64 v5, v5, s7
    v_fma_f32 v216, v184, s7, -v4
    v_fma_f32 v217, v185, s7, -v4
    v_fma_f32 v184, -v184, s7, v5
    s_add_u32 s82, s19, 393216
    buffer_load_dwordx4 v[104:107], v248, s[48:51], s82 offen nt
    v_fma_f32 v185, -v185, s7, v5
    v_fma_f32 v218, v186, s7, -v4
    v_fma_f32 v219, v187, s7, -v4
    v_fma_f32 v186, -v186, s7, v5
    v_fma_f32 v187, -v187, s7, v5
    s_waitcnt vmcnt(15)
    s_waitcnt vmcnt(13)
    s_barrier
    s_setprio 3
    ds_read_b128 v[152:155], v0
    ds_read_b128 v[156:159], v0 offset:1024
    s_waitcnt lgkmcnt(1)
    v_mfma_f32_32x32x16_bf16 v[200:215], v[176:179], v[152:155], 0
    s_waitcnt lgkmcnt(0)
    v_mfma_f32_32x32x16_bf16 v[200:215], v[180:183], v[156:159], v[200:215]
    s_setprio 0
    v_fma_f32 v220, v188, s7, -v4
    v_fma_f32 v221, v189, s7, -v4
    v_fma_f32 v188, -v188, s7, v5
    v_fma_f32 v189, -v189, s7, v5
    v_fma_f32 v222, v190, s7, -v4
    s_add_u32 s82, s19, 491520
    buffer_load_dwordx4 v[108:111], v248, s[48:51], s82 offen nt
    v_fma_f32 v223, v191, s7, -v4
    s_mov_b32 s82, s80
    buffer_load_dwordx4 v[56:59], v27, s[52:55], s82 offen nt
    v_fma_f32 v190, -v190, s7, v5
    v_fma_f32 v191, -v191, s7, v5
    v_fma_f32 v224, v192, s7, -v4
    v_fma_f32 v225, v193, s7, -v4
    v_fma_f32 v192, -v192, s7, v5
    v_fma_f32 v193, -v193, s7, v5
    v_fma_f32 v226, v194, s7, -v4
    v_fma_f32 v227, v195, s7, -v4
    v_fma_f32 v194, -v194, s7, v5
    s_add_u32 s82, s19, 589824
    buffer_load_dwordx4 v[112:115], v248, s[48:51], s82 offen nt
    v_fma_f32 v195, -v195, s7, v5
    v_fma_f32 v228, v196, s7, -v4
    v_fma_f32 v229, v197, s7, -v4
    v_fma_f32 v196, -v196, s7, v5
    v_fma_f32 v197, -v197, s7, v5
    v_fma_f32 v230, v198, s7, -v4
    v_fma_f32 v231, v199, s7, -v4
    v_fma_f32 v198, -v198, s7, v5
    v_fma_f32 v199, -v199, s7, v5
    v_exp_f32 v216, v216
    s_add_u32 s82, s19, 688128
    buffer_load_dwordx4 v[116:119], v248, s[48:51], s82 offen nt
    v_exp_f32 v184, v184
    s_add_u32 s82, s80, 4294049792
    buffer_load_dwordx4 v[60:63], v27, s[52:55], s82 offen nt
    v_exp_f32 v217, v217
    v_exp_f32 v185, v185
    v_exp_f32 v218, v218
    v_exp_f32 v186, v186
    v_exp_f32 v219, v219
    v_exp_f32 v187, v187
    v_exp_f32 v220, v220
    v_exp_f32 v188, v188
    v_exp_f32 v221, v221
    v_exp_f32 v189, v189
    v_exp_f32 v222, v222
    v_exp_f32 v190, v190
    v_exp_f32 v223, v223
    v_exp_f32 v191, v191
    v_exp_f32 v224, v224
    v_exp_f32 v192, v192
    v_exp_f32 v225, v225
    v_exp_f32 v193, v193
    v_exp_f32 v226, v226
    s_add_u32 s82, s80, 57344
    buffer_load_dwordx4 v[64:67], v27, s[52:55], s82 offen nt
    v_exp_f32 v194, v194
    v_exp_f32 v227, v227
    v_exp_f32 v195, v195
    v_exp_f32 v228, v228
    v_exp_f32 v196, v196
    v_exp_f32 v229, v229
    v_exp_f32 v197, v197
    v_exp_f32 v230, v230
    v_exp_f32 v198, v198
    v_exp_f32 v231, v231
    v_exp_f32 v199, v199
    v_add_f32 v8, v216, v218
    v_add_f32 v9, v217, v219
    v_add_f32 v10, v184, v186
    v_add_f32 v11, v185, v187
    v_add_f32 v8, v8, v220
    v_add_f32 v9, v9, v221
    v_add_f32 v10, v10, v188
    v_add_f32 v11, v11, v189
    v_add_f32 v8, v8, v222
    s_add_u32 s82, s80, 4294107136
    buffer_load_dwordx4 v[68:71], v27, s[52:55], s82 offen nt
    v_add_f32 v9, v9, v223
    v_add_f32 v10, v10, v190
    v_add_f32 v11, v11, v191
    v_add_f32 v8, v8, v224
    v_add_f32 v9, v9, v225
    v_add_f32 v10, v10, v192
    v_add_f32 v11, v11, v193
    v_add_f32 v8, v8, v226
    v_add_f32 v9, v9, v227
    v_add_f32 v10, v10, v194
    v_add_f32 v11, v11, v195
    v_add_f32 v8, v8, v228
    v_add_f32 v9, v9, v229
    v_add_f32 v10, v10, v196
    v_add_f32 v11, v11, v197
    v_add_f32 v8, v8, v230
    v_add_f32 v9, v9, v231
    v_add_f32 v10, v10, v198
    v_add_f32 v11, v11, v199
    v_add_f32 v6, v8, v9
    v_add_f32 v7, v10, v11
    v_add_f32 v4, v8, v9
    v_add_f32 v5, v10, v11
    s_nop 0
    v_permlane32_swap_b32 v4, v6
    v_permlane32_swap_b32 v5, v7
    v_add_f32 v4, v4, v6
    v_add_f32 v5, v5, v7
    v_rcp_f32 v4, v4
    v_rcp_f32 v5, v5
    v_mul_f32 v216, v216, v4
    v_mul_f32 v217, v217, v4
    v_mul_f32 v184, v184, v5
    v_mul_f32 v185, v185, v5
    v_mul_f32 v218, v218, v4
    v_mul_f32 v219, v219, v4
    v_mul_f32 v186, v186, v5
    v_mul_f32 v187, v187, v5
    v_mul_f32 v220, v220, v4
    v_mul_f32 v221, v221, v4
    v_mul_f32 v188, v188, v5
    v_mul_f32 v189, v189, v5
    v_mul_f32 v222, v222, v4
    v_mul_f32 v223, v223, v4
    v_mul_f32 v190, v190, v5
    v_mul_f32 v191, v191, v5
    v_mul_f32 v224, v224, v4
    v_mul_f32 v225, v225, v4
    v_mul_f32 v192, v192, v5
    v_mul_f32 v193, v193, v5
    v_mul_f32 v226, v226, v4
    v_mul_f32 v227, v227, v4
    v_mul_f32 v194, v194, v5
    v_mul_f32 v195, v195, v5
    v_mul_f32 v228, v228, v4
    v_mul_f32 v229, v229, v4
    v_mul_f32 v196, v196, v5
    v_mul_f32 v197, v197, v5
    v_mul_f32 v230, v230, v4
    v_mul_f32 v231, v231, v4
    v_mul_f32 v198, v198, v5
    v_mul_f32 v199, v199, v5
    v_cvt_pk_bf16_f32 v216, v216, v217
    v_cvt_pk_bf16_f32 v217, v218, v219
    v_cvt_pk_bf16_f32 v218, v220, v221
    v_cvt_pk_bf16_f32 v219, v222, v223
    v_cvt_pk_bf16_f32 v220, v224, v225
    v_cvt_pk_bf16_f32 v221, v226, v227
    v_cvt_pk_bf16_f32 v222, v228, v229
    v_cvt_pk_bf16_f32 v223, v230, v231
    ds_write_b128 v232, v[216:219]
    v_cvt_pk_bf16_f32 v224, v184, v185
    v_cvt_pk_bf16_f32 v225, v186, v187
    v_cvt_pk_bf16_f32 v226, v188, v189
    v_cvt_pk_bf16_f32 v227, v190, v191
    ds_write_b128 v232, v[220:223] offset:4096
    ds_write_b128 v232, v[224:227] offset:8192
    v_cvt_pk_bf16_f32 v228, v192, v193
    v_cvt_pk_bf16_f32 v229, v194, v195
    v_cvt_pk_bf16_f32 v230, v196, v197
    v_cvt_pk_bf16_f32 v231, v198, v199
    ds_write_b128 v232, v[228:231] offset:12288
    s_waitcnt vmcnt(18)
    s_waitcnt vmcnt(16)
    s_waitcnt vmcnt(14)
    s_waitcnt vmcnt(12)
    s_barrier
    v_cvt_pk_bf16_f32 v200, 0, v200
    v_cvt_pk_bf16_f32 v201, 0, v201
    v_cvt_pk_bf16_f32 v202, 0, v202
    v_cvt_pk_bf16_f32 v203, 0, v203
    s_xor_b32 s96, s95, 786432
    s_add_u32 s97, s96, s90
    s_sub_u32 s82, s97, 65536
    s_add_u32 m0, s83, 45056
    s_nop 0
    buffer_load_dwordx4 v26, s[44:47], s82 offen lds
    v_cvt_pk_bf16_f32 v204, 0, v204
    v_cvt_pk_bf16_f32 v205, 0, v205
    v_cvt_pk_bf16_f32 v206, 0, v206
    v_cvt_pk_bf16_f32 v207, 0, v207
    v_cvt_pk_bf16_f32 v208, 0, v208
    v_cvt_pk_bf16_f32 v209, 0, v209
    v_cvt_pk_bf16_f32 v210, 0, v210
    v_cvt_pk_bf16_f32 v211, 0, v211
    v_cvt_pk_bf16_f32 v212, 0, v212
    v_cvt_pk_bf16_f32 v213, 0, v213
    v_cvt_pk_bf16_f32 v214, 0, v214
    v_cvt_pk_bf16_f32 v215, 0, v215
    v_max3_f32 v4, v200, v201, v202
    v_min3_f32 v5, v200, v201, v202
    s_xor_b32 s96, s95, 786432
    s_add_u32 s82, s96, s90
    s_add_u32 m0, s83, 49152
    s_nop 0
    buffer_load_dwordx4 v26, s[44:47], s82 offen lds
    v_max3_f32 v4, v4, v203, v204
    v_min3_f32 v5, v5, v203, v204
    v_max3_f32 v4, v4, v205, v206
    v_min3_f32 v5, v5, v205, v206
    v_max3_f32 v4, v4, v207, v208
    v_min3_f32 v5, v5, v207, v208
    v_max3_f32 v4, v4, v209, v210
    v_min3_f32 v5, v5, v209, v210
    v_max3_f32 v4, v4, v211, v212
    v_min3_f32 v5, v5, v211, v212
    v_max3_f32 v4, v4, v213, v214
    v_min3_f32 v5, v5, v213, v214
    v_max_f32 v6, v4, v215
    v_min_f32 v7, v5, v215
    s_xor_b32 s96, s95, 917504
    s_add_u32 s97, s96, s90
    s_sub_u32 s82, s97, 65536
    s_add_u32 m0, s83, 53248
    s_nop 0
    buffer_load_dwordx4 v26, s[44:47], s82 offen lds
    v_max_f32 v4, v4, v215
    s_waitcnt lgkmcnt(0)
    v_min_f32 v5, v5, v215
    v_permlane32_swap_b32 v4, v6
    s_nop 0
    v_permlane32_swap_b32 v5, v7
    v_max_f32 v4, v4, v6
    v_min_f32 v5, v5, v7
    v_mul_f32_e64 v4, v4, s7
    v_mul_f32_e64 v5, v5, s7
    v_fma_f32 v216, v200, s7, -v4
    v_fma_f32 v217, v201, s7, -v4
    v_fma_f32 v200, -v200, s7, v5
    v_fma_f32 v201, -v201, s7, v5
    v_fma_f32 v218, v202, s7, -v4
    s_xor_b32 s96, s95, 917504
    s_add_u32 s82, s96, s90
    s_add_u32 m0, s83, 57344
    s_nop 0
    buffer_load_dwordx4 v26, s[44:47], s82 offen lds
    v_fma_f32 v219, v203, s7, -v4
    v_fma_f32 v202, -v202, s7, v5
    v_fma_f32 v203, -v203, s7, v5
    v_fma_f32 v220, v204, s7, -v4
    v_fma_f32 v221, v205, s7, -v4
    v_fma_f32 v204, -v204, s7, v5
    v_fma_f32 v205, -v205, s7, v5
    v_fma_f32 v222, v206, s7, -v4
    v_fma_f32 v223, v207, s7, -v4
    v_fma_f32 v206, -v206, s7, v5
    v_fma_f32 v207, -v207, s7, v5
    v_fma_f32 v224, v208, s7, -v4
    v_fma_f32 v225, v209, s7, -v4
    v_fma_f32 v208, -v208, s7, v5
    s_xor_b32 s96, s95, 1048576
    s_add_u32 s97, s96, s90
    s_sub_u32 s82, s97, 65536
    s_add_u32 m0, s83, 61440
    s_nop 0
    buffer_load_dwordx4 v26, s[44:47], s82 offen lds
    v_fma_f32 v209, -v209, s7, v5
    v_fma_f32 v226, v210, s7, -v4
    v_fma_f32 v227, v211, s7, -v4
    v_fma_f32 v210, -v210, s7, v5
    v_fma_f32 v211, -v211, s7, v5
    v_fma_f32 v228, v212, s7, -v4
    v_fma_f32 v229, v213, s7, -v4
    v_fma_f32 v212, -v212, s7, v5
    v_fma_f32 v213, -v213, s7, v5
    v_fma_f32 v230, v214, s7, -v4
    v_fma_f32 v231, v215, s7, -v4
    v_fma_f32 v214, -v214, s7, v5
    v_fma_f32 v215, -v215, s7, v5
    v_exp_f32 v216, v216
    s_xor_b32 s96, s95, 1048576
    s_add_u32 s82, s96, s90
    s_add_u32 m0, s83, 65536
    s_nop 0
    buffer_load_dwordx4 v26, s[44:47], s82 offen lds
    v_exp_f32 v200, v200
    v_exp_f32 v217, v217
    v_exp_f32 v201, v201
    v_exp_f32 v218, v218
    v_exp_f32 v202, v202
    v_exp_f32 v219, v219
    v_exp_f32 v203, v203
    v_exp_f32 v220, v220
    v_exp_f32 v204, v204
    v_exp_f32 v221, v221
    v_exp_f32 v205, v205
    v_exp_f32 v222, v222
    v_exp_f32 v206, v206
    v_exp_f32 v223, v223
    s_xor_b32 s96, s95, 1179648
    s_add_u32 s97, s96, s90
    s_sub_u32 s82, s97, 65536
    s_add_u32 m0, s83, 69632
    s_nop 0
    buffer_load_dwordx4 v26, s[44:47], s82 offen lds
    v_exp_f32 v207, v207
    v_exp_f32 v224, v224
    v_exp_f32 v208, v208
    v_exp_f32 v225, v225
    v_exp_f32 v209, v209
    v_exp_f32 v226, v226
    v_exp_f32 v210, v210
    v_exp_f32 v227, v227
    v_exp_f32 v211, v211
    v_exp_f32 v228, v228
    v_exp_f32 v212, v212
    v_exp_f32 v229, v229
    v_exp_f32 v213, v213
    v_exp_f32 v230, v230
    s_xor_b32 s96, s95, 1179648
    s_add_u32 s82, s96, s90
    s_add_u32 m0, s83, 73728
    s_nop 0
    buffer_load_dwordx4 v26, s[44:47], s82 offen lds
    v_exp_f32 v214, v214
    v_exp_f32 v231, v231
    v_exp_f32 v215, v215
    v_add_f32 v8, v216, v218
    v_add_f32 v9, v217, v219
    v_add_f32 v10, v200, v202
    v_add_f32 v11, v201, v203
    v_add_f32 v8, v8, v220
    v_add_f32 v9, v9, v221
    v_add_f32 v10, v10, v204
    v_add_f32 v11, v11, v205
    v_add_f32 v8, v8, v222
    v_add_f32 v9, v9, v223
    v_add_f32 v10, v10, v206
    s_xor_b32 s96, s95, 1310720
    s_add_u32 s97, s96, s90
    s_sub_u32 s82, s97, 65536
    s_add_u32 m0, s83, 77824
    s_nop 0
    buffer_load_dwordx4 v26, s[44:47], s82 offen lds
L_PAD6:
    s_cbranch_execz L_RET6
    v_add_f32 v11, v11, v207
    v_add_f32 v8, v8, v224
    v_add_f32 v9, v9, v225
    v_add_f32 v10, v10, v208
    v_add_f32 v11, v11, v209
    v_add_f32 v8, v8, v226
    v_add_f32 v9, v9, v227
    v_add_f32 v10, v10, v210
    v_add_f32 v11, v11, v211
    v_add_f32 v8, v8, v228
    v_add_f32 v9, v9, v229
    v_add_f32 v10, v10, v212
    v_add_f32 v11, v11, v213
    v_add_f32 v8, v8, v230
    s_xor_b32 s96, s95, 1310720
    s_add_u32 s82, s96, s90
    s_add_u32 m0, s83, 81920
    s_nop 0
    buffer_load_dwordx4 v26, s[44:47], s82 offen lds
    v_add_f32 v9, v9, v231
    v_add_f32 v10, v10, v214
    v_add_f32 v11, v11, v215
    v_add_f32 v6, v8, v9
    v_add_f32 v7, v10, v11
    v_add_f32 v4, v8, v9
    v_add_f32 v5, v10, v11
    s_nop 0
    v_permlane32_swap_b32 v4, v6
    v_permlane32_swap_b32 v5, v7
    v_add_f32 v4, v4, v6
    v_add_f32 v5, v5, v7
    v_rcp_f32 v4, v4
    v_rcp_f32 v5, v5
    v_mul_f32 v216, v216, v4
    s_xor_b32 s96, s95, 1441792
    s_add_u32 s97, s96, s90
    s_sub_u32 s82, s97, 65536
    s_add_u32 m0, s83, 86016
    s_nop 0
    buffer_load_dwordx4 v26, s[44:47], s82 offen lds
    v_mul_f32 v217, v217, v4
    v_mul_f32 v200, v200, v5
    v_mul_f32 v201, v201, v5
    v_mul_f32 v218, v218, v4
    v_mul_f32 v219, v219, v4
    v_mul_f32 v202, v202, v5
    v_mul_f32 v203, v203, v5
    v_mul_f32 v220, v220, v4
    v_mul_f32 v221, v221, v4
    v_mul_f32 v204, v204, v5
    v_mul_f32 v205, v205, v5
    v_mul_f32 v222, v222, v4
    v_mul_f32 v223, v223, v4
    v_mul_f32 v206, v206, v5
    s_xor_b32 s96, s95, 1441792
    s_add_u32 s82, s96, s90
    s_add_u32 m0, s83, 90112
    s_nop 0
    buffer_load_dwordx4 v26, s[44:47], s82 offen lds
    v_mul_f32 v207, v207, v5
    v_mul_f32 v224, v224, v4
    v_mul_f32 v225, v225, v4
    v_mul_f32 v208, v208, v5
    v_mul_f32 v209, v209, v5
    v_mul_f32 v226, v226, v4
    v_mul_f32 v227, v227, v4
    v_mul_f32 v210, v210, v5
    v_mul_f32 v211, v211, v5
    v_mul_f32 v228, v228, v4
    v_mul_f32 v229, v229, v4
    v_mul_f32 v212, v212, v5
    v_mul_f32 v213, v213, v5
    v_mul_f32 v230, v230, v4
    v_mul_f32 v231, v231, v4
    v_mul_f32 v214, v214, v5
    v_mul_f32 v215, v215, v5
    v_cvt_pk_bf16_f32 v216, v216, v217
    v_cvt_pk_bf16_f32 v217, v218, v219
    v_cvt_pk_bf16_f32 v218, v220, v221
    v_cvt_pk_bf16_f32 v219, v222, v223
    v_cvt_pk_bf16_f32 v220, v224, v225
    v_cvt_pk_bf16_f32 v221, v226, v227
    v_cvt_pk_bf16_f32 v222, v228, v229
    v_cvt_pk_bf16_f32 v223, v230, v231
    ds_write_b128 v232, v[216:219] offset:16384
    v_cvt_pk_bf16_f32 v224, v200, v201
    v_cvt_pk_bf16_f32 v225, v202, v203
    v_cvt_pk_bf16_f32 v226, v204, v205
    v_cvt_pk_bf16_f32 v227, v206, v207
    ds_write_b128 v232, v[220:223] offset:20480
    ds_write_b128 v232, v[224:227] offset:24576
    v_cvt_pk_bf16_f32 v228, v208, v209
    v_cvt_pk_bf16_f32 v229, v210, v211
    v_cvt_pk_bf16_f32 v230, v212, v213
    v_cvt_pk_bf16_f32 v231, v214, v215
    ds_write_b128 v232, v[228:231] offset:28672
    s_lshl_b32 s96, s77, 11
    s_add_u32 s14, s96, 151552
    v_add_u32 v0, s14, v2
    s_setprio 0
L_JOIN:
    v_and_b32 v45, 1, v1
    v_lshlrev_b32 v45, 3, v45
    v_bfe_u32 v9, v1, 2, 2
    v_lshl_add_u32 v45, v9, 4, v45
    v_bfe_u32 v9, v1, 4, 1
    v_lshl_add_u32 v45, v9, 6, v45
    v_bfe_u32 v9, v1, 1, 1
    v_lshl_add_u32 v45, v9, 7, v45
    v_lshrrev_b32 v9, 5, v1
    v_lshl_add_u32 v45, v9, 8, v45
    s_lshl_b32 s13, s3, 12
    v_add_u32 v44, s13, v45
    s_lshl_b32 s96, s76, 13
    s_add_u32 s13, s96, 32768
    v_add_u32 v45, s13, v45
    v_mov_b32 v244, 0x3f803f80
    v_mov_b32 v245, 0x3f803f80
    v_mov_b32 v246, 0x3f803f80
    v_mov_b32 v247, 0x3f803f80
    s_lshl3_add_u32 s96, s11, s3
    s_lshl_b32 s97, s96, 5
    s_add_u32 s98, s97, s10
    s_lshl_b32 s99, s98, 10
    s_add_u32 s13, s99, 25165824
    s_add_u32 s15, s13, 16384
    s_lshl3_add_u32 s96, s11, s3
    s_lshl_b32 s97, s96, 10
    s_add_u32 s16, s97, 21495808
    s_lshl_b32 s96, s10, 6
    s_add_u32 s14, s96, s16
    s_waitcnt lgkmcnt(0)
    s_barrier
    ds_read_b64_tr_b16 v[184:185], v44
    ds_read_b64_tr_b16 v[186:187], v44 offset:512
    ds_read_b64_tr_b16 v[200:201], v45
    ds_read_b64_tr_b16 v[202:203], v45 offset:512
    ds_read_b64_tr_b16 v[204:205], v45 offset:1024
    ds_read_b64_tr_b16 v[206:207], v45 offset:1536
    ds_read_b64_tr_b16 v[188:189], v44 offset:1024
    ds_read_b64_tr_b16 v[190:191], v44 offset:1536
    ds_read_b64_tr_b16 v[208:209], v45 offset:2048
    ds_read_b64_tr_b16 v[210:211], v45 offset:2560
    ds_read_b64_tr_b16 v[212:213], v45 offset:3072
    ds_read_b64_tr_b16 v[214:215], v45 offset:3584
    ds_read_b64_tr_b16 v[192:193], v44 offset:2048
    ds_read_b64_tr_b16 v[194:195], v44 offset:2560
    ds_read_b64_tr_b16 v[216:217], v45 offset:4096
    ds_read_b64_tr_b16 v[218:219], v45 offset:4608
    ds_read_b64_tr_b16 v[220:221], v45 offset:5120
    ds_read_b64_tr_b16 v[222:223], v45 offset:5632
    s_waitcnt lgkmcnt(12)
    v_mfma_f32_16x16x32_bf16 v[232:235], v[184:187], v[200:203], 0
    v_mfma_f32_16x16x32_bf16 v[236:239], v[184:187], v[204:207], 0
    v_mfma_f32_16x16x32_bf16 v[240:243], v[184:187], v[244:247], 0
    ds_read_b64_tr_b16 v[196:197], v44 offset:3072
    ds_read_b64_tr_b16 v[198:199], v44 offset:3584
    ds_read_b64_tr_b16 v[224:225], v45 offset:6144
    ds_read_b64_tr_b16 v[226:227], v45 offset:6656
    ds_read_b64_tr_b16 v[228:229], v45 offset:7168
    ds_read_b64_tr_b16 v[230:231], v45 offset:7680
    s_waitcnt lgkmcnt(12)
    v_mfma_f32_16x16x32_bf16 v[232:235], v[188:191], v[208:211], v[232:235]
    v_mfma_f32_16x16x32_bf16 v[236:239], v[188:191], v[212:215], v[236:239]
    v_mfma_f32_16x16x32_bf16 v[240:243], v[188:191], v[244:247], v[240:243]
    s_waitcnt lgkmcnt(6)
    v_mfma_f32_16x16x32_bf16 v[232:235], v[192:195], v[216:219], v[232:235]
    v_mfma_f32_16x16x32_bf16 v[236:239], v[192:195], v[220:223], v[236:239]
    v_mfma_f32_16x16x32_bf16 v[240:243], v[192:195], v[244:247], v[240:243]
    s_waitcnt lgkmcnt(0)
    v_mfma_f32_16x16x32_bf16 v[232:235], v[196:199], v[224:227], v[232:235]
    v_mfma_f32_16x16x32_bf16 v[236:239], v[196:199], v[228:231], v[236:239]
    v_mfma_f32_16x16x32_bf16 v[240:243], v[196:199], v[244:247], v[240:243]
    s_cmp_lt_u32 s3, 4
    s_cbranch_scc1 L_NOQX
    ds_read_b128 v[168:171], v0
    ds_read_b128 v[172:175], v0 offset:1024
L_NOQX:
    s_nop 3
    buffer_store_dwordx4 v[232:235], v2, s[32:35], s13 offen sc1
    buffer_store_dwordx4 v[236:239], v2, s[32:35], s15 offen sc1
    s_mov_b32 exec_lo, 0x00010001
    s_mov_b32 exec_hi, 0x00010001
    buffer_store_dwordx4 v[240:243], v1, s[32:35], s14 offen sc1
    s_mov_b64 exec, -1
    s_waitcnt lgkmcnt(0)
    v_mfma_f32_32x32x16_bf16 v[120:135], v[176:179], v[168:171], 0
    v_mfma_f32_32x32x16_bf16 v[120:135], v[180:183], v[172:175], v[120:135]
    v_and_b32 v46, 7, v1
    v_lshlrev_b32 v46, 17, v46
    v_bfe_u32 v9, v1, 3, 1
    v_lshl_add_u32 v46, v9, 14, v46
    s_and_b32 s96, s10, 1
    s_and_b32 s97, s2, 27
    s_lshl_b32 s98, s97, 12
    s_lshr_b32 s99, s10, 1
    s_lshl_b32 s97, s99, 6
    s_add_u32 s99, s98, s97
    s_lshl2_add_u32 s98, s96, s99
    s_add_u32 s97, s98, 1048576
    s_add_u32 s17, s97, 512
    v_lshrrev_b32 v47, 3, v1
    v_lshlrev_b32 v47, 10, v47
    v_and_b32 v9, 7, v1
    v_lshl_add_u32 v47, v9, 4, v47
    v_and_b32 v48, 7, v1
    v_lshlrev_b32 v48, 4, v48
    v_lshrrev_b32 v9, 5, v1
    v_lshl_add_u32 v48, v9, 3, v48
    v_cvt_pk_bf16_f32 v120, 0, v120
    v_cvt_pk_bf16_f32 v121, 0, v121
    v_cvt_pk_bf16_f32 v122, 0, v122
    v_cvt_pk_bf16_f32 v123, 0, v123
    v_cvt_pk_bf16_f32 v124, 0, v124
    v_cvt_pk_bf16_f32 v125, 0, v125
    v_cvt_pk_bf16_f32 v126, 0, v126
    v_cvt_pk_bf16_f32 v127, 0, v127
    v_cvt_pk_bf16_f32 v128, 0, v128
    v_cvt_pk_bf16_f32 v129, 0, v129
    v_cvt_pk_bf16_f32 v130, 0, v130
    v_cvt_pk_bf16_f32 v131, 0, v131
    v_cvt_pk_bf16_f32 v132, 0, v132
    v_cvt_pk_bf16_f32 v133, 0, v133
    v_cvt_pk_bf16_f32 v134, 0, v134
    v_cvt_pk_bf16_f32 v135, 0, v135
    v_max3_f32 v4, v120, v121, v122
    v_min3_f32 v5, v120, v121, v122
    v_max3_f32 v4, v4, v123, v124
    v_min3_f32 v5, v5, v123, v124
    v_max3_f32 v4, v4, v125, v126
    v_min3_f32 v5, v5, v125, v126
    v_max3_f32 v4, v4, v127, v128
    v_min3_f32 v5, v5, v127, v128
    v_max3_f32 v4, v4, v129, v130
    v_min3_f32 v5, v5, v129, v130
    v_max3_f32 v4, v4, v131, v132
    v_min3_f32 v5, v5, v131, v132
    v_max3_f32 v4, v4, v133, v134
    v_min3_f32 v5, v5, v133, v134
    v_max_f32 v6, v4, v135
    v_min_f32 v7, v5, v135
    v_max_f32 v4, v4, v135
    v_min_f32 v5, v5, v135
    s_nop 0
    v_permlane32_swap_b32 v4, v6
    v_permlane32_swap_b32 v5, v7
    v_max_f32 v4, v4, v6
    v_min_f32 v5, v5, v7
    v_pk_mul_f32 v[4:5], v[4:5], s[6:7] op_sel:[0,1]
    v_mov_b32 v6, v5
    v_pk_fma_f32 v[136:137], v[120:121], s[6:7], v[4:5] op_sel:[0,1,0] op_sel_hi:[1,1,0] neg_lo:[0,0,1] neg_hi:[0,0,1]
    v_pk_fma_f32 v[120:121], v[120:121], s[6:7], v[6:7] op_sel:[0,1,0] op_sel_hi:[1,1,0] neg_lo:[1,0,0] neg_hi:[1,0,0]
    v_pk_fma_f32 v[138:139], v[122:123], s[6:7], v[4:5] op_sel:[0,1,0] op_sel_hi:[1,1,0] neg_lo:[0,0,1] neg_hi:[0,0,1]
    v_pk_fma_f32 v[122:123], v[122:123], s[6:7], v[6:7] op_sel:[0,1,0] op_sel_hi:[1,1,0] neg_lo:[1,0,0] neg_hi:[1,0,0]
    v_pk_fma_f32 v[140:141], v[124:125], s[6:7], v[4:5] op_sel:[0,1,0] op_sel_hi:[1,1,0] neg_lo:[0,0,1] neg_hi:[0,0,1]
    v_pk_fma_f32 v[124:125], v[124:125], s[6:7], v[6:7] op_sel:[0,1,0] op_sel_hi:[1,1,0] neg_lo:[1,0,0] neg_hi:[1,0,0]
    v_pk_fma_f32 v[142:143], v[126:127], s[6:7], v[4:5] op_sel:[0,1,0] op_sel_hi:[1,1,0] neg_lo:[0,0,1] neg_hi:[0,0,1]
    v_pk_fma_f32 v[126:127], v[126:127], s[6:7], v[6:7] op_sel:[0,1,0] op_sel_hi:[1,1,0] neg_lo:[1,0,0] neg_hi:[1,0,0]
    v_pk_fma_f32 v[144:145], v[128:129], s[6:7], v[4:5] op_sel:[0,1,0] op_sel_hi:[1,1,0] neg_lo:[0,0,1] neg_hi:[0,0,1]
    v_pk_fma_f32 v[128:129], v[128:129], s[6:7], v[6:7] op_sel:[0,1,0] op_sel_hi:[1,1,0] neg_lo:[1,0,0] neg_hi:[1,0,0]
    v_pk_fma_f32 v[146:147], v[130:131], s[6:7], v[4:5] op_sel:[0,1,0] op_sel_hi:[1,1,0] neg_lo:[0,0,1] neg_hi:[0,0,1]
    v_pk_fma_f32 v[130:131], v[130:131], s[6:7], v[6:7] op_sel:[0,1,0] op_sel_hi:[1,1,0] neg_lo:[1,0,0] neg_hi:[1,0,0]
    v_pk_fma_f32 v[148:149], v[132:133], s[6:7], v[4:5] op_sel:[0,1,0] op_sel_hi:[1,1,0] neg_lo:[0,0,1] neg_hi:[0,0,1]
    v_pk_fma_f32 v[132:133], v[132:133], s[6:7], v[6:7] op_sel:[0,1,0] op_sel_hi:[1,1,0] neg_lo:[1,0,0] neg_hi:[1,0,0]
    v_pk_fma_f32 v[150:151], v[134:135], s[6:7], v[4:5] op_sel:[0,1,0] op_sel_hi:[1,1,0] neg_lo:[0,0,1] neg_hi:[0,0,1]
    v_pk_fma_f32 v[134:135], v[134:135], s[6:7], v[6:7] op_sel:[0,1,0] op_sel_hi:[1,1,0] neg_lo:[1,0,0] neg_hi:[1,0,0]
    v_exp_f32 v136, v136
    v_exp_f32 v120, v120
    v_exp_f32 v137, v137
    v_exp_f32 v121, v121
    v_exp_f32 v138, v138
    v_exp_f32 v122, v122
    v_exp_f32 v139, v139
    v_exp_f32 v123, v123
    v_exp_f32 v140, v140
    v_exp_f32 v124, v124
    v_exp_f32 v141, v141
    v_exp_f32 v125, v125
    v_exp_f32 v142, v142
    v_exp_f32 v126, v126
    v_exp_f32 v143, v143
    v_exp_f32 v127, v127
    s_waitcnt vmcnt(0)
    s_barrier
    s_cmp_lg_u32 s3, 0
    s_cbranch_scc1 L_PC
    v_mov_b32 v45, s4
    s_mov_b32 exec_hi, 0
    s_mov_b32 exec_lo, 65535
    buffer_store_dword v45, v46, s[32:35], s17 offen sc1
    s_mov_b64 exec, -1
L_PC:
    s_xor_b32 s96, s95, 1572864
    s_add_u32 s82, s96, s90
    s_add_u32 m0, s83, 98304
    s_nop 0
    buffer_load_dwordx4 v26, s[44:47], s82 offen lds
    v_exp_f32 v144, v144
    v_exp_f32 v128, v128
    v_exp_f32 v145, v145
    v_exp_f32 v129, v129
    v_exp_f32 v146, v146
    v_exp_f32 v130, v130
    v_exp_f32 v147, v147
    v_exp_f32 v131, v131
    s_xor_b32 s96, s95, 1703936
    s_add_u32 s82, s96, s90
    s_add_u32 m0, s83, 106496
    s_nop 0
    buffer_load_dwordx4 v26, s[44:47], s82 offen lds
    v_exp_f32 v148, v148
    v_exp_f32 v132, v132
    v_exp_f32 v149, v149
    v_exp_f32 v133, v133
    v_exp_f32 v150, v150
    v_exp_f32 v134, v134
    v_exp_f32 v151, v151
    v_exp_f32 v135, v135
    s_lshl4_add_u32 s96, s11, s10
    s_lshl_b32 s97, s96, 14
    s_lshl_b32 s98, s3, 7
    s_add_u32 s99, s97, s98
    s_add_u32 s13, s99, 25165824
    s_add_u32 s14, s13, 8192
    s_lshl4_add_u32 s96, s11, s10
    s_lshl_b32 s97, s96, 10
    s_lshl_b32 s98, s3, 7
    s_add_u32 s99, s97, s98
    s_add_u32 s15, s99, 29360128
    s_add_u32 s17, s17, 3072
    s_load_dwordx2 s[24:25], s[32:33], s92 offset:512 glc
    s_xor_b32 s96, s95, 1835008
    s_add_u32 s82, s96, s90
    s_add_u32 m0, s83, 114688
    s_nop 0
    buffer_load_dwordx4 v26, s[44:47], s82 offen lds
    v_pk_add_f32 v[8:9], v[136:137], v[138:139]
    v_pk_add_f32 v[10:11], v[120:121], v[122:123]
    v_pk_add_f32 v[8:9], v[8:9], v[140:141]
    v_pk_add_f32 v[10:11], v[10:11], v[124:125]
    v_pk_add_f32 v[8:9], v[8:9], v[142:143]
    v_pk_add_f32 v[10:11], v[10:11], v[126:127]
    v_pk_add_f32 v[8:9], v[8:9], v[144:145]
    v_pk_add_f32 v[10:11], v[10:11], v[128:129]
    v_pk_add_f32 v[8:9], v[8:9], v[146:147]
    v_pk_add_f32 v[10:11], v[10:11], v[130:131]
    v_pk_add_f32 v[8:9], v[8:9], v[148:149]
    v_pk_add_f32 v[10:11], v[10:11], v[132:133]
    v_pk_add_f32 v[8:9], v[8:9], v[150:151]
    v_pk_add_f32 v[10:11], v[10:11], v[134:135]
    s_xor_b32 s96, s95, 1966080
    s_add_u32 s82, s96, s90
    s_add_u32 m0, s83, 122880
    s_nop 0
    buffer_load_dwordx4 v26, s[44:47], s82 offen lds
    v_add_f32 v6, v8, v9
    v_add_f32 v7, v10, v11
    v_add_f32 v4, v8, v9
    v_add_f32 v5, v10, v11
    s_nop 0
    v_permlane32_swap_b32 v4, v6
    v_permlane32_swap_b32 v5, v7
    v_pk_add_f32 v[4:5], v[4:5], v[6:7]
    v_rcp_f32 v4, v4
    v_rcp_f32 v5, v5
    s_nop 0
    v_pk_mul_f32 v[136:137], v[136:137], v[4:5] op_sel_hi:[1,0]
    v_pk_mul_f32 v[120:121], v[4:5], v[120:121] op_sel:[1,0]
    v_pk_mul_f32 v[138:139], v[138:139], v[4:5] op_sel_hi:[1,0]
    v_pk_mul_f32 v[122:123], v[4:5], v[122:123] op_sel:[1,0]
    v_pk_mul_f32 v[140:141], v[140:141], v[4:5] op_sel_hi:[1,0]
    s_add_u32 s82, s95, s90
    s_mov_b32 m0, s83
    s_nop 0
    buffer_load_dwordx4 v26, s[44:47], s82 offen lds
    v_pk_mul_f32 v[124:125], v[4:5], v[124:125] op_sel:[1,0]
    v_pk_mul_f32 v[142:143], v[142:143], v[4:5] op_sel_hi:[1,0]
    v_pk_mul_f32 v[126:127], v[4:5], v[126:127] op_sel:[1,0]
    v_pk_mul_f32 v[144:145], v[144:145], v[4:5] op_sel_hi:[1,0]
    v_pk_mul_f32 v[128:129], v[4:5], v[128:129] op_sel:[1,0]
    v_pk_mul_f32 v[146:147], v[146:147], v[4:5] op_sel_hi:[1,0]
    v_pk_mul_f32 v[130:131], v[4:5], v[130:131] op_sel:[1,0]
    v_pk_mul_f32 v[148:149], v[148:149], v[4:5] op_sel_hi:[1,0]
    v_pk_mul_f32 v[132:133], v[4:5], v[132:133] op_sel:[1,0]
    v_pk_mul_f32 v[150:151], v[150:151], v[4:5] op_sel_hi:[1,0]
    v_pk_mul_f32 v[134:135], v[4:5], v[134:135] op_sel:[1,0]
    v_cvt_pk_bf16_f32 v152, v136, v137
    v_cvt_pk_bf16_f32 v153, v138, v139
    v_cvt_pk_bf16_f32 v154, v140, v141
    s_xor_b32 s96, s95, 131072
    s_add_u32 s82, s96, s90
    s_add_u32 m0, s83, 8192
    s_nop 0
    buffer_load_dwordx4 v26, s[44:47], s82 offen lds
    v_cvt_pk_bf16_f32 v155, v142, v143
    v_cvt_pk_bf16_f32 v156, v144, v145
    v_cvt_pk_bf16_f32 v157, v146, v147
    v_cvt_pk_bf16_f32 v158, v148, v149
    v_cvt_pk_bf16_f32 v159, v150, v151
    v_cvt_pk_bf16_f32 v160, v120, v121
    v_cvt_pk_bf16_f32 v161, v122, v123
    v_cvt_pk_bf16_f32 v162, v124, v125
    v_cvt_pk_bf16_f32 v163, v126, v127
    v_cvt_pk_bf16_f32 v164, v128, v129
    v_cvt_pk_bf16_f32 v165, v130, v131
    v_cvt_pk_bf16_f32 v166, v132, v133
    v_cvt_pk_bf16_f32 v167, v134, v135
    s_branch SCHK_17
SPOLL_16:
    s_load_dwordx2 s[24:25], s[32:33], s92 offset:512 glc
SCHK_17:
    s_add_u32 s5, s5, 1
    s_cmp_ge_u32 s5, 200000
    s_waitcnt lgkmcnt(0)
    s_cbranch_scc1 SDONE_18
    s_cmp_lg_u32 s24, s4
    s_cbranch_scc1 SPOLL_16
    s_cmp_lg_u32 s25, s4
    s_cbranch_scc1 SPOLL_16
SDONE_18:
    s_barrier
    buffer_load_dwordx4 v[184:187], v47, s[32:35], s13 offen sc1
    buffer_load_dwordx4 v[188:191], v47, s[32:35], s14 offen sc1
    buffer_load_dwordx4 v[192:195], v2, s[32:35], s16 offen sc1
    s_lshl_b32 s96, s3, 5
    s_add_u32 s14, s96, 155648
    v_and_b32 v6, 3, v1
    v_lshl_add_u32 v6, v6, 3, s14
    v_lshrrev_b32 v9, 5, v1
    v_lshl_add_u32 v6, v9, 2, v6
    s_lshl_b32 s96, s3, 10
    s_add_u32 s14, s96, 147456
    v_and_b32 v5, 15, v1
    v_lshl_add_u32 v5, v5, 4, s14
    v_lshrrev_b32 v9, 5, v1
    v_lshl_add_u32 v5, v9, 9, v5
    v_bfe_u32 v9, v1, 4, 1
    v_lshl_add_u32 v5, v9, 3, v5
    s_lshl_b32 s96, s76, 7
    s_add_u32 s14, s96, 155648
    v_lshrrev_b32 v7, 5, v1
    v_lshl_add_u32 v7, v7, 4, s14
    s_lshl_b32 s96, s76, 12
    s_add_u32 s14, s96, 147456
    v_add_u32 v44, s14, v2
    s_cmp_lt_u32 s3, 4
    s_cbranch_scc1 L_HG1
    v_lshlrev_b32 v52, 16, v88
    v_and_b32 v53, s6, v88
    v_pk_mul_f32 v[196:197], v[36:37], v[52:53] op_sel:[0,0] op_sel_hi:[0,1]
    v_lshlrev_b32 v54, 16, v89
    v_and_b32 v55, s6, v89
    v_pk_mul_f32 v[198:199], v[36:37], v[54:55] op_sel:[0,0] op_sel_hi:[0,1]
    v_lshlrev_b32 v52, 16, v90
    v_and_b32 v53, s6, v90
    v_pk_mul_f32 v[200:201], v[36:37], v[52:53] op_sel:[0,0] op_sel_hi:[0,1]
    v_lshlrev_b32 v54, 16, v91
    v_and_b32 v55, s6, v91
    v_pk_mul_f32 v[202:203], v[36:37], v[54:55] op_sel:[0,0] op_sel_hi:[0,1]
    v_lshlrev_b32 v52, 16, v92
    v_and_b32 v53, s6, v92
    v_pk_fma_f32 v[196:197], v[36:37], v[52:53], v[196:197] op_sel:[1,0,0] op_sel_hi:[1,1,1]
    v_lshlrev_b32 v54, 16, v93
    v_and_b32 v55, s6, v93
    v_pk_fma_f32 v[198:199], v[36:37], v[54:55], v[198:199] op_sel:[1,0,0] op_sel_hi:[1,1,1]
    v_lshlrev_b32 v52, 16, v94
    v_and_b32 v53, s6, v94
    v_pk_fma_f32 v[200:201], v[36:37], v[52:53], v[200:201] op_sel:[1,0,0] op_sel_hi:[1,1,1]
    v_lshlrev_b32 v54, 16, v95
    v_and_b32 v55, s6, v95
    v_pk_fma_f32 v[202:203], v[36:37], v[54:55], v[202:203] op_sel:[1,0,0] op_sel_hi:[1,1,1]
    v_lshlrev_b32 v52, 16, v96
    v_and_b32 v53, s6, v96
    v_pk_fma_f32 v[196:197], v[38:39], v[52:53], v[196:197] op_sel:[0,0,0] op_sel_hi:[0,1,1]
    v_lshlrev_b32 v54, 16, v97
    v_and_b32 v55, s6, v97
    v_pk_fma_f32 v[198:199], v[38:39], v[54:55], v[198:199] op_sel:[0,0,0] op_sel_hi:[0,1,1]
    v_lshlrev_b32 v52, 16, v98
    v_and_b32 v53, s6, v98
    v_pk_fma_f32 v[200:201], v[38:39], v[52:53], v[200:201] op_sel:[0,0,0] op_sel_hi:[0,1,1]
    v_lshlrev_b32 v54, 16, v99
    v_and_b32 v55, s6, v99
    v_pk_fma_f32 v[202:203], v[38:39], v[54:55], v[202:203] op_sel:[0,0,0] op_sel_hi:[0,1,1]
    v_lshlrev_b32 v52, 16, v100
    v_and_b32 v53, s6, v100
    v_pk_fma_f32 v[196:197], v[38:39], v[52:53], v[196:197] op_sel:[1,0,0] op_sel_hi:[1,1,1]
    v_lshlrev_b32 v54, 16, v101
    v_and_b32 v55, s6, v101
    v_pk_fma_f32 v[198:199], v[38:39], v[54:55], v[198:199] op_sel:[1,0,0] op_sel_hi:[1,1,1]
    v_lshlrev_b32 v52, 16, v102
    v_and_b32 v53, s6, v102
    v_pk_fma_f32 v[200:201], v[38:39], v[52:53], v[200:201] op_sel:[1,0,0] op_sel_hi:[1,1,1]
    v_lshlrev_b32 v54, 16, v103
    v_and_b32 v55, s6, v103
    v_pk_fma_f32 v[202:203], v[38:39], v[54:55], v[202:203] op_sel:[1,0,0] op_sel_hi:[1,1,1]
    v_lshlrev_b32 v52, 16, v104
    v_and_b32 v53, s6, v104
    v_pk_fma_f32 v[196:197], v[40:41], v[52:53], v[196:197] op_sel:[0,0,0] op_sel_hi:[0,1,1]
    v_lshlrev_b32 v54, 16, v105
    v_and_b32 v55, s6, v105
    v_pk_fma_f32 v[198:199], v[40:41], v[54:55], v[198:199] op_sel:[0,0,0] op_sel_hi:[0,1,1]
    v_lshlrev_b32 v52, 16, v106
    v_and_b32 v53, s6, v106
    v_pk_fma_f32 v[200:201], v[40:41], v[52:53], v[200:201] op_sel:[0,0,0] op_sel_hi:[0,1,1]
    v_lshlrev_b32 v54, 16, v107
    v_and_b32 v55, s6, v107
    v_pk_fma_f32 v[202:203], v[40:41], v[54:55], v[202:203] op_sel:[0,0,0] op_sel_hi:[0,1,1]
    v_lshlrev_b32 v52, 16, v108
    v_and_b32 v53, s6, v108
    v_pk_fma_f32 v[196:197], v[40:41], v[52:53], v[196:197] op_sel:[1,0,0] op_sel_hi:[1,1,1]
    v_lshlrev_b32 v54, 16, v109
    v_and_b32 v55, s6, v109
    v_pk_fma_f32 v[198:199], v[40:41], v[54:55], v[198:199] op_sel:[1,0,0] op_sel_hi:[1,1,1]
    v_lshlrev_b32 v52, 16, v110
    v_and_b32 v53, s6, v110
    v_pk_fma_f32 v[200:201], v[40:41], v[52:53], v[200:201] op_sel:[1,0,0] op_sel_hi:[1,1,1]
    v_lshlrev_b32 v54, 16, v111
    v_and_b32 v55, s6, v111
    v_pk_fma_f32 v[202:203], v[40:41], v[54:55], v[202:203] op_sel:[1,0,0] op_sel_hi:[1,1,1]
    v_lshlrev_b32 v52, 16, v112
    v_and_b32 v53, s6, v112
    v_pk_fma_f32 v[196:197], v[42:43], v[52:53], v[196:197] op_sel:[0,0,0] op_sel_hi:[0,1,1]
    v_lshlrev_b32 v54, 16, v113
    v_and_b32 v55, s6, v113
    v_pk_fma_f32 v[198:199], v[42:43], v[54:55], v[198:199] op_sel:[0,0,0] op_sel_hi:[0,1,1]
    v_lshlrev_b32 v52, 16, v114
    v_and_b32 v53, s6, v114
    v_pk_fma_f32 v[200:201], v[42:43], v[52:53], v[200:201] op_sel:[0,0,0] op_sel_hi:[0,1,1]
    v_lshlrev_b32 v54, 16, v115
    v_and_b32 v55, s6, v115
    v_pk_fma_f32 v[202:203], v[42:43], v[54:55], v[202:203] op_sel:[0,0,0] op_sel_hi:[0,1,1]
    v_lshlrev_b32 v52, 16, v116
    v_and_b32 v53, s6, v116
    v_pk_fma_f32 v[196:197], v[42:43], v[52:53], v[196:197] op_sel:[1,0,0] op_sel_hi:[1,1,1]
    v_lshlrev_b32 v54, 16, v117
    v_and_b32 v55, s6, v117
    v_pk_fma_f32 v[198:199], v[42:43], v[54:55], v[198:199] op_sel:[1,0,0] op_sel_hi:[1,1,1]
    v_lshlrev_b32 v52, 16, v118
    v_and_b32 v53, s6, v118
    v_pk_fma_f32 v[200:201], v[42:43], v[52:53], v[200:201] op_sel:[1,0,0] op_sel_hi:[1,1,1]
    v_lshlrev_b32 v54, 16, v119
    v_and_b32 v55, s6, v119
    v_pk_fma_f32 v[202:203], v[42:43], v[54:55], v[202:203] op_sel:[1,0,0] op_sel_hi:[1,1,1]
    v_permlane32_swap_b32 v196, v200
    v_permlane32_swap_b32 v197, v201
    v_permlane32_swap_b32 v198, v202
    v_permlane32_swap_b32 v199, v203
    v_add_f32 v196, v196, v200
    v_add_f32 v197, v197, v201
    v_add_f32 v198, v198, v202
    v_add_f32 v199, v199, v203
    s_nop 0
    v_permlane16_swap_b32 v196, v198
    v_permlane16_swap_b32 v197, v199
    v_add_f32 v196, v196, v198
    v_add_f32 v197, v197, v199
    s_nop 0
    v_add_f32_dpp v196, v196, v196 row_ror:8 row_mask:0xf bank_mask:0xf
    v_add_f32_dpp v197, v197, v197 row_ror:8 row_mask:0xf bank_mask:0xf
    s_nop 1
    v_mov_b32_dpp v196, v197 quad_perm:[0,1,2,3] row_mask:0xf bank_mask:0xc
    ds_write_b32 v252, v196 offset:9984
L_HG1:
    s_waitcnt vmcnt(1)
    v_pk_add_f32 v[184:185], v[184:185], v[188:189]
    v_pk_add_f32 v[186:187], v[186:187], v[190:191]
    s_nop 1
    v_permlane32_swap_b32 v184, v186
    v_permlane32_swap_b32 v185, v187
    v_pk_add_f32 v[184:185], v[184:185], v[186:187]
    s_nop 1
    v_add_f32_dpp v184, v184, v184 row_ror:8 row_mask:0xf bank_mask:0xf
    v_add_f32_dpp v185, v185, v185 row_ror:8 row_mask:0xf bank_mask:0xf
    v_mov_b32 v186, v184
    v_mov_b32 v187, v185
    s_nop 0
    v_permlane16_swap_b32 v184, v186
    v_permlane16_swap_b32 v185, v187
    v_pk_add_f32 v[184:185], v[184:185], v[186:187]
    v_cvt_pk_bf16_f32 v184, v184, v185
    v_mov_b32 v185, s4
    s_mov_b32 exec_lo, 0xff
    s_mov_b32 exec_hi, 0xff
    buffer_store_dwordx2 v[184:185], v48, s[32:35], s15 offen sc1
    s_mov_b64 exec, -1
    s_waitcnt lgkmcnt(0)
    s_barrier
    s_cmp_lg_u32 s3, 0
    s_cbranch_scc1 L_PC2
    v_mov_b32 v45, s4
    s_mov_b32 exec_hi, 0
    s_mov_b32 exec_lo, 65535
    buffer_store_dword v45, v46, s[32:35], s17 offen sc1
    s_mov_b64 exec, -1
L_PC2:
    s_cmp_lg_u32 s3, 3
    s_cbranch_scc1 L_M2F
    ds_read_b128 v[196:199], v251 offset:10000
    s_lshr_b32 s96, s8, 2
    s_lshl1_add_u32 s97, s9, s96
    s_and_b32 s98, s8, 3
    s_lshl2_add_u32 s99, s97, s98
    s_lshl_b32 s96, s99, 9
    s_add_u32 s18, s96, 131072
    s_waitcnt lgkmcnt(0)
    v_add_f32 v196, v196, v197
    v_add_f32 v198, v198, v199
    v_mov_b32 v197, s4
    v_add_f32 v196, v196, v198
    buffer_store_dwordx2 v[196:197], v250, s[32:35], s18 offen sc1
L_M2F:
    s_waitcnt vmcnt(1)
    s_xor_b32 s96, s95, 262144
    s_add_u32 s82, s96, s90
    s_add_u32 m0, s83, 16384
    s_nop 0
    buffer_load_dwordx4 v26, s[44:47], s82 offen lds
    v_permlane32_swap_b32 v192, v194
    v_permlane32_swap_b32 v193, v195
    v_pk_add_f32 v[192:193], v[192:193], v[194:195]
    s_nop 1
    v_add_f32_dpp v192, v192, v192 row_ror:4 row_mask:0xf bank_mask:0xf
    s_xor_b32 s96, s95, 393216
    s_add_u32 s82, s96, s90
    s_add_u32 m0, s83, 24576
    s_nop 0
    buffer_load_dwordx4 v26, s[44:47], s82 offen lds
    v_add_f32_dpp v193, v193, v193 row_ror:4 row_mask:0xf bank_mask:0xf
    v_add_f32_dpp v192, v192, v192 row_ror:8 row_mask:0xf bank_mask:0xf
    s_nop 0
    v_add_f32_dpp v193, v193, v193 row_ror:8 row_mask:0xf bank_mask:0xf
    s_xor_b32 s96, s95, 524288
    s_add_u32 s82, s96, s90
    s_add_u32 m0, s83, 32768
    s_nop 0
    buffer_load_dwordx4 v26, s[44:47], s82 offen lds
    v_mov_b32 v194, v192
    v_mov_b32 v195, v193
    s_nop 0
    v_permlane16_swap_b32 v192, v194
    s_xor_b32 s96, s95, 655360
    s_add_u32 s82, s96, s90
    s_add_u32 m0, s83, 40960
    s_nop 0
    buffer_load_dwordx4 v26, s[44:47], s82 offen lds
    v_permlane16_swap_b32 v193, v195
    v_pk_add_f32 v[192:193], v[192:193], v[194:195]
    v_cvt_pk_bf16_f32 v192, v192, v193
    ds_write_b32 v6, v192
    s_waitcnt lgkmcnt(0)
    s_barrier
    ds_read_b128 v[196:199], v7
    ds_read_b128 v[200:203], v7 offset:32
    ds_read_b128 v[204:207], v7 offset:64
    ds_read_b128 v[208:211], v7 offset:96
    s_lshr_b32 s96, s8, 2
    s_lshl1_add_u32 s97, s9, s96
    s_and_b32 s98, s8, 3
    s_lshl2_add_u32 s99, s97, s98
    s_lshl_b32 s96, s99, 9
    s_add_u32 s18, s96, 131072
    s_waitcnt lgkmcnt(0)
    s_lshl3_add_u32 s96, s11, s3
    s_lshl_b32 s97, s96, 11
    s_add_u32 s13, s97, 29360128
    s_load_dwordx2 s[24:25], s[32:33], s92 offset:3584 glc
    v_mfma_f32_32x32x16_bf16 v[136:151], v[196:199], v[152:155], 0
    v_mfma_f32_32x32x16_bf16 v[136:151], v[200:203], v[156:159], v[136:151]
    v_mfma_f32_32x32x16_bf16 v[136:151], v[204:207], v[160:163], v[136:151]
    v_mfma_f32_32x32x16_bf16 v[136:151], v[208:211], v[164:167], v[136:151]
    s_nop 11
    v_cvt_pk_bf16_f32 v136, 0, v136
    v_add_f32 v136, 0x358637bd, v136
    v_cvt_pk_bf16_f32 v136, 0, v136
    v_rcp_f32 v136, v136
    s_branch SCHK_20
SPOLL_19:
    s_load_dwordx2 s[24:25], s[32:33], s92 offset:3584 glc
SCHK_20:
    s_add_u32 s5, s5, 1
    s_cmp_ge_u32 s5, 200000
    s_waitcnt lgkmcnt(0)
    s_cbranch_scc1 SDONE_21
    s_cmp_lg_u32 s24, s4
    s_cbranch_scc1 SPOLL_19
    s_cmp_lg_u32 s25, s4
    s_cbranch_scc1 SPOLL_19
SDONE_21:
    buffer_load_dwordx4 v[228:231], v2, s[32:35], s13 offen sc1
    buffer_load_dwordx4 v[232:235], v2, s[32:35], s13 offen offset:1024 sc1
    s_waitcnt vmcnt(0)
    v_bitop3_b32 v4, v229, v231, s4 bitop3:0x7e
    v_bitop3_b32 v4, v4, v233, s4 bitop3:0xf6
    v_bitop3_b32 v4, v4, v235, s4 bitop3:0xf6
    v_cmp_ne_u32 vcc, 0, v4
    s_cbranch_vccz TOK_23
POLL_24:
    buffer_load_dwordx4 v[228:231], v2, s[32:35], s13 offen sc1
    buffer_load_dwordx4 v[232:235], v2, s[32:35], s13 offen offset:1024 sc1
    s_waitcnt vmcnt(0)
    v_bitop3_b32 v4, v229, v231, s4 bitop3:0x7e
    v_bitop3_b32 v4, v4, v233, s4 bitop3:0xf6
    v_bitop3_b32 v4, v4, v235, s4 bitop3:0xf6
    v_cmp_ne_u32 vcc, 0, v4
    s_cbranch_vccz PDONE_25
    s_add_u32 s5, s5, 1
    s_cmp_lt_u32 s5, 200000
    s_cbranch_scc1 POLL_24
PDONE_25:
TOK_23:
L_PAD7:
    s_cbranch_execz L_RET7
    ds_write2_b32 v5, v228, v230 offset0:0 offset1:1
    ds_write2_b32 v5, v232, v234 offset0:64 offset1:65
    s_waitcnt lgkmcnt(0)
    s_barrier
    ds_read_b128 v[212:215], v44
    ds_read_b128 v[216:219], v44 offset:1024
    ds_read_b128 v[220:223], v44 offset:2048
    ds_read_b128 v[224:227], v44 offset:3072
    s_lshl_b32 s96, s77, 1
    s_lshl3_add_u32 s97, s10, s96
    s_lshl_b32 s98, s97, 5
    s_lshl1_add_u32 s99, s11, s98
    s_add_u32 s96, s99, s76
    s_lshl_b32 s97, s96, 10
    s_add_u32 s13, s97, 8388608
    v_and_b32 v47, 15, v1
    v_lshlrev_b32 v47, 4, v47
    v_bfe_u32 v9, v1, 4, 1
    v_lshl_add_u32 v47, v9, 15, v47
    v_lshrrev_b32 v9, 5, v1
    v_lshl_add_u32 v47, v9, 8, v47
    s_waitcnt lgkmcnt(3)
    v_mfma_f32_32x32x16_bf16 v[120:135], v[212:215], v[152:155], 0
    s_waitcnt lgkmcnt(2)
    v_mfma_f32_32x32x16_bf16 v[120:135], v[216:219], v[156:159], v[120:135]
    s_waitcnt lgkmcnt(1)
    v_mfma_f32_32x32x16_bf16 v[120:135], v[220:223], v[160:163], v[120:135]
    s_waitcnt lgkmcnt(0)
    v_mfma_f32_32x32x16_bf16 v[120:135], v[224:227], v[164:167], v[120:135]
    s_lshr_b32 s96, s3, 1
    s_lshl4_add_u32 s97, s96, s12
    s_lshl_b32 s98, s97, 11
    s_and_b32 s99, s3, 1
    s_lshl_b32 s96, s99, 10
    s_add_u32 s97, s98, s96
    s_add_u32 s18, s97, 131072
    s_lshl_b32 s19, s12, 7
    v_and_b32 v44, 3, v1
    v_lshl_add_u32 v44, v44, 1, s19
    v_lshrrev_b32 v9, 5, v1
    v_lshl_add_u32 v44, v9, 3, v44
    v_bfe_u32 v9, v1, 4, 1
    v_lshl_add_u32 v44, v9, 4, v44
    v_bfe_u32 v9, v1, 2, 2
    v_lshl_add_u32 v44, v9, 5, v44
    global_load_ushort v32, v44, s[78:79]
    v_cvt_pk_bf16_f32 v120, 0, v120
    v_cvt_pk_bf16_f32 v121, 0, v121
    v_cvt_pk_bf16_f32 v122, 0, v122
    v_cvt_pk_bf16_f32 v123, 0, v123
    v_cvt_pk_bf16_f32 v124, 0, v124
    v_cvt_pk_bf16_f32 v125, 0, v125
    v_cvt_pk_bf16_f32 v126, 0, v126
    v_cvt_pk_bf16_f32 v127, 0, v127
    v_pk_mul_f32 v[120:121], v[120:121], v[136:137] op_sel_hi:[1,0]
    v_pk_mul_f32 v[122:123], v[122:123], v[136:137] op_sel_hi:[1,0]
    v_pk_mul_f32 v[124:125], v[124:125], v[136:137] op_sel_hi:[1,0]
    v_pk_mul_f32 v[126:127], v[126:127], v[136:137] op_sel_hi:[1,0]
    v_cvt_pk_bf16_f32 v168, v120, v121
    v_cvt_pk_bf16_f32 v169, v122, v123
    v_cvt_pk_bf16_f32 v170, v124, v125
    v_cvt_pk_bf16_f32 v171, v126, v127
    buffer_store_dwordx4 v[168:171], v47, s[32:35], s13 offen sc1
    v_cvt_pk_bf16_f32 v128, 0, v128
    v_cvt_pk_bf16_f32 v129, 0, v129
    v_cvt_pk_bf16_f32 v130, 0, v130
    v_cvt_pk_bf16_f32 v131, 0, v131
    v_cvt_pk_bf16_f32 v132, 0, v132
    v_cvt_pk_bf16_f32 v133, 0, v133
    v_cvt_pk_bf16_f32 v134, 0, v134
    v_cvt_pk_bf16_f32 v135, 0, v135
    v_pk_mul_f32 v[128:129], v[128:129], v[136:137] op_sel_hi:[1,0]
    v_pk_mul_f32 v[130:131], v[130:131], v[136:137] op_sel_hi:[1,0]
    v_pk_mul_f32 v[132:133], v[132:133], v[136:137] op_sel_hi:[1,0]
    v_pk_mul_f32 v[134:135], v[134:135], v[136:137] op_sel_hi:[1,0]
    v_cvt_pk_bf16_f32 v172, v128, v129
    v_cvt_pk_bf16_f32 v173, v130, v131
    v_cvt_pk_bf16_f32 v174, v132, v133
    v_cvt_pk_bf16_f32 v175, v134, v135
    buffer_store_dwordx4 v[172:175], v47, s[32:35], s13 offen offset:512 sc1
    buffer_load_dwordx4 v[28:31], v2, s[32:35], s18 offen sc1
    v_mov_b32 v50, -1
    v_mov_b32 v51, -1
    v_mov_b32 v52, -1
    v_mov_b32 v53, -1
    s_lshl3_add_u32 s96, s21, s3
    s_lshl4_add_u32 s97, s96, s12
    s_lshl_b32 s98, s97, 8
    s_add_u32 s19, s98, 12582912
    v_lshlrev_b32 v54, 2, v1
    buffer_store_dword v50, v54, s[32:35], s19 offen sc1
    s_lshl_b32 s96, s21, 14
    s_lshl_b32 s97, s12, 9
    s_add_u32 s98, s96, s97
    s_add_u32 s19, s98, 13631488
    v_and_b32 v54, 31, v1
    v_lshlrev_b32 v54, 4, v54
    v_lshrrev_b32 v55, 5, v1
    v_lshl_add_u32 v54, v55, 13, v54
    s_cmp_lg_u32 s3, 5
    s_cbranch_scc1 L_NOPO
    buffer_store_dwordx4 v[50:53], v54, s[32:35], s19 offen sc1
L_NOPO:
    v_bfe_u32 v36, v1, 2, 2
    v_lshlrev_b32 v36, 7, v36
    v_lshrrev_b32 v9, 4, v1
    v_lshl_add_u32 v36, v9, 10, v36
    v_and_b32 v9, 1, v1
    v_lshl_add_u32 v36, v9, 4, v36
    v_bfe_u32 v9, v1, 1, 1
    v_lshl_add_u32 v36, v9, 3, v36
    v_bfe_u32 v9, v1, 3, 2
    v_lshl_add_u32 v36, v9, 5, v36
    s_and_b32 s96, s9, 1
    s_lshl_b32 s97, s96, 2
    s_xor_b32 s98, s3, s97
    s_lshl_b32 s17, s98, 12
    s_lshl_b32 s96, s17, 2
    s_lshr_b32 s97, s95, 4
    s_xor_b32 s14, s96, s97
    v_add_u32 v36, s14, v36
    v_xor_b32 v37, 32, v36
    v_xor_b32 v38, 64, v36
    v_xor_b32 v39, 96, v36
    v_and_b32 v5, 7, v1
    v_lshlrev_b32 v5, 15, v5
    v_bfe_u32 v9, v1, 3, 1
    v_lshl_add_u32 v5, v9, 12, v5
    s_and_b32 s96, s11, 1
    s_lshr_b32 s97, s10, 2
    s_and_b32 s98, s10, 3
    s_lshl_b32 s99, s98, 6
    s_lshl1_add_u32 s98, s97, s99
    s_lshl_b32 s97, s98, 12
    s_lshr_b32 s99, s11, 1
    s_lshl_b32 s98, s99, 6
    s_add_u32 s99, s97, s98
    s_lshl2_add_u32 s97, s96, s99
    s_add_u32 s98, s97, 1048576
    s_add_u32 s15, s98, 1024
    v_lshlrev_b32 v152, 16, v12
    v_and_b32 v153, s6, v12
    v_lshlrev_b32 v154, 16, v13
    v_and_b32 v155, s6, v13
    v_lshlrev_b32 v156, 16, v14
    v_and_b32 v157, s6, v14
    v_lshlrev_b32 v158, 16, v15
    v_and_b32 v159, s6, v15
    v_lshlrev_b32 v160, 16, v16
    v_and_b32 v161, s6, v16
    v_lshlrev_b32 v162, 16, v17
    v_and_b32 v163, s6, v17
    v_lshlrev_b32 v164, 16, v18
    v_and_b32 v165, s6, v18
    v_lshlrev_b32 v166, 16, v19
    v_and_b32 v167, s6, v19
    s_lshl3_add_u32 s96, s21, s3
    s_lshl_b32 s97, s96, 15
    s_add_u32 s19, s97, 8388608
    s_and_b32 s96, s3, 1
    s_lshr_b32 s97, s3, 1
    s_lshl_b32 s98, s97, 10
    s_lshl3_add_u32 s99, s96, s98
    s_add_u32 s14, s99, 159744
    v_and_b32 v4, 31, v1
    v_lshl_add_u32 v4, v4, 5, s14
    v_lshrrev_b32 v9, 5, v1
    v_lshl_add_u32 v4, v9, 2, v4
    v_and_b32 v7, 3, v1
    v_lshlrev_b32 v7, 4, v7
    v_lshrrev_b32 v9, 5, v1
    v_lshl_add_u32 v7, v9, 6, v7
    v_bfe_u32 v9, v1, 4, 1
    v_lshl_add_u32 v7, v9, 7, v7
    v_bfe_u32 v9, v1, 2, 2
    v_lshl_add_u32 v7, v9, 8, v7
    v_add_u32 v7, 159744, v7
    s_waitcnt vmcnt(2)
    s_waitcnt lgkmcnt(0)
    s_barrier
    s_cmp_lg_u32 s3, 0
    s_cbranch_scc1 L_PD
    v_mov_b32 v6, s4
    s_mov_b32 exec_hi, 0
    s_mov_b32 exec_lo, 65535
    buffer_store_dword v6, v5, s[32:35], s15 offen sc1
    s_mov_b64 exec, -1
L_PD:
    s_waitcnt vmcnt(1)
    v_bitop3_b32 v6, v29, v31, s4 bitop3:0x7e
    v_cmp_ne_u32 vcc, 0, v6
    s_cbranch_vccz L_MGOK
POLL_26:
    buffer_load_dwordx4 v[28:31], v2, s[32:35], s18 offen sc1
    s_waitcnt vmcnt(0)
    v_bitop3_b32 v6, v29, v31, s4 bitop3:0x7e
    v_cmp_ne_u32 vcc, 0, v6
    s_cbranch_vccz PDONE_27
    s_add_u32 s5, s5, 1
    s_cmp_lt_u32 s5, 200000
    s_cbranch_scc1 POLL_26
PDONE_27:
L_MGOK:
    ds_write2_b32 v4, v28, v30 offset0:0 offset1:4
    s_waitcnt lgkmcnt(0)
    s_barrier
    s_lshl_b32 s96, s2, 12
    s_lshr_b32 s97, s17, 6
    s_add_u32 s98, s96, s97
    s_add_u32 s99, s98, 1048576
    s_add_u32 s18, s99, 1024
    ds_read_b128 v[192:195], v7
    ds_read_b128 v[196:199], v7 offset:1024
    ds_read_b128 v[200:203], v7 offset:2048
    ds_read_b128 v[204:207], v7 offset:3072
    v_and_b32 v8, 3, v1
    v_lshlrev_b32 v8, 2, v8
    v_lshrrev_b32 v9, 5, v1
    v_lshl_add_u32 v8, v9, 4, v8
    v_bfe_u32 v9, v1, 4, 1
    v_lshl_add_u32 v8, v9, 5, v8
    v_bfe_u32 v9, v1, 2, 2
    v_lshl_add_u32 v8, v9, 6, v8
    v_add_u32 v8, 157184, v8
    s_lshl4_add_u32 s96, s21, s12
    s_lshl_b32 s97, s96, 6
    s_add_u32 s13, s97, 14155776
    s_waitcnt lgkmcnt(0)
    s_load_dwordx2 s[24:25], s[32:33], s18 offset:0 glc
    v_pk_add_f32 v[192:193], v[192:193], v[194:195]
    v_add_f32 v28, v192, v193
    v_pk_add_f32 v[196:197], v[196:197], v[198:199]
    v_add_f32 v29, v196, v197
    v_pk_add_f32 v[200:201], v[200:201], v[202:203]
    v_add_f32 v30, v200, v201
    v_pk_add_f32 v[204:205], v[204:205], v[206:207]
    v_add_f32 v31, v204, v205
    v_cvt_pk_bf16_f32 v28, 0, v28
    v_cvt_pk_bf16_f32 v29, 0, v29
    v_cvt_pk_bf16_f32 v30, 0, v30
    v_cvt_pk_bf16_f32 v31, 0, v31
    v_add_f32 v30, 1.0, v30
    v_lshlrev_b32 v32, 16, v32
    v_cvt_pk_bf16_f32 v30, 0, v30
    ds_write_b32 v8, v31
    v_mul_f32 v192, v30, v32
    v_cvt_pk_bf16_f32 v193, 0, v192
    v_sub_f32 v194, v192, v193
    v_add_f32_dpp v192, v192, v192 quad_perm:[1,0,3,2] row_mask:0xf bank_mask:0xf
    s_nop 1
    v_add_f32_dpp v192, v192, v192 quad_perm:[2,3,0,1] row_mask:0xf bank_mask:0xf
    s_nop 1
    v_add_f32_dpp v192, v192, v192 row_half_mirror row_mask:0xf bank_mask:0xf
    s_nop 1
    v_add_f32_dpp v192, v192, v192 row_ror:8 row_mask:0xf bank_mask:0xf
    v_mov_b32 v199, v192
    s_nop 1
    v_permlane16_swap_b32 v192, v199
    v_add_f32 v192, v192, v199
    v_mov_b32 v199, v192
    s_nop 1
    v_permlane32_swap_b32 v192, v199
    v_add_f32 v192, v192, v199
    v_mov_b32_dpp v196, v193 row_shl:1 row_mask:0xf bank_mask:0xf
    v_mov_b32_dpp v197, v194 row_shl:1 row_mask:0xf bank_mask:0xf
    v_mov_b32_dpp v198, v32 row_shl:1 row_mask:0xf bank_mask:0xf
    v_cvt_pk_bf16_f32 v196, v193, v196
    v_cvt_pk_bf16_f32 v197, v194, v197
    v_cvt_pk_bf16_f32 v198, v32, v198
    v_mov_b32 v193, s4
    v_mov_b32 v194, 0
    s_cmp_lg_u32 s3, 2
    s_cbranch_scc1 L_NOUP
    s_mov_b64 exec, 1
    buffer_store_dwordx2 v[192:193], v194, s[32:35], s13 offen sc1
    s_mov_b64 exec, -1
L_NOUP:
    v_mov_b32 v184, 0x3f803f80
    s_nop 1
    v_mov_b32_dpp v184, v196 row_newbcast:0 row_mask:0xf bank_mask:0x2
    s_nop 1
    v_mov_b32_dpp v184, v197 row_newbcast:0 row_mask:0xf bank_mask:0x4
    s_nop 1
    v_mov_b32_dpp v184, v198 row_newbcast:0 row_mask:0xf bank_mask:0x8
    v_mov_b32 v185, 0x3f803f80
    s_nop 1
    v_mov_b32_dpp v185, v196 row_newbcast:2 row_mask:0xf bank_mask:0x2
    s_nop 1
    v_mov_b32_dpp v185, v197 row_newbcast:2 row_mask:0xf bank_mask:0x4
    s_nop 1
    v_mov_b32_dpp v185, v198 row_newbcast:2 row_mask:0xf bank_mask:0x8
    v_mov_b32 v186, 0x3f803f80
    s_nop 1
    v_mov_b32_dpp v186, v196 row_newbcast:4 row_mask:0xf bank_mask:0x2
    s_nop 1
    v_mov_b32_dpp v186, v197 row_newbcast:4 row_mask:0xf bank_mask:0x4
    s_nop 1
    v_mov_b32_dpp v186, v198 row_newbcast:4 row_mask:0xf bank_mask:0x8
    v_mov_b32 v187, 0x3f803f80
    s_nop 1
    v_mov_b32_dpp v187, v196 row_newbcast:6 row_mask:0xf bank_mask:0x2
    s_nop 1
    v_mov_b32_dpp v187, v197 row_newbcast:6 row_mask:0xf bank_mask:0x4
    s_nop 1
    v_mov_b32_dpp v187, v198 row_newbcast:6 row_mask:0xf bank_mask:0x8
    v_mov_b32 v188, 0x3f803f80
    s_nop 1
    v_mov_b32_dpp v188, v196 row_newbcast:8 row_mask:0xf bank_mask:0x2
    s_nop 1
    v_mov_b32_dpp v188, v197 row_newbcast:8 row_mask:0xf bank_mask:0x4
    s_nop 1
    v_mov_b32_dpp v188, v198 row_newbcast:8 row_mask:0xf bank_mask:0x8
    v_mov_b32 v189, 0x3f803f80
    s_nop 1
    v_mov_b32_dpp v189, v196 row_newbcast:10 row_mask:0xf bank_mask:0x2
    s_nop 1
    v_mov_b32_dpp v189, v197 row_newbcast:10 row_mask:0xf bank_mask:0x4
    s_nop 1
    v_mov_b32_dpp v189, v198 row_newbcast:10 row_mask:0xf bank_mask:0x8
    v_mov_b32 v190, 0x3f803f80
    s_nop 1
    v_mov_b32_dpp v190, v196 row_newbcast:12 row_mask:0xf bank_mask:0x2
    s_nop 1
    v_mov_b32_dpp v190, v197 row_newbcast:12 row_mask:0xf bank_mask:0x4
    s_nop 1
    v_mov_b32_dpp v190, v198 row_newbcast:12 row_mask:0xf bank_mask:0x8
    v_mov_b32 v191, 0x3f803f80
    s_nop 1
    v_mov_b32_dpp v191, v196 row_newbcast:14 row_mask:0xf bank_mask:0x2
    s_nop 1
    v_mov_b32_dpp v191, v197 row_newbcast:14 row_mask:0xf bank_mask:0x4
    s_nop 1
    v_mov_b32_dpp v191, v198 row_newbcast:14 row_mask:0xf bank_mask:0x8
    v_mov_b32 v42, v29
    v_mov_b32 v43, v31
    v_mov_b32 v33, v30
    v_mov_b32_dpp v136, v28 row_newbcast:0 row_mask:0xf bank_mask:0xf
    v_mov_b32_dpp v137, v28 row_newbcast:1 row_mask:0xf bank_mask:0xf
    v_mov_b32_dpp v138, v28 row_newbcast:2 row_mask:0xf bank_mask:0xf
    v_mov_b32_dpp v139, v28 row_newbcast:3 row_mask:0xf bank_mask:0xf
    v_mov_b32_dpp v140, v28 row_newbcast:4 row_mask:0xf bank_mask:0xf
    v_mov_b32_dpp v141, v28 row_newbcast:5 row_mask:0xf bank_mask:0xf
    v_mov_b32_dpp v142, v28 row_newbcast:6 row_mask:0xf bank_mask:0xf
    v_mov_b32_dpp v143, v28 row_newbcast:7 row_mask:0xf bank_mask:0xf
    v_mov_b32_dpp v144, v28 row_newbcast:8 row_mask:0xf bank_mask:0xf
    v_mov_b32_dpp v145, v28 row_newbcast:9 row_mask:0xf bank_mask:0xf
    v_mov_b32_dpp v146, v28 row_newbcast:10 row_mask:0xf bank_mask:0xf
    v_mov_b32_dpp v147, v28 row_newbcast:11 row_mask:0xf bank_mask:0xf
    v_mov_b32_dpp v148, v28 row_newbcast:12 row_mask:0xf bank_mask:0xf
    v_mov_b32_dpp v149, v28 row_newbcast:13 row_mask:0xf bank_mask:0xf
    v_mov_b32_dpp v150, v28 row_newbcast:14 row_mask:0xf bank_mask:0xf
    v_mov_b32_dpp v151, v28 row_newbcast:15 row_mask:0xf bank_mask:0xf
    s_branch SCHK_29
SPOLL_28:
    s_load_dwordx2 s[24:25], s[32:33], s18 offset:0 glc
SCHK_29:
    s_add_u32 s5, s5, 1
    s_cmp_ge_u32 s5, 200000
    s_waitcnt lgkmcnt(0)
    s_cbranch_scc1 SDONE_30
    s_cmp_lg_u32 s24, s4
    s_cbranch_scc1 SPOLL_28
    s_cmp_lg_u32 s25, s4
    s_cbranch_scc1 SPOLL_28
SDONE_30:
    s_add_u32 s20, s17, s19
    buffer_load_dwordx4 v[224:227], v2, s[32:35], s20 offen sc1
    ds_read_b64_tr_b16 v[192:193], v36
    ds_read_b64_tr_b16 v[194:195], v36 offset:512
    ds_read_b64_tr_b16 v[196:197], v37
    ds_read_b64_tr_b16 v[198:199], v37 offset:512
    ds_read_b64_tr_b16 v[200:201], v38
    ds_read_b64_tr_b16 v[202:203], v38 offset:512
    ds_read_b64_tr_b16 v[204:205], v39
    ds_read_b64_tr_b16 v[206:207], v39 offset:512
    ds_read_b64_tr_b16 v[208:209], v36 offset:4096
    ds_read_b64_tr_b16 v[210:211], v36 offset:4608
    ds_read_b64_tr_b16 v[212:213], v37 offset:4096
    ds_read_b64_tr_b16 v[214:215], v37 offset:4608
    ds_read_b64_tr_b16 v[216:217], v38 offset:4096
    ds_read_b64_tr_b16 v[218:219], v38 offset:4608
    buffer_load_dwordx4 v[228:231], v2, s[32:35], s20 offen offset:1024 sc1
    buffer_load_dwordx4 v[232:235], v2, s[32:35], s20 offen offset:2048 sc1
    buffer_load_dwordx4 v[236:239], v2, s[32:35], s20 offen offset:3072 sc1
    s_barrier
    s_xor_b32 s96, s17, 4096
    s_add_u32 s20, s96, s19
    buffer_load_dwordx4 v[240:243], v2, s[32:35], s20 offen sc1
    buffer_load_dwordx4 v[244:247], v2, s[32:35], s20 offen offset:1024 sc1
    buffer_load_dwordx4 v[44:47], v2, s[32:35], s20 offen offset:2048 sc1
    buffer_load_dwordx4 v[48:51], v2, s[32:35], s20 offen offset:3072 sc1
    s_lshl_b32 s96, s21, 10
    s_add_u32 s13, s96, 14155776
    v_and_b32 v10, 15, v1
    v_lshlrev_b32 v10, 6, v10
    s_cmp_lt_u32 s3, 4
    s_cbranch_scc1 L_G2P0
    s_setprio 1
L_G2P0:
    s_waitcnt vmcnt(7)
    s_waitcnt lgkmcnt(6)
    v_mfma_f32_16x16x32_bf16 v[120:123], v[192:195], v[224:227], 0
    ds_read_b64_tr_b16 v[220:221], v39 offset:4096
    ds_read_b64_tr_b16 v[222:223], v39 offset:4608
    v_mfma_f32_16x16x32_bf16 v[124:127], v[196:199], v[224:227], 0
    ds_read_b64_tr_b16 v[192:193], v36 offset:8192
    ds_read_b64_tr_b16 v[194:195], v36 offset:8704
    v_mfma_f32_16x16x32_bf16 v[128:131], v[200:203], v[224:227], 0
    ds_read_b64_tr_b16 v[196:197], v37 offset:8192
    ds_read_b64_tr_b16 v[198:199], v37 offset:8704
    v_mfma_f32_16x16x32_bf16 v[132:135], v[204:207], v[224:227], 0
    ds_read_b64_tr_b16 v[200:201], v38 offset:8192
    ds_read_b64_tr_b16 v[202:203], v38 offset:8704
    s_xor_b32 s96, s17, 8192
    s_add_u32 s20, s96, s19
    buffer_load_dwordx4 v[224:227], v2, s[32:35], s20 offen sc1
    s_waitcnt vmcnt(7)
    s_waitcnt lgkmcnt(6)
    v_mfma_f32_16x16x32_bf16 v[120:123], v[208:211], v[228:231], v[120:123]
    ds_read_b64_tr_b16 v[204:205], v39 offset:8192
    ds_read_b64_tr_b16 v[206:207], v39 offset:8704
    v_mfma_f32_16x16x32_bf16 v[124:127], v[212:215], v[228:231], v[124:127]
    ds_read_b64_tr_b16 v[208:209], v36 offset:12288
    ds_read_b64_tr_b16 v[210:211], v36 offset:12800
    v_xor_b32 v36, 16384, v36
    v_mfma_f32_16x16x32_bf16 v[128:131], v[216:219], v[228:231], v[128:131]
    ds_read_b64_tr_b16 v[212:213], v37 offset:12288
    ds_read_b64_tr_b16 v[214:215], v37 offset:12800
    v_xor_b32 v37, 16384, v37
    v_mfma_f32_16x16x32_bf16 v[132:135], v[220:223], v[228:231], v[132:135]
    ds_read_b64_tr_b16 v[216:217], v38 offset:12288
    ds_read_b64_tr_b16 v[218:219], v38 offset:12800
    v_xor_b32 v38, 16384, v38
    buffer_load_dwordx4 v[228:231], v2, s[32:35], s20 offen offset:1024 sc1
    s_waitcnt vmcnt(7)
    s_waitcnt lgkmcnt(6)
    v_mfma_f32_16x16x32_bf16 v[120:123], v[192:195], v[232:235], v[120:123]
    ds_read_b64_tr_b16 v[220:221], v39 offset:12288
    ds_read_b64_tr_b16 v[222:223], v39 offset:12800
    v_xor_b32 v39, 16384, v39
    v_mfma_f32_16x16x32_bf16 v[124:127], v[196:199], v[232:235], v[124:127]
    ds_read_b64_tr_b16 v[192:193], v36
    ds_read_b64_tr_b16 v[194:195], v36 offset:512
    v_mfma_f32_16x16x32_bf16 v[128:131], v[200:203], v[232:235], v[128:131]
    ds_read_b64_tr_b16 v[196:197], v37
    ds_read_b64_tr_b16 v[198:199], v37 offset:512
    v_mfma_f32_16x16x32_bf16 v[132:135], v[204:207], v[232:235], v[132:135]
    ds_read_b64_tr_b16 v[200:201], v38
    ds_read_b64_tr_b16 v[202:203], v38 offset:512
    buffer_load_dwordx4 v[232:235], v2, s[32:35], s20 offen offset:2048 sc1
    s_waitcnt vmcnt(7)
    s_waitcnt lgkmcnt(6)
    v_mfma_f32_16x16x32_bf16 v[120:123], v[208:211], v[236:239], v[120:123]
    ds_read_b64_tr_b16 v[204:205], v39
    ds_read_b64_tr_b16 v[206:207], v39 offset:512
    v_mfma_f32_16x16x32_bf16 v[124:127], v[212:215], v[236:239], v[124:127]
    ds_read_b64_tr_b16 v[208:209], v36 offset:4096
    ds_read_b64_tr_b16 v[210:211], v36 offset:4608
    v_mfma_f32_16x16x32_bf16 v[128:131], v[216:219], v[236:239], v[128:131]
    ds_read_b64_tr_b16 v[212:213], v37 offset:4096
    ds_read_b64_tr_b16 v[214:215], v37 offset:4608
    v_mfma_f32_16x16x32_bf16 v[132:135], v[220:223], v[236:239], v[132:135]
    ds_read_b64_tr_b16 v[216:217], v38 offset:4096
    ds_read_b64_tr_b16 v[218:219], v38 offset:4608
    buffer_load_dwordx4 v[236:239], v2, s[32:35], s20 offen offset:3072 sc1
    s_waitcnt vmcnt(7)
    s_waitcnt lgkmcnt(6)
    v_mfma_f32_16x16x32_bf16 v[120:123], v[192:195], v[240:243], v[120:123]
    ds_read_b64_tr_b16 v[220:221], v39 offset:4096
    ds_read_b64_tr_b16 v[222:223], v39 offset:4608
    v_mfma_f32_16x16x32_bf16 v[124:127], v[196:199], v[240:243], v[124:127]
    ds_read_b64_tr_b16 v[192:193], v36 offset:8192
    ds_read_b64_tr_b16 v[194:195], v36 offset:8704
    v_mfma_f32_16x16x32_bf16 v[128:131], v[200:203], v[240:243], v[128:131]
    ds_read_b64_tr_b16 v[196:197], v37 offset:8192
    ds_read_b64_tr_b16 v[198:199], v37 offset:8704
    v_mfma_f32_16x16x32_bf16 v[132:135], v[204:207], v[240:243], v[132:135]
    ds_read_b64_tr_b16 v[200:201], v38 offset:8192
    ds_read_b64_tr_b16 v[202:203], v38 offset:8704
    s_xor_b32 s96, s17, 12288
    s_add_u32 s20, s96, s19
    buffer_load_dwordx4 v[240:243], v2, s[32:35], s20 offen sc1
    s_waitcnt vmcnt(7)
    s_waitcnt lgkmcnt(6)
    v_mfma_f32_16x16x32_bf16 v[120:123], v[208:211], v[244:247], v[120:123]
    ds_read_b64_tr_b16 v[204:205], v39 offset:8192
    ds_read_b64_tr_b16 v[206:207], v39 offset:8704
    v_mfma_f32_16x16x32_bf16 v[124:127], v[212:215], v[244:247], v[124:127]
    ds_read_b64_tr_b16 v[208:209], v36 offset:12288
    ds_read_b64_tr_b16 v[210:211], v36 offset:12800
    v_xor_b32 v36, 49152, v36
    v_mfma_f32_16x16x32_bf16 v[128:131], v[216:219], v[244:247], v[128:131]
    ds_read_b64_tr_b16 v[212:213], v37 offset:12288
    ds_read_b64_tr_b16 v[214:215], v37 offset:12800
    v_xor_b32 v37, 49152, v37
    v_mfma_f32_16x16x32_bf16 v[132:135], v[220:223], v[244:247], v[132:135]
    ds_read_b64_tr_b16 v[216:217], v38 offset:12288
    ds_read_b64_tr_b16 v[218:219], v38 offset:12800
    v_xor_b32 v38, 49152, v38
    buffer_load_dwordx4 v[244:247], v2, s[32:35], s20 offen offset:1024 sc1
    s_waitcnt vmcnt(7)
    s_waitcnt lgkmcnt(6)
    v_mfma_f32_16x16x32_bf16 v[120:123], v[192:195], v[44:47], v[120:123]
    ds_read_b64_tr_b16 v[220:221], v39 offset:12288
    ds_read_b64_tr_b16 v[222:223], v39 offset:12800
    v_xor_b32 v39, 49152, v39
    v_mfma_f32_16x16x32_bf16 v[124:127], v[196:199], v[44:47], v[124:127]
    ds_read_b64_tr_b16 v[192:193], v36
    ds_read_b64_tr_b16 v[194:195], v36 offset:512
    v_mfma_f32_16x16x32_bf16 v[128:131], v[200:203], v[44:47], v[128:131]
    ds_read_b64_tr_b16 v[196:197], v37
    ds_read_b64_tr_b16 v[198:199], v37 offset:512
    v_mfma_f32_16x16x32_bf16 v[132:135], v[204:207], v[44:47], v[132:135]
    ds_read_b64_tr_b16 v[200:201], v38
    ds_read_b64_tr_b16 v[202:203], v38 offset:512
    buffer_load_dwordx4 v[44:47], v2, s[32:35], s20 offen offset:2048 sc1
    s_waitcnt vmcnt(7)
    s_waitcnt lgkmcnt(6)
    v_mfma_f32_16x16x32_bf16 v[120:123], v[208:211], v[48:51], v[120:123]
    ds_read_b64_tr_b16 v[204:205], v39
    ds_read_b64_tr_b16 v[206:207], v39 offset:512
    v_mfma_f32_16x16x32_bf16 v[124:127], v[212:215], v[48:51], v[124:127]
    ds_read_b64_tr_b16 v[208:209], v36 offset:4096
    ds_read_b64_tr_b16 v[210:211], v36 offset:4608
    v_mfma_f32_16x16x32_bf16 v[128:131], v[216:219], v[48:51], v[128:131]
    ds_read_b64_tr_b16 v[212:213], v37 offset:4096
    ds_read_b64_tr_b16 v[214:215], v37 offset:4608
    v_mfma_f32_16x16x32_bf16 v[132:135], v[220:223], v[48:51], v[132:135]
    ds_read_b64_tr_b16 v[216:217], v38 offset:4096
    ds_read_b64_tr_b16 v[218:219], v38 offset:4608
    buffer_load_dwordx4 v[48:51], v2, s[32:35], s20 offen offset:3072 sc1
    s_waitcnt vmcnt(7)
    s_waitcnt lgkmcnt(6)
    v_mfma_f32_16x16x32_bf16 v[120:123], v[192:195], v[224:227], v[120:123]
    ds_read_b64_tr_b16 v[220:221], v39 offset:4096
    ds_read_b64_tr_b16 v[222:223], v39 offset:4608
    v_mfma_f32_16x16x32_bf16 v[124:127], v[196:199], v[224:227], v[124:127]
    ds_read_b64_tr_b16 v[192:193], v36 offset:8192
    ds_read_b64_tr_b16 v[194:195], v36 offset:8704
    v_mfma_f32_16x16x32_bf16 v[128:131], v[200:203], v[224:227], v[128:131]
    ds_read_b64_tr_b16 v[196:197], v37 offset:8192
    ds_read_b64_tr_b16 v[198:199], v37 offset:8704
    v_mfma_f32_16x16x32_bf16 v[132:135], v[204:207], v[224:227], v[132:135]
    ds_read_b64_tr_b16 v[200:201], v38 offset:8192
    ds_read_b64_tr_b16 v[202:203], v38 offset:8704
    s_xor_b32 s96, s17, 16384
    s_add_u32 s20, s96, s19
    buffer_load_dwordx4 v[224:227], v2, s[32:35], s20 offen sc1
    s_waitcnt vmcnt(7)
    s_waitcnt lgkmcnt(6)
    v_mfma_f32_16x16x32_bf16 v[120:123], v[208:211], v[228:231], v[120:123]
    ds_read_b64_tr_b16 v[204:205], v39 offset:8192
    ds_read_b64_tr_b16 v[206:207], v39 offset:8704
    v_mfma_f32_16x16x32_bf16 v[124:127], v[212:215], v[228:231], v[124:127]
    ds_read_b64_tr_b16 v[208:209], v36 offset:12288
    ds_read_b64_tr_b16 v[210:211], v36 offset:12800
    v_xor_b32 v36, 16384, v36
    v_mfma_f32_16x16x32_bf16 v[128:131], v[216:219], v[228:231], v[128:131]
    ds_read_b64_tr_b16 v[212:213], v37 offset:12288
    ds_read_b64_tr_b16 v[214:215], v37 offset:12800
    v_xor_b32 v37, 16384, v37
    v_mfma_f32_16x16x32_bf16 v[132:135], v[220:223], v[228:231], v[132:135]
    ds_read_b64_tr_b16 v[216:217], v38 offset:12288
    ds_read_b64_tr_b16 v[218:219], v38 offset:12800
    v_xor_b32 v38, 16384, v38
    buffer_load_dwordx4 v[228:231], v2, s[32:35], s20 offen offset:1024 sc1
    s_waitcnt vmcnt(7)
    s_waitcnt lgkmcnt(6)
    v_mfma_f32_16x16x32_bf16 v[120:123], v[192:195], v[232:235], v[120:123]
    ds_read_b64_tr_b16 v[220:221], v39 offset:12288
    ds_read_b64_tr_b16 v[222:223], v39 offset:12800
    v_xor_b32 v39, 16384, v39
    v_mfma_f32_16x16x32_bf16 v[124:127], v[196:199], v[232:235], v[124:127]
    ds_read_b64_tr_b16 v[192:193], v36
    ds_read_b64_tr_b16 v[194:195], v36 offset:512
    v_mfma_f32_16x16x32_bf16 v[128:131], v[200:203], v[232:235], v[128:131]
    ds_read_b64_tr_b16 v[196:197], v37
    ds_read_b64_tr_b16 v[198:199], v37 offset:512
    v_mfma_f32_16x16x32_bf16 v[132:135], v[204:207], v[232:235], v[132:135]
    ds_read_b64_tr_b16 v[200:201], v38
    ds_read_b64_tr_b16 v[202:203], v38 offset:512
    buffer_load_dwordx4 v[232:235], v2, s[32:35], s20 offen offset:2048 sc1
    s_waitcnt vmcnt(7)
    s_waitcnt lgkmcnt(6)
    v_mfma_f32_16x16x32_bf16 v[120:123], v[208:211], v[236:239], v[120:123]
    ds_read_b64_tr_b16 v[204:205], v39
    ds_read_b64_tr_b16 v[206:207], v39 offset:512
    v_mfma_f32_16x16x32_bf16 v[124:127], v[212:215], v[236:239], v[124:127]
    ds_read_b64_tr_b16 v[208:209], v36 offset:4096
    ds_read_b64_tr_b16 v[210:211], v36 offset:4608
    v_mfma_f32_16x16x32_bf16 v[128:131], v[216:219], v[236:239], v[128:131]
    ds_read_b64_tr_b16 v[212:213], v37 offset:4096
    ds_read_b64_tr_b16 v[214:215], v37 offset:4608
    v_mfma_f32_16x16x32_bf16 v[132:135], v[220:223], v[236:239], v[132:135]
    ds_read_b64_tr_b16 v[216:217], v38 offset:4096
    ds_read_b64_tr_b16 v[218:219], v38 offset:4608
    buffer_load_dwordx4 v[236:239], v2, s[32:35], s20 offen offset:3072 sc1
    s_waitcnt vmcnt(7)
    s_waitcnt lgkmcnt(6)
    v_mfma_f32_16x16x32_bf16 v[120:123], v[192:195], v[240:243], v[120:123]
    ds_read_b64_tr_b16 v[220:221], v39 offset:4096
    ds_read_b64_tr_b16 v[222:223], v39 offset:4608
    v_mfma_f32_16x16x32_bf16 v[124:127], v[196:199], v[240:243], v[124:127]
    ds_read_b64_tr_b16 v[192:193], v36 offset:8192
    ds_read_b64_tr_b16 v[194:195], v36 offset:8704
    v_mfma_f32_16x16x32_bf16 v[128:131], v[200:203], v[240:243], v[128:131]
    ds_read_b64_tr_b16 v[196:197], v37 offset:8192
    ds_read_b64_tr_b16 v[198:199], v37 offset:8704
    v_mfma_f32_16x16x32_bf16 v[132:135], v[204:207], v[240:243], v[132:135]
    ds_read_b64_tr_b16 v[200:201], v38 offset:8192
    ds_read_b64_tr_b16 v[202:203], v38 offset:8704
    s_xor_b32 s96, s17, 20480
    s_add_u32 s20, s96, s19
    buffer_load_dwordx4 v[240:243], v2, s[32:35], s20 offen sc1
    s_waitcnt vmcnt(7)
    s_waitcnt lgkmcnt(6)
    v_mfma_f32_16x16x32_bf16 v[120:123], v[208:211], v[244:247], v[120:123]
    ds_read_b64_tr_b16 v[204:205], v39 offset:8192
    ds_read_b64_tr_b16 v[206:207], v39 offset:8704
    v_mfma_f32_16x16x32_bf16 v[124:127], v[212:215], v[244:247], v[124:127]
    ds_read_b64_tr_b16 v[208:209], v36 offset:12288
    ds_read_b64_tr_b16 v[210:211], v36 offset:12800
    v_xor_b32 v36, 114688, v36
    v_mfma_f32_16x16x32_bf16 v[128:131], v[216:219], v[244:247], v[128:131]
    ds_read_b64_tr_b16 v[212:213], v37 offset:12288
    ds_read_b64_tr_b16 v[214:215], v37 offset:12800
    v_xor_b32 v37, 114688, v37
    v_mfma_f32_16x16x32_bf16 v[132:135], v[220:223], v[244:247], v[132:135]
    ds_read_b64_tr_b16 v[216:217], v38 offset:12288
    ds_read_b64_tr_b16 v[218:219], v38 offset:12800
    v_xor_b32 v38, 114688, v38
    buffer_load_dwordx4 v[244:247], v2, s[32:35], s20 offen offset:1024 sc1
L_PAD8:
    s_cbranch_execz L_RET8
    s_waitcnt vmcnt(7)
    s_waitcnt lgkmcnt(6)
    v_mfma_f32_16x16x32_bf16 v[120:123], v[192:195], v[44:47], v[120:123]
    ds_read_b64_tr_b16 v[220:221], v39 offset:12288
    ds_read_b64_tr_b16 v[222:223], v39 offset:12800
    v_xor_b32 v39, 114688, v39
    v_mfma_f32_16x16x32_bf16 v[124:127], v[196:199], v[44:47], v[124:127]
    ds_read_b64_tr_b16 v[192:193], v36
    ds_read_b64_tr_b16 v[194:195], v36 offset:512
    v_mfma_f32_16x16x32_bf16 v[128:131], v[200:203], v[44:47], v[128:131]
    ds_read_b64_tr_b16 v[196:197], v37
    ds_read_b64_tr_b16 v[198:199], v37 offset:512
    v_mfma_f32_16x16x32_bf16 v[132:135], v[204:207], v[44:47], v[132:135]
    ds_read_b64_tr_b16 v[200:201], v38
    ds_read_b64_tr_b16 v[202:203], v38 offset:512
    buffer_load_dwordx4 v[44:47], v2, s[32:35], s20 offen offset:2048 sc1
    s_waitcnt vmcnt(7)
    s_waitcnt lgkmcnt(6)
    v_mfma_f32_16x16x32_bf16 v[120:123], v[208:211], v[48:51], v[120:123]
    ds_read_b64_tr_b16 v[204:205], v39
    ds_read_b64_tr_b16 v[206:207], v39 offset:512
    v_mfma_f32_16x16x32_bf16 v[124:127], v[212:215], v[48:51], v[124:127]
    ds_read_b64_tr_b16 v[208:209], v36 offset:4096
    ds_read_b64_tr_b16 v[210:211], v36 offset:4608
    v_mfma_f32_16x16x32_bf16 v[128:131], v[216:219], v[48:51], v[128:131]
    ds_read_b64_tr_b16 v[212:213], v37 offset:4096
    ds_read_b64_tr_b16 v[214:215], v37 offset:4608
    v_mfma_f32_16x16x32_bf16 v[132:135], v[220:223], v[48:51], v[132:135]
    ds_read_b64_tr_b16 v[216:217], v38 offset:4096
    ds_read_b64_tr_b16 v[218:219], v38 offset:4608
    buffer_load_dwordx4 v[48:51], v2, s[32:35], s20 offen offset:3072 sc1
    s_waitcnt vmcnt(7)
    s_waitcnt lgkmcnt(6)
    v_mfma_f32_16x16x32_bf16 v[120:123], v[192:195], v[224:227], v[120:123]
    ds_read_b64_tr_b16 v[220:221], v39 offset:4096
    ds_read_b64_tr_b16 v[222:223], v39 offset:4608
    v_mfma_f32_16x16x32_bf16 v[124:127], v[196:199], v[224:227], v[124:127]
    ds_read_b64_tr_b16 v[192:193], v36 offset:8192
    ds_read_b64_tr_b16 v[194:195], v36 offset:8704
    v_mfma_f32_16x16x32_bf16 v[128:131], v[200:203], v[224:227], v[128:131]
    ds_read_b64_tr_b16 v[196:197], v37 offset:8192
    ds_read_b64_tr_b16 v[198:199], v37 offset:8704
    v_mfma_f32_16x16x32_bf16 v[132:135], v[204:207], v[224:227], v[132:135]
    ds_read_b64_tr_b16 v[200:201], v38 offset:8192
    ds_read_b64_tr_b16 v[202:203], v38 offset:8704
    s_xor_b32 s96, s17, 24576
    s_add_u32 s20, s96, s19
    buffer_load_dwordx4 v[224:227], v2, s[32:35], s20 offen sc1
    s_waitcnt vmcnt(7)
    s_waitcnt lgkmcnt(6)
    v_mfma_f32_16x16x32_bf16 v[120:123], v[208:211], v[228:231], v[120:123]
    ds_read_b64_tr_b16 v[204:205], v39 offset:8192
    ds_read_b64_tr_b16 v[206:207], v39 offset:8704
    v_mfma_f32_16x16x32_bf16 v[124:127], v[212:215], v[228:231], v[124:127]
    ds_read_b64_tr_b16 v[208:209], v36 offset:12288
    ds_read_b64_tr_b16 v[210:211], v36 offset:12800
    v_xor_b32 v36, 16384, v36
    v_mfma_f32_16x16x32_bf16 v[128:131], v[216:219], v[228:231], v[128:131]
    ds_read_b64_tr_b16 v[212:213], v37 offset:12288
    ds_read_b64_tr_b16 v[214:215], v37 offset:12800
    v_xor_b32 v37, 16384, v37
    v_mfma_f32_16x16x32_bf16 v[132:135], v[220:223], v[228:231], v[132:135]
    ds_read_b64_tr_b16 v[216:217], v38 offset:12288
    ds_read_b64_tr_b16 v[218:219], v38 offset:12800
    v_xor_b32 v38, 16384, v38
    buffer_load_dwordx4 v[228:231], v2, s[32:35], s20 offen offset:1024 sc1
    s_waitcnt vmcnt(7)
    s_waitcnt lgkmcnt(6)
    v_mfma_f32_16x16x32_bf16 v[120:123], v[192:195], v[232:235], v[120:123]
    ds_read_b64_tr_b16 v[220:221], v39 offset:12288
    ds_read_b64_tr_b16 v[222:223], v39 offset:12800
    v_xor_b32 v39, 16384, v39
    v_mfma_f32_16x16x32_bf16 v[124:127], v[196:199], v[232:235], v[124:127]
    ds_read_b64_tr_b16 v[192:193], v36
    ds_read_b64_tr_b16 v[194:195], v36 offset:512
    v_mfma_f32_16x16x32_bf16 v[128:131], v[200:203], v[232:235], v[128:131]
    ds_read_b64_tr_b16 v[196:197], v37
    ds_read_b64_tr_b16 v[198:199], v37 offset:512
    v_mfma_f32_16x16x32_bf16 v[132:135], v[204:207], v[232:235], v[132:135]
    ds_read_b64_tr_b16 v[200:201], v38
    ds_read_b64_tr_b16 v[202:203], v38 offset:512
    buffer_load_dwordx4 v[232:235], v2, s[32:35], s20 offen offset:2048 sc1
    s_waitcnt vmcnt(7)
    s_waitcnt lgkmcnt(6)
    v_mfma_f32_16x16x32_bf16 v[120:123], v[208:211], v[236:239], v[120:123]
    ds_read_b64_tr_b16 v[204:205], v39
    ds_read_b64_tr_b16 v[206:207], v39 offset:512
    v_mfma_f32_16x16x32_bf16 v[124:127], v[212:215], v[236:239], v[124:127]
    ds_read_b64_tr_b16 v[208:209], v36 offset:4096
    ds_read_b64_tr_b16 v[210:211], v36 offset:4608
    v_mfma_f32_16x16x32_bf16 v[128:131], v[216:219], v[236:239], v[128:131]
    ds_read_b64_tr_b16 v[212:213], v37 offset:4096
    ds_read_b64_tr_b16 v[214:215], v37 offset:4608
    v_mfma_f32_16x16x32_bf16 v[132:135], v[220:223], v[236:239], v[132:135]
    ds_read_b64_tr_b16 v[216:217], v38 offset:4096
    ds_read_b64_tr_b16 v[218:219], v38 offset:4608
    buffer_load_dwordx4 v[236:239], v2, s[32:35], s20 offen offset:3072 sc1
    s_waitcnt vmcnt(7)
    s_waitcnt lgkmcnt(6)
    v_mfma_f32_16x16x32_bf16 v[120:123], v[192:195], v[240:243], v[120:123]
    ds_read_b64_tr_b16 v[220:221], v39 offset:4096
    ds_read_b64_tr_b16 v[222:223], v39 offset:4608
    v_mfma_f32_16x16x32_bf16 v[124:127], v[196:199], v[240:243], v[124:127]
    ds_read_b64_tr_b16 v[192:193], v36 offset:8192
    ds_read_b64_tr_b16 v[194:195], v36 offset:8704
    v_mfma_f32_16x16x32_bf16 v[128:131], v[200:203], v[240:243], v[128:131]
    ds_read_b64_tr_b16 v[196:197], v37 offset:8192
    ds_read_b64_tr_b16 v[198:199], v37 offset:8704
    v_mfma_f32_16x16x32_bf16 v[132:135], v[204:207], v[240:243], v[132:135]
    ds_read_b64_tr_b16 v[200:201], v38 offset:8192
    ds_read_b64_tr_b16 v[202:203], v38 offset:8704
    s_xor_b32 s96, s17, 28672
    s_add_u32 s20, s96, s19
    buffer_load_dwordx4 v[240:243], v2, s[32:35], s20 offen sc1
    s_waitcnt vmcnt(7)
    s_waitcnt lgkmcnt(6)
    v_mfma_f32_16x16x32_bf16 v[120:123], v[208:211], v[244:247], v[120:123]
    ds_read_b64_tr_b16 v[204:205], v39 offset:8192
    ds_read_b64_tr_b16 v[206:207], v39 offset:8704
    v_mfma_f32_16x16x32_bf16 v[124:127], v[212:215], v[244:247], v[124:127]
    ds_read_b64_tr_b16 v[208:209], v36 offset:12288
    ds_read_b64_tr_b16 v[210:211], v36 offset:12800
    v_xor_b32 v36, 49152, v36
    v_mfma_f32_16x16x32_bf16 v[128:131], v[216:219], v[244:247], v[128:131]
    ds_read_b64_tr_b16 v[212:213], v37 offset:12288
    ds_read_b64_tr_b16 v[214:215], v37 offset:12800
    v_xor_b32 v37, 49152, v37
    v_mfma_f32_16x16x32_bf16 v[132:135], v[220:223], v[244:247], v[132:135]
    ds_read_b64_tr_b16 v[216:217], v38 offset:12288
    ds_read_b64_tr_b16 v[218:219], v38 offset:12800
    v_xor_b32 v38, 49152, v38
    buffer_load_dwordx4 v[244:247], v2, s[32:35], s20 offen offset:1024 sc1
    s_waitcnt vmcnt(7)
    s_waitcnt lgkmcnt(6)
    v_mfma_f32_16x16x32_bf16 v[120:123], v[192:195], v[44:47], v[120:123]
    ds_read_b64_tr_b16 v[220:221], v39 offset:12288
    ds_read_b64_tr_b16 v[222:223], v39 offset:12800
    v_xor_b32 v39, 49152, v39
    v_mfma_f32_16x16x32_bf16 v[124:127], v[196:199], v[44:47], v[124:127]
    ds_read_b64_tr_b16 v[192:193], v36
    ds_read_b64_tr_b16 v[194:195], v36 offset:512
    v_mfma_f32_16x16x32_bf16 v[128:131], v[200:203], v[44:47], v[128:131]
    ds_read_b64_tr_b16 v[196:197], v37
    ds_read_b64_tr_b16 v[198:199], v37 offset:512
    v_mfma_f32_16x16x32_bf16 v[132:135], v[204:207], v[44:47], v[132:135]
    ds_read_b64_tr_b16 v[200:201], v38
    ds_read_b64_tr_b16 v[202:203], v38 offset:512
    buffer_load_dwordx4 v[44:47], v2, s[32:35], s20 offen offset:2048 sc1
    s_waitcnt vmcnt(7)
    s_waitcnt lgkmcnt(6)
    v_mfma_f32_16x16x32_bf16 v[120:123], v[208:211], v[48:51], v[120:123]
    ds_read_b64_tr_b16 v[204:205], v39
    ds_read_b64_tr_b16 v[206:207], v39 offset:512
    v_mfma_f32_16x16x32_bf16 v[124:127], v[212:215], v[48:51], v[124:127]
    ds_read_b64_tr_b16 v[208:209], v36 offset:4096
    ds_read_b64_tr_b16 v[210:211], v36 offset:4608
    v_mfma_f32_16x16x32_bf16 v[128:131], v[216:219], v[48:51], v[128:131]
    ds_read_b64_tr_b16 v[212:213], v37 offset:4096
    ds_read_b64_tr_b16 v[214:215], v37 offset:4608
    v_mfma_f32_16x16x32_bf16 v[132:135], v[220:223], v[48:51], v[132:135]
    ds_read_b64_tr_b16 v[216:217], v38 offset:4096
    ds_read_b64_tr_b16 v[218:219], v38 offset:4608
    buffer_load_dwordx4 v[48:51], v2, s[32:35], s20 offen offset:3072 sc1
    buffer_load_dwordx2 v[40:41], v10, s[32:35], s13 offen sc1
    s_add_u32 s82, s80, 114688
    buffer_load_dwordx4 v[72:75], v27, s[52:55], s82 offen nt
    s_add_u32 s82, s80, 172032
    buffer_load_dwordx4 v[76:79], v27, s[52:55], s82 offen nt
    s_waitcnt vmcnt(10)
    s_waitcnt lgkmcnt(6)
    v_mfma_f32_16x16x32_bf16 v[120:123], v[192:195], v[224:227], v[120:123]
    ds_read_b64_tr_b16 v[220:221], v39 offset:4096
    ds_read_b64_tr_b16 v[222:223], v39 offset:4608
    v_mfma_f32_16x16x32_bf16 v[124:127], v[196:199], v[224:227], v[124:127]
    ds_read_b64_tr_b16 v[192:193], v36 offset:8192
    ds_read_b64_tr_b16 v[194:195], v36 offset:8704
    v_mfma_f32_16x16x32_bf16 v[128:131], v[200:203], v[224:227], v[128:131]
    ds_read_b64_tr_b16 v[196:197], v37 offset:8192
    ds_read_b64_tr_b16 v[198:199], v37 offset:8704
    v_mfma_f32_16x16x32_bf16 v[132:135], v[204:207], v[224:227], v[132:135]
    ds_read_b64_tr_b16 v[200:201], v38 offset:8192
    ds_read_b64_tr_b16 v[202:203], v38 offset:8704
    s_waitcnt vmcnt(9)
    s_waitcnt lgkmcnt(6)
    v_mfma_f32_16x16x32_bf16 v[120:123], v[208:211], v[228:231], v[120:123]
    ds_read_b64_tr_b16 v[204:205], v39 offset:8192
    ds_read_b64_tr_b16 v[206:207], v39 offset:8704
    v_mfma_f32_16x16x32_bf16 v[124:127], v[212:215], v[228:231], v[124:127]
    ds_read_b64_tr_b16 v[208:209], v36 offset:12288
    ds_read_b64_tr_b16 v[210:211], v36 offset:12800
    v_xor_b32 v36, 16384, v36
    v_mfma_f32_16x16x32_bf16 v[128:131], v[216:219], v[228:231], v[128:131]
    ds_read_b64_tr_b16 v[212:213], v37 offset:12288
    ds_read_b64_tr_b16 v[214:215], v37 offset:12800
    v_xor_b32 v37, 16384, v37
    v_mfma_f32_16x16x32_bf16 v[132:135], v[220:223], v[228:231], v[132:135]
    ds_read_b64_tr_b16 v[216:217], v38 offset:12288
    ds_read_b64_tr_b16 v[218:219], v38 offset:12800
    v_xor_b32 v38, 16384, v38
    s_waitcnt vmcnt(8)
    s_waitcnt lgkmcnt(6)
    v_mfma_f32_16x16x32_bf16 v[120:123], v[192:195], v[232:235], v[120:123]
    ds_read_b64_tr_b16 v[220:221], v39 offset:12288
    ds_read_b64_tr_b16 v[222:223], v39 offset:12800
    v_xor_b32 v39, 16384, v39
    v_mfma_f32_16x16x32_bf16 v[124:127], v[196:199], v[232:235], v[124:127]
    ds_read_b64_tr_b16 v[192:193], v36
    ds_read_b64_tr_b16 v[194:195], v36 offset:512
    v_mfma_f32_16x16x32_bf16 v[128:131], v[200:203], v[232:235], v[128:131]
    ds_read_b64_tr_b16 v[196:197], v37
    ds_read_b64_tr_b16 v[198:199], v37 offset:512
    v_mfma_f32_16x16x32_bf16 v[132:135], v[204:207], v[232:235], v[132:135]
    ds_read_b64_tr_b16 v[200:201], v38
    ds_read_b64_tr_b16 v[202:203], v38 offset:512
    s_waitcnt vmcnt(7)
    s_waitcnt lgkmcnt(6)
    v_mfma_f32_16x16x32_bf16 v[120:123], v[208:211], v[236:239], v[120:123]
    ds_read_b64_tr_b16 v[204:205], v39
    ds_read_b64_tr_b16 v[206:207], v39 offset:512
    v_mfma_f32_16x16x32_bf16 v[124:127], v[212:215], v[236:239], v[124:127]
    ds_read_b64_tr_b16 v[208:209], v36 offset:4096
    ds_read_b64_tr_b16 v[210:211], v36 offset:4608
    v_mfma_f32_16x16x32_bf16 v[128:131], v[216:219], v[236:239], v[128:131]
    ds_read_b64_tr_b16 v[212:213], v37 offset:4096
    ds_read_b64_tr_b16 v[214:215], v37 offset:4608
    v_mfma_f32_16x16x32_bf16 v[132:135], v[220:223], v[236:239], v[132:135]
    ds_read_b64_tr_b16 v[216:217], v38 offset:4096
    ds_read_b64_tr_b16 v[218:219], v38 offset:4608
    s_cmp_lt_u32 s3, 4
    s_cbranch_scc1 L_G2P28
    s_setprio 0
L_G2P28:
    s_waitcnt vmcnt(6)
    s_waitcnt lgkmcnt(6)
    v_mfma_f32_16x16x32_bf16 v[120:123], v[192:195], v[240:243], v[120:123]
    ds_read_b64_tr_b16 v[220:221], v39 offset:4096
    ds_read_b64_tr_b16 v[222:223], v39 offset:4608
    v_mfma_f32_16x16x32_bf16 v[124:127], v[196:199], v[240:243], v[124:127]
    ds_read_b64_tr_b16 v[192:193], v36 offset:8192
    ds_read_b64_tr_b16 v[194:195], v36 offset:8704
    v_mfma_f32_16x16x32_bf16 v[128:131], v[200:203], v[240:243], v[128:131]
    ds_read_b64_tr_b16 v[196:197], v37 offset:8192
    ds_read_b64_tr_b16 v[198:199], v37 offset:8704
    v_mfma_f32_16x16x32_bf16 v[132:135], v[204:207], v[240:243], v[132:135]
    ds_read_b64_tr_b16 v[200:201], v38 offset:8192
    ds_read_b64_tr_b16 v[202:203], v38 offset:8704
    s_waitcnt vmcnt(5)
    s_waitcnt lgkmcnt(6)
    v_mfma_f32_16x16x32_bf16 v[120:123], v[208:211], v[244:247], v[120:123]
    ds_read_b64_tr_b16 v[204:205], v39 offset:8192
    ds_read_b64_tr_b16 v[206:207], v39 offset:8704
    v_mfma_f32_16x16x32_bf16 v[124:127], v[212:215], v[244:247], v[124:127]
    ds_read_b64_tr_b16 v[208:209], v36 offset:12288
    ds_read_b64_tr_b16 v[210:211], v36 offset:12800
    v_mfma_f32_16x16x32_bf16 v[128:131], v[216:219], v[244:247], v[128:131]
    ds_read_b64_tr_b16 v[212:213], v37 offset:12288
    ds_read_b64_tr_b16 v[214:215], v37 offset:12800
    v_mfma_f32_16x16x32_bf16 v[132:135], v[220:223], v[244:247], v[132:135]
    ds_read_b64_tr_b16 v[216:217], v38 offset:12288
    ds_read_b64_tr_b16 v[218:219], v38 offset:12800
    s_waitcnt vmcnt(4)
    s_waitcnt lgkmcnt(6)
    v_mfma_f32_16x16x32_bf16 v[120:123], v[192:195], v[44:47], v[120:123]
    ds_read_b64_tr_b16 v[220:221], v39 offset:12288
    ds_read_b64_tr_b16 v[222:223], v39 offset:12800
    v_mfma_f32_16x16x32_bf16 v[124:127], v[196:199], v[44:47], v[124:127]
    v_mfma_f32_16x16x32_bf16 v[128:131], v[200:203], v[44:47], v[128:131]
    v_mfma_f32_16x16x32_bf16 v[132:135], v[204:207], v[44:47], v[132:135]
    s_waitcnt vmcnt(3)
    s_waitcnt lgkmcnt(0)
    v_mfma_f32_16x16x32_bf16 v[120:123], v[208:211], v[48:51], v[120:123]
    v_mfma_f32_16x16x32_bf16 v[124:127], v[212:215], v[48:51], v[124:127]
    v_mfma_f32_16x16x32_bf16 v[128:131], v[216:219], v[48:51], v[128:131]
    v_mfma_f32_16x16x32_bf16 v[132:135], v[220:223], v[48:51], v[132:135]
    s_lshl3_add_u32 s96, s21, s3
    s_lshl4_add_u32 s97, s96, s12
    s_lshl_b32 s98, s97, 8
    s_add_u32 s14, s98, 12582912
    v_and_b32 v28, 15, v1
    v_lshlrev_b32 v28, 4, v28
    v_lshrrev_b32 v9, 4, v1
    v_lshl_add_u32 v28, v9, 2, v28
    v_cvt_pk_bf16_f32 v120, 0, v120
    v_cvt_pk_bf16_f32 v121, 0, v121
    v_cvt_pk_bf16_f32 v122, 0, v122
    v_cvt_pk_bf16_f32 v123, 0, v123
    v_cvt_pk_bf16_f32 v124, 0, v124
    v_cvt_pk_bf16_f32 v125, 0, v125
    v_cvt_pk_bf16_f32 v126, 0, v126
    v_cvt_pk_bf16_f32 v127, 0, v127
    v_pk_mul_f32 v[120:121], v[120:121], v[136:137]
    v_pk_mul_f32 v[122:123], v[122:123], v[138:139]
    v_pk_mul_f32 v[124:125], v[124:125], v[140:141]
    v_pk_mul_f32 v[126:127], v[126:127], v[142:143]
    v_cvt_pk_bf16_f32 v120, 0, v120
    v_cvt_pk_bf16_f32 v121, 0, v121
    v_cvt_pk_bf16_f32 v122, 0, v122
    v_cvt_pk_bf16_f32 v123, 0, v123
    v_cvt_pk_bf16_f32 v124, 0, v124
    v_cvt_pk_bf16_f32 v125, 0, v125
    v_cvt_pk_bf16_f32 v126, 0, v126
    v_cvt_pk_bf16_f32 v127, 0, v127
    v_pk_add_f32 v[120:121], v[120:121], v[152:153]
    v_pk_add_f32 v[122:123], v[122:123], v[154:155]
    v_pk_add_f32 v[124:125], v[124:125], v[156:157]
    v_pk_add_f32 v[126:127], v[126:127], v[158:159]
    v_cvt_pk_bf16_f32 v12, v120, v121
    v_cvt_pk_bf16_f32 v13, v122, v123
    v_cvt_pk_bf16_f32 v14, v124, v125
    v_cvt_pk_bf16_f32 v15, v126, v127
    v_dot2_f32_bf16 v4, v12, v12, 0
    v_dot2_f32_bf16 v5, v13, v13, 0
    v_dot2_f32_bf16 v4, v14, v14, v4
    v_dot2_f32_bf16 v5, v15, v15, v5
    v_mfma_f32_16x16x32_bf16 v[240:243], v[184:187], v[12:15], 0
    v_cvt_pk_bf16_f32 v128, 0, v128
    v_cvt_pk_bf16_f32 v129, 0, v129
    v_cvt_pk_bf16_f32 v130, 0, v130
    v_cvt_pk_bf16_f32 v131, 0, v131
    v_cvt_pk_bf16_f32 v132, 0, v132
    v_cvt_pk_bf16_f32 v133, 0, v133
    v_cvt_pk_bf16_f32 v134, 0, v134
    v_cvt_pk_bf16_f32 v135, 0, v135
    v_pk_mul_f32 v[128:129], v[128:129], v[144:145]
    v_pk_mul_f32 v[130:131], v[130:131], v[146:147]
    v_pk_mul_f32 v[132:133], v[132:133], v[148:149]
    v_pk_mul_f32 v[134:135], v[134:135], v[150:151]
    v_cvt_pk_bf16_f32 v128, 0, v128
    v_cvt_pk_bf16_f32 v129, 0, v129
    v_cvt_pk_bf16_f32 v130, 0, v130
    v_cvt_pk_bf16_f32 v131, 0, v131
    v_cvt_pk_bf16_f32 v132, 0, v132
    v_cvt_pk_bf16_f32 v133, 0, v133
    v_cvt_pk_bf16_f32 v134, 0, v134
    v_cvt_pk_bf16_f32 v135, 0, v135
    v_pk_add_f32 v[128:129], v[128:129], v[160:161]
    v_pk_add_f32 v[130:131], v[130:131], v[162:163]
    v_pk_add_f32 v[132:133], v[132:133], v[164:165]
    v_pk_add_f32 v[134:135], v[134:135], v[166:167]
    v_cvt_pk_bf16_f32 v16, v128, v129
    v_cvt_pk_bf16_f32 v17, v130, v131
    v_cvt_pk_bf16_f32 v18, v132, v133
    v_cvt_pk_bf16_f32 v19, v134, v135
    v_dot2_f32_bf16 v4, v16, v16, v4
    v_dot2_f32_bf16 v5, v17, v17, v5
    v_dot2_f32_bf16 v4, v18, v18, v4
    v_dot2_f32_bf16 v5, v19, v19, v5
    v_mfma_f32_16x16x32_bf16 v[240:243], v[188:191], v[16:19], v[240:243]
    v_and_b32 v7, 7, v1
    v_lshlrev_b32 v7, 15, v7
    v_bfe_u32 v9, v1, 3, 1
    v_lshl_add_u32 v7, v9, 12, v7
    v_add_f32 v4, v4, v5
    v_mov_b32 v5, v4
    s_nop 1
    v_permlane32_swap_b32 v4, v5
    v_add_f32 v4, v4, v5
    v_mov_b32 v5, v4
    s_nop 1
    v_permlane16_swap_b32 v4, v5
    v_add_f32 v4, v4, v5
    s_nop 1
    v_mov_b32_dpp v240, v4 quad_perm:[0,1,2,3] row_mask:0x8 bank_mask:0xf
    buffer_store_dword v240, v28, s[32:35], s14 offen sc1
    s_and_b32 s96, s12, 1
    s_lshr_b32 s97, s21, 2
    s_and_b32 s98, s21, 3
    s_lshl_b32 s99, s98, 6
    s_lshl1_add_u32 s98, s97, s99
    s_lshl_b32 s97, s98, 12
    s_lshr_b32 s99, s12, 1
    s_lshl_b32 s98, s99, 6
    s_add_u32 s99, s97, s98
    s_lshl2_add_u32 s97, s96, s99
    s_add_u32 s98, s97, 1048576
    s_add_u32 s16, s98, 1536
    s_barrier
    s_cmp_lg_u32 s3, 0
    s_cbranch_scc1 L_PE
    v_mov_b32 v6, s4
    s_mov_b32 exec_hi, 0
    s_mov_b32 exec_lo, 65535
    buffer_store_dword v6, v7, s[32:35], s16 offen sc1
    s_mov_b64 exec, -1
L_PE:
    s_mov_b32 s82, s80
    s_lshl2_add_u32 m0, s83, 32768
    s_nop 0
    buffer_load_dwordx4 v27, s[56:59], s82 offen nt lds
    s_add_u32 s82, s80, 57344
    s_lshl2_add_u32 m0, s83, 33792
    s_nop 0
    buffer_load_dwordx4 v27, s[56:59], s82 offen nt lds
    s_lshl_b32 s15, s3, 12
    v_add_u32 v4, s15, v2
    v_add_u32 v7, 65536, v4
    s_waitcnt vmcnt(5)
    v_cmp_ne_u32 vcc, s4, v41
    s_cbranch_vccz L_UPOK
POLL_31:
    buffer_load_dwordx2 v[40:41], v10, s[32:35], s13 offen sc1
    s_waitcnt vmcnt(0)
    v_cmp_ne_u32 vcc, s4, v41
    s_cbranch_vccz PDONE_32
    s_add_u32 s5, s5, 1
    s_cmp_lt_u32 s5, 200000
    s_cbranch_scc1 POLL_31
PDONE_32:
L_UPOK:
    s_lshl3_add_u32 s96, s21, s3
    s_lshl_b32 s97, s96, 12
    s_add_u32 s14, s97, 12582912
    s_load_dwordx2 s[24:25], s[32:33], s92 offset:1536 glc
    v_add_f32_dpp v40, v40, v40 quad_perm:[1,0,3,2] row_mask:0xf bank_mask:0xf
    s_nop 1
    v_add_f32_dpp v40, v40, v40 quad_perm:[2,3,0,1] row_mask:0xf bank_mask:0xf
    s_nop 1
    v_add_f32_dpp v40, v40, v40 row_half_mirror row_mask:0xf bank_mask:0xf
    s_nop 1
    v_add_f32_dpp v40, v40, v40 row_mirror row_mask:0xf bank_mask:0xf
    v_lshlrev_b32 v152, 16, v12
    v_and_b32 v153, s6, v12
    v_lshlrev_b32 v154, 16, v13
    v_and_b32 v155, s6, v13
    v_lshlrev_b32 v156, 16, v14
    v_and_b32 v157, s6, v14
    v_lshlrev_b32 v158, 16, v15
    v_and_b32 v159, s6, v15
    v_lshlrev_b32 v160, 16, v16
    v_and_b32 v161, s6, v16
    v_lshlrev_b32 v162, 16, v17
    v_and_b32 v163, s6, v17
    v_lshlrev_b32 v164, 16, v18
    v_and_b32 v165, s6, v18
    v_lshlrev_b32 v166, 16, v19
    v_and_b32 v167, s6, v19
    s_lshl_b32 s96, s3, 9
    s_lshl1_add_u32 s15, s21, s96
    v_and_b32 v29, 15, v1
    v_lshl_add_u32 v29, v29, 5, s15
    v_xor_b32 v5, 0x4000, v4
    v_xor_b32 v8, 0x4000, v7
    s_waitcnt vmcnt(3)
    ds_write_b128 v4, v[72:75] offset:2048
    ds_write_b128 v4, v[76:79] offset:3072
    s_cmp_lt_u32 s3, 4
    s_cbranch_scc1 L_FW1
    ds_write_b128 v4, v[56:59] offset:0
    ds_write_b128 v5, v[60:63] offset:0
    ds_write_b128 v4, v[64:67] offset:1024
    ds_write_b128 v5, v[68:71] offset:1024
L_FW1:
    s_branch SCHK_34
SPOLL_33:
    s_load_dwordx2 s[24:25], s[32:33], s92 offset:1536 glc
SCHK_34:
    s_add_u32 s5, s5, 1
    s_cmp_ge_u32 s5, 200000
    s_waitcnt lgkmcnt(0)
    s_cbranch_scc1 SDONE_35
    s_cmp_lg_u32 s24, s4
    s_cbranch_scc1 SPOLL_33
    s_cmp_lg_u32 s25, s4
    s_cbranch_scc1 SPOLL_33
SDONE_35:
    s_barrier
    buffer_load_dwordx4 v[192:195], v2, s[32:35], s14 offen sc1
    buffer_load_dwordx4 v[196:199], v2, s[32:35], s14 offen offset:1024 sc1
    buffer_load_dwordx4 v[200:203], v2, s[32:35], s14 offen offset:2048 sc1
    buffer_load_dwordx4 v[204:207], v2, s[32:35], s14 offen offset:3072 sc1
    s_barrier
    s_add_u32 s82, s80, 114688
    s_lshl2_add_u32 m0, s83, 34816
    s_nop 0
    buffer_load_dwordx4 v27, s[56:59], s82 offen nt lds
    s_add_u32 s82, s80, 172032
    s_lshl2_add_u32 m0, s83, 35840
    s_nop 0
    buffer_load_dwordx4 v27, s[56:59], s82 offen nt lds
    v_mov_b32_dpp v168, v33 row_newbcast:0 row_mask:0xf bank_mask:0xf
    v_mov_b32_dpp v169, v33 row_newbcast:1 row_mask:0xf bank_mask:0xf
    v_mov_b32_dpp v170, v33 row_newbcast:2 row_mask:0xf bank_mask:0xf
    v_mov_b32_dpp v171, v33 row_newbcast:3 row_mask:0xf bank_mask:0xf
    v_mov_b32_dpp v172, v33 row_newbcast:4 row_mask:0xf bank_mask:0xf
    v_mov_b32_dpp v173, v33 row_newbcast:5 row_mask:0xf bank_mask:0xf
    v_mov_b32_dpp v174, v33 row_newbcast:6 row_mask:0xf bank_mask:0xf
    v_mov_b32_dpp v175, v33 row_newbcast:7 row_mask:0xf bank_mask:0xf
    v_mov_b32_dpp v176, v33 row_newbcast:8 row_mask:0xf bank_mask:0xf
    v_mov_b32_dpp v177, v33 row_newbcast:9 row_mask:0xf bank_mask:0xf
    v_mov_b32_dpp v178, v33 row_newbcast:10 row_mask:0xf bank_mask:0xf
    v_mov_b32_dpp v179, v33 row_newbcast:11 row_mask:0xf bank_mask:0xf
    v_mov_b32_dpp v180, v33 row_newbcast:12 row_mask:0xf bank_mask:0xf
    v_mov_b32_dpp v181, v33 row_newbcast:13 row_mask:0xf bank_mask:0xf
    v_mov_b32_dpp v182, v33 row_newbcast:14 row_mask:0xf bank_mask:0xf
    v_mov_b32_dpp v183, v33 row_newbcast:15 row_mask:0xf bank_mask:0xf
    v_mov_b32_dpp v88, v42 row_newbcast:0 row_mask:0xf bank_mask:0xf
    v_mov_b32_dpp v89, v42 row_newbcast:1 row_mask:0xf bank_mask:0xf
    v_mov_b32_dpp v90, v42 row_newbcast:2 row_mask:0xf bank_mask:0xf
    v_mov_b32_dpp v91, v42 row_newbcast:3 row_mask:0xf bank_mask:0xf
    v_mov_b32_dpp v92, v42 row_newbcast:4 row_mask:0xf bank_mask:0xf
    v_mov_b32_dpp v93, v42 row_newbcast:5 row_mask:0xf bank_mask:0xf
    v_mov_b32_dpp v94, v42 row_newbcast:6 row_mask:0xf bank_mask:0xf
    v_mov_b32_dpp v95, v42 row_newbcast:7 row_mask:0xf bank_mask:0xf
    v_mov_b32_dpp v96, v42 row_newbcast:8 row_mask:0xf bank_mask:0xf
    v_mov_b32_dpp v97, v42 row_newbcast:9 row_mask:0xf bank_mask:0xf
    v_mov_b32_dpp v98, v42 row_newbcast:10 row_mask:0xf bank_mask:0xf
    v_mov_b32_dpp v99, v42 row_newbcast:11 row_mask:0xf bank_mask:0xf
    v_mov_b32_dpp v100, v42 row_newbcast:12 row_mask:0xf bank_mask:0xf
    v_mov_b32_dpp v101, v42 row_newbcast:13 row_mask:0xf bank_mask:0xf
    v_mov_b32_dpp v102, v42 row_newbcast:14 row_mask:0xf bank_mask:0xf
    v_mov_b32_dpp v103, v42 row_newbcast:15 row_mask:0xf bank_mask:0xf
    v_mov_b32_dpp v104, v43 row_newbcast:0 row_mask:0xf bank_mask:0xf
    v_mov_b32_dpp v105, v43 row_newbcast:1 row_mask:0xf bank_mask:0xf
    v_mov_b32_dpp v106, v43 row_newbcast:2 row_mask:0xf bank_mask:0xf
    v_mov_b32_dpp v107, v43 row_newbcast:3 row_mask:0xf bank_mask:0xf
    v_mov_b32_dpp v108, v43 row_newbcast:4 row_mask:0xf bank_mask:0xf
    v_mov_b32_dpp v109, v43 row_newbcast:5 row_mask:0xf bank_mask:0xf
    v_mov_b32_dpp v110, v43 row_newbcast:6 row_mask:0xf bank_mask:0xf
    v_mov_b32_dpp v111, v43 row_newbcast:7 row_mask:0xf bank_mask:0xf
    v_mov_b32_dpp v112, v43 row_newbcast:8 row_mask:0xf bank_mask:0xf
    v_mov_b32_dpp v113, v43 row_newbcast:9 row_mask:0xf bank_mask:0xf
    v_mov_b32_dpp v114, v43 row_newbcast:10 row_mask:0xf bank_mask:0xf
    v_mov_b32_dpp v115, v43 row_newbcast:11 row_mask:0xf bank_mask:0xf
    v_mov_b32_dpp v116, v43 row_newbcast:12 row_mask:0xf bank_mask:0xf
    v_mov_b32_dpp v117, v43 row_newbcast:13 row_mask:0xf bank_mask:0xf
    v_mov_b32_dpp v118, v43 row_newbcast:14 row_mask:0xf bank_mask:0xf
    v_mov_b32_dpp v119, v43 row_newbcast:15 row_mask:0xf bank_mask:0xf
    s_lshl3_add_u32 s15, s3, 156160
    v_mov_b32 v4, s15
    v_and_b32 v5, 7, v1
    v_lshlrev_b32 v5, 3, v5
    v_add_u32 v5, 156160, v5
    v_and_b32 v6, 3, v1
    v_lshlrev_b32 v6, 18, v6
    v_bfe_u32 v9, v1, 2, 2
    v_lshl_add_u32 v6, v9, 13, v6
    s_and_b32 s96, s21, 1
    s_and_b32 s97, s12, 7
    s_lshr_b32 s98, s12, 3
    s_lshl3_add_u32 s99, s97, s98
    s_lshl_b32 s97, s99, 12
    s_lshr_b32 s98, s21, 1
    s_lshl_b32 s99, s98, 6
    s_add_u32 s98, s97, s99
    s_lshl4_add_u32 s97, s96, s98
    s_add_u32 s99, s97, 1048576
    s_add_u32 s16, s99, 2560
    s_waitcnt vmcnt(2)
    v_pk_add_f32 v[192:193], v[192:193], v[196:197]
    v_pk_add_f32 v[200:201], v[200:201], v[204:205]
    v_pk_add_f32 v[194:195], v[194:195], v[198:199]
    v_pk_add_f32 v[202:203], v[202:203], v[206:207]
    v_pk_add_f32 v[192:193], v[192:193], v[200:201]
    v_pk_add_f32 v[194:195], v[194:195], v[202:203]
    v_add_f32 v193, v193, v194
    v_add_f32 v197, v192, v195
    v_cmp_u_f32 vcc, v193, v197
    s_cbranch_vccz POK_37
PRE_38:
    buffer_load_dwordx4 v[192:195], v2, s[32:35], s14 offen sc1
    buffer_load_dwordx4 v[196:199], v2, s[32:35], s14 offen offset:1024 sc1
    buffer_load_dwordx4 v[200:203], v2, s[32:35], s14 offen offset:2048 sc1
    buffer_load_dwordx4 v[204:207], v2, s[32:35], s14 offen offset:3072 sc1
    s_waitcnt vmcnt(0)
    v_pk_add_f32 v[192:193], v[192:193], v[196:197]
    v_pk_add_f32 v[200:201], v[200:201], v[204:205]
    v_pk_add_f32 v[194:195], v[194:195], v[198:199]
    v_pk_add_f32 v[202:203], v[202:203], v[206:207]
    v_pk_add_f32 v[192:193], v[192:193], v[200:201]
    v_pk_add_f32 v[194:195], v[194:195], v[202:203]
    v_add_f32 v193, v193, v194
    v_add_f32 v197, v192, v195
    v_cmp_u_f32 vcc, v193, v197
    s_cbranch_vccz POK_37
    s_add_u32 s5, s5, 1
    s_cmp_lt_u32 s5, 200000
    s_cbranch_scc1 PRE_38
POK_37:
    v_mov_b32 v196, v195
    s_nop 1
    v_permlane32_swap_b32 v195, v196
    v_permlane32_swap_b32 v192, v193
    v_add_f32 v195, v195, v196
    v_add_f32 v192, v192, v193
    s_nop 1
    v_permlane16_swap_b32 v192, v195
    v_add_f32 v193, v192, v195
    v_add_f32 v195, v192, v195
    s_nop 1
    v_permlane16_swap_b32 v193, v195
    v_mov_b32 v192, v193
    v_mul_f32 v195, 0x3a800000, v195
    s_nop 0
    v_permlane32_swap_b32 v192, v193
    v_mul_f32 v192, 0x3a800000, v192
    v_fma_f32 v31, -v192, v192, v195
    v_cvt_pk_bf16_f32 v30, 0, v192
    v_max_f32 v31, 0, v31
    v_cvt_pk_bf16_f32 v31, 0, v31
    v_fma_f32 v193, -v30, v40, v193
    v_add_f32 v31, 0x3727c5ac, v31
    v_cvt_pk_bf16_f32 v31, 0, v31
    v_sqrt_f32 v31, v31
    s_nop 0
    v_cvt_pk_bf16_f32 v31, 0, v31
    v_rcp_f32 v31, v31
    s_nop 0
    v_mul_f32 v32, v193, v31
    v_ashrrev_i32 v196, 31, v32
    v_or_b32 v196, 0x80000000, v196
L_PAD9:
    s_cbranch_execz L_RET9
    v_xor_b32 v32, v32, v196
    s_mov_b32 s15, 0xfffff000
    v_and_or_b32 v32, v32, s15, v29
    s_nop 1
    v_max_u32_dpp v244, v32, v32 quad_perm:[1,0,3,2] row_mask:0xf bank_mask:0xf
    v_min_u32_dpp v245, v32, v32 quad_perm:[1,0,3,2] row_mask:0xf bank_mask:0xf
    s_nop 0
    v_min_u32_dpp v196, v244, v244 quad_perm:[2,3,0,1] row_mask:0xf bank_mask:0xf
    v_max_u32_dpp v245, v245, v245 quad_perm:[2,3,0,1] row_mask:0xf bank_mask:0xf
    v_max_u32_dpp v244, v244, v244 quad_perm:[2,3,0,1] row_mask:0xf bank_mask:0xf
    v_max_u32 v245, v245, v196
    s_nop 0
    v_min_u32_dpp v196, v244, v244 row_half_mirror row_mask:0xf bank_mask:0xf
    v_max_u32_dpp v245, v245, v245 row_half_mirror row_mask:0xf bank_mask:0xf
    v_max_u32_dpp v244, v244, v244 row_half_mirror row_mask:0xf bank_mask:0xf
    v_max_u32 v245, v245, v196
    s_nop 0
    v_min_u32_dpp v196, v244, v244 row_mirror row_mask:0xf bank_mask:0xf
    v_max_u32_dpp v245, v245, v245 row_mirror row_mask:0xf bank_mask:0xf
    v_max_u32_dpp v244, v244, v244 row_mirror row_mask:0xf bank_mask:0xf
    v_max_u32 v245, v245, v196
    ds_write_b64 v4, v[244:245]
    s_waitcnt lgkmcnt(0)
    s_barrier
    ds_read_b64 v[244:245], v5
    v_pk_add_f32 v[208:209], v[152:153], v[30:31] op_sel_hi:[1,0] neg_lo:[0,1] neg_hi:[0,1]
    v_pk_add_f32 v[210:211], v[154:155], v[30:31] op_sel_hi:[1,0] neg_lo:[0,1] neg_hi:[0,1]
    v_pk_add_f32 v[212:213], v[156:157], v[30:31] op_sel_hi:[1,0] neg_lo:[0,1] neg_hi:[0,1]
    v_pk_add_f32 v[214:215], v[158:159], v[30:31] op_sel_hi:[1,0] neg_lo:[0,1] neg_hi:[0,1]
    v_pk_add_f32 v[216:217], v[160:161], v[30:31] op_sel_hi:[1,0] neg_lo:[0,1] neg_hi:[0,1]
    v_pk_add_f32 v[218:219], v[162:163], v[30:31] op_sel_hi:[1,0] neg_lo:[0,1] neg_hi:[0,1]
    v_pk_add_f32 v[220:221], v[164:165], v[30:31] op_sel_hi:[1,0] neg_lo:[0,1] neg_hi:[0,1]
    v_pk_add_f32 v[222:223], v[166:167], v[30:31] op_sel_hi:[1,0] neg_lo:[0,1] neg_hi:[0,1]
    s_waitcnt lgkmcnt(0)
    v_min_u32_dpp v196, v244, v244 quad_perm:[1,0,3,2] row_mask:0xf bank_mask:0xf
    v_max_u32_dpp v245, v245, v245 quad_perm:[1,0,3,2] row_mask:0xf bank_mask:0xf
    v_max_u32_dpp v244, v244, v244 quad_perm:[1,0,3,2] row_mask:0xf bank_mask:0xf
    v_max_u32 v245, v245, v196
    s_nop 0
    v_min_u32_dpp v196, v244, v244 quad_perm:[2,3,0,1] row_mask:0xf bank_mask:0xf
    v_max_u32_dpp v245, v245, v245 quad_perm:[2,3,0,1] row_mask:0xf bank_mask:0xf
    v_max_u32_dpp v244, v244, v244 quad_perm:[2,3,0,1] row_mask:0xf bank_mask:0xf
    v_max_u32 v245, v245, v196
    s_nop 0
    v_min_u32_dpp v196, v244, v244 row_half_mirror row_mask:0xf bank_mask:0xf
    v_max_u32_dpp v245, v245, v245 row_half_mirror row_mask:0xf bank_mask:0xf
    v_max_u32_dpp v244, v244, v244 row_half_mirror row_mask:0xf bank_mask:0xf
    v_max_u32 v245, v245, v196
    v_cmp_eq_u32 s[88:89], v32, v245
    v_cmp_eq_u32 vcc, v32, v244
    v_or_b32 v246, 1, v245
    v_mov_b32 v245, s4
    v_mov_b32 v247, s4
    s_or_b64 s[84:85], vcc, s[88:89]
    s_cmp_lg_u32 s3, 0
    s_cbranch_scc1 L_NOF
    s_mov_b64 exec, 0xffff
    buffer_store_dwordx4 v[244:247], v6, s[32:35], s16 offen sc1
    s_mov_b64 exec, -1
L_NOF:
    s_cmp_eq_u64 s[84:85], 0
    s_cbranch_scc1 L_NOPR
    s_setprio 1
L_NOPR:
    s_lshl4_add_u32 s13, s3, 156288
    v_mov_b32 v4, s13
    v_and_b32 v5, 7, v1
    v_lshlrev_b32 v5, 4, v5
    v_add_u32 v5, 156288, v5
    s_load_dwordx8 s[24:31], s[32:33], s92 offset:2560 glc
    v_cvt_pk_bf16_f32 v208, 0, v208
    v_cvt_pk_bf16_f32 v209, 0, v209
    v_cvt_pk_bf16_f32 v210, 0, v210
    v_cvt_pk_bf16_f32 v211, 0, v211
    v_cvt_pk_bf16_f32 v212, 0, v212
    v_cvt_pk_bf16_f32 v213, 0, v213
    v_cvt_pk_bf16_f32 v214, 0, v214
    v_cvt_pk_bf16_f32 v215, 0, v215
    v_cvt_pk_bf16_f32 v216, 0, v216
    v_cvt_pk_bf16_f32 v217, 0, v217
    v_cvt_pk_bf16_f32 v218, 0, v218
    v_cvt_pk_bf16_f32 v219, 0, v219
    v_cvt_pk_bf16_f32 v220, 0, v220
    v_cvt_pk_bf16_f32 v221, 0, v221
    v_cvt_pk_bf16_f32 v222, 0, v222
    v_cvt_pk_bf16_f32 v223, 0, v223
    v_pk_mul_f32 v[208:209], v[30:31], v[208:209] op_sel:[1,0]
    v_pk_mul_f32 v[210:211], v[30:31], v[210:211] op_sel:[1,0]
    v_pk_mul_f32 v[212:213], v[30:31], v[212:213] op_sel:[1,0]
    v_pk_mul_f32 v[214:215], v[30:31], v[214:215] op_sel:[1,0]
    v_pk_mul_f32 v[216:217], v[30:31], v[216:217] op_sel:[1,0]
    v_pk_mul_f32 v[218:219], v[30:31], v[218:219] op_sel:[1,0]
    v_pk_mul_f32 v[220:221], v[30:31], v[220:221] op_sel:[1,0]
    v_pk_mul_f32 v[222:223], v[30:31], v[222:223] op_sel:[1,0]
    v_cvt_pk_bf16_f32 v208, 0, v208
    v_cvt_pk_bf16_f32 v209, 0, v209
    v_cvt_pk_bf16_f32 v210, 0, v210
    v_cvt_pk_bf16_f32 v211, 0, v211
    v_cvt_pk_bf16_f32 v212, 0, v212
    v_cvt_pk_bf16_f32 v213, 0, v213
    v_cvt_pk_bf16_f32 v214, 0, v214
    v_cvt_pk_bf16_f32 v215, 0, v215
    v_cvt_pk_bf16_f32 v216, 0, v216
    v_cvt_pk_bf16_f32 v217, 0, v217
    v_cvt_pk_bf16_f32 v218, 0, v218
    v_cvt_pk_bf16_f32 v219, 0, v219
    v_cvt_pk_bf16_f32 v220, 0, v220
    v_cvt_pk_bf16_f32 v221, 0, v221
    v_cvt_pk_bf16_f32 v222, 0, v222
    v_cvt_pk_bf16_f32 v223, 0, v223
    v_pk_mul_f32 v[208:209], v[208:209], v[168:169]
    v_pk_mul_f32 v[210:211], v[210:211], v[170:171]
    v_pk_mul_f32 v[212:213], v[212:213], v[172:173]
    v_pk_mul_f32 v[214:215], v[214:215], v[174:175]
    v_pk_mul_f32 v[216:217], v[216:217], v[176:177]
    v_pk_mul_f32 v[218:219], v[218:219], v[178:179]
    v_pk_mul_f32 v[220:221], v[220:221], v[180:181]
    v_pk_mul_f32 v[222:223], v[222:223], v[182:183]
    v_cvt_pk_bf16_f32 v208, 0, v208
    v_cvt_pk_bf16_f32 v209, 0, v209
    v_cvt_pk_bf16_f32 v210, 0, v210
    v_cvt_pk_bf16_f32 v211, 0, v211
    v_cvt_pk_bf16_f32 v212, 0, v212
    v_cvt_pk_bf16_f32 v213, 0, v213
    v_cvt_pk_bf16_f32 v214, 0, v214
    v_cvt_pk_bf16_f32 v215, 0, v215
    v_cvt_pk_bf16_f32 v216, 0, v216
    v_cvt_pk_bf16_f32 v217, 0, v217
    v_cvt_pk_bf16_f32 v218, 0, v218
    v_cvt_pk_bf16_f32 v219, 0, v219
    v_cvt_pk_bf16_f32 v220, 0, v220
    v_cvt_pk_bf16_f32 v221, 0, v221
    v_cvt_pk_bf16_f32 v222, 0, v222
    v_cvt_pk_bf16_f32 v223, 0, v223
    v_pk_add_f32 v[208:209], v[208:209], v[88:89]
    v_pk_add_f32 v[210:211], v[210:211], v[90:91]
    v_pk_add_f32 v[212:213], v[212:213], v[92:93]
    v_pk_add_f32 v[214:215], v[214:215], v[94:95]
    v_pk_add_f32 v[216:217], v[216:217], v[96:97]
    v_pk_add_f32 v[218:219], v[218:219], v[98:99]
    v_pk_add_f32 v[220:221], v[220:221], v[100:101]
    v_pk_add_f32 v[222:223], v[222:223], v[102:103]
    v_cvt_pk_bf16_f32 v224, v208, v209
    v_cvt_pk_bf16_f32 v225, v210, v211
    v_cvt_pk_bf16_f32 v226, v212, v213
    v_cvt_pk_bf16_f32 v227, v214, v215
    v_cvt_pk_bf16_f32 v228, v216, v217
    v_cvt_pk_bf16_f32 v229, v218, v219
    v_cvt_pk_bf16_f32 v230, v220, v221
    v_cvt_pk_bf16_f32 v231, v222, v223
    s_cmp_eq_u64 s[84:85], 0
    s_cbranch_scc1 L_NOCAND
    v_mfma_f32_16x16x32_bf16 v[240:243], v[184:187], v[224:227], 0
    v_mfma_f32_16x16x32_bf16 v[240:243], v[188:191], v[228:231], v[240:243]
    v_mov_b32 v232, v224
    v_mov_b32 v233, v225
    v_mov_b32 v234, v226
    v_mov_b32 v235, v227
    v_mov_b32 v236, v228
    v_mov_b32 v237, v229
    v_mov_b32 v238, v230
    v_mov_b32 v239, v231
    s_lshl_b32 s96, s21, 14
    s_lshl_b32 s97, s12, 9
    s_add_u32 s98, s96, s97
    s_add_u32 s15, s98, 13631488
    v_lshrrev_b32 v7, 4, v1
    v_lshlrev_b32 v7, 4, v7
    v_add_u32 v8, 8192, v7
    v_permlane32_swap_b32 v232, v234
    v_permlane32_swap_b32 v233, v235
    v_permlane32_swap_b32 v236, v238
    v_permlane32_swap_b32 v237, v239
    v_permlane32_swap_b32 v12, v14
    v_permlane32_swap_b32 v13, v15
    v_permlane32_swap_b32 v16, v18
    v_permlane32_swap_b32 v17, v19
    v_cndmask_b32 v7, v7, v8, s[88:89]
    s_mov_b64 exec, s[84:85]
    buffer_store_dwordx4 v[232:235], v7, s[32:35], s15 offen sc1
    buffer_store_dwordx4 v[236:239], v7, s[32:35], s15 offen offset:64 sc1
    s_mov_b32 exec_lo, 0
    s_and_b32 exec_hi, s85, 0xffff0000
    buffer_store_dword v240, v7, s[32:35], s15 offen offset:208 sc1
    s_mov_b64 exec, s[84:85]
    buffer_store_dwordx4 v[12:15], v7, s[32:35], s15 offen offset:128 sc1
    buffer_store_dwordx4 v[16:19], v7, s[32:35], s15 offen offset:192 sc1
    s_mov_b64 exec, -1
    s_setprio 0
L_NOCAND:
    s_mov_b32 s82, s81
    s_lshl2_add_u32 m0, s83, 65536
    s_nop 0
    buffer_load_dwordx4 v253, s[60:63], s82 offen nt lds
    s_add_u32 s82, s81, 4096
    s_lshl2_add_u32 m0, s83, 66560
    s_nop 0
    buffer_load_dwordx4 v253, s[60:63], s82 offen nt lds
    v_lshlrev_b32 v208, 16, v224
    v_and_b32 v209, s6, v224
    v_lshlrev_b32 v210, 16, v225
    v_and_b32 v211, s6, v225
    v_lshlrev_b32 v212, 16, v226
    v_and_b32 v213, s6, v226
    v_lshlrev_b32 v214, 16, v227
    v_and_b32 v215, s6, v227
    v_lshlrev_b32 v216, 16, v228
    v_and_b32 v217, s6, v228
    v_lshlrev_b32 v218, 16, v229
    v_and_b32 v219, s6, v229
    v_lshlrev_b32 v220, 16, v230
    v_and_b32 v221, s6, v230
    v_lshlrev_b32 v222, 16, v231
    v_and_b32 v223, s6, v231
    v_pk_mul_f32 v[208:209], v[208:209], v[104:105]
    v_pk_mul_f32 v[210:211], v[210:211], v[106:107]
    v_pk_mul_f32 v[212:213], v[212:213], v[108:109]
    v_pk_mul_f32 v[214:215], v[214:215], v[110:111]
    v_pk_mul_f32 v[216:217], v[216:217], v[112:113]
    v_pk_mul_f32 v[218:219], v[218:219], v[114:115]
    v_pk_mul_f32 v[220:221], v[220:221], v[116:117]
    v_pk_mul_f32 v[222:223], v[222:223], v[118:119]
    v_cvt_pk_bf16_f32 v208, 0, v208
    v_cvt_pk_bf16_f32 v209, 0, v209
    v_cvt_pk_bf16_f32 v210, 0, v210
    v_cvt_pk_bf16_f32 v211, 0, v211
    v_cvt_pk_bf16_f32 v212, 0, v212
    v_cvt_pk_bf16_f32 v213, 0, v213
    v_cvt_pk_bf16_f32 v214, 0, v214
    v_cvt_pk_bf16_f32 v215, 0, v215
    v_cvt_pk_bf16_f32 v216, 0, v216
    v_cvt_pk_bf16_f32 v217, 0, v217
    v_cvt_pk_bf16_f32 v218, 0, v218
    v_cvt_pk_bf16_f32 v219, 0, v219
    v_cvt_pk_bf16_f32 v220, 0, v220
    v_cvt_pk_bf16_f32 v221, 0, v221
    v_cvt_pk_bf16_f32 v222, 0, v222
    v_cvt_pk_bf16_f32 v223, 0, v223
    s_lshl_b32 s96, s3, 11
    s_add_u32 s13, s96, 98304
    v_lshrrev_b32 v202, 4, v1
    v_lshlrev_b32 v202, 4, v202
    v_and_b32 v203, 7, v1
    v_lshlrev_b32 v203, 4, v203
    v_xor_b32 v202, v202, v203
    v_and_b32 v204, 15, v1
    v_lshl_add_u32 v204, v204, 7, s13
    v_add_u32 v202, v202, v204
    v_xor_b32 v204, 64, v202
    v_lshrrev_b32 v205, 3, v1
    v_lshlrev_b32 v205, 4, v205
    v_xor_b32 v203, v205, v203
    v_lshrrev_b32 v205, 3, v1
    v_lshl_add_u32 v205, v205, 7, s13
    v_add_u32 v203, v203, v205
    s_lshl_b32 s96, s21, 7
    s_sub_u32 s97, 2047, s96
    s_lshl_b32 s98, s3, 4
    s_sub_u32 s13, s97, s98
    v_lshrrev_b32 v43, 3, v1
    v_sub_u32 v42, s13, v43
    v_subrev_u32 v43, 8, v42
    v_lshrrev_b32 v33, 3, v1
    v_lshlrev_b32 v33, 11, v33
    v_and_b32 v9, 7, v1
    v_lshl_add_u32 v33, v9, 4, v33
    s_lshl3_add_u32 s96, s21, s3
    s_lshl_b32 s97, s96, 15
    s_lshl_b32 s98, s12, 7
    s_add_u32 s16, s97, s98
    s_add_u32 s15, s16, 16384
    s_branch SCHK_40
SPOLL_39:
    s_load_dwordx8 s[24:31], s[32:33], s92 offset:2560 glc
SCHK_40:
    s_add_u32 s5, s5, 1
    s_cmp_ge_u32 s5, 200000
    s_waitcnt lgkmcnt(0)
    s_cbranch_scc1 SDONE_41
    s_cmp_lg_u32 s25, s4
    s_cbranch_scc1 SPOLL_39
    s_cmp_lg_u32 s27, s4
    s_cbranch_scc1 SPOLL_39
    s_cmp_lg_u32 s29, s4
    s_cbranch_scc1 SPOLL_39
    s_cmp_lg_u32 s31, s4
    s_cbranch_scc1 SPOLL_39
SDONE_41:
    s_min_u32 s25, s24, s28
    s_min_u32 s27, s26, s28
    s_min_u32 s29, s24, s30
    s_max_u32 s24, s24, s28
    s_max_u32 s26, s26, s30
    s_max_u32 s27, s27, s29
    s_max_u32 s25, s25, s26
    v_mov_b32 v244, s24
    v_mov_b32 v246, s27
    v_mov_b32 v245, s25
    ds_write_b128 v4, v[244:247]
    s_lshr_b32 s96, s3, 2
    s_lshl_b32 s97, s96, 15
    s_and_b32 s98, s3, 3
    s_lshl_b32 s99, s98, 5
    s_add_u32 s13, s97, s99
    v_lshrrev_b32 v34, 4, v1
    v_lshlrev_b32 v34, 13, v34
    v_bfe_u32 v9, v1, 2, 2
    v_lshl_add_u32 v34, v9, 7, v34
    v_bfe_u32 v9, v1, 3, 2
    v_lshl_add_u32 v34, v9, 5, v34
    v_and_b32 v9, 3, v1
    v_lshl_add_u32 v34, v9, 3, v34
    v_xor_b32 v34, s13, v34
    s_lshl_b32 s96, s75, 11
    s_add_u32 s13, s96, 13631488
    v_and_b32 v36, 7, v1
    v_lshl_add_u32 v36, v36, 4, s13
    v_lshrrev_b32 v9, 4, v1
    v_lshl_add_u32 v36, v9, 9, v36
    v_and_b32 v10, 15, v1
    v_lshlrev_b32 v10, 9, v10
    v_add_u32 v10, 13631744, v10
    s_waitcnt vmcnt(0)
    s_waitcnt lgkmcnt(0)
    s_barrier
    ds_read_b128 v[244:247], v5
    v_and_b32 v8, 8, v1
    v_cmp_eq_u32 s[22:23], 0, v8
    v_cmp_gt_u32 s[24:25], 16, v1
    v_cmp_gt_u32 s[26:27], 32, v1
    s_waitcnt lgkmcnt(0)
    v_min_u32_dpp v192, v244, v244 quad_perm:[1,0,3,2] row_mask:0xf bank_mask:0xf
    v_min_u32_dpp v193, v245, v244 quad_perm:[1,0,3,2] row_mask:0xf bank_mask:0xf
    v_min_u32_dpp v194, v244, v245 quad_perm:[1,0,3,2] row_mask:0xf bank_mask:0xf
    v_max_u32_dpp v246, v246, v246 quad_perm:[1,0,3,2] row_mask:0xf bank_mask:0xf
    v_max_u32_dpp v245, v245, v245 quad_perm:[1,0,3,2] row_mask:0xf bank_mask:0xf
    v_max_u32_dpp v244, v244, v244 quad_perm:[1,0,3,2] row_mask:0xf bank_mask:0xf
    v_max3_u32 v246, v246, v193, v194
    v_max_u32 v245, v245, v192
    v_min_u32_dpp v192, v244, v244 quad_perm:[2,3,0,1] row_mask:0xf bank_mask:0xf
    s_nop 0
    v_min_u32_dpp v193, v245, v244 quad_perm:[2,3,0,1] row_mask:0xf bank_mask:0xf
    v_min_u32_dpp v194, v244, v245 quad_perm:[2,3,0,1] row_mask:0xf bank_mask:0xf
    v_max_u32_dpp v246, v246, v246 quad_perm:[2,3,0,1] row_mask:0xf bank_mask:0xf
    v_max_u32_dpp v245, v245, v245 quad_perm:[2,3,0,1] row_mask:0xf bank_mask:0xf
    v_max_u32_dpp v244, v244, v244 quad_perm:[2,3,0,1] row_mask:0xf bank_mask:0xf
    v_max3_u32 v246, v246, v193, v194
    v_max_u32 v245, v245, v192
    v_min_u32_dpp v192, v244, v244 row_half_mirror row_mask:0xf bank_mask:0xf
    s_nop 0
    v_min_u32_dpp v193, v245, v244 row_half_mirror row_mask:0xf bank_mask:0xf
    v_min_u32_dpp v194, v244, v245 row_half_mirror row_mask:0xf bank_mask:0xf
    v_max_u32_dpp v246, v246, v246 row_half_mirror row_mask:0xf bank_mask:0xf
    v_max_u32_dpp v245, v245, v245 row_half_mirror row_mask:0xf bank_mask:0xf
    v_max_u32_dpp v244, v244, v244 row_half_mirror row_mask:0xf bank_mask:0xf
    v_max3_u32 v246, v246, v193, v194
    v_max_u32 v245, v245, v192
    v_cndmask_b32 v192, v245, v244, s[22:23]
    v_cndmask_b32 v201, v246, v245, s[26:27]
    v_and_b32 v193, 31, v246
    v_and_b32 v192, 31, v192
    v_cndmask_b32 v201, v201, v244, s[24:25]
    v_lshl_add_u32 v4, v192, 13, v36
    v_lshl_add_u32 v5, v193, 13, v36
    v_and_b32 v194, 31, v201
    v_lshl_add_u32 v6, v194, 13, v10
    buffer_load_dwordx4 v[192:195], v4, s[32:35], 0 offen sc1
    buffer_load_dwordx4 v[196:199], v5, s[32:35], 0 offen sc1
    buffer_load_dword v200, v6, s[32:35], 0 offen sc1
    s_barrier
    s_add_u32 s82, s81, 8192
    s_lshl2_add_u32 m0, s83, 67584
    s_nop 0
    buffer_load_dwordx4 v253, s[60:63], s82 offen nt lds
    s_add_u32 s82, s81, 12288
    s_lshl2_add_u32 m0, s83, 68608
    s_nop 0
    buffer_load_dwordx4 v253, s[60:63], s82 offen nt lds
    v_readfirstlane_b32 s91, v244
    v_readfirstlane_b32 s94, v245
    v_readfirstlane_b32 s95, v246
    ds_read_b64_tr_b16 v[56:57], v34
    ds_read_b64_tr_b16 v[58:59], v34 offset:512
    ds_read_b64_tr_b16 v[60:61], v34 offset:1024
    ds_read_b64_tr_b16 v[62:63], v34 offset:1536
    ds_read_b64_tr_b16 v[64:65], v34 offset:2048
    ds_read_b64_tr_b16 v[66:67], v34 offset:2560
    ds_read_b64_tr_b16 v[68:69], v34 offset:3072
    ds_read_b64_tr_b16 v[70:71], v34 offset:3584
    ds_read_b64_tr_b16 v[72:73], v34 offset:4096
    ds_read_b64_tr_b16 v[74:75], v34 offset:4608
    ds_read_b64_tr_b16 v[76:77], v34 offset:5120
    ds_read_b64_tr_b16 v[78:79], v34 offset:5632
    ds_read_b64_tr_b16 v[80:81], v34 offset:6144
    ds_read_b64_tr_b16 v[82:83], v34 offset:6656
    ds_read_b64_tr_b16 v[84:85], v34 offset:7168
    ds_read_b64_tr_b16 v[86:87], v34 offset:7680
    s_bfe_u32 s96, s91, 262145
    s_lshl_b32 s97, s96, 7
    s_bfe_u32 s98, s91, 458757
    s_add_u32 s99, s97, s98
    s_xor_b32 s17, s99, 2047
    s_bfe_u32 s96, s94, 262145
    s_lshl_b32 s97, s96, 7
    s_bfe_u32 s98, s94, 458757
    s_add_u32 s99, s97, s98
    s_xor_b32 s18, s99, 2047
    s_bfe_u32 s96, s95, 262145
    s_lshl_b32 s97, s96, 7
    s_bfe_u32 s98, s95, 458757
    s_add_u32 s99, s97, s98
    s_xor_b32 s19, s99, 2047
    s_waitcnt lgkmcnt(0)
    s_lshl_b32 s13, s3, 6
    v_bfe_u32 v35, v1, 2, 1
    v_lshlrev_b32 v35, 9, v35
    v_bfe_u32 v9, v1, 3, 1
    v_lshl_add_u32 v35, v9, 12, v35
    v_lshrrev_b32 v9, 5, v1
    v_lshl_add_u32 v35, v9, 11, v35
    v_bfe_u32 v9, v1, 2, 2
    v_lshl_add_u32 v35, v9, 6, v35
    v_bfe_u32 v9, v1, 4, 1
    v_lshl_add_u32 v35, v9, 5, v35
    v_and_b32 v9, 3, v1
    v_lshl_add_u32 v35, v9, 3, v35
    v_xor_b32 v35, s13, v35
    v_add_u32 v35, 65536, v35
    v_and_b32 v8, 15, v1
    v_lshlrev_b32 v8, 4, v8
    v_lshrrev_b32 v9, 5, v1
    v_lshl_add_u32 v8, v9, 3, v8
    s_lshl_b32 s96, s74, 13
    s_add_u32 s14, s96, 20971520
    s_lshl3_add_u32 s96, s75, s3
    s_lshl_b32 s97, s96, 8
    s_add_u32 s20, s97, s14
    v_bfe_u32 v7, v201, 1, 4
    v_bfe_u32 v201, v201, 5, 7
    v_lshl_or_b32 v201, v7, 7, v201
    v_xor_b32 v201, 0x7ff, v201
    s_waitcnt vmcnt(2)
    v_max3_u32 v7, v192, v196, v200
    v_cmp_eq_u32 vcc, -1, v7
    s_cbranch_vccz POK_43
PRE_44:
    buffer_load_dwordx4 v[192:195], v4, s[32:35], 0 offen sc1
    buffer_load_dwordx4 v[196:199], v5, s[32:35], 0 offen sc1
    buffer_load_dword v200, v6, s[32:35], 0 offen sc1
    s_waitcnt vmcnt(0)
    v_max3_u32 v7, v192, v196, v200
    v_cmp_eq_u32 vcc, -1, v7
    s_cbranch_vccz POK_43
    s_add_u32 s5, s5, 1
    s_cmp_lt_u32 s5, 200000
    s_cbranch_scc1 PRE_44
POK_43:
    v_add_f32_dpp v200, v200, v200 quad_perm:[1,0,3,2] row_mask:0xf bank_mask:0xf
    s_nop 1
    v_add_f32_dpp v200, v200, v200 quad_perm:[2,3,0,1] row_mask:0xf bank_mask:0xf
    s_nop 1
    v_add_f32_dpp v200, v200, v200 row_half_mirror row_mask:0xf bank_mask:0xf
    s_nop 1
    v_add_f32_dpp v200, v200, v200 row_mirror row_mask:0xf bank_mask:0xf
    v_cvt_pk_bf16_f32 v200, 0, v200
    v_ashrrev_i32 v7, 31, v200
    v_or_b32 v7, 0x80000000, v7
    v_xor_b32 v200, v200, v7
    v_lshrrev_b32 v200, 16, v200
    v_lshl_or_b32 v200, v200, 11, v201
    s_nop 0
    v_readlane_b32 s24, v200, 0
    v_readlane_b32 s25, v200, 16
    v_readlane_b32 s26, v200, 32
    s_not_b64 s[28:29], s[22:23]
    s_cmp_lt_u32 s24, s25
    s_cselect_b64 s[28:29], s[22:23], s[28:29]
    s_cselect_b32 s27, s24, s25
    s_cmp_gt_u32 s26, s27
    s_cselect_b64 vcc, s[28:29], 0
    v_cndmask_b32 v192, v192, v196, vcc
    v_cndmask_b32 v193, v193, v197, vcc
    v_cndmask_b32 v194, v194, v198, vcc
    v_cndmask_b32 v195, v195, v199, vcc
    s_bitcmp1_b32 vcc_lo, 0
    s_cselect_b32 s24, s26, s24
    s_cselect_b32 s19, s17, s19
    s_cselect_b32 s17, s95, s91
    s_bitcmp1_b32 vcc_lo, 8
    s_cselect_b32 s25, s26, s25
    s_cselect_b32 s19, s18, s19
    s_cselect_b32 s18, s95, s94
    s_waitcnt lgkmcnt(0)
    v_mfma_f32_16x16x32_bf16 v[136:139], v[192:195], v[56:59], 0
    v_mfma_f32_16x16x32_bf16 v[140:143], v[192:195], v[60:63], 0
    v_mfma_f32_16x16x32_bf16 v[144:147], v[192:195], v[64:67], 0
    v_mfma_f32_16x16x32_bf16 v[148:151], v[192:195], v[68:71], 0
    v_mfma_f32_16x16x32_bf16 v[168:171], v[192:195], v[72:75], 0
    v_mfma_f32_16x16x32_bf16 v[172:175], v[192:195], v[76:79], 0
    v_mfma_f32_16x16x32_bf16 v[176:179], v[192:195], v[80:83], 0
    v_mfma_f32_16x16x32_bf16 v[180:183], v[192:195], v[84:87], 0
    s_nop 1
    v_add_f32 v196, v136, v141
    s_nop 0
    v_add_f32 v197, v146, v151
    s_nop 0
    v_add_f32 v198, v168, v173
    s_nop 0
    v_add_f32 v199, v178, v183
    v_add_f32 v196, v196, v197
    v_add_f32 v198, v198, v199
    v_mov_b32 v197, s4
    s_nop 0
    v_permlane16_swap_b32 v198, v199
    s_cmp_ge_u32 s9, 28
    s_cbranch_scc1 L_NOHP
    v_add_f32 v196, v196, v199
    s_mov_b32 exec_lo, 0xffff
    s_mov_b32 exec_hi, 0xffff
    buffer_store_dwordx2 v[196:197], v8, s[32:35], s20 offen sc1
    s_mov_b64 exec, -1
L_NOHP:
    s_and_b32 s68, s24, 2047
    s_and_b32 s69, s25, 2047
    s_mov_b32 s70, s16
    s_mov_b32 s71, s15
    v_pk_add_f32 v[208:209], v[208:209], v[152:153]
    v_pk_add_f32 v[210:211], v[210:211], v[154:155]
    v_pk_add_f32 v[212:213], v[212:213], v[156:157]
    v_pk_add_f32 v[214:215], v[214:215], v[158:159]
    v_pk_add_f32 v[216:217], v[216:217], v[160:161]
    v_pk_add_f32 v[218:219], v[218:219], v[162:163]
    v_pk_add_f32 v[220:221], v[220:221], v[164:165]
    v_pk_add_f32 v[222:223], v[222:223], v[166:167]
    v_cvt_pk_bf16_f32 v232, v208, v209
    v_cvt_pk_bf16_f32 v233, v210, v211
    v_cvt_pk_bf16_f32 v234, v212, v213
    v_cvt_pk_bf16_f32 v235, v214, v215
    v_cvt_pk_bf16_f32 v236, v216, v217
    v_cvt_pk_bf16_f32 v237, v218, v219
    v_cvt_pk_bf16_f32 v238, v220, v221
    v_cvt_pk_bf16_f32 v239, v222, v223
    v_permlane32_swap_b32 v232, v234
    v_permlane32_swap_b32 v233, v235
    v_permlane32_swap_b32 v236, v238
    v_permlane32_swap_b32 v237, v239
    ds_write_b128 v202, v[232:235]
    ds_write_b128 v204, v[236:239]
    ds_read_b128 v[232:235], v203
    ds_read_b128 v[236:239], v203 offset:1024
    s_waitcnt lgkmcnt(0)
    s_cmp_lg_u32 s93, 7
    s_cbranch_scc1 L_NONON
    v_mov_b32 v6, s4
    v_mov_b32 v7, 0
    s_mov_b64 exec, 1
    buffer_store_dword v6, v7, s[32:35], 0 offen sc1
    s_mov_b64 exec, -1
L_NONON:
    s_cmp_ge_u32 s9, 28
    s_cbranch_scc1 L_FIN2
    s_cmp_lg_u32 s3, 7
    s_cbranch_scc1 L_NOFZ
    s_bitcmp1_b32 s9, 3
    s_cselect_b32 s15, s25, s24
    s_cselect_b32 s17, s18, s17
    s_andn2_b32 s18, 2047, s15
    s_lshr_b32 s96, s8, 1
    s_lshl2_add_u32 s19, s12, s96
    s_lshr_b32 s96, s19, 1
    s_lshr_b32 s97, s9, 3
    s_lshl_b32 s98, s97, 1
    s_lshl2_add_u32 s99, s96, s98
    s_and_b32 s97, s19, 1
    s_add_u32 s96, s99, s97
    s_mul_i32 s98, s96, 7168
    s_add_u32 s20, s98, 22020096
    s_lshl_b32 s96, s18, 11
    s_lshl_b32 s97, s19, 5
    s_add_u32 s82, s96, s97
    v_and_b32 v10, 7, v1
    v_lshlrev_b32 v10, 2, v10
    s_lshr_b32 s96, s8, 1
    s_lshl_b32 s97, s96, 6
    s_add_u32 s13, s97, 157184
    v_and_b32 v5, 7, v1
    v_lshl_add_u32 v5, v5, 3, s13
    ds_read_b64 v[206:207], v5
    s_and_b32 s96, s17, 31
    s_lshl_b32 s97, s96, 13
    s_lshl_b32 s98, s12, 9
    s_add_u32 s99, s97, s98
    s_lshr_b32 s96, s8, 1
    s_lshl_b32 s97, s96, 5
    s_add_u32 s98, s99, s97
    s_add_u32 s91, s98, 13631488
    s_lshr_b32 s13, s15, 11
    s_lshl_b32 s13, s13, 16
    s_ashr_i32 s15, s13, 31
    s_andn2_b32 s15, 0x7fff0000, s15
    s_or_b32 s15, s15, 0x80000000
    s_xor_b32 s13, s13, s15
    v_mov_b32 v204, s13
    v_mul_f32 v204, s7, v204
    v_exp_f32 v204, -v204
    s_nop 0
    v_add_f32 v204, 1.0, v204
    v_rcp_f32 v204, v204
    s_nop 0
    v_cvt_pk_bf16_f32 v204, 0, v204
L_NOFZ:
    s_cmp_ge_u32 s3, 4
    s_cbranch_scc1 L_NOH
    s_lshl_b32 s96, s3, 8
    s_add_u32 s13, s96, s14
    v_lshrrev_b32 v4, 4, v1
    v_lshlrev_b32 v4, 11, v4
    v_and_b32 v9, 15, v1
    v_lshl_add_u32 v4, v9, 4, v4
    s_lshl_b32 s96, s3, 5
    s_add_u32 s15, s96, 156672
    v_lshrrev_b32 v5, 5, v1
    v_lshl_add_u32 v5, v5, 7, s15
    v_bfe_u32 v9, v1, 2, 1
    v_lshl_add_u32 v5, v9, 4, v5
    v_bfe_u32 v9, v1, 1, 1
    v_lshl_add_u32 v5, v9, 3, v5
    v_bfe_u32 v9, v1, 3, 1
    v_lshl_add_u32 v5, v9, 2, v5
    v_and_b32 v9, 1, v1
    v_lshl_add_u32 v5, v9, 1, v5
SPOLL_45:
    s_load_dword s24, s[32:33], s13 offset:1276 glc
    s_load_dword s25, s[32:33], s13 offset:3324 glc
    s_load_dword s26, s[32:33], s13 offset:5372 glc
    s_load_dword s27, s[32:33], s13 offset:7420 glc
SCHK_46:
    s_add_u32 s5, s5, 1
    s_cmp_ge_u32 s5, 200000
    s_waitcnt lgkmcnt(0)
    s_cbranch_scc1 SDONE_47
    s_cmp_lg_u32 s24, s4
    s_cbranch_scc1 SPOLL_45
    s_cmp_lg_u32 s25, s4
    s_cbranch_scc1 SPOLL_45
    s_cmp_lg_u32 s26, s4
    s_cbranch_scc1 SPOLL_45
    s_cmp_lg_u32 s27, s4
    s_cbranch_scc1 SPOLL_45
SDONE_47:
POLL_48:
    buffer_load_dwordx4 v[88:91], v4, s[32:35], s13 offen sc1
    buffer_load_dwordx4 v[92:95], v4, s[32:35], s13 offen offset:1024 sc1
    s_waitcnt vmcnt(0)
    v_bitop3_b32 v6, v89, v91, s4 bitop3:0x7e
    v_bitop3_b32 v6, v6, v93, s4 bitop3:0xf6
    v_bitop3_b32 v6, v6, v95, s4 bitop3:0xf6
    v_cmp_ne_u32 vcc, 0, v6
    s_cbranch_vccz PDONE_49
    s_add_u32 s5, s5, 1
    s_cmp_lt_u32 s5, 200000
    s_cbranch_scc1 POLL_48
PDONE_49:
    v_permlane32_swap_b32 v88, v90
    v_permlane32_swap_b32 v92, v94
    v_add_f32 v88, v88, v90
    v_add_f32 v92, v92, v94
    v_mov_b32 v90, v88
    v_mov_b32 v94, v92
    s_nop 0
    v_permlane16_swap_b32 v88, v90
    v_permlane16_swap_b32 v92, v94
    v_add_f32 v88, v88, v90
    v_add_f32 v92, v92, v94
    v_cvt_pk_bf16_f32 v88, 0, v88
    v_cvt_pk_bf16_f32 v92, 0, v92
    v_mul_f32 v6, s7, v88
    v_exp_f32 v6, -v6
    s_nop 0
    v_add_f32 v6, 1.0, v6
    v_rcp_f32 v6, v6
    s_nop 0
    v_mul_f32 v88, v88, v6
    v_cvt_pk_bf16_f32 v88, 0, v88
    v_mul_f32 v88, v88, v92
    v_cvt_pk_bf16_f32 v88, v88, v88
    ds_write_b16 v5, v88
L_NOH:
    v_bfe_u32 v4, v1, 2, 1
    v_lshlrev_b32 v4, 7, v4
    v_lshrrev_b32 v9, 5, v1
    v_lshl_add_u32 v4, v9, 4, v4
L_PAD10:
    s_cbranch_execz L_RET10
    v_add_u32 v4, 156672, v4
    v_lshrrev_b32 v5, 4, v1
    v_mul_u32_u24 v5, 7168, v5
    v_and_b32 v9, 15, v1
    v_lshl_add_u32 v5, v9, 3, v5
    s_lshl3_add_u32 s96, s75, s3
    s_mul_i32 s97, s96, 28672
    s_lshl_b32 s98, s74, 7
    s_add_u32 s99, s97, s98
    s_add_u32 s13, s99, 22020096
    v_and_b32 v6, 1, v1
    v_lshlrev_b32 v6, 13, v6
    v_bfe_u32 v9, v1, 1, 1
    v_lshl_add_u32 v6, v9, 18, v6
    s_lshr_b32 s96, s9, 2
    s_and_b32 s97, s75, 1
    s_lshr_b32 s98, s3, 1
    s_lshl2_add_u32 s99, s97, s98
    s_and_b32 s97, s3, 1
    s_lshr_b32 s98, s75, 1
    s_lshl2_add_u32 s97, s97, s98
    s_lshl3_add_u32 s98, s99, s97
    s_lshl_b32 s99, s98, 12
    s_lshl_b32 s97, s8, 6
    s_add_u32 s98, s99, s97
    s_lshl2_add_u32 s99, s96, s98
    s_add_u32 s97, s99, 1048576
    s_add_u32 s14, s97, 3072
    s_waitcnt vmcnt(0)
    s_waitcnt lgkmcnt(0)
    s_barrier
    ds_read_b128 v[88:91], v4
    ds_read_b64_tr_b16 v[120:121], v35
    ds_read_b64_tr_b16 v[122:123], v35 offset:1024
    ds_read_b128 v[92:95], v4 offset:32
    ds_read_b64_tr_b16 v[124:125], v35 offset:8192
    ds_read_b64_tr_b16 v[126:127], v35 offset:9216
    ds_read_b128 v[96:99], v4 offset:64
    ds_read_b64_tr_b16 v[128:129], v35 offset:16384
    ds_read_b64_tr_b16 v[130:131], v35 offset:17408
    ds_read_b128 v[100:103], v4 offset:96
    ds_read_b64_tr_b16 v[132:133], v35 offset:24576
    ds_read_b64_tr_b16 v[134:135], v35 offset:25600
    s_waitcnt lgkmcnt(9)
    v_mfma_f32_32x32x16_bf16 v[208:223], v[88:91], v[120:123], 0
    s_waitcnt lgkmcnt(6)
    v_mfma_f32_32x32x16_bf16 v[208:223], v[92:95], v[124:127], v[208:223]
    s_waitcnt lgkmcnt(3)
    v_mfma_f32_32x32x16_bf16 v[208:223], v[96:99], v[128:131], v[208:223]
    s_waitcnt lgkmcnt(0)
    v_mfma_f32_32x32x16_bf16 v[208:223], v[100:103], v[132:135], v[208:223]
    s_nop 11
    v_mov_b32 v209, s4
    buffer_store_dwordx2 v[208:209], v5, s[32:35], s13 offen sc1
    s_mov_b64 exec, 15
    buffer_store_dword v209, v6, s[32:35], s14 offen sc1
    s_mov_b64 exec, -1
    s_barrier
L_FIN2:
    v_cmp_ne_u32 vcc, s68, v42
    v_cmp_ne_u32 s[22:23], s69, v42
    s_nop 0
    s_and_b64 exec, vcc, s[22:23]
    buffer_store_dwordx4 v[232:235], v33, s[64:67], s70 offen sc1
    s_mov_b64 exec, -1
    v_cmp_ne_u32 vcc, s68, v43
    v_cmp_ne_u32 s[22:23], s69, v43
    s_nop 0
    s_and_b64 exec, vcc, s[22:23]
    buffer_store_dwordx4 v[236:239], v33, s[64:67], s71 offen sc1
    s_mov_b64 exec, -1
    s_cmp_ge_u32 s9, 16
    s_cbranch_scc1 L_FIN
SPOLL_50:
    s_load_dwordx8 s[24:31], s[32:33], s92 offset:3072 glc
SCHK_51:
    s_add_u32 s5, s5, 1
    s_cmp_ge_u32 s5, 200000
    s_waitcnt lgkmcnt(0)
    s_cbranch_scc1 SDONE_52
    s_cmp_lg_u32 s24, s4
    s_cbranch_scc1 SPOLL_50
    s_cmp_lg_u32 s25, s4
    s_cbranch_scc1 SPOLL_50
    s_cmp_lg_u32 s26, s4
    s_cbranch_scc1 SPOLL_50
    s_cmp_lg_u32 s27, s4
    s_cbranch_scc1 SPOLL_50
    s_cmp_lg_u32 s28, s4
    s_cbranch_scc1 SPOLL_50
    s_cmp_lg_u32 s29, s4
    s_cbranch_scc1 SPOLL_50
    s_cmp_lg_u32 s30, s4
    s_cbranch_scc1 SPOLL_50
SDONE_52:
    s_barrier
    s_cmp_lg_u32 s3, 7
    s_cbranch_scc1 L_FIN
    s_add_u32 s13, s20, 4096
    v_mov_b32 v5, s4
    v_not_b32 v6, v5
POLL_53:
    buffer_load_dwordx4 v[88:91], v2, s[32:35], s20 offen sc1
    buffer_load_dwordx4 v[92:95], v2, s[32:35], s20 offen offset:1024 sc1
    buffer_load_dwordx4 v[96:99], v2, s[32:35], s20 offen offset:2048 sc1
    buffer_load_dwordx4 v[100:103], v2, s[32:35], s20 offen offset:3072 sc1
    buffer_load_dwordx4 v[104:107], v2, s[32:35], s13 offen sc1
    buffer_load_dwordx4 v[108:111], v2, s[32:35], s13 offen offset:1024 sc1
    buffer_load_dwordx4 v[112:115], v2, s[32:35], s13 offen offset:2048 sc1
    buffer_load_dword v244, v10, s[32:35], s91 offen sc1
    buffer_load_dword v245, v10, s[32:35], s91 offen offset:128 sc1
    s_waitcnt vmcnt(0)
    v_max_u32 v246, v244, v245
    v_cmp_ne_u32 vcc, -1, v246
    s_nop 1
    v_cndmask_b32 v246, v6, v5, vcc
    v_bitop3_b32 v4, v89, v91, s4 bitop3:0x7e
    v_bitop3_b32 v4, v4, v93, s4 bitop3:0xf6
    v_bitop3_b32 v4, v4, v95, s4 bitop3:0xf6
    v_bitop3_b32 v4, v4, v97, s4 bitop3:0xf6
    v_bitop3_b32 v4, v4, v99, s4 bitop3:0xf6
    v_bitop3_b32 v4, v4, v101, s4 bitop3:0xf6
    v_bitop3_b32 v4, v4, v103, s4 bitop3:0xf6
    v_bitop3_b32 v4, v4, v105, s4 bitop3:0xf6
    v_bitop3_b32 v4, v4, v107, s4 bitop3:0xf6
    v_bitop3_b32 v4, v4, v109, s4 bitop3:0xf6
    v_bitop3_b32 v4, v4, v111, s4 bitop3:0xf6
    v_bitop3_b32 v4, v4, v113, s4 bitop3:0xf6
    v_bitop3_b32 v4, v4, v115, s4 bitop3:0xf6
    v_bitop3_b32 v4, v4, v246, s4 bitop3:0xf6
    v_cmp_ne_u32 vcc, 0, v4
    s_cbranch_vccz PDONE_54
    s_add_u32 s5, s5, 1
    s_cmp_lt_u32 s5, 200000
    s_cbranch_scc1 POLL_53
PDONE_54:
    v_add_f32 v88, v88, v92
    v_add_f32 v90, v90, v94
    v_add_f32 v88, v88, v96
    v_add_f32 v90, v90, v98
    v_add_f32 v88, v88, v100
    v_add_f32 v90, v90, v102
    v_add_f32 v88, v88, v104
    v_add_f32 v90, v90, v106
    v_add_f32 v88, v88, v108
    v_add_f32 v90, v90, v110
    v_add_f32 v88, v88, v112
    v_add_f32 v90, v90, v114
    v_mov_b32 v89, v90
    v_add_f32_dpp v88, v88, v88 row_ror:8 row_mask:0xf bank_mask:0xf
    s_nop 0
    v_add_f32_dpp v89, v89, v89 row_ror:8 row_mask:0xf bank_mask:0xf
    v_mov_b32 v90, v88
    v_mov_b32 v91, v89
    s_nop 0
    v_permlane16_swap_b32 v88, v90
    v_permlane16_swap_b32 v89, v91
    v_pk_add_f32 v[88:89], v[88:89], v[90:91]
    v_mov_b32 v90, v88
    v_mov_b32 v91, v89
    s_nop 0
    v_permlane32_swap_b32 v88, v90
    v_permlane32_swap_b32 v89, v91
    v_pk_add_f32 v[88:89], v[88:89], v[90:91]
    v_cvt_pk_bf16_f32 v88, 0, v88
    v_cvt_pk_bf16_f32 v89, 0, v89
    v_pk_mul_f32 v[88:89], v[88:89], v[204:205] op_sel_hi:[1,0]
    v_lshlrev_b32 v4, 16, v244
    v_and_b32 v5, s6, v244
    v_cvt_pk_bf16_f32 v88, 0, v88
    v_cvt_pk_bf16_f32 v89, 0, v89
    v_pk_add_f32 v[88:89], v[88:89], v[4:5]
    v_cvt_pk_bf16_f32 v88, 0, v88
    v_cvt_pk_bf16_f32 v89, 0, v89
    v_pk_mul_f32 v[88:89], v[88:89], v[206:207]
    v_lshlrev_b32 v4, 16, v245
    v_and_b32 v5, s6, v245
    v_cvt_pk_bf16_f32 v88, 0, v88
    v_cvt_pk_bf16_f32 v89, 0, v89
    v_pk_add_f32 v[88:89], v[88:89], v[4:5]
    v_cvt_pk_bf16_f32 v88, v88, v89
    s_mov_b64 exec, 0xff
    buffer_store_dword v88, v10, s[64:67], s82 offen
    s_mov_b64 exec, -1
L_FIN:
L_END:
    s_endpgm
.p2align 10
.fill 768, 4, 0xbf800000
.section .rodata,"a"
.p2align 6
.amdhsa_kernel adaLN_cond__linear_kernel_hedgehog__moe_arch_mod__prompt_kernel
  .amdhsa_next_free_vgpr 256
  .amdhsa_next_free_sgpr 102
  .amdhsa_accum_offset 256
  .amdhsa_group_segment_fixed_size 0
  .amdhsa_kernarg_size 112
  .amdhsa_user_sgpr_count 2
  .amdhsa_user_sgpr_kernarg_segment_ptr 1
  .amdhsa_system_sgpr_workgroup_id_x 1
  .amdhsa_float_denorm_mode_32 3
  .amdhsa_float_denorm_mode_16_64 3
.end_amdhsa_kernel
```

```asm
; @launch grid=(256,1,1) block=(512,1,1) lds=163840
.amdgcn_target "amdgcn-amd-amdhsa--gfx950"
.text
.globl adaLN_cond__linear_kernel_hedgehog__moe_arch_mod__prompt_kernel
.p2align 12
.type adaLN_cond__linear_kernel_hedgehog__moe_arch_mod__prompt_kernel,@function
adaLN_cond__linear_kernel_hedgehog__moe_arch_mod__prompt_kernel:
    s_load_dwordx16 s[68:83], s[0:1], 0
    s_load_dwordx8 s[84:91], s[0:1], 64
    s_load_dwordx2 s[32:33], s[0:1], 104
    s_cmp_ge_u32 s2, 256
    s_cbranch_scc1 L_END
    v_lshrrev_b32 v4, 6, v0
    v_and_b32 v1, 63, v0
    s_nop 0
    v_readfirstlane_b32 s3, v4
    v_lshlrev_b32 v2, 4, v1
    s_mov_b32 s38, 4194304
    s_mov_b32 s39, 0x20000
    s_mov_b32 s50, 12582912
    s_mov_b32 s51, 0x20000
    s_mov_b32 s34, 268435456
    s_mov_b32 s35, 0x20000
    s_mov_b32 s42, 6291456
    s_mov_b32 s43, 0x20000
    s_mov_b32 s46, 2097152
    s_mov_b32 s47, 0x20000
    s_mov_b32 s54, 7340032
    s_mov_b32 s55, 0x20000
    s_mov_b32 s58, 7340032
    s_mov_b32 s59, 0x20000
    s_mov_b32 s62, 7340032
    s_mov_b32 s63, 0x20000
    s_mov_b32 s66, 4194304
    s_mov_b32 s67, 0x20000
    s_mov_b32 s5, 0
    s_mov_b32 s6, 0xffff0000
    s_mov_b32 s7, 0x3fb8aa3b
    s_and_b32 s8, s2, 7
    s_lshr_b32 s9, s2, 3
    s_lshl3_add_u32 s93, s2, s3
    s_and_b32 s96, s8, 4
    s_lshr_b32 s97, s9, 2
    s_lshl1_add_u32 s10, s96, s97
    s_and_b32 s96, s8, 3
    s_and_b32 s97, s9, 3
    s_xor_b32 s98, s97, 2
    s_lshl2_add_u32 s11, s96, s98
    s_and_b32 s96, s8, 1
    s_and_b32 s97, s9, 7
    s_lshl3_add_u32 s12, s96, s97
    s_lshr_b32 s96, s8, 1
    s_lshr_b32 s97, s9, 3
    s_lshl2_add_u32 s21, s96, s97
    s_lshl_b32 s96, s2, 6
    s_add_u32 s97, s96, s3
    s_lshl_b32 s98, s97, 6
    s_add_u32 s92, s98, 1048576
    s_lshr_b32 s96, s8, 1
    s_lshl_b32 s97, s96, 8
    s_lshl3_add_u32 s98, s9, s97
    s_add_u32 s99, s98, s3
    s_lshl_b32 s96, s99, 12
    s_and_b32 s97, s8, 1
    s_lshl_b32 s98, s97, 10
    s_add_u32 s16, s96, s98
    v_and_b32 v8, 31, v1
    v_lshlrev_b32 v8, 4, v8
    v_lshrrev_b32 v9, 5, v1
    v_lshl_add_u32 v8, v9, 11, v8
    s_lshl3_add_u32 s96, s8, s3
    s_lshl_b32 s15, s96, 5
    s_mul_i32 s96, s15, 6144
    s_xor_b32 s97, s9, 1
    s_lshl_b32 s98, s97, 7
    s_add_u32 s13, s96, s98
    s_add_u32 s14, s13, 98304
    s_lshl3_add_u32 s96, s21, s3
    s_lshl_b32 s97, s96, 15
    s_lshl_b32 s98, s12, 7
    s_add_u32 s18, s97, s98
    s_lshr_b32 s96, s8, 1
    s_lshl4_add_u32 s97, s96, s12
    s_lshl4_add_u32 s98, s97, s3
    s_lshl_b32 s99, s98, 9
    s_add_u32 s17, s99, 524288
    v_lshrrev_b32 v248, 3, v1
    v_mul_u32_u24 v248, 12288, v248
    v_and_b32 v9, 7, v1
    v_lshl_add_u32 v248, v9, 4, v248
    v_lshrrev_b32 v249, 3, v1
    v_lshl_add_u32 v249, v249, 1, s15
    v_and_b32 v10, 15, v1
    v_lshlrev_b32 v10, 11, v10
    v_lshrrev_b32 v9, 4, v1
    v_lshl_add_u32 v10, v9, 4, v10
    s_waitcnt lgkmcnt(0)
    s_mov_b64 s[48:49], s[88:89]
    buffer_load_dwordx4 v[160:163], v248, s[48:51], s13 offen nt
    buffer_load_dwordx4 v[164:167], v248, s[48:51], s14 offen nt
    s_load_dword s4, s[32:33], 0
    global_load_ushort v168, v249, s[86:87]
    global_load_ushort v169, v249, s[86:87] offset:16
    s_mov_b64 s[36:37], s[68:69]
    s_load_dword s24, s[32:33], s92 offset:0 glc
    s_load_dword s25, s[32:33], s17 offset:508 glc
    s_load_dword s26, s[32:33], s17 offset:4604 glc
    s_barrier
    buffer_load_dwordx4 v[152:155], v8, s[36:39], s16 offen
    buffer_load_dwordx4 v[156:159], v8, s[36:39], s16 offen offset:512
    s_mov_b64 s[40:41], s[70:71]
    s_mov_b64 s[44:45], s[74:75]
    s_mov_b64 s[52:53], s[80:81]
    s_mov_b64 s[56:57], s[82:83]
    s_mov_b64 s[60:61], s[84:85]
    s_mov_b64 s[64:65], s[90:91]
    s_getpc_b64 s[22:23]
    s_and_b32 s22, s22, 0xfffffc00
    s_lshl3_add_u32 s96, s9, s3
    s_lshl_b32 s19, s96, 7
    v_lshrrev_b32 v4, 5, v1
    v_lshl_add_u32 v4, v4, 15, s19
    v_min_u32 v4, 41984, v4
    global_load_dword v11, v4, s[22:23]
    s_lshr_b32 s76, s3, 2
    s_and_b32 s77, s3, 3
    s_lshl_b32 s83, s3, 10
    s_mul_i32 s96, s8, 7
    s_lshr_b32 s97, s9, 2
    s_add_u32 s74, s96, s97
    s_and_b32 s75, s9, 3
    v_bfe_u32 v6, v1, 4, 1
    v_lshlrev_b32 v6, 6, v6
    v_and_b32 v3, 7, v1
    v_lshlrev_b32 v3, 4, v3
    v_xor_b32 v3, v3, v6
    v_lshrrev_b32 v6, 3, v1
    v_mul_u32_u24 v6, 6144, v6
    v_add_u32 v3, v3, v6
    s_and_b32 s84, s9, 12
    s_mul_i32 s96, s3, 49152
    s_lshl_b32 s97, s11, 7
    s_add_u32 s85, s96, s97
    v_lshlrev_b32 v250, 3, v1
    v_lshlrev_b32 v251, 5, v1
    v_add_u32 v251, 147456, v251
    s_lshl2_add_u32 s13, s3, 147456
    v_lshrrev_b32 v252, 4, v1
    v_lshl_add_u32 v252, v252, 6, s13
    v_and_b32 v9, 7, v1
    v_lshl_add_u32 v252, v9, 8, v252
    v_bfe_u32 v9, v1, 3, 1
    v_lshl_add_u32 v252, v9, 5, v252
    buffer_load_dwordx4 v[12:15], v10, s[36:39], s18 offen
    buffer_load_dwordx4 v[16:19], v10, s[36:39], s18 offen offset:64
    s_lshr_b32 s96, s3, 1
    s_xor_b32 s97, s9, 1
    s_and_b32 s98, s97, 15
    s_lshl4_add_u32 s99, s96, s98
    s_lshr_b32 s97, s9, 4
    s_lshl1_add_u32 s96, s99, s97
    s_lshl3_add_u32 s98, s96, s8
    s_lshl_b32 s99, s98, 9
    s_add_u32 s13, s99, 524288
    s_waitcnt vmcnt(5)
    v_lshlrev_b32 v168, 16, v168
    v_mul_f32 v4, s7, v168
    v_exp_f32 v4, -v4
    s_nop 0
    v_add_f32 v4, 1.0, v4
    v_rcp_f32 v4, v4
    s_nop 0
    v_mul_f32 v168, v168, v4
    v_cvt_pk_bf16_f32 v168, 0, v168
    v_lshlrev_b32 v169, 16, v169
    v_mul_f32 v5, s7, v169
    v_exp_f32 v5, -v5
    s_nop 0
    v_add_f32 v5, 1.0, v5
    v_rcp_f32 v5, v5
    s_nop 0
    v_mul_f32 v169, v169, v5
    v_cvt_pk_bf16_f32 v169, 0, v169
    v_lshlrev_b32 v4, 16, v160
    v_and_b32 v5, s6, v160
    v_pk_mul_f32 v[176:177], v[168:169], v[4:5] op_sel:[0,0] op_sel_hi:[0,1]
    v_lshlrev_b32 v6, 16, v161
    v_and_b32 v7, s6, v161
    v_pk_mul_f32 v[178:179], v[168:169], v[6:7] op_sel:[0,0] op_sel_hi:[0,1]
    v_lshlrev_b32 v4, 16, v162
    v_and_b32 v5, s6, v162
    v_pk_mul_f32 v[180:181], v[168:169], v[4:5] op_sel:[0,0] op_sel_hi:[0,1]
    v_lshlrev_b32 v6, 16, v163
    v_and_b32 v7, s6, v163
    v_pk_mul_f32 v[182:183], v[168:169], v[6:7] op_sel:[0,0] op_sel_hi:[0,1]
    v_lshlrev_b32 v4, 16, v164
    v_and_b32 v5, s6, v164
    v_pk_fma_f32 v[176:177], v[168:169], v[4:5], v[176:177] op_sel:[1,0,0] op_sel_hi:[1,1,1]
    v_lshlrev_b32 v6, 16, v165
    v_and_b32 v7, s6, v165
    v_pk_fma_f32 v[178:179], v[168:169], v[6:7], v[178:179] op_sel:[1,0,0] op_sel_hi:[1,1,1]
    v_lshlrev_b32 v4, 16, v166
    v_and_b32 v5, s6, v166
    v_pk_fma_f32 v[180:181], v[168:169], v[4:5], v[180:181] op_sel:[1,0,0] op_sel_hi:[1,1,1]
    v_lshlrev_b32 v6, 16, v167
    v_and_b32 v7, s6, v167
    v_pk_fma_f32 v[182:183], v[168:169], v[6:7], v[182:183] op_sel:[1,0,0] op_sel_hi:[1,1,1]
    v_permlane32_swap_b32 v176, v180
    v_permlane32_swap_b32 v177, v181
    v_permlane32_swap_b32 v178, v182
    v_permlane32_swap_b32 v179, v183
    v_add_f32 v176, v176, v180
    v_add_f32 v177, v177, v181
    v_add_f32 v178, v178, v182
    v_add_f32 v179, v179, v183
    s_nop 0
    v_permlane16_swap_b32 v176, v178
    v_permlane16_swap_b32 v177, v179
    v_add_f32 v176, v176, v178
    v_add_f32 v177, v177, v179
    s_nop 0
    v_add_f32_dpp v176, v176, v176 row_ror:8 row_mask:0xf bank_mask:0xf
    v_add_f32_dpp v177, v177, v177 row_ror:8 row_mask:0xf bank_mask:0xf
    s_nop 1
    v_mov_b32_dpp v176, v177 quad_perm:[0,1,2,3] row_mask:0xf bank_mask:0xc
    s_waitcnt lgkmcnt(0)
    s_mul_i32 s4, s4, 0x9e3779b1
    s_add_u32 s4, s4, 0x7f4a7c15
    ds_write_b32 v252, v176
    s_waitcnt lgkmcnt(0)
    s_barrier
    ds_read_b128 v[176:179], v251
    ds_read_b128 v[180:183], v251 offset:16
    s_waitcnt lgkmcnt(0)
    v_pk_add_f32 v[176:177], v[176:177], v[178:179]
    v_pk_add_f32 v[180:181], v[180:181], v[182:183]
    v_pk_add_f32 v[176:177], v[176:177], v[180:181]
    v_add_f32 v176, v176, v177
    v_mov_b32 v177, s4
    s_bitcmp1_b32 s3, 0
    s_cselect_b32 exec_lo, 0, -1
    s_cselect_b32 exec_hi, -1, 0
    buffer_store_dwordx2 v[176:177], v250, s[32:35], s13 offen sc1
    s_mov_b64 exec, -1
    s_lshr_b32 s96, s9, 4
    s_lshl_b32 s94, s96, 1
    s_add_u32 s96, s94, s84
    s_and_b32 s97, s96, 15
    s_mul_i32 s98, s97, 393216
    s_add_u32 s91, s98, s85
    s_lshl_b32 s96, s94, 13
    s_add_u32 s94, s96, s83
    s_add_u32 s82, s91, 2048
    s_mov_b32 m0, s94
    s_nop 0
    buffer_load_dwordx4 v3, s[40:43], s82 offen lds
    s_add_u32 s82, s91, 4096
    s_add_u32 m0, s94, 49152
    s_nop 0
    buffer_load_dwordx4 v3, s[40:43], s82 offen lds
    s_waitcnt vmcnt(6)
    v_mov_b32 v8, 0x3f803f80
    v_dot2_f32_bf16 v4, v152, v8, 0
    v_dot2_f32_bf16 v5, v152, v152, 0
    v_dot2_f32_bf16 v6, v153, v8, 0
    v_dot2_f32_bf16 v7, v153, v153, 0
    v_dot2_f32_bf16 v4, v154, v8, v4
    v_dot2_f32_bf16 v5, v154, v154, v5
    v_dot2_f32_bf16 v6, v155, v8, v6
    v_dot2_f32_bf16 v7, v155, v155, v7
    v_dot2_f32_bf16 v4, v156, v8, v4
    v_dot2_f32_bf16 v5, v156, v156, v5
    v_dot2_f32_bf16 v6, v157, v8, v6
    v_dot2_f32_bf16 v7, v157, v157, v7
    v_dot2_f32_bf16 v4, v158, v8, v4
    v_dot2_f32_bf16 v5, v158, v158, v5
    v_dot2_f32_bf16 v6, v159, v8, v6
    v_dot2_f32_bf16 v7, v159, v159, v7
    s_lshl_b32 s96, s3, 5
    s_add_u32 s13, s96, 153600
    v_lshrrev_b32 v8, 5, v1
    v_lshl_add_u32 v8, v8, 4, s13
    v_bfe_u32 v9, v1, 4, 1
    v_lshl_add_u32 v8, v9, 3, v8
    v_pk_add_f32 v[172:173], v[4:5], v[6:7]
    v_and_b32 v5, 15, v1
    v_lshlrev_b32 v5, 4, v5
    v_add_u32 v5, 153600, v5
    v_and_b32 v4, 15, v1
    v_lshlrev_b32 v4, 4, v4
    v_bfe_u32 v9, v1, 4, 1
    v_lshl_add_u32 v4, v9, 12, v4
    v_add_f32_dpp v172, v172, v172 quad_perm:[1,0,3,2] row_mask:0xf bank_mask:0xf
    v_add_f32_dpp v173, v173, v173 quad_perm:[1,0,3,2] row_mask:0xf bank_mask:0xf
    s_nop 0
    v_add_f32_dpp v172, v172, v172 quad_perm:[2,3,0,1] row_mask:0xf bank_mask:0xf
    v_add_f32_dpp v173, v173, v173 quad_perm:[2,3,0,1] row_mask:0xf bank_mask:0xf
    s_nop 0
    v_add_f32_dpp v172, v172, v172 row_half_mirror row_mask:0xf bank_mask:0xf
    v_add_f32_dpp v173, v173, v173 row_half_mirror row_mask:0xf bank_mask:0xf
    s_nop 0
    v_add_f32_dpp v172, v172, v172 row_mirror row_mask:0xf bank_mask:0xf
    v_add_f32_dpp v173, v173, v173 row_mirror row_mask:0xf bank_mask:0xf
    s_and_b32 s96, s9, 24
    s_add_u32 s97, s96, s3
    s_and_b32 s98, s8, 6
    s_lshl3_add_u32 s99, s97, s98
    s_lshl_b32 s96, s99, 12
    s_and_b32 s97, s9, 7
    s_lshl_b32 s98, s97, 9
    s_add_u32 s99, s96, s98
    s_and_b32 s97, s8, 1
    s_lshl_b32 s96, s97, 8
    s_add_u32 s98, s99, s96
    s_add_u32 s13, s98, 2097152
    v_permlane16_swap_b32 v172, v173
    v_add_f32 v172, v172, v173
    v_mov_b32 v173, s4
    ds_write_b64 v8, v[172:173]
    s_waitcnt lgkmcnt(0)
    s_barrier
    ds_read_b128 v[172:175], v5
    s_waitcnt lgkmcnt(0)
    s_mov_b32 exec_hi, 0
    buffer_store_dwordx4 v[172:175], v4, s[32:35], s13 offen sc1
    s_mov_b32 exec_hi, -1
    s_mov_b32 s82, s91
    s_add_u32 m0, s94, 98304
    s_nop 0
    buffer_load_dwordx4 v3, s[40:43], s82 offen lds
    s_lshr_b32 s96, s9, 4
    s_lshl_b32 s97, s96, 1
    s_xor_b32 s94, s97, 1
    s_add_u32 s96, s94, s84
    s_and_b32 s97, s96, 15
    s_mul_i32 s98, s97, 393216
    s_add_u32 s91, s98, s85
    s_lshl_b32 s96, s94, 13
    s_add_u32 s94, s96, s83
    s_add_u32 s82, s91, 2048
    s_mov_b32 m0, s94
    s_nop 0
    buffer_load_dwordx4 v3, s[40:43], s82 offen lds
    s_load_dword s24, s[32:33], s17 offset:508 glc
    s_load_dword s25, s[32:33], s17 offset:4604 glc
    v_and_b32 v4, 31, v1
    v_lshlrev_b32 v4, 4, v4
    v_lshrrev_b32 v9, 5, v1
    v_lshl_add_u32 v4, v9, 12, v4
    s_lshl2_add_u32 s14, s3, 155648
    v_lshl_add_u32 v5, v1, 6, s14
    v_and_b32 v6, 3, v1
    v_lshlrev_b32 v6, 5, v6
    v_lshrrev_b32 v9, 5, v1
    v_lshl_add_u32 v6, v9, 7, v6
    v_bfe_u32 v9, v1, 4, 1
    v_lshl_add_u32 v6, v9, 8, v6
    v_bfe_u32 v9, v1, 2, 2
    v_lshl_add_u32 v6, v9, 9, v6
    v_add_u32 v6, 155648, v6
    s_lshl3_add_u32 s96, s2, s3
    s_lshl_b32 s97, s96, 9
    s_add_u32 s14, s97, 2097152
    v_and_b32 v8, 31, v1
    v_lshlrev_b32 v8, 4, v8
    s_branch SCHK_2
SPOLL_1:
    s_load_dword s24, s[32:33], s17 offset:508 glc
    s_load_dword s25, s[32:33], s17 offset:4604 glc
SCHK_2:
    s_add_u32 s5, s5, 1
    s_cmp_ge_u32 s5, 200000
    s_waitcnt lgkmcnt(0)
    s_cbranch_scc1 SDONE_3
    s_cmp_lg_u32 s24, s4
    s_cbranch_scc1 SPOLL_1
    s_cmp_lg_u32 s25, s4
    s_cbranch_scc1 SPOLL_1
SDONE_3:
    buffer_load_dwordx4 v[176:179], v4, s[32:35], s17 offen sc1
    s_load_dword s24, s[32:33], s14 offset:252 glc
    s_load_dword s25, s[32:33], s14 offset:508 glc
    s_waitcnt vmcnt(7)
    v_permlane32_swap_b32 v12, v14
    v_permlane32_swap_b32 v13, v15
    v_permlane32_swap_b32 v16, v18
    v_permlane32_swap_b32 v17, v19
    v_lshlrev_b32 v184, 16, v12
    v_and_b32 v185, s6, v12
    v_lshlrev_b32 v186, 16, v13
    v_and_b32 v187, s6, v13
    v_lshlrev_b32 v188, 16, v14
    v_and_b32 v189, s6, v14
    v_lshlrev_b32 v190, 16, v15
    v_and_b32 v191, s6, v15
    v_lshlrev_b32 v192, 16, v16
    v_and_b32 v193, s6, v16
    v_lshlrev_b32 v194, 16, v17
    v_and_b32 v195, s6, v17
    v_lshlrev_b32 v196, 16, v18
    v_and_b32 v197, s6, v18
    v_lshlrev_b32 v198, 16, v19
    v_and_b32 v199, s6, v19
    s_branch SCHK_6
SPOLL_5:
    s_load_dword s24, s[32:33], s14 offset:252 glc
    s_load_dword s25, s[32:33], s14 offset:508 glc
SCHK_6:
    s_add_u32 s5, s5, 1
    s_cmp_ge_u32 s5, 200000
    s_waitcnt lgkmcnt(0)
    s_cbranch_scc1 SDONE_7
    s_cmp_lg_u32 s24, s4
    s_cbranch_scc1 SPOLL_5
    s_cmp_lg_u32 s25, s4
    s_cbranch_scc1 SPOLL_5
SDONE_7:
    buffer_load_dwordx4 v[172:175], v8, s[32:35], s14 offen sc1
    s_add_u32 s82, s91, 4096
    s_add_u32 m0, s94, 49152
    s_nop 0
    buffer_load_dwordx4 v3, s[40:43], s82 offen lds
    s_mov_b32 s82, s91
    s_add_u32 m0, s94, 98304
    s_nop 0
    buffer_load_dwordx4 v3, s[40:43], s82 offen lds
    s_lshr_b32 s96, s9, 4
    s_lshl_b32 s97, s96, 1
    s_xor_b32 s94, s97, 2
    s_add_u32 s96, s94, s84
    s_and_b32 s97, s96, 15
    s_mul_i32 s98, s97, 393216
    s_add_u32 s91, s98, s85
    s_lshl_b32 s96, s94, 13
    s_add_u32 s94, s96, s83
    s_add_u32 s82, s91, 2048
    s_mov_b32 m0, s94
    s_nop 0
    buffer_load_dwordx4 v3, s[40:43], s82 offen lds
    s_waitcnt vmcnt(4)
    v_bitop3_b32 v7, v177, v179, s4 bitop3:0x7e
    v_cmp_ne_u32 vcc, 0, v7
    s_cbranch_vccz TOK_8
POLL_9:
    buffer_load_dwordx4 v[176:179], v4, s[32:35], s17 offen sc1
    s_waitcnt vmcnt(0)
    v_bitop3_b32 v7, v177, v179, s4 bitop3:0x7e
    v_cmp_ne_u32 vcc, 0, v7
    s_cbranch_vccz PDONE_10
    s_add_u32 s5, s5, 1
    s_cmp_lt_u32 s5, 200000
    s_cbranch_scc1 POLL_9
PDONE_10:
TOK_8:
    ds_write2_b32 v5, v176, v178 offset0:0 offset1:8
    s_waitcnt lgkmcnt(0)
    s_barrier
    ds_read_b128 v[208:211], v6 offset:2048
    ds_read_b128 v[212:215], v6 offset:2064
    ds_read_b128 v[200:203], v6
    ds_read_b128 v[204:207], v6 offset:16
    s_lshl_b32 s96, s11, 12
    s_lshl_b32 s97, s3, 9
    s_add_u32 s13, s96, s97
    v_add_u32 v4, s13, v2
    s_lshl_b32 s96, s3, 9
    s_add_u32 m0, s96, 159744
    s_mov_b32 exec_hi, 0
    global_load_lds_dwordx4 v4, s[72:73]
    s_mov_b32 exec_hi, -1
    s_lshl4_add_u32 s96, s21, s12
    s_lshr_b32 s97, s3, 1
    s_lshl2_add_u32 s98, s96, s97
    s_lshl_b32 s99, s98, 12
    s_and_b32 s96, s3, 1
    s_lshl_b32 s97, s96, 8
    s_add_u32 s98, s99, s97
    s_add_u32 s13, s98, 4194304
    v_and_b32 v4, 15, v1
    v_lshlrev_b32 v4, 4, v4
    v_bfe_u32 v9, v1, 4, 1
    v_lshl_add_u32 v4, v9, 10, v4
    v_lshrrev_b32 v9, 5, v1
    v_lshl_add_u32 v4, v9, 9, v4
    s_waitcnt lgkmcnt(2)
    v_pk_add_f32 v[208:209], v[208:209], v[210:211]
    v_pk_add_f32 v[212:213], v[212:213], v[214:215]
    v_pk_add_f32 v[208:209], v[208:209], v[212:213]
    v_add_f32 v208, v208, v209
    v_cvt_pk_bf16_f32 v208, 0, v208
    s_waitcnt lgkmcnt(0)
    v_pk_add_f32 v[200:201], v[200:201], v[202:203]
    v_pk_add_f32 v[204:205], v[204:205], v[206:207]
    v_pk_add_f32 v[200:201], v[200:201], v[204:205]
    v_add_f32 v200, v200, v201
    v_add_f32 v208, 1.0, v208
    v_cvt_pk_bf16_f32 v208, 0, v208
    v_cvt_pk_bf16_f32 v200, 0, v200
    s_waitcnt vmcnt(4)
    v_bitop3_b32 v7, v173, v175, s4 bitop3:0x7e
    v_cmp_ne_u32 vcc, 0, v7
    s_cbranch_vccz L_STOK
POLL_11:
    buffer_load_dwordx4 v[172:175], v8, s[32:35], s14 offen sc1
    s_waitcnt vmcnt(0)
    v_bitop3_b32 v7, v173, v175, s4 bitop3:0x7e
    v_cmp_ne_u32 vcc, 0, v7
    s_cbranch_vccz PDONE_12
    s_add_u32 s5, s5, 1
    s_cmp_lt_u32 s5, 200000
    s_cbranch_scc1 POLL_11
PDONE_12:
L_STOK:
    v_permlane16_swap_b32 v172, v174
    v_add_f32 v175, v172, v174
    v_mul_f32 v174, 0x3a800000, v175
    v_mul_f32 v175, 0x3a800000, v175
    s_nop 1
    v_permlane16_swap_b32 v174, v175
    v_fma_f32 v172, -v174, v174, v175
    v_cvt_pk_bf16_f32 v173, 0, v174
    v_max_f32 v172, 0, v172
    v_cvt_pk_bf16_f32 v172, 0, v172
    v_pk_add_f32 v[184:185], v[172:173], v[184:185] op_sel:[1,0] neg_lo:[1,0] neg_hi:[1,0]
    v_pk_add_f32 v[186:187], v[172:173], v[186:187] op_sel:[1,0] neg_lo:[1,0] neg_hi:[1,0]
    v_pk_add_f32 v[188:189], v[172:173], v[188:189] op_sel:[1,0] neg_lo:[1,0] neg_hi:[1,0]
    v_pk_add_f32 v[190:191], v[172:173], v[190:191] op_sel:[1,0] neg_lo:[1,0] neg_hi:[1,0]
    v_add_f32 v172, 0x3727c5ac, v172
    v_cvt_pk_bf16_f32 v172, 0, v172
    v_sqrt_f32 v172, v172
    s_nop 0
    v_pk_add_f32 v[192:193], v[172:173], v[192:193] op_sel:[1,0] neg_lo:[1,0] neg_hi:[1,0]
    v_pk_add_f32 v[194:195], v[172:173], v[194:195] op_sel:[1,0] neg_lo:[1,0] neg_hi:[1,0]
    v_pk_add_f32 v[196:197], v[172:173], v[196:197] op_sel:[1,0] neg_lo:[1,0] neg_hi:[1,0]
    v_pk_add_f32 v[198:199], v[172:173], v[198:199] op_sel:[1,0] neg_lo:[1,0] neg_hi:[1,0]
    v_cvt_pk_bf16_f32 v172, 0, v172
    v_rcp_f32 v172, v172
    v_cvt_pk_bf16_f32 v184, 0, v184
    v_cvt_pk_bf16_f32 v185, 0, v185
    v_cvt_pk_bf16_f32 v186, 0, v186
    v_cvt_pk_bf16_f32 v187, 0, v187
    v_cvt_pk_bf16_f32 v188, 0, v188
    v_cvt_pk_bf16_f32 v189, 0, v189
    v_cvt_pk_bf16_f32 v190, 0, v190
    v_cvt_pk_bf16_f32 v191, 0, v191
    v_cvt_pk_bf16_f32 v192, 0, v192
    v_cvt_pk_bf16_f32 v193, 0, v193
    v_cvt_pk_bf16_f32 v194, 0, v194
    v_cvt_pk_bf16_f32 v195, 0, v195
    v_cvt_pk_bf16_f32 v196, 0, v196
    v_cvt_pk_bf16_f32 v197, 0, v197
    v_cvt_pk_bf16_f32 v198, 0, v198
    v_cvt_pk_bf16_f32 v199, 0, v199
    v_pk_mul_f32 v[184:185], v[184:185], v[172:173] op_sel_hi:[1,0]
    v_pk_mul_f32 v[186:187], v[186:187], v[172:173] op_sel_hi:[1,0]
    v_pk_mul_f32 v[188:189], v[188:189], v[172:173] op_sel_hi:[1,0]
    v_pk_mul_f32 v[190:191], v[190:191], v[172:173] op_sel_hi:[1,0]
    v_pk_mul_f32 v[192:193], v[192:193], v[172:173] op_sel_hi:[1,0]
    v_pk_mul_f32 v[194:195], v[194:195], v[172:173] op_sel_hi:[1,0]
    v_pk_mul_f32 v[196:197], v[196:197], v[172:173] op_sel_hi:[1,0]
    v_pk_mul_f32 v[198:199], v[198:199], v[172:173] op_sel_hi:[1,0]
    v_cvt_pk_bf16_f32 v184, 0, v184
    v_cvt_pk_bf16_f32 v185, 0, v185
    v_cvt_pk_bf16_f32 v186, 0, v186
    v_cvt_pk_bf16_f32 v187, 0, v187
    v_cvt_pk_bf16_f32 v188, 0, v188
    v_cvt_pk_bf16_f32 v189, 0, v189
    v_cvt_pk_bf16_f32 v190, 0, v190
    v_cvt_pk_bf16_f32 v191, 0, v191
    v_cvt_pk_bf16_f32 v192, 0, v192
    v_cvt_pk_bf16_f32 v193, 0, v193
    v_cvt_pk_bf16_f32 v194, 0, v194
    v_cvt_pk_bf16_f32 v195, 0, v195
    v_cvt_pk_bf16_f32 v196, 0, v196
    v_cvt_pk_bf16_f32 v197, 0, v197
    v_cvt_pk_bf16_f32 v198, 0, v198
    v_cvt_pk_bf16_f32 v199, 0, v199
    v_mul_f32_dpp v184, v208, v184 row_newbcast:0 row_mask:0xf bank_mask:0xf
    v_mul_f32_dpp v185, v208, v185 row_newbcast:1 row_mask:0xf bank_mask:0xf
    v_mul_f32_dpp v186, v208, v186 row_newbcast:2 row_mask:0xf bank_mask:0xf
    v_mul_f32_dpp v187, v208, v187 row_newbcast:3 row_mask:0xf bank_mask:0xf
    v_mul_f32_dpp v188, v208, v188 row_newbcast:4 row_mask:0xf bank_mask:0xf
    v_mul_f32_dpp v189, v208, v189 row_newbcast:5 row_mask:0xf bank_mask:0xf
    v_mul_f32_dpp v190, v208, v190 row_newbcast:6 row_mask:0xf bank_mask:0xf
    v_mul_f32_dpp v191, v208, v191 row_newbcast:7 row_mask:0xf bank_mask:0xf
    v_cvt_pk_bf16_f32 v184, 0, v184
    v_cvt_pk_bf16_f32 v185, 0, v185
    v_cvt_pk_bf16_f32 v186, 0, v186
    v_cvt_pk_bf16_f32 v187, 0, v187
    v_cvt_pk_bf16_f32 v188, 0, v188
    v_cvt_pk_bf16_f32 v189, 0, v189
    v_cvt_pk_bf16_f32 v190, 0, v190
    v_cvt_pk_bf16_f32 v191, 0, v191
    v_add_f32_dpp v184, v200, v184 row_newbcast:0 row_mask:0xf bank_mask:0xf
    v_add_f32_dpp v185, v200, v185 row_newbcast:1 row_mask:0xf bank_mask:0xf
    v_add_f32_dpp v186, v200, v186 row_newbcast:2 row_mask:0xf bank_mask:0xf
    v_add_f32_dpp v187, v200, v187 row_newbcast:3 row_mask:0xf bank_mask:0xf
    v_add_f32_dpp v188, v200, v188 row_newbcast:4 row_mask:0xf bank_mask:0xf
    v_add_f32_dpp v189, v200, v189 row_newbcast:5 row_mask:0xf bank_mask:0xf
    v_add_f32_dpp v190, v200, v190 row_newbcast:6 row_mask:0xf bank_mask:0xf
    v_add_f32_dpp v191, v200, v191 row_newbcast:7 row_mask:0xf bank_mask:0xf
    v_cvt_pk_bf16_f32 v216, v184, v185
    v_cvt_pk_bf16_f32 v217, v186, v187
    v_cvt_pk_bf16_f32 v218, v188, v189
    v_cvt_pk_bf16_f32 v219, v190, v191
    buffer_store_dwordx4 v[216:219], v4, s[32:35], s13 offen sc1
    v_mul_f32_dpp v192, v208, v192 row_newbcast:8 row_mask:0xf bank_mask:0xf
    v_mul_f32_dpp v193, v208, v193 row_newbcast:9 row_mask:0xf bank_mask:0xf
    v_mul_f32_dpp v194, v208, v194 row_newbcast:10 row_mask:0xf bank_mask:0xf
    v_mul_f32_dpp v195, v208, v195 row_newbcast:11 row_mask:0xf bank_mask:0xf
    v_mul_f32_dpp v196, v208, v196 row_newbcast:12 row_mask:0xf bank_mask:0xf
    v_mul_f32_dpp v197, v208, v197 row_newbcast:13 row_mask:0xf bank_mask:0xf
    v_mul_f32_dpp v198, v208, v198 row_newbcast:14 row_mask:0xf bank_mask:0xf
    v_mul_f32_dpp v199, v208, v199 row_newbcast:15 row_mask:0xf bank_mask:0xf
    v_cvt_pk_bf16_f32 v192, 0, v192
    v_cvt_pk_bf16_f32 v193, 0, v193
    v_cvt_pk_bf16_f32 v194, 0, v194
    v_cvt_pk_bf16_f32 v195, 0, v195
    v_cvt_pk_bf16_f32 v196, 0, v196
    v_cvt_pk_bf16_f32 v197, 0, v197
    v_cvt_pk_bf16_f32 v198, 0, v198
    v_cvt_pk_bf16_f32 v199, 0, v199
    v_add_f32_dpp v192, v200, v192 row_newbcast:8 row_mask:0xf bank_mask:0xf
    v_add_f32_dpp v193, v200, v193 row_newbcast:9 row_mask:0xf bank_mask:0xf
    v_add_f32_dpp v194, v200, v194 row_newbcast:10 row_mask:0xf bank_mask:0xf
    v_add_f32_dpp v195, v200, v195 row_newbcast:11 row_mask:0xf bank_mask:0xf
    v_add_f32_dpp v196, v200, v196 row_newbcast:12 row_mask:0xf bank_mask:0xf
    v_add_f32_dpp v197, v200, v197 row_newbcast:13 row_mask:0xf bank_mask:0xf
    v_add_f32_dpp v198, v200, v198 row_newbcast:14 row_mask:0xf bank_mask:0xf
    v_add_f32_dpp v199, v200, v199 row_newbcast:15 row_mask:0xf bank_mask:0xf
    v_cvt_pk_bf16_f32 v220, v192, v193
    v_cvt_pk_bf16_f32 v221, v194, v195
    v_cvt_pk_bf16_f32 v222, v196, v197
    v_cvt_pk_bf16_f32 v223, v198, v199
    buffer_store_dwordx4 v[220:223], v4, s[32:35], s13 offen offset:2048 sc1
    v_bfe_u32 v20, v1, 2, 2
    v_lshlrev_b32 v20, 7, v20
    v_bfe_u32 v9, v1, 3, 1
    v_lshl_add_u32 v20, v9, 6, v20
    v_bfe_u32 v9, v1, 4, 1
    v_lshl_add_u32 v20, v9, 5, v20
    v_and_b32 v9, 3, v1
    v_lshl_add_u32 v20, v9, 3, v20
    v_lshrrev_b32 v9, 5, v1
    v_lshl_add_u32 v20, v9, 9, v20
    v_xor_b32 v21, 64, v20
    v_add_u32 v22, 49152, v20
    v_add_u32 v23, 49152, v21
    v_add_u32 v24, 98304, v20
    v_add_u32 v25, 98304, v21
    v_and_b32 v5, 3, v1
    v_lshlrev_b32 v5, 15, v5
    v_bfe_u32 v9, v1, 2, 2
    v_lshl_add_u32 v5, v9, 12, v5
    s_and_b32 s96, s12, 1
    s_lshr_b32 s97, s21, 3
    s_and_b32 s98, s21, 7
    s_lshl_b32 s99, s98, 5
    s_lshl2_add_u32 s98, s97, s99
    s_lshl_b32 s97, s98, 12
    s_lshr_b32 s99, s12, 1
    s_lshl_b32 s98, s99, 6
    s_add_u32 s99, s97, s98
    s_lshl2_add_u32 s97, s96, s99
    s_add_u32 s13, s97, 1048576
    s_lshl_b32 s96, s10, 18
    s_lshl_b32 s97, s77, 12
    s_add_u32 s98, s96, s97
    s_add_u32 s88, s98, 4194304
    s_cmp_ge_u32 s9, 28
    s_cselect_b32 s54, 0, s54
    s_cselect_b32 s58, 0, s58
    s_cselect_b32 s62, 0, s62
    s_waitcnt vmcnt(0)
    s_barrier
    s_cmp_lg_u32 s3, 0
    s_cbranch_scc1 L_PB
    v_mov_b32 v6, s4
    s_mov_b32 exec_hi, 0
    s_mov_b32 exec_lo, 65535
    buffer_store_dword v6, v5, s[32:35], s13 offen sc1
    s_mov_b64 exec, -1
L_PB:
    s_add_u32 s82, s91, 4096
    s_add_u32 m0, s94, 49152
    s_nop 0
    buffer_load_dwordx4 v3, s[40:43], s82 offen lds
    s_mov_b32 s82, s91
    s_add_u32 m0, s94, 98304
    s_nop 0
    buffer_load_dwordx4 v3, s[40:43], s82 offen lds
    s_lshr_b32 s96, s9, 4
    s_lshl_b32 s97, s96, 1
    s_xor_b32 s94, s97, 3
    s_add_u32 s96, s94, s84
    s_and_b32 s97, s96, 15
    s_mul_i32 s98, s97, 393216
    s_add_u32 s91, s98, s85
    s_lshl_b32 s96, s94, 13
    s_add_u32 s94, s96, s83
    s_add_u32 s82, s91, 2048
    s_mov_b32 m0, s94
    s_nop 0
    buffer_load_dwordx4 v3, s[40:43], s82 offen lds
    s_add_u32 s82, s91, 4096
    s_add_u32 m0, s94, 49152
    s_nop 0
    buffer_load_dwordx4 v3, s[40:43], s82 offen lds
    s_mov_b32 s82, s91
    s_add_u32 m0, s94, 98304
    s_nop 0
    buffer_load_dwordx4 v3, s[40:43], s82 offen lds
    s_lshl_b32 s96, s2, 12
    s_add_u32 s19, s96, 1048576
    s_and_b32 s96, s3, 3
    s_lshl_b32 s97, s96, 7
    s_add_u32 s20, s97, s19
    s_lshl_b32 s96, s84, 5
    s_add_u32 s19, s96, s19
    s_cmp_ge_u32 s3, 4
    s_cselect_b32 s19, s20, s19
    s_load_dwordx2 s[24:25], s[32:33], s19 offset:0 glc
    s_load_dwordx2 s[26:27], s[32:33], s19 offset:64 glc
    s_add_u32 s96, s84, 4
    s_and_b32 s97, s96, 15
    s_mul_i32 s98, s97, 393216
    s_add_u32 s91, s98, s85
    s_add_u32 s94, s83, 32768
    s_add_u32 s82, s91, 2048
    s_mov_b32 m0, s94
    s_nop 0
    buffer_load_dwordx4 v3, s[40:43], s82 offen lds
    s_add_u32 s82, s91, 4096
    s_add_u32 m0, s94, 49152
    s_nop 0
    buffer_load_dwordx4 v3, s[40:43], s82 offen lds
    s_mov_b32 s82, s91
    s_add_u32 m0, s94, 98304
    s_nop 0
    buffer_load_dwordx4 v3, s[40:43], s82 offen lds
    s_lshl_b32 s96, s3, 14
    s_lshl_b32 s97, s12, 7
    s_add_u32 s90, s96, s97
    s_and_b32 s96, s9, 1
    s_lshr_b32 s97, s9, 3
    s_lshl_b32 s98, s97, 1
    s_lshl3_add_u32 s99, s96, s98
    s_lshl_b32 s95, s99, 17
    s_lshl3_add_u32 s96, s75, s3
    s_mul_i32 s97, s96, 229376
    s_lshl_b32 s98, s74, 7
    s_add_u32 s80, s97, s98
    s_lshl3_add_u32 s96, s74, s3
    s_lshl_b32 s97, s96, 14
    s_lshl_b32 s98, s75, 9
    s_add_u32 s81, s97, s98
    s_and_b32 s96, s8, 3
    s_lshl3_add_u32 s97, s96, s3
    s_mul_i32 s98, s97, 393216
    s_lshr_b32 s99, s8, 2
    s_lshl1_add_u32 s96, s9, s99
    s_lshl_b32 s97, s96, 7
    s_add_u32 s99, s98, s97
    s_add_u32 s89, s99, 4096
    s_and_b32 s96, s3, 1
    s_lshl_b32 s14, s96, 6
    v_bfe_u32 v6, v1, 4, 1
    v_lshl_add_u32 v6, v6, 5, s14
    v_and_b32 v26, 7, v1
    v_lshlrev_b32 v26, 4, v26
    v_xor_b32 v26, v26, v6
    v_lshrrev_b32 v6, 3, v1
    v_lshlrev_b32 v6, 11, v6
    v_add_u32 v26, v26, v6
    s_and_b32 s96, s3, 2
    s_lshl_b32 s14, s96, 5
    v_bfe_u32 v6, v1, 4, 1
    v_lshl_add_u32 v6, v6, 5, s14
    v_and_b32 v27, 7, v1
    v_lshlrev_b32 v27, 4, v27
    v_xor_b32 v27, v27, v6
    v_lshrrev_b32 v6, 3, v1
    v_mul_u32_u24 v6, 7168, v6
    v_add_u32 v27, v27, v6
    s_and_b32 s96, s3, 1
    s_lshl_b32 s14, s96, 7
    v_lshrrev_b32 v6, 5, v1
    v_lshl_add_u32 v6, v6, 6, s14
    v_and_b32 v253, 31, v1
    v_lshlrev_b32 v253, 4, v253
    v_lshrrev_b32 v9, 5, v1
    v_lshl_add_u32 v253, v9, 11, v253
    v_xor_b32 v253, v253, v6
    s_lshl_b32 s16, s84, 14
    v_add_u32 v249, s88, v2
    s_lshl_b32 s96, s77, 11
    s_add_u32 s14, s96, 151552
    v_add_u32 v0, s14, v2
    s_mov_b64 exec, 0
    s_cmp_eq_u32 s3, 4
    s_cbranch_scc1 L_PAD2
    s_cmp_eq_u32 s3, 5
    s_cbranch_scc1 L_PAD3
    s_cmp_eq_u32 s3, 6
    s_cbranch_scc1 L_PAD4
    s_cmp_eq_u32 s3, 7
    s_cbranch_scc1 L_PAD5
    s_branch L_TEND
L_RET2:
    s_branch L_PAD6
L_RET6:
    s_branch L_PAD10
L_RET10:
    s_branch L_TEND
L_RET3:
    s_branch L_PAD7
L_RET7:
    s_branch L_TEND
L_RET4:
    s_branch L_PAD8
L_RET8:
    s_branch L_TEND
L_RET5:
    s_branch L_PAD9
L_RET9:
    s_branch L_TEND
    s_nop 0
    s_nop 0
    s_nop 0
    s_nop 0
    s_nop 0
    s_nop 0
    s_nop 0
    s_nop 0
    s_nop 0
    s_nop 0
    s_nop 0
    s_nop 0
    s_nop 0
    s_nop 0
    s_nop 0
    s_nop 0
    s_nop 0
    s_nop 0
    s_nop 0
    s_nop 0
    s_nop 0
    s_nop 0
    s_nop 0
    s_nop 0
    s_nop 0
    s_nop 0
    s_nop 0
    s_nop 0
L_TEND:
    s_mov_b64 exec, -1
    s_branch SCHK_14
SPOLL_13:
    s_load_dwordx2 s[24:25], s[32:33], s19 offset:0 glc
    s_load_dwordx2 s[26:27], s[32:33], s19 offset:64 glc
SCHK_14:
    s_add_u32 s5, s5, 1
    s_cmp_ge_u32 s5, 200000
    s_waitcnt lgkmcnt(0)
    s_cbranch_scc1 SDONE_15
    s_cmp_lg_u32 s24, s4
    s_cbranch_scc1 SPOLL_13
    s_cmp_lg_u32 s25, s4
    s_cbranch_scc1 SPOLL_13
    s_cmp_lg_u32 s26, s4
    s_cbranch_scc1 SPOLL_13
    s_cmp_lg_u32 s27, s4
    s_cbranch_scc1 SPOLL_13
SDONE_15:
    s_cmp_ge_u32 s3, 4
    s_cbranch_scc1 L_HELP
    s_setprio 2
    buffer_load_dwordx4 v[152:155], v249, s[32:35], s16 offen sc1
    buffer_load_dwordx4 v[156:159], v249, s[32:35], s16 offen offset:1024 sc1
    buffer_load_dwordx4 v[160:163], v249, s[32:35], s16 offen offset:2048 sc1
    buffer_load_dwordx4 v[164:167], v249, s[32:35], s16 offen offset:3072 sc1
    s_add_u32 s16, s16, 16384
    s_and_b32 s16, s16, 0x3ffff
    buffer_load_dwordx4 v[168:171], v249, s[32:35], s16 offen sc1
    buffer_load_dwordx4 v[172:175], v249, s[32:35], s16 offen offset:1024 sc1
    s_waitcnt vmcnt(9)
    s_barrier
    ds_read_b64_tr_b16 v[28:29], v20
    ds_read_b64_tr_b16 v[30:31], v20 offset:2048
    ds_read_b64_tr_b16 v[32:33], v21
    ds_read_b64_tr_b16 v[34:35], v21 offset:2048
    ds_read_b64_tr_b16 v[36:37], v24
    ds_read_b64_tr_b16 v[38:39], v24 offset:2048
    ds_read_b64_tr_b16 v[40:41], v25
    ds_read_b64_tr_b16 v[42:43], v25 offset:2048
    ds_read_b64_tr_b16 v[44:45], v22
    ds_read_b64_tr_b16 v[46:47], v22 offset:2048
    ds_read_b64_tr_b16 v[48:49], v23
    ds_read_b64_tr_b16 v[50:51], v23 offset:2048
    s_waitcnt vmcnt(5)
    s_waitcnt lgkmcnt(10)
    v_mfma_f32_32x32x16_bf16 v[56:71], v[28:31], v[152:155], 0
    ds_read_b64_tr_b16 v[52:53], v20 offset:1024
    ds_read_b64_tr_b16 v[54:55], v20 offset:3072
    s_waitcnt lgkmcnt(10)
    v_mfma_f32_32x32x16_bf16 v[72:87], v[32:35], v[152:155], 0
    ds_read_b64_tr_b16 v[28:29], v21 offset:1024
    ds_read_b64_tr_b16 v[30:31], v21 offset:3072
    s_waitcnt lgkmcnt(10)
    v_mfma_f32_32x32x16_bf16 v[120:135], v[36:39], v[152:155], 0
    ds_read_b64_tr_b16 v[32:33], v24 offset:1024
    ds_read_b64_tr_b16 v[34:35], v24 offset:3072
    s_waitcnt lgkmcnt(10)
    v_mfma_f32_32x32x16_bf16 v[136:151], v[40:43], v[152:155], 0
    buffer_load_dwordx4 v[176:179], v249, s[32:35], s16 offen offset:2048 sc1
    ds_read_b64_tr_b16 v[36:37], v25 offset:1024
    ds_read_b64_tr_b16 v[38:39], v25 offset:3072
    s_waitcnt lgkmcnt(10)
    v_mfma_f32_32x32x16_bf16 v[88:103], v[44:47], v[152:155], 0
    ds_read_b64_tr_b16 v[40:41], v22 offset:1024
    ds_read_b64_tr_b16 v[42:43], v22 offset:3072
    s_waitcnt lgkmcnt(10)
    v_mfma_f32_32x32x16_bf16 v[104:119], v[48:51], v[152:155], 0
    ds_read_b64_tr_b16 v[44:45], v23 offset:1024
    ds_read_b64_tr_b16 v[46:47], v23 offset:3072
    s_waitcnt vmcnt(5)
    s_waitcnt lgkmcnt(10)
    v_mfma_f32_32x32x16_bf16 v[56:71], v[52:55], v[156:159], v[56:71]
    ds_read_b64_tr_b16 v[48:49], v20 offset:4096
    ds_read_b64_tr_b16 v[50:51], v20 offset:6144
    s_waitcnt lgkmcnt(10)
    v_mfma_f32_32x32x16_bf16 v[72:87], v[28:31], v[156:159], v[72:87]
    buffer_load_dwordx4 v[180:183], v249, s[32:35], s16 offen offset:3072 sc1
    ds_read_b64_tr_b16 v[52:53], v21 offset:4096
    ds_read_b64_tr_b16 v[54:55], v21 offset:6144
    s_waitcnt lgkmcnt(10)
    v_mfma_f32_32x32x16_bf16 v[120:135], v[32:35], v[156:159], v[120:135]
    s_add_u32 s16, s16, 16384
    ds_read_b64_tr_b16 v[28:29], v24 offset:4096
    ds_read_b64_tr_b16 v[30:31], v24 offset:6144
    s_waitcnt lgkmcnt(10)
    v_mfma_f32_32x32x16_bf16 v[136:151], v[36:39], v[156:159], v[136:151]
    s_and_b32 s16, s16, 0x3ffff
    ds_read_b64_tr_b16 v[32:33], v25 offset:4096
    ds_read_b64_tr_b16 v[34:35], v25 offset:6144
    s_waitcnt lgkmcnt(10)
    v_mfma_f32_32x32x16_bf16 v[88:103], v[40:43], v[156:159], v[88:103]
    ds_read_b64_tr_b16 v[36:37], v22 offset:4096
    ds_read_b64_tr_b16 v[38:39], v22 offset:6144
    s_waitcnt lgkmcnt(10)
    v_mfma_f32_32x32x16_bf16 v[104:119], v[44:47], v[156:159], v[104:119]
    buffer_load_dwordx4 v[184:187], v249, s[32:35], s16 offen sc1
    ds_read_b64_tr_b16 v[40:41], v23 offset:4096
    ds_read_b64_tr_b16 v[42:43], v23 offset:6144
    s_waitcnt vmcnt(6)
    s_waitcnt lgkmcnt(10)
    v_mfma_f32_32x32x16_bf16 v[56:71], v[48:51], v[160:163], v[56:71]
    ds_read_b64_tr_b16 v[44:45], v20 offset:5120
    ds_read_b64_tr_b16 v[46:47], v20 offset:7168
    s_waitcnt lgkmcnt(10)
    v_mfma_f32_32x32x16_bf16 v[72:87], v[52:55], v[160:163], v[72:87]
    ds_read_b64_tr_b16 v[48:49], v21 offset:5120
    ds_read_b64_tr_b16 v[50:51], v21 offset:7168
    s_waitcnt lgkmcnt(10)
    v_mfma_f32_32x32x16_bf16 v[120:135], v[28:31], v[160:163], v[120:135]
    ds_read_b64_tr_b16 v[52:53], v24 offset:5120
    ds_read_b64_tr_b16 v[54:55], v24 offset:7168
    s_waitcnt lgkmcnt(10)
    v_mfma_f32_32x32x16_bf16 v[136:151], v[32:35], v[160:163], v[136:151]
    buffer_load_dwordx4 v[188:191], v249, s[32:35], s16 offen offset:1024 sc1
    ds_read_b64_tr_b16 v[28:29], v25 offset:5120
    ds_read_b64_tr_b16 v[30:31], v25 offset:7168
    s_waitcnt lgkmcnt(10)
    v_mfma_f32_32x32x16_bf16 v[88:103], v[36:39], v[160:163], v[88:103]
    ds_read_b64_tr_b16 v[32:33], v22 offset:5120
    ds_read_b64_tr_b16 v[34:35], v22 offset:7168
    s_waitcnt lgkmcnt(10)
    v_mfma_f32_32x32x16_bf16 v[104:119], v[40:43], v[160:163], v[104:119]
    ds_read_b64_tr_b16 v[36:37], v23 offset:5120
    ds_read_b64_tr_b16 v[38:39], v23 offset:7168
    s_waitcnt vmcnt(6)
    s_waitcnt lgkmcnt(10)
    v_mfma_f32_32x32x16_bf16 v[56:71], v[44:47], v[164:167], v[56:71]
    ds_read_b64_tr_b16 v[40:41], v20 offset:8192
    ds_read_b64_tr_b16 v[42:43], v20 offset:10240
    s_waitcnt lgkmcnt(10)
    v_mfma_f32_32x32x16_bf16 v[72:87], v[48:51], v[164:167], v[72:87]
    buffer_load_dwordx4 v[192:195], v249, s[32:35], s16 offen offset:2048 sc1
    ds_read_b64_tr_b16 v[44:45], v21 offset:8192
    ds_read_b64_tr_b16 v[46:47], v21 offset:10240
    s_waitcnt lgkmcnt(10)
    v_mfma_f32_32x32x16_bf16 v[120:135], v[52:55], v[164:167], v[120:135]
    ds_read_b64_tr_b16 v[48:49], v24 offset:8192
    ds_read_b64_tr_b16 v[50:51], v24 offset:10240
    s_waitcnt lgkmcnt(10)
    v_mfma_f32_32x32x16_bf16 v[136:151], v[28:31], v[164:167], v[136:151]
    ds_read_b64_tr_b16 v[52:53], v25 offset:8192
    ds_read_b64_tr_b16 v[54:55], v25 offset:10240
    s_waitcnt lgkmcnt(10)
    v_mfma_f32_32x32x16_bf16 v[88:103], v[32:35], v[164:167], v[88:103]
    ds_read_b64_tr_b16 v[28:29], v22 offset:8192
    ds_read_b64_tr_b16 v[30:31], v22 offset:10240
    s_waitcnt lgkmcnt(10)
    v_mfma_f32_32x32x16_bf16 v[104:119], v[36:39], v[164:167], v[104:119]
    buffer_load_dwordx4 v[196:199], v249, s[32:35], s16 offen offset:3072 sc1
    ds_read_b64_tr_b16 v[32:33], v23 offset:8192
    ds_read_b64_tr_b16 v[34:35], v23 offset:10240
    s_barrier
    s_waitcnt vmcnt(7)
    s_waitcnt lgkmcnt(10)
    v_mfma_f32_32x32x16_bf16 v[56:71], v[40:43], v[168:171], v[56:71]
    s_add_u32 s16, s16, 16384
    ds_read_b64_tr_b16 v[36:37], v20 offset:9216
    ds_read_b64_tr_b16 v[38:39], v20 offset:11264
    s_waitcnt lgkmcnt(10)
    v_mfma_f32_32x32x16_bf16 v[72:87], v[44:47], v[168:171], v[72:87]
    s_and_b32 s16, s16, 0x3ffff
    ds_read_b64_tr_b16 v[40:41], v21 offset:9216
    ds_read_b64_tr_b16 v[42:43], v21 offset:11264
    s_waitcnt lgkmcnt(10)
    v_mfma_f32_32x32x16_bf16 v[120:135], v[48:51], v[168:171], v[120:135]
    ds_read_b64_tr_b16 v[44:45], v24 offset:9216
    ds_read_b64_tr_b16 v[46:47], v24 offset:11264
    s_waitcnt lgkmcnt(10)
    v_mfma_f32_32x32x16_bf16 v[136:151], v[52:55], v[168:171], v[136:151]
    ds_read_b64_tr_b16 v[48:49], v25 offset:9216
    ds_read_b64_tr_b16 v[50:51], v25 offset:11264
    s_waitcnt lgkmcnt(10)
    v_mfma_f32_32x32x16_bf16 v[88:103], v[28:31], v[168:171], v[88:103]
    ds_read_b64_tr_b16 v[52:53], v22 offset:9216
    ds_read_b64_tr_b16 v[54:55], v22 offset:11264
    s_waitcnt lgkmcnt(10)
    v_mfma_f32_32x32x16_bf16 v[104:119], v[32:35], v[168:171], v[104:119]
    ds_read_b64_tr_b16 v[28:29], v23 offset:9216
    ds_read_b64_tr_b16 v[30:31], v23 offset:11264
    s_waitcnt vmcnt(6)
    s_waitcnt lgkmcnt(10)
    v_mfma_f32_32x32x16_bf16 v[56:71], v[36:39], v[172:175], v[56:71]
    ds_read_b64_tr_b16 v[32:33], v20 offset:12288
    ds_read_b64_tr_b16 v[34:35], v20 offset:14336
    s_waitcnt lgkmcnt(10)
    v_mfma_f32_32x32x16_bf16 v[72:87], v[40:43], v[172:175], v[72:87]
    ds_read_b64_tr_b16 v[36:37], v21 offset:12288
    ds_read_b64_tr_b16 v[38:39], v21 offset:14336
    s_waitcnt lgkmcnt(10)
    v_mfma_f32_32x32x16_bf16 v[120:135], v[44:47], v[172:175], v[120:135]
    buffer_load_dwordx4 v[200:203], v249, s[32:35], s16 offen sc1
    ds_read_b64_tr_b16 v[40:41], v24 offset:12288
    ds_read_b64_tr_b16 v[42:43], v24 offset:14336
    s_waitcnt lgkmcnt(10)
    v_mfma_f32_32x32x16_bf16 v[136:151], v[48:51], v[172:175], v[136:151]
    ds_read_b64_tr_b16 v[44:45], v25 offset:12288
    ds_read_b64_tr_b16 v[46:47], v25 offset:14336
    s_waitcnt lgkmcnt(10)
    v_mfma_f32_32x32x16_bf16 v[88:103], v[52:55], v[172:175], v[88:103]
    ds_read_b64_tr_b16 v[48:49], v22 offset:12288
    ds_read_b64_tr_b16 v[50:51], v22 offset:14336
    s_waitcnt lgkmcnt(10)
    v_mfma_f32_32x32x16_bf16 v[104:119], v[28:31], v[172:175], v[104:119]
    buffer_load_dwordx4 v[204:207], v249, s[32:35], s16 offen offset:1024 sc1
    ds_read_b64_tr_b16 v[52:53], v23 offset:12288
    ds_read_b64_tr_b16 v[54:55], v23 offset:14336
    s_waitcnt vmcnt(7)
    s_waitcnt lgkmcnt(10)
    v_mfma_f32_32x32x16_bf16 v[56:71], v[32:35], v[176:179], v[56:71]
    ds_read_b64_tr_b16 v[28:29], v20 offset:13312
    ds_read_b64_tr_b16 v[30:31], v20 offset:15360
    s_waitcnt lgkmcnt(10)
    v_mfma_f32_32x32x16_bf16 v[72:87], v[36:39], v[176:179], v[72:87]
    ds_read_b64_tr_b16 v[32:33], v21 offset:13312
    ds_read_b64_tr_b16 v[34:35], v21 offset:15360
    s_waitcnt lgkmcnt(10)
    v_mfma_f32_32x32x16_bf16 v[120:135], v[40:43], v[176:179], v[120:135]
    buffer_load_dwordx4 v[208:211], v249, s[32:35], s16 offen offset:2048 sc1
    ds_read_b64_tr_b16 v[36:37], v24 offset:13312
    ds_read_b64_tr_b16 v[38:39], v24 offset:15360
    s_waitcnt lgkmcnt(10)
    v_mfma_f32_32x32x16_bf16 v[136:151], v[44:47], v[176:179], v[136:151]
    ds_read_b64_tr_b16 v[40:41], v25 offset:13312
    ds_read_b64_tr_b16 v[42:43], v25 offset:15360
    s_waitcnt lgkmcnt(10)
    v_mfma_f32_32x32x16_bf16 v[88:103], v[48:51], v[176:179], v[88:103]
    ds_read_b64_tr_b16 v[44:45], v22 offset:13312
    ds_read_b64_tr_b16 v[46:47], v22 offset:15360
    s_waitcnt lgkmcnt(10)
    v_mfma_f32_32x32x16_bf16 v[104:119], v[52:55], v[176:179], v[104:119]
    buffer_load_dwordx4 v[212:215], v249, s[32:35], s16 offen offset:3072 sc1
    ds_read_b64_tr_b16 v[48:49], v23 offset:13312
    ds_read_b64_tr_b16 v[50:51], v23 offset:15360
    s_waitcnt vmcnt(8)
    s_waitcnt lgkmcnt(10)
    v_mfma_f32_32x32x16_bf16 v[56:71], v[28:31], v[180:183], v[56:71]
    s_add_u32 s16, s16, 16384
    ds_read_b64_tr_b16 v[52:53], v20 offset:16384
    ds_read_b64_tr_b16 v[54:55], v20 offset:18432
    s_waitcnt lgkmcnt(10)
    v_mfma_f32_32x32x16_bf16 v[72:87], v[32:35], v[180:183], v[72:87]
    s_and_b32 s16, s16, 0x3ffff
    ds_read_b64_tr_b16 v[28:29], v21 offset:16384
    ds_read_b64_tr_b16 v[30:31], v21 offset:18432
    s_waitcnt lgkmcnt(10)
    v_mfma_f32_32x32x16_bf16 v[120:135], v[36:39], v[180:183], v[120:135]
    buffer_load_dwordx4 v[216:219], v249, s[32:35], s16 offen sc1
    ds_read_b64_tr_b16 v[32:33], v24 offset:16384
    ds_read_b64_tr_b16 v[34:35], v24 offset:18432
    s_waitcnt lgkmcnt(10)
    v_mfma_f32_32x32x16_bf16 v[136:151], v[40:43], v[180:183], v[136:151]
    ds_read_b64_tr_b16 v[36:37], v25 offset:16384
    ds_read_b64_tr_b16 v[38:39], v25 offset:18432
    s_waitcnt lgkmcnt(10)
    v_mfma_f32_32x32x16_bf16 v[88:103], v[44:47], v[180:183], v[88:103]
    ds_read_b64_tr_b16 v[40:41], v22 offset:16384
    ds_read_b64_tr_b16 v[42:43], v22 offset:18432
    s_waitcnt lgkmcnt(10)
    v_mfma_f32_32x32x16_bf16 v[104:119], v[48:51], v[180:183], v[104:119]
    buffer_load_dwordx4 v[220:223], v249, s[32:35], s16 offen offset:1024 sc1
    ds_read_b64_tr_b16 v[44:45], v23 offset:16384
    ds_read_b64_tr_b16 v[46:47], v23 offset:18432
    s_barrier
    s_waitcnt vmcnt(9)
    s_waitcnt lgkmcnt(10)
    v_mfma_f32_32x32x16_bf16 v[56:71], v[52:55], v[184:187], v[56:71]
    ds_read_b64_tr_b16 v[48:49], v20 offset:17408
    ds_read_b64_tr_b16 v[50:51], v20 offset:19456
    s_waitcnt lgkmcnt(10)
    v_mfma_f32_32x32x16_bf16 v[72:87], v[28:31], v[184:187], v[72:87]
    ds_read_b64_tr_b16 v[52:53], v21 offset:17408
    ds_read_b64_tr_b16 v[54:55], v21 offset:19456
    s_waitcnt lgkmcnt(10)
    v_mfma_f32_32x32x16_bf16 v[120:135], v[32:35], v[184:187], v[120:135]
    ds_read_b64_tr_b16 v[28:29], v24 offset:17408
    ds_read_b64_tr_b16 v[30:31], v24 offset:19456
    s_waitcnt lgkmcnt(10)
    v_mfma_f32_32x32x16_bf16 v[136:151], v[36:39], v[184:187], v[136:151]
    ds_read_b64_tr_b16 v[32:33], v25 offset:17408
    ds_read_b64_tr_b16 v[34:35], v25 offset:19456
    s_waitcnt lgkmcnt(10)
    v_mfma_f32_32x32x16_bf16 v[88:103], v[40:43], v[184:187], v[88:103]
    ds_read_b64_tr_b16 v[36:37], v22 offset:17408
    ds_read_b64_tr_b16 v[38:39], v22 offset:19456
    s_waitcnt lgkmcnt(10)
    v_mfma_f32_32x32x16_bf16 v[104:119], v[44:47], v[184:187], v[104:119]
    ds_read_b64_tr_b16 v[40:41], v23 offset:17408
    ds_read_b64_tr_b16 v[42:43], v23 offset:19456
    s_waitcnt vmcnt(8)
    s_waitcnt lgkmcnt(10)
    v_mfma_f32_32x32x16_bf16 v[56:71], v[48:51], v[188:191], v[56:71]
    ds_read_b64_tr_b16 v[44:45], v20 offset:20480
    ds_read_b64_tr_b16 v[46:47], v20 offset:22528
    s_waitcnt lgkmcnt(10)
    v_mfma_f32_32x32x16_bf16 v[72:87], v[52:55], v[188:191], v[72:87]
    ds_read_b64_tr_b16 v[48:49], v21 offset:20480
    ds_read_b64_tr_b16 v[50:51], v21 offset:22528
    s_waitcnt lgkmcnt(10)
    v_mfma_f32_32x32x16_bf16 v[120:135], v[28:31], v[188:191], v[120:135]
    buffer_load_dwordx4 v[224:227], v249, s[32:35], s16 offen offset:2048 sc1
    ds_read_b64_tr_b16 v[52:53], v24 offset:20480
    ds_read_b64_tr_b16 v[54:55], v24 offset:22528
    s_waitcnt lgkmcnt(10)
    v_mfma_f32_32x32x16_bf16 v[136:151], v[32:35], v[188:191], v[136:151]
    ds_read_b64_tr_b16 v[28:29], v25 offset:20480
    ds_read_b64_tr_b16 v[30:31], v25 offset:22528
    s_waitcnt lgkmcnt(10)
    v_mfma_f32_32x32x16_bf16 v[88:103], v[36:39], v[188:191], v[88:103]
    ds_read_b64_tr_b16 v[32:33], v22 offset:20480
    ds_read_b64_tr_b16 v[34:35], v22 offset:22528
    s_waitcnt lgkmcnt(10)
    v_mfma_f32_32x32x16_bf16 v[104:119], v[40:43], v[188:191], v[104:119]
    buffer_load_dwordx4 v[228:231], v249, s[32:35], s16 offen offset:3072 sc1
    ds_read_b64_tr_b16 v[36:37], v23 offset:20480
    ds_read_b64_tr_b16 v[38:39], v23 offset:22528
    s_waitcnt vmcnt(9)
    s_waitcnt lgkmcnt(10)
    v_mfma_f32_32x32x16_bf16 v[56:71], v[44:47], v[192:195], v[56:71]
    s_add_u32 s16, s16, 16384
    ds_read_b64_tr_b16 v[40:41], v20 offset:21504
    ds_read_b64_tr_b16 v[42:43], v20 offset:23552
    s_waitcnt lgkmcnt(10)
    v_mfma_f32_32x32x16_bf16 v[72:87], v[48:51], v[192:195], v[72:87]
    s_and_b32 s16, s16, 0x3ffff
    ds_read_b64_tr_b16 v[44:45], v21 offset:21504
    ds_read_b64_tr_b16 v[46:47], v21 offset:23552
    s_waitcnt lgkmcnt(10)
    v_mfma_f32_32x32x16_bf16 v[120:135], v[52:55], v[192:195], v[120:135]
    buffer_load_dwordx4 v[232:235], v249, s[32:35], s16 offen sc1
    ds_read_b64_tr_b16 v[48:49], v24 offset:21504
    ds_read_b64_tr_b16 v[50:51], v24 offset:23552
    s_waitcnt lgkmcnt(10)
    v_mfma_f32_32x32x16_bf16 v[136:151], v[28:31], v[192:195], v[136:151]
    ds_read_b64_tr_b16 v[52:53], v25 offset:21504
    ds_read_b64_tr_b16 v[54:55], v25 offset:23552
    s_waitcnt lgkmcnt(10)
    v_mfma_f32_32x32x16_bf16 v[88:103], v[32:35], v[192:195], v[88:103]
    ds_read_b64_tr_b16 v[28:29], v22 offset:21504
    ds_read_b64_tr_b16 v[30:31], v22 offset:23552
    s_waitcnt lgkmcnt(10)
    v_mfma_f32_32x32x16_bf16 v[104:119], v[36:39], v[192:195], v[104:119]
    buffer_load_dwordx4 v[236:239], v249, s[32:35], s16 offen offset:1024 sc1
    ds_read_b64_tr_b16 v[32:33], v23 offset:21504
    ds_read_b64_tr_b16 v[34:35], v23 offset:23552
    s_waitcnt vmcnt(10)
    s_waitcnt lgkmcnt(10)
    v_mfma_f32_32x32x16_bf16 v[56:71], v[40:43], v[196:199], v[56:71]
    ds_read_b64_tr_b16 v[36:37], v20 offset:24576
    ds_read_b64_tr_b16 v[38:39], v20 offset:26624
    s_waitcnt lgkmcnt(10)
    v_mfma_f32_32x32x16_bf16 v[72:87], v[44:47], v[196:199], v[72:87]
    ds_read_b64_tr_b16 v[40:41], v21 offset:24576
    ds_read_b64_tr_b16 v[42:43], v21 offset:26624
    s_waitcnt lgkmcnt(10)
    v_mfma_f32_32x32x16_bf16 v[120:135], v[48:51], v[196:199], v[120:135]
    buffer_load_dwordx4 v[240:243], v249, s[32:35], s16 offen offset:2048 sc1
    ds_read_b64_tr_b16 v[44:45], v24 offset:24576
    ds_read_b64_tr_b16 v[46:47], v24 offset:26624
    s_waitcnt lgkmcnt(10)
    v_mfma_f32_32x32x16_bf16 v[136:151], v[52:55], v[196:199], v[136:151]
    ds_read_b64_tr_b16 v[48:49], v25 offset:24576
    ds_read_b64_tr_b16 v[50:51], v25 offset:26624
    s_waitcnt lgkmcnt(10)
    v_mfma_f32_32x32x16_bf16 v[88:103], v[28:31], v[196:199], v[88:103]
    ds_read_b64_tr_b16 v[52:53], v22 offset:24576
    ds_read_b64_tr_b16 v[54:55], v22 offset:26624
    s_waitcnt lgkmcnt(10)
    v_mfma_f32_32x32x16_bf16 v[104:119], v[32:35], v[196:199], v[104:119]
    buffer_load_dwordx4 v[244:247], v249, s[32:35], s16 offen offset:3072 sc1
    ds_read_b64_tr_b16 v[28:29], v23 offset:24576
    ds_read_b64_tr_b16 v[30:31], v23 offset:26624
    s_barrier
    s_waitcnt vmcnt(11)
    s_waitcnt lgkmcnt(10)
    v_mfma_f32_32x32x16_bf16 v[56:71], v[36:39], v[200:203], v[56:71]
    s_add_u32 s16, s16, 16384
    ds_read_b64_tr_b16 v[32:33], v20 offset:25600
    ds_read_b64_tr_b16 v[34:35], v20 offset:27648
    s_waitcnt lgkmcnt(10)
    v_mfma_f32_32x32x16_bf16 v[72:87], v[40:43], v[200:203], v[72:87]
    s_and_b32 s16, s16, 0x3ffff
    ds_read_b64_tr_b16 v[36:37], v21 offset:25600
    ds_read_b64_tr_b16 v[38:39], v21 offset:27648
    s_waitcnt lgkmcnt(10)
    v_mfma_f32_32x32x16_bf16 v[120:135], v[44:47], v[200:203], v[120:135]
    ds_read_b64_tr_b16 v[40:41], v24 offset:25600
    ds_read_b64_tr_b16 v[42:43], v24 offset:27648
    s_waitcnt lgkmcnt(10)
    v_mfma_f32_32x32x16_bf16 v[136:151], v[48:51], v[200:203], v[136:151]
    ds_read_b64_tr_b16 v[44:45], v25 offset:25600
    ds_read_b64_tr_b16 v[46:47], v25 offset:27648
    s_waitcnt lgkmcnt(10)
    v_mfma_f32_32x32x16_bf16 v[88:103], v[52:55], v[200:203], v[88:103]
    ds_read_b64_tr_b16 v[48:49], v22 offset:25600
    ds_read_b64_tr_b16 v[50:51], v22 offset:27648
L_PAD2:
    s_cbranch_execz L_RET2
    s_waitcnt lgkmcnt(10)
    v_mfma_f32_32x32x16_bf16 v[104:119], v[28:31], v[200:203], v[104:119]
    ds_read_b64_tr_b16 v[52:53], v23 offset:25600
    ds_read_b64_tr_b16 v[54:55], v23 offset:27648
    s_waitcnt vmcnt(10)
    s_waitcnt lgkmcnt(10)
    v_mfma_f32_32x32x16_bf16 v[56:71], v[32:35], v[204:207], v[56:71]
    ds_read_b64_tr_b16 v[28:29], v20 offset:28672
    ds_read_b64_tr_b16 v[30:31], v20 offset:30720
    s_waitcnt lgkmcnt(10)
    v_mfma_f32_32x32x16_bf16 v[72:87], v[36:39], v[204:207], v[72:87]
    ds_read_b64_tr_b16 v[32:33], v21 offset:28672
    ds_read_b64_tr_b16 v[34:35], v21 offset:30720
    s_waitcnt lgkmcnt(10)
    v_mfma_f32_32x32x16_bf16 v[120:135], v[40:43], v[204:207], v[120:135]
    buffer_load_dwordx4 v[152:155], v249, s[32:35], s16 offen sc1
    ds_read_b64_tr_b16 v[36:37], v24 offset:28672
    ds_read_b64_tr_b16 v[38:39], v24 offset:30720
    s_waitcnt lgkmcnt(10)
    v_mfma_f32_32x32x16_bf16 v[136:151], v[44:47], v[204:207], v[136:151]
    ds_read_b64_tr_b16 v[40:41], v25 offset:28672
    ds_read_b64_tr_b16 v[42:43], v25 offset:30720
    s_waitcnt lgkmcnt(10)
    v_mfma_f32_32x32x16_bf16 v[88:103], v[48:51], v[204:207], v[88:103]
    ds_read_b64_tr_b16 v[44:45], v22 offset:28672
    ds_read_b64_tr_b16 v[46:47], v22 offset:30720
    s_waitcnt lgkmcnt(10)
    v_mfma_f32_32x32x16_bf16 v[104:119], v[52:55], v[204:207], v[104:119]
    buffer_load_dwordx4 v[156:159], v249, s[32:35], s16 offen offset:1024 sc1
    ds_read_b64_tr_b16 v[48:49], v23 offset:28672
    ds_read_b64_tr_b16 v[50:51], v23 offset:30720
    s_waitcnt vmcnt(11)
    s_waitcnt lgkmcnt(10)
    v_mfma_f32_32x32x16_bf16 v[56:71], v[28:31], v[208:211], v[56:71]
    ds_read_b64_tr_b16 v[52:53], v20 offset:29696
    ds_read_b64_tr_b16 v[54:55], v20 offset:31744
    s_waitcnt lgkmcnt(10)
    v_mfma_f32_32x32x16_bf16 v[72:87], v[32:35], v[208:211], v[72:87]
    ds_read_b64_tr_b16 v[28:29], v21 offset:29696
    ds_read_b64_tr_b16 v[30:31], v21 offset:31744
    s_waitcnt lgkmcnt(10)
    v_mfma_f32_32x32x16_bf16 v[120:135], v[36:39], v[208:211], v[120:135]
    buffer_load_dwordx4 v[160:163], v249, s[32:35], s16 offen offset:2048 sc1
    ds_read_b64_tr_b16 v[32:33], v24 offset:29696
    ds_read_b64_tr_b16 v[34:35], v24 offset:31744
    s_waitcnt lgkmcnt(10)
    v_mfma_f32_32x32x16_bf16 v[136:151], v[40:43], v[208:211], v[136:151]
    ds_read_b64_tr_b16 v[36:37], v25 offset:29696
    ds_read_b64_tr_b16 v[38:39], v25 offset:31744
    s_waitcnt lgkmcnt(10)
    v_mfma_f32_32x32x16_bf16 v[88:103], v[44:47], v[208:211], v[88:103]
    ds_read_b64_tr_b16 v[40:41], v22 offset:29696
    ds_read_b64_tr_b16 v[42:43], v22 offset:31744
    s_waitcnt lgkmcnt(10)
    v_mfma_f32_32x32x16_bf16 v[104:119], v[48:51], v[208:211], v[104:119]
    buffer_load_dwordx4 v[164:167], v249, s[32:35], s16 offen offset:3072 sc1
    ds_read_b64_tr_b16 v[44:45], v23 offset:29696
    ds_read_b64_tr_b16 v[46:47], v23 offset:31744
    s_waitcnt vmcnt(12)
    s_waitcnt lgkmcnt(10)
    v_mfma_f32_32x32x16_bf16 v[56:71], v[52:55], v[212:215], v[56:71]
    s_add_u32 s16, s16, 16384
    ds_read_b64_tr_b16 v[48:49], v20 offset:32768
    ds_read_b64_tr_b16 v[50:51], v20 offset:34816
    s_waitcnt lgkmcnt(10)
    v_mfma_f32_32x32x16_bf16 v[72:87], v[28:31], v[212:215], v[72:87]
    s_and_b32 s16, s16, 0x3ffff
    ds_read_b64_tr_b16 v[52:53], v21 offset:32768
    ds_read_b64_tr_b16 v[54:55], v21 offset:34816
    s_waitcnt lgkmcnt(10)
    v_mfma_f32_32x32x16_bf16 v[120:135], v[32:35], v[212:215], v[120:135]
    buffer_load_dwordx4 v[168:171], v249, s[32:35], s16 offen sc1
    ds_read_b64_tr_b16 v[28:29], v24 offset:32768
    ds_read_b64_tr_b16 v[30:31], v24 offset:34816
    s_waitcnt lgkmcnt(10)
    v_mfma_f32_32x32x16_bf16 v[136:151], v[36:39], v[212:215], v[136:151]
    ds_read_b64_tr_b16 v[32:33], v25 offset:32768
    ds_read_b64_tr_b16 v[34:35], v25 offset:34816
    s_waitcnt lgkmcnt(10)
    v_mfma_f32_32x32x16_bf16 v[88:103], v[40:43], v[212:215], v[88:103]
    ds_read_b64_tr_b16 v[36:37], v22 offset:32768
    ds_read_b64_tr_b16 v[38:39], v22 offset:34816
    s_waitcnt lgkmcnt(10)
    v_mfma_f32_32x32x16_bf16 v[104:119], v[44:47], v[212:215], v[104:119]
    buffer_load_dwordx4 v[172:175], v249, s[32:35], s16 offen offset:1024 sc1
    ds_read_b64_tr_b16 v[40:41], v23 offset:32768
    ds_read_b64_tr_b16 v[42:43], v23 offset:34816
    s_barrier
    s_waitcnt vmcnt(13)
    s_waitcnt lgkmcnt(10)
    v_mfma_f32_32x32x16_bf16 v[56:71], v[48:51], v[216:219], v[56:71]
    ds_read_b64_tr_b16 v[44:45], v20 offset:33792
    ds_read_b64_tr_b16 v[46:47], v20 offset:35840
    s_waitcnt lgkmcnt(10)
    v_mfma_f32_32x32x16_bf16 v[72:87], v[52:55], v[216:219], v[72:87]
    ds_read_b64_tr_b16 v[48:49], v21 offset:33792
    ds_read_b64_tr_b16 v[50:51], v21 offset:35840
    s_waitcnt lgkmcnt(10)
    v_mfma_f32_32x32x16_bf16 v[120:135], v[28:31], v[216:219], v[120:135]
    ds_read_b64_tr_b16 v[52:53], v24 offset:33792
    ds_read_b64_tr_b16 v[54:55], v24 offset:35840
    s_waitcnt lgkmcnt(10)
    v_mfma_f32_32x32x16_bf16 v[136:151], v[32:35], v[216:219], v[136:151]
    ds_read_b64_tr_b16 v[28:29], v25 offset:33792
    ds_read_b64_tr_b16 v[30:31], v25 offset:35840
    s_waitcnt lgkmcnt(10)
    v_mfma_f32_32x32x16_bf16 v[88:103], v[36:39], v[216:219], v[88:103]
    ds_read_b64_tr_b16 v[32:33], v22 offset:33792
    ds_read_b64_tr_b16 v[34:35], v22 offset:35840
    s_waitcnt lgkmcnt(10)
    v_mfma_f32_32x32x16_bf16 v[104:119], v[40:43], v[216:219], v[104:119]
    ds_read_b64_tr_b16 v[36:37], v23 offset:33792
    ds_read_b64_tr_b16 v[38:39], v23 offset:35840
    s_waitcnt vmcnt(12)
    s_waitcnt lgkmcnt(10)
    v_mfma_f32_32x32x16_bf16 v[56:71], v[44:47], v[220:223], v[56:71]
    ds_read_b64_tr_b16 v[40:41], v20 offset:36864
    ds_read_b64_tr_b16 v[42:43], v20 offset:38912
    s_waitcnt lgkmcnt(10)
    v_mfma_f32_32x32x16_bf16 v[72:87], v[48:51], v[220:223], v[72:87]
    ds_read_b64_tr_b16 v[44:45], v21 offset:36864
    ds_read_b64_tr_b16 v[46:47], v21 offset:38912
    s_waitcnt lgkmcnt(10)
    v_mfma_f32_32x32x16_bf16 v[120:135], v[52:55], v[220:223], v[120:135]
    buffer_load_dwordx4 v[176:179], v249, s[32:35], s16 offen offset:2048 sc1
    ds_read_b64_tr_b16 v[48:49], v24 offset:36864
    ds_read_b64_tr_b16 v[50:51], v24 offset:38912
    s_waitcnt lgkmcnt(10)
    v_mfma_f32_32x32x16_bf16 v[136:151], v[28:31], v[220:223], v[136:151]
    ds_read_b64_tr_b16 v[52:53], v25 offset:36864
    ds_read_b64_tr_b16 v[54:55], v25 offset:38912
    s_waitcnt lgkmcnt(10)
    v_mfma_f32_32x32x16_bf16 v[88:103], v[32:35], v[220:223], v[88:103]
    ds_read_b64_tr_b16 v[28:29], v22 offset:36864
    ds_read_b64_tr_b16 v[30:31], v22 offset:38912
    s_waitcnt lgkmcnt(10)
    v_mfma_f32_32x32x16_bf16 v[104:119], v[36:39], v[220:223], v[104:119]
    buffer_load_dwordx4 v[180:183], v249, s[32:35], s16 offen offset:3072 sc1
    ds_read_b64_tr_b16 v[32:33], v23 offset:36864
    ds_read_b64_tr_b16 v[34:35], v23 offset:38912
    s_waitcnt vmcnt(13)
    s_waitcnt lgkmcnt(10)
    v_mfma_f32_32x32x16_bf16 v[56:71], v[40:43], v[224:227], v[56:71]
    s_add_u32 s16, s16, 16384
    ds_read_b64_tr_b16 v[36:37], v20 offset:37888
    ds_read_b64_tr_b16 v[38:39], v20 offset:39936
    s_waitcnt lgkmcnt(10)
    v_mfma_f32_32x32x16_bf16 v[72:87], v[44:47], v[224:227], v[72:87]
    s_and_b32 s16, s16, 0x3ffff
    ds_read_b64_tr_b16 v[40:41], v21 offset:37888
    ds_read_b64_tr_b16 v[42:43], v21 offset:39936
    s_waitcnt lgkmcnt(10)
    v_mfma_f32_32x32x16_bf16 v[120:135], v[48:51], v[224:227], v[120:135]
    buffer_load_dwordx4 v[184:187], v249, s[32:35], s16 offen sc1
    ds_read_b64_tr_b16 v[44:45], v24 offset:37888
    ds_read_b64_tr_b16 v[46:47], v24 offset:39936
    s_waitcnt lgkmcnt(10)
    v_mfma_f32_32x32x16_bf16 v[136:151], v[52:55], v[224:227], v[136:151]
    ds_read_b64_tr_b16 v[48:49], v25 offset:37888
    ds_read_b64_tr_b16 v[50:51], v25 offset:39936
    s_waitcnt lgkmcnt(10)
    v_mfma_f32_32x32x16_bf16 v[88:103], v[28:31], v[224:227], v[88:103]
    ds_read_b64_tr_b16 v[52:53], v22 offset:37888
    ds_read_b64_tr_b16 v[54:55], v22 offset:39936
    s_waitcnt lgkmcnt(10)
    v_mfma_f32_32x32x16_bf16 v[104:119], v[32:35], v[224:227], v[104:119]
    buffer_load_dwordx4 v[188:191], v249, s[32:35], s16 offen offset:1024 sc1
    ds_read_b64_tr_b16 v[28:29], v23 offset:37888
    ds_read_b64_tr_b16 v[30:31], v23 offset:39936
    s_waitcnt vmcnt(14)
    s_waitcnt lgkmcnt(10)
    v_mfma_f32_32x32x16_bf16 v[56:71], v[36:39], v[228:231], v[56:71]
    ds_read_b64_tr_b16 v[32:33], v20 offset:40960
    ds_read_b64_tr_b16 v[34:35], v20 offset:43008
    s_waitcnt lgkmcnt(10)
    v_mfma_f32_32x32x16_bf16 v[72:87], v[40:43], v[228:231], v[72:87]
    ds_read_b64_tr_b16 v[36:37], v21 offset:40960
    ds_read_b64_tr_b16 v[38:39], v21 offset:43008
    s_waitcnt lgkmcnt(10)
    v_mfma_f32_32x32x16_bf16 v[120:135], v[44:47], v[228:231], v[120:135]
    buffer_load_dwordx4 v[192:195], v249, s[32:35], s16 offen offset:2048 sc1
    ds_read_b64_tr_b16 v[40:41], v24 offset:40960
    ds_read_b64_tr_b16 v[42:43], v24 offset:43008
    s_waitcnt lgkmcnt(10)
    v_mfma_f32_32x32x16_bf16 v[136:151], v[48:51], v[228:231], v[136:151]
    ds_read_b64_tr_b16 v[44:45], v25 offset:40960
    ds_read_b64_tr_b16 v[46:47], v25 offset:43008
    s_waitcnt lgkmcnt(10)
    v_mfma_f32_32x32x16_bf16 v[88:103], v[52:55], v[228:231], v[88:103]
    ds_read_b64_tr_b16 v[48:49], v22 offset:40960
    ds_read_b64_tr_b16 v[50:51], v22 offset:43008
    s_waitcnt lgkmcnt(10)
    v_mfma_f32_32x32x16_bf16 v[104:119], v[28:31], v[228:231], v[104:119]
    buffer_load_dwordx4 v[196:199], v249, s[32:35], s16 offen offset:3072 sc1
    ds_read_b64_tr_b16 v[52:53], v23 offset:40960
    ds_read_b64_tr_b16 v[54:55], v23 offset:43008
    s_barrier
    s_waitcnt vmcnt(15)
    s_waitcnt lgkmcnt(10)
    v_mfma_f32_32x32x16_bf16 v[56:71], v[32:35], v[232:235], v[56:71]
    s_add_u32 s16, s16, 16384
    ds_read_b64_tr_b16 v[28:29], v20 offset:41984
    ds_read_b64_tr_b16 v[30:31], v20 offset:44032
    s_waitcnt lgkmcnt(10)
    v_mfma_f32_32x32x16_bf16 v[72:87], v[36:39], v[232:235], v[72:87]
    s_and_b32 s16, s16, 0x3ffff
    ds_read_b64_tr_b16 v[32:33], v21 offset:41984
    ds_read_b64_tr_b16 v[34:35], v21 offset:44032
    s_waitcnt lgkmcnt(10)
    v_mfma_f32_32x32x16_bf16 v[120:135], v[40:43], v[232:235], v[120:135]
    ds_read_b64_tr_b16 v[36:37], v24 offset:41984
    ds_read_b64_tr_b16 v[38:39], v24 offset:44032
    s_waitcnt lgkmcnt(10)
    v_mfma_f32_32x32x16_bf16 v[136:151], v[44:47], v[232:235], v[136:151]
    ds_read_b64_tr_b16 v[40:41], v25 offset:41984
    ds_read_b64_tr_b16 v[42:43], v25 offset:44032
    s_waitcnt lgkmcnt(10)
    v_mfma_f32_32x32x16_bf16 v[88:103], v[48:51], v[232:235], v[88:103]
    ds_read_b64_tr_b16 v[44:45], v22 offset:41984
    ds_read_b64_tr_b16 v[46:47], v22 offset:44032
    s_waitcnt lgkmcnt(10)
    v_mfma_f32_32x32x16_bf16 v[104:119], v[52:55], v[232:235], v[104:119]
    ds_read_b64_tr_b16 v[48:49], v23 offset:41984
    ds_read_b64_tr_b16 v[50:51], v23 offset:44032
    s_waitcnt vmcnt(14)
    s_waitcnt lgkmcnt(10)
    v_mfma_f32_32x32x16_bf16 v[56:71], v[28:31], v[236:239], v[56:71]
    ds_read_b64_tr_b16 v[52:53], v20 offset:45056
    ds_read_b64_tr_b16 v[54:55], v20 offset:47104
    s_waitcnt lgkmcnt(10)
    v_mfma_f32_32x32x16_bf16 v[72:87], v[32:35], v[236:239], v[72:87]
    ds_read_b64_tr_b16 v[28:29], v21 offset:45056
    ds_read_b64_tr_b16 v[30:31], v21 offset:47104
    s_waitcnt lgkmcnt(10)
    v_mfma_f32_32x32x16_bf16 v[120:135], v[36:39], v[236:239], v[120:135]
    buffer_load_dwordx4 v[200:203], v249, s[32:35], s16 offen sc1
    ds_read_b64_tr_b16 v[32:33], v24 offset:45056
    ds_read_b64_tr_b16 v[34:35], v24 offset:47104
    s_waitcnt lgkmcnt(10)
    v_mfma_f32_32x32x16_bf16 v[136:151], v[40:43], v[236:239], v[136:151]
    ds_read_b64_tr_b16 v[36:37], v25 offset:45056
    ds_read_b64_tr_b16 v[38:39], v25 offset:47104
    s_waitcnt lgkmcnt(10)
    v_mfma_f32_32x32x16_bf16 v[88:103], v[44:47], v[236:239], v[88:103]
    ds_read_b64_tr_b16 v[40:41], v22 offset:45056
    ds_read_b64_tr_b16 v[42:43], v22 offset:47104
    s_waitcnt lgkmcnt(10)
    v_mfma_f32_32x32x16_bf16 v[104:119], v[48:51], v[236:239], v[104:119]
    buffer_load_dwordx4 v[204:207], v249, s[32:35], s16 offen offset:1024 sc1
    ds_read_b64_tr_b16 v[44:45], v23 offset:45056
    ds_read_b64_tr_b16 v[46:47], v23 offset:47104
    s_waitcnt vmcnt(15)
    s_waitcnt lgkmcnt(10)
    v_mfma_f32_32x32x16_bf16 v[56:71], v[52:55], v[240:243], v[56:71]
    ds_read_b64_tr_b16 v[48:49], v20 offset:46080
    ds_read_b64_tr_b16 v[50:51], v20 offset:48128
    s_waitcnt lgkmcnt(10)
    v_mfma_f32_32x32x16_bf16 v[72:87], v[28:31], v[240:243], v[72:87]
    ds_read_b64_tr_b16 v[52:53], v21 offset:46080
    ds_read_b64_tr_b16 v[54:55], v21 offset:48128
    s_waitcnt lgkmcnt(10)
    v_mfma_f32_32x32x16_bf16 v[120:135], v[32:35], v[240:243], v[120:135]
    buffer_load_dwordx4 v[208:211], v249, s[32:35], s16 offen offset:2048 sc1
    ds_read_b64_tr_b16 v[28:29], v24 offset:46080
    ds_read_b64_tr_b16 v[30:31], v24 offset:48128
    s_waitcnt lgkmcnt(10)
    v_mfma_f32_32x32x16_bf16 v[136:151], v[36:39], v[240:243], v[136:151]
    ds_read_b64_tr_b16 v[32:33], v25 offset:46080
    ds_read_b64_tr_b16 v[34:35], v25 offset:48128
    s_waitcnt lgkmcnt(10)
    v_mfma_f32_32x32x16_bf16 v[88:103], v[40:43], v[240:243], v[88:103]
    ds_read_b64_tr_b16 v[36:37], v22 offset:46080
    ds_read_b64_tr_b16 v[38:39], v22 offset:48128
    s_waitcnt lgkmcnt(10)
    v_mfma_f32_32x32x16_bf16 v[104:119], v[44:47], v[240:243], v[104:119]
    buffer_load_dwordx4 v[212:215], v249, s[32:35], s16 offen offset:3072 sc1
    ds_read_b64_tr_b16 v[40:41], v23 offset:46080
    ds_read_b64_tr_b16 v[42:43], v23 offset:48128
    s_waitcnt vmcnt(16)
    s_waitcnt lgkmcnt(10)
    v_mfma_f32_32x32x16_bf16 v[56:71], v[48:51], v[244:247], v[56:71]
    s_add_u32 s16, s16, 16384
    ds_read_b64_tr_b16 v[44:45], v20
    ds_read_b64_tr_b16 v[46:47], v20 offset:2048
    s_waitcnt lgkmcnt(10)
    v_mfma_f32_32x32x16_bf16 v[72:87], v[52:55], v[244:247], v[72:87]
    s_and_b32 s16, s16, 0x3ffff
    ds_read_b64_tr_b16 v[48:49], v21
    ds_read_b64_tr_b16 v[50:51], v21 offset:2048
    s_waitcnt lgkmcnt(10)
    v_mfma_f32_32x32x16_bf16 v[120:135], v[28:31], v[244:247], v[120:135]
    buffer_load_dwordx4 v[216:219], v249, s[32:35], s16 offen sc1
    ds_read_b64_tr_b16 v[52:53], v24
    ds_read_b64_tr_b16 v[54:55], v24 offset:2048
    s_waitcnt lgkmcnt(10)
    v_mfma_f32_32x32x16_bf16 v[136:151], v[32:35], v[244:247], v[136:151]
    ds_read_b64_tr_b16 v[28:29], v25
    ds_read_b64_tr_b16 v[30:31], v25 offset:2048
    s_waitcnt lgkmcnt(10)
    v_mfma_f32_32x32x16_bf16 v[88:103], v[36:39], v[244:247], v[88:103]
    ds_read_b64_tr_b16 v[32:33], v22
    ds_read_b64_tr_b16 v[34:35], v22 offset:2048
    s_waitcnt lgkmcnt(10)
    v_mfma_f32_32x32x16_bf16 v[104:119], v[40:43], v[244:247], v[104:119]
    buffer_load_dwordx4 v[220:223], v249, s[32:35], s16 offen offset:1024 sc1
    ds_read_b64_tr_b16 v[36:37], v23
    ds_read_b64_tr_b16 v[38:39], v23 offset:2048
    s_barrier
    s_waitcnt vmcnt(17)
    s_waitcnt lgkmcnt(10)
    v_mfma_f32_32x32x16_bf16 v[56:71], v[44:47], v[152:155], v[56:71]
    ds_read_b64_tr_b16 v[40:41], v20 offset:1024
    ds_read_b64_tr_b16 v[42:43], v20 offset:3072
    s_waitcnt lgkmcnt(10)
    v_mfma_f32_32x32x16_bf16 v[72:87], v[48:51], v[152:155], v[72:87]
    ds_read_b64_tr_b16 v[44:45], v21 offset:1024
    ds_read_b64_tr_b16 v[46:47], v21 offset:3072
    s_waitcnt lgkmcnt(10)
    v_mfma_f32_32x32x16_bf16 v[120:135], v[52:55], v[152:155], v[120:135]
    ds_read_b64_tr_b16 v[48:49], v24 offset:1024
    ds_read_b64_tr_b16 v[50:51], v24 offset:3072
    s_waitcnt lgkmcnt(10)
    v_mfma_f32_32x32x16_bf16 v[136:151], v[28:31], v[152:155], v[136:151]
    ds_read_b64_tr_b16 v[52:53], v25 offset:1024
    ds_read_b64_tr_b16 v[54:55], v25 offset:3072
    s_waitcnt lgkmcnt(10)
    v_mfma_f32_32x32x16_bf16 v[88:103], v[32:35], v[152:155], v[88:103]
    ds_read_b64_tr_b16 v[28:29], v22 offset:1024
    ds_read_b64_tr_b16 v[30:31], v22 offset:3072
    s_waitcnt lgkmcnt(10)
    v_mfma_f32_32x32x16_bf16 v[104:119], v[36:39], v[152:155], v[104:119]
    ds_read_b64_tr_b16 v[32:33], v23 offset:1024
    ds_read_b64_tr_b16 v[34:35], v23 offset:3072
    s_waitcnt vmcnt(16)
    s_waitcnt lgkmcnt(10)
    v_mfma_f32_32x32x16_bf16 v[56:71], v[40:43], v[156:159], v[56:71]
    ds_read_b64_tr_b16 v[36:37], v20 offset:4096
    ds_read_b64_tr_b16 v[38:39], v20 offset:6144
    s_waitcnt lgkmcnt(10)
    v_mfma_f32_32x32x16_bf16 v[72:87], v[44:47], v[156:159], v[72:87]
    ds_read_b64_tr_b16 v[40:41], v21 offset:4096
    ds_read_b64_tr_b16 v[42:43], v21 offset:6144
    s_waitcnt lgkmcnt(10)
    v_mfma_f32_32x32x16_bf16 v[120:135], v[48:51], v[156:159], v[120:135]
    buffer_load_dwordx4 v[224:227], v249, s[32:35], s16 offen offset:2048 sc1
    ds_read_b64_tr_b16 v[44:45], v24 offset:4096
    ds_read_b64_tr_b16 v[46:47], v24 offset:6144
    s_waitcnt lgkmcnt(10)
    v_mfma_f32_32x32x16_bf16 v[136:151], v[52:55], v[156:159], v[136:151]
    ds_read_b64_tr_b16 v[48:49], v25 offset:4096
    ds_read_b64_tr_b16 v[50:51], v25 offset:6144
    s_waitcnt lgkmcnt(10)
    v_mfma_f32_32x32x16_bf16 v[88:103], v[28:31], v[156:159], v[88:103]
    ds_read_b64_tr_b16 v[52:53], v22 offset:4096
    ds_read_b64_tr_b16 v[54:55], v22 offset:6144
    s_waitcnt lgkmcnt(10)
    v_mfma_f32_32x32x16_bf16 v[104:119], v[32:35], v[156:159], v[104:119]
    buffer_load_dwordx4 v[228:231], v249, s[32:35], s16 offen offset:3072 sc1
    ds_read_b64_tr_b16 v[28:29], v23 offset:4096
    ds_read_b64_tr_b16 v[30:31], v23 offset:6144
    s_waitcnt vmcnt(17)
    s_waitcnt lgkmcnt(10)
    v_mfma_f32_32x32x16_bf16 v[56:71], v[36:39], v[160:163], v[56:71]
    s_add_u32 s16, s16, 16384
    ds_read_b64_tr_b16 v[32:33], v20 offset:5120
    ds_read_b64_tr_b16 v[34:35], v20 offset:7168
    s_waitcnt lgkmcnt(10)
    v_mfma_f32_32x32x16_bf16 v[72:87], v[40:43], v[160:163], v[72:87]
    s_and_b32 s16, s16, 0x3ffff
    ds_read_b64_tr_b16 v[36:37], v21 offset:5120
    ds_read_b64_tr_b16 v[38:39], v21 offset:7168
    s_waitcnt lgkmcnt(10)
    v_mfma_f32_32x32x16_bf16 v[120:135], v[44:47], v[160:163], v[120:135]
    buffer_load_dwordx4 v[232:235], v249, s[32:35], s16 offen sc1
    ds_read_b64_tr_b16 v[40:41], v24 offset:5120
    ds_read_b64_tr_b16 v[42:43], v24 offset:7168
    s_waitcnt lgkmcnt(10)
    v_mfma_f32_32x32x16_bf16 v[136:151], v[48:51], v[160:163], v[136:151]
    ds_read_b64_tr_b16 v[44:45], v25 offset:5120
    ds_read_b64_tr_b16 v[46:47], v25 offset:7168
    s_waitcnt lgkmcnt(10)
    v_mfma_f32_32x32x16_bf16 v[88:103], v[52:55], v[160:163], v[88:103]
    ds_read_b64_tr_b16 v[48:49], v22 offset:5120
    ds_read_b64_tr_b16 v[50:51], v22 offset:7168
    s_waitcnt lgkmcnt(10)
    v_mfma_f32_32x32x16_bf16 v[104:119], v[28:31], v[160:163], v[104:119]
    buffer_load_dwordx4 v[236:239], v249, s[32:35], s16 offen offset:1024 sc1
    ds_read_b64_tr_b16 v[52:53], v23 offset:5120
    ds_read_b64_tr_b16 v[54:55], v23 offset:7168
    s_waitcnt vmcnt(18)
    s_waitcnt lgkmcnt(10)
    v_mfma_f32_32x32x16_bf16 v[56:71], v[32:35], v[164:167], v[56:71]
    ds_read_b64_tr_b16 v[28:29], v20 offset:8192
    ds_read_b64_tr_b16 v[30:31], v20 offset:10240
    s_waitcnt lgkmcnt(10)
    v_mfma_f32_32x32x16_bf16 v[72:87], v[36:39], v[164:167], v[72:87]
    ds_read_b64_tr_b16 v[32:33], v21 offset:8192
    ds_read_b64_tr_b16 v[34:35], v21 offset:10240
    s_waitcnt lgkmcnt(10)
    v_mfma_f32_32x32x16_bf16 v[120:135], v[40:43], v[164:167], v[120:135]
    buffer_load_dwordx4 v[240:243], v249, s[32:35], s16 offen offset:2048 sc1
    ds_read_b64_tr_b16 v[36:37], v24 offset:8192
    ds_read_b64_tr_b16 v[38:39], v24 offset:10240
    s_waitcnt lgkmcnt(10)
    v_mfma_f32_32x32x16_bf16 v[136:151], v[44:47], v[164:167], v[136:151]
    ds_read_b64_tr_b16 v[40:41], v25 offset:8192
    ds_read_b64_tr_b16 v[42:43], v25 offset:10240
    s_waitcnt lgkmcnt(10)
    v_mfma_f32_32x32x16_bf16 v[88:103], v[48:51], v[164:167], v[88:103]
    ds_read_b64_tr_b16 v[44:45], v22 offset:8192
    ds_read_b64_tr_b16 v[46:47], v22 offset:10240
    s_waitcnt lgkmcnt(10)
    v_mfma_f32_32x32x16_bf16 v[104:119], v[52:55], v[164:167], v[104:119]
    buffer_load_dwordx4 v[244:247], v249, s[32:35], s16 offen offset:3072 sc1
    ds_read_b64_tr_b16 v[48:49], v23 offset:8192
    ds_read_b64_tr_b16 v[50:51], v23 offset:10240
    s_barrier
    s_waitcnt vmcnt(19)
    s_waitcnt lgkmcnt(10)
    v_mfma_f32_32x32x16_bf16 v[56:71], v[28:31], v[168:171], v[56:71]
    s_add_u32 s16, s16, 16384
    ds_read_b64_tr_b16 v[52:53], v20 offset:9216
    ds_read_b64_tr_b16 v[54:55], v20 offset:11264
    s_waitcnt lgkmcnt(10)
    v_mfma_f32_32x32x16_bf16 v[72:87], v[32:35], v[168:171], v[72:87]
    s_and_b32 s16, s16, 0x3ffff
    ds_read_b64_tr_b16 v[28:29], v21 offset:9216
    ds_read_b64_tr_b16 v[30:31], v21 offset:11264
    s_waitcnt lgkmcnt(10)
    v_mfma_f32_32x32x16_bf16 v[120:135], v[36:39], v[168:171], v[120:135]
    ds_read_b64_tr_b16 v[32:33], v24 offset:9216
    ds_read_b64_tr_b16 v[34:35], v24 offset:11264
    s_waitcnt lgkmcnt(10)
    v_mfma_f32_32x32x16_bf16 v[136:151], v[40:43], v[168:171], v[136:151]
    ds_read_b64_tr_b16 v[36:37], v25 offset:9216
    ds_read_b64_tr_b16 v[38:39], v25 offset:11264
    s_waitcnt lgkmcnt(10)
    v_mfma_f32_32x32x16_bf16 v[88:103], v[44:47], v[168:171], v[88:103]
    ds_read_b64_tr_b16 v[40:41], v22 offset:9216
    ds_read_b64_tr_b16 v[42:43], v22 offset:11264
    s_waitcnt lgkmcnt(10)
    v_mfma_f32_32x32x16_bf16 v[104:119], v[48:51], v[168:171], v[104:119]
    ds_read_b64_tr_b16 v[44:45], v23 offset:9216
    ds_read_b64_tr_b16 v[46:47], v23 offset:11264
    s_waitcnt vmcnt(18)
    s_waitcnt lgkmcnt(10)
    v_mfma_f32_32x32x16_bf16 v[56:71], v[52:55], v[172:175], v[56:71]
    ds_read_b64_tr_b16 v[48:49], v20 offset:12288
    ds_read_b64_tr_b16 v[50:51], v20 offset:14336
    s_waitcnt lgkmcnt(10)
    v_mfma_f32_32x32x16_bf16 v[72:87], v[28:31], v[172:175], v[72:87]
    ds_read_b64_tr_b16 v[52:53], v21 offset:12288
    ds_read_b64_tr_b16 v[54:55], v21 offset:14336
    s_waitcnt lgkmcnt(10)
    v_mfma_f32_32x32x16_bf16 v[120:135], v[32:35], v[172:175], v[120:135]
    buffer_load_dwordx4 v[152:155], v249, s[32:35], s16 offen sc1
    ds_read_b64_tr_b16 v[28:29], v24 offset:12288
    ds_read_b64_tr_b16 v[30:31], v24 offset:14336
    s_waitcnt lgkmcnt(10)
    v_mfma_f32_32x32x16_bf16 v[136:151], v[36:39], v[172:175], v[136:151]
    ds_read_b64_tr_b16 v[32:33], v25 offset:12288
    ds_read_b64_tr_b16 v[34:35], v25 offset:14336
    s_waitcnt lgkmcnt(10)
    v_mfma_f32_32x32x16_bf16 v[88:103], v[40:43], v[172:175], v[88:103]
    ds_read_b64_tr_b16 v[36:37], v22 offset:12288
    ds_read_b64_tr_b16 v[38:39], v22 offset:14336
    s_waitcnt lgkmcnt(10)
    v_mfma_f32_32x32x16_bf16 v[104:119], v[44:47], v[172:175], v[104:119]
    buffer_load_dwordx4 v[156:159], v249, s[32:35], s16 offen offset:1024 sc1
    ds_read_b64_tr_b16 v[40:41], v23 offset:12288
    ds_read_b64_tr_b16 v[42:43], v23 offset:14336
    s_waitcnt vmcnt(19)
    s_waitcnt lgkmcnt(10)
    v_mfma_f32_32x32x16_bf16 v[56:71], v[48:51], v[176:179], v[56:71]
    ds_read_b64_tr_b16 v[44:45], v20 offset:13312
    ds_read_b64_tr_b16 v[46:47], v20 offset:15360
    s_waitcnt lgkmcnt(10)
    v_mfma_f32_32x32x16_bf16 v[72:87], v[52:55], v[176:179], v[72:87]
    ds_read_b64_tr_b16 v[48:49], v21 offset:13312
    ds_read_b64_tr_b16 v[50:51], v21 offset:15360
    s_waitcnt lgkmcnt(10)
    v_mfma_f32_32x32x16_bf16 v[120:135], v[28:31], v[176:179], v[120:135]
    buffer_load_dwordx4 v[160:163], v249, s[32:35], s16 offen offset:2048 sc1
    ds_read_b64_tr_b16 v[52:53], v24 offset:13312
    ds_read_b64_tr_b16 v[54:55], v24 offset:15360
    s_waitcnt lgkmcnt(10)
    v_mfma_f32_32x32x16_bf16 v[136:151], v[32:35], v[176:179], v[136:151]
    ds_read_b64_tr_b16 v[28:29], v25 offset:13312
    ds_read_b64_tr_b16 v[30:31], v25 offset:15360
    s_waitcnt lgkmcnt(10)
    v_mfma_f32_32x32x16_bf16 v[88:103], v[36:39], v[176:179], v[88:103]
    ds_read_b64_tr_b16 v[32:33], v22 offset:13312
    ds_read_b64_tr_b16 v[34:35], v22 offset:15360
    s_waitcnt lgkmcnt(10)
    v_mfma_f32_32x32x16_bf16 v[104:119], v[40:43], v[176:179], v[104:119]
    buffer_load_dwordx4 v[164:167], v249, s[32:35], s16 offen offset:3072 sc1
    ds_read_b64_tr_b16 v[36:37], v23 offset:13312
    ds_read_b64_tr_b16 v[38:39], v23 offset:15360
    s_waitcnt vmcnt(20)
    s_waitcnt lgkmcnt(10)
    v_mfma_f32_32x32x16_bf16 v[56:71], v[44:47], v[180:183], v[56:71]
    s_add_u32 s16, s16, 16384
    ds_read_b64_tr_b16 v[40:41], v20 offset:16384
    ds_read_b64_tr_b16 v[42:43], v20 offset:18432
    s_waitcnt lgkmcnt(10)
    v_mfma_f32_32x32x16_bf16 v[72:87], v[48:51], v[180:183], v[72:87]
    s_and_b32 s16, s16, 0x3ffff
    ds_read_b64_tr_b16 v[44:45], v21 offset:16384
    ds_read_b64_tr_b16 v[46:47], v21 offset:18432
    s_waitcnt lgkmcnt(10)
    v_mfma_f32_32x32x16_bf16 v[120:135], v[52:55], v[180:183], v[120:135]
    buffer_load_dwordx4 v[168:171], v249, s[32:35], s16 offen sc1
    ds_read_b64_tr_b16 v[48:49], v24 offset:16384
    ds_read_b64_tr_b16 v[50:51], v24 offset:18432
    s_waitcnt lgkmcnt(10)
    v_mfma_f32_32x32x16_bf16 v[136:151], v[28:31], v[180:183], v[136:151]
    ds_read_b64_tr_b16 v[52:53], v25 offset:16384
    ds_read_b64_tr_b16 v[54:55], v25 offset:18432
    s_waitcnt lgkmcnt(10)
    v_mfma_f32_32x32x16_bf16 v[88:103], v[32:35], v[180:183], v[88:103]
    ds_read_b64_tr_b16 v[28:29], v22 offset:16384
    ds_read_b64_tr_b16 v[30:31], v22 offset:18432
    s_waitcnt lgkmcnt(10)
    v_mfma_f32_32x32x16_bf16 v[104:119], v[36:39], v[180:183], v[104:119]
    buffer_load_dwordx4 v[172:175], v249, s[32:35], s16 offen offset:1024 sc1
    ds_read_b64_tr_b16 v[32:33], v23 offset:16384
    ds_read_b64_tr_b16 v[34:35], v23 offset:18432
    s_barrier
    s_waitcnt vmcnt(21)
    s_waitcnt lgkmcnt(10)
    v_mfma_f32_32x32x16_bf16 v[56:71], v[40:43], v[184:187], v[56:71]
    ds_read_b64_tr_b16 v[36:37], v20 offset:17408
    ds_read_b64_tr_b16 v[38:39], v20 offset:19456
    s_waitcnt lgkmcnt(10)
    v_mfma_f32_32x32x16_bf16 v[72:87], v[44:47], v[184:187], v[72:87]
    ds_read_b64_tr_b16 v[40:41], v21 offset:17408
    ds_read_b64_tr_b16 v[42:43], v21 offset:19456
    s_waitcnt lgkmcnt(10)
    v_mfma_f32_32x32x16_bf16 v[120:135], v[48:51], v[184:187], v[120:135]
    ds_read_b64_tr_b16 v[44:45], v24 offset:17408
    ds_read_b64_tr_b16 v[46:47], v24 offset:19456
    s_waitcnt lgkmcnt(10)
    v_mfma_f32_32x32x16_bf16 v[136:151], v[52:55], v[184:187], v[136:151]
    ds_read_b64_tr_b16 v[48:49], v25 offset:17408
    ds_read_b64_tr_b16 v[50:51], v25 offset:19456
    s_waitcnt lgkmcnt(10)
    v_mfma_f32_32x32x16_bf16 v[88:103], v[28:31], v[184:187], v[88:103]
    ds_read_b64_tr_b16 v[52:53], v22 offset:17408
    ds_read_b64_tr_b16 v[54:55], v22 offset:19456
    s_waitcnt lgkmcnt(10)
    v_mfma_f32_32x32x16_bf16 v[104:119], v[32:35], v[184:187], v[104:119]
    ds_read_b64_tr_b16 v[28:29], v23 offset:17408
    ds_read_b64_tr_b16 v[30:31], v23 offset:19456
    s_waitcnt vmcnt(20)
    s_waitcnt lgkmcnt(10)
    v_mfma_f32_32x32x16_bf16 v[56:71], v[36:39], v[188:191], v[56:71]
    ds_read_b64_tr_b16 v[32:33], v20 offset:20480
    ds_read_b64_tr_b16 v[34:35], v20 offset:22528
    s_waitcnt lgkmcnt(10)
    v_mfma_f32_32x32x16_bf16 v[72:87], v[40:43], v[188:191], v[72:87]
    ds_read_b64_tr_b16 v[36:37], v21 offset:20480
    ds_read_b64_tr_b16 v[38:39], v21 offset:22528
    s_waitcnt lgkmcnt(10)
    v_mfma_f32_32x32x16_bf16 v[120:135], v[44:47], v[188:191], v[120:135]
    ds_read_b64_tr_b16 v[40:41], v24 offset:20480
    ds_read_b64_tr_b16 v[42:43], v24 offset:22528
    s_waitcnt lgkmcnt(10)
    v_mfma_f32_32x32x16_bf16 v[136:151], v[48:51], v[188:191], v[136:151]
    buffer_load_dwordx4 v[176:179], v249, s[32:35], s16 offen offset:2048 sc1
    ds_read_b64_tr_b16 v[44:45], v25 offset:20480
    ds_read_b64_tr_b16 v[46:47], v25 offset:22528
    s_waitcnt lgkmcnt(10)
    v_mfma_f32_32x32x16_bf16 v[88:103], v[52:55], v[188:191], v[88:103]
    ds_read_b64_tr_b16 v[48:49], v22 offset:20480
    ds_read_b64_tr_b16 v[50:51], v22 offset:22528
    s_waitcnt lgkmcnt(10)
    v_mfma_f32_32x32x16_bf16 v[104:119], v[28:31], v[188:191], v[104:119]
    ds_read_b64_tr_b16 v[52:53], v23 offset:20480
    ds_read_b64_tr_b16 v[54:55], v23 offset:22528
    s_waitcnt vmcnt(20)
    s_waitcnt lgkmcnt(10)
    v_mfma_f32_32x32x16_bf16 v[56:71], v[32:35], v[192:195], v[56:71]
    ds_read_b64_tr_b16 v[28:29], v20 offset:21504
    ds_read_b64_tr_b16 v[30:31], v20 offset:23552
    s_waitcnt lgkmcnt(10)
    v_mfma_f32_32x32x16_bf16 v[72:87], v[36:39], v[192:195], v[72:87]
    buffer_load_dwordx4 v[180:183], v249, s[32:35], s16 offen offset:3072 sc1
    ds_read_b64_tr_b16 v[32:33], v21 offset:21504
    ds_read_b64_tr_b16 v[34:35], v21 offset:23552
    s_waitcnt lgkmcnt(10)
L_PAD3:
    s_cbranch_execz L_RET3
    v_mfma_f32_32x32x16_bf16 v[120:135], v[40:43], v[192:195], v[120:135]
    s_add_u32 s16, s16, 16384
    ds_read_b64_tr_b16 v[36:37], v24 offset:21504
    ds_read_b64_tr_b16 v[38:39], v24 offset:23552
    s_waitcnt lgkmcnt(10)
    v_mfma_f32_32x32x16_bf16 v[136:151], v[44:47], v[192:195], v[136:151]
    s_and_b32 s16, s16, 0x3ffff
    ds_read_b64_tr_b16 v[40:41], v25 offset:21504
    ds_read_b64_tr_b16 v[42:43], v25 offset:23552
    s_waitcnt lgkmcnt(10)
    v_mfma_f32_32x32x16_bf16 v[88:103], v[48:51], v[192:195], v[88:103]
    buffer_load_dwordx4 v[184:187], v249, s[32:35], s16 offen sc1
    ds_read_b64_tr_b16 v[44:45], v22 offset:21504
    ds_read_b64_tr_b16 v[46:47], v22 offset:23552
    s_waitcnt lgkmcnt(10)
    v_mfma_f32_32x32x16_bf16 v[104:119], v[52:55], v[192:195], v[104:119]
    ds_read_b64_tr_b16 v[48:49], v23 offset:21504
    ds_read_b64_tr_b16 v[50:51], v23 offset:23552
    s_waitcnt vmcnt(21)
    s_waitcnt lgkmcnt(10)
    v_mfma_f32_32x32x16_bf16 v[56:71], v[28:31], v[196:199], v[56:71]
    ds_read_b64_tr_b16 v[52:53], v20 offset:24576
    ds_read_b64_tr_b16 v[54:55], v20 offset:26624
    s_waitcnt lgkmcnt(10)
    v_mfma_f32_32x32x16_bf16 v[72:87], v[32:35], v[196:199], v[72:87]
    ds_read_b64_tr_b16 v[28:29], v21 offset:24576
    ds_read_b64_tr_b16 v[30:31], v21 offset:26624
    s_waitcnt lgkmcnt(10)
    v_mfma_f32_32x32x16_bf16 v[120:135], v[36:39], v[196:199], v[120:135]
    buffer_load_dwordx4 v[188:191], v249, s[32:35], s16 offen offset:1024 sc1
    ds_read_b64_tr_b16 v[32:33], v20 offset:25600
    ds_read_b64_tr_b16 v[34:35], v20 offset:27648
    s_waitcnt lgkmcnt(10)
    v_mfma_f32_32x32x16_bf16 v[136:151], v[40:43], v[196:199], v[136:151]
    ds_read_b64_tr_b16 v[36:37], v21 offset:25600
    ds_read_b64_tr_b16 v[38:39], v21 offset:27648
    s_waitcnt lgkmcnt(10)
    v_mfma_f32_32x32x16_bf16 v[88:103], v[44:47], v[196:199], v[88:103]
    ds_read_b64_tr_b16 v[40:41], v20 offset:28672
    ds_read_b64_tr_b16 v[42:43], v20 offset:30720
    s_waitcnt lgkmcnt(10)
    v_mfma_f32_32x32x16_bf16 v[104:119], v[48:51], v[196:199], v[104:119]
    buffer_load_dwordx4 v[192:195], v249, s[32:35], s16 offen offset:2048 sc1
    ds_read_b64_tr_b16 v[44:45], v21 offset:28672
    ds_read_b64_tr_b16 v[46:47], v21 offset:30720
    s_barrier
    s_waitcnt vmcnt(22)
    s_waitcnt lgkmcnt(10)
    v_mfma_f32_32x32x16_bf16 v[56:71], v[52:55], v[200:203], v[56:71]
    ds_read_b64_tr_b16 v[48:49], v20 offset:29696
    ds_read_b64_tr_b16 v[50:51], v20 offset:31744
    s_waitcnt lgkmcnt(10)
    v_mfma_f32_32x32x16_bf16 v[72:87], v[28:31], v[200:203], v[72:87]
    ds_read_b64_tr_b16 v[52:53], v21 offset:29696
    ds_read_b64_tr_b16 v[54:55], v21 offset:31744
    s_waitcnt vmcnt(21)
    s_waitcnt lgkmcnt(10)
    v_mfma_f32_32x32x16_bf16 v[56:71], v[32:35], v[204:207], v[56:71]
    ds_read_b64_tr_b16 v[28:29], v24 offset:24576
    ds_read_b64_tr_b16 v[30:31], v24 offset:26624
    s_waitcnt lgkmcnt(10)
    v_mfma_f32_32x32x16_bf16 v[72:87], v[36:39], v[204:207], v[72:87]
    ds_read_b64_tr_b16 v[32:33], v25 offset:24576
    ds_read_b64_tr_b16 v[34:35], v25 offset:26624
    s_waitcnt vmcnt(20)
    s_waitcnt lgkmcnt(10)
    v_mfma_f32_32x32x16_bf16 v[56:71], v[40:43], v[208:211], v[56:71]
    ds_read_b64_tr_b16 v[36:37], v22 offset:24576
    ds_read_b64_tr_b16 v[38:39], v22 offset:26624
    s_waitcnt lgkmcnt(10)
    v_mfma_f32_32x32x16_bf16 v[72:87], v[44:47], v[208:211], v[72:87]
    ds_read_b64_tr_b16 v[40:41], v23 offset:24576
    ds_read_b64_tr_b16 v[42:43], v23 offset:26624
    s_waitcnt vmcnt(19)
    s_waitcnt lgkmcnt(10)
    v_mfma_f32_32x32x16_bf16 v[56:71], v[48:51], v[212:215], v[56:71]
    ds_read_b64_tr_b16 v[44:45], v24 offset:25600
    ds_read_b64_tr_b16 v[46:47], v24 offset:27648
    s_waitcnt lgkmcnt(10)
    v_mfma_f32_32x32x16_bf16 v[72:87], v[52:55], v[212:215], v[72:87]
    ds_read_b64_tr_b16 v[48:49], v25 offset:25600
    ds_read_b64_tr_b16 v[50:51], v25 offset:27648
    s_barrier
    s_waitcnt lgkmcnt(10)
    v_mfma_f32_32x32x16_bf16 v[120:135], v[28:31], v[200:203], v[120:135]
    ds_read_b64_tr_b16 v[52:53], v22 offset:25600
    ds_read_b64_tr_b16 v[54:55], v22 offset:27648
    s_waitcnt lgkmcnt(10)
    v_mfma_f32_32x32x16_bf16 v[136:151], v[32:35], v[200:203], v[136:151]
    buffer_load_dwordx4 v[196:199], v249, s[32:35], s16 offen offset:3072 sc1
    ds_read_b64_tr_b16 v[28:29], v23 offset:25600
    ds_read_b64_tr_b16 v[30:31], v23 offset:27648
    s_waitcnt lgkmcnt(10)
    v_mfma_f32_32x32x16_bf16 v[88:103], v[36:39], v[200:203], v[88:103]
    s_add_u32 s16, s16, 16384
    ds_read_b64_tr_b16 v[32:33], v24 offset:28672
    ds_read_b64_tr_b16 v[34:35], v24 offset:30720
    s_waitcnt lgkmcnt(10)
    v_mfma_f32_32x32x16_bf16 v[104:119], v[40:43], v[200:203], v[104:119]
    s_and_b32 s16, s16, 0x3ffff
    ds_read_b64_tr_b16 v[36:37], v25 offset:28672
    ds_read_b64_tr_b16 v[38:39], v25 offset:30720
    s_waitcnt lgkmcnt(10)
    v_mfma_f32_32x32x16_bf16 v[120:135], v[44:47], v[204:207], v[120:135]
    ds_read_b64_tr_b16 v[40:41], v22 offset:28672
    ds_read_b64_tr_b16 v[42:43], v22 offset:30720
    s_waitcnt lgkmcnt(10)
    v_mfma_f32_32x32x16_bf16 v[136:151], v[48:51], v[204:207], v[136:151]
    buffer_load_dwordx4 v[200:203], v249, s[32:35], s16 offen sc1
    ds_read_b64_tr_b16 v[44:45], v23 offset:28672
    ds_read_b64_tr_b16 v[46:47], v23 offset:30720
    s_waitcnt lgkmcnt(10)
    v_mfma_f32_32x32x16_bf16 v[88:103], v[52:55], v[204:207], v[88:103]
    ds_read_b64_tr_b16 v[48:49], v24 offset:29696
    ds_read_b64_tr_b16 v[50:51], v24 offset:31744
    s_waitcnt lgkmcnt(10)
    v_mfma_f32_32x32x16_bf16 v[104:119], v[28:31], v[204:207], v[104:119]
    ds_read_b64_tr_b16 v[52:53], v25 offset:29696
    ds_read_b64_tr_b16 v[54:55], v25 offset:31744
    s_waitcnt lgkmcnt(10)
    v_mfma_f32_32x32x16_bf16 v[120:135], v[32:35], v[208:211], v[120:135]
    buffer_load_dwordx4 v[204:207], v249, s[32:35], s16 offen offset:1024 sc1
    ds_read_b64_tr_b16 v[28:29], v22 offset:29696
    ds_read_b64_tr_b16 v[30:31], v22 offset:31744
    s_waitcnt lgkmcnt(10)
    v_mfma_f32_32x32x16_bf16 v[136:151], v[36:39], v[208:211], v[136:151]
    ds_read_b64_tr_b16 v[32:33], v23 offset:29696
    ds_read_b64_tr_b16 v[34:35], v23 offset:31744
    s_waitcnt lgkmcnt(10)
    v_mfma_f32_32x32x16_bf16 v[88:103], v[40:43], v[208:211], v[88:103]
    ds_read_b64_tr_b16 v[36:37], v20 offset:32768
    ds_read_b64_tr_b16 v[38:39], v20 offset:34816
    s_waitcnt lgkmcnt(10)
    v_mfma_f32_32x32x16_bf16 v[104:119], v[44:47], v[208:211], v[104:119]
    ds_read_b64_tr_b16 v[40:41], v20 offset:33792
    ds_read_b64_tr_b16 v[42:43], v20 offset:35840
    s_waitcnt lgkmcnt(10)
    v_mfma_f32_32x32x16_bf16 v[120:135], v[48:51], v[212:215], v[120:135]
    buffer_load_dwordx4 v[208:211], v249, s[32:35], s16 offen offset:2048 sc1
    ds_read_b64_tr_b16 v[44:45], v20 offset:36864
    ds_read_b64_tr_b16 v[46:47], v20 offset:38912
    s_waitcnt lgkmcnt(10)
    v_mfma_f32_32x32x16_bf16 v[136:151], v[52:55], v[212:215], v[136:151]
    ds_read_b64_tr_b16 v[48:49], v20 offset:37888
    ds_read_b64_tr_b16 v[50:51], v20 offset:39936
    s_waitcnt lgkmcnt(10)
    v_mfma_f32_32x32x16_bf16 v[88:103], v[28:31], v[212:215], v[88:103]
    ds_read_b64_tr_b16 v[52:53], v20 offset:40960
    ds_read_b64_tr_b16 v[54:55], v20 offset:43008
    s_waitcnt lgkmcnt(10)
    v_mfma_f32_32x32x16_bf16 v[104:119], v[32:35], v[212:215], v[104:119]
    buffer_load_dwordx4 v[212:215], v249, s[32:35], s16 offen offset:3072 sc1
    ds_read_b64_tr_b16 v[28:29], v20 offset:41984
    ds_read_b64_tr_b16 v[30:31], v20 offset:44032
    s_barrier
    s_waitcnt vmcnt(23)
    s_waitcnt lgkmcnt(10)
    v_mfma_f32_32x32x16_bf16 v[56:71], v[36:39], v[216:219], v[56:71]
    s_add_u32 s16, s16, 16384
    ds_read_b64_tr_b16 v[32:33], v20 offset:45056
    ds_read_b64_tr_b16 v[34:35], v20 offset:47104
    s_waitcnt vmcnt(22)
    s_waitcnt lgkmcnt(10)
    v_mfma_f32_32x32x16_bf16 v[56:71], v[40:43], v[220:223], v[56:71]
    s_and_b32 s16, s16, 0x3ffff
    ds_read_b64_tr_b16 v[36:37], v20 offset:46080
    ds_read_b64_tr_b16 v[38:39], v20 offset:48128
    s_waitcnt vmcnt(21)
    s_waitcnt lgkmcnt(10)
    v_mfma_f32_32x32x16_bf16 v[56:71], v[44:47], v[224:227], v[56:71]
    ds_read_b64_tr_b16 v[40:41], v20
    ds_read_b64_tr_b16 v[42:43], v20 offset:2048
    s_waitcnt vmcnt(20)
    s_waitcnt lgkmcnt(10)
    v_mfma_f32_32x32x16_bf16 v[56:71], v[48:51], v[228:231], v[56:71]
    ds_read_b64_tr_b16 v[44:45], v20 offset:1024
    ds_read_b64_tr_b16 v[46:47], v20 offset:3072
    s_waitcnt vmcnt(19)
    s_waitcnt lgkmcnt(10)
    v_mfma_f32_32x32x16_bf16 v[56:71], v[52:55], v[232:235], v[56:71]
    ds_read_b64_tr_b16 v[48:49], v20 offset:4096
    ds_read_b64_tr_b16 v[50:51], v20 offset:6144
    s_waitcnt vmcnt(18)
    s_waitcnt lgkmcnt(10)
    v_mfma_f32_32x32x16_bf16 v[56:71], v[28:31], v[236:239], v[56:71]
    ds_read_b64_tr_b16 v[52:53], v20 offset:5120
    ds_read_b64_tr_b16 v[54:55], v20 offset:7168
    s_waitcnt vmcnt(17)
    s_waitcnt lgkmcnt(10)
    v_mfma_f32_32x32x16_bf16 v[56:71], v[32:35], v[240:243], v[56:71]
    ds_read_b64_tr_b16 v[28:29], v20 offset:8192
    ds_read_b64_tr_b16 v[30:31], v20 offset:10240
    s_waitcnt vmcnt(16)
    s_waitcnt lgkmcnt(10)
    v_mfma_f32_32x32x16_bf16 v[56:71], v[36:39], v[244:247], v[56:71]
    ds_read_b64_tr_b16 v[32:33], v20 offset:9216
    ds_read_b64_tr_b16 v[34:35], v20 offset:11264
    s_waitcnt vmcnt(15)
    s_waitcnt lgkmcnt(10)
    v_mfma_f32_32x32x16_bf16 v[56:71], v[40:43], v[152:155], v[56:71]
    ds_read_b64_tr_b16 v[36:37], v20 offset:12288
    ds_read_b64_tr_b16 v[38:39], v20 offset:14336
    s_waitcnt vmcnt(14)
    s_waitcnt lgkmcnt(10)
    v_mfma_f32_32x32x16_bf16 v[56:71], v[44:47], v[156:159], v[56:71]
    ds_read_b64_tr_b16 v[40:41], v20 offset:13312
    ds_read_b64_tr_b16 v[42:43], v20 offset:15360
    s_waitcnt vmcnt(13)
    s_waitcnt lgkmcnt(10)
    v_mfma_f32_32x32x16_bf16 v[56:71], v[48:51], v[160:163], v[56:71]
    ds_read_b64_tr_b16 v[44:45], v20 offset:16384
    ds_read_b64_tr_b16 v[46:47], v20 offset:18432
    s_waitcnt vmcnt(12)
    s_waitcnt lgkmcnt(10)
    v_mfma_f32_32x32x16_bf16 v[56:71], v[52:55], v[164:167], v[56:71]
    ds_read_b64_tr_b16 v[48:49], v20 offset:17408
    ds_read_b64_tr_b16 v[50:51], v20 offset:19456
    s_waitcnt vmcnt(11)
    s_waitcnt lgkmcnt(10)
    v_mfma_f32_32x32x16_bf16 v[56:71], v[28:31], v[168:171], v[56:71]
    ds_read_b64_tr_b16 v[52:53], v20 offset:20480
    ds_read_b64_tr_b16 v[54:55], v20 offset:22528
    s_waitcnt vmcnt(10)
    s_waitcnt lgkmcnt(10)
    v_mfma_f32_32x32x16_bf16 v[56:71], v[32:35], v[172:175], v[56:71]
    ds_read_b64_tr_b16 v[28:29], v20 offset:21504
    ds_read_b64_tr_b16 v[30:31], v20 offset:23552
    s_barrier
    s_waitcnt vmcnt(9)
    s_waitcnt lgkmcnt(10)
    v_mfma_f32_32x32x16_bf16 v[56:71], v[36:39], v[176:179], v[56:71]
    ds_read_b64_tr_b16 v[32:33], v20 offset:24576
    ds_read_b64_tr_b16 v[34:35], v20 offset:26624
    s_waitcnt vmcnt(8)
    s_waitcnt lgkmcnt(10)
    v_mfma_f32_32x32x16_bf16 v[56:71], v[40:43], v[180:183], v[56:71]
    ds_read_b64_tr_b16 v[36:37], v20 offset:25600
    ds_read_b64_tr_b16 v[38:39], v20 offset:27648
    s_waitcnt vmcnt(7)
    s_waitcnt lgkmcnt(10)
    v_mfma_f32_32x32x16_bf16 v[56:71], v[44:47], v[184:187], v[56:71]
    ds_read_b64_tr_b16 v[40:41], v20 offset:28672
    ds_read_b64_tr_b16 v[42:43], v20 offset:30720
    s_waitcnt vmcnt(6)
    s_waitcnt lgkmcnt(10)
    v_mfma_f32_32x32x16_bf16 v[56:71], v[48:51], v[188:191], v[56:71]
    ds_read_b64_tr_b16 v[44:45], v20 offset:29696
    ds_read_b64_tr_b16 v[46:47], v20 offset:31744
    s_waitcnt vmcnt(5)
    s_waitcnt lgkmcnt(10)
    v_mfma_f32_32x32x16_bf16 v[56:71], v[52:55], v[192:195], v[56:71]
    ds_read_b64_tr_b16 v[48:49], v21 offset:32768
    ds_read_b64_tr_b16 v[50:51], v21 offset:34816
    s_waitcnt vmcnt(4)
    s_waitcnt lgkmcnt(10)
    v_mfma_f32_32x32x16_bf16 v[56:71], v[28:31], v[196:199], v[56:71]
    ds_read_b64_tr_b16 v[52:53], v21 offset:33792
    ds_read_b64_tr_b16 v[54:55], v21 offset:35840
    s_waitcnt vmcnt(3)
    s_waitcnt lgkmcnt(10)
    v_mfma_f32_32x32x16_bf16 v[56:71], v[32:35], v[200:203], v[56:71]
    ds_read_b64_tr_b16 v[28:29], v21 offset:36864
    ds_read_b64_tr_b16 v[30:31], v21 offset:38912
    s_waitcnt vmcnt(2)
    s_waitcnt lgkmcnt(10)
    v_mfma_f32_32x32x16_bf16 v[56:71], v[36:39], v[204:207], v[56:71]
    ds_read_b64_tr_b16 v[32:33], v21 offset:37888
    ds_read_b64_tr_b16 v[34:35], v21 offset:39936
    s_waitcnt vmcnt(1)
    s_waitcnt lgkmcnt(10)
    v_mfma_f32_32x32x16_bf16 v[56:71], v[40:43], v[208:211], v[56:71]
    ds_read_b64_tr_b16 v[36:37], v21 offset:40960
    ds_read_b64_tr_b16 v[38:39], v21 offset:43008
    s_waitcnt vmcnt(0)
    s_waitcnt lgkmcnt(10)
    v_mfma_f32_32x32x16_bf16 v[56:71], v[44:47], v[212:215], v[56:71]
    ds_read_b64_tr_b16 v[40:41], v21 offset:41984
    ds_read_b64_tr_b16 v[42:43], v21 offset:44032
    s_waitcnt lgkmcnt(10)
    v_mfma_f32_32x32x16_bf16 v[72:87], v[48:51], v[216:219], v[72:87]
    ds_read_b64_tr_b16 v[44:45], v21 offset:45056
    ds_read_b64_tr_b16 v[46:47], v21 offset:47104
    s_waitcnt lgkmcnt(10)
    v_mfma_f32_32x32x16_bf16 v[72:87], v[52:55], v[220:223], v[72:87]
    s_nop 3
    v_cvt_pk_bf16_f32 v56, v56, v57
    v_cvt_pk_bf16_f32 v57, v58, v59
    ds_read_b64_tr_b16 v[48:49], v21 offset:46080
    ds_read_b64_tr_b16 v[50:51], v21 offset:48128
    s_waitcnt lgkmcnt(10)
    v_mfma_f32_32x32x16_bf16 v[72:87], v[28:31], v[224:227], v[72:87]
    v_cvt_pk_bf16_f32 v58, v60, v61
    v_cvt_pk_bf16_f32 v59, v62, v63
    ds_read_b64_tr_b16 v[52:53], v21
    ds_read_b64_tr_b16 v[54:55], v21 offset:2048
    s_waitcnt lgkmcnt(10)
    v_mfma_f32_32x32x16_bf16 v[72:87], v[32:35], v[228:231], v[72:87]
    ds_write_b128 v0, v[56:59]
    v_cvt_pk_bf16_f32 v60, v64, v65
    ds_read_b64_tr_b16 v[28:29], v21 offset:1024
    ds_read_b64_tr_b16 v[30:31], v21 offset:3072
    s_waitcnt lgkmcnt(11)
    v_mfma_f32_32x32x16_bf16 v[72:87], v[36:39], v[232:235], v[72:87]
    v_cvt_pk_bf16_f32 v61, v66, v67
    v_cvt_pk_bf16_f32 v62, v68, v69
    ds_read_b64_tr_b16 v[32:33], v21 offset:4096
    ds_read_b64_tr_b16 v[34:35], v21 offset:6144
    s_waitcnt lgkmcnt(11)
    v_mfma_f32_32x32x16_bf16 v[72:87], v[40:43], v[236:239], v[72:87]
    v_cvt_pk_bf16_f32 v63, v70, v71
    ds_write_b128 v0, v[60:63] offset:1024
    ds_read_b64_tr_b16 v[36:37], v21 offset:5120
    ds_read_b64_tr_b16 v[38:39], v21 offset:7168
    s_waitcnt lgkmcnt(12)
    v_mfma_f32_32x32x16_bf16 v[72:87], v[44:47], v[240:243], v[72:87]
    v_subrev_u32 v0, 118784, v0
    ds_read_b64_tr_b16 v[40:41], v21 offset:8192
    ds_read_b64_tr_b16 v[42:43], v21 offset:10240
    s_waitcnt lgkmcnt(12)
    v_mfma_f32_32x32x16_bf16 v[72:87], v[48:51], v[244:247], v[72:87]
    ds_read_b64_tr_b16 v[44:45], v21 offset:9216
    ds_read_b64_tr_b16 v[46:47], v21 offset:11264
    s_waitcnt lgkmcnt(6)
    s_barrier
    v_mfma_f32_32x32x16_bf16 v[72:87], v[52:55], v[152:155], v[72:87]
    ds_read_b64_tr_b16 v[48:49], v21 offset:12288
    ds_read_b64_tr_b16 v[50:51], v21 offset:14336
    v_mfma_f32_32x32x16_bf16 v[72:87], v[28:31], v[156:159], v[72:87]
    ds_read_b64_tr_b16 v[52:53], v21 offset:13312
    ds_read_b64_tr_b16 v[54:55], v21 offset:15360
    v_mfma_f32_32x32x16_bf16 v[72:87], v[32:35], v[160:163], v[72:87]
    ds_read_b64_tr_b16 v[28:29], v21 offset:16384
    ds_read_b64_tr_b16 v[30:31], v21 offset:18432
    s_waitcnt lgkmcnt(10)
    v_mfma_f32_32x32x16_bf16 v[72:87], v[36:39], v[164:167], v[72:87]
    ds_read_b64_tr_b16 v[32:33], v21 offset:17408
    ds_read_b64_tr_b16 v[34:35], v21 offset:19456
    s_waitcnt lgkmcnt(10)
    v_mfma_f32_32x32x16_bf16 v[72:87], v[40:43], v[168:171], v[72:87]
    ds_read_b64_tr_b16 v[36:37], v21 offset:20480
    ds_read_b64_tr_b16 v[38:39], v21 offset:22528
    s_waitcnt lgkmcnt(10)
    v_mfma_f32_32x32x16_bf16 v[72:87], v[44:47], v[172:175], v[72:87]
    ds_read_b64_tr_b16 v[40:41], v21 offset:21504
    ds_read_b64_tr_b16 v[42:43], v21 offset:23552
    s_waitcnt lgkmcnt(10)
    v_mfma_f32_32x32x16_bf16 v[72:87], v[48:51], v[176:179], v[72:87]
    ds_read_b64_tr_b16 v[44:45], v21 offset:24576
    ds_read_b64_tr_b16 v[46:47], v21 offset:26624
    s_waitcnt lgkmcnt(10)
    v_mfma_f32_32x32x16_bf16 v[72:87], v[52:55], v[180:183], v[72:87]
    ds_read_b64_tr_b16 v[48:49], v21 offset:25600
    ds_read_b64_tr_b16 v[50:51], v21 offset:27648
    s_waitcnt lgkmcnt(10)
    v_mfma_f32_32x32x16_bf16 v[72:87], v[28:31], v[184:187], v[72:87]
    ds_read_b64_tr_b16 v[52:53], v21 offset:28672
    ds_read_b64_tr_b16 v[54:55], v21 offset:30720
    s_waitcnt lgkmcnt(10)
    v_mfma_f32_32x32x16_bf16 v[72:87], v[32:35], v[188:191], v[72:87]
    ds_read_b64_tr_b16 v[28:29], v21 offset:29696
    ds_read_b64_tr_b16 v[30:31], v21 offset:31744
    s_waitcnt lgkmcnt(10)
    v_mfma_f32_32x32x16_bf16 v[72:87], v[36:39], v[192:195], v[72:87]
    ds_read_b64_tr_b16 v[32:33], v22 offset:32768
    ds_read_b64_tr_b16 v[34:35], v22 offset:34816
    s_waitcnt lgkmcnt(10)
    v_mfma_f32_32x32x16_bf16 v[72:87], v[40:43], v[196:199], v[72:87]
    ds_read_b64_tr_b16 v[36:37], v23 offset:32768
    ds_read_b64_tr_b16 v[38:39], v23 offset:34816
    s_waitcnt lgkmcnt(10)
    v_mfma_f32_32x32x16_bf16 v[72:87], v[44:47], v[200:203], v[72:87]
    ds_read_b64_tr_b16 v[40:41], v22 offset:33792
    ds_read_b64_tr_b16 v[42:43], v22 offset:35840
    s_waitcnt lgkmcnt(10)
    v_mfma_f32_32x32x16_bf16 v[72:87], v[48:51], v[204:207], v[72:87]
    ds_read_b64_tr_b16 v[44:45], v23 offset:33792
    ds_read_b64_tr_b16 v[46:47], v23 offset:35840
    s_waitcnt lgkmcnt(10)
    v_mfma_f32_32x32x16_bf16 v[72:87], v[52:55], v[208:211], v[72:87]
    ds_read_b64_tr_b16 v[48:49], v22 offset:36864
    ds_read_b64_tr_b16 v[50:51], v22 offset:38912
    s_waitcnt lgkmcnt(10)
    v_mfma_f32_32x32x16_bf16 v[72:87], v[28:31], v[212:215], v[72:87]
    ds_read_b64_tr_b16 v[52:53], v23 offset:36864
    ds_read_b64_tr_b16 v[54:55], v23 offset:38912
    s_waitcnt lgkmcnt(10)
    v_mfma_f32_32x32x16_bf16 v[88:103], v[32:35], v[216:219], v[88:103]
    ds_read_b64_tr_b16 v[28:29], v22 offset:37888
    ds_read_b64_tr_b16 v[30:31], v22 offset:39936
    s_waitcnt lgkmcnt(10)
    v_mfma_f32_32x32x16_bf16 v[104:119], v[36:39], v[216:219], v[104:119]
    s_nop 3
    v_cvt_pk_bf16_f32 v72, v72, v73
    v_cvt_pk_bf16_f32 v73, v74, v75
    ds_read_b64_tr_b16 v[32:33], v23 offset:37888
    ds_read_b64_tr_b16 v[34:35], v23 offset:39936
    s_waitcnt lgkmcnt(10)
    v_mfma_f32_32x32x16_bf16 v[88:103], v[40:43], v[220:223], v[88:103]
    v_cvt_pk_bf16_f32 v74, v76, v77
    v_cvt_pk_bf16_f32 v75, v78, v79
    ds_read_b64_tr_b16 v[36:37], v22 offset:40960
    ds_read_b64_tr_b16 v[38:39], v22 offset:43008
    s_waitcnt lgkmcnt(10)
    v_mfma_f32_32x32x16_bf16 v[104:119], v[44:47], v[220:223], v[104:119]
    ds_write_b128 v0, v[72:75]
    v_cvt_pk_bf16_f32 v76, v80, v81
    ds_read_b64_tr_b16 v[40:41], v23 offset:40960
    ds_read_b64_tr_b16 v[42:43], v23 offset:43008
    s_waitcnt lgkmcnt(11)
    v_mfma_f32_32x32x16_bf16 v[88:103], v[48:51], v[224:227], v[88:103]
    v_cvt_pk_bf16_f32 v77, v82, v83
    v_cvt_pk_bf16_f32 v78, v84, v85
    ds_read_b64_tr_b16 v[44:45], v22 offset:41984
    ds_read_b64_tr_b16 v[46:47], v22 offset:44032
    s_waitcnt lgkmcnt(11)
    v_mfma_f32_32x32x16_bf16 v[104:119], v[52:55], v[224:227], v[104:119]
    v_cvt_pk_bf16_f32 v79, v86, v87
    ds_write_b128 v0, v[76:79] offset:1024
    ds_read_b64_tr_b16 v[48:49], v23 offset:41984
    ds_read_b64_tr_b16 v[50:51], v23 offset:44032
    s_waitcnt lgkmcnt(12)
    v_mfma_f32_32x32x16_bf16 v[88:103], v[28:31], v[228:231], v[88:103]
    ds_read_b64_tr_b16 v[52:53], v22 offset:45056
    ds_read_b64_tr_b16 v[54:55], v22 offset:47104
    s_waitcnt lgkmcnt(12)
    v_mfma_f32_32x32x16_bf16 v[104:119], v[32:35], v[228:231], v[104:119]
    ds_read_b64_tr_b16 v[28:29], v23 offset:45056
    ds_read_b64_tr_b16 v[30:31], v23 offset:47104
    s_waitcnt lgkmcnt(6)
    s_barrier
    v_mfma_f32_32x32x16_bf16 v[88:103], v[36:39], v[232:235], v[88:103]
    s_lshl_b32 s96, s77, 11
    s_add_u32 s14, s96, 32768
    v_and_b32 v0, 7, v1
    ds_read_b64_tr_b16 v[32:33], v22 offset:46080
    ds_read_b64_tr_b16 v[34:35], v22 offset:48128
    v_mfma_f32_32x32x16_bf16 v[104:119], v[40:43], v[232:235], v[104:119]
    v_lshl_add_u32 v0, v0, 4, s14
    ds_read_b64_tr_b16 v[36:37], v23 offset:46080
    ds_read_b64_tr_b16 v[38:39], v23 offset:48128
    v_mfma_f32_32x32x16_bf16 v[88:103], v[44:47], v[236:239], v[88:103]
    v_bfe_u32 v4, v1, 3, 2
    ds_read_b64_tr_b16 v[40:41], v22
    ds_read_b64_tr_b16 v[42:43], v22 offset:2048
    s_waitcnt lgkmcnt(10)
    v_mfma_f32_32x32x16_bf16 v[104:119], v[48:51], v[236:239], v[104:119]
    v_lshl_add_u32 v0, v4, 8, v0
    v_lshrrev_b32 v4, 5, v1
    ds_read_b64_tr_b16 v[44:45], v23
    ds_read_b64_tr_b16 v[46:47], v23 offset:2048
    s_waitcnt lgkmcnt(10)
    v_mfma_f32_32x32x16_bf16 v[88:103], v[52:55], v[240:243], v[88:103]
    v_lshl_add_u32 v0, v4, 7, v0
    ds_read_b64_tr_b16 v[48:49], v22 offset:1024
    ds_read_b64_tr_b16 v[50:51], v22 offset:3072
    s_waitcnt lgkmcnt(10)
    v_mfma_f32_32x32x16_bf16 v[104:119], v[28:31], v[240:243], v[104:119]
    ds_read_b64_tr_b16 v[52:53], v23 offset:1024
    ds_read_b64_tr_b16 v[54:55], v23 offset:3072
    s_waitcnt lgkmcnt(10)
    v_mfma_f32_32x32x16_bf16 v[88:103], v[32:35], v[244:247], v[88:103]
    ds_read_b64_tr_b16 v[28:29], v22 offset:4096
    ds_read_b64_tr_b16 v[30:31], v22 offset:6144
    s_waitcnt lgkmcnt(10)
    v_mfma_f32_32x32x16_bf16 v[104:119], v[36:39], v[244:247], v[104:119]
    ds_read_b64_tr_b16 v[32:33], v23 offset:4096
    ds_read_b64_tr_b16 v[34:35], v23 offset:6144
    s_waitcnt lgkmcnt(10)
    v_mfma_f32_32x32x16_bf16 v[88:103], v[40:43], v[152:155], v[88:103]
    ds_read_b64_tr_b16 v[36:37], v22 offset:5120
    ds_read_b64_tr_b16 v[38:39], v22 offset:7168
    s_waitcnt lgkmcnt(10)
    v_mfma_f32_32x32x16_bf16 v[104:119], v[44:47], v[152:155], v[104:119]
    ds_read_b64_tr_b16 v[40:41], v23 offset:5120
    ds_read_b64_tr_b16 v[42:43], v23 offset:7168
    s_waitcnt lgkmcnt(10)
    v_mfma_f32_32x32x16_bf16 v[88:103], v[48:51], v[156:159], v[88:103]
    ds_read_b64_tr_b16 v[44:45], v22 offset:8192
    ds_read_b64_tr_b16 v[46:47], v22 offset:10240
    s_waitcnt lgkmcnt(10)
    v_mfma_f32_32x32x16_bf16 v[104:119], v[52:55], v[156:159], v[104:119]
    ds_read_b64_tr_b16 v[48:49], v23 offset:8192
    ds_read_b64_tr_b16 v[50:51], v23 offset:10240
    s_waitcnt lgkmcnt(10)
    v_mfma_f32_32x32x16_bf16 v[88:103], v[28:31], v[160:163], v[88:103]
    ds_read_b64_tr_b16 v[52:53], v22 offset:9216
    ds_read_b64_tr_b16 v[54:55], v22 offset:11264
    s_waitcnt lgkmcnt(10)
    v_mfma_f32_32x32x16_bf16 v[104:119], v[32:35], v[160:163], v[104:119]
    ds_read_b64_tr_b16 v[28:29], v23 offset:9216
    ds_read_b64_tr_b16 v[30:31], v23 offset:11264
    s_waitcnt lgkmcnt(10)
    v_mfma_f32_32x32x16_bf16 v[88:103], v[36:39], v[164:167], v[88:103]
    ds_read_b64_tr_b16 v[32:33], v22 offset:12288
    ds_read_b64_tr_b16 v[34:35], v22 offset:14336
    s_waitcnt lgkmcnt(10)
    v_mfma_f32_32x32x16_bf16 v[104:119], v[40:43], v[164:167], v[104:119]
    ds_read_b64_tr_b16 v[36:37], v23 offset:12288
    ds_read_b64_tr_b16 v[38:39], v23 offset:14336
    s_waitcnt lgkmcnt(10)
    v_mfma_f32_32x32x16_bf16 v[88:103], v[44:47], v[168:171], v[88:103]
    ds_read_b64_tr_b16 v[40:41], v22 offset:13312
    ds_read_b64_tr_b16 v[42:43], v22 offset:15360
    s_waitcnt lgkmcnt(10)
    v_mfma_f32_32x32x16_bf16 v[104:119], v[48:51], v[168:171], v[104:119]
    ds_read_b64_tr_b16 v[44:45], v23 offset:13312
    ds_read_b64_tr_b16 v[46:47], v23 offset:15360
    s_waitcnt lgkmcnt(10)
    v_mfma_f32_32x32x16_bf16 v[88:103], v[52:55], v[172:175], v[88:103]
    ds_read_b64_tr_b16 v[48:49], v22 offset:16384
    ds_read_b64_tr_b16 v[50:51], v22 offset:18432
    s_waitcnt lgkmcnt(10)
    v_mfma_f32_32x32x16_bf16 v[104:119], v[28:31], v[172:175], v[104:119]
    ds_read_b64_tr_b16 v[52:53], v23 offset:16384
    ds_read_b64_tr_b16 v[54:55], v23 offset:18432
    s_waitcnt lgkmcnt(10)
    v_mfma_f32_32x32x16_bf16 v[88:103], v[32:35], v[176:179], v[88:103]
    ds_read_b64_tr_b16 v[28:29], v22 offset:17408
    ds_read_b64_tr_b16 v[30:31], v22 offset:19456
    s_waitcnt lgkmcnt(10)
    v_mfma_f32_32x32x16_bf16 v[104:119], v[36:39], v[176:179], v[104:119]
    ds_read_b64_tr_b16 v[32:33], v23 offset:17408
    ds_read_b64_tr_b16 v[34:35], v23 offset:19456
    s_waitcnt lgkmcnt(10)
    v_mfma_f32_32x32x16_bf16 v[88:103], v[40:43], v[180:183], v[88:103]
    ds_read_b64_tr_b16 v[36:37], v22 offset:20480
    ds_read_b64_tr_b16 v[38:39], v22 offset:22528
    s_waitcnt lgkmcnt(10)
    v_mfma_f32_32x32x16_bf16 v[104:119], v[44:47], v[180:183], v[104:119]
    ds_read_b64_tr_b16 v[40:41], v23 offset:20480
    ds_read_b64_tr_b16 v[42:43], v23 offset:22528
    s_waitcnt lgkmcnt(10)
    v_mfma_f32_32x32x16_bf16 v[88:103], v[48:51], v[184:187], v[88:103]
    ds_read_b64_tr_b16 v[44:45], v22 offset:21504
    ds_read_b64_tr_b16 v[46:47], v22 offset:23552
    s_waitcnt lgkmcnt(10)
    v_mfma_f32_32x32x16_bf16 v[104:119], v[52:55], v[184:187], v[104:119]
    ds_read_b64_tr_b16 v[48:49], v23 offset:21504
    ds_read_b64_tr_b16 v[50:51], v23 offset:23552
    s_waitcnt lgkmcnt(10)
    v_mfma_f32_32x32x16_bf16 v[88:103], v[28:31], v[188:191], v[88:103]
    ds_read_b64_tr_b16 v[52:53], v22 offset:24576
    ds_read_b64_tr_b16 v[54:55], v22 offset:26624
    s_waitcnt lgkmcnt(10)
    v_mfma_f32_32x32x16_bf16 v[104:119], v[32:35], v[188:191], v[104:119]
    ds_read_b64_tr_b16 v[28:29], v23 offset:24576
    ds_read_b64_tr_b16 v[30:31], v23 offset:26624
    s_waitcnt lgkmcnt(10)
    v_mfma_f32_32x32x16_bf16 v[88:103], v[36:39], v[192:195], v[88:103]
    ds_read_b64_tr_b16 v[32:33], v22 offset:25600
    ds_read_b64_tr_b16 v[34:35], v22 offset:27648
    s_waitcnt lgkmcnt(10)
    v_mfma_f32_32x32x16_bf16 v[104:119], v[40:43], v[192:195], v[104:119]
    ds_read_b64_tr_b16 v[36:37], v23 offset:25600
    ds_read_b64_tr_b16 v[38:39], v23 offset:27648
    s_waitcnt lgkmcnt(10)
    v_mfma_f32_32x32x16_bf16 v[88:103], v[44:47], v[196:199], v[88:103]
    ds_read_b64_tr_b16 v[40:41], v22 offset:28672
    ds_read_b64_tr_b16 v[42:43], v22 offset:30720
    s_waitcnt lgkmcnt(10)
    v_mfma_f32_32x32x16_bf16 v[104:119], v[48:51], v[196:199], v[104:119]
    ds_read_b64_tr_b16 v[44:45], v23 offset:28672
    ds_read_b64_tr_b16 v[46:47], v23 offset:30720
    s_waitcnt lgkmcnt(10)
    v_mfma_f32_32x32x16_bf16 v[88:103], v[52:55], v[200:203], v[88:103]
    ds_read_b64_tr_b16 v[48:49], v22 offset:29696
    ds_read_b64_tr_b16 v[50:51], v22 offset:31744
    s_waitcnt lgkmcnt(10)
    v_mfma_f32_32x32x16_bf16 v[104:119], v[28:31], v[200:203], v[104:119]
    ds_read_b64_tr_b16 v[52:53], v23 offset:29696
    ds_read_b64_tr_b16 v[54:55], v23 offset:31744
    s_waitcnt lgkmcnt(10)
    v_mfma_f32_32x32x16_bf16 v[88:103], v[32:35], v[204:207], v[88:103]
    ds_read_b64_tr_b16 v[28:29], v24 offset:32768
    ds_read_b64_tr_b16 v[30:31], v24 offset:34816
    s_waitcnt lgkmcnt(10)
    v_mfma_f32_32x32x16_bf16 v[104:119], v[36:39], v[204:207], v[104:119]
    ds_read_b64_tr_b16 v[32:33], v25 offset:32768
    ds_read_b64_tr_b16 v[34:35], v25 offset:34816
    s_waitcnt lgkmcnt(10)
    v_mfma_f32_32x32x16_bf16 v[88:103], v[40:43], v[208:211], v[88:103]
    ds_read_b64_tr_b16 v[36:37], v24 offset:33792
    ds_read_b64_tr_b16 v[38:39], v24 offset:35840
    s_waitcnt lgkmcnt(10)
    v_mfma_f32_32x32x16_bf16 v[104:119], v[44:47], v[208:211], v[104:119]
    ds_read_b64_tr_b16 v[40:41], v25 offset:33792
    ds_read_b64_tr_b16 v[42:43], v25 offset:35840
    s_waitcnt lgkmcnt(10)
    v_mfma_f32_32x32x16_bf16 v[88:103], v[48:51], v[212:215], v[88:103]
    ds_read_b64_tr_b16 v[44:45], v24 offset:36864
    ds_read_b64_tr_b16 v[46:47], v24 offset:38912
    s_waitcnt lgkmcnt(10)
    v_mfma_f32_32x32x16_bf16 v[104:119], v[52:55], v[212:215], v[104:119]
    ds_read_b64_tr_b16 v[48:49], v25 offset:36864
L_PAD4:
    s_cbranch_execz L_RET4
    ds_read_b64_tr_b16 v[50:51], v25 offset:38912
    s_barrier
    s_waitcnt lgkmcnt(10)
    v_mfma_f32_32x32x16_bf16 v[120:135], v[28:31], v[216:219], v[120:135]
    ds_read_b64_tr_b16 v[52:53], v24 offset:37888
    ds_read_b64_tr_b16 v[54:55], v24 offset:39936
    s_waitcnt lgkmcnt(10)
    v_mfma_f32_32x32x16_bf16 v[136:151], v[32:35], v[216:219], v[136:151]
    ds_read_b64_tr_b16 v[28:29], v25 offset:37888
    ds_read_b64_tr_b16 v[30:31], v25 offset:39936
    s_waitcnt lgkmcnt(10)
    v_mfma_f32_32x32x16_bf16 v[120:135], v[36:39], v[220:223], v[120:135]
    v_cvt_pk_bf16_f32 v88, v88, v89
    ds_read_b64_tr_b16 v[32:33], v24 offset:40960
    ds_read_b64_tr_b16 v[34:35], v24 offset:43008
    s_waitcnt lgkmcnt(10)
    v_mfma_f32_32x32x16_bf16 v[136:151], v[40:43], v[220:223], v[136:151]
    v_cvt_pk_bf16_f32 v89, v90, v91
    ds_read_b64_tr_b16 v[36:37], v25 offset:40960
    ds_read_b64_tr_b16 v[38:39], v25 offset:43008
    s_waitcnt lgkmcnt(10)
    v_mfma_f32_32x32x16_bf16 v[120:135], v[44:47], v[224:227], v[120:135]
    v_cvt_pk_bf16_f32 v90, v92, v93
    ds_read_b64_tr_b16 v[40:41], v24 offset:41984
    ds_read_b64_tr_b16 v[42:43], v24 offset:44032
    s_waitcnt lgkmcnt(10)
    v_mfma_f32_32x32x16_bf16 v[136:151], v[48:51], v[224:227], v[136:151]
    v_cvt_pk_bf16_f32 v91, v94, v95
    ds_read_b64_tr_b16 v[44:45], v25 offset:41984
    ds_read_b64_tr_b16 v[46:47], v25 offset:44032
    s_waitcnt lgkmcnt(10)
    v_mfma_f32_32x32x16_bf16 v[120:135], v[52:55], v[228:231], v[120:135]
    ds_write_b128 v0, v[88:91]
    ds_read_b64_tr_b16 v[48:49], v24 offset:45056
    ds_read_b64_tr_b16 v[50:51], v24 offset:47104
    s_waitcnt lgkmcnt(11)
    v_mfma_f32_32x32x16_bf16 v[136:151], v[28:31], v[228:231], v[136:151]
    v_cvt_pk_bf16_f32 v92, v96, v97
    ds_read_b64_tr_b16 v[52:53], v25 offset:45056
    ds_read_b64_tr_b16 v[54:55], v25 offset:47104
    s_waitcnt lgkmcnt(11)
    v_mfma_f32_32x32x16_bf16 v[120:135], v[32:35], v[232:235], v[120:135]
    v_cvt_pk_bf16_f32 v93, v98, v99
    ds_read_b64_tr_b16 v[28:29], v24 offset:46080
    ds_read_b64_tr_b16 v[30:31], v24 offset:48128
    s_waitcnt lgkmcnt(11)
    v_mfma_f32_32x32x16_bf16 v[136:151], v[36:39], v[232:235], v[136:151]
    v_cvt_pk_bf16_f32 v94, v100, v101
    ds_read_b64_tr_b16 v[32:33], v25 offset:46080
    ds_read_b64_tr_b16 v[34:35], v25 offset:48128
    s_waitcnt lgkmcnt(11)
    v_mfma_f32_32x32x16_bf16 v[120:135], v[40:43], v[236:239], v[120:135]
    v_cvt_pk_bf16_f32 v95, v102, v103
    ds_read_b64_tr_b16 v[36:37], v24
    ds_read_b64_tr_b16 v[38:39], v24 offset:2048
    s_waitcnt lgkmcnt(11)
    v_mfma_f32_32x32x16_bf16 v[136:151], v[44:47], v[236:239], v[136:151]
    ds_write_b128 v0, v[92:95] offset:1024
    ds_read_b64_tr_b16 v[40:41], v25
    ds_read_b64_tr_b16 v[42:43], v25 offset:2048
    s_waitcnt lgkmcnt(11)
    v_mfma_f32_32x32x16_bf16 v[120:135], v[48:51], v[240:243], v[120:135]
    v_cvt_pk_bf16_f32 v104, v104, v105
    ds_read_b64_tr_b16 v[44:45], v24 offset:1024
    ds_read_b64_tr_b16 v[46:47], v24 offset:3072
    s_waitcnt lgkmcnt(11)
    v_mfma_f32_32x32x16_bf16 v[136:151], v[52:55], v[240:243], v[136:151]
    v_cvt_pk_bf16_f32 v105, v106, v107
    ds_read_b64_tr_b16 v[48:49], v25 offset:1024
    ds_read_b64_tr_b16 v[50:51], v25 offset:3072
    s_waitcnt lgkmcnt(11)
    v_mfma_f32_32x32x16_bf16 v[120:135], v[28:31], v[244:247], v[120:135]
    v_cvt_pk_bf16_f32 v106, v108, v109
    ds_read_b64_tr_b16 v[52:53], v24 offset:4096
    ds_read_b64_tr_b16 v[54:55], v24 offset:6144
    s_waitcnt lgkmcnt(11)
    v_mfma_f32_32x32x16_bf16 v[136:151], v[32:35], v[244:247], v[136:151]
    v_cvt_pk_bf16_f32 v107, v110, v111
    ds_read_b64_tr_b16 v[28:29], v25 offset:4096
    ds_read_b64_tr_b16 v[30:31], v25 offset:6144
    s_waitcnt lgkmcnt(11)
    v_mfma_f32_32x32x16_bf16 v[120:135], v[36:39], v[152:155], v[120:135]
    ds_write_b128 v0, v[104:107] offset:8192
    ds_read_b64_tr_b16 v[32:33], v24 offset:5120
    ds_read_b64_tr_b16 v[34:35], v24 offset:7168
    s_waitcnt lgkmcnt(11)
    v_mfma_f32_32x32x16_bf16 v[136:151], v[40:43], v[152:155], v[136:151]
    v_cvt_pk_bf16_f32 v108, v112, v113
    ds_read_b64_tr_b16 v[36:37], v25 offset:5120
    ds_read_b64_tr_b16 v[38:39], v25 offset:7168
    s_waitcnt lgkmcnt(11)
    v_mfma_f32_32x32x16_bf16 v[120:135], v[44:47], v[156:159], v[120:135]
    v_cvt_pk_bf16_f32 v109, v114, v115
    ds_read_b64_tr_b16 v[40:41], v24 offset:8192
    ds_read_b64_tr_b16 v[42:43], v24 offset:10240
    s_waitcnt lgkmcnt(11)
    v_mfma_f32_32x32x16_bf16 v[136:151], v[48:51], v[156:159], v[136:151]
    v_cvt_pk_bf16_f32 v110, v116, v117
    ds_read_b64_tr_b16 v[44:45], v25 offset:8192
    ds_read_b64_tr_b16 v[46:47], v25 offset:10240
    s_waitcnt lgkmcnt(11)
    v_mfma_f32_32x32x16_bf16 v[120:135], v[52:55], v[160:163], v[120:135]
    v_cvt_pk_bf16_f32 v111, v118, v119
    ds_read_b64_tr_b16 v[48:49], v24 offset:9216
    ds_read_b64_tr_b16 v[50:51], v24 offset:11264
    s_waitcnt lgkmcnt(11)
    v_mfma_f32_32x32x16_bf16 v[136:151], v[28:31], v[160:163], v[136:151]
    ds_write_b128 v0, v[108:111] offset:9216
    ds_read_b64_tr_b16 v[52:53], v25 offset:9216
    ds_read_b64_tr_b16 v[54:55], v25 offset:11264
    s_waitcnt lgkmcnt(11)
    v_mfma_f32_32x32x16_bf16 v[120:135], v[32:35], v[164:167], v[120:135]
    ds_read_b64_tr_b16 v[28:29], v24 offset:12288
    ds_read_b64_tr_b16 v[30:31], v24 offset:14336
    s_waitcnt lgkmcnt(11)
    v_mfma_f32_32x32x16_bf16 v[136:151], v[36:39], v[164:167], v[136:151]
    ds_read_b64_tr_b16 v[32:33], v25 offset:12288
    ds_read_b64_tr_b16 v[34:35], v25 offset:14336
    s_waitcnt lgkmcnt(11)
    v_mfma_f32_32x32x16_bf16 v[120:135], v[40:43], v[168:171], v[120:135]
    ds_read_b64_tr_b16 v[36:37], v24 offset:13312
    ds_read_b64_tr_b16 v[38:39], v24 offset:15360
    s_waitcnt lgkmcnt(11)
    v_mfma_f32_32x32x16_bf16 v[136:151], v[44:47], v[168:171], v[136:151]
    ds_read_b64_tr_b16 v[40:41], v25 offset:13312
    ds_read_b64_tr_b16 v[42:43], v25 offset:15360
    s_waitcnt lgkmcnt(11)
    v_mfma_f32_32x32x16_bf16 v[120:135], v[48:51], v[172:175], v[120:135]
    ds_read_b64_tr_b16 v[44:45], v24 offset:16384
    ds_read_b64_tr_b16 v[46:47], v24 offset:18432
    s_waitcnt lgkmcnt(10)
    v_mfma_f32_32x32x16_bf16 v[136:151], v[52:55], v[172:175], v[136:151]
    ds_read_b64_tr_b16 v[48:49], v25 offset:16384
    ds_read_b64_tr_b16 v[50:51], v25 offset:18432
    s_waitcnt lgkmcnt(10)
    v_mfma_f32_32x32x16_bf16 v[120:135], v[28:31], v[176:179], v[120:135]
    ds_read_b64_tr_b16 v[52:53], v24 offset:17408
    ds_read_b64_tr_b16 v[54:55], v24 offset:19456
    s_waitcnt lgkmcnt(10)
    v_mfma_f32_32x32x16_bf16 v[136:151], v[32:35], v[176:179], v[136:151]
    ds_read_b64_tr_b16 v[28:29], v25 offset:17408
    ds_read_b64_tr_b16 v[30:31], v25 offset:19456
    s_waitcnt lgkmcnt(10)
    v_mfma_f32_32x32x16_bf16 v[120:135], v[36:39], v[180:183], v[120:135]
    ds_read_b64_tr_b16 v[32:33], v24 offset:20480
    ds_read_b64_tr_b16 v[34:35], v24 offset:22528
    s_waitcnt lgkmcnt(10)
    v_mfma_f32_32x32x16_bf16 v[136:151], v[40:43], v[180:183], v[136:151]
    ds_read_b64_tr_b16 v[36:37], v25 offset:20480
    ds_read_b64_tr_b16 v[38:39], v25 offset:22528
    s_waitcnt lgkmcnt(10)
    v_mfma_f32_32x32x16_bf16 v[120:135], v[44:47], v[184:187], v[120:135]
    ds_read_b64_tr_b16 v[40:41], v24 offset:21504
    ds_read_b64_tr_b16 v[42:43], v24 offset:23552
    s_waitcnt lgkmcnt(10)
    v_mfma_f32_32x32x16_bf16 v[136:151], v[48:51], v[184:187], v[136:151]
    ds_read_b64_tr_b16 v[44:45], v25 offset:21504
    ds_read_b64_tr_b16 v[46:47], v25 offset:23552
    s_waitcnt lgkmcnt(10)
    v_mfma_f32_32x32x16_bf16 v[120:135], v[52:55], v[188:191], v[120:135]
    ds_read_b64_tr_b16 v[48:49], v24 offset:24576
    ds_read_b64_tr_b16 v[50:51], v24 offset:26624
    s_waitcnt lgkmcnt(10)
    v_mfma_f32_32x32x16_bf16 v[136:151], v[28:31], v[188:191], v[136:151]
    ds_read_b64_tr_b16 v[52:53], v25 offset:24576
    ds_read_b64_tr_b16 v[54:55], v25 offset:26624
    s_waitcnt lgkmcnt(10)
    v_mfma_f32_32x32x16_bf16 v[120:135], v[32:35], v[192:195], v[120:135]
    ds_read_b64_tr_b16 v[28:29], v24 offset:25600
    ds_read_b64_tr_b16 v[30:31], v24 offset:27648
    s_waitcnt lgkmcnt(10)
    v_mfma_f32_32x32x16_bf16 v[136:151], v[36:39], v[192:195], v[136:151]
    ds_read_b64_tr_b16 v[32:33], v25 offset:25600
    ds_read_b64_tr_b16 v[34:35], v25 offset:27648
    s_waitcnt lgkmcnt(10)
    v_mfma_f32_32x32x16_bf16 v[120:135], v[40:43], v[196:199], v[120:135]
    ds_read_b64_tr_b16 v[36:37], v24 offset:28672
    ds_read_b64_tr_b16 v[38:39], v24 offset:30720
    s_waitcnt lgkmcnt(10)
    v_mfma_f32_32x32x16_bf16 v[136:151], v[44:47], v[196:199], v[136:151]
    ds_read_b64_tr_b16 v[40:41], v25 offset:28672
    ds_read_b64_tr_b16 v[42:43], v25 offset:30720
    s_waitcnt lgkmcnt(10)
    v_mfma_f32_32x32x16_bf16 v[120:135], v[48:51], v[200:203], v[120:135]
    ds_read_b64_tr_b16 v[44:45], v25 offset:29696
    ds_read_b64_tr_b16 v[46:47], v25 offset:31744
    s_waitcnt lgkmcnt(10)
    v_mfma_f32_32x32x16_bf16 v[136:151], v[52:55], v[200:203], v[136:151]
    ds_read_b64_tr_b16 v[48:49], v24 offset:29696
    ds_read_b64_tr_b16 v[50:51], v24 offset:31744
    s_waitcnt lgkmcnt(10)
    v_mfma_f32_32x32x16_bf16 v[120:135], v[28:31], v[204:207], v[120:135]
    s_waitcnt lgkmcnt(8)
    v_mfma_f32_32x32x16_bf16 v[136:151], v[32:35], v[204:207], v[136:151]
    s_waitcnt lgkmcnt(6)
    v_mfma_f32_32x32x16_bf16 v[120:135], v[36:39], v[208:211], v[120:135]
    s_waitcnt lgkmcnt(4)
    v_mfma_f32_32x32x16_bf16 v[136:151], v[40:43], v[208:211], v[136:151]
    s_waitcnt lgkmcnt(2)
    v_mfma_f32_32x32x16_bf16 v[136:151], v[44:47], v[212:215], v[136:151]
    s_waitcnt lgkmcnt(0)
    v_mfma_f32_32x32x16_bf16 v[120:135], v[48:51], v[212:215], v[120:135]
    s_lshl_b32 s96, s77, 11
    s_add_u32 s14, s96, 151552
    v_add_u32 v0, s14, v2
    v_bfe_u32 v4, v1, 2, 2
    v_lshlrev_b32 v4, 6, v4
    v_bfe_u32 v9, v1, 4, 1
    v_lshl_add_u32 v4, v9, 5, v4
    v_and_b32 v9, 3, v1
    v_lshl_add_u32 v4, v9, 3, v4
    v_lshrrev_b32 v9, 5, v1
    v_lshl_add_u32 v4, v9, 8, v4
    v_add_u32 v4, 159744, v4
    ds_read_b64_tr_b16 v[176:177], v4
    ds_read_b64_tr_b16 v[178:179], v4 offset:512
    ds_read_b64_tr_b16 v[180:181], v4 offset:1024
    ds_read_b64_tr_b16 v[182:183], v4 offset:1536
    v_cvt_pk_bf16_f32 v152, v136, v137
    v_cvt_pk_bf16_f32 v153, v138, v139
    v_cvt_pk_bf16_f32 v154, v140, v141
    v_cvt_pk_bf16_f32 v155, v142, v143
    v_cvt_pk_bf16_f32 v156, v144, v145
    v_cvt_pk_bf16_f32 v157, v146, v147
    v_cvt_pk_bf16_f32 v158, v148, v149
    v_cvt_pk_bf16_f32 v159, v150, v151
    ds_write_b128 v0, v[152:155]
    ds_write_b128 v0, v[156:159] offset:1024
    v_cvt_pk_bf16_f32 v168, v120, v121
    v_cvt_pk_bf16_f32 v169, v122, v123
    v_cvt_pk_bf16_f32 v170, v124, v125
    v_cvt_pk_bf16_f32 v171, v126, v127
    v_cvt_pk_bf16_f32 v172, v128, v129
    v_cvt_pk_bf16_f32 v173, v130, v131
    v_cvt_pk_bf16_f32 v174, v132, v133
    v_cvt_pk_bf16_f32 v175, v134, v135
    s_setprio 0
    s_branch L_JOIN
L_HELP:
    s_waitcnt vmcnt(3)
    s_barrier
    s_add_u32 s96, s84, 5
    s_and_b32 s97, s96, 15
    s_mul_i32 s98, s97, 393216
    s_add_u32 s99, s98, s85
    s_add_u32 s82, s99, 4294772736
    s_add_u32 m0, s83, 36864
    s_nop 0
    buffer_load_dwordx4 v3, s[40:43], s82 offen lds
    s_add_u32 s96, s84, 5
    s_and_b32 s97, s96, 15
    s_mul_i32 s98, s97, 393216
    s_add_u32 s99, s98, s85
    s_add_u32 s82, s99, 2048
    s_add_u32 m0, s83, 40960
    s_nop 0
    buffer_load_dwordx4 v3, s[40:43], s82 offen lds
    s_add_u32 s96, s84, 5
    s_and_b32 s97, s96, 15
    s_mul_i32 s98, s97, 393216
    s_add_u32 s99, s98, s85
    s_add_u32 s82, s99, 4294774784
    s_add_u32 m0, s83, 86016
    s_nop 0
    buffer_load_dwordx4 v3, s[40:43], s82 offen lds
    s_add_u32 s96, s84, 5
    s_and_b32 s97, s96, 15
    s_mul_i32 s98, s97, 393216
    s_add_u32 s99, s98, s85
    s_add_u32 s82, s99, 4096
    s_add_u32 m0, s83, 90112
    s_nop 0
    buffer_load_dwordx4 v3, s[40:43], s82 offen lds
    s_add_u32 s96, s84, 5
    s_and_b32 s97, s96, 15
    s_mul_i32 s98, s97, 393216
    s_add_u32 s99, s98, s85
    s_add_u32 s82, s99, 4294770688
    s_add_u32 m0, s83, 135168
    s_nop 0
    buffer_load_dwordx4 v3, s[40:43], s82 offen lds
    s_add_u32 s96, s84, 5
    s_and_b32 s97, s96, 15
    s_mul_i32 s98, s97, 393216
    s_add_u32 s82, s98, s85
    s_add_u32 m0, s83, 139264
    s_nop 0
    buffer_load_dwordx4 v3, s[40:43], s82 offen lds
    v_bfe_u32 v4, v1, 2, 2
    v_lshlrev_b32 v4, 6, v4
    v_bfe_u32 v9, v1, 4, 1
    v_lshl_add_u32 v4, v9, 5, v4
    v_and_b32 v9, 3, v1
    v_lshl_add_u32 v4, v9, 3, v4
    v_lshrrev_b32 v9, 5, v1
    v_lshl_add_u32 v4, v9, 8, v4
    v_add_u32 v4, 159744, v4
    ds_read_b64_tr_b16 v[168:169], v4
    ds_read_b64_tr_b16 v[170:171], v4 offset:512
    ds_read_b64_tr_b16 v[172:173], v4 offset:1024
    ds_read_b64_tr_b16 v[174:175], v4 offset:1536
    ds_read_b64_tr_b16 v[176:177], v4 offset:2048
    ds_read_b64_tr_b16 v[178:179], v4 offset:2560
    ds_read_b64_tr_b16 v[180:181], v4 offset:3072
    ds_read_b64_tr_b16 v[182:183], v4 offset:3584
    s_lshl_b32 s14, s77, 10
    v_and_b32 v232, 7, v1
    v_lshl_add_u32 v232, v232, 4, s14
    v_bfe_u32 v9, v1, 3, 2
    v_lshl_add_u32 v232, v9, 8, v232
    v_lshrrev_b32 v9, 5, v1
    v_lshl_add_u32 v232, v9, 7, v232
    s_and_b32 s96, s9, 1
    s_lshl1_add_u32 s18, s96, 1
    s_and_b32 s96, s8, 3
    s_lshl2_add_u32 s97, s96, s3
    s_sub_u32 s98, s97, 4
    s_lshl_b32 s82, s98, 7
    v_lshrrev_b32 v52, 3, v1
    v_lshl_add_u32 v52, v52, 1, s82
    global_load_ushort v36, v52, s[86:87] offset:0
    global_load_ushort v37, v52, s[86:87] offset:16
    global_load_ushort v38, v52, s[86:87] offset:32
    global_load_ushort v39, v52, s[86:87] offset:48
    global_load_ushort v40, v52, s[86:87] offset:64
    global_load_ushort v41, v52, s[86:87] offset:80
    global_load_ushort v42, v52, s[86:87] offset:96
    global_load_ushort v43, v52, s[86:87] offset:112
    s_and_b32 s96, s8, 3
    s_lshl2_add_u32 s97, s96, s3
    s_sub_u32 s98, s97, 4
    s_mul_i32 s99, s98, 786432
    s_lshr_b32 s96, s8, 2
    s_lshl1_add_u32 s97, s9, s96
    s_lshl_b32 s98, s97, 7
    s_add_u32 s96, s99, s98
    s_add_u32 s19, s96, 4096
    s_barrier
    s_add_u32 s96, s84, 6
    s_and_b32 s97, s96, 15
    s_mul_i32 s98, s97, 393216
    s_add_u32 s99, s98, s85
    s_add_u32 s82, s99, 4294772736
    s_add_u32 m0, s83, 4294963200
    s_nop 0
    buffer_load_dwordx4 v3, s[40:43], s82 offen lds
    s_add_u32 s96, s84, 6
    s_and_b32 s97, s96, 15
    s_mul_i32 s98, s97, 393216
    s_add_u32 s99, s98, s85
    s_add_u32 s82, s99, 2048
    s_mov_b32 m0, s83
    s_nop 0
    buffer_load_dwordx4 v3, s[40:43], s82 offen lds
    s_add_u32 s96, s84, 6
    s_and_b32 s97, s96, 15
    s_mul_i32 s98, s97, 393216
    s_add_u32 s99, s98, s85
    s_add_u32 s82, s99, 4294770688
    s_add_u32 m0, s83, 94208
    s_nop 0
    buffer_load_dwordx4 v3, s[40:43], s82 offen lds
    s_add_u32 s96, s84, 6
    s_and_b32 s97, s96, 15
    s_mul_i32 s98, s97, 393216
    s_add_u32 s82, s98, s85
    s_add_u32 m0, s83, 98304
    s_nop 0
    buffer_load_dwordx4 v3, s[40:43], s82 offen lds
    s_add_u32 s96, s84, 6
    s_and_b32 s97, s96, 15
    s_mul_i32 s98, s97, 393216
    s_add_u32 s99, s98, s85
    s_add_u32 s82, s99, 4294774784
    s_add_u32 m0, s83, 45056
    s_nop 0
    buffer_load_dwordx4 v3, s[40:43], s82 offen lds
    s_add_u32 s96, s84, 6
    s_and_b32 s97, s96, 15
    s_mul_i32 s98, s97, 393216
    s_add_u32 s99, s98, s85
    s_add_u32 s82, s99, 4096
    s_add_u32 m0, s83, 49152
    s_nop 0
    buffer_load_dwordx4 v3, s[40:43], s82 offen lds
    s_waitcnt lgkmcnt(0)
    s_load_dword s24, s[32:33], s92 offset:512 glc
    s_load_dword s25, s[32:33], s92 offset:256 glc
    s_load_dword s26, s[32:33], s92 offset:3584 glc
    s_load_dword s27, s[32:33], s92 offset:3328 glc
    s_barrier
    s_add_u32 s96, s84, 7
    s_and_b32 s97, s96, 15
    s_mul_i32 s98, s97, 393216
    s_add_u32 s99, s98, s85
    s_add_u32 s82, s99, 4294772736
    s_add_u32 m0, s83, 4096
    s_nop 0
    buffer_load_dwordx4 v3, s[40:43], s82 offen lds
    s_add_u32 s96, s84, 7
    s_and_b32 s97, s96, 15
    s_mul_i32 s98, s97, 393216
    s_add_u32 s99, s98, s85
    s_add_u32 s82, s99, 2048
    s_add_u32 m0, s83, 8192
    s_nop 0
    buffer_load_dwordx4 v3, s[40:43], s82 offen lds
    s_add_u32 s96, s84, 7
    s_and_b32 s97, s96, 15
    s_mul_i32 s98, s97, 393216
    s_add_u32 s99, s98, s85
    s_add_u32 s82, s99, 4294770688
    s_add_u32 m0, s83, 102400
    s_nop 0
    buffer_load_dwordx4 v3, s[40:43], s82 offen lds
    s_add_u32 s96, s84, 7
    s_and_b32 s97, s96, 15
    s_mul_i32 s98, s97, 393216
    s_add_u32 s82, s98, s85
    s_add_u32 m0, s83, 106496
    s_nop 0
    buffer_load_dwordx4 v3, s[40:43], s82 offen lds
    s_add_u32 s96, s84, 7
    s_and_b32 s97, s96, 15
    s_mul_i32 s98, s97, 393216
    s_add_u32 s99, s98, s85
    s_add_u32 s82, s99, 4294774784
    s_add_u32 m0, s83, 53248
    s_nop 0
    buffer_load_dwordx4 v3, s[40:43], s82 offen lds
    s_add_u32 s96, s84, 7
    s_and_b32 s97, s96, 15
    s_mul_i32 s98, s97, 393216
    s_add_u32 s99, s98, s85
    s_add_u32 s82, s99, 4096
    s_add_u32 m0, s83, 57344
    s_nop 0
    buffer_load_dwordx4 v3, s[40:43], s82 offen lds
    s_waitcnt vmcnt(26)
    s_barrier
    s_add_u32 s96, s84, 8
    s_and_b32 s97, s96, 15
    s_mul_i32 s98, s97, 393216
    s_add_u32 s99, s98, s85
    s_add_u32 s82, s99, 4294772736
    s_add_u32 m0, s83, 12288
    s_nop 0
    buffer_load_dwordx4 v3, s[40:43], s82 offen lds
    s_add_u32 s96, s84, 8
    s_and_b32 s97, s96, 15
    s_mul_i32 s98, s97, 393216
    s_add_u32 s99, s98, s85
    s_add_u32 s82, s99, 2048
    s_add_u32 m0, s83, 16384
    s_nop 0
    buffer_load_dwordx4 v3, s[40:43], s82 offen lds
    s_add_u32 s96, s84, 8
    s_and_b32 s97, s96, 15
    s_mul_i32 s98, s97, 393216
    s_add_u32 s99, s98, s85
    s_add_u32 s82, s99, 4294770688
    s_add_u32 m0, s83, 110592
    s_nop 0
    buffer_load_dwordx4 v3, s[40:43], s82 offen lds
    s_add_u32 s96, s84, 8
    s_and_b32 s97, s96, 15
    s_mul_i32 s98, s97, 393216
    s_add_u32 s82, s98, s85
    s_add_u32 m0, s83, 114688
    s_nop 0
    buffer_load_dwordx4 v3, s[40:43], s82 offen lds
    s_add_u32 s96, s84, 8
    s_and_b32 s97, s96, 15
    s_mul_i32 s98, s97, 393216
    s_add_u32 s99, s98, s85
    s_add_u32 s82, s99, 4294774784
    s_add_u32 m0, s83, 61440
    s_nop 0
    buffer_load_dwordx4 v3, s[40:43], s82 offen lds
    s_add_u32 s96, s84, 8
    s_and_b32 s97, s96, 15
    s_mul_i32 s98, s97, 393216
    s_add_u32 s99, s98, s85
    s_add_u32 s82, s99, 4096
    s_add_u32 m0, s83, 65536
    s_nop 0
    buffer_load_dwordx4 v3, s[40:43], s82 offen lds
    s_waitcnt vmcnt(18)
    v_lshlrev_b32 v36, 16, v36
    v_mul_f32 v52, s7, v36
    v_exp_f32 v52, -v52
    s_nop 0
    v_add_f32 v52, 1.0, v52
    v_rcp_f32 v52, v52
    s_nop 0
    v_mul_f32 v36, v36, v52
    v_cvt_pk_bf16_f32 v36, 0, v36
    v_lshlrev_b32 v37, 16, v37
    v_mul_f32 v53, s7, v37
    v_exp_f32 v53, -v53
    s_nop 0
    v_add_f32 v53, 1.0, v53
    v_rcp_f32 v53, v53
    s_nop 0
    v_mul_f32 v37, v37, v53
    v_cvt_pk_bf16_f32 v37, 0, v37
    v_lshlrev_b32 v38, 16, v38
    v_mul_f32 v52, s7, v38
    v_exp_f32 v52, -v52
    s_nop 0
    v_add_f32 v52, 1.0, v52
    v_rcp_f32 v52, v52
    s_nop 0
    v_mul_f32 v38, v38, v52
    v_cvt_pk_bf16_f32 v38, 0, v38
    v_lshlrev_b32 v39, 16, v39
    v_mul_f32 v53, s7, v39
    v_exp_f32 v53, -v53
    s_nop 0
    v_add_f32 v53, 1.0, v53
    v_rcp_f32 v53, v53
    s_nop 0
    v_mul_f32 v39, v39, v53
    v_cvt_pk_bf16_f32 v39, 0, v39
    v_lshlrev_b32 v40, 16, v40
    v_mul_f32 v52, s7, v40
    v_exp_f32 v52, -v52
    s_nop 0
    v_add_f32 v52, 1.0, v52
    v_rcp_f32 v52, v52
    s_nop 0
    v_mul_f32 v40, v40, v52
    v_cvt_pk_bf16_f32 v40, 0, v40
    v_lshlrev_b32 v41, 16, v41
    v_mul_f32 v53, s7, v41
    v_exp_f32 v53, -v53
    s_nop 0
    v_add_f32 v53, 1.0, v53
    v_rcp_f32 v53, v53
    s_nop 0
    v_mul_f32 v41, v41, v53
    v_cvt_pk_bf16_f32 v41, 0, v41
    v_lshlrev_b32 v42, 16, v42
    v_mul_f32 v52, s7, v42
    v_exp_f32 v52, -v52
    s_nop 0
    v_add_f32 v52, 1.0, v52
    v_rcp_f32 v52, v52
    s_nop 0
    v_mul_f32 v42, v42, v52
    v_cvt_pk_bf16_f32 v42, 0, v42
    v_lshlrev_b32 v43, 16, v43
    v_mul_f32 v53, s7, v43
    v_exp_f32 v53, -v53
    s_nop 0
    v_add_f32 v53, 1.0, v53
    v_rcp_f32 v53, v53
    s_nop 0
    v_mul_f32 v43, v43, v53
    v_cvt_pk_bf16_f32 v43, 0, v43
    s_waitcnt lgkmcnt(0)
    s_load_dword s24, s[32:33], s92 offset:1024 glc
    s_load_dword s25, s[32:33], s92 offset:768 glc
    s_load_dword s26, s[32:33], s92 offset:1536 glc
    s_load_dword s27, s[32:33], s92 offset:1280 glc
    s_barrier
    s_add_u32 s96, s84, 9
    s_and_b32 s97, s96, 15
    s_mul_i32 s98, s97, 393216
    s_add_u32 s99, s98, s85
    s_add_u32 s82, s99, 4294772736
    s_add_u32 m0, s83, 20480
    s_nop 0
    buffer_load_dwordx4 v3, s[40:43], s82 offen lds
    s_add_u32 s96, s84, 9
    s_and_b32 s97, s96, 15
    s_mul_i32 s98, s97, 393216
    s_add_u32 s99, s98, s85
    s_add_u32 s82, s99, 2048
    s_add_u32 m0, s83, 24576
    s_nop 0
    buffer_load_dwordx4 v3, s[40:43], s82 offen lds
    s_add_u32 s96, s84, 9
    s_and_b32 s97, s96, 15
    s_mul_i32 s98, s97, 393216
    s_add_u32 s99, s98, s85
    s_add_u32 s82, s99, 4294770688
    s_add_u32 m0, s83, 118784
    s_nop 0
    buffer_load_dwordx4 v3, s[40:43], s82 offen lds
    s_add_u32 s96, s84, 9
    s_and_b32 s97, s96, 15
    s_mul_i32 s98, s97, 393216
    s_add_u32 s82, s98, s85
    s_add_u32 m0, s83, 122880
    s_nop 0
    buffer_load_dwordx4 v3, s[40:43], s82 offen lds
    s_add_u32 s96, s84, 9
    s_and_b32 s97, s96, 15
    s_mul_i32 s98, s97, 393216
    s_add_u32 s99, s98, s85
    s_add_u32 s82, s99, 4294774784
    s_add_u32 m0, s83, 69632
    s_nop 0
    buffer_load_dwordx4 v3, s[40:43], s82 offen lds
    s_add_u32 s96, s84, 9
    s_and_b32 s97, s96, 15
    s_mul_i32 s98, s97, 393216
    s_add_u32 s99, s98, s85
    s_add_u32 s82, s99, 4096
    s_add_u32 m0, s83, 73728
    s_nop 0
    buffer_load_dwordx4 v3, s[40:43], s82 offen lds
    s_waitcnt vmcnt(22)
    s_waitcnt vmcnt(20)
    s_waitcnt vmcnt(18)
    s_barrier
    s_add_u32 s96, s84, 10
    s_and_b32 s97, s96, 15
    s_mul_i32 s98, s97, 393216
    s_add_u32 s99, s98, s85
    s_add_u32 s82, s99, 4294772736
    s_add_u32 m0, s83, 28672
    s_nop 0
    buffer_load_dwordx4 v3, s[40:43], s82 offen lds
    s_add_u32 s96, s84, 10
    s_and_b32 s97, s96, 15
    s_mul_i32 s98, s97, 393216
    s_add_u32 s99, s98, s85
    s_add_u32 s82, s99, 2048
    s_add_u32 m0, s83, 32768
    s_nop 0
    buffer_load_dwordx4 v3, s[40:43], s82 offen lds
    s_add_u32 s96, s84, 10
    s_and_b32 s97, s96, 15
    s_mul_i32 s98, s97, 393216
    s_add_u32 s99, s98, s85
    s_add_u32 s82, s99, 4294774784
    s_add_u32 m0, s83, 77824
    s_nop 0
    buffer_load_dwordx4 v3, s[40:43], s82 offen lds
    s_add_u32 s96, s84, 10
    s_and_b32 s97, s96, 15
    s_mul_i32 s98, s97, 393216
    s_add_u32 s99, s98, s85
    s_add_u32 s82, s99, 4096
    s_add_u32 m0, s83, 81920
    s_nop 0
    buffer_load_dwordx4 v3, s[40:43], s82 offen lds
    s_waitcnt lgkmcnt(0)
    s_load_dword s24, s[32:33], s92 offset:2560 glc
    s_load_dword s25, s[32:33], s92 offset:2304 glc
    s_load_dword s26, s[32:33], s92 offset:3072 glc
    s_load_dword s27, s[32:33], s92 offset:2816 glc
    s_waitcnt vmcnt(20)
L_PAD5:
    s_cbranch_execz L_RET5
    s_waitcnt vmcnt(18)
    s_waitcnt vmcnt(16)
    s_barrier
    s_add_u32 s96, s84, 11
    s_and_b32 s97, s96, 15
    s_mul_i32 s98, s97, 393216
    s_add_u32 s99, s98, s85
    s_add_u32 s82, s99, 4294772736
    s_add_u32 m0, s83, 36864
    s_nop 0
    buffer_load_dwordx4 v3, s[40:43], s82 offen lds
    s_add_u32 s96, s84, 11
    s_and_b32 s97, s96, 15
    s_mul_i32 s98, s97, 393216
    s_add_u32 s99, s98, s85
    s_add_u32 s82, s99, 2048
    s_add_u32 m0, s83, 40960
    s_nop 0
    buffer_load_dwordx4 v3, s[40:43], s82 offen lds
    s_add_u32 s96, s84, 11
    s_and_b32 s97, s96, 15
    s_mul_i32 s98, s97, 393216
    s_add_u32 s99, s98, s85
    s_add_u32 s82, s99, 4294774784
    s_add_u32 m0, s83, 86016
    s_nop 0
    buffer_load_dwordx4 v3, s[40:43], s82 offen lds
    s_add_u32 s96, s84, 11
    s_and_b32 s97, s96, 15
    s_mul_i32 s98, s97, 393216
    s_add_u32 s99, s98, s85
    s_add_u32 s82, s99, 4096
    s_add_u32 m0, s83, 90112
    s_nop 0
    buffer_load_dwordx4 v3, s[40:43], s82 offen lds
    s_waitcnt vmcnt(18)
    s_waitcnt vmcnt(16)
    s_waitcnt vmcnt(14)
    s_barrier
    s_add_u32 s96, s84, 12
    s_and_b32 s97, s96, 15
    s_mul_i32 s98, s97, 393216
    s_add_u32 s99, s98, s85
    s_add_u32 s82, s99, 4294772736
    s_add_u32 m0, s83, 4294963200
    s_nop 0
    buffer_load_dwordx4 v3, s[40:43], s82 offen lds
    s_add_u32 s96, s84, 12
    s_and_b32 s97, s96, 15
    s_mul_i32 s98, s97, 393216
    s_add_u32 s99, s98, s85
    s_add_u32 s82, s99, 2048
    s_mov_b32 m0, s83
    s_nop 0
    buffer_load_dwordx4 v3, s[40:43], s82 offen lds
    s_add_u32 s96, s84, 12
    s_and_b32 s97, s96, 15
    s_mul_i32 s98, s97, 393216
    s_add_u32 s99, s98, s85
    s_add_u32 s82, s99, 4294774784
    s_add_u32 m0, s83, 45056
    s_nop 0
    buffer_load_dwordx4 v3, s[40:43], s82 offen lds
    s_add_u32 s96, s84, 12
    s_and_b32 s97, s96, 15
    s_mul_i32 s98, s97, 393216
    s_add_u32 s99, s98, s85
    s_add_u32 s82, s99, 4096
    s_add_u32 m0, s83, 49152
    s_nop 0
    buffer_load_dwordx4 v3, s[40:43], s82 offen lds
    s_waitcnt vmcnt(16)
    s_barrier
    s_add_u32 s96, s84, 13
    s_and_b32 s97, s96, 15
    s_mul_i32 s98, s97, 393216
    s_add_u32 s99, s98, s85
    s_add_u32 s82, s99, 4294772736
    s_add_u32 m0, s83, 4096
    s_nop 0
    buffer_load_dwordx4 v3, s[40:43], s82 offen lds
    s_add_u32 s96, s84, 13
    s_and_b32 s97, s96, 15
    s_mul_i32 s98, s97, 393216
    s_add_u32 s99, s98, s85
    s_add_u32 s82, s99, 2048
    s_add_u32 m0, s83, 8192
    s_nop 0
    buffer_load_dwordx4 v3, s[40:43], s82 offen lds
    s_add_u32 s96, s84, 13
    s_and_b32 s97, s96, 15
    s_mul_i32 s98, s97, 393216
    s_add_u32 s99, s98, s85
    s_add_u32 s82, s99, 4294774784
    s_add_u32 m0, s83, 53248
    s_nop 0
    buffer_load_dwordx4 v3, s[40:43], s82 offen lds
    s_add_u32 s96, s84, 13
    s_and_b32 s97, s96, 15
    s_mul_i32 s98, s97, 393216
    s_add_u32 s99, s98, s85
    s_add_u32 s82, s99, 4096
    s_add_u32 m0, s83, 57344
    s_nop 0
    buffer_load_dwordx4 v3, s[40:43], s82 offen lds
    s_lshl_b32 s96, s74, 13
    s_sub_u32 s97, s3, 4
    s_lshl_b32 s98, s97, 8
    s_add_u32 s99, s96, s98
    s_add_u32 s13, s99, 20971520
    s_waitcnt lgkmcnt(0)
    s_load_dword s24, s[32:33], s13 offset:1276 glc
    s_load_dword s25, s[32:33], s13 offset:3324 glc
    s_load_dword s26, s[32:33], s13 offset:5372 glc
    s_load_dword s27, s[32:33], s13 offset:7420 glc
    s_waitcnt vmcnt(18)
    s_waitcnt vmcnt(16)
    s_barrier
    s_add_u32 s96, s84, 14
    s_and_b32 s97, s96, 15
    s_mul_i32 s98, s97, 393216
    s_add_u32 s99, s98, s85
    s_add_u32 s82, s99, 4294772736
    s_add_u32 m0, s83, 12288
    s_nop 0
    buffer_load_dwordx4 v3, s[40:43], s82 offen lds
    s_add_u32 s96, s84, 14
    s_and_b32 s97, s96, 15
    s_mul_i32 s98, s97, 393216
    s_add_u32 s99, s98, s85
    s_add_u32 s82, s99, 2048
    s_add_u32 m0, s83, 16384
    s_nop 0
    buffer_load_dwordx4 v3, s[40:43], s82 offen lds
    s_add_u32 s96, s84, 10
    s_and_b32 s97, s96, 15
    s_mul_i32 s98, s97, 393216
    s_add_u32 s99, s98, s85
    s_add_u32 s82, s99, 4294770688
    s_add_u32 m0, s83, 126976
    s_nop 0
    buffer_load_dwordx4 v3, s[40:43], s82 offen lds
    s_add_u32 s96, s84, 10
    s_and_b32 s97, s96, 15
    s_mul_i32 s98, s97, 393216
    s_add_u32 s82, s98, s85
    s_add_u32 m0, s83, 131072
    s_nop 0
    buffer_load_dwordx4 v3, s[40:43], s82 offen lds
    s_waitcnt vmcnt(18)
    s_waitcnt vmcnt(14)
    s_barrier
    s_add_u32 s96, s84, 15
    s_and_b32 s97, s96, 15
    s_mul_i32 s98, s97, 393216
    s_add_u32 s99, s98, s85
    s_add_u32 s82, s99, 4294772736
    s_add_u32 m0, s83, 20480
    s_nop 0
    buffer_load_dwordx4 v3, s[40:43], s82 offen lds
    s_add_u32 s96, s84, 15
    s_and_b32 s97, s96, 15
    s_mul_i32 s98, s97, 393216
    s_add_u32 s99, s98, s85
    s_add_u32 s82, s99, 2048
    s_add_u32 m0, s83, 24576
    s_nop 0
    buffer_load_dwordx4 v3, s[40:43], s82 offen lds
    s_add_u32 s96, s84, 11
    s_and_b32 s97, s96, 15
    s_mul_i32 s98, s97, 393216
    s_add_u32 s99, s98, s85
    s_add_u32 s82, s99, 4294770688
    s_add_u32 m0, s83, 135168
    s_nop 0
    buffer_load_dwordx4 v3, s[40:43], s82 offen lds
    s_add_u32 s96, s84, 11
    s_and_b32 s97, s96, 15
    s_mul_i32 s98, s97, 393216
    s_add_u32 s82, s98, s85
    s_add_u32 m0, s83, 139264
    s_nop 0
    buffer_load_dwordx4 v3, s[40:43], s82 offen lds
    s_waitcnt vmcnt(14)
    s_waitcnt vmcnt(10)
    s_waitcnt vmcnt(6)
    s_barrier
    s_add_u32 s96, s84, 14
    s_and_b32 s97, s96, 15
    s_mul_i32 s98, s97, 393216
    s_add_u32 s99, s98, s85
    s_add_u32 s82, s99, 4294774784
    s_add_u32 m0, s83, 61440
    s_nop 0
    buffer_load_dwordx4 v3, s[40:43], s82 offen lds
    s_add_u32 s96, s84, 14
    s_and_b32 s97, s96, 15
    s_mul_i32 s98, s97, 393216
    s_add_u32 s99, s98, s85
    s_add_u32 s82, s99, 4096
    s_add_u32 m0, s83, 65536
    s_nop 0
    buffer_load_dwordx4 v3, s[40:43], s82 offen lds
    s_add_u32 s96, s84, 15
    s_and_b32 s97, s96, 15
    s_mul_i32 s98, s97, 393216
    s_add_u32 s99, s98, s85
    s_add_u32 s82, s99, 4294774784
    s_add_u32 m0, s83, 69632
    s_nop 0
    buffer_load_dwordx4 v3, s[40:43], s82 offen lds
    s_add_u32 s96, s84, 15
    s_and_b32 s97, s96, 15
    s_mul_i32 s98, s97, 393216
    s_add_u32 s99, s98, s85
    s_add_u32 s82, s99, 4096
    s_add_u32 m0, s83, 73728
    s_nop 0
    buffer_load_dwordx4 v3, s[40:43], s82 offen lds
    s_add_u32 s96, s84, 12
    s_and_b32 s97, s96, 15
    s_mul_i32 s98, s97, 393216
    s_add_u32 s99, s98, s85
    s_add_u32 s82, s99, 4294770688
    s_add_u32 m0, s83, 94208
    s_nop 0
    buffer_load_dwordx4 v3, s[40:43], s82 offen lds
    s_add_u32 s96, s84, 12
    s_and_b32 s97, s96, 15
    s_mul_i32 s98, s97, 393216
    s_add_u32 s82, s98, s85
    s_add_u32 m0, s83, 98304
    s_nop 0
    buffer_load_dwordx4 v3, s[40:43], s82 offen lds
    s_mov_b32 s82, s19
    buffer_load_dwordx4 v[88:91], v248, s[48:51], s82 offen nt
    s_add_u32 s82, s19, 98304
    buffer_load_dwordx4 v[92:95], v248, s[48:51], s82 offen nt
    s_add_u32 s82, s19, 196608
    buffer_load_dwordx4 v[96:99], v248, s[48:51], s82 offen nt
    s_add_u32 s82, s19, 294912
    buffer_load_dwordx4 v[100:103], v248, s[48:51], s82 offen nt
    s_waitcnt vmcnt(12)
    s_barrier
    s_add_u32 s96, s84, 13
    s_and_b32 s97, s96, 15
    s_mul_i32 s98, s97, 393216
    s_add_u32 s99, s98, s85
    s_add_u32 s82, s99, 4294770688
    s_add_u32 m0, s83, 102400
    s_nop 0
    buffer_load_dwordx4 v3, s[40:43], s82 offen lds
    s_add_u32 s96, s84, 13
    s_and_b32 s97, s96, 15
    s_mul_i32 s98, s97, 393216
    s_add_u32 s82, s98, s85
    s_add_u32 m0, s83, 106496
    s_nop 0
    buffer_load_dwordx4 v3, s[40:43], s82 offen lds
    s_add_u32 s96, s84, 14
    s_and_b32 s97, s96, 15
    s_mul_i32 s98, s97, 393216
    s_add_u32 s99, s98, s85
    s_add_u32 s82, s99, 4294770688
    s_add_u32 m0, s83, 110592
    s_nop 0
    buffer_load_dwordx4 v3, s[40:43], s82 offen lds
    s_add_u32 s96, s84, 14
    s_and_b32 s97, s96, 15
    s_mul_i32 s98, s97, 393216
    s_add_u32 s82, s98, s85
    s_add_u32 m0, s83, 114688
    s_nop 0
    buffer_load_dwordx4 v3, s[40:43], s82 offen lds
    s_add_u32 s96, s84, 15
    s_and_b32 s97, s96, 15
    s_mul_i32 s98, s97, 393216
    s_add_u32 s99, s98, s85
    s_add_u32 s82, s99, 4294770688
    s_add_u32 m0, s83, 118784
    s_nop 0
    buffer_load_dwordx4 v3, s[40:43], s82 offen lds
    s_add_u32 s96, s84, 15
    s_and_b32 s97, s96, 15
    s_mul_i32 s98, s97, 393216
    s_add_u32 s82, s98, s85
    s_add_u32 m0, s83, 122880
    s_nop 0
    buffer_load_dwordx4 v3, s[40:43], s82 offen lds
    s_waitcnt lgkmcnt(0)
    s_barrier
    s_setprio 3
    ds_read_b128 v[152:155], v0
    ds_read_b128 v[156:159], v0 offset:1024
    v_subrev_u32 v0, 118784, v0
    s_waitcnt lgkmcnt(1)
    v_mfma_f32_32x32x16_bf16 v[184:199], v[168:171], v[152:155], 0
    s_waitcnt lgkmcnt(0)
    v_mfma_f32_32x32x16_bf16 v[184:199], v[172:175], v[156:159], v[184:199]
    s_setprio 0
    s_nop 10
    v_cvt_pk_bf16_f32 v184, 0, v184
    v_cvt_pk_bf16_f32 v185, 0, v185
    v_cvt_pk_bf16_f32 v186, 0, v186
    s_add_u32 s82, s19, 393216
    buffer_load_dwordx4 v[104:107], v248, s[48:51], s82 offen nt
    v_cvt_pk_bf16_f32 v187, 0, v187
    v_cvt_pk_bf16_f32 v188, 0, v188
    v_cvt_pk_bf16_f32 v189, 0, v189
    v_cvt_pk_bf16_f32 v190, 0, v190
    v_cvt_pk_bf16_f32 v191, 0, v191
    v_cvt_pk_bf16_f32 v192, 0, v192
    v_cvt_pk_bf16_f32 v193, 0, v193
    v_cvt_pk_bf16_f32 v194, 0, v194
    v_cvt_pk_bf16_f32 v195, 0, v195
    v_cvt_pk_bf16_f32 v196, 0, v196
    s_add_u32 s82, s19, 491520
    buffer_load_dwordx4 v[108:111], v248, s[48:51], s82 offen nt
    v_cvt_pk_bf16_f32 v197, 0, v197
    v_cvt_pk_bf16_f32 v198, 0, v198
    v_cvt_pk_bf16_f32 v199, 0, v199
    v_max3_f32 v4, v184, v185, v186
    v_min3_f32 v5, v184, v185, v186
    v_max3_f32 v4, v4, v187, v188
    v_min3_f32 v5, v5, v187, v188
    v_max3_f32 v4, v4, v189, v190
    v_min3_f32 v5, v5, v189, v190
    v_max3_f32 v4, v4, v191, v192
    s_add_u32 s82, s19, 589824
    buffer_load_dwordx4 v[112:115], v248, s[48:51], s82 offen nt
    v_min3_f32 v5, v5, v191, v192
    v_max3_f32 v4, v4, v193, v194
    v_min3_f32 v5, v5, v193, v194
    v_max3_f32 v4, v4, v195, v196
    v_min3_f32 v5, v5, v195, v196
    v_max3_f32 v4, v4, v197, v198
    v_min3_f32 v5, v5, v197, v198
    v_max_f32 v6, v4, v199
    v_min_f32 v7, v5, v199
    v_max_f32 v4, v4, v199
    s_add_u32 s82, s19, 688128
    buffer_load_dwordx4 v[116:119], v248, s[48:51], s82 offen nt
    v_min_f32 v5, v5, v199
    v_permlane32_swap_b32 v4, v6
    s_nop 0
    v_permlane32_swap_b32 v5, v7
    v_max_f32 v4, v4, v6
    v_min_f32 v5, v5, v7
    v_mul_f32_e64 v4, v4, s7
    v_mul_f32_e64 v5, v5, s7
    v_fma_f32 v216, v184, s7, -v4
    v_fma_f32 v217, v185, s7, -v4
    v_fma_f32 v184, -v184, s7, v5
    v_fma_f32 v185, -v185, s7, v5
    v_fma_f32 v218, v186, s7, -v4
    v_fma_f32 v219, v187, s7, -v4
    v_fma_f32 v186, -v186, s7, v5
    v_fma_f32 v187, -v187, s7, v5
    s_waitcnt vmcnt(18)
    s_waitcnt vmcnt(16)
    s_barrier
    s_setprio 3
    ds_read_b128 v[152:155], v0
    ds_read_b128 v[156:159], v0 offset:1024
    s_waitcnt lgkmcnt(1)
    v_mfma_f32_32x32x16_bf16 v[200:215], v[176:179], v[152:155], 0
    s_waitcnt lgkmcnt(0)
    v_mfma_f32_32x32x16_bf16 v[200:215], v[180:183], v[156:159], v[200:215]
    s_setprio 0
    v_fma_f32 v220, v188, s7, -v4
    v_fma_f32 v221, v189, s7, -v4
    v_fma_f32 v188, -v188, s7, v5
    v_fma_f32 v189, -v189, s7, v5
    v_fma_f32 v222, v190, s7, -v4
    s_mov_b32 s82, s80
    buffer_load_dwordx4 v[56:59], v27, s[52:55], s82 offen nt
    v_fma_f32 v223, v191, s7, -v4
    v_fma_f32 v190, -v190, s7, v5
    v_fma_f32 v191, -v191, s7, v5
    v_fma_f32 v224, v192, s7, -v4
    v_fma_f32 v225, v193, s7, -v4
    s_setprio 3
    v_fma_f32 v192, -v192, s7, v5
    v_fma_f32 v193, -v193, s7, v5
    v_fma_f32 v226, v194, s7, -v4
    v_fma_f32 v227, v195, s7, -v4
    v_fma_f32 v194, -v194, s7, v5
    v_fma_f32 v195, -v195, s7, v5
    v_fma_f32 v228, v196, s7, -v4
    v_fma_f32 v229, v197, s7, -v4
    v_fma_f32 v196, -v196, s7, v5
    v_fma_f32 v197, -v197, s7, v5
    v_fma_f32 v230, v198, s7, -v4
    v_fma_f32 v231, v199, s7, -v4
    v_fma_f32 v198, -v198, s7, v5
    v_fma_f32 v199, -v199, s7, v5
    v_exp_f32 v216, v216
    s_add_u32 s82, s80, 4294049792
    buffer_load_dwordx4 v[60:63], v27, s[52:55], s82 offen nt
    v_exp_f32 v184, v184
    v_exp_f32 v217, v217
    v_exp_f32 v185, v185
    v_exp_f32 v218, v218
    v_exp_f32 v186, v186
    v_exp_f32 v219, v219
    v_exp_f32 v187, v187
    v_exp_f32 v220, v220
    v_exp_f32 v188, v188
    v_exp_f32 v221, v221
    v_exp_f32 v189, v189
    v_exp_f32 v222, v222
    v_exp_f32 v190, v190
    v_exp_f32 v223, v223
    v_exp_f32 v191, v191
    v_exp_f32 v224, v224
    v_exp_f32 v192, v192
    v_exp_f32 v225, v225
    v_exp_f32 v193, v193
    v_exp_f32 v226, v226
    s_add_u32 s82, s80, 57344
    buffer_load_dwordx4 v[64:67], v27, s[52:55], s82 offen nt
    v_exp_f32 v194, v194
    v_exp_f32 v227, v227
    v_exp_f32 v195, v195
    v_exp_f32 v228, v228
    v_exp_f32 v196, v196
    v_exp_f32 v229, v229
    v_exp_f32 v197, v197
    v_exp_f32 v230, v230
    v_exp_f32 v198, v198
    v_exp_f32 v231, v231
    v_exp_f32 v199, v199
    v_add_f32 v8, v216, v218
    v_add_f32 v9, v217, v219
    v_add_f32 v10, v184, v186
    v_add_f32 v11, v185, v187
    v_add_f32 v8, v8, v220
    v_add_f32 v9, v9, v221
    v_add_f32 v10, v10, v188
    v_add_f32 v11, v11, v189
    v_add_f32 v8, v8, v222
    s_add_u32 s82, s80, 4294107136
    buffer_load_dwordx4 v[68:71], v27, s[52:55], s82 offen nt
    v_add_f32 v9, v9, v223
    v_add_f32 v10, v10, v190
    v_add_f32 v11, v11, v191
    v_add_f32 v8, v8, v224
    v_add_f32 v9, v9, v225
    v_add_f32 v10, v10, v192
    v_add_f32 v11, v11, v193
    v_add_f32 v8, v8, v226
    v_add_f32 v9, v9, v227
    v_add_f32 v10, v10, v194
    v_add_f32 v11, v11, v195
    v_add_f32 v8, v8, v228
    v_add_f32 v9, v9, v229
    v_add_f32 v10, v10, v196
    v_add_f32 v11, v11, v197
    v_add_f32 v8, v8, v230
    v_add_f32 v9, v9, v231
    v_add_f32 v10, v10, v198
    v_add_f32 v11, v11, v199
    v_add_f32 v6, v8, v9
    v_add_f32 v7, v10, v11
    v_add_f32 v4, v8, v9
    s_setprio 0
    v_add_f32 v5, v10, v11
    v_permlane32_swap_b32 v4, v6
    s_nop 0
    v_permlane32_swap_b32 v5, v7
    v_add_f32 v4, v4, v6
    v_add_f32 v5, v5, v7
    v_rcp_f32 v4, v4
    v_rcp_f32 v5, v5
    v_mul_f32 v216, v216, v4
    v_mul_f32 v217, v217, v4
    v_mul_f32 v184, v184, v5
    v_mul_f32 v185, v185, v5
    v_mul_f32 v218, v218, v4
    v_mul_f32 v219, v219, v4
    v_mul_f32 v186, v186, v5
    v_mul_f32 v187, v187, v5
    v_mul_f32 v220, v220, v4
    v_mul_f32 v221, v221, v4
    v_mul_f32 v188, v188, v5
    v_mul_f32 v189, v189, v5
    v_mul_f32 v222, v222, v4
    v_mul_f32 v223, v223, v4
    v_mul_f32 v190, v190, v5
    v_mul_f32 v191, v191, v5
    v_mul_f32 v224, v224, v4
    v_mul_f32 v225, v225, v4
    v_mul_f32 v192, v192, v5
    v_mul_f32 v193, v193, v5
    v_mul_f32 v226, v226, v4
    v_mul_f32 v227, v227, v4
    v_mul_f32 v194, v194, v5
    v_mul_f32 v195, v195, v5
    v_mul_f32 v228, v228, v4
    v_mul_f32 v229, v229, v4
    v_mul_f32 v196, v196, v5
    v_mul_f32 v197, v197, v5
    v_mul_f32 v230, v230, v4
    v_mul_f32 v231, v231, v4
    v_mul_f32 v198, v198, v5
    v_mul_f32 v199, v199, v5
    v_cvt_pk_bf16_f32 v216, v216, v217
    v_cvt_pk_bf16_f32 v217, v218, v219
    v_cvt_pk_bf16_f32 v218, v220, v221
    v_cvt_pk_bf16_f32 v219, v222, v223
    v_cvt_pk_bf16_f32 v220, v224, v225
    v_cvt_pk_bf16_f32 v221, v226, v227
    v_cvt_pk_bf16_f32 v222, v228, v229
    v_cvt_pk_bf16_f32 v223, v230, v231
    ds_write_b128 v232, v[216:219]
    v_cvt_pk_bf16_f32 v224, v184, v185
    v_cvt_pk_bf16_f32 v225, v186, v187
    v_cvt_pk_bf16_f32 v226, v188, v189
    v_cvt_pk_bf16_f32 v227, v190, v191
    ds_write_b128 v232, v[220:223] offset:4096
    s_waitcnt vmcnt(18)
    s_waitcnt vmcnt(12)
    s_waitcnt vmcnt(10)
    s_waitcnt vmcnt(8)
    s_barrier
    ds_write_b128 v232, v[224:227] offset:8192
    v_cvt_pk_bf16_f32 v228, v192, v193
    v_cvt_pk_bf16_f32 v229, v194, v195
    v_cvt_pk_bf16_f32 v230, v196, v197
    v_cvt_pk_bf16_f32 v231, v198, v199
    s_xor_b32 s96, s95, 786432
    s_add_u32 s97, s96, s90
    s_sub_u32 s82, s97, 65536
    s_add_u32 m0, s83, 45056
    s_nop 0
    buffer_load_dwordx4 v26, s[44:47], s82 offen lds
    ds_write_b128 v232, v[228:231] offset:12288
    v_cvt_pk_bf16_f32 v200, 0, v200
    v_cvt_pk_bf16_f32 v201, 0, v201
    v_cvt_pk_bf16_f32 v202, 0, v202
    v_cvt_pk_bf16_f32 v203, 0, v203
    v_cvt_pk_bf16_f32 v204, 0, v204
    v_cvt_pk_bf16_f32 v205, 0, v205
    v_cvt_pk_bf16_f32 v206, 0, v206
    v_cvt_pk_bf16_f32 v207, 0, v207
    v_cvt_pk_bf16_f32 v208, 0, v208
    v_cvt_pk_bf16_f32 v209, 0, v209
    v_cvt_pk_bf16_f32 v210, 0, v210
    v_cvt_pk_bf16_f32 v211, 0, v211
    s_xor_b32 s96, s95, 786432
    s_add_u32 s82, s96, s90
    s_add_u32 m0, s83, 49152
    s_nop 0
    buffer_load_dwordx4 v26, s[44:47], s82 offen lds
    v_cvt_pk_bf16_f32 v212, 0, v212
    v_cvt_pk_bf16_f32 v213, 0, v213
    v_cvt_pk_bf16_f32 v214, 0, v214
    v_cvt_pk_bf16_f32 v215, 0, v215
    v_max3_f32 v4, v200, v201, v202
    v_min3_f32 v5, v200, v201, v202
    v_max3_f32 v4, v4, v203, v204
    v_min3_f32 v5, v5, v203, v204
    v_max3_f32 v4, v4, v205, v206
    v_min3_f32 v5, v5, v205, v206
    v_max3_f32 v4, v4, v207, v208
    v_min3_f32 v5, v5, v207, v208
    v_max3_f32 v4, v4, v209, v210
    v_min3_f32 v5, v5, v209, v210
    s_xor_b32 s96, s95, 917504
    s_add_u32 s97, s96, s90
    s_sub_u32 s82, s97, 65536
    s_add_u32 m0, s83, 53248
    s_nop 0
    buffer_load_dwordx4 v26, s[44:47], s82 offen lds
    v_max3_f32 v4, v4, v211, v212
    v_min3_f32 v5, v5, v211, v212
    v_max3_f32 v4, v4, v213, v214
    v_min3_f32 v5, v5, v213, v214
    v_max_f32 v6, v4, v215
    v_min_f32 v7, v5, v215
    v_max_f32 v4, v4, v215
    s_waitcnt lgkmcnt(0)
    v_min_f32 v5, v5, v215
    v_permlane32_swap_b32 v4, v6
    s_nop 0
    v_permlane32_swap_b32 v5, v7
    v_max_f32 v4, v4, v6
    v_min_f32 v5, v5, v7
    v_mul_f32_e64 v4, v4, s7
    s_xor_b32 s96, s95, 917504
    s_add_u32 s82, s96, s90
    s_add_u32 m0, s83, 57344
    s_nop 0
    buffer_load_dwordx4 v26, s[44:47], s82 offen lds
    v_mul_f32_e64 v5, v5, s7
    v_fma_f32 v216, v200, s7, -v4
    v_fma_f32 v217, v201, s7, -v4
    v_fma_f32 v200, -v200, s7, v5
    v_fma_f32 v201, -v201, s7, v5
    v_fma_f32 v218, v202, s7, -v4
    v_fma_f32 v219, v203, s7, -v4
    v_fma_f32 v202, -v202, s7, v5
    v_fma_f32 v203, -v203, s7, v5
    v_fma_f32 v220, v204, s7, -v4
    v_fma_f32 v221, v205, s7, -v4
    v_fma_f32 v204, -v204, s7, v5
    v_fma_f32 v205, -v205, s7, v5
    v_fma_f32 v222, v206, s7, -v4
    s_xor_b32 s96, s95, 1048576
    s_add_u32 s97, s96, s90
    s_sub_u32 s82, s97, 65536
    s_add_u32 m0, s83, 61440
    s_nop 0
    buffer_load_dwordx4 v26, s[44:47], s82 offen lds
    v_fma_f32 v223, v207, s7, -v4
    v_fma_f32 v206, -v206, s7, v5
    v_fma_f32 v207, -v207, s7, v5
    v_fma_f32 v224, v208, s7, -v4
    v_fma_f32 v225, v209, s7, -v4
    v_fma_f32 v208, -v208, s7, v5
    v_fma_f32 v209, -v209, s7, v5
    v_fma_f32 v226, v210, s7, -v4
    v_fma_f32 v227, v211, s7, -v4
    v_fma_f32 v210, -v210, s7, v5
    v_fma_f32 v211, -v211, s7, v5
    v_fma_f32 v228, v212, s7, -v4
    v_fma_f32 v229, v213, s7, -v4
    v_fma_f32 v212, -v212, s7, v5
    s_xor_b32 s96, s95, 1048576
    s_add_u32 s82, s96, s90
    s_add_u32 m0, s83, 65536
    s_nop 0
    buffer_load_dwordx4 v26, s[44:47], s82 offen lds
    v_fma_f32 v213, -v213, s7, v5
    v_fma_f32 v230, v214, s7, -v4
    v_fma_f32 v231, v215, s7, -v4
    v_fma_f32 v214, -v214, s7, v5
    v_fma_f32 v215, -v215, s7, v5
    v_exp_f32 v216, v216
    v_exp_f32 v200, v200
    v_exp_f32 v217, v217
    v_exp_f32 v201, v201
    v_exp_f32 v218, v218
    v_exp_f32 v202, v202
    v_exp_f32 v219, v219
    v_exp_f32 v203, v203
    v_exp_f32 v220, v220
    s_xor_b32 s96, s95, 1179648
    s_add_u32 s97, s96, s90
    s_sub_u32 s82, s97, 65536
    s_add_u32 m0, s83, 69632
    s_nop 0
    buffer_load_dwordx4 v26, s[44:47], s82 offen lds
    v_exp_f32 v204, v204
    v_exp_f32 v221, v221
    v_exp_f32 v205, v205
    v_exp_f32 v222, v222
    v_exp_f32 v206, v206
    v_exp_f32 v223, v223
    v_exp_f32 v207, v207
    v_exp_f32 v224, v224
    v_exp_f32 v208, v208
    v_exp_f32 v225, v225
    v_exp_f32 v209, v209
    v_exp_f32 v226, v226
    v_exp_f32 v210, v210
    v_exp_f32 v227, v227
    s_xor_b32 s96, s95, 1179648
    s_add_u32 s82, s96, s90
    s_add_u32 m0, s83, 73728
    s_nop 0
    buffer_load_dwordx4 v26, s[44:47], s82 offen lds
    v_exp_f32 v211, v211
    v_exp_f32 v228, v228
    v_exp_f32 v212, v212
    v_exp_f32 v229, v229
    v_exp_f32 v213, v213
    v_exp_f32 v230, v230
    v_exp_f32 v214, v214
    v_exp_f32 v231, v231
    v_exp_f32 v215, v215
    v_add_f32 v8, v216, v218
    v_add_f32 v9, v217, v219
    v_add_f32 v10, v200, v202
    v_add_f32 v11, v201, v203
    v_add_f32 v8, v8, v220
    v_add_f32 v9, v9, v221
    v_add_f32 v10, v10, v204
    v_add_f32 v11, v11, v205
    v_add_f32 v8, v8, v222
L_PAD6:
    s_cbranch_execz L_RET6
    v_add_f32 v9, v9, v223
    v_add_f32 v10, v10, v206
    v_add_f32 v11, v11, v207
    v_add_f32 v8, v8, v224
    v_add_f32 v9, v9, v225
    v_add_f32 v10, v10, v208
    v_add_f32 v11, v11, v209
    v_add_f32 v8, v8, v226
    v_add_f32 v9, v9, v227
    v_add_f32 v10, v10, v210
    v_add_f32 v11, v11, v211
    v_add_f32 v8, v8, v228
    v_add_f32 v9, v9, v229
    v_add_f32 v10, v10, v212
    v_add_f32 v11, v11, v213
    v_add_f32 v8, v8, v230
    v_add_f32 v9, v9, v231
    v_add_f32 v10, v10, v214
    v_add_f32 v11, v11, v215
    v_add_f32 v6, v8, v9
    v_add_f32 v7, v10, v11
    v_add_f32 v4, v8, v9
    v_add_f32 v5, v10, v11
    s_nop 0
    v_permlane32_swap_b32 v4, v6
    v_permlane32_swap_b32 v5, v7
    v_add_f32 v4, v4, v6
    v_add_f32 v5, v5, v7
    v_rcp_f32 v4, v4
    v_rcp_f32 v5, v5
    v_mul_f32 v216, v216, v4
    v_mul_f32 v217, v217, v4
    v_mul_f32 v200, v200, v5
    v_mul_f32 v201, v201, v5
    v_mul_f32 v218, v218, v4
    v_mul_f32 v219, v219, v4
    v_mul_f32 v202, v202, v5
    v_mul_f32 v203, v203, v5
    v_mul_f32 v220, v220, v4
    v_mul_f32 v221, v221, v4
    v_mul_f32 v204, v204, v5
    v_mul_f32 v205, v205, v5
    v_mul_f32 v222, v222, v4
    v_mul_f32 v223, v223, v4
    v_mul_f32 v206, v206, v5
    v_mul_f32 v207, v207, v5
    v_mul_f32 v224, v224, v4
    v_mul_f32 v225, v225, v4
    v_mul_f32 v208, v208, v5
    v_mul_f32 v209, v209, v5
    v_mul_f32 v226, v226, v4
    v_mul_f32 v227, v227, v4
    v_mul_f32 v210, v210, v5
    v_mul_f32 v211, v211, v5
    v_mul_f32 v228, v228, v4
    v_mul_f32 v229, v229, v4
    v_mul_f32 v212, v212, v5
    v_mul_f32 v213, v213, v5
    v_mul_f32 v230, v230, v4
    v_mul_f32 v231, v231, v4
    v_mul_f32 v214, v214, v5
    v_mul_f32 v215, v215, v5
    v_cvt_pk_bf16_f32 v216, v216, v217
    v_cvt_pk_bf16_f32 v217, v218, v219
    v_cvt_pk_bf16_f32 v218, v220, v221
    v_cvt_pk_bf16_f32 v219, v222, v223
    v_cvt_pk_bf16_f32 v220, v224, v225
    v_cvt_pk_bf16_f32 v221, v226, v227
    v_cvt_pk_bf16_f32 v222, v228, v229
    v_cvt_pk_bf16_f32 v223, v230, v231
    ds_write_b128 v232, v[216:219] offset:16384
    v_cvt_pk_bf16_f32 v224, v200, v201
    v_cvt_pk_bf16_f32 v225, v202, v203
    v_cvt_pk_bf16_f32 v226, v204, v205
    v_cvt_pk_bf16_f32 v227, v206, v207
    ds_write_b128 v232, v[220:223] offset:20480
    ds_write_b128 v232, v[224:227] offset:24576
    v_cvt_pk_bf16_f32 v228, v208, v209
    v_cvt_pk_bf16_f32 v229, v210, v211
    v_cvt_pk_bf16_f32 v230, v212, v213
    v_cvt_pk_bf16_f32 v231, v214, v215
    ds_write_b128 v232, v[228:231] offset:28672
    s_lshl_b32 s96, s77, 11
    s_add_u32 s14, s96, 151552
    v_add_u32 v0, s14, v2
    s_setprio 0
L_JOIN:
    v_and_b32 v45, 1, v1
    v_lshlrev_b32 v45, 3, v45
    v_bfe_u32 v9, v1, 2, 2
    v_lshl_add_u32 v45, v9, 4, v45
    v_bfe_u32 v9, v1, 4, 1
    v_lshl_add_u32 v45, v9, 6, v45
    v_bfe_u32 v9, v1, 1, 1
    v_lshl_add_u32 v45, v9, 7, v45
    v_lshrrev_b32 v9, 5, v1
    v_lshl_add_u32 v45, v9, 8, v45
    s_lshl_b32 s13, s3, 12
    v_add_u32 v44, s13, v45
    s_lshl_b32 s96, s76, 13
    s_add_u32 s13, s96, 32768
    v_add_u32 v45, s13, v45
    v_mov_b32 v244, 0x3f803f80
    v_mov_b32 v245, 0x3f803f80
    v_mov_b32 v246, 0x3f803f80
    v_mov_b32 v247, 0x3f803f80
    s_lshl3_add_u32 s96, s11, s3
    s_lshl_b32 s97, s96, 5
    s_add_u32 s98, s97, s10
    s_lshl_b32 s99, s98, 10
    s_add_u32 s13, s99, 25165824
    s_add_u32 s15, s13, 16384
    s_lshl3_add_u32 s96, s11, s3
    s_lshl_b32 s97, s96, 10
    s_add_u32 s16, s97, 21495808
    s_lshl_b32 s96, s10, 6
    s_add_u32 s14, s96, s16
    s_waitcnt lgkmcnt(0)
    s_barrier
    ds_read_b64_tr_b16 v[184:185], v44
    ds_read_b64_tr_b16 v[186:187], v44 offset:512
    ds_read_b64_tr_b16 v[200:201], v45
    ds_read_b64_tr_b16 v[202:203], v45 offset:512
    ds_read_b64_tr_b16 v[204:205], v45 offset:1024
    ds_read_b64_tr_b16 v[206:207], v45 offset:1536
    ds_read_b64_tr_b16 v[188:189], v44 offset:1024
    ds_read_b64_tr_b16 v[190:191], v44 offset:1536
    ds_read_b64_tr_b16 v[208:209], v45 offset:2048
    ds_read_b64_tr_b16 v[210:211], v45 offset:2560
    ds_read_b64_tr_b16 v[212:213], v45 offset:3072
    ds_read_b64_tr_b16 v[214:215], v45 offset:3584
    ds_read_b64_tr_b16 v[192:193], v44 offset:2048
    ds_read_b64_tr_b16 v[194:195], v44 offset:2560
    ds_read_b64_tr_b16 v[216:217], v45 offset:4096
    ds_read_b64_tr_b16 v[218:219], v45 offset:4608
    ds_read_b64_tr_b16 v[220:221], v45 offset:5120
    ds_read_b64_tr_b16 v[222:223], v45 offset:5632
    s_waitcnt lgkmcnt(12)
    v_mfma_f32_16x16x32_bf16 v[232:235], v[184:187], v[200:203], 0
    v_mfma_f32_16x16x32_bf16 v[236:239], v[184:187], v[204:207], 0
    v_mfma_f32_16x16x32_bf16 v[240:243], v[184:187], v[244:247], 0
    ds_read_b64_tr_b16 v[196:197], v44 offset:3072
    ds_read_b64_tr_b16 v[198:199], v44 offset:3584
    ds_read_b64_tr_b16 v[224:225], v45 offset:6144
    ds_read_b64_tr_b16 v[226:227], v45 offset:6656
    ds_read_b64_tr_b16 v[228:229], v45 offset:7168
    ds_read_b64_tr_b16 v[230:231], v45 offset:7680
    s_waitcnt lgkmcnt(12)
    v_mfma_f32_16x16x32_bf16 v[232:235], v[188:191], v[208:211], v[232:235]
    v_mfma_f32_16x16x32_bf16 v[236:239], v[188:191], v[212:215], v[236:239]
    v_mfma_f32_16x16x32_bf16 v[240:243], v[188:191], v[244:247], v[240:243]
    s_waitcnt lgkmcnt(6)
    v_mfma_f32_16x16x32_bf16 v[232:235], v[192:195], v[216:219], v[232:235]
    v_mfma_f32_16x16x32_bf16 v[236:239], v[192:195], v[220:223], v[236:239]
    v_mfma_f32_16x16x32_bf16 v[240:243], v[192:195], v[244:247], v[240:243]
    s_waitcnt lgkmcnt(0)
    v_mfma_f32_16x16x32_bf16 v[232:235], v[196:199], v[224:227], v[232:235]
    v_mfma_f32_16x16x32_bf16 v[236:239], v[196:199], v[228:231], v[236:239]
    v_mfma_f32_16x16x32_bf16 v[240:243], v[196:199], v[244:247], v[240:243]
    s_cmp_lt_u32 s3, 4
    s_cbranch_scc1 L_NOQX
    ds_read_b128 v[168:171], v0
    ds_read_b128 v[172:175], v0 offset:1024
L_NOQX:
    s_nop 3
    buffer_store_dwordx4 v[232:235], v2, s[32:35], s13 offen sc1
    buffer_store_dwordx4 v[236:239], v2, s[32:35], s15 offen sc1
    s_mov_b32 exec_lo, 0x00010001
    s_mov_b32 exec_hi, 0x00010001
    buffer_store_dwordx4 v[240:243], v1, s[32:35], s14 offen sc1
    s_mov_b64 exec, -1
    s_waitcnt lgkmcnt(0)
    v_mfma_f32_32x32x16_bf16 v[120:135], v[176:179], v[168:171], 0
    v_mfma_f32_32x32x16_bf16 v[120:135], v[180:183], v[172:175], v[120:135]
    v_and_b32 v46, 7, v1
    v_lshlrev_b32 v46, 17, v46
    v_bfe_u32 v9, v1, 3, 1
    v_lshl_add_u32 v46, v9, 14, v46
    s_and_b32 s96, s10, 1
    s_and_b32 s97, s2, 27
    s_lshl_b32 s98, s97, 12
    s_lshr_b32 s99, s10, 1
    s_lshl_b32 s97, s99, 6
    s_add_u32 s99, s98, s97
    s_lshl2_add_u32 s98, s96, s99
    s_add_u32 s97, s98, 1048576
    s_add_u32 s17, s97, 512
    v_lshrrev_b32 v47, 3, v1
    v_lshlrev_b32 v47, 10, v47
    v_and_b32 v9, 7, v1
    v_lshl_add_u32 v47, v9, 4, v47
    v_and_b32 v48, 7, v1
    v_lshlrev_b32 v48, 4, v48
    v_lshrrev_b32 v9, 5, v1
    v_lshl_add_u32 v48, v9, 3, v48
    v_cvt_pk_bf16_f32 v120, 0, v120
    v_cvt_pk_bf16_f32 v121, 0, v121
    v_cvt_pk_bf16_f32 v122, 0, v122
    v_cvt_pk_bf16_f32 v123, 0, v123
    v_cvt_pk_bf16_f32 v124, 0, v124
    v_cvt_pk_bf16_f32 v125, 0, v125
    v_cvt_pk_bf16_f32 v126, 0, v126
    v_cvt_pk_bf16_f32 v127, 0, v127
    v_cvt_pk_bf16_f32 v128, 0, v128
    v_cvt_pk_bf16_f32 v129, 0, v129
    v_cvt_pk_bf16_f32 v130, 0, v130
    v_cvt_pk_bf16_f32 v131, 0, v131
    v_cvt_pk_bf16_f32 v132, 0, v132
    v_cvt_pk_bf16_f32 v133, 0, v133
    v_cvt_pk_bf16_f32 v134, 0, v134
    v_cvt_pk_bf16_f32 v135, 0, v135
    v_max3_f32 v4, v120, v121, v122
    v_min3_f32 v5, v120, v121, v122
    v_max3_f32 v4, v4, v123, v124
    v_min3_f32 v5, v5, v123, v124
    v_max3_f32 v4, v4, v125, v126
    v_min3_f32 v5, v5, v125, v126
    v_max3_f32 v4, v4, v127, v128
    v_min3_f32 v5, v5, v127, v128
    v_max3_f32 v4, v4, v129, v130
    v_min3_f32 v5, v5, v129, v130
    v_max3_f32 v4, v4, v131, v132
    v_min3_f32 v5, v5, v131, v132
    v_max3_f32 v4, v4, v133, v134
    v_min3_f32 v5, v5, v133, v134
    v_max_f32 v6, v4, v135
    v_min_f32 v7, v5, v135
    v_max_f32 v4, v4, v135
    v_min_f32 v5, v5, v135
    s_nop 0
    v_permlane32_swap_b32 v4, v6
    v_permlane32_swap_b32 v5, v7
    v_max_f32 v4, v4, v6
    v_min_f32 v5, v5, v7
    v_pk_mul_f32 v[4:5], v[4:5], s[6:7] op_sel:[0,1]
    v_mov_b32 v6, v5
    v_pk_fma_f32 v[136:137], v[120:121], s[6:7], v[4:5] op_sel:[0,1,0] op_sel_hi:[1,1,0] neg_lo:[0,0,1] neg_hi:[0,0,1]
    v_pk_fma_f32 v[120:121], v[120:121], s[6:7], v[6:7] op_sel:[0,1,0] op_sel_hi:[1,1,0] neg_lo:[1,0,0] neg_hi:[1,0,0]
    v_pk_fma_f32 v[138:139], v[122:123], s[6:7], v[4:5] op_sel:[0,1,0] op_sel_hi:[1,1,0] neg_lo:[0,0,1] neg_hi:[0,0,1]
    v_pk_fma_f32 v[122:123], v[122:123], s[6:7], v[6:7] op_sel:[0,1,0] op_sel_hi:[1,1,0] neg_lo:[1,0,0] neg_hi:[1,0,0]
    v_pk_fma_f32 v[140:141], v[124:125], s[6:7], v[4:5] op_sel:[0,1,0] op_sel_hi:[1,1,0] neg_lo:[0,0,1] neg_hi:[0,0,1]
    v_pk_fma_f32 v[124:125], v[124:125], s[6:7], v[6:7] op_sel:[0,1,0] op_sel_hi:[1,1,0] neg_lo:[1,0,0] neg_hi:[1,0,0]
    v_pk_fma_f32 v[142:143], v[126:127], s[6:7], v[4:5] op_sel:[0,1,0] op_sel_hi:[1,1,0] neg_lo:[0,0,1] neg_hi:[0,0,1]
    v_pk_fma_f32 v[126:127], v[126:127], s[6:7], v[6:7] op_sel:[0,1,0] op_sel_hi:[1,1,0] neg_lo:[1,0,0] neg_hi:[1,0,0]
    v_pk_fma_f32 v[144:145], v[128:129], s[6:7], v[4:5] op_sel:[0,1,0] op_sel_hi:[1,1,0] neg_lo:[0,0,1] neg_hi:[0,0,1]
    v_pk_fma_f32 v[128:129], v[128:129], s[6:7], v[6:7] op_sel:[0,1,0] op_sel_hi:[1,1,0] neg_lo:[1,0,0] neg_hi:[1,0,0]
    v_pk_fma_f32 v[146:147], v[130:131], s[6:7], v[4:5] op_sel:[0,1,0] op_sel_hi:[1,1,0] neg_lo:[0,0,1] neg_hi:[0,0,1]
    v_pk_fma_f32 v[130:131], v[130:131], s[6:7], v[6:7] op_sel:[0,1,0] op_sel_hi:[1,1,0] neg_lo:[1,0,0] neg_hi:[1,0,0]
    v_pk_fma_f32 v[148:149], v[132:133], s[6:7], v[4:5] op_sel:[0,1,0] op_sel_hi:[1,1,0] neg_lo:[0,0,1] neg_hi:[0,0,1]
    v_pk_fma_f32 v[132:133], v[132:133], s[6:7], v[6:7] op_sel:[0,1,0] op_sel_hi:[1,1,0] neg_lo:[1,0,0] neg_hi:[1,0,0]
    v_pk_fma_f32 v[150:151], v[134:135], s[6:7], v[4:5] op_sel:[0,1,0] op_sel_hi:[1,1,0] neg_lo:[0,0,1] neg_hi:[0,0,1]
    v_pk_fma_f32 v[134:135], v[134:135], s[6:7], v[6:7] op_sel:[0,1,0] op_sel_hi:[1,1,0] neg_lo:[1,0,0] neg_hi:[1,0,0]
    v_exp_f32 v136, v136
    v_exp_f32 v120, v120
    v_exp_f32 v137, v137
    v_exp_f32 v121, v121
    v_exp_f32 v138, v138
    v_exp_f32 v122, v122
    v_exp_f32 v139, v139
    v_exp_f32 v123, v123
    v_exp_f32 v140, v140
    v_exp_f32 v124, v124
    v_exp_f32 v141, v141
    v_exp_f32 v125, v125
    v_exp_f32 v142, v142
    v_exp_f32 v126, v126
    v_exp_f32 v143, v143
    v_exp_f32 v127, v127
    s_waitcnt vmcnt(0)
    s_barrier
    s_cmp_lg_u32 s3, 0
    s_cbranch_scc1 L_PC
    v_mov_b32 v45, s4
    s_mov_b32 exec_hi, 0
    s_mov_b32 exec_lo, 65535
    buffer_store_dword v45, v46, s[32:35], s17 offen sc1
    s_mov_b64 exec, -1
L_PC:
    s_xor_b32 s96, s95, 1310720
    s_add_u32 s82, s96, s90
    s_add_u32 m0, s83, 81920
    s_nop 0
    buffer_load_dwordx4 v26, s[44:47], s82 offen lds
    v_exp_f32 v144, v144
    v_exp_f32 v128, v128
    v_exp_f32 v145, v145
    v_exp_f32 v129, v129
    s_xor_b32 s96, s95, 1441792
    s_add_u32 s82, s96, s90
    s_add_u32 m0, s83, 90112
    s_nop 0
    buffer_load_dwordx4 v26, s[44:47], s82 offen lds
    v_exp_f32 v146, v146
    v_exp_f32 v130, v130
    v_exp_f32 v147, v147
    v_exp_f32 v131, v131
    s_xor_b32 s96, s95, 1572864
    s_add_u32 s82, s96, s90
    s_add_u32 m0, s83, 98304
    s_nop 0
    buffer_load_dwordx4 v26, s[44:47], s82 offen lds
    v_exp_f32 v148, v148
    v_exp_f32 v132, v132
    v_exp_f32 v149, v149
    v_exp_f32 v133, v133
    s_xor_b32 s96, s95, 1703936
    s_add_u32 s82, s96, s90
    s_add_u32 m0, s83, 106496
    s_nop 0
    buffer_load_dwordx4 v26, s[44:47], s82 offen lds
    v_exp_f32 v150, v150
    v_exp_f32 v134, v134
    v_exp_f32 v151, v151
    v_exp_f32 v135, v135
    s_lshl4_add_u32 s96, s11, s10
    s_lshl_b32 s97, s96, 14
    s_lshl_b32 s98, s3, 7
    s_add_u32 s99, s97, s98
    s_add_u32 s13, s99, 25165824
    s_add_u32 s14, s13, 8192
    s_lshl4_add_u32 s96, s11, s10
    s_lshl_b32 s97, s96, 10
    s_lshl_b32 s98, s3, 7
    s_add_u32 s99, s97, s98
    s_add_u32 s15, s99, 29360128
    s_add_u32 s17, s17, 3072
    s_load_dwordx2 s[24:25], s[32:33], s92 offset:512 glc
    s_xor_b32 s96, s95, 1835008
    s_add_u32 s82, s96, s90
    s_add_u32 m0, s83, 114688
    s_nop 0
    buffer_load_dwordx4 v26, s[44:47], s82 offen lds
    v_pk_add_f32 v[8:9], v[136:137], v[138:139]
    v_pk_add_f32 v[10:11], v[120:121], v[122:123]
    v_pk_add_f32 v[8:9], v[8:9], v[140:141]
    v_pk_add_f32 v[10:11], v[10:11], v[124:125]
    v_pk_add_f32 v[8:9], v[8:9], v[142:143]
    v_pk_add_f32 v[10:11], v[10:11], v[126:127]
    v_pk_add_f32 v[8:9], v[8:9], v[144:145]
    v_pk_add_f32 v[10:11], v[10:11], v[128:129]
    v_pk_add_f32 v[8:9], v[8:9], v[146:147]
    v_pk_add_f32 v[10:11], v[10:11], v[130:131]
    v_pk_add_f32 v[8:9], v[8:9], v[148:149]
    v_pk_add_f32 v[10:11], v[10:11], v[132:133]
    v_pk_add_f32 v[8:9], v[8:9], v[150:151]
    v_pk_add_f32 v[10:11], v[10:11], v[134:135]
    s_xor_b32 s96, s95, 1966080
    s_add_u32 s82, s96, s90
    s_add_u32 m0, s83, 122880
    s_nop 0
    buffer_load_dwordx4 v26, s[44:47], s82 offen lds
    v_add_f32 v6, v8, v9
    v_add_f32 v7, v10, v11
    v_add_f32 v4, v8, v9
    v_add_f32 v5, v10, v11
    s_nop 0
    v_permlane32_swap_b32 v4, v6
    v_permlane32_swap_b32 v5, v7
    v_pk_add_f32 v[4:5], v[4:5], v[6:7]
    v_rcp_f32 v4, v4
    v_rcp_f32 v5, v5
    s_nop 0
    v_pk_mul_f32 v[136:137], v[136:137], v[4:5] op_sel_hi:[1,0]
    v_pk_mul_f32 v[120:121], v[4:5], v[120:121] op_sel:[1,0]
    v_pk_mul_f32 v[138:139], v[138:139], v[4:5] op_sel_hi:[1,0]
    v_pk_mul_f32 v[122:123], v[4:5], v[122:123] op_sel:[1,0]
    v_pk_mul_f32 v[140:141], v[140:141], v[4:5] op_sel_hi:[1,0]
    s_add_u32 s82, s95, s90
    s_mov_b32 m0, s83
    s_nop 0
    buffer_load_dwordx4 v26, s[44:47], s82 offen lds
    v_pk_mul_f32 v[124:125], v[4:5], v[124:125] op_sel:[1,0]
    v_pk_mul_f32 v[142:143], v[142:143], v[4:5] op_sel_hi:[1,0]
    v_pk_mul_f32 v[126:127], v[4:5], v[126:127] op_sel:[1,0]
    v_pk_mul_f32 v[144:145], v[144:145], v[4:5] op_sel_hi:[1,0]
    v_pk_mul_f32 v[128:129], v[4:5], v[128:129] op_sel:[1,0]
    v_pk_mul_f32 v[146:147], v[146:147], v[4:5] op_sel_hi:[1,0]
    v_pk_mul_f32 v[130:131], v[4:5], v[130:131] op_sel:[1,0]
    v_pk_mul_f32 v[148:149], v[148:149], v[4:5] op_sel_hi:[1,0]
    v_pk_mul_f32 v[132:133], v[4:5], v[132:133] op_sel:[1,0]
    v_pk_mul_f32 v[150:151], v[150:151], v[4:5] op_sel_hi:[1,0]
    v_pk_mul_f32 v[134:135], v[4:5], v[134:135] op_sel:[1,0]
    v_cvt_pk_bf16_f32 v152, v136, v137
    v_cvt_pk_bf16_f32 v153, v138, v139
    v_cvt_pk_bf16_f32 v154, v140, v141
    s_xor_b32 s96, s95, 131072
    s_add_u32 s82, s96, s90
    s_add_u32 m0, s83, 8192
    s_nop 0
    buffer_load_dwordx4 v26, s[44:47], s82 offen lds
    v_cvt_pk_bf16_f32 v155, v142, v143
    v_cvt_pk_bf16_f32 v156, v144, v145
    v_cvt_pk_bf16_f32 v157, v146, v147
    v_cvt_pk_bf16_f32 v158, v148, v149
    v_cvt_pk_bf16_f32 v159, v150, v151
    v_cvt_pk_bf16_f32 v160, v120, v121
    v_cvt_pk_bf16_f32 v161, v122, v123
    v_cvt_pk_bf16_f32 v162, v124, v125
    v_cvt_pk_bf16_f32 v163, v126, v127
    v_cvt_pk_bf16_f32 v164, v128, v129
    v_cvt_pk_bf16_f32 v165, v130, v131
    v_cvt_pk_bf16_f32 v166, v132, v133
    v_cvt_pk_bf16_f32 v167, v134, v135
    s_branch SCHK_17
SPOLL_16:
    s_load_dwordx2 s[24:25], s[32:33], s92 offset:512 glc
SCHK_17:
    s_add_u32 s5, s5, 1
    s_cmp_ge_u32 s5, 200000
    s_waitcnt lgkmcnt(0)
    s_cbranch_scc1 SDONE_18
    s_cmp_lg_u32 s24, s4
    s_cbranch_scc1 SPOLL_16
    s_cmp_lg_u32 s25, s4
    s_cbranch_scc1 SPOLL_16
SDONE_18:
    s_barrier
    buffer_load_dwordx4 v[184:187], v47, s[32:35], s13 offen sc1
    buffer_load_dwordx4 v[188:191], v47, s[32:35], s14 offen sc1
    buffer_load_dwordx4 v[192:195], v2, s[32:35], s16 offen sc1
    s_lshl_b32 s96, s3, 5
    s_add_u32 s14, s96, 155648
    v_and_b32 v6, 3, v1
    v_lshl_add_u32 v6, v6, 3, s14
    v_lshrrev_b32 v9, 5, v1
    v_lshl_add_u32 v6, v9, 2, v6
    s_lshl_b32 s96, s3, 10
    s_add_u32 s14, s96, 147456
    v_and_b32 v5, 15, v1
    v_lshl_add_u32 v5, v5, 4, s14
    v_lshrrev_b32 v9, 5, v1
    v_lshl_add_u32 v5, v9, 9, v5
    v_bfe_u32 v9, v1, 4, 1
    v_lshl_add_u32 v5, v9, 3, v5
    s_lshl_b32 s96, s76, 7
    s_add_u32 s14, s96, 155648
    v_lshrrev_b32 v7, 5, v1
    v_lshl_add_u32 v7, v7, 4, s14
    s_lshl_b32 s96, s76, 12
    s_add_u32 s14, s96, 147456
    v_add_u32 v44, s14, v2
    s_cmp_lt_u32 s3, 4
    s_cbranch_scc1 L_HG1
    v_lshlrev_b32 v52, 16, v88
    v_and_b32 v53, s6, v88
    v_pk_mul_f32 v[196:197], v[36:37], v[52:53] op_sel:[0,0] op_sel_hi:[0,1]
    v_lshlrev_b32 v54, 16, v89
    v_and_b32 v55, s6, v89
    v_pk_mul_f32 v[198:199], v[36:37], v[54:55] op_sel:[0,0] op_sel_hi:[0,1]
    v_lshlrev_b32 v52, 16, v90
    v_and_b32 v53, s6, v90
    v_pk_mul_f32 v[200:201], v[36:37], v[52:53] op_sel:[0,0] op_sel_hi:[0,1]
    v_lshlrev_b32 v54, 16, v91
    v_and_b32 v55, s6, v91
    v_pk_mul_f32 v[202:203], v[36:37], v[54:55] op_sel:[0,0] op_sel_hi:[0,1]
    v_lshlrev_b32 v52, 16, v92
    v_and_b32 v53, s6, v92
    v_pk_fma_f32 v[196:197], v[36:37], v[52:53], v[196:197] op_sel:[1,0,0] op_sel_hi:[1,1,1]
    v_lshlrev_b32 v54, 16, v93
    v_and_b32 v55, s6, v93
    v_pk_fma_f32 v[198:199], v[36:37], v[54:55], v[198:199] op_sel:[1,0,0] op_sel_hi:[1,1,1]
    v_lshlrev_b32 v52, 16, v94
    v_and_b32 v53, s6, v94
    v_pk_fma_f32 v[200:201], v[36:37], v[52:53], v[200:201] op_sel:[1,0,0] op_sel_hi:[1,1,1]
    v_lshlrev_b32 v54, 16, v95
    v_and_b32 v55, s6, v95
    v_pk_fma_f32 v[202:203], v[36:37], v[54:55], v[202:203] op_sel:[1,0,0] op_sel_hi:[1,1,1]
    v_lshlrev_b32 v52, 16, v96
    v_and_b32 v53, s6, v96
    v_pk_fma_f32 v[196:197], v[38:39], v[52:53], v[196:197] op_sel:[0,0,0] op_sel_hi:[0,1,1]
    v_lshlrev_b32 v54, 16, v97
    v_and_b32 v55, s6, v97
    v_pk_fma_f32 v[198:199], v[38:39], v[54:55], v[198:199] op_sel:[0,0,0] op_sel_hi:[0,1,1]
    v_lshlrev_b32 v52, 16, v98
    v_and_b32 v53, s6, v98
    v_pk_fma_f32 v[200:201], v[38:39], v[52:53], v[200:201] op_sel:[0,0,0] op_sel_hi:[0,1,1]
    v_lshlrev_b32 v54, 16, v99
    v_and_b32 v55, s6, v99
    v_pk_fma_f32 v[202:203], v[38:39], v[54:55], v[202:203] op_sel:[0,0,0] op_sel_hi:[0,1,1]
    v_lshlrev_b32 v52, 16, v100
    v_and_b32 v53, s6, v100
    v_pk_fma_f32 v[196:197], v[38:39], v[52:53], v[196:197] op_sel:[1,0,0] op_sel_hi:[1,1,1]
    v_lshlrev_b32 v54, 16, v101
    v_and_b32 v55, s6, v101
    v_pk_fma_f32 v[198:199], v[38:39], v[54:55], v[198:199] op_sel:[1,0,0] op_sel_hi:[1,1,1]
    v_lshlrev_b32 v52, 16, v102
    v_and_b32 v53, s6, v102
    v_pk_fma_f32 v[200:201], v[38:39], v[52:53], v[200:201] op_sel:[1,0,0] op_sel_hi:[1,1,1]
    v_lshlrev_b32 v54, 16, v103
    v_and_b32 v55, s6, v103
    v_pk_fma_f32 v[202:203], v[38:39], v[54:55], v[202:203] op_sel:[1,0,0] op_sel_hi:[1,1,1]
    v_lshlrev_b32 v52, 16, v104
    v_and_b32 v53, s6, v104
    v_pk_fma_f32 v[196:197], v[40:41], v[52:53], v[196:197] op_sel:[0,0,0] op_sel_hi:[0,1,1]
    v_lshlrev_b32 v54, 16, v105
    v_and_b32 v55, s6, v105
    v_pk_fma_f32 v[198:199], v[40:41], v[54:55], v[198:199] op_sel:[0,0,0] op_sel_hi:[0,1,1]
    v_lshlrev_b32 v52, 16, v106
    v_and_b32 v53, s6, v106
    v_pk_fma_f32 v[200:201], v[40:41], v[52:53], v[200:201] op_sel:[0,0,0] op_sel_hi:[0,1,1]
    v_lshlrev_b32 v54, 16, v107
    v_and_b32 v55, s6, v107
    v_pk_fma_f32 v[202:203], v[40:41], v[54:55], v[202:203] op_sel:[0,0,0] op_sel_hi:[0,1,1]
    v_lshlrev_b32 v52, 16, v108
    v_and_b32 v53, s6, v108
    v_pk_fma_f32 v[196:197], v[40:41], v[52:53], v[196:197] op_sel:[1,0,0] op_sel_hi:[1,1,1]
    v_lshlrev_b32 v54, 16, v109
    v_and_b32 v55, s6, v109
    v_pk_fma_f32 v[198:199], v[40:41], v[54:55], v[198:199] op_sel:[1,0,0] op_sel_hi:[1,1,1]
    v_lshlrev_b32 v52, 16, v110
    v_and_b32 v53, s6, v110
    v_pk_fma_f32 v[200:201], v[40:41], v[52:53], v[200:201] op_sel:[1,0,0] op_sel_hi:[1,1,1]
    v_lshlrev_b32 v54, 16, v111
    v_and_b32 v55, s6, v111
    v_pk_fma_f32 v[202:203], v[40:41], v[54:55], v[202:203] op_sel:[1,0,0] op_sel_hi:[1,1,1]
    v_lshlrev_b32 v52, 16, v112
    v_and_b32 v53, s6, v112
    v_pk_fma_f32 v[196:197], v[42:43], v[52:53], v[196:197] op_sel:[0,0,0] op_sel_hi:[0,1,1]
    v_lshlrev_b32 v54, 16, v113
    v_and_b32 v55, s6, v113
    v_pk_fma_f32 v[198:199], v[42:43], v[54:55], v[198:199] op_sel:[0,0,0] op_sel_hi:[0,1,1]
    v_lshlrev_b32 v52, 16, v114
    v_and_b32 v53, s6, v114
    v_pk_fma_f32 v[200:201], v[42:43], v[52:53], v[200:201] op_sel:[0,0,0] op_sel_hi:[0,1,1]
    v_lshlrev_b32 v54, 16, v115
    v_and_b32 v55, s6, v115
    v_pk_fma_f32 v[202:203], v[42:43], v[54:55], v[202:203] op_sel:[0,0,0] op_sel_hi:[0,1,1]
    v_lshlrev_b32 v52, 16, v116
    v_and_b32 v53, s6, v116
    v_pk_fma_f32 v[196:197], v[42:43], v[52:53], v[196:197] op_sel:[1,0,0] op_sel_hi:[1,1,1]
    v_lshlrev_b32 v54, 16, v117
    v_and_b32 v55, s6, v117
    v_pk_fma_f32 v[198:199], v[42:43], v[54:55], v[198:199] op_sel:[1,0,0] op_sel_hi:[1,1,1]
    v_lshlrev_b32 v52, 16, v118
    v_and_b32 v53, s6, v118
    v_pk_fma_f32 v[200:201], v[42:43], v[52:53], v[200:201] op_sel:[1,0,0] op_sel_hi:[1,1,1]
    v_lshlrev_b32 v54, 16, v119
    v_and_b32 v55, s6, v119
    v_pk_fma_f32 v[202:203], v[42:43], v[54:55], v[202:203] op_sel:[1,0,0] op_sel_hi:[1,1,1]
    v_permlane32_swap_b32 v196, v200
    v_permlane32_swap_b32 v197, v201
    v_permlane32_swap_b32 v198, v202
    v_permlane32_swap_b32 v199, v203
    v_add_f32 v196, v196, v200
    v_add_f32 v197, v197, v201
    v_add_f32 v198, v198, v202
    v_add_f32 v199, v199, v203
    s_nop 0
    v_permlane16_swap_b32 v196, v198
    v_permlane16_swap_b32 v197, v199
    v_add_f32 v196, v196, v198
    v_add_f32 v197, v197, v199
    s_nop 0
    v_add_f32_dpp v196, v196, v196 row_ror:8 row_mask:0xf bank_mask:0xf
    v_add_f32_dpp v197, v197, v197 row_ror:8 row_mask:0xf bank_mask:0xf
    s_nop 1
    v_mov_b32_dpp v196, v197 quad_perm:[0,1,2,3] row_mask:0xf bank_mask:0xc
    ds_write_b32 v252, v196 offset:9984
L_HG1:
    s_waitcnt vmcnt(1)
    v_pk_add_f32 v[184:185], v[184:185], v[188:189]
    v_pk_add_f32 v[186:187], v[186:187], v[190:191]
    s_nop 1
    v_permlane32_swap_b32 v184, v186
    v_permlane32_swap_b32 v185, v187
    v_pk_add_f32 v[184:185], v[184:185], v[186:187]
    s_nop 1
    v_add_f32_dpp v184, v184, v184 row_ror:8 row_mask:0xf bank_mask:0xf
    v_add_f32_dpp v185, v185, v185 row_ror:8 row_mask:0xf bank_mask:0xf
    v_mov_b32 v186, v184
    v_mov_b32 v187, v185
    s_nop 0
    v_permlane16_swap_b32 v184, v186
    v_permlane16_swap_b32 v185, v187
    v_pk_add_f32 v[184:185], v[184:185], v[186:187]
    v_cvt_pk_bf16_f32 v184, v184, v185
    v_mov_b32 v185, s4
    s_mov_b32 exec_lo, 0xff
    s_mov_b32 exec_hi, 0xff
    buffer_store_dwordx2 v[184:185], v48, s[32:35], s15 offen sc1
    s_mov_b64 exec, -1
    s_waitcnt lgkmcnt(0)
    s_barrier
    s_cmp_lg_u32 s3, 0
    s_cbranch_scc1 L_PC2
    v_mov_b32 v45, s4
    s_mov_b32 exec_hi, 0
    s_mov_b32 exec_lo, 65535
    buffer_store_dword v45, v46, s[32:35], s17 offen sc1
    s_mov_b64 exec, -1
L_PC2:
    s_cmp_lg_u32 s3, 3
    s_cbranch_scc1 L_M2F
    ds_read_b128 v[196:199], v251 offset:10000
    s_lshr_b32 s96, s8, 2
    s_lshl1_add_u32 s97, s9, s96
    s_and_b32 s98, s8, 3
    s_lshl2_add_u32 s99, s97, s98
    s_lshl_b32 s96, s99, 9
    s_add_u32 s18, s96, 131072
    s_waitcnt lgkmcnt(0)
    v_add_f32 v196, v196, v197
    v_add_f32 v198, v198, v199
    v_mov_b32 v197, s4
    v_add_f32 v196, v196, v198
    buffer_store_dwordx2 v[196:197], v250, s[32:35], s18 offen sc1
L_M2F:
    s_waitcnt vmcnt(1)
    s_xor_b32 s96, s95, 262144
    s_add_u32 s82, s96, s90
    s_add_u32 m0, s83, 16384
    s_nop 0
    buffer_load_dwordx4 v26, s[44:47], s82 offen lds
    v_permlane32_swap_b32 v192, v194
    v_permlane32_swap_b32 v193, v195
    v_pk_add_f32 v[192:193], v[192:193], v[194:195]
    s_nop 1
    v_add_f32_dpp v192, v192, v192 row_ror:4 row_mask:0xf bank_mask:0xf
    s_xor_b32 s96, s95, 393216
    s_add_u32 s82, s96, s90
    s_add_u32 m0, s83, 24576
    s_nop 0
    buffer_load_dwordx4 v26, s[44:47], s82 offen lds
    v_add_f32_dpp v193, v193, v193 row_ror:4 row_mask:0xf bank_mask:0xf
    v_add_f32_dpp v192, v192, v192 row_ror:8 row_mask:0xf bank_mask:0xf
    s_nop 0
    v_add_f32_dpp v193, v193, v193 row_ror:8 row_mask:0xf bank_mask:0xf
    s_xor_b32 s96, s95, 524288
    s_add_u32 s82, s96, s90
    s_add_u32 m0, s83, 32768
    s_nop 0
    buffer_load_dwordx4 v26, s[44:47], s82 offen lds
    v_mov_b32 v194, v192
    v_mov_b32 v195, v193
    s_nop 0
    v_permlane16_swap_b32 v192, v194
    s_xor_b32 s96, s95, 655360
    s_add_u32 s82, s96, s90
    s_add_u32 m0, s83, 40960
    s_nop 0
    buffer_load_dwordx4 v26, s[44:47], s82 offen lds
    v_permlane16_swap_b32 v193, v195
    v_pk_add_f32 v[192:193], v[192:193], v[194:195]
    v_cvt_pk_bf16_f32 v192, v192, v193
    ds_write_b32 v6, v192
    s_waitcnt lgkmcnt(0)
    s_barrier
    ds_read_b128 v[196:199], v7
    ds_read_b128 v[200:203], v7 offset:32
    ds_read_b128 v[204:207], v7 offset:64
    ds_read_b128 v[208:211], v7 offset:96
    s_lshr_b32 s96, s8, 2
    s_lshl1_add_u32 s97, s9, s96
    s_and_b32 s98, s8, 3
    s_lshl2_add_u32 s99, s97, s98
    s_lshl_b32 s96, s99, 9
    s_add_u32 s18, s96, 131072
    s_waitcnt lgkmcnt(0)
    s_lshl3_add_u32 s96, s11, s3
    s_lshl_b32 s97, s96, 11
    s_add_u32 s13, s97, 29360128
    s_load_dwordx2 s[24:25], s[32:33], s92 offset:3584 glc
    v_mfma_f32_32x32x16_bf16 v[136:151], v[196:199], v[152:155], 0
    v_mfma_f32_32x32x16_bf16 v[136:151], v[200:203], v[156:159], v[136:151]
    v_mfma_f32_32x32x16_bf16 v[136:151], v[204:207], v[160:163], v[136:151]
    v_mfma_f32_32x32x16_bf16 v[136:151], v[208:211], v[164:167], v[136:151]
    s_nop 11
    v_cvt_pk_bf16_f32 v136, 0, v136
    v_add_f32 v136, 0x358637bd, v136
    v_cvt_pk_bf16_f32 v136, 0, v136
    v_rcp_f32 v136, v136
    s_branch SCHK_20
SPOLL_19:
    s_load_dwordx2 s[24:25], s[32:33], s92 offset:3584 glc
SCHK_20:
    s_add_u32 s5, s5, 1
    s_cmp_ge_u32 s5, 200000
    s_waitcnt lgkmcnt(0)
    s_cbranch_scc1 SDONE_21
    s_cmp_lg_u32 s24, s4
    s_cbranch_scc1 SPOLL_19
    s_cmp_lg_u32 s25, s4
    s_cbranch_scc1 SPOLL_19
SDONE_21:
    buffer_load_dwordx4 v[228:231], v2, s[32:35], s13 offen sc1
    buffer_load_dwordx4 v[232:235], v2, s[32:35], s13 offen offset:1024 sc1
    s_waitcnt vmcnt(0)
    v_bitop3_b32 v4, v229, v231, s4 bitop3:0x7e
    v_bitop3_b32 v4, v4, v233, s4 bitop3:0xf6
    v_bitop3_b32 v4, v4, v235, s4 bitop3:0xf6
    v_cmp_ne_u32 vcc, 0, v4
    s_cbranch_vccz TOK_23
POLL_24:
    buffer_load_dwordx4 v[228:231], v2, s[32:35], s13 offen sc1
    buffer_load_dwordx4 v[232:235], v2, s[32:35], s13 offen offset:1024 sc1
    s_waitcnt vmcnt(0)
    v_bitop3_b32 v4, v229, v231, s4 bitop3:0x7e
    v_bitop3_b32 v4, v4, v233, s4 bitop3:0xf6
    v_bitop3_b32 v4, v4, v235, s4 bitop3:0xf6
    v_cmp_ne_u32 vcc, 0, v4
    s_cbranch_vccz PDONE_25
    s_add_u32 s5, s5, 1
    s_cmp_lt_u32 s5, 200000
    s_cbranch_scc1 POLL_24
PDONE_25:
TOK_23:
    ds_write2_b32 v5, v228, v230 offset0:0 offset1:1
    ds_write2_b32 v5, v232, v234 offset0:64 offset1:65
    s_waitcnt lgkmcnt(0)
    s_barrier
    ds_read_b128 v[212:215], v44
L_PAD7:
    s_cbranch_execz L_RET7
    ds_read_b128 v[216:219], v44 offset:1024
    ds_read_b128 v[220:223], v44 offset:2048
    ds_read_b128 v[224:227], v44 offset:3072
    s_lshl_b32 s96, s77, 1
    s_lshl3_add_u32 s97, s10, s96
    s_lshl_b32 s98, s97, 5
    s_lshl1_add_u32 s99, s11, s98
    s_add_u32 s96, s99, s76
    s_lshl_b32 s97, s96, 10
    s_add_u32 s13, s97, 8388608
    v_and_b32 v47, 15, v1
    v_lshlrev_b32 v47, 4, v47
    v_bfe_u32 v9, v1, 4, 1
    v_lshl_add_u32 v47, v9, 15, v47
    v_lshrrev_b32 v9, 5, v1
    v_lshl_add_u32 v47, v9, 8, v47
    s_waitcnt lgkmcnt(3)
    v_mfma_f32_32x32x16_bf16 v[120:135], v[212:215], v[152:155], 0
    s_waitcnt lgkmcnt(2)
    v_mfma_f32_32x32x16_bf16 v[120:135], v[216:219], v[156:159], v[120:135]
    s_waitcnt lgkmcnt(1)
    v_mfma_f32_32x32x16_bf16 v[120:135], v[220:223], v[160:163], v[120:135]
    s_waitcnt lgkmcnt(0)
    v_mfma_f32_32x32x16_bf16 v[120:135], v[224:227], v[164:167], v[120:135]
    s_lshr_b32 s96, s3, 1
    s_lshl4_add_u32 s97, s96, s12
    s_lshl_b32 s98, s97, 11
    s_and_b32 s99, s3, 1
    s_lshl_b32 s96, s99, 10
    s_add_u32 s97, s98, s96
    s_add_u32 s18, s97, 131072
    s_lshl_b32 s19, s12, 7
    v_and_b32 v44, 3, v1
    v_lshl_add_u32 v44, v44, 1, s19
    v_lshrrev_b32 v9, 5, v1
    v_lshl_add_u32 v44, v9, 3, v44
    v_bfe_u32 v9, v1, 4, 1
    v_lshl_add_u32 v44, v9, 4, v44
    v_bfe_u32 v9, v1, 2, 2
    v_lshl_add_u32 v44, v9, 5, v44
    global_load_ushort v32, v44, s[78:79]
    v_cvt_pk_bf16_f32 v120, 0, v120
    v_cvt_pk_bf16_f32 v121, 0, v121
    v_cvt_pk_bf16_f32 v122, 0, v122
    v_cvt_pk_bf16_f32 v123, 0, v123
    v_cvt_pk_bf16_f32 v124, 0, v124
    v_cvt_pk_bf16_f32 v125, 0, v125
    v_cvt_pk_bf16_f32 v126, 0, v126
    v_cvt_pk_bf16_f32 v127, 0, v127
    v_pk_mul_f32 v[120:121], v[120:121], v[136:137] op_sel_hi:[1,0]
    v_pk_mul_f32 v[122:123], v[122:123], v[136:137] op_sel_hi:[1,0]
    v_pk_mul_f32 v[124:125], v[124:125], v[136:137] op_sel_hi:[1,0]
    v_pk_mul_f32 v[126:127], v[126:127], v[136:137] op_sel_hi:[1,0]
    v_cvt_pk_bf16_f32 v168, v120, v121
    v_cvt_pk_bf16_f32 v169, v122, v123
    v_cvt_pk_bf16_f32 v170, v124, v125
    v_cvt_pk_bf16_f32 v171, v126, v127
    buffer_store_dwordx4 v[168:171], v47, s[32:35], s13 offen sc1
    v_cvt_pk_bf16_f32 v128, 0, v128
    v_cvt_pk_bf16_f32 v129, 0, v129
    v_cvt_pk_bf16_f32 v130, 0, v130
    v_cvt_pk_bf16_f32 v131, 0, v131
    v_cvt_pk_bf16_f32 v132, 0, v132
    v_cvt_pk_bf16_f32 v133, 0, v133
    v_cvt_pk_bf16_f32 v134, 0, v134
    v_cvt_pk_bf16_f32 v135, 0, v135
    v_pk_mul_f32 v[128:129], v[128:129], v[136:137] op_sel_hi:[1,0]
    v_pk_mul_f32 v[130:131], v[130:131], v[136:137] op_sel_hi:[1,0]
    v_pk_mul_f32 v[132:133], v[132:133], v[136:137] op_sel_hi:[1,0]
    v_pk_mul_f32 v[134:135], v[134:135], v[136:137] op_sel_hi:[1,0]
    v_cvt_pk_bf16_f32 v172, v128, v129
    v_cvt_pk_bf16_f32 v173, v130, v131
    v_cvt_pk_bf16_f32 v174, v132, v133
    v_cvt_pk_bf16_f32 v175, v134, v135
    buffer_store_dwordx4 v[172:175], v47, s[32:35], s13 offen offset:512 sc1
    buffer_load_dwordx4 v[28:31], v2, s[32:35], s18 offen sc1
    v_mov_b32 v50, -1
    v_mov_b32 v51, -1
    v_mov_b32 v52, -1
    v_mov_b32 v53, -1
    s_lshl3_add_u32 s96, s21, s3
    s_lshl4_add_u32 s97, s96, s12
    s_lshl_b32 s98, s97, 8
    s_add_u32 s19, s98, 12582912
    v_lshlrev_b32 v54, 2, v1
    buffer_store_dword v50, v54, s[32:35], s19 offen sc1
    s_lshl_b32 s96, s21, 14
    s_lshl_b32 s97, s12, 9
    s_add_u32 s98, s96, s97
    s_add_u32 s19, s98, 13631488
    v_and_b32 v54, 31, v1
    v_lshlrev_b32 v54, 4, v54
    v_lshrrev_b32 v55, 5, v1
    v_lshl_add_u32 v54, v55, 13, v54
    s_cmp_lg_u32 s3, 5
    s_cbranch_scc1 L_NOPO
    buffer_store_dwordx4 v[50:53], v54, s[32:35], s19 offen sc1
L_NOPO:
    v_bfe_u32 v36, v1, 2, 2
    v_lshlrev_b32 v36, 7, v36
    v_lshrrev_b32 v9, 4, v1
    v_lshl_add_u32 v36, v9, 10, v36
    v_and_b32 v9, 1, v1
    v_lshl_add_u32 v36, v9, 4, v36
    v_bfe_u32 v9, v1, 1, 1
    v_lshl_add_u32 v36, v9, 3, v36
    v_bfe_u32 v9, v1, 3, 2
    v_lshl_add_u32 v36, v9, 5, v36
    s_and_b32 s96, s9, 1
    s_lshl_b32 s97, s96, 2
    s_xor_b32 s98, s3, s97
    s_lshl_b32 s17, s98, 12
    s_lshl_b32 s96, s17, 2
    s_lshr_b32 s97, s95, 4
    s_xor_b32 s14, s96, s97
    v_add_u32 v36, s14, v36
    v_xor_b32 v37, 32, v36
    v_xor_b32 v38, 64, v36
    v_xor_b32 v39, 96, v36
    v_and_b32 v5, 7, v1
    v_lshlrev_b32 v5, 15, v5
    v_bfe_u32 v9, v1, 3, 1
    v_lshl_add_u32 v5, v9, 12, v5
    s_and_b32 s96, s11, 1
    s_lshr_b32 s97, s10, 2
    s_and_b32 s98, s10, 3
    s_lshl_b32 s99, s98, 6
    s_lshl1_add_u32 s98, s97, s99
    s_lshl_b32 s97, s98, 12
    s_lshr_b32 s99, s11, 1
    s_lshl_b32 s98, s99, 6
    s_add_u32 s99, s97, s98
    s_lshl2_add_u32 s97, s96, s99
    s_add_u32 s98, s97, 1048576
    s_add_u32 s15, s98, 1024
    v_lshlrev_b32 v152, 16, v12
    v_and_b32 v153, s6, v12
    v_lshlrev_b32 v154, 16, v13
    v_and_b32 v155, s6, v13
    v_lshlrev_b32 v156, 16, v14
    v_and_b32 v157, s6, v14
    v_lshlrev_b32 v158, 16, v15
    v_and_b32 v159, s6, v15
    v_lshlrev_b32 v160, 16, v16
    v_and_b32 v161, s6, v16
    v_lshlrev_b32 v162, 16, v17
    v_and_b32 v163, s6, v17
    v_lshlrev_b32 v164, 16, v18
    v_and_b32 v165, s6, v18
    v_lshlrev_b32 v166, 16, v19
    v_and_b32 v167, s6, v19
    s_lshl3_add_u32 s96, s21, s3
    s_lshl_b32 s97, s96, 15
    s_add_u32 s19, s97, 8388608
    s_and_b32 s96, s3, 1
    s_lshr_b32 s97, s3, 1
    s_lshl_b32 s98, s97, 10
    s_lshl3_add_u32 s99, s96, s98
    s_add_u32 s14, s99, 159744
    v_and_b32 v4, 31, v1
    v_lshl_add_u32 v4, v4, 5, s14
    v_lshrrev_b32 v9, 5, v1
    v_lshl_add_u32 v4, v9, 2, v4
    v_and_b32 v7, 3, v1
    v_lshlrev_b32 v7, 4, v7
    v_lshrrev_b32 v9, 5, v1
    v_lshl_add_u32 v7, v9, 6, v7
    v_bfe_u32 v9, v1, 4, 1
    v_lshl_add_u32 v7, v9, 7, v7
    v_bfe_u32 v9, v1, 2, 2
    v_lshl_add_u32 v7, v9, 8, v7
    v_add_u32 v7, 159744, v7
    s_waitcnt vmcnt(2)
    s_waitcnt lgkmcnt(0)
    s_barrier
    s_cmp_lg_u32 s3, 0
    s_cbranch_scc1 L_PD
    v_mov_b32 v6, s4
    s_mov_b32 exec_hi, 0
    s_mov_b32 exec_lo, 65535
    buffer_store_dword v6, v5, s[32:35], s15 offen sc1
    s_mov_b64 exec, -1
L_PD:
    s_waitcnt vmcnt(1)
    v_bitop3_b32 v6, v29, v31, s4 bitop3:0x7e
    v_cmp_ne_u32 vcc, 0, v6
    s_cbranch_vccz L_MGOK
POLL_26:
    buffer_load_dwordx4 v[28:31], v2, s[32:35], s18 offen sc1
    s_waitcnt vmcnt(0)
    v_bitop3_b32 v6, v29, v31, s4 bitop3:0x7e
    v_cmp_ne_u32 vcc, 0, v6
    s_cbranch_vccz PDONE_27
    s_add_u32 s5, s5, 1
    s_cmp_lt_u32 s5, 200000
    s_cbranch_scc1 POLL_26
PDONE_27:
L_MGOK:
    ds_write2_b32 v4, v28, v30 offset0:0 offset1:4
    s_waitcnt lgkmcnt(0)
    s_barrier
    s_lshl_b32 s96, s2, 12
    s_lshr_b32 s97, s17, 6
    s_add_u32 s98, s96, s97
    s_add_u32 s99, s98, 1048576
    s_add_u32 s18, s99, 1024
    ds_read_b128 v[192:195], v7
    ds_read_b128 v[196:199], v7 offset:1024
    ds_read_b128 v[200:203], v7 offset:2048
    ds_read_b128 v[204:207], v7 offset:3072
    v_and_b32 v8, 3, v1
    v_lshlrev_b32 v8, 2, v8
    v_lshrrev_b32 v9, 5, v1
    v_lshl_add_u32 v8, v9, 4, v8
    v_bfe_u32 v9, v1, 4, 1
    v_lshl_add_u32 v8, v9, 5, v8
    v_bfe_u32 v9, v1, 2, 2
    v_lshl_add_u32 v8, v9, 6, v8
    v_add_u32 v8, 157184, v8
    s_lshl4_add_u32 s96, s21, s12
    s_lshl_b32 s97, s96, 6
    s_add_u32 s13, s97, 14155776
    s_waitcnt lgkmcnt(0)
    s_load_dwordx2 s[24:25], s[32:33], s18 offset:0 glc
    v_pk_add_f32 v[192:193], v[192:193], v[194:195]
    v_add_f32 v28, v192, v193
    v_pk_add_f32 v[196:197], v[196:197], v[198:199]
    v_add_f32 v29, v196, v197
    v_pk_add_f32 v[200:201], v[200:201], v[202:203]
    v_add_f32 v30, v200, v201
    v_pk_add_f32 v[204:205], v[204:205], v[206:207]
    v_add_f32 v31, v204, v205
    v_cvt_pk_bf16_f32 v28, 0, v28
    v_cvt_pk_bf16_f32 v29, 0, v29
    v_cvt_pk_bf16_f32 v30, 0, v30
    v_cvt_pk_bf16_f32 v31, 0, v31
    v_add_f32 v30, 1.0, v30
    v_lshlrev_b32 v32, 16, v32
    v_cvt_pk_bf16_f32 v30, 0, v30
    ds_write_b32 v8, v31
    v_mul_f32 v192, v30, v32
    v_cvt_pk_bf16_f32 v193, 0, v192
    v_sub_f32 v194, v192, v193
    v_add_f32_dpp v192, v192, v192 quad_perm:[1,0,3,2] row_mask:0xf bank_mask:0xf
    s_nop 1
    v_add_f32_dpp v192, v192, v192 quad_perm:[2,3,0,1] row_mask:0xf bank_mask:0xf
    s_nop 1
    v_add_f32_dpp v192, v192, v192 row_half_mirror row_mask:0xf bank_mask:0xf
    s_nop 1
    v_add_f32_dpp v192, v192, v192 row_ror:8 row_mask:0xf bank_mask:0xf
    v_mov_b32 v199, v192
    s_nop 1
    v_permlane16_swap_b32 v192, v199
    v_add_f32 v192, v192, v199
    v_mov_b32 v199, v192
    s_nop 1
    v_permlane32_swap_b32 v192, v199
    v_add_f32 v192, v192, v199
    v_mov_b32_dpp v196, v193 row_shl:1 row_mask:0xf bank_mask:0xf
    v_mov_b32_dpp v197, v194 row_shl:1 row_mask:0xf bank_mask:0xf
    v_mov_b32_dpp v198, v32 row_shl:1 row_mask:0xf bank_mask:0xf
    v_cvt_pk_bf16_f32 v196, v193, v196
    v_cvt_pk_bf16_f32 v197, v194, v197
    v_cvt_pk_bf16_f32 v198, v32, v198
    v_mov_b32 v193, s4
    v_mov_b32 v194, 0
    s_cmp_lg_u32 s3, 2
    s_cbranch_scc1 L_NOUP
    s_mov_b64 exec, 1
    buffer_store_dwordx2 v[192:193], v194, s[32:35], s13 offen sc1
    s_mov_b64 exec, -1
L_NOUP:
    v_mov_b32 v184, 0x3f803f80
    s_nop 1
    v_mov_b32_dpp v184, v196 row_newbcast:0 row_mask:0xf bank_mask:0x2
    s_nop 1
    v_mov_b32_dpp v184, v197 row_newbcast:0 row_mask:0xf bank_mask:0x4
    s_nop 1
    v_mov_b32_dpp v184, v198 row_newbcast:0 row_mask:0xf bank_mask:0x8
    v_mov_b32 v185, 0x3f803f80
    s_nop 1
    v_mov_b32_dpp v185, v196 row_newbcast:2 row_mask:0xf bank_mask:0x2
    s_nop 1
    v_mov_b32_dpp v185, v197 row_newbcast:2 row_mask:0xf bank_mask:0x4
    s_nop 1
    v_mov_b32_dpp v185, v198 row_newbcast:2 row_mask:0xf bank_mask:0x8
    v_mov_b32 v186, 0x3f803f80
    s_nop 1
    v_mov_b32_dpp v186, v196 row_newbcast:4 row_mask:0xf bank_mask:0x2
    s_nop 1
    v_mov_b32_dpp v186, v197 row_newbcast:4 row_mask:0xf bank_mask:0x4
    s_nop 1
    v_mov_b32_dpp v186, v198 row_newbcast:4 row_mask:0xf bank_mask:0x8
    v_mov_b32 v187, 0x3f803f80
    s_nop 1
    v_mov_b32_dpp v187, v196 row_newbcast:6 row_mask:0xf bank_mask:0x2
    s_nop 1
    v_mov_b32_dpp v187, v197 row_newbcast:6 row_mask:0xf bank_mask:0x4
    s_nop 1
    v_mov_b32_dpp v187, v198 row_newbcast:6 row_mask:0xf bank_mask:0x8
    v_mov_b32 v188, 0x3f803f80
    s_nop 1
    v_mov_b32_dpp v188, v196 row_newbcast:8 row_mask:0xf bank_mask:0x2
    s_nop 1
    v_mov_b32_dpp v188, v197 row_newbcast:8 row_mask:0xf bank_mask:0x4
    s_nop 1
    v_mov_b32_dpp v188, v198 row_newbcast:8 row_mask:0xf bank_mask:0x8
    v_mov_b32 v189, 0x3f803f80
    s_nop 1
    v_mov_b32_dpp v189, v196 row_newbcast:10 row_mask:0xf bank_mask:0x2
    s_nop 1
    v_mov_b32_dpp v189, v197 row_newbcast:10 row_mask:0xf bank_mask:0x4
    s_nop 1
    v_mov_b32_dpp v189, v198 row_newbcast:10 row_mask:0xf bank_mask:0x8
    v_mov_b32 v190, 0x3f803f80
    s_nop 1
    v_mov_b32_dpp v190, v196 row_newbcast:12 row_mask:0xf bank_mask:0x2
    s_nop 1
    v_mov_b32_dpp v190, v197 row_newbcast:12 row_mask:0xf bank_mask:0x4
    s_nop 1
    v_mov_b32_dpp v190, v198 row_newbcast:12 row_mask:0xf bank_mask:0x8
    v_mov_b32 v191, 0x3f803f80
    s_nop 1
    v_mov_b32_dpp v191, v196 row_newbcast:14 row_mask:0xf bank_mask:0x2
    s_nop 1
    v_mov_b32_dpp v191, v197 row_newbcast:14 row_mask:0xf bank_mask:0x4
    s_nop 1
    v_mov_b32_dpp v191, v198 row_newbcast:14 row_mask:0xf bank_mask:0x8
    v_mov_b32 v42, v29
    v_mov_b32 v43, v31
    v_mov_b32 v33, v30
    v_mov_b32_dpp v136, v28 row_newbcast:0 row_mask:0xf bank_mask:0xf
    v_mov_b32_dpp v137, v28 row_newbcast:1 row_mask:0xf bank_mask:0xf
    v_mov_b32_dpp v138, v28 row_newbcast:2 row_mask:0xf bank_mask:0xf
    v_mov_b32_dpp v139, v28 row_newbcast:3 row_mask:0xf bank_mask:0xf
    v_mov_b32_dpp v140, v28 row_newbcast:4 row_mask:0xf bank_mask:0xf
    v_mov_b32_dpp v141, v28 row_newbcast:5 row_mask:0xf bank_mask:0xf
    v_mov_b32_dpp v142, v28 row_newbcast:6 row_mask:0xf bank_mask:0xf
    v_mov_b32_dpp v143, v28 row_newbcast:7 row_mask:0xf bank_mask:0xf
    v_mov_b32_dpp v144, v28 row_newbcast:8 row_mask:0xf bank_mask:0xf
    v_mov_b32_dpp v145, v28 row_newbcast:9 row_mask:0xf bank_mask:0xf
    v_mov_b32_dpp v146, v28 row_newbcast:10 row_mask:0xf bank_mask:0xf
    v_mov_b32_dpp v147, v28 row_newbcast:11 row_mask:0xf bank_mask:0xf
    v_mov_b32_dpp v148, v28 row_newbcast:12 row_mask:0xf bank_mask:0xf
    v_mov_b32_dpp v149, v28 row_newbcast:13 row_mask:0xf bank_mask:0xf
    v_mov_b32_dpp v150, v28 row_newbcast:14 row_mask:0xf bank_mask:0xf
    v_mov_b32_dpp v151, v28 row_newbcast:15 row_mask:0xf bank_mask:0xf
    s_branch SCHK_29
SPOLL_28:
    s_load_dwordx2 s[24:25], s[32:33], s18 offset:0 glc
SCHK_29:
    s_add_u32 s5, s5, 1
    s_cmp_ge_u32 s5, 200000
    s_waitcnt lgkmcnt(0)
    s_cbranch_scc1 SDONE_30
    s_cmp_lg_u32 s24, s4
    s_cbranch_scc1 SPOLL_28
    s_cmp_lg_u32 s25, s4
    s_cbranch_scc1 SPOLL_28
SDONE_30:
    s_add_u32 s20, s17, s19
    buffer_load_dwordx4 v[224:227], v2, s[32:35], s20 offen sc1
    ds_read_b64_tr_b16 v[192:193], v36
    ds_read_b64_tr_b16 v[194:195], v36 offset:512
    ds_read_b64_tr_b16 v[196:197], v37
    ds_read_b64_tr_b16 v[198:199], v37 offset:512
    ds_read_b64_tr_b16 v[200:201], v38
    ds_read_b64_tr_b16 v[202:203], v38 offset:512
    ds_read_b64_tr_b16 v[204:205], v39
    ds_read_b64_tr_b16 v[206:207], v39 offset:512
    ds_read_b64_tr_b16 v[208:209], v36 offset:4096
    ds_read_b64_tr_b16 v[210:211], v36 offset:4608
    ds_read_b64_tr_b16 v[212:213], v37 offset:4096
    ds_read_b64_tr_b16 v[214:215], v37 offset:4608
    ds_read_b64_tr_b16 v[216:217], v38 offset:4096
    ds_read_b64_tr_b16 v[218:219], v38 offset:4608
    buffer_load_dwordx4 v[228:231], v2, s[32:35], s20 offen offset:1024 sc1
    buffer_load_dwordx4 v[232:235], v2, s[32:35], s20 offen offset:2048 sc1
    buffer_load_dwordx4 v[236:239], v2, s[32:35], s20 offen offset:3072 sc1
    s_barrier
    s_xor_b32 s96, s17, 4096
    s_add_u32 s20, s96, s19
    buffer_load_dwordx4 v[240:243], v2, s[32:35], s20 offen sc1
    buffer_load_dwordx4 v[244:247], v2, s[32:35], s20 offen offset:1024 sc1
    buffer_load_dwordx4 v[44:47], v2, s[32:35], s20 offen offset:2048 sc1
    buffer_load_dwordx4 v[48:51], v2, s[32:35], s20 offen offset:3072 sc1
    s_lshl_b32 s96, s21, 10
    s_add_u32 s13, s96, 14155776
    v_and_b32 v10, 15, v1
    v_lshlrev_b32 v10, 6, v10
    s_cmp_lt_u32 s3, 4
    s_cbranch_scc1 L_G2P0
    s_setprio 1
L_G2P0:
    s_waitcnt vmcnt(7)
    s_waitcnt lgkmcnt(6)
    v_mfma_f32_16x16x32_bf16 v[120:123], v[192:195], v[224:227], 0
    ds_read_b64_tr_b16 v[220:221], v39 offset:4096
    ds_read_b64_tr_b16 v[222:223], v39 offset:4608
    v_mfma_f32_16x16x32_bf16 v[124:127], v[196:199], v[224:227], 0
    ds_read_b64_tr_b16 v[192:193], v36 offset:8192
    ds_read_b64_tr_b16 v[194:195], v36 offset:8704
    v_mfma_f32_16x16x32_bf16 v[128:131], v[200:203], v[224:227], 0
    ds_read_b64_tr_b16 v[196:197], v37 offset:8192
    ds_read_b64_tr_b16 v[198:199], v37 offset:8704
    v_mfma_f32_16x16x32_bf16 v[132:135], v[204:207], v[224:227], 0
    ds_read_b64_tr_b16 v[200:201], v38 offset:8192
    ds_read_b64_tr_b16 v[202:203], v38 offset:8704
    s_xor_b32 s96, s17, 8192
    s_add_u32 s20, s96, s19
    buffer_load_dwordx4 v[224:227], v2, s[32:35], s20 offen sc1
    s_waitcnt vmcnt(7)
    s_waitcnt lgkmcnt(6)
    v_mfma_f32_16x16x32_bf16 v[120:123], v[208:211], v[228:231], v[120:123]
    ds_read_b64_tr_b16 v[204:205], v39 offset:8192
    ds_read_b64_tr_b16 v[206:207], v39 offset:8704
    v_mfma_f32_16x16x32_bf16 v[124:127], v[212:215], v[228:231], v[124:127]
    ds_read_b64_tr_b16 v[208:209], v36 offset:12288
    ds_read_b64_tr_b16 v[210:211], v36 offset:12800
    v_xor_b32 v36, 16384, v36
    v_mfma_f32_16x16x32_bf16 v[128:131], v[216:219], v[228:231], v[128:131]
    ds_read_b64_tr_b16 v[212:213], v37 offset:12288
    ds_read_b64_tr_b16 v[214:215], v37 offset:12800
    v_xor_b32 v37, 16384, v37
    v_mfma_f32_16x16x32_bf16 v[132:135], v[220:223], v[228:231], v[132:135]
    ds_read_b64_tr_b16 v[216:217], v38 offset:12288
    ds_read_b64_tr_b16 v[218:219], v38 offset:12800
    v_xor_b32 v38, 16384, v38
    buffer_load_dwordx4 v[228:231], v2, s[32:35], s20 offen offset:1024 sc1
    s_waitcnt vmcnt(7)
    s_waitcnt lgkmcnt(6)
    v_mfma_f32_16x16x32_bf16 v[120:123], v[192:195], v[232:235], v[120:123]
    ds_read_b64_tr_b16 v[220:221], v39 offset:12288
    ds_read_b64_tr_b16 v[222:223], v39 offset:12800
    v_xor_b32 v39, 16384, v39
    v_mfma_f32_16x16x32_bf16 v[124:127], v[196:199], v[232:235], v[124:127]
    ds_read_b64_tr_b16 v[192:193], v36
    ds_read_b64_tr_b16 v[194:195], v36 offset:512
    v_mfma_f32_16x16x32_bf16 v[128:131], v[200:203], v[232:235], v[128:131]
    ds_read_b64_tr_b16 v[196:197], v37
    ds_read_b64_tr_b16 v[198:199], v37 offset:512
    v_mfma_f32_16x16x32_bf16 v[132:135], v[204:207], v[232:235], v[132:135]
    ds_read_b64_tr_b16 v[200:201], v38
    ds_read_b64_tr_b16 v[202:203], v38 offset:512
    buffer_load_dwordx4 v[232:235], v2, s[32:35], s20 offen offset:2048 sc1
    s_waitcnt vmcnt(7)
    s_waitcnt lgkmcnt(6)
    v_mfma_f32_16x16x32_bf16 v[120:123], v[208:211], v[236:239], v[120:123]
    ds_read_b64_tr_b16 v[204:205], v39
    ds_read_b64_tr_b16 v[206:207], v39 offset:512
    v_mfma_f32_16x16x32_bf16 v[124:127], v[212:215], v[236:239], v[124:127]
    ds_read_b64_tr_b16 v[208:209], v36 offset:4096
    ds_read_b64_tr_b16 v[210:211], v36 offset:4608
    v_mfma_f32_16x16x32_bf16 v[128:131], v[216:219], v[236:239], v[128:131]
    ds_read_b64_tr_b16 v[212:213], v37 offset:4096
    ds_read_b64_tr_b16 v[214:215], v37 offset:4608
    v_mfma_f32_16x16x32_bf16 v[132:135], v[220:223], v[236:239], v[132:135]
    ds_read_b64_tr_b16 v[216:217], v38 offset:4096
    ds_read_b64_tr_b16 v[218:219], v38 offset:4608
    buffer_load_dwordx4 v[236:239], v2, s[32:35], s20 offen offset:3072 sc1
    s_waitcnt vmcnt(7)
    s_waitcnt lgkmcnt(6)
    v_mfma_f32_16x16x32_bf16 v[120:123], v[192:195], v[240:243], v[120:123]
    ds_read_b64_tr_b16 v[220:221], v39 offset:4096
    ds_read_b64_tr_b16 v[222:223], v39 offset:4608
    v_mfma_f32_16x16x32_bf16 v[124:127], v[196:199], v[240:243], v[124:127]
    ds_read_b64_tr_b16 v[192:193], v36 offset:8192
    ds_read_b64_tr_b16 v[194:195], v36 offset:8704
    v_mfma_f32_16x16x32_bf16 v[128:131], v[200:203], v[240:243], v[128:131]
    ds_read_b64_tr_b16 v[196:197], v37 offset:8192
    ds_read_b64_tr_b16 v[198:199], v37 offset:8704
    v_mfma_f32_16x16x32_bf16 v[132:135], v[204:207], v[240:243], v[132:135]
    ds_read_b64_tr_b16 v[200:201], v38 offset:8192
    ds_read_b64_tr_b16 v[202:203], v38 offset:8704
    s_xor_b32 s96, s17, 12288
    s_add_u32 s20, s96, s19
    buffer_load_dwordx4 v[240:243], v2, s[32:35], s20 offen sc1
    s_waitcnt vmcnt(7)
    s_waitcnt lgkmcnt(6)
    v_mfma_f32_16x16x32_bf16 v[120:123], v[208:211], v[244:247], v[120:123]
    ds_read_b64_tr_b16 v[204:205], v39 offset:8192
    ds_read_b64_tr_b16 v[206:207], v39 offset:8704
    v_mfma_f32_16x16x32_bf16 v[124:127], v[212:215], v[244:247], v[124:127]
    ds_read_b64_tr_b16 v[208:209], v36 offset:12288
    ds_read_b64_tr_b16 v[210:211], v36 offset:12800
    v_xor_b32 v36, 49152, v36
    v_mfma_f32_16x16x32_bf16 v[128:131], v[216:219], v[244:247], v[128:131]
    ds_read_b64_tr_b16 v[212:213], v37 offset:12288
    ds_read_b64_tr_b16 v[214:215], v37 offset:12800
    v_xor_b32 v37, 49152, v37
    v_mfma_f32_16x16x32_bf16 v[132:135], v[220:223], v[244:247], v[132:135]
    ds_read_b64_tr_b16 v[216:217], v38 offset:12288
    ds_read_b64_tr_b16 v[218:219], v38 offset:12800
    v_xor_b32 v38, 49152, v38
    buffer_load_dwordx4 v[244:247], v2, s[32:35], s20 offen offset:1024 sc1
    s_waitcnt vmcnt(7)
    s_waitcnt lgkmcnt(6)
    v_mfma_f32_16x16x32_bf16 v[120:123], v[192:195], v[44:47], v[120:123]
    ds_read_b64_tr_b16 v[220:221], v39 offset:12288
    ds_read_b64_tr_b16 v[222:223], v39 offset:12800
    v_xor_b32 v39, 49152, v39
    v_mfma_f32_16x16x32_bf16 v[124:127], v[196:199], v[44:47], v[124:127]
    ds_read_b64_tr_b16 v[192:193], v36
    ds_read_b64_tr_b16 v[194:195], v36 offset:512
    v_mfma_f32_16x16x32_bf16 v[128:131], v[200:203], v[44:47], v[128:131]
    ds_read_b64_tr_b16 v[196:197], v37
    ds_read_b64_tr_b16 v[198:199], v37 offset:512
    v_mfma_f32_16x16x32_bf16 v[132:135], v[204:207], v[44:47], v[132:135]
    ds_read_b64_tr_b16 v[200:201], v38
    ds_read_b64_tr_b16 v[202:203], v38 offset:512
    buffer_load_dwordx4 v[44:47], v2, s[32:35], s20 offen offset:2048 sc1
    s_waitcnt vmcnt(7)
    s_waitcnt lgkmcnt(6)
    v_mfma_f32_16x16x32_bf16 v[120:123], v[208:211], v[48:51], v[120:123]
    ds_read_b64_tr_b16 v[204:205], v39
    ds_read_b64_tr_b16 v[206:207], v39 offset:512
    v_mfma_f32_16x16x32_bf16 v[124:127], v[212:215], v[48:51], v[124:127]
    ds_read_b64_tr_b16 v[208:209], v36 offset:4096
    ds_read_b64_tr_b16 v[210:211], v36 offset:4608
    v_mfma_f32_16x16x32_bf16 v[128:131], v[216:219], v[48:51], v[128:131]
    ds_read_b64_tr_b16 v[212:213], v37 offset:4096
    ds_read_b64_tr_b16 v[214:215], v37 offset:4608
    v_mfma_f32_16x16x32_bf16 v[132:135], v[220:223], v[48:51], v[132:135]
    ds_read_b64_tr_b16 v[216:217], v38 offset:4096
    ds_read_b64_tr_b16 v[218:219], v38 offset:4608
    buffer_load_dwordx4 v[48:51], v2, s[32:35], s20 offen offset:3072 sc1
    s_waitcnt vmcnt(7)
    s_waitcnt lgkmcnt(6)
    v_mfma_f32_16x16x32_bf16 v[120:123], v[192:195], v[224:227], v[120:123]
    ds_read_b64_tr_b16 v[220:221], v39 offset:4096
    ds_read_b64_tr_b16 v[222:223], v39 offset:4608
    v_mfma_f32_16x16x32_bf16 v[124:127], v[196:199], v[224:227], v[124:127]
    ds_read_b64_tr_b16 v[192:193], v36 offset:8192
    ds_read_b64_tr_b16 v[194:195], v36 offset:8704
    v_mfma_f32_16x16x32_bf16 v[128:131], v[200:203], v[224:227], v[128:131]
    ds_read_b64_tr_b16 v[196:197], v37 offset:8192
    ds_read_b64_tr_b16 v[198:199], v37 offset:8704
    v_mfma_f32_16x16x32_bf16 v[132:135], v[204:207], v[224:227], v[132:135]
    ds_read_b64_tr_b16 v[200:201], v38 offset:8192
    ds_read_b64_tr_b16 v[202:203], v38 offset:8704
    s_xor_b32 s96, s17, 16384
    s_add_u32 s20, s96, s19
    buffer_load_dwordx4 v[224:227], v2, s[32:35], s20 offen sc1
    s_waitcnt vmcnt(7)
    s_waitcnt lgkmcnt(6)
    v_mfma_f32_16x16x32_bf16 v[120:123], v[208:211], v[228:231], v[120:123]
    ds_read_b64_tr_b16 v[204:205], v39 offset:8192
    ds_read_b64_tr_b16 v[206:207], v39 offset:8704
    v_mfma_f32_16x16x32_bf16 v[124:127], v[212:215], v[228:231], v[124:127]
    ds_read_b64_tr_b16 v[208:209], v36 offset:12288
    ds_read_b64_tr_b16 v[210:211], v36 offset:12800
    v_xor_b32 v36, 16384, v36
    v_mfma_f32_16x16x32_bf16 v[128:131], v[216:219], v[228:231], v[128:131]
    ds_read_b64_tr_b16 v[212:213], v37 offset:12288
    ds_read_b64_tr_b16 v[214:215], v37 offset:12800
    v_xor_b32 v37, 16384, v37
    v_mfma_f32_16x16x32_bf16 v[132:135], v[220:223], v[228:231], v[132:135]
    ds_read_b64_tr_b16 v[216:217], v38 offset:12288
    ds_read_b64_tr_b16 v[218:219], v38 offset:12800
    v_xor_b32 v38, 16384, v38
    buffer_load_dwordx4 v[228:231], v2, s[32:35], s20 offen offset:1024 sc1
    s_waitcnt vmcnt(7)
    s_waitcnt lgkmcnt(6)
    v_mfma_f32_16x16x32_bf16 v[120:123], v[192:195], v[232:235], v[120:123]
    ds_read_b64_tr_b16 v[220:221], v39 offset:12288
    ds_read_b64_tr_b16 v[222:223], v39 offset:12800
    v_xor_b32 v39, 16384, v39
    v_mfma_f32_16x16x32_bf16 v[124:127], v[196:199], v[232:235], v[124:127]
    ds_read_b64_tr_b16 v[192:193], v36
    ds_read_b64_tr_b16 v[194:195], v36 offset:512
    v_mfma_f32_16x16x32_bf16 v[128:131], v[200:203], v[232:235], v[128:131]
    ds_read_b64_tr_b16 v[196:197], v37
    ds_read_b64_tr_b16 v[198:199], v37 offset:512
    v_mfma_f32_16x16x32_bf16 v[132:135], v[204:207], v[232:235], v[132:135]
    ds_read_b64_tr_b16 v[200:201], v38
    ds_read_b64_tr_b16 v[202:203], v38 offset:512
    buffer_load_dwordx4 v[232:235], v2, s[32:35], s20 offen offset:2048 sc1
    s_waitcnt vmcnt(7)
    s_waitcnt lgkmcnt(6)
    v_mfma_f32_16x16x32_bf16 v[120:123], v[208:211], v[236:239], v[120:123]
    ds_read_b64_tr_b16 v[204:205], v39
    ds_read_b64_tr_b16 v[206:207], v39 offset:512
    v_mfma_f32_16x16x32_bf16 v[124:127], v[212:215], v[236:239], v[124:127]
    ds_read_b64_tr_b16 v[208:209], v36 offset:4096
    ds_read_b64_tr_b16 v[210:211], v36 offset:4608
    v_mfma_f32_16x16x32_bf16 v[128:131], v[216:219], v[236:239], v[128:131]
    ds_read_b64_tr_b16 v[212:213], v37 offset:4096
    ds_read_b64_tr_b16 v[214:215], v37 offset:4608
    v_mfma_f32_16x16x32_bf16 v[132:135], v[220:223], v[236:239], v[132:135]
    ds_read_b64_tr_b16 v[216:217], v38 offset:4096
    ds_read_b64_tr_b16 v[218:219], v38 offset:4608
    buffer_load_dwordx4 v[236:239], v2, s[32:35], s20 offen offset:3072 sc1
    s_waitcnt vmcnt(7)
    s_waitcnt lgkmcnt(6)
    v_mfma_f32_16x16x32_bf16 v[120:123], v[192:195], v[240:243], v[120:123]
    ds_read_b64_tr_b16 v[220:221], v39 offset:4096
    ds_read_b64_tr_b16 v[222:223], v39 offset:4608
    v_mfma_f32_16x16x32_bf16 v[124:127], v[196:199], v[240:243], v[124:127]
    ds_read_b64_tr_b16 v[192:193], v36 offset:8192
    ds_read_b64_tr_b16 v[194:195], v36 offset:8704
    v_mfma_f32_16x16x32_bf16 v[128:131], v[200:203], v[240:243], v[128:131]
    ds_read_b64_tr_b16 v[196:197], v37 offset:8192
    ds_read_b64_tr_b16 v[198:199], v37 offset:8704
    v_mfma_f32_16x16x32_bf16 v[132:135], v[204:207], v[240:243], v[132:135]
    ds_read_b64_tr_b16 v[200:201], v38 offset:8192
    ds_read_b64_tr_b16 v[202:203], v38 offset:8704
    s_xor_b32 s96, s17, 20480
    s_add_u32 s20, s96, s19
    buffer_load_dwordx4 v[240:243], v2, s[32:35], s20 offen sc1
    s_waitcnt vmcnt(7)
    s_waitcnt lgkmcnt(6)
    v_mfma_f32_16x16x32_bf16 v[120:123], v[208:211], v[244:247], v[120:123]
    ds_read_b64_tr_b16 v[204:205], v39 offset:8192
    ds_read_b64_tr_b16 v[206:207], v39 offset:8704
    v_mfma_f32_16x16x32_bf16 v[124:127], v[212:215], v[244:247], v[124:127]
    ds_read_b64_tr_b16 v[208:209], v36 offset:12288
    ds_read_b64_tr_b16 v[210:211], v36 offset:12800
    v_xor_b32 v36, 114688, v36
    v_mfma_f32_16x16x32_bf16 v[128:131], v[216:219], v[244:247], v[128:131]
    ds_read_b64_tr_b16 v[212:213], v37 offset:12288
    ds_read_b64_tr_b16 v[214:215], v37 offset:12800
    v_xor_b32 v37, 114688, v37
    v_mfma_f32_16x16x32_bf16 v[132:135], v[220:223], v[244:247], v[132:135]
    ds_read_b64_tr_b16 v[216:217], v38 offset:12288
    ds_read_b64_tr_b16 v[218:219], v38 offset:12800
    v_xor_b32 v38, 114688, v38
    buffer_load_dwordx4 v[244:247], v2, s[32:35], s20 offen offset:1024 sc1
    s_waitcnt vmcnt(7)
    s_waitcnt lgkmcnt(6)
    v_mfma_f32_16x16x32_bf16 v[120:123], v[192:195], v[44:47], v[120:123]
    ds_read_b64_tr_b16 v[220:221], v39 offset:12288
    ds_read_b64_tr_b16 v[222:223], v39 offset:12800
L_PAD8:
    s_cbranch_execz L_RET8
    v_xor_b32 v39, 114688, v39
    v_mfma_f32_16x16x32_bf16 v[124:127], v[196:199], v[44:47], v[124:127]
    ds_read_b64_tr_b16 v[192:193], v36
    ds_read_b64_tr_b16 v[194:195], v36 offset:512
    v_mfma_f32_16x16x32_bf16 v[128:131], v[200:203], v[44:47], v[128:131]
    ds_read_b64_tr_b16 v[196:197], v37
    ds_read_b64_tr_b16 v[198:199], v37 offset:512
    v_mfma_f32_16x16x32_bf16 v[132:135], v[204:207], v[44:47], v[132:135]
    ds_read_b64_tr_b16 v[200:201], v38
    ds_read_b64_tr_b16 v[202:203], v38 offset:512
    buffer_load_dwordx4 v[44:47], v2, s[32:35], s20 offen offset:2048 sc1
    s_waitcnt vmcnt(7)
    s_waitcnt lgkmcnt(6)
    v_mfma_f32_16x16x32_bf16 v[120:123], v[208:211], v[48:51], v[120:123]
    ds_read_b64_tr_b16 v[204:205], v39
    ds_read_b64_tr_b16 v[206:207], v39 offset:512
    v_mfma_f32_16x16x32_bf16 v[124:127], v[212:215], v[48:51], v[124:127]
    ds_read_b64_tr_b16 v[208:209], v36 offset:4096
    ds_read_b64_tr_b16 v[210:211], v36 offset:4608
    v_mfma_f32_16x16x32_bf16 v[128:131], v[216:219], v[48:51], v[128:131]
    ds_read_b64_tr_b16 v[212:213], v37 offset:4096
    ds_read_b64_tr_b16 v[214:215], v37 offset:4608
    v_mfma_f32_16x16x32_bf16 v[132:135], v[220:223], v[48:51], v[132:135]
    ds_read_b64_tr_b16 v[216:217], v38 offset:4096
    ds_read_b64_tr_b16 v[218:219], v38 offset:4608
    buffer_load_dwordx4 v[48:51], v2, s[32:35], s20 offen offset:3072 sc1
    s_waitcnt vmcnt(7)
    s_waitcnt lgkmcnt(6)
    v_mfma_f32_16x16x32_bf16 v[120:123], v[192:195], v[224:227], v[120:123]
    ds_read_b64_tr_b16 v[220:221], v39 offset:4096
    ds_read_b64_tr_b16 v[222:223], v39 offset:4608
    v_mfma_f32_16x16x32_bf16 v[124:127], v[196:199], v[224:227], v[124:127]
    ds_read_b64_tr_b16 v[192:193], v36 offset:8192
    ds_read_b64_tr_b16 v[194:195], v36 offset:8704
    v_mfma_f32_16x16x32_bf16 v[128:131], v[200:203], v[224:227], v[128:131]
    ds_read_b64_tr_b16 v[196:197], v37 offset:8192
    ds_read_b64_tr_b16 v[198:199], v37 offset:8704
    v_mfma_f32_16x16x32_bf16 v[132:135], v[204:207], v[224:227], v[132:135]
    ds_read_b64_tr_b16 v[200:201], v38 offset:8192
    ds_read_b64_tr_b16 v[202:203], v38 offset:8704
    s_xor_b32 s96, s17, 24576
    s_add_u32 s20, s96, s19
    buffer_load_dwordx4 v[224:227], v2, s[32:35], s20 offen sc1
    s_waitcnt vmcnt(7)
    s_waitcnt lgkmcnt(6)
    v_mfma_f32_16x16x32_bf16 v[120:123], v[208:211], v[228:231], v[120:123]
    ds_read_b64_tr_b16 v[204:205], v39 offset:8192
    ds_read_b64_tr_b16 v[206:207], v39 offset:8704
    v_mfma_f32_16x16x32_bf16 v[124:127], v[212:215], v[228:231], v[124:127]
    ds_read_b64_tr_b16 v[208:209], v36 offset:12288
    ds_read_b64_tr_b16 v[210:211], v36 offset:12800
    v_xor_b32 v36, 16384, v36
    v_mfma_f32_16x16x32_bf16 v[128:131], v[216:219], v[228:231], v[128:131]
    ds_read_b64_tr_b16 v[212:213], v37 offset:12288
    ds_read_b64_tr_b16 v[214:215], v37 offset:12800
    v_xor_b32 v37, 16384, v37
    v_mfma_f32_16x16x32_bf16 v[132:135], v[220:223], v[228:231], v[132:135]
    ds_read_b64_tr_b16 v[216:217], v38 offset:12288
    ds_read_b64_tr_b16 v[218:219], v38 offset:12800
    v_xor_b32 v38, 16384, v38
    buffer_load_dwordx4 v[228:231], v2, s[32:35], s20 offen offset:1024 sc1
    s_waitcnt vmcnt(7)
    s_waitcnt lgkmcnt(6)
    v_mfma_f32_16x16x32_bf16 v[120:123], v[192:195], v[232:235], v[120:123]
    ds_read_b64_tr_b16 v[220:221], v39 offset:12288
    ds_read_b64_tr_b16 v[222:223], v39 offset:12800
    v_xor_b32 v39, 16384, v39
    v_mfma_f32_16x16x32_bf16 v[124:127], v[196:199], v[232:235], v[124:127]
    ds_read_b64_tr_b16 v[192:193], v36
    ds_read_b64_tr_b16 v[194:195], v36 offset:512
    v_mfma_f32_16x16x32_bf16 v[128:131], v[200:203], v[232:235], v[128:131]
    ds_read_b64_tr_b16 v[196:197], v37
    ds_read_b64_tr_b16 v[198:199], v37 offset:512
    v_mfma_f32_16x16x32_bf16 v[132:135], v[204:207], v[232:235], v[132:135]
    ds_read_b64_tr_b16 v[200:201], v38
    ds_read_b64_tr_b16 v[202:203], v38 offset:512
    buffer_load_dwordx4 v[232:235], v2, s[32:35], s20 offen offset:2048 sc1
    s_waitcnt vmcnt(7)
    s_waitcnt lgkmcnt(6)
    v_mfma_f32_16x16x32_bf16 v[120:123], v[208:211], v[236:239], v[120:123]
    ds_read_b64_tr_b16 v[204:205], v39
    ds_read_b64_tr_b16 v[206:207], v39 offset:512
    v_mfma_f32_16x16x32_bf16 v[124:127], v[212:215], v[236:239], v[124:127]
    ds_read_b64_tr_b16 v[208:209], v36 offset:4096
    ds_read_b64_tr_b16 v[210:211], v36 offset:4608
    v_mfma_f32_16x16x32_bf16 v[128:131], v[216:219], v[236:239], v[128:131]
    ds_read_b64_tr_b16 v[212:213], v37 offset:4096
    ds_read_b64_tr_b16 v[214:215], v37 offset:4608
    v_mfma_f32_16x16x32_bf16 v[132:135], v[220:223], v[236:239], v[132:135]
    ds_read_b64_tr_b16 v[216:217], v38 offset:4096
    ds_read_b64_tr_b16 v[218:219], v38 offset:4608
    buffer_load_dwordx4 v[236:239], v2, s[32:35], s20 offen offset:3072 sc1
    s_waitcnt vmcnt(7)
    s_waitcnt lgkmcnt(6)
    v_mfma_f32_16x16x32_bf16 v[120:123], v[192:195], v[240:243], v[120:123]
    ds_read_b64_tr_b16 v[220:221], v39 offset:4096
    ds_read_b64_tr_b16 v[222:223], v39 offset:4608
    v_mfma_f32_16x16x32_bf16 v[124:127], v[196:199], v[240:243], v[124:127]
    ds_read_b64_tr_b16 v[192:193], v36 offset:8192
    ds_read_b64_tr_b16 v[194:195], v36 offset:8704
    v_mfma_f32_16x16x32_bf16 v[128:131], v[200:203], v[240:243], v[128:131]
    ds_read_b64_tr_b16 v[196:197], v37 offset:8192
    ds_read_b64_tr_b16 v[198:199], v37 offset:8704
    v_mfma_f32_16x16x32_bf16 v[132:135], v[204:207], v[240:243], v[132:135]
    ds_read_b64_tr_b16 v[200:201], v38 offset:8192
    ds_read_b64_tr_b16 v[202:203], v38 offset:8704
    s_xor_b32 s96, s17, 28672
    s_add_u32 s20, s96, s19
    buffer_load_dwordx4 v[240:243], v2, s[32:35], s20 offen sc1
    s_waitcnt vmcnt(7)
    s_waitcnt lgkmcnt(6)
    v_mfma_f32_16x16x32_bf16 v[120:123], v[208:211], v[244:247], v[120:123]
    ds_read_b64_tr_b16 v[204:205], v39 offset:8192
    ds_read_b64_tr_b16 v[206:207], v39 offset:8704
    v_mfma_f32_16x16x32_bf16 v[124:127], v[212:215], v[244:247], v[124:127]
    ds_read_b64_tr_b16 v[208:209], v36 offset:12288
    ds_read_b64_tr_b16 v[210:211], v36 offset:12800
    v_xor_b32 v36, 49152, v36
    v_mfma_f32_16x16x32_bf16 v[128:131], v[216:219], v[244:247], v[128:131]
    ds_read_b64_tr_b16 v[212:213], v37 offset:12288
    ds_read_b64_tr_b16 v[214:215], v37 offset:12800
    v_xor_b32 v37, 49152, v37
    v_mfma_f32_16x16x32_bf16 v[132:135], v[220:223], v[244:247], v[132:135]
    ds_read_b64_tr_b16 v[216:217], v38 offset:12288
    ds_read_b64_tr_b16 v[218:219], v38 offset:12800
    v_xor_b32 v38, 49152, v38
    buffer_load_dwordx4 v[244:247], v2, s[32:35], s20 offen offset:1024 sc1
    s_waitcnt vmcnt(7)
    s_waitcnt lgkmcnt(6)
    v_mfma_f32_16x16x32_bf16 v[120:123], v[192:195], v[44:47], v[120:123]
    ds_read_b64_tr_b16 v[220:221], v39 offset:12288
    ds_read_b64_tr_b16 v[222:223], v39 offset:12800
    v_xor_b32 v39, 49152, v39
    v_mfma_f32_16x16x32_bf16 v[124:127], v[196:199], v[44:47], v[124:127]
    ds_read_b64_tr_b16 v[192:193], v36
    ds_read_b64_tr_b16 v[194:195], v36 offset:512
    v_mfma_f32_16x16x32_bf16 v[128:131], v[200:203], v[44:47], v[128:131]
    ds_read_b64_tr_b16 v[196:197], v37
    ds_read_b64_tr_b16 v[198:199], v37 offset:512
    v_mfma_f32_16x16x32_bf16 v[132:135], v[204:207], v[44:47], v[132:135]
    ds_read_b64_tr_b16 v[200:201], v38
    ds_read_b64_tr_b16 v[202:203], v38 offset:512
    buffer_load_dwordx4 v[44:47], v2, s[32:35], s20 offen offset:2048 sc1
    s_waitcnt vmcnt(7)
    s_waitcnt lgkmcnt(6)
    v_mfma_f32_16x16x32_bf16 v[120:123], v[208:211], v[48:51], v[120:123]
    ds_read_b64_tr_b16 v[204:205], v39
    ds_read_b64_tr_b16 v[206:207], v39 offset:512
    v_mfma_f32_16x16x32_bf16 v[124:127], v[212:215], v[48:51], v[124:127]
    ds_read_b64_tr_b16 v[208:209], v36 offset:4096
    ds_read_b64_tr_b16 v[210:211], v36 offset:4608
    v_mfma_f32_16x16x32_bf16 v[128:131], v[216:219], v[48:51], v[128:131]
    ds_read_b64_tr_b16 v[212:213], v37 offset:4096
    ds_read_b64_tr_b16 v[214:215], v37 offset:4608
    v_mfma_f32_16x16x32_bf16 v[132:135], v[220:223], v[48:51], v[132:135]
    ds_read_b64_tr_b16 v[216:217], v38 offset:4096
    ds_read_b64_tr_b16 v[218:219], v38 offset:4608
    buffer_load_dwordx4 v[48:51], v2, s[32:35], s20 offen offset:3072 sc1
    buffer_load_dwordx2 v[40:41], v10, s[32:35], s13 offen sc1
    s_add_u32 s82, s80, 114688
    buffer_load_dwordx4 v[72:75], v27, s[52:55], s82 offen nt
    s_add_u32 s82, s80, 172032
    buffer_load_dwordx4 v[76:79], v27, s[52:55], s82 offen nt
    s_waitcnt vmcnt(10)
    s_waitcnt lgkmcnt(6)
    v_mfma_f32_16x16x32_bf16 v[120:123], v[192:195], v[224:227], v[120:123]
    ds_read_b64_tr_b16 v[220:221], v39 offset:4096
    ds_read_b64_tr_b16 v[222:223], v39 offset:4608
    v_mfma_f32_16x16x32_bf16 v[124:127], v[196:199], v[224:227], v[124:127]
    ds_read_b64_tr_b16 v[192:193], v36 offset:8192
    ds_read_b64_tr_b16 v[194:195], v36 offset:8704
    v_mfma_f32_16x16x32_bf16 v[128:131], v[200:203], v[224:227], v[128:131]
    ds_read_b64_tr_b16 v[196:197], v37 offset:8192
    ds_read_b64_tr_b16 v[198:199], v37 offset:8704
    v_mfma_f32_16x16x32_bf16 v[132:135], v[204:207], v[224:227], v[132:135]
    ds_read_b64_tr_b16 v[200:201], v38 offset:8192
    ds_read_b64_tr_b16 v[202:203], v38 offset:8704
    s_waitcnt vmcnt(9)
    s_waitcnt lgkmcnt(6)
    v_mfma_f32_16x16x32_bf16 v[120:123], v[208:211], v[228:231], v[120:123]
    ds_read_b64_tr_b16 v[204:205], v39 offset:8192
    ds_read_b64_tr_b16 v[206:207], v39 offset:8704
    v_mfma_f32_16x16x32_bf16 v[124:127], v[212:215], v[228:231], v[124:127]
    ds_read_b64_tr_b16 v[208:209], v36 offset:12288
    ds_read_b64_tr_b16 v[210:211], v36 offset:12800
    v_xor_b32 v36, 16384, v36
    v_mfma_f32_16x16x32_bf16 v[128:131], v[216:219], v[228:231], v[128:131]
    ds_read_b64_tr_b16 v[212:213], v37 offset:12288
    ds_read_b64_tr_b16 v[214:215], v37 offset:12800
    v_xor_b32 v37, 16384, v37
    v_mfma_f32_16x16x32_bf16 v[132:135], v[220:223], v[228:231], v[132:135]
    ds_read_b64_tr_b16 v[216:217], v38 offset:12288
    ds_read_b64_tr_b16 v[218:219], v38 offset:12800
    v_xor_b32 v38, 16384, v38
    s_waitcnt vmcnt(8)
    s_waitcnt lgkmcnt(6)
    v_mfma_f32_16x16x32_bf16 v[120:123], v[192:195], v[232:235], v[120:123]
    ds_read_b64_tr_b16 v[220:221], v39 offset:12288
    ds_read_b64_tr_b16 v[222:223], v39 offset:12800
    v_xor_b32 v39, 16384, v39
    v_mfma_f32_16x16x32_bf16 v[124:127], v[196:199], v[232:235], v[124:127]
    ds_read_b64_tr_b16 v[192:193], v36
    ds_read_b64_tr_b16 v[194:195], v36 offset:512
    v_mfma_f32_16x16x32_bf16 v[128:131], v[200:203], v[232:235], v[128:131]
    ds_read_b64_tr_b16 v[196:197], v37
    ds_read_b64_tr_b16 v[198:199], v37 offset:512
    v_mfma_f32_16x16x32_bf16 v[132:135], v[204:207], v[232:235], v[132:135]
    ds_read_b64_tr_b16 v[200:201], v38
    ds_read_b64_tr_b16 v[202:203], v38 offset:512
    s_waitcnt vmcnt(7)
    s_waitcnt lgkmcnt(6)
    v_mfma_f32_16x16x32_bf16 v[120:123], v[208:211], v[236:239], v[120:123]
    ds_read_b64_tr_b16 v[204:205], v39
    ds_read_b64_tr_b16 v[206:207], v39 offset:512
    v_mfma_f32_16x16x32_bf16 v[124:127], v[212:215], v[236:239], v[124:127]
    ds_read_b64_tr_b16 v[208:209], v36 offset:4096
    ds_read_b64_tr_b16 v[210:211], v36 offset:4608
    v_mfma_f32_16x16x32_bf16 v[128:131], v[216:219], v[236:239], v[128:131]
    ds_read_b64_tr_b16 v[212:213], v37 offset:4096
    ds_read_b64_tr_b16 v[214:215], v37 offset:4608
    v_mfma_f32_16x16x32_bf16 v[132:135], v[220:223], v[236:239], v[132:135]
    ds_read_b64_tr_b16 v[216:217], v38 offset:4096
    ds_read_b64_tr_b16 v[218:219], v38 offset:4608
    s_cmp_lt_u32 s3, 4
    s_cbranch_scc1 L_G2P28
    s_setprio 0
L_G2P28:
    s_waitcnt vmcnt(6)
    s_waitcnt lgkmcnt(6)
    v_mfma_f32_16x16x32_bf16 v[120:123], v[192:195], v[240:243], v[120:123]
    ds_read_b64_tr_b16 v[220:221], v39 offset:4096
    ds_read_b64_tr_b16 v[222:223], v39 offset:4608
    v_mfma_f32_16x16x32_bf16 v[124:127], v[196:199], v[240:243], v[124:127]
    ds_read_b64_tr_b16 v[192:193], v36 offset:8192
    ds_read_b64_tr_b16 v[194:195], v36 offset:8704
    v_mfma_f32_16x16x32_bf16 v[128:131], v[200:203], v[240:243], v[128:131]
    ds_read_b64_tr_b16 v[196:197], v37 offset:8192
    ds_read_b64_tr_b16 v[198:199], v37 offset:8704
    v_mfma_f32_16x16x32_bf16 v[132:135], v[204:207], v[240:243], v[132:135]
    ds_read_b64_tr_b16 v[200:201], v38 offset:8192
    ds_read_b64_tr_b16 v[202:203], v38 offset:8704
    s_waitcnt vmcnt(5)
    s_waitcnt lgkmcnt(6)
    v_mfma_f32_16x16x32_bf16 v[120:123], v[208:211], v[244:247], v[120:123]
    ds_read_b64_tr_b16 v[204:205], v39 offset:8192
    ds_read_b64_tr_b16 v[206:207], v39 offset:8704
    v_mfma_f32_16x16x32_bf16 v[124:127], v[212:215], v[244:247], v[124:127]
    ds_read_b64_tr_b16 v[208:209], v36 offset:12288
    ds_read_b64_tr_b16 v[210:211], v36 offset:12800
    v_mfma_f32_16x16x32_bf16 v[128:131], v[216:219], v[244:247], v[128:131]
    ds_read_b64_tr_b16 v[212:213], v37 offset:12288
    ds_read_b64_tr_b16 v[214:215], v37 offset:12800
    v_mfma_f32_16x16x32_bf16 v[132:135], v[220:223], v[244:247], v[132:135]
    ds_read_b64_tr_b16 v[216:217], v38 offset:12288
    ds_read_b64_tr_b16 v[218:219], v38 offset:12800
    s_waitcnt vmcnt(4)
    s_waitcnt lgkmcnt(6)
    v_mfma_f32_16x16x32_bf16 v[120:123], v[192:195], v[44:47], v[120:123]
    ds_read_b64_tr_b16 v[220:221], v39 offset:12288
    ds_read_b64_tr_b16 v[222:223], v39 offset:12800
    v_mfma_f32_16x16x32_bf16 v[124:127], v[196:199], v[44:47], v[124:127]
    v_mfma_f32_16x16x32_bf16 v[128:131], v[200:203], v[44:47], v[128:131]
    v_mfma_f32_16x16x32_bf16 v[132:135], v[204:207], v[44:47], v[132:135]
    s_waitcnt vmcnt(3)
    s_waitcnt lgkmcnt(0)
    v_mfma_f32_16x16x32_bf16 v[120:123], v[208:211], v[48:51], v[120:123]
    v_mfma_f32_16x16x32_bf16 v[124:127], v[212:215], v[48:51], v[124:127]
    v_mfma_f32_16x16x32_bf16 v[128:131], v[216:219], v[48:51], v[128:131]
    v_mfma_f32_16x16x32_bf16 v[132:135], v[220:223], v[48:51], v[132:135]
    s_lshl3_add_u32 s96, s21, s3
    s_lshl4_add_u32 s97, s96, s12
    s_lshl_b32 s98, s97, 8
    s_add_u32 s14, s98, 12582912
    v_and_b32 v28, 15, v1
    v_lshlrev_b32 v28, 4, v28
    v_lshrrev_b32 v9, 4, v1
    v_lshl_add_u32 v28, v9, 2, v28
    v_cvt_pk_bf16_f32 v120, 0, v120
    v_cvt_pk_bf16_f32 v121, 0, v121
    v_cvt_pk_bf16_f32 v122, 0, v122
    v_cvt_pk_bf16_f32 v123, 0, v123
    v_cvt_pk_bf16_f32 v124, 0, v124
    v_cvt_pk_bf16_f32 v125, 0, v125
    v_cvt_pk_bf16_f32 v126, 0, v126
    v_cvt_pk_bf16_f32 v127, 0, v127
    v_pk_mul_f32 v[120:121], v[120:121], v[136:137]
    v_pk_mul_f32 v[122:123], v[122:123], v[138:139]
    v_pk_mul_f32 v[124:125], v[124:125], v[140:141]
    v_pk_mul_f32 v[126:127], v[126:127], v[142:143]
    v_cvt_pk_bf16_f32 v120, 0, v120
    v_cvt_pk_bf16_f32 v121, 0, v121
    v_cvt_pk_bf16_f32 v122, 0, v122
    v_cvt_pk_bf16_f32 v123, 0, v123
    v_cvt_pk_bf16_f32 v124, 0, v124
    v_cvt_pk_bf16_f32 v125, 0, v125
    v_cvt_pk_bf16_f32 v126, 0, v126
    v_cvt_pk_bf16_f32 v127, 0, v127
    v_pk_add_f32 v[120:121], v[120:121], v[152:153]
    v_pk_add_f32 v[122:123], v[122:123], v[154:155]
    v_pk_add_f32 v[124:125], v[124:125], v[156:157]
    v_pk_add_f32 v[126:127], v[126:127], v[158:159]
    v_cvt_pk_bf16_f32 v12, v120, v121
    v_cvt_pk_bf16_f32 v13, v122, v123
    v_cvt_pk_bf16_f32 v14, v124, v125
    v_cvt_pk_bf16_f32 v15, v126, v127
    v_dot2_f32_bf16 v4, v12, v12, 0
    v_dot2_f32_bf16 v5, v13, v13, 0
    v_dot2_f32_bf16 v4, v14, v14, v4
    v_dot2_f32_bf16 v5, v15, v15, v5
    v_mfma_f32_16x16x32_bf16 v[240:243], v[184:187], v[12:15], 0
    v_cvt_pk_bf16_f32 v128, 0, v128
    v_cvt_pk_bf16_f32 v129, 0, v129
    v_cvt_pk_bf16_f32 v130, 0, v130
    v_cvt_pk_bf16_f32 v131, 0, v131
    v_cvt_pk_bf16_f32 v132, 0, v132
    v_cvt_pk_bf16_f32 v133, 0, v133
    v_cvt_pk_bf16_f32 v134, 0, v134
    v_cvt_pk_bf16_f32 v135, 0, v135
    v_pk_mul_f32 v[128:129], v[128:129], v[144:145]
    v_pk_mul_f32 v[130:131], v[130:131], v[146:147]
    v_pk_mul_f32 v[132:133], v[132:133], v[148:149]
    v_pk_mul_f32 v[134:135], v[134:135], v[150:151]
    v_cvt_pk_bf16_f32 v128, 0, v128
    v_cvt_pk_bf16_f32 v129, 0, v129
    v_cvt_pk_bf16_f32 v130, 0, v130
    v_cvt_pk_bf16_f32 v131, 0, v131
    v_cvt_pk_bf16_f32 v132, 0, v132
    v_cvt_pk_bf16_f32 v133, 0, v133
    v_cvt_pk_bf16_f32 v134, 0, v134
    v_cvt_pk_bf16_f32 v135, 0, v135
    v_pk_add_f32 v[128:129], v[128:129], v[160:161]
    v_pk_add_f32 v[130:131], v[130:131], v[162:163]
    v_pk_add_f32 v[132:133], v[132:133], v[164:165]
    v_pk_add_f32 v[134:135], v[134:135], v[166:167]
    v_cvt_pk_bf16_f32 v16, v128, v129
    v_cvt_pk_bf16_f32 v17, v130, v131
    v_cvt_pk_bf16_f32 v18, v132, v133
    v_cvt_pk_bf16_f32 v19, v134, v135
    v_dot2_f32_bf16 v4, v16, v16, v4
    v_dot2_f32_bf16 v5, v17, v17, v5
    v_dot2_f32_bf16 v4, v18, v18, v4
    v_dot2_f32_bf16 v5, v19, v19, v5
    v_mfma_f32_16x16x32_bf16 v[240:243], v[188:191], v[16:19], v[240:243]
    v_and_b32 v7, 7, v1
    v_lshlrev_b32 v7, 15, v7
    v_bfe_u32 v9, v1, 3, 1
    v_lshl_add_u32 v7, v9, 12, v7
    v_add_f32 v4, v4, v5
    v_mov_b32 v5, v4
    s_nop 1
    v_permlane32_swap_b32 v4, v5
    v_add_f32 v4, v4, v5
    v_mov_b32 v5, v4
    s_nop 1
    v_permlane16_swap_b32 v4, v5
    v_add_f32 v4, v4, v5
    s_nop 1
    v_mov_b32_dpp v240, v4 quad_perm:[0,1,2,3] row_mask:0x8 bank_mask:0xf
    buffer_store_dword v240, v28, s[32:35], s14 offen sc1
    s_and_b32 s96, s12, 1
    s_lshr_b32 s97, s21, 2
    s_and_b32 s98, s21, 3
    s_lshl_b32 s99, s98, 6
    s_lshl1_add_u32 s98, s97, s99
    s_lshl_b32 s97, s98, 12
    s_lshr_b32 s99, s12, 1
    s_lshl_b32 s98, s99, 6
    s_add_u32 s99, s97, s98
    s_lshl2_add_u32 s97, s96, s99
    s_add_u32 s98, s97, 1048576
    s_add_u32 s16, s98, 1536
    s_barrier
    s_cmp_lg_u32 s3, 0
    s_cbranch_scc1 L_PE
    v_mov_b32 v6, s4
    s_mov_b32 exec_hi, 0
    s_mov_b32 exec_lo, 65535
    buffer_store_dword v6, v7, s[32:35], s16 offen sc1
    s_mov_b64 exec, -1
L_PE:
    s_mov_b32 s82, s80
    s_lshl2_add_u32 m0, s83, 32768
    s_nop 0
    buffer_load_dwordx4 v27, s[56:59], s82 offen nt lds
    s_add_u32 s82, s80, 57344
    s_lshl2_add_u32 m0, s83, 33792
    s_nop 0
    buffer_load_dwordx4 v27, s[56:59], s82 offen nt lds
    s_lshl_b32 s15, s3, 12
    v_add_u32 v4, s15, v2
    v_add_u32 v7, 65536, v4
    s_waitcnt vmcnt(5)
    v_cmp_ne_u32 vcc, s4, v41
    s_cbranch_vccz L_UPOK
POLL_31:
    buffer_load_dwordx2 v[40:41], v10, s[32:35], s13 offen sc1
    s_waitcnt vmcnt(0)
    v_cmp_ne_u32 vcc, s4, v41
    s_cbranch_vccz PDONE_32
    s_add_u32 s5, s5, 1
    s_cmp_lt_u32 s5, 200000
    s_cbranch_scc1 POLL_31
PDONE_32:
L_UPOK:
    s_lshl3_add_u32 s96, s21, s3
    s_lshl_b32 s97, s96, 12
    s_add_u32 s14, s97, 12582912
    s_load_dwordx2 s[24:25], s[32:33], s92 offset:1536 glc
    v_add_f32_dpp v40, v40, v40 quad_perm:[1,0,3,2] row_mask:0xf bank_mask:0xf
    s_nop 1
    v_add_f32_dpp v40, v40, v40 quad_perm:[2,3,0,1] row_mask:0xf bank_mask:0xf
    s_nop 1
    v_add_f32_dpp v40, v40, v40 row_half_mirror row_mask:0xf bank_mask:0xf
    s_nop 1
    v_add_f32_dpp v40, v40, v40 row_mirror row_mask:0xf bank_mask:0xf
    v_lshlrev_b32 v152, 16, v12
    v_and_b32 v153, s6, v12
    v_lshlrev_b32 v154, 16, v13
    v_and_b32 v155, s6, v13
    v_lshlrev_b32 v156, 16, v14
    v_and_b32 v157, s6, v14
    v_lshlrev_b32 v158, 16, v15
    v_and_b32 v159, s6, v15
    v_lshlrev_b32 v160, 16, v16
    v_and_b32 v161, s6, v16
    v_lshlrev_b32 v162, 16, v17
    v_and_b32 v163, s6, v17
    v_lshlrev_b32 v164, 16, v18
    v_and_b32 v165, s6, v18
    v_lshlrev_b32 v166, 16, v19
    v_and_b32 v167, s6, v19
    s_lshl_b32 s96, s3, 9
    s_lshl1_add_u32 s15, s21, s96
    v_and_b32 v29, 15, v1
    v_lshl_add_u32 v29, v29, 5, s15
    v_xor_b32 v5, 0x4000, v4
    v_xor_b32 v8, 0x4000, v7
    s_waitcnt vmcnt(3)
    ds_write_b128 v4, v[72:75] offset:2048
    ds_write_b128 v4, v[76:79] offset:3072
    s_cmp_lt_u32 s3, 4
    s_cbranch_scc1 L_FW1
    ds_write_b128 v4, v[56:59] offset:0
    ds_write_b128 v5, v[60:63] offset:0
    ds_write_b128 v4, v[64:67] offset:1024
    ds_write_b128 v5, v[68:71] offset:1024
L_FW1:
    s_branch SCHK_34
SPOLL_33:
    s_load_dwordx2 s[24:25], s[32:33], s92 offset:1536 glc
SCHK_34:
    s_add_u32 s5, s5, 1
    s_cmp_ge_u32 s5, 200000
    s_waitcnt lgkmcnt(0)
    s_cbranch_scc1 SDONE_35
    s_cmp_lg_u32 s24, s4
    s_cbranch_scc1 SPOLL_33
    s_cmp_lg_u32 s25, s4
    s_cbranch_scc1 SPOLL_33
SDONE_35:
    s_barrier
    buffer_load_dwordx4 v[192:195], v2, s[32:35], s14 offen sc1
    buffer_load_dwordx4 v[196:199], v2, s[32:35], s14 offen offset:1024 sc1
    buffer_load_dwordx4 v[200:203], v2, s[32:35], s14 offen offset:2048 sc1
    buffer_load_dwordx4 v[204:207], v2, s[32:35], s14 offen offset:3072 sc1
    s_barrier
    s_add_u32 s82, s80, 114688
    s_lshl2_add_u32 m0, s83, 34816
    s_nop 0
    buffer_load_dwordx4 v27, s[56:59], s82 offen nt lds
    s_add_u32 s82, s80, 172032
    s_lshl2_add_u32 m0, s83, 35840
    s_nop 0
    buffer_load_dwordx4 v27, s[56:59], s82 offen nt lds
    v_mov_b32_dpp v168, v33 row_newbcast:0 row_mask:0xf bank_mask:0xf
    v_mov_b32_dpp v169, v33 row_newbcast:1 row_mask:0xf bank_mask:0xf
    v_mov_b32_dpp v170, v33 row_newbcast:2 row_mask:0xf bank_mask:0xf
    v_mov_b32_dpp v171, v33 row_newbcast:3 row_mask:0xf bank_mask:0xf
    v_mov_b32_dpp v172, v33 row_newbcast:4 row_mask:0xf bank_mask:0xf
    v_mov_b32_dpp v173, v33 row_newbcast:5 row_mask:0xf bank_mask:0xf
    v_mov_b32_dpp v174, v33 row_newbcast:6 row_mask:0xf bank_mask:0xf
    v_mov_b32_dpp v175, v33 row_newbcast:7 row_mask:0xf bank_mask:0xf
    v_mov_b32_dpp v176, v33 row_newbcast:8 row_mask:0xf bank_mask:0xf
    v_mov_b32_dpp v177, v33 row_newbcast:9 row_mask:0xf bank_mask:0xf
    v_mov_b32_dpp v178, v33 row_newbcast:10 row_mask:0xf bank_mask:0xf
    v_mov_b32_dpp v179, v33 row_newbcast:11 row_mask:0xf bank_mask:0xf
    v_mov_b32_dpp v180, v33 row_newbcast:12 row_mask:0xf bank_mask:0xf
    v_mov_b32_dpp v181, v33 row_newbcast:13 row_mask:0xf bank_mask:0xf
    v_mov_b32_dpp v182, v33 row_newbcast:14 row_mask:0xf bank_mask:0xf
    v_mov_b32_dpp v183, v33 row_newbcast:15 row_mask:0xf bank_mask:0xf
    v_mov_b32_dpp v88, v42 row_newbcast:0 row_mask:0xf bank_mask:0xf
    v_mov_b32_dpp v89, v42 row_newbcast:1 row_mask:0xf bank_mask:0xf
    v_mov_b32_dpp v90, v42 row_newbcast:2 row_mask:0xf bank_mask:0xf
    v_mov_b32_dpp v91, v42 row_newbcast:3 row_mask:0xf bank_mask:0xf
    v_mov_b32_dpp v92, v42 row_newbcast:4 row_mask:0xf bank_mask:0xf
    v_mov_b32_dpp v93, v42 row_newbcast:5 row_mask:0xf bank_mask:0xf
    v_mov_b32_dpp v94, v42 row_newbcast:6 row_mask:0xf bank_mask:0xf
    v_mov_b32_dpp v95, v42 row_newbcast:7 row_mask:0xf bank_mask:0xf
    v_mov_b32_dpp v96, v42 row_newbcast:8 row_mask:0xf bank_mask:0xf
    v_mov_b32_dpp v97, v42 row_newbcast:9 row_mask:0xf bank_mask:0xf
    v_mov_b32_dpp v98, v42 row_newbcast:10 row_mask:0xf bank_mask:0xf
    v_mov_b32_dpp v99, v42 row_newbcast:11 row_mask:0xf bank_mask:0xf
    v_mov_b32_dpp v100, v42 row_newbcast:12 row_mask:0xf bank_mask:0xf
    v_mov_b32_dpp v101, v42 row_newbcast:13 row_mask:0xf bank_mask:0xf
    v_mov_b32_dpp v102, v42 row_newbcast:14 row_mask:0xf bank_mask:0xf
    v_mov_b32_dpp v103, v42 row_newbcast:15 row_mask:0xf bank_mask:0xf
    v_mov_b32_dpp v104, v43 row_newbcast:0 row_mask:0xf bank_mask:0xf
    v_mov_b32_dpp v105, v43 row_newbcast:1 row_mask:0xf bank_mask:0xf
    v_mov_b32_dpp v106, v43 row_newbcast:2 row_mask:0xf bank_mask:0xf
    v_mov_b32_dpp v107, v43 row_newbcast:3 row_mask:0xf bank_mask:0xf
    v_mov_b32_dpp v108, v43 row_newbcast:4 row_mask:0xf bank_mask:0xf
    v_mov_b32_dpp v109, v43 row_newbcast:5 row_mask:0xf bank_mask:0xf
    v_mov_b32_dpp v110, v43 row_newbcast:6 row_mask:0xf bank_mask:0xf
    v_mov_b32_dpp v111, v43 row_newbcast:7 row_mask:0xf bank_mask:0xf
    v_mov_b32_dpp v112, v43 row_newbcast:8 row_mask:0xf bank_mask:0xf
    v_mov_b32_dpp v113, v43 row_newbcast:9 row_mask:0xf bank_mask:0xf
    v_mov_b32_dpp v114, v43 row_newbcast:10 row_mask:0xf bank_mask:0xf
    v_mov_b32_dpp v115, v43 row_newbcast:11 row_mask:0xf bank_mask:0xf
    v_mov_b32_dpp v116, v43 row_newbcast:12 row_mask:0xf bank_mask:0xf
    v_mov_b32_dpp v117, v43 row_newbcast:13 row_mask:0xf bank_mask:0xf
    v_mov_b32_dpp v118, v43 row_newbcast:14 row_mask:0xf bank_mask:0xf
    v_mov_b32_dpp v119, v43 row_newbcast:15 row_mask:0xf bank_mask:0xf
    s_lshl3_add_u32 s15, s3, 156160
    v_mov_b32 v4, s15
    v_and_b32 v5, 7, v1
    v_lshlrev_b32 v5, 3, v5
    v_add_u32 v5, 156160, v5
    v_and_b32 v6, 3, v1
    v_lshlrev_b32 v6, 18, v6
    v_bfe_u32 v9, v1, 2, 2
    v_lshl_add_u32 v6, v9, 13, v6
    s_and_b32 s96, s21, 1
    s_and_b32 s97, s12, 7
    s_lshr_b32 s98, s12, 3
    s_lshl3_add_u32 s99, s97, s98
    s_lshl_b32 s97, s99, 12
    s_lshr_b32 s98, s21, 1
    s_lshl_b32 s99, s98, 6
    s_add_u32 s98, s97, s99
    s_lshl4_add_u32 s97, s96, s98
    s_add_u32 s99, s97, 1048576
    s_add_u32 s16, s99, 2560
    s_waitcnt vmcnt(2)
    v_pk_add_f32 v[192:193], v[192:193], v[196:197]
    v_pk_add_f32 v[200:201], v[200:201], v[204:205]
    v_pk_add_f32 v[194:195], v[194:195], v[198:199]
    v_pk_add_f32 v[202:203], v[202:203], v[206:207]
    v_pk_add_f32 v[192:193], v[192:193], v[200:201]
    v_pk_add_f32 v[194:195], v[194:195], v[202:203]
    v_add_f32 v193, v193, v194
    v_add_f32 v197, v192, v195
    v_cmp_u_f32 vcc, v193, v197
    s_cbranch_vccz POK_37
PRE_38:
    buffer_load_dwordx4 v[192:195], v2, s[32:35], s14 offen sc1
    buffer_load_dwordx4 v[196:199], v2, s[32:35], s14 offen offset:1024 sc1
    buffer_load_dwordx4 v[200:203], v2, s[32:35], s14 offen offset:2048 sc1
    buffer_load_dwordx4 v[204:207], v2, s[32:35], s14 offen offset:3072 sc1
    s_waitcnt vmcnt(0)
    v_pk_add_f32 v[192:193], v[192:193], v[196:197]
    v_pk_add_f32 v[200:201], v[200:201], v[204:205]
    v_pk_add_f32 v[194:195], v[194:195], v[198:199]
    v_pk_add_f32 v[202:203], v[202:203], v[206:207]
    v_pk_add_f32 v[192:193], v[192:193], v[200:201]
    v_pk_add_f32 v[194:195], v[194:195], v[202:203]
    v_add_f32 v193, v193, v194
    v_add_f32 v197, v192, v195
    v_cmp_u_f32 vcc, v193, v197
    s_cbranch_vccz POK_37
    s_add_u32 s5, s5, 1
    s_cmp_lt_u32 s5, 200000
    s_cbranch_scc1 PRE_38
POK_37:
    v_mov_b32 v196, v195
    s_nop 1
    v_permlane32_swap_b32 v195, v196
    v_permlane32_swap_b32 v192, v193
    v_add_f32 v195, v195, v196
    v_add_f32 v192, v192, v193
    s_nop 1
    v_permlane16_swap_b32 v192, v195
    v_add_f32 v193, v192, v195
    v_add_f32 v195, v192, v195
    s_nop 1
    v_permlane16_swap_b32 v193, v195
    v_mov_b32 v192, v193
    v_mul_f32 v195, 0x3a800000, v195
    s_nop 0
    v_permlane32_swap_b32 v192, v193
    v_mul_f32 v192, 0x3a800000, v192
    v_fma_f32 v31, -v192, v192, v195
    v_cvt_pk_bf16_f32 v30, 0, v192
    v_max_f32 v31, 0, v31
    v_cvt_pk_bf16_f32 v31, 0, v31
    v_fma_f32 v193, -v30, v40, v193
    v_add_f32 v31, 0x3727c5ac, v31
    v_cvt_pk_bf16_f32 v31, 0, v31
    v_sqrt_f32 v31, v31
    s_nop 0
    v_cvt_pk_bf16_f32 v31, 0, v31
    v_rcp_f32 v31, v31
    s_nop 0
    v_mul_f32 v32, v193, v31
    v_ashrrev_i32 v196, 31, v32
    v_or_b32 v196, 0x80000000, v196
    v_xor_b32 v32, v32, v196
    s_mov_b32 s15, 0xfffff000
    v_and_or_b32 v32, v32, s15, v29
    s_nop 1
    v_max_u32_dpp v244, v32, v32 quad_perm:[1,0,3,2] row_mask:0xf bank_mask:0xf
L_PAD9:
    s_cbranch_execz L_RET9
    v_min_u32_dpp v245, v32, v32 quad_perm:[1,0,3,2] row_mask:0xf bank_mask:0xf
    s_nop 0
    v_min_u32_dpp v196, v244, v244 quad_perm:[2,3,0,1] row_mask:0xf bank_mask:0xf
    v_max_u32_dpp v245, v245, v245 quad_perm:[2,3,0,1] row_mask:0xf bank_mask:0xf
    v_max_u32_dpp v244, v244, v244 quad_perm:[2,3,0,1] row_mask:0xf bank_mask:0xf
    v_max_u32 v245, v245, v196
    s_nop 0
    v_min_u32_dpp v196, v244, v244 row_half_mirror row_mask:0xf bank_mask:0xf
    v_max_u32_dpp v245, v245, v245 row_half_mirror row_mask:0xf bank_mask:0xf
    v_max_u32_dpp v244, v244, v244 row_half_mirror row_mask:0xf bank_mask:0xf
    v_max_u32 v245, v245, v196
    s_nop 0
    v_min_u32_dpp v196, v244, v244 row_mirror row_mask:0xf bank_mask:0xf
    v_max_u32_dpp v245, v245, v245 row_mirror row_mask:0xf bank_mask:0xf
    v_max_u32_dpp v244, v244, v244 row_mirror row_mask:0xf bank_mask:0xf
    v_max_u32 v245, v245, v196
    ds_write_b64 v4, v[244:245]
    s_waitcnt lgkmcnt(0)
    s_barrier
    ds_read_b64 v[244:245], v5
    v_pk_add_f32 v[208:209], v[152:153], v[30:31] op_sel_hi:[1,0] neg_lo:[0,1] neg_hi:[0,1]
    v_pk_add_f32 v[210:211], v[154:155], v[30:31] op_sel_hi:[1,0] neg_lo:[0,1] neg_hi:[0,1]
    v_pk_add_f32 v[212:213], v[156:157], v[30:31] op_sel_hi:[1,0] neg_lo:[0,1] neg_hi:[0,1]
    v_pk_add_f32 v[214:215], v[158:159], v[30:31] op_sel_hi:[1,0] neg_lo:[0,1] neg_hi:[0,1]
    v_pk_add_f32 v[216:217], v[160:161], v[30:31] op_sel_hi:[1,0] neg_lo:[0,1] neg_hi:[0,1]
    v_pk_add_f32 v[218:219], v[162:163], v[30:31] op_sel_hi:[1,0] neg_lo:[0,1] neg_hi:[0,1]
    v_pk_add_f32 v[220:221], v[164:165], v[30:31] op_sel_hi:[1,0] neg_lo:[0,1] neg_hi:[0,1]
    v_pk_add_f32 v[222:223], v[166:167], v[30:31] op_sel_hi:[1,0] neg_lo:[0,1] neg_hi:[0,1]
    s_waitcnt lgkmcnt(0)
    v_min_u32_dpp v196, v244, v244 quad_perm:[1,0,3,2] row_mask:0xf bank_mask:0xf
    v_max_u32_dpp v245, v245, v245 quad_perm:[1,0,3,2] row_mask:0xf bank_mask:0xf
    v_max_u32_dpp v244, v244, v244 quad_perm:[1,0,3,2] row_mask:0xf bank_mask:0xf
    v_max_u32 v245, v245, v196
    s_nop 0
    v_min_u32_dpp v196, v244, v244 quad_perm:[2,3,0,1] row_mask:0xf bank_mask:0xf
    v_max_u32_dpp v245, v245, v245 quad_perm:[2,3,0,1] row_mask:0xf bank_mask:0xf
    v_max_u32_dpp v244, v244, v244 quad_perm:[2,3,0,1] row_mask:0xf bank_mask:0xf
    v_max_u32 v245, v245, v196
    s_nop 0
    v_min_u32_dpp v196, v244, v244 row_half_mirror row_mask:0xf bank_mask:0xf
    v_max_u32_dpp v245, v245, v245 row_half_mirror row_mask:0xf bank_mask:0xf
    v_max_u32_dpp v244, v244, v244 row_half_mirror row_mask:0xf bank_mask:0xf
    v_max_u32 v245, v245, v196
    v_cmp_eq_u32 s[88:89], v32, v245
    v_cmp_eq_u32 vcc, v32, v244
    v_or_b32 v246, 1, v245
    v_mov_b32 v245, s4
    v_mov_b32 v247, s4
    s_or_b64 s[84:85], vcc, s[88:89]
    s_cmp_lg_u32 s3, 0
    s_cbranch_scc1 L_NOF
    s_mov_b64 exec, 0xffff
    buffer_store_dwordx4 v[244:247], v6, s[32:35], s16 offen sc1
    s_mov_b64 exec, -1
L_NOF:
    s_cmp_eq_u64 s[84:85], 0
    s_cbranch_scc1 L_NOPR
    s_setprio 1
L_NOPR:
    s_lshl4_add_u32 s13, s3, 156288
    v_mov_b32 v4, s13
    v_and_b32 v5, 7, v1
    v_lshlrev_b32 v5, 4, v5
    v_add_u32 v5, 156288, v5
    s_load_dwordx8 s[24:31], s[32:33], s92 offset:2560 glc
    v_cvt_pk_bf16_f32 v208, 0, v208
    v_cvt_pk_bf16_f32 v209, 0, v209
    v_cvt_pk_bf16_f32 v210, 0, v210
    v_cvt_pk_bf16_f32 v211, 0, v211
    v_cvt_pk_bf16_f32 v212, 0, v212
    v_cvt_pk_bf16_f32 v213, 0, v213
    v_cvt_pk_bf16_f32 v214, 0, v214
    v_cvt_pk_bf16_f32 v215, 0, v215
    v_cvt_pk_bf16_f32 v216, 0, v216
    v_cvt_pk_bf16_f32 v217, 0, v217
    v_cvt_pk_bf16_f32 v218, 0, v218
    v_cvt_pk_bf16_f32 v219, 0, v219
    v_cvt_pk_bf16_f32 v220, 0, v220
    v_cvt_pk_bf16_f32 v221, 0, v221
    v_cvt_pk_bf16_f32 v222, 0, v222
    v_cvt_pk_bf16_f32 v223, 0, v223
    v_pk_mul_f32 v[208:209], v[30:31], v[208:209] op_sel:[1,0]
    v_pk_mul_f32 v[210:211], v[30:31], v[210:211] op_sel:[1,0]
    v_pk_mul_f32 v[212:213], v[30:31], v[212:213] op_sel:[1,0]
    v_pk_mul_f32 v[214:215], v[30:31], v[214:215] op_sel:[1,0]
    v_pk_mul_f32 v[216:217], v[30:31], v[216:217] op_sel:[1,0]
    v_pk_mul_f32 v[218:219], v[30:31], v[218:219] op_sel:[1,0]
    v_pk_mul_f32 v[220:221], v[30:31], v[220:221] op_sel:[1,0]
    v_pk_mul_f32 v[222:223], v[30:31], v[222:223] op_sel:[1,0]
    v_cvt_pk_bf16_f32 v208, 0, v208
    v_cvt_pk_bf16_f32 v209, 0, v209
    v_cvt_pk_bf16_f32 v210, 0, v210
    v_cvt_pk_bf16_f32 v211, 0, v211
    v_cvt_pk_bf16_f32 v212, 0, v212
    v_cvt_pk_bf16_f32 v213, 0, v213
    v_cvt_pk_bf16_f32 v214, 0, v214
    v_cvt_pk_bf16_f32 v215, 0, v215
    v_cvt_pk_bf16_f32 v216, 0, v216
    v_cvt_pk_bf16_f32 v217, 0, v217
    v_cvt_pk_bf16_f32 v218, 0, v218
    v_cvt_pk_bf16_f32 v219, 0, v219
    v_cvt_pk_bf16_f32 v220, 0, v220
    v_cvt_pk_bf16_f32 v221, 0, v221
    v_cvt_pk_bf16_f32 v222, 0, v222
    v_cvt_pk_bf16_f32 v223, 0, v223
    v_pk_mul_f32 v[208:209], v[208:209], v[168:169]
    v_pk_mul_f32 v[210:211], v[210:211], v[170:171]
    v_pk_mul_f32 v[212:213], v[212:213], v[172:173]
    v_pk_mul_f32 v[214:215], v[214:215], v[174:175]
    v_pk_mul_f32 v[216:217], v[216:217], v[176:177]
    v_pk_mul_f32 v[218:219], v[218:219], v[178:179]
    v_pk_mul_f32 v[220:221], v[220:221], v[180:181]
    v_pk_mul_f32 v[222:223], v[222:223], v[182:183]
    v_cvt_pk_bf16_f32 v208, 0, v208
    v_cvt_pk_bf16_f32 v209, 0, v209
    v_cvt_pk_bf16_f32 v210, 0, v210
    v_cvt_pk_bf16_f32 v211, 0, v211
    v_cvt_pk_bf16_f32 v212, 0, v212
    v_cvt_pk_bf16_f32 v213, 0, v213
    v_cvt_pk_bf16_f32 v214, 0, v214
    v_cvt_pk_bf16_f32 v215, 0, v215
    v_cvt_pk_bf16_f32 v216, 0, v216
    v_cvt_pk_bf16_f32 v217, 0, v217
    v_cvt_pk_bf16_f32 v218, 0, v218
    v_cvt_pk_bf16_f32 v219, 0, v219
    v_cvt_pk_bf16_f32 v220, 0, v220
    v_cvt_pk_bf16_f32 v221, 0, v221
    v_cvt_pk_bf16_f32 v222, 0, v222
    v_cvt_pk_bf16_f32 v223, 0, v223
    v_pk_add_f32 v[208:209], v[208:209], v[88:89]
    v_pk_add_f32 v[210:211], v[210:211], v[90:91]
    v_pk_add_f32 v[212:213], v[212:213], v[92:93]
    v_pk_add_f32 v[214:215], v[214:215], v[94:95]
    v_pk_add_f32 v[216:217], v[216:217], v[96:97]
    v_pk_add_f32 v[218:219], v[218:219], v[98:99]
    v_pk_add_f32 v[220:221], v[220:221], v[100:101]
    v_pk_add_f32 v[222:223], v[222:223], v[102:103]
    v_cvt_pk_bf16_f32 v224, v208, v209
    v_cvt_pk_bf16_f32 v225, v210, v211
    v_cvt_pk_bf16_f32 v226, v212, v213
    v_cvt_pk_bf16_f32 v227, v214, v215
    v_cvt_pk_bf16_f32 v228, v216, v217
    v_cvt_pk_bf16_f32 v229, v218, v219
    v_cvt_pk_bf16_f32 v230, v220, v221
    v_cvt_pk_bf16_f32 v231, v222, v223
    s_cmp_eq_u64 s[84:85], 0
    s_cbranch_scc1 L_NOCAND
    v_mfma_f32_16x16x32_bf16 v[240:243], v[184:187], v[224:227], 0
    v_mfma_f32_16x16x32_bf16 v[240:243], v[188:191], v[228:231], v[240:243]
    v_mov_b32 v232, v224
    v_mov_b32 v233, v225
    v_mov_b32 v234, v226
    v_mov_b32 v235, v227
    v_mov_b32 v236, v228
    v_mov_b32 v237, v229
    v_mov_b32 v238, v230
    v_mov_b32 v239, v231
    s_lshl_b32 s96, s21, 14
    s_lshl_b32 s97, s12, 9
    s_add_u32 s98, s96, s97
    s_add_u32 s15, s98, 13631488
    v_lshrrev_b32 v7, 4, v1
    v_lshlrev_b32 v7, 4, v7
    v_add_u32 v8, 8192, v7
    v_permlane32_swap_b32 v232, v234
    v_permlane32_swap_b32 v233, v235
    v_permlane32_swap_b32 v236, v238
    v_permlane32_swap_b32 v237, v239
    v_permlane32_swap_b32 v12, v14
    v_permlane32_swap_b32 v13, v15
    v_permlane32_swap_b32 v16, v18
    v_permlane32_swap_b32 v17, v19
    v_cndmask_b32 v7, v7, v8, s[88:89]
    s_mov_b64 exec, s[84:85]
    buffer_store_dwordx4 v[232:235], v7, s[32:35], s15 offen sc1
    buffer_store_dwordx4 v[236:239], v7, s[32:35], s15 offen offset:64 sc1
    s_mov_b32 exec_lo, 0
    s_and_b32 exec_hi, s85, 0xffff0000
    buffer_store_dword v240, v7, s[32:35], s15 offen offset:208 sc1
    s_mov_b64 exec, s[84:85]
    buffer_store_dwordx4 v[12:15], v7, s[32:35], s15 offen offset:128 sc1
    buffer_store_dwordx4 v[16:19], v7, s[32:35], s15 offen offset:192 sc1
    s_mov_b64 exec, -1
    s_setprio 0
L_NOCAND:
    s_mov_b32 s82, s81
    s_lshl2_add_u32 m0, s83, 65536
    s_nop 0
    buffer_load_dwordx4 v253, s[60:63], s82 offen nt lds
    s_add_u32 s82, s81, 4096
    s_lshl2_add_u32 m0, s83, 66560
    s_nop 0
    buffer_load_dwordx4 v253, s[60:63], s82 offen nt lds
    v_lshlrev_b32 v208, 16, v224
    v_and_b32 v209, s6, v224
    v_lshlrev_b32 v210, 16, v225
    v_and_b32 v211, s6, v225
    v_lshlrev_b32 v212, 16, v226
    v_and_b32 v213, s6, v226
    v_lshlrev_b32 v214, 16, v227
    v_and_b32 v215, s6, v227
    v_lshlrev_b32 v216, 16, v228
    v_and_b32 v217, s6, v228
    v_lshlrev_b32 v218, 16, v229
    v_and_b32 v219, s6, v229
    v_lshlrev_b32 v220, 16, v230
    v_and_b32 v221, s6, v230
    v_lshlrev_b32 v222, 16, v231
    v_and_b32 v223, s6, v231
    v_pk_mul_f32 v[208:209], v[208:209], v[104:105]
    v_pk_mul_f32 v[210:211], v[210:211], v[106:107]
    v_pk_mul_f32 v[212:213], v[212:213], v[108:109]
    v_pk_mul_f32 v[214:215], v[214:215], v[110:111]
    v_pk_mul_f32 v[216:217], v[216:217], v[112:113]
    v_pk_mul_f32 v[218:219], v[218:219], v[114:115]
    v_pk_mul_f32 v[220:221], v[220:221], v[116:117]
    v_pk_mul_f32 v[222:223], v[222:223], v[118:119]
    v_cvt_pk_bf16_f32 v208, 0, v208
    v_cvt_pk_bf16_f32 v209, 0, v209
    v_cvt_pk_bf16_f32 v210, 0, v210
    v_cvt_pk_bf16_f32 v211, 0, v211
    v_cvt_pk_bf16_f32 v212, 0, v212
    v_cvt_pk_bf16_f32 v213, 0, v213
    v_cvt_pk_bf16_f32 v214, 0, v214
    v_cvt_pk_bf16_f32 v215, 0, v215
    v_cvt_pk_bf16_f32 v216, 0, v216
    v_cvt_pk_bf16_f32 v217, 0, v217
    v_cvt_pk_bf16_f32 v218, 0, v218
    v_cvt_pk_bf16_f32 v219, 0, v219
    v_cvt_pk_bf16_f32 v220, 0, v220
    v_cvt_pk_bf16_f32 v221, 0, v221
    v_cvt_pk_bf16_f32 v222, 0, v222
    v_cvt_pk_bf16_f32 v223, 0, v223
    s_lshl_b32 s96, s3, 11
    s_add_u32 s13, s96, 98304
    v_lshrrev_b32 v202, 4, v1
    v_lshlrev_b32 v202, 4, v202
    v_and_b32 v203, 7, v1
    v_lshlrev_b32 v203, 4, v203
    v_xor_b32 v202, v202, v203
    v_and_b32 v204, 15, v1
    v_lshl_add_u32 v204, v204, 7, s13
    v_add_u32 v202, v202, v204
    v_xor_b32 v204, 64, v202
    v_lshrrev_b32 v205, 3, v1
    v_lshlrev_b32 v205, 4, v205
    v_xor_b32 v203, v205, v203
    v_lshrrev_b32 v205, 3, v1
    v_lshl_add_u32 v205, v205, 7, s13
    v_add_u32 v203, v203, v205
    s_lshl_b32 s96, s21, 7
    s_sub_u32 s97, 2047, s96
    s_lshl_b32 s98, s3, 4
    s_sub_u32 s13, s97, s98
    v_lshrrev_b32 v43, 3, v1
    v_sub_u32 v42, s13, v43
    v_subrev_u32 v43, 8, v42
    v_lshrrev_b32 v33, 3, v1
    v_lshlrev_b32 v33, 11, v33
    v_and_b32 v9, 7, v1
    v_lshl_add_u32 v33, v9, 4, v33
    s_lshl3_add_u32 s96, s21, s3
    s_lshl_b32 s97, s96, 15
    s_lshl_b32 s98, s12, 7
    s_add_u32 s16, s97, s98
    s_add_u32 s15, s16, 16384
    s_branch SCHK_40
SPOLL_39:
    s_load_dwordx8 s[24:31], s[32:33], s92 offset:2560 glc
SCHK_40:
    s_add_u32 s5, s5, 1
    s_cmp_ge_u32 s5, 200000
    s_waitcnt lgkmcnt(0)
    s_cbranch_scc1 SDONE_41
    s_cmp_lg_u32 s25, s4
    s_cbranch_scc1 SPOLL_39
    s_cmp_lg_u32 s27, s4
    s_cbranch_scc1 SPOLL_39
    s_cmp_lg_u32 s29, s4
    s_cbranch_scc1 SPOLL_39
    s_cmp_lg_u32 s31, s4
    s_cbranch_scc1 SPOLL_39
SDONE_41:
    s_min_u32 s25, s24, s28
    s_min_u32 s27, s26, s28
    s_min_u32 s29, s24, s30
    s_max_u32 s24, s24, s28
    s_max_u32 s26, s26, s30
    s_max_u32 s27, s27, s29
    s_max_u32 s25, s25, s26
    v_mov_b32 v244, s24
    v_mov_b32 v246, s27
    v_mov_b32 v245, s25
    ds_write_b128 v4, v[244:247]
    s_lshr_b32 s96, s3, 2
    s_lshl_b32 s97, s96, 15
    s_and_b32 s98, s3, 3
    s_lshl_b32 s99, s98, 5
    s_add_u32 s13, s97, s99
    v_lshrrev_b32 v34, 4, v1
    v_lshlrev_b32 v34, 13, v34
    v_bfe_u32 v9, v1, 2, 2
    v_lshl_add_u32 v34, v9, 7, v34
    v_bfe_u32 v9, v1, 3, 2
    v_lshl_add_u32 v34, v9, 5, v34
    v_and_b32 v9, 3, v1
    v_lshl_add_u32 v34, v9, 3, v34
    v_xor_b32 v34, s13, v34
    s_lshl_b32 s96, s75, 11
    s_add_u32 s13, s96, 13631488
    v_and_b32 v36, 7, v1
    v_lshl_add_u32 v36, v36, 4, s13
    v_lshrrev_b32 v9, 4, v1
    v_lshl_add_u32 v36, v9, 9, v36
    v_and_b32 v10, 15, v1
    v_lshlrev_b32 v10, 9, v10
    v_add_u32 v10, 13631744, v10
    s_waitcnt vmcnt(0)
    s_waitcnt lgkmcnt(0)
    s_barrier
    ds_read_b128 v[244:247], v5
    v_and_b32 v8, 8, v1
    v_cmp_eq_u32 s[22:23], 0, v8
    v_cmp_gt_u32 s[24:25], 16, v1
    v_cmp_gt_u32 s[26:27], 32, v1
    s_waitcnt lgkmcnt(0)
    v_min_u32_dpp v192, v244, v244 quad_perm:[1,0,3,2] row_mask:0xf bank_mask:0xf
    v_min_u32_dpp v193, v245, v244 quad_perm:[1,0,3,2] row_mask:0xf bank_mask:0xf
    v_min_u32_dpp v194, v244, v245 quad_perm:[1,0,3,2] row_mask:0xf bank_mask:0xf
    v_max_u32_dpp v246, v246, v246 quad_perm:[1,0,3,2] row_mask:0xf bank_mask:0xf
    v_max_u32_dpp v245, v245, v245 quad_perm:[1,0,3,2] row_mask:0xf bank_mask:0xf
    v_max_u32_dpp v244, v244, v244 quad_perm:[1,0,3,2] row_mask:0xf bank_mask:0xf
    v_max3_u32 v246, v246, v193, v194
    v_max_u32 v245, v245, v192
    v_min_u32_dpp v192, v244, v244 quad_perm:[2,3,0,1] row_mask:0xf bank_mask:0xf
    s_nop 0
    v_min_u32_dpp v193, v245, v244 quad_perm:[2,3,0,1] row_mask:0xf bank_mask:0xf
    v_min_u32_dpp v194, v244, v245 quad_perm:[2,3,0,1] row_mask:0xf bank_mask:0xf
    v_max_u32_dpp v246, v246, v246 quad_perm:[2,3,0,1] row_mask:0xf bank_mask:0xf
    v_max_u32_dpp v245, v245, v245 quad_perm:[2,3,0,1] row_mask:0xf bank_mask:0xf
    v_max_u32_dpp v244, v244, v244 quad_perm:[2,3,0,1] row_mask:0xf bank_mask:0xf
    v_max3_u32 v246, v246, v193, v194
    v_max_u32 v245, v245, v192
    v_min_u32_dpp v192, v244, v244 row_half_mirror row_mask:0xf bank_mask:0xf
    s_nop 0
    v_min_u32_dpp v193, v245, v244 row_half_mirror row_mask:0xf bank_mask:0xf
    v_min_u32_dpp v194, v244, v245 row_half_mirror row_mask:0xf bank_mask:0xf
    v_max_u32_dpp v246, v246, v246 row_half_mirror row_mask:0xf bank_mask:0xf
    v_max_u32_dpp v245, v245, v245 row_half_mirror row_mask:0xf bank_mask:0xf
    v_max_u32_dpp v244, v244, v244 row_half_mirror row_mask:0xf bank_mask:0xf
    v_max3_u32 v246, v246, v193, v194
    v_max_u32 v245, v245, v192
    v_cndmask_b32 v192, v245, v244, s[22:23]
    v_cndmask_b32 v201, v246, v245, s[26:27]
    v_and_b32 v193, 31, v246
    v_and_b32 v192, 31, v192
    v_cndmask_b32 v201, v201, v244, s[24:25]
    v_lshl_add_u32 v4, v192, 13, v36
    v_lshl_add_u32 v5, v193, 13, v36
    v_and_b32 v194, 31, v201
    v_lshl_add_u32 v6, v194, 13, v10
    buffer_load_dwordx4 v[192:195], v4, s[32:35], 0 offen sc1
    buffer_load_dwordx4 v[196:199], v5, s[32:35], 0 offen sc1
    buffer_load_dword v200, v6, s[32:35], 0 offen sc1
    s_barrier
    s_add_u32 s82, s81, 8192
    s_lshl2_add_u32 m0, s83, 67584
    s_nop 0
    buffer_load_dwordx4 v253, s[60:63], s82 offen nt lds
    s_add_u32 s82, s81, 12288
    s_lshl2_add_u32 m0, s83, 68608
    s_nop 0
    buffer_load_dwordx4 v253, s[60:63], s82 offen nt lds
    v_readfirstlane_b32 s91, v244
    v_readfirstlane_b32 s94, v245
    v_readfirstlane_b32 s95, v246
    ds_read_b64_tr_b16 v[56:57], v34
    ds_read_b64_tr_b16 v[58:59], v34 offset:512
    ds_read_b64_tr_b16 v[60:61], v34 offset:1024
    ds_read_b64_tr_b16 v[62:63], v34 offset:1536
    ds_read_b64_tr_b16 v[64:65], v34 offset:2048
    ds_read_b64_tr_b16 v[66:67], v34 offset:2560
    ds_read_b64_tr_b16 v[68:69], v34 offset:3072
    ds_read_b64_tr_b16 v[70:71], v34 offset:3584
    ds_read_b64_tr_b16 v[72:73], v34 offset:4096
    ds_read_b64_tr_b16 v[74:75], v34 offset:4608
    ds_read_b64_tr_b16 v[76:77], v34 offset:5120
    ds_read_b64_tr_b16 v[78:79], v34 offset:5632
    ds_read_b64_tr_b16 v[80:81], v34 offset:6144
    ds_read_b64_tr_b16 v[82:83], v34 offset:6656
    ds_read_b64_tr_b16 v[84:85], v34 offset:7168
    ds_read_b64_tr_b16 v[86:87], v34 offset:7680
    s_bfe_u32 s96, s91, 262145
    s_lshl_b32 s97, s96, 7
    s_bfe_u32 s98, s91, 458757
    s_add_u32 s99, s97, s98
    s_xor_b32 s17, s99, 2047
    s_bfe_u32 s96, s94, 262145
    s_lshl_b32 s97, s96, 7
    s_bfe_u32 s98, s94, 458757
    s_add_u32 s99, s97, s98
    s_xor_b32 s18, s99, 2047
    s_bfe_u32 s96, s95, 262145
    s_lshl_b32 s97, s96, 7
    s_bfe_u32 s98, s95, 458757
    s_add_u32 s99, s97, s98
    s_xor_b32 s19, s99, 2047
    s_waitcnt lgkmcnt(0)
    s_lshl_b32 s13, s3, 6
    v_bfe_u32 v35, v1, 2, 1
    v_lshlrev_b32 v35, 9, v35
    v_bfe_u32 v9, v1, 3, 1
    v_lshl_add_u32 v35, v9, 12, v35
    v_lshrrev_b32 v9, 5, v1
    v_lshl_add_u32 v35, v9, 11, v35
    v_bfe_u32 v9, v1, 2, 2
    v_lshl_add_u32 v35, v9, 6, v35
    v_bfe_u32 v9, v1, 4, 1
    v_lshl_add_u32 v35, v9, 5, v35
    v_and_b32 v9, 3, v1
    v_lshl_add_u32 v35, v9, 3, v35
    v_xor_b32 v35, s13, v35
    v_add_u32 v35, 65536, v35
    v_and_b32 v8, 15, v1
    v_lshlrev_b32 v8, 4, v8
    v_lshrrev_b32 v9, 5, v1
    v_lshl_add_u32 v8, v9, 3, v8
    s_lshl_b32 s96, s74, 13
    s_add_u32 s14, s96, 20971520
    s_lshl3_add_u32 s96, s75, s3
    s_lshl_b32 s97, s96, 8
    s_add_u32 s20, s97, s14
    v_bfe_u32 v7, v201, 1, 4
    v_bfe_u32 v201, v201, 5, 7
    v_lshl_or_b32 v201, v7, 7, v201
    v_xor_b32 v201, 0x7ff, v201
    s_waitcnt vmcnt(2)
    v_max3_u32 v7, v192, v196, v200
    v_cmp_eq_u32 vcc, -1, v7
    s_cbranch_vccz POK_43
PRE_44:
    buffer_load_dwordx4 v[192:195], v4, s[32:35], 0 offen sc1
    buffer_load_dwordx4 v[196:199], v5, s[32:35], 0 offen sc1
    buffer_load_dword v200, v6, s[32:35], 0 offen sc1
    s_waitcnt vmcnt(0)
    v_max3_u32 v7, v192, v196, v200
    v_cmp_eq_u32 vcc, -1, v7
    s_cbranch_vccz POK_43
    s_add_u32 s5, s5, 1
    s_cmp_lt_u32 s5, 200000
    s_cbranch_scc1 PRE_44
POK_43:
    v_add_f32_dpp v200, v200, v200 quad_perm:[1,0,3,2] row_mask:0xf bank_mask:0xf
    s_nop 1
    v_add_f32_dpp v200, v200, v200 quad_perm:[2,3,0,1] row_mask:0xf bank_mask:0xf
    s_nop 1
    v_add_f32_dpp v200, v200, v200 row_half_mirror row_mask:0xf bank_mask:0xf
    s_nop 1
    v_add_f32_dpp v200, v200, v200 row_mirror row_mask:0xf bank_mask:0xf
    v_cvt_pk_bf16_f32 v200, 0, v200
    v_ashrrev_i32 v7, 31, v200
    v_or_b32 v7, 0x80000000, v7
    v_xor_b32 v200, v200, v7
    v_lshrrev_b32 v200, 16, v200
    v_lshl_or_b32 v200, v200, 11, v201
    s_nop 0
    v_readlane_b32 s24, v200, 0
    v_readlane_b32 s25, v200, 16
    v_readlane_b32 s26, v200, 32
    s_not_b64 s[28:29], s[22:23]
    s_cmp_lt_u32 s24, s25
    s_cselect_b64 s[28:29], s[22:23], s[28:29]
    s_cselect_b32 s27, s24, s25
    s_cmp_gt_u32 s26, s27
    s_cselect_b64 vcc, s[28:29], 0
    v_cndmask_b32 v192, v192, v196, vcc
    v_cndmask_b32 v193, v193, v197, vcc
    v_cndmask_b32 v194, v194, v198, vcc
    v_cndmask_b32 v195, v195, v199, vcc
    s_bitcmp1_b32 vcc_lo, 0
    s_cselect_b32 s24, s26, s24
    s_cselect_b32 s19, s17, s19
    s_cselect_b32 s17, s95, s91
    s_bitcmp1_b32 vcc_lo, 8
    s_cselect_b32 s25, s26, s25
    s_cselect_b32 s19, s18, s19
    s_cselect_b32 s18, s95, s94
    s_waitcnt lgkmcnt(0)
    v_mfma_f32_16x16x32_bf16 v[136:139], v[192:195], v[56:59], 0
    v_mfma_f32_16x16x32_bf16 v[140:143], v[192:195], v[60:63], 0
    v_mfma_f32_16x16x32_bf16 v[144:147], v[192:195], v[64:67], 0
    v_mfma_f32_16x16x32_bf16 v[148:151], v[192:195], v[68:71], 0
    v_mfma_f32_16x16x32_bf16 v[168:171], v[192:195], v[72:75], 0
    v_mfma_f32_16x16x32_bf16 v[172:175], v[192:195], v[76:79], 0
    v_mfma_f32_16x16x32_bf16 v[176:179], v[192:195], v[80:83], 0
    v_mfma_f32_16x16x32_bf16 v[180:183], v[192:195], v[84:87], 0
    s_nop 1
    v_add_f32 v196, v136, v141
    s_nop 0
    v_add_f32 v197, v146, v151
    s_nop 0
    v_add_f32 v198, v168, v173
    s_nop 0
    v_add_f32 v199, v178, v183
    v_add_f32 v196, v196, v197
    v_add_f32 v198, v198, v199
    v_mov_b32 v197, s4
    s_nop 0
    v_permlane16_swap_b32 v198, v199
    s_cmp_ge_u32 s9, 28
    s_cbranch_scc1 L_NOHP
    v_add_f32 v196, v196, v199
    s_mov_b32 exec_lo, 0xffff
    s_mov_b32 exec_hi, 0xffff
    buffer_store_dwordx2 v[196:197], v8, s[32:35], s20 offen sc1
    s_mov_b64 exec, -1
L_NOHP:
    s_and_b32 s68, s24, 2047
    s_and_b32 s69, s25, 2047
    s_mov_b32 s70, s16
    s_mov_b32 s71, s15
    v_pk_add_f32 v[208:209], v[208:209], v[152:153]
    v_pk_add_f32 v[210:211], v[210:211], v[154:155]
    v_pk_add_f32 v[212:213], v[212:213], v[156:157]
    v_pk_add_f32 v[214:215], v[214:215], v[158:159]
    v_pk_add_f32 v[216:217], v[216:217], v[160:161]
    v_pk_add_f32 v[218:219], v[218:219], v[162:163]
    v_pk_add_f32 v[220:221], v[220:221], v[164:165]
    v_pk_add_f32 v[222:223], v[222:223], v[166:167]
    v_cvt_pk_bf16_f32 v232, v208, v209
    v_cvt_pk_bf16_f32 v233, v210, v211
    v_cvt_pk_bf16_f32 v234, v212, v213
    v_cvt_pk_bf16_f32 v235, v214, v215
    v_cvt_pk_bf16_f32 v236, v216, v217
    v_cvt_pk_bf16_f32 v237, v218, v219
    v_cvt_pk_bf16_f32 v238, v220, v221
    v_cvt_pk_bf16_f32 v239, v222, v223
    v_permlane32_swap_b32 v232, v234
    v_permlane32_swap_b32 v233, v235
    v_permlane32_swap_b32 v236, v238
    v_permlane32_swap_b32 v237, v239
    ds_write_b128 v202, v[232:235]
    ds_write_b128 v204, v[236:239]
    ds_read_b128 v[232:235], v203
    ds_read_b128 v[236:239], v203 offset:1024
    s_waitcnt lgkmcnt(0)
    s_cmp_lg_u32 s93, 7
    s_cbranch_scc1 L_NONON
    v_mov_b32 v6, s4
    v_mov_b32 v7, 0
    s_mov_b64 exec, 1
    buffer_store_dword v6, v7, s[32:35], 0 offen sc1
    s_mov_b64 exec, -1
L_NONON:
    s_cmp_ge_u32 s9, 28
    s_cbranch_scc1 L_FIN2
    s_cmp_lg_u32 s3, 7
    s_cbranch_scc1 L_NOFZ
    s_bitcmp1_b32 s9, 3
    s_cselect_b32 s15, s25, s24
    s_cselect_b32 s17, s18, s17
    s_andn2_b32 s18, 2047, s15
    s_lshr_b32 s96, s8, 1
    s_lshl2_add_u32 s19, s12, s96
    s_lshr_b32 s96, s19, 1
    s_lshr_b32 s97, s9, 3
    s_lshl_b32 s98, s97, 1
    s_lshl2_add_u32 s99, s96, s98
    s_and_b32 s97, s19, 1
    s_add_u32 s96, s99, s97
    s_mul_i32 s98, s96, 7168
    s_add_u32 s20, s98, 22020096
    s_lshl_b32 s96, s18, 11
    s_lshl_b32 s97, s19, 5
    s_add_u32 s82, s96, s97
    v_and_b32 v10, 7, v1
    v_lshlrev_b32 v10, 2, v10
    s_lshr_b32 s96, s8, 1
    s_lshl_b32 s97, s96, 6
    s_add_u32 s13, s97, 157184
    v_and_b32 v5, 7, v1
    v_lshl_add_u32 v5, v5, 3, s13
    ds_read_b64 v[206:207], v5
    s_and_b32 s96, s17, 31
    s_lshl_b32 s97, s96, 13
    s_lshl_b32 s98, s12, 9
    s_add_u32 s99, s97, s98
    s_lshr_b32 s96, s8, 1
    s_lshl_b32 s97, s96, 5
    s_add_u32 s98, s99, s97
    s_add_u32 s91, s98, 13631488
    s_lshr_b32 s13, s15, 11
    s_lshl_b32 s13, s13, 16
    s_ashr_i32 s15, s13, 31
    s_andn2_b32 s15, 0x7fff0000, s15
    s_or_b32 s15, s15, 0x80000000
    s_xor_b32 s13, s13, s15
    v_mov_b32 v204, s13
    v_mul_f32 v204, s7, v204
    v_exp_f32 v204, -v204
    s_nop 0
    v_add_f32 v204, 1.0, v204
    v_rcp_f32 v204, v204
    s_nop 0
    v_cvt_pk_bf16_f32 v204, 0, v204
L_NOFZ:
    s_cmp_ge_u32 s3, 4
    s_cbranch_scc1 L_NOH
    s_lshl_b32 s96, s3, 8
    s_add_u32 s13, s96, s14
    v_lshrrev_b32 v4, 4, v1
    v_lshlrev_b32 v4, 11, v4
    v_and_b32 v9, 15, v1
    v_lshl_add_u32 v4, v9, 4, v4
    s_lshl_b32 s96, s3, 5
    s_add_u32 s15, s96, 156672
    v_lshrrev_b32 v5, 5, v1
    v_lshl_add_u32 v5, v5, 7, s15
    v_bfe_u32 v9, v1, 2, 1
    v_lshl_add_u32 v5, v9, 4, v5
    v_bfe_u32 v9, v1, 1, 1
    v_lshl_add_u32 v5, v9, 3, v5
    v_bfe_u32 v9, v1, 3, 1
    v_lshl_add_u32 v5, v9, 2, v5
    v_and_b32 v9, 1, v1
    v_lshl_add_u32 v5, v9, 1, v5
SPOLL_45:
    s_load_dword s24, s[32:33], s13 offset:1276 glc
    s_load_dword s25, s[32:33], s13 offset:3324 glc
    s_load_dword s26, s[32:33], s13 offset:5372 glc
    s_load_dword s27, s[32:33], s13 offset:7420 glc
SCHK_46:
    s_add_u32 s5, s5, 1
    s_cmp_ge_u32 s5, 200000
    s_waitcnt lgkmcnt(0)
    s_cbranch_scc1 SDONE_47
    s_cmp_lg_u32 s24, s4
    s_cbranch_scc1 SPOLL_45
    s_cmp_lg_u32 s25, s4
    s_cbranch_scc1 SPOLL_45
    s_cmp_lg_u32 s26, s4
    s_cbranch_scc1 SPOLL_45
    s_cmp_lg_u32 s27, s4
    s_cbranch_scc1 SPOLL_45
SDONE_47:
POLL_48:
    buffer_load_dwordx4 v[88:91], v4, s[32:35], s13 offen sc1
    buffer_load_dwordx4 v[92:95], v4, s[32:35], s13 offen offset:1024 sc1
    s_waitcnt vmcnt(0)
    v_bitop3_b32 v6, v89, v91, s4 bitop3:0x7e
    v_bitop3_b32 v6, v6, v93, s4 bitop3:0xf6
    v_bitop3_b32 v6, v6, v95, s4 bitop3:0xf6
    v_cmp_ne_u32 vcc, 0, v6
    s_cbranch_vccz PDONE_49
    s_add_u32 s5, s5, 1
    s_cmp_lt_u32 s5, 200000
    s_cbranch_scc1 POLL_48
PDONE_49:
    v_permlane32_swap_b32 v88, v90
    v_permlane32_swap_b32 v92, v94
    v_add_f32 v88, v88, v90
    v_add_f32 v92, v92, v94
    v_mov_b32 v90, v88
    v_mov_b32 v94, v92
    s_nop 0
    v_permlane16_swap_b32 v88, v90
    v_permlane16_swap_b32 v92, v94
    v_add_f32 v88, v88, v90
    v_add_f32 v92, v92, v94
    v_cvt_pk_bf16_f32 v88, 0, v88
    v_cvt_pk_bf16_f32 v92, 0, v92
    v_mul_f32 v6, s7, v88
    v_exp_f32 v6, -v6
    s_nop 0
    v_add_f32 v6, 1.0, v6
    v_rcp_f32 v6, v6
    s_nop 0
    v_mul_f32 v88, v88, v6
    v_cvt_pk_bf16_f32 v88, 0, v88
    v_mul_f32 v88, v88, v92
    v_cvt_pk_bf16_f32 v88, v88, v88
    ds_write_b16 v5, v88
L_NOH:
    v_bfe_u32 v4, v1, 2, 1
    v_lshlrev_b32 v4, 7, v4
    v_lshrrev_b32 v9, 5, v1
    v_lshl_add_u32 v4, v9, 4, v4
    v_add_u32 v4, 156672, v4
    v_lshrrev_b32 v5, 4, v1
    v_mul_u32_u24 v5, 7168, v5
    v_and_b32 v9, 15, v1
    v_lshl_add_u32 v5, v9, 3, v5
L_PAD10:
    s_cbranch_execz L_RET10
    s_lshl3_add_u32 s96, s75, s3
    s_mul_i32 s97, s96, 28672
    s_lshl_b32 s98, s74, 7
    s_add_u32 s99, s97, s98
    s_add_u32 s13, s99, 22020096
    v_and_b32 v6, 1, v1
    v_lshlrev_b32 v6, 13, v6
    v_bfe_u32 v9, v1, 1, 1
    v_lshl_add_u32 v6, v9, 18, v6
    s_lshr_b32 s96, s9, 2
    s_and_b32 s97, s75, 1
    s_lshr_b32 s98, s3, 1
    s_lshl2_add_u32 s99, s97, s98
    s_and_b32 s97, s3, 1
    s_lshr_b32 s98, s75, 1
    s_lshl2_add_u32 s97, s97, s98
    s_lshl3_add_u32 s98, s99, s97
    s_lshl_b32 s99, s98, 12
    s_lshl_b32 s97, s8, 6
    s_add_u32 s98, s99, s97
    s_lshl2_add_u32 s99, s96, s98
    s_add_u32 s97, s99, 1048576
    s_add_u32 s14, s97, 3072
    s_waitcnt vmcnt(0)
    s_waitcnt lgkmcnt(0)
    s_barrier
    ds_read_b128 v[88:91], v4
    ds_read_b64_tr_b16 v[120:121], v35
    ds_read_b64_tr_b16 v[122:123], v35 offset:1024
    ds_read_b128 v[92:95], v4 offset:32
    ds_read_b64_tr_b16 v[124:125], v35 offset:8192
    ds_read_b64_tr_b16 v[126:127], v35 offset:9216
    ds_read_b128 v[96:99], v4 offset:64
    ds_read_b64_tr_b16 v[128:129], v35 offset:16384
    ds_read_b64_tr_b16 v[130:131], v35 offset:17408
    ds_read_b128 v[100:103], v4 offset:96
    ds_read_b64_tr_b16 v[132:133], v35 offset:24576
    ds_read_b64_tr_b16 v[134:135], v35 offset:25600
    s_waitcnt lgkmcnt(9)
    v_mfma_f32_32x32x16_bf16 v[208:223], v[88:91], v[120:123], 0
    s_waitcnt lgkmcnt(6)
    v_mfma_f32_32x32x16_bf16 v[208:223], v[92:95], v[124:127], v[208:223]
    s_waitcnt lgkmcnt(3)
    v_mfma_f32_32x32x16_bf16 v[208:223], v[96:99], v[128:131], v[208:223]
    s_waitcnt lgkmcnt(0)
    v_mfma_f32_32x32x16_bf16 v[208:223], v[100:103], v[132:135], v[208:223]
    s_nop 11
    v_mov_b32 v209, s4
    buffer_store_dwordx2 v[208:209], v5, s[32:35], s13 offen sc1
    s_mov_b64 exec, 15
    buffer_store_dword v209, v6, s[32:35], s14 offen sc1
    s_mov_b64 exec, -1
    s_barrier
L_FIN2:
    v_cmp_ne_u32 vcc, s68, v42
    v_cmp_ne_u32 s[22:23], s69, v42
    s_nop 0
    s_and_b64 exec, vcc, s[22:23]
    buffer_store_dwordx4 v[232:235], v33, s[64:67], s70 offen sc1
    s_mov_b64 exec, -1
    v_cmp_ne_u32 vcc, s68, v43
    v_cmp_ne_u32 s[22:23], s69, v43
    s_nop 0
    s_and_b64 exec, vcc, s[22:23]
    buffer_store_dwordx4 v[236:239], v33, s[64:67], s71 offen sc1
    s_mov_b64 exec, -1
    s_cmp_ge_u32 s9, 16
    s_cbranch_scc1 L_FIN
SPOLL_50:
    s_load_dwordx8 s[24:31], s[32:33], s92 offset:3072 glc
SCHK_51:
    s_add_u32 s5, s5, 1
    s_cmp_ge_u32 s5, 200000
    s_waitcnt lgkmcnt(0)
    s_cbranch_scc1 SDONE_52
    s_cmp_lg_u32 s24, s4
    s_cbranch_scc1 SPOLL_50
    s_cmp_lg_u32 s25, s4
    s_cbranch_scc1 SPOLL_50
    s_cmp_lg_u32 s26, s4
    s_cbranch_scc1 SPOLL_50
    s_cmp_lg_u32 s27, s4
    s_cbranch_scc1 SPOLL_50
    s_cmp_lg_u32 s28, s4
    s_cbranch_scc1 SPOLL_50
    s_cmp_lg_u32 s29, s4
    s_cbranch_scc1 SPOLL_50
    s_cmp_lg_u32 s30, s4
    s_cbranch_scc1 SPOLL_50
SDONE_52:
    s_barrier
    s_cmp_lg_u32 s3, 7
    s_cbranch_scc1 L_FIN
    s_add_u32 s13, s20, 4096
    v_mov_b32 v5, s4
    v_not_b32 v6, v5
POLL_53:
    buffer_load_dwordx4 v[88:91], v2, s[32:35], s20 offen sc1
    buffer_load_dwordx4 v[92:95], v2, s[32:35], s20 offen offset:1024 sc1
    buffer_load_dwordx4 v[96:99], v2, s[32:35], s20 offen offset:2048 sc1
    buffer_load_dwordx4 v[100:103], v2, s[32:35], s20 offen offset:3072 sc1
    buffer_load_dwordx4 v[104:107], v2, s[32:35], s13 offen sc1
    buffer_load_dwordx4 v[108:111], v2, s[32:35], s13 offen offset:1024 sc1
    buffer_load_dwordx4 v[112:115], v2, s[32:35], s13 offen offset:2048 sc1
    buffer_load_dword v244, v10, s[32:35], s91 offen sc1
    buffer_load_dword v245, v10, s[32:35], s91 offen offset:128 sc1
    s_waitcnt vmcnt(0)
    v_max_u32 v246, v244, v245
    v_cmp_ne_u32 vcc, -1, v246
    s_nop 1
    v_cndmask_b32 v246, v6, v5, vcc
    v_bitop3_b32 v4, v89, v91, s4 bitop3:0x7e
    v_bitop3_b32 v4, v4, v93, s4 bitop3:0xf6
    v_bitop3_b32 v4, v4, v95, s4 bitop3:0xf6
    v_bitop3_b32 v4, v4, v97, s4 bitop3:0xf6
    v_bitop3_b32 v4, v4, v99, s4 bitop3:0xf6
    v_bitop3_b32 v4, v4, v101, s4 bitop3:0xf6
    v_bitop3_b32 v4, v4, v103, s4 bitop3:0xf6
    v_bitop3_b32 v4, v4, v105, s4 bitop3:0xf6
    v_bitop3_b32 v4, v4, v107, s4 bitop3:0xf6
    v_bitop3_b32 v4, v4, v109, s4 bitop3:0xf6
    v_bitop3_b32 v4, v4, v111, s4 bitop3:0xf6
    v_bitop3_b32 v4, v4, v113, s4 bitop3:0xf6
    v_bitop3_b32 v4, v4, v115, s4 bitop3:0xf6
    v_bitop3_b32 v4, v4, v246, s4 bitop3:0xf6
    v_cmp_ne_u32 vcc, 0, v4
    s_cbranch_vccz PDONE_54
    s_add_u32 s5, s5, 1
    s_cmp_lt_u32 s5, 200000
    s_cbranch_scc1 POLL_53
PDONE_54:
    v_add_f32 v88, v88, v92
    v_add_f32 v90, v90, v94
    v_add_f32 v88, v88, v96
    v_add_f32 v90, v90, v98
    v_add_f32 v88, v88, v100
    v_add_f32 v90, v90, v102
    v_add_f32 v88, v88, v104
    v_add_f32 v90, v90, v106
    v_add_f32 v88, v88, v108
    v_add_f32 v90, v90, v110
    v_add_f32 v88, v88, v112
    v_add_f32 v90, v90, v114
    v_mov_b32 v89, v90
    v_add_f32_dpp v88, v88, v88 row_ror:8 row_mask:0xf bank_mask:0xf
    s_nop 0
    v_add_f32_dpp v89, v89, v89 row_ror:8 row_mask:0xf bank_mask:0xf
    v_mov_b32 v90, v88
    v_mov_b32 v91, v89
    s_nop 0
    v_permlane16_swap_b32 v88, v90
    v_permlane16_swap_b32 v89, v91
    v_pk_add_f32 v[88:89], v[88:89], v[90:91]
    v_mov_b32 v90, v88
    v_mov_b32 v91, v89
    s_nop 0
    v_permlane32_swap_b32 v88, v90
    v_permlane32_swap_b32 v89, v91
    v_pk_add_f32 v[88:89], v[88:89], v[90:91]
    v_cvt_pk_bf16_f32 v88, 0, v88
    v_cvt_pk_bf16_f32 v89, 0, v89
    v_pk_mul_f32 v[88:89], v[88:89], v[204:205] op_sel_hi:[1,0]
    v_lshlrev_b32 v4, 16, v244
    v_and_b32 v5, s6, v244
    v_cvt_pk_bf16_f32 v88, 0, v88
    v_cvt_pk_bf16_f32 v89, 0, v89
    v_pk_add_f32 v[88:89], v[88:89], v[4:5]
    v_cvt_pk_bf16_f32 v88, 0, v88
    v_cvt_pk_bf16_f32 v89, 0, v89
    v_pk_mul_f32 v[88:89], v[88:89], v[206:207]
    v_lshlrev_b32 v4, 16, v245
    v_and_b32 v5, s6, v245
    v_cvt_pk_bf16_f32 v88, 0, v88
    v_cvt_pk_bf16_f32 v89, 0, v89
    v_pk_add_f32 v[88:89], v[88:89], v[4:5]
    v_cvt_pk_bf16_f32 v88, v88, v89
    s_mov_b64 exec, 0xff
    buffer_store_dword v88, v10, s[64:67], s82 offen
    s_mov_b64 exec, -1
L_FIN:
L_END:
    s_endpgm
.p2align 10
.fill 768, 4, 0xbf800000
.section .rodata,"a"
.p2align 6
.amdhsa_kernel adaLN_cond__linear_kernel_hedgehog__moe_arch_mod__prompt_kernel
  .amdhsa_next_free_vgpr 256
  .amdhsa_next_free_sgpr 102
  .amdhsa_accum_offset 256
  .amdhsa_group_segment_fixed_size 0
  .amdhsa_kernarg_size 112
  .amdhsa_user_sgpr_count 2
  .amdhsa_user_sgpr_kernarg_segment_ptr 1
  .amdhsa_system_sgpr_workgroup_id_x 1
  .amdhsa_float_denorm_mode_32 3
  .amdhsa_float_denorm_mode_16_64 3
.end_amdhsa_kernel
```

```asm
; @launch grid=(256,1,1) block=(512,1,1) lds=163840
.amdgcn_target "amdgcn-amd-amdhsa--gfx950"
.text
.globl adaLN_cond__linear_kernel_hedgehog__moe_arch_mod__prompt_kernel
.p2align 12
.type adaLN_cond__linear_kernel_hedgehog__moe_arch_mod__prompt_kernel,@function
adaLN_cond__linear_kernel_hedgehog__moe_arch_mod__prompt_kernel:
    s_load_dwordx16 s[68:83], s[0:1], 0
    s_load_dwordx8 s[84:91], s[0:1], 64
    s_load_dwordx2 s[32:33], s[0:1], 104
    s_cmp_ge_u32 s2, 256
    s_cbranch_scc1 L_END
    v_lshrrev_b32 v4, 6, v0
    v_and_b32 v1, 63, v0
    s_nop 0
    v_readfirstlane_b32 s3, v4
    v_lshlrev_b32 v2, 4, v1
    s_mov_b32 s38, 4194304
    s_mov_b32 s39, 0x20000
    s_mov_b32 s50, 12582912
    s_mov_b32 s51, 0x20000
    s_mov_b32 s34, 268435456
    s_mov_b32 s35, 0x20000
    s_mov_b32 s42, 6291456
    s_mov_b32 s43, 0x20000
    s_mov_b32 s46, 2097152
    s_mov_b32 s47, 0x20000
    s_mov_b32 s54, 7340032
    s_mov_b32 s55, 0x20000
    s_mov_b32 s58, 7340032
    s_mov_b32 s59, 0x20000
    s_mov_b32 s62, 7340032
    s_mov_b32 s63, 0x20000
    s_mov_b32 s66, 4194304
    s_mov_b32 s67, 0x20000
    s_mov_b32 s5, 0
    s_mov_b32 s6, 0xffff0000
    s_mov_b32 s7, 0x3fb8aa3b
    s_and_b32 s8, s2, 7
    s_lshr_b32 s9, s2, 3
    s_lshl3_add_u32 s93, s2, s3
    s_and_b32 s96, s8, 4
    s_lshr_b32 s97, s9, 2
    s_lshl1_add_u32 s10, s96, s97
    s_and_b32 s96, s8, 3
    s_and_b32 s97, s9, 3
    s_xor_b32 s98, s97, 2
    s_lshl2_add_u32 s11, s96, s98
    s_and_b32 s96, s8, 1
    s_and_b32 s97, s9, 7
    s_lshl3_add_u32 s12, s96, s97
    s_lshr_b32 s96, s8, 1
    s_lshr_b32 s97, s9, 3
    s_lshl2_add_u32 s21, s96, s97
    s_lshl_b32 s96, s2, 6
    s_add_u32 s97, s96, s3
    s_lshl_b32 s98, s97, 6
    s_add_u32 s92, s98, 1048576
    s_lshr_b32 s96, s8, 1
    s_lshl_b32 s97, s96, 8
    s_lshl3_add_u32 s98, s9, s97
    s_add_u32 s99, s98, s3
    s_lshl_b32 s96, s99, 12
    s_and_b32 s97, s8, 1
    s_lshl_b32 s98, s97, 10
    s_add_u32 s16, s96, s98
    v_and_b32 v8, 31, v1
    v_lshlrev_b32 v8, 4, v8
    v_lshrrev_b32 v9, 5, v1
    v_lshl_add_u32 v8, v9, 11, v8
    s_lshl3_add_u32 s96, s8, s3
    s_lshl_b32 s15, s96, 5
    s_mul_i32 s96, s15, 6144
    s_xor_b32 s97, s9, 1
    s_lshl_b32 s98, s97, 7
    s_add_u32 s13, s96, s98
    s_add_u32 s14, s13, 98304
    s_lshl3_add_u32 s96, s21, s3
    s_lshl_b32 s97, s96, 15
    s_lshl_b32 s98, s12, 7
    s_add_u32 s18, s97, s98
    s_lshr_b32 s96, s8, 1
    s_lshl4_add_u32 s97, s96, s12
    s_lshl4_add_u32 s98, s97, s3
    s_lshl_b32 s99, s98, 9
    s_add_u32 s17, s99, 524288
    v_lshrrev_b32 v248, 3, v1
    v_mul_u32_u24 v248, 12288, v248
    v_and_b32 v9, 7, v1
    v_lshl_add_u32 v248, v9, 4, v248
    v_lshrrev_b32 v249, 3, v1
    v_lshl_add_u32 v249, v249, 1, s15
    v_and_b32 v10, 15, v1
    v_lshlrev_b32 v10, 11, v10
    v_lshrrev_b32 v9, 4, v1
    v_lshl_add_u32 v10, v9, 4, v10
    s_waitcnt lgkmcnt(0)
    s_mov_b64 s[48:49], s[88:89]
    buffer_load_dwordx4 v[160:163], v248, s[48:51], s13 offen nt
    buffer_load_dwordx4 v[164:167], v248, s[48:51], s14 offen nt
    s_load_dword s4, s[32:33], 0
    global_load_ushort v168, v249, s[86:87]
    global_load_ushort v169, v249, s[86:87] offset:16
    s_mov_b64 s[36:37], s[68:69]
    s_load_dword s24, s[32:33], s92 offset:0 glc
    s_load_dword s25, s[32:33], s17 offset:508 glc
    s_load_dword s26, s[32:33], s17 offset:4604 glc
    s_barrier
    buffer_load_dwordx4 v[152:155], v8, s[36:39], s16 offen
    buffer_load_dwordx4 v[156:159], v8, s[36:39], s16 offen offset:512
    s_mov_b64 s[40:41], s[70:71]
    s_mov_b64 s[44:45], s[74:75]
    s_mov_b64 s[52:53], s[80:81]
    s_mov_b64 s[56:57], s[82:83]
    s_mov_b64 s[60:61], s[84:85]
    s_mov_b64 s[64:65], s[90:91]
    s_getpc_b64 s[22:23]
    s_and_b32 s22, s22, 0xfffffc00
    s_lshl3_add_u32 s96, s9, s3
    s_lshl_b32 s19, s96, 7
    v_lshrrev_b32 v4, 5, v1
    v_lshl_add_u32 v4, v4, 15, s19
    v_min_u32 v4, 41984, v4
    global_load_dword v11, v4, s[22:23]
    s_lshr_b32 s76, s3, 2
    s_and_b32 s77, s3, 3
    s_lshl_b32 s83, s3, 10
    s_mul_i32 s96, s8, 7
    s_lshr_b32 s97, s9, 2
    s_add_u32 s74, s96, s97
    s_and_b32 s75, s9, 3
    v_bfe_u32 v6, v1, 4, 1
    v_lshlrev_b32 v6, 6, v6
    v_and_b32 v3, 7, v1
    v_lshlrev_b32 v3, 4, v3
    v_xor_b32 v3, v3, v6
    v_lshrrev_b32 v6, 3, v1
    v_mul_u32_u24 v6, 6144, v6
    v_add_u32 v3, v3, v6
    s_and_b32 s84, s9, 12
    s_mul_i32 s96, s3, 49152
    s_lshl_b32 s97, s11, 7
    s_add_u32 s85, s96, s97
    v_lshlrev_b32 v250, 3, v1
    v_lshlrev_b32 v251, 5, v1
    v_add_u32 v251, 147456, v251
    s_lshl2_add_u32 s13, s3, 147456
    v_lshrrev_b32 v252, 4, v1
    v_lshl_add_u32 v252, v252, 6, s13
    v_and_b32 v9, 7, v1
    v_lshl_add_u32 v252, v9, 8, v252
    v_bfe_u32 v9, v1, 3, 1
    v_lshl_add_u32 v252, v9, 5, v252
    buffer_load_dwordx4 v[12:15], v10, s[36:39], s18 offen
    buffer_load_dwordx4 v[16:19], v10, s[36:39], s18 offen offset:64
    s_lshr_b32 s96, s3, 1
    s_xor_b32 s97, s9, 1
    s_and_b32 s98, s97, 15
    s_lshl4_add_u32 s99, s96, s98
    s_lshr_b32 s97, s9, 4
    s_lshl1_add_u32 s96, s99, s97
    s_lshl3_add_u32 s98, s96, s8
    s_lshl_b32 s99, s98, 9
    s_add_u32 s13, s99, 524288
    s_waitcnt vmcnt(5)
    v_lshlrev_b32 v168, 16, v168
    v_mul_f32 v4, s7, v168
    v_exp_f32 v4, -v4
    s_nop 0
    v_add_f32 v4, 1.0, v4
    v_rcp_f32 v4, v4
    s_nop 0
    v_mul_f32 v168, v168, v4
    v_cvt_pk_bf16_f32 v168, 0, v168
    v_lshlrev_b32 v169, 16, v169
    v_mul_f32 v5, s7, v169
    v_exp_f32 v5, -v5
    s_nop 0
    v_add_f32 v5, 1.0, v5
    v_rcp_f32 v5, v5
    s_nop 0
    v_mul_f32 v169, v169, v5
    v_cvt_pk_bf16_f32 v169, 0, v169
    v_lshlrev_b32 v4, 16, v160
    v_and_b32 v5, s6, v160
    v_pk_mul_f32 v[176:177], v[168:169], v[4:5] op_sel:[0,0] op_sel_hi:[0,1]
    v_lshlrev_b32 v6, 16, v161
    v_and_b32 v7, s6, v161
    v_pk_mul_f32 v[178:179], v[168:169], v[6:7] op_sel:[0,0] op_sel_hi:[0,1]
    v_lshlrev_b32 v4, 16, v162
    v_and_b32 v5, s6, v162
    v_pk_mul_f32 v[180:181], v[168:169], v[4:5] op_sel:[0,0] op_sel_hi:[0,1]
    v_lshlrev_b32 v6, 16, v163
    v_and_b32 v7, s6, v163
    v_pk_mul_f32 v[182:183], v[168:169], v[6:7] op_sel:[0,0] op_sel_hi:[0,1]
    v_lshlrev_b32 v4, 16, v164
    v_and_b32 v5, s6, v164
    v_pk_fma_f32 v[176:177], v[168:169], v[4:5], v[176:177] op_sel:[1,0,0] op_sel_hi:[1,1,1]
    v_lshlrev_b32 v6, 16, v165
    v_and_b32 v7, s6, v165
    v_pk_fma_f32 v[178:179], v[168:169], v[6:7], v[178:179] op_sel:[1,0,0] op_sel_hi:[1,1,1]
    v_lshlrev_b32 v4, 16, v166
    v_and_b32 v5, s6, v166
    v_pk_fma_f32 v[180:181], v[168:169], v[4:5], v[180:181] op_sel:[1,0,0] op_sel_hi:[1,1,1]
    v_lshlrev_b32 v6, 16, v167
    v_and_b32 v7, s6, v167
    v_pk_fma_f32 v[182:183], v[168:169], v[6:7], v[182:183] op_sel:[1,0,0] op_sel_hi:[1,1,1]
    v_permlane32_swap_b32 v176, v180
    v_permlane32_swap_b32 v177, v181
    v_permlane32_swap_b32 v178, v182
    v_permlane32_swap_b32 v179, v183
    v_add_f32 v176, v176, v180
    v_add_f32 v177, v177, v181
    v_add_f32 v178, v178, v182
    v_add_f32 v179, v179, v183
    s_nop 0
    v_permlane16_swap_b32 v176, v178
    v_permlane16_swap_b32 v177, v179
    v_add_f32 v176, v176, v178
    v_add_f32 v177, v177, v179
    s_nop 0
    v_add_f32_dpp v176, v176, v176 row_ror:8 row_mask:0xf bank_mask:0xf
    v_add_f32_dpp v177, v177, v177 row_ror:8 row_mask:0xf bank_mask:0xf
    s_nop 1
    v_mov_b32_dpp v176, v177 quad_perm:[0,1,2,3] row_mask:0xf bank_mask:0xc
    s_waitcnt lgkmcnt(0)
    s_mul_i32 s4, s4, 0x9e3779b1
    s_add_u32 s4, s4, 0x7f4a7c15
    ds_write_b32 v252, v176
    s_waitcnt lgkmcnt(0)
    s_barrier
    ds_read_b128 v[176:179], v251
    ds_read_b128 v[180:183], v251 offset:16
    s_waitcnt lgkmcnt(0)
    v_pk_add_f32 v[176:177], v[176:177], v[178:179]
    v_pk_add_f32 v[180:181], v[180:181], v[182:183]
    v_pk_add_f32 v[176:177], v[176:177], v[180:181]
    v_add_f32 v176, v176, v177
    v_mov_b32 v177, s4
    s_bitcmp1_b32 s3, 0
    s_cselect_b32 exec_lo, 0, -1
    s_cselect_b32 exec_hi, -1, 0
    buffer_store_dwordx2 v[176:177], v250, s[32:35], s13 offen sc1
    s_mov_b64 exec, -1
    s_lshr_b32 s96, s9, 4
    s_lshl_b32 s94, s96, 1
    s_add_u32 s96, s94, s84
    s_and_b32 s97, s96, 15
    s_mul_i32 s98, s97, 393216
    s_add_u32 s91, s98, s85
    s_lshl_b32 s96, s94, 13
    s_add_u32 s94, s96, s83
    s_add_u32 s82, s91, 2048
    s_mov_b32 m0, s94
    s_nop 0
    buffer_load_dwordx4 v3, s[40:43], s82 offen lds
    s_add_u32 s82, s91, 4096
    s_add_u32 m0, s94, 49152
    s_nop 0
    buffer_load_dwordx4 v3, s[40:43], s82 offen lds
    s_waitcnt vmcnt(6)
    v_mov_b32 v8, 0x3f803f80
    v_dot2_f32_bf16 v4, v152, v8, 0
    v_dot2_f32_bf16 v5, v152, v152, 0
    v_dot2_f32_bf16 v6, v153, v8, 0
    v_dot2_f32_bf16 v7, v153, v153, 0
    v_dot2_f32_bf16 v4, v154, v8, v4
    v_dot2_f32_bf16 v5, v154, v154, v5
    v_dot2_f32_bf16 v6, v155, v8, v6
    v_dot2_f32_bf16 v7, v155, v155, v7
    v_dot2_f32_bf16 v4, v156, v8, v4
    v_dot2_f32_bf16 v5, v156, v156, v5
    v_dot2_f32_bf16 v6, v157, v8, v6
    v_dot2_f32_bf16 v7, v157, v157, v7
    v_dot2_f32_bf16 v4, v158, v8, v4
    v_dot2_f32_bf16 v5, v158, v158, v5
    v_dot2_f32_bf16 v6, v159, v8, v6
    v_dot2_f32_bf16 v7, v159, v159, v7
    s_lshl_b32 s96, s3, 5
    s_add_u32 s13, s96, 153600
    v_lshrrev_b32 v8, 5, v1
    v_lshl_add_u32 v8, v8, 4, s13
    v_bfe_u32 v9, v1, 4, 1
    v_lshl_add_u32 v8, v9, 3, v8
    v_pk_add_f32 v[172:173], v[4:5], v[6:7]
    v_and_b32 v5, 15, v1
    v_lshlrev_b32 v5, 4, v5
    v_add_u32 v5, 153600, v5
    v_and_b32 v4, 15, v1
    v_lshlrev_b32 v4, 4, v4
    v_bfe_u32 v9, v1, 4, 1
    v_lshl_add_u32 v4, v9, 12, v4
    v_add_f32_dpp v172, v172, v172 quad_perm:[1,0,3,2] row_mask:0xf bank_mask:0xf
    v_add_f32_dpp v173, v173, v173 quad_perm:[1,0,3,2] row_mask:0xf bank_mask:0xf
    s_nop 0
    v_add_f32_dpp v172, v172, v172 quad_perm:[2,3,0,1] row_mask:0xf bank_mask:0xf
    v_add_f32_dpp v173, v173, v173 quad_perm:[2,3,0,1] row_mask:0xf bank_mask:0xf
    s_nop 0
    v_add_f32_dpp v172, v172, v172 row_half_mirror row_mask:0xf bank_mask:0xf
    v_add_f32_dpp v173, v173, v173 row_half_mirror row_mask:0xf bank_mask:0xf
    s_nop 0
    v_add_f32_dpp v172, v172, v172 row_mirror row_mask:0xf bank_mask:0xf
    v_add_f32_dpp v173, v173, v173 row_mirror row_mask:0xf bank_mask:0xf
    s_and_b32 s96, s9, 24
    s_add_u32 s97, s96, s3
    s_and_b32 s98, s8, 6
    s_lshl3_add_u32 s99, s97, s98
    s_lshl_b32 s96, s99, 12
    s_and_b32 s97, s9, 7
    s_lshl_b32 s98, s97, 9
    s_add_u32 s99, s96, s98
    s_and_b32 s97, s8, 1
    s_lshl_b32 s96, s97, 8
    s_add_u32 s98, s99, s96
    s_add_u32 s13, s98, 2097152
    v_permlane16_swap_b32 v172, v173
    v_add_f32 v172, v172, v173
    v_mov_b32 v173, s4
    ds_write_b64 v8, v[172:173]
    s_waitcnt lgkmcnt(0)
    s_barrier
    ds_read_b128 v[172:175], v5
    s_waitcnt lgkmcnt(0)
    s_mov_b32 exec_hi, 0
    buffer_store_dwordx4 v[172:175], v4, s[32:35], s13 offen sc1
    s_mov_b32 exec_hi, -1
    s_mov_b32 s82, s91
    s_add_u32 m0, s94, 98304
    s_nop 0
    buffer_load_dwordx4 v3, s[40:43], s82 offen lds
    s_lshr_b32 s96, s9, 4
    s_lshl_b32 s97, s96, 1
    s_xor_b32 s94, s97, 1
    s_add_u32 s96, s94, s84
    s_and_b32 s97, s96, 15
    s_mul_i32 s98, s97, 393216
    s_add_u32 s91, s98, s85
    s_lshl_b32 s96, s94, 13
    s_add_u32 s94, s96, s83
    s_add_u32 s82, s91, 2048
    s_mov_b32 m0, s94
    s_nop 0
    buffer_load_dwordx4 v3, s[40:43], s82 offen lds
    s_load_dword s24, s[32:33], s17 offset:508 glc
    s_load_dword s25, s[32:33], s17 offset:4604 glc
    v_and_b32 v4, 31, v1
    v_lshlrev_b32 v4, 4, v4
    v_lshrrev_b32 v9, 5, v1
    v_lshl_add_u32 v4, v9, 12, v4
    s_lshl2_add_u32 s14, s3, 155648
    v_lshl_add_u32 v5, v1, 6, s14
    v_and_b32 v6, 3, v1
    v_lshlrev_b32 v6, 5, v6
    v_lshrrev_b32 v9, 5, v1
    v_lshl_add_u32 v6, v9, 7, v6
    v_bfe_u32 v9, v1, 4, 1
    v_lshl_add_u32 v6, v9, 8, v6
    v_bfe_u32 v9, v1, 2, 2
    v_lshl_add_u32 v6, v9, 9, v6
    v_add_u32 v6, 155648, v6
    s_lshl3_add_u32 s96, s2, s3
    s_lshl_b32 s97, s96, 9
    s_add_u32 s14, s97, 2097152
    v_and_b32 v8, 31, v1
    v_lshlrev_b32 v8, 4, v8
    s_branch SCHK_2
SPOLL_1:
    s_load_dword s24, s[32:33], s17 offset:508 glc
    s_load_dword s25, s[32:33], s17 offset:4604 glc
SCHK_2:
    s_add_u32 s5, s5, 1
    s_cmp_ge_u32 s5, 200000
    s_waitcnt lgkmcnt(0)
    s_cbranch_scc1 SDONE_3
    s_cmp_lg_u32 s24, s4
    s_cbranch_scc1 SPOLL_1
    s_cmp_lg_u32 s25, s4
    s_cbranch_scc1 SPOLL_1
SDONE_3:
    buffer_load_dwordx4 v[176:179], v4, s[32:35], s17 offen sc1
    s_load_dword s24, s[32:33], s14 offset:252 glc
    s_load_dword s25, s[32:33], s14 offset:508 glc
    s_waitcnt vmcnt(7)
    v_permlane32_swap_b32 v12, v14
    v_permlane32_swap_b32 v13, v15
    v_permlane32_swap_b32 v16, v18
    v_permlane32_swap_b32 v17, v19
    v_lshlrev_b32 v184, 16, v12
    v_and_b32 v185, s6, v12
    v_lshlrev_b32 v186, 16, v13
    v_and_b32 v187, s6, v13
    v_lshlrev_b32 v188, 16, v14
    v_and_b32 v189, s6, v14
    v_lshlrev_b32 v190, 16, v15
    v_and_b32 v191, s6, v15
    v_lshlrev_b32 v192, 16, v16
    v_and_b32 v193, s6, v16
    v_lshlrev_b32 v194, 16, v17
    v_and_b32 v195, s6, v17
    v_lshlrev_b32 v196, 16, v18
    v_and_b32 v197, s6, v18
    v_lshlrev_b32 v198, 16, v19
    v_and_b32 v199, s6, v19
    s_branch SCHK_6
SPOLL_5:
    s_load_dword s24, s[32:33], s14 offset:252 glc
    s_load_dword s25, s[32:33], s14 offset:508 glc
SCHK_6:
    s_add_u32 s5, s5, 1
    s_cmp_ge_u32 s5, 200000
    s_waitcnt lgkmcnt(0)
    s_cbranch_scc1 SDONE_7
    s_cmp_lg_u32 s24, s4
    s_cbranch_scc1 SPOLL_5
    s_cmp_lg_u32 s25, s4
    s_cbranch_scc1 SPOLL_5
SDONE_7:
    buffer_load_dwordx4 v[172:175], v8, s[32:35], s14 offen sc1
    s_add_u32 s82, s91, 4096
    s_add_u32 m0, s94, 49152
    s_nop 0
    buffer_load_dwordx4 v3, s[40:43], s82 offen lds
    s_mov_b32 s82, s91
    s_add_u32 m0, s94, 98304
    s_nop 0
    buffer_load_dwordx4 v3, s[40:43], s82 offen lds
    s_waitcnt vmcnt(3)
    v_bitop3_b32 v7, v177, v179, s4 bitop3:0x7e
    v_cmp_ne_u32 vcc, 0, v7
    s_cbranch_vccz TOK_8
POLL_9:
    buffer_load_dwordx4 v[176:179], v4, s[32:35], s17 offen sc1
    s_waitcnt vmcnt(0)
    v_bitop3_b32 v7, v177, v179, s4 bitop3:0x7e
    v_cmp_ne_u32 vcc, 0, v7
    s_cbranch_vccz PDONE_10
    s_add_u32 s5, s5, 1
    s_cmp_lt_u32 s5, 200000
    s_cbranch_scc1 POLL_9
PDONE_10:
TOK_8:
    ds_write2_b32 v5, v176, v178 offset0:0 offset1:8
    s_waitcnt lgkmcnt(0)
    s_barrier
    ds_read_b128 v[208:211], v6 offset:2048
    ds_read_b128 v[212:215], v6 offset:2064
    ds_read_b128 v[200:203], v6
    ds_read_b128 v[204:207], v6 offset:16
    s_lshl_b32 s96, s11, 12
    s_lshl_b32 s97, s3, 9
    s_add_u32 s13, s96, s97
    v_add_u32 v4, s13, v2
    s_lshl_b32 s96, s3, 9
    s_add_u32 m0, s96, 159744
    s_mov_b32 exec_hi, 0
    global_load_lds_dwordx4 v4, s[72:73]
    s_mov_b32 exec_hi, -1
    s_lshl4_add_u32 s96, s21, s12
    s_lshr_b32 s97, s3, 1
    s_lshl2_add_u32 s98, s96, s97
    s_lshl_b32 s99, s98, 12
    s_and_b32 s96, s3, 1
    s_lshl_b32 s97, s96, 8
    s_add_u32 s98, s99, s97
    s_add_u32 s13, s98, 4194304
    v_and_b32 v4, 15, v1
    v_lshlrev_b32 v4, 4, v4
    v_bfe_u32 v9, v1, 4, 1
    v_lshl_add_u32 v4, v9, 10, v4
    v_lshrrev_b32 v9, 5, v1
    v_lshl_add_u32 v4, v9, 9, v4
    s_waitcnt lgkmcnt(2)
    v_pk_add_f32 v[208:209], v[208:209], v[210:211]
    v_pk_add_f32 v[212:213], v[212:213], v[214:215]
    v_pk_add_f32 v[208:209], v[208:209], v[212:213]
    v_add_f32 v208, v208, v209
    v_cvt_pk_bf16_f32 v208, 0, v208
    s_waitcnt lgkmcnt(0)
    v_pk_add_f32 v[200:201], v[200:201], v[202:203]
    v_pk_add_f32 v[204:205], v[204:205], v[206:207]
    v_pk_add_f32 v[200:201], v[200:201], v[204:205]
    v_add_f32 v200, v200, v201
    v_add_f32 v208, 1.0, v208
    v_cvt_pk_bf16_f32 v208, 0, v208
    v_cvt_pk_bf16_f32 v200, 0, v200
    s_waitcnt vmcnt(3)
    v_bitop3_b32 v7, v173, v175, s4 bitop3:0x7e
    v_cmp_ne_u32 vcc, 0, v7
    s_cbranch_vccz L_STOK
POLL_11:
    buffer_load_dwordx4 v[172:175], v8, s[32:35], s14 offen sc1
    s_waitcnt vmcnt(0)
    v_bitop3_b32 v7, v173, v175, s4 bitop3:0x7e
    v_cmp_ne_u32 vcc, 0, v7
    s_cbranch_vccz PDONE_12
    s_add_u32 s5, s5, 1
    s_cmp_lt_u32 s5, 200000
    s_cbranch_scc1 POLL_11
PDONE_12:
L_STOK:
    v_permlane16_swap_b32 v172, v174
    v_add_f32 v175, v172, v174
    v_mul_f32 v174, 0x3a800000, v175
    v_mul_f32 v175, 0x3a800000, v175
    s_nop 1
    v_permlane16_swap_b32 v174, v175
    v_fma_f32 v172, -v174, v174, v175
    v_cvt_pk_bf16_f32 v173, 0, v174
    v_max_f32 v172, 0, v172
    v_cvt_pk_bf16_f32 v172, 0, v172
    v_pk_add_f32 v[184:185], v[172:173], v[184:185] op_sel:[1,0] neg_lo:[1,0] neg_hi:[1,0]
    v_pk_add_f32 v[186:187], v[172:173], v[186:187] op_sel:[1,0] neg_lo:[1,0] neg_hi:[1,0]
    v_pk_add_f32 v[188:189], v[172:173], v[188:189] op_sel:[1,0] neg_lo:[1,0] neg_hi:[1,0]
    v_pk_add_f32 v[190:191], v[172:173], v[190:191] op_sel:[1,0] neg_lo:[1,0] neg_hi:[1,0]
    v_add_f32 v172, 0x3727c5ac, v172
    v_cvt_pk_bf16_f32 v172, 0, v172
    v_sqrt_f32 v172, v172
    s_nop 0
    v_pk_add_f32 v[192:193], v[172:173], v[192:193] op_sel:[1,0] neg_lo:[1,0] neg_hi:[1,0]
    v_pk_add_f32 v[194:195], v[172:173], v[194:195] op_sel:[1,0] neg_lo:[1,0] neg_hi:[1,0]
    v_pk_add_f32 v[196:197], v[172:173], v[196:197] op_sel:[1,0] neg_lo:[1,0] neg_hi:[1,0]
    v_pk_add_f32 v[198:199], v[172:173], v[198:199] op_sel:[1,0] neg_lo:[1,0] neg_hi:[1,0]
    v_cvt_pk_bf16_f32 v172, 0, v172
    v_rcp_f32 v172, v172
    v_cvt_pk_bf16_f32 v184, 0, v184
    v_cvt_pk_bf16_f32 v185, 0, v185
    v_cvt_pk_bf16_f32 v186, 0, v186
    v_cvt_pk_bf16_f32 v187, 0, v187
    v_cvt_pk_bf16_f32 v188, 0, v188
    v_cvt_pk_bf16_f32 v189, 0, v189
    v_cvt_pk_bf16_f32 v190, 0, v190
    v_cvt_pk_bf16_f32 v191, 0, v191
    v_cvt_pk_bf16_f32 v192, 0, v192
    v_cvt_pk_bf16_f32 v193, 0, v193
    v_cvt_pk_bf16_f32 v194, 0, v194
    v_cvt_pk_bf16_f32 v195, 0, v195
    v_cvt_pk_bf16_f32 v196, 0, v196
    v_cvt_pk_bf16_f32 v197, 0, v197
    v_cvt_pk_bf16_f32 v198, 0, v198
    v_cvt_pk_bf16_f32 v199, 0, v199
    v_pk_mul_f32 v[184:185], v[184:185], v[172:173] op_sel_hi:[1,0]
    v_pk_mul_f32 v[186:187], v[186:187], v[172:173] op_sel_hi:[1,0]
    v_pk_mul_f32 v[188:189], v[188:189], v[172:173] op_sel_hi:[1,0]
    v_pk_mul_f32 v[190:191], v[190:191], v[172:173] op_sel_hi:[1,0]
    v_pk_mul_f32 v[192:193], v[192:193], v[172:173] op_sel_hi:[1,0]
    v_pk_mul_f32 v[194:195], v[194:195], v[172:173] op_sel_hi:[1,0]
    v_pk_mul_f32 v[196:197], v[196:197], v[172:173] op_sel_hi:[1,0]
    v_pk_mul_f32 v[198:199], v[198:199], v[172:173] op_sel_hi:[1,0]
    v_cvt_pk_bf16_f32 v184, 0, v184
    v_cvt_pk_bf16_f32 v185, 0, v185
    v_cvt_pk_bf16_f32 v186, 0, v186
    v_cvt_pk_bf16_f32 v187, 0, v187
    v_cvt_pk_bf16_f32 v188, 0, v188
    v_cvt_pk_bf16_f32 v189, 0, v189
    v_cvt_pk_bf16_f32 v190, 0, v190
    v_cvt_pk_bf16_f32 v191, 0, v191
    v_cvt_pk_bf16_f32 v192, 0, v192
    v_cvt_pk_bf16_f32 v193, 0, v193
    v_cvt_pk_bf16_f32 v194, 0, v194
    v_cvt_pk_bf16_f32 v195, 0, v195
    v_cvt_pk_bf16_f32 v196, 0, v196
    v_cvt_pk_bf16_f32 v197, 0, v197
    v_cvt_pk_bf16_f32 v198, 0, v198
    v_cvt_pk_bf16_f32 v199, 0, v199
    v_mul_f32_dpp v184, v208, v184 row_newbcast:0 row_mask:0xf bank_mask:0xf
    v_mul_f32_dpp v185, v208, v185 row_newbcast:1 row_mask:0xf bank_mask:0xf
    v_mul_f32_dpp v186, v208, v186 row_newbcast:2 row_mask:0xf bank_mask:0xf
    v_mul_f32_dpp v187, v208, v187 row_newbcast:3 row_mask:0xf bank_mask:0xf
    v_mul_f32_dpp v188, v208, v188 row_newbcast:4 row_mask:0xf bank_mask:0xf
    v_mul_f32_dpp v189, v208, v189 row_newbcast:5 row_mask:0xf bank_mask:0xf
    v_mul_f32_dpp v190, v208, v190 row_newbcast:6 row_mask:0xf bank_mask:0xf
    v_mul_f32_dpp v191, v208, v191 row_newbcast:7 row_mask:0xf bank_mask:0xf
    v_cvt_pk_bf16_f32 v184, 0, v184
    v_cvt_pk_bf16_f32 v185, 0, v185
    v_cvt_pk_bf16_f32 v186, 0, v186
    v_cvt_pk_bf16_f32 v187, 0, v187
    v_cvt_pk_bf16_f32 v188, 0, v188
    v_cvt_pk_bf16_f32 v189, 0, v189
    v_cvt_pk_bf16_f32 v190, 0, v190
    v_cvt_pk_bf16_f32 v191, 0, v191
    v_add_f32_dpp v184, v200, v184 row_newbcast:0 row_mask:0xf bank_mask:0xf
    v_add_f32_dpp v185, v200, v185 row_newbcast:1 row_mask:0xf bank_mask:0xf
    v_add_f32_dpp v186, v200, v186 row_newbcast:2 row_mask:0xf bank_mask:0xf
    v_add_f32_dpp v187, v200, v187 row_newbcast:3 row_mask:0xf bank_mask:0xf
    v_add_f32_dpp v188, v200, v188 row_newbcast:4 row_mask:0xf bank_mask:0xf
    v_add_f32_dpp v189, v200, v189 row_newbcast:5 row_mask:0xf bank_mask:0xf
    v_add_f32_dpp v190, v200, v190 row_newbcast:6 row_mask:0xf bank_mask:0xf
    v_add_f32_dpp v191, v200, v191 row_newbcast:7 row_mask:0xf bank_mask:0xf
    v_cvt_pk_bf16_f32 v216, v184, v185
    v_cvt_pk_bf16_f32 v217, v186, v187
    v_cvt_pk_bf16_f32 v218, v188, v189
    v_cvt_pk_bf16_f32 v219, v190, v191
    buffer_store_dwordx4 v[216:219], v4, s[32:35], s13 offen sc1
    v_mul_f32_dpp v192, v208, v192 row_newbcast:8 row_mask:0xf bank_mask:0xf
    v_mul_f32_dpp v193, v208, v193 row_newbcast:9 row_mask:0xf bank_mask:0xf
    v_mul_f32_dpp v194, v208, v194 row_newbcast:10 row_mask:0xf bank_mask:0xf
    v_mul_f32_dpp v195, v208, v195 row_newbcast:11 row_mask:0xf bank_mask:0xf
    v_mul_f32_dpp v196, v208, v196 row_newbcast:12 row_mask:0xf bank_mask:0xf
    v_mul_f32_dpp v197, v208, v197 row_newbcast:13 row_mask:0xf bank_mask:0xf
    v_mul_f32_dpp v198, v208, v198 row_newbcast:14 row_mask:0xf bank_mask:0xf
    v_mul_f32_dpp v199, v208, v199 row_newbcast:15 row_mask:0xf bank_mask:0xf
    v_cvt_pk_bf16_f32 v192, 0, v192
    v_cvt_pk_bf16_f32 v193, 0, v193
    v_cvt_pk_bf16_f32 v194, 0, v194
    v_cvt_pk_bf16_f32 v195, 0, v195
    v_cvt_pk_bf16_f32 v196, 0, v196
    v_cvt_pk_bf16_f32 v197, 0, v197
    v_cvt_pk_bf16_f32 v198, 0, v198
    v_cvt_pk_bf16_f32 v199, 0, v199
    v_add_f32_dpp v192, v200, v192 row_newbcast:8 row_mask:0xf bank_mask:0xf
    v_add_f32_dpp v193, v200, v193 row_newbcast:9 row_mask:0xf bank_mask:0xf
    v_add_f32_dpp v194, v200, v194 row_newbcast:10 row_mask:0xf bank_mask:0xf
    v_add_f32_dpp v195, v200, v195 row_newbcast:11 row_mask:0xf bank_mask:0xf
    v_add_f32_dpp v196, v200, v196 row_newbcast:12 row_mask:0xf bank_mask:0xf
    v_add_f32_dpp v197, v200, v197 row_newbcast:13 row_mask:0xf bank_mask:0xf
    v_add_f32_dpp v198, v200, v198 row_newbcast:14 row_mask:0xf bank_mask:0xf
    v_add_f32_dpp v199, v200, v199 row_newbcast:15 row_mask:0xf bank_mask:0xf
    v_cvt_pk_bf16_f32 v220, v192, v193
    v_cvt_pk_bf16_f32 v221, v194, v195
    v_cvt_pk_bf16_f32 v222, v196, v197
    v_cvt_pk_bf16_f32 v223, v198, v199
    buffer_store_dwordx4 v[220:223], v4, s[32:35], s13 offen offset:2048 sc1
    v_bfe_u32 v20, v1, 2, 2
    v_lshlrev_b32 v20, 7, v20
    v_bfe_u32 v9, v1, 3, 1
    v_lshl_add_u32 v20, v9, 6, v20
    v_bfe_u32 v9, v1, 4, 1
    v_lshl_add_u32 v20, v9, 5, v20
    v_and_b32 v9, 3, v1
    v_lshl_add_u32 v20, v9, 3, v20
    v_lshrrev_b32 v9, 5, v1
    v_lshl_add_u32 v20, v9, 9, v20
    v_xor_b32 v21, 64, v20
    v_add_u32 v22, 49152, v20
    v_add_u32 v23, 49152, v21
    v_add_u32 v24, 98304, v20
    v_add_u32 v25, 98304, v21
    v_and_b32 v5, 3, v1
    v_lshlrev_b32 v5, 15, v5
    v_bfe_u32 v9, v1, 2, 2
    v_lshl_add_u32 v5, v9, 12, v5
    s_and_b32 s96, s12, 1
    s_lshr_b32 s97, s21, 3
    s_and_b32 s98, s21, 7
    s_lshl_b32 s99, s98, 5
    s_lshl2_add_u32 s98, s97, s99
    s_lshl_b32 s97, s98, 12
    s_lshr_b32 s99, s12, 1
    s_lshl_b32 s98, s99, 6
    s_add_u32 s99, s97, s98
    s_lshl2_add_u32 s97, s96, s99
    s_add_u32 s13, s97, 1048576
    s_lshl_b32 s96, s10, 18
    s_lshl_b32 s97, s77, 12
    s_add_u32 s98, s96, s97
    s_add_u32 s88, s98, 4194304
    s_cmp_ge_u32 s9, 28
    s_cselect_b32 s54, 0, s54
    s_cselect_b32 s58, 0, s58
    s_cselect_b32 s62, 0, s62
    s_waitcnt vmcnt(0)
    s_barrier
    s_cmp_lg_u32 s3, 0
    s_cbranch_scc1 L_PB
    v_mov_b32 v6, s4
    s_mov_b32 exec_hi, 0
    s_mov_b32 exec_lo, 65535
    buffer_store_dword v6, v5, s[32:35], s13 offen sc1
    s_mov_b64 exec, -1
L_PB:
    s_lshr_b32 s96, s9, 4
    s_lshl_b32 s97, s96, 1
    s_xor_b32 s94, s97, 2
    s_add_u32 s96, s94, s84
    s_and_b32 s97, s96, 15
    s_mul_i32 s98, s97, 393216
    s_add_u32 s91, s98, s85
    s_lshl_b32 s96, s94, 13
    s_add_u32 s94, s96, s83
    s_add_u32 s82, s91, 2048
    s_mov_b32 m0, s94
    s_nop 0
    buffer_load_dwordx4 v3, s[40:43], s82 offen lds
    s_add_u32 s82, s91, 4096
    s_add_u32 m0, s94, 49152
    s_nop 0
    buffer_load_dwordx4 v3, s[40:43], s82 offen lds
    s_mov_b32 s82, s91
    s_add_u32 m0, s94, 98304
    s_nop 0
    buffer_load_dwordx4 v3, s[40:43], s82 offen lds
    s_lshr_b32 s96, s9, 4
    s_lshl_b32 s97, s96, 1
    s_xor_b32 s94, s97, 3
    s_add_u32 s96, s94, s84
    s_and_b32 s97, s96, 15
    s_mul_i32 s98, s97, 393216
    s_add_u32 s91, s98, s85
    s_lshl_b32 s96, s94, 13
    s_add_u32 s94, s96, s83
    s_add_u32 s82, s91, 2048
    s_mov_b32 m0, s94
    s_nop 0
    buffer_load_dwordx4 v3, s[40:43], s82 offen lds
    s_add_u32 s82, s91, 4096
    s_add_u32 m0, s94, 49152
    s_nop 0
    buffer_load_dwordx4 v3, s[40:43], s82 offen lds
    s_mov_b32 s82, s91
    s_add_u32 m0, s94, 98304
    s_nop 0
    buffer_load_dwordx4 v3, s[40:43], s82 offen lds
    s_lshl_b32 s96, s2, 12
    s_add_u32 s19, s96, 1048576
    s_and_b32 s96, s3, 3
    s_lshl_b32 s97, s96, 7
    s_add_u32 s20, s97, s19
    s_lshl_b32 s96, s84, 5
    s_add_u32 s19, s96, s19
    s_cmp_ge_u32 s3, 4
    s_cselect_b32 s19, s20, s19
    s_load_dwordx2 s[24:25], s[32:33], s19 offset:0 glc
    s_load_dwordx2 s[26:27], s[32:33], s19 offset:64 glc
    s_lshl_b32 s96, s3, 14
    s_lshl_b32 s97, s12, 7
    s_add_u32 s90, s96, s97
    s_and_b32 s96, s9, 1
    s_lshr_b32 s97, s9, 3
    s_lshl_b32 s98, s97, 1
    s_lshl3_add_u32 s99, s96, s98
    s_lshl_b32 s95, s99, 17
    s_lshl3_add_u32 s96, s75, s3
    s_mul_i32 s97, s96, 229376
    s_lshl_b32 s98, s74, 7
    s_add_u32 s80, s97, s98
    s_lshl3_add_u32 s96, s74, s3
    s_lshl_b32 s97, s96, 14
    s_lshl_b32 s98, s75, 9
    s_add_u32 s81, s97, s98
    s_and_b32 s96, s8, 3
    s_lshl3_add_u32 s97, s96, s3
    s_mul_i32 s98, s97, 393216
    s_lshr_b32 s99, s8, 2
    s_lshl1_add_u32 s96, s9, s99
    s_lshl_b32 s97, s96, 7
    s_add_u32 s99, s98, s97
    s_add_u32 s89, s99, 4096
    s_and_b32 s96, s3, 1
    s_lshl_b32 s14, s96, 6
    v_bfe_u32 v6, v1, 4, 1
    v_lshl_add_u32 v6, v6, 5, s14
    v_and_b32 v26, 7, v1
    v_lshlrev_b32 v26, 4, v26
    v_xor_b32 v26, v26, v6
    v_lshrrev_b32 v6, 3, v1
    v_lshlrev_b32 v6, 11, v6
    v_add_u32 v26, v26, v6
    s_and_b32 s96, s3, 2
    s_lshl_b32 s14, s96, 5
    v_bfe_u32 v6, v1, 4, 1
    v_lshl_add_u32 v6, v6, 5, s14
    v_and_b32 v27, 7, v1
    v_lshlrev_b32 v27, 4, v27
    v_xor_b32 v27, v27, v6
    v_lshrrev_b32 v6, 3, v1
    v_mul_u32_u24 v6, 7168, v6
    v_add_u32 v27, v27, v6
    s_and_b32 s96, s3, 1
    s_lshl_b32 s14, s96, 7
    v_lshrrev_b32 v6, 5, v1
    v_lshl_add_u32 v6, v6, 6, s14
    v_and_b32 v253, 31, v1
    v_lshlrev_b32 v253, 4, v253
    v_lshrrev_b32 v9, 5, v1
    v_lshl_add_u32 v253, v9, 11, v253
    v_xor_b32 v253, v253, v6
    s_lshl_b32 s16, s84, 14
    v_add_u32 v249, s88, v2
    s_lshl_b32 s96, s77, 11
    s_add_u32 s14, s96, 151552
    v_add_u32 v0, s14, v2
    s_mov_b64 exec, 0
    s_cmp_eq_u32 s3, 4
    s_cbranch_scc1 L_PAD2
    s_cmp_eq_u32 s3, 5
    s_cbranch_scc1 L_PAD3
    s_cmp_eq_u32 s3, 6
    s_cbranch_scc1 L_PAD4
    s_cmp_eq_u32 s3, 7
    s_cbranch_scc1 L_PAD5
    s_branch L_TEND
L_RET2:
    s_branch L_PAD6
L_RET6:
    s_branch L_PAD10
L_RET10:
    s_branch L_TEND
L_RET3:
    s_branch L_PAD7
L_RET7:
    s_branch L_TEND
L_RET4:
    s_branch L_PAD8
L_RET8:
    s_branch L_TEND
L_RET5:
    s_branch L_PAD9
L_RET9:
    s_branch L_TEND
    s_nop 0
    s_nop 0
    s_nop 0
    s_nop 0
    s_nop 0
    s_nop 0
    s_nop 0
    s_nop 0
    s_nop 0
    s_nop 0
    s_nop 0
    s_nop 0
    s_nop 0
    s_nop 0
    s_nop 0
    s_nop 0
    s_nop 0
    s_nop 0
    s_nop 0
    s_nop 0
    s_nop 0
    s_nop 0
    s_nop 0
    s_nop 0
    s_nop 0
    s_nop 0
    s_nop 0
    s_nop 0
L_TEND:
    s_mov_b64 exec, -1
    s_cmp_ge_u32 s3, 4
    s_cbranch_scc1 L_HELP
    s_branch SCHK_14
SPOLL_13:
    s_load_dwordx2 s[24:25], s[32:33], s19 offset:0 glc
    s_load_dwordx2 s[26:27], s[32:33], s19 offset:64 glc
SCHK_14:
    s_add_u32 s5, s5, 1
    s_cmp_ge_u32 s5, 200000
    s_waitcnt lgkmcnt(0)
    s_cbranch_scc1 SDONE_15
    s_cmp_lg_u32 s24, s4
    s_cbranch_scc1 SPOLL_13
    s_cmp_lg_u32 s25, s4
    s_cbranch_scc1 SPOLL_13
    s_cmp_lg_u32 s26, s4
    s_cbranch_scc1 SPOLL_13
    s_cmp_lg_u32 s27, s4
    s_cbranch_scc1 SPOLL_13
SDONE_15:
    s_setprio 2
    buffer_load_dwordx4 v[152:155], v249, s[32:35], s16 offen sc1
    buffer_load_dwordx4 v[156:159], v249, s[32:35], s16 offen offset:1024 sc1
    buffer_load_dwordx4 v[160:163], v249, s[32:35], s16 offen offset:2048 sc1
    buffer_load_dwordx4 v[164:167], v249, s[32:35], s16 offen offset:3072 sc1
    s_add_u32 s16, s16, 16384
    s_and_b32 s16, s16, 0x3ffff
    buffer_load_dwordx4 v[168:171], v249, s[32:35], s16 offen sc1
    buffer_load_dwordx4 v[172:175], v249, s[32:35], s16 offen offset:1024 sc1
    buffer_load_dwordx4 v[176:179], v249, s[32:35], s16 offen offset:2048 sc1
    buffer_load_dwordx4 v[180:183], v249, s[32:35], s16 offen offset:3072 sc1
    s_waitcnt vmcnt(8)
    s_barrier
    ds_read_b64_tr_b16 v[28:29], v20
    ds_read_b64_tr_b16 v[30:31], v20 offset:2048
    ds_read_b64_tr_b16 v[32:33], v21
    ds_read_b64_tr_b16 v[34:35], v21 offset:2048
    ds_read_b64_tr_b16 v[36:37], v24
    ds_read_b64_tr_b16 v[38:39], v24 offset:2048
    ds_read_b64_tr_b16 v[40:41], v25
    ds_read_b64_tr_b16 v[42:43], v25 offset:2048
    ds_read_b64_tr_b16 v[44:45], v22
    ds_read_b64_tr_b16 v[46:47], v22 offset:2048
    ds_read_b64_tr_b16 v[48:49], v23
    ds_read_b64_tr_b16 v[50:51], v23 offset:2048
    s_waitcnt vmcnt(7)
    s_waitcnt lgkmcnt(10)
    v_mfma_f32_32x32x16_bf16 v[56:71], v[28:31], v[152:155], 0
    s_add_u32 s16, s16, 16384
    ds_read_b64_tr_b16 v[52:53], v20 offset:1024
    ds_read_b64_tr_b16 v[54:55], v20 offset:3072
    s_waitcnt lgkmcnt(10)
    v_mfma_f32_32x32x16_bf16 v[72:87], v[32:35], v[152:155], 0
    s_and_b32 s16, s16, 0x3ffff
    ds_read_b64_tr_b16 v[28:29], v21 offset:1024
    ds_read_b64_tr_b16 v[30:31], v21 offset:3072
    s_waitcnt lgkmcnt(10)
    v_mfma_f32_32x32x16_bf16 v[120:135], v[36:39], v[152:155], 0
    ds_read_b64_tr_b16 v[32:33], v24 offset:1024
    ds_read_b64_tr_b16 v[34:35], v24 offset:3072
    s_waitcnt lgkmcnt(10)
    v_mfma_f32_32x32x16_bf16 v[136:151], v[40:43], v[152:155], 0
    buffer_load_dwordx4 v[184:187], v249, s[32:35], s16 offen sc1
    ds_read_b64_tr_b16 v[36:37], v25 offset:1024
    ds_read_b64_tr_b16 v[38:39], v25 offset:3072
    s_waitcnt lgkmcnt(10)
    v_mfma_f32_32x32x16_bf16 v[88:103], v[44:47], v[152:155], 0
    ds_read_b64_tr_b16 v[40:41], v22 offset:1024
    ds_read_b64_tr_b16 v[42:43], v22 offset:3072
    s_waitcnt lgkmcnt(10)
    v_mfma_f32_32x32x16_bf16 v[104:119], v[48:51], v[152:155], 0
    ds_read_b64_tr_b16 v[44:45], v23 offset:1024
    ds_read_b64_tr_b16 v[46:47], v23 offset:3072
    s_waitcnt vmcnt(7)
    s_waitcnt lgkmcnt(10)
    v_mfma_f32_32x32x16_bf16 v[56:71], v[52:55], v[156:159], v[56:71]
    ds_read_b64_tr_b16 v[48:49], v20 offset:4096
    ds_read_b64_tr_b16 v[50:51], v20 offset:6144
    s_waitcnt lgkmcnt(10)
    v_mfma_f32_32x32x16_bf16 v[72:87], v[28:31], v[156:159], v[72:87]
    buffer_load_dwordx4 v[188:191], v249, s[32:35], s16 offen offset:1024 sc1
    ds_read_b64_tr_b16 v[52:53], v21 offset:4096
    ds_read_b64_tr_b16 v[54:55], v21 offset:6144
    s_waitcnt lgkmcnt(10)
    v_mfma_f32_32x32x16_bf16 v[120:135], v[32:35], v[156:159], v[120:135]
    ds_read_b64_tr_b16 v[28:29], v24 offset:4096
    ds_read_b64_tr_b16 v[30:31], v24 offset:6144
    s_waitcnt lgkmcnt(10)
    v_mfma_f32_32x32x16_bf16 v[136:151], v[36:39], v[156:159], v[136:151]
    ds_read_b64_tr_b16 v[32:33], v25 offset:4096
    ds_read_b64_tr_b16 v[34:35], v25 offset:6144
    s_waitcnt lgkmcnt(10)
    v_mfma_f32_32x32x16_bf16 v[88:103], v[40:43], v[156:159], v[88:103]
    ds_read_b64_tr_b16 v[36:37], v22 offset:4096
    ds_read_b64_tr_b16 v[38:39], v22 offset:6144
    s_waitcnt lgkmcnt(10)
    v_mfma_f32_32x32x16_bf16 v[104:119], v[44:47], v[156:159], v[104:119]
    buffer_load_dwordx4 v[192:195], v249, s[32:35], s16 offen offset:2048 sc1
    ds_read_b64_tr_b16 v[40:41], v23 offset:4096
    ds_read_b64_tr_b16 v[42:43], v23 offset:6144
    s_waitcnt vmcnt(8)
    s_waitcnt lgkmcnt(10)
    v_mfma_f32_32x32x16_bf16 v[56:71], v[48:51], v[160:163], v[56:71]
    ds_read_b64_tr_b16 v[44:45], v20 offset:5120
    ds_read_b64_tr_b16 v[46:47], v20 offset:7168
    s_waitcnt lgkmcnt(10)
    v_mfma_f32_32x32x16_bf16 v[72:87], v[52:55], v[160:163], v[72:87]
    ds_read_b64_tr_b16 v[48:49], v21 offset:5120
    ds_read_b64_tr_b16 v[50:51], v21 offset:7168
    s_waitcnt lgkmcnt(10)
    v_mfma_f32_32x32x16_bf16 v[120:135], v[28:31], v[160:163], v[120:135]
    ds_read_b64_tr_b16 v[52:53], v24 offset:5120
    ds_read_b64_tr_b16 v[54:55], v24 offset:7168
    s_waitcnt lgkmcnt(10)
    v_mfma_f32_32x32x16_bf16 v[136:151], v[32:35], v[160:163], v[136:151]
    buffer_load_dwordx4 v[196:199], v249, s[32:35], s16 offen offset:3072 sc1
    ds_read_b64_tr_b16 v[28:29], v25 offset:5120
    ds_read_b64_tr_b16 v[30:31], v25 offset:7168
    s_waitcnt lgkmcnt(10)
    v_mfma_f32_32x32x16_bf16 v[88:103], v[36:39], v[160:163], v[88:103]
    s_add_u32 s16, s16, 16384
    ds_read_b64_tr_b16 v[32:33], v22 offset:5120
    ds_read_b64_tr_b16 v[34:35], v22 offset:7168
    s_waitcnt lgkmcnt(10)
    v_mfma_f32_32x32x16_bf16 v[104:119], v[40:43], v[160:163], v[104:119]
    s_and_b32 s16, s16, 0x3ffff
    ds_read_b64_tr_b16 v[36:37], v23 offset:5120
    ds_read_b64_tr_b16 v[38:39], v23 offset:7168
    s_waitcnt vmcnt(8)
    s_waitcnt lgkmcnt(10)
    v_mfma_f32_32x32x16_bf16 v[56:71], v[44:47], v[164:167], v[56:71]
    ds_read_b64_tr_b16 v[40:41], v20 offset:8192
    ds_read_b64_tr_b16 v[42:43], v20 offset:10240
    s_waitcnt lgkmcnt(10)
    v_mfma_f32_32x32x16_bf16 v[72:87], v[48:51], v[164:167], v[72:87]
    buffer_load_dwordx4 v[200:203], v249, s[32:35], s16 offen sc1
    ds_read_b64_tr_b16 v[44:45], v21 offset:8192
    ds_read_b64_tr_b16 v[46:47], v21 offset:10240
    s_waitcnt lgkmcnt(10)
    v_mfma_f32_32x32x16_bf16 v[120:135], v[52:55], v[164:167], v[120:135]
    ds_read_b64_tr_b16 v[48:49], v24 offset:8192
    ds_read_b64_tr_b16 v[50:51], v24 offset:10240
    s_waitcnt lgkmcnt(10)
    v_mfma_f32_32x32x16_bf16 v[136:151], v[28:31], v[164:167], v[136:151]
    ds_read_b64_tr_b16 v[52:53], v25 offset:8192
    ds_read_b64_tr_b16 v[54:55], v25 offset:10240
    s_waitcnt lgkmcnt(10)
    v_mfma_f32_32x32x16_bf16 v[88:103], v[32:35], v[164:167], v[88:103]
    ds_read_b64_tr_b16 v[28:29], v22 offset:8192
    ds_read_b64_tr_b16 v[30:31], v22 offset:10240
    s_waitcnt lgkmcnt(10)
    v_mfma_f32_32x32x16_bf16 v[104:119], v[36:39], v[164:167], v[104:119]
    buffer_load_dwordx4 v[204:207], v249, s[32:35], s16 offen offset:1024 sc1
    ds_read_b64_tr_b16 v[32:33], v23 offset:8192
    ds_read_b64_tr_b16 v[34:35], v23 offset:10240
    s_barrier
    s_waitcnt vmcnt(9)
    s_waitcnt lgkmcnt(10)
    v_mfma_f32_32x32x16_bf16 v[56:71], v[40:43], v[168:171], v[56:71]
    ds_read_b64_tr_b16 v[36:37], v20 offset:9216
    ds_read_b64_tr_b16 v[38:39], v20 offset:11264
    s_waitcnt lgkmcnt(10)
    v_mfma_f32_32x32x16_bf16 v[72:87], v[44:47], v[168:171], v[72:87]
    ds_read_b64_tr_b16 v[40:41], v21 offset:9216
    ds_read_b64_tr_b16 v[42:43], v21 offset:11264
    s_waitcnt lgkmcnt(10)
    v_mfma_f32_32x32x16_bf16 v[120:135], v[48:51], v[168:171], v[120:135]
    ds_read_b64_tr_b16 v[44:45], v24 offset:9216
    ds_read_b64_tr_b16 v[46:47], v24 offset:11264
    s_waitcnt lgkmcnt(10)
    v_mfma_f32_32x32x16_bf16 v[136:151], v[52:55], v[168:171], v[136:151]
    ds_read_b64_tr_b16 v[48:49], v25 offset:9216
    ds_read_b64_tr_b16 v[50:51], v25 offset:11264
    s_waitcnt lgkmcnt(10)
    v_mfma_f32_32x32x16_bf16 v[88:103], v[28:31], v[168:171], v[88:103]
    ds_read_b64_tr_b16 v[52:53], v22 offset:9216
    ds_read_b64_tr_b16 v[54:55], v22 offset:11264
    s_waitcnt lgkmcnt(10)
    v_mfma_f32_32x32x16_bf16 v[104:119], v[32:35], v[168:171], v[104:119]
    ds_read_b64_tr_b16 v[28:29], v23 offset:9216
    ds_read_b64_tr_b16 v[30:31], v23 offset:11264
    s_waitcnt vmcnt(8)
    s_waitcnt lgkmcnt(10)
    v_mfma_f32_32x32x16_bf16 v[56:71], v[36:39], v[172:175], v[56:71]
    ds_read_b64_tr_b16 v[32:33], v20 offset:12288
    ds_read_b64_tr_b16 v[34:35], v20 offset:14336
    s_waitcnt lgkmcnt(10)
    v_mfma_f32_32x32x16_bf16 v[72:87], v[40:43], v[172:175], v[72:87]
    ds_read_b64_tr_b16 v[36:37], v21 offset:12288
    ds_read_b64_tr_b16 v[38:39], v21 offset:14336
    s_waitcnt lgkmcnt(10)
    v_mfma_f32_32x32x16_bf16 v[120:135], v[44:47], v[172:175], v[120:135]
    buffer_load_dwordx4 v[208:211], v249, s[32:35], s16 offen offset:2048 sc1
    ds_read_b64_tr_b16 v[40:41], v24 offset:12288
    ds_read_b64_tr_b16 v[42:43], v24 offset:14336
    s_waitcnt lgkmcnt(10)
    v_mfma_f32_32x32x16_bf16 v[136:151], v[48:51], v[172:175], v[136:151]
    ds_read_b64_tr_b16 v[44:45], v25 offset:12288
    ds_read_b64_tr_b16 v[46:47], v25 offset:14336
    s_waitcnt lgkmcnt(10)
    v_mfma_f32_32x32x16_bf16 v[88:103], v[52:55], v[172:175], v[88:103]
    ds_read_b64_tr_b16 v[48:49], v22 offset:12288
    ds_read_b64_tr_b16 v[50:51], v22 offset:14336
    s_waitcnt lgkmcnt(10)
    v_mfma_f32_32x32x16_bf16 v[104:119], v[28:31], v[172:175], v[104:119]
    buffer_load_dwordx4 v[212:215], v249, s[32:35], s16 offen offset:3072 sc1
    ds_read_b64_tr_b16 v[52:53], v23 offset:12288
    ds_read_b64_tr_b16 v[54:55], v23 offset:14336
    s_waitcnt vmcnt(9)
    s_waitcnt lgkmcnt(10)
    v_mfma_f32_32x32x16_bf16 v[56:71], v[32:35], v[176:179], v[56:71]
    s_add_u32 s16, s16, 16384
    ds_read_b64_tr_b16 v[28:29], v20 offset:13312
    ds_read_b64_tr_b16 v[30:31], v20 offset:15360
    s_waitcnt lgkmcnt(10)
    v_mfma_f32_32x32x16_bf16 v[72:87], v[36:39], v[176:179], v[72:87]
    s_and_b32 s16, s16, 0x3ffff
    ds_read_b64_tr_b16 v[32:33], v21 offset:13312
    ds_read_b64_tr_b16 v[34:35], v21 offset:15360
    s_waitcnt lgkmcnt(10)
    v_mfma_f32_32x32x16_bf16 v[120:135], v[40:43], v[176:179], v[120:135]
    buffer_load_dwordx4 v[216:219], v249, s[32:35], s16 offen sc1
    ds_read_b64_tr_b16 v[36:37], v24 offset:13312
    ds_read_b64_tr_b16 v[38:39], v24 offset:15360
    s_waitcnt lgkmcnt(10)
    v_mfma_f32_32x32x16_bf16 v[136:151], v[44:47], v[176:179], v[136:151]
    ds_read_b64_tr_b16 v[40:41], v25 offset:13312
    ds_read_b64_tr_b16 v[42:43], v25 offset:15360
    s_waitcnt lgkmcnt(10)
    v_mfma_f32_32x32x16_bf16 v[88:103], v[48:51], v[176:179], v[88:103]
    ds_read_b64_tr_b16 v[44:45], v22 offset:13312
    ds_read_b64_tr_b16 v[46:47], v22 offset:15360
    s_waitcnt lgkmcnt(10)
    v_mfma_f32_32x32x16_bf16 v[104:119], v[52:55], v[176:179], v[104:119]
    buffer_load_dwordx4 v[220:223], v249, s[32:35], s16 offen offset:1024 sc1
    ds_read_b64_tr_b16 v[48:49], v23 offset:13312
    ds_read_b64_tr_b16 v[50:51], v23 offset:15360
    s_waitcnt vmcnt(10)
    s_waitcnt lgkmcnt(10)
    v_mfma_f32_32x32x16_bf16 v[56:71], v[28:31], v[180:183], v[56:71]
    ds_read_b64_tr_b16 v[52:53], v20 offset:16384
    ds_read_b64_tr_b16 v[54:55], v20 offset:18432
    s_waitcnt lgkmcnt(10)
    v_mfma_f32_32x32x16_bf16 v[72:87], v[32:35], v[180:183], v[72:87]
    ds_read_b64_tr_b16 v[28:29], v21 offset:16384
    ds_read_b64_tr_b16 v[30:31], v21 offset:18432
    s_waitcnt lgkmcnt(10)
    v_mfma_f32_32x32x16_bf16 v[120:135], v[36:39], v[180:183], v[120:135]
    buffer_load_dwordx4 v[224:227], v249, s[32:35], s16 offen offset:2048 sc1
    ds_read_b64_tr_b16 v[32:33], v24 offset:16384
    ds_read_b64_tr_b16 v[34:35], v24 offset:18432
    s_waitcnt lgkmcnt(10)
    v_mfma_f32_32x32x16_bf16 v[136:151], v[40:43], v[180:183], v[136:151]
    ds_read_b64_tr_b16 v[36:37], v25 offset:16384
    ds_read_b64_tr_b16 v[38:39], v25 offset:18432
    s_waitcnt lgkmcnt(10)
    v_mfma_f32_32x32x16_bf16 v[88:103], v[44:47], v[180:183], v[88:103]
    ds_read_b64_tr_b16 v[40:41], v22 offset:16384
    ds_read_b64_tr_b16 v[42:43], v22 offset:18432
    s_waitcnt lgkmcnt(10)
    v_mfma_f32_32x32x16_bf16 v[104:119], v[48:51], v[180:183], v[104:119]
    buffer_load_dwordx4 v[228:231], v249, s[32:35], s16 offen offset:3072 sc1
    ds_read_b64_tr_b16 v[44:45], v23 offset:16384
    ds_read_b64_tr_b16 v[46:47], v23 offset:18432
    s_barrier
    s_waitcnt vmcnt(11)
    s_waitcnt lgkmcnt(10)
    v_mfma_f32_32x32x16_bf16 v[56:71], v[52:55], v[184:187], v[56:71]
    s_add_u32 s16, s16, 16384
    ds_read_b64_tr_b16 v[48:49], v20 offset:17408
    ds_read_b64_tr_b16 v[50:51], v20 offset:19456
    s_waitcnt lgkmcnt(10)
    v_mfma_f32_32x32x16_bf16 v[72:87], v[28:31], v[184:187], v[72:87]
    s_and_b32 s16, s16, 0x3ffff
    ds_read_b64_tr_b16 v[52:53], v21 offset:17408
    ds_read_b64_tr_b16 v[54:55], v21 offset:19456
    s_waitcnt lgkmcnt(10)
    v_mfma_f32_32x32x16_bf16 v[120:135], v[32:35], v[184:187], v[120:135]
    ds_read_b64_tr_b16 v[28:29], v24 offset:17408
    ds_read_b64_tr_b16 v[30:31], v24 offset:19456
    s_waitcnt lgkmcnt(10)
    v_mfma_f32_32x32x16_bf16 v[136:151], v[36:39], v[184:187], v[136:151]
    ds_read_b64_tr_b16 v[32:33], v25 offset:17408
    ds_read_b64_tr_b16 v[34:35], v25 offset:19456
    s_waitcnt lgkmcnt(10)
    v_mfma_f32_32x32x16_bf16 v[88:103], v[40:43], v[184:187], v[88:103]
    ds_read_b64_tr_b16 v[36:37], v22 offset:17408
    ds_read_b64_tr_b16 v[38:39], v22 offset:19456
    s_waitcnt lgkmcnt(10)
    v_mfma_f32_32x32x16_bf16 v[104:119], v[44:47], v[184:187], v[104:119]
    ds_read_b64_tr_b16 v[40:41], v23 offset:17408
    ds_read_b64_tr_b16 v[42:43], v23 offset:19456
    s_waitcnt vmcnt(10)
    s_waitcnt lgkmcnt(10)
    v_mfma_f32_32x32x16_bf16 v[56:71], v[48:51], v[188:191], v[56:71]
    ds_read_b64_tr_b16 v[44:45], v20 offset:20480
    ds_read_b64_tr_b16 v[46:47], v20 offset:22528
    s_waitcnt lgkmcnt(10)
    v_mfma_f32_32x32x16_bf16 v[72:87], v[52:55], v[188:191], v[72:87]
    ds_read_b64_tr_b16 v[48:49], v21 offset:20480
    ds_read_b64_tr_b16 v[50:51], v21 offset:22528
    s_waitcnt lgkmcnt(10)
    v_mfma_f32_32x32x16_bf16 v[120:135], v[28:31], v[188:191], v[120:135]
    buffer_load_dwordx4 v[232:235], v249, s[32:35], s16 offen sc1
    ds_read_b64_tr_b16 v[52:53], v24 offset:20480
    ds_read_b64_tr_b16 v[54:55], v24 offset:22528
    s_waitcnt lgkmcnt(10)
    v_mfma_f32_32x32x16_bf16 v[136:151], v[32:35], v[188:191], v[136:151]
    ds_read_b64_tr_b16 v[28:29], v25 offset:20480
    ds_read_b64_tr_b16 v[30:31], v25 offset:22528
    s_waitcnt lgkmcnt(10)
    v_mfma_f32_32x32x16_bf16 v[88:103], v[36:39], v[188:191], v[88:103]
    ds_read_b64_tr_b16 v[32:33], v22 offset:20480
    ds_read_b64_tr_b16 v[34:35], v22 offset:22528
    s_waitcnt lgkmcnt(10)
    v_mfma_f32_32x32x16_bf16 v[104:119], v[40:43], v[188:191], v[104:119]
    buffer_load_dwordx4 v[236:239], v249, s[32:35], s16 offen offset:1024 sc1
    ds_read_b64_tr_b16 v[36:37], v23 offset:20480
    ds_read_b64_tr_b16 v[38:39], v23 offset:22528
    s_waitcnt vmcnt(11)
    s_waitcnt lgkmcnt(10)
    v_mfma_f32_32x32x16_bf16 v[56:71], v[44:47], v[192:195], v[56:71]
    ds_read_b64_tr_b16 v[40:41], v20 offset:21504
    ds_read_b64_tr_b16 v[42:43], v20 offset:23552
    s_waitcnt lgkmcnt(10)
    v_mfma_f32_32x32x16_bf16 v[72:87], v[48:51], v[192:195], v[72:87]
    ds_read_b64_tr_b16 v[44:45], v21 offset:21504
    ds_read_b64_tr_b16 v[46:47], v21 offset:23552
    s_waitcnt lgkmcnt(10)
    v_mfma_f32_32x32x16_bf16 v[120:135], v[52:55], v[192:195], v[120:135]
    buffer_load_dwordx4 v[240:243], v249, s[32:35], s16 offen offset:2048 sc1
    ds_read_b64_tr_b16 v[48:49], v24 offset:21504
    ds_read_b64_tr_b16 v[50:51], v24 offset:23552
    s_waitcnt lgkmcnt(10)
    v_mfma_f32_32x32x16_bf16 v[136:151], v[28:31], v[192:195], v[136:151]
    ds_read_b64_tr_b16 v[52:53], v25 offset:21504
    ds_read_b64_tr_b16 v[54:55], v25 offset:23552
    s_waitcnt lgkmcnt(10)
    v_mfma_f32_32x32x16_bf16 v[88:103], v[32:35], v[192:195], v[88:103]
    ds_read_b64_tr_b16 v[28:29], v22 offset:21504
    ds_read_b64_tr_b16 v[30:31], v22 offset:23552
    s_waitcnt lgkmcnt(10)
    v_mfma_f32_32x32x16_bf16 v[104:119], v[36:39], v[192:195], v[104:119]
    buffer_load_dwordx4 v[244:247], v249, s[32:35], s16 offen offset:3072 sc1
    ds_read_b64_tr_b16 v[32:33], v23 offset:21504
    ds_read_b64_tr_b16 v[34:35], v23 offset:23552
    s_waitcnt vmcnt(12)
    s_waitcnt lgkmcnt(10)
    v_mfma_f32_32x32x16_bf16 v[56:71], v[40:43], v[196:199], v[56:71]
    s_add_u32 s16, s16, 16384
    ds_read_b64_tr_b16 v[36:37], v20 offset:24576
    ds_read_b64_tr_b16 v[38:39], v20 offset:26624
    s_waitcnt lgkmcnt(10)
    v_mfma_f32_32x32x16_bf16 v[72:87], v[44:47], v[196:199], v[72:87]
    s_and_b32 s16, s16, 0x3ffff
    ds_read_b64_tr_b16 v[40:41], v21 offset:24576
    ds_read_b64_tr_b16 v[42:43], v21 offset:26624
    s_waitcnt lgkmcnt(10)
    v_mfma_f32_32x32x16_bf16 v[120:135], v[48:51], v[196:199], v[120:135]
    buffer_load_dwordx4 v[152:155], v249, s[32:35], s16 offen sc1
    ds_read_b64_tr_b16 v[44:45], v24 offset:24576
    ds_read_b64_tr_b16 v[46:47], v24 offset:26624
    s_waitcnt lgkmcnt(10)
    v_mfma_f32_32x32x16_bf16 v[136:151], v[52:55], v[196:199], v[136:151]
    ds_read_b64_tr_b16 v[48:49], v25 offset:24576
    ds_read_b64_tr_b16 v[50:51], v25 offset:26624
    s_waitcnt lgkmcnt(10)
    v_mfma_f32_32x32x16_bf16 v[88:103], v[28:31], v[196:199], v[88:103]
    ds_read_b64_tr_b16 v[52:53], v22 offset:24576
    ds_read_b64_tr_b16 v[54:55], v22 offset:26624
    s_waitcnt lgkmcnt(10)
    v_mfma_f32_32x32x16_bf16 v[104:119], v[32:35], v[196:199], v[104:119]
    buffer_load_dwordx4 v[156:159], v249, s[32:35], s16 offen offset:1024 sc1
    ds_read_b64_tr_b16 v[28:29], v23 offset:24576
    ds_read_b64_tr_b16 v[30:31], v23 offset:26624
    s_barrier
    s_waitcnt vmcnt(13)
    s_waitcnt lgkmcnt(10)
    v_mfma_f32_32x32x16_bf16 v[56:71], v[36:39], v[200:203], v[56:71]
    ds_read_b64_tr_b16 v[32:33], v20 offset:25600
    ds_read_b64_tr_b16 v[34:35], v20 offset:27648
    s_waitcnt lgkmcnt(10)
    v_mfma_f32_32x32x16_bf16 v[72:87], v[40:43], v[200:203], v[72:87]
    ds_read_b64_tr_b16 v[36:37], v21 offset:25600
    ds_read_b64_tr_b16 v[38:39], v21 offset:27648
    s_waitcnt lgkmcnt(10)
    v_mfma_f32_32x32x16_bf16 v[120:135], v[44:47], v[200:203], v[120:135]
    ds_read_b64_tr_b16 v[40:41], v24 offset:25600
    ds_read_b64_tr_b16 v[42:43], v24 offset:27648
    s_waitcnt lgkmcnt(10)
    v_mfma_f32_32x32x16_bf16 v[136:151], v[48:51], v[200:203], v[136:151]
    ds_read_b64_tr_b16 v[44:45], v25 offset:25600
    ds_read_b64_tr_b16 v[46:47], v25 offset:27648
    s_waitcnt lgkmcnt(10)
    v_mfma_f32_32x32x16_bf16 v[88:103], v[52:55], v[200:203], v[88:103]
    ds_read_b64_tr_b16 v[48:49], v22 offset:25600
    ds_read_b64_tr_b16 v[50:51], v22 offset:27648
    s_waitcnt lgkmcnt(10)
    v_mfma_f32_32x32x16_bf16 v[104:119], v[28:31], v[200:203], v[104:119]
    ds_read_b64_tr_b16 v[52:53], v23 offset:25600
    ds_read_b64_tr_b16 v[54:55], v23 offset:27648
    s_waitcnt vmcnt(12)
    s_waitcnt lgkmcnt(10)
    v_mfma_f32_32x32x16_bf16 v[56:71], v[32:35], v[204:207], v[56:71]
    ds_read_b64_tr_b16 v[28:29], v20 offset:28672
    ds_read_b64_tr_b16 v[30:31], v20 offset:30720
    s_waitcnt lgkmcnt(10)
    v_mfma_f32_32x32x16_bf16 v[72:87], v[36:39], v[204:207], v[72:87]
    ds_read_b64_tr_b16 v[32:33], v21 offset:28672
    ds_read_b64_tr_b16 v[34:35], v21 offset:30720
L_PAD2:
    s_cbranch_execz L_RET2
    s_waitcnt lgkmcnt(10)
    v_mfma_f32_32x32x16_bf16 v[120:135], v[40:43], v[204:207], v[120:135]
    buffer_load_dwordx4 v[160:163], v249, s[32:35], s16 offen offset:2048 sc1
    ds_read_b64_tr_b16 v[36:37], v24 offset:28672
    ds_read_b64_tr_b16 v[38:39], v24 offset:30720
    s_waitcnt lgkmcnt(10)
    v_mfma_f32_32x32x16_bf16 v[136:151], v[44:47], v[204:207], v[136:151]
    ds_read_b64_tr_b16 v[40:41], v25 offset:28672
    ds_read_b64_tr_b16 v[42:43], v25 offset:30720
    s_waitcnt lgkmcnt(10)
    v_mfma_f32_32x32x16_bf16 v[88:103], v[48:51], v[204:207], v[88:103]
    ds_read_b64_tr_b16 v[44:45], v22 offset:28672
    ds_read_b64_tr_b16 v[46:47], v22 offset:30720
    s_waitcnt lgkmcnt(10)
    v_mfma_f32_32x32x16_bf16 v[104:119], v[52:55], v[204:207], v[104:119]
    buffer_load_dwordx4 v[164:167], v249, s[32:35], s16 offen offset:3072 sc1
    ds_read_b64_tr_b16 v[48:49], v23 offset:28672
    ds_read_b64_tr_b16 v[50:51], v23 offset:30720
    s_waitcnt vmcnt(13)
    s_waitcnt lgkmcnt(10)
    v_mfma_f32_32x32x16_bf16 v[56:71], v[28:31], v[208:211], v[56:71]
    s_add_u32 s16, s16, 16384
    ds_read_b64_tr_b16 v[52:53], v20 offset:29696
    ds_read_b64_tr_b16 v[54:55], v20 offset:31744
    s_waitcnt lgkmcnt(10)
    v_mfma_f32_32x32x16_bf16 v[72:87], v[32:35], v[208:211], v[72:87]
    s_and_b32 s16, s16, 0x3ffff
    ds_read_b64_tr_b16 v[28:29], v21 offset:29696
    ds_read_b64_tr_b16 v[30:31], v21 offset:31744
    s_waitcnt lgkmcnt(10)
    v_mfma_f32_32x32x16_bf16 v[120:135], v[36:39], v[208:211], v[120:135]
    buffer_load_dwordx4 v[168:171], v249, s[32:35], s16 offen sc1
    ds_read_b64_tr_b16 v[32:33], v24 offset:29696
    ds_read_b64_tr_b16 v[34:35], v24 offset:31744
    s_waitcnt lgkmcnt(10)
    v_mfma_f32_32x32x16_bf16 v[136:151], v[40:43], v[208:211], v[136:151]
    ds_read_b64_tr_b16 v[36:37], v25 offset:29696
    ds_read_b64_tr_b16 v[38:39], v25 offset:31744
    s_waitcnt lgkmcnt(10)
    v_mfma_f32_32x32x16_bf16 v[88:103], v[44:47], v[208:211], v[88:103]
    ds_read_b64_tr_b16 v[40:41], v22 offset:29696
    ds_read_b64_tr_b16 v[42:43], v22 offset:31744
    s_waitcnt lgkmcnt(10)
    v_mfma_f32_32x32x16_bf16 v[104:119], v[48:51], v[208:211], v[104:119]
    buffer_load_dwordx4 v[172:175], v249, s[32:35], s16 offen offset:1024 sc1
    ds_read_b64_tr_b16 v[44:45], v23 offset:29696
    ds_read_b64_tr_b16 v[46:47], v23 offset:31744
    s_waitcnt vmcnt(14)
    s_waitcnt lgkmcnt(10)
    v_mfma_f32_32x32x16_bf16 v[56:71], v[52:55], v[212:215], v[56:71]
    ds_read_b64_tr_b16 v[48:49], v20 offset:32768
    ds_read_b64_tr_b16 v[50:51], v20 offset:34816
    s_waitcnt lgkmcnt(10)
    v_mfma_f32_32x32x16_bf16 v[72:87], v[28:31], v[212:215], v[72:87]
    ds_read_b64_tr_b16 v[52:53], v21 offset:32768
    ds_read_b64_tr_b16 v[54:55], v21 offset:34816
    s_waitcnt lgkmcnt(10)
    v_mfma_f32_32x32x16_bf16 v[120:135], v[32:35], v[212:215], v[120:135]
    buffer_load_dwordx4 v[176:179], v249, s[32:35], s16 offen offset:2048 sc1
    ds_read_b64_tr_b16 v[28:29], v24 offset:32768
    ds_read_b64_tr_b16 v[30:31], v24 offset:34816
    s_waitcnt lgkmcnt(10)
    v_mfma_f32_32x32x16_bf16 v[136:151], v[36:39], v[212:215], v[136:151]
    ds_read_b64_tr_b16 v[32:33], v25 offset:32768
    ds_read_b64_tr_b16 v[34:35], v25 offset:34816
    s_waitcnt lgkmcnt(10)
    v_mfma_f32_32x32x16_bf16 v[88:103], v[40:43], v[212:215], v[88:103]
    ds_read_b64_tr_b16 v[36:37], v22 offset:32768
    ds_read_b64_tr_b16 v[38:39], v22 offset:34816
    s_waitcnt lgkmcnt(10)
    v_mfma_f32_32x32x16_bf16 v[104:119], v[44:47], v[212:215], v[104:119]
    buffer_load_dwordx4 v[180:183], v249, s[32:35], s16 offen offset:3072 sc1
    ds_read_b64_tr_b16 v[40:41], v23 offset:32768
    ds_read_b64_tr_b16 v[42:43], v23 offset:34816
    s_barrier
    s_waitcnt vmcnt(15)
    s_waitcnt lgkmcnt(10)
    v_mfma_f32_32x32x16_bf16 v[56:71], v[48:51], v[216:219], v[56:71]
    s_add_u32 s16, s16, 16384
    ds_read_b64_tr_b16 v[44:45], v20 offset:33792
    ds_read_b64_tr_b16 v[46:47], v20 offset:35840
    s_waitcnt lgkmcnt(10)
    v_mfma_f32_32x32x16_bf16 v[72:87], v[52:55], v[216:219], v[72:87]
    s_and_b32 s16, s16, 0x3ffff
    ds_read_b64_tr_b16 v[48:49], v21 offset:33792
    ds_read_b64_tr_b16 v[50:51], v21 offset:35840
    s_waitcnt lgkmcnt(10)
    v_mfma_f32_32x32x16_bf16 v[120:135], v[28:31], v[216:219], v[120:135]
    ds_read_b64_tr_b16 v[52:53], v24 offset:33792
    ds_read_b64_tr_b16 v[54:55], v24 offset:35840
    s_waitcnt lgkmcnt(10)
    v_mfma_f32_32x32x16_bf16 v[136:151], v[32:35], v[216:219], v[136:151]
    ds_read_b64_tr_b16 v[28:29], v25 offset:33792
    ds_read_b64_tr_b16 v[30:31], v25 offset:35840
    s_waitcnt lgkmcnt(10)
    v_mfma_f32_32x32x16_bf16 v[88:103], v[36:39], v[216:219], v[88:103]
    ds_read_b64_tr_b16 v[32:33], v22 offset:33792
    ds_read_b64_tr_b16 v[34:35], v22 offset:35840
    s_waitcnt lgkmcnt(10)
    v_mfma_f32_32x32x16_bf16 v[104:119], v[40:43], v[216:219], v[104:119]
    ds_read_b64_tr_b16 v[36:37], v23 offset:33792
    ds_read_b64_tr_b16 v[38:39], v23 offset:35840
    s_waitcnt vmcnt(14)
    s_waitcnt lgkmcnt(10)
    v_mfma_f32_32x32x16_bf16 v[56:71], v[44:47], v[220:223], v[56:71]
    ds_read_b64_tr_b16 v[40:41], v20 offset:36864
    ds_read_b64_tr_b16 v[42:43], v20 offset:38912
    s_waitcnt lgkmcnt(10)
    v_mfma_f32_32x32x16_bf16 v[72:87], v[48:51], v[220:223], v[72:87]
    ds_read_b64_tr_b16 v[44:45], v21 offset:36864
    ds_read_b64_tr_b16 v[46:47], v21 offset:38912
    s_waitcnt lgkmcnt(10)
    v_mfma_f32_32x32x16_bf16 v[120:135], v[52:55], v[220:223], v[120:135]
    buffer_load_dwordx4 v[184:187], v249, s[32:35], s16 offen sc1
    ds_read_b64_tr_b16 v[48:49], v24 offset:36864
    ds_read_b64_tr_b16 v[50:51], v24 offset:38912
    s_waitcnt lgkmcnt(10)
    v_mfma_f32_32x32x16_bf16 v[136:151], v[28:31], v[220:223], v[136:151]
    ds_read_b64_tr_b16 v[52:53], v25 offset:36864
    ds_read_b64_tr_b16 v[54:55], v25 offset:38912
    s_waitcnt lgkmcnt(10)
    v_mfma_f32_32x32x16_bf16 v[88:103], v[32:35], v[220:223], v[88:103]
    ds_read_b64_tr_b16 v[28:29], v22 offset:36864
    ds_read_b64_tr_b16 v[30:31], v22 offset:38912
    s_waitcnt lgkmcnt(10)
    v_mfma_f32_32x32x16_bf16 v[104:119], v[36:39], v[220:223], v[104:119]
    buffer_load_dwordx4 v[188:191], v249, s[32:35], s16 offen offset:1024 sc1
    ds_read_b64_tr_b16 v[32:33], v23 offset:36864
    ds_read_b64_tr_b16 v[34:35], v23 offset:38912
    s_waitcnt vmcnt(15)
    s_waitcnt lgkmcnt(10)
    v_mfma_f32_32x32x16_bf16 v[56:71], v[40:43], v[224:227], v[56:71]
    ds_read_b64_tr_b16 v[36:37], v20 offset:37888
    ds_read_b64_tr_b16 v[38:39], v20 offset:39936
    s_waitcnt lgkmcnt(10)
    v_mfma_f32_32x32x16_bf16 v[72:87], v[44:47], v[224:227], v[72:87]
    ds_read_b64_tr_b16 v[40:41], v21 offset:37888
    ds_read_b64_tr_b16 v[42:43], v21 offset:39936
    s_waitcnt lgkmcnt(10)
    v_mfma_f32_32x32x16_bf16 v[120:135], v[48:51], v[224:227], v[120:135]
    buffer_load_dwordx4 v[192:195], v249, s[32:35], s16 offen offset:2048 sc1
    ds_read_b64_tr_b16 v[44:45], v24 offset:37888
    ds_read_b64_tr_b16 v[46:47], v24 offset:39936
    s_waitcnt lgkmcnt(10)
    v_mfma_f32_32x32x16_bf16 v[136:151], v[52:55], v[224:227], v[136:151]
    ds_read_b64_tr_b16 v[48:49], v25 offset:37888
    ds_read_b64_tr_b16 v[50:51], v25 offset:39936
    s_waitcnt lgkmcnt(10)
    v_mfma_f32_32x32x16_bf16 v[88:103], v[28:31], v[224:227], v[88:103]
    ds_read_b64_tr_b16 v[52:53], v22 offset:37888
    ds_read_b64_tr_b16 v[54:55], v22 offset:39936
    s_waitcnt lgkmcnt(10)
    v_mfma_f32_32x32x16_bf16 v[104:119], v[32:35], v[224:227], v[104:119]
    buffer_load_dwordx4 v[196:199], v249, s[32:35], s16 offen offset:3072 sc1
    ds_read_b64_tr_b16 v[28:29], v23 offset:37888
    ds_read_b64_tr_b16 v[30:31], v23 offset:39936
    s_waitcnt vmcnt(16)
    s_waitcnt lgkmcnt(10)
    v_mfma_f32_32x32x16_bf16 v[56:71], v[36:39], v[228:231], v[56:71]
    s_add_u32 s16, s16, 16384
    ds_read_b64_tr_b16 v[32:33], v20 offset:40960
    ds_read_b64_tr_b16 v[34:35], v20 offset:43008
    s_waitcnt lgkmcnt(10)
    v_mfma_f32_32x32x16_bf16 v[72:87], v[40:43], v[228:231], v[72:87]
    s_and_b32 s16, s16, 0x3ffff
    ds_read_b64_tr_b16 v[36:37], v21 offset:40960
    ds_read_b64_tr_b16 v[38:39], v21 offset:43008
    s_waitcnt lgkmcnt(10)
    v_mfma_f32_32x32x16_bf16 v[120:135], v[44:47], v[228:231], v[120:135]
    buffer_load_dwordx4 v[200:203], v249, s[32:35], s16 offen sc1
    ds_read_b64_tr_b16 v[40:41], v24 offset:40960
    ds_read_b64_tr_b16 v[42:43], v24 offset:43008
    s_waitcnt lgkmcnt(10)
    v_mfma_f32_32x32x16_bf16 v[136:151], v[48:51], v[228:231], v[136:151]
    ds_read_b64_tr_b16 v[44:45], v25 offset:40960
    ds_read_b64_tr_b16 v[46:47], v25 offset:43008
    s_waitcnt lgkmcnt(10)
    v_mfma_f32_32x32x16_bf16 v[88:103], v[52:55], v[228:231], v[88:103]
    ds_read_b64_tr_b16 v[48:49], v22 offset:40960
    ds_read_b64_tr_b16 v[50:51], v22 offset:43008
    s_waitcnt lgkmcnt(10)
    v_mfma_f32_32x32x16_bf16 v[104:119], v[28:31], v[228:231], v[104:119]
    buffer_load_dwordx4 v[204:207], v249, s[32:35], s16 offen offset:1024 sc1
    ds_read_b64_tr_b16 v[52:53], v23 offset:40960
    ds_read_b64_tr_b16 v[54:55], v23 offset:43008
    s_barrier
    s_waitcnt vmcnt(17)
    s_waitcnt lgkmcnt(10)
    v_mfma_f32_32x32x16_bf16 v[56:71], v[32:35], v[232:235], v[56:71]
    ds_read_b64_tr_b16 v[28:29], v20 offset:41984
    ds_read_b64_tr_b16 v[30:31], v20 offset:44032
    s_waitcnt lgkmcnt(10)
    v_mfma_f32_32x32x16_bf16 v[72:87], v[36:39], v[232:235], v[72:87]
    ds_read_b64_tr_b16 v[32:33], v21 offset:41984
    ds_read_b64_tr_b16 v[34:35], v21 offset:44032
    s_waitcnt lgkmcnt(10)
    v_mfma_f32_32x32x16_bf16 v[120:135], v[40:43], v[232:235], v[120:135]
    ds_read_b64_tr_b16 v[36:37], v24 offset:41984
    ds_read_b64_tr_b16 v[38:39], v24 offset:44032
    s_waitcnt lgkmcnt(10)
    v_mfma_f32_32x32x16_bf16 v[136:151], v[44:47], v[232:235], v[136:151]
    ds_read_b64_tr_b16 v[40:41], v25 offset:41984
    ds_read_b64_tr_b16 v[42:43], v25 offset:44032
    s_waitcnt lgkmcnt(10)
    v_mfma_f32_32x32x16_bf16 v[88:103], v[48:51], v[232:235], v[88:103]
    ds_read_b64_tr_b16 v[44:45], v22 offset:41984
    ds_read_b64_tr_b16 v[46:47], v22 offset:44032
    s_waitcnt lgkmcnt(10)
    v_mfma_f32_32x32x16_bf16 v[104:119], v[52:55], v[232:235], v[104:119]
    ds_read_b64_tr_b16 v[48:49], v23 offset:41984
    ds_read_b64_tr_b16 v[50:51], v23 offset:44032
    s_waitcnt vmcnt(16)
    s_waitcnt lgkmcnt(10)
    v_mfma_f32_32x32x16_bf16 v[56:71], v[28:31], v[236:239], v[56:71]
    ds_read_b64_tr_b16 v[52:53], v20 offset:45056
    ds_read_b64_tr_b16 v[54:55], v20 offset:47104
    s_waitcnt lgkmcnt(10)
    v_mfma_f32_32x32x16_bf16 v[72:87], v[32:35], v[236:239], v[72:87]
    ds_read_b64_tr_b16 v[28:29], v21 offset:45056
    ds_read_b64_tr_b16 v[30:31], v21 offset:47104
    s_waitcnt lgkmcnt(10)
    v_mfma_f32_32x32x16_bf16 v[120:135], v[36:39], v[236:239], v[120:135]
    buffer_load_dwordx4 v[208:211], v249, s[32:35], s16 offen offset:2048 sc1
    ds_read_b64_tr_b16 v[32:33], v24 offset:45056
    ds_read_b64_tr_b16 v[34:35], v24 offset:47104
    s_waitcnt lgkmcnt(10)
    v_mfma_f32_32x32x16_bf16 v[136:151], v[40:43], v[236:239], v[136:151]
    ds_read_b64_tr_b16 v[36:37], v25 offset:45056
    ds_read_b64_tr_b16 v[38:39], v25 offset:47104
    s_waitcnt lgkmcnt(10)
    v_mfma_f32_32x32x16_bf16 v[88:103], v[44:47], v[236:239], v[88:103]
    ds_read_b64_tr_b16 v[40:41], v22 offset:45056
    ds_read_b64_tr_b16 v[42:43], v22 offset:47104
    s_waitcnt lgkmcnt(10)
    v_mfma_f32_32x32x16_bf16 v[104:119], v[48:51], v[236:239], v[104:119]
    buffer_load_dwordx4 v[212:215], v249, s[32:35], s16 offen offset:3072 sc1
    ds_read_b64_tr_b16 v[44:45], v23 offset:45056
    ds_read_b64_tr_b16 v[46:47], v23 offset:47104
    s_waitcnt vmcnt(17)
    s_waitcnt lgkmcnt(10)
    v_mfma_f32_32x32x16_bf16 v[56:71], v[52:55], v[240:243], v[56:71]
    s_add_u32 s16, s16, 16384
    ds_read_b64_tr_b16 v[48:49], v20 offset:46080
    ds_read_b64_tr_b16 v[50:51], v20 offset:48128
    s_waitcnt lgkmcnt(10)
    v_mfma_f32_32x32x16_bf16 v[72:87], v[28:31], v[240:243], v[72:87]
    s_and_b32 s16, s16, 0x3ffff
    ds_read_b64_tr_b16 v[52:53], v21 offset:46080
    ds_read_b64_tr_b16 v[54:55], v21 offset:48128
    s_waitcnt lgkmcnt(10)
    v_mfma_f32_32x32x16_bf16 v[120:135], v[32:35], v[240:243], v[120:135]
    buffer_load_dwordx4 v[216:219], v249, s[32:35], s16 offen sc1
    ds_read_b64_tr_b16 v[28:29], v24 offset:46080
    ds_read_b64_tr_b16 v[30:31], v24 offset:48128
    s_waitcnt lgkmcnt(10)
    v_mfma_f32_32x32x16_bf16 v[136:151], v[36:39], v[240:243], v[136:151]
    ds_read_b64_tr_b16 v[32:33], v25 offset:46080
    ds_read_b64_tr_b16 v[34:35], v25 offset:48128
    s_waitcnt lgkmcnt(10)
    v_mfma_f32_32x32x16_bf16 v[88:103], v[40:43], v[240:243], v[88:103]
    ds_read_b64_tr_b16 v[36:37], v22 offset:46080
    ds_read_b64_tr_b16 v[38:39], v22 offset:48128
    s_waitcnt lgkmcnt(10)
    v_mfma_f32_32x32x16_bf16 v[104:119], v[44:47], v[240:243], v[104:119]
    buffer_load_dwordx4 v[220:223], v249, s[32:35], s16 offen offset:1024 sc1
    ds_read_b64_tr_b16 v[40:41], v23 offset:46080
    ds_read_b64_tr_b16 v[42:43], v23 offset:48128
    s_waitcnt vmcnt(18)
    s_waitcnt lgkmcnt(10)
    v_mfma_f32_32x32x16_bf16 v[56:71], v[48:51], v[244:247], v[56:71]
    ds_read_b64_tr_b16 v[44:45], v20
    ds_read_b64_tr_b16 v[46:47], v20 offset:2048
    s_waitcnt lgkmcnt(10)
    v_mfma_f32_32x32x16_bf16 v[72:87], v[52:55], v[244:247], v[72:87]
    ds_read_b64_tr_b16 v[48:49], v21
    ds_read_b64_tr_b16 v[50:51], v21 offset:2048
    s_waitcnt lgkmcnt(10)
    v_mfma_f32_32x32x16_bf16 v[120:135], v[28:31], v[244:247], v[120:135]
    buffer_load_dwordx4 v[224:227], v249, s[32:35], s16 offen offset:2048 sc1
    ds_read_b64_tr_b16 v[52:53], v24
    ds_read_b64_tr_b16 v[54:55], v24 offset:2048
    s_waitcnt lgkmcnt(10)
    v_mfma_f32_32x32x16_bf16 v[136:151], v[32:35], v[244:247], v[136:151]
    ds_read_b64_tr_b16 v[28:29], v25
    ds_read_b64_tr_b16 v[30:31], v25 offset:2048
    s_waitcnt lgkmcnt(10)
    v_mfma_f32_32x32x16_bf16 v[88:103], v[36:39], v[244:247], v[88:103]
    ds_read_b64_tr_b16 v[32:33], v22
    ds_read_b64_tr_b16 v[34:35], v22 offset:2048
    s_waitcnt lgkmcnt(10)
    v_mfma_f32_32x32x16_bf16 v[104:119], v[40:43], v[244:247], v[104:119]
    buffer_load_dwordx4 v[228:231], v249, s[32:35], s16 offen offset:3072 sc1
    ds_read_b64_tr_b16 v[36:37], v23
    ds_read_b64_tr_b16 v[38:39], v23 offset:2048
    s_barrier
    s_waitcnt vmcnt(19)
    s_waitcnt lgkmcnt(10)
    v_mfma_f32_32x32x16_bf16 v[56:71], v[44:47], v[152:155], v[56:71]
    s_add_u32 s16, s16, 16384
    ds_read_b64_tr_b16 v[40:41], v20 offset:1024
    ds_read_b64_tr_b16 v[42:43], v20 offset:3072
    s_waitcnt lgkmcnt(10)
    v_mfma_f32_32x32x16_bf16 v[72:87], v[48:51], v[152:155], v[72:87]
    s_and_b32 s16, s16, 0x3ffff
    ds_read_b64_tr_b16 v[44:45], v21 offset:1024
    ds_read_b64_tr_b16 v[46:47], v21 offset:3072
    s_waitcnt lgkmcnt(10)
    v_mfma_f32_32x32x16_bf16 v[120:135], v[52:55], v[152:155], v[120:135]
    ds_read_b64_tr_b16 v[48:49], v24 offset:1024
    ds_read_b64_tr_b16 v[50:51], v24 offset:3072
    s_waitcnt lgkmcnt(10)
    v_mfma_f32_32x32x16_bf16 v[136:151], v[28:31], v[152:155], v[136:151]
    ds_read_b64_tr_b16 v[52:53], v25 offset:1024
    ds_read_b64_tr_b16 v[54:55], v25 offset:3072
    s_waitcnt lgkmcnt(10)
    v_mfma_f32_32x32x16_bf16 v[88:103], v[32:35], v[152:155], v[88:103]
    ds_read_b64_tr_b16 v[28:29], v22 offset:1024
    ds_read_b64_tr_b16 v[30:31], v22 offset:3072
    s_waitcnt lgkmcnt(10)
    v_mfma_f32_32x32x16_bf16 v[104:119], v[36:39], v[152:155], v[104:119]
    ds_read_b64_tr_b16 v[32:33], v23 offset:1024
    ds_read_b64_tr_b16 v[34:35], v23 offset:3072
    s_waitcnt vmcnt(18)
    s_waitcnt lgkmcnt(10)
    v_mfma_f32_32x32x16_bf16 v[56:71], v[40:43], v[156:159], v[56:71]
    ds_read_b64_tr_b16 v[36:37], v20 offset:4096
    ds_read_b64_tr_b16 v[38:39], v20 offset:6144
    s_waitcnt lgkmcnt(10)
    v_mfma_f32_32x32x16_bf16 v[72:87], v[44:47], v[156:159], v[72:87]
    ds_read_b64_tr_b16 v[40:41], v21 offset:4096
    ds_read_b64_tr_b16 v[42:43], v21 offset:6144
    s_waitcnt lgkmcnt(10)
    v_mfma_f32_32x32x16_bf16 v[120:135], v[48:51], v[156:159], v[120:135]
    ds_read_b64_tr_b16 v[44:45], v24 offset:4096
    ds_read_b64_tr_b16 v[46:47], v24 offset:6144
    s_waitcnt lgkmcnt(10)
    v_mfma_f32_32x32x16_bf16 v[136:151], v[52:55], v[156:159], v[136:151]
    buffer_load_dwordx4 v[232:235], v249, s[32:35], s16 offen sc1
    ds_read_b64_tr_b16 v[48:49], v25 offset:4096
    ds_read_b64_tr_b16 v[50:51], v25 offset:6144
    s_waitcnt lgkmcnt(10)
    v_mfma_f32_32x32x16_bf16 v[88:103], v[28:31], v[156:159], v[88:103]
    ds_read_b64_tr_b16 v[52:53], v22 offset:4096
    ds_read_b64_tr_b16 v[54:55], v22 offset:6144
    s_waitcnt lgkmcnt(10)
    v_mfma_f32_32x32x16_bf16 v[104:119], v[32:35], v[156:159], v[104:119]
    ds_read_b64_tr_b16 v[28:29], v23 offset:4096
    ds_read_b64_tr_b16 v[30:31], v23 offset:6144
    s_waitcnt vmcnt(18)
    s_waitcnt lgkmcnt(10)
    v_mfma_f32_32x32x16_bf16 v[56:71], v[36:39], v[160:163], v[56:71]
    ds_read_b64_tr_b16 v[32:33], v20 offset:5120
    ds_read_b64_tr_b16 v[34:35], v20 offset:7168
    s_waitcnt lgkmcnt(10)
    v_mfma_f32_32x32x16_bf16 v[72:87], v[40:43], v[160:163], v[72:87]
    buffer_load_dwordx4 v[236:239], v249, s[32:35], s16 offen offset:1024 sc1
    ds_read_b64_tr_b16 v[36:37], v21 offset:5120
    ds_read_b64_tr_b16 v[38:39], v21 offset:7168
    s_waitcnt lgkmcnt(10)
    v_mfma_f32_32x32x16_bf16 v[120:135], v[44:47], v[160:163], v[120:135]
    ds_read_b64_tr_b16 v[40:41], v24 offset:5120
    ds_read_b64_tr_b16 v[42:43], v24 offset:7168
    s_waitcnt lgkmcnt(10)
    v_mfma_f32_32x32x16_bf16 v[136:151], v[48:51], v[160:163], v[136:151]
    ds_read_b64_tr_b16 v[44:45], v25 offset:5120
    ds_read_b64_tr_b16 v[46:47], v25 offset:7168
    s_waitcnt lgkmcnt(10)
    v_mfma_f32_32x32x16_bf16 v[88:103], v[52:55], v[160:163], v[88:103]
    buffer_load_dwordx4 v[240:243], v249, s[32:35], s16 offen offset:2048 sc1
    ds_read_b64_tr_b16 v[48:49], v22 offset:5120
    ds_read_b64_tr_b16 v[50:51], v22 offset:7168
    s_waitcnt lgkmcnt(10)
    v_mfma_f32_32x32x16_bf16 v[104:119], v[28:31], v[160:163], v[104:119]
    ds_read_b64_tr_b16 v[52:53], v23 offset:5120
    ds_read_b64_tr_b16 v[54:55], v23 offset:7168
    s_waitcnt vmcnt(19)
    s_waitcnt lgkmcnt(10)
    v_mfma_f32_32x32x16_bf16 v[56:71], v[32:35], v[164:167], v[56:71]
    ds_read_b64_tr_b16 v[28:29], v20 offset:8192
    ds_read_b64_tr_b16 v[30:31], v20 offset:10240
    s_waitcnt lgkmcnt(10)
    v_mfma_f32_32x32x16_bf16 v[72:87], v[36:39], v[164:167], v[72:87]
    ds_read_b64_tr_b16 v[32:33], v21 offset:8192
    ds_read_b64_tr_b16 v[34:35], v21 offset:10240
    s_waitcnt lgkmcnt(10)
    v_mfma_f32_32x32x16_bf16 v[120:135], v[40:43], v[164:167], v[120:135]
    buffer_load_dwordx4 v[244:247], v249, s[32:35], s16 offen offset:3072 sc1
    ds_read_b64_tr_b16 v[36:37], v24 offset:8192
    ds_read_b64_tr_b16 v[38:39], v24 offset:10240
    s_waitcnt lgkmcnt(10)
    v_mfma_f32_32x32x16_bf16 v[136:151], v[44:47], v[164:167], v[136:151]
    s_add_u32 s16, s16, 16384
    ds_read_b64_tr_b16 v[40:41], v25 offset:8192
    ds_read_b64_tr_b16 v[42:43], v25 offset:10240
    s_waitcnt lgkmcnt(10)
    v_mfma_f32_32x32x16_bf16 v[88:103], v[48:51], v[164:167], v[88:103]
    s_and_b32 s16, s16, 0x3ffff
    ds_read_b64_tr_b16 v[44:45], v22 offset:8192
    ds_read_b64_tr_b16 v[46:47], v22 offset:10240
    s_waitcnt lgkmcnt(10)
    v_mfma_f32_32x32x16_bf16 v[104:119], v[52:55], v[164:167], v[104:119]
    buffer_load_dwordx4 v[152:155], v249, s[32:35], s16 offen sc1
    ds_read_b64_tr_b16 v[48:49], v23 offset:8192
    ds_read_b64_tr_b16 v[50:51], v23 offset:10240
    s_barrier
    s_waitcnt vmcnt(20)
    s_waitcnt lgkmcnt(10)
    v_mfma_f32_32x32x16_bf16 v[56:71], v[28:31], v[168:171], v[56:71]
    ds_read_b64_tr_b16 v[52:53], v20 offset:9216
    ds_read_b64_tr_b16 v[54:55], v20 offset:11264
    s_waitcnt lgkmcnt(10)
    v_mfma_f32_32x32x16_bf16 v[72:87], v[32:35], v[168:171], v[72:87]
    ds_read_b64_tr_b16 v[28:29], v21 offset:9216
    ds_read_b64_tr_b16 v[30:31], v21 offset:11264
    s_waitcnt lgkmcnt(10)
    v_mfma_f32_32x32x16_bf16 v[120:135], v[36:39], v[168:171], v[120:135]
    ds_read_b64_tr_b16 v[32:33], v24 offset:9216
    ds_read_b64_tr_b16 v[34:35], v24 offset:11264
    s_waitcnt lgkmcnt(10)
    v_mfma_f32_32x32x16_bf16 v[136:151], v[40:43], v[168:171], v[136:151]
    ds_read_b64_tr_b16 v[36:37], v25 offset:9216
    ds_read_b64_tr_b16 v[38:39], v25 offset:11264
    s_waitcnt lgkmcnt(10)
    v_mfma_f32_32x32x16_bf16 v[88:103], v[44:47], v[168:171], v[88:103]
    ds_read_b64_tr_b16 v[40:41], v22 offset:9216
    ds_read_b64_tr_b16 v[42:43], v22 offset:11264
    s_waitcnt lgkmcnt(10)
    v_mfma_f32_32x32x16_bf16 v[104:119], v[48:51], v[168:171], v[104:119]
    ds_read_b64_tr_b16 v[44:45], v23 offset:9216
    ds_read_b64_tr_b16 v[46:47], v23 offset:11264
    s_waitcnt vmcnt(19)
    s_waitcnt lgkmcnt(10)
    v_mfma_f32_32x32x16_bf16 v[56:71], v[52:55], v[172:175], v[56:71]
    ds_read_b64_tr_b16 v[48:49], v20 offset:12288
    ds_read_b64_tr_b16 v[50:51], v20 offset:14336
    s_waitcnt lgkmcnt(10)
    v_mfma_f32_32x32x16_bf16 v[72:87], v[28:31], v[172:175], v[72:87]
    ds_read_b64_tr_b16 v[52:53], v21 offset:12288
    ds_read_b64_tr_b16 v[54:55], v21 offset:14336
    s_waitcnt lgkmcnt(10)
    v_mfma_f32_32x32x16_bf16 v[120:135], v[32:35], v[172:175], v[120:135]
    ds_read_b64_tr_b16 v[28:29], v24 offset:12288
    ds_read_b64_tr_b16 v[30:31], v24 offset:14336
    s_waitcnt lgkmcnt(10)
    v_mfma_f32_32x32x16_bf16 v[136:151], v[36:39], v[172:175], v[136:151]
    buffer_load_dwordx4 v[156:159], v249, s[32:35], s16 offen offset:1024 sc1
    ds_read_b64_tr_b16 v[32:33], v25 offset:12288
    ds_read_b64_tr_b16 v[34:35], v25 offset:14336
    s_waitcnt lgkmcnt(10)
    v_mfma_f32_32x32x16_bf16 v[88:103], v[40:43], v[172:175], v[88:103]
    ds_read_b64_tr_b16 v[36:37], v22 offset:12288
    ds_read_b64_tr_b16 v[38:39], v22 offset:14336
    s_waitcnt lgkmcnt(10)
    v_mfma_f32_32x32x16_bf16 v[104:119], v[44:47], v[172:175], v[104:119]
    ds_read_b64_tr_b16 v[40:41], v23 offset:12288
    ds_read_b64_tr_b16 v[42:43], v23 offset:14336
    s_waitcnt vmcnt(19)
    s_waitcnt lgkmcnt(10)
    v_mfma_f32_32x32x16_bf16 v[56:71], v[48:51], v[176:179], v[56:71]
    ds_read_b64_tr_b16 v[44:45], v20 offset:13312
    ds_read_b64_tr_b16 v[46:47], v20 offset:15360
    s_waitcnt lgkmcnt(10)
    v_mfma_f32_32x32x16_bf16 v[72:87], v[52:55], v[176:179], v[72:87]
    buffer_load_dwordx4 v[160:163], v249, s[32:35], s16 offen offset:2048 sc1
    ds_read_b64_tr_b16 v[48:49], v21 offset:13312
    ds_read_b64_tr_b16 v[50:51], v21 offset:15360
    s_waitcnt lgkmcnt(10)
    v_mfma_f32_32x32x16_bf16 v[120:135], v[28:31], v[176:179], v[120:135]
    ds_read_b64_tr_b16 v[52:53], v24 offset:13312
    ds_read_b64_tr_b16 v[54:55], v24 offset:15360
    s_waitcnt lgkmcnt(10)
    v_mfma_f32_32x32x16_bf16 v[136:151], v[32:35], v[176:179], v[136:151]
    ds_read_b64_tr_b16 v[28:29], v25 offset:13312
    ds_read_b64_tr_b16 v[30:31], v25 offset:15360
    s_waitcnt lgkmcnt(10)
    v_mfma_f32_32x32x16_bf16 v[88:103], v[36:39], v[176:179], v[88:103]
    buffer_load_dwordx4 v[164:167], v249, s[32:35], s16 offen offset:3072 sc1
    ds_read_b64_tr_b16 v[32:33], v22 offset:13312
    ds_read_b64_tr_b16 v[34:35], v22 offset:15360
    s_waitcnt lgkmcnt(10)
    v_mfma_f32_32x32x16_bf16 v[104:119], v[40:43], v[176:179], v[104:119]
    s_add_u32 s16, s16, 16384
    ds_read_b64_tr_b16 v[36:37], v23 offset:13312
    ds_read_b64_tr_b16 v[38:39], v23 offset:15360
    s_waitcnt vmcnt(20)
    s_waitcnt lgkmcnt(10)
    v_mfma_f32_32x32x16_bf16 v[56:71], v[44:47], v[180:183], v[56:71]
    s_and_b32 s16, s16, 0x3ffff
    ds_read_b64_tr_b16 v[40:41], v20 offset:16384
    ds_read_b64_tr_b16 v[42:43], v20 offset:18432
    s_waitcnt lgkmcnt(10)
    v_mfma_f32_32x32x16_bf16 v[72:87], v[48:51], v[180:183], v[72:87]
    ds_read_b64_tr_b16 v[44:45], v21 offset:16384
    ds_read_b64_tr_b16 v[46:47], v21 offset:18432
    s_waitcnt lgkmcnt(10)
    v_mfma_f32_32x32x16_bf16 v[120:135], v[52:55], v[180:183], v[120:135]
    buffer_load_dwordx4 v[168:171], v249, s[32:35], s16 offen sc1
    ds_read_b64_tr_b16 v[48:49], v24 offset:16384
    ds_read_b64_tr_b16 v[50:51], v24 offset:18432
    s_waitcnt lgkmcnt(10)
    v_mfma_f32_32x32x16_bf16 v[136:151], v[28:31], v[180:183], v[136:151]
    ds_read_b64_tr_b16 v[52:53], v25 offset:16384
    ds_read_b64_tr_b16 v[54:55], v25 offset:18432
    s_waitcnt lgkmcnt(10)
    v_mfma_f32_32x32x16_bf16 v[88:103], v[32:35], v[180:183], v[88:103]
    ds_read_b64_tr_b16 v[28:29], v22 offset:16384
    ds_read_b64_tr_b16 v[30:31], v22 offset:18432
    s_waitcnt lgkmcnt(10)
    v_mfma_f32_32x32x16_bf16 v[104:119], v[36:39], v[180:183], v[104:119]
    buffer_load_dwordx4 v[172:175], v249, s[32:35], s16 offen offset:1024 sc1
    ds_read_b64_tr_b16 v[32:33], v23 offset:16384
    ds_read_b64_tr_b16 v[34:35], v23 offset:18432
    s_barrier
    s_waitcnt vmcnt(21)
    s_waitcnt lgkmcnt(10)
    v_mfma_f32_32x32x16_bf16 v[56:71], v[40:43], v[184:187], v[56:71]
    ds_read_b64_tr_b16 v[36:37], v20 offset:17408
    ds_read_b64_tr_b16 v[38:39], v20 offset:19456
    s_waitcnt lgkmcnt(10)
    v_mfma_f32_32x32x16_bf16 v[72:87], v[44:47], v[184:187], v[72:87]
    ds_read_b64_tr_b16 v[40:41], v21 offset:17408
    ds_read_b64_tr_b16 v[42:43], v21 offset:19456
    s_waitcnt lgkmcnt(10)
    v_mfma_f32_32x32x16_bf16 v[120:135], v[48:51], v[184:187], v[120:135]
    ds_read_b64_tr_b16 v[44:45], v24 offset:17408
    ds_read_b64_tr_b16 v[46:47], v24 offset:19456
    s_waitcnt lgkmcnt(10)
    v_mfma_f32_32x32x16_bf16 v[136:151], v[52:55], v[184:187], v[136:151]
    ds_read_b64_tr_b16 v[48:49], v25 offset:17408
    ds_read_b64_tr_b16 v[50:51], v25 offset:19456
    s_waitcnt lgkmcnt(10)
    v_mfma_f32_32x32x16_bf16 v[88:103], v[28:31], v[184:187], v[88:103]
    ds_read_b64_tr_b16 v[52:53], v22 offset:17408
    ds_read_b64_tr_b16 v[54:55], v22 offset:19456
    s_waitcnt lgkmcnt(10)
    v_mfma_f32_32x32x16_bf16 v[104:119], v[32:35], v[184:187], v[104:119]
    ds_read_b64_tr_b16 v[28:29], v23 offset:17408
    ds_read_b64_tr_b16 v[30:31], v23 offset:19456
    s_waitcnt vmcnt(20)
    s_waitcnt lgkmcnt(10)
    v_mfma_f32_32x32x16_bf16 v[56:71], v[36:39], v[188:191], v[56:71]
    ds_read_b64_tr_b16 v[32:33], v20 offset:20480
    ds_read_b64_tr_b16 v[34:35], v20 offset:22528
    s_waitcnt lgkmcnt(10)
    v_mfma_f32_32x32x16_bf16 v[72:87], v[40:43], v[188:191], v[72:87]
    ds_read_b64_tr_b16 v[36:37], v21 offset:20480
    ds_read_b64_tr_b16 v[38:39], v21 offset:22528
    s_waitcnt lgkmcnt(10)
    v_mfma_f32_32x32x16_bf16 v[120:135], v[44:47], v[188:191], v[120:135]
    ds_read_b64_tr_b16 v[40:41], v24 offset:20480
    ds_read_b64_tr_b16 v[42:43], v24 offset:22528
    s_waitcnt lgkmcnt(10)
    v_mfma_f32_32x32x16_bf16 v[136:151], v[48:51], v[188:191], v[136:151]
    buffer_load_dwordx4 v[176:179], v249, s[32:35], s16 offen offset:2048 sc1
    ds_read_b64_tr_b16 v[44:45], v25 offset:20480
    ds_read_b64_tr_b16 v[46:47], v25 offset:22528
    s_waitcnt lgkmcnt(10)
    v_mfma_f32_32x32x16_bf16 v[88:103], v[52:55], v[188:191], v[88:103]
    ds_read_b64_tr_b16 v[48:49], v22 offset:20480
    ds_read_b64_tr_b16 v[50:51], v22 offset:22528
    s_waitcnt lgkmcnt(10)
    v_mfma_f32_32x32x16_bf16 v[104:119], v[28:31], v[188:191], v[104:119]
    ds_read_b64_tr_b16 v[52:53], v23 offset:20480
    ds_read_b64_tr_b16 v[54:55], v23 offset:22528
    s_waitcnt vmcnt(20)
    s_waitcnt lgkmcnt(10)
    v_mfma_f32_32x32x16_bf16 v[56:71], v[32:35], v[192:195], v[56:71]
    ds_read_b64_tr_b16 v[28:29], v20 offset:21504
    ds_read_b64_tr_b16 v[30:31], v20 offset:23552
    s_waitcnt lgkmcnt(10)
    v_mfma_f32_32x32x16_bf16 v[72:87], v[36:39], v[192:195], v[72:87]
    buffer_load_dwordx4 v[180:183], v249, s[32:35], s16 offen offset:3072 sc1
    ds_read_b64_tr_b16 v[32:33], v21 offset:21504
    ds_read_b64_tr_b16 v[34:35], v21 offset:23552
    s_waitcnt lgkmcnt(10)
    v_mfma_f32_32x32x16_bf16 v[120:135], v[40:43], v[192:195], v[120:135]
    s_add_u32 s16, s16, 16384
    ds_read_b64_tr_b16 v[36:37], v24 offset:21504
    ds_read_b64_tr_b16 v[38:39], v24 offset:23552
    s_waitcnt lgkmcnt(10)
    v_mfma_f32_32x32x16_bf16 v[136:151], v[44:47], v[192:195], v[136:151]
    s_and_b32 s16, s16, 0x3ffff
    ds_read_b64_tr_b16 v[40:41], v25 offset:21504
    ds_read_b64_tr_b16 v[42:43], v25 offset:23552
    s_waitcnt lgkmcnt(10)
    v_mfma_f32_32x32x16_bf16 v[88:103], v[48:51], v[192:195], v[88:103]
    buffer_load_dwordx4 v[184:187], v249, s[32:35], s16 offen sc1
    ds_read_b64_tr_b16 v[44:45], v22 offset:21504
    ds_read_b64_tr_b16 v[46:47], v22 offset:23552
L_PAD3:
    s_cbranch_execz L_RET3
    s_waitcnt lgkmcnt(10)
    v_mfma_f32_32x32x16_bf16 v[104:119], v[52:55], v[192:195], v[104:119]
    ds_read_b64_tr_b16 v[48:49], v23 offset:21504
    ds_read_b64_tr_b16 v[50:51], v23 offset:23552
    s_waitcnt vmcnt(21)
    s_waitcnt lgkmcnt(10)
    v_mfma_f32_32x32x16_bf16 v[56:71], v[28:31], v[196:199], v[56:71]
    ds_read_b64_tr_b16 v[52:53], v20 offset:24576
    ds_read_b64_tr_b16 v[54:55], v20 offset:26624
    s_waitcnt lgkmcnt(10)
    v_mfma_f32_32x32x16_bf16 v[72:87], v[32:35], v[196:199], v[72:87]
    ds_read_b64_tr_b16 v[28:29], v21 offset:24576
    ds_read_b64_tr_b16 v[30:31], v21 offset:26624
    s_waitcnt lgkmcnt(10)
    v_mfma_f32_32x32x16_bf16 v[120:135], v[36:39], v[196:199], v[120:135]
    buffer_load_dwordx4 v[188:191], v249, s[32:35], s16 offen offset:1024 sc1
    ds_read_b64_tr_b16 v[32:33], v20 offset:25600
    ds_read_b64_tr_b16 v[34:35], v20 offset:27648
    s_waitcnt lgkmcnt(10)
    v_mfma_f32_32x32x16_bf16 v[136:151], v[40:43], v[196:199], v[136:151]
    ds_read_b64_tr_b16 v[36:37], v21 offset:25600
    ds_read_b64_tr_b16 v[38:39], v21 offset:27648
    s_waitcnt lgkmcnt(10)
    v_mfma_f32_32x32x16_bf16 v[88:103], v[44:47], v[196:199], v[88:103]
    ds_read_b64_tr_b16 v[40:41], v20 offset:28672
    ds_read_b64_tr_b16 v[42:43], v20 offset:30720
    s_waitcnt lgkmcnt(10)
    v_mfma_f32_32x32x16_bf16 v[104:119], v[48:51], v[196:199], v[104:119]
    buffer_load_dwordx4 v[192:195], v249, s[32:35], s16 offen offset:2048 sc1
    ds_read_b64_tr_b16 v[44:45], v21 offset:28672
    ds_read_b64_tr_b16 v[46:47], v21 offset:30720
    s_barrier
    s_waitcnt vmcnt(22)
    s_waitcnt lgkmcnt(10)
    v_mfma_f32_32x32x16_bf16 v[56:71], v[52:55], v[200:203], v[56:71]
    ds_read_b64_tr_b16 v[48:49], v20 offset:29696
    ds_read_b64_tr_b16 v[50:51], v20 offset:31744
    s_waitcnt lgkmcnt(10)
    v_mfma_f32_32x32x16_bf16 v[72:87], v[28:31], v[200:203], v[72:87]
    ds_read_b64_tr_b16 v[52:53], v21 offset:29696
    ds_read_b64_tr_b16 v[54:55], v21 offset:31744
    s_waitcnt vmcnt(21)
    s_waitcnt lgkmcnt(10)
    v_mfma_f32_32x32x16_bf16 v[56:71], v[32:35], v[204:207], v[56:71]
    ds_read_b64_tr_b16 v[28:29], v24 offset:24576
    ds_read_b64_tr_b16 v[30:31], v24 offset:26624
    s_waitcnt lgkmcnt(10)
    v_mfma_f32_32x32x16_bf16 v[72:87], v[36:39], v[204:207], v[72:87]
    ds_read_b64_tr_b16 v[32:33], v25 offset:24576
    ds_read_b64_tr_b16 v[34:35], v25 offset:26624
    s_waitcnt vmcnt(20)
    s_waitcnt lgkmcnt(10)
    v_mfma_f32_32x32x16_bf16 v[56:71], v[40:43], v[208:211], v[56:71]
    ds_read_b64_tr_b16 v[36:37], v22 offset:24576
    ds_read_b64_tr_b16 v[38:39], v22 offset:26624
    s_waitcnt lgkmcnt(10)
    v_mfma_f32_32x32x16_bf16 v[72:87], v[44:47], v[208:211], v[72:87]
    ds_read_b64_tr_b16 v[40:41], v23 offset:24576
    ds_read_b64_tr_b16 v[42:43], v23 offset:26624
    s_waitcnt vmcnt(19)
    s_waitcnt lgkmcnt(10)
    v_mfma_f32_32x32x16_bf16 v[56:71], v[48:51], v[212:215], v[56:71]
    ds_read_b64_tr_b16 v[44:45], v24 offset:25600
    ds_read_b64_tr_b16 v[46:47], v24 offset:27648
    s_waitcnt lgkmcnt(10)
    v_mfma_f32_32x32x16_bf16 v[72:87], v[52:55], v[212:215], v[72:87]
    ds_read_b64_tr_b16 v[48:49], v25 offset:25600
    ds_read_b64_tr_b16 v[50:51], v25 offset:27648
    s_barrier
    s_waitcnt lgkmcnt(10)
    v_mfma_f32_32x32x16_bf16 v[120:135], v[28:31], v[200:203], v[120:135]
    ds_read_b64_tr_b16 v[52:53], v22 offset:25600
    ds_read_b64_tr_b16 v[54:55], v22 offset:27648
    s_waitcnt lgkmcnt(10)
    v_mfma_f32_32x32x16_bf16 v[136:151], v[32:35], v[200:203], v[136:151]
    buffer_load_dwordx4 v[196:199], v249, s[32:35], s16 offen offset:3072 sc1
    ds_read_b64_tr_b16 v[28:29], v23 offset:25600
    ds_read_b64_tr_b16 v[30:31], v23 offset:27648
    s_waitcnt lgkmcnt(10)
    v_mfma_f32_32x32x16_bf16 v[88:103], v[36:39], v[200:203], v[88:103]
    s_add_u32 s16, s16, 16384
    ds_read_b64_tr_b16 v[32:33], v24 offset:28672
    ds_read_b64_tr_b16 v[34:35], v24 offset:30720
    s_waitcnt lgkmcnt(10)
    v_mfma_f32_32x32x16_bf16 v[104:119], v[40:43], v[200:203], v[104:119]
    s_and_b32 s16, s16, 0x3ffff
    ds_read_b64_tr_b16 v[36:37], v25 offset:28672
    ds_read_b64_tr_b16 v[38:39], v25 offset:30720
    s_waitcnt lgkmcnt(10)
    v_mfma_f32_32x32x16_bf16 v[120:135], v[44:47], v[204:207], v[120:135]
    ds_read_b64_tr_b16 v[40:41], v22 offset:28672
    ds_read_b64_tr_b16 v[42:43], v22 offset:30720
    s_waitcnt lgkmcnt(10)
    v_mfma_f32_32x32x16_bf16 v[136:151], v[48:51], v[204:207], v[136:151]
    buffer_load_dwordx4 v[200:203], v249, s[32:35], s16 offen sc1
    ds_read_b64_tr_b16 v[44:45], v23 offset:28672
    ds_read_b64_tr_b16 v[46:47], v23 offset:30720
    s_waitcnt lgkmcnt(10)
    v_mfma_f32_32x32x16_bf16 v[88:103], v[52:55], v[204:207], v[88:103]
    ds_read_b64_tr_b16 v[48:49], v24 offset:29696
    ds_read_b64_tr_b16 v[50:51], v24 offset:31744
    s_waitcnt lgkmcnt(10)
    v_mfma_f32_32x32x16_bf16 v[104:119], v[28:31], v[204:207], v[104:119]
    ds_read_b64_tr_b16 v[52:53], v25 offset:29696
    ds_read_b64_tr_b16 v[54:55], v25 offset:31744
    s_waitcnt lgkmcnt(10)
    v_mfma_f32_32x32x16_bf16 v[120:135], v[32:35], v[208:211], v[120:135]
    buffer_load_dwordx4 v[204:207], v249, s[32:35], s16 offen offset:1024 sc1
    ds_read_b64_tr_b16 v[28:29], v22 offset:29696
    ds_read_b64_tr_b16 v[30:31], v22 offset:31744
    s_waitcnt lgkmcnt(10)
    v_mfma_f32_32x32x16_bf16 v[136:151], v[36:39], v[208:211], v[136:151]
    ds_read_b64_tr_b16 v[32:33], v23 offset:29696
    ds_read_b64_tr_b16 v[34:35], v23 offset:31744
    s_waitcnt lgkmcnt(10)
    v_mfma_f32_32x32x16_bf16 v[88:103], v[40:43], v[208:211], v[88:103]
    ds_read_b64_tr_b16 v[36:37], v20 offset:32768
    ds_read_b64_tr_b16 v[38:39], v20 offset:34816
    s_waitcnt lgkmcnt(10)
    v_mfma_f32_32x32x16_bf16 v[104:119], v[44:47], v[208:211], v[104:119]
    ds_read_b64_tr_b16 v[40:41], v20 offset:33792
    ds_read_b64_tr_b16 v[42:43], v20 offset:35840
    s_waitcnt lgkmcnt(10)
    v_mfma_f32_32x32x16_bf16 v[120:135], v[48:51], v[212:215], v[120:135]
    buffer_load_dwordx4 v[208:211], v249, s[32:35], s16 offen offset:2048 sc1
    ds_read_b64_tr_b16 v[44:45], v20 offset:36864
    ds_read_b64_tr_b16 v[46:47], v20 offset:38912
    s_waitcnt lgkmcnt(10)
    v_mfma_f32_32x32x16_bf16 v[136:151], v[52:55], v[212:215], v[136:151]
    ds_read_b64_tr_b16 v[48:49], v20 offset:37888
    ds_read_b64_tr_b16 v[50:51], v20 offset:39936
    s_waitcnt lgkmcnt(10)
    v_mfma_f32_32x32x16_bf16 v[88:103], v[28:31], v[212:215], v[88:103]
    ds_read_b64_tr_b16 v[52:53], v20 offset:40960
    ds_read_b64_tr_b16 v[54:55], v20 offset:43008
    s_waitcnt lgkmcnt(10)
    v_mfma_f32_32x32x16_bf16 v[104:119], v[32:35], v[212:215], v[104:119]
    buffer_load_dwordx4 v[212:215], v249, s[32:35], s16 offen offset:3072 sc1
    ds_read_b64_tr_b16 v[28:29], v20 offset:41984
    ds_read_b64_tr_b16 v[30:31], v20 offset:44032
    s_barrier
    s_waitcnt vmcnt(23)
    s_waitcnt lgkmcnt(10)
    v_mfma_f32_32x32x16_bf16 v[56:71], v[36:39], v[216:219], v[56:71]
    s_add_u32 s16, s16, 16384
    ds_read_b64_tr_b16 v[32:33], v20 offset:45056
    ds_read_b64_tr_b16 v[34:35], v20 offset:47104
    s_waitcnt vmcnt(22)
    s_waitcnt lgkmcnt(10)
    v_mfma_f32_32x32x16_bf16 v[56:71], v[40:43], v[220:223], v[56:71]
    s_and_b32 s16, s16, 0x3ffff
    ds_read_b64_tr_b16 v[36:37], v20 offset:46080
    ds_read_b64_tr_b16 v[38:39], v20 offset:48128
    s_waitcnt vmcnt(21)
    s_waitcnt lgkmcnt(10)
    v_mfma_f32_32x32x16_bf16 v[56:71], v[44:47], v[224:227], v[56:71]
    ds_read_b64_tr_b16 v[40:41], v20
    ds_read_b64_tr_b16 v[42:43], v20 offset:2048
    s_waitcnt vmcnt(20)
    s_waitcnt lgkmcnt(10)
    v_mfma_f32_32x32x16_bf16 v[56:71], v[48:51], v[228:231], v[56:71]
    ds_read_b64_tr_b16 v[44:45], v20 offset:1024
    ds_read_b64_tr_b16 v[46:47], v20 offset:3072
    s_waitcnt vmcnt(19)
    s_waitcnt lgkmcnt(10)
    v_mfma_f32_32x32x16_bf16 v[56:71], v[52:55], v[232:235], v[56:71]
    ds_read_b64_tr_b16 v[48:49], v20 offset:4096
    ds_read_b64_tr_b16 v[50:51], v20 offset:6144
    s_waitcnt vmcnt(18)
    s_waitcnt lgkmcnt(10)
    v_mfma_f32_32x32x16_bf16 v[56:71], v[28:31], v[236:239], v[56:71]
    ds_read_b64_tr_b16 v[52:53], v20 offset:5120
    ds_read_b64_tr_b16 v[54:55], v20 offset:7168
    s_waitcnt vmcnt(17)
    s_waitcnt lgkmcnt(10)
    v_mfma_f32_32x32x16_bf16 v[56:71], v[32:35], v[240:243], v[56:71]
    ds_read_b64_tr_b16 v[28:29], v20 offset:8192
    ds_read_b64_tr_b16 v[30:31], v20 offset:10240
    s_waitcnt vmcnt(16)
    s_waitcnt lgkmcnt(10)
    v_mfma_f32_32x32x16_bf16 v[56:71], v[36:39], v[244:247], v[56:71]
    ds_read_b64_tr_b16 v[32:33], v20 offset:9216
    ds_read_b64_tr_b16 v[34:35], v20 offset:11264
    s_waitcnt vmcnt(15)
    s_waitcnt lgkmcnt(10)
    v_mfma_f32_32x32x16_bf16 v[56:71], v[40:43], v[152:155], v[56:71]
    ds_read_b64_tr_b16 v[36:37], v20 offset:12288
    ds_read_b64_tr_b16 v[38:39], v20 offset:14336
    s_waitcnt vmcnt(14)
    s_waitcnt lgkmcnt(10)
    v_mfma_f32_32x32x16_bf16 v[56:71], v[44:47], v[156:159], v[56:71]
    ds_read_b64_tr_b16 v[40:41], v20 offset:13312
    ds_read_b64_tr_b16 v[42:43], v20 offset:15360
    s_waitcnt vmcnt(13)
    s_waitcnt lgkmcnt(10)
    v_mfma_f32_32x32x16_bf16 v[56:71], v[48:51], v[160:163], v[56:71]
    ds_read_b64_tr_b16 v[44:45], v20 offset:16384
    ds_read_b64_tr_b16 v[46:47], v20 offset:18432
    s_waitcnt vmcnt(12)
    s_waitcnt lgkmcnt(10)
    v_mfma_f32_32x32x16_bf16 v[56:71], v[52:55], v[164:167], v[56:71]
    ds_read_b64_tr_b16 v[48:49], v20 offset:17408
    ds_read_b64_tr_b16 v[50:51], v20 offset:19456
    s_waitcnt vmcnt(11)
    s_waitcnt lgkmcnt(10)
    v_mfma_f32_32x32x16_bf16 v[56:71], v[28:31], v[168:171], v[56:71]
    ds_read_b64_tr_b16 v[52:53], v20 offset:20480
    ds_read_b64_tr_b16 v[54:55], v20 offset:22528
    s_waitcnt vmcnt(10)
    s_waitcnt lgkmcnt(10)
    v_mfma_f32_32x32x16_bf16 v[56:71], v[32:35], v[172:175], v[56:71]
    ds_read_b64_tr_b16 v[28:29], v20 offset:21504
    ds_read_b64_tr_b16 v[30:31], v20 offset:23552
    s_barrier
    s_waitcnt vmcnt(9)
    s_waitcnt lgkmcnt(10)
    v_mfma_f32_32x32x16_bf16 v[56:71], v[36:39], v[176:179], v[56:71]
    ds_read_b64_tr_b16 v[32:33], v20 offset:24576
    ds_read_b64_tr_b16 v[34:35], v20 offset:26624
    s_waitcnt vmcnt(8)
    s_waitcnt lgkmcnt(10)
    v_mfma_f32_32x32x16_bf16 v[56:71], v[40:43], v[180:183], v[56:71]
    ds_read_b64_tr_b16 v[36:37], v20 offset:25600
    ds_read_b64_tr_b16 v[38:39], v20 offset:27648
    s_waitcnt vmcnt(7)
    s_waitcnt lgkmcnt(10)
    v_mfma_f32_32x32x16_bf16 v[56:71], v[44:47], v[184:187], v[56:71]
    ds_read_b64_tr_b16 v[40:41], v20 offset:28672
    ds_read_b64_tr_b16 v[42:43], v20 offset:30720
    s_waitcnt vmcnt(6)
    s_waitcnt lgkmcnt(10)
    v_mfma_f32_32x32x16_bf16 v[56:71], v[48:51], v[188:191], v[56:71]
    ds_read_b64_tr_b16 v[44:45], v20 offset:29696
    ds_read_b64_tr_b16 v[46:47], v20 offset:31744
    s_waitcnt vmcnt(5)
    s_waitcnt lgkmcnt(10)
    v_mfma_f32_32x32x16_bf16 v[56:71], v[52:55], v[192:195], v[56:71]
    ds_read_b64_tr_b16 v[48:49], v21 offset:32768
    ds_read_b64_tr_b16 v[50:51], v21 offset:34816
    s_waitcnt vmcnt(4)
    s_waitcnt lgkmcnt(10)
    v_mfma_f32_32x32x16_bf16 v[56:71], v[28:31], v[196:199], v[56:71]
    ds_read_b64_tr_b16 v[52:53], v21 offset:33792
    ds_read_b64_tr_b16 v[54:55], v21 offset:35840
    s_waitcnt vmcnt(3)
    s_waitcnt lgkmcnt(10)
    v_mfma_f32_32x32x16_bf16 v[56:71], v[32:35], v[200:203], v[56:71]
    ds_read_b64_tr_b16 v[28:29], v21 offset:36864
    ds_read_b64_tr_b16 v[30:31], v21 offset:38912
    s_waitcnt vmcnt(2)
    s_waitcnt lgkmcnt(10)
    v_mfma_f32_32x32x16_bf16 v[56:71], v[36:39], v[204:207], v[56:71]
    ds_read_b64_tr_b16 v[32:33], v21 offset:37888
    ds_read_b64_tr_b16 v[34:35], v21 offset:39936
    s_waitcnt vmcnt(1)
    s_waitcnt lgkmcnt(10)
    v_mfma_f32_32x32x16_bf16 v[56:71], v[40:43], v[208:211], v[56:71]
    ds_read_b64_tr_b16 v[36:37], v21 offset:40960
    ds_read_b64_tr_b16 v[38:39], v21 offset:43008
    s_waitcnt vmcnt(0)
    s_waitcnt lgkmcnt(10)
    v_mfma_f32_32x32x16_bf16 v[56:71], v[44:47], v[212:215], v[56:71]
    ds_read_b64_tr_b16 v[40:41], v21 offset:41984
    ds_read_b64_tr_b16 v[42:43], v21 offset:44032
    s_waitcnt lgkmcnt(10)
    v_mfma_f32_32x32x16_bf16 v[72:87], v[48:51], v[216:219], v[72:87]
    ds_read_b64_tr_b16 v[44:45], v21 offset:45056
    ds_read_b64_tr_b16 v[46:47], v21 offset:47104
    s_waitcnt lgkmcnt(10)
    v_mfma_f32_32x32x16_bf16 v[72:87], v[52:55], v[220:223], v[72:87]
    s_nop 3
    v_cvt_pk_bf16_f32 v56, v56, v57
    v_cvt_pk_bf16_f32 v57, v58, v59
    ds_read_b64_tr_b16 v[48:49], v21 offset:46080
    ds_read_b64_tr_b16 v[50:51], v21 offset:48128
    s_waitcnt lgkmcnt(10)
    v_mfma_f32_32x32x16_bf16 v[72:87], v[28:31], v[224:227], v[72:87]
    v_cvt_pk_bf16_f32 v58, v60, v61
    v_cvt_pk_bf16_f32 v59, v62, v63
    ds_read_b64_tr_b16 v[52:53], v21
    ds_read_b64_tr_b16 v[54:55], v21 offset:2048
    s_waitcnt lgkmcnt(10)
    v_mfma_f32_32x32x16_bf16 v[72:87], v[32:35], v[228:231], v[72:87]
    ds_write_b128 v0, v[56:59]
    v_cvt_pk_bf16_f32 v60, v64, v65
    ds_read_b64_tr_b16 v[28:29], v21 offset:1024
    ds_read_b64_tr_b16 v[30:31], v21 offset:3072
    s_waitcnt lgkmcnt(11)
    v_mfma_f32_32x32x16_bf16 v[72:87], v[36:39], v[232:235], v[72:87]
    v_cvt_pk_bf16_f32 v61, v66, v67
    v_cvt_pk_bf16_f32 v62, v68, v69
    ds_read_b64_tr_b16 v[32:33], v21 offset:4096
    ds_read_b64_tr_b16 v[34:35], v21 offset:6144
    s_waitcnt lgkmcnt(11)
    v_mfma_f32_32x32x16_bf16 v[72:87], v[40:43], v[236:239], v[72:87]
    v_cvt_pk_bf16_f32 v63, v70, v71
    ds_write_b128 v0, v[60:63] offset:1024
    ds_read_b64_tr_b16 v[36:37], v21 offset:5120
    ds_read_b64_tr_b16 v[38:39], v21 offset:7168
    s_waitcnt lgkmcnt(12)
    v_mfma_f32_32x32x16_bf16 v[72:87], v[44:47], v[240:243], v[72:87]
    v_subrev_u32 v0, 118784, v0
    ds_read_b64_tr_b16 v[40:41], v21 offset:8192
    ds_read_b64_tr_b16 v[42:43], v21 offset:10240
    s_waitcnt lgkmcnt(12)
    v_mfma_f32_32x32x16_bf16 v[72:87], v[48:51], v[244:247], v[72:87]
    ds_read_b64_tr_b16 v[44:45], v21 offset:9216
    ds_read_b64_tr_b16 v[46:47], v21 offset:11264
    s_waitcnt lgkmcnt(6)
    s_barrier
    v_mfma_f32_32x32x16_bf16 v[72:87], v[52:55], v[152:155], v[72:87]
    ds_read_b64_tr_b16 v[48:49], v21 offset:12288
    ds_read_b64_tr_b16 v[50:51], v21 offset:14336
    v_mfma_f32_32x32x16_bf16 v[72:87], v[28:31], v[156:159], v[72:87]
    ds_read_b64_tr_b16 v[52:53], v21 offset:13312
    ds_read_b64_tr_b16 v[54:55], v21 offset:15360
    v_mfma_f32_32x32x16_bf16 v[72:87], v[32:35], v[160:163], v[72:87]
    ds_read_b64_tr_b16 v[28:29], v21 offset:16384
    ds_read_b64_tr_b16 v[30:31], v21 offset:18432
    s_waitcnt lgkmcnt(10)
    v_mfma_f32_32x32x16_bf16 v[72:87], v[36:39], v[164:167], v[72:87]
    ds_read_b64_tr_b16 v[32:33], v21 offset:17408
    ds_read_b64_tr_b16 v[34:35], v21 offset:19456
    s_waitcnt lgkmcnt(10)
    v_mfma_f32_32x32x16_bf16 v[72:87], v[40:43], v[168:171], v[72:87]
    ds_read_b64_tr_b16 v[36:37], v21 offset:20480
    ds_read_b64_tr_b16 v[38:39], v21 offset:22528
    s_waitcnt lgkmcnt(10)
    v_mfma_f32_32x32x16_bf16 v[72:87], v[44:47], v[172:175], v[72:87]
    ds_read_b64_tr_b16 v[40:41], v21 offset:21504
    ds_read_b64_tr_b16 v[42:43], v21 offset:23552
    s_waitcnt lgkmcnt(10)
    v_mfma_f32_32x32x16_bf16 v[72:87], v[48:51], v[176:179], v[72:87]
    ds_read_b64_tr_b16 v[44:45], v21 offset:24576
    ds_read_b64_tr_b16 v[46:47], v21 offset:26624
    s_waitcnt lgkmcnt(10)
    v_mfma_f32_32x32x16_bf16 v[72:87], v[52:55], v[180:183], v[72:87]
    ds_read_b64_tr_b16 v[48:49], v21 offset:25600
    ds_read_b64_tr_b16 v[50:51], v21 offset:27648
    s_waitcnt lgkmcnt(10)
    v_mfma_f32_32x32x16_bf16 v[72:87], v[28:31], v[184:187], v[72:87]
    ds_read_b64_tr_b16 v[52:53], v21 offset:28672
    ds_read_b64_tr_b16 v[54:55], v21 offset:30720
    s_waitcnt lgkmcnt(10)
    v_mfma_f32_32x32x16_bf16 v[72:87], v[32:35], v[188:191], v[72:87]
    ds_read_b64_tr_b16 v[28:29], v21 offset:29696
    ds_read_b64_tr_b16 v[30:31], v21 offset:31744
    s_waitcnt lgkmcnt(10)
    v_mfma_f32_32x32x16_bf16 v[72:87], v[36:39], v[192:195], v[72:87]
    ds_read_b64_tr_b16 v[32:33], v22 offset:32768
    ds_read_b64_tr_b16 v[34:35], v22 offset:34816
    s_waitcnt lgkmcnt(10)
    v_mfma_f32_32x32x16_bf16 v[72:87], v[40:43], v[196:199], v[72:87]
    ds_read_b64_tr_b16 v[36:37], v23 offset:32768
    ds_read_b64_tr_b16 v[38:39], v23 offset:34816
    s_waitcnt lgkmcnt(10)
    v_mfma_f32_32x32x16_bf16 v[72:87], v[44:47], v[200:203], v[72:87]
    ds_read_b64_tr_b16 v[40:41], v22 offset:33792
    ds_read_b64_tr_b16 v[42:43], v22 offset:35840
    s_waitcnt lgkmcnt(10)
    v_mfma_f32_32x32x16_bf16 v[72:87], v[48:51], v[204:207], v[72:87]
    ds_read_b64_tr_b16 v[44:45], v23 offset:33792
    ds_read_b64_tr_b16 v[46:47], v23 offset:35840
    s_waitcnt lgkmcnt(10)
    v_mfma_f32_32x32x16_bf16 v[72:87], v[52:55], v[208:211], v[72:87]
    ds_read_b64_tr_b16 v[48:49], v22 offset:36864
    ds_read_b64_tr_b16 v[50:51], v22 offset:38912
    s_waitcnt lgkmcnt(10)
    v_mfma_f32_32x32x16_bf16 v[72:87], v[28:31], v[212:215], v[72:87]
    ds_read_b64_tr_b16 v[52:53], v23 offset:36864
    ds_read_b64_tr_b16 v[54:55], v23 offset:38912
    s_waitcnt lgkmcnt(10)
    v_mfma_f32_32x32x16_bf16 v[88:103], v[32:35], v[216:219], v[88:103]
    ds_read_b64_tr_b16 v[28:29], v22 offset:37888
    ds_read_b64_tr_b16 v[30:31], v22 offset:39936
    s_waitcnt lgkmcnt(10)
    v_mfma_f32_32x32x16_bf16 v[104:119], v[36:39], v[216:219], v[104:119]
    s_nop 3
    v_cvt_pk_bf16_f32 v72, v72, v73
    v_cvt_pk_bf16_f32 v73, v74, v75
    ds_read_b64_tr_b16 v[32:33], v23 offset:37888
    ds_read_b64_tr_b16 v[34:35], v23 offset:39936
    s_waitcnt lgkmcnt(10)
    v_mfma_f32_32x32x16_bf16 v[88:103], v[40:43], v[220:223], v[88:103]
    v_cvt_pk_bf16_f32 v74, v76, v77
    v_cvt_pk_bf16_f32 v75, v78, v79
    ds_read_b64_tr_b16 v[36:37], v22 offset:40960
    ds_read_b64_tr_b16 v[38:39], v22 offset:43008
    s_waitcnt lgkmcnt(10)
    v_mfma_f32_32x32x16_bf16 v[104:119], v[44:47], v[220:223], v[104:119]
    ds_write_b128 v0, v[72:75]
    v_cvt_pk_bf16_f32 v76, v80, v81
    ds_read_b64_tr_b16 v[40:41], v23 offset:40960
    ds_read_b64_tr_b16 v[42:43], v23 offset:43008
    s_waitcnt lgkmcnt(11)
    v_mfma_f32_32x32x16_bf16 v[88:103], v[48:51], v[224:227], v[88:103]
    v_cvt_pk_bf16_f32 v77, v82, v83
    v_cvt_pk_bf16_f32 v78, v84, v85
    ds_read_b64_tr_b16 v[44:45], v22 offset:41984
    ds_read_b64_tr_b16 v[46:47], v22 offset:44032
    s_waitcnt lgkmcnt(11)
    v_mfma_f32_32x32x16_bf16 v[104:119], v[52:55], v[224:227], v[104:119]
    v_cvt_pk_bf16_f32 v79, v86, v87
    ds_write_b128 v0, v[76:79] offset:1024
    ds_read_b64_tr_b16 v[48:49], v23 offset:41984
    ds_read_b64_tr_b16 v[50:51], v23 offset:44032
    s_waitcnt lgkmcnt(12)
    v_mfma_f32_32x32x16_bf16 v[88:103], v[28:31], v[228:231], v[88:103]
    ds_read_b64_tr_b16 v[52:53], v22 offset:45056
    ds_read_b64_tr_b16 v[54:55], v22 offset:47104
    s_waitcnt lgkmcnt(12)
    v_mfma_f32_32x32x16_bf16 v[104:119], v[32:35], v[228:231], v[104:119]
    ds_read_b64_tr_b16 v[28:29], v23 offset:45056
    ds_read_b64_tr_b16 v[30:31], v23 offset:47104
    s_waitcnt lgkmcnt(6)
    s_barrier
    v_mfma_f32_32x32x16_bf16 v[88:103], v[36:39], v[232:235], v[88:103]
    s_lshl_b32 s96, s77, 11
    s_add_u32 s14, s96, 32768
    v_and_b32 v0, 7, v1
    ds_read_b64_tr_b16 v[32:33], v22 offset:46080
    ds_read_b64_tr_b16 v[34:35], v22 offset:48128
    v_mfma_f32_32x32x16_bf16 v[104:119], v[40:43], v[232:235], v[104:119]
    v_lshl_add_u32 v0, v0, 4, s14
    ds_read_b64_tr_b16 v[36:37], v23 offset:46080
    ds_read_b64_tr_b16 v[38:39], v23 offset:48128
    v_mfma_f32_32x32x16_bf16 v[88:103], v[44:47], v[236:239], v[88:103]
    v_bfe_u32 v4, v1, 3, 2
    ds_read_b64_tr_b16 v[40:41], v22
    ds_read_b64_tr_b16 v[42:43], v22 offset:2048
    s_waitcnt lgkmcnt(10)
    v_mfma_f32_32x32x16_bf16 v[104:119], v[48:51], v[236:239], v[104:119]
    v_lshl_add_u32 v0, v4, 8, v0
    v_lshrrev_b32 v4, 5, v1
    ds_read_b64_tr_b16 v[44:45], v23
    ds_read_b64_tr_b16 v[46:47], v23 offset:2048
    s_waitcnt lgkmcnt(10)
    v_mfma_f32_32x32x16_bf16 v[88:103], v[52:55], v[240:243], v[88:103]
    v_lshl_add_u32 v0, v4, 7, v0
    ds_read_b64_tr_b16 v[48:49], v22 offset:1024
    ds_read_b64_tr_b16 v[50:51], v22 offset:3072
    s_waitcnt lgkmcnt(10)
    v_mfma_f32_32x32x16_bf16 v[104:119], v[28:31], v[240:243], v[104:119]
    ds_read_b64_tr_b16 v[52:53], v23 offset:1024
    ds_read_b64_tr_b16 v[54:55], v23 offset:3072
    s_waitcnt lgkmcnt(10)
    v_mfma_f32_32x32x16_bf16 v[88:103], v[32:35], v[244:247], v[88:103]
    ds_read_b64_tr_b16 v[28:29], v22 offset:4096
    ds_read_b64_tr_b16 v[30:31], v22 offset:6144
    s_waitcnt lgkmcnt(10)
    v_mfma_f32_32x32x16_bf16 v[104:119], v[36:39], v[244:247], v[104:119]
    ds_read_b64_tr_b16 v[32:33], v23 offset:4096
    ds_read_b64_tr_b16 v[34:35], v23 offset:6144
    s_waitcnt lgkmcnt(10)
    v_mfma_f32_32x32x16_bf16 v[88:103], v[40:43], v[152:155], v[88:103]
    ds_read_b64_tr_b16 v[36:37], v22 offset:5120
    ds_read_b64_tr_b16 v[38:39], v22 offset:7168
    s_waitcnt lgkmcnt(10)
    v_mfma_f32_32x32x16_bf16 v[104:119], v[44:47], v[152:155], v[104:119]
    ds_read_b64_tr_b16 v[40:41], v23 offset:5120
    ds_read_b64_tr_b16 v[42:43], v23 offset:7168
    s_waitcnt lgkmcnt(10)
    v_mfma_f32_32x32x16_bf16 v[88:103], v[48:51], v[156:159], v[88:103]
    ds_read_b64_tr_b16 v[44:45], v22 offset:8192
    ds_read_b64_tr_b16 v[46:47], v22 offset:10240
    s_waitcnt lgkmcnt(10)
    v_mfma_f32_32x32x16_bf16 v[104:119], v[52:55], v[156:159], v[104:119]
    ds_read_b64_tr_b16 v[48:49], v23 offset:8192
    ds_read_b64_tr_b16 v[50:51], v23 offset:10240
    s_waitcnt lgkmcnt(10)
    v_mfma_f32_32x32x16_bf16 v[88:103], v[28:31], v[160:163], v[88:103]
    ds_read_b64_tr_b16 v[52:53], v22 offset:9216
    ds_read_b64_tr_b16 v[54:55], v22 offset:11264
    s_waitcnt lgkmcnt(10)
    v_mfma_f32_32x32x16_bf16 v[104:119], v[32:35], v[160:163], v[104:119]
    ds_read_b64_tr_b16 v[28:29], v23 offset:9216
    ds_read_b64_tr_b16 v[30:31], v23 offset:11264
    s_waitcnt lgkmcnt(10)
    v_mfma_f32_32x32x16_bf16 v[88:103], v[36:39], v[164:167], v[88:103]
    ds_read_b64_tr_b16 v[32:33], v22 offset:12288
    ds_read_b64_tr_b16 v[34:35], v22 offset:14336
    s_waitcnt lgkmcnt(10)
    v_mfma_f32_32x32x16_bf16 v[104:119], v[40:43], v[164:167], v[104:119]
    ds_read_b64_tr_b16 v[36:37], v23 offset:12288
    ds_read_b64_tr_b16 v[38:39], v23 offset:14336
    s_waitcnt lgkmcnt(10)
    v_mfma_f32_32x32x16_bf16 v[88:103], v[44:47], v[168:171], v[88:103]
    ds_read_b64_tr_b16 v[40:41], v22 offset:13312
    ds_read_b64_tr_b16 v[42:43], v22 offset:15360
    s_waitcnt lgkmcnt(10)
    v_mfma_f32_32x32x16_bf16 v[104:119], v[48:51], v[168:171], v[104:119]
    ds_read_b64_tr_b16 v[44:45], v23 offset:13312
    ds_read_b64_tr_b16 v[46:47], v23 offset:15360
    s_waitcnt lgkmcnt(10)
    v_mfma_f32_32x32x16_bf16 v[88:103], v[52:55], v[172:175], v[88:103]
    ds_read_b64_tr_b16 v[48:49], v22 offset:16384
    ds_read_b64_tr_b16 v[50:51], v22 offset:18432
    s_waitcnt lgkmcnt(10)
    v_mfma_f32_32x32x16_bf16 v[104:119], v[28:31], v[172:175], v[104:119]
    ds_read_b64_tr_b16 v[52:53], v23 offset:16384
    ds_read_b64_tr_b16 v[54:55], v23 offset:18432
    s_waitcnt lgkmcnt(10)
    v_mfma_f32_32x32x16_bf16 v[88:103], v[32:35], v[176:179], v[88:103]
    ds_read_b64_tr_b16 v[28:29], v22 offset:17408
    ds_read_b64_tr_b16 v[30:31], v22 offset:19456
    s_waitcnt lgkmcnt(10)
    v_mfma_f32_32x32x16_bf16 v[104:119], v[36:39], v[176:179], v[104:119]
    ds_read_b64_tr_b16 v[32:33], v23 offset:17408
    ds_read_b64_tr_b16 v[34:35], v23 offset:19456
    s_waitcnt lgkmcnt(10)
    v_mfma_f32_32x32x16_bf16 v[88:103], v[40:43], v[180:183], v[88:103]
    ds_read_b64_tr_b16 v[36:37], v22 offset:20480
    ds_read_b64_tr_b16 v[38:39], v22 offset:22528
    s_waitcnt lgkmcnt(10)
    v_mfma_f32_32x32x16_bf16 v[104:119], v[44:47], v[180:183], v[104:119]
    ds_read_b64_tr_b16 v[40:41], v23 offset:20480
    ds_read_b64_tr_b16 v[42:43], v23 offset:22528
    s_waitcnt lgkmcnt(10)
    v_mfma_f32_32x32x16_bf16 v[88:103], v[48:51], v[184:187], v[88:103]
    ds_read_b64_tr_b16 v[44:45], v22 offset:21504
    ds_read_b64_tr_b16 v[46:47], v22 offset:23552
    s_waitcnt lgkmcnt(10)
    v_mfma_f32_32x32x16_bf16 v[104:119], v[52:55], v[184:187], v[104:119]
    ds_read_b64_tr_b16 v[48:49], v23 offset:21504
    ds_read_b64_tr_b16 v[50:51], v23 offset:23552
    s_waitcnt lgkmcnt(10)
    v_mfma_f32_32x32x16_bf16 v[88:103], v[28:31], v[188:191], v[88:103]
    ds_read_b64_tr_b16 v[52:53], v22 offset:24576
    ds_read_b64_tr_b16 v[54:55], v22 offset:26624
    s_waitcnt lgkmcnt(10)
    v_mfma_f32_32x32x16_bf16 v[104:119], v[32:35], v[188:191], v[104:119]
    ds_read_b64_tr_b16 v[28:29], v23 offset:24576
    ds_read_b64_tr_b16 v[30:31], v23 offset:26624
    s_waitcnt lgkmcnt(10)
    v_mfma_f32_32x32x16_bf16 v[88:103], v[36:39], v[192:195], v[88:103]
    ds_read_b64_tr_b16 v[32:33], v22 offset:25600
    ds_read_b64_tr_b16 v[34:35], v22 offset:27648
    s_waitcnt lgkmcnt(10)
    v_mfma_f32_32x32x16_bf16 v[104:119], v[40:43], v[192:195], v[104:119]
    ds_read_b64_tr_b16 v[36:37], v23 offset:25600
    ds_read_b64_tr_b16 v[38:39], v23 offset:27648
    s_waitcnt lgkmcnt(10)
    v_mfma_f32_32x32x16_bf16 v[88:103], v[44:47], v[196:199], v[88:103]
    ds_read_b64_tr_b16 v[40:41], v22 offset:28672
    ds_read_b64_tr_b16 v[42:43], v22 offset:30720
    s_waitcnt lgkmcnt(10)
    v_mfma_f32_32x32x16_bf16 v[104:119], v[48:51], v[196:199], v[104:119]
    ds_read_b64_tr_b16 v[44:45], v23 offset:28672
    ds_read_b64_tr_b16 v[46:47], v23 offset:30720
    s_waitcnt lgkmcnt(10)
    v_mfma_f32_32x32x16_bf16 v[88:103], v[52:55], v[200:203], v[88:103]
    ds_read_b64_tr_b16 v[48:49], v22 offset:29696
    ds_read_b64_tr_b16 v[50:51], v22 offset:31744
    s_waitcnt lgkmcnt(10)
    v_mfma_f32_32x32x16_bf16 v[104:119], v[28:31], v[200:203], v[104:119]
    ds_read_b64_tr_b16 v[52:53], v23 offset:29696
    ds_read_b64_tr_b16 v[54:55], v23 offset:31744
    s_waitcnt lgkmcnt(10)
    v_mfma_f32_32x32x16_bf16 v[88:103], v[32:35], v[204:207], v[88:103]
    ds_read_b64_tr_b16 v[28:29], v24 offset:32768
    ds_read_b64_tr_b16 v[30:31], v24 offset:34816
    s_waitcnt lgkmcnt(10)
    v_mfma_f32_32x32x16_bf16 v[104:119], v[36:39], v[204:207], v[104:119]
    ds_read_b64_tr_b16 v[32:33], v25 offset:32768
    ds_read_b64_tr_b16 v[34:35], v25 offset:34816
    s_waitcnt lgkmcnt(10)
    v_mfma_f32_32x32x16_bf16 v[88:103], v[40:43], v[208:211], v[88:103]
    ds_read_b64_tr_b16 v[36:37], v24 offset:33792
    ds_read_b64_tr_b16 v[38:39], v24 offset:35840
    s_waitcnt lgkmcnt(10)
    v_mfma_f32_32x32x16_bf16 v[104:119], v[44:47], v[208:211], v[104:119]
    ds_read_b64_tr_b16 v[40:41], v25 offset:33792
    ds_read_b64_tr_b16 v[42:43], v25 offset:35840
    s_waitcnt lgkmcnt(10)
    v_mfma_f32_32x32x16_bf16 v[88:103], v[48:51], v[212:215], v[88:103]
    ds_read_b64_tr_b16 v[44:45], v24 offset:36864
    ds_read_b64_tr_b16 v[46:47], v24 offset:38912
    s_waitcnt lgkmcnt(10)
    v_mfma_f32_32x32x16_bf16 v[104:119], v[52:55], v[212:215], v[104:119]
    ds_read_b64_tr_b16 v[48:49], v25 offset:36864
    ds_read_b64_tr_b16 v[50:51], v25 offset:38912
    s_barrier
    s_waitcnt lgkmcnt(10)
    v_mfma_f32_32x32x16_bf16 v[120:135], v[28:31], v[216:219], v[120:135]
    ds_read_b64_tr_b16 v[52:53], v24 offset:37888
    ds_read_b64_tr_b16 v[54:55], v24 offset:39936
    s_waitcnt lgkmcnt(10)
    v_mfma_f32_32x32x16_bf16 v[136:151], v[32:35], v[216:219], v[136:151]
    ds_read_b64_tr_b16 v[28:29], v25 offset:37888
    ds_read_b64_tr_b16 v[30:31], v25 offset:39936
    s_waitcnt lgkmcnt(10)
    v_mfma_f32_32x32x16_bf16 v[120:135], v[36:39], v[220:223], v[120:135]
    v_cvt_pk_bf16_f32 v88, v88, v89
    ds_read_b64_tr_b16 v[32:33], v24 offset:40960
    ds_read_b64_tr_b16 v[34:35], v24 offset:43008
L_PAD4:
    s_cbranch_execz L_RET4
    s_waitcnt lgkmcnt(10)
    v_mfma_f32_32x32x16_bf16 v[136:151], v[40:43], v[220:223], v[136:151]
    v_cvt_pk_bf16_f32 v89, v90, v91
    ds_read_b64_tr_b16 v[36:37], v25 offset:40960
    ds_read_b64_tr_b16 v[38:39], v25 offset:43008
    s_waitcnt lgkmcnt(10)
    v_mfma_f32_32x32x16_bf16 v[120:135], v[44:47], v[224:227], v[120:135]
    v_cvt_pk_bf16_f32 v90, v92, v93
    ds_read_b64_tr_b16 v[40:41], v24 offset:41984
    ds_read_b64_tr_b16 v[42:43], v24 offset:44032
    s_waitcnt lgkmcnt(10)
    v_mfma_f32_32x32x16_bf16 v[136:151], v[48:51], v[224:227], v[136:151]
    v_cvt_pk_bf16_f32 v91, v94, v95
    ds_read_b64_tr_b16 v[44:45], v25 offset:41984
    ds_read_b64_tr_b16 v[46:47], v25 offset:44032
    s_waitcnt lgkmcnt(10)
    v_mfma_f32_32x32x16_bf16 v[120:135], v[52:55], v[228:231], v[120:135]
    ds_write_b128 v0, v[88:91]
    ds_read_b64_tr_b16 v[48:49], v24 offset:45056
    ds_read_b64_tr_b16 v[50:51], v24 offset:47104
    s_waitcnt lgkmcnt(11)
    v_mfma_f32_32x32x16_bf16 v[136:151], v[28:31], v[228:231], v[136:151]
    v_cvt_pk_bf16_f32 v92, v96, v97
    ds_read_b64_tr_b16 v[52:53], v25 offset:45056
    ds_read_b64_tr_b16 v[54:55], v25 offset:47104
    s_waitcnt lgkmcnt(11)
    v_mfma_f32_32x32x16_bf16 v[120:135], v[32:35], v[232:235], v[120:135]
    v_cvt_pk_bf16_f32 v93, v98, v99
    ds_read_b64_tr_b16 v[28:29], v24 offset:46080
    ds_read_b64_tr_b16 v[30:31], v24 offset:48128
    s_waitcnt lgkmcnt(11)
    v_mfma_f32_32x32x16_bf16 v[136:151], v[36:39], v[232:235], v[136:151]
    v_cvt_pk_bf16_f32 v94, v100, v101
    ds_read_b64_tr_b16 v[32:33], v25 offset:46080
    ds_read_b64_tr_b16 v[34:35], v25 offset:48128
    s_waitcnt lgkmcnt(11)
    v_mfma_f32_32x32x16_bf16 v[120:135], v[40:43], v[236:239], v[120:135]
    v_cvt_pk_bf16_f32 v95, v102, v103
    ds_read_b64_tr_b16 v[36:37], v24
    ds_read_b64_tr_b16 v[38:39], v24 offset:2048
    s_waitcnt lgkmcnt(11)
    v_mfma_f32_32x32x16_bf16 v[136:151], v[44:47], v[236:239], v[136:151]
    ds_write_b128 v0, v[92:95] offset:1024
    ds_read_b64_tr_b16 v[40:41], v25
    ds_read_b64_tr_b16 v[42:43], v25 offset:2048
    s_waitcnt lgkmcnt(11)
    v_mfma_f32_32x32x16_bf16 v[120:135], v[48:51], v[240:243], v[120:135]
    v_cvt_pk_bf16_f32 v104, v104, v105
    ds_read_b64_tr_b16 v[44:45], v24 offset:1024
    ds_read_b64_tr_b16 v[46:47], v24 offset:3072
    s_waitcnt lgkmcnt(11)
    v_mfma_f32_32x32x16_bf16 v[136:151], v[52:55], v[240:243], v[136:151]
    v_cvt_pk_bf16_f32 v105, v106, v107
    ds_read_b64_tr_b16 v[48:49], v25 offset:1024
    ds_read_b64_tr_b16 v[50:51], v25 offset:3072
    s_waitcnt lgkmcnt(11)
    v_mfma_f32_32x32x16_bf16 v[120:135], v[28:31], v[244:247], v[120:135]
    v_cvt_pk_bf16_f32 v106, v108, v109
    ds_read_b64_tr_b16 v[52:53], v24 offset:4096
    ds_read_b64_tr_b16 v[54:55], v24 offset:6144
    s_waitcnt lgkmcnt(11)
    v_mfma_f32_32x32x16_bf16 v[136:151], v[32:35], v[244:247], v[136:151]
    v_cvt_pk_bf16_f32 v107, v110, v111
    ds_read_b64_tr_b16 v[28:29], v25 offset:4096
    ds_read_b64_tr_b16 v[30:31], v25 offset:6144
    s_waitcnt lgkmcnt(11)
    v_mfma_f32_32x32x16_bf16 v[120:135], v[36:39], v[152:155], v[120:135]
    ds_write_b128 v0, v[104:107] offset:8192
    ds_read_b64_tr_b16 v[32:33], v24 offset:5120
    ds_read_b64_tr_b16 v[34:35], v24 offset:7168
    s_waitcnt lgkmcnt(11)
    v_mfma_f32_32x32x16_bf16 v[136:151], v[40:43], v[152:155], v[136:151]
    v_cvt_pk_bf16_f32 v108, v112, v113
    ds_read_b64_tr_b16 v[36:37], v25 offset:5120
    ds_read_b64_tr_b16 v[38:39], v25 offset:7168
    s_waitcnt lgkmcnt(11)
    v_mfma_f32_32x32x16_bf16 v[120:135], v[44:47], v[156:159], v[120:135]
    v_cvt_pk_bf16_f32 v109, v114, v115
    ds_read_b64_tr_b16 v[40:41], v24 offset:8192
    ds_read_b64_tr_b16 v[42:43], v24 offset:10240
    s_waitcnt lgkmcnt(11)
    v_mfma_f32_32x32x16_bf16 v[136:151], v[48:51], v[156:159], v[136:151]
    v_cvt_pk_bf16_f32 v110, v116, v117
    ds_read_b64_tr_b16 v[44:45], v25 offset:8192
    ds_read_b64_tr_b16 v[46:47], v25 offset:10240
    s_waitcnt lgkmcnt(11)
    v_mfma_f32_32x32x16_bf16 v[120:135], v[52:55], v[160:163], v[120:135]
    v_cvt_pk_bf16_f32 v111, v118, v119
    ds_read_b64_tr_b16 v[48:49], v24 offset:9216
    ds_read_b64_tr_b16 v[50:51], v24 offset:11264
    s_waitcnt lgkmcnt(11)
    v_mfma_f32_32x32x16_bf16 v[136:151], v[28:31], v[160:163], v[136:151]
    ds_write_b128 v0, v[108:111] offset:9216
    ds_read_b64_tr_b16 v[52:53], v25 offset:9216
    ds_read_b64_tr_b16 v[54:55], v25 offset:11264
    s_waitcnt lgkmcnt(11)
    v_mfma_f32_32x32x16_bf16 v[120:135], v[32:35], v[164:167], v[120:135]
    ds_read_b64_tr_b16 v[28:29], v24 offset:12288
    ds_read_b64_tr_b16 v[30:31], v24 offset:14336
    s_waitcnt lgkmcnt(11)
    v_mfma_f32_32x32x16_bf16 v[136:151], v[36:39], v[164:167], v[136:151]
    ds_read_b64_tr_b16 v[32:33], v25 offset:12288
    ds_read_b64_tr_b16 v[34:35], v25 offset:14336
    s_waitcnt lgkmcnt(11)
    v_mfma_f32_32x32x16_bf16 v[120:135], v[40:43], v[168:171], v[120:135]
    ds_read_b64_tr_b16 v[36:37], v24 offset:13312
    ds_read_b64_tr_b16 v[38:39], v24 offset:15360
    s_waitcnt lgkmcnt(11)
    v_mfma_f32_32x32x16_bf16 v[136:151], v[44:47], v[168:171], v[136:151]
    ds_read_b64_tr_b16 v[40:41], v25 offset:13312
    ds_read_b64_tr_b16 v[42:43], v25 offset:15360
    s_waitcnt lgkmcnt(11)
    v_mfma_f32_32x32x16_bf16 v[120:135], v[48:51], v[172:175], v[120:135]
    ds_read_b64_tr_b16 v[44:45], v24 offset:16384
    ds_read_b64_tr_b16 v[46:47], v24 offset:18432
    s_waitcnt lgkmcnt(10)
    v_mfma_f32_32x32x16_bf16 v[136:151], v[52:55], v[172:175], v[136:151]
    ds_read_b64_tr_b16 v[48:49], v25 offset:16384
    ds_read_b64_tr_b16 v[50:51], v25 offset:18432
    s_waitcnt lgkmcnt(10)
    v_mfma_f32_32x32x16_bf16 v[120:135], v[28:31], v[176:179], v[120:135]
    ds_read_b64_tr_b16 v[52:53], v24 offset:17408
    ds_read_b64_tr_b16 v[54:55], v24 offset:19456
    s_waitcnt lgkmcnt(10)
    v_mfma_f32_32x32x16_bf16 v[136:151], v[32:35], v[176:179], v[136:151]
    ds_read_b64_tr_b16 v[28:29], v25 offset:17408
    ds_read_b64_tr_b16 v[30:31], v25 offset:19456
    s_waitcnt lgkmcnt(10)
    v_mfma_f32_32x32x16_bf16 v[120:135], v[36:39], v[180:183], v[120:135]
    ds_read_b64_tr_b16 v[32:33], v24 offset:20480
    ds_read_b64_tr_b16 v[34:35], v24 offset:22528
    s_waitcnt lgkmcnt(10)
    v_mfma_f32_32x32x16_bf16 v[136:151], v[40:43], v[180:183], v[136:151]
    ds_read_b64_tr_b16 v[36:37], v25 offset:20480
    ds_read_b64_tr_b16 v[38:39], v25 offset:22528
    s_waitcnt lgkmcnt(10)
    v_mfma_f32_32x32x16_bf16 v[120:135], v[44:47], v[184:187], v[120:135]
    ds_read_b64_tr_b16 v[40:41], v24 offset:21504
    ds_read_b64_tr_b16 v[42:43], v24 offset:23552
    s_waitcnt lgkmcnt(10)
    v_mfma_f32_32x32x16_bf16 v[136:151], v[48:51], v[184:187], v[136:151]
    ds_read_b64_tr_b16 v[44:45], v25 offset:21504
    ds_read_b64_tr_b16 v[46:47], v25 offset:23552
    s_waitcnt lgkmcnt(10)
    v_mfma_f32_32x32x16_bf16 v[120:135], v[52:55], v[188:191], v[120:135]
    ds_read_b64_tr_b16 v[48:49], v24 offset:24576
    ds_read_b64_tr_b16 v[50:51], v24 offset:26624
    s_waitcnt lgkmcnt(10)
    v_mfma_f32_32x32x16_bf16 v[136:151], v[28:31], v[188:191], v[136:151]
    ds_read_b64_tr_b16 v[52:53], v25 offset:24576
    ds_read_b64_tr_b16 v[54:55], v25 offset:26624
    s_waitcnt lgkmcnt(10)
    v_mfma_f32_32x32x16_bf16 v[120:135], v[32:35], v[192:195], v[120:135]
    ds_read_b64_tr_b16 v[28:29], v24 offset:25600
    ds_read_b64_tr_b16 v[30:31], v24 offset:27648
    s_waitcnt lgkmcnt(10)
    v_mfma_f32_32x32x16_bf16 v[136:151], v[36:39], v[192:195], v[136:151]
    ds_read_b64_tr_b16 v[32:33], v25 offset:25600
    ds_read_b64_tr_b16 v[34:35], v25 offset:27648
    s_waitcnt lgkmcnt(10)
    v_mfma_f32_32x32x16_bf16 v[120:135], v[40:43], v[196:199], v[120:135]
    ds_read_b64_tr_b16 v[36:37], v24 offset:28672
    ds_read_b64_tr_b16 v[38:39], v24 offset:30720
    s_waitcnt lgkmcnt(10)
    v_mfma_f32_32x32x16_bf16 v[136:151], v[44:47], v[196:199], v[136:151]
    ds_read_b64_tr_b16 v[40:41], v25 offset:28672
    ds_read_b64_tr_b16 v[42:43], v25 offset:30720
    s_waitcnt lgkmcnt(10)
    v_mfma_f32_32x32x16_bf16 v[120:135], v[48:51], v[200:203], v[120:135]
    ds_read_b64_tr_b16 v[44:45], v25 offset:29696
    ds_read_b64_tr_b16 v[46:47], v25 offset:31744
    s_waitcnt lgkmcnt(10)
    v_mfma_f32_32x32x16_bf16 v[136:151], v[52:55], v[200:203], v[136:151]
    ds_read_b64_tr_b16 v[48:49], v24 offset:29696
    ds_read_b64_tr_b16 v[50:51], v24 offset:31744
    s_waitcnt lgkmcnt(10)
    v_mfma_f32_32x32x16_bf16 v[120:135], v[28:31], v[204:207], v[120:135]
    s_waitcnt lgkmcnt(8)
    v_mfma_f32_32x32x16_bf16 v[136:151], v[32:35], v[204:207], v[136:151]
    s_waitcnt lgkmcnt(6)
    v_mfma_f32_32x32x16_bf16 v[120:135], v[36:39], v[208:211], v[120:135]
    s_waitcnt lgkmcnt(4)
    v_mfma_f32_32x32x16_bf16 v[136:151], v[40:43], v[208:211], v[136:151]
    s_waitcnt lgkmcnt(2)
    v_mfma_f32_32x32x16_bf16 v[136:151], v[44:47], v[212:215], v[136:151]
    s_waitcnt lgkmcnt(0)
    v_mfma_f32_32x32x16_bf16 v[120:135], v[48:51], v[212:215], v[120:135]
    s_lshl_b32 s96, s77, 11
    s_add_u32 s14, s96, 151552
    v_add_u32 v0, s14, v2
    v_bfe_u32 v4, v1, 2, 2
    v_lshlrev_b32 v4, 6, v4
    v_bfe_u32 v9, v1, 4, 1
    v_lshl_add_u32 v4, v9, 5, v4
    v_and_b32 v9, 3, v1
    v_lshl_add_u32 v4, v9, 3, v4
    v_lshrrev_b32 v9, 5, v1
    v_lshl_add_u32 v4, v9, 8, v4
    v_add_u32 v4, 159744, v4
    ds_read_b64_tr_b16 v[176:177], v4
    ds_read_b64_tr_b16 v[178:179], v4 offset:512
    ds_read_b64_tr_b16 v[180:181], v4 offset:1024
    ds_read_b64_tr_b16 v[182:183], v4 offset:1536
    v_cvt_pk_bf16_f32 v152, v136, v137
    v_cvt_pk_bf16_f32 v153, v138, v139
    v_cvt_pk_bf16_f32 v154, v140, v141
    v_cvt_pk_bf16_f32 v155, v142, v143
    v_cvt_pk_bf16_f32 v156, v144, v145
    v_cvt_pk_bf16_f32 v157, v146, v147
    v_cvt_pk_bf16_f32 v158, v148, v149
    v_cvt_pk_bf16_f32 v159, v150, v151
    ds_write_b128 v0, v[152:155]
    ds_write_b128 v0, v[156:159] offset:1024
    v_cvt_pk_bf16_f32 v168, v120, v121
    v_cvt_pk_bf16_f32 v169, v122, v123
    v_cvt_pk_bf16_f32 v170, v124, v125
    v_cvt_pk_bf16_f32 v171, v126, v127
    v_cvt_pk_bf16_f32 v172, v128, v129
    v_cvt_pk_bf16_f32 v173, v130, v131
    v_cvt_pk_bf16_f32 v174, v132, v133
    v_cvt_pk_bf16_f32 v175, v134, v135
    s_setprio 0
    s_branch L_JOIN
L_HELP:
    s_waitcnt vmcnt(0)
    s_barrier
    s_add_u32 s96, s84, 4
    s_and_b32 s97, s96, 15
    s_mul_i32 s98, s97, 393216
    s_add_u32 s99, s98, s85
    s_add_u32 s82, s99, 4294772736
    s_add_u32 m0, s83, 28672
    s_nop 0
    buffer_load_dwordx4 v3, s[40:43], s82 offen lds
    s_add_u32 s96, s84, 4
    s_and_b32 s97, s96, 15
    s_mul_i32 s98, s97, 393216
    s_add_u32 s99, s98, s85
    s_add_u32 s82, s99, 2048
    s_add_u32 m0, s83, 32768
    s_nop 0
    buffer_load_dwordx4 v3, s[40:43], s82 offen lds
    s_add_u32 s96, s84, 4
    s_and_b32 s97, s96, 15
    s_mul_i32 s98, s97, 393216
    s_add_u32 s99, s98, s85
    s_add_u32 s82, s99, 4294774784
    s_add_u32 m0, s83, 77824
    s_nop 0
    buffer_load_dwordx4 v3, s[40:43], s82 offen lds
    s_add_u32 s96, s84, 4
    s_and_b32 s97, s96, 15
    s_mul_i32 s98, s97, 393216
    s_add_u32 s99, s98, s85
    s_add_u32 s82, s99, 4096
    s_add_u32 m0, s83, 81920
    s_nop 0
    buffer_load_dwordx4 v3, s[40:43], s82 offen lds
    s_add_u32 s96, s84, 4
    s_and_b32 s97, s96, 15
    s_mul_i32 s98, s97, 393216
    s_add_u32 s99, s98, s85
    s_add_u32 s82, s99, 4294770688
    s_add_u32 m0, s83, 126976
    s_nop 0
    buffer_load_dwordx4 v3, s[40:43], s82 offen lds
    s_add_u32 s96, s84, 4
    s_and_b32 s97, s96, 15
    s_mul_i32 s98, s97, 393216
    s_add_u32 s82, s98, s85
    s_add_u32 m0, s83, 131072
    s_nop 0
    buffer_load_dwordx4 v3, s[40:43], s82 offen lds
    s_add_u32 s96, s84, 5
    s_and_b32 s97, s96, 15
    s_mul_i32 s98, s97, 393216
    s_add_u32 s99, s98, s85
    s_add_u32 s82, s99, 4294772736
    s_add_u32 m0, s83, 36864
    s_nop 0
    buffer_load_dwordx4 v3, s[40:43], s82 offen lds
    s_add_u32 s96, s84, 5
    s_and_b32 s97, s96, 15
    s_mul_i32 s98, s97, 393216
    s_add_u32 s99, s98, s85
    s_add_u32 s82, s99, 2048
    s_add_u32 m0, s83, 40960
    s_nop 0
    buffer_load_dwordx4 v3, s[40:43], s82 offen lds
    s_add_u32 s96, s84, 5
    s_and_b32 s97, s96, 15
    s_mul_i32 s98, s97, 393216
    s_add_u32 s99, s98, s85
    s_add_u32 s82, s99, 4294774784
    s_add_u32 m0, s83, 86016
    s_nop 0
    buffer_load_dwordx4 v3, s[40:43], s82 offen lds
    s_add_u32 s96, s84, 5
    s_and_b32 s97, s96, 15
    s_mul_i32 s98, s97, 393216
    s_add_u32 s99, s98, s85
    s_add_u32 s82, s99, 4096
    s_add_u32 m0, s83, 90112
    s_nop 0
    buffer_load_dwordx4 v3, s[40:43], s82 offen lds
    s_add_u32 s96, s84, 5
    s_and_b32 s97, s96, 15
    s_mul_i32 s98, s97, 393216
    s_add_u32 s99, s98, s85
    s_add_u32 s82, s99, 4294770688
    s_add_u32 m0, s83, 135168
    s_nop 0
    buffer_load_dwordx4 v3, s[40:43], s82 offen lds
    s_add_u32 s96, s84, 5
    s_and_b32 s97, s96, 15
    s_mul_i32 s98, s97, 393216
    s_add_u32 s82, s98, s85
    s_add_u32 m0, s83, 139264
    s_nop 0
    buffer_load_dwordx4 v3, s[40:43], s82 offen lds
    s_waitcnt lgkmcnt(0)
SPOLL_16:
    s_load_dwordx2 s[24:25], s[32:33], s19 offset:0 glc
    s_load_dwordx2 s[26:27], s[32:33], s19 offset:64 glc
SCHK_17:
    s_add_u32 s5, s5, 1
    s_cmp_ge_u32 s5, 200000
    s_waitcnt lgkmcnt(0)
    s_cbranch_scc1 SDONE_18
    s_cmp_lg_u32 s24, s4
    s_cbranch_scc1 SPOLL_16
    s_cmp_lg_u32 s25, s4
    s_cbranch_scc1 SPOLL_16
    s_cmp_lg_u32 s26, s4
    s_cbranch_scc1 SPOLL_16
    s_cmp_lg_u32 s27, s4
    s_cbranch_scc1 SPOLL_16
SDONE_18:
    v_bfe_u32 v4, v1, 2, 2
    v_lshlrev_b32 v4, 6, v4
    v_bfe_u32 v9, v1, 4, 1
    v_lshl_add_u32 v4, v9, 5, v4
    v_and_b32 v9, 3, v1
    v_lshl_add_u32 v4, v9, 3, v4
    v_lshrrev_b32 v9, 5, v1
    v_lshl_add_u32 v4, v9, 8, v4
    v_add_u32 v4, 159744, v4
    ds_read_b64_tr_b16 v[168:169], v4
    ds_read_b64_tr_b16 v[170:171], v4 offset:512
    ds_read_b64_tr_b16 v[172:173], v4 offset:1024
    ds_read_b64_tr_b16 v[174:175], v4 offset:1536
    ds_read_b64_tr_b16 v[176:177], v4 offset:2048
    ds_read_b64_tr_b16 v[178:179], v4 offset:2560
    ds_read_b64_tr_b16 v[180:181], v4 offset:3072
    ds_read_b64_tr_b16 v[182:183], v4 offset:3584
    s_lshl_b32 s14, s77, 10
    v_and_b32 v232, 7, v1
    v_lshl_add_u32 v232, v232, 4, s14
    v_bfe_u32 v9, v1, 3, 2
    v_lshl_add_u32 v232, v9, 8, v232
    v_lshrrev_b32 v9, 5, v1
    v_lshl_add_u32 v232, v9, 7, v232
    s_and_b32 s96, s9, 1
    s_lshl1_add_u32 s18, s96, 1
    s_and_b32 s96, s8, 3
    s_lshl2_add_u32 s97, s96, s3
    s_sub_u32 s98, s97, 4
    s_lshl_b32 s82, s98, 7
    v_lshrrev_b32 v52, 3, v1
    v_lshl_add_u32 v52, v52, 1, s82
    global_load_ushort v36, v52, s[86:87] offset:0
    global_load_ushort v37, v52, s[86:87] offset:16
    global_load_ushort v38, v52, s[86:87] offset:32
    global_load_ushort v39, v52, s[86:87] offset:48
    global_load_ushort v40, v52, s[86:87] offset:64
    global_load_ushort v41, v52, s[86:87] offset:80
    global_load_ushort v42, v52, s[86:87] offset:96
    global_load_ushort v43, v52, s[86:87] offset:112
    s_and_b32 s96, s8, 3
    s_lshl2_add_u32 s97, s96, s3
    s_sub_u32 s98, s97, 4
    s_mul_i32 s99, s98, 786432
    s_lshr_b32 s96, s8, 2
    s_lshl1_add_u32 s97, s9, s96
    s_lshl_b32 s98, s97, 7
    s_add_u32 s96, s99, s98
    s_add_u32 s19, s96, 4096
    s_barrier
    s_add_u32 s96, s84, 6
    s_and_b32 s97, s96, 15
    s_mul_i32 s98, s97, 393216
    s_add_u32 s99, s98, s85
    s_add_u32 s82, s99, 4294772736
    s_add_u32 m0, s83, 4294963200
    s_nop 0
    buffer_load_dwordx4 v3, s[40:43], s82 offen lds
    s_add_u32 s96, s84, 6
    s_and_b32 s97, s96, 15
    s_mul_i32 s98, s97, 393216
    s_add_u32 s99, s98, s85
    s_add_u32 s82, s99, 2048
    s_mov_b32 m0, s83
    s_nop 0
    buffer_load_dwordx4 v3, s[40:43], s82 offen lds
    s_add_u32 s96, s84, 6
    s_and_b32 s97, s96, 15
    s_mul_i32 s98, s97, 393216
    s_add_u32 s99, s98, s85
    s_add_u32 s82, s99, 4294770688
    s_add_u32 m0, s83, 94208
    s_nop 0
    buffer_load_dwordx4 v3, s[40:43], s82 offen lds
    s_add_u32 s96, s84, 6
    s_and_b32 s97, s96, 15
    s_mul_i32 s98, s97, 393216
    s_add_u32 s82, s98, s85
    s_add_u32 m0, s83, 98304
    s_nop 0
    buffer_load_dwordx4 v3, s[40:43], s82 offen lds
    s_add_u32 s96, s84, 6
    s_and_b32 s97, s96, 15
    s_mul_i32 s98, s97, 393216
    s_add_u32 s99, s98, s85
    s_add_u32 s82, s99, 4294774784
    s_add_u32 m0, s83, 45056
    s_nop 0
    buffer_load_dwordx4 v3, s[40:43], s82 offen lds
    s_add_u32 s96, s84, 6
    s_and_b32 s97, s96, 15
    s_mul_i32 s98, s97, 393216
    s_add_u32 s99, s98, s85
    s_add_u32 s82, s99, 4096
    s_add_u32 m0, s83, 49152
    s_nop 0
    buffer_load_dwordx4 v3, s[40:43], s82 offen lds
    s_waitcnt lgkmcnt(0)
    s_load_dword s24, s[32:33], s92 offset:512 glc
    s_load_dword s25, s[32:33], s92 offset:256 glc
    s_load_dword s26, s[32:33], s92 offset:3584 glc
    s_load_dword s27, s[32:33], s92 offset:3328 glc
    s_barrier
    s_add_u32 s96, s84, 7
    s_and_b32 s97, s96, 15
    s_mul_i32 s98, s97, 393216
    s_add_u32 s99, s98, s85
    s_add_u32 s82, s99, 4294772736
    s_add_u32 m0, s83, 4096
    s_nop 0
    buffer_load_dwordx4 v3, s[40:43], s82 offen lds
    s_add_u32 s96, s84, 7
    s_and_b32 s97, s96, 15
    s_mul_i32 s98, s97, 393216
    s_add_u32 s99, s98, s85
    s_add_u32 s82, s99, 2048
    s_add_u32 m0, s83, 8192
    s_nop 0
    buffer_load_dwordx4 v3, s[40:43], s82 offen lds
    s_add_u32 s96, s84, 7
    s_and_b32 s97, s96, 15
    s_mul_i32 s98, s97, 393216
    s_add_u32 s99, s98, s85
    s_add_u32 s82, s99, 4294770688
    s_add_u32 m0, s83, 102400
    s_nop 0
    buffer_load_dwordx4 v3, s[40:43], s82 offen lds
    s_add_u32 s96, s84, 7
    s_and_b32 s97, s96, 15
    s_mul_i32 s98, s97, 393216
    s_add_u32 s82, s98, s85
    s_add_u32 m0, s83, 106496
    s_nop 0
    buffer_load_dwordx4 v3, s[40:43], s82 offen lds
    s_add_u32 s96, s84, 7
    s_and_b32 s97, s96, 15
    s_mul_i32 s98, s97, 393216
    s_add_u32 s99, s98, s85
    s_add_u32 s82, s99, 4294774784
    s_add_u32 m0, s83, 53248
    s_nop 0
    buffer_load_dwordx4 v3, s[40:43], s82 offen lds
    s_add_u32 s96, s84, 7
    s_and_b32 s97, s96, 15
    s_mul_i32 s98, s97, 393216
    s_add_u32 s99, s98, s85
    s_add_u32 s82, s99, 4096
    s_add_u32 m0, s83, 57344
    s_nop 0
    buffer_load_dwordx4 v3, s[40:43], s82 offen lds
    s_waitcnt vmcnt(30)
    s_waitcnt vmcnt(26)
    s_barrier
    s_add_u32 s96, s84, 8
    s_and_b32 s97, s96, 15
    s_mul_i32 s98, s97, 393216
    s_add_u32 s99, s98, s85
    s_add_u32 s82, s99, 4294772736
    s_add_u32 m0, s83, 12288
    s_nop 0
    buffer_load_dwordx4 v3, s[40:43], s82 offen lds
    s_add_u32 s96, s84, 8
    s_and_b32 s97, s96, 15
    s_mul_i32 s98, s97, 393216
    s_add_u32 s99, s98, s85
    s_add_u32 s82, s99, 2048
    s_add_u32 m0, s83, 16384
    s_nop 0
    buffer_load_dwordx4 v3, s[40:43], s82 offen lds
    s_add_u32 s96, s84, 8
    s_and_b32 s97, s96, 15
    s_mul_i32 s98, s97, 393216
    s_add_u32 s99, s98, s85
    s_add_u32 s82, s99, 4294770688
    s_add_u32 m0, s83, 110592
    s_nop 0
    buffer_load_dwordx4 v3, s[40:43], s82 offen lds
    s_add_u32 s96, s84, 8
    s_and_b32 s97, s96, 15
    s_mul_i32 s98, s97, 393216
    s_add_u32 s82, s98, s85
    s_add_u32 m0, s83, 114688
    s_nop 0
    buffer_load_dwordx4 v3, s[40:43], s82 offen lds
    s_add_u32 s96, s84, 8
    s_and_b32 s97, s96, 15
    s_mul_i32 s98, s97, 393216
    s_add_u32 s99, s98, s85
    s_add_u32 s82, s99, 4294774784
    s_add_u32 m0, s83, 61440
    s_nop 0
    buffer_load_dwordx4 v3, s[40:43], s82 offen lds
    s_add_u32 s96, s84, 8
    s_and_b32 s97, s96, 15
    s_mul_i32 s98, s97, 393216
    s_add_u32 s99, s98, s85
    s_add_u32 s82, s99, 4096
    s_add_u32 m0, s83, 65536
    s_nop 0
    buffer_load_dwordx4 v3, s[40:43], s82 offen lds
    s_waitcnt vmcnt(18)
    v_lshlrev_b32 v36, 16, v36
    v_mul_f32 v52, s7, v36
    v_exp_f32 v52, -v52
    s_nop 0
    v_add_f32 v52, 1.0, v52
    v_rcp_f32 v52, v52
    s_nop 0
    v_mul_f32 v36, v36, v52
    v_cvt_pk_bf16_f32 v36, 0, v36
    v_lshlrev_b32 v37, 16, v37
    v_mul_f32 v53, s7, v37
    v_exp_f32 v53, -v53
    s_nop 0
    v_add_f32 v53, 1.0, v53
    v_rcp_f32 v53, v53
    s_nop 0
    v_mul_f32 v37, v37, v53
    v_cvt_pk_bf16_f32 v37, 0, v37
    v_lshlrev_b32 v38, 16, v38
    v_mul_f32 v52, s7, v38
    v_exp_f32 v52, -v52
    s_nop 0
    v_add_f32 v52, 1.0, v52
    v_rcp_f32 v52, v52
    s_nop 0
    v_mul_f32 v38, v38, v52
    v_cvt_pk_bf16_f32 v38, 0, v38
    v_lshlrev_b32 v39, 16, v39
    v_mul_f32 v53, s7, v39
    v_exp_f32 v53, -v53
    s_nop 0
    v_add_f32 v53, 1.0, v53
    v_rcp_f32 v53, v53
    s_nop 0
    v_mul_f32 v39, v39, v53
    v_cvt_pk_bf16_f32 v39, 0, v39
    v_lshlrev_b32 v40, 16, v40
    v_mul_f32 v52, s7, v40
    v_exp_f32 v52, -v52
    s_nop 0
    v_add_f32 v52, 1.0, v52
    v_rcp_f32 v52, v52
    s_nop 0
    v_mul_f32 v40, v40, v52
    v_cvt_pk_bf16_f32 v40, 0, v40
    v_lshlrev_b32 v41, 16, v41
    v_mul_f32 v53, s7, v41
    v_exp_f32 v53, -v53
    s_nop 0
    v_add_f32 v53, 1.0, v53
    v_rcp_f32 v53, v53
    s_nop 0
    v_mul_f32 v41, v41, v53
    v_cvt_pk_bf16_f32 v41, 0, v41
    v_lshlrev_b32 v42, 16, v42
    v_mul_f32 v52, s7, v42
    v_exp_f32 v52, -v52
    s_nop 0
    v_add_f32 v52, 1.0, v52
    v_rcp_f32 v52, v52
    s_nop 0
    v_mul_f32 v42, v42, v52
    v_cvt_pk_bf16_f32 v42, 0, v42
    v_lshlrev_b32 v43, 16, v43
    v_mul_f32 v53, s7, v43
    v_exp_f32 v53, -v53
    s_nop 0
    v_add_f32 v53, 1.0, v53
    v_rcp_f32 v53, v53
    s_nop 0
    v_mul_f32 v43, v43, v53
    v_cvt_pk_bf16_f32 v43, 0, v43
    s_waitcnt lgkmcnt(0)
    s_load_dword s24, s[32:33], s92 offset:1024 glc
    s_load_dword s25, s[32:33], s92 offset:768 glc
    s_load_dword s26, s[32:33], s92 offset:1536 glc
    s_load_dword s27, s[32:33], s92 offset:1280 glc
    s_barrier
    s_add_u32 s96, s84, 9
    s_and_b32 s97, s96, 15
    s_mul_i32 s98, s97, 393216
    s_add_u32 s99, s98, s85
    s_add_u32 s82, s99, 4294772736
    s_add_u32 m0, s83, 20480
    s_nop 0
    buffer_load_dwordx4 v3, s[40:43], s82 offen lds
    s_add_u32 s96, s84, 9
    s_and_b32 s97, s96, 15
    s_mul_i32 s98, s97, 393216
    s_add_u32 s99, s98, s85
    s_add_u32 s82, s99, 2048
    s_add_u32 m0, s83, 24576
    s_nop 0
    buffer_load_dwordx4 v3, s[40:43], s82 offen lds
    s_add_u32 s96, s84, 9
    s_and_b32 s97, s96, 15
    s_mul_i32 s98, s97, 393216
    s_add_u32 s99, s98, s85
    s_add_u32 s82, s99, 4294770688
    s_add_u32 m0, s83, 118784
    s_nop 0
    buffer_load_dwordx4 v3, s[40:43], s82 offen lds
    s_add_u32 s96, s84, 9
    s_and_b32 s97, s96, 15
    s_mul_i32 s98, s97, 393216
    s_add_u32 s82, s98, s85
    s_add_u32 m0, s83, 122880
    s_nop 0
    buffer_load_dwordx4 v3, s[40:43], s82 offen lds
    s_add_u32 s96, s84, 9
    s_and_b32 s97, s96, 15
    s_mul_i32 s98, s97, 393216
    s_add_u32 s99, s98, s85
    s_add_u32 s82, s99, 4294774784
    s_add_u32 m0, s83, 69632
    s_nop 0
    buffer_load_dwordx4 v3, s[40:43], s82 offen lds
    s_add_u32 s96, s84, 9
    s_and_b32 s97, s96, 15
    s_mul_i32 s98, s97, 393216
    s_add_u32 s99, s98, s85
    s_add_u32 s82, s99, 4096
    s_add_u32 m0, s83, 73728
    s_nop 0
    buffer_load_dwordx4 v3, s[40:43], s82 offen lds
L_PAD5:
    s_cbranch_execz L_RET5
    s_waitcnt vmcnt(22)
    s_waitcnt vmcnt(20)
    s_waitcnt vmcnt(18)
    s_barrier
    s_add_u32 s96, s84, 10
    s_and_b32 s97, s96, 15
    s_mul_i32 s98, s97, 393216
    s_add_u32 s99, s98, s85
    s_add_u32 s82, s99, 4294772736
    s_add_u32 m0, s83, 28672
    s_nop 0
    buffer_load_dwordx4 v3, s[40:43], s82 offen lds
    s_add_u32 s96, s84, 10
    s_and_b32 s97, s96, 15
    s_mul_i32 s98, s97, 393216
    s_add_u32 s99, s98, s85
    s_add_u32 s82, s99, 2048
    s_add_u32 m0, s83, 32768
    s_nop 0
    buffer_load_dwordx4 v3, s[40:43], s82 offen lds
    s_add_u32 s96, s84, 10
    s_and_b32 s97, s96, 15
    s_mul_i32 s98, s97, 393216
    s_add_u32 s99, s98, s85
    s_add_u32 s82, s99, 4294774784
    s_add_u32 m0, s83, 77824
    s_nop 0
    buffer_load_dwordx4 v3, s[40:43], s82 offen lds
    s_add_u32 s96, s84, 10
    s_and_b32 s97, s96, 15
    s_mul_i32 s98, s97, 393216
    s_add_u32 s99, s98, s85
    s_add_u32 s82, s99, 4096
    s_add_u32 m0, s83, 81920
    s_nop 0
    buffer_load_dwordx4 v3, s[40:43], s82 offen lds
    s_waitcnt lgkmcnt(0)
    s_load_dword s24, s[32:33], s92 offset:2560 glc
    s_load_dword s25, s[32:33], s92 offset:2304 glc
    s_load_dword s26, s[32:33], s92 offset:3072 glc
    s_load_dword s27, s[32:33], s92 offset:2816 glc
    s_waitcnt vmcnt(20)
    s_waitcnt vmcnt(18)
    s_waitcnt vmcnt(16)
    s_barrier
    s_add_u32 s96, s84, 11
    s_and_b32 s97, s96, 15
    s_mul_i32 s98, s97, 393216
    s_add_u32 s99, s98, s85
    s_add_u32 s82, s99, 4294772736
    s_add_u32 m0, s83, 36864
    s_nop 0
    buffer_load_dwordx4 v3, s[40:43], s82 offen lds
    s_add_u32 s96, s84, 11
    s_and_b32 s97, s96, 15
    s_mul_i32 s98, s97, 393216
    s_add_u32 s99, s98, s85
    s_add_u32 s82, s99, 2048
    s_add_u32 m0, s83, 40960
    s_nop 0
    buffer_load_dwordx4 v3, s[40:43], s82 offen lds
    s_add_u32 s96, s84, 11
    s_and_b32 s97, s96, 15
    s_mul_i32 s98, s97, 393216
    s_add_u32 s99, s98, s85
    s_add_u32 s82, s99, 4294774784
    s_add_u32 m0, s83, 86016
    s_nop 0
    buffer_load_dwordx4 v3, s[40:43], s82 offen lds
    s_add_u32 s96, s84, 11
    s_and_b32 s97, s96, 15
    s_mul_i32 s98, s97, 393216
    s_add_u32 s99, s98, s85
    s_add_u32 s82, s99, 4096
    s_add_u32 m0, s83, 90112
    s_nop 0
    buffer_load_dwordx4 v3, s[40:43], s82 offen lds
    s_waitcnt vmcnt(18)
    s_waitcnt vmcnt(16)
    s_waitcnt vmcnt(14)
    s_barrier
    s_add_u32 s96, s84, 12
    s_and_b32 s97, s96, 15
    s_mul_i32 s98, s97, 393216
    s_add_u32 s99, s98, s85
    s_add_u32 s82, s99, 4294772736
    s_add_u32 m0, s83, 4294963200
    s_nop 0
    buffer_load_dwordx4 v3, s[40:43], s82 offen lds
    s_add_u32 s96, s84, 12
    s_and_b32 s97, s96, 15
    s_mul_i32 s98, s97, 393216
    s_add_u32 s99, s98, s85
    s_add_u32 s82, s99, 2048
    s_mov_b32 m0, s83
    s_nop 0
    buffer_load_dwordx4 v3, s[40:43], s82 offen lds
    s_add_u32 s96, s84, 12
    s_and_b32 s97, s96, 15
    s_mul_i32 s98, s97, 393216
    s_add_u32 s99, s98, s85
    s_add_u32 s82, s99, 4294774784
    s_add_u32 m0, s83, 45056
    s_nop 0
    buffer_load_dwordx4 v3, s[40:43], s82 offen lds
    s_add_u32 s96, s84, 12
    s_and_b32 s97, s96, 15
    s_mul_i32 s98, s97, 393216
    s_add_u32 s99, s98, s85
    s_add_u32 s82, s99, 4096
    s_add_u32 m0, s83, 49152
    s_nop 0
    buffer_load_dwordx4 v3, s[40:43], s82 offen lds
    s_waitcnt vmcnt(16)
    s_barrier
    s_add_u32 s96, s84, 13
    s_and_b32 s97, s96, 15
    s_mul_i32 s98, s97, 393216
    s_add_u32 s99, s98, s85
    s_add_u32 s82, s99, 4294772736
    s_add_u32 m0, s83, 4096
    s_nop 0
    buffer_load_dwordx4 v3, s[40:43], s82 offen lds
    s_add_u32 s96, s84, 13
    s_and_b32 s97, s96, 15
    s_mul_i32 s98, s97, 393216
    s_add_u32 s99, s98, s85
    s_add_u32 s82, s99, 2048
    s_add_u32 m0, s83, 8192
    s_nop 0
    buffer_load_dwordx4 v3, s[40:43], s82 offen lds
    s_add_u32 s96, s84, 13
    s_and_b32 s97, s96, 15
    s_mul_i32 s98, s97, 393216
    s_add_u32 s99, s98, s85
    s_add_u32 s82, s99, 4294774784
    s_add_u32 m0, s83, 53248
    s_nop 0
    buffer_load_dwordx4 v3, s[40:43], s82 offen lds
    s_add_u32 s96, s84, 13
    s_and_b32 s97, s96, 15
    s_mul_i32 s98, s97, 393216
    s_add_u32 s99, s98, s85
    s_add_u32 s82, s99, 4096
    s_add_u32 m0, s83, 57344
    s_nop 0
    buffer_load_dwordx4 v3, s[40:43], s82 offen lds
    s_lshl_b32 s96, s74, 13
    s_sub_u32 s97, s3, 4
    s_lshl_b32 s98, s97, 8
    s_add_u32 s99, s96, s98
    s_add_u32 s13, s99, 20971520
    s_waitcnt lgkmcnt(0)
    s_load_dword s24, s[32:33], s13 offset:1276 glc
    s_load_dword s25, s[32:33], s13 offset:3324 glc
    s_load_dword s26, s[32:33], s13 offset:5372 glc
    s_load_dword s27, s[32:33], s13 offset:7420 glc
    s_waitcnt vmcnt(18)
    s_waitcnt vmcnt(16)
    s_barrier
    s_add_u32 s96, s84, 14
    s_and_b32 s97, s96, 15
    s_mul_i32 s98, s97, 393216
    s_add_u32 s99, s98, s85
    s_add_u32 s82, s99, 4294772736
    s_add_u32 m0, s83, 12288
    s_nop 0
    buffer_load_dwordx4 v3, s[40:43], s82 offen lds
    s_add_u32 s96, s84, 14
    s_and_b32 s97, s96, 15
    s_mul_i32 s98, s97, 393216
    s_add_u32 s99, s98, s85
    s_add_u32 s82, s99, 2048
    s_add_u32 m0, s83, 16384
    s_nop 0
    buffer_load_dwordx4 v3, s[40:43], s82 offen lds
    s_add_u32 s96, s84, 10
    s_and_b32 s97, s96, 15
    s_mul_i32 s98, s97, 393216
    s_add_u32 s99, s98, s85
    s_add_u32 s82, s99, 4294770688
    s_add_u32 m0, s83, 126976
    s_nop 0
    buffer_load_dwordx4 v3, s[40:43], s82 offen lds
    s_add_u32 s96, s84, 10
    s_and_b32 s97, s96, 15
    s_mul_i32 s98, s97, 393216
    s_add_u32 s82, s98, s85
    s_add_u32 m0, s83, 131072
    s_nop 0
    buffer_load_dwordx4 v3, s[40:43], s82 offen lds
    s_waitcnt vmcnt(18)
    s_waitcnt vmcnt(14)
    s_barrier
    s_add_u32 s96, s84, 15
    s_and_b32 s97, s96, 15
    s_mul_i32 s98, s97, 393216
    s_add_u32 s99, s98, s85
    s_add_u32 s82, s99, 4294772736
    s_add_u32 m0, s83, 20480
    s_nop 0
    buffer_load_dwordx4 v3, s[40:43], s82 offen lds
    s_add_u32 s96, s84, 15
    s_and_b32 s97, s96, 15
    s_mul_i32 s98, s97, 393216
    s_add_u32 s99, s98, s85
    s_add_u32 s82, s99, 2048
    s_add_u32 m0, s83, 24576
    s_nop 0
    buffer_load_dwordx4 v3, s[40:43], s82 offen lds
    s_add_u32 s96, s84, 11
    s_and_b32 s97, s96, 15
    s_mul_i32 s98, s97, 393216
    s_add_u32 s99, s98, s85
    s_add_u32 s82, s99, 4294770688
    s_add_u32 m0, s83, 135168
    s_nop 0
    buffer_load_dwordx4 v3, s[40:43], s82 offen lds
    s_add_u32 s96, s84, 11
    s_and_b32 s97, s96, 15
    s_mul_i32 s98, s97, 393216
    s_add_u32 s82, s98, s85
    s_add_u32 m0, s83, 139264
    s_nop 0
    buffer_load_dwordx4 v3, s[40:43], s82 offen lds
    s_waitcnt vmcnt(14)
    s_waitcnt vmcnt(10)
    s_waitcnt vmcnt(6)
    s_barrier
    s_add_u32 s96, s84, 14
    s_and_b32 s97, s96, 15
    s_mul_i32 s98, s97, 393216
    s_add_u32 s99, s98, s85
    s_add_u32 s82, s99, 4294774784
    s_add_u32 m0, s83, 61440
    s_nop 0
    buffer_load_dwordx4 v3, s[40:43], s82 offen lds
    s_add_u32 s96, s84, 14
    s_and_b32 s97, s96, 15
    s_mul_i32 s98, s97, 393216
    s_add_u32 s99, s98, s85
    s_add_u32 s82, s99, 4096
    s_add_u32 m0, s83, 65536
    s_nop 0
    buffer_load_dwordx4 v3, s[40:43], s82 offen lds
    s_add_u32 s96, s84, 15
    s_and_b32 s97, s96, 15
    s_mul_i32 s98, s97, 393216
    s_add_u32 s99, s98, s85
    s_add_u32 s82, s99, 4294774784
    s_add_u32 m0, s83, 69632
    s_nop 0
    buffer_load_dwordx4 v3, s[40:43], s82 offen lds
    s_add_u32 s96, s84, 15
    s_and_b32 s97, s96, 15
    s_mul_i32 s98, s97, 393216
    s_add_u32 s99, s98, s85
    s_add_u32 s82, s99, 4096
    s_add_u32 m0, s83, 73728
    s_nop 0
    buffer_load_dwordx4 v3, s[40:43], s82 offen lds
    s_add_u32 s96, s84, 12
    s_and_b32 s97, s96, 15
    s_mul_i32 s98, s97, 393216
    s_add_u32 s99, s98, s85
    s_add_u32 s82, s99, 4294770688
    s_add_u32 m0, s83, 94208
    s_nop 0
    buffer_load_dwordx4 v3, s[40:43], s82 offen lds
    s_add_u32 s96, s84, 12
    s_and_b32 s97, s96, 15
    s_mul_i32 s98, s97, 393216
    s_add_u32 s82, s98, s85
    s_add_u32 m0, s83, 98304
    s_nop 0
    buffer_load_dwordx4 v3, s[40:43], s82 offen lds
    s_mov_b32 s82, s19
    buffer_load_dwordx4 v[88:91], v248, s[48:51], s82 offen nt
    s_add_u32 s82, s19, 98304
    buffer_load_dwordx4 v[92:95], v248, s[48:51], s82 offen nt
    s_add_u32 s82, s19, 196608
    buffer_load_dwordx4 v[96:99], v248, s[48:51], s82 offen nt
    s_add_u32 s82, s19, 294912
    buffer_load_dwordx4 v[100:103], v248, s[48:51], s82 offen nt
    s_waitcnt vmcnt(12)
    s_barrier
    s_add_u32 s96, s84, 13
    s_and_b32 s97, s96, 15
    s_mul_i32 s98, s97, 393216
    s_add_u32 s99, s98, s85
    s_add_u32 s82, s99, 4294770688
    s_add_u32 m0, s83, 102400
    s_nop 0
    buffer_load_dwordx4 v3, s[40:43], s82 offen lds
    s_add_u32 s96, s84, 13
    s_and_b32 s97, s96, 15
    s_mul_i32 s98, s97, 393216
    s_add_u32 s82, s98, s85
    s_add_u32 m0, s83, 106496
    s_nop 0
    buffer_load_dwordx4 v3, s[40:43], s82 offen lds
    s_add_u32 s96, s84, 14
    s_and_b32 s97, s96, 15
    s_mul_i32 s98, s97, 393216
    s_add_u32 s99, s98, s85
    s_add_u32 s82, s99, 4294770688
    s_add_u32 m0, s83, 110592
    s_nop 0
    buffer_load_dwordx4 v3, s[40:43], s82 offen lds
    s_add_u32 s96, s84, 14
    s_and_b32 s97, s96, 15
    s_mul_i32 s98, s97, 393216
    s_add_u32 s82, s98, s85
    s_add_u32 m0, s83, 114688
    s_nop 0
    buffer_load_dwordx4 v3, s[40:43], s82 offen lds
    s_add_u32 s96, s84, 15
    s_and_b32 s97, s96, 15
    s_mul_i32 s98, s97, 393216
    s_add_u32 s99, s98, s85
    s_add_u32 s82, s99, 4294770688
    s_add_u32 m0, s83, 118784
    s_nop 0
    buffer_load_dwordx4 v3, s[40:43], s82 offen lds
    s_add_u32 s96, s84, 15
    s_and_b32 s97, s96, 15
    s_mul_i32 s98, s97, 393216
    s_add_u32 s82, s98, s85
    s_add_u32 m0, s83, 122880
    s_nop 0
    buffer_load_dwordx4 v3, s[40:43], s82 offen lds
    s_waitcnt lgkmcnt(0)
    s_barrier
    s_setprio 3
    ds_read_b128 v[152:155], v0
    ds_read_b128 v[156:159], v0 offset:1024
    v_subrev_u32 v0, 118784, v0
    s_waitcnt lgkmcnt(1)
    v_mfma_f32_32x32x16_bf16 v[184:199], v[168:171], v[152:155], 0
    s_waitcnt lgkmcnt(0)
    v_mfma_f32_32x32x16_bf16 v[184:199], v[172:175], v[156:159], v[184:199]
    s_setprio 0
    s_nop 10
    v_cvt_pk_bf16_f32 v184, 0, v184
    v_cvt_pk_bf16_f32 v185, 0, v185
    v_cvt_pk_bf16_f32 v186, 0, v186
    s_add_u32 s82, s19, 393216
    buffer_load_dwordx4 v[104:107], v248, s[48:51], s82 offen nt
    v_cvt_pk_bf16_f32 v187, 0, v187
    v_cvt_pk_bf16_f32 v188, 0, v188
    v_cvt_pk_bf16_f32 v189, 0, v189
    v_cvt_pk_bf16_f32 v190, 0, v190
    v_cvt_pk_bf16_f32 v191, 0, v191
    v_cvt_pk_bf16_f32 v192, 0, v192
    v_cvt_pk_bf16_f32 v193, 0, v193
    v_cvt_pk_bf16_f32 v194, 0, v194
    v_cvt_pk_bf16_f32 v195, 0, v195
    v_cvt_pk_bf16_f32 v196, 0, v196
    s_add_u32 s82, s19, 491520
    buffer_load_dwordx4 v[108:111], v248, s[48:51], s82 offen nt
    v_cvt_pk_bf16_f32 v197, 0, v197
    v_cvt_pk_bf16_f32 v198, 0, v198
    v_cvt_pk_bf16_f32 v199, 0, v199
    v_max3_f32 v4, v184, v185, v186
    v_min3_f32 v5, v184, v185, v186
    v_max3_f32 v4, v4, v187, v188
    v_min3_f32 v5, v5, v187, v188
    v_max3_f32 v4, v4, v189, v190
    v_min3_f32 v5, v5, v189, v190
    v_max3_f32 v4, v4, v191, v192
    s_add_u32 s82, s19, 589824
    buffer_load_dwordx4 v[112:115], v248, s[48:51], s82 offen nt
    v_min3_f32 v5, v5, v191, v192
    v_max3_f32 v4, v4, v193, v194
    v_min3_f32 v5, v5, v193, v194
    v_max3_f32 v4, v4, v195, v196
    v_min3_f32 v5, v5, v195, v196
    v_max3_f32 v4, v4, v197, v198
    v_min3_f32 v5, v5, v197, v198
    v_max_f32 v6, v4, v199
    v_min_f32 v7, v5, v199
    v_max_f32 v4, v4, v199
    s_add_u32 s82, s19, 688128
    buffer_load_dwordx4 v[116:119], v248, s[48:51], s82 offen nt
    v_min_f32 v5, v5, v199
    v_permlane32_swap_b32 v4, v6
    s_nop 0
    v_permlane32_swap_b32 v5, v7
    v_max_f32 v4, v4, v6
    v_min_f32 v5, v5, v7
    v_mul_f32_e64 v4, v4, s7
    v_mul_f32_e64 v5, v5, s7
    v_fma_f32 v216, v184, s7, -v4
    v_fma_f32 v217, v185, s7, -v4
    v_fma_f32 v184, -v184, s7, v5
    v_fma_f32 v185, -v185, s7, v5
    v_fma_f32 v218, v186, s7, -v4
    v_fma_f32 v219, v187, s7, -v4
    v_fma_f32 v186, -v186, s7, v5
    v_fma_f32 v187, -v187, s7, v5
    s_waitcnt vmcnt(18)
    s_waitcnt vmcnt(16)
    s_barrier
    s_setprio 3
    ds_read_b128 v[152:155], v0
    ds_read_b128 v[156:159], v0 offset:1024
    s_waitcnt lgkmcnt(1)
    v_mfma_f32_32x32x16_bf16 v[200:215], v[176:179], v[152:155], 0
    s_waitcnt lgkmcnt(0)
    v_mfma_f32_32x32x16_bf16 v[200:215], v[180:183], v[156:159], v[200:215]
    s_setprio 0
    v_fma_f32 v220, v188, s7, -v4
    v_fma_f32 v221, v189, s7, -v4
    v_fma_f32 v188, -v188, s7, v5
    v_fma_f32 v189, -v189, s7, v5
    v_fma_f32 v222, v190, s7, -v4
    s_mov_b32 s82, s80
    buffer_load_dwordx4 v[56:59], v27, s[52:55], s82 offen nt
    v_fma_f32 v223, v191, s7, -v4
    v_fma_f32 v190, -v190, s7, v5
    v_fma_f32 v191, -v191, s7, v5
    v_fma_f32 v224, v192, s7, -v4
    v_fma_f32 v225, v193, s7, -v4
    s_setprio 3
    v_fma_f32 v192, -v192, s7, v5
    v_fma_f32 v193, -v193, s7, v5
    v_fma_f32 v226, v194, s7, -v4
    v_fma_f32 v227, v195, s7, -v4
    v_fma_f32 v194, -v194, s7, v5
    v_fma_f32 v195, -v195, s7, v5
    v_fma_f32 v228, v196, s7, -v4
    v_fma_f32 v229, v197, s7, -v4
    v_fma_f32 v196, -v196, s7, v5
    v_fma_f32 v197, -v197, s7, v5
    v_fma_f32 v230, v198, s7, -v4
    v_fma_f32 v231, v199, s7, -v4
    v_fma_f32 v198, -v198, s7, v5
    v_fma_f32 v199, -v199, s7, v5
    v_exp_f32 v216, v216
    s_add_u32 s82, s80, 4294049792
    buffer_load_dwordx4 v[60:63], v27, s[52:55], s82 offen nt
    v_exp_f32 v184, v184
    v_exp_f32 v217, v217
    v_exp_f32 v185, v185
    v_exp_f32 v218, v218
    v_exp_f32 v186, v186
    v_exp_f32 v219, v219
    v_exp_f32 v187, v187
    v_exp_f32 v220, v220
    v_exp_f32 v188, v188
    v_exp_f32 v221, v221
    v_exp_f32 v189, v189
    v_exp_f32 v222, v222
    v_exp_f32 v190, v190
    v_exp_f32 v223, v223
    v_exp_f32 v191, v191
    v_exp_f32 v224, v224
    v_exp_f32 v192, v192
    v_exp_f32 v225, v225
    v_exp_f32 v193, v193
    v_exp_f32 v226, v226
    s_add_u32 s82, s80, 57344
    buffer_load_dwordx4 v[64:67], v27, s[52:55], s82 offen nt
    v_exp_f32 v194, v194
    v_exp_f32 v227, v227
    v_exp_f32 v195, v195
    v_exp_f32 v228, v228
    v_exp_f32 v196, v196
    v_exp_f32 v229, v229
    v_exp_f32 v197, v197
    v_exp_f32 v230, v230
    v_exp_f32 v198, v198
    v_exp_f32 v231, v231
    v_exp_f32 v199, v199
    v_add_f32 v8, v216, v218
    v_add_f32 v9, v217, v219
    v_add_f32 v10, v184, v186
    v_add_f32 v11, v185, v187
    v_add_f32 v8, v8, v220
    v_add_f32 v9, v9, v221
    v_add_f32 v10, v10, v188
    v_add_f32 v11, v11, v189
    v_add_f32 v8, v8, v222
    s_add_u32 s82, s80, 4294107136
    buffer_load_dwordx4 v[68:71], v27, s[52:55], s82 offen nt
    v_add_f32 v9, v9, v223
    v_add_f32 v10, v10, v190
    v_add_f32 v11, v11, v191
    v_add_f32 v8, v8, v224
    v_add_f32 v9, v9, v225
    v_add_f32 v10, v10, v192
    v_add_f32 v11, v11, v193
    v_add_f32 v8, v8, v226
    v_add_f32 v9, v9, v227
    v_add_f32 v10, v10, v194
    v_add_f32 v11, v11, v195
    v_add_f32 v8, v8, v228
    v_add_f32 v9, v9, v229
    v_add_f32 v10, v10, v196
    v_add_f32 v11, v11, v197
    v_add_f32 v8, v8, v230
    v_add_f32 v9, v9, v231
    v_add_f32 v10, v10, v198
    v_add_f32 v11, v11, v199
    v_add_f32 v6, v8, v9
    v_add_f32 v7, v10, v11
    v_add_f32 v4, v8, v9
    s_setprio 0
    v_add_f32 v5, v10, v11
    v_permlane32_swap_b32 v4, v6
    s_nop 0
    v_permlane32_swap_b32 v5, v7
    v_add_f32 v4, v4, v6
    v_add_f32 v5, v5, v7
    v_rcp_f32 v4, v4
    v_rcp_f32 v5, v5
    v_mul_f32 v216, v216, v4
    v_mul_f32 v217, v217, v4
    v_mul_f32 v184, v184, v5
    v_mul_f32 v185, v185, v5
    v_mul_f32 v218, v218, v4
    v_mul_f32 v219, v219, v4
    v_mul_f32 v186, v186, v5
    v_mul_f32 v187, v187, v5
    v_mul_f32 v220, v220, v4
    v_mul_f32 v221, v221, v4
    v_mul_f32 v188, v188, v5
    v_mul_f32 v189, v189, v5
    v_mul_f32 v222, v222, v4
    v_mul_f32 v223, v223, v4
    v_mul_f32 v190, v190, v5
    v_mul_f32 v191, v191, v5
    v_mul_f32 v224, v224, v4
    v_mul_f32 v225, v225, v4
    v_mul_f32 v192, v192, v5
    v_mul_f32 v193, v193, v5
    v_mul_f32 v226, v226, v4
    v_mul_f32 v227, v227, v4
    v_mul_f32 v194, v194, v5
    v_mul_f32 v195, v195, v5
    v_mul_f32 v228, v228, v4
    v_mul_f32 v229, v229, v4
    v_mul_f32 v196, v196, v5
    v_mul_f32 v197, v197, v5
    v_mul_f32 v230, v230, v4
    v_mul_f32 v231, v231, v4
    v_mul_f32 v198, v198, v5
    v_mul_f32 v199, v199, v5
    v_cvt_pk_bf16_f32 v216, v216, v217
    v_cvt_pk_bf16_f32 v217, v218, v219
    v_cvt_pk_bf16_f32 v218, v220, v221
    v_cvt_pk_bf16_f32 v219, v222, v223
    v_cvt_pk_bf16_f32 v220, v224, v225
    v_cvt_pk_bf16_f32 v221, v226, v227
    v_cvt_pk_bf16_f32 v222, v228, v229
    v_cvt_pk_bf16_f32 v223, v230, v231
    ds_write_b128 v232, v[216:219]
    v_cvt_pk_bf16_f32 v224, v184, v185
    v_cvt_pk_bf16_f32 v225, v186, v187
    v_cvt_pk_bf16_f32 v226, v188, v189
    v_cvt_pk_bf16_f32 v227, v190, v191
    ds_write_b128 v232, v[220:223] offset:4096
    s_waitcnt vmcnt(18)
    s_waitcnt vmcnt(12)
    s_waitcnt vmcnt(10)
    s_waitcnt vmcnt(8)
    s_barrier
    ds_write_b128 v232, v[224:227] offset:8192
    v_cvt_pk_bf16_f32 v228, v192, v193
    v_cvt_pk_bf16_f32 v229, v194, v195
    v_cvt_pk_bf16_f32 v230, v196, v197
    v_cvt_pk_bf16_f32 v231, v198, v199
    s_xor_b32 s96, s95, 786432
    s_add_u32 s97, s96, s90
    s_sub_u32 s82, s97, 65536
    s_add_u32 m0, s83, 45056
    s_nop 0
    buffer_load_dwordx4 v26, s[44:47], s82 offen lds
    ds_write_b128 v232, v[228:231] offset:12288
    v_cvt_pk_bf16_f32 v200, 0, v200
    v_cvt_pk_bf16_f32 v201, 0, v201
    v_cvt_pk_bf16_f32 v202, 0, v202
    v_cvt_pk_bf16_f32 v203, 0, v203
    v_cvt_pk_bf16_f32 v204, 0, v204
    v_cvt_pk_bf16_f32 v205, 0, v205
    v_cvt_pk_bf16_f32 v206, 0, v206
    v_cvt_pk_bf16_f32 v207, 0, v207
    v_cvt_pk_bf16_f32 v208, 0, v208
    v_cvt_pk_bf16_f32 v209, 0, v209
    v_cvt_pk_bf16_f32 v210, 0, v210
    v_cvt_pk_bf16_f32 v211, 0, v211
    s_xor_b32 s96, s95, 786432
    s_add_u32 s82, s96, s90
    s_add_u32 m0, s83, 49152
    s_nop 0
    buffer_load_dwordx4 v26, s[44:47], s82 offen lds
    v_cvt_pk_bf16_f32 v212, 0, v212
    v_cvt_pk_bf16_f32 v213, 0, v213
    v_cvt_pk_bf16_f32 v214, 0, v214
    v_cvt_pk_bf16_f32 v215, 0, v215
    v_max3_f32 v4, v200, v201, v202
    v_min3_f32 v5, v200, v201, v202
    v_max3_f32 v4, v4, v203, v204
    v_min3_f32 v5, v5, v203, v204
    v_max3_f32 v4, v4, v205, v206
    v_min3_f32 v5, v5, v205, v206
    v_max3_f32 v4, v4, v207, v208
    v_min3_f32 v5, v5, v207, v208
    v_max3_f32 v4, v4, v209, v210
    v_min3_f32 v5, v5, v209, v210
    s_xor_b32 s96, s95, 917504
    s_add_u32 s97, s96, s90
    s_sub_u32 s82, s97, 65536
    s_add_u32 m0, s83, 53248
    s_nop 0
    buffer_load_dwordx4 v26, s[44:47], s82 offen lds
    v_max3_f32 v4, v4, v211, v212
    v_min3_f32 v5, v5, v211, v212
    v_max3_f32 v4, v4, v213, v214
    v_min3_f32 v5, v5, v213, v214
    v_max_f32 v6, v4, v215
    v_min_f32 v7, v5, v215
    v_max_f32 v4, v4, v215
    s_waitcnt lgkmcnt(0)
    v_min_f32 v5, v5, v215
    v_permlane32_swap_b32 v4, v6
    s_nop 0
    v_permlane32_swap_b32 v5, v7
    v_max_f32 v4, v4, v6
    v_min_f32 v5, v5, v7
    v_mul_f32_e64 v4, v4, s7
    s_xor_b32 s96, s95, 917504
    s_add_u32 s82, s96, s90
    s_add_u32 m0, s83, 57344
    s_nop 0
    buffer_load_dwordx4 v26, s[44:47], s82 offen lds
    v_mul_f32_e64 v5, v5, s7
    v_fma_f32 v216, v200, s7, -v4
    v_fma_f32 v217, v201, s7, -v4
    v_fma_f32 v200, -v200, s7, v5
    v_fma_f32 v201, -v201, s7, v5
    v_fma_f32 v218, v202, s7, -v4
    v_fma_f32 v219, v203, s7, -v4
    v_fma_f32 v202, -v202, s7, v5
    v_fma_f32 v203, -v203, s7, v5
    v_fma_f32 v220, v204, s7, -v4
    v_fma_f32 v221, v205, s7, -v4
    v_fma_f32 v204, -v204, s7, v5
    v_fma_f32 v205, -v205, s7, v5
    v_fma_f32 v222, v206, s7, -v4
    s_xor_b32 s96, s95, 1048576
    s_add_u32 s97, s96, s90
    s_sub_u32 s82, s97, 65536
    s_add_u32 m0, s83, 61440
    s_nop 0
    buffer_load_dwordx4 v26, s[44:47], s82 offen lds
    v_fma_f32 v223, v207, s7, -v4
    v_fma_f32 v206, -v206, s7, v5
    v_fma_f32 v207, -v207, s7, v5
    v_fma_f32 v224, v208, s7, -v4
    v_fma_f32 v225, v209, s7, -v4
    v_fma_f32 v208, -v208, s7, v5
    v_fma_f32 v209, -v209, s7, v5
    v_fma_f32 v226, v210, s7, -v4
    v_fma_f32 v227, v211, s7, -v4
    v_fma_f32 v210, -v210, s7, v5
    v_fma_f32 v211, -v211, s7, v5
    v_fma_f32 v228, v212, s7, -v4
    v_fma_f32 v229, v213, s7, -v4
    v_fma_f32 v212, -v212, s7, v5
    s_xor_b32 s96, s95, 1048576
    s_add_u32 s82, s96, s90
    s_add_u32 m0, s83, 65536
    s_nop 0
    buffer_load_dwordx4 v26, s[44:47], s82 offen lds
    v_fma_f32 v213, -v213, s7, v5
    v_fma_f32 v230, v214, s7, -v4
    v_fma_f32 v231, v215, s7, -v4
L_PAD6:
    s_cbranch_execz L_RET6
    v_fma_f32 v214, -v214, s7, v5
    v_fma_f32 v215, -v215, s7, v5
    v_exp_f32 v216, v216
    v_exp_f32 v200, v200
    v_exp_f32 v217, v217
    v_exp_f32 v201, v201
    v_exp_f32 v218, v218
    v_exp_f32 v202, v202
    v_exp_f32 v219, v219
    v_exp_f32 v203, v203
    v_exp_f32 v220, v220
    s_xor_b32 s96, s95, 1179648
    s_add_u32 s97, s96, s90
    s_sub_u32 s82, s97, 65536
    s_add_u32 m0, s83, 69632
    s_nop 0
    buffer_load_dwordx4 v26, s[44:47], s82 offen lds
    v_exp_f32 v204, v204
    v_exp_f32 v221, v221
    v_exp_f32 v205, v205
    v_exp_f32 v222, v222
    v_exp_f32 v206, v206
    v_exp_f32 v223, v223
    v_exp_f32 v207, v207
    v_exp_f32 v224, v224
    v_exp_f32 v208, v208
    v_exp_f32 v225, v225
    v_exp_f32 v209, v209
    v_exp_f32 v226, v226
    v_exp_f32 v210, v210
    v_exp_f32 v227, v227
    s_xor_b32 s96, s95, 1179648
    s_add_u32 s82, s96, s90
    s_add_u32 m0, s83, 73728
    s_nop 0
    buffer_load_dwordx4 v26, s[44:47], s82 offen lds
    v_exp_f32 v211, v211
    v_exp_f32 v228, v228
    v_exp_f32 v212, v212
    v_exp_f32 v229, v229
    v_exp_f32 v213, v213
    v_exp_f32 v230, v230
    v_exp_f32 v214, v214
    v_exp_f32 v231, v231
    v_exp_f32 v215, v215
    v_add_f32 v8, v216, v218
    v_add_f32 v9, v217, v219
    v_add_f32 v10, v200, v202
    v_add_f32 v11, v201, v203
    v_add_f32 v8, v8, v220
    v_add_f32 v9, v9, v221
    v_add_f32 v10, v10, v204
    v_add_f32 v11, v11, v205
    v_add_f32 v8, v8, v222
    v_add_f32 v9, v9, v223
    v_add_f32 v10, v10, v206
    v_add_f32 v11, v11, v207
    v_add_f32 v8, v8, v224
    v_add_f32 v9, v9, v225
    v_add_f32 v10, v10, v208
    v_add_f32 v11, v11, v209
    v_add_f32 v8, v8, v226
    v_add_f32 v9, v9, v227
    v_add_f32 v10, v10, v210
    v_add_f32 v11, v11, v211
    v_add_f32 v8, v8, v228
    v_add_f32 v9, v9, v229
    v_add_f32 v10, v10, v212
    v_add_f32 v11, v11, v213
    v_add_f32 v8, v8, v230
    v_add_f32 v9, v9, v231
    v_add_f32 v10, v10, v214
    v_add_f32 v11, v11, v215
    v_add_f32 v6, v8, v9
    v_add_f32 v7, v10, v11
    v_add_f32 v4, v8, v9
    v_add_f32 v5, v10, v11
    s_nop 0
    v_permlane32_swap_b32 v4, v6
    v_permlane32_swap_b32 v5, v7
    v_add_f32 v4, v4, v6
    v_add_f32 v5, v5, v7
    v_rcp_f32 v4, v4
    v_rcp_f32 v5, v5
    v_mul_f32 v216, v216, v4
    v_mul_f32 v217, v217, v4
    v_mul_f32 v200, v200, v5
    v_mul_f32 v201, v201, v5
    v_mul_f32 v218, v218, v4
    v_mul_f32 v219, v219, v4
    v_mul_f32 v202, v202, v5
    v_mul_f32 v203, v203, v5
    v_mul_f32 v220, v220, v4
    v_mul_f32 v221, v221, v4
    v_mul_f32 v204, v204, v5
    v_mul_f32 v205, v205, v5
    v_mul_f32 v222, v222, v4
    v_mul_f32 v223, v223, v4
    v_mul_f32 v206, v206, v5
    v_mul_f32 v207, v207, v5
    v_mul_f32 v224, v224, v4
    v_mul_f32 v225, v225, v4
    v_mul_f32 v208, v208, v5
    v_mul_f32 v209, v209, v5
    v_mul_f32 v226, v226, v4
    v_mul_f32 v227, v227, v4
    v_mul_f32 v210, v210, v5
    v_mul_f32 v211, v211, v5
    v_mul_f32 v228, v228, v4
    v_mul_f32 v229, v229, v4
    v_mul_f32 v212, v212, v5
    v_mul_f32 v213, v213, v5
    v_mul_f32 v230, v230, v4
    v_mul_f32 v231, v231, v4
    v_mul_f32 v214, v214, v5
    v_mul_f32 v215, v215, v5
    v_cvt_pk_bf16_f32 v216, v216, v217
    v_cvt_pk_bf16_f32 v217, v218, v219
    v_cvt_pk_bf16_f32 v218, v220, v221
    v_cvt_pk_bf16_f32 v219, v222, v223
    v_cvt_pk_bf16_f32 v220, v224, v225
    v_cvt_pk_bf16_f32 v221, v226, v227
    v_cvt_pk_bf16_f32 v222, v228, v229
    v_cvt_pk_bf16_f32 v223, v230, v231
    ds_write_b128 v232, v[216:219] offset:16384
    v_cvt_pk_bf16_f32 v224, v200, v201
    v_cvt_pk_bf16_f32 v225, v202, v203
    v_cvt_pk_bf16_f32 v226, v204, v205
    v_cvt_pk_bf16_f32 v227, v206, v207
    ds_write_b128 v232, v[220:223] offset:20480
    ds_write_b128 v232, v[224:227] offset:24576
    v_cvt_pk_bf16_f32 v228, v208, v209
    v_cvt_pk_bf16_f32 v229, v210, v211
    v_cvt_pk_bf16_f32 v230, v212, v213
    v_cvt_pk_bf16_f32 v231, v214, v215
    ds_write_b128 v232, v[228:231] offset:28672
    s_lshl_b32 s96, s77, 11
    s_add_u32 s14, s96, 151552
    v_add_u32 v0, s14, v2
    s_setprio 0
L_JOIN:
    v_and_b32 v45, 1, v1
    v_lshlrev_b32 v45, 3, v45
    v_bfe_u32 v9, v1, 2, 2
    v_lshl_add_u32 v45, v9, 4, v45
    v_bfe_u32 v9, v1, 4, 1
    v_lshl_add_u32 v45, v9, 6, v45
    v_bfe_u32 v9, v1, 1, 1
    v_lshl_add_u32 v45, v9, 7, v45
    v_lshrrev_b32 v9, 5, v1
    v_lshl_add_u32 v45, v9, 8, v45
    s_lshl_b32 s13, s3, 12
    v_add_u32 v44, s13, v45
    s_lshl_b32 s96, s76, 13
    s_add_u32 s13, s96, 32768
    v_add_u32 v45, s13, v45
    v_mov_b32 v244, 0x3f803f80
    v_mov_b32 v245, 0x3f803f80
    v_mov_b32 v246, 0x3f803f80
    v_mov_b32 v247, 0x3f803f80
    s_lshl3_add_u32 s96, s11, s3
    s_lshl_b32 s97, s96, 5
    s_add_u32 s98, s97, s10
    s_lshl_b32 s99, s98, 10
    s_add_u32 s13, s99, 25165824
    s_add_u32 s15, s13, 16384
    s_lshl3_add_u32 s96, s11, s3
    s_lshl_b32 s97, s96, 10
    s_add_u32 s16, s97, 21495808
    s_lshl_b32 s96, s10, 6
    s_add_u32 s14, s96, s16
    s_waitcnt lgkmcnt(0)
    s_barrier
    ds_read_b64_tr_b16 v[184:185], v44
    ds_read_b64_tr_b16 v[186:187], v44 offset:512
    ds_read_b64_tr_b16 v[200:201], v45
    ds_read_b64_tr_b16 v[202:203], v45 offset:512
    ds_read_b64_tr_b16 v[204:205], v45 offset:1024
    ds_read_b64_tr_b16 v[206:207], v45 offset:1536
    ds_read_b64_tr_b16 v[188:189], v44 offset:1024
    ds_read_b64_tr_b16 v[190:191], v44 offset:1536
    ds_read_b64_tr_b16 v[208:209], v45 offset:2048
    ds_read_b64_tr_b16 v[210:211], v45 offset:2560
    ds_read_b64_tr_b16 v[212:213], v45 offset:3072
    ds_read_b64_tr_b16 v[214:215], v45 offset:3584
    ds_read_b64_tr_b16 v[192:193], v44 offset:2048
    ds_read_b64_tr_b16 v[194:195], v44 offset:2560
    ds_read_b64_tr_b16 v[216:217], v45 offset:4096
    ds_read_b64_tr_b16 v[218:219], v45 offset:4608
    ds_read_b64_tr_b16 v[220:221], v45 offset:5120
    ds_read_b64_tr_b16 v[222:223], v45 offset:5632
    s_waitcnt lgkmcnt(12)
    v_mfma_f32_16x16x32_bf16 v[232:235], v[184:187], v[200:203], 0
    v_mfma_f32_16x16x32_bf16 v[236:239], v[184:187], v[204:207], 0
    v_mfma_f32_16x16x32_bf16 v[240:243], v[184:187], v[244:247], 0
    ds_read_b64_tr_b16 v[196:197], v44 offset:3072
    ds_read_b64_tr_b16 v[198:199], v44 offset:3584
    ds_read_b64_tr_b16 v[224:225], v45 offset:6144
    ds_read_b64_tr_b16 v[226:227], v45 offset:6656
    ds_read_b64_tr_b16 v[228:229], v45 offset:7168
    ds_read_b64_tr_b16 v[230:231], v45 offset:7680
    s_waitcnt lgkmcnt(12)
    v_mfma_f32_16x16x32_bf16 v[232:235], v[188:191], v[208:211], v[232:235]
    v_mfma_f32_16x16x32_bf16 v[236:239], v[188:191], v[212:215], v[236:239]
    v_mfma_f32_16x16x32_bf16 v[240:243], v[188:191], v[244:247], v[240:243]
    s_waitcnt lgkmcnt(6)
    v_mfma_f32_16x16x32_bf16 v[232:235], v[192:195], v[216:219], v[232:235]
    v_mfma_f32_16x16x32_bf16 v[236:239], v[192:195], v[220:223], v[236:239]
    v_mfma_f32_16x16x32_bf16 v[240:243], v[192:195], v[244:247], v[240:243]
    s_waitcnt lgkmcnt(0)
    v_mfma_f32_16x16x32_bf16 v[232:235], v[196:199], v[224:227], v[232:235]
    v_mfma_f32_16x16x32_bf16 v[236:239], v[196:199], v[228:231], v[236:239]
    v_mfma_f32_16x16x32_bf16 v[240:243], v[196:199], v[244:247], v[240:243]
    s_cmp_lt_u32 s3, 4
    s_cbranch_scc1 L_NOQX
    ds_read_b128 v[168:171], v0
    ds_read_b128 v[172:175], v0 offset:1024
L_NOQX:
    s_nop 3
    buffer_store_dwordx4 v[232:235], v2, s[32:35], s13 offen sc1
    buffer_store_dwordx4 v[236:239], v2, s[32:35], s15 offen sc1
    s_mov_b32 exec_lo, 0x00010001
    s_mov_b32 exec_hi, 0x00010001
    buffer_store_dwordx4 v[240:243], v1, s[32:35], s14 offen sc1
    s_mov_b64 exec, -1
    s_waitcnt lgkmcnt(0)
    v_mfma_f32_32x32x16_bf16 v[120:135], v[176:179], v[168:171], 0
    v_mfma_f32_32x32x16_bf16 v[120:135], v[180:183], v[172:175], v[120:135]
    v_and_b32 v46, 7, v1
    v_lshlrev_b32 v46, 17, v46
    v_bfe_u32 v9, v1, 3, 1
    v_lshl_add_u32 v46, v9, 14, v46
    s_and_b32 s96, s10, 1
    s_and_b32 s97, s2, 27
    s_lshl_b32 s98, s97, 12
    s_lshr_b32 s99, s10, 1
    s_lshl_b32 s97, s99, 6
    s_add_u32 s99, s98, s97
    s_lshl2_add_u32 s98, s96, s99
    s_add_u32 s97, s98, 1048576
    s_add_u32 s17, s97, 512
    v_lshrrev_b32 v47, 3, v1
    v_lshlrev_b32 v47, 10, v47
    v_and_b32 v9, 7, v1
    v_lshl_add_u32 v47, v9, 4, v47
    v_and_b32 v48, 7, v1
    v_lshlrev_b32 v48, 4, v48
    v_lshrrev_b32 v9, 5, v1
    v_lshl_add_u32 v48, v9, 3, v48
    v_cvt_pk_bf16_f32 v120, 0, v120
    v_cvt_pk_bf16_f32 v121, 0, v121
    v_cvt_pk_bf16_f32 v122, 0, v122
    v_cvt_pk_bf16_f32 v123, 0, v123
    v_cvt_pk_bf16_f32 v124, 0, v124
    v_cvt_pk_bf16_f32 v125, 0, v125
    v_cvt_pk_bf16_f32 v126, 0, v126
    v_cvt_pk_bf16_f32 v127, 0, v127
    v_cvt_pk_bf16_f32 v128, 0, v128
    v_cvt_pk_bf16_f32 v129, 0, v129
    v_cvt_pk_bf16_f32 v130, 0, v130
    v_cvt_pk_bf16_f32 v131, 0, v131
    v_cvt_pk_bf16_f32 v132, 0, v132
    v_cvt_pk_bf16_f32 v133, 0, v133
    v_cvt_pk_bf16_f32 v134, 0, v134
    v_cvt_pk_bf16_f32 v135, 0, v135
    v_max3_f32 v4, v120, v121, v122
    v_min3_f32 v5, v120, v121, v122
    v_max3_f32 v4, v4, v123, v124
    v_min3_f32 v5, v5, v123, v124
    v_max3_f32 v4, v4, v125, v126
    v_min3_f32 v5, v5, v125, v126
    v_max3_f32 v4, v4, v127, v128
    v_min3_f32 v5, v5, v127, v128
    v_max3_f32 v4, v4, v129, v130
    v_min3_f32 v5, v5, v129, v130
    v_max3_f32 v4, v4, v131, v132
    v_min3_f32 v5, v5, v131, v132
    v_max3_f32 v4, v4, v133, v134
    v_min3_f32 v5, v5, v133, v134
    v_max_f32 v6, v4, v135
    v_min_f32 v7, v5, v135
    v_max_f32 v4, v4, v135
    v_min_f32 v5, v5, v135
    s_nop 0
    v_permlane32_swap_b32 v4, v6
    v_permlane32_swap_b32 v5, v7
    v_max_f32 v4, v4, v6
    v_min_f32 v5, v5, v7
    v_pk_mul_f32 v[4:5], v[4:5], s[6:7] op_sel:[0,1]
    v_mov_b32 v6, v5
    v_pk_fma_f32 v[136:137], v[120:121], s[6:7], v[4:5] op_sel:[0,1,0] op_sel_hi:[1,1,0] neg_lo:[0,0,1] neg_hi:[0,0,1]
    v_pk_fma_f32 v[120:121], v[120:121], s[6:7], v[6:7] op_sel:[0,1,0] op_sel_hi:[1,1,0] neg_lo:[1,0,0] neg_hi:[1,0,0]
    v_pk_fma_f32 v[138:139], v[122:123], s[6:7], v[4:5] op_sel:[0,1,0] op_sel_hi:[1,1,0] neg_lo:[0,0,1] neg_hi:[0,0,1]
    v_pk_fma_f32 v[122:123], v[122:123], s[6:7], v[6:7] op_sel:[0,1,0] op_sel_hi:[1,1,0] neg_lo:[1,0,0] neg_hi:[1,0,0]
    v_pk_fma_f32 v[140:141], v[124:125], s[6:7], v[4:5] op_sel:[0,1,0] op_sel_hi:[1,1,0] neg_lo:[0,0,1] neg_hi:[0,0,1]
    v_pk_fma_f32 v[124:125], v[124:125], s[6:7], v[6:7] op_sel:[0,1,0] op_sel_hi:[1,1,0] neg_lo:[1,0,0] neg_hi:[1,0,0]
    v_pk_fma_f32 v[142:143], v[126:127], s[6:7], v[4:5] op_sel:[0,1,0] op_sel_hi:[1,1,0] neg_lo:[0,0,1] neg_hi:[0,0,1]
    v_pk_fma_f32 v[126:127], v[126:127], s[6:7], v[6:7] op_sel:[0,1,0] op_sel_hi:[1,1,0] neg_lo:[1,0,0] neg_hi:[1,0,0]
    v_pk_fma_f32 v[144:145], v[128:129], s[6:7], v[4:5] op_sel:[0,1,0] op_sel_hi:[1,1,0] neg_lo:[0,0,1] neg_hi:[0,0,1]
    v_pk_fma_f32 v[128:129], v[128:129], s[6:7], v[6:7] op_sel:[0,1,0] op_sel_hi:[1,1,0] neg_lo:[1,0,0] neg_hi:[1,0,0]
    v_pk_fma_f32 v[146:147], v[130:131], s[6:7], v[4:5] op_sel:[0,1,0] op_sel_hi:[1,1,0] neg_lo:[0,0,1] neg_hi:[0,0,1]
    v_pk_fma_f32 v[130:131], v[130:131], s[6:7], v[6:7] op_sel:[0,1,0] op_sel_hi:[1,1,0] neg_lo:[1,0,0] neg_hi:[1,0,0]
    v_pk_fma_f32 v[148:149], v[132:133], s[6:7], v[4:5] op_sel:[0,1,0] op_sel_hi:[1,1,0] neg_lo:[0,0,1] neg_hi:[0,0,1]
    v_pk_fma_f32 v[132:133], v[132:133], s[6:7], v[6:7] op_sel:[0,1,0] op_sel_hi:[1,1,0] neg_lo:[1,0,0] neg_hi:[1,0,0]
    v_pk_fma_f32 v[150:151], v[134:135], s[6:7], v[4:5] op_sel:[0,1,0] op_sel_hi:[1,1,0] neg_lo:[0,0,1] neg_hi:[0,0,1]
    v_pk_fma_f32 v[134:135], v[134:135], s[6:7], v[6:7] op_sel:[0,1,0] op_sel_hi:[1,1,0] neg_lo:[1,0,0] neg_hi:[1,0,0]
    v_exp_f32 v136, v136
    v_exp_f32 v120, v120
    v_exp_f32 v137, v137
    v_exp_f32 v121, v121
    v_exp_f32 v138, v138
    v_exp_f32 v122, v122
    v_exp_f32 v139, v139
    v_exp_f32 v123, v123
    v_exp_f32 v140, v140
    v_exp_f32 v124, v124
    v_exp_f32 v141, v141
    v_exp_f32 v125, v125
    v_exp_f32 v142, v142
    v_exp_f32 v126, v126
    v_exp_f32 v143, v143
    v_exp_f32 v127, v127
    s_waitcnt vmcnt(0)
    s_barrier
    s_cmp_lg_u32 s3, 0
    s_cbranch_scc1 L_PC
    v_mov_b32 v45, s4
    s_mov_b32 exec_hi, 0
    s_mov_b32 exec_lo, 65535
    buffer_store_dword v45, v46, s[32:35], s17 offen sc1
    s_mov_b64 exec, -1
L_PC:
    s_xor_b32 s96, s95, 1310720
    s_add_u32 s82, s96, s90
    s_add_u32 m0, s83, 81920
    s_nop 0
    buffer_load_dwordx4 v26, s[44:47], s82 offen lds
    v_exp_f32 v144, v144
    v_exp_f32 v128, v128
    v_exp_f32 v145, v145
    v_exp_f32 v129, v129
    s_xor_b32 s96, s95, 1441792
    s_add_u32 s82, s96, s90
    s_add_u32 m0, s83, 90112
    s_nop 0
    buffer_load_dwordx4 v26, s[44:47], s82 offen lds
    v_exp_f32 v146, v146
    v_exp_f32 v130, v130
    v_exp_f32 v147, v147
    v_exp_f32 v131, v131
    s_xor_b32 s96, s95, 1572864
    s_add_u32 s82, s96, s90
    s_add_u32 m0, s83, 98304
    s_nop 0
    buffer_load_dwordx4 v26, s[44:47], s82 offen lds
    v_exp_f32 v148, v148
    v_exp_f32 v132, v132
    v_exp_f32 v149, v149
    v_exp_f32 v133, v133
    s_xor_b32 s96, s95, 1703936
    s_add_u32 s82, s96, s90
    s_add_u32 m0, s83, 106496
    s_nop 0
    buffer_load_dwordx4 v26, s[44:47], s82 offen lds
    v_exp_f32 v150, v150
    v_exp_f32 v134, v134
    v_exp_f32 v151, v151
    v_exp_f32 v135, v135
    s_lshl4_add_u32 s96, s11, s10
    s_lshl_b32 s97, s96, 14
    s_lshl_b32 s98, s3, 7
    s_add_u32 s99, s97, s98
    s_add_u32 s13, s99, 25165824
    s_add_u32 s14, s13, 8192
    s_lshl4_add_u32 s96, s11, s10
    s_lshl_b32 s97, s96, 10
    s_lshl_b32 s98, s3, 7
    s_add_u32 s99, s97, s98
    s_add_u32 s15, s99, 29360128
    s_add_u32 s17, s17, 3072
    s_load_dwordx2 s[24:25], s[32:33], s92 offset:512 glc
    s_xor_b32 s96, s95, 1835008
    s_add_u32 s82, s96, s90
    s_add_u32 m0, s83, 114688
    s_nop 0
    buffer_load_dwordx4 v26, s[44:47], s82 offen lds
    v_pk_add_f32 v[8:9], v[136:137], v[138:139]
    v_pk_add_f32 v[10:11], v[120:121], v[122:123]
    v_pk_add_f32 v[8:9], v[8:9], v[140:141]
    v_pk_add_f32 v[10:11], v[10:11], v[124:125]
    v_pk_add_f32 v[8:9], v[8:9], v[142:143]
    v_pk_add_f32 v[10:11], v[10:11], v[126:127]
    v_pk_add_f32 v[8:9], v[8:9], v[144:145]
    v_pk_add_f32 v[10:11], v[10:11], v[128:129]
    v_pk_add_f32 v[8:9], v[8:9], v[146:147]
    v_pk_add_f32 v[10:11], v[10:11], v[130:131]
    v_pk_add_f32 v[8:9], v[8:9], v[148:149]
    v_pk_add_f32 v[10:11], v[10:11], v[132:133]
    v_pk_add_f32 v[8:9], v[8:9], v[150:151]
    v_pk_add_f32 v[10:11], v[10:11], v[134:135]
    s_xor_b32 s96, s95, 1966080
    s_add_u32 s82, s96, s90
    s_add_u32 m0, s83, 122880
    s_nop 0
    buffer_load_dwordx4 v26, s[44:47], s82 offen lds
    v_add_f32 v6, v8, v9
    v_add_f32 v7, v10, v11
    v_add_f32 v4, v8, v9
    v_add_f32 v5, v10, v11
    s_nop 0
    v_permlane32_swap_b32 v4, v6
    v_permlane32_swap_b32 v5, v7
    v_pk_add_f32 v[4:5], v[4:5], v[6:7]
    v_rcp_f32 v4, v4
    v_rcp_f32 v5, v5
    s_nop 0
    v_pk_mul_f32 v[136:137], v[136:137], v[4:5] op_sel_hi:[1,0]
    v_pk_mul_f32 v[120:121], v[4:5], v[120:121] op_sel:[1,0]
    v_pk_mul_f32 v[138:139], v[138:139], v[4:5] op_sel_hi:[1,0]
    v_pk_mul_f32 v[122:123], v[4:5], v[122:123] op_sel:[1,0]
    v_pk_mul_f32 v[140:141], v[140:141], v[4:5] op_sel_hi:[1,0]
    s_add_u32 s82, s95, s90
    s_mov_b32 m0, s83
    s_nop 0
    buffer_load_dwordx4 v26, s[44:47], s82 offen lds
    v_pk_mul_f32 v[124:125], v[4:5], v[124:125] op_sel:[1,0]
    v_pk_mul_f32 v[142:143], v[142:143], v[4:5] op_sel_hi:[1,0]
    v_pk_mul_f32 v[126:127], v[4:5], v[126:127] op_sel:[1,0]
    v_pk_mul_f32 v[144:145], v[144:145], v[4:5] op_sel_hi:[1,0]
    v_pk_mul_f32 v[128:129], v[4:5], v[128:129] op_sel:[1,0]
    v_pk_mul_f32 v[146:147], v[146:147], v[4:5] op_sel_hi:[1,0]
    v_pk_mul_f32 v[130:131], v[4:5], v[130:131] op_sel:[1,0]
    v_pk_mul_f32 v[148:149], v[148:149], v[4:5] op_sel_hi:[1,0]
    v_pk_mul_f32 v[132:133], v[4:5], v[132:133] op_sel:[1,0]
    v_pk_mul_f32 v[150:151], v[150:151], v[4:5] op_sel_hi:[1,0]
    v_pk_mul_f32 v[134:135], v[4:5], v[134:135] op_sel:[1,0]
    v_cvt_pk_bf16_f32 v152, v136, v137
    v_cvt_pk_bf16_f32 v153, v138, v139
    v_cvt_pk_bf16_f32 v154, v140, v141
    s_xor_b32 s96, s95, 131072
    s_add_u32 s82, s96, s90
    s_add_u32 m0, s83, 8192
    s_nop 0
    buffer_load_dwordx4 v26, s[44:47], s82 offen lds
    v_cvt_pk_bf16_f32 v155, v142, v143
    v_cvt_pk_bf16_f32 v156, v144, v145
    v_cvt_pk_bf16_f32 v157, v146, v147
    v_cvt_pk_bf16_f32 v158, v148, v149
    v_cvt_pk_bf16_f32 v159, v150, v151
    v_cvt_pk_bf16_f32 v160, v120, v121
    v_cvt_pk_bf16_f32 v161, v122, v123
    v_cvt_pk_bf16_f32 v162, v124, v125
    v_cvt_pk_bf16_f32 v163, v126, v127
    v_cvt_pk_bf16_f32 v164, v128, v129
    v_cvt_pk_bf16_f32 v165, v130, v131
    v_cvt_pk_bf16_f32 v166, v132, v133
    v_cvt_pk_bf16_f32 v167, v134, v135
    s_branch SCHK_20
SPOLL_19:
    s_load_dwordx2 s[24:25], s[32:33], s92 offset:512 glc
SCHK_20:
    s_add_u32 s5, s5, 1
    s_cmp_ge_u32 s5, 200000
    s_waitcnt lgkmcnt(0)
    s_cbranch_scc1 SDONE_21
    s_cmp_lg_u32 s24, s4
    s_cbranch_scc1 SPOLL_19
    s_cmp_lg_u32 s25, s4
    s_cbranch_scc1 SPOLL_19
SDONE_21:
    s_barrier
    buffer_load_dwordx4 v[184:187], v47, s[32:35], s13 offen sc1
    buffer_load_dwordx4 v[188:191], v47, s[32:35], s14 offen sc1
    buffer_load_dwordx4 v[192:195], v2, s[32:35], s16 offen sc1
    s_lshl_b32 s96, s3, 5
    s_add_u32 s14, s96, 155648
    v_and_b32 v6, 3, v1
    v_lshl_add_u32 v6, v6, 3, s14
    v_lshrrev_b32 v9, 5, v1
    v_lshl_add_u32 v6, v9, 2, v6
    s_lshl_b32 s96, s3, 10
    s_add_u32 s14, s96, 147456
    v_and_b32 v5, 15, v1
    v_lshl_add_u32 v5, v5, 4, s14
    v_lshrrev_b32 v9, 5, v1
    v_lshl_add_u32 v5, v9, 9, v5
    v_bfe_u32 v9, v1, 4, 1
    v_lshl_add_u32 v5, v9, 3, v5
    s_lshl_b32 s96, s76, 7
    s_add_u32 s14, s96, 155648
    v_lshrrev_b32 v7, 5, v1
    v_lshl_add_u32 v7, v7, 4, s14
    s_lshl_b32 s96, s76, 12
    s_add_u32 s14, s96, 147456
    v_add_u32 v44, s14, v2
    s_cmp_lt_u32 s3, 4
    s_cbranch_scc1 L_HG1
    v_lshlrev_b32 v52, 16, v88
    v_and_b32 v53, s6, v88
    v_pk_mul_f32 v[196:197], v[36:37], v[52:53] op_sel:[0,0] op_sel_hi:[0,1]
    v_lshlrev_b32 v54, 16, v89
    v_and_b32 v55, s6, v89
    v_pk_mul_f32 v[198:199], v[36:37], v[54:55] op_sel:[0,0] op_sel_hi:[0,1]
    v_lshlrev_b32 v52, 16, v90
    v_and_b32 v53, s6, v90
    v_pk_mul_f32 v[200:201], v[36:37], v[52:53] op_sel:[0,0] op_sel_hi:[0,1]
    v_lshlrev_b32 v54, 16, v91
    v_and_b32 v55, s6, v91
    v_pk_mul_f32 v[202:203], v[36:37], v[54:55] op_sel:[0,0] op_sel_hi:[0,1]
    v_lshlrev_b32 v52, 16, v92
    v_and_b32 v53, s6, v92
    v_pk_fma_f32 v[196:197], v[36:37], v[52:53], v[196:197] op_sel:[1,0,0] op_sel_hi:[1,1,1]
    v_lshlrev_b32 v54, 16, v93
    v_and_b32 v55, s6, v93
    v_pk_fma_f32 v[198:199], v[36:37], v[54:55], v[198:199] op_sel:[1,0,0] op_sel_hi:[1,1,1]
    v_lshlrev_b32 v52, 16, v94
    v_and_b32 v53, s6, v94
    v_pk_fma_f32 v[200:201], v[36:37], v[52:53], v[200:201] op_sel:[1,0,0] op_sel_hi:[1,1,1]
    v_lshlrev_b32 v54, 16, v95
    v_and_b32 v55, s6, v95
    v_pk_fma_f32 v[202:203], v[36:37], v[54:55], v[202:203] op_sel:[1,0,0] op_sel_hi:[1,1,1]
    v_lshlrev_b32 v52, 16, v96
    v_and_b32 v53, s6, v96
    v_pk_fma_f32 v[196:197], v[38:39], v[52:53], v[196:197] op_sel:[0,0,0] op_sel_hi:[0,1,1]
    v_lshlrev_b32 v54, 16, v97
    v_and_b32 v55, s6, v97
    v_pk_fma_f32 v[198:199], v[38:39], v[54:55], v[198:199] op_sel:[0,0,0] op_sel_hi:[0,1,1]
    v_lshlrev_b32 v52, 16, v98
    v_and_b32 v53, s6, v98
    v_pk_fma_f32 v[200:201], v[38:39], v[52:53], v[200:201] op_sel:[0,0,0] op_sel_hi:[0,1,1]
    v_lshlrev_b32 v54, 16, v99
    v_and_b32 v55, s6, v99
    v_pk_fma_f32 v[202:203], v[38:39], v[54:55], v[202:203] op_sel:[0,0,0] op_sel_hi:[0,1,1]
    v_lshlrev_b32 v52, 16, v100
    v_and_b32 v53, s6, v100
    v_pk_fma_f32 v[196:197], v[38:39], v[52:53], v[196:197] op_sel:[1,0,0] op_sel_hi:[1,1,1]
    v_lshlrev_b32 v54, 16, v101
    v_and_b32 v55, s6, v101
    v_pk_fma_f32 v[198:199], v[38:39], v[54:55], v[198:199] op_sel:[1,0,0] op_sel_hi:[1,1,1]
    v_lshlrev_b32 v52, 16, v102
    v_and_b32 v53, s6, v102
    v_pk_fma_f32 v[200:201], v[38:39], v[52:53], v[200:201] op_sel:[1,0,0] op_sel_hi:[1,1,1]
    v_lshlrev_b32 v54, 16, v103
    v_and_b32 v55, s6, v103
    v_pk_fma_f32 v[202:203], v[38:39], v[54:55], v[202:203] op_sel:[1,0,0] op_sel_hi:[1,1,1]
    v_lshlrev_b32 v52, 16, v104
    v_and_b32 v53, s6, v104
    v_pk_fma_f32 v[196:197], v[40:41], v[52:53], v[196:197] op_sel:[0,0,0] op_sel_hi:[0,1,1]
    v_lshlrev_b32 v54, 16, v105
    v_and_b32 v55, s6, v105
    v_pk_fma_f32 v[198:199], v[40:41], v[54:55], v[198:199] op_sel:[0,0,0] op_sel_hi:[0,1,1]
    v_lshlrev_b32 v52, 16, v106
    v_and_b32 v53, s6, v106
    v_pk_fma_f32 v[200:201], v[40:41], v[52:53], v[200:201] op_sel:[0,0,0] op_sel_hi:[0,1,1]
    v_lshlrev_b32 v54, 16, v107
    v_and_b32 v55, s6, v107
    v_pk_fma_f32 v[202:203], v[40:41], v[54:55], v[202:203] op_sel:[0,0,0] op_sel_hi:[0,1,1]
    v_lshlrev_b32 v52, 16, v108
    v_and_b32 v53, s6, v108
    v_pk_fma_f32 v[196:197], v[40:41], v[52:53], v[196:197] op_sel:[1,0,0] op_sel_hi:[1,1,1]
    v_lshlrev_b32 v54, 16, v109
    v_and_b32 v55, s6, v109
    v_pk_fma_f32 v[198:199], v[40:41], v[54:55], v[198:199] op_sel:[1,0,0] op_sel_hi:[1,1,1]
    v_lshlrev_b32 v52, 16, v110
    v_and_b32 v53, s6, v110
    v_pk_fma_f32 v[200:201], v[40:41], v[52:53], v[200:201] op_sel:[1,0,0] op_sel_hi:[1,1,1]
    v_lshlrev_b32 v54, 16, v111
    v_and_b32 v55, s6, v111
    v_pk_fma_f32 v[202:203], v[40:41], v[54:55], v[202:203] op_sel:[1,0,0] op_sel_hi:[1,1,1]
    v_lshlrev_b32 v52, 16, v112
    v_and_b32 v53, s6, v112
    v_pk_fma_f32 v[196:197], v[42:43], v[52:53], v[196:197] op_sel:[0,0,0] op_sel_hi:[0,1,1]
    v_lshlrev_b32 v54, 16, v113
    v_and_b32 v55, s6, v113
    v_pk_fma_f32 v[198:199], v[42:43], v[54:55], v[198:199] op_sel:[0,0,0] op_sel_hi:[0,1,1]
    v_lshlrev_b32 v52, 16, v114
    v_and_b32 v53, s6, v114
    v_pk_fma_f32 v[200:201], v[42:43], v[52:53], v[200:201] op_sel:[0,0,0] op_sel_hi:[0,1,1]
    v_lshlrev_b32 v54, 16, v115
    v_and_b32 v55, s6, v115
    v_pk_fma_f32 v[202:203], v[42:43], v[54:55], v[202:203] op_sel:[0,0,0] op_sel_hi:[0,1,1]
    v_lshlrev_b32 v52, 16, v116
    v_and_b32 v53, s6, v116
    v_pk_fma_f32 v[196:197], v[42:43], v[52:53], v[196:197] op_sel:[1,0,0] op_sel_hi:[1,1,1]
    v_lshlrev_b32 v54, 16, v117
    v_and_b32 v55, s6, v117
    v_pk_fma_f32 v[198:199], v[42:43], v[54:55], v[198:199] op_sel:[1,0,0] op_sel_hi:[1,1,1]
    v_lshlrev_b32 v52, 16, v118
    v_and_b32 v53, s6, v118
    v_pk_fma_f32 v[200:201], v[42:43], v[52:53], v[200:201] op_sel:[1,0,0] op_sel_hi:[1,1,1]
    v_lshlrev_b32 v54, 16, v119
    v_and_b32 v55, s6, v119
    v_pk_fma_f32 v[202:203], v[42:43], v[54:55], v[202:203] op_sel:[1,0,0] op_sel_hi:[1,1,1]
    v_permlane32_swap_b32 v196, v200
    v_permlane32_swap_b32 v197, v201
    v_permlane32_swap_b32 v198, v202
    v_permlane32_swap_b32 v199, v203
    v_add_f32 v196, v196, v200
    v_add_f32 v197, v197, v201
    v_add_f32 v198, v198, v202
    v_add_f32 v199, v199, v203
    s_nop 0
    v_permlane16_swap_b32 v196, v198
    v_permlane16_swap_b32 v197, v199
    v_add_f32 v196, v196, v198
    v_add_f32 v197, v197, v199
    s_nop 0
    v_add_f32_dpp v196, v196, v196 row_ror:8 row_mask:0xf bank_mask:0xf
    v_add_f32_dpp v197, v197, v197 row_ror:8 row_mask:0xf bank_mask:0xf
    s_nop 1
    v_mov_b32_dpp v196, v197 quad_perm:[0,1,2,3] row_mask:0xf bank_mask:0xc
    ds_write_b32 v252, v196 offset:9984
L_HG1:
    s_waitcnt vmcnt(1)
    v_pk_add_f32 v[184:185], v[184:185], v[188:189]
    v_pk_add_f32 v[186:187], v[186:187], v[190:191]
    s_nop 1
    v_permlane32_swap_b32 v184, v186
    v_permlane32_swap_b32 v185, v187
    v_pk_add_f32 v[184:185], v[184:185], v[186:187]
    s_nop 1
    v_add_f32_dpp v184, v184, v184 row_ror:8 row_mask:0xf bank_mask:0xf
    v_add_f32_dpp v185, v185, v185 row_ror:8 row_mask:0xf bank_mask:0xf
    v_mov_b32 v186, v184
    v_mov_b32 v187, v185
    s_nop 0
    v_permlane16_swap_b32 v184, v186
    v_permlane16_swap_b32 v185, v187
    v_pk_add_f32 v[184:185], v[184:185], v[186:187]
    v_cvt_pk_bf16_f32 v184, v184, v185
    v_mov_b32 v185, s4
    s_mov_b32 exec_lo, 0xff
    s_mov_b32 exec_hi, 0xff
    buffer_store_dwordx2 v[184:185], v48, s[32:35], s15 offen sc1
    s_mov_b64 exec, -1
    s_waitcnt lgkmcnt(0)
    s_barrier
    s_cmp_lg_u32 s3, 0
    s_cbranch_scc1 L_PC2
    v_mov_b32 v45, s4
    s_mov_b32 exec_hi, 0
    s_mov_b32 exec_lo, 65535
    buffer_store_dword v45, v46, s[32:35], s17 offen sc1
    s_mov_b64 exec, -1
L_PC2:
    s_cmp_lg_u32 s3, 3
    s_cbranch_scc1 L_M2F
    ds_read_b128 v[196:199], v251 offset:10000
    s_lshr_b32 s96, s8, 2
    s_lshl1_add_u32 s97, s9, s96
    s_and_b32 s98, s8, 3
    s_lshl2_add_u32 s99, s97, s98
    s_lshl_b32 s96, s99, 9
    s_add_u32 s18, s96, 131072
    s_waitcnt lgkmcnt(0)
    v_add_f32 v196, v196, v197
    v_add_f32 v198, v198, v199
    v_mov_b32 v197, s4
    v_add_f32 v196, v196, v198
    buffer_store_dwordx2 v[196:197], v250, s[32:35], s18 offen sc1
L_M2F:
    s_waitcnt vmcnt(1)
    s_xor_b32 s96, s95, 262144
    s_add_u32 s82, s96, s90
    s_add_u32 m0, s83, 16384
    s_nop 0
    buffer_load_dwordx4 v26, s[44:47], s82 offen lds
    v_permlane32_swap_b32 v192, v194
    v_permlane32_swap_b32 v193, v195
    v_pk_add_f32 v[192:193], v[192:193], v[194:195]
    s_nop 1
    v_add_f32_dpp v192, v192, v192 row_ror:4 row_mask:0xf bank_mask:0xf
    s_xor_b32 s96, s95, 393216
    s_add_u32 s82, s96, s90
    s_add_u32 m0, s83, 24576
    s_nop 0
    buffer_load_dwordx4 v26, s[44:47], s82 offen lds
    v_add_f32_dpp v193, v193, v193 row_ror:4 row_mask:0xf bank_mask:0xf
    v_add_f32_dpp v192, v192, v192 row_ror:8 row_mask:0xf bank_mask:0xf
    s_nop 0
    v_add_f32_dpp v193, v193, v193 row_ror:8 row_mask:0xf bank_mask:0xf
    s_xor_b32 s96, s95, 524288
    s_add_u32 s82, s96, s90
    s_add_u32 m0, s83, 32768
    s_nop 0
    buffer_load_dwordx4 v26, s[44:47], s82 offen lds
    v_mov_b32 v194, v192
    v_mov_b32 v195, v193
    s_nop 0
    v_permlane16_swap_b32 v192, v194
    s_xor_b32 s96, s95, 655360
    s_add_u32 s82, s96, s90
    s_add_u32 m0, s83, 40960
    s_nop 0
    buffer_load_dwordx4 v26, s[44:47], s82 offen lds
    v_permlane16_swap_b32 v193, v195
    v_pk_add_f32 v[192:193], v[192:193], v[194:195]
    v_cvt_pk_bf16_f32 v192, v192, v193
    ds_write_b32 v6, v192
    s_waitcnt lgkmcnt(0)
    s_barrier
    ds_read_b128 v[196:199], v7
    ds_read_b128 v[200:203], v7 offset:32
    ds_read_b128 v[204:207], v7 offset:64
    ds_read_b128 v[208:211], v7 offset:96
    s_lshr_b32 s96, s8, 2
    s_lshl1_add_u32 s97, s9, s96
    s_and_b32 s98, s8, 3
    s_lshl2_add_u32 s99, s97, s98
    s_lshl_b32 s96, s99, 9
    s_add_u32 s18, s96, 131072
    s_waitcnt lgkmcnt(0)
    s_lshl3_add_u32 s96, s11, s3
    s_lshl_b32 s97, s96, 11
    s_add_u32 s13, s97, 29360128
    s_load_dwordx2 s[24:25], s[32:33], s92 offset:3584 glc
    v_mfma_f32_32x32x16_bf16 v[136:151], v[196:199], v[152:155], 0
    v_mfma_f32_32x32x16_bf16 v[136:151], v[200:203], v[156:159], v[136:151]
L_PAD7:
    s_cbranch_execz L_RET7
    v_mfma_f32_32x32x16_bf16 v[136:151], v[204:207], v[160:163], v[136:151]
    v_mfma_f32_32x32x16_bf16 v[136:151], v[208:211], v[164:167], v[136:151]
    s_nop 11
    v_cvt_pk_bf16_f32 v136, 0, v136
    v_add_f32 v136, 0x358637bd, v136
    v_cvt_pk_bf16_f32 v136, 0, v136
    v_rcp_f32 v136, v136
    s_branch SCHK_23
SPOLL_22:
    s_load_dwordx2 s[24:25], s[32:33], s92 offset:3584 glc
SCHK_23:
    s_add_u32 s5, s5, 1
    s_cmp_ge_u32 s5, 200000
    s_waitcnt lgkmcnt(0)
    s_cbranch_scc1 SDONE_24
    s_cmp_lg_u32 s24, s4
    s_cbranch_scc1 SPOLL_22
    s_cmp_lg_u32 s25, s4
    s_cbranch_scc1 SPOLL_22
SDONE_24:
    buffer_load_dwordx4 v[228:231], v2, s[32:35], s13 offen sc1
    buffer_load_dwordx4 v[232:235], v2, s[32:35], s13 offen offset:1024 sc1
    s_waitcnt vmcnt(0)
    v_bitop3_b32 v4, v229, v231, s4 bitop3:0x7e
    v_bitop3_b32 v4, v4, v233, s4 bitop3:0xf6
    v_bitop3_b32 v4, v4, v235, s4 bitop3:0xf6
    v_cmp_ne_u32 vcc, 0, v4
    s_cbranch_vccz TOK_26
POLL_27:
    buffer_load_dwordx4 v[228:231], v2, s[32:35], s13 offen sc1
    buffer_load_dwordx4 v[232:235], v2, s[32:35], s13 offen offset:1024 sc1
    s_waitcnt vmcnt(0)
    v_bitop3_b32 v4, v229, v231, s4 bitop3:0x7e
    v_bitop3_b32 v4, v4, v233, s4 bitop3:0xf6
    v_bitop3_b32 v4, v4, v235, s4 bitop3:0xf6
    v_cmp_ne_u32 vcc, 0, v4
    s_cbranch_vccz PDONE_28
    s_add_u32 s5, s5, 1
    s_cmp_lt_u32 s5, 200000
    s_cbranch_scc1 POLL_27
PDONE_28:
TOK_26:
    ds_write2_b32 v5, v228, v230 offset0:0 offset1:1
    ds_write2_b32 v5, v232, v234 offset0:64 offset1:65
    s_waitcnt lgkmcnt(0)
    s_barrier
    ds_read_b128 v[212:215], v44
    ds_read_b128 v[216:219], v44 offset:1024
    ds_read_b128 v[220:223], v44 offset:2048
    ds_read_b128 v[224:227], v44 offset:3072
    s_lshl_b32 s96, s77, 1
    s_lshl3_add_u32 s97, s10, s96
    s_lshl_b32 s98, s97, 5
    s_lshl1_add_u32 s99, s11, s98
    s_add_u32 s96, s99, s76
    s_lshl_b32 s97, s96, 10
    s_add_u32 s13, s97, 8388608
    v_and_b32 v47, 15, v1
    v_lshlrev_b32 v47, 4, v47
    v_bfe_u32 v9, v1, 4, 1
    v_lshl_add_u32 v47, v9, 15, v47
    v_lshrrev_b32 v9, 5, v1
    v_lshl_add_u32 v47, v9, 8, v47
    s_waitcnt lgkmcnt(3)
    v_mfma_f32_32x32x16_bf16 v[120:135], v[212:215], v[152:155], 0
    s_waitcnt lgkmcnt(2)
    v_mfma_f32_32x32x16_bf16 v[120:135], v[216:219], v[156:159], v[120:135]
    s_waitcnt lgkmcnt(1)
    v_mfma_f32_32x32x16_bf16 v[120:135], v[220:223], v[160:163], v[120:135]
    s_waitcnt lgkmcnt(0)
    v_mfma_f32_32x32x16_bf16 v[120:135], v[224:227], v[164:167], v[120:135]
    s_lshr_b32 s96, s3, 1
    s_lshl4_add_u32 s97, s96, s12
    s_lshl_b32 s98, s97, 11
    s_and_b32 s99, s3, 1
    s_lshl_b32 s96, s99, 10
    s_add_u32 s97, s98, s96
    s_add_u32 s18, s97, 131072
    s_lshl_b32 s19, s12, 7
    v_and_b32 v44, 3, v1
    v_lshl_add_u32 v44, v44, 1, s19
    v_lshrrev_b32 v9, 5, v1
    v_lshl_add_u32 v44, v9, 3, v44
    v_bfe_u32 v9, v1, 4, 1
    v_lshl_add_u32 v44, v9, 4, v44
    v_bfe_u32 v9, v1, 2, 2
    v_lshl_add_u32 v44, v9, 5, v44
    global_load_ushort v32, v44, s[78:79]
    v_cvt_pk_bf16_f32 v120, 0, v120
    v_cvt_pk_bf16_f32 v121, 0, v121
    v_cvt_pk_bf16_f32 v122, 0, v122
    v_cvt_pk_bf16_f32 v123, 0, v123
    v_cvt_pk_bf16_f32 v124, 0, v124
    v_cvt_pk_bf16_f32 v125, 0, v125
    v_cvt_pk_bf16_f32 v126, 0, v126
    v_cvt_pk_bf16_f32 v127, 0, v127
    v_pk_mul_f32 v[120:121], v[120:121], v[136:137] op_sel_hi:[1,0]
    v_pk_mul_f32 v[122:123], v[122:123], v[136:137] op_sel_hi:[1,0]
    v_pk_mul_f32 v[124:125], v[124:125], v[136:137] op_sel_hi:[1,0]
    v_pk_mul_f32 v[126:127], v[126:127], v[136:137] op_sel_hi:[1,0]
    v_cvt_pk_bf16_f32 v168, v120, v121
    v_cvt_pk_bf16_f32 v169, v122, v123
    v_cvt_pk_bf16_f32 v170, v124, v125
    v_cvt_pk_bf16_f32 v171, v126, v127
    buffer_store_dwordx4 v[168:171], v47, s[32:35], s13 offen sc1
    v_cvt_pk_bf16_f32 v128, 0, v128
    v_cvt_pk_bf16_f32 v129, 0, v129
    v_cvt_pk_bf16_f32 v130, 0, v130
    v_cvt_pk_bf16_f32 v131, 0, v131
    v_cvt_pk_bf16_f32 v132, 0, v132
    v_cvt_pk_bf16_f32 v133, 0, v133
    v_cvt_pk_bf16_f32 v134, 0, v134
    v_cvt_pk_bf16_f32 v135, 0, v135
    v_pk_mul_f32 v[128:129], v[128:129], v[136:137] op_sel_hi:[1,0]
    v_pk_mul_f32 v[130:131], v[130:131], v[136:137] op_sel_hi:[1,0]
    v_pk_mul_f32 v[132:133], v[132:133], v[136:137] op_sel_hi:[1,0]
    v_pk_mul_f32 v[134:135], v[134:135], v[136:137] op_sel_hi:[1,0]
    v_cvt_pk_bf16_f32 v172, v128, v129
    v_cvt_pk_bf16_f32 v173, v130, v131
    v_cvt_pk_bf16_f32 v174, v132, v133
    v_cvt_pk_bf16_f32 v175, v134, v135
    buffer_store_dwordx4 v[172:175], v47, s[32:35], s13 offen offset:512 sc1
    buffer_load_dwordx4 v[28:31], v2, s[32:35], s18 offen sc1
    v_mov_b32 v50, -1
    v_mov_b32 v51, -1
    v_mov_b32 v52, -1
    v_mov_b32 v53, -1
    s_lshl3_add_u32 s96, s21, s3
    s_lshl4_add_u32 s97, s96, s12
    s_lshl_b32 s98, s97, 8
    s_add_u32 s19, s98, 12582912
    v_lshlrev_b32 v54, 2, v1
    buffer_store_dword v50, v54, s[32:35], s19 offen sc1
    s_lshl_b32 s96, s21, 14
    s_lshl_b32 s97, s12, 9
    s_add_u32 s98, s96, s97
    s_add_u32 s19, s98, 13631488
    v_and_b32 v54, 31, v1
    v_lshlrev_b32 v54, 4, v54
    v_lshrrev_b32 v55, 5, v1
    v_lshl_add_u32 v54, v55, 13, v54
    s_cmp_lg_u32 s3, 5
    s_cbranch_scc1 L_NOPO
    buffer_store_dwordx4 v[50:53], v54, s[32:35], s19 offen sc1
L_NOPO:
    v_bfe_u32 v36, v1, 2, 2
    v_lshlrev_b32 v36, 7, v36
    v_lshrrev_b32 v9, 4, v1
    v_lshl_add_u32 v36, v9, 10, v36
    v_and_b32 v9, 1, v1
    v_lshl_add_u32 v36, v9, 4, v36
    v_bfe_u32 v9, v1, 1, 1
    v_lshl_add_u32 v36, v9, 3, v36
    v_bfe_u32 v9, v1, 3, 2
    v_lshl_add_u32 v36, v9, 5, v36
    s_and_b32 s96, s9, 1
    s_lshl_b32 s97, s96, 2
    s_xor_b32 s98, s3, s97
    s_lshl_b32 s17, s98, 12
    s_lshl_b32 s96, s17, 2
    s_lshr_b32 s97, s95, 4
    s_xor_b32 s14, s96, s97
    v_add_u32 v36, s14, v36
    v_xor_b32 v37, 32, v36
    v_xor_b32 v38, 64, v36
    v_xor_b32 v39, 96, v36
    v_and_b32 v5, 7, v1
    v_lshlrev_b32 v5, 15, v5
    v_bfe_u32 v9, v1, 3, 1
    v_lshl_add_u32 v5, v9, 12, v5
    s_and_b32 s96, s11, 1
    s_lshr_b32 s97, s10, 2
    s_and_b32 s98, s10, 3
    s_lshl_b32 s99, s98, 6
    s_lshl1_add_u32 s98, s97, s99
    s_lshl_b32 s97, s98, 12
    s_lshr_b32 s99, s11, 1
    s_lshl_b32 s98, s99, 6
    s_add_u32 s99, s97, s98
    s_lshl2_add_u32 s97, s96, s99
    s_add_u32 s98, s97, 1048576
    s_add_u32 s15, s98, 1024
    v_lshlrev_b32 v152, 16, v12
    v_and_b32 v153, s6, v12
    v_lshlrev_b32 v154, 16, v13
    v_and_b32 v155, s6, v13
    v_lshlrev_b32 v156, 16, v14
    v_and_b32 v157, s6, v14
    v_lshlrev_b32 v158, 16, v15
    v_and_b32 v159, s6, v15
    v_lshlrev_b32 v160, 16, v16
    v_and_b32 v161, s6, v16
    v_lshlrev_b32 v162, 16, v17
    v_and_b32 v163, s6, v17
    v_lshlrev_b32 v164, 16, v18
    v_and_b32 v165, s6, v18
    v_lshlrev_b32 v166, 16, v19
    v_and_b32 v167, s6, v19
    s_lshl3_add_u32 s96, s21, s3
    s_lshl_b32 s97, s96, 15
    s_add_u32 s19, s97, 8388608
    s_and_b32 s96, s3, 1
    s_lshr_b32 s97, s3, 1
    s_lshl_b32 s98, s97, 10
    s_lshl3_add_u32 s99, s96, s98
    s_add_u32 s14, s99, 159744
    v_and_b32 v4, 31, v1
    v_lshl_add_u32 v4, v4, 5, s14
    v_lshrrev_b32 v9, 5, v1
    v_lshl_add_u32 v4, v9, 2, v4
    v_and_b32 v7, 3, v1
    v_lshlrev_b32 v7, 4, v7
    v_lshrrev_b32 v9, 5, v1
    v_lshl_add_u32 v7, v9, 6, v7
    v_bfe_u32 v9, v1, 4, 1
    v_lshl_add_u32 v7, v9, 7, v7
    v_bfe_u32 v9, v1, 2, 2
    v_lshl_add_u32 v7, v9, 8, v7
    v_add_u32 v7, 159744, v7
    s_waitcnt vmcnt(2)
    s_waitcnt lgkmcnt(0)
    s_barrier
    s_cmp_lg_u32 s3, 0
    s_cbranch_scc1 L_PD
    v_mov_b32 v6, s4
    s_mov_b32 exec_hi, 0
    s_mov_b32 exec_lo, 65535
    buffer_store_dword v6, v5, s[32:35], s15 offen sc1
    s_mov_b64 exec, -1
L_PD:
    s_waitcnt vmcnt(1)
    v_bitop3_b32 v6, v29, v31, s4 bitop3:0x7e
    v_cmp_ne_u32 vcc, 0, v6
    s_cbranch_vccz L_MGOK
POLL_29:
    buffer_load_dwordx4 v[28:31], v2, s[32:35], s18 offen sc1
    s_waitcnt vmcnt(0)
    v_bitop3_b32 v6, v29, v31, s4 bitop3:0x7e
    v_cmp_ne_u32 vcc, 0, v6
    s_cbranch_vccz PDONE_30
    s_add_u32 s5, s5, 1
    s_cmp_lt_u32 s5, 200000
    s_cbranch_scc1 POLL_29
PDONE_30:
L_MGOK:
    ds_write2_b32 v4, v28, v30 offset0:0 offset1:4
    s_waitcnt lgkmcnt(0)
    s_barrier
    s_lshl_b32 s96, s2, 12
    s_lshr_b32 s97, s17, 6
    s_add_u32 s98, s96, s97
    s_add_u32 s99, s98, 1048576
    s_add_u32 s18, s99, 1024
    ds_read_b128 v[192:195], v7
    ds_read_b128 v[196:199], v7 offset:1024
    ds_read_b128 v[200:203], v7 offset:2048
    ds_read_b128 v[204:207], v7 offset:3072
    v_and_b32 v8, 3, v1
    v_lshlrev_b32 v8, 2, v8
    v_lshrrev_b32 v9, 5, v1
    v_lshl_add_u32 v8, v9, 4, v8
    v_bfe_u32 v9, v1, 4, 1
    v_lshl_add_u32 v8, v9, 5, v8
    v_bfe_u32 v9, v1, 2, 2
    v_lshl_add_u32 v8, v9, 6, v8
    v_add_u32 v8, 157184, v8
    s_lshl4_add_u32 s96, s21, s12
    s_lshl_b32 s97, s96, 6
    s_add_u32 s13, s97, 14155776
    s_waitcnt lgkmcnt(0)
    s_load_dwordx2 s[24:25], s[32:33], s18 offset:0 glc
    v_pk_add_f32 v[192:193], v[192:193], v[194:195]
    v_add_f32 v28, v192, v193
    v_pk_add_f32 v[196:197], v[196:197], v[198:199]
    v_add_f32 v29, v196, v197
    v_pk_add_f32 v[200:201], v[200:201], v[202:203]
    v_add_f32 v30, v200, v201
    v_pk_add_f32 v[204:205], v[204:205], v[206:207]
    v_add_f32 v31, v204, v205
    v_cvt_pk_bf16_f32 v28, 0, v28
    v_cvt_pk_bf16_f32 v29, 0, v29
    v_cvt_pk_bf16_f32 v30, 0, v30
    v_cvt_pk_bf16_f32 v31, 0, v31
    v_add_f32 v30, 1.0, v30
    v_lshlrev_b32 v32, 16, v32
    v_cvt_pk_bf16_f32 v30, 0, v30
    ds_write_b32 v8, v31
    v_mul_f32 v192, v30, v32
    v_cvt_pk_bf16_f32 v193, 0, v192
    v_sub_f32 v194, v192, v193
    v_add_f32_dpp v192, v192, v192 quad_perm:[1,0,3,2] row_mask:0xf bank_mask:0xf
    s_nop 1
    v_add_f32_dpp v192, v192, v192 quad_perm:[2,3,0,1] row_mask:0xf bank_mask:0xf
    s_nop 1
    v_add_f32_dpp v192, v192, v192 row_half_mirror row_mask:0xf bank_mask:0xf
    s_nop 1
    v_add_f32_dpp v192, v192, v192 row_ror:8 row_mask:0xf bank_mask:0xf
    v_mov_b32 v199, v192
    s_nop 1
    v_permlane16_swap_b32 v192, v199
    v_add_f32 v192, v192, v199
    v_mov_b32 v199, v192
    s_nop 1
    v_permlane32_swap_b32 v192, v199
    v_add_f32 v192, v192, v199
    v_mov_b32_dpp v196, v193 row_shl:1 row_mask:0xf bank_mask:0xf
    v_mov_b32_dpp v197, v194 row_shl:1 row_mask:0xf bank_mask:0xf
    v_mov_b32_dpp v198, v32 row_shl:1 row_mask:0xf bank_mask:0xf
    v_cvt_pk_bf16_f32 v196, v193, v196
    v_cvt_pk_bf16_f32 v197, v194, v197
    v_cvt_pk_bf16_f32 v198, v32, v198
    v_mov_b32 v193, s4
    v_mov_b32 v194, 0
    s_cmp_lg_u32 s3, 2
    s_cbranch_scc1 L_NOUP
    s_mov_b64 exec, 1
    buffer_store_dwordx2 v[192:193], v194, s[32:35], s13 offen sc1
    s_mov_b64 exec, -1
L_NOUP:
    v_mov_b32 v184, 0x3f803f80
    s_nop 1
    v_mov_b32_dpp v184, v196 row_newbcast:0 row_mask:0xf bank_mask:0x2
    s_nop 1
    v_mov_b32_dpp v184, v197 row_newbcast:0 row_mask:0xf bank_mask:0x4
    s_nop 1
    v_mov_b32_dpp v184, v198 row_newbcast:0 row_mask:0xf bank_mask:0x8
    v_mov_b32 v185, 0x3f803f80
    s_nop 1
    v_mov_b32_dpp v185, v196 row_newbcast:2 row_mask:0xf bank_mask:0x2
    s_nop 1
    v_mov_b32_dpp v185, v197 row_newbcast:2 row_mask:0xf bank_mask:0x4
    s_nop 1
    v_mov_b32_dpp v185, v198 row_newbcast:2 row_mask:0xf bank_mask:0x8
    v_mov_b32 v186, 0x3f803f80
    s_nop 1
    v_mov_b32_dpp v186, v196 row_newbcast:4 row_mask:0xf bank_mask:0x2
    s_nop 1
    v_mov_b32_dpp v186, v197 row_newbcast:4 row_mask:0xf bank_mask:0x4
    s_nop 1
    v_mov_b32_dpp v186, v198 row_newbcast:4 row_mask:0xf bank_mask:0x8
    v_mov_b32 v187, 0x3f803f80
    s_nop 1
    v_mov_b32_dpp v187, v196 row_newbcast:6 row_mask:0xf bank_mask:0x2
    s_nop 1
    v_mov_b32_dpp v187, v197 row_newbcast:6 row_mask:0xf bank_mask:0x4
    s_nop 1
    v_mov_b32_dpp v187, v198 row_newbcast:6 row_mask:0xf bank_mask:0x8
    v_mov_b32 v188, 0x3f803f80
    s_nop 1
    v_mov_b32_dpp v188, v196 row_newbcast:8 row_mask:0xf bank_mask:0x2
    s_nop 1
    v_mov_b32_dpp v188, v197 row_newbcast:8 row_mask:0xf bank_mask:0x4
    s_nop 1
    v_mov_b32_dpp v188, v198 row_newbcast:8 row_mask:0xf bank_mask:0x8
    v_mov_b32 v189, 0x3f803f80
    s_nop 1
    v_mov_b32_dpp v189, v196 row_newbcast:10 row_mask:0xf bank_mask:0x2
    s_nop 1
    v_mov_b32_dpp v189, v197 row_newbcast:10 row_mask:0xf bank_mask:0x4
    s_nop 1
    v_mov_b32_dpp v189, v198 row_newbcast:10 row_mask:0xf bank_mask:0x8
    v_mov_b32 v190, 0x3f803f80
    s_nop 1
    v_mov_b32_dpp v190, v196 row_newbcast:12 row_mask:0xf bank_mask:0x2
    s_nop 1
    v_mov_b32_dpp v190, v197 row_newbcast:12 row_mask:0xf bank_mask:0x4
    s_nop 1
    v_mov_b32_dpp v190, v198 row_newbcast:12 row_mask:0xf bank_mask:0x8
    v_mov_b32 v191, 0x3f803f80
    s_nop 1
    v_mov_b32_dpp v191, v196 row_newbcast:14 row_mask:0xf bank_mask:0x2
    s_nop 1
    v_mov_b32_dpp v191, v197 row_newbcast:14 row_mask:0xf bank_mask:0x4
    s_nop 1
    v_mov_b32_dpp v191, v198 row_newbcast:14 row_mask:0xf bank_mask:0x8
    v_mov_b32 v42, v29
    v_mov_b32 v43, v31
    v_mov_b32 v33, v30
    v_mov_b32_dpp v136, v28 row_newbcast:0 row_mask:0xf bank_mask:0xf
    v_mov_b32_dpp v137, v28 row_newbcast:1 row_mask:0xf bank_mask:0xf
    v_mov_b32_dpp v138, v28 row_newbcast:2 row_mask:0xf bank_mask:0xf
    v_mov_b32_dpp v139, v28 row_newbcast:3 row_mask:0xf bank_mask:0xf
    v_mov_b32_dpp v140, v28 row_newbcast:4 row_mask:0xf bank_mask:0xf
    v_mov_b32_dpp v141, v28 row_newbcast:5 row_mask:0xf bank_mask:0xf
    v_mov_b32_dpp v142, v28 row_newbcast:6 row_mask:0xf bank_mask:0xf
    v_mov_b32_dpp v143, v28 row_newbcast:7 row_mask:0xf bank_mask:0xf
    v_mov_b32_dpp v144, v28 row_newbcast:8 row_mask:0xf bank_mask:0xf
    v_mov_b32_dpp v145, v28 row_newbcast:9 row_mask:0xf bank_mask:0xf
    v_mov_b32_dpp v146, v28 row_newbcast:10 row_mask:0xf bank_mask:0xf
    v_mov_b32_dpp v147, v28 row_newbcast:11 row_mask:0xf bank_mask:0xf
    v_mov_b32_dpp v148, v28 row_newbcast:12 row_mask:0xf bank_mask:0xf
    v_mov_b32_dpp v149, v28 row_newbcast:13 row_mask:0xf bank_mask:0xf
    v_mov_b32_dpp v150, v28 row_newbcast:14 row_mask:0xf bank_mask:0xf
    v_mov_b32_dpp v151, v28 row_newbcast:15 row_mask:0xf bank_mask:0xf
    s_branch SCHK_32
SPOLL_31:
    s_load_dwordx2 s[24:25], s[32:33], s18 offset:0 glc
SCHK_32:
    s_add_u32 s5, s5, 1
    s_cmp_ge_u32 s5, 200000
    s_waitcnt lgkmcnt(0)
    s_cbranch_scc1 SDONE_33
    s_cmp_lg_u32 s24, s4
    s_cbranch_scc1 SPOLL_31
    s_cmp_lg_u32 s25, s4
    s_cbranch_scc1 SPOLL_31
SDONE_33:
    s_add_u32 s20, s17, s19
    buffer_load_dwordx4 v[224:227], v2, s[32:35], s20 offen sc1
    ds_read_b64_tr_b16 v[192:193], v36
    ds_read_b64_tr_b16 v[194:195], v36 offset:512
    ds_read_b64_tr_b16 v[196:197], v37
    ds_read_b64_tr_b16 v[198:199], v37 offset:512
    ds_read_b64_tr_b16 v[200:201], v38
    ds_read_b64_tr_b16 v[202:203], v38 offset:512
    ds_read_b64_tr_b16 v[204:205], v39
    ds_read_b64_tr_b16 v[206:207], v39 offset:512
    ds_read_b64_tr_b16 v[208:209], v36 offset:4096
    ds_read_b64_tr_b16 v[210:211], v36 offset:4608
    ds_read_b64_tr_b16 v[212:213], v37 offset:4096
    ds_read_b64_tr_b16 v[214:215], v37 offset:4608
    ds_read_b64_tr_b16 v[216:217], v38 offset:4096
    ds_read_b64_tr_b16 v[218:219], v38 offset:4608
    buffer_load_dwordx4 v[228:231], v2, s[32:35], s20 offen offset:1024 sc1
    buffer_load_dwordx4 v[232:235], v2, s[32:35], s20 offen offset:2048 sc1
    buffer_load_dwordx4 v[236:239], v2, s[32:35], s20 offen offset:3072 sc1
    s_barrier
    s_xor_b32 s96, s17, 4096
    s_add_u32 s20, s96, s19
    buffer_load_dwordx4 v[240:243], v2, s[32:35], s20 offen sc1
    buffer_load_dwordx4 v[244:247], v2, s[32:35], s20 offen offset:1024 sc1
    buffer_load_dwordx4 v[44:47], v2, s[32:35], s20 offen offset:2048 sc1
    buffer_load_dwordx4 v[48:51], v2, s[32:35], s20 offen offset:3072 sc1
    s_lshl_b32 s96, s21, 10
    s_add_u32 s13, s96, 14155776
    v_and_b32 v10, 15, v1
    v_lshlrev_b32 v10, 6, v10
    s_cmp_lt_u32 s3, 4
    s_cbranch_scc1 L_G2P0
    s_setprio 1
L_G2P0:
    s_waitcnt vmcnt(7)
    s_waitcnt lgkmcnt(6)
    v_mfma_f32_16x16x32_bf16 v[120:123], v[192:195], v[224:227], 0
    ds_read_b64_tr_b16 v[220:221], v39 offset:4096
    ds_read_b64_tr_b16 v[222:223], v39 offset:4608
    v_mfma_f32_16x16x32_bf16 v[124:127], v[196:199], v[224:227], 0
    ds_read_b64_tr_b16 v[192:193], v36 offset:8192
    ds_read_b64_tr_b16 v[194:195], v36 offset:8704
    v_mfma_f32_16x16x32_bf16 v[128:131], v[200:203], v[224:227], 0
    ds_read_b64_tr_b16 v[196:197], v37 offset:8192
    ds_read_b64_tr_b16 v[198:199], v37 offset:8704
    v_mfma_f32_16x16x32_bf16 v[132:135], v[204:207], v[224:227], 0
    ds_read_b64_tr_b16 v[200:201], v38 offset:8192
    ds_read_b64_tr_b16 v[202:203], v38 offset:8704
    s_xor_b32 s96, s17, 8192
    s_add_u32 s20, s96, s19
    buffer_load_dwordx4 v[224:227], v2, s[32:35], s20 offen sc1
    s_waitcnt vmcnt(7)
    s_waitcnt lgkmcnt(6)
    v_mfma_f32_16x16x32_bf16 v[120:123], v[208:211], v[228:231], v[120:123]
    ds_read_b64_tr_b16 v[204:205], v39 offset:8192
    ds_read_b64_tr_b16 v[206:207], v39 offset:8704
    v_mfma_f32_16x16x32_bf16 v[124:127], v[212:215], v[228:231], v[124:127]
    ds_read_b64_tr_b16 v[208:209], v36 offset:12288
    ds_read_b64_tr_b16 v[210:211], v36 offset:12800
    v_xor_b32 v36, 16384, v36
    v_mfma_f32_16x16x32_bf16 v[128:131], v[216:219], v[228:231], v[128:131]
    ds_read_b64_tr_b16 v[212:213], v37 offset:12288
    ds_read_b64_tr_b16 v[214:215], v37 offset:12800
    v_xor_b32 v37, 16384, v37
    v_mfma_f32_16x16x32_bf16 v[132:135], v[220:223], v[228:231], v[132:135]
    ds_read_b64_tr_b16 v[216:217], v38 offset:12288
    ds_read_b64_tr_b16 v[218:219], v38 offset:12800
    v_xor_b32 v38, 16384, v38
    buffer_load_dwordx4 v[228:231], v2, s[32:35], s20 offen offset:1024 sc1
    s_waitcnt vmcnt(7)
    s_waitcnt lgkmcnt(6)
    v_mfma_f32_16x16x32_bf16 v[120:123], v[192:195], v[232:235], v[120:123]
    ds_read_b64_tr_b16 v[220:221], v39 offset:12288
    ds_read_b64_tr_b16 v[222:223], v39 offset:12800
    v_xor_b32 v39, 16384, v39
    v_mfma_f32_16x16x32_bf16 v[124:127], v[196:199], v[232:235], v[124:127]
    ds_read_b64_tr_b16 v[192:193], v36
    ds_read_b64_tr_b16 v[194:195], v36 offset:512
    v_mfma_f32_16x16x32_bf16 v[128:131], v[200:203], v[232:235], v[128:131]
    ds_read_b64_tr_b16 v[196:197], v37
    ds_read_b64_tr_b16 v[198:199], v37 offset:512
    v_mfma_f32_16x16x32_bf16 v[132:135], v[204:207], v[232:235], v[132:135]
    ds_read_b64_tr_b16 v[200:201], v38
    ds_read_b64_tr_b16 v[202:203], v38 offset:512
    buffer_load_dwordx4 v[232:235], v2, s[32:35], s20 offen offset:2048 sc1
    s_waitcnt vmcnt(7)
    s_waitcnt lgkmcnt(6)
    v_mfma_f32_16x16x32_bf16 v[120:123], v[208:211], v[236:239], v[120:123]
    ds_read_b64_tr_b16 v[204:205], v39
    ds_read_b64_tr_b16 v[206:207], v39 offset:512
    v_mfma_f32_16x16x32_bf16 v[124:127], v[212:215], v[236:239], v[124:127]
    ds_read_b64_tr_b16 v[208:209], v36 offset:4096
    ds_read_b64_tr_b16 v[210:211], v36 offset:4608
    v_mfma_f32_16x16x32_bf16 v[128:131], v[216:219], v[236:239], v[128:131]
    ds_read_b64_tr_b16 v[212:213], v37 offset:4096
    ds_read_b64_tr_b16 v[214:215], v37 offset:4608
    v_mfma_f32_16x16x32_bf16 v[132:135], v[220:223], v[236:239], v[132:135]
    ds_read_b64_tr_b16 v[216:217], v38 offset:4096
    ds_read_b64_tr_b16 v[218:219], v38 offset:4608
    buffer_load_dwordx4 v[236:239], v2, s[32:35], s20 offen offset:3072 sc1
    s_waitcnt vmcnt(7)
    s_waitcnt lgkmcnt(6)
    v_mfma_f32_16x16x32_bf16 v[120:123], v[192:195], v[240:243], v[120:123]
    ds_read_b64_tr_b16 v[220:221], v39 offset:4096
    ds_read_b64_tr_b16 v[222:223], v39 offset:4608
    v_mfma_f32_16x16x32_bf16 v[124:127], v[196:199], v[240:243], v[124:127]
    ds_read_b64_tr_b16 v[192:193], v36 offset:8192
    ds_read_b64_tr_b16 v[194:195], v36 offset:8704
    v_mfma_f32_16x16x32_bf16 v[128:131], v[200:203], v[240:243], v[128:131]
    ds_read_b64_tr_b16 v[196:197], v37 offset:8192
    ds_read_b64_tr_b16 v[198:199], v37 offset:8704
    v_mfma_f32_16x16x32_bf16 v[132:135], v[204:207], v[240:243], v[132:135]
    ds_read_b64_tr_b16 v[200:201], v38 offset:8192
    ds_read_b64_tr_b16 v[202:203], v38 offset:8704
    s_xor_b32 s96, s17, 12288
    s_add_u32 s20, s96, s19
    buffer_load_dwordx4 v[240:243], v2, s[32:35], s20 offen sc1
    s_waitcnt vmcnt(7)
    s_waitcnt lgkmcnt(6)
    v_mfma_f32_16x16x32_bf16 v[120:123], v[208:211], v[244:247], v[120:123]
    ds_read_b64_tr_b16 v[204:205], v39 offset:8192
    ds_read_b64_tr_b16 v[206:207], v39 offset:8704
    v_mfma_f32_16x16x32_bf16 v[124:127], v[212:215], v[244:247], v[124:127]
    ds_read_b64_tr_b16 v[208:209], v36 offset:12288
    ds_read_b64_tr_b16 v[210:211], v36 offset:12800
    v_xor_b32 v36, 49152, v36
    v_mfma_f32_16x16x32_bf16 v[128:131], v[216:219], v[244:247], v[128:131]
    ds_read_b64_tr_b16 v[212:213], v37 offset:12288
    ds_read_b64_tr_b16 v[214:215], v37 offset:12800
    v_xor_b32 v37, 49152, v37
    v_mfma_f32_16x16x32_bf16 v[132:135], v[220:223], v[244:247], v[132:135]
    ds_read_b64_tr_b16 v[216:217], v38 offset:12288
    ds_read_b64_tr_b16 v[218:219], v38 offset:12800
    v_xor_b32 v38, 49152, v38
    buffer_load_dwordx4 v[244:247], v2, s[32:35], s20 offen offset:1024 sc1
    s_waitcnt vmcnt(7)
    s_waitcnt lgkmcnt(6)
    v_mfma_f32_16x16x32_bf16 v[120:123], v[192:195], v[44:47], v[120:123]
    ds_read_b64_tr_b16 v[220:221], v39 offset:12288
    ds_read_b64_tr_b16 v[222:223], v39 offset:12800
    v_xor_b32 v39, 49152, v39
    v_mfma_f32_16x16x32_bf16 v[124:127], v[196:199], v[44:47], v[124:127]
    ds_read_b64_tr_b16 v[192:193], v36
    ds_read_b64_tr_b16 v[194:195], v36 offset:512
    v_mfma_f32_16x16x32_bf16 v[128:131], v[200:203], v[44:47], v[128:131]
    ds_read_b64_tr_b16 v[196:197], v37
    ds_read_b64_tr_b16 v[198:199], v37 offset:512
    v_mfma_f32_16x16x32_bf16 v[132:135], v[204:207], v[44:47], v[132:135]
    ds_read_b64_tr_b16 v[200:201], v38
    ds_read_b64_tr_b16 v[202:203], v38 offset:512
    buffer_load_dwordx4 v[44:47], v2, s[32:35], s20 offen offset:2048 sc1
    s_waitcnt vmcnt(7)
    s_waitcnt lgkmcnt(6)
    v_mfma_f32_16x16x32_bf16 v[120:123], v[208:211], v[48:51], v[120:123]
    ds_read_b64_tr_b16 v[204:205], v39
    ds_read_b64_tr_b16 v[206:207], v39 offset:512
    v_mfma_f32_16x16x32_bf16 v[124:127], v[212:215], v[48:51], v[124:127]
    ds_read_b64_tr_b16 v[208:209], v36 offset:4096
    ds_read_b64_tr_b16 v[210:211], v36 offset:4608
    v_mfma_f32_16x16x32_bf16 v[128:131], v[216:219], v[48:51], v[128:131]
    ds_read_b64_tr_b16 v[212:213], v37 offset:4096
    ds_read_b64_tr_b16 v[214:215], v37 offset:4608
    v_mfma_f32_16x16x32_bf16 v[132:135], v[220:223], v[48:51], v[132:135]
    ds_read_b64_tr_b16 v[216:217], v38 offset:4096
    ds_read_b64_tr_b16 v[218:219], v38 offset:4608
    buffer_load_dwordx4 v[48:51], v2, s[32:35], s20 offen offset:3072 sc1
    s_waitcnt vmcnt(7)
    s_waitcnt lgkmcnt(6)
    v_mfma_f32_16x16x32_bf16 v[120:123], v[192:195], v[224:227], v[120:123]
    ds_read_b64_tr_b16 v[220:221], v39 offset:4096
    ds_read_b64_tr_b16 v[222:223], v39 offset:4608
    v_mfma_f32_16x16x32_bf16 v[124:127], v[196:199], v[224:227], v[124:127]
    ds_read_b64_tr_b16 v[192:193], v36 offset:8192
    ds_read_b64_tr_b16 v[194:195], v36 offset:8704
    v_mfma_f32_16x16x32_bf16 v[128:131], v[200:203], v[224:227], v[128:131]
    ds_read_b64_tr_b16 v[196:197], v37 offset:8192
    ds_read_b64_tr_b16 v[198:199], v37 offset:8704
    v_mfma_f32_16x16x32_bf16 v[132:135], v[204:207], v[224:227], v[132:135]
    ds_read_b64_tr_b16 v[200:201], v38 offset:8192
    ds_read_b64_tr_b16 v[202:203], v38 offset:8704
    s_xor_b32 s96, s17, 16384
    s_add_u32 s20, s96, s19
    buffer_load_dwordx4 v[224:227], v2, s[32:35], s20 offen sc1
    s_waitcnt vmcnt(7)
    s_waitcnt lgkmcnt(6)
    v_mfma_f32_16x16x32_bf16 v[120:123], v[208:211], v[228:231], v[120:123]
    ds_read_b64_tr_b16 v[204:205], v39 offset:8192
    ds_read_b64_tr_b16 v[206:207], v39 offset:8704
    v_mfma_f32_16x16x32_bf16 v[124:127], v[212:215], v[228:231], v[124:127]
    ds_read_b64_tr_b16 v[208:209], v36 offset:12288
    ds_read_b64_tr_b16 v[210:211], v36 offset:12800
    v_xor_b32 v36, 16384, v36
    v_mfma_f32_16x16x32_bf16 v[128:131], v[216:219], v[228:231], v[128:131]
    ds_read_b64_tr_b16 v[212:213], v37 offset:12288
    ds_read_b64_tr_b16 v[214:215], v37 offset:12800
    v_xor_b32 v37, 16384, v37
    v_mfma_f32_16x16x32_bf16 v[132:135], v[220:223], v[228:231], v[132:135]
    ds_read_b64_tr_b16 v[216:217], v38 offset:12288
    ds_read_b64_tr_b16 v[218:219], v38 offset:12800
    v_xor_b32 v38, 16384, v38
    buffer_load_dwordx4 v[228:231], v2, s[32:35], s20 offen offset:1024 sc1
    s_waitcnt vmcnt(7)
    s_waitcnt lgkmcnt(6)
    v_mfma_f32_16x16x32_bf16 v[120:123], v[192:195], v[232:235], v[120:123]
    ds_read_b64_tr_b16 v[220:221], v39 offset:12288
    ds_read_b64_tr_b16 v[222:223], v39 offset:12800
    v_xor_b32 v39, 16384, v39
    v_mfma_f32_16x16x32_bf16 v[124:127], v[196:199], v[232:235], v[124:127]
    ds_read_b64_tr_b16 v[192:193], v36
    ds_read_b64_tr_b16 v[194:195], v36 offset:512
    v_mfma_f32_16x16x32_bf16 v[128:131], v[200:203], v[232:235], v[128:131]
    ds_read_b64_tr_b16 v[196:197], v37
    ds_read_b64_tr_b16 v[198:199], v37 offset:512
    v_mfma_f32_16x16x32_bf16 v[132:135], v[204:207], v[232:235], v[132:135]
    ds_read_b64_tr_b16 v[200:201], v38
    ds_read_b64_tr_b16 v[202:203], v38 offset:512
    buffer_load_dwordx4 v[232:235], v2, s[32:35], s20 offen offset:2048 sc1
    s_waitcnt vmcnt(7)
    s_waitcnt lgkmcnt(6)
    v_mfma_f32_16x16x32_bf16 v[120:123], v[208:211], v[236:239], v[120:123]
    ds_read_b64_tr_b16 v[204:205], v39
    ds_read_b64_tr_b16 v[206:207], v39 offset:512
    v_mfma_f32_16x16x32_bf16 v[124:127], v[212:215], v[236:239], v[124:127]
    ds_read_b64_tr_b16 v[208:209], v36 offset:4096
    ds_read_b64_tr_b16 v[210:211], v36 offset:4608
    v_mfma_f32_16x16x32_bf16 v[128:131], v[216:219], v[236:239], v[128:131]
    ds_read_b64_tr_b16 v[212:213], v37 offset:4096
    ds_read_b64_tr_b16 v[214:215], v37 offset:4608
    v_mfma_f32_16x16x32_bf16 v[132:135], v[220:223], v[236:239], v[132:135]
    ds_read_b64_tr_b16 v[216:217], v38 offset:4096
    ds_read_b64_tr_b16 v[218:219], v38 offset:4608
    buffer_load_dwordx4 v[236:239], v2, s[32:35], s20 offen offset:3072 sc1
    s_waitcnt vmcnt(7)
    s_waitcnt lgkmcnt(6)
    v_mfma_f32_16x16x32_bf16 v[120:123], v[192:195], v[240:243], v[120:123]
    ds_read_b64_tr_b16 v[220:221], v39 offset:4096
    ds_read_b64_tr_b16 v[222:223], v39 offset:4608
    v_mfma_f32_16x16x32_bf16 v[124:127], v[196:199], v[240:243], v[124:127]
L_PAD8:
    s_cbranch_execz L_RET8
    ds_read_b64_tr_b16 v[192:193], v36 offset:8192
    ds_read_b64_tr_b16 v[194:195], v36 offset:8704
    v_mfma_f32_16x16x32_bf16 v[128:131], v[200:203], v[240:243], v[128:131]
    ds_read_b64_tr_b16 v[196:197], v37 offset:8192
    ds_read_b64_tr_b16 v[198:199], v37 offset:8704
    v_mfma_f32_16x16x32_bf16 v[132:135], v[204:207], v[240:243], v[132:135]
    ds_read_b64_tr_b16 v[200:201], v38 offset:8192
    ds_read_b64_tr_b16 v[202:203], v38 offset:8704
    s_xor_b32 s96, s17, 20480
    s_add_u32 s20, s96, s19
    buffer_load_dwordx4 v[240:243], v2, s[32:35], s20 offen sc1
    s_waitcnt vmcnt(7)
    s_waitcnt lgkmcnt(6)
    v_mfma_f32_16x16x32_bf16 v[120:123], v[208:211], v[244:247], v[120:123]
    ds_read_b64_tr_b16 v[204:205], v39 offset:8192
    ds_read_b64_tr_b16 v[206:207], v39 offset:8704
    v_mfma_f32_16x16x32_bf16 v[124:127], v[212:215], v[244:247], v[124:127]
    ds_read_b64_tr_b16 v[208:209], v36 offset:12288
    ds_read_b64_tr_b16 v[210:211], v36 offset:12800
    v_xor_b32 v36, 114688, v36
    v_mfma_f32_16x16x32_bf16 v[128:131], v[216:219], v[244:247], v[128:131]
    ds_read_b64_tr_b16 v[212:213], v37 offset:12288
    ds_read_b64_tr_b16 v[214:215], v37 offset:12800
    v_xor_b32 v37, 114688, v37
    v_mfma_f32_16x16x32_bf16 v[132:135], v[220:223], v[244:247], v[132:135]
    ds_read_b64_tr_b16 v[216:217], v38 offset:12288
    ds_read_b64_tr_b16 v[218:219], v38 offset:12800
    v_xor_b32 v38, 114688, v38
    buffer_load_dwordx4 v[244:247], v2, s[32:35], s20 offen offset:1024 sc1
    s_waitcnt vmcnt(7)
    s_waitcnt lgkmcnt(6)
    v_mfma_f32_16x16x32_bf16 v[120:123], v[192:195], v[44:47], v[120:123]
    ds_read_b64_tr_b16 v[220:221], v39 offset:12288
    ds_read_b64_tr_b16 v[222:223], v39 offset:12800
    v_xor_b32 v39, 114688, v39
    v_mfma_f32_16x16x32_bf16 v[124:127], v[196:199], v[44:47], v[124:127]
    ds_read_b64_tr_b16 v[192:193], v36
    ds_read_b64_tr_b16 v[194:195], v36 offset:512
    v_mfma_f32_16x16x32_bf16 v[128:131], v[200:203], v[44:47], v[128:131]
    ds_read_b64_tr_b16 v[196:197], v37
    ds_read_b64_tr_b16 v[198:199], v37 offset:512
    v_mfma_f32_16x16x32_bf16 v[132:135], v[204:207], v[44:47], v[132:135]
    ds_read_b64_tr_b16 v[200:201], v38
    ds_read_b64_tr_b16 v[202:203], v38 offset:512
    buffer_load_dwordx4 v[44:47], v2, s[32:35], s20 offen offset:2048 sc1
    s_waitcnt vmcnt(7)
    s_waitcnt lgkmcnt(6)
    v_mfma_f32_16x16x32_bf16 v[120:123], v[208:211], v[48:51], v[120:123]
    ds_read_b64_tr_b16 v[204:205], v39
    ds_read_b64_tr_b16 v[206:207], v39 offset:512
    v_mfma_f32_16x16x32_bf16 v[124:127], v[212:215], v[48:51], v[124:127]
    ds_read_b64_tr_b16 v[208:209], v36 offset:4096
    ds_read_b64_tr_b16 v[210:211], v36 offset:4608
    v_mfma_f32_16x16x32_bf16 v[128:131], v[216:219], v[48:51], v[128:131]
    ds_read_b64_tr_b16 v[212:213], v37 offset:4096
    ds_read_b64_tr_b16 v[214:215], v37 offset:4608
    v_mfma_f32_16x16x32_bf16 v[132:135], v[220:223], v[48:51], v[132:135]
    ds_read_b64_tr_b16 v[216:217], v38 offset:4096
    ds_read_b64_tr_b16 v[218:219], v38 offset:4608
    buffer_load_dwordx4 v[48:51], v2, s[32:35], s20 offen offset:3072 sc1
    s_waitcnt vmcnt(7)
    s_waitcnt lgkmcnt(6)
    v_mfma_f32_16x16x32_bf16 v[120:123], v[192:195], v[224:227], v[120:123]
    ds_read_b64_tr_b16 v[220:221], v39 offset:4096
    ds_read_b64_tr_b16 v[222:223], v39 offset:4608
    v_mfma_f32_16x16x32_bf16 v[124:127], v[196:199], v[224:227], v[124:127]
    ds_read_b64_tr_b16 v[192:193], v36 offset:8192
    ds_read_b64_tr_b16 v[194:195], v36 offset:8704
    v_mfma_f32_16x16x32_bf16 v[128:131], v[200:203], v[224:227], v[128:131]
    ds_read_b64_tr_b16 v[196:197], v37 offset:8192
    ds_read_b64_tr_b16 v[198:199], v37 offset:8704
    v_mfma_f32_16x16x32_bf16 v[132:135], v[204:207], v[224:227], v[132:135]
    ds_read_b64_tr_b16 v[200:201], v38 offset:8192
    ds_read_b64_tr_b16 v[202:203], v38 offset:8704
    s_xor_b32 s96, s17, 24576
    s_add_u32 s20, s96, s19
    buffer_load_dwordx4 v[224:227], v2, s[32:35], s20 offen sc1
    s_waitcnt vmcnt(7)
    s_waitcnt lgkmcnt(6)
    v_mfma_f32_16x16x32_bf16 v[120:123], v[208:211], v[228:231], v[120:123]
    ds_read_b64_tr_b16 v[204:205], v39 offset:8192
    ds_read_b64_tr_b16 v[206:207], v39 offset:8704
    v_mfma_f32_16x16x32_bf16 v[124:127], v[212:215], v[228:231], v[124:127]
    ds_read_b64_tr_b16 v[208:209], v36 offset:12288
    ds_read_b64_tr_b16 v[210:211], v36 offset:12800
    v_xor_b32 v36, 16384, v36
    v_mfma_f32_16x16x32_bf16 v[128:131], v[216:219], v[228:231], v[128:131]
    ds_read_b64_tr_b16 v[212:213], v37 offset:12288
    ds_read_b64_tr_b16 v[214:215], v37 offset:12800
    v_xor_b32 v37, 16384, v37
    v_mfma_f32_16x16x32_bf16 v[132:135], v[220:223], v[228:231], v[132:135]
    ds_read_b64_tr_b16 v[216:217], v38 offset:12288
    ds_read_b64_tr_b16 v[218:219], v38 offset:12800
    v_xor_b32 v38, 16384, v38
    buffer_load_dwordx4 v[228:231], v2, s[32:35], s20 offen offset:1024 sc1
    s_waitcnt vmcnt(7)
    s_waitcnt lgkmcnt(6)
    v_mfma_f32_16x16x32_bf16 v[120:123], v[192:195], v[232:235], v[120:123]
    ds_read_b64_tr_b16 v[220:221], v39 offset:12288
    ds_read_b64_tr_b16 v[222:223], v39 offset:12800
    v_xor_b32 v39, 16384, v39
    v_mfma_f32_16x16x32_bf16 v[124:127], v[196:199], v[232:235], v[124:127]
    ds_read_b64_tr_b16 v[192:193], v36
    ds_read_b64_tr_b16 v[194:195], v36 offset:512
    v_mfma_f32_16x16x32_bf16 v[128:131], v[200:203], v[232:235], v[128:131]
    ds_read_b64_tr_b16 v[196:197], v37
    ds_read_b64_tr_b16 v[198:199], v37 offset:512
    v_mfma_f32_16x16x32_bf16 v[132:135], v[204:207], v[232:235], v[132:135]
    ds_read_b64_tr_b16 v[200:201], v38
    ds_read_b64_tr_b16 v[202:203], v38 offset:512
    buffer_load_dwordx4 v[232:235], v2, s[32:35], s20 offen offset:2048 sc1
    s_waitcnt vmcnt(7)
    s_waitcnt lgkmcnt(6)
    v_mfma_f32_16x16x32_bf16 v[120:123], v[208:211], v[236:239], v[120:123]
    ds_read_b64_tr_b16 v[204:205], v39
    ds_read_b64_tr_b16 v[206:207], v39 offset:512
    v_mfma_f32_16x16x32_bf16 v[124:127], v[212:215], v[236:239], v[124:127]
    ds_read_b64_tr_b16 v[208:209], v36 offset:4096
    ds_read_b64_tr_b16 v[210:211], v36 offset:4608
    v_mfma_f32_16x16x32_bf16 v[128:131], v[216:219], v[236:239], v[128:131]
    ds_read_b64_tr_b16 v[212:213], v37 offset:4096
    ds_read_b64_tr_b16 v[214:215], v37 offset:4608
    v_mfma_f32_16x16x32_bf16 v[132:135], v[220:223], v[236:239], v[132:135]
    ds_read_b64_tr_b16 v[216:217], v38 offset:4096
    ds_read_b64_tr_b16 v[218:219], v38 offset:4608
    buffer_load_dwordx4 v[236:239], v2, s[32:35], s20 offen offset:3072 sc1
    s_waitcnt vmcnt(7)
    s_waitcnt lgkmcnt(6)
    v_mfma_f32_16x16x32_bf16 v[120:123], v[192:195], v[240:243], v[120:123]
    ds_read_b64_tr_b16 v[220:221], v39 offset:4096
    ds_read_b64_tr_b16 v[222:223], v39 offset:4608
    v_mfma_f32_16x16x32_bf16 v[124:127], v[196:199], v[240:243], v[124:127]
    ds_read_b64_tr_b16 v[192:193], v36 offset:8192
    ds_read_b64_tr_b16 v[194:195], v36 offset:8704
    v_mfma_f32_16x16x32_bf16 v[128:131], v[200:203], v[240:243], v[128:131]
    ds_read_b64_tr_b16 v[196:197], v37 offset:8192
    ds_read_b64_tr_b16 v[198:199], v37 offset:8704
    v_mfma_f32_16x16x32_bf16 v[132:135], v[204:207], v[240:243], v[132:135]
    ds_read_b64_tr_b16 v[200:201], v38 offset:8192
    ds_read_b64_tr_b16 v[202:203], v38 offset:8704
    s_xor_b32 s96, s17, 28672
    s_add_u32 s20, s96, s19
    buffer_load_dwordx4 v[240:243], v2, s[32:35], s20 offen sc1
    s_waitcnt vmcnt(7)
    s_waitcnt lgkmcnt(6)
    v_mfma_f32_16x16x32_bf16 v[120:123], v[208:211], v[244:247], v[120:123]
    ds_read_b64_tr_b16 v[204:205], v39 offset:8192
    ds_read_b64_tr_b16 v[206:207], v39 offset:8704
    v_mfma_f32_16x16x32_bf16 v[124:127], v[212:215], v[244:247], v[124:127]
    ds_read_b64_tr_b16 v[208:209], v36 offset:12288
    ds_read_b64_tr_b16 v[210:211], v36 offset:12800
    v_xor_b32 v36, 49152, v36
    v_mfma_f32_16x16x32_bf16 v[128:131], v[216:219], v[244:247], v[128:131]
    ds_read_b64_tr_b16 v[212:213], v37 offset:12288
    ds_read_b64_tr_b16 v[214:215], v37 offset:12800
    v_xor_b32 v37, 49152, v37
    v_mfma_f32_16x16x32_bf16 v[132:135], v[220:223], v[244:247], v[132:135]
    ds_read_b64_tr_b16 v[216:217], v38 offset:12288
    ds_read_b64_tr_b16 v[218:219], v38 offset:12800
    v_xor_b32 v38, 49152, v38
    buffer_load_dwordx4 v[244:247], v2, s[32:35], s20 offen offset:1024 sc1
    s_waitcnt vmcnt(7)
    s_waitcnt lgkmcnt(6)
    v_mfma_f32_16x16x32_bf16 v[120:123], v[192:195], v[44:47], v[120:123]
    ds_read_b64_tr_b16 v[220:221], v39 offset:12288
    ds_read_b64_tr_b16 v[222:223], v39 offset:12800
    v_xor_b32 v39, 49152, v39
    v_mfma_f32_16x16x32_bf16 v[124:127], v[196:199], v[44:47], v[124:127]
    ds_read_b64_tr_b16 v[192:193], v36
    ds_read_b64_tr_b16 v[194:195], v36 offset:512
    v_mfma_f32_16x16x32_bf16 v[128:131], v[200:203], v[44:47], v[128:131]
    ds_read_b64_tr_b16 v[196:197], v37
    ds_read_b64_tr_b16 v[198:199], v37 offset:512
    v_mfma_f32_16x16x32_bf16 v[132:135], v[204:207], v[44:47], v[132:135]
    ds_read_b64_tr_b16 v[200:201], v38
    ds_read_b64_tr_b16 v[202:203], v38 offset:512
    buffer_load_dwordx4 v[44:47], v2, s[32:35], s20 offen offset:2048 sc1
    s_waitcnt vmcnt(7)
    s_waitcnt lgkmcnt(6)
    v_mfma_f32_16x16x32_bf16 v[120:123], v[208:211], v[48:51], v[120:123]
    ds_read_b64_tr_b16 v[204:205], v39
    ds_read_b64_tr_b16 v[206:207], v39 offset:512
    v_mfma_f32_16x16x32_bf16 v[124:127], v[212:215], v[48:51], v[124:127]
    ds_read_b64_tr_b16 v[208:209], v36 offset:4096
    ds_read_b64_tr_b16 v[210:211], v36 offset:4608
    v_mfma_f32_16x16x32_bf16 v[128:131], v[216:219], v[48:51], v[128:131]
    ds_read_b64_tr_b16 v[212:213], v37 offset:4096
    ds_read_b64_tr_b16 v[214:215], v37 offset:4608
    v_mfma_f32_16x16x32_bf16 v[132:135], v[220:223], v[48:51], v[132:135]
    ds_read_b64_tr_b16 v[216:217], v38 offset:4096
    ds_read_b64_tr_b16 v[218:219], v38 offset:4608
    buffer_load_dwordx4 v[48:51], v2, s[32:35], s20 offen offset:3072 sc1
    buffer_load_dwordx2 v[40:41], v10, s[32:35], s13 offen sc1
    s_add_u32 s82, s80, 114688
    buffer_load_dwordx4 v[72:75], v27, s[52:55], s82 offen nt
    s_add_u32 s82, s80, 172032
    buffer_load_dwordx4 v[76:79], v27, s[52:55], s82 offen nt
    s_waitcnt vmcnt(10)
    s_waitcnt lgkmcnt(6)
    v_mfma_f32_16x16x32_bf16 v[120:123], v[192:195], v[224:227], v[120:123]
    ds_read_b64_tr_b16 v[220:221], v39 offset:4096
    ds_read_b64_tr_b16 v[222:223], v39 offset:4608
    v_mfma_f32_16x16x32_bf16 v[124:127], v[196:199], v[224:227], v[124:127]
    ds_read_b64_tr_b16 v[192:193], v36 offset:8192
    ds_read_b64_tr_b16 v[194:195], v36 offset:8704
    v_mfma_f32_16x16x32_bf16 v[128:131], v[200:203], v[224:227], v[128:131]
    ds_read_b64_tr_b16 v[196:197], v37 offset:8192
    ds_read_b64_tr_b16 v[198:199], v37 offset:8704
    v_mfma_f32_16x16x32_bf16 v[132:135], v[204:207], v[224:227], v[132:135]
    ds_read_b64_tr_b16 v[200:201], v38 offset:8192
    ds_read_b64_tr_b16 v[202:203], v38 offset:8704
    s_waitcnt vmcnt(9)
    s_waitcnt lgkmcnt(6)
    v_mfma_f32_16x16x32_bf16 v[120:123], v[208:211], v[228:231], v[120:123]
    ds_read_b64_tr_b16 v[204:205], v39 offset:8192
    ds_read_b64_tr_b16 v[206:207], v39 offset:8704
    v_mfma_f32_16x16x32_bf16 v[124:127], v[212:215], v[228:231], v[124:127]
    ds_read_b64_tr_b16 v[208:209], v36 offset:12288
    ds_read_b64_tr_b16 v[210:211], v36 offset:12800
    v_xor_b32 v36, 16384, v36
    v_mfma_f32_16x16x32_bf16 v[128:131], v[216:219], v[228:231], v[128:131]
    ds_read_b64_tr_b16 v[212:213], v37 offset:12288
    ds_read_b64_tr_b16 v[214:215], v37 offset:12800
    v_xor_b32 v37, 16384, v37
    v_mfma_f32_16x16x32_bf16 v[132:135], v[220:223], v[228:231], v[132:135]
    ds_read_b64_tr_b16 v[216:217], v38 offset:12288
    ds_read_b64_tr_b16 v[218:219], v38 offset:12800
    v_xor_b32 v38, 16384, v38
    s_waitcnt vmcnt(8)
    s_waitcnt lgkmcnt(6)
    v_mfma_f32_16x16x32_bf16 v[120:123], v[192:195], v[232:235], v[120:123]
    ds_read_b64_tr_b16 v[220:221], v39 offset:12288
    ds_read_b64_tr_b16 v[222:223], v39 offset:12800
    v_xor_b32 v39, 16384, v39
    v_mfma_f32_16x16x32_bf16 v[124:127], v[196:199], v[232:235], v[124:127]
    ds_read_b64_tr_b16 v[192:193], v36
    ds_read_b64_tr_b16 v[194:195], v36 offset:512
    v_mfma_f32_16x16x32_bf16 v[128:131], v[200:203], v[232:235], v[128:131]
    ds_read_b64_tr_b16 v[196:197], v37
    ds_read_b64_tr_b16 v[198:199], v37 offset:512
    v_mfma_f32_16x16x32_bf16 v[132:135], v[204:207], v[232:235], v[132:135]
    ds_read_b64_tr_b16 v[200:201], v38
    ds_read_b64_tr_b16 v[202:203], v38 offset:512
    s_waitcnt vmcnt(7)
    s_waitcnt lgkmcnt(6)
    v_mfma_f32_16x16x32_bf16 v[120:123], v[208:211], v[236:239], v[120:123]
    ds_read_b64_tr_b16 v[204:205], v39
    ds_read_b64_tr_b16 v[206:207], v39 offset:512
    v_mfma_f32_16x16x32_bf16 v[124:127], v[212:215], v[236:239], v[124:127]
    ds_read_b64_tr_b16 v[208:209], v36 offset:4096
    ds_read_b64_tr_b16 v[210:211], v36 offset:4608
    v_mfma_f32_16x16x32_bf16 v[128:131], v[216:219], v[236:239], v[128:131]
    ds_read_b64_tr_b16 v[212:213], v37 offset:4096
    ds_read_b64_tr_b16 v[214:215], v37 offset:4608
    v_mfma_f32_16x16x32_bf16 v[132:135], v[220:223], v[236:239], v[132:135]
    ds_read_b64_tr_b16 v[216:217], v38 offset:4096
    ds_read_b64_tr_b16 v[218:219], v38 offset:4608
    s_cmp_lt_u32 s3, 4
    s_cbranch_scc1 L_G2P28
    s_setprio 0
L_G2P28:
    s_waitcnt vmcnt(6)
    s_waitcnt lgkmcnt(6)
    v_mfma_f32_16x16x32_bf16 v[120:123], v[192:195], v[240:243], v[120:123]
    ds_read_b64_tr_b16 v[220:221], v39 offset:4096
    ds_read_b64_tr_b16 v[222:223], v39 offset:4608
    v_mfma_f32_16x16x32_bf16 v[124:127], v[196:199], v[240:243], v[124:127]
    ds_read_b64_tr_b16 v[192:193], v36 offset:8192
    ds_read_b64_tr_b16 v[194:195], v36 offset:8704
    v_mfma_f32_16x16x32_bf16 v[128:131], v[200:203], v[240:243], v[128:131]
    ds_read_b64_tr_b16 v[196:197], v37 offset:8192
    ds_read_b64_tr_b16 v[198:199], v37 offset:8704
    v_mfma_f32_16x16x32_bf16 v[132:135], v[204:207], v[240:243], v[132:135]
    ds_read_b64_tr_b16 v[200:201], v38 offset:8192
    ds_read_b64_tr_b16 v[202:203], v38 offset:8704
    s_waitcnt vmcnt(5)
    s_waitcnt lgkmcnt(6)
    v_mfma_f32_16x16x32_bf16 v[120:123], v[208:211], v[244:247], v[120:123]
    ds_read_b64_tr_b16 v[204:205], v39 offset:8192
    ds_read_b64_tr_b16 v[206:207], v39 offset:8704
    v_mfma_f32_16x16x32_bf16 v[124:127], v[212:215], v[244:247], v[124:127]
    ds_read_b64_tr_b16 v[208:209], v36 offset:12288
    ds_read_b64_tr_b16 v[210:211], v36 offset:12800
    v_mfma_f32_16x16x32_bf16 v[128:131], v[216:219], v[244:247], v[128:131]
    ds_read_b64_tr_b16 v[212:213], v37 offset:12288
    ds_read_b64_tr_b16 v[214:215], v37 offset:12800
    v_mfma_f32_16x16x32_bf16 v[132:135], v[220:223], v[244:247], v[132:135]
    ds_read_b64_tr_b16 v[216:217], v38 offset:12288
    ds_read_b64_tr_b16 v[218:219], v38 offset:12800
    s_waitcnt vmcnt(4)
    s_waitcnt lgkmcnt(6)
    v_mfma_f32_16x16x32_bf16 v[120:123], v[192:195], v[44:47], v[120:123]
    ds_read_b64_tr_b16 v[220:221], v39 offset:12288
    ds_read_b64_tr_b16 v[222:223], v39 offset:12800
    v_mfma_f32_16x16x32_bf16 v[124:127], v[196:199], v[44:47], v[124:127]
    v_mfma_f32_16x16x32_bf16 v[128:131], v[200:203], v[44:47], v[128:131]
    v_mfma_f32_16x16x32_bf16 v[132:135], v[204:207], v[44:47], v[132:135]
    s_waitcnt vmcnt(3)
    s_waitcnt lgkmcnt(0)
    v_mfma_f32_16x16x32_bf16 v[120:123], v[208:211], v[48:51], v[120:123]
    v_mfma_f32_16x16x32_bf16 v[124:127], v[212:215], v[48:51], v[124:127]
    v_mfma_f32_16x16x32_bf16 v[128:131], v[216:219], v[48:51], v[128:131]
    v_mfma_f32_16x16x32_bf16 v[132:135], v[220:223], v[48:51], v[132:135]
    s_lshl3_add_u32 s96, s21, s3
    s_lshl4_add_u32 s97, s96, s12
    s_lshl_b32 s98, s97, 8
    s_add_u32 s14, s98, 12582912
    v_and_b32 v28, 15, v1
    v_lshlrev_b32 v28, 4, v28
    v_lshrrev_b32 v9, 4, v1
    v_lshl_add_u32 v28, v9, 2, v28
    v_cvt_pk_bf16_f32 v120, 0, v120
    v_cvt_pk_bf16_f32 v121, 0, v121
    v_cvt_pk_bf16_f32 v122, 0, v122
    v_cvt_pk_bf16_f32 v123, 0, v123
    v_cvt_pk_bf16_f32 v124, 0, v124
    v_cvt_pk_bf16_f32 v125, 0, v125
    v_cvt_pk_bf16_f32 v126, 0, v126
    v_cvt_pk_bf16_f32 v127, 0, v127
    v_pk_mul_f32 v[120:121], v[120:121], v[136:137]
    v_pk_mul_f32 v[122:123], v[122:123], v[138:139]
    v_pk_mul_f32 v[124:125], v[124:125], v[140:141]
    v_pk_mul_f32 v[126:127], v[126:127], v[142:143]
    v_cvt_pk_bf16_f32 v120, 0, v120
    v_cvt_pk_bf16_f32 v121, 0, v121
    v_cvt_pk_bf16_f32 v122, 0, v122
    v_cvt_pk_bf16_f32 v123, 0, v123
    v_cvt_pk_bf16_f32 v124, 0, v124
    v_cvt_pk_bf16_f32 v125, 0, v125
    v_cvt_pk_bf16_f32 v126, 0, v126
    v_cvt_pk_bf16_f32 v127, 0, v127
    v_pk_add_f32 v[120:121], v[120:121], v[152:153]
    v_pk_add_f32 v[122:123], v[122:123], v[154:155]
    v_pk_add_f32 v[124:125], v[124:125], v[156:157]
    v_pk_add_f32 v[126:127], v[126:127], v[158:159]
    v_cvt_pk_bf16_f32 v12, v120, v121
    v_cvt_pk_bf16_f32 v13, v122, v123
    v_cvt_pk_bf16_f32 v14, v124, v125
    v_cvt_pk_bf16_f32 v15, v126, v127
    v_dot2_f32_bf16 v4, v12, v12, 0
    v_dot2_f32_bf16 v5, v13, v13, 0
    v_dot2_f32_bf16 v4, v14, v14, v4
    v_dot2_f32_bf16 v5, v15, v15, v5
    v_mfma_f32_16x16x32_bf16 v[240:243], v[184:187], v[12:15], 0
    v_cvt_pk_bf16_f32 v128, 0, v128
    v_cvt_pk_bf16_f32 v129, 0, v129
    v_cvt_pk_bf16_f32 v130, 0, v130
    v_cvt_pk_bf16_f32 v131, 0, v131
    v_cvt_pk_bf16_f32 v132, 0, v132
    v_cvt_pk_bf16_f32 v133, 0, v133
    v_cvt_pk_bf16_f32 v134, 0, v134
    v_cvt_pk_bf16_f32 v135, 0, v135
    v_pk_mul_f32 v[128:129], v[128:129], v[144:145]
    v_pk_mul_f32 v[130:131], v[130:131], v[146:147]
    v_pk_mul_f32 v[132:133], v[132:133], v[148:149]
    v_pk_mul_f32 v[134:135], v[134:135], v[150:151]
    v_cvt_pk_bf16_f32 v128, 0, v128
    v_cvt_pk_bf16_f32 v129, 0, v129
    v_cvt_pk_bf16_f32 v130, 0, v130
    v_cvt_pk_bf16_f32 v131, 0, v131
    v_cvt_pk_bf16_f32 v132, 0, v132
    v_cvt_pk_bf16_f32 v133, 0, v133
    v_cvt_pk_bf16_f32 v134, 0, v134
    v_cvt_pk_bf16_f32 v135, 0, v135
    v_pk_add_f32 v[128:129], v[128:129], v[160:161]
    v_pk_add_f32 v[130:131], v[130:131], v[162:163]
    v_pk_add_f32 v[132:133], v[132:133], v[164:165]
    v_pk_add_f32 v[134:135], v[134:135], v[166:167]
    v_cvt_pk_bf16_f32 v16, v128, v129
    v_cvt_pk_bf16_f32 v17, v130, v131
    v_cvt_pk_bf16_f32 v18, v132, v133
    v_cvt_pk_bf16_f32 v19, v134, v135
    v_dot2_f32_bf16 v4, v16, v16, v4
    v_dot2_f32_bf16 v5, v17, v17, v5
    v_dot2_f32_bf16 v4, v18, v18, v4
    v_dot2_f32_bf16 v5, v19, v19, v5
    v_mfma_f32_16x16x32_bf16 v[240:243], v[188:191], v[16:19], v[240:243]
    v_and_b32 v7, 7, v1
    v_lshlrev_b32 v7, 15, v7
    v_bfe_u32 v9, v1, 3, 1
    v_lshl_add_u32 v7, v9, 12, v7
    v_add_f32 v4, v4, v5
    v_mov_b32 v5, v4
    s_nop 1
    v_permlane32_swap_b32 v4, v5
    v_add_f32 v4, v4, v5
    v_mov_b32 v5, v4
    s_nop 1
    v_permlane16_swap_b32 v4, v5
    v_add_f32 v4, v4, v5
    s_nop 1
    v_mov_b32_dpp v240, v4 quad_perm:[0,1,2,3] row_mask:0x8 bank_mask:0xf
    buffer_store_dword v240, v28, s[32:35], s14 offen sc1
    s_and_b32 s96, s12, 1
    s_lshr_b32 s97, s21, 2
    s_and_b32 s98, s21, 3
    s_lshl_b32 s99, s98, 6
    s_lshl1_add_u32 s98, s97, s99
    s_lshl_b32 s97, s98, 12
    s_lshr_b32 s99, s12, 1
    s_lshl_b32 s98, s99, 6
    s_add_u32 s99, s97, s98
    s_lshl2_add_u32 s97, s96, s99
    s_add_u32 s98, s97, 1048576
    s_add_u32 s16, s98, 1536
    s_barrier
    s_cmp_lg_u32 s3, 0
    s_cbranch_scc1 L_PE
    v_mov_b32 v6, s4
    s_mov_b32 exec_hi, 0
    s_mov_b32 exec_lo, 65535
    buffer_store_dword v6, v7, s[32:35], s16 offen sc1
    s_mov_b64 exec, -1
L_PE:
    s_mov_b32 s82, s80
    s_lshl2_add_u32 m0, s83, 32768
    s_nop 0
    buffer_load_dwordx4 v27, s[56:59], s82 offen nt lds
    s_add_u32 s82, s80, 57344
    s_lshl2_add_u32 m0, s83, 33792
    s_nop 0
    buffer_load_dwordx4 v27, s[56:59], s82 offen nt lds
    s_lshl_b32 s15, s3, 12
    v_add_u32 v4, s15, v2
    v_add_u32 v7, 65536, v4
    s_waitcnt vmcnt(5)
    v_cmp_ne_u32 vcc, s4, v41
    s_cbranch_vccz L_UPOK
POLL_34:
    buffer_load_dwordx2 v[40:41], v10, s[32:35], s13 offen sc1
    s_waitcnt vmcnt(0)
    v_cmp_ne_u32 vcc, s4, v41
    s_cbranch_vccz PDONE_35
    s_add_u32 s5, s5, 1
    s_cmp_lt_u32 s5, 200000
    s_cbranch_scc1 POLL_34
PDONE_35:
L_UPOK:
    s_lshl3_add_u32 s96, s21, s3
    s_lshl_b32 s97, s96, 12
    s_add_u32 s14, s97, 12582912
    s_load_dwordx2 s[24:25], s[32:33], s92 offset:1536 glc
    v_add_f32_dpp v40, v40, v40 quad_perm:[1,0,3,2] row_mask:0xf bank_mask:0xf
    s_nop 1
    v_add_f32_dpp v40, v40, v40 quad_perm:[2,3,0,1] row_mask:0xf bank_mask:0xf
    s_nop 1
    v_add_f32_dpp v40, v40, v40 row_half_mirror row_mask:0xf bank_mask:0xf
    s_nop 1
    v_add_f32_dpp v40, v40, v40 row_mirror row_mask:0xf bank_mask:0xf
    v_lshlrev_b32 v152, 16, v12
    v_and_b32 v153, s6, v12
    v_lshlrev_b32 v154, 16, v13
    v_and_b32 v155, s6, v13
    v_lshlrev_b32 v156, 16, v14
    v_and_b32 v157, s6, v14
    v_lshlrev_b32 v158, 16, v15
    v_and_b32 v159, s6, v15
    v_lshlrev_b32 v160, 16, v16
    v_and_b32 v161, s6, v16
    v_lshlrev_b32 v162, 16, v17
    v_and_b32 v163, s6, v17
    v_lshlrev_b32 v164, 16, v18
    v_and_b32 v165, s6, v18
    v_lshlrev_b32 v166, 16, v19
    v_and_b32 v167, s6, v19
    s_lshl_b32 s96, s3, 9
    s_lshl1_add_u32 s15, s21, s96
    v_and_b32 v29, 15, v1
    v_lshl_add_u32 v29, v29, 5, s15
    v_xor_b32 v5, 0x4000, v4
    v_xor_b32 v8, 0x4000, v7
    s_waitcnt vmcnt(3)
    ds_write_b128 v4, v[72:75] offset:2048
    ds_write_b128 v4, v[76:79] offset:3072
    s_cmp_lt_u32 s3, 4
    s_cbranch_scc1 L_FW1
    ds_write_b128 v4, v[56:59] offset:0
    ds_write_b128 v5, v[60:63] offset:0
    ds_write_b128 v4, v[64:67] offset:1024
    ds_write_b128 v5, v[68:71] offset:1024
L_FW1:
    s_branch SCHK_37
SPOLL_36:
    s_load_dwordx2 s[24:25], s[32:33], s92 offset:1536 glc
SCHK_37:
    s_add_u32 s5, s5, 1
    s_cmp_ge_u32 s5, 200000
    s_waitcnt lgkmcnt(0)
    s_cbranch_scc1 SDONE_38
    s_cmp_lg_u32 s24, s4
    s_cbranch_scc1 SPOLL_36
    s_cmp_lg_u32 s25, s4
    s_cbranch_scc1 SPOLL_36
SDONE_38:
    s_barrier
    buffer_load_dwordx4 v[192:195], v2, s[32:35], s14 offen sc1
    buffer_load_dwordx4 v[196:199], v2, s[32:35], s14 offen offset:1024 sc1
    buffer_load_dwordx4 v[200:203], v2, s[32:35], s14 offen offset:2048 sc1
    buffer_load_dwordx4 v[204:207], v2, s[32:35], s14 offen offset:3072 sc1
    s_barrier
    s_add_u32 s82, s80, 114688
    s_lshl2_add_u32 m0, s83, 34816
    s_nop 0
    buffer_load_dwordx4 v27, s[56:59], s82 offen nt lds
    s_add_u32 s82, s80, 172032
    s_lshl2_add_u32 m0, s83, 35840
    s_nop 0
    buffer_load_dwordx4 v27, s[56:59], s82 offen nt lds
    v_mov_b32_dpp v168, v33 row_newbcast:0 row_mask:0xf bank_mask:0xf
    v_mov_b32_dpp v169, v33 row_newbcast:1 row_mask:0xf bank_mask:0xf
    v_mov_b32_dpp v170, v33 row_newbcast:2 row_mask:0xf bank_mask:0xf
    v_mov_b32_dpp v171, v33 row_newbcast:3 row_mask:0xf bank_mask:0xf
    v_mov_b32_dpp v172, v33 row_newbcast:4 row_mask:0xf bank_mask:0xf
    v_mov_b32_dpp v173, v33 row_newbcast:5 row_mask:0xf bank_mask:0xf
    v_mov_b32_dpp v174, v33 row_newbcast:6 row_mask:0xf bank_mask:0xf
    v_mov_b32_dpp v175, v33 row_newbcast:7 row_mask:0xf bank_mask:0xf
    v_mov_b32_dpp v176, v33 row_newbcast:8 row_mask:0xf bank_mask:0xf
    v_mov_b32_dpp v177, v33 row_newbcast:9 row_mask:0xf bank_mask:0xf
    v_mov_b32_dpp v178, v33 row_newbcast:10 row_mask:0xf bank_mask:0xf
    v_mov_b32_dpp v179, v33 row_newbcast:11 row_mask:0xf bank_mask:0xf
    v_mov_b32_dpp v180, v33 row_newbcast:12 row_mask:0xf bank_mask:0xf
    v_mov_b32_dpp v181, v33 row_newbcast:13 row_mask:0xf bank_mask:0xf
    v_mov_b32_dpp v182, v33 row_newbcast:14 row_mask:0xf bank_mask:0xf
    v_mov_b32_dpp v183, v33 row_newbcast:15 row_mask:0xf bank_mask:0xf
    v_mov_b32_dpp v88, v42 row_newbcast:0 row_mask:0xf bank_mask:0xf
    v_mov_b32_dpp v89, v42 row_newbcast:1 row_mask:0xf bank_mask:0xf
    v_mov_b32_dpp v90, v42 row_newbcast:2 row_mask:0xf bank_mask:0xf
    v_mov_b32_dpp v91, v42 row_newbcast:3 row_mask:0xf bank_mask:0xf
    v_mov_b32_dpp v92, v42 row_newbcast:4 row_mask:0xf bank_mask:0xf
    v_mov_b32_dpp v93, v42 row_newbcast:5 row_mask:0xf bank_mask:0xf
    v_mov_b32_dpp v94, v42 row_newbcast:6 row_mask:0xf bank_mask:0xf
    v_mov_b32_dpp v95, v42 row_newbcast:7 row_mask:0xf bank_mask:0xf
    v_mov_b32_dpp v96, v42 row_newbcast:8 row_mask:0xf bank_mask:0xf
    v_mov_b32_dpp v97, v42 row_newbcast:9 row_mask:0xf bank_mask:0xf
    v_mov_b32_dpp v98, v42 row_newbcast:10 row_mask:0xf bank_mask:0xf
    v_mov_b32_dpp v99, v42 row_newbcast:11 row_mask:0xf bank_mask:0xf
    v_mov_b32_dpp v100, v42 row_newbcast:12 row_mask:0xf bank_mask:0xf
    v_mov_b32_dpp v101, v42 row_newbcast:13 row_mask:0xf bank_mask:0xf
    v_mov_b32_dpp v102, v42 row_newbcast:14 row_mask:0xf bank_mask:0xf
    v_mov_b32_dpp v103, v42 row_newbcast:15 row_mask:0xf bank_mask:0xf
    v_mov_b32_dpp v104, v43 row_newbcast:0 row_mask:0xf bank_mask:0xf
    v_mov_b32_dpp v105, v43 row_newbcast:1 row_mask:0xf bank_mask:0xf
    v_mov_b32_dpp v106, v43 row_newbcast:2 row_mask:0xf bank_mask:0xf
    v_mov_b32_dpp v107, v43 row_newbcast:3 row_mask:0xf bank_mask:0xf
    v_mov_b32_dpp v108, v43 row_newbcast:4 row_mask:0xf bank_mask:0xf
    v_mov_b32_dpp v109, v43 row_newbcast:5 row_mask:0xf bank_mask:0xf
    v_mov_b32_dpp v110, v43 row_newbcast:6 row_mask:0xf bank_mask:0xf
    v_mov_b32_dpp v111, v43 row_newbcast:7 row_mask:0xf bank_mask:0xf
    v_mov_b32_dpp v112, v43 row_newbcast:8 row_mask:0xf bank_mask:0xf
    v_mov_b32_dpp v113, v43 row_newbcast:9 row_mask:0xf bank_mask:0xf
    v_mov_b32_dpp v114, v43 row_newbcast:10 row_mask:0xf bank_mask:0xf
    v_mov_b32_dpp v115, v43 row_newbcast:11 row_mask:0xf bank_mask:0xf
    v_mov_b32_dpp v116, v43 row_newbcast:12 row_mask:0xf bank_mask:0xf
    v_mov_b32_dpp v117, v43 row_newbcast:13 row_mask:0xf bank_mask:0xf
    v_mov_b32_dpp v118, v43 row_newbcast:14 row_mask:0xf bank_mask:0xf
    v_mov_b32_dpp v119, v43 row_newbcast:15 row_mask:0xf bank_mask:0xf
    s_lshl3_add_u32 s15, s3, 156160
    v_mov_b32 v4, s15
    v_and_b32 v5, 7, v1
    v_lshlrev_b32 v5, 3, v5
    v_add_u32 v5, 156160, v5
    v_and_b32 v6, 3, v1
    v_lshlrev_b32 v6, 18, v6
    v_bfe_u32 v9, v1, 2, 2
    v_lshl_add_u32 v6, v9, 13, v6
    s_and_b32 s96, s21, 1
    s_and_b32 s97, s12, 7
    s_lshr_b32 s98, s12, 3
    s_lshl3_add_u32 s99, s97, s98
    s_lshl_b32 s97, s99, 12
    s_lshr_b32 s98, s21, 1
    s_lshl_b32 s99, s98, 6
    s_add_u32 s98, s97, s99
    s_lshl4_add_u32 s97, s96, s98
    s_add_u32 s99, s97, 1048576
    s_add_u32 s16, s99, 2560
    s_waitcnt vmcnt(2)
    v_pk_add_f32 v[192:193], v[192:193], v[196:197]
    v_pk_add_f32 v[200:201], v[200:201], v[204:205]
    v_pk_add_f32 v[194:195], v[194:195], v[198:199]
    v_pk_add_f32 v[202:203], v[202:203], v[206:207]
    v_pk_add_f32 v[192:193], v[192:193], v[200:201]
    v_pk_add_f32 v[194:195], v[194:195], v[202:203]
    v_add_f32 v193, v193, v194
    v_add_f32 v197, v192, v195
    v_cmp_u_f32 vcc, v193, v197
    s_cbranch_vccz POK_40
PRE_41:
    buffer_load_dwordx4 v[192:195], v2, s[32:35], s14 offen sc1
    buffer_load_dwordx4 v[196:199], v2, s[32:35], s14 offen offset:1024 sc1
    buffer_load_dwordx4 v[200:203], v2, s[32:35], s14 offen offset:2048 sc1
    buffer_load_dwordx4 v[204:207], v2, s[32:35], s14 offen offset:3072 sc1
    s_waitcnt vmcnt(0)
    v_pk_add_f32 v[192:193], v[192:193], v[196:197]
    v_pk_add_f32 v[200:201], v[200:201], v[204:205]
    v_pk_add_f32 v[194:195], v[194:195], v[198:199]
L_PAD9:
    s_cbranch_execz L_RET9
    v_pk_add_f32 v[202:203], v[202:203], v[206:207]
    v_pk_add_f32 v[192:193], v[192:193], v[200:201]
    v_pk_add_f32 v[194:195], v[194:195], v[202:203]
    v_add_f32 v193, v193, v194
    v_add_f32 v197, v192, v195
    v_cmp_u_f32 vcc, v193, v197
    s_cbranch_vccz POK_40
    s_add_u32 s5, s5, 1
    s_cmp_lt_u32 s5, 200000
    s_cbranch_scc1 PRE_41
POK_40:
    v_mov_b32 v196, v195
    s_nop 1
    v_permlane32_swap_b32 v195, v196
    v_permlane32_swap_b32 v192, v193
    v_add_f32 v195, v195, v196
    v_add_f32 v192, v192, v193
    s_nop 1
    v_permlane16_swap_b32 v192, v195
    v_add_f32 v193, v192, v195
    v_add_f32 v195, v192, v195
    s_nop 1
    v_permlane16_swap_b32 v193, v195
    v_mov_b32 v192, v193
    v_mul_f32 v195, 0x3a800000, v195
    s_nop 0
    v_permlane32_swap_b32 v192, v193
    v_mul_f32 v192, 0x3a800000, v192
    v_fma_f32 v31, -v192, v192, v195
    v_cvt_pk_bf16_f32 v30, 0, v192
    v_max_f32 v31, 0, v31
    v_cvt_pk_bf16_f32 v31, 0, v31
    v_fma_f32 v193, -v30, v40, v193
    v_add_f32 v31, 0x3727c5ac, v31
    v_cvt_pk_bf16_f32 v31, 0, v31
    v_sqrt_f32 v31, v31
    s_nop 0
    v_cvt_pk_bf16_f32 v31, 0, v31
    v_rcp_f32 v31, v31
    s_nop 0
    v_mul_f32 v32, v193, v31
    v_ashrrev_i32 v196, 31, v32
    v_or_b32 v196, 0x80000000, v196
    v_xor_b32 v32, v32, v196
    s_mov_b32 s15, 0xfffff000
    v_and_or_b32 v32, v32, s15, v29
    s_nop 1
    v_max_u32_dpp v244, v32, v32 quad_perm:[1,0,3,2] row_mask:0xf bank_mask:0xf
    v_min_u32_dpp v245, v32, v32 quad_perm:[1,0,3,2] row_mask:0xf bank_mask:0xf
    s_nop 0
    v_min_u32_dpp v196, v244, v244 quad_perm:[2,3,0,1] row_mask:0xf bank_mask:0xf
    v_max_u32_dpp v245, v245, v245 quad_perm:[2,3,0,1] row_mask:0xf bank_mask:0xf
    v_max_u32_dpp v244, v244, v244 quad_perm:[2,3,0,1] row_mask:0xf bank_mask:0xf
    v_max_u32 v245, v245, v196
    s_nop 0
    v_min_u32_dpp v196, v244, v244 row_half_mirror row_mask:0xf bank_mask:0xf
    v_max_u32_dpp v245, v245, v245 row_half_mirror row_mask:0xf bank_mask:0xf
    v_max_u32_dpp v244, v244, v244 row_half_mirror row_mask:0xf bank_mask:0xf
    v_max_u32 v245, v245, v196
    s_nop 0
    v_min_u32_dpp v196, v244, v244 row_mirror row_mask:0xf bank_mask:0xf
    v_max_u32_dpp v245, v245, v245 row_mirror row_mask:0xf bank_mask:0xf
    v_max_u32_dpp v244, v244, v244 row_mirror row_mask:0xf bank_mask:0xf
    v_max_u32 v245, v245, v196
    ds_write_b64 v4, v[244:245]
    s_waitcnt lgkmcnt(0)
    s_barrier
    ds_read_b64 v[244:245], v5
    v_pk_add_f32 v[208:209], v[152:153], v[30:31] op_sel_hi:[1,0] neg_lo:[0,1] neg_hi:[0,1]
    v_pk_add_f32 v[210:211], v[154:155], v[30:31] op_sel_hi:[1,0] neg_lo:[0,1] neg_hi:[0,1]
    v_pk_add_f32 v[212:213], v[156:157], v[30:31] op_sel_hi:[1,0] neg_lo:[0,1] neg_hi:[0,1]
    v_pk_add_f32 v[214:215], v[158:159], v[30:31] op_sel_hi:[1,0] neg_lo:[0,1] neg_hi:[0,1]
    v_pk_add_f32 v[216:217], v[160:161], v[30:31] op_sel_hi:[1,0] neg_lo:[0,1] neg_hi:[0,1]
    v_pk_add_f32 v[218:219], v[162:163], v[30:31] op_sel_hi:[1,0] neg_lo:[0,1] neg_hi:[0,1]
    v_pk_add_f32 v[220:221], v[164:165], v[30:31] op_sel_hi:[1,0] neg_lo:[0,1] neg_hi:[0,1]
    v_pk_add_f32 v[222:223], v[166:167], v[30:31] op_sel_hi:[1,0] neg_lo:[0,1] neg_hi:[0,1]
    s_waitcnt lgkmcnt(0)
    v_min_u32_dpp v196, v244, v244 quad_perm:[1,0,3,2] row_mask:0xf bank_mask:0xf
    v_max_u32_dpp v245, v245, v245 quad_perm:[1,0,3,2] row_mask:0xf bank_mask:0xf
    v_max_u32_dpp v244, v244, v244 quad_perm:[1,0,3,2] row_mask:0xf bank_mask:0xf
    v_max_u32 v245, v245, v196
    s_nop 0
    v_min_u32_dpp v196, v244, v244 quad_perm:[2,3,0,1] row_mask:0xf bank_mask:0xf
    v_max_u32_dpp v245, v245, v245 quad_perm:[2,3,0,1] row_mask:0xf bank_mask:0xf
    v_max_u32_dpp v244, v244, v244 quad_perm:[2,3,0,1] row_mask:0xf bank_mask:0xf
    v_max_u32 v245, v245, v196
    s_nop 0
    v_min_u32_dpp v196, v244, v244 row_half_mirror row_mask:0xf bank_mask:0xf
    v_max_u32_dpp v245, v245, v245 row_half_mirror row_mask:0xf bank_mask:0xf
    v_max_u32_dpp v244, v244, v244 row_half_mirror row_mask:0xf bank_mask:0xf
    v_max_u32 v245, v245, v196
    v_cmp_eq_u32 s[88:89], v32, v245
    v_cmp_eq_u32 vcc, v32, v244
    v_or_b32 v246, 1, v245
    v_mov_b32 v245, s4
    v_mov_b32 v247, s4
    s_or_b64 s[84:85], vcc, s[88:89]
    s_cmp_lg_u32 s3, 0
    s_cbranch_scc1 L_NOF
    s_mov_b64 exec, 0xffff
    buffer_store_dwordx4 v[244:247], v6, s[32:35], s16 offen sc1
    s_mov_b64 exec, -1
L_NOF:
    s_cmp_eq_u64 s[84:85], 0
    s_cbranch_scc1 L_NOPR
    s_setprio 1
L_NOPR:
    s_lshl4_add_u32 s13, s3, 156288
    v_mov_b32 v4, s13
    v_and_b32 v5, 7, v1
    v_lshlrev_b32 v5, 4, v5
    v_add_u32 v5, 156288, v5
    s_load_dwordx8 s[24:31], s[32:33], s92 offset:2560 glc
    v_cvt_pk_bf16_f32 v208, 0, v208
    v_cvt_pk_bf16_f32 v209, 0, v209
    v_cvt_pk_bf16_f32 v210, 0, v210
    v_cvt_pk_bf16_f32 v211, 0, v211
    v_cvt_pk_bf16_f32 v212, 0, v212
    v_cvt_pk_bf16_f32 v213, 0, v213
    v_cvt_pk_bf16_f32 v214, 0, v214
    v_cvt_pk_bf16_f32 v215, 0, v215
    v_cvt_pk_bf16_f32 v216, 0, v216
    v_cvt_pk_bf16_f32 v217, 0, v217
    v_cvt_pk_bf16_f32 v218, 0, v218
    v_cvt_pk_bf16_f32 v219, 0, v219
    v_cvt_pk_bf16_f32 v220, 0, v220
    v_cvt_pk_bf16_f32 v221, 0, v221
    v_cvt_pk_bf16_f32 v222, 0, v222
    v_cvt_pk_bf16_f32 v223, 0, v223
    v_pk_mul_f32 v[208:209], v[30:31], v[208:209] op_sel:[1,0]
    v_pk_mul_f32 v[210:211], v[30:31], v[210:211] op_sel:[1,0]
    v_pk_mul_f32 v[212:213], v[30:31], v[212:213] op_sel:[1,0]
    v_pk_mul_f32 v[214:215], v[30:31], v[214:215] op_sel:[1,0]
    v_pk_mul_f32 v[216:217], v[30:31], v[216:217] op_sel:[1,0]
    v_pk_mul_f32 v[218:219], v[30:31], v[218:219] op_sel:[1,0]
    v_pk_mul_f32 v[220:221], v[30:31], v[220:221] op_sel:[1,0]
    v_pk_mul_f32 v[222:223], v[30:31], v[222:223] op_sel:[1,0]
    v_cvt_pk_bf16_f32 v208, 0, v208
    v_cvt_pk_bf16_f32 v209, 0, v209
    v_cvt_pk_bf16_f32 v210, 0, v210
    v_cvt_pk_bf16_f32 v211, 0, v211
    v_cvt_pk_bf16_f32 v212, 0, v212
    v_cvt_pk_bf16_f32 v213, 0, v213
    v_cvt_pk_bf16_f32 v214, 0, v214
    v_cvt_pk_bf16_f32 v215, 0, v215
    v_cvt_pk_bf16_f32 v216, 0, v216
    v_cvt_pk_bf16_f32 v217, 0, v217
    v_cvt_pk_bf16_f32 v218, 0, v218
    v_cvt_pk_bf16_f32 v219, 0, v219
    v_cvt_pk_bf16_f32 v220, 0, v220
    v_cvt_pk_bf16_f32 v221, 0, v221
    v_cvt_pk_bf16_f32 v222, 0, v222
    v_cvt_pk_bf16_f32 v223, 0, v223
    v_pk_mul_f32 v[208:209], v[208:209], v[168:169]
    v_pk_mul_f32 v[210:211], v[210:211], v[170:171]
    v_pk_mul_f32 v[212:213], v[212:213], v[172:173]
    v_pk_mul_f32 v[214:215], v[214:215], v[174:175]
    v_pk_mul_f32 v[216:217], v[216:217], v[176:177]
    v_pk_mul_f32 v[218:219], v[218:219], v[178:179]
    v_pk_mul_f32 v[220:221], v[220:221], v[180:181]
    v_pk_mul_f32 v[222:223], v[222:223], v[182:183]
    v_cvt_pk_bf16_f32 v208, 0, v208
    v_cvt_pk_bf16_f32 v209, 0, v209
    v_cvt_pk_bf16_f32 v210, 0, v210
    v_cvt_pk_bf16_f32 v211, 0, v211
    v_cvt_pk_bf16_f32 v212, 0, v212
    v_cvt_pk_bf16_f32 v213, 0, v213
    v_cvt_pk_bf16_f32 v214, 0, v214
    v_cvt_pk_bf16_f32 v215, 0, v215
    v_cvt_pk_bf16_f32 v216, 0, v216
    v_cvt_pk_bf16_f32 v217, 0, v217
    v_cvt_pk_bf16_f32 v218, 0, v218
    v_cvt_pk_bf16_f32 v219, 0, v219
    v_cvt_pk_bf16_f32 v220, 0, v220
    v_cvt_pk_bf16_f32 v221, 0, v221
    v_cvt_pk_bf16_f32 v222, 0, v222
    v_cvt_pk_bf16_f32 v223, 0, v223
    v_pk_add_f32 v[208:209], v[208:209], v[88:89]
    v_pk_add_f32 v[210:211], v[210:211], v[90:91]
    v_pk_add_f32 v[212:213], v[212:213], v[92:93]
    v_pk_add_f32 v[214:215], v[214:215], v[94:95]
    v_pk_add_f32 v[216:217], v[216:217], v[96:97]
    v_pk_add_f32 v[218:219], v[218:219], v[98:99]
    v_pk_add_f32 v[220:221], v[220:221], v[100:101]
    v_pk_add_f32 v[222:223], v[222:223], v[102:103]
    v_cvt_pk_bf16_f32 v224, v208, v209
    v_cvt_pk_bf16_f32 v225, v210, v211
    v_cvt_pk_bf16_f32 v226, v212, v213
    v_cvt_pk_bf16_f32 v227, v214, v215
    v_cvt_pk_bf16_f32 v228, v216, v217
    v_cvt_pk_bf16_f32 v229, v218, v219
    v_cvt_pk_bf16_f32 v230, v220, v221
    v_cvt_pk_bf16_f32 v231, v222, v223
    s_cmp_eq_u64 s[84:85], 0
    s_cbranch_scc1 L_NOCAND
    v_mfma_f32_16x16x32_bf16 v[240:243], v[184:187], v[224:227], 0
    v_mfma_f32_16x16x32_bf16 v[240:243], v[188:191], v[228:231], v[240:243]
    v_mov_b32 v232, v224
    v_mov_b32 v233, v225
    v_mov_b32 v234, v226
    v_mov_b32 v235, v227
    v_mov_b32 v236, v228
    v_mov_b32 v237, v229
    v_mov_b32 v238, v230
    v_mov_b32 v239, v231
    s_lshl_b32 s96, s21, 14
    s_lshl_b32 s97, s12, 9
    s_add_u32 s98, s96, s97
    s_add_u32 s15, s98, 13631488
    v_lshrrev_b32 v7, 4, v1
    v_lshlrev_b32 v7, 4, v7
    v_add_u32 v8, 8192, v7
    v_permlane32_swap_b32 v232, v234
    v_permlane32_swap_b32 v233, v235
    v_permlane32_swap_b32 v236, v238
    v_permlane32_swap_b32 v237, v239
    v_permlane32_swap_b32 v12, v14
    v_permlane32_swap_b32 v13, v15
    v_permlane32_swap_b32 v16, v18
    v_permlane32_swap_b32 v17, v19
    v_cndmask_b32 v7, v7, v8, s[88:89]
    s_mov_b64 exec, s[84:85]
    buffer_store_dwordx4 v[232:235], v7, s[32:35], s15 offen sc1
    buffer_store_dwordx4 v[236:239], v7, s[32:35], s15 offen offset:64 sc1
    s_mov_b32 exec_lo, 0
    s_and_b32 exec_hi, s85, 0xffff0000
    buffer_store_dword v240, v7, s[32:35], s15 offen offset:208 sc1
    s_mov_b64 exec, s[84:85]
    buffer_store_dwordx4 v[12:15], v7, s[32:35], s15 offen offset:128 sc1
    buffer_store_dwordx4 v[16:19], v7, s[32:35], s15 offen offset:192 sc1
    s_mov_b64 exec, -1
    s_setprio 0
L_NOCAND:
    s_mov_b32 s82, s81
    s_lshl2_add_u32 m0, s83, 65536
    s_nop 0
    buffer_load_dwordx4 v253, s[60:63], s82 offen nt lds
    s_add_u32 s82, s81, 4096
    s_lshl2_add_u32 m0, s83, 66560
    s_nop 0
    buffer_load_dwordx4 v253, s[60:63], s82 offen nt lds
    v_lshlrev_b32 v208, 16, v224
    v_and_b32 v209, s6, v224
    v_lshlrev_b32 v210, 16, v225
    v_and_b32 v211, s6, v225
    v_lshlrev_b32 v212, 16, v226
    v_and_b32 v213, s6, v226
    v_lshlrev_b32 v214, 16, v227
    v_and_b32 v215, s6, v227
    v_lshlrev_b32 v216, 16, v228
    v_and_b32 v217, s6, v228
    v_lshlrev_b32 v218, 16, v229
    v_and_b32 v219, s6, v229
    v_lshlrev_b32 v220, 16, v230
    v_and_b32 v221, s6, v230
    v_lshlrev_b32 v222, 16, v231
    v_and_b32 v223, s6, v231
    v_pk_mul_f32 v[208:209], v[208:209], v[104:105]
    v_pk_mul_f32 v[210:211], v[210:211], v[106:107]
    v_pk_mul_f32 v[212:213], v[212:213], v[108:109]
    v_pk_mul_f32 v[214:215], v[214:215], v[110:111]
    v_pk_mul_f32 v[216:217], v[216:217], v[112:113]
    v_pk_mul_f32 v[218:219], v[218:219], v[114:115]
    v_pk_mul_f32 v[220:221], v[220:221], v[116:117]
    v_pk_mul_f32 v[222:223], v[222:223], v[118:119]
    v_cvt_pk_bf16_f32 v208, 0, v208
    v_cvt_pk_bf16_f32 v209, 0, v209
    v_cvt_pk_bf16_f32 v210, 0, v210
    v_cvt_pk_bf16_f32 v211, 0, v211
    v_cvt_pk_bf16_f32 v212, 0, v212
    v_cvt_pk_bf16_f32 v213, 0, v213
    v_cvt_pk_bf16_f32 v214, 0, v214
    v_cvt_pk_bf16_f32 v215, 0, v215
    v_cvt_pk_bf16_f32 v216, 0, v216
    v_cvt_pk_bf16_f32 v217, 0, v217
    v_cvt_pk_bf16_f32 v218, 0, v218
    v_cvt_pk_bf16_f32 v219, 0, v219
    v_cvt_pk_bf16_f32 v220, 0, v220
    v_cvt_pk_bf16_f32 v221, 0, v221
    v_cvt_pk_bf16_f32 v222, 0, v222
    v_cvt_pk_bf16_f32 v223, 0, v223
    s_lshl_b32 s96, s3, 11
    s_add_u32 s13, s96, 98304
    v_lshrrev_b32 v202, 4, v1
    v_lshlrev_b32 v202, 4, v202
    v_and_b32 v203, 7, v1
    v_lshlrev_b32 v203, 4, v203
    v_xor_b32 v202, v202, v203
    v_and_b32 v204, 15, v1
    v_lshl_add_u32 v204, v204, 7, s13
    v_add_u32 v202, v202, v204
    v_xor_b32 v204, 64, v202
    v_lshrrev_b32 v205, 3, v1
    v_lshlrev_b32 v205, 4, v205
    v_xor_b32 v203, v205, v203
    v_lshrrev_b32 v205, 3, v1
    v_lshl_add_u32 v205, v205, 7, s13
    v_add_u32 v203, v203, v205
    s_lshl_b32 s96, s21, 7
    s_sub_u32 s97, 2047, s96
    s_lshl_b32 s98, s3, 4
    s_sub_u32 s13, s97, s98
    v_lshrrev_b32 v43, 3, v1
    v_sub_u32 v42, s13, v43
    v_subrev_u32 v43, 8, v42
    v_lshrrev_b32 v33, 3, v1
    v_lshlrev_b32 v33, 11, v33
    v_and_b32 v9, 7, v1
    v_lshl_add_u32 v33, v9, 4, v33
    s_lshl3_add_u32 s96, s21, s3
    s_lshl_b32 s97, s96, 15
    s_lshl_b32 s98, s12, 7
    s_add_u32 s16, s97, s98
    s_add_u32 s15, s16, 16384
    s_branch SCHK_43
SPOLL_42:
    s_load_dwordx8 s[24:31], s[32:33], s92 offset:2560 glc
SCHK_43:
    s_add_u32 s5, s5, 1
    s_cmp_ge_u32 s5, 200000
    s_waitcnt lgkmcnt(0)
    s_cbranch_scc1 SDONE_44
    s_cmp_lg_u32 s25, s4
    s_cbranch_scc1 SPOLL_42
    s_cmp_lg_u32 s27, s4
    s_cbranch_scc1 SPOLL_42
    s_cmp_lg_u32 s29, s4
    s_cbranch_scc1 SPOLL_42
    s_cmp_lg_u32 s31, s4
    s_cbranch_scc1 SPOLL_42
SDONE_44:
    s_min_u32 s25, s24, s28
    s_min_u32 s27, s26, s28
    s_min_u32 s29, s24, s30
    s_max_u32 s24, s24, s28
    s_max_u32 s26, s26, s30
    s_max_u32 s27, s27, s29
    s_max_u32 s25, s25, s26
    v_mov_b32 v244, s24
    v_mov_b32 v246, s27
    v_mov_b32 v245, s25
    ds_write_b128 v4, v[244:247]
    s_lshr_b32 s96, s3, 2
    s_lshl_b32 s97, s96, 15
    s_and_b32 s98, s3, 3
    s_lshl_b32 s99, s98, 5
    s_add_u32 s13, s97, s99
    v_lshrrev_b32 v34, 4, v1
    v_lshlrev_b32 v34, 13, v34
    v_bfe_u32 v9, v1, 2, 2
    v_lshl_add_u32 v34, v9, 7, v34
    v_bfe_u32 v9, v1, 3, 2
    v_lshl_add_u32 v34, v9, 5, v34
    v_and_b32 v9, 3, v1
    v_lshl_add_u32 v34, v9, 3, v34
    v_xor_b32 v34, s13, v34
    s_lshl_b32 s96, s75, 11
    s_add_u32 s13, s96, 13631488
    v_and_b32 v36, 7, v1
    v_lshl_add_u32 v36, v36, 4, s13
    v_lshrrev_b32 v9, 4, v1
    v_lshl_add_u32 v36, v9, 9, v36
    v_and_b32 v10, 15, v1
    v_lshlrev_b32 v10, 9, v10
    v_add_u32 v10, 13631744, v10
    s_waitcnt vmcnt(0)
    s_waitcnt lgkmcnt(0)
    s_barrier
    ds_read_b128 v[244:247], v5
    v_and_b32 v8, 8, v1
    v_cmp_eq_u32 s[22:23], 0, v8
    v_cmp_gt_u32 s[24:25], 16, v1
    v_cmp_gt_u32 s[26:27], 32, v1
    s_waitcnt lgkmcnt(0)
    v_min_u32_dpp v192, v244, v244 quad_perm:[1,0,3,2] row_mask:0xf bank_mask:0xf
    v_min_u32_dpp v193, v245, v244 quad_perm:[1,0,3,2] row_mask:0xf bank_mask:0xf
    v_min_u32_dpp v194, v244, v245 quad_perm:[1,0,3,2] row_mask:0xf bank_mask:0xf
    v_max_u32_dpp v246, v246, v246 quad_perm:[1,0,3,2] row_mask:0xf bank_mask:0xf
    v_max_u32_dpp v245, v245, v245 quad_perm:[1,0,3,2] row_mask:0xf bank_mask:0xf
    v_max_u32_dpp v244, v244, v244 quad_perm:[1,0,3,2] row_mask:0xf bank_mask:0xf
    v_max3_u32 v246, v246, v193, v194
    v_max_u32 v245, v245, v192
    v_min_u32_dpp v192, v244, v244 quad_perm:[2,3,0,1] row_mask:0xf bank_mask:0xf
    s_nop 0
    v_min_u32_dpp v193, v245, v244 quad_perm:[2,3,0,1] row_mask:0xf bank_mask:0xf
    v_min_u32_dpp v194, v244, v245 quad_perm:[2,3,0,1] row_mask:0xf bank_mask:0xf
    v_max_u32_dpp v246, v246, v246 quad_perm:[2,3,0,1] row_mask:0xf bank_mask:0xf
    v_max_u32_dpp v245, v245, v245 quad_perm:[2,3,0,1] row_mask:0xf bank_mask:0xf
    v_max_u32_dpp v244, v244, v244 quad_perm:[2,3,0,1] row_mask:0xf bank_mask:0xf
    v_max3_u32 v246, v246, v193, v194
    v_max_u32 v245, v245, v192
    v_min_u32_dpp v192, v244, v244 row_half_mirror row_mask:0xf bank_mask:0xf
    s_nop 0
    v_min_u32_dpp v193, v245, v244 row_half_mirror row_mask:0xf bank_mask:0xf
    v_min_u32_dpp v194, v244, v245 row_half_mirror row_mask:0xf bank_mask:0xf
    v_max_u32_dpp v246, v246, v246 row_half_mirror row_mask:0xf bank_mask:0xf
    v_max_u32_dpp v245, v245, v245 row_half_mirror row_mask:0xf bank_mask:0xf
    v_max_u32_dpp v244, v244, v244 row_half_mirror row_mask:0xf bank_mask:0xf
    v_max3_u32 v246, v246, v193, v194
    v_max_u32 v245, v245, v192
    v_cndmask_b32 v192, v245, v244, s[22:23]
    v_cndmask_b32 v201, v246, v245, s[26:27]
    v_and_b32 v193, 31, v246
    v_and_b32 v192, 31, v192
    v_cndmask_b32 v201, v201, v244, s[24:25]
    v_lshl_add_u32 v4, v192, 13, v36
    v_lshl_add_u32 v5, v193, 13, v36
    v_and_b32 v194, 31, v201
    v_lshl_add_u32 v6, v194, 13, v10
    buffer_load_dwordx4 v[192:195], v4, s[32:35], 0 offen sc1
    buffer_load_dwordx4 v[196:199], v5, s[32:35], 0 offen sc1
    buffer_load_dword v200, v6, s[32:35], 0 offen sc1
    s_barrier
    s_add_u32 s82, s81, 8192
    s_lshl2_add_u32 m0, s83, 67584
    s_nop 0
    buffer_load_dwordx4 v253, s[60:63], s82 offen nt lds
    s_add_u32 s82, s81, 12288
    s_lshl2_add_u32 m0, s83, 68608
    s_nop 0
    buffer_load_dwordx4 v253, s[60:63], s82 offen nt lds
    v_readfirstlane_b32 s91, v244
    v_readfirstlane_b32 s94, v245
    v_readfirstlane_b32 s95, v246
    ds_read_b64_tr_b16 v[56:57], v34
    ds_read_b64_tr_b16 v[58:59], v34 offset:512
    ds_read_b64_tr_b16 v[60:61], v34 offset:1024
    ds_read_b64_tr_b16 v[62:63], v34 offset:1536
    ds_read_b64_tr_b16 v[64:65], v34 offset:2048
    ds_read_b64_tr_b16 v[66:67], v34 offset:2560
    ds_read_b64_tr_b16 v[68:69], v34 offset:3072
    ds_read_b64_tr_b16 v[70:71], v34 offset:3584
    ds_read_b64_tr_b16 v[72:73], v34 offset:4096
    ds_read_b64_tr_b16 v[74:75], v34 offset:4608
    ds_read_b64_tr_b16 v[76:77], v34 offset:5120
    ds_read_b64_tr_b16 v[78:79], v34 offset:5632
    ds_read_b64_tr_b16 v[80:81], v34 offset:6144
    ds_read_b64_tr_b16 v[82:83], v34 offset:6656
    ds_read_b64_tr_b16 v[84:85], v34 offset:7168
    ds_read_b64_tr_b16 v[86:87], v34 offset:7680
    s_bfe_u32 s96, s91, 262145
    s_lshl_b32 s97, s96, 7
    s_bfe_u32 s98, s91, 458757
    s_add_u32 s99, s97, s98
    s_xor_b32 s17, s99, 2047
    s_bfe_u32 s96, s94, 262145
    s_lshl_b32 s97, s96, 7
    s_bfe_u32 s98, s94, 458757
    s_add_u32 s99, s97, s98
    s_xor_b32 s18, s99, 2047
    s_bfe_u32 s96, s95, 262145
    s_lshl_b32 s97, s96, 7
    s_bfe_u32 s98, s95, 458757
    s_add_u32 s99, s97, s98
    s_xor_b32 s19, s99, 2047
    s_waitcnt lgkmcnt(0)
    s_lshl_b32 s13, s3, 6
    v_bfe_u32 v35, v1, 2, 1
    v_lshlrev_b32 v35, 9, v35
    v_bfe_u32 v9, v1, 3, 1
    v_lshl_add_u32 v35, v9, 12, v35
    v_lshrrev_b32 v9, 5, v1
    v_lshl_add_u32 v35, v9, 11, v35
    v_bfe_u32 v9, v1, 2, 2
    v_lshl_add_u32 v35, v9, 6, v35
    v_bfe_u32 v9, v1, 4, 1
    v_lshl_add_u32 v35, v9, 5, v35
    v_and_b32 v9, 3, v1
    v_lshl_add_u32 v35, v9, 3, v35
    v_xor_b32 v35, s13, v35
    v_add_u32 v35, 65536, v35
    v_and_b32 v8, 15, v1
    v_lshlrev_b32 v8, 4, v8
    v_lshrrev_b32 v9, 5, v1
    v_lshl_add_u32 v8, v9, 3, v8
    s_lshl_b32 s96, s74, 13
    s_add_u32 s14, s96, 20971520
    s_lshl3_add_u32 s96, s75, s3
    s_lshl_b32 s97, s96, 8
    s_add_u32 s20, s97, s14
    v_bfe_u32 v7, v201, 1, 4
    v_bfe_u32 v201, v201, 5, 7
    v_lshl_or_b32 v201, v7, 7, v201
    v_xor_b32 v201, 0x7ff, v201
    s_waitcnt vmcnt(2)
    v_max3_u32 v7, v192, v196, v200
    v_cmp_eq_u32 vcc, -1, v7
    s_cbranch_vccz POK_46
PRE_47:
    buffer_load_dwordx4 v[192:195], v4, s[32:35], 0 offen sc1
    buffer_load_dwordx4 v[196:199], v5, s[32:35], 0 offen sc1
    buffer_load_dword v200, v6, s[32:35], 0 offen sc1
    s_waitcnt vmcnt(0)
    v_max3_u32 v7, v192, v196, v200
    v_cmp_eq_u32 vcc, -1, v7
    s_cbranch_vccz POK_46
    s_add_u32 s5, s5, 1
    s_cmp_lt_u32 s5, 200000
    s_cbranch_scc1 PRE_47
POK_46:
    v_add_f32_dpp v200, v200, v200 quad_perm:[1,0,3,2] row_mask:0xf bank_mask:0xf
    s_nop 1
    v_add_f32_dpp v200, v200, v200 quad_perm:[2,3,0,1] row_mask:0xf bank_mask:0xf
    s_nop 1
    v_add_f32_dpp v200, v200, v200 row_half_mirror row_mask:0xf bank_mask:0xf
    s_nop 1
    v_add_f32_dpp v200, v200, v200 row_mirror row_mask:0xf bank_mask:0xf
    v_cvt_pk_bf16_f32 v200, 0, v200
    v_ashrrev_i32 v7, 31, v200
    v_or_b32 v7, 0x80000000, v7
    v_xor_b32 v200, v200, v7
    v_lshrrev_b32 v200, 16, v200
    v_lshl_or_b32 v200, v200, 11, v201
    s_nop 0
    v_readlane_b32 s24, v200, 0
    v_readlane_b32 s25, v200, 16
    v_readlane_b32 s26, v200, 32
    s_not_b64 s[28:29], s[22:23]
    s_cmp_lt_u32 s24, s25
    s_cselect_b64 s[28:29], s[22:23], s[28:29]
    s_cselect_b32 s27, s24, s25
    s_cmp_gt_u32 s26, s27
    s_cselect_b64 vcc, s[28:29], 0
    v_cndmask_b32 v192, v192, v196, vcc
    v_cndmask_b32 v193, v193, v197, vcc
    v_cndmask_b32 v194, v194, v198, vcc
    v_cndmask_b32 v195, v195, v199, vcc
    s_bitcmp1_b32 vcc_lo, 0
    s_cselect_b32 s24, s26, s24
    s_cselect_b32 s19, s17, s19
    s_cselect_b32 s17, s95, s91
    s_bitcmp1_b32 vcc_lo, 8
    s_cselect_b32 s25, s26, s25
    s_cselect_b32 s19, s18, s19
    s_cselect_b32 s18, s95, s94
    s_waitcnt lgkmcnt(0)
    v_mfma_f32_16x16x32_bf16 v[136:139], v[192:195], v[56:59], 0
    v_mfma_f32_16x16x32_bf16 v[140:143], v[192:195], v[60:63], 0
    v_mfma_f32_16x16x32_bf16 v[144:147], v[192:195], v[64:67], 0
    v_mfma_f32_16x16x32_bf16 v[148:151], v[192:195], v[68:71], 0
    v_mfma_f32_16x16x32_bf16 v[168:171], v[192:195], v[72:75], 0
    v_mfma_f32_16x16x32_bf16 v[172:175], v[192:195], v[76:79], 0
    v_mfma_f32_16x16x32_bf16 v[176:179], v[192:195], v[80:83], 0
    v_mfma_f32_16x16x32_bf16 v[180:183], v[192:195], v[84:87], 0
    s_nop 1
    v_add_f32 v196, v136, v141
    s_nop 0
    v_add_f32 v197, v146, v151
    s_nop 0
    v_add_f32 v198, v168, v173
    s_nop 0
    v_add_f32 v199, v178, v183
    v_add_f32 v196, v196, v197
    v_add_f32 v198, v198, v199
    v_mov_b32 v197, s4
    s_nop 0
    v_permlane16_swap_b32 v198, v199
    s_cmp_ge_u32 s9, 28
    s_cbranch_scc1 L_NOHP
    v_add_f32 v196, v196, v199
    s_mov_b32 exec_lo, 0xffff
    s_mov_b32 exec_hi, 0xffff
    buffer_store_dwordx2 v[196:197], v8, s[32:35], s20 offen sc1
    s_mov_b64 exec, -1
L_NOHP:
    s_and_b32 s68, s24, 2047
    s_and_b32 s69, s25, 2047
    s_mov_b32 s70, s16
    s_mov_b32 s71, s15
    v_pk_add_f32 v[208:209], v[208:209], v[152:153]
    v_pk_add_f32 v[210:211], v[210:211], v[154:155]
    v_pk_add_f32 v[212:213], v[212:213], v[156:157]
    v_pk_add_f32 v[214:215], v[214:215], v[158:159]
    v_pk_add_f32 v[216:217], v[216:217], v[160:161]
    v_pk_add_f32 v[218:219], v[218:219], v[162:163]
    v_pk_add_f32 v[220:221], v[220:221], v[164:165]
    v_pk_add_f32 v[222:223], v[222:223], v[166:167]
    v_cvt_pk_bf16_f32 v232, v208, v209
    v_cvt_pk_bf16_f32 v233, v210, v211
    v_cvt_pk_bf16_f32 v234, v212, v213
    v_cvt_pk_bf16_f32 v235, v214, v215
    v_cvt_pk_bf16_f32 v236, v216, v217
    v_cvt_pk_bf16_f32 v237, v218, v219
    v_cvt_pk_bf16_f32 v238, v220, v221
    v_cvt_pk_bf16_f32 v239, v222, v223
    v_permlane32_swap_b32 v232, v234
    v_permlane32_swap_b32 v233, v235
    v_permlane32_swap_b32 v236, v238
    v_permlane32_swap_b32 v237, v239
    ds_write_b128 v202, v[232:235]
    ds_write_b128 v204, v[236:239]
    ds_read_b128 v[232:235], v203
    ds_read_b128 v[236:239], v203 offset:1024
    s_waitcnt lgkmcnt(0)
    s_cmp_lg_u32 s93, 7
    s_cbranch_scc1 L_NONON
    v_mov_b32 v6, s4
    v_mov_b32 v7, 0
    s_mov_b64 exec, 1
    buffer_store_dword v6, v7, s[32:35], 0 offen sc1
    s_mov_b64 exec, -1
L_NONON:
    s_cmp_ge_u32 s9, 28
    s_cbranch_scc1 L_FIN2
    s_cmp_lg_u32 s3, 7
    s_cbranch_scc1 L_NOFZ
    s_bitcmp1_b32 s9, 3
    s_cselect_b32 s15, s25, s24
    s_cselect_b32 s17, s18, s17
    s_andn2_b32 s18, 2047, s15
    s_lshr_b32 s96, s8, 1
    s_lshl2_add_u32 s19, s12, s96
    s_lshr_b32 s96, s19, 1
    s_lshr_b32 s97, s9, 3
    s_lshl_b32 s98, s97, 1
    s_lshl2_add_u32 s99, s96, s98
    s_and_b32 s97, s19, 1
    s_add_u32 s96, s99, s97
    s_mul_i32 s98, s96, 7168
    s_add_u32 s20, s98, 22020096
    s_lshl_b32 s96, s18, 11
    s_lshl_b32 s97, s19, 5
    s_add_u32 s82, s96, s97
    v_and_b32 v10, 7, v1
    v_lshlrev_b32 v10, 2, v10
    s_lshr_b32 s96, s8, 1
    s_lshl_b32 s97, s96, 6
    s_add_u32 s13, s97, 157184
    v_and_b32 v5, 7, v1
    v_lshl_add_u32 v5, v5, 3, s13
    ds_read_b64 v[206:207], v5
    s_and_b32 s96, s17, 31
    s_lshl_b32 s97, s96, 13
    s_lshl_b32 s98, s12, 9
    s_add_u32 s99, s97, s98
    s_lshr_b32 s96, s8, 1
    s_lshl_b32 s97, s96, 5
    s_add_u32 s98, s99, s97
    s_add_u32 s91, s98, 13631488
    s_lshr_b32 s13, s15, 11
    s_lshl_b32 s13, s13, 16
    s_ashr_i32 s15, s13, 31
    s_andn2_b32 s15, 0x7fff0000, s15
    s_or_b32 s15, s15, 0x80000000
    s_xor_b32 s13, s13, s15
    v_mov_b32 v204, s13
    v_mul_f32 v204, s7, v204
    v_exp_f32 v204, -v204
    s_nop 0
    v_add_f32 v204, 1.0, v204
    v_rcp_f32 v204, v204
    s_nop 0
    v_cvt_pk_bf16_f32 v204, 0, v204
L_NOFZ:
    s_cmp_ge_u32 s3, 4
    s_cbranch_scc1 L_NOH
    s_lshl_b32 s96, s3, 8
    s_add_u32 s13, s96, s14
    v_lshrrev_b32 v4, 4, v1
    v_lshlrev_b32 v4, 11, v4
    v_and_b32 v9, 15, v1
    v_lshl_add_u32 v4, v9, 4, v4
    s_lshl_b32 s96, s3, 5
    s_add_u32 s15, s96, 156672
    v_lshrrev_b32 v5, 5, v1
    v_lshl_add_u32 v5, v5, 7, s15
    v_bfe_u32 v9, v1, 2, 1
    v_lshl_add_u32 v5, v9, 4, v5
    v_bfe_u32 v9, v1, 1, 1
    v_lshl_add_u32 v5, v9, 3, v5
    v_bfe_u32 v9, v1, 3, 1
    v_lshl_add_u32 v5, v9, 2, v5
    v_and_b32 v9, 1, v1
    v_lshl_add_u32 v5, v9, 1, v5
SPOLL_48:
    s_load_dword s24, s[32:33], s13 offset:1276 glc
    s_load_dword s25, s[32:33], s13 offset:3324 glc
    s_load_dword s26, s[32:33], s13 offset:5372 glc
    s_load_dword s27, s[32:33], s13 offset:7420 glc
SCHK_49:
    s_add_u32 s5, s5, 1
    s_cmp_ge_u32 s5, 200000
    s_waitcnt lgkmcnt(0)
    s_cbranch_scc1 SDONE_50
    s_cmp_lg_u32 s24, s4
    s_cbranch_scc1 SPOLL_48
    s_cmp_lg_u32 s25, s4
    s_cbranch_scc1 SPOLL_48
    s_cmp_lg_u32 s26, s4
    s_cbranch_scc1 SPOLL_48
L_PAD10:
    s_cbranch_execz L_RET10
    s_cmp_lg_u32 s27, s4
    s_cbranch_scc1 SPOLL_48
SDONE_50:
POLL_51:
    buffer_load_dwordx4 v[88:91], v4, s[32:35], s13 offen sc1
    buffer_load_dwordx4 v[92:95], v4, s[32:35], s13 offen offset:1024 sc1
    s_waitcnt vmcnt(0)
    v_bitop3_b32 v6, v89, v91, s4 bitop3:0x7e
    v_bitop3_b32 v6, v6, v93, s4 bitop3:0xf6
    v_bitop3_b32 v6, v6, v95, s4 bitop3:0xf6
    v_cmp_ne_u32 vcc, 0, v6
    s_cbranch_vccz PDONE_52
    s_add_u32 s5, s5, 1
    s_cmp_lt_u32 s5, 200000
    s_cbranch_scc1 POLL_51
PDONE_52:
    v_permlane32_swap_b32 v88, v90
    v_permlane32_swap_b32 v92, v94
    v_add_f32 v88, v88, v90
    v_add_f32 v92, v92, v94
    v_mov_b32 v90, v88
    v_mov_b32 v94, v92
    s_nop 0
    v_permlane16_swap_b32 v88, v90
    v_permlane16_swap_b32 v92, v94
    v_add_f32 v88, v88, v90
    v_add_f32 v92, v92, v94
    v_cvt_pk_bf16_f32 v88, 0, v88
    v_cvt_pk_bf16_f32 v92, 0, v92
    v_mul_f32 v6, s7, v88
    v_exp_f32 v6, -v6
    s_nop 0
    v_add_f32 v6, 1.0, v6
    v_rcp_f32 v6, v6
    s_nop 0
    v_mul_f32 v88, v88, v6
    v_cvt_pk_bf16_f32 v88, 0, v88
    v_mul_f32 v88, v88, v92
    v_cvt_pk_bf16_f32 v88, v88, v88
    ds_write_b16 v5, v88
L_NOH:
    v_bfe_u32 v4, v1, 2, 1
    v_lshlrev_b32 v4, 7, v4
    v_lshrrev_b32 v9, 5, v1
    v_lshl_add_u32 v4, v9, 4, v4
    v_add_u32 v4, 156672, v4
    v_lshrrev_b32 v5, 4, v1
    v_mul_u32_u24 v5, 7168, v5
    v_and_b32 v9, 15, v1
    v_lshl_add_u32 v5, v9, 3, v5
    s_lshl3_add_u32 s96, s75, s3
    s_mul_i32 s97, s96, 28672
    s_lshl_b32 s98, s74, 7
    s_add_u32 s99, s97, s98
    s_add_u32 s13, s99, 22020096
    v_and_b32 v6, 1, v1
    v_lshlrev_b32 v6, 13, v6
    v_bfe_u32 v9, v1, 1, 1
    v_lshl_add_u32 v6, v9, 18, v6
    s_lshr_b32 s96, s9, 2
    s_and_b32 s97, s75, 1
    s_lshr_b32 s98, s3, 1
    s_lshl2_add_u32 s99, s97, s98
    s_and_b32 s97, s3, 1
    s_lshr_b32 s98, s75, 1
    s_lshl2_add_u32 s97, s97, s98
    s_lshl3_add_u32 s98, s99, s97
    s_lshl_b32 s99, s98, 12
    s_lshl_b32 s97, s8, 6
    s_add_u32 s98, s99, s97
    s_lshl2_add_u32 s99, s96, s98
    s_add_u32 s97, s99, 1048576
    s_add_u32 s14, s97, 3072
    s_waitcnt vmcnt(0)
    s_waitcnt lgkmcnt(0)
    s_barrier
    ds_read_b128 v[88:91], v4
    ds_read_b64_tr_b16 v[120:121], v35
    ds_read_b64_tr_b16 v[122:123], v35 offset:1024
    ds_read_b128 v[92:95], v4 offset:32
    ds_read_b64_tr_b16 v[124:125], v35 offset:8192
    ds_read_b64_tr_b16 v[126:127], v35 offset:9216
    ds_read_b128 v[96:99], v4 offset:64
    ds_read_b64_tr_b16 v[128:129], v35 offset:16384
    ds_read_b64_tr_b16 v[130:131], v35 offset:17408
    ds_read_b128 v[100:103], v4 offset:96
    ds_read_b64_tr_b16 v[132:133], v35 offset:24576
    ds_read_b64_tr_b16 v[134:135], v35 offset:25600
    s_waitcnt lgkmcnt(9)
    v_mfma_f32_32x32x16_bf16 v[208:223], v[88:91], v[120:123], 0
    s_waitcnt lgkmcnt(6)
    v_mfma_f32_32x32x16_bf16 v[208:223], v[92:95], v[124:127], v[208:223]
    s_waitcnt lgkmcnt(3)
    v_mfma_f32_32x32x16_bf16 v[208:223], v[96:99], v[128:131], v[208:223]
    s_waitcnt lgkmcnt(0)
    v_mfma_f32_32x32x16_bf16 v[208:223], v[100:103], v[132:135], v[208:223]
    s_nop 11
    v_mov_b32 v209, s4
    buffer_store_dwordx2 v[208:209], v5, s[32:35], s13 offen sc1
    s_mov_b64 exec, 15
    buffer_store_dword v209, v6, s[32:35], s14 offen sc1
    s_mov_b64 exec, -1
    s_barrier
L_FIN2:
    v_cmp_ne_u32 vcc, s68, v42
    v_cmp_ne_u32 s[22:23], s69, v42
    s_nop 0
    s_and_b64 exec, vcc, s[22:23]
    buffer_store_dwordx4 v[232:235], v33, s[64:67], s70 offen sc1
    s_mov_b64 exec, -1
    v_cmp_ne_u32 vcc, s68, v43
    v_cmp_ne_u32 s[22:23], s69, v43
    s_nop 0
    s_and_b64 exec, vcc, s[22:23]
    buffer_store_dwordx4 v[236:239], v33, s[64:67], s71 offen sc1
    s_mov_b64 exec, -1
    s_cmp_ge_u32 s9, 16
    s_cbranch_scc1 L_FIN
SPOLL_53:
    s_load_dwordx8 s[24:31], s[32:33], s92 offset:3072 glc
SCHK_54:
    s_add_u32 s5, s5, 1
    s_cmp_ge_u32 s5, 200000
    s_waitcnt lgkmcnt(0)
    s_cbranch_scc1 SDONE_55
    s_cmp_lg_u32 s24, s4
    s_cbranch_scc1 SPOLL_53
    s_cmp_lg_u32 s25, s4
    s_cbranch_scc1 SPOLL_53
    s_cmp_lg_u32 s26, s4
    s_cbranch_scc1 SPOLL_53
    s_cmp_lg_u32 s27, s4
    s_cbranch_scc1 SPOLL_53
    s_cmp_lg_u32 s28, s4
    s_cbranch_scc1 SPOLL_53
    s_cmp_lg_u32 s29, s4
    s_cbranch_scc1 SPOLL_53
    s_cmp_lg_u32 s30, s4
    s_cbranch_scc1 SPOLL_53
SDONE_55:
    s_barrier
    s_cmp_lg_u32 s3, 7
    s_cbranch_scc1 L_FIN
    s_add_u32 s13, s20, 4096
    v_mov_b32 v5, s4
    v_not_b32 v6, v5
POLL_56:
    buffer_load_dwordx4 v[88:91], v2, s[32:35], s20 offen sc1
    buffer_load_dwordx4 v[92:95], v2, s[32:35], s20 offen offset:1024 sc1
    buffer_load_dwordx4 v[96:99], v2, s[32:35], s20 offen offset:2048 sc1
    buffer_load_dwordx4 v[100:103], v2, s[32:35], s20 offen offset:3072 sc1
    buffer_load_dwordx4 v[104:107], v2, s[32:35], s13 offen sc1
    buffer_load_dwordx4 v[108:111], v2, s[32:35], s13 offen offset:1024 sc1
    buffer_load_dwordx4 v[112:115], v2, s[32:35], s13 offen offset:2048 sc1
    buffer_load_dword v244, v10, s[32:35], s91 offen sc1
    buffer_load_dword v245, v10, s[32:35], s91 offen offset:128 sc1
    s_waitcnt vmcnt(0)
    v_max_u32 v246, v244, v245
    v_cmp_ne_u32 vcc, -1, v246
    s_nop 1
    v_cndmask_b32 v246, v6, v5, vcc
    v_bitop3_b32 v4, v89, v91, s4 bitop3:0x7e
    v_bitop3_b32 v4, v4, v93, s4 bitop3:0xf6
    v_bitop3_b32 v4, v4, v95, s4 bitop3:0xf6
    v_bitop3_b32 v4, v4, v97, s4 bitop3:0xf6
    v_bitop3_b32 v4, v4, v99, s4 bitop3:0xf6
    v_bitop3_b32 v4, v4, v101, s4 bitop3:0xf6
    v_bitop3_b32 v4, v4, v103, s4 bitop3:0xf6
    v_bitop3_b32 v4, v4, v105, s4 bitop3:0xf6
    v_bitop3_b32 v4, v4, v107, s4 bitop3:0xf6
    v_bitop3_b32 v4, v4, v109, s4 bitop3:0xf6
    v_bitop3_b32 v4, v4, v111, s4 bitop3:0xf6
    v_bitop3_b32 v4, v4, v113, s4 bitop3:0xf6
    v_bitop3_b32 v4, v4, v115, s4 bitop3:0xf6
    v_bitop3_b32 v4, v4, v246, s4 bitop3:0xf6
    v_cmp_ne_u32 vcc, 0, v4
    s_cbranch_vccz PDONE_57
    s_add_u32 s5, s5, 1
    s_cmp_lt_u32 s5, 200000
    s_cbranch_scc1 POLL_56
PDONE_57:
    v_add_f32 v88, v88, v92
    v_add_f32 v90, v90, v94
    v_add_f32 v88, v88, v96
    v_add_f32 v90, v90, v98
    v_add_f32 v88, v88, v100
    v_add_f32 v90, v90, v102
    v_add_f32 v88, v88, v104
    v_add_f32 v90, v90, v106
    v_add_f32 v88, v88, v108
    v_add_f32 v90, v90, v110
    v_add_f32 v88, v88, v112
    v_add_f32 v90, v90, v114
    v_mov_b32 v89, v90
    v_add_f32_dpp v88, v88, v88 row_ror:8 row_mask:0xf bank_mask:0xf
    s_nop 0
    v_add_f32_dpp v89, v89, v89 row_ror:8 row_mask:0xf bank_mask:0xf
    v_mov_b32 v90, v88
    v_mov_b32 v91, v89
    s_nop 0
    v_permlane16_swap_b32 v88, v90
    v_permlane16_swap_b32 v89, v91
    v_pk_add_f32 v[88:89], v[88:89], v[90:91]
    v_mov_b32 v90, v88
    v_mov_b32 v91, v89
    s_nop 0
    v_permlane32_swap_b32 v88, v90
    v_permlane32_swap_b32 v89, v91
    v_pk_add_f32 v[88:89], v[88:89], v[90:91]
    v_cvt_pk_bf16_f32 v88, 0, v88
    v_cvt_pk_bf16_f32 v89, 0, v89
    v_pk_mul_f32 v[88:89], v[88:89], v[204:205] op_sel_hi:[1,0]
    v_lshlrev_b32 v4, 16, v244
    v_and_b32 v5, s6, v244
    v_cvt_pk_bf16_f32 v88, 0, v88
    v_cvt_pk_bf16_f32 v89, 0, v89
    v_pk_add_f32 v[88:89], v[88:89], v[4:5]
    v_cvt_pk_bf16_f32 v88, 0, v88
    v_cvt_pk_bf16_f32 v89, 0, v89
    v_pk_mul_f32 v[88:89], v[88:89], v[206:207]
    v_lshlrev_b32 v4, 16, v245
    v_and_b32 v5, s6, v245
    v_cvt_pk_bf16_f32 v88, 0, v88
    v_cvt_pk_bf16_f32 v89, 0, v89
    v_pk_add_f32 v[88:89], v[88:89], v[4:5]
    v_cvt_pk_bf16_f32 v88, v88, v89
    s_mov_b64 exec, 0xff
    buffer_store_dword v88, v10, s[64:67], s82 offen
    s_mov_b64 exec, -1
L_FIN:
L_END:
    s_endpgm
.p2align 10
.fill 768, 4, 0xbf800000
.section .rodata,"a"
.p2align 6
.amdhsa_kernel adaLN_cond__linear_kernel_hedgehog__moe_arch_mod__prompt_kernel
  .amdhsa_next_free_vgpr 256
  .amdhsa_next_free_sgpr 102
  .amdhsa_accum_offset 256
  .amdhsa_group_segment_fixed_size 0
  .amdhsa_kernarg_size 112
  .amdhsa_user_sgpr_count 2
  .amdhsa_user_sgpr_kernarg_segment_ptr 1
  .amdhsa_system_sgpr_workgroup_id_x 1
  .amdhsa_float_denorm_mode_32 3
  .amdhsa_float_denorm_mode_16_64 3
.end_amdhsa_kernel
```

```asm
; @launch grid=(256,1,1) block=(512,1,1) lds=163840
.amdgcn_target "amdgcn-amd-amdhsa--gfx950"
.text
.globl adaLN_cond__linear_kernel_hedgehog__moe_arch_mod__prompt_kernel
.p2align 12
.type adaLN_cond__linear_kernel_hedgehog__moe_arch_mod__prompt_kernel,@function
adaLN_cond__linear_kernel_hedgehog__moe_arch_mod__prompt_kernel:
    s_load_dwordx16 s[68:83], s[0:1], 0
    s_load_dwordx8 s[84:91], s[0:1], 64
    s_load_dwordx2 s[32:33], s[0:1], 104
    s_cmp_ge_u32 s2, 256
    s_cbranch_scc1 L_END
    v_lshrrev_b32 v4, 6, v0
    v_and_b32 v1, 63, v0
    s_nop 0
    v_readfirstlane_b32 s3, v4
    v_lshlrev_b32 v2, 4, v1
    s_mov_b32 s38, 4194304
    s_mov_b32 s39, 0x20000
    s_mov_b32 s50, 12582912
    s_mov_b32 s51, 0x20000
    s_mov_b32 s34, 268435456
    s_mov_b32 s35, 0x20000
    s_mov_b32 s42, 6291456
    s_mov_b32 s43, 0x20000
    s_mov_b32 s46, 2097152
    s_mov_b32 s47, 0x20000
    s_mov_b32 s54, 7340032
    s_mov_b32 s55, 0x20000
    s_mov_b32 s58, 7340032
    s_mov_b32 s59, 0x20000
    s_mov_b32 s62, 7340032
    s_mov_b32 s63, 0x20000
    s_mov_b32 s66, 4194304
    s_mov_b32 s67, 0x20000
    s_mov_b32 s5, 0
    s_mov_b32 s6, 0xffff0000
    s_mov_b32 s7, 0x3fb8aa3b
    s_and_b32 s8, s2, 7
    s_lshr_b32 s9, s2, 3
    s_lshl3_add_u32 s93, s2, s3
    s_and_b32 s96, s8, 4
    s_lshr_b32 s97, s9, 2
    s_lshl1_add_u32 s10, s96, s97
    s_and_b32 s96, s8, 3
    s_and_b32 s97, s9, 3
    s_xor_b32 s98, s97, 2
    s_lshl2_add_u32 s11, s96, s98
    s_and_b32 s96, s8, 1
    s_and_b32 s97, s9, 7
    s_lshl3_add_u32 s12, s96, s97
    s_lshr_b32 s96, s8, 1
    s_lshr_b32 s97, s9, 3
    s_lshl2_add_u32 s21, s96, s97
    s_lshl_b32 s96, s2, 6
    s_add_u32 s97, s96, s3
    s_lshl_b32 s98, s97, 6
    s_add_u32 s92, s98, 1048576
    s_lshr_b32 s96, s8, 1
    s_lshl_b32 s97, s96, 8
    s_lshl3_add_u32 s98, s9, s97
    s_add_u32 s99, s98, s3
    s_lshl_b32 s96, s99, 12
    s_and_b32 s97, s8, 1
    s_lshl_b32 s98, s97, 10
    s_add_u32 s16, s96, s98
    v_and_b32 v8, 31, v1
    v_lshlrev_b32 v8, 4, v8
    v_lshrrev_b32 v9, 5, v1
    v_lshl_add_u32 v8, v9, 11, v8
    s_lshl3_add_u32 s96, s8, s3
    s_lshl_b32 s15, s96, 5
    s_mul_i32 s96, s15, 6144
    s_xor_b32 s97, s9, 1
    s_lshl_b32 s98, s97, 7
    s_add_u32 s13, s96, s98
    s_add_u32 s14, s13, 98304
    s_lshl3_add_u32 s96, s21, s3
    s_lshl_b32 s97, s96, 15
    s_lshl_b32 s98, s12, 7
    s_add_u32 s18, s97, s98
    s_lshr_b32 s96, s8, 1
    s_lshl4_add_u32 s97, s96, s12
    s_lshl4_add_u32 s98, s97, s3
    s_lshl_b32 s99, s98, 9
    s_add_u32 s17, s99, 524288
    v_lshrrev_b32 v248, 3, v1
    v_mul_u32_u24 v248, 12288, v248
    v_and_b32 v9, 7, v1
    v_lshl_add_u32 v248, v9, 4, v248
    v_lshrrev_b32 v249, 3, v1
    v_lshl_add_u32 v249, v249, 1, s15
    v_and_b32 v10, 15, v1
    v_lshlrev_b32 v10, 11, v10
    v_lshrrev_b32 v9, 4, v1
    v_lshl_add_u32 v10, v9, 4, v10
    s_waitcnt lgkmcnt(0)
    s_mov_b64 s[48:49], s[88:89]
    buffer_load_dwordx4 v[160:163], v248, s[48:51], s13 offen nt
    buffer_load_dwordx4 v[164:167], v248, s[48:51], s14 offen nt
    s_load_dword s4, s[32:33], 0
    global_load_ushort v168, v249, s[86:87]
    global_load_ushort v169, v249, s[86:87] offset:16
    s_mov_b64 s[36:37], s[68:69]
    s_load_dword s24, s[32:33], s92 offset:0 glc
    s_load_dword s25, s[32:33], s17 offset:508 glc
    s_load_dword s26, s[32:33], s17 offset:4604 glc
    s_barrier
    buffer_load_dwordx4 v[152:155], v8, s[36:39], s16 offen
    buffer_load_dwordx4 v[156:159], v8, s[36:39], s16 offen offset:512
    s_mov_b64 s[40:41], s[70:71]
    s_mov_b64 s[44:45], s[74:75]
    s_mov_b64 s[52:53], s[80:81]
    s_mov_b64 s[56:57], s[82:83]
    s_mov_b64 s[60:61], s[84:85]
    s_mov_b64 s[64:65], s[90:91]
    s_getpc_b64 s[22:23]
    s_and_b32 s22, s22, 0xfffffc00
    s_lshl3_add_u32 s96, s9, s3
    s_lshl_b32 s19, s96, 7
    v_lshrrev_b32 v4, 5, v1
    v_lshl_add_u32 v4, v4, 15, s19
    v_min_u32 v4, 41984, v4
    global_load_dword v11, v4, s[22:23]
    s_lshr_b32 s76, s3, 2
    s_and_b32 s77, s3, 3
    s_lshl_b32 s83, s3, 10
    s_mul_i32 s96, s8, 7
    s_lshr_b32 s97, s9, 2
    s_add_u32 s74, s96, s97
    s_and_b32 s75, s9, 3
    v_bfe_u32 v6, v1, 4, 1
    v_lshlrev_b32 v6, 6, v6
    v_and_b32 v3, 7, v1
    v_lshlrev_b32 v3, 4, v3
    v_xor_b32 v3, v3, v6
    v_lshrrev_b32 v6, 3, v1
    v_mul_u32_u24 v6, 6144, v6
    v_add_u32 v3, v3, v6
    s_and_b32 s84, s9, 12
    s_mul_i32 s96, s3, 49152
    s_lshl_b32 s97, s11, 7
    s_add_u32 s85, s96, s97
    v_lshlrev_b32 v250, 3, v1
    v_lshlrev_b32 v251, 5, v1
    v_add_u32 v251, 147456, v251
    s_lshl2_add_u32 s13, s3, 147456
    v_lshrrev_b32 v252, 4, v1
    v_lshl_add_u32 v252, v252, 6, s13
    v_and_b32 v9, 7, v1
    v_lshl_add_u32 v252, v9, 8, v252
    v_bfe_u32 v9, v1, 3, 1
    v_lshl_add_u32 v252, v9, 5, v252
    buffer_load_dwordx4 v[12:15], v10, s[36:39], s18 offen
    buffer_load_dwordx4 v[16:19], v10, s[36:39], s18 offen offset:64
    s_lshr_b32 s96, s3, 1
    s_xor_b32 s97, s9, 1
    s_and_b32 s98, s97, 15
    s_lshl4_add_u32 s99, s96, s98
    s_lshr_b32 s97, s9, 4
    s_lshl1_add_u32 s96, s99, s97
    s_lshl3_add_u32 s98, s96, s8
    s_lshl_b32 s99, s98, 9
    s_add_u32 s13, s99, 524288
    s_waitcnt vmcnt(5)
    v_lshlrev_b32 v168, 16, v168
    v_mul_f32 v4, s7, v168
    v_exp_f32 v4, -v4
    s_nop 0
    v_add_f32 v4, 1.0, v4
    v_rcp_f32 v4, v4
    s_nop 0
    v_mul_f32 v168, v168, v4
    v_cvt_pk_bf16_f32 v168, 0, v168
    v_lshlrev_b32 v169, 16, v169
    v_mul_f32 v5, s7, v169
    v_exp_f32 v5, -v5
    s_nop 0
    v_add_f32 v5, 1.0, v5
    v_rcp_f32 v5, v5
    s_nop 0
    v_mul_f32 v169, v169, v5
    v_cvt_pk_bf16_f32 v169, 0, v169
    v_lshlrev_b32 v4, 16, v160
    v_and_b32 v5, s6, v160
    v_pk_mul_f32 v[176:177], v[168:169], v[4:5] op_sel:[0,0] op_sel_hi:[0,1]
    v_lshlrev_b32 v6, 16, v161
    v_and_b32 v7, s6, v161
    v_pk_mul_f32 v[178:179], v[168:169], v[6:7] op_sel:[0,0] op_sel_hi:[0,1]
    v_lshlrev_b32 v4, 16, v162
    v_and_b32 v5, s6, v162
    v_pk_mul_f32 v[180:181], v[168:169], v[4:5] op_sel:[0,0] op_sel_hi:[0,1]
    v_lshlrev_b32 v6, 16, v163
    v_and_b32 v7, s6, v163
    v_pk_mul_f32 v[182:183], v[168:169], v[6:7] op_sel:[0,0] op_sel_hi:[0,1]
    v_lshlrev_b32 v4, 16, v164
    v_and_b32 v5, s6, v164
    v_pk_fma_f32 v[176:177], v[168:169], v[4:5], v[176:177] op_sel:[1,0,0] op_sel_hi:[1,1,1]
    v_lshlrev_b32 v6, 16, v165
    v_and_b32 v7, s6, v165
    v_pk_fma_f32 v[178:179], v[168:169], v[6:7], v[178:179] op_sel:[1,0,0] op_sel_hi:[1,1,1]
    v_lshlrev_b32 v4, 16, v166
    v_and_b32 v5, s6, v166
    v_pk_fma_f32 v[180:181], v[168:169], v[4:5], v[180:181] op_sel:[1,0,0] op_sel_hi:[1,1,1]
    v_lshlrev_b32 v6, 16, v167
    v_and_b32 v7, s6, v167
    v_pk_fma_f32 v[182:183], v[168:169], v[6:7], v[182:183] op_sel:[1,0,0] op_sel_hi:[1,1,1]
    v_permlane32_swap_b32 v176, v180
    v_permlane32_swap_b32 v177, v181
    v_permlane32_swap_b32 v178, v182
    v_permlane32_swap_b32 v179, v183
    v_add_f32 v176, v176, v180
    v_add_f32 v177, v177, v181
    v_add_f32 v178, v178, v182
    v_add_f32 v179, v179, v183
    s_nop 0
    v_permlane16_swap_b32 v176, v178
    v_permlane16_swap_b32 v177, v179
    v_add_f32 v176, v176, v178
    v_add_f32 v177, v177, v179
    s_nop 0
    v_add_f32_dpp v176, v176, v176 row_ror:8 row_mask:0xf bank_mask:0xf
    v_add_f32_dpp v177, v177, v177 row_ror:8 row_mask:0xf bank_mask:0xf
    s_nop 1
    v_mov_b32_dpp v176, v177 quad_perm:[0,1,2,3] row_mask:0xf bank_mask:0xc
    s_waitcnt lgkmcnt(0)
    s_mul_i32 s4, s4, 0x9e3779b1
    s_add_u32 s4, s4, 0x7f4a7c15
    ds_write_b32 v252, v176
    s_waitcnt lgkmcnt(0)
    s_barrier
    ds_read_b128 v[176:179], v251
    ds_read_b128 v[180:183], v251 offset:16
    s_waitcnt lgkmcnt(0)
    v_pk_add_f32 v[176:177], v[176:177], v[178:179]
    v_pk_add_f32 v[180:181], v[180:181], v[182:183]
    v_pk_add_f32 v[176:177], v[176:177], v[180:181]
    v_add_f32 v176, v176, v177
    v_mov_b32 v177, s4
    s_bitcmp1_b32 s3, 0
    s_cselect_b32 exec_lo, 0, -1
    s_cselect_b32 exec_hi, -1, 0
    buffer_store_dwordx2 v[176:177], v250, s[32:35], s13 offen sc1
    s_mov_b64 exec, -1
    s_lshr_b32 s96, s9, 4
    s_lshl_b32 s94, s96, 1
    s_add_u32 s96, s94, s84
    s_and_b32 s97, s96, 15
    s_mul_i32 s98, s97, 393216
    s_add_u32 s91, s98, s85
    s_lshl_b32 s96, s94, 13
    s_add_u32 s94, s96, s83
    s_add_u32 s82, s91, 2048
    s_mov_b32 m0, s94
    s_nop 0
    buffer_load_dwordx4 v3, s[40:43], s82 offen lds
    s_add_u32 s82, s91, 4096
    s_add_u32 m0, s94, 49152
    s_nop 0
    buffer_load_dwordx4 v3, s[40:43], s82 offen lds
    s_waitcnt vmcnt(6)
    v_mov_b32 v8, 0x3f803f80
    v_dot2_f32_bf16 v4, v152, v8, 0
    v_dot2_f32_bf16 v5, v152, v152, 0
    v_dot2_f32_bf16 v6, v153, v8, 0
    v_dot2_f32_bf16 v7, v153, v153, 0
    v_dot2_f32_bf16 v4, v154, v8, v4
    v_dot2_f32_bf16 v5, v154, v154, v5
    v_dot2_f32_bf16 v6, v155, v8, v6
    v_dot2_f32_bf16 v7, v155, v155, v7
    v_dot2_f32_bf16 v4, v156, v8, v4
    v_dot2_f32_bf16 v5, v156, v156, v5
    v_dot2_f32_bf16 v6, v157, v8, v6
    v_dot2_f32_bf16 v7, v157, v157, v7
    v_dot2_f32_bf16 v4, v158, v8, v4
    v_dot2_f32_bf16 v5, v158, v158, v5
    v_dot2_f32_bf16 v6, v159, v8, v6
    v_dot2_f32_bf16 v7, v159, v159, v7
    s_lshl_b32 s96, s3, 5
    s_add_u32 s13, s96, 153600
    v_lshrrev_b32 v8, 5, v1
    v_lshl_add_u32 v8, v8, 4, s13
    v_bfe_u32 v9, v1, 4, 1
    v_lshl_add_u32 v8, v9, 3, v8
    v_pk_add_f32 v[172:173], v[4:5], v[6:7]
    v_and_b32 v5, 15, v1
    v_lshlrev_b32 v5, 4, v5
    v_add_u32 v5, 153600, v5
    v_and_b32 v4, 15, v1
    v_lshlrev_b32 v4, 4, v4
    v_bfe_u32 v9, v1, 4, 1
    v_lshl_add_u32 v4, v9, 12, v4
    v_add_f32_dpp v172, v172, v172 quad_perm:[1,0,3,2] row_mask:0xf bank_mask:0xf
    v_add_f32_dpp v173, v173, v173 quad_perm:[1,0,3,2] row_mask:0xf bank_mask:0xf
    s_nop 0
    v_add_f32_dpp v172, v172, v172 quad_perm:[2,3,0,1] row_mask:0xf bank_mask:0xf
    v_add_f32_dpp v173, v173, v173 quad_perm:[2,3,0,1] row_mask:0xf bank_mask:0xf
    s_nop 0
    v_add_f32_dpp v172, v172, v172 row_half_mirror row_mask:0xf bank_mask:0xf
    v_add_f32_dpp v173, v173, v173 row_half_mirror row_mask:0xf bank_mask:0xf
    s_nop 0
    v_add_f32_dpp v172, v172, v172 row_mirror row_mask:0xf bank_mask:0xf
    v_add_f32_dpp v173, v173, v173 row_mirror row_mask:0xf bank_mask:0xf
    s_and_b32 s96, s9, 24
    s_add_u32 s97, s96, s3
    s_and_b32 s98, s8, 6
    s_lshl3_add_u32 s99, s97, s98
    s_lshl_b32 s96, s99, 12
    s_and_b32 s97, s9, 7
    s_lshl_b32 s98, s97, 9
    s_add_u32 s99, s96, s98
    s_and_b32 s97, s8, 1
    s_lshl_b32 s96, s97, 8
    s_add_u32 s98, s99, s96
    s_add_u32 s13, s98, 2097152
    v_permlane16_swap_b32 v172, v173
    v_add_f32 v172, v172, v173
    v_mov_b32 v173, s4
    ds_write_b64 v8, v[172:173]
    s_waitcnt lgkmcnt(0)
    s_barrier
    ds_read_b128 v[172:175], v5
    s_waitcnt lgkmcnt(0)
    s_mov_b32 exec_hi, 0
    buffer_store_dwordx4 v[172:175], v4, s[32:35], s13 offen sc1
    s_mov_b32 exec_hi, -1
    s_mov_b32 s82, s91
    s_add_u32 m0, s94, 98304
    s_nop 0
    buffer_load_dwordx4 v3, s[40:43], s82 offen lds
    s_lshr_b32 s96, s9, 4
    s_lshl_b32 s97, s96, 1
    s_xor_b32 s94, s97, 1
    s_add_u32 s96, s94, s84
    s_and_b32 s97, s96, 15
    s_mul_i32 s98, s97, 393216
    s_add_u32 s91, s98, s85
    s_lshl_b32 s96, s94, 13
    s_add_u32 s94, s96, s83
    s_add_u32 s82, s91, 2048
    s_mov_b32 m0, s94
    s_nop 0
    buffer_load_dwordx4 v3, s[40:43], s82 offen lds
    s_load_dword s24, s[32:33], s17 offset:508 glc
    s_load_dword s25, s[32:33], s17 offset:4604 glc
    v_and_b32 v4, 31, v1
    v_lshlrev_b32 v4, 4, v4
    v_lshrrev_b32 v9, 5, v1
    v_lshl_add_u32 v4, v9, 12, v4
    s_lshl2_add_u32 s14, s3, 155648
    v_lshl_add_u32 v5, v1, 6, s14
    v_and_b32 v6, 3, v1
    v_lshlrev_b32 v6, 5, v6
    v_lshrrev_b32 v9, 5, v1
    v_lshl_add_u32 v6, v9, 7, v6
    v_bfe_u32 v9, v1, 4, 1
    v_lshl_add_u32 v6, v9, 8, v6
    v_bfe_u32 v9, v1, 2, 2
    v_lshl_add_u32 v6, v9, 9, v6
    v_add_u32 v6, 155648, v6
    s_lshl3_add_u32 s96, s2, s3
    s_lshl_b32 s97, s96, 9
    s_add_u32 s14, s97, 2097152
    v_and_b32 v8, 31, v1
    v_lshlrev_b32 v8, 4, v8
    s_branch SCHK_2
SPOLL_1:
    s_load_dword s24, s[32:33], s17 offset:508 glc
    s_load_dword s25, s[32:33], s17 offset:4604 glc
SCHK_2:
    s_add_u32 s5, s5, 1
    s_cmp_ge_u32 s5, 200000
    s_waitcnt lgkmcnt(0)
    s_cbranch_scc1 SDONE_3
    s_cmp_lg_u32 s24, s4
    s_cbranch_scc1 SPOLL_1
    s_cmp_lg_u32 s25, s4
    s_cbranch_scc1 SPOLL_1
SDONE_3:
    buffer_load_dwordx4 v[176:179], v4, s[32:35], s17 offen sc1
    s_load_dword s24, s[32:33], s14 offset:252 glc
    s_load_dword s25, s[32:33], s14 offset:508 glc
    s_waitcnt vmcnt(7)
    v_permlane32_swap_b32 v12, v14
    v_permlane32_swap_b32 v13, v15
    v_permlane32_swap_b32 v16, v18
    v_permlane32_swap_b32 v17, v19
    v_lshlrev_b32 v184, 16, v12
    v_and_b32 v185, s6, v12
    v_lshlrev_b32 v186, 16, v13
    v_and_b32 v187, s6, v13
    v_lshlrev_b32 v188, 16, v14
    v_and_b32 v189, s6, v14
    v_lshlrev_b32 v190, 16, v15
    v_and_b32 v191, s6, v15
    v_lshlrev_b32 v192, 16, v16
    v_and_b32 v193, s6, v16
    v_lshlrev_b32 v194, 16, v17
    v_and_b32 v195, s6, v17
    v_lshlrev_b32 v196, 16, v18
    v_and_b32 v197, s6, v18
    v_lshlrev_b32 v198, 16, v19
    v_and_b32 v199, s6, v19
    s_branch SCHK_6
SPOLL_5:
    s_load_dword s24, s[32:33], s14 offset:252 glc
    s_load_dword s25, s[32:33], s14 offset:508 glc
SCHK_6:
    s_add_u32 s5, s5, 1
    s_cmp_ge_u32 s5, 200000
    s_waitcnt lgkmcnt(0)
    s_cbranch_scc1 SDONE_7
    s_cmp_lg_u32 s24, s4
    s_cbranch_scc1 SPOLL_5
    s_cmp_lg_u32 s25, s4
    s_cbranch_scc1 SPOLL_5
SDONE_7:
    buffer_load_dwordx4 v[172:175], v8, s[32:35], s14 offen sc1
    s_add_u32 s82, s91, 4096
    s_add_u32 m0, s94, 49152
    s_nop 0
    buffer_load_dwordx4 v3, s[40:43], s82 offen lds
    s_mov_b32 s82, s91
    s_add_u32 m0, s94, 98304
    s_nop 0
    buffer_load_dwordx4 v3, s[40:43], s82 offen lds
    s_waitcnt vmcnt(3)
    v_bitop3_b32 v7, v177, v179, s4 bitop3:0x7e
    v_cmp_ne_u32 vcc, 0, v7
    s_cbranch_vccz TOK_8
POLL_9:
    buffer_load_dwordx4 v[176:179], v4, s[32:35], s17 offen sc1
    s_waitcnt vmcnt(0)
    v_bitop3_b32 v7, v177, v179, s4 bitop3:0x7e
    v_cmp_ne_u32 vcc, 0, v7
    s_cbranch_vccz PDONE_10
    s_add_u32 s5, s5, 1
    s_cmp_lt_u32 s5, 200000
    s_cbranch_scc1 POLL_9
PDONE_10:
TOK_8:
    ds_write2_b32 v5, v176, v178 offset0:0 offset1:8
    s_waitcnt lgkmcnt(0)
    s_barrier
    ds_read_b128 v[208:211], v6 offset:2048
    ds_read_b128 v[212:215], v6 offset:2064
    ds_read_b128 v[200:203], v6
    ds_read_b128 v[204:207], v6 offset:16
    s_lshl_b32 s96, s11, 12
    s_lshl_b32 s97, s3, 9
    s_add_u32 s13, s96, s97
    v_add_u32 v4, s13, v2
    s_lshl_b32 s96, s3, 9
    s_add_u32 m0, s96, 159744
    s_mov_b32 exec_hi, 0
    global_load_lds_dwordx4 v4, s[72:73]
    s_mov_b32 exec_hi, -1
    s_lshl4_add_u32 s96, s21, s12
    s_lshr_b32 s97, s3, 1
    s_lshl2_add_u32 s98, s96, s97
    s_lshl_b32 s99, s98, 12
    s_and_b32 s96, s3, 1
    s_lshl_b32 s97, s96, 8
    s_add_u32 s98, s99, s97
    s_add_u32 s13, s98, 4194304
    v_and_b32 v4, 15, v1
    v_lshlrev_b32 v4, 4, v4
    v_bfe_u32 v9, v1, 4, 1
    v_lshl_add_u32 v4, v9, 10, v4
    v_lshrrev_b32 v9, 5, v1
    v_lshl_add_u32 v4, v9, 9, v4
    s_waitcnt lgkmcnt(2)
    v_pk_add_f32 v[208:209], v[208:209], v[210:211]
    v_pk_add_f32 v[212:213], v[212:213], v[214:215]
    v_pk_add_f32 v[208:209], v[208:209], v[212:213]
    v_add_f32 v208, v208, v209
    v_cvt_pk_bf16_f32 v208, 0, v208
    s_waitcnt lgkmcnt(0)
    v_pk_add_f32 v[200:201], v[200:201], v[202:203]
    v_pk_add_f32 v[204:205], v[204:205], v[206:207]
    v_pk_add_f32 v[200:201], v[200:201], v[204:205]
    v_add_f32 v200, v200, v201
    v_add_f32 v208, 1.0, v208
    v_cvt_pk_bf16_f32 v208, 0, v208
    v_cvt_pk_bf16_f32 v200, 0, v200
    s_waitcnt vmcnt(3)
    v_bitop3_b32 v7, v173, v175, s4 bitop3:0x7e
    v_cmp_ne_u32 vcc, 0, v7
    s_cbranch_vccz L_STOK
POLL_11:
    buffer_load_dwordx4 v[172:175], v8, s[32:35], s14 offen sc1
    s_waitcnt vmcnt(0)
    v_bitop3_b32 v7, v173, v175, s4 bitop3:0x7e
    v_cmp_ne_u32 vcc, 0, v7
    s_cbranch_vccz PDONE_12
    s_add_u32 s5, s5, 1
    s_cmp_lt_u32 s5, 200000
    s_cbranch_scc1 POLL_11
PDONE_12:
L_STOK:
    v_permlane16_swap_b32 v172, v174
    v_add_f32 v175, v172, v174
    v_mul_f32 v174, 0x3a800000, v175
    v_mul_f32 v175, 0x3a800000, v175
    s_nop 1
    v_permlane16_swap_b32 v174, v175
    v_fma_f32 v172, -v174, v174, v175
    v_cvt_pk_bf16_f32 v173, 0, v174
    v_max_f32 v172, 0, v172
    v_cvt_pk_bf16_f32 v172, 0, v172
    v_pk_add_f32 v[184:185], v[172:173], v[184:185] op_sel:[1,0] neg_lo:[1,0] neg_hi:[1,0]
    v_pk_add_f32 v[186:187], v[172:173], v[186:187] op_sel:[1,0] neg_lo:[1,0] neg_hi:[1,0]
    v_pk_add_f32 v[188:189], v[172:173], v[188:189] op_sel:[1,0] neg_lo:[1,0] neg_hi:[1,0]
    v_pk_add_f32 v[190:191], v[172:173], v[190:191] op_sel:[1,0] neg_lo:[1,0] neg_hi:[1,0]
    v_add_f32 v172, 0x3727c5ac, v172
    v_cvt_pk_bf16_f32 v172, 0, v172
    v_sqrt_f32 v172, v172
    s_nop 0
    v_pk_add_f32 v[192:193], v[172:173], v[192:193] op_sel:[1,0] neg_lo:[1,0] neg_hi:[1,0]
    v_pk_add_f32 v[194:195], v[172:173], v[194:195] op_sel:[1,0] neg_lo:[1,0] neg_hi:[1,0]
    v_pk_add_f32 v[196:197], v[172:173], v[196:197] op_sel:[1,0] neg_lo:[1,0] neg_hi:[1,0]
    v_pk_add_f32 v[198:199], v[172:173], v[198:199] op_sel:[1,0] neg_lo:[1,0] neg_hi:[1,0]
    v_cvt_pk_bf16_f32 v172, 0, v172
    v_rcp_f32 v172, v172
    v_cvt_pk_bf16_f32 v184, 0, v184
    v_cvt_pk_bf16_f32 v185, 0, v185
    v_cvt_pk_bf16_f32 v186, 0, v186
    v_cvt_pk_bf16_f32 v187, 0, v187
    v_cvt_pk_bf16_f32 v188, 0, v188
    v_cvt_pk_bf16_f32 v189, 0, v189
    v_cvt_pk_bf16_f32 v190, 0, v190
    v_cvt_pk_bf16_f32 v191, 0, v191
    v_cvt_pk_bf16_f32 v192, 0, v192
    v_cvt_pk_bf16_f32 v193, 0, v193
    v_cvt_pk_bf16_f32 v194, 0, v194
    v_cvt_pk_bf16_f32 v195, 0, v195
    v_cvt_pk_bf16_f32 v196, 0, v196
    v_cvt_pk_bf16_f32 v197, 0, v197
    v_cvt_pk_bf16_f32 v198, 0, v198
    v_cvt_pk_bf16_f32 v199, 0, v199
    v_pk_mul_f32 v[184:185], v[184:185], v[172:173] op_sel_hi:[1,0]
    v_pk_mul_f32 v[186:187], v[186:187], v[172:173] op_sel_hi:[1,0]
    v_pk_mul_f32 v[188:189], v[188:189], v[172:173] op_sel_hi:[1,0]
    v_pk_mul_f32 v[190:191], v[190:191], v[172:173] op_sel_hi:[1,0]
    v_pk_mul_f32 v[192:193], v[192:193], v[172:173] op_sel_hi:[1,0]
    v_pk_mul_f32 v[194:195], v[194:195], v[172:173] op_sel_hi:[1,0]
    v_pk_mul_f32 v[196:197], v[196:197], v[172:173] op_sel_hi:[1,0]
    v_pk_mul_f32 v[198:199], v[198:199], v[172:173] op_sel_hi:[1,0]
    v_cvt_pk_bf16_f32 v184, 0, v184
    v_cvt_pk_bf16_f32 v185, 0, v185
    v_cvt_pk_bf16_f32 v186, 0, v186
    v_cvt_pk_bf16_f32 v187, 0, v187
    v_cvt_pk_bf16_f32 v188, 0, v188
    v_cvt_pk_bf16_f32 v189, 0, v189
    v_cvt_pk_bf16_f32 v190, 0, v190
    v_cvt_pk_bf16_f32 v191, 0, v191
    v_cvt_pk_bf16_f32 v192, 0, v192
    v_cvt_pk_bf16_f32 v193, 0, v193
    v_cvt_pk_bf16_f32 v194, 0, v194
    v_cvt_pk_bf16_f32 v195, 0, v195
    v_cvt_pk_bf16_f32 v196, 0, v196
    v_cvt_pk_bf16_f32 v197, 0, v197
    v_cvt_pk_bf16_f32 v198, 0, v198
    v_cvt_pk_bf16_f32 v199, 0, v199
    v_mul_f32_dpp v184, v208, v184 row_newbcast:0 row_mask:0xf bank_mask:0xf
    v_mul_f32_dpp v185, v208, v185 row_newbcast:1 row_mask:0xf bank_mask:0xf
    v_mul_f32_dpp v186, v208, v186 row_newbcast:2 row_mask:0xf bank_mask:0xf
    v_mul_f32_dpp v187, v208, v187 row_newbcast:3 row_mask:0xf bank_mask:0xf
    v_mul_f32_dpp v188, v208, v188 row_newbcast:4 row_mask:0xf bank_mask:0xf
    v_mul_f32_dpp v189, v208, v189 row_newbcast:5 row_mask:0xf bank_mask:0xf
    v_mul_f32_dpp v190, v208, v190 row_newbcast:6 row_mask:0xf bank_mask:0xf
    v_mul_f32_dpp v191, v208, v191 row_newbcast:7 row_mask:0xf bank_mask:0xf
    v_cvt_pk_bf16_f32 v184, 0, v184
    v_cvt_pk_bf16_f32 v185, 0, v185
    v_cvt_pk_bf16_f32 v186, 0, v186
    v_cvt_pk_bf16_f32 v187, 0, v187
    v_cvt_pk_bf16_f32 v188, 0, v188
    v_cvt_pk_bf16_f32 v189, 0, v189
    v_cvt_pk_bf16_f32 v190, 0, v190
    v_cvt_pk_bf16_f32 v191, 0, v191
    v_add_f32_dpp v184, v200, v184 row_newbcast:0 row_mask:0xf bank_mask:0xf
    v_add_f32_dpp v185, v200, v185 row_newbcast:1 row_mask:0xf bank_mask:0xf
    v_add_f32_dpp v186, v200, v186 row_newbcast:2 row_mask:0xf bank_mask:0xf
    v_add_f32_dpp v187, v200, v187 row_newbcast:3 row_mask:0xf bank_mask:0xf
    v_add_f32_dpp v188, v200, v188 row_newbcast:4 row_mask:0xf bank_mask:0xf
    v_add_f32_dpp v189, v200, v189 row_newbcast:5 row_mask:0xf bank_mask:0xf
    v_add_f32_dpp v190, v200, v190 row_newbcast:6 row_mask:0xf bank_mask:0xf
    v_add_f32_dpp v191, v200, v191 row_newbcast:7 row_mask:0xf bank_mask:0xf
    v_cvt_pk_bf16_f32 v216, v184, v185
    v_cvt_pk_bf16_f32 v217, v186, v187
    v_cvt_pk_bf16_f32 v218, v188, v189
    v_cvt_pk_bf16_f32 v219, v190, v191
    buffer_store_dwordx4 v[216:219], v4, s[32:35], s13 offen sc1
    v_mul_f32_dpp v192, v208, v192 row_newbcast:8 row_mask:0xf bank_mask:0xf
    v_mul_f32_dpp v193, v208, v193 row_newbcast:9 row_mask:0xf bank_mask:0xf
    v_mul_f32_dpp v194, v208, v194 row_newbcast:10 row_mask:0xf bank_mask:0xf
    v_mul_f32_dpp v195, v208, v195 row_newbcast:11 row_mask:0xf bank_mask:0xf
    v_mul_f32_dpp v196, v208, v196 row_newbcast:12 row_mask:0xf bank_mask:0xf
    v_mul_f32_dpp v197, v208, v197 row_newbcast:13 row_mask:0xf bank_mask:0xf
    v_mul_f32_dpp v198, v208, v198 row_newbcast:14 row_mask:0xf bank_mask:0xf
    v_mul_f32_dpp v199, v208, v199 row_newbcast:15 row_mask:0xf bank_mask:0xf
    v_cvt_pk_bf16_f32 v192, 0, v192
    v_cvt_pk_bf16_f32 v193, 0, v193
    v_cvt_pk_bf16_f32 v194, 0, v194
    v_cvt_pk_bf16_f32 v195, 0, v195
    v_cvt_pk_bf16_f32 v196, 0, v196
    v_cvt_pk_bf16_f32 v197, 0, v197
    v_cvt_pk_bf16_f32 v198, 0, v198
    v_cvt_pk_bf16_f32 v199, 0, v199
    v_add_f32_dpp v192, v200, v192 row_newbcast:8 row_mask:0xf bank_mask:0xf
    v_add_f32_dpp v193, v200, v193 row_newbcast:9 row_mask:0xf bank_mask:0xf
    v_add_f32_dpp v194, v200, v194 row_newbcast:10 row_mask:0xf bank_mask:0xf
    v_add_f32_dpp v195, v200, v195 row_newbcast:11 row_mask:0xf bank_mask:0xf
    v_add_f32_dpp v196, v200, v196 row_newbcast:12 row_mask:0xf bank_mask:0xf
    v_add_f32_dpp v197, v200, v197 row_newbcast:13 row_mask:0xf bank_mask:0xf
    v_add_f32_dpp v198, v200, v198 row_newbcast:14 row_mask:0xf bank_mask:0xf
    v_add_f32_dpp v199, v200, v199 row_newbcast:15 row_mask:0xf bank_mask:0xf
    v_cvt_pk_bf16_f32 v220, v192, v193
    v_cvt_pk_bf16_f32 v221, v194, v195
    v_cvt_pk_bf16_f32 v222, v196, v197
    v_cvt_pk_bf16_f32 v223, v198, v199
    buffer_store_dwordx4 v[220:223], v4, s[32:35], s13 offen offset:2048 sc1
    v_bfe_u32 v20, v1, 2, 2
    v_lshlrev_b32 v20, 7, v20
    v_bfe_u32 v9, v1, 3, 1
    v_lshl_add_u32 v20, v9, 6, v20
    v_bfe_u32 v9, v1, 4, 1
    v_lshl_add_u32 v20, v9, 5, v20
    v_and_b32 v9, 3, v1
    v_lshl_add_u32 v20, v9, 3, v20
    v_lshrrev_b32 v9, 5, v1
    v_lshl_add_u32 v20, v9, 9, v20
    v_xor_b32 v21, 64, v20
    v_add_u32 v22, 49152, v20
    v_add_u32 v23, 49152, v21
    v_add_u32 v24, 98304, v20
    v_add_u32 v25, 98304, v21
    v_and_b32 v5, 3, v1
    v_lshlrev_b32 v5, 15, v5
    v_bfe_u32 v9, v1, 2, 2
    v_lshl_add_u32 v5, v9, 12, v5
    s_and_b32 s96, s12, 1
    s_lshr_b32 s97, s21, 3
    s_and_b32 s98, s21, 7
    s_lshl_b32 s99, s98, 5
    s_lshl2_add_u32 s98, s97, s99
    s_lshl_b32 s97, s98, 12
    s_lshr_b32 s99, s12, 1
    s_lshl_b32 s98, s99, 6
    s_add_u32 s99, s97, s98
    s_lshl2_add_u32 s97, s96, s99
    s_add_u32 s13, s97, 1048576
    s_lshl_b32 s96, s10, 18
    s_lshl_b32 s97, s77, 12
    s_add_u32 s98, s96, s97
    s_add_u32 s88, s98, 4194304
    s_cmp_ge_u32 s9, 28
    s_cselect_b32 s54, 0, s54
    s_cselect_b32 s58, 0, s58
    s_cselect_b32 s62, 0, s62
    s_waitcnt vmcnt(0)
    s_barrier
    s_cmp_lg_u32 s3, 0
    s_cbranch_scc1 L_PB
    v_mov_b32 v6, s4
    s_mov_b32 exec_hi, 0
    s_mov_b32 exec_lo, 65535
    buffer_store_dword v6, v5, s[32:35], s13 offen sc1
    s_mov_b64 exec, -1
L_PB:
    s_lshr_b32 s96, s9, 4
    s_lshl_b32 s97, s96, 1
    s_xor_b32 s94, s97, 2
    s_add_u32 s96, s94, s84
    s_and_b32 s97, s96, 15
    s_mul_i32 s98, s97, 393216
    s_add_u32 s91, s98, s85
    s_lshl_b32 s96, s94, 13
    s_add_u32 s94, s96, s83
    s_add_u32 s82, s91, 2048
    s_mov_b32 m0, s94
    s_nop 0
    buffer_load_dwordx4 v3, s[40:43], s82 offen lds
    s_add_u32 s82, s91, 4096
    s_add_u32 m0, s94, 49152
    s_nop 0
    buffer_load_dwordx4 v3, s[40:43], s82 offen lds
    s_mov_b32 s82, s91
    s_add_u32 m0, s94, 98304
    s_nop 0
    buffer_load_dwordx4 v3, s[40:43], s82 offen lds
    s_lshr_b32 s96, s9, 4
    s_lshl_b32 s97, s96, 1
    s_xor_b32 s94, s97, 3
    s_add_u32 s96, s94, s84
    s_and_b32 s97, s96, 15
    s_mul_i32 s98, s97, 393216
    s_add_u32 s91, s98, s85
    s_lshl_b32 s96, s94, 13
    s_add_u32 s94, s96, s83
    s_add_u32 s82, s91, 2048
    s_mov_b32 m0, s94
    s_nop 0
    buffer_load_dwordx4 v3, s[40:43], s82 offen lds
    s_add_u32 s82, s91, 4096
    s_add_u32 m0, s94, 49152
    s_nop 0
    buffer_load_dwordx4 v3, s[40:43], s82 offen lds
    s_mov_b32 s82, s91
    s_add_u32 m0, s94, 98304
    s_nop 0
    buffer_load_dwordx4 v3, s[40:43], s82 offen lds
    s_lshl_b32 s96, s2, 12
    s_add_u32 s19, s96, 1048576
    s_and_b32 s96, s3, 3
    s_lshl_b32 s97, s96, 7
    s_add_u32 s20, s97, s19
    s_lshl_b32 s96, s84, 5
    s_add_u32 s19, s96, s19
    s_cmp_ge_u32 s3, 4
    s_cselect_b32 s19, s20, s19
    s_load_dwordx2 s[24:25], s[32:33], s19 offset:0 glc
    s_load_dwordx2 s[26:27], s[32:33], s19 offset:64 glc
    s_lshl_b32 s96, s3, 14
    s_lshl_b32 s97, s12, 7
    s_add_u32 s90, s96, s97
    s_and_b32 s96, s9, 1
    s_lshr_b32 s97, s9, 3
    s_lshl_b32 s98, s97, 1
    s_lshl3_add_u32 s99, s96, s98
    s_lshl_b32 s95, s99, 17
    s_lshl3_add_u32 s96, s75, s3
    s_mul_i32 s97, s96, 229376
    s_lshl_b32 s98, s74, 7
    s_add_u32 s80, s97, s98
    s_lshl3_add_u32 s96, s74, s3
    s_lshl_b32 s97, s96, 14
    s_lshl_b32 s98, s75, 9
    s_add_u32 s81, s97, s98
    s_and_b32 s96, s8, 3
    s_lshl3_add_u32 s97, s96, s3
    s_mul_i32 s98, s97, 393216
    s_lshr_b32 s99, s8, 2
    s_lshl1_add_u32 s96, s9, s99
    s_lshl_b32 s97, s96, 7
    s_add_u32 s99, s98, s97
    s_add_u32 s89, s99, 4096
    s_and_b32 s96, s3, 1
    s_lshl_b32 s14, s96, 6
    v_bfe_u32 v6, v1, 4, 1
    v_lshl_add_u32 v6, v6, 5, s14
    v_and_b32 v26, 7, v1
    v_lshlrev_b32 v26, 4, v26
    v_xor_b32 v26, v26, v6
    v_lshrrev_b32 v6, 3, v1
    v_lshlrev_b32 v6, 11, v6
    v_add_u32 v26, v26, v6
    s_and_b32 s96, s3, 2
    s_lshl_b32 s14, s96, 5
    v_bfe_u32 v6, v1, 4, 1
    v_lshl_add_u32 v6, v6, 5, s14
    v_and_b32 v27, 7, v1
    v_lshlrev_b32 v27, 4, v27
    v_xor_b32 v27, v27, v6
    v_lshrrev_b32 v6, 3, v1
    v_mul_u32_u24 v6, 7168, v6
    v_add_u32 v27, v27, v6
    s_and_b32 s96, s3, 1
    s_lshl_b32 s14, s96, 7
    v_lshrrev_b32 v6, 5, v1
    v_lshl_add_u32 v6, v6, 6, s14
    v_and_b32 v253, 31, v1
    v_lshlrev_b32 v253, 4, v253
    v_lshrrev_b32 v9, 5, v1
    v_lshl_add_u32 v253, v9, 11, v253
    v_xor_b32 v253, v253, v6
    s_lshl_b32 s16, s84, 14
    v_add_u32 v249, s88, v2
    s_lshl_b32 s96, s77, 11
    s_add_u32 s14, s96, 151552
    v_add_u32 v0, s14, v2
    s_mov_b64 exec, 0
    s_cmp_eq_u32 s3, 4
    s_cbranch_scc1 L_PAD2
    s_cmp_eq_u32 s3, 5
    s_cbranch_scc1 L_PAD3
    s_cmp_eq_u32 s3, 6
    s_cbranch_scc1 L_PAD4
    s_cmp_eq_u32 s3, 7
    s_cbranch_scc1 L_PAD5
    s_branch L_TEND
L_RET2:
    s_branch L_PAD6
L_RET6:
    s_branch L_PAD10
L_RET10:
    s_branch L_TEND
L_RET3:
    s_branch L_PAD7
L_RET7:
    s_branch L_TEND
L_RET4:
    s_branch L_PAD8
L_RET8:
    s_branch L_TEND
L_RET5:
    s_branch L_PAD9
L_RET9:
    s_branch L_TEND
    s_nop 0
    s_nop 0
    s_nop 0
    s_nop 0
    s_nop 0
    s_nop 0
    s_nop 0
    s_nop 0
    s_nop 0
    s_nop 0
    s_nop 0
    s_nop 0
    s_nop 0
    s_nop 0
    s_nop 0
    s_nop 0
    s_nop 0
    s_nop 0
    s_nop 0
    s_nop 0
    s_nop 0
    s_nop 0
    s_nop 0
    s_nop 0
    s_nop 0
    s_nop 0
    s_nop 0
    s_nop 0
L_TEND:
    s_mov_b64 exec, -1
    s_cmp_ge_u32 s3, 4
    s_cbranch_scc1 L_HELP
    s_branch SCHK_14
SPOLL_13:
    s_load_dwordx2 s[24:25], s[32:33], s19 offset:0 glc
    s_load_dwordx2 s[26:27], s[32:33], s19 offset:64 glc
SCHK_14:
    s_add_u32 s5, s5, 1
    s_cmp_ge_u32 s5, 200000
    s_waitcnt lgkmcnt(0)
    s_cbranch_scc1 SDONE_15
    s_cmp_lg_u32 s24, s4
    s_cbranch_scc1 SPOLL_13
    s_cmp_lg_u32 s25, s4
    s_cbranch_scc1 SPOLL_13
    s_cmp_lg_u32 s26, s4
    s_cbranch_scc1 SPOLL_13
    s_cmp_lg_u32 s27, s4
    s_cbranch_scc1 SPOLL_13
SDONE_15:
    s_setprio 2
    buffer_load_dwordx4 v[152:155], v249, s[32:35], s16 offen sc1
    buffer_load_dwordx4 v[156:159], v249, s[32:35], s16 offen offset:1024 sc1
    buffer_load_dwordx4 v[160:163], v249, s[32:35], s16 offen offset:2048 sc1
    buffer_load_dwordx4 v[164:167], v249, s[32:35], s16 offen offset:3072 sc1
    s_add_u32 s16, s16, 16384
    s_and_b32 s16, s16, 0x3ffff
    buffer_load_dwordx4 v[168:171], v249, s[32:35], s16 offen sc1
    buffer_load_dwordx4 v[172:175], v249, s[32:35], s16 offen offset:1024 sc1
    buffer_load_dwordx4 v[176:179], v249, s[32:35], s16 offen offset:2048 sc1
    buffer_load_dwordx4 v[180:183], v249, s[32:35], s16 offen offset:3072 sc1
    s_waitcnt vmcnt(8)
    s_barrier
    ds_read_b64_tr_b16 v[28:29], v20
    ds_read_b64_tr_b16 v[30:31], v20 offset:2048
    ds_read_b64_tr_b16 v[32:33], v21
    ds_read_b64_tr_b16 v[34:35], v21 offset:2048
    ds_read_b64_tr_b16 v[36:37], v24
    ds_read_b64_tr_b16 v[38:39], v24 offset:2048
    ds_read_b64_tr_b16 v[40:41], v25
    ds_read_b64_tr_b16 v[42:43], v25 offset:2048
    ds_read_b64_tr_b16 v[44:45], v22
    ds_read_b64_tr_b16 v[46:47], v22 offset:2048
    ds_read_b64_tr_b16 v[48:49], v23
    ds_read_b64_tr_b16 v[50:51], v23 offset:2048
    s_waitcnt vmcnt(7)
    s_waitcnt lgkmcnt(10)
    v_mfma_f32_32x32x16_bf16 v[56:71], v[28:31], v[152:155], 0
    s_add_u32 s16, s16, 16384
    ds_read_b64_tr_b16 v[52:53], v20 offset:1024
    ds_read_b64_tr_b16 v[54:55], v20 offset:3072
    s_waitcnt lgkmcnt(10)
    v_mfma_f32_32x32x16_bf16 v[72:87], v[32:35], v[152:155], 0
    s_and_b32 s16, s16, 0x3ffff
    ds_read_b64_tr_b16 v[28:29], v21 offset:1024
    ds_read_b64_tr_b16 v[30:31], v21 offset:3072
    s_waitcnt lgkmcnt(10)
    v_mfma_f32_32x32x16_bf16 v[120:135], v[36:39], v[152:155], 0
    ds_read_b64_tr_b16 v[32:33], v24 offset:1024
    ds_read_b64_tr_b16 v[34:35], v24 offset:3072
    s_waitcnt lgkmcnt(10)
    v_mfma_f32_32x32x16_bf16 v[136:151], v[40:43], v[152:155], 0
    buffer_load_dwordx4 v[184:187], v249, s[32:35], s16 offen sc1
    ds_read_b64_tr_b16 v[36:37], v25 offset:1024
    ds_read_b64_tr_b16 v[38:39], v25 offset:3072
    s_waitcnt lgkmcnt(10)
    v_mfma_f32_32x32x16_bf16 v[88:103], v[44:47], v[152:155], 0
    ds_read_b64_tr_b16 v[40:41], v22 offset:1024
    ds_read_b64_tr_b16 v[42:43], v22 offset:3072
    s_waitcnt lgkmcnt(10)
    v_mfma_f32_32x32x16_bf16 v[104:119], v[48:51], v[152:155], 0
    ds_read_b64_tr_b16 v[44:45], v23 offset:1024
    ds_read_b64_tr_b16 v[46:47], v23 offset:3072
    s_waitcnt vmcnt(7)
    s_waitcnt lgkmcnt(10)
    v_mfma_f32_32x32x16_bf16 v[56:71], v[52:55], v[156:159], v[56:71]
    ds_read_b64_tr_b16 v[48:49], v20 offset:4096
    ds_read_b64_tr_b16 v[50:51], v20 offset:6144
    s_waitcnt lgkmcnt(10)
    v_mfma_f32_32x32x16_bf16 v[72:87], v[28:31], v[156:159], v[72:87]
    buffer_load_dwordx4 v[188:191], v249, s[32:35], s16 offen offset:1024 sc1
    ds_read_b64_tr_b16 v[52:53], v21 offset:4096
    ds_read_b64_tr_b16 v[54:55], v21 offset:6144
    s_waitcnt lgkmcnt(10)
    v_mfma_f32_32x32x16_bf16 v[120:135], v[32:35], v[156:159], v[120:135]
    ds_read_b64_tr_b16 v[28:29], v24 offset:4096
    ds_read_b64_tr_b16 v[30:31], v24 offset:6144
    s_waitcnt lgkmcnt(10)
    v_mfma_f32_32x32x16_bf16 v[136:151], v[36:39], v[156:159], v[136:151]
    ds_read_b64_tr_b16 v[32:33], v25 offset:4096
    ds_read_b64_tr_b16 v[34:35], v25 offset:6144
    s_waitcnt lgkmcnt(10)
    v_mfma_f32_32x32x16_bf16 v[88:103], v[40:43], v[156:159], v[88:103]
    ds_read_b64_tr_b16 v[36:37], v22 offset:4096
    ds_read_b64_tr_b16 v[38:39], v22 offset:6144
    s_waitcnt lgkmcnt(10)
    v_mfma_f32_32x32x16_bf16 v[104:119], v[44:47], v[156:159], v[104:119]
    buffer_load_dwordx4 v[192:195], v249, s[32:35], s16 offen offset:2048 sc1
    ds_read_b64_tr_b16 v[40:41], v23 offset:4096
    ds_read_b64_tr_b16 v[42:43], v23 offset:6144
    s_waitcnt vmcnt(8)
    s_waitcnt lgkmcnt(10)
    v_mfma_f32_32x32x16_bf16 v[56:71], v[48:51], v[160:163], v[56:71]
    ds_read_b64_tr_b16 v[44:45], v20 offset:5120
    ds_read_b64_tr_b16 v[46:47], v20 offset:7168
    s_waitcnt lgkmcnt(10)
    v_mfma_f32_32x32x16_bf16 v[72:87], v[52:55], v[160:163], v[72:87]
    ds_read_b64_tr_b16 v[48:49], v21 offset:5120
    ds_read_b64_tr_b16 v[50:51], v21 offset:7168
    s_waitcnt lgkmcnt(10)
    v_mfma_f32_32x32x16_bf16 v[120:135], v[28:31], v[160:163], v[120:135]
    ds_read_b64_tr_b16 v[52:53], v24 offset:5120
    ds_read_b64_tr_b16 v[54:55], v24 offset:7168
    s_waitcnt lgkmcnt(10)
    v_mfma_f32_32x32x16_bf16 v[136:151], v[32:35], v[160:163], v[136:151]
    buffer_load_dwordx4 v[196:199], v249, s[32:35], s16 offen offset:3072 sc1
    ds_read_b64_tr_b16 v[28:29], v25 offset:5120
    ds_read_b64_tr_b16 v[30:31], v25 offset:7168
    s_waitcnt lgkmcnt(10)
    v_mfma_f32_32x32x16_bf16 v[88:103], v[36:39], v[160:163], v[88:103]
    s_add_u32 s16, s16, 16384
    ds_read_b64_tr_b16 v[32:33], v22 offset:5120
    ds_read_b64_tr_b16 v[34:35], v22 offset:7168
    s_waitcnt lgkmcnt(10)
    v_mfma_f32_32x32x16_bf16 v[104:119], v[40:43], v[160:163], v[104:119]
    s_and_b32 s16, s16, 0x3ffff
    ds_read_b64_tr_b16 v[36:37], v23 offset:5120
    ds_read_b64_tr_b16 v[38:39], v23 offset:7168
    s_waitcnt vmcnt(8)
    s_waitcnt lgkmcnt(10)
    v_mfma_f32_32x32x16_bf16 v[56:71], v[44:47], v[164:167], v[56:71]
    ds_read_b64_tr_b16 v[40:41], v20 offset:8192
    ds_read_b64_tr_b16 v[42:43], v20 offset:10240
    s_waitcnt lgkmcnt(10)
    v_mfma_f32_32x32x16_bf16 v[72:87], v[48:51], v[164:167], v[72:87]
    buffer_load_dwordx4 v[200:203], v249, s[32:35], s16 offen sc1
    ds_read_b64_tr_b16 v[44:45], v21 offset:8192
    ds_read_b64_tr_b16 v[46:47], v21 offset:10240
    s_waitcnt lgkmcnt(10)
    v_mfma_f32_32x32x16_bf16 v[120:135], v[52:55], v[164:167], v[120:135]
    ds_read_b64_tr_b16 v[48:49], v24 offset:8192
    ds_read_b64_tr_b16 v[50:51], v24 offset:10240
    s_waitcnt lgkmcnt(10)
    v_mfma_f32_32x32x16_bf16 v[136:151], v[28:31], v[164:167], v[136:151]
    ds_read_b64_tr_b16 v[52:53], v25 offset:8192
    ds_read_b64_tr_b16 v[54:55], v25 offset:10240
    s_waitcnt lgkmcnt(10)
    v_mfma_f32_32x32x16_bf16 v[88:103], v[32:35], v[164:167], v[88:103]
    ds_read_b64_tr_b16 v[28:29], v22 offset:8192
    ds_read_b64_tr_b16 v[30:31], v22 offset:10240
    s_waitcnt lgkmcnt(10)
    v_mfma_f32_32x32x16_bf16 v[104:119], v[36:39], v[164:167], v[104:119]
    buffer_load_dwordx4 v[204:207], v249, s[32:35], s16 offen offset:1024 sc1
    ds_read_b64_tr_b16 v[32:33], v23 offset:8192
    ds_read_b64_tr_b16 v[34:35], v23 offset:10240
    s_barrier
    s_waitcnt vmcnt(9)
    s_waitcnt lgkmcnt(10)
    v_mfma_f32_32x32x16_bf16 v[56:71], v[40:43], v[168:171], v[56:71]
    ds_read_b64_tr_b16 v[36:37], v20 offset:9216
    ds_read_b64_tr_b16 v[38:39], v20 offset:11264
    s_waitcnt lgkmcnt(10)
    v_mfma_f32_32x32x16_bf16 v[72:87], v[44:47], v[168:171], v[72:87]
    ds_read_b64_tr_b16 v[40:41], v21 offset:9216
    ds_read_b64_tr_b16 v[42:43], v21 offset:11264
    s_waitcnt lgkmcnt(10)
    v_mfma_f32_32x32x16_bf16 v[120:135], v[48:51], v[168:171], v[120:135]
    ds_read_b64_tr_b16 v[44:45], v24 offset:9216
    ds_read_b64_tr_b16 v[46:47], v24 offset:11264
    s_waitcnt lgkmcnt(10)
    v_mfma_f32_32x32x16_bf16 v[136:151], v[52:55], v[168:171], v[136:151]
    ds_read_b64_tr_b16 v[48:49], v25 offset:9216
    ds_read_b64_tr_b16 v[50:51], v25 offset:11264
    s_waitcnt lgkmcnt(10)
    v_mfma_f32_32x32x16_bf16 v[88:103], v[28:31], v[168:171], v[88:103]
    ds_read_b64_tr_b16 v[52:53], v22 offset:9216
    ds_read_b64_tr_b16 v[54:55], v22 offset:11264
    s_waitcnt lgkmcnt(10)
    v_mfma_f32_32x32x16_bf16 v[104:119], v[32:35], v[168:171], v[104:119]
    ds_read_b64_tr_b16 v[28:29], v23 offset:9216
    ds_read_b64_tr_b16 v[30:31], v23 offset:11264
    s_waitcnt vmcnt(8)
    s_waitcnt lgkmcnt(10)
    v_mfma_f32_32x32x16_bf16 v[56:71], v[36:39], v[172:175], v[56:71]
    ds_read_b64_tr_b16 v[32:33], v20 offset:12288
    ds_read_b64_tr_b16 v[34:35], v20 offset:14336
    s_waitcnt lgkmcnt(10)
    v_mfma_f32_32x32x16_bf16 v[72:87], v[40:43], v[172:175], v[72:87]
    ds_read_b64_tr_b16 v[36:37], v21 offset:12288
    ds_read_b64_tr_b16 v[38:39], v21 offset:14336
    s_waitcnt lgkmcnt(10)
    v_mfma_f32_32x32x16_bf16 v[120:135], v[44:47], v[172:175], v[120:135]
    buffer_load_dwordx4 v[208:211], v249, s[32:35], s16 offen offset:2048 sc1
    ds_read_b64_tr_b16 v[40:41], v24 offset:12288
    ds_read_b64_tr_b16 v[42:43], v24 offset:14336
    s_waitcnt lgkmcnt(10)
    v_mfma_f32_32x32x16_bf16 v[136:151], v[48:51], v[172:175], v[136:151]
    ds_read_b64_tr_b16 v[44:45], v25 offset:12288
    ds_read_b64_tr_b16 v[46:47], v25 offset:14336
    s_waitcnt lgkmcnt(10)
    v_mfma_f32_32x32x16_bf16 v[88:103], v[52:55], v[172:175], v[88:103]
    ds_read_b64_tr_b16 v[48:49], v22 offset:12288
    ds_read_b64_tr_b16 v[50:51], v22 offset:14336
    s_waitcnt lgkmcnt(10)
    v_mfma_f32_32x32x16_bf16 v[104:119], v[28:31], v[172:175], v[104:119]
    buffer_load_dwordx4 v[212:215], v249, s[32:35], s16 offen offset:3072 sc1
    ds_read_b64_tr_b16 v[52:53], v23 offset:12288
    ds_read_b64_tr_b16 v[54:55], v23 offset:14336
    s_waitcnt vmcnt(9)
    s_waitcnt lgkmcnt(10)
    v_mfma_f32_32x32x16_bf16 v[56:71], v[32:35], v[176:179], v[56:71]
    s_add_u32 s16, s16, 16384
    ds_read_b64_tr_b16 v[28:29], v20 offset:13312
    ds_read_b64_tr_b16 v[30:31], v20 offset:15360
    s_waitcnt lgkmcnt(10)
    v_mfma_f32_32x32x16_bf16 v[72:87], v[36:39], v[176:179], v[72:87]
    s_and_b32 s16, s16, 0x3ffff
    ds_read_b64_tr_b16 v[32:33], v21 offset:13312
    ds_read_b64_tr_b16 v[34:35], v21 offset:15360
    s_waitcnt lgkmcnt(10)
    v_mfma_f32_32x32x16_bf16 v[120:135], v[40:43], v[176:179], v[120:135]
    buffer_load_dwordx4 v[216:219], v249, s[32:35], s16 offen sc1
    ds_read_b64_tr_b16 v[36:37], v24 offset:13312
    ds_read_b64_tr_b16 v[38:39], v24 offset:15360
    s_waitcnt lgkmcnt(10)
    v_mfma_f32_32x32x16_bf16 v[136:151], v[44:47], v[176:179], v[136:151]
    ds_read_b64_tr_b16 v[40:41], v25 offset:13312
    ds_read_b64_tr_b16 v[42:43], v25 offset:15360
    s_waitcnt lgkmcnt(10)
    v_mfma_f32_32x32x16_bf16 v[88:103], v[48:51], v[176:179], v[88:103]
    ds_read_b64_tr_b16 v[44:45], v22 offset:13312
    ds_read_b64_tr_b16 v[46:47], v22 offset:15360
    s_waitcnt lgkmcnt(10)
    v_mfma_f32_32x32x16_bf16 v[104:119], v[52:55], v[176:179], v[104:119]
    buffer_load_dwordx4 v[220:223], v249, s[32:35], s16 offen offset:1024 sc1
    ds_read_b64_tr_b16 v[48:49], v23 offset:13312
    ds_read_b64_tr_b16 v[50:51], v23 offset:15360
    s_waitcnt vmcnt(10)
    s_waitcnt lgkmcnt(10)
    v_mfma_f32_32x32x16_bf16 v[56:71], v[28:31], v[180:183], v[56:71]
    ds_read_b64_tr_b16 v[52:53], v20 offset:16384
    ds_read_b64_tr_b16 v[54:55], v20 offset:18432
    s_waitcnt lgkmcnt(10)
    v_mfma_f32_32x32x16_bf16 v[72:87], v[32:35], v[180:183], v[72:87]
    ds_read_b64_tr_b16 v[28:29], v21 offset:16384
    ds_read_b64_tr_b16 v[30:31], v21 offset:18432
    s_waitcnt lgkmcnt(10)
    v_mfma_f32_32x32x16_bf16 v[120:135], v[36:39], v[180:183], v[120:135]
    buffer_load_dwordx4 v[224:227], v249, s[32:35], s16 offen offset:2048 sc1
    ds_read_b64_tr_b16 v[32:33], v24 offset:16384
    ds_read_b64_tr_b16 v[34:35], v24 offset:18432
    s_waitcnt lgkmcnt(10)
    v_mfma_f32_32x32x16_bf16 v[136:151], v[40:43], v[180:183], v[136:151]
    ds_read_b64_tr_b16 v[36:37], v25 offset:16384
    ds_read_b64_tr_b16 v[38:39], v25 offset:18432
    s_waitcnt lgkmcnt(10)
    v_mfma_f32_32x32x16_bf16 v[88:103], v[44:47], v[180:183], v[88:103]
    ds_read_b64_tr_b16 v[40:41], v22 offset:16384
    ds_read_b64_tr_b16 v[42:43], v22 offset:18432
    s_waitcnt lgkmcnt(10)
    v_mfma_f32_32x32x16_bf16 v[104:119], v[48:51], v[180:183], v[104:119]
    buffer_load_dwordx4 v[228:231], v249, s[32:35], s16 offen offset:3072 sc1
    ds_read_b64_tr_b16 v[44:45], v23 offset:16384
    ds_read_b64_tr_b16 v[46:47], v23 offset:18432
    s_barrier
    s_waitcnt vmcnt(11)
    s_waitcnt lgkmcnt(10)
    v_mfma_f32_32x32x16_bf16 v[56:71], v[52:55], v[184:187], v[56:71]
    s_add_u32 s16, s16, 16384
    ds_read_b64_tr_b16 v[48:49], v20 offset:17408
    ds_read_b64_tr_b16 v[50:51], v20 offset:19456
    s_waitcnt lgkmcnt(10)
    v_mfma_f32_32x32x16_bf16 v[72:87], v[28:31], v[184:187], v[72:87]
    s_and_b32 s16, s16, 0x3ffff
    ds_read_b64_tr_b16 v[52:53], v21 offset:17408
    ds_read_b64_tr_b16 v[54:55], v21 offset:19456
    s_waitcnt lgkmcnt(10)
    v_mfma_f32_32x32x16_bf16 v[120:135], v[32:35], v[184:187], v[120:135]
    ds_read_b64_tr_b16 v[28:29], v24 offset:17408
    ds_read_b64_tr_b16 v[30:31], v24 offset:19456
    s_waitcnt lgkmcnt(10)
    v_mfma_f32_32x32x16_bf16 v[136:151], v[36:39], v[184:187], v[136:151]
    ds_read_b64_tr_b16 v[32:33], v25 offset:17408
    ds_read_b64_tr_b16 v[34:35], v25 offset:19456
    s_waitcnt lgkmcnt(10)
    v_mfma_f32_32x32x16_bf16 v[88:103], v[40:43], v[184:187], v[88:103]
    ds_read_b64_tr_b16 v[36:37], v22 offset:17408
    ds_read_b64_tr_b16 v[38:39], v22 offset:19456
    s_waitcnt lgkmcnt(10)
    v_mfma_f32_32x32x16_bf16 v[104:119], v[44:47], v[184:187], v[104:119]
    ds_read_b64_tr_b16 v[40:41], v23 offset:17408
    ds_read_b64_tr_b16 v[42:43], v23 offset:19456
    s_waitcnt vmcnt(10)
    s_waitcnt lgkmcnt(10)
    v_mfma_f32_32x32x16_bf16 v[56:71], v[48:51], v[188:191], v[56:71]
    ds_read_b64_tr_b16 v[44:45], v20 offset:20480
    ds_read_b64_tr_b16 v[46:47], v20 offset:22528
    s_waitcnt lgkmcnt(10)
    v_mfma_f32_32x32x16_bf16 v[72:87], v[52:55], v[188:191], v[72:87]
    ds_read_b64_tr_b16 v[48:49], v21 offset:20480
    ds_read_b64_tr_b16 v[50:51], v21 offset:22528
    s_waitcnt lgkmcnt(10)
    v_mfma_f32_32x32x16_bf16 v[120:135], v[28:31], v[188:191], v[120:135]
    buffer_load_dwordx4 v[232:235], v249, s[32:35], s16 offen sc1
    ds_read_b64_tr_b16 v[52:53], v24 offset:20480
    ds_read_b64_tr_b16 v[54:55], v24 offset:22528
    s_waitcnt lgkmcnt(10)
    v_mfma_f32_32x32x16_bf16 v[136:151], v[32:35], v[188:191], v[136:151]
    ds_read_b64_tr_b16 v[28:29], v25 offset:20480
    ds_read_b64_tr_b16 v[30:31], v25 offset:22528
    s_waitcnt lgkmcnt(10)
    v_mfma_f32_32x32x16_bf16 v[88:103], v[36:39], v[188:191], v[88:103]
    ds_read_b64_tr_b16 v[32:33], v22 offset:20480
    ds_read_b64_tr_b16 v[34:35], v22 offset:22528
    s_waitcnt lgkmcnt(10)
    v_mfma_f32_32x32x16_bf16 v[104:119], v[40:43], v[188:191], v[104:119]
    buffer_load_dwordx4 v[236:239], v249, s[32:35], s16 offen offset:1024 sc1
    ds_read_b64_tr_b16 v[36:37], v23 offset:20480
    ds_read_b64_tr_b16 v[38:39], v23 offset:22528
    s_waitcnt vmcnt(11)
    s_waitcnt lgkmcnt(10)
    v_mfma_f32_32x32x16_bf16 v[56:71], v[44:47], v[192:195], v[56:71]
    ds_read_b64_tr_b16 v[40:41], v20 offset:21504
    ds_read_b64_tr_b16 v[42:43], v20 offset:23552
    s_waitcnt lgkmcnt(10)
    v_mfma_f32_32x32x16_bf16 v[72:87], v[48:51], v[192:195], v[72:87]
    ds_read_b64_tr_b16 v[44:45], v21 offset:21504
    ds_read_b64_tr_b16 v[46:47], v21 offset:23552
    s_waitcnt lgkmcnt(10)
    v_mfma_f32_32x32x16_bf16 v[120:135], v[52:55], v[192:195], v[120:135]
    buffer_load_dwordx4 v[240:243], v249, s[32:35], s16 offen offset:2048 sc1
    ds_read_b64_tr_b16 v[48:49], v24 offset:21504
    ds_read_b64_tr_b16 v[50:51], v24 offset:23552
    s_waitcnt lgkmcnt(10)
    v_mfma_f32_32x32x16_bf16 v[136:151], v[28:31], v[192:195], v[136:151]
    ds_read_b64_tr_b16 v[52:53], v25 offset:21504
    ds_read_b64_tr_b16 v[54:55], v25 offset:23552
    s_waitcnt lgkmcnt(10)
    v_mfma_f32_32x32x16_bf16 v[88:103], v[32:35], v[192:195], v[88:103]
    ds_read_b64_tr_b16 v[28:29], v22 offset:21504
    ds_read_b64_tr_b16 v[30:31], v22 offset:23552
    s_waitcnt lgkmcnt(10)
    v_mfma_f32_32x32x16_bf16 v[104:119], v[36:39], v[192:195], v[104:119]
    buffer_load_dwordx4 v[244:247], v249, s[32:35], s16 offen offset:3072 sc1
    ds_read_b64_tr_b16 v[32:33], v23 offset:21504
    ds_read_b64_tr_b16 v[34:35], v23 offset:23552
    s_waitcnt vmcnt(12)
    s_waitcnt lgkmcnt(10)
    v_mfma_f32_32x32x16_bf16 v[56:71], v[40:43], v[196:199], v[56:71]
    s_add_u32 s16, s16, 16384
    ds_read_b64_tr_b16 v[36:37], v20 offset:24576
    ds_read_b64_tr_b16 v[38:39], v20 offset:26624
    s_waitcnt lgkmcnt(10)
    v_mfma_f32_32x32x16_bf16 v[72:87], v[44:47], v[196:199], v[72:87]
    s_and_b32 s16, s16, 0x3ffff
    ds_read_b64_tr_b16 v[40:41], v21 offset:24576
    ds_read_b64_tr_b16 v[42:43], v21 offset:26624
    s_waitcnt lgkmcnt(10)
    v_mfma_f32_32x32x16_bf16 v[120:135], v[48:51], v[196:199], v[120:135]
    buffer_load_dwordx4 v[152:155], v249, s[32:35], s16 offen sc1
    ds_read_b64_tr_b16 v[44:45], v24 offset:24576
    ds_read_b64_tr_b16 v[46:47], v24 offset:26624
    s_waitcnt lgkmcnt(10)
    v_mfma_f32_32x32x16_bf16 v[136:151], v[52:55], v[196:199], v[136:151]
    ds_read_b64_tr_b16 v[48:49], v25 offset:24576
    ds_read_b64_tr_b16 v[50:51], v25 offset:26624
    s_waitcnt lgkmcnt(10)
    v_mfma_f32_32x32x16_bf16 v[88:103], v[28:31], v[196:199], v[88:103]
    ds_read_b64_tr_b16 v[52:53], v22 offset:24576
    ds_read_b64_tr_b16 v[54:55], v22 offset:26624
    s_waitcnt lgkmcnt(10)
    v_mfma_f32_32x32x16_bf16 v[104:119], v[32:35], v[196:199], v[104:119]
    buffer_load_dwordx4 v[156:159], v249, s[32:35], s16 offen offset:1024 sc1
    ds_read_b64_tr_b16 v[28:29], v23 offset:24576
    ds_read_b64_tr_b16 v[30:31], v23 offset:26624
    s_barrier
    s_waitcnt vmcnt(13)
    s_waitcnt lgkmcnt(10)
    v_mfma_f32_32x32x16_bf16 v[56:71], v[36:39], v[200:203], v[56:71]
    ds_read_b64_tr_b16 v[32:33], v20 offset:25600
    ds_read_b64_tr_b16 v[34:35], v20 offset:27648
    s_waitcnt lgkmcnt(10)
    v_mfma_f32_32x32x16_bf16 v[72:87], v[40:43], v[200:203], v[72:87]
    ds_read_b64_tr_b16 v[36:37], v21 offset:25600
    ds_read_b64_tr_b16 v[38:39], v21 offset:27648
    s_waitcnt lgkmcnt(10)
    v_mfma_f32_32x32x16_bf16 v[120:135], v[44:47], v[200:203], v[120:135]
    ds_read_b64_tr_b16 v[40:41], v24 offset:25600
    ds_read_b64_tr_b16 v[42:43], v24 offset:27648
    s_waitcnt lgkmcnt(10)
    v_mfma_f32_32x32x16_bf16 v[136:151], v[48:51], v[200:203], v[136:151]
    ds_read_b64_tr_b16 v[44:45], v25 offset:25600
    ds_read_b64_tr_b16 v[46:47], v25 offset:27648
    s_waitcnt lgkmcnt(10)
    v_mfma_f32_32x32x16_bf16 v[88:103], v[52:55], v[200:203], v[88:103]
    ds_read_b64_tr_b16 v[48:49], v22 offset:25600
    ds_read_b64_tr_b16 v[50:51], v22 offset:27648
    s_waitcnt lgkmcnt(10)
    v_mfma_f32_32x32x16_bf16 v[104:119], v[28:31], v[200:203], v[104:119]
    ds_read_b64_tr_b16 v[52:53], v23 offset:25600
    ds_read_b64_tr_b16 v[54:55], v23 offset:27648
    s_waitcnt vmcnt(12)
    s_waitcnt lgkmcnt(10)
    v_mfma_f32_32x32x16_bf16 v[56:71], v[32:35], v[204:207], v[56:71]
    ds_read_b64_tr_b16 v[28:29], v20 offset:28672
    ds_read_b64_tr_b16 v[30:31], v20 offset:30720
    s_waitcnt lgkmcnt(10)
    v_mfma_f32_32x32x16_bf16 v[72:87], v[36:39], v[204:207], v[72:87]
    ds_read_b64_tr_b16 v[32:33], v21 offset:28672
    ds_read_b64_tr_b16 v[34:35], v21 offset:30720
L_PAD2:
    s_cbranch_execz L_RET2
    s_waitcnt lgkmcnt(10)
    v_mfma_f32_32x32x16_bf16 v[120:135], v[40:43], v[204:207], v[120:135]
    buffer_load_dwordx4 v[160:163], v249, s[32:35], s16 offen offset:2048 sc1
    ds_read_b64_tr_b16 v[36:37], v24 offset:28672
    ds_read_b64_tr_b16 v[38:39], v24 offset:30720
    s_waitcnt lgkmcnt(10)
    v_mfma_f32_32x32x16_bf16 v[136:151], v[44:47], v[204:207], v[136:151]
    ds_read_b64_tr_b16 v[40:41], v25 offset:28672
    ds_read_b64_tr_b16 v[42:43], v25 offset:30720
    s_waitcnt lgkmcnt(10)
    v_mfma_f32_32x32x16_bf16 v[88:103], v[48:51], v[204:207], v[88:103]
    ds_read_b64_tr_b16 v[44:45], v22 offset:28672
    ds_read_b64_tr_b16 v[46:47], v22 offset:30720
    s_waitcnt lgkmcnt(10)
    v_mfma_f32_32x32x16_bf16 v[104:119], v[52:55], v[204:207], v[104:119]
    buffer_load_dwordx4 v[164:167], v249, s[32:35], s16 offen offset:3072 sc1
    ds_read_b64_tr_b16 v[48:49], v23 offset:28672
    ds_read_b64_tr_b16 v[50:51], v23 offset:30720
    s_waitcnt vmcnt(13)
    s_waitcnt lgkmcnt(10)
    v_mfma_f32_32x32x16_bf16 v[56:71], v[28:31], v[208:211], v[56:71]
    s_add_u32 s16, s16, 16384
    ds_read_b64_tr_b16 v[52:53], v20 offset:29696
    ds_read_b64_tr_b16 v[54:55], v20 offset:31744
    s_waitcnt lgkmcnt(10)
    v_mfma_f32_32x32x16_bf16 v[72:87], v[32:35], v[208:211], v[72:87]
    s_and_b32 s16, s16, 0x3ffff
    ds_read_b64_tr_b16 v[28:29], v21 offset:29696
    ds_read_b64_tr_b16 v[30:31], v21 offset:31744
    s_waitcnt lgkmcnt(10)
    v_mfma_f32_32x32x16_bf16 v[120:135], v[36:39], v[208:211], v[120:135]
    buffer_load_dwordx4 v[168:171], v249, s[32:35], s16 offen sc1
    ds_read_b64_tr_b16 v[32:33], v24 offset:29696
    ds_read_b64_tr_b16 v[34:35], v24 offset:31744
    s_waitcnt lgkmcnt(10)
    v_mfma_f32_32x32x16_bf16 v[136:151], v[40:43], v[208:211], v[136:151]
    ds_read_b64_tr_b16 v[36:37], v25 offset:29696
    ds_read_b64_tr_b16 v[38:39], v25 offset:31744
    s_waitcnt lgkmcnt(10)
    v_mfma_f32_32x32x16_bf16 v[88:103], v[44:47], v[208:211], v[88:103]
    ds_read_b64_tr_b16 v[40:41], v22 offset:29696
    ds_read_b64_tr_b16 v[42:43], v22 offset:31744
    s_waitcnt lgkmcnt(10)
    v_mfma_f32_32x32x16_bf16 v[104:119], v[48:51], v[208:211], v[104:119]
    buffer_load_dwordx4 v[172:175], v249, s[32:35], s16 offen offset:1024 sc1
    ds_read_b64_tr_b16 v[44:45], v23 offset:29696
    ds_read_b64_tr_b16 v[46:47], v23 offset:31744
    s_waitcnt vmcnt(14)
    s_waitcnt lgkmcnt(10)
    v_mfma_f32_32x32x16_bf16 v[56:71], v[52:55], v[212:215], v[56:71]
    ds_read_b64_tr_b16 v[48:49], v20 offset:32768
    ds_read_b64_tr_b16 v[50:51], v20 offset:34816
    s_waitcnt lgkmcnt(10)
    v_mfma_f32_32x32x16_bf16 v[72:87], v[28:31], v[212:215], v[72:87]
    ds_read_b64_tr_b16 v[52:53], v21 offset:32768
    ds_read_b64_tr_b16 v[54:55], v21 offset:34816
    s_waitcnt lgkmcnt(10)
    v_mfma_f32_32x32x16_bf16 v[120:135], v[32:35], v[212:215], v[120:135]
    buffer_load_dwordx4 v[176:179], v249, s[32:35], s16 offen offset:2048 sc1
    ds_read_b64_tr_b16 v[28:29], v24 offset:32768
    ds_read_b64_tr_b16 v[30:31], v24 offset:34816
    s_waitcnt lgkmcnt(10)
    v_mfma_f32_32x32x16_bf16 v[136:151], v[36:39], v[212:215], v[136:151]
    ds_read_b64_tr_b16 v[32:33], v25 offset:32768
    ds_read_b64_tr_b16 v[34:35], v25 offset:34816
    s_waitcnt lgkmcnt(10)
    v_mfma_f32_32x32x16_bf16 v[88:103], v[40:43], v[212:215], v[88:103]
    ds_read_b64_tr_b16 v[36:37], v22 offset:32768
    ds_read_b64_tr_b16 v[38:39], v22 offset:34816
    s_waitcnt lgkmcnt(10)
    v_mfma_f32_32x32x16_bf16 v[104:119], v[44:47], v[212:215], v[104:119]
    buffer_load_dwordx4 v[180:183], v249, s[32:35], s16 offen offset:3072 sc1
    ds_read_b64_tr_b16 v[40:41], v23 offset:32768
    ds_read_b64_tr_b16 v[42:43], v23 offset:34816
    s_barrier
    s_waitcnt vmcnt(15)
    s_waitcnt lgkmcnt(10)
    v_mfma_f32_32x32x16_bf16 v[56:71], v[48:51], v[216:219], v[56:71]
    s_add_u32 s16, s16, 16384
    ds_read_b64_tr_b16 v[44:45], v20 offset:33792
    ds_read_b64_tr_b16 v[46:47], v20 offset:35840
    s_waitcnt lgkmcnt(10)
    v_mfma_f32_32x32x16_bf16 v[72:87], v[52:55], v[216:219], v[72:87]
    s_and_b32 s16, s16, 0x3ffff
    ds_read_b64_tr_b16 v[48:49], v21 offset:33792
    ds_read_b64_tr_b16 v[50:51], v21 offset:35840
    s_waitcnt lgkmcnt(10)
    v_mfma_f32_32x32x16_bf16 v[120:135], v[28:31], v[216:219], v[120:135]
    ds_read_b64_tr_b16 v[52:53], v24 offset:33792
    ds_read_b64_tr_b16 v[54:55], v24 offset:35840
    s_waitcnt lgkmcnt(10)
    v_mfma_f32_32x32x16_bf16 v[136:151], v[32:35], v[216:219], v[136:151]
    ds_read_b64_tr_b16 v[28:29], v25 offset:33792
    ds_read_b64_tr_b16 v[30:31], v25 offset:35840
    s_waitcnt lgkmcnt(10)
    v_mfma_f32_32x32x16_bf16 v[88:103], v[36:39], v[216:219], v[88:103]
    ds_read_b64_tr_b16 v[32:33], v22 offset:33792
    ds_read_b64_tr_b16 v[34:35], v22 offset:35840
    s_waitcnt lgkmcnt(10)
    v_mfma_f32_32x32x16_bf16 v[104:119], v[40:43], v[216:219], v[104:119]
    ds_read_b64_tr_b16 v[36:37], v23 offset:33792
    ds_read_b64_tr_b16 v[38:39], v23 offset:35840
    s_waitcnt vmcnt(14)
    s_waitcnt lgkmcnt(10)
    v_mfma_f32_32x32x16_bf16 v[56:71], v[44:47], v[220:223], v[56:71]
    ds_read_b64_tr_b16 v[40:41], v20 offset:36864
    ds_read_b64_tr_b16 v[42:43], v20 offset:38912
    s_waitcnt lgkmcnt(10)
    v_mfma_f32_32x32x16_bf16 v[72:87], v[48:51], v[220:223], v[72:87]
    ds_read_b64_tr_b16 v[44:45], v21 offset:36864
    ds_read_b64_tr_b16 v[46:47], v21 offset:38912
    s_waitcnt lgkmcnt(10)
    v_mfma_f32_32x32x16_bf16 v[120:135], v[52:55], v[220:223], v[120:135]
    buffer_load_dwordx4 v[184:187], v249, s[32:35], s16 offen sc1
    ds_read_b64_tr_b16 v[48:49], v24 offset:36864
    ds_read_b64_tr_b16 v[50:51], v24 offset:38912
    s_waitcnt lgkmcnt(10)
    v_mfma_f32_32x32x16_bf16 v[136:151], v[28:31], v[220:223], v[136:151]
    ds_read_b64_tr_b16 v[52:53], v25 offset:36864
    ds_read_b64_tr_b16 v[54:55], v25 offset:38912
    s_waitcnt lgkmcnt(10)
    v_mfma_f32_32x32x16_bf16 v[88:103], v[32:35], v[220:223], v[88:103]
    ds_read_b64_tr_b16 v[28:29], v22 offset:36864
    ds_read_b64_tr_b16 v[30:31], v22 offset:38912
    s_waitcnt lgkmcnt(10)
    v_mfma_f32_32x32x16_bf16 v[104:119], v[36:39], v[220:223], v[104:119]
    buffer_load_dwordx4 v[188:191], v249, s[32:35], s16 offen offset:1024 sc1
    ds_read_b64_tr_b16 v[32:33], v23 offset:36864
    ds_read_b64_tr_b16 v[34:35], v23 offset:38912
    s_waitcnt vmcnt(15)
    s_waitcnt lgkmcnt(10)
    v_mfma_f32_32x32x16_bf16 v[56:71], v[40:43], v[224:227], v[56:71]
    ds_read_b64_tr_b16 v[36:37], v20 offset:37888
    ds_read_b64_tr_b16 v[38:39], v20 offset:39936
    s_waitcnt lgkmcnt(10)
    v_mfma_f32_32x32x16_bf16 v[72:87], v[44:47], v[224:227], v[72:87]
    ds_read_b64_tr_b16 v[40:41], v21 offset:37888
    ds_read_b64_tr_b16 v[42:43], v21 offset:39936
    s_waitcnt lgkmcnt(10)
    v_mfma_f32_32x32x16_bf16 v[120:135], v[48:51], v[224:227], v[120:135]
    buffer_load_dwordx4 v[192:195], v249, s[32:35], s16 offen offset:2048 sc1
    ds_read_b64_tr_b16 v[44:45], v24 offset:37888
    ds_read_b64_tr_b16 v[46:47], v24 offset:39936
    s_waitcnt lgkmcnt(10)
    v_mfma_f32_32x32x16_bf16 v[136:151], v[52:55], v[224:227], v[136:151]
    ds_read_b64_tr_b16 v[48:49], v25 offset:37888
    ds_read_b64_tr_b16 v[50:51], v25 offset:39936
    s_waitcnt lgkmcnt(10)
    v_mfma_f32_32x32x16_bf16 v[88:103], v[28:31], v[224:227], v[88:103]
    ds_read_b64_tr_b16 v[52:53], v22 offset:37888
    ds_read_b64_tr_b16 v[54:55], v22 offset:39936
    s_waitcnt lgkmcnt(10)
    v_mfma_f32_32x32x16_bf16 v[104:119], v[32:35], v[224:227], v[104:119]
    buffer_load_dwordx4 v[196:199], v249, s[32:35], s16 offen offset:3072 sc1
    ds_read_b64_tr_b16 v[28:29], v23 offset:37888
    ds_read_b64_tr_b16 v[30:31], v23 offset:39936
    s_waitcnt vmcnt(16)
    s_waitcnt lgkmcnt(10)
    v_mfma_f32_32x32x16_bf16 v[56:71], v[36:39], v[228:231], v[56:71]
    s_add_u32 s16, s16, 16384
    ds_read_b64_tr_b16 v[32:33], v20 offset:40960
    ds_read_b64_tr_b16 v[34:35], v20 offset:43008
    s_waitcnt lgkmcnt(10)
    v_mfma_f32_32x32x16_bf16 v[72:87], v[40:43], v[228:231], v[72:87]
    s_and_b32 s16, s16, 0x3ffff
    ds_read_b64_tr_b16 v[36:37], v21 offset:40960
    ds_read_b64_tr_b16 v[38:39], v21 offset:43008
    s_waitcnt lgkmcnt(10)
    v_mfma_f32_32x32x16_bf16 v[120:135], v[44:47], v[228:231], v[120:135]
    buffer_load_dwordx4 v[200:203], v249, s[32:35], s16 offen sc1
    ds_read_b64_tr_b16 v[40:41], v24 offset:40960
    ds_read_b64_tr_b16 v[42:43], v24 offset:43008
    s_waitcnt lgkmcnt(10)
    v_mfma_f32_32x32x16_bf16 v[136:151], v[48:51], v[228:231], v[136:151]
    ds_read_b64_tr_b16 v[44:45], v25 offset:40960
    ds_read_b64_tr_b16 v[46:47], v25 offset:43008
    s_waitcnt lgkmcnt(10)
    v_mfma_f32_32x32x16_bf16 v[88:103], v[52:55], v[228:231], v[88:103]
    ds_read_b64_tr_b16 v[48:49], v22 offset:40960
    ds_read_b64_tr_b16 v[50:51], v22 offset:43008
    s_waitcnt lgkmcnt(10)
    v_mfma_f32_32x32x16_bf16 v[104:119], v[28:31], v[228:231], v[104:119]
    buffer_load_dwordx4 v[204:207], v249, s[32:35], s16 offen offset:1024 sc1
    ds_read_b64_tr_b16 v[52:53], v23 offset:40960
    ds_read_b64_tr_b16 v[54:55], v23 offset:43008
    s_barrier
    s_waitcnt vmcnt(17)
    s_waitcnt lgkmcnt(10)
    v_mfma_f32_32x32x16_bf16 v[56:71], v[32:35], v[232:235], v[56:71]
    ds_read_b64_tr_b16 v[28:29], v20 offset:41984
    ds_read_b64_tr_b16 v[30:31], v20 offset:44032
    s_waitcnt lgkmcnt(10)
    v_mfma_f32_32x32x16_bf16 v[72:87], v[36:39], v[232:235], v[72:87]
    ds_read_b64_tr_b16 v[32:33], v21 offset:41984
    ds_read_b64_tr_b16 v[34:35], v21 offset:44032
    s_waitcnt lgkmcnt(10)
    v_mfma_f32_32x32x16_bf16 v[120:135], v[40:43], v[232:235], v[120:135]
    ds_read_b64_tr_b16 v[36:37], v24 offset:41984
    ds_read_b64_tr_b16 v[38:39], v24 offset:44032
    s_waitcnt lgkmcnt(10)
    v_mfma_f32_32x32x16_bf16 v[136:151], v[44:47], v[232:235], v[136:151]
    ds_read_b64_tr_b16 v[40:41], v25 offset:41984
    ds_read_b64_tr_b16 v[42:43], v25 offset:44032
    s_waitcnt lgkmcnt(10)
    v_mfma_f32_32x32x16_bf16 v[88:103], v[48:51], v[232:235], v[88:103]
    ds_read_b64_tr_b16 v[44:45], v22 offset:41984
    ds_read_b64_tr_b16 v[46:47], v22 offset:44032
    s_waitcnt lgkmcnt(10)
    v_mfma_f32_32x32x16_bf16 v[104:119], v[52:55], v[232:235], v[104:119]
    ds_read_b64_tr_b16 v[48:49], v23 offset:41984
    ds_read_b64_tr_b16 v[50:51], v23 offset:44032
    s_waitcnt vmcnt(16)
    s_waitcnt lgkmcnt(10)
    v_mfma_f32_32x32x16_bf16 v[56:71], v[28:31], v[236:239], v[56:71]
    ds_read_b64_tr_b16 v[52:53], v20 offset:45056
    ds_read_b64_tr_b16 v[54:55], v20 offset:47104
    s_waitcnt lgkmcnt(10)
    v_mfma_f32_32x32x16_bf16 v[72:87], v[32:35], v[236:239], v[72:87]
    ds_read_b64_tr_b16 v[28:29], v21 offset:45056
    ds_read_b64_tr_b16 v[30:31], v21 offset:47104
    s_waitcnt lgkmcnt(10)
    v_mfma_f32_32x32x16_bf16 v[120:135], v[36:39], v[236:239], v[120:135]
    buffer_load_dwordx4 v[208:211], v249, s[32:35], s16 offen offset:2048 sc1
    ds_read_b64_tr_b16 v[32:33], v24 offset:45056
    ds_read_b64_tr_b16 v[34:35], v24 offset:47104
    s_waitcnt lgkmcnt(10)
    v_mfma_f32_32x32x16_bf16 v[136:151], v[40:43], v[236:239], v[136:151]
    ds_read_b64_tr_b16 v[36:37], v25 offset:45056
    ds_read_b64_tr_b16 v[38:39], v25 offset:47104
    s_waitcnt lgkmcnt(10)
    v_mfma_f32_32x32x16_bf16 v[88:103], v[44:47], v[236:239], v[88:103]
    ds_read_b64_tr_b16 v[40:41], v22 offset:45056
    ds_read_b64_tr_b16 v[42:43], v22 offset:47104
    s_waitcnt lgkmcnt(10)
    v_mfma_f32_32x32x16_bf16 v[104:119], v[48:51], v[236:239], v[104:119]
    buffer_load_dwordx4 v[212:215], v249, s[32:35], s16 offen offset:3072 sc1
    ds_read_b64_tr_b16 v[44:45], v23 offset:45056
    ds_read_b64_tr_b16 v[46:47], v23 offset:47104
    s_waitcnt vmcnt(17)
    s_waitcnt lgkmcnt(10)
    v_mfma_f32_32x32x16_bf16 v[56:71], v[52:55], v[240:243], v[56:71]
    s_add_u32 s16, s16, 16384
    ds_read_b64_tr_b16 v[48:49], v20 offset:46080
    ds_read_b64_tr_b16 v[50:51], v20 offset:48128
    s_waitcnt lgkmcnt(10)
    v_mfma_f32_32x32x16_bf16 v[72:87], v[28:31], v[240:243], v[72:87]
    s_and_b32 s16, s16, 0x3ffff
    ds_read_b64_tr_b16 v[52:53], v21 offset:46080
    ds_read_b64_tr_b16 v[54:55], v21 offset:48128
    s_waitcnt lgkmcnt(10)
    v_mfma_f32_32x32x16_bf16 v[120:135], v[32:35], v[240:243], v[120:135]
    buffer_load_dwordx4 v[216:219], v249, s[32:35], s16 offen sc1
    ds_read_b64_tr_b16 v[28:29], v24 offset:46080
    ds_read_b64_tr_b16 v[30:31], v24 offset:48128
    s_waitcnt lgkmcnt(10)
    v_mfma_f32_32x32x16_bf16 v[136:151], v[36:39], v[240:243], v[136:151]
    ds_read_b64_tr_b16 v[32:33], v25 offset:46080
    ds_read_b64_tr_b16 v[34:35], v25 offset:48128
    s_waitcnt lgkmcnt(10)
    v_mfma_f32_32x32x16_bf16 v[88:103], v[40:43], v[240:243], v[88:103]
    ds_read_b64_tr_b16 v[36:37], v22 offset:46080
    ds_read_b64_tr_b16 v[38:39], v22 offset:48128
    s_waitcnt lgkmcnt(10)
    v_mfma_f32_32x32x16_bf16 v[104:119], v[44:47], v[240:243], v[104:119]
    buffer_load_dwordx4 v[220:223], v249, s[32:35], s16 offen offset:1024 sc1
    ds_read_b64_tr_b16 v[40:41], v23 offset:46080
    ds_read_b64_tr_b16 v[42:43], v23 offset:48128
    s_waitcnt vmcnt(18)
    s_waitcnt lgkmcnt(10)
    v_mfma_f32_32x32x16_bf16 v[56:71], v[48:51], v[244:247], v[56:71]
    ds_read_b64_tr_b16 v[44:45], v20
    ds_read_b64_tr_b16 v[46:47], v20 offset:2048
    s_waitcnt lgkmcnt(10)
    v_mfma_f32_32x32x16_bf16 v[72:87], v[52:55], v[244:247], v[72:87]
    ds_read_b64_tr_b16 v[48:49], v21
    ds_read_b64_tr_b16 v[50:51], v21 offset:2048
    s_waitcnt lgkmcnt(10)
    v_mfma_f32_32x32x16_bf16 v[120:135], v[28:31], v[244:247], v[120:135]
    buffer_load_dwordx4 v[224:227], v249, s[32:35], s16 offen offset:2048 sc1
    ds_read_b64_tr_b16 v[52:53], v24
    ds_read_b64_tr_b16 v[54:55], v24 offset:2048
    s_waitcnt lgkmcnt(10)
    v_mfma_f32_32x32x16_bf16 v[136:151], v[32:35], v[244:247], v[136:151]
    ds_read_b64_tr_b16 v[28:29], v25
    ds_read_b64_tr_b16 v[30:31], v25 offset:2048
    s_waitcnt lgkmcnt(10)
    v_mfma_f32_32x32x16_bf16 v[88:103], v[36:39], v[244:247], v[88:103]
    ds_read_b64_tr_b16 v[32:33], v22
    ds_read_b64_tr_b16 v[34:35], v22 offset:2048
    s_waitcnt lgkmcnt(10)
    v_mfma_f32_32x32x16_bf16 v[104:119], v[40:43], v[244:247], v[104:119]
    buffer_load_dwordx4 v[228:231], v249, s[32:35], s16 offen offset:3072 sc1
    ds_read_b64_tr_b16 v[36:37], v23
    ds_read_b64_tr_b16 v[38:39], v23 offset:2048
    s_barrier
    s_waitcnt vmcnt(19)
    s_waitcnt lgkmcnt(10)
    v_mfma_f32_32x32x16_bf16 v[56:71], v[44:47], v[152:155], v[56:71]
    s_add_u32 s16, s16, 16384
    ds_read_b64_tr_b16 v[40:41], v20 offset:1024
    ds_read_b64_tr_b16 v[42:43], v20 offset:3072
    s_waitcnt lgkmcnt(10)
    v_mfma_f32_32x32x16_bf16 v[72:87], v[48:51], v[152:155], v[72:87]
    s_and_b32 s16, s16, 0x3ffff
    ds_read_b64_tr_b16 v[44:45], v21 offset:1024
    ds_read_b64_tr_b16 v[46:47], v21 offset:3072
    s_waitcnt lgkmcnt(10)
    v_mfma_f32_32x32x16_bf16 v[120:135], v[52:55], v[152:155], v[120:135]
    ds_read_b64_tr_b16 v[48:49], v24 offset:1024
    ds_read_b64_tr_b16 v[50:51], v24 offset:3072
    s_waitcnt lgkmcnt(10)
    v_mfma_f32_32x32x16_bf16 v[136:151], v[28:31], v[152:155], v[136:151]
    ds_read_b64_tr_b16 v[52:53], v25 offset:1024
    ds_read_b64_tr_b16 v[54:55], v25 offset:3072
    s_waitcnt lgkmcnt(10)
    v_mfma_f32_32x32x16_bf16 v[88:103], v[32:35], v[152:155], v[88:103]
    ds_read_b64_tr_b16 v[28:29], v22 offset:1024
    ds_read_b64_tr_b16 v[30:31], v22 offset:3072
    s_waitcnt lgkmcnt(10)
    v_mfma_f32_32x32x16_bf16 v[104:119], v[36:39], v[152:155], v[104:119]
    ds_read_b64_tr_b16 v[32:33], v23 offset:1024
    ds_read_b64_tr_b16 v[34:35], v23 offset:3072
    s_waitcnt vmcnt(18)
    s_waitcnt lgkmcnt(10)
    v_mfma_f32_32x32x16_bf16 v[56:71], v[40:43], v[156:159], v[56:71]
    ds_read_b64_tr_b16 v[36:37], v20 offset:4096
    ds_read_b64_tr_b16 v[38:39], v20 offset:6144
    s_waitcnt lgkmcnt(10)
    v_mfma_f32_32x32x16_bf16 v[72:87], v[44:47], v[156:159], v[72:87]
    ds_read_b64_tr_b16 v[40:41], v21 offset:4096
    ds_read_b64_tr_b16 v[42:43], v21 offset:6144
    s_waitcnt lgkmcnt(10)
    v_mfma_f32_32x32x16_bf16 v[120:135], v[48:51], v[156:159], v[120:135]
    ds_read_b64_tr_b16 v[44:45], v24 offset:4096
    ds_read_b64_tr_b16 v[46:47], v24 offset:6144
    s_waitcnt lgkmcnt(10)
    v_mfma_f32_32x32x16_bf16 v[136:151], v[52:55], v[156:159], v[136:151]
    buffer_load_dwordx4 v[232:235], v249, s[32:35], s16 offen sc1
    ds_read_b64_tr_b16 v[48:49], v25 offset:4096
    ds_read_b64_tr_b16 v[50:51], v25 offset:6144
    s_waitcnt lgkmcnt(10)
    v_mfma_f32_32x32x16_bf16 v[88:103], v[28:31], v[156:159], v[88:103]
    ds_read_b64_tr_b16 v[52:53], v22 offset:4096
    ds_read_b64_tr_b16 v[54:55], v22 offset:6144
    s_waitcnt lgkmcnt(10)
    v_mfma_f32_32x32x16_bf16 v[104:119], v[32:35], v[156:159], v[104:119]
    ds_read_b64_tr_b16 v[28:29], v23 offset:4096
    ds_read_b64_tr_b16 v[30:31], v23 offset:6144
    s_waitcnt vmcnt(18)
    s_waitcnt lgkmcnt(10)
    v_mfma_f32_32x32x16_bf16 v[56:71], v[36:39], v[160:163], v[56:71]
    ds_read_b64_tr_b16 v[32:33], v20 offset:5120
    ds_read_b64_tr_b16 v[34:35], v20 offset:7168
    s_waitcnt lgkmcnt(10)
    v_mfma_f32_32x32x16_bf16 v[72:87], v[40:43], v[160:163], v[72:87]
    buffer_load_dwordx4 v[236:239], v249, s[32:35], s16 offen offset:1024 sc1
    ds_read_b64_tr_b16 v[36:37], v21 offset:5120
    ds_read_b64_tr_b16 v[38:39], v21 offset:7168
    s_waitcnt lgkmcnt(10)
    v_mfma_f32_32x32x16_bf16 v[120:135], v[44:47], v[160:163], v[120:135]
    ds_read_b64_tr_b16 v[40:41], v24 offset:5120
    ds_read_b64_tr_b16 v[42:43], v24 offset:7168
    s_waitcnt lgkmcnt(10)
    v_mfma_f32_32x32x16_bf16 v[136:151], v[48:51], v[160:163], v[136:151]
    ds_read_b64_tr_b16 v[44:45], v25 offset:5120
    ds_read_b64_tr_b16 v[46:47], v25 offset:7168
    s_waitcnt lgkmcnt(10)
    v_mfma_f32_32x32x16_bf16 v[88:103], v[52:55], v[160:163], v[88:103]
    buffer_load_dwordx4 v[240:243], v249, s[32:35], s16 offen offset:2048 sc1
    ds_read_b64_tr_b16 v[48:49], v22 offset:5120
    ds_read_b64_tr_b16 v[50:51], v22 offset:7168
    s_waitcnt lgkmcnt(10)
    v_mfma_f32_32x32x16_bf16 v[104:119], v[28:31], v[160:163], v[104:119]
    ds_read_b64_tr_b16 v[52:53], v23 offset:5120
    ds_read_b64_tr_b16 v[54:55], v23 offset:7168
    s_waitcnt vmcnt(19)
    s_waitcnt lgkmcnt(10)
    v_mfma_f32_32x32x16_bf16 v[56:71], v[32:35], v[164:167], v[56:71]
    ds_read_b64_tr_b16 v[28:29], v20 offset:8192
    ds_read_b64_tr_b16 v[30:31], v20 offset:10240
    s_waitcnt lgkmcnt(10)
    v_mfma_f32_32x32x16_bf16 v[72:87], v[36:39], v[164:167], v[72:87]
    ds_read_b64_tr_b16 v[32:33], v21 offset:8192
    ds_read_b64_tr_b16 v[34:35], v21 offset:10240
    s_waitcnt lgkmcnt(10)
    v_mfma_f32_32x32x16_bf16 v[120:135], v[40:43], v[164:167], v[120:135]
    buffer_load_dwordx4 v[244:247], v249, s[32:35], s16 offen offset:3072 sc1
    ds_read_b64_tr_b16 v[36:37], v24 offset:8192
    ds_read_b64_tr_b16 v[38:39], v24 offset:10240
    s_waitcnt lgkmcnt(10)
    v_mfma_f32_32x32x16_bf16 v[136:151], v[44:47], v[164:167], v[136:151]
    s_add_u32 s16, s16, 16384
    ds_read_b64_tr_b16 v[40:41], v25 offset:8192
    ds_read_b64_tr_b16 v[42:43], v25 offset:10240
    s_waitcnt lgkmcnt(10)
    v_mfma_f32_32x32x16_bf16 v[88:103], v[48:51], v[164:167], v[88:103]
    s_and_b32 s16, s16, 0x3ffff
    ds_read_b64_tr_b16 v[44:45], v22 offset:8192
    ds_read_b64_tr_b16 v[46:47], v22 offset:10240
    s_waitcnt lgkmcnt(10)
    v_mfma_f32_32x32x16_bf16 v[104:119], v[52:55], v[164:167], v[104:119]
    buffer_load_dwordx4 v[152:155], v249, s[32:35], s16 offen sc1
    ds_read_b64_tr_b16 v[48:49], v23 offset:8192
    ds_read_b64_tr_b16 v[50:51], v23 offset:10240
    s_barrier
    s_waitcnt vmcnt(20)
    s_waitcnt lgkmcnt(10)
    v_mfma_f32_32x32x16_bf16 v[56:71], v[28:31], v[168:171], v[56:71]
    ds_read_b64_tr_b16 v[52:53], v20 offset:9216
    ds_read_b64_tr_b16 v[54:55], v20 offset:11264
    s_waitcnt lgkmcnt(10)
    v_mfma_f32_32x32x16_bf16 v[72:87], v[32:35], v[168:171], v[72:87]
    ds_read_b64_tr_b16 v[28:29], v21 offset:9216
    ds_read_b64_tr_b16 v[30:31], v21 offset:11264
    s_waitcnt lgkmcnt(10)
    v_mfma_f32_32x32x16_bf16 v[120:135], v[36:39], v[168:171], v[120:135]
    ds_read_b64_tr_b16 v[32:33], v24 offset:9216
    ds_read_b64_tr_b16 v[34:35], v24 offset:11264
    s_waitcnt lgkmcnt(10)
    v_mfma_f32_32x32x16_bf16 v[136:151], v[40:43], v[168:171], v[136:151]
    ds_read_b64_tr_b16 v[36:37], v25 offset:9216
    ds_read_b64_tr_b16 v[38:39], v25 offset:11264
    s_waitcnt lgkmcnt(10)
    v_mfma_f32_32x32x16_bf16 v[88:103], v[44:47], v[168:171], v[88:103]
    ds_read_b64_tr_b16 v[40:41], v22 offset:9216
    ds_read_b64_tr_b16 v[42:43], v22 offset:11264
    s_waitcnt lgkmcnt(10)
    v_mfma_f32_32x32x16_bf16 v[104:119], v[48:51], v[168:171], v[104:119]
    ds_read_b64_tr_b16 v[44:45], v23 offset:9216
    ds_read_b64_tr_b16 v[46:47], v23 offset:11264
    s_waitcnt vmcnt(19)
    s_waitcnt lgkmcnt(10)
    v_mfma_f32_32x32x16_bf16 v[56:71], v[52:55], v[172:175], v[56:71]
    ds_read_b64_tr_b16 v[48:49], v20 offset:12288
    ds_read_b64_tr_b16 v[50:51], v20 offset:14336
    s_waitcnt lgkmcnt(10)
    v_mfma_f32_32x32x16_bf16 v[72:87], v[28:31], v[172:175], v[72:87]
    ds_read_b64_tr_b16 v[52:53], v21 offset:12288
    ds_read_b64_tr_b16 v[54:55], v21 offset:14336
    s_waitcnt lgkmcnt(10)
    v_mfma_f32_32x32x16_bf16 v[120:135], v[32:35], v[172:175], v[120:135]
    ds_read_b64_tr_b16 v[28:29], v24 offset:12288
    ds_read_b64_tr_b16 v[30:31], v24 offset:14336
    s_waitcnt lgkmcnt(10)
    v_mfma_f32_32x32x16_bf16 v[136:151], v[36:39], v[172:175], v[136:151]
    buffer_load_dwordx4 v[156:159], v249, s[32:35], s16 offen offset:1024 sc1
    ds_read_b64_tr_b16 v[32:33], v25 offset:12288
    ds_read_b64_tr_b16 v[34:35], v25 offset:14336
    s_waitcnt lgkmcnt(10)
    v_mfma_f32_32x32x16_bf16 v[88:103], v[40:43], v[172:175], v[88:103]
    ds_read_b64_tr_b16 v[36:37], v22 offset:12288
    ds_read_b64_tr_b16 v[38:39], v22 offset:14336
    s_waitcnt lgkmcnt(10)
    v_mfma_f32_32x32x16_bf16 v[104:119], v[44:47], v[172:175], v[104:119]
    ds_read_b64_tr_b16 v[40:41], v23 offset:12288
    ds_read_b64_tr_b16 v[42:43], v23 offset:14336
    s_waitcnt vmcnt(19)
    s_waitcnt lgkmcnt(10)
    v_mfma_f32_32x32x16_bf16 v[56:71], v[48:51], v[176:179], v[56:71]
    ds_read_b64_tr_b16 v[44:45], v20 offset:13312
    ds_read_b64_tr_b16 v[46:47], v20 offset:15360
    s_waitcnt lgkmcnt(10)
    v_mfma_f32_32x32x16_bf16 v[72:87], v[52:55], v[176:179], v[72:87]
    buffer_load_dwordx4 v[160:163], v249, s[32:35], s16 offen offset:2048 sc1
    ds_read_b64_tr_b16 v[48:49], v21 offset:13312
    ds_read_b64_tr_b16 v[50:51], v21 offset:15360
    s_waitcnt lgkmcnt(10)
    v_mfma_f32_32x32x16_bf16 v[120:135], v[28:31], v[176:179], v[120:135]
    ds_read_b64_tr_b16 v[52:53], v24 offset:13312
    ds_read_b64_tr_b16 v[54:55], v24 offset:15360
    s_waitcnt lgkmcnt(10)
    v_mfma_f32_32x32x16_bf16 v[136:151], v[32:35], v[176:179], v[136:151]
    ds_read_b64_tr_b16 v[28:29], v25 offset:13312
    ds_read_b64_tr_b16 v[30:31], v25 offset:15360
    s_waitcnt lgkmcnt(10)
    v_mfma_f32_32x32x16_bf16 v[88:103], v[36:39], v[176:179], v[88:103]
    buffer_load_dwordx4 v[164:167], v249, s[32:35], s16 offen offset:3072 sc1
    ds_read_b64_tr_b16 v[32:33], v22 offset:13312
    ds_read_b64_tr_b16 v[34:35], v22 offset:15360
    s_waitcnt lgkmcnt(10)
    v_mfma_f32_32x32x16_bf16 v[104:119], v[40:43], v[176:179], v[104:119]
    s_add_u32 s16, s16, 16384
    ds_read_b64_tr_b16 v[36:37], v23 offset:13312
    ds_read_b64_tr_b16 v[38:39], v23 offset:15360
    s_waitcnt vmcnt(20)
    s_waitcnt lgkmcnt(10)
    v_mfma_f32_32x32x16_bf16 v[56:71], v[44:47], v[180:183], v[56:71]
    s_and_b32 s16, s16, 0x3ffff
    ds_read_b64_tr_b16 v[40:41], v20 offset:16384
    ds_read_b64_tr_b16 v[42:43], v20 offset:18432
    s_waitcnt lgkmcnt(10)
    v_mfma_f32_32x32x16_bf16 v[72:87], v[48:51], v[180:183], v[72:87]
    ds_read_b64_tr_b16 v[44:45], v21 offset:16384
    ds_read_b64_tr_b16 v[46:47], v21 offset:18432
    s_waitcnt lgkmcnt(10)
    v_mfma_f32_32x32x16_bf16 v[120:135], v[52:55], v[180:183], v[120:135]
    buffer_load_dwordx4 v[168:171], v249, s[32:35], s16 offen sc1
    ds_read_b64_tr_b16 v[48:49], v24 offset:16384
    ds_read_b64_tr_b16 v[50:51], v24 offset:18432
    s_waitcnt lgkmcnt(10)
    v_mfma_f32_32x32x16_bf16 v[136:151], v[28:31], v[180:183], v[136:151]
    ds_read_b64_tr_b16 v[52:53], v25 offset:16384
    ds_read_b64_tr_b16 v[54:55], v25 offset:18432
    s_waitcnt lgkmcnt(10)
    v_mfma_f32_32x32x16_bf16 v[88:103], v[32:35], v[180:183], v[88:103]
    ds_read_b64_tr_b16 v[28:29], v22 offset:16384
    ds_read_b64_tr_b16 v[30:31], v22 offset:18432
    s_waitcnt lgkmcnt(10)
    v_mfma_f32_32x32x16_bf16 v[104:119], v[36:39], v[180:183], v[104:119]
    buffer_load_dwordx4 v[172:175], v249, s[32:35], s16 offen offset:1024 sc1
    ds_read_b64_tr_b16 v[32:33], v23 offset:16384
    ds_read_b64_tr_b16 v[34:35], v23 offset:18432
    s_barrier
    s_waitcnt vmcnt(21)
    s_waitcnt lgkmcnt(10)
    v_mfma_f32_32x32x16_bf16 v[56:71], v[40:43], v[184:187], v[56:71]
    ds_read_b64_tr_b16 v[36:37], v20 offset:17408
    ds_read_b64_tr_b16 v[38:39], v20 offset:19456
    s_waitcnt lgkmcnt(10)
    v_mfma_f32_32x32x16_bf16 v[72:87], v[44:47], v[184:187], v[72:87]
    ds_read_b64_tr_b16 v[40:41], v21 offset:17408
    ds_read_b64_tr_b16 v[42:43], v21 offset:19456
    s_waitcnt lgkmcnt(10)
    v_mfma_f32_32x32x16_bf16 v[120:135], v[48:51], v[184:187], v[120:135]
    ds_read_b64_tr_b16 v[44:45], v24 offset:17408
    ds_read_b64_tr_b16 v[46:47], v24 offset:19456
    s_waitcnt lgkmcnt(10)
    v_mfma_f32_32x32x16_bf16 v[136:151], v[52:55], v[184:187], v[136:151]
    ds_read_b64_tr_b16 v[48:49], v25 offset:17408
    ds_read_b64_tr_b16 v[50:51], v25 offset:19456
    s_waitcnt lgkmcnt(10)
    v_mfma_f32_32x32x16_bf16 v[88:103], v[28:31], v[184:187], v[88:103]
    ds_read_b64_tr_b16 v[52:53], v22 offset:17408
    ds_read_b64_tr_b16 v[54:55], v22 offset:19456
    s_waitcnt lgkmcnt(10)
    v_mfma_f32_32x32x16_bf16 v[104:119], v[32:35], v[184:187], v[104:119]
    ds_read_b64_tr_b16 v[28:29], v23 offset:17408
    ds_read_b64_tr_b16 v[30:31], v23 offset:19456
    s_waitcnt vmcnt(20)
    s_waitcnt lgkmcnt(10)
    v_mfma_f32_32x32x16_bf16 v[56:71], v[36:39], v[188:191], v[56:71]
    ds_read_b64_tr_b16 v[32:33], v20 offset:20480
    ds_read_b64_tr_b16 v[34:35], v20 offset:22528
    s_waitcnt lgkmcnt(10)
    v_mfma_f32_32x32x16_bf16 v[72:87], v[40:43], v[188:191], v[72:87]
    ds_read_b64_tr_b16 v[36:37], v21 offset:20480
    ds_read_b64_tr_b16 v[38:39], v21 offset:22528
    s_waitcnt lgkmcnt(10)
    v_mfma_f32_32x32x16_bf16 v[120:135], v[44:47], v[188:191], v[120:135]
    ds_read_b64_tr_b16 v[40:41], v24 offset:20480
    ds_read_b64_tr_b16 v[42:43], v24 offset:22528
    s_waitcnt lgkmcnt(10)
    v_mfma_f32_32x32x16_bf16 v[136:151], v[48:51], v[188:191], v[136:151]
    buffer_load_dwordx4 v[176:179], v249, s[32:35], s16 offen offset:2048 sc1
    ds_read_b64_tr_b16 v[44:45], v25 offset:20480
    ds_read_b64_tr_b16 v[46:47], v25 offset:22528
    s_waitcnt lgkmcnt(10)
    v_mfma_f32_32x32x16_bf16 v[88:103], v[52:55], v[188:191], v[88:103]
    ds_read_b64_tr_b16 v[48:49], v22 offset:20480
    ds_read_b64_tr_b16 v[50:51], v22 offset:22528
    s_waitcnt lgkmcnt(10)
    v_mfma_f32_32x32x16_bf16 v[104:119], v[28:31], v[188:191], v[104:119]
    ds_read_b64_tr_b16 v[52:53], v23 offset:20480
    ds_read_b64_tr_b16 v[54:55], v23 offset:22528
    s_waitcnt vmcnt(20)
    s_waitcnt lgkmcnt(10)
    v_mfma_f32_32x32x16_bf16 v[56:71], v[32:35], v[192:195], v[56:71]
    ds_read_b64_tr_b16 v[28:29], v20 offset:21504
    ds_read_b64_tr_b16 v[30:31], v20 offset:23552
    s_waitcnt lgkmcnt(10)
    v_mfma_f32_32x32x16_bf16 v[72:87], v[36:39], v[192:195], v[72:87]
    buffer_load_dwordx4 v[180:183], v249, s[32:35], s16 offen offset:3072 sc1
    ds_read_b64_tr_b16 v[32:33], v21 offset:21504
    ds_read_b64_tr_b16 v[34:35], v21 offset:23552
    s_waitcnt lgkmcnt(10)
    v_mfma_f32_32x32x16_bf16 v[120:135], v[40:43], v[192:195], v[120:135]
    s_add_u32 s16, s16, 16384
    ds_read_b64_tr_b16 v[36:37], v24 offset:21504
    ds_read_b64_tr_b16 v[38:39], v24 offset:23552
    s_waitcnt lgkmcnt(10)
    v_mfma_f32_32x32x16_bf16 v[136:151], v[44:47], v[192:195], v[136:151]
    s_and_b32 s16, s16, 0x3ffff
    ds_read_b64_tr_b16 v[40:41], v25 offset:21504
    ds_read_b64_tr_b16 v[42:43], v25 offset:23552
    s_waitcnt lgkmcnt(10)
    v_mfma_f32_32x32x16_bf16 v[88:103], v[48:51], v[192:195], v[88:103]
    buffer_load_dwordx4 v[184:187], v249, s[32:35], s16 offen sc1
    ds_read_b64_tr_b16 v[44:45], v22 offset:21504
    ds_read_b64_tr_b16 v[46:47], v22 offset:23552
L_PAD3:
    s_cbranch_execz L_RET3
    s_waitcnt lgkmcnt(10)
    v_mfma_f32_32x32x16_bf16 v[104:119], v[52:55], v[192:195], v[104:119]
    ds_read_b64_tr_b16 v[48:49], v23 offset:21504
    ds_read_b64_tr_b16 v[50:51], v23 offset:23552
    s_waitcnt vmcnt(21)
    s_waitcnt lgkmcnt(10)
    v_mfma_f32_32x32x16_bf16 v[56:71], v[28:31], v[196:199], v[56:71]
    ds_read_b64_tr_b16 v[52:53], v20 offset:24576
    ds_read_b64_tr_b16 v[54:55], v20 offset:26624
    s_waitcnt lgkmcnt(10)
    v_mfma_f32_32x32x16_bf16 v[72:87], v[32:35], v[196:199], v[72:87]
    ds_read_b64_tr_b16 v[28:29], v21 offset:24576
    ds_read_b64_tr_b16 v[30:31], v21 offset:26624
    s_waitcnt lgkmcnt(10)
    v_mfma_f32_32x32x16_bf16 v[120:135], v[36:39], v[196:199], v[120:135]
    buffer_load_dwordx4 v[188:191], v249, s[32:35], s16 offen offset:1024 sc1
    ds_read_b64_tr_b16 v[32:33], v20 offset:25600
    ds_read_b64_tr_b16 v[34:35], v20 offset:27648
    s_waitcnt lgkmcnt(10)
    v_mfma_f32_32x32x16_bf16 v[136:151], v[40:43], v[196:199], v[136:151]
    ds_read_b64_tr_b16 v[36:37], v21 offset:25600
    ds_read_b64_tr_b16 v[38:39], v21 offset:27648
    s_waitcnt lgkmcnt(10)
    v_mfma_f32_32x32x16_bf16 v[88:103], v[44:47], v[196:199], v[88:103]
    ds_read_b64_tr_b16 v[40:41], v20 offset:28672
    ds_read_b64_tr_b16 v[42:43], v20 offset:30720
    s_waitcnt lgkmcnt(10)
    v_mfma_f32_32x32x16_bf16 v[104:119], v[48:51], v[196:199], v[104:119]
    buffer_load_dwordx4 v[192:195], v249, s[32:35], s16 offen offset:2048 sc1
    ds_read_b64_tr_b16 v[44:45], v21 offset:28672
    ds_read_b64_tr_b16 v[46:47], v21 offset:30720
    s_barrier
    s_waitcnt vmcnt(22)
    s_waitcnt lgkmcnt(10)
    v_mfma_f32_32x32x16_bf16 v[56:71], v[52:55], v[200:203], v[56:71]
    ds_read_b64_tr_b16 v[48:49], v20 offset:29696
    ds_read_b64_tr_b16 v[50:51], v20 offset:31744
    s_waitcnt lgkmcnt(10)
    v_mfma_f32_32x32x16_bf16 v[72:87], v[28:31], v[200:203], v[72:87]
    ds_read_b64_tr_b16 v[52:53], v21 offset:29696
    ds_read_b64_tr_b16 v[54:55], v21 offset:31744
    s_waitcnt vmcnt(21)
    s_waitcnt lgkmcnt(10)
    v_mfma_f32_32x32x16_bf16 v[56:71], v[32:35], v[204:207], v[56:71]
    ds_read_b64_tr_b16 v[28:29], v24 offset:24576
    ds_read_b64_tr_b16 v[30:31], v24 offset:26624
    s_waitcnt lgkmcnt(10)
    v_mfma_f32_32x32x16_bf16 v[72:87], v[36:39], v[204:207], v[72:87]
    ds_read_b64_tr_b16 v[32:33], v25 offset:24576
    ds_read_b64_tr_b16 v[34:35], v25 offset:26624
    s_waitcnt vmcnt(20)
    s_waitcnt lgkmcnt(10)
    v_mfma_f32_32x32x16_bf16 v[56:71], v[40:43], v[208:211], v[56:71]
    ds_read_b64_tr_b16 v[36:37], v22 offset:24576
    ds_read_b64_tr_b16 v[38:39], v22 offset:26624
    s_waitcnt lgkmcnt(10)
    v_mfma_f32_32x32x16_bf16 v[72:87], v[44:47], v[208:211], v[72:87]
    ds_read_b64_tr_b16 v[40:41], v23 offset:24576
    ds_read_b64_tr_b16 v[42:43], v23 offset:26624
    s_waitcnt vmcnt(19)
    s_waitcnt lgkmcnt(10)
    v_mfma_f32_32x32x16_bf16 v[56:71], v[48:51], v[212:215], v[56:71]
    ds_read_b64_tr_b16 v[44:45], v24 offset:25600
    ds_read_b64_tr_b16 v[46:47], v24 offset:27648
    s_waitcnt lgkmcnt(10)
    v_mfma_f32_32x32x16_bf16 v[72:87], v[52:55], v[212:215], v[72:87]
    ds_read_b64_tr_b16 v[48:49], v25 offset:25600
    ds_read_b64_tr_b16 v[50:51], v25 offset:27648
    s_barrier
    s_waitcnt lgkmcnt(10)
    v_mfma_f32_32x32x16_bf16 v[120:135], v[28:31], v[200:203], v[120:135]
    ds_read_b64_tr_b16 v[52:53], v22 offset:25600
    ds_read_b64_tr_b16 v[54:55], v22 offset:27648
    s_waitcnt lgkmcnt(10)
    v_mfma_f32_32x32x16_bf16 v[136:151], v[32:35], v[200:203], v[136:151]
    buffer_load_dwordx4 v[196:199], v249, s[32:35], s16 offen offset:3072 sc1
    ds_read_b64_tr_b16 v[28:29], v23 offset:25600
    ds_read_b64_tr_b16 v[30:31], v23 offset:27648
    s_waitcnt lgkmcnt(10)
    v_mfma_f32_32x32x16_bf16 v[88:103], v[36:39], v[200:203], v[88:103]
    s_add_u32 s16, s16, 16384
    ds_read_b64_tr_b16 v[32:33], v24 offset:28672
    ds_read_b64_tr_b16 v[34:35], v24 offset:30720
    s_waitcnt lgkmcnt(10)
    v_mfma_f32_32x32x16_bf16 v[104:119], v[40:43], v[200:203], v[104:119]
    s_and_b32 s16, s16, 0x3ffff
    ds_read_b64_tr_b16 v[36:37], v25 offset:28672
    ds_read_b64_tr_b16 v[38:39], v25 offset:30720
    s_waitcnt lgkmcnt(10)
    v_mfma_f32_32x32x16_bf16 v[120:135], v[44:47], v[204:207], v[120:135]
    ds_read_b64_tr_b16 v[40:41], v22 offset:28672
    ds_read_b64_tr_b16 v[42:43], v22 offset:30720
    s_waitcnt lgkmcnt(10)
    v_mfma_f32_32x32x16_bf16 v[136:151], v[48:51], v[204:207], v[136:151]
    buffer_load_dwordx4 v[200:203], v249, s[32:35], s16 offen sc1
    ds_read_b64_tr_b16 v[44:45], v23 offset:28672
    ds_read_b64_tr_b16 v[46:47], v23 offset:30720
    s_waitcnt lgkmcnt(10)
    v_mfma_f32_32x32x16_bf16 v[88:103], v[52:55], v[204:207], v[88:103]
    ds_read_b64_tr_b16 v[48:49], v24 offset:29696
    ds_read_b64_tr_b16 v[50:51], v24 offset:31744
    s_waitcnt lgkmcnt(10)
    v_mfma_f32_32x32x16_bf16 v[104:119], v[28:31], v[204:207], v[104:119]
    ds_read_b64_tr_b16 v[52:53], v25 offset:29696
    ds_read_b64_tr_b16 v[54:55], v25 offset:31744
    s_waitcnt lgkmcnt(10)
    v_mfma_f32_32x32x16_bf16 v[120:135], v[32:35], v[208:211], v[120:135]
    buffer_load_dwordx4 v[204:207], v249, s[32:35], s16 offen offset:1024 sc1
    ds_read_b64_tr_b16 v[28:29], v22 offset:29696
    ds_read_b64_tr_b16 v[30:31], v22 offset:31744
    s_waitcnt lgkmcnt(10)
    v_mfma_f32_32x32x16_bf16 v[136:151], v[36:39], v[208:211], v[136:151]
    ds_read_b64_tr_b16 v[32:33], v23 offset:29696
    ds_read_b64_tr_b16 v[34:35], v23 offset:31744
    s_waitcnt lgkmcnt(10)
    v_mfma_f32_32x32x16_bf16 v[88:103], v[40:43], v[208:211], v[88:103]
    ds_read_b64_tr_b16 v[36:37], v20 offset:32768
    ds_read_b64_tr_b16 v[38:39], v20 offset:34816
    s_waitcnt lgkmcnt(10)
    v_mfma_f32_32x32x16_bf16 v[104:119], v[44:47], v[208:211], v[104:119]
    ds_read_b64_tr_b16 v[40:41], v20 offset:33792
    ds_read_b64_tr_b16 v[42:43], v20 offset:35840
    s_waitcnt lgkmcnt(10)
    v_mfma_f32_32x32x16_bf16 v[120:135], v[48:51], v[212:215], v[120:135]
    buffer_load_dwordx4 v[208:211], v249, s[32:35], s16 offen offset:2048 sc1
    ds_read_b64_tr_b16 v[44:45], v20 offset:36864
    ds_read_b64_tr_b16 v[46:47], v20 offset:38912
    s_waitcnt lgkmcnt(10)
    v_mfma_f32_32x32x16_bf16 v[136:151], v[52:55], v[212:215], v[136:151]
    ds_read_b64_tr_b16 v[48:49], v20 offset:37888
    ds_read_b64_tr_b16 v[50:51], v20 offset:39936
    s_waitcnt lgkmcnt(10)
    v_mfma_f32_32x32x16_bf16 v[88:103], v[28:31], v[212:215], v[88:103]
    ds_read_b64_tr_b16 v[52:53], v20 offset:40960
    ds_read_b64_tr_b16 v[54:55], v20 offset:43008
    s_waitcnt lgkmcnt(10)
    v_mfma_f32_32x32x16_bf16 v[104:119], v[32:35], v[212:215], v[104:119]
    buffer_load_dwordx4 v[212:215], v249, s[32:35], s16 offen offset:3072 sc1
    ds_read_b64_tr_b16 v[28:29], v20 offset:41984
    ds_read_b64_tr_b16 v[30:31], v20 offset:44032
    s_barrier
    s_waitcnt vmcnt(23)
    s_waitcnt lgkmcnt(10)
    v_mfma_f32_32x32x16_bf16 v[56:71], v[36:39], v[216:219], v[56:71]
    s_add_u32 s16, s16, 16384
    ds_read_b64_tr_b16 v[32:33], v20 offset:45056
    ds_read_b64_tr_b16 v[34:35], v20 offset:47104
    s_waitcnt vmcnt(22)
    s_waitcnt lgkmcnt(10)
    v_mfma_f32_32x32x16_bf16 v[56:71], v[40:43], v[220:223], v[56:71]
    s_and_b32 s16, s16, 0x3ffff
    ds_read_b64_tr_b16 v[36:37], v20 offset:46080
    ds_read_b64_tr_b16 v[38:39], v20 offset:48128
    s_waitcnt vmcnt(21)
    s_waitcnt lgkmcnt(10)
    v_mfma_f32_32x32x16_bf16 v[56:71], v[44:47], v[224:227], v[56:71]
    ds_read_b64_tr_b16 v[40:41], v20
    ds_read_b64_tr_b16 v[42:43], v20 offset:2048
    s_waitcnt vmcnt(20)
    s_waitcnt lgkmcnt(10)
    v_mfma_f32_32x32x16_bf16 v[56:71], v[48:51], v[228:231], v[56:71]
    ds_read_b64_tr_b16 v[44:45], v20 offset:1024
    ds_read_b64_tr_b16 v[46:47], v20 offset:3072
    s_waitcnt vmcnt(19)
    s_waitcnt lgkmcnt(10)
    v_mfma_f32_32x32x16_bf16 v[56:71], v[52:55], v[232:235], v[56:71]
    ds_read_b64_tr_b16 v[48:49], v20 offset:4096
    ds_read_b64_tr_b16 v[50:51], v20 offset:6144
    s_waitcnt vmcnt(18)
    s_waitcnt lgkmcnt(10)
    v_mfma_f32_32x32x16_bf16 v[56:71], v[28:31], v[236:239], v[56:71]
    ds_read_b64_tr_b16 v[52:53], v20 offset:5120
    ds_read_b64_tr_b16 v[54:55], v20 offset:7168
    s_waitcnt vmcnt(17)
    s_waitcnt lgkmcnt(10)
    v_mfma_f32_32x32x16_bf16 v[56:71], v[32:35], v[240:243], v[56:71]
    ds_read_b64_tr_b16 v[28:29], v20 offset:8192
    ds_read_b64_tr_b16 v[30:31], v20 offset:10240
    s_waitcnt vmcnt(16)
    s_waitcnt lgkmcnt(10)
    v_mfma_f32_32x32x16_bf16 v[56:71], v[36:39], v[244:247], v[56:71]
    ds_read_b64_tr_b16 v[32:33], v20 offset:9216
    ds_read_b64_tr_b16 v[34:35], v20 offset:11264
    s_waitcnt vmcnt(15)
    s_waitcnt lgkmcnt(10)
    v_mfma_f32_32x32x16_bf16 v[56:71], v[40:43], v[152:155], v[56:71]
    ds_read_b64_tr_b16 v[36:37], v20 offset:12288
    ds_read_b64_tr_b16 v[38:39], v20 offset:14336
    s_waitcnt vmcnt(14)
    s_waitcnt lgkmcnt(10)
    v_mfma_f32_32x32x16_bf16 v[56:71], v[44:47], v[156:159], v[56:71]
    ds_read_b64_tr_b16 v[40:41], v20 offset:13312
    ds_read_b64_tr_b16 v[42:43], v20 offset:15360
    s_waitcnt vmcnt(13)
    s_waitcnt lgkmcnt(10)
    v_mfma_f32_32x32x16_bf16 v[56:71], v[48:51], v[160:163], v[56:71]
    ds_read_b64_tr_b16 v[44:45], v20 offset:16384
    ds_read_b64_tr_b16 v[46:47], v20 offset:18432
    s_waitcnt vmcnt(12)
    s_waitcnt lgkmcnt(10)
    v_mfma_f32_32x32x16_bf16 v[56:71], v[52:55], v[164:167], v[56:71]
    ds_read_b64_tr_b16 v[48:49], v20 offset:17408
    ds_read_b64_tr_b16 v[50:51], v20 offset:19456
    s_waitcnt vmcnt(11)
    s_waitcnt lgkmcnt(10)
    v_mfma_f32_32x32x16_bf16 v[56:71], v[28:31], v[168:171], v[56:71]
    ds_read_b64_tr_b16 v[52:53], v20 offset:20480
    ds_read_b64_tr_b16 v[54:55], v20 offset:22528
    s_waitcnt vmcnt(10)
    s_waitcnt lgkmcnt(10)
    v_mfma_f32_32x32x16_bf16 v[56:71], v[32:35], v[172:175], v[56:71]
    ds_read_b64_tr_b16 v[28:29], v20 offset:21504
    ds_read_b64_tr_b16 v[30:31], v20 offset:23552
    s_barrier
    s_waitcnt vmcnt(9)
    s_waitcnt lgkmcnt(10)
    v_mfma_f32_32x32x16_bf16 v[56:71], v[36:39], v[176:179], v[56:71]
    ds_read_b64_tr_b16 v[32:33], v20 offset:24576
    ds_read_b64_tr_b16 v[34:35], v20 offset:26624
    s_waitcnt vmcnt(8)
    s_waitcnt lgkmcnt(10)
    v_mfma_f32_32x32x16_bf16 v[56:71], v[40:43], v[180:183], v[56:71]
    ds_read_b64_tr_b16 v[36:37], v20 offset:25600
    ds_read_b64_tr_b16 v[38:39], v20 offset:27648
    s_waitcnt vmcnt(7)
    s_waitcnt lgkmcnt(10)
    v_mfma_f32_32x32x16_bf16 v[56:71], v[44:47], v[184:187], v[56:71]
    ds_read_b64_tr_b16 v[40:41], v20 offset:28672
    ds_read_b64_tr_b16 v[42:43], v20 offset:30720
    s_waitcnt vmcnt(6)
    s_waitcnt lgkmcnt(10)
    v_mfma_f32_32x32x16_bf16 v[56:71], v[48:51], v[188:191], v[56:71]
    ds_read_b64_tr_b16 v[44:45], v20 offset:29696
    ds_read_b64_tr_b16 v[46:47], v20 offset:31744
    s_waitcnt vmcnt(5)
    s_waitcnt lgkmcnt(10)
    v_mfma_f32_32x32x16_bf16 v[56:71], v[52:55], v[192:195], v[56:71]
    ds_read_b64_tr_b16 v[48:49], v21 offset:32768
    ds_read_b64_tr_b16 v[50:51], v21 offset:34816
    s_waitcnt vmcnt(4)
    s_waitcnt lgkmcnt(10)
    v_mfma_f32_32x32x16_bf16 v[56:71], v[28:31], v[196:199], v[56:71]
    ds_read_b64_tr_b16 v[52:53], v21 offset:33792
    ds_read_b64_tr_b16 v[54:55], v21 offset:35840
    s_waitcnt vmcnt(3)
    s_waitcnt lgkmcnt(10)
    v_mfma_f32_32x32x16_bf16 v[56:71], v[32:35], v[200:203], v[56:71]
    ds_read_b64_tr_b16 v[28:29], v21 offset:36864
    ds_read_b64_tr_b16 v[30:31], v21 offset:38912
    s_waitcnt vmcnt(2)
    s_waitcnt lgkmcnt(10)
    v_mfma_f32_32x32x16_bf16 v[56:71], v[36:39], v[204:207], v[56:71]
    ds_read_b64_tr_b16 v[32:33], v21 offset:37888
    ds_read_b64_tr_b16 v[34:35], v21 offset:39936
    s_waitcnt vmcnt(1)
    s_waitcnt lgkmcnt(10)
    v_mfma_f32_32x32x16_bf16 v[56:71], v[40:43], v[208:211], v[56:71]
    ds_read_b64_tr_b16 v[36:37], v21 offset:40960
    ds_read_b64_tr_b16 v[38:39], v21 offset:43008
    s_waitcnt vmcnt(0)
    s_waitcnt lgkmcnt(10)
    v_mfma_f32_32x32x16_bf16 v[56:71], v[44:47], v[212:215], v[56:71]
    ds_read_b64_tr_b16 v[40:41], v21 offset:41984
    ds_read_b64_tr_b16 v[42:43], v21 offset:44032
    s_waitcnt lgkmcnt(10)
    v_mfma_f32_32x32x16_bf16 v[72:87], v[48:51], v[216:219], v[72:87]
    ds_read_b64_tr_b16 v[44:45], v21 offset:45056
    ds_read_b64_tr_b16 v[46:47], v21 offset:47104
    s_waitcnt lgkmcnt(10)
    v_mfma_f32_32x32x16_bf16 v[72:87], v[52:55], v[220:223], v[72:87]
    s_nop 3
    v_cvt_pk_bf16_f32 v56, v56, v57
    v_cvt_pk_bf16_f32 v57, v58, v59
    ds_read_b64_tr_b16 v[48:49], v21 offset:46080
    ds_read_b64_tr_b16 v[50:51], v21 offset:48128
    s_waitcnt lgkmcnt(10)
    v_mfma_f32_32x32x16_bf16 v[72:87], v[28:31], v[224:227], v[72:87]
    v_cvt_pk_bf16_f32 v58, v60, v61
    v_cvt_pk_bf16_f32 v59, v62, v63
    ds_read_b64_tr_b16 v[52:53], v21
    ds_read_b64_tr_b16 v[54:55], v21 offset:2048
    s_waitcnt lgkmcnt(10)
    v_mfma_f32_32x32x16_bf16 v[72:87], v[32:35], v[228:231], v[72:87]
    ds_write_b128 v0, v[56:59]
    v_cvt_pk_bf16_f32 v60, v64, v65
    ds_read_b64_tr_b16 v[28:29], v21 offset:1024
    ds_read_b64_tr_b16 v[30:31], v21 offset:3072
    s_waitcnt lgkmcnt(11)
    v_mfma_f32_32x32x16_bf16 v[72:87], v[36:39], v[232:235], v[72:87]
    v_cvt_pk_bf16_f32 v61, v66, v67
    v_cvt_pk_bf16_f32 v62, v68, v69
    ds_read_b64_tr_b16 v[32:33], v21 offset:4096
    ds_read_b64_tr_b16 v[34:35], v21 offset:6144
    s_waitcnt lgkmcnt(11)
    v_mfma_f32_32x32x16_bf16 v[72:87], v[40:43], v[236:239], v[72:87]
    v_cvt_pk_bf16_f32 v63, v70, v71
    ds_write_b128 v0, v[60:63] offset:1024
    ds_read_b64_tr_b16 v[36:37], v21 offset:5120
    ds_read_b64_tr_b16 v[38:39], v21 offset:7168
    s_waitcnt lgkmcnt(12)
    v_mfma_f32_32x32x16_bf16 v[72:87], v[44:47], v[240:243], v[72:87]
    v_subrev_u32 v0, 118784, v0
    ds_read_b64_tr_b16 v[40:41], v21 offset:8192
    ds_read_b64_tr_b16 v[42:43], v21 offset:10240
    s_waitcnt lgkmcnt(12)
    v_mfma_f32_32x32x16_bf16 v[72:87], v[48:51], v[244:247], v[72:87]
    ds_read_b64_tr_b16 v[44:45], v21 offset:9216
    ds_read_b64_tr_b16 v[46:47], v21 offset:11264
    s_waitcnt lgkmcnt(6)
    s_barrier
    v_mfma_f32_32x32x16_bf16 v[72:87], v[52:55], v[152:155], v[72:87]
    ds_read_b64_tr_b16 v[48:49], v21 offset:12288
    ds_read_b64_tr_b16 v[50:51], v21 offset:14336
    v_mfma_f32_32x32x16_bf16 v[72:87], v[28:31], v[156:159], v[72:87]
    ds_read_b64_tr_b16 v[52:53], v21 offset:13312
    ds_read_b64_tr_b16 v[54:55], v21 offset:15360
    v_mfma_f32_32x32x16_bf16 v[72:87], v[32:35], v[160:163], v[72:87]
    ds_read_b64_tr_b16 v[28:29], v21 offset:16384
    ds_read_b64_tr_b16 v[30:31], v21 offset:18432
    s_waitcnt lgkmcnt(10)
    v_mfma_f32_32x32x16_bf16 v[72:87], v[36:39], v[164:167], v[72:87]
    ds_read_b64_tr_b16 v[32:33], v21 offset:17408
    ds_read_b64_tr_b16 v[34:35], v21 offset:19456
    s_waitcnt lgkmcnt(10)
    v_mfma_f32_32x32x16_bf16 v[72:87], v[40:43], v[168:171], v[72:87]
    ds_read_b64_tr_b16 v[36:37], v21 offset:20480
    ds_read_b64_tr_b16 v[38:39], v21 offset:22528
    s_waitcnt lgkmcnt(10)
    v_mfma_f32_32x32x16_bf16 v[72:87], v[44:47], v[172:175], v[72:87]
    ds_read_b64_tr_b16 v[40:41], v21 offset:21504
    ds_read_b64_tr_b16 v[42:43], v21 offset:23552
    s_waitcnt lgkmcnt(10)
    v_mfma_f32_32x32x16_bf16 v[72:87], v[48:51], v[176:179], v[72:87]
    ds_read_b64_tr_b16 v[44:45], v21 offset:24576
    ds_read_b64_tr_b16 v[46:47], v21 offset:26624
    s_waitcnt lgkmcnt(10)
    v_mfma_f32_32x32x16_bf16 v[72:87], v[52:55], v[180:183], v[72:87]
    ds_read_b64_tr_b16 v[48:49], v21 offset:25600
    ds_read_b64_tr_b16 v[50:51], v21 offset:27648
    s_waitcnt lgkmcnt(10)
    v_mfma_f32_32x32x16_bf16 v[72:87], v[28:31], v[184:187], v[72:87]
    ds_read_b64_tr_b16 v[52:53], v21 offset:28672
    ds_read_b64_tr_b16 v[54:55], v21 offset:30720
    s_waitcnt lgkmcnt(10)
    v_mfma_f32_32x32x16_bf16 v[72:87], v[32:35], v[188:191], v[72:87]
    ds_read_b64_tr_b16 v[28:29], v21 offset:29696
    ds_read_b64_tr_b16 v[30:31], v21 offset:31744
    s_waitcnt lgkmcnt(10)
    v_mfma_f32_32x32x16_bf16 v[72:87], v[36:39], v[192:195], v[72:87]
    ds_read_b64_tr_b16 v[32:33], v22 offset:32768
    ds_read_b64_tr_b16 v[34:35], v22 offset:34816
    s_waitcnt lgkmcnt(10)
    v_mfma_f32_32x32x16_bf16 v[72:87], v[40:43], v[196:199], v[72:87]
    ds_read_b64_tr_b16 v[36:37], v23 offset:32768
    ds_read_b64_tr_b16 v[38:39], v23 offset:34816
    s_waitcnt lgkmcnt(10)
    v_mfma_f32_32x32x16_bf16 v[72:87], v[44:47], v[200:203], v[72:87]
    ds_read_b64_tr_b16 v[40:41], v22 offset:33792
    ds_read_b64_tr_b16 v[42:43], v22 offset:35840
    s_waitcnt lgkmcnt(10)
    v_mfma_f32_32x32x16_bf16 v[72:87], v[48:51], v[204:207], v[72:87]
    ds_read_b64_tr_b16 v[44:45], v23 offset:33792
    ds_read_b64_tr_b16 v[46:47], v23 offset:35840
    s_waitcnt lgkmcnt(10)
    v_mfma_f32_32x32x16_bf16 v[72:87], v[52:55], v[208:211], v[72:87]
    ds_read_b64_tr_b16 v[48:49], v22 offset:36864
    ds_read_b64_tr_b16 v[50:51], v22 offset:38912
    s_waitcnt lgkmcnt(10)
    v_mfma_f32_32x32x16_bf16 v[72:87], v[28:31], v[212:215], v[72:87]
    ds_read_b64_tr_b16 v[52:53], v23 offset:36864
    ds_read_b64_tr_b16 v[54:55], v23 offset:38912
    s_waitcnt lgkmcnt(10)
    v_mfma_f32_32x32x16_bf16 v[88:103], v[32:35], v[216:219], v[88:103]
    ds_read_b64_tr_b16 v[28:29], v22 offset:37888
    ds_read_b64_tr_b16 v[30:31], v22 offset:39936
    s_waitcnt lgkmcnt(10)
    v_mfma_f32_32x32x16_bf16 v[104:119], v[36:39], v[216:219], v[104:119]
    s_nop 3
    v_cvt_pk_bf16_f32 v72, v72, v73
    v_cvt_pk_bf16_f32 v73, v74, v75
    ds_read_b64_tr_b16 v[32:33], v23 offset:37888
    ds_read_b64_tr_b16 v[34:35], v23 offset:39936
    s_waitcnt lgkmcnt(10)
    v_mfma_f32_32x32x16_bf16 v[88:103], v[40:43], v[220:223], v[88:103]
    v_cvt_pk_bf16_f32 v74, v76, v77
    v_cvt_pk_bf16_f32 v75, v78, v79
    ds_read_b64_tr_b16 v[36:37], v22 offset:40960
    ds_read_b64_tr_b16 v[38:39], v22 offset:43008
    s_waitcnt lgkmcnt(10)
    v_mfma_f32_32x32x16_bf16 v[104:119], v[44:47], v[220:223], v[104:119]
    ds_write_b128 v0, v[72:75]
    v_cvt_pk_bf16_f32 v76, v80, v81
    ds_read_b64_tr_b16 v[40:41], v23 offset:40960
    ds_read_b64_tr_b16 v[42:43], v23 offset:43008
    s_waitcnt lgkmcnt(11)
    v_mfma_f32_32x32x16_bf16 v[88:103], v[48:51], v[224:227], v[88:103]
    v_cvt_pk_bf16_f32 v77, v82, v83
    v_cvt_pk_bf16_f32 v78, v84, v85
    ds_read_b64_tr_b16 v[44:45], v22 offset:41984
    ds_read_b64_tr_b16 v[46:47], v22 offset:44032
    s_waitcnt lgkmcnt(11)
    v_mfma_f32_32x32x16_bf16 v[104:119], v[52:55], v[224:227], v[104:119]
    v_cvt_pk_bf16_f32 v79, v86, v87
    ds_write_b128 v0, v[76:79] offset:1024
    ds_read_b64_tr_b16 v[48:49], v23 offset:41984
    ds_read_b64_tr_b16 v[50:51], v23 offset:44032
    s_waitcnt lgkmcnt(12)
    v_mfma_f32_32x32x16_bf16 v[88:103], v[28:31], v[228:231], v[88:103]
    ds_read_b64_tr_b16 v[52:53], v22 offset:45056
    ds_read_b64_tr_b16 v[54:55], v22 offset:47104
    s_waitcnt lgkmcnt(12)
    v_mfma_f32_32x32x16_bf16 v[104:119], v[32:35], v[228:231], v[104:119]
    ds_read_b64_tr_b16 v[28:29], v23 offset:45056
    ds_read_b64_tr_b16 v[30:31], v23 offset:47104
    s_waitcnt lgkmcnt(6)
    s_barrier
    v_mfma_f32_32x32x16_bf16 v[88:103], v[36:39], v[232:235], v[88:103]
    s_lshl_b32 s96, s77, 11
    s_add_u32 s14, s96, 32768
    v_and_b32 v0, 7, v1
    ds_read_b64_tr_b16 v[32:33], v22 offset:46080
    ds_read_b64_tr_b16 v[34:35], v22 offset:48128
    v_mfma_f32_32x32x16_bf16 v[104:119], v[40:43], v[232:235], v[104:119]
    v_lshl_add_u32 v0, v0, 4, s14
    ds_read_b64_tr_b16 v[36:37], v23 offset:46080
    ds_read_b64_tr_b16 v[38:39], v23 offset:48128
    v_mfma_f32_32x32x16_bf16 v[88:103], v[44:47], v[236:239], v[88:103]
    v_bfe_u32 v4, v1, 3, 2
    ds_read_b64_tr_b16 v[40:41], v22
    ds_read_b64_tr_b16 v[42:43], v22 offset:2048
    s_waitcnt lgkmcnt(10)
    v_mfma_f32_32x32x16_bf16 v[104:119], v[48:51], v[236:239], v[104:119]
    v_lshl_add_u32 v0, v4, 8, v0
    v_lshrrev_b32 v4, 5, v1
    ds_read_b64_tr_b16 v[44:45], v23
    ds_read_b64_tr_b16 v[46:47], v23 offset:2048
    s_waitcnt lgkmcnt(10)
    v_mfma_f32_32x32x16_bf16 v[88:103], v[52:55], v[240:243], v[88:103]
    v_lshl_add_u32 v0, v4, 7, v0
    ds_read_b64_tr_b16 v[48:49], v22 offset:1024
    ds_read_b64_tr_b16 v[50:51], v22 offset:3072
    s_waitcnt lgkmcnt(10)
    v_mfma_f32_32x32x16_bf16 v[104:119], v[28:31], v[240:243], v[104:119]
    ds_read_b64_tr_b16 v[52:53], v23 offset:1024
    ds_read_b64_tr_b16 v[54:55], v23 offset:3072
    s_waitcnt lgkmcnt(10)
    v_mfma_f32_32x32x16_bf16 v[88:103], v[32:35], v[244:247], v[88:103]
    ds_read_b64_tr_b16 v[28:29], v22 offset:4096
    ds_read_b64_tr_b16 v[30:31], v22 offset:6144
    s_waitcnt lgkmcnt(10)
    v_mfma_f32_32x32x16_bf16 v[104:119], v[36:39], v[244:247], v[104:119]
    ds_read_b64_tr_b16 v[32:33], v23 offset:4096
    ds_read_b64_tr_b16 v[34:35], v23 offset:6144
    s_waitcnt lgkmcnt(10)
    v_mfma_f32_32x32x16_bf16 v[88:103], v[40:43], v[152:155], v[88:103]
    ds_read_b64_tr_b16 v[36:37], v22 offset:5120
    ds_read_b64_tr_b16 v[38:39], v22 offset:7168
    s_waitcnt lgkmcnt(10)
    v_mfma_f32_32x32x16_bf16 v[104:119], v[44:47], v[152:155], v[104:119]
    ds_read_b64_tr_b16 v[40:41], v23 offset:5120
    ds_read_b64_tr_b16 v[42:43], v23 offset:7168
    s_waitcnt lgkmcnt(10)
    v_mfma_f32_32x32x16_bf16 v[88:103], v[48:51], v[156:159], v[88:103]
    ds_read_b64_tr_b16 v[44:45], v22 offset:8192
    ds_read_b64_tr_b16 v[46:47], v22 offset:10240
    s_waitcnt lgkmcnt(10)
    v_mfma_f32_32x32x16_bf16 v[104:119], v[52:55], v[156:159], v[104:119]
    ds_read_b64_tr_b16 v[48:49], v23 offset:8192
    ds_read_b64_tr_b16 v[50:51], v23 offset:10240
    s_waitcnt lgkmcnt(10)
    v_mfma_f32_32x32x16_bf16 v[88:103], v[28:31], v[160:163], v[88:103]
    ds_read_b64_tr_b16 v[52:53], v22 offset:9216
    ds_read_b64_tr_b16 v[54:55], v22 offset:11264
    s_waitcnt lgkmcnt(10)
    v_mfma_f32_32x32x16_bf16 v[104:119], v[32:35], v[160:163], v[104:119]
    ds_read_b64_tr_b16 v[28:29], v23 offset:9216
    ds_read_b64_tr_b16 v[30:31], v23 offset:11264
    s_waitcnt lgkmcnt(10)
    v_mfma_f32_32x32x16_bf16 v[88:103], v[36:39], v[164:167], v[88:103]
    ds_read_b64_tr_b16 v[32:33], v22 offset:12288
    ds_read_b64_tr_b16 v[34:35], v22 offset:14336
    s_waitcnt lgkmcnt(10)
    v_mfma_f32_32x32x16_bf16 v[104:119], v[40:43], v[164:167], v[104:119]
    ds_read_b64_tr_b16 v[36:37], v23 offset:12288
    ds_read_b64_tr_b16 v[38:39], v23 offset:14336
    s_waitcnt lgkmcnt(10)
    v_mfma_f32_32x32x16_bf16 v[88:103], v[44:47], v[168:171], v[88:103]
    ds_read_b64_tr_b16 v[40:41], v22 offset:13312
    ds_read_b64_tr_b16 v[42:43], v22 offset:15360
    s_waitcnt lgkmcnt(10)
    v_mfma_f32_32x32x16_bf16 v[104:119], v[48:51], v[168:171], v[104:119]
    ds_read_b64_tr_b16 v[44:45], v23 offset:13312
    ds_read_b64_tr_b16 v[46:47], v23 offset:15360
    s_waitcnt lgkmcnt(10)
    v_mfma_f32_32x32x16_bf16 v[88:103], v[52:55], v[172:175], v[88:103]
    ds_read_b64_tr_b16 v[48:49], v22 offset:16384
    ds_read_b64_tr_b16 v[50:51], v22 offset:18432
    s_waitcnt lgkmcnt(10)
    v_mfma_f32_32x32x16_bf16 v[104:119], v[28:31], v[172:175], v[104:119]
    ds_read_b64_tr_b16 v[52:53], v23 offset:16384
    ds_read_b64_tr_b16 v[54:55], v23 offset:18432
    s_waitcnt lgkmcnt(10)
    v_mfma_f32_32x32x16_bf16 v[88:103], v[32:35], v[176:179], v[88:103]
    ds_read_b64_tr_b16 v[28:29], v22 offset:17408
    ds_read_b64_tr_b16 v[30:31], v22 offset:19456
    s_waitcnt lgkmcnt(10)
    v_mfma_f32_32x32x16_bf16 v[104:119], v[36:39], v[176:179], v[104:119]
    ds_read_b64_tr_b16 v[32:33], v23 offset:17408
    ds_read_b64_tr_b16 v[34:35], v23 offset:19456
    s_waitcnt lgkmcnt(10)
    v_mfma_f32_32x32x16_bf16 v[88:103], v[40:43], v[180:183], v[88:103]
    ds_read_b64_tr_b16 v[36:37], v22 offset:20480
    ds_read_b64_tr_b16 v[38:39], v22 offset:22528
    s_waitcnt lgkmcnt(10)
    v_mfma_f32_32x32x16_bf16 v[104:119], v[44:47], v[180:183], v[104:119]
    ds_read_b64_tr_b16 v[40:41], v23 offset:20480
    ds_read_b64_tr_b16 v[42:43], v23 offset:22528
    s_waitcnt lgkmcnt(10)
    v_mfma_f32_32x32x16_bf16 v[88:103], v[48:51], v[184:187], v[88:103]
    ds_read_b64_tr_b16 v[44:45], v22 offset:21504
    ds_read_b64_tr_b16 v[46:47], v22 offset:23552
    s_waitcnt lgkmcnt(10)
    v_mfma_f32_32x32x16_bf16 v[104:119], v[52:55], v[184:187], v[104:119]
    ds_read_b64_tr_b16 v[48:49], v23 offset:21504
    ds_read_b64_tr_b16 v[50:51], v23 offset:23552
    s_waitcnt lgkmcnt(10)
    v_mfma_f32_32x32x16_bf16 v[88:103], v[28:31], v[188:191], v[88:103]
    ds_read_b64_tr_b16 v[52:53], v22 offset:24576
    ds_read_b64_tr_b16 v[54:55], v22 offset:26624
    s_waitcnt lgkmcnt(10)
    v_mfma_f32_32x32x16_bf16 v[104:119], v[32:35], v[188:191], v[104:119]
    ds_read_b64_tr_b16 v[28:29], v23 offset:24576
    ds_read_b64_tr_b16 v[30:31], v23 offset:26624
    s_waitcnt lgkmcnt(10)
    v_mfma_f32_32x32x16_bf16 v[88:103], v[36:39], v[192:195], v[88:103]
    ds_read_b64_tr_b16 v[32:33], v22 offset:25600
    ds_read_b64_tr_b16 v[34:35], v22 offset:27648
    s_waitcnt lgkmcnt(10)
    v_mfma_f32_32x32x16_bf16 v[104:119], v[40:43], v[192:195], v[104:119]
    ds_read_b64_tr_b16 v[36:37], v23 offset:25600
    ds_read_b64_tr_b16 v[38:39], v23 offset:27648
    s_waitcnt lgkmcnt(10)
    v_mfma_f32_32x32x16_bf16 v[88:103], v[44:47], v[196:199], v[88:103]
    ds_read_b64_tr_b16 v[40:41], v22 offset:28672
    ds_read_b64_tr_b16 v[42:43], v22 offset:30720
    s_waitcnt lgkmcnt(10)
    v_mfma_f32_32x32x16_bf16 v[104:119], v[48:51], v[196:199], v[104:119]
    ds_read_b64_tr_b16 v[44:45], v23 offset:28672
    ds_read_b64_tr_b16 v[46:47], v23 offset:30720
    s_waitcnt lgkmcnt(10)
    v_mfma_f32_32x32x16_bf16 v[88:103], v[52:55], v[200:203], v[88:103]
    ds_read_b64_tr_b16 v[48:49], v22 offset:29696
    ds_read_b64_tr_b16 v[50:51], v22 offset:31744
    s_waitcnt lgkmcnt(10)
    v_mfma_f32_32x32x16_bf16 v[104:119], v[28:31], v[200:203], v[104:119]
    ds_read_b64_tr_b16 v[52:53], v23 offset:29696
    ds_read_b64_tr_b16 v[54:55], v23 offset:31744
    s_waitcnt lgkmcnt(10)
    v_mfma_f32_32x32x16_bf16 v[88:103], v[32:35], v[204:207], v[88:103]
    ds_read_b64_tr_b16 v[28:29], v24 offset:32768
    ds_read_b64_tr_b16 v[30:31], v24 offset:34816
    s_waitcnt lgkmcnt(10)
    v_mfma_f32_32x32x16_bf16 v[104:119], v[36:39], v[204:207], v[104:119]
    ds_read_b64_tr_b16 v[32:33], v25 offset:32768
    ds_read_b64_tr_b16 v[34:35], v25 offset:34816
    s_waitcnt lgkmcnt(10)
    v_mfma_f32_32x32x16_bf16 v[88:103], v[40:43], v[208:211], v[88:103]
    ds_read_b64_tr_b16 v[36:37], v24 offset:33792
    ds_read_b64_tr_b16 v[38:39], v24 offset:35840
    s_waitcnt lgkmcnt(10)
    v_mfma_f32_32x32x16_bf16 v[104:119], v[44:47], v[208:211], v[104:119]
    ds_read_b64_tr_b16 v[40:41], v25 offset:33792
    ds_read_b64_tr_b16 v[42:43], v25 offset:35840
    s_waitcnt lgkmcnt(10)
    v_mfma_f32_32x32x16_bf16 v[88:103], v[48:51], v[212:215], v[88:103]
    ds_read_b64_tr_b16 v[44:45], v24 offset:36864
    ds_read_b64_tr_b16 v[46:47], v24 offset:38912
    s_waitcnt lgkmcnt(10)
    v_mfma_f32_32x32x16_bf16 v[104:119], v[52:55], v[212:215], v[104:119]
    ds_read_b64_tr_b16 v[48:49], v25 offset:36864
    ds_read_b64_tr_b16 v[50:51], v25 offset:38912
    s_barrier
    s_waitcnt lgkmcnt(10)
    v_mfma_f32_32x32x16_bf16 v[120:135], v[28:31], v[216:219], v[120:135]
    ds_read_b64_tr_b16 v[52:53], v24 offset:37888
    ds_read_b64_tr_b16 v[54:55], v24 offset:39936
    s_waitcnt lgkmcnt(10)
    v_mfma_f32_32x32x16_bf16 v[136:151], v[32:35], v[216:219], v[136:151]
    ds_read_b64_tr_b16 v[28:29], v25 offset:37888
    ds_read_b64_tr_b16 v[30:31], v25 offset:39936
    s_waitcnt lgkmcnt(10)
    v_mfma_f32_32x32x16_bf16 v[120:135], v[36:39], v[220:223], v[120:135]
    v_cvt_pk_bf16_f32 v88, v88, v89
    ds_read_b64_tr_b16 v[32:33], v24 offset:40960
    ds_read_b64_tr_b16 v[34:35], v24 offset:43008
L_PAD4:
    s_cbranch_execz L_RET4
    s_waitcnt lgkmcnt(10)
    v_mfma_f32_32x32x16_bf16 v[136:151], v[40:43], v[220:223], v[136:151]
    v_cvt_pk_bf16_f32 v89, v90, v91
    ds_read_b64_tr_b16 v[36:37], v25 offset:40960
    ds_read_b64_tr_b16 v[38:39], v25 offset:43008
    s_waitcnt lgkmcnt(10)
    v_mfma_f32_32x32x16_bf16 v[120:135], v[44:47], v[224:227], v[120:135]
    v_cvt_pk_bf16_f32 v90, v92, v93
    ds_read_b64_tr_b16 v[40:41], v24 offset:41984
    ds_read_b64_tr_b16 v[42:43], v24 offset:44032
    s_waitcnt lgkmcnt(10)
    v_mfma_f32_32x32x16_bf16 v[136:151], v[48:51], v[224:227], v[136:151]
    v_cvt_pk_bf16_f32 v91, v94, v95
    ds_read_b64_tr_b16 v[44:45], v25 offset:41984
    ds_read_b64_tr_b16 v[46:47], v25 offset:44032
    s_waitcnt lgkmcnt(10)
    v_mfma_f32_32x32x16_bf16 v[120:135], v[52:55], v[228:231], v[120:135]
    ds_write_b128 v0, v[88:91]
    ds_read_b64_tr_b16 v[48:49], v24 offset:45056
    ds_read_b64_tr_b16 v[50:51], v24 offset:47104
    s_waitcnt lgkmcnt(11)
    v_mfma_f32_32x32x16_bf16 v[136:151], v[28:31], v[228:231], v[136:151]
    v_cvt_pk_bf16_f32 v92, v96, v97
    ds_read_b64_tr_b16 v[52:53], v25 offset:45056
    ds_read_b64_tr_b16 v[54:55], v25 offset:47104
    s_waitcnt lgkmcnt(11)
    v_mfma_f32_32x32x16_bf16 v[120:135], v[32:35], v[232:235], v[120:135]
    v_cvt_pk_bf16_f32 v93, v98, v99
    ds_read_b64_tr_b16 v[28:29], v24 offset:46080
    ds_read_b64_tr_b16 v[30:31], v24 offset:48128
    s_waitcnt lgkmcnt(11)
    v_mfma_f32_32x32x16_bf16 v[136:151], v[36:39], v[232:235], v[136:151]
    v_cvt_pk_bf16_f32 v94, v100, v101
    ds_read_b64_tr_b16 v[32:33], v25 offset:46080
    ds_read_b64_tr_b16 v[34:35], v25 offset:48128
    s_waitcnt lgkmcnt(11)
    v_mfma_f32_32x32x16_bf16 v[120:135], v[40:43], v[236:239], v[120:135]
    v_cvt_pk_bf16_f32 v95, v102, v103
    ds_read_b64_tr_b16 v[36:37], v24
    ds_read_b64_tr_b16 v[38:39], v24 offset:2048
    s_waitcnt lgkmcnt(11)
    v_mfma_f32_32x32x16_bf16 v[136:151], v[44:47], v[236:239], v[136:151]
    ds_write_b128 v0, v[92:95] offset:1024
    ds_read_b64_tr_b16 v[40:41], v25
    ds_read_b64_tr_b16 v[42:43], v25 offset:2048
    s_waitcnt lgkmcnt(11)
    v_mfma_f32_32x32x16_bf16 v[120:135], v[48:51], v[240:243], v[120:135]
    v_cvt_pk_bf16_f32 v104, v104, v105
    ds_read_b64_tr_b16 v[44:45], v24 offset:1024
    ds_read_b64_tr_b16 v[46:47], v24 offset:3072
    s_waitcnt lgkmcnt(11)
    v_mfma_f32_32x32x16_bf16 v[136:151], v[52:55], v[240:243], v[136:151]
    v_cvt_pk_bf16_f32 v105, v106, v107
    ds_read_b64_tr_b16 v[48:49], v25 offset:1024
    ds_read_b64_tr_b16 v[50:51], v25 offset:3072
    s_waitcnt lgkmcnt(11)
    v_mfma_f32_32x32x16_bf16 v[120:135], v[28:31], v[244:247], v[120:135]
    v_cvt_pk_bf16_f32 v106, v108, v109
    ds_read_b64_tr_b16 v[52:53], v24 offset:4096
    ds_read_b64_tr_b16 v[54:55], v24 offset:6144
    s_waitcnt lgkmcnt(11)
    v_mfma_f32_32x32x16_bf16 v[136:151], v[32:35], v[244:247], v[136:151]
    v_cvt_pk_bf16_f32 v107, v110, v111
    ds_read_b64_tr_b16 v[28:29], v25 offset:4096
    ds_read_b64_tr_b16 v[30:31], v25 offset:6144
    s_waitcnt lgkmcnt(11)
    v_mfma_f32_32x32x16_bf16 v[120:135], v[36:39], v[152:155], v[120:135]
    ds_write_b128 v0, v[104:107] offset:8192
    ds_read_b64_tr_b16 v[32:33], v24 offset:5120
    ds_read_b64_tr_b16 v[34:35], v24 offset:7168
    s_waitcnt lgkmcnt(11)
    v_mfma_f32_32x32x16_bf16 v[136:151], v[40:43], v[152:155], v[136:151]
    v_cvt_pk_bf16_f32 v108, v112, v113
    ds_read_b64_tr_b16 v[36:37], v25 offset:5120
    ds_read_b64_tr_b16 v[38:39], v25 offset:7168
    s_waitcnt lgkmcnt(11)
    v_mfma_f32_32x32x16_bf16 v[120:135], v[44:47], v[156:159], v[120:135]
    v_cvt_pk_bf16_f32 v109, v114, v115
    ds_read_b64_tr_b16 v[40:41], v24 offset:8192
    ds_read_b64_tr_b16 v[42:43], v24 offset:10240
    s_waitcnt lgkmcnt(11)
    v_mfma_f32_32x32x16_bf16 v[136:151], v[48:51], v[156:159], v[136:151]
    v_cvt_pk_bf16_f32 v110, v116, v117
    ds_read_b64_tr_b16 v[44:45], v25 offset:8192
    ds_read_b64_tr_b16 v[46:47], v25 offset:10240
    s_waitcnt lgkmcnt(11)
    v_mfma_f32_32x32x16_bf16 v[120:135], v[52:55], v[160:163], v[120:135]
    v_cvt_pk_bf16_f32 v111, v118, v119
    ds_read_b64_tr_b16 v[48:49], v24 offset:9216
    ds_read_b64_tr_b16 v[50:51], v24 offset:11264
    s_waitcnt lgkmcnt(11)
    v_mfma_f32_32x32x16_bf16 v[136:151], v[28:31], v[160:163], v[136:151]
    ds_write_b128 v0, v[108:111] offset:9216
    ds_read_b64_tr_b16 v[52:53], v25 offset:9216
    ds_read_b64_tr_b16 v[54:55], v25 offset:11264
    s_waitcnt lgkmcnt(11)
    v_mfma_f32_32x32x16_bf16 v[120:135], v[32:35], v[164:167], v[120:135]
    ds_read_b64_tr_b16 v[28:29], v24 offset:12288
    ds_read_b64_tr_b16 v[30:31], v24 offset:14336
    s_waitcnt lgkmcnt(11)
    v_mfma_f32_32x32x16_bf16 v[136:151], v[36:39], v[164:167], v[136:151]
    ds_read_b64_tr_b16 v[32:33], v25 offset:12288
    ds_read_b64_tr_b16 v[34:35], v25 offset:14336
    s_waitcnt lgkmcnt(11)
    v_mfma_f32_32x32x16_bf16 v[120:135], v[40:43], v[168:171], v[120:135]
    ds_read_b64_tr_b16 v[36:37], v24 offset:13312
    ds_read_b64_tr_b16 v[38:39], v24 offset:15360
    s_waitcnt lgkmcnt(11)
    v_mfma_f32_32x32x16_bf16 v[136:151], v[44:47], v[168:171], v[136:151]
    ds_read_b64_tr_b16 v[40:41], v25 offset:13312
    ds_read_b64_tr_b16 v[42:43], v25 offset:15360
    s_waitcnt lgkmcnt(11)
    v_mfma_f32_32x32x16_bf16 v[120:135], v[48:51], v[172:175], v[120:135]
    ds_read_b64_tr_b16 v[44:45], v24 offset:16384
    ds_read_b64_tr_b16 v[46:47], v24 offset:18432
    s_waitcnt lgkmcnt(10)
    v_mfma_f32_32x32x16_bf16 v[136:151], v[52:55], v[172:175], v[136:151]
    ds_read_b64_tr_b16 v[48:49], v25 offset:16384
    ds_read_b64_tr_b16 v[50:51], v25 offset:18432
    s_waitcnt lgkmcnt(10)
    v_mfma_f32_32x32x16_bf16 v[120:135], v[28:31], v[176:179], v[120:135]
    ds_read_b64_tr_b16 v[52:53], v24 offset:17408
    ds_read_b64_tr_b16 v[54:55], v24 offset:19456
    s_waitcnt lgkmcnt(10)
    v_mfma_f32_32x32x16_bf16 v[136:151], v[32:35], v[176:179], v[136:151]
    ds_read_b64_tr_b16 v[28:29], v25 offset:17408
    ds_read_b64_tr_b16 v[30:31], v25 offset:19456
    s_waitcnt lgkmcnt(10)
    v_mfma_f32_32x32x16_bf16 v[120:135], v[36:39], v[180:183], v[120:135]
    ds_read_b64_tr_b16 v[32:33], v24 offset:20480
    ds_read_b64_tr_b16 v[34:35], v24 offset:22528
    s_waitcnt lgkmcnt(10)
    v_mfma_f32_32x32x16_bf16 v[136:151], v[40:43], v[180:183], v[136:151]
    ds_read_b64_tr_b16 v[36:37], v25 offset:20480
    ds_read_b64_tr_b16 v[38:39], v25 offset:22528
    s_waitcnt lgkmcnt(10)
    v_mfma_f32_32x32x16_bf16 v[120:135], v[44:47], v[184:187], v[120:135]
    ds_read_b64_tr_b16 v[40:41], v24 offset:21504
    ds_read_b64_tr_b16 v[42:43], v24 offset:23552
    s_waitcnt lgkmcnt(10)
    v_mfma_f32_32x32x16_bf16 v[136:151], v[48:51], v[184:187], v[136:151]
    ds_read_b64_tr_b16 v[44:45], v25 offset:21504
    ds_read_b64_tr_b16 v[46:47], v25 offset:23552
    s_waitcnt lgkmcnt(10)
    v_mfma_f32_32x32x16_bf16 v[120:135], v[52:55], v[188:191], v[120:135]
    ds_read_b64_tr_b16 v[48:49], v24 offset:24576
    ds_read_b64_tr_b16 v[50:51], v24 offset:26624
    s_waitcnt lgkmcnt(10)
    v_mfma_f32_32x32x16_bf16 v[136:151], v[28:31], v[188:191], v[136:151]
    ds_read_b64_tr_b16 v[52:53], v25 offset:24576
    ds_read_b64_tr_b16 v[54:55], v25 offset:26624
    s_waitcnt lgkmcnt(10)
    v_mfma_f32_32x32x16_bf16 v[120:135], v[32:35], v[192:195], v[120:135]
    ds_read_b64_tr_b16 v[28:29], v24 offset:25600
    ds_read_b64_tr_b16 v[30:31], v24 offset:27648
    s_waitcnt lgkmcnt(10)
    v_mfma_f32_32x32x16_bf16 v[136:151], v[36:39], v[192:195], v[136:151]
    ds_read_b64_tr_b16 v[32:33], v25 offset:25600
    ds_read_b64_tr_b16 v[34:35], v25 offset:27648
    s_waitcnt lgkmcnt(10)
    v_mfma_f32_32x32x16_bf16 v[120:135], v[40:43], v[196:199], v[120:135]
    ds_read_b64_tr_b16 v[36:37], v24 offset:28672
    ds_read_b64_tr_b16 v[38:39], v24 offset:30720
    s_waitcnt lgkmcnt(10)
    v_mfma_f32_32x32x16_bf16 v[136:151], v[44:47], v[196:199], v[136:151]
    ds_read_b64_tr_b16 v[40:41], v25 offset:28672
    ds_read_b64_tr_b16 v[42:43], v25 offset:30720
    s_waitcnt lgkmcnt(10)
    v_mfma_f32_32x32x16_bf16 v[120:135], v[48:51], v[200:203], v[120:135]
    ds_read_b64_tr_b16 v[44:45], v25 offset:29696
    ds_read_b64_tr_b16 v[46:47], v25 offset:31744
    s_waitcnt lgkmcnt(10)
    v_mfma_f32_32x32x16_bf16 v[136:151], v[52:55], v[200:203], v[136:151]
    ds_read_b64_tr_b16 v[48:49], v24 offset:29696
    ds_read_b64_tr_b16 v[50:51], v24 offset:31744
    s_waitcnt lgkmcnt(10)
    v_mfma_f32_32x32x16_bf16 v[120:135], v[28:31], v[204:207], v[120:135]
    s_waitcnt lgkmcnt(8)
    v_mfma_f32_32x32x16_bf16 v[136:151], v[32:35], v[204:207], v[136:151]
    s_waitcnt lgkmcnt(6)
    v_mfma_f32_32x32x16_bf16 v[120:135], v[36:39], v[208:211], v[120:135]
    s_waitcnt lgkmcnt(4)
    v_mfma_f32_32x32x16_bf16 v[136:151], v[40:43], v[208:211], v[136:151]
    s_waitcnt lgkmcnt(2)
    v_mfma_f32_32x32x16_bf16 v[136:151], v[44:47], v[212:215], v[136:151]
    s_waitcnt lgkmcnt(0)
    v_mfma_f32_32x32x16_bf16 v[120:135], v[48:51], v[212:215], v[120:135]
    s_lshl_b32 s96, s77, 11
    s_add_u32 s14, s96, 151552
    v_add_u32 v0, s14, v2
    v_bfe_u32 v4, v1, 2, 2
    v_lshlrev_b32 v4, 6, v4
    v_bfe_u32 v9, v1, 4, 1
    v_lshl_add_u32 v4, v9, 5, v4
    v_and_b32 v9, 3, v1
    v_lshl_add_u32 v4, v9, 3, v4
    v_lshrrev_b32 v9, 5, v1
    v_lshl_add_u32 v4, v9, 8, v4
    v_add_u32 v4, 159744, v4
    ds_read_b64_tr_b16 v[176:177], v4
    ds_read_b64_tr_b16 v[178:179], v4 offset:512
    ds_read_b64_tr_b16 v[180:181], v4 offset:1024
    ds_read_b64_tr_b16 v[182:183], v4 offset:1536
    v_cvt_pk_bf16_f32 v152, v136, v137
    v_cvt_pk_bf16_f32 v153, v138, v139
    v_cvt_pk_bf16_f32 v154, v140, v141
    v_cvt_pk_bf16_f32 v155, v142, v143
    v_cvt_pk_bf16_f32 v156, v144, v145
    v_cvt_pk_bf16_f32 v157, v146, v147
    v_cvt_pk_bf16_f32 v158, v148, v149
    v_cvt_pk_bf16_f32 v159, v150, v151
    ds_write_b128 v0, v[152:155]
    ds_write_b128 v0, v[156:159] offset:1024
    v_cvt_pk_bf16_f32 v168, v120, v121
    v_cvt_pk_bf16_f32 v169, v122, v123
    v_cvt_pk_bf16_f32 v170, v124, v125
    v_cvt_pk_bf16_f32 v171, v126, v127
    v_cvt_pk_bf16_f32 v172, v128, v129
    v_cvt_pk_bf16_f32 v173, v130, v131
    v_cvt_pk_bf16_f32 v174, v132, v133
    v_cvt_pk_bf16_f32 v175, v134, v135
    s_setprio 0
    s_branch L_JOIN
L_HELP:
    s_waitcnt vmcnt(0)
    s_barrier
    s_add_u32 s96, s84, 4
    s_and_b32 s97, s96, 15
    s_mul_i32 s98, s97, 393216
    s_add_u32 s99, s98, s85
    s_add_u32 s82, s99, 4294772736
    s_add_u32 m0, s83, 28672
    s_nop 0
    buffer_load_dwordx4 v3, s[40:43], s82 offen lds
    s_add_u32 s96, s84, 4
    s_and_b32 s97, s96, 15
    s_mul_i32 s98, s97, 393216
    s_add_u32 s99, s98, s85
    s_add_u32 s82, s99, 2048
    s_add_u32 m0, s83, 32768
    s_nop 0
    buffer_load_dwordx4 v3, s[40:43], s82 offen lds
    s_add_u32 s96, s84, 4
    s_and_b32 s97, s96, 15
    s_mul_i32 s98, s97, 393216
    s_add_u32 s99, s98, s85
    s_add_u32 s82, s99, 4294774784
    s_add_u32 m0, s83, 77824
    s_nop 0
    buffer_load_dwordx4 v3, s[40:43], s82 offen lds
    s_add_u32 s96, s84, 4
    s_and_b32 s97, s96, 15
    s_mul_i32 s98, s97, 393216
    s_add_u32 s99, s98, s85
    s_add_u32 s82, s99, 4096
    s_add_u32 m0, s83, 81920
    s_nop 0
    buffer_load_dwordx4 v3, s[40:43], s82 offen lds
    s_add_u32 s96, s84, 4
    s_and_b32 s97, s96, 15
    s_mul_i32 s98, s97, 393216
    s_add_u32 s99, s98, s85
    s_add_u32 s82, s99, 4294770688
    s_add_u32 m0, s83, 126976
    s_nop 0
    buffer_load_dwordx4 v3, s[40:43], s82 offen lds
    s_add_u32 s96, s84, 4
    s_and_b32 s97, s96, 15
    s_mul_i32 s98, s97, 393216
    s_add_u32 s82, s98, s85
    s_add_u32 m0, s83, 131072
    s_nop 0
    buffer_load_dwordx4 v3, s[40:43], s82 offen lds
    s_add_u32 s96, s84, 5
    s_and_b32 s97, s96, 15
    s_mul_i32 s98, s97, 393216
    s_add_u32 s99, s98, s85
    s_add_u32 s82, s99, 4294772736
    s_add_u32 m0, s83, 36864
    s_nop 0
    buffer_load_dwordx4 v3, s[40:43], s82 offen lds
    s_add_u32 s96, s84, 5
    s_and_b32 s97, s96, 15
    s_mul_i32 s98, s97, 393216
    s_add_u32 s99, s98, s85
    s_add_u32 s82, s99, 2048
    s_add_u32 m0, s83, 40960
    s_nop 0
    buffer_load_dwordx4 v3, s[40:43], s82 offen lds
    s_add_u32 s96, s84, 5
    s_and_b32 s97, s96, 15
    s_mul_i32 s98, s97, 393216
    s_add_u32 s99, s98, s85
    s_add_u32 s82, s99, 4294774784
    s_add_u32 m0, s83, 86016
    s_nop 0
    buffer_load_dwordx4 v3, s[40:43], s82 offen lds
    s_add_u32 s96, s84, 5
    s_and_b32 s97, s96, 15
    s_mul_i32 s98, s97, 393216
    s_add_u32 s99, s98, s85
    s_add_u32 s82, s99, 4096
    s_add_u32 m0, s83, 90112
    s_nop 0
    buffer_load_dwordx4 v3, s[40:43], s82 offen lds
    s_add_u32 s96, s84, 5
    s_and_b32 s97, s96, 15
    s_mul_i32 s98, s97, 393216
    s_add_u32 s99, s98, s85
    s_add_u32 s82, s99, 4294770688
    s_add_u32 m0, s83, 135168
    s_nop 0
    buffer_load_dwordx4 v3, s[40:43], s82 offen lds
    s_add_u32 s96, s84, 5
    s_and_b32 s97, s96, 15
    s_mul_i32 s98, s97, 393216
    s_add_u32 s82, s98, s85
    s_add_u32 m0, s83, 139264
    s_nop 0
    buffer_load_dwordx4 v3, s[40:43], s82 offen lds
    s_waitcnt lgkmcnt(0)
SPOLL_16:
    s_load_dwordx2 s[24:25], s[32:33], s19 offset:0 glc
    s_load_dwordx2 s[26:27], s[32:33], s19 offset:64 glc
SCHK_17:
    s_add_u32 s5, s5, 1
    s_cmp_ge_u32 s5, 200000
    s_waitcnt lgkmcnt(0)
    s_cbranch_scc1 SDONE_18
    s_cmp_lg_u32 s24, s4
    s_cbranch_scc1 SPOLL_16
    s_cmp_lg_u32 s25, s4
    s_cbranch_scc1 SPOLL_16
    s_cmp_lg_u32 s26, s4
    s_cbranch_scc1 SPOLL_16
    s_cmp_lg_u32 s27, s4
    s_cbranch_scc1 SPOLL_16
SDONE_18:
    v_bfe_u32 v4, v1, 2, 2
    v_lshlrev_b32 v4, 6, v4
    v_bfe_u32 v9, v1, 4, 1
    v_lshl_add_u32 v4, v9, 5, v4
    v_and_b32 v9, 3, v1
    v_lshl_add_u32 v4, v9, 3, v4
    v_lshrrev_b32 v9, 5, v1
    v_lshl_add_u32 v4, v9, 8, v4
    v_add_u32 v4, 159744, v4
    ds_read_b64_tr_b16 v[168:169], v4
    ds_read_b64_tr_b16 v[170:171], v4 offset:512
    ds_read_b64_tr_b16 v[172:173], v4 offset:1024
    ds_read_b64_tr_b16 v[174:175], v4 offset:1536
    ds_read_b64_tr_b16 v[176:177], v4 offset:2048
    ds_read_b64_tr_b16 v[178:179], v4 offset:2560
    ds_read_b64_tr_b16 v[180:181], v4 offset:3072
    ds_read_b64_tr_b16 v[182:183], v4 offset:3584
    s_lshl_b32 s14, s77, 10
    v_and_b32 v232, 7, v1
    v_lshl_add_u32 v232, v232, 4, s14
    v_bfe_u32 v9, v1, 3, 2
    v_lshl_add_u32 v232, v9, 8, v232
    v_lshrrev_b32 v9, 5, v1
    v_lshl_add_u32 v232, v9, 7, v232
    s_and_b32 s96, s9, 1
    s_lshl1_add_u32 s18, s96, 1
    s_and_b32 s96, s8, 3
    s_lshl2_add_u32 s97, s96, s3
    s_sub_u32 s98, s97, 4
    s_lshl_b32 s82, s98, 7
    v_lshrrev_b32 v52, 3, v1
    v_lshl_add_u32 v52, v52, 1, s82
    global_load_ushort v36, v52, s[86:87] offset:0
    global_load_ushort v37, v52, s[86:87] offset:16
    global_load_ushort v38, v52, s[86:87] offset:32
    global_load_ushort v39, v52, s[86:87] offset:48
    global_load_ushort v40, v52, s[86:87] offset:64
    global_load_ushort v41, v52, s[86:87] offset:80
    global_load_ushort v42, v52, s[86:87] offset:96
    global_load_ushort v43, v52, s[86:87] offset:112
    s_and_b32 s96, s8, 3
    s_lshl2_add_u32 s97, s96, s3
    s_sub_u32 s98, s97, 4
    s_mul_i32 s99, s98, 786432
    s_lshr_b32 s96, s8, 2
    s_lshl1_add_u32 s97, s9, s96
    s_lshl_b32 s98, s97, 7
    s_add_u32 s96, s99, s98
    s_add_u32 s19, s96, 4096
    s_barrier
    s_add_u32 s96, s84, 6
    s_and_b32 s97, s96, 15
    s_mul_i32 s98, s97, 393216
    s_add_u32 s99, s98, s85
    s_add_u32 s82, s99, 4294772736
    s_add_u32 m0, s83, 4294963200
    s_nop 0
    buffer_load_dwordx4 v3, s[40:43], s82 offen lds
    s_add_u32 s96, s84, 6
    s_and_b32 s97, s96, 15
    s_mul_i32 s98, s97, 393216
    s_add_u32 s99, s98, s85
    s_add_u32 s82, s99, 2048
    s_mov_b32 m0, s83
    s_nop 0
    buffer_load_dwordx4 v3, s[40:43], s82 offen lds
    s_add_u32 s96, s84, 6
    s_and_b32 s97, s96, 15
    s_mul_i32 s98, s97, 393216
    s_add_u32 s99, s98, s85
    s_add_u32 s82, s99, 4294770688
    s_add_u32 m0, s83, 94208
    s_nop 0
    buffer_load_dwordx4 v3, s[40:43], s82 offen lds
    s_add_u32 s96, s84, 6
    s_and_b32 s97, s96, 15
    s_mul_i32 s98, s97, 393216
    s_add_u32 s82, s98, s85
    s_add_u32 m0, s83, 98304
    s_nop 0
    buffer_load_dwordx4 v3, s[40:43], s82 offen lds
    s_add_u32 s96, s84, 6
    s_and_b32 s97, s96, 15
    s_mul_i32 s98, s97, 393216
    s_add_u32 s99, s98, s85
    s_add_u32 s82, s99, 4294774784
    s_add_u32 m0, s83, 45056
    s_nop 0
    buffer_load_dwordx4 v3, s[40:43], s82 offen lds
    s_add_u32 s96, s84, 6
    s_and_b32 s97, s96, 15
    s_mul_i32 s98, s97, 393216
    s_add_u32 s99, s98, s85
    s_add_u32 s82, s99, 4096
    s_add_u32 m0, s83, 49152
    s_nop 0
    buffer_load_dwordx4 v3, s[40:43], s82 offen lds
    s_waitcnt lgkmcnt(0)
    s_load_dword s24, s[32:33], s92 offset:512 glc
    s_load_dword s25, s[32:33], s92 offset:256 glc
    s_load_dword s26, s[32:33], s92 offset:3584 glc
    s_load_dword s27, s[32:33], s92 offset:3328 glc
    s_barrier
    s_add_u32 s96, s84, 7
    s_and_b32 s97, s96, 15
    s_mul_i32 s98, s97, 393216
    s_add_u32 s99, s98, s85
    s_add_u32 s82, s99, 4294772736
    s_add_u32 m0, s83, 4096
    s_nop 0
    buffer_load_dwordx4 v3, s[40:43], s82 offen lds
    s_add_u32 s96, s84, 7
    s_and_b32 s97, s96, 15
    s_mul_i32 s98, s97, 393216
    s_add_u32 s99, s98, s85
    s_add_u32 s82, s99, 2048
    s_add_u32 m0, s83, 8192
    s_nop 0
    buffer_load_dwordx4 v3, s[40:43], s82 offen lds
    s_add_u32 s96, s84, 7
    s_and_b32 s97, s96, 15
    s_mul_i32 s98, s97, 393216
    s_add_u32 s99, s98, s85
    s_add_u32 s82, s99, 4294770688
    s_add_u32 m0, s83, 102400
    s_nop 0
    buffer_load_dwordx4 v3, s[40:43], s82 offen lds
    s_add_u32 s96, s84, 7
    s_and_b32 s97, s96, 15
    s_mul_i32 s98, s97, 393216
    s_add_u32 s82, s98, s85
    s_add_u32 m0, s83, 106496
    s_nop 0
    buffer_load_dwordx4 v3, s[40:43], s82 offen lds
    s_add_u32 s96, s84, 7
    s_and_b32 s97, s96, 15
    s_mul_i32 s98, s97, 393216
    s_add_u32 s99, s98, s85
    s_add_u32 s82, s99, 4294774784
    s_add_u32 m0, s83, 53248
    s_nop 0
    buffer_load_dwordx4 v3, s[40:43], s82 offen lds
    s_add_u32 s96, s84, 7
    s_and_b32 s97, s96, 15
    s_mul_i32 s98, s97, 393216
    s_add_u32 s99, s98, s85
    s_add_u32 s82, s99, 4096
    s_add_u32 m0, s83, 57344
    s_nop 0
    buffer_load_dwordx4 v3, s[40:43], s82 offen lds
    s_waitcnt vmcnt(30)
    s_waitcnt vmcnt(26)
    s_barrier
    s_add_u32 s96, s84, 8
    s_and_b32 s97, s96, 15
    s_mul_i32 s98, s97, 393216
    s_add_u32 s99, s98, s85
    s_add_u32 s82, s99, 4294772736
    s_add_u32 m0, s83, 12288
    s_nop 0
    buffer_load_dwordx4 v3, s[40:43], s82 offen lds
    s_add_u32 s96, s84, 8
    s_and_b32 s97, s96, 15
    s_mul_i32 s98, s97, 393216
    s_add_u32 s99, s98, s85
    s_add_u32 s82, s99, 2048
    s_add_u32 m0, s83, 16384
    s_nop 0
    buffer_load_dwordx4 v3, s[40:43], s82 offen lds
    s_add_u32 s96, s84, 8
    s_and_b32 s97, s96, 15
    s_mul_i32 s98, s97, 393216
    s_add_u32 s99, s98, s85
    s_add_u32 s82, s99, 4294770688
    s_add_u32 m0, s83, 110592
    s_nop 0
    buffer_load_dwordx4 v3, s[40:43], s82 offen lds
    s_add_u32 s96, s84, 8
    s_and_b32 s97, s96, 15
    s_mul_i32 s98, s97, 393216
    s_add_u32 s82, s98, s85
    s_add_u32 m0, s83, 114688
    s_nop 0
    buffer_load_dwordx4 v3, s[40:43], s82 offen lds
    s_add_u32 s96, s84, 8
    s_and_b32 s97, s96, 15
    s_mul_i32 s98, s97, 393216
    s_add_u32 s99, s98, s85
    s_add_u32 s82, s99, 4294774784
    s_add_u32 m0, s83, 61440
    s_nop 0
    buffer_load_dwordx4 v3, s[40:43], s82 offen lds
    s_add_u32 s96, s84, 8
    s_and_b32 s97, s96, 15
    s_mul_i32 s98, s97, 393216
    s_add_u32 s99, s98, s85
    s_add_u32 s82, s99, 4096
    s_add_u32 m0, s83, 65536
    s_nop 0
    buffer_load_dwordx4 v3, s[40:43], s82 offen lds
    s_waitcnt vmcnt(18)
    v_lshlrev_b32 v36, 16, v36
    v_mul_f32 v52, s7, v36
    v_exp_f32 v52, -v52
    s_nop 0
    v_add_f32 v52, 1.0, v52
    v_rcp_f32 v52, v52
    s_nop 0
    v_mul_f32 v36, v36, v52
    v_cvt_pk_bf16_f32 v36, 0, v36
    v_lshlrev_b32 v37, 16, v37
    v_mul_f32 v53, s7, v37
    v_exp_f32 v53, -v53
    s_nop 0
    v_add_f32 v53, 1.0, v53
    v_rcp_f32 v53, v53
    s_nop 0
    v_mul_f32 v37, v37, v53
    v_cvt_pk_bf16_f32 v37, 0, v37
    v_lshlrev_b32 v38, 16, v38
    v_mul_f32 v52, s7, v38
    v_exp_f32 v52, -v52
    s_nop 0
    v_add_f32 v52, 1.0, v52
    v_rcp_f32 v52, v52
    s_nop 0
    v_mul_f32 v38, v38, v52
    v_cvt_pk_bf16_f32 v38, 0, v38
    v_lshlrev_b32 v39, 16, v39
    v_mul_f32 v53, s7, v39
    v_exp_f32 v53, -v53
    s_nop 0
    v_add_f32 v53, 1.0, v53
    v_rcp_f32 v53, v53
    s_nop 0
    v_mul_f32 v39, v39, v53
    v_cvt_pk_bf16_f32 v39, 0, v39
    v_lshlrev_b32 v40, 16, v40
    v_mul_f32 v52, s7, v40
    v_exp_f32 v52, -v52
    s_nop 0
    v_add_f32 v52, 1.0, v52
    v_rcp_f32 v52, v52
    s_nop 0
    v_mul_f32 v40, v40, v52
    v_cvt_pk_bf16_f32 v40, 0, v40
    v_lshlrev_b32 v41, 16, v41
    v_mul_f32 v53, s7, v41
    v_exp_f32 v53, -v53
    s_nop 0
    v_add_f32 v53, 1.0, v53
    v_rcp_f32 v53, v53
    s_nop 0
    v_mul_f32 v41, v41, v53
    v_cvt_pk_bf16_f32 v41, 0, v41
    v_lshlrev_b32 v42, 16, v42
    v_mul_f32 v52, s7, v42
    v_exp_f32 v52, -v52
    s_nop 0
    v_add_f32 v52, 1.0, v52
    v_rcp_f32 v52, v52
    s_nop 0
    v_mul_f32 v42, v42, v52
    v_cvt_pk_bf16_f32 v42, 0, v42
    v_lshlrev_b32 v43, 16, v43
    v_mul_f32 v53, s7, v43
    v_exp_f32 v53, -v53
    s_nop 0
    v_add_f32 v53, 1.0, v53
    v_rcp_f32 v53, v53
    s_nop 0
    v_mul_f32 v43, v43, v53
    v_cvt_pk_bf16_f32 v43, 0, v43
    s_waitcnt lgkmcnt(0)
    s_load_dword s24, s[32:33], s92 offset:1024 glc
    s_load_dword s25, s[32:33], s92 offset:768 glc
    s_load_dword s26, s[32:33], s92 offset:1536 glc
    s_load_dword s27, s[32:33], s92 offset:1280 glc
    s_barrier
    s_add_u32 s96, s84, 9
    s_and_b32 s97, s96, 15
    s_mul_i32 s98, s97, 393216
    s_add_u32 s99, s98, s85
    s_add_u32 s82, s99, 4294772736
    s_add_u32 m0, s83, 20480
    s_nop 0
    buffer_load_dwordx4 v3, s[40:43], s82 offen lds
    s_add_u32 s96, s84, 9
    s_and_b32 s97, s96, 15
    s_mul_i32 s98, s97, 393216
    s_add_u32 s99, s98, s85
    s_add_u32 s82, s99, 2048
    s_add_u32 m0, s83, 24576
    s_nop 0
    buffer_load_dwordx4 v3, s[40:43], s82 offen lds
    s_add_u32 s96, s84, 9
    s_and_b32 s97, s96, 15
    s_mul_i32 s98, s97, 393216
    s_add_u32 s99, s98, s85
    s_add_u32 s82, s99, 4294770688
    s_add_u32 m0, s83, 118784
    s_nop 0
    buffer_load_dwordx4 v3, s[40:43], s82 offen lds
    s_add_u32 s96, s84, 9
    s_and_b32 s97, s96, 15
    s_mul_i32 s98, s97, 393216
    s_add_u32 s82, s98, s85
    s_add_u32 m0, s83, 122880
    s_nop 0
    buffer_load_dwordx4 v3, s[40:43], s82 offen lds
    s_add_u32 s96, s84, 9
    s_and_b32 s97, s96, 15
    s_mul_i32 s98, s97, 393216
    s_add_u32 s99, s98, s85
    s_add_u32 s82, s99, 4294774784
    s_add_u32 m0, s83, 69632
    s_nop 0
    buffer_load_dwordx4 v3, s[40:43], s82 offen lds
    s_add_u32 s96, s84, 9
    s_and_b32 s97, s96, 15
    s_mul_i32 s98, s97, 393216
    s_add_u32 s99, s98, s85
    s_add_u32 s82, s99, 4096
    s_add_u32 m0, s83, 73728
    s_nop 0
    buffer_load_dwordx4 v3, s[40:43], s82 offen lds
L_PAD5:
    s_cbranch_execz L_RET5
    s_waitcnt vmcnt(22)
    s_waitcnt vmcnt(20)
    s_waitcnt vmcnt(18)
    s_barrier
    s_add_u32 s96, s84, 10
    s_and_b32 s97, s96, 15
    s_mul_i32 s98, s97, 393216
    s_add_u32 s99, s98, s85
    s_add_u32 s82, s99, 4294772736
    s_add_u32 m0, s83, 28672
    s_nop 0
    buffer_load_dwordx4 v3, s[40:43], s82 offen lds
    s_add_u32 s96, s84, 10
    s_and_b32 s97, s96, 15
    s_mul_i32 s98, s97, 393216
    s_add_u32 s99, s98, s85
    s_add_u32 s82, s99, 2048
    s_add_u32 m0, s83, 32768
    s_nop 0
    buffer_load_dwordx4 v3, s[40:43], s82 offen lds
    s_add_u32 s96, s84, 10
    s_and_b32 s97, s96, 15
    s_mul_i32 s98, s97, 393216
    s_add_u32 s99, s98, s85
    s_add_u32 s82, s99, 4294774784
    s_add_u32 m0, s83, 77824
    s_nop 0
    buffer_load_dwordx4 v3, s[40:43], s82 offen lds
    s_add_u32 s96, s84, 10
    s_and_b32 s97, s96, 15
    s_mul_i32 s98, s97, 393216
    s_add_u32 s99, s98, s85
    s_add_u32 s82, s99, 4096
    s_add_u32 m0, s83, 81920
    s_nop 0
    buffer_load_dwordx4 v3, s[40:43], s82 offen lds
    s_waitcnt lgkmcnt(0)
    s_load_dword s24, s[32:33], s92 offset:2560 glc
    s_load_dword s25, s[32:33], s92 offset:2304 glc
    s_load_dword s26, s[32:33], s92 offset:3072 glc
    s_load_dword s27, s[32:33], s92 offset:2816 glc
    s_waitcnt vmcnt(20)
    s_waitcnt vmcnt(18)
    s_waitcnt vmcnt(16)
    s_barrier
    s_add_u32 s96, s84, 11
    s_and_b32 s97, s96, 15
    s_mul_i32 s98, s97, 393216
    s_add_u32 s99, s98, s85
    s_add_u32 s82, s99, 4294772736
    s_add_u32 m0, s83, 36864
    s_nop 0
    buffer_load_dwordx4 v3, s[40:43], s82 offen lds
    s_add_u32 s96, s84, 11
    s_and_b32 s97, s96, 15
    s_mul_i32 s98, s97, 393216
    s_add_u32 s99, s98, s85
    s_add_u32 s82, s99, 2048
    s_add_u32 m0, s83, 40960
    s_nop 0
    buffer_load_dwordx4 v3, s[40:43], s82 offen lds
    s_add_u32 s96, s84, 11
    s_and_b32 s97, s96, 15
    s_mul_i32 s98, s97, 393216
    s_add_u32 s99, s98, s85
    s_add_u32 s82, s99, 4294774784
    s_add_u32 m0, s83, 86016
    s_nop 0
    buffer_load_dwordx4 v3, s[40:43], s82 offen lds
    s_add_u32 s96, s84, 11
    s_and_b32 s97, s96, 15
    s_mul_i32 s98, s97, 393216
    s_add_u32 s99, s98, s85
    s_add_u32 s82, s99, 4096
    s_add_u32 m0, s83, 90112
    s_nop 0
    buffer_load_dwordx4 v3, s[40:43], s82 offen lds
    s_waitcnt vmcnt(18)
    s_waitcnt vmcnt(16)
    s_waitcnt vmcnt(14)
    s_barrier
    s_add_u32 s96, s84, 12
    s_and_b32 s97, s96, 15
    s_mul_i32 s98, s97, 393216
    s_add_u32 s99, s98, s85
    s_add_u32 s82, s99, 4294772736
    s_add_u32 m0, s83, 4294963200
    s_nop 0
    buffer_load_dwordx4 v3, s[40:43], s82 offen lds
    s_add_u32 s96, s84, 12
    s_and_b32 s97, s96, 15
    s_mul_i32 s98, s97, 393216
    s_add_u32 s99, s98, s85
    s_add_u32 s82, s99, 2048
    s_mov_b32 m0, s83
    s_nop 0
    buffer_load_dwordx4 v3, s[40:43], s82 offen lds
    s_add_u32 s96, s84, 12
    s_and_b32 s97, s96, 15
    s_mul_i32 s98, s97, 393216
    s_add_u32 s99, s98, s85
    s_add_u32 s82, s99, 4294774784
    s_add_u32 m0, s83, 45056
    s_nop 0
    buffer_load_dwordx4 v3, s[40:43], s82 offen lds
    s_add_u32 s96, s84, 12
    s_and_b32 s97, s96, 15
    s_mul_i32 s98, s97, 393216
    s_add_u32 s99, s98, s85
    s_add_u32 s82, s99, 4096
    s_add_u32 m0, s83, 49152
    s_nop 0
    buffer_load_dwordx4 v3, s[40:43], s82 offen lds
    s_waitcnt vmcnt(16)
    s_barrier
    s_add_u32 s96, s84, 13
    s_and_b32 s97, s96, 15
    s_mul_i32 s98, s97, 393216
    s_add_u32 s99, s98, s85
    s_add_u32 s82, s99, 4294772736
    s_add_u32 m0, s83, 4096
    s_nop 0
    buffer_load_dwordx4 v3, s[40:43], s82 offen lds
    s_add_u32 s96, s84, 13
    s_and_b32 s97, s96, 15
    s_mul_i32 s98, s97, 393216
    s_add_u32 s99, s98, s85
    s_add_u32 s82, s99, 2048
    s_add_u32 m0, s83, 8192
    s_nop 0
    buffer_load_dwordx4 v3, s[40:43], s82 offen lds
    s_add_u32 s96, s84, 13
    s_and_b32 s97, s96, 15
    s_mul_i32 s98, s97, 393216
    s_add_u32 s99, s98, s85
    s_add_u32 s82, s99, 4294774784
    s_add_u32 m0, s83, 53248
    s_nop 0
    buffer_load_dwordx4 v3, s[40:43], s82 offen lds
    s_add_u32 s96, s84, 13
    s_and_b32 s97, s96, 15
    s_mul_i32 s98, s97, 393216
    s_add_u32 s99, s98, s85
    s_add_u32 s82, s99, 4096
    s_add_u32 m0, s83, 57344
    s_nop 0
    buffer_load_dwordx4 v3, s[40:43], s82 offen lds
    s_lshl_b32 s96, s74, 13
    s_sub_u32 s97, s3, 4
    s_lshl_b32 s98, s97, 8
    s_add_u32 s99, s96, s98
    s_add_u32 s13, s99, 20971520
    s_waitcnt lgkmcnt(0)
    s_load_dword s24, s[32:33], s13 offset:1276 glc
    s_load_dword s25, s[32:33], s13 offset:3324 glc
    s_load_dword s26, s[32:33], s13 offset:5372 glc
    s_load_dword s27, s[32:33], s13 offset:7420 glc
    s_waitcnt vmcnt(18)
    s_waitcnt vmcnt(16)
    s_barrier
    s_add_u32 s96, s84, 14
    s_and_b32 s97, s96, 15
    s_mul_i32 s98, s97, 393216
    s_add_u32 s99, s98, s85
    s_add_u32 s82, s99, 4294772736
    s_add_u32 m0, s83, 12288
    s_nop 0
    buffer_load_dwordx4 v3, s[40:43], s82 offen lds
    s_add_u32 s96, s84, 14
    s_and_b32 s97, s96, 15
    s_mul_i32 s98, s97, 393216
    s_add_u32 s99, s98, s85
    s_add_u32 s82, s99, 2048
    s_add_u32 m0, s83, 16384
    s_nop 0
    buffer_load_dwordx4 v3, s[40:43], s82 offen lds
    s_add_u32 s96, s84, 10
    s_and_b32 s97, s96, 15
    s_mul_i32 s98, s97, 393216
    s_add_u32 s99, s98, s85
    s_add_u32 s82, s99, 4294770688
    s_add_u32 m0, s83, 126976
    s_nop 0
    buffer_load_dwordx4 v3, s[40:43], s82 offen lds
    s_add_u32 s96, s84, 10
    s_and_b32 s97, s96, 15
    s_mul_i32 s98, s97, 393216
    s_add_u32 s82, s98, s85
    s_add_u32 m0, s83, 131072
    s_nop 0
    buffer_load_dwordx4 v3, s[40:43], s82 offen lds
    s_waitcnt vmcnt(18)
    s_waitcnt vmcnt(14)
    s_barrier
    s_add_u32 s96, s84, 15
    s_and_b32 s97, s96, 15
    s_mul_i32 s98, s97, 393216
    s_add_u32 s99, s98, s85
    s_add_u32 s82, s99, 4294772736
    s_add_u32 m0, s83, 20480
    s_nop 0
    buffer_load_dwordx4 v3, s[40:43], s82 offen lds
    s_add_u32 s96, s84, 15
    s_and_b32 s97, s96, 15
    s_mul_i32 s98, s97, 393216
    s_add_u32 s99, s98, s85
    s_add_u32 s82, s99, 2048
    s_add_u32 m0, s83, 24576
    s_nop 0
    buffer_load_dwordx4 v3, s[40:43], s82 offen lds
    s_add_u32 s96, s84, 11
    s_and_b32 s97, s96, 15
    s_mul_i32 s98, s97, 393216
    s_add_u32 s99, s98, s85
    s_add_u32 s82, s99, 4294770688
    s_add_u32 m0, s83, 135168
    s_nop 0
    buffer_load_dwordx4 v3, s[40:43], s82 offen lds
    s_add_u32 s96, s84, 11
    s_and_b32 s97, s96, 15
    s_mul_i32 s98, s97, 393216
    s_add_u32 s82, s98, s85
    s_add_u32 m0, s83, 139264
    s_nop 0
    buffer_load_dwordx4 v3, s[40:43], s82 offen lds
    s_waitcnt vmcnt(14)
    s_waitcnt vmcnt(10)
    s_waitcnt vmcnt(6)
    s_barrier
    s_add_u32 s96, s84, 14
    s_and_b32 s97, s96, 15
    s_mul_i32 s98, s97, 393216
    s_add_u32 s99, s98, s85
    s_add_u32 s82, s99, 4294774784
    s_add_u32 m0, s83, 61440
    s_nop 0
    buffer_load_dwordx4 v3, s[40:43], s82 offen lds
    s_add_u32 s96, s84, 14
    s_and_b32 s97, s96, 15
    s_mul_i32 s98, s97, 393216
    s_add_u32 s99, s98, s85
    s_add_u32 s82, s99, 4096
    s_add_u32 m0, s83, 65536
    s_nop 0
    buffer_load_dwordx4 v3, s[40:43], s82 offen lds
    s_add_u32 s96, s84, 15
    s_and_b32 s97, s96, 15
    s_mul_i32 s98, s97, 393216
    s_add_u32 s99, s98, s85
    s_add_u32 s82, s99, 4294774784
    s_add_u32 m0, s83, 69632
    s_nop 0
    buffer_load_dwordx4 v3, s[40:43], s82 offen lds
    s_add_u32 s96, s84, 15
    s_and_b32 s97, s96, 15
    s_mul_i32 s98, s97, 393216
    s_add_u32 s99, s98, s85
    s_add_u32 s82, s99, 4096
    s_add_u32 m0, s83, 73728
    s_nop 0
    buffer_load_dwordx4 v3, s[40:43], s82 offen lds
    s_add_u32 s96, s84, 12
    s_and_b32 s97, s96, 15
    s_mul_i32 s98, s97, 393216
    s_add_u32 s99, s98, s85
    s_add_u32 s82, s99, 4294770688
    s_add_u32 m0, s83, 94208
    s_nop 0
    buffer_load_dwordx4 v3, s[40:43], s82 offen lds
    s_add_u32 s96, s84, 12
    s_and_b32 s97, s96, 15
    s_mul_i32 s98, s97, 393216
    s_add_u32 s82, s98, s85
    s_add_u32 m0, s83, 98304
    s_nop 0
    buffer_load_dwordx4 v3, s[40:43], s82 offen lds
    s_mov_b32 s82, s19
    buffer_load_dwordx4 v[88:91], v248, s[48:51], s82 offen nt
    s_add_u32 s82, s19, 98304
    buffer_load_dwordx4 v[92:95], v248, s[48:51], s82 offen nt
    s_add_u32 s82, s19, 196608
    buffer_load_dwordx4 v[96:99], v248, s[48:51], s82 offen nt
    s_add_u32 s82, s19, 294912
    buffer_load_dwordx4 v[100:103], v248, s[48:51], s82 offen nt
    s_waitcnt vmcnt(12)
    s_barrier
    s_add_u32 s96, s84, 13
    s_and_b32 s97, s96, 15
    s_mul_i32 s98, s97, 393216
    s_add_u32 s99, s98, s85
    s_add_u32 s82, s99, 4294770688
    s_add_u32 m0, s83, 102400
    s_nop 0
    buffer_load_dwordx4 v3, s[40:43], s82 offen lds
    s_add_u32 s96, s84, 13
    s_and_b32 s97, s96, 15
    s_mul_i32 s98, s97, 393216
    s_add_u32 s82, s98, s85
    s_add_u32 m0, s83, 106496
    s_nop 0
    buffer_load_dwordx4 v3, s[40:43], s82 offen lds
    s_add_u32 s96, s84, 14
    s_and_b32 s97, s96, 15
    s_mul_i32 s98, s97, 393216
    s_add_u32 s99, s98, s85
    s_add_u32 s82, s99, 4294770688
    s_add_u32 m0, s83, 110592
    s_nop 0
    buffer_load_dwordx4 v3, s[40:43], s82 offen lds
    s_add_u32 s96, s84, 14
    s_and_b32 s97, s96, 15
    s_mul_i32 s98, s97, 393216
    s_add_u32 s82, s98, s85
    s_add_u32 m0, s83, 114688
    s_nop 0
    buffer_load_dwordx4 v3, s[40:43], s82 offen lds
    s_add_u32 s96, s84, 15
    s_and_b32 s97, s96, 15
    s_mul_i32 s98, s97, 393216
    s_add_u32 s99, s98, s85
    s_add_u32 s82, s99, 4294770688
    s_add_u32 m0, s83, 118784
    s_nop 0
    buffer_load_dwordx4 v3, s[40:43], s82 offen lds
    s_add_u32 s96, s84, 15
    s_and_b32 s97, s96, 15
    s_mul_i32 s98, s97, 393216
    s_add_u32 s82, s98, s85
    s_add_u32 m0, s83, 122880
    s_nop 0
    buffer_load_dwordx4 v3, s[40:43], s82 offen lds
    s_waitcnt lgkmcnt(0)
    s_barrier
    s_setprio 3
    ds_read_b128 v[152:155], v0
    ds_read_b128 v[156:159], v0 offset:1024
    v_subrev_u32 v0, 118784, v0
    s_waitcnt lgkmcnt(1)
    v_mfma_f32_32x32x16_bf16 v[184:199], v[168:171], v[152:155], 0
    s_waitcnt lgkmcnt(0)
    v_mfma_f32_32x32x16_bf16 v[184:199], v[172:175], v[156:159], v[184:199]
    s_setprio 0
    s_nop 10
    v_cvt_pk_bf16_f32 v184, 0, v184
    v_cvt_pk_bf16_f32 v185, 0, v185
    v_cvt_pk_bf16_f32 v186, 0, v186
    s_add_u32 s82, s19, 393216
    buffer_load_dwordx4 v[104:107], v248, s[48:51], s82 offen nt
    v_cvt_pk_bf16_f32 v187, 0, v187
    v_cvt_pk_bf16_f32 v188, 0, v188
    v_cvt_pk_bf16_f32 v189, 0, v189
    v_cvt_pk_bf16_f32 v190, 0, v190
    v_cvt_pk_bf16_f32 v191, 0, v191
    v_cvt_pk_bf16_f32 v192, 0, v192
    v_cvt_pk_bf16_f32 v193, 0, v193
    v_cvt_pk_bf16_f32 v194, 0, v194
    v_cvt_pk_bf16_f32 v195, 0, v195
    v_cvt_pk_bf16_f32 v196, 0, v196
    s_add_u32 s82, s19, 491520
    buffer_load_dwordx4 v[108:111], v248, s[48:51], s82 offen nt
    v_cvt_pk_bf16_f32 v197, 0, v197
    v_cvt_pk_bf16_f32 v198, 0, v198
    v_cvt_pk_bf16_f32 v199, 0, v199
    v_max3_f32 v4, v184, v185, v186
    v_min3_f32 v5, v184, v185, v186
    v_max3_f32 v4, v4, v187, v188
    v_min3_f32 v5, v5, v187, v188
    v_max3_f32 v4, v4, v189, v190
    v_min3_f32 v5, v5, v189, v190
    v_max3_f32 v4, v4, v191, v192
    s_add_u32 s82, s19, 589824
    buffer_load_dwordx4 v[112:115], v248, s[48:51], s82 offen nt
    v_min3_f32 v5, v5, v191, v192
    v_max3_f32 v4, v4, v193, v194
    v_min3_f32 v5, v5, v193, v194
    v_max3_f32 v4, v4, v195, v196
    v_min3_f32 v5, v5, v195, v196
    v_max3_f32 v4, v4, v197, v198
    v_min3_f32 v5, v5, v197, v198
    v_max_f32 v6, v4, v199
    v_min_f32 v7, v5, v199
    v_max_f32 v4, v4, v199
    s_add_u32 s82, s19, 688128
    buffer_load_dwordx4 v[116:119], v248, s[48:51], s82 offen nt
    v_min_f32 v5, v5, v199
    v_permlane32_swap_b32 v4, v6
    s_nop 0
    v_permlane32_swap_b32 v5, v7
    v_max_f32 v4, v4, v6
    v_min_f32 v5, v5, v7
    v_mul_f32_e64 v4, v4, s7
    v_mul_f32_e64 v5, v5, s7
    v_fma_f32 v216, v184, s7, -v4
    v_fma_f32 v217, v185, s7, -v4
    v_fma_f32 v184, -v184, s7, v5
    v_fma_f32 v185, -v185, s7, v5
    v_fma_f32 v218, v186, s7, -v4
    v_fma_f32 v219, v187, s7, -v4
    v_fma_f32 v186, -v186, s7, v5
    v_fma_f32 v187, -v187, s7, v5
    s_waitcnt vmcnt(18)
    s_waitcnt vmcnt(16)
    s_barrier
    s_setprio 3
    ds_read_b128 v[152:155], v0
    ds_read_b128 v[156:159], v0 offset:1024
    s_waitcnt lgkmcnt(1)
    v_mfma_f32_32x32x16_bf16 v[200:215], v[176:179], v[152:155], 0
    s_waitcnt lgkmcnt(0)
    v_mfma_f32_32x32x16_bf16 v[200:215], v[180:183], v[156:159], v[200:215]
    s_setprio 0
    v_fma_f32 v220, v188, s7, -v4
    v_fma_f32 v221, v189, s7, -v4
    v_fma_f32 v188, -v188, s7, v5
    v_fma_f32 v189, -v189, s7, v5
    v_fma_f32 v222, v190, s7, -v4
    s_mov_b32 s82, s80
    buffer_load_dwordx4 v[56:59], v27, s[52:55], s82 offen nt
    v_fma_f32 v223, v191, s7, -v4
    v_fma_f32 v190, -v190, s7, v5
    v_fma_f32 v191, -v191, s7, v5
    v_fma_f32 v224, v192, s7, -v4
    v_fma_f32 v225, v193, s7, -v4
    s_setprio 3
    v_fma_f32 v192, -v192, s7, v5
    v_fma_f32 v193, -v193, s7, v5
    v_fma_f32 v226, v194, s7, -v4
    v_fma_f32 v227, v195, s7, -v4
    v_fma_f32 v194, -v194, s7, v5
    v_fma_f32 v195, -v195, s7, v5
    v_fma_f32 v228, v196, s7, -v4
    v_fma_f32 v229, v197, s7, -v4
    v_fma_f32 v196, -v196, s7, v5
    v_fma_f32 v197, -v197, s7, v5
    v_fma_f32 v230, v198, s7, -v4
    v_fma_f32 v231, v199, s7, -v4
    v_fma_f32 v198, -v198, s7, v5
    v_fma_f32 v199, -v199, s7, v5
    v_exp_f32 v216, v216
    s_add_u32 s82, s80, 4294049792
    buffer_load_dwordx4 v[60:63], v27, s[52:55], s82 offen nt
    v_exp_f32 v184, v184
    v_exp_f32 v217, v217
    v_exp_f32 v185, v185
    v_exp_f32 v218, v218
    v_exp_f32 v186, v186
    v_exp_f32 v219, v219
    v_exp_f32 v187, v187
    v_exp_f32 v220, v220
    v_exp_f32 v188, v188
    v_exp_f32 v221, v221
    v_exp_f32 v189, v189
    v_exp_f32 v222, v222
    v_exp_f32 v190, v190
    v_exp_f32 v223, v223
    v_exp_f32 v191, v191
    v_exp_f32 v224, v224
    v_exp_f32 v192, v192
    v_exp_f32 v225, v225
    v_exp_f32 v193, v193
    v_exp_f32 v226, v226
    s_add_u32 s82, s80, 57344
    buffer_load_dwordx4 v[64:67], v27, s[52:55], s82 offen nt
    v_exp_f32 v194, v194
    v_exp_f32 v227, v227
    v_exp_f32 v195, v195
    v_exp_f32 v228, v228
    v_exp_f32 v196, v196
    v_exp_f32 v229, v229
    v_exp_f32 v197, v197
    v_exp_f32 v230, v230
    v_exp_f32 v198, v198
    v_exp_f32 v231, v231
    v_exp_f32 v199, v199
    v_add_f32 v8, v216, v218
    v_add_f32 v9, v217, v219
    v_add_f32 v10, v184, v186
    v_add_f32 v11, v185, v187
    v_add_f32 v8, v8, v220
    v_add_f32 v9, v9, v221
    v_add_f32 v10, v10, v188
    v_add_f32 v11, v11, v189
    v_add_f32 v8, v8, v222
    s_add_u32 s82, s80, 4294107136
    buffer_load_dwordx4 v[68:71], v27, s[52:55], s82 offen nt
    v_add_f32 v9, v9, v223
    v_add_f32 v10, v10, v190
    v_add_f32 v11, v11, v191
    v_add_f32 v8, v8, v224
    v_add_f32 v9, v9, v225
    v_add_f32 v10, v10, v192
    v_add_f32 v11, v11, v193
    v_add_f32 v8, v8, v226
    v_add_f32 v9, v9, v227
    v_add_f32 v10, v10, v194
    v_add_f32 v11, v11, v195
    v_add_f32 v8, v8, v228
    v_add_f32 v9, v9, v229
    v_add_f32 v10, v10, v196
    v_add_f32 v11, v11, v197
    v_add_f32 v8, v8, v230
    v_add_f32 v9, v9, v231
    v_add_f32 v10, v10, v198
    v_add_f32 v11, v11, v199
    v_add_f32 v6, v8, v9
    v_add_f32 v7, v10, v11
    v_add_f32 v4, v8, v9
    s_setprio 0
    v_add_f32 v5, v10, v11
    v_permlane32_swap_b32 v4, v6
    s_nop 0
    v_permlane32_swap_b32 v5, v7
    v_add_f32 v4, v4, v6
    v_add_f32 v5, v5, v7
    v_rcp_f32 v4, v4
    v_rcp_f32 v5, v5
    v_mul_f32 v216, v216, v4
    v_mul_f32 v217, v217, v4
    v_mul_f32 v184, v184, v5
    v_mul_f32 v185, v185, v5
    v_mul_f32 v218, v218, v4
    v_mul_f32 v219, v219, v4
    v_mul_f32 v186, v186, v5
    v_mul_f32 v187, v187, v5
    v_mul_f32 v220, v220, v4
    v_mul_f32 v221, v221, v4
    v_mul_f32 v188, v188, v5
    v_mul_f32 v189, v189, v5
    v_mul_f32 v222, v222, v4
    v_mul_f32 v223, v223, v4
    v_mul_f32 v190, v190, v5
    v_mul_f32 v191, v191, v5
    v_mul_f32 v224, v224, v4
    v_mul_f32 v225, v225, v4
    v_mul_f32 v192, v192, v5
    v_mul_f32 v193, v193, v5
    v_mul_f32 v226, v226, v4
    v_mul_f32 v227, v227, v4
    v_mul_f32 v194, v194, v5
    v_mul_f32 v195, v195, v5
    v_mul_f32 v228, v228, v4
    v_mul_f32 v229, v229, v4
    v_mul_f32 v196, v196, v5
    v_mul_f32 v197, v197, v5
    v_mul_f32 v230, v230, v4
    v_mul_f32 v231, v231, v4
    v_mul_f32 v198, v198, v5
    v_mul_f32 v199, v199, v5
    v_cvt_pk_bf16_f32 v216, v216, v217
    v_cvt_pk_bf16_f32 v217, v218, v219
    v_cvt_pk_bf16_f32 v218, v220, v221
    v_cvt_pk_bf16_f32 v219, v222, v223
    v_cvt_pk_bf16_f32 v220, v224, v225
    v_cvt_pk_bf16_f32 v221, v226, v227
    v_cvt_pk_bf16_f32 v222, v228, v229
    v_cvt_pk_bf16_f32 v223, v230, v231
    ds_write_b128 v232, v[216:219]
    v_cvt_pk_bf16_f32 v224, v184, v185
    v_cvt_pk_bf16_f32 v225, v186, v187
    v_cvt_pk_bf16_f32 v226, v188, v189
    v_cvt_pk_bf16_f32 v227, v190, v191
    ds_write_b128 v232, v[220:223] offset:4096
    s_waitcnt vmcnt(18)
    s_waitcnt vmcnt(12)
    s_waitcnt vmcnt(10)
    s_waitcnt vmcnt(8)
    s_barrier
    ds_write_b128 v232, v[224:227] offset:8192
    v_cvt_pk_bf16_f32 v228, v192, v193
    v_cvt_pk_bf16_f32 v229, v194, v195
    v_cvt_pk_bf16_f32 v230, v196, v197
    v_cvt_pk_bf16_f32 v231, v198, v199
    s_xor_b32 s96, s95, 786432
    s_add_u32 s97, s96, s90
    s_sub_u32 s82, s97, 65536
    s_add_u32 m0, s83, 45056
    s_nop 0
    buffer_load_dwordx4 v26, s[44:47], s82 offen lds
    ds_write_b128 v232, v[228:231] offset:12288
    v_cvt_pk_bf16_f32 v200, 0, v200
    v_cvt_pk_bf16_f32 v201, 0, v201
    v_cvt_pk_bf16_f32 v202, 0, v202
    v_cvt_pk_bf16_f32 v203, 0, v203
    v_cvt_pk_bf16_f32 v204, 0, v204
    v_cvt_pk_bf16_f32 v205, 0, v205
    v_cvt_pk_bf16_f32 v206, 0, v206
    v_cvt_pk_bf16_f32 v207, 0, v207
    v_cvt_pk_bf16_f32 v208, 0, v208
    v_cvt_pk_bf16_f32 v209, 0, v209
    v_cvt_pk_bf16_f32 v210, 0, v210
    v_cvt_pk_bf16_f32 v211, 0, v211
    s_xor_b32 s96, s95, 786432
    s_add_u32 s82, s96, s90
    s_add_u32 m0, s83, 49152
    s_nop 0
    buffer_load_dwordx4 v26, s[44:47], s82 offen lds
    v_cvt_pk_bf16_f32 v212, 0, v212
    v_cvt_pk_bf16_f32 v213, 0, v213
    v_cvt_pk_bf16_f32 v214, 0, v214
    v_cvt_pk_bf16_f32 v215, 0, v215
    v_max3_f32 v4, v200, v201, v202
    v_min3_f32 v5, v200, v201, v202
    v_max3_f32 v4, v4, v203, v204
    v_min3_f32 v5, v5, v203, v204
    v_max3_f32 v4, v4, v205, v206
    v_min3_f32 v5, v5, v205, v206
    v_max3_f32 v4, v4, v207, v208
    v_min3_f32 v5, v5, v207, v208
    v_max3_f32 v4, v4, v209, v210
    v_min3_f32 v5, v5, v209, v210
    s_xor_b32 s96, s95, 917504
    s_add_u32 s97, s96, s90
    s_sub_u32 s82, s97, 65536
    s_add_u32 m0, s83, 53248
    s_nop 0
    buffer_load_dwordx4 v26, s[44:47], s82 offen lds
    v_max3_f32 v4, v4, v211, v212
    v_min3_f32 v5, v5, v211, v212
    v_max3_f32 v4, v4, v213, v214
    v_min3_f32 v5, v5, v213, v214
    v_max_f32 v6, v4, v215
    v_min_f32 v7, v5, v215
    v_max_f32 v4, v4, v215
    s_waitcnt lgkmcnt(0)
    v_min_f32 v5, v5, v215
    v_permlane32_swap_b32 v4, v6
    s_nop 0
    v_permlane32_swap_b32 v5, v7
    v_max_f32 v4, v4, v6
    v_min_f32 v5, v5, v7
    v_mul_f32_e64 v4, v4, s7
    s_xor_b32 s96, s95, 917504
    s_add_u32 s82, s96, s90
    s_add_u32 m0, s83, 57344
    s_nop 0
    buffer_load_dwordx4 v26, s[44:47], s82 offen lds
    v_mul_f32_e64 v5, v5, s7
    v_fma_f32 v216, v200, s7, -v4
    v_fma_f32 v217, v201, s7, -v4
    v_fma_f32 v200, -v200, s7, v5
    v_fma_f32 v201, -v201, s7, v5
    v_fma_f32 v218, v202, s7, -v4
    v_fma_f32 v219, v203, s7, -v4
    v_fma_f32 v202, -v202, s7, v5
    v_fma_f32 v203, -v203, s7, v5
    v_fma_f32 v220, v204, s7, -v4
    v_fma_f32 v221, v205, s7, -v4
    v_fma_f32 v204, -v204, s7, v5
    v_fma_f32 v205, -v205, s7, v5
    v_fma_f32 v222, v206, s7, -v4
    s_xor_b32 s96, s95, 1048576
    s_add_u32 s97, s96, s90
    s_sub_u32 s82, s97, 65536
    s_add_u32 m0, s83, 61440
    s_nop 0
    buffer_load_dwordx4 v26, s[44:47], s82 offen lds
    v_fma_f32 v223, v207, s7, -v4
    v_fma_f32 v206, -v206, s7, v5
    v_fma_f32 v207, -v207, s7, v5
    v_fma_f32 v224, v208, s7, -v4
    v_fma_f32 v225, v209, s7, -v4
    v_fma_f32 v208, -v208, s7, v5
    v_fma_f32 v209, -v209, s7, v5
    v_fma_f32 v226, v210, s7, -v4
    v_fma_f32 v227, v211, s7, -v4
    v_fma_f32 v210, -v210, s7, v5
    v_fma_f32 v211, -v211, s7, v5
    v_fma_f32 v228, v212, s7, -v4
    v_fma_f32 v229, v213, s7, -v4
    v_fma_f32 v212, -v212, s7, v5
    s_xor_b32 s96, s95, 1048576
    s_add_u32 s82, s96, s90
    s_add_u32 m0, s83, 65536
    s_nop 0
    buffer_load_dwordx4 v26, s[44:47], s82 offen lds
    v_fma_f32 v213, -v213, s7, v5
    v_fma_f32 v230, v214, s7, -v4
    v_fma_f32 v231, v215, s7, -v4
L_PAD6:
    s_cbranch_execz L_RET6
    v_fma_f32 v214, -v214, s7, v5
    v_fma_f32 v215, -v215, s7, v5
    v_exp_f32 v216, v216
    v_exp_f32 v200, v200
    v_exp_f32 v217, v217
    v_exp_f32 v201, v201
    v_exp_f32 v218, v218
    v_exp_f32 v202, v202
    v_exp_f32 v219, v219
    v_exp_f32 v203, v203
    v_exp_f32 v220, v220
    s_xor_b32 s96, s95, 1179648
    s_add_u32 s97, s96, s90
    s_sub_u32 s82, s97, 65536
    s_add_u32 m0, s83, 69632
    s_nop 0
    buffer_load_dwordx4 v26, s[44:47], s82 offen lds
    v_exp_f32 v204, v204
    v_exp_f32 v221, v221
    v_exp_f32 v205, v205
    v_exp_f32 v222, v222
    v_exp_f32 v206, v206
    v_exp_f32 v223, v223
    v_exp_f32 v207, v207
    v_exp_f32 v224, v224
    v_exp_f32 v208, v208
    v_exp_f32 v225, v225
    v_exp_f32 v209, v209
    v_exp_f32 v226, v226
    v_exp_f32 v210, v210
    v_exp_f32 v227, v227
    s_xor_b32 s96, s95, 1179648
    s_add_u32 s82, s96, s90
    s_add_u32 m0, s83, 73728
    s_nop 0
    buffer_load_dwordx4 v26, s[44:47], s82 offen lds
    v_exp_f32 v211, v211
    v_exp_f32 v228, v228
    v_exp_f32 v212, v212
    v_exp_f32 v229, v229
    v_exp_f32 v213, v213
    v_exp_f32 v230, v230
    v_exp_f32 v214, v214
    v_exp_f32 v231, v231
    v_exp_f32 v215, v215
    v_add_f32 v8, v216, v218
    v_add_f32 v9, v217, v219
    v_add_f32 v10, v200, v202
    v_add_f32 v11, v201, v203
    v_add_f32 v8, v8, v220
    v_add_f32 v9, v9, v221
    v_add_f32 v10, v10, v204
    v_add_f32 v11, v11, v205
    v_add_f32 v8, v8, v222
    v_add_f32 v9, v9, v223
    v_add_f32 v10, v10, v206
    v_add_f32 v11, v11, v207
    v_add_f32 v8, v8, v224
    v_add_f32 v9, v9, v225
    v_add_f32 v10, v10, v208
    v_add_f32 v11, v11, v209
    v_add_f32 v8, v8, v226
    v_add_f32 v9, v9, v227
    v_add_f32 v10, v10, v210
    v_add_f32 v11, v11, v211
    v_add_f32 v8, v8, v228
    v_add_f32 v9, v9, v229
    v_add_f32 v10, v10, v212
    v_add_f32 v11, v11, v213
    v_add_f32 v8, v8, v230
    v_add_f32 v9, v9, v231
    v_add_f32 v10, v10, v214
    v_add_f32 v11, v11, v215
    v_add_f32 v6, v8, v9
    v_add_f32 v7, v10, v11
    v_add_f32 v4, v8, v9
    v_add_f32 v5, v10, v11
    s_nop 0
    v_permlane32_swap_b32 v4, v6
    v_permlane32_swap_b32 v5, v7
    v_add_f32 v4, v4, v6
    v_add_f32 v5, v5, v7
    v_rcp_f32 v4, v4
    v_rcp_f32 v5, v5
    v_mul_f32 v216, v216, v4
    v_mul_f32 v217, v217, v4
    v_mul_f32 v200, v200, v5
    v_mul_f32 v201, v201, v5
    v_mul_f32 v218, v218, v4
    v_mul_f32 v219, v219, v4
    v_mul_f32 v202, v202, v5
    v_mul_f32 v203, v203, v5
    v_mul_f32 v220, v220, v4
    v_mul_f32 v221, v221, v4
    v_mul_f32 v204, v204, v5
    v_mul_f32 v205, v205, v5
    v_mul_f32 v222, v222, v4
    v_mul_f32 v223, v223, v4
    v_mul_f32 v206, v206, v5
    v_mul_f32 v207, v207, v5
    v_mul_f32 v224, v224, v4
    v_mul_f32 v225, v225, v4
    v_mul_f32 v208, v208, v5
    v_mul_f32 v209, v209, v5
    v_mul_f32 v226, v226, v4
    v_mul_f32 v227, v227, v4
    v_mul_f32 v210, v210, v5
    v_mul_f32 v211, v211, v5
    v_mul_f32 v228, v228, v4
    v_mul_f32 v229, v229, v4
    v_mul_f32 v212, v212, v5
    v_mul_f32 v213, v213, v5
    v_mul_f32 v230, v230, v4
    v_mul_f32 v231, v231, v4
    v_mul_f32 v214, v214, v5
    v_mul_f32 v215, v215, v5
    v_cvt_pk_bf16_f32 v216, v216, v217
    v_cvt_pk_bf16_f32 v217, v218, v219
    v_cvt_pk_bf16_f32 v218, v220, v221
    v_cvt_pk_bf16_f32 v219, v222, v223
    v_cvt_pk_bf16_f32 v220, v224, v225
    v_cvt_pk_bf16_f32 v221, v226, v227
    v_cvt_pk_bf16_f32 v222, v228, v229
    v_cvt_pk_bf16_f32 v223, v230, v231
    ds_write_b128 v232, v[216:219] offset:16384
    v_cvt_pk_bf16_f32 v224, v200, v201
    v_cvt_pk_bf16_f32 v225, v202, v203
    v_cvt_pk_bf16_f32 v226, v204, v205
    v_cvt_pk_bf16_f32 v227, v206, v207
    ds_write_b128 v232, v[220:223] offset:20480
    ds_write_b128 v232, v[224:227] offset:24576
    v_cvt_pk_bf16_f32 v228, v208, v209
    v_cvt_pk_bf16_f32 v229, v210, v211
    v_cvt_pk_bf16_f32 v230, v212, v213
    v_cvt_pk_bf16_f32 v231, v214, v215
    ds_write_b128 v232, v[228:231] offset:28672
    s_lshl_b32 s96, s77, 11
    s_add_u32 s14, s96, 151552
    v_add_u32 v0, s14, v2
    s_setprio 0
L_JOIN:
    v_and_b32 v45, 1, v1
    v_lshlrev_b32 v45, 3, v45
    v_bfe_u32 v9, v1, 2, 2
    v_lshl_add_u32 v45, v9, 4, v45
    v_bfe_u32 v9, v1, 4, 1
    v_lshl_add_u32 v45, v9, 6, v45
    v_bfe_u32 v9, v1, 1, 1
    v_lshl_add_u32 v45, v9, 7, v45
    v_lshrrev_b32 v9, 5, v1
    v_lshl_add_u32 v45, v9, 8, v45
    s_lshl_b32 s13, s3, 12
    v_add_u32 v44, s13, v45
    s_lshl_b32 s96, s76, 13
    s_add_u32 s13, s96, 32768
    v_add_u32 v45, s13, v45
    v_mov_b32 v244, 0x3f803f80
    v_mov_b32 v245, 0x3f803f80
    v_mov_b32 v246, 0x3f803f80
    v_mov_b32 v247, 0x3f803f80
    s_lshl3_add_u32 s96, s11, s3
    s_lshl_b32 s97, s96, 5
    s_add_u32 s98, s97, s10
    s_lshl_b32 s99, s98, 10
    s_add_u32 s13, s99, 25165824
    s_add_u32 s15, s13, 16384
    s_lshl3_add_u32 s96, s11, s3
    s_lshl_b32 s97, s96, 10
    s_add_u32 s16, s97, 21495808
    s_lshl_b32 s96, s10, 6
    s_add_u32 s14, s96, s16
    s_waitcnt lgkmcnt(0)
    s_barrier
    ds_read_b64_tr_b16 v[184:185], v44
    ds_read_b64_tr_b16 v[186:187], v44 offset:512
    ds_read_b64_tr_b16 v[200:201], v45
    ds_read_b64_tr_b16 v[202:203], v45 offset:512
    ds_read_b64_tr_b16 v[204:205], v45 offset:1024
    ds_read_b64_tr_b16 v[206:207], v45 offset:1536
    ds_read_b64_tr_b16 v[188:189], v44 offset:1024
    ds_read_b64_tr_b16 v[190:191], v44 offset:1536
    ds_read_b64_tr_b16 v[208:209], v45 offset:2048
    ds_read_b64_tr_b16 v[210:211], v45 offset:2560
    ds_read_b64_tr_b16 v[212:213], v45 offset:3072
    ds_read_b64_tr_b16 v[214:215], v45 offset:3584
    ds_read_b64_tr_b16 v[192:193], v44 offset:2048
    ds_read_b64_tr_b16 v[194:195], v44 offset:2560
    ds_read_b64_tr_b16 v[216:217], v45 offset:4096
    ds_read_b64_tr_b16 v[218:219], v45 offset:4608
    ds_read_b64_tr_b16 v[220:221], v45 offset:5120
    ds_read_b64_tr_b16 v[222:223], v45 offset:5632
    s_waitcnt lgkmcnt(12)
    v_mfma_f32_16x16x32_bf16 v[232:235], v[184:187], v[200:203], 0
    v_mfma_f32_16x16x32_bf16 v[236:239], v[184:187], v[204:207], 0
    v_mfma_f32_16x16x32_bf16 v[240:243], v[184:187], v[244:247], 0
    ds_read_b64_tr_b16 v[196:197], v44 offset:3072
    ds_read_b64_tr_b16 v[198:199], v44 offset:3584
    ds_read_b64_tr_b16 v[224:225], v45 offset:6144
    ds_read_b64_tr_b16 v[226:227], v45 offset:6656
    ds_read_b64_tr_b16 v[228:229], v45 offset:7168
    ds_read_b64_tr_b16 v[230:231], v45 offset:7680
    s_waitcnt lgkmcnt(12)
    v_mfma_f32_16x16x32_bf16 v[232:235], v[188:191], v[208:211], v[232:235]
    v_mfma_f32_16x16x32_bf16 v[236:239], v[188:191], v[212:215], v[236:239]
    v_mfma_f32_16x16x32_bf16 v[240:243], v[188:191], v[244:247], v[240:243]
    s_waitcnt lgkmcnt(6)
    v_mfma_f32_16x16x32_bf16 v[232:235], v[192:195], v[216:219], v[232:235]
    v_mfma_f32_16x16x32_bf16 v[236:239], v[192:195], v[220:223], v[236:239]
    v_mfma_f32_16x16x32_bf16 v[240:243], v[192:195], v[244:247], v[240:243]
    s_waitcnt lgkmcnt(0)
    v_mfma_f32_16x16x32_bf16 v[232:235], v[196:199], v[224:227], v[232:235]
    v_mfma_f32_16x16x32_bf16 v[236:239], v[196:199], v[228:231], v[236:239]
    v_mfma_f32_16x16x32_bf16 v[240:243], v[196:199], v[244:247], v[240:243]
    s_cmp_lt_u32 s3, 4
    s_cbranch_scc1 L_NOQX
    ds_read_b128 v[168:171], v0
    ds_read_b128 v[172:175], v0 offset:1024
L_NOQX:
    s_nop 3
    buffer_store_dwordx4 v[232:235], v2, s[32:35], s13 offen sc1
    buffer_store_dwordx4 v[236:239], v2, s[32:35], s15 offen sc1
    s_mov_b32 exec_lo, 0x00010001
    s_mov_b32 exec_hi, 0x00010001
    buffer_store_dwordx4 v[240:243], v1, s[32:35], s14 offen sc1
    s_mov_b64 exec, -1
    s_waitcnt lgkmcnt(0)
    v_mfma_f32_32x32x16_bf16 v[120:135], v[176:179], v[168:171], 0
    v_mfma_f32_32x32x16_bf16 v[120:135], v[180:183], v[172:175], v[120:135]
    v_and_b32 v46, 7, v1
    v_lshlrev_b32 v46, 17, v46
    v_bfe_u32 v9, v1, 3, 1
    v_lshl_add_u32 v46, v9, 14, v46
    s_and_b32 s96, s10, 1
    s_and_b32 s97, s2, 27
    s_lshl_b32 s98, s97, 12
    s_lshr_b32 s99, s10, 1
    s_lshl_b32 s97, s99, 6
    s_add_u32 s99, s98, s97
    s_lshl2_add_u32 s98, s96, s99
    s_add_u32 s97, s98, 1048576
    s_add_u32 s17, s97, 512
    v_lshrrev_b32 v47, 3, v1
    v_lshlrev_b32 v47, 10, v47
    v_and_b32 v9, 7, v1
    v_lshl_add_u32 v47, v9, 4, v47
    v_and_b32 v48, 7, v1
    v_lshlrev_b32 v48, 4, v48
    v_lshrrev_b32 v9, 5, v1
    v_lshl_add_u32 v48, v9, 3, v48
    v_cvt_pk_bf16_f32 v120, 0, v120
    v_cvt_pk_bf16_f32 v121, 0, v121
    v_cvt_pk_bf16_f32 v122, 0, v122
    v_cvt_pk_bf16_f32 v123, 0, v123
    v_cvt_pk_bf16_f32 v124, 0, v124
    v_cvt_pk_bf16_f32 v125, 0, v125
    v_cvt_pk_bf16_f32 v126, 0, v126
    v_cvt_pk_bf16_f32 v127, 0, v127
    v_cvt_pk_bf16_f32 v128, 0, v128
    v_cvt_pk_bf16_f32 v129, 0, v129
    v_cvt_pk_bf16_f32 v130, 0, v130
    v_cvt_pk_bf16_f32 v131, 0, v131
    v_cvt_pk_bf16_f32 v132, 0, v132
    v_cvt_pk_bf16_f32 v133, 0, v133
    v_cvt_pk_bf16_f32 v134, 0, v134
    v_cvt_pk_bf16_f32 v135, 0, v135
    v_max3_f32 v4, v120, v121, v122
    v_min3_f32 v5, v120, v121, v122
    v_max3_f32 v4, v4, v123, v124
    v_min3_f32 v5, v5, v123, v124
    v_max3_f32 v4, v4, v125, v126
    v_min3_f32 v5, v5, v125, v126
    v_max3_f32 v4, v4, v127, v128
    v_min3_f32 v5, v5, v127, v128
    v_max3_f32 v4, v4, v129, v130
    v_min3_f32 v5, v5, v129, v130
    v_max3_f32 v4, v4, v131, v132
    v_min3_f32 v5, v5, v131, v132
    v_max3_f32 v4, v4, v133, v134
    v_min3_f32 v5, v5, v133, v134
    v_max_f32 v6, v4, v135
    v_min_f32 v7, v5, v135
    v_max_f32 v4, v4, v135
    v_min_f32 v5, v5, v135
    s_nop 0
    v_permlane32_swap_b32 v4, v6
    v_permlane32_swap_b32 v5, v7
    v_max_f32 v4, v4, v6
    v_min_f32 v5, v5, v7
    v_pk_mul_f32 v[4:5], v[4:5], s[6:7] op_sel:[0,1]
    v_mov_b32 v6, v5
    v_pk_fma_f32 v[136:137], v[120:121], s[6:7], v[4:5] op_sel:[0,1,0] op_sel_hi:[1,1,0] neg_lo:[0,0,1] neg_hi:[0,0,1]
    v_pk_fma_f32 v[120:121], v[120:121], s[6:7], v[6:7] op_sel:[0,1,0] op_sel_hi:[1,1,0] neg_lo:[1,0,0] neg_hi:[1,0,0]
    v_pk_fma_f32 v[138:139], v[122:123], s[6:7], v[4:5] op_sel:[0,1,0] op_sel_hi:[1,1,0] neg_lo:[0,0,1] neg_hi:[0,0,1]
    v_pk_fma_f32 v[122:123], v[122:123], s[6:7], v[6:7] op_sel:[0,1,0] op_sel_hi:[1,1,0] neg_lo:[1,0,0] neg_hi:[1,0,0]
    v_pk_fma_f32 v[140:141], v[124:125], s[6:7], v[4:5] op_sel:[0,1,0] op_sel_hi:[1,1,0] neg_lo:[0,0,1] neg_hi:[0,0,1]
    v_pk_fma_f32 v[124:125], v[124:125], s[6:7], v[6:7] op_sel:[0,1,0] op_sel_hi:[1,1,0] neg_lo:[1,0,0] neg_hi:[1,0,0]
    v_pk_fma_f32 v[142:143], v[126:127], s[6:7], v[4:5] op_sel:[0,1,0] op_sel_hi:[1,1,0] neg_lo:[0,0,1] neg_hi:[0,0,1]
    v_pk_fma_f32 v[126:127], v[126:127], s[6:7], v[6:7] op_sel:[0,1,0] op_sel_hi:[1,1,0] neg_lo:[1,0,0] neg_hi:[1,0,0]
    v_pk_fma_f32 v[144:145], v[128:129], s[6:7], v[4:5] op_sel:[0,1,0] op_sel_hi:[1,1,0] neg_lo:[0,0,1] neg_hi:[0,0,1]
    v_pk_fma_f32 v[128:129], v[128:129], s[6:7], v[6:7] op_sel:[0,1,0] op_sel_hi:[1,1,0] neg_lo:[1,0,0] neg_hi:[1,0,0]
    v_pk_fma_f32 v[146:147], v[130:131], s[6:7], v[4:5] op_sel:[0,1,0] op_sel_hi:[1,1,0] neg_lo:[0,0,1] neg_hi:[0,0,1]
    v_pk_fma_f32 v[130:131], v[130:131], s[6:7], v[6:7] op_sel:[0,1,0] op_sel_hi:[1,1,0] neg_lo:[1,0,0] neg_hi:[1,0,0]
    v_pk_fma_f32 v[148:149], v[132:133], s[6:7], v[4:5] op_sel:[0,1,0] op_sel_hi:[1,1,0] neg_lo:[0,0,1] neg_hi:[0,0,1]
    v_pk_fma_f32 v[132:133], v[132:133], s[6:7], v[6:7] op_sel:[0,1,0] op_sel_hi:[1,1,0] neg_lo:[1,0,0] neg_hi:[1,0,0]
    v_pk_fma_f32 v[150:151], v[134:135], s[6:7], v[4:5] op_sel:[0,1,0] op_sel_hi:[1,1,0] neg_lo:[0,0,1] neg_hi:[0,0,1]
    v_pk_fma_f32 v[134:135], v[134:135], s[6:7], v[6:7] op_sel:[0,1,0] op_sel_hi:[1,1,0] neg_lo:[1,0,0] neg_hi:[1,0,0]
    v_exp_f32 v136, v136
    v_exp_f32 v120, v120
    v_exp_f32 v137, v137
    v_exp_f32 v121, v121
    v_exp_f32 v138, v138
    v_exp_f32 v122, v122
    v_exp_f32 v139, v139
    v_exp_f32 v123, v123
    v_exp_f32 v140, v140
    v_exp_f32 v124, v124
    v_exp_f32 v141, v141
    v_exp_f32 v125, v125
    v_exp_f32 v142, v142
    v_exp_f32 v126, v126
    v_exp_f32 v143, v143
    v_exp_f32 v127, v127
    s_waitcnt vmcnt(0)
    s_barrier
    s_cmp_lg_u32 s3, 0
    s_cbranch_scc1 L_PC
    v_mov_b32 v45, s4
    s_mov_b32 exec_hi, 0
    s_mov_b32 exec_lo, 65535
    buffer_store_dword v45, v46, s[32:35], s17 offen sc1
    s_mov_b64 exec, -1
L_PC:
    s_xor_b32 s96, s95, 1310720
    s_add_u32 s82, s96, s90
    s_add_u32 m0, s83, 81920
    s_nop 0
    buffer_load_dwordx4 v26, s[44:47], s82 offen lds
    v_exp_f32 v144, v144
    v_exp_f32 v128, v128
    v_exp_f32 v145, v145
    v_exp_f32 v129, v129
    s_xor_b32 s96, s95, 1441792
    s_add_u32 s82, s96, s90
    s_add_u32 m0, s83, 90112
    s_nop 0
    buffer_load_dwordx4 v26, s[44:47], s82 offen lds
    v_exp_f32 v146, v146
    v_exp_f32 v130, v130
    v_exp_f32 v147, v147
    v_exp_f32 v131, v131
    s_xor_b32 s96, s95, 1572864
    s_add_u32 s82, s96, s90
    s_add_u32 m0, s83, 98304
    s_nop 0
    buffer_load_dwordx4 v26, s[44:47], s82 offen lds
    v_exp_f32 v148, v148
    v_exp_f32 v132, v132
    v_exp_f32 v149, v149
    v_exp_f32 v133, v133
    s_xor_b32 s96, s95, 1703936
    s_add_u32 s82, s96, s90
    s_add_u32 m0, s83, 106496
    s_nop 0
    buffer_load_dwordx4 v26, s[44:47], s82 offen lds
    v_exp_f32 v150, v150
    v_exp_f32 v134, v134
    v_exp_f32 v151, v151
    v_exp_f32 v135, v135
    s_lshl4_add_u32 s96, s11, s10
    s_lshl_b32 s97, s96, 14
    s_lshl_b32 s98, s3, 7
    s_add_u32 s99, s97, s98
    s_add_u32 s13, s99, 25165824
    s_add_u32 s14, s13, 8192
    s_lshl4_add_u32 s96, s11, s10
    s_lshl_b32 s97, s96, 10
    s_lshl_b32 s98, s3, 7
    s_add_u32 s99, s97, s98
    s_add_u32 s15, s99, 29360128
    s_add_u32 s17, s17, 3072
    s_load_dwordx2 s[24:25], s[32:33], s92 offset:512 glc
    s_xor_b32 s96, s95, 1835008
    s_add_u32 s82, s96, s90
    s_add_u32 m0, s83, 114688
    s_nop 0
    buffer_load_dwordx4 v26, s[44:47], s82 offen lds
    v_pk_add_f32 v[8:9], v[136:137], v[138:139]
    v_pk_add_f32 v[10:11], v[120:121], v[122:123]
    v_pk_add_f32 v[8:9], v[8:9], v[140:141]
    v_pk_add_f32 v[10:11], v[10:11], v[124:125]
    v_pk_add_f32 v[8:9], v[8:9], v[142:143]
    v_pk_add_f32 v[10:11], v[10:11], v[126:127]
    v_pk_add_f32 v[8:9], v[8:9], v[144:145]
    v_pk_add_f32 v[10:11], v[10:11], v[128:129]
    v_pk_add_f32 v[8:9], v[8:9], v[146:147]
    v_pk_add_f32 v[10:11], v[10:11], v[130:131]
    v_pk_add_f32 v[8:9], v[8:9], v[148:149]
    v_pk_add_f32 v[10:11], v[10:11], v[132:133]
    v_pk_add_f32 v[8:9], v[8:9], v[150:151]
    v_pk_add_f32 v[10:11], v[10:11], v[134:135]
    s_xor_b32 s96, s95, 1966080
    s_add_u32 s82, s96, s90
    s_add_u32 m0, s83, 122880
    s_nop 0
    buffer_load_dwordx4 v26, s[44:47], s82 offen lds
    v_add_f32 v6, v8, v9
    v_add_f32 v7, v10, v11
    v_add_f32 v4, v8, v9
    v_add_f32 v5, v10, v11
    s_nop 0
    v_permlane32_swap_b32 v4, v6
    v_permlane32_swap_b32 v5, v7
    v_pk_add_f32 v[4:5], v[4:5], v[6:7]
    v_rcp_f32 v4, v4
    v_rcp_f32 v5, v5
    s_nop 0
    v_pk_mul_f32 v[136:137], v[136:137], v[4:5] op_sel_hi:[1,0]
    v_pk_mul_f32 v[120:121], v[4:5], v[120:121] op_sel:[1,0]
    v_pk_mul_f32 v[138:139], v[138:139], v[4:5] op_sel_hi:[1,0]
    v_pk_mul_f32 v[122:123], v[4:5], v[122:123] op_sel:[1,0]
    v_pk_mul_f32 v[140:141], v[140:141], v[4:5] op_sel_hi:[1,0]
    s_add_u32 s82, s95, s90
    s_mov_b32 m0, s83
    s_nop 0
    buffer_load_dwordx4 v26, s[44:47], s82 offen lds
    v_pk_mul_f32 v[124:125], v[4:5], v[124:125] op_sel:[1,0]
    v_pk_mul_f32 v[142:143], v[142:143], v[4:5] op_sel_hi:[1,0]
    v_pk_mul_f32 v[126:127], v[4:5], v[126:127] op_sel:[1,0]
    v_pk_mul_f32 v[144:145], v[144:145], v[4:5] op_sel_hi:[1,0]
    v_pk_mul_f32 v[128:129], v[4:5], v[128:129] op_sel:[1,0]
    v_pk_mul_f32 v[146:147], v[146:147], v[4:5] op_sel_hi:[1,0]
    v_pk_mul_f32 v[130:131], v[4:5], v[130:131] op_sel:[1,0]
    v_pk_mul_f32 v[148:149], v[148:149], v[4:5] op_sel_hi:[1,0]
    v_pk_mul_f32 v[132:133], v[4:5], v[132:133] op_sel:[1,0]
    v_pk_mul_f32 v[150:151], v[150:151], v[4:5] op_sel_hi:[1,0]
    v_pk_mul_f32 v[134:135], v[4:5], v[134:135] op_sel:[1,0]
    v_cvt_pk_bf16_f32 v152, v136, v137
    v_cvt_pk_bf16_f32 v153, v138, v139
    v_cvt_pk_bf16_f32 v154, v140, v141
    s_xor_b32 s96, s95, 131072
    s_add_u32 s82, s96, s90
    s_add_u32 m0, s83, 8192
    s_nop 0
    buffer_load_dwordx4 v26, s[44:47], s82 offen lds
    v_cvt_pk_bf16_f32 v155, v142, v143
    v_cvt_pk_bf16_f32 v156, v144, v145
    v_cvt_pk_bf16_f32 v157, v146, v147
    v_cvt_pk_bf16_f32 v158, v148, v149
    v_cvt_pk_bf16_f32 v159, v150, v151
    v_cvt_pk_bf16_f32 v160, v120, v121
    v_cvt_pk_bf16_f32 v161, v122, v123
    v_cvt_pk_bf16_f32 v162, v124, v125
    v_cvt_pk_bf16_f32 v163, v126, v127
    v_cvt_pk_bf16_f32 v164, v128, v129
    v_cvt_pk_bf16_f32 v165, v130, v131
    v_cvt_pk_bf16_f32 v166, v132, v133
    v_cvt_pk_bf16_f32 v167, v134, v135
    s_branch SCHK_20
SPOLL_19:
    s_load_dwordx2 s[24:25], s[32:33], s92 offset:512 glc
SCHK_20:
    s_add_u32 s5, s5, 1
    s_cmp_ge_u32 s5, 200000
    s_waitcnt lgkmcnt(0)
    s_cbranch_scc1 SDONE_21
    s_cmp_lg_u32 s24, s4
    s_cbranch_scc1 SPOLL_19
    s_cmp_lg_u32 s25, s4
    s_cbranch_scc1 SPOLL_19
SDONE_21:
    s_barrier
    buffer_load_dwordx4 v[184:187], v47, s[32:35], s13 offen sc1
    buffer_load_dwordx4 v[188:191], v47, s[32:35], s14 offen sc1
    buffer_load_dwordx4 v[192:195], v2, s[32:35], s16 offen sc1
    s_lshl_b32 s96, s3, 5
    s_add_u32 s14, s96, 155648
    v_and_b32 v6, 3, v1
    v_lshl_add_u32 v6, v6, 3, s14
    v_lshrrev_b32 v9, 5, v1
    v_lshl_add_u32 v6, v9, 2, v6
    s_lshl_b32 s96, s3, 10
    s_add_u32 s14, s96, 147456
    v_and_b32 v5, 15, v1
    v_lshl_add_u32 v5, v5, 4, s14
    v_lshrrev_b32 v9, 5, v1
    v_lshl_add_u32 v5, v9, 9, v5
    v_bfe_u32 v9, v1, 4, 1
    v_lshl_add_u32 v5, v9, 3, v5
    s_lshl_b32 s96, s76, 7
    s_add_u32 s14, s96, 155648
    v_lshrrev_b32 v7, 5, v1
    v_lshl_add_u32 v7, v7, 4, s14
    s_lshl_b32 s96, s76, 12
    s_add_u32 s14, s96, 147456
    v_add_u32 v44, s14, v2
    s_cmp_lt_u32 s3, 4
    s_cbranch_scc1 L_HG1
    v_lshlrev_b32 v52, 16, v88
    v_and_b32 v53, s6, v88
    v_pk_mul_f32 v[196:197], v[36:37], v[52:53] op_sel:[0,0] op_sel_hi:[0,1]
    v_lshlrev_b32 v54, 16, v89
    v_and_b32 v55, s6, v89
    v_pk_mul_f32 v[198:199], v[36:37], v[54:55] op_sel:[0,0] op_sel_hi:[0,1]
    v_lshlrev_b32 v52, 16, v90
    v_and_b32 v53, s6, v90
    v_pk_mul_f32 v[200:201], v[36:37], v[52:53] op_sel:[0,0] op_sel_hi:[0,1]
    v_lshlrev_b32 v54, 16, v91
    v_and_b32 v55, s6, v91
    v_pk_mul_f32 v[202:203], v[36:37], v[54:55] op_sel:[0,0] op_sel_hi:[0,1]
    v_lshlrev_b32 v52, 16, v92
    v_and_b32 v53, s6, v92
    v_pk_fma_f32 v[196:197], v[36:37], v[52:53], v[196:197] op_sel:[1,0,0] op_sel_hi:[1,1,1]
    v_lshlrev_b32 v54, 16, v93
    v_and_b32 v55, s6, v93
    v_pk_fma_f32 v[198:199], v[36:37], v[54:55], v[198:199] op_sel:[1,0,0] op_sel_hi:[1,1,1]
    v_lshlrev_b32 v52, 16, v94
    v_and_b32 v53, s6, v94
    v_pk_fma_f32 v[200:201], v[36:37], v[52:53], v[200:201] op_sel:[1,0,0] op_sel_hi:[1,1,1]
    v_lshlrev_b32 v54, 16, v95
    v_and_b32 v55, s6, v95
    v_pk_fma_f32 v[202:203], v[36:37], v[54:55], v[202:203] op_sel:[1,0,0] op_sel_hi:[1,1,1]
    v_lshlrev_b32 v52, 16, v96
    v_and_b32 v53, s6, v96
    v_pk_fma_f32 v[196:197], v[38:39], v[52:53], v[196:197] op_sel:[0,0,0] op_sel_hi:[0,1,1]
    v_lshlrev_b32 v54, 16, v97
    v_and_b32 v55, s6, v97
    v_pk_fma_f32 v[198:199], v[38:39], v[54:55], v[198:199] op_sel:[0,0,0] op_sel_hi:[0,1,1]
    v_lshlrev_b32 v52, 16, v98
    v_and_b32 v53, s6, v98
    v_pk_fma_f32 v[200:201], v[38:39], v[52:53], v[200:201] op_sel:[0,0,0] op_sel_hi:[0,1,1]
    v_lshlrev_b32 v54, 16, v99
    v_and_b32 v55, s6, v99
    v_pk_fma_f32 v[202:203], v[38:39], v[54:55], v[202:203] op_sel:[0,0,0] op_sel_hi:[0,1,1]
    v_lshlrev_b32 v52, 16, v100
    v_and_b32 v53, s6, v100
    v_pk_fma_f32 v[196:197], v[38:39], v[52:53], v[196:197] op_sel:[1,0,0] op_sel_hi:[1,1,1]
    v_lshlrev_b32 v54, 16, v101
    v_and_b32 v55, s6, v101
    v_pk_fma_f32 v[198:199], v[38:39], v[54:55], v[198:199] op_sel:[1,0,0] op_sel_hi:[1,1,1]
    v_lshlrev_b32 v52, 16, v102
    v_and_b32 v53, s6, v102
    v_pk_fma_f32 v[200:201], v[38:39], v[52:53], v[200:201] op_sel:[1,0,0] op_sel_hi:[1,1,1]
    v_lshlrev_b32 v54, 16, v103
    v_and_b32 v55, s6, v103
    v_pk_fma_f32 v[202:203], v[38:39], v[54:55], v[202:203] op_sel:[1,0,0] op_sel_hi:[1,1,1]
    v_lshlrev_b32 v52, 16, v104
    v_and_b32 v53, s6, v104
    v_pk_fma_f32 v[196:197], v[40:41], v[52:53], v[196:197] op_sel:[0,0,0] op_sel_hi:[0,1,1]
    v_lshlrev_b32 v54, 16, v105
    v_and_b32 v55, s6, v105
    v_pk_fma_f32 v[198:199], v[40:41], v[54:55], v[198:199] op_sel:[0,0,0] op_sel_hi:[0,1,1]
    v_lshlrev_b32 v52, 16, v106
    v_and_b32 v53, s6, v106
    v_pk_fma_f32 v[200:201], v[40:41], v[52:53], v[200:201] op_sel:[0,0,0] op_sel_hi:[0,1,1]
    v_lshlrev_b32 v54, 16, v107
    v_and_b32 v55, s6, v107
    v_pk_fma_f32 v[202:203], v[40:41], v[54:55], v[202:203] op_sel:[0,0,0] op_sel_hi:[0,1,1]
    v_lshlrev_b32 v52, 16, v108
    v_and_b32 v53, s6, v108
    v_pk_fma_f32 v[196:197], v[40:41], v[52:53], v[196:197] op_sel:[1,0,0] op_sel_hi:[1,1,1]
    v_lshlrev_b32 v54, 16, v109
    v_and_b32 v55, s6, v109
    v_pk_fma_f32 v[198:199], v[40:41], v[54:55], v[198:199] op_sel:[1,0,0] op_sel_hi:[1,1,1]
    v_lshlrev_b32 v52, 16, v110
    v_and_b32 v53, s6, v110
    v_pk_fma_f32 v[200:201], v[40:41], v[52:53], v[200:201] op_sel:[1,0,0] op_sel_hi:[1,1,1]
    v_lshlrev_b32 v54, 16, v111
    v_and_b32 v55, s6, v111
    v_pk_fma_f32 v[202:203], v[40:41], v[54:55], v[202:203] op_sel:[1,0,0] op_sel_hi:[1,1,1]
    v_lshlrev_b32 v52, 16, v112
    v_and_b32 v53, s6, v112
    v_pk_fma_f32 v[196:197], v[42:43], v[52:53], v[196:197] op_sel:[0,0,0] op_sel_hi:[0,1,1]
    v_lshlrev_b32 v54, 16, v113
    v_and_b32 v55, s6, v113
    v_pk_fma_f32 v[198:199], v[42:43], v[54:55], v[198:199] op_sel:[0,0,0] op_sel_hi:[0,1,1]
    v_lshlrev_b32 v52, 16, v114
    v_and_b32 v53, s6, v114
    v_pk_fma_f32 v[200:201], v[42:43], v[52:53], v[200:201] op_sel:[0,0,0] op_sel_hi:[0,1,1]
    v_lshlrev_b32 v54, 16, v115
    v_and_b32 v55, s6, v115
    v_pk_fma_f32 v[202:203], v[42:43], v[54:55], v[202:203] op_sel:[0,0,0] op_sel_hi:[0,1,1]
    v_lshlrev_b32 v52, 16, v116
    v_and_b32 v53, s6, v116
    v_pk_fma_f32 v[196:197], v[42:43], v[52:53], v[196:197] op_sel:[1,0,0] op_sel_hi:[1,1,1]
    v_lshlrev_b32 v54, 16, v117
    v_and_b32 v55, s6, v117
    v_pk_fma_f32 v[198:199], v[42:43], v[54:55], v[198:199] op_sel:[1,0,0] op_sel_hi:[1,1,1]
    v_lshlrev_b32 v52, 16, v118
    v_and_b32 v53, s6, v118
    v_pk_fma_f32 v[200:201], v[42:43], v[52:53], v[200:201] op_sel:[1,0,0] op_sel_hi:[1,1,1]
    v_lshlrev_b32 v54, 16, v119
    v_and_b32 v55, s6, v119
    v_pk_fma_f32 v[202:203], v[42:43], v[54:55], v[202:203] op_sel:[1,0,0] op_sel_hi:[1,1,1]
    v_permlane32_swap_b32 v196, v200
    v_permlane32_swap_b32 v197, v201
    v_permlane32_swap_b32 v198, v202
    v_permlane32_swap_b32 v199, v203
    v_add_f32 v196, v196, v200
    v_add_f32 v197, v197, v201
    v_add_f32 v198, v198, v202
    v_add_f32 v199, v199, v203
    s_nop 0
    v_permlane16_swap_b32 v196, v198
    v_permlane16_swap_b32 v197, v199
    v_add_f32 v196, v196, v198
    v_add_f32 v197, v197, v199
    s_nop 0
    v_add_f32_dpp v196, v196, v196 row_ror:8 row_mask:0xf bank_mask:0xf
    v_add_f32_dpp v197, v197, v197 row_ror:8 row_mask:0xf bank_mask:0xf
    s_nop 1
    v_mov_b32_dpp v196, v197 quad_perm:[0,1,2,3] row_mask:0xf bank_mask:0xc
    ds_write_b32 v252, v196 offset:9984
L_HG1:
    s_waitcnt vmcnt(1)
    v_pk_add_f32 v[184:185], v[184:185], v[188:189]
    v_pk_add_f32 v[186:187], v[186:187], v[190:191]
    s_nop 1
    v_permlane32_swap_b32 v184, v186
    v_permlane32_swap_b32 v185, v187
    v_pk_add_f32 v[184:185], v[184:185], v[186:187]
    s_nop 1
    v_add_f32_dpp v184, v184, v184 row_ror:8 row_mask:0xf bank_mask:0xf
    v_add_f32_dpp v185, v185, v185 row_ror:8 row_mask:0xf bank_mask:0xf
    v_mov_b32 v186, v184
    v_mov_b32 v187, v185
    s_nop 0
    v_permlane16_swap_b32 v184, v186
    v_permlane16_swap_b32 v185, v187
    v_pk_add_f32 v[184:185], v[184:185], v[186:187]
    v_cvt_pk_bf16_f32 v184, v184, v185
    v_mov_b32 v185, s4
    s_mov_b32 exec_lo, 0xff
    s_mov_b32 exec_hi, 0xff
    buffer_store_dwordx2 v[184:185], v48, s[32:35], s15 offen sc1
    s_mov_b64 exec, -1
    s_waitcnt lgkmcnt(0)
    s_barrier
    s_cmp_lg_u32 s3, 0
    s_cbranch_scc1 L_PC2
    v_mov_b32 v45, s4
    s_mov_b32 exec_hi, 0
    s_mov_b32 exec_lo, 65535
    buffer_store_dword v45, v46, s[32:35], s17 offen sc1
    s_mov_b64 exec, -1
L_PC2:
    s_cmp_lg_u32 s3, 3
    s_cbranch_scc1 L_M2F
    ds_read_b128 v[196:199], v251 offset:10000
    s_lshr_b32 s96, s8, 2
    s_lshl1_add_u32 s97, s9, s96
    s_and_b32 s98, s8, 3
    s_lshl2_add_u32 s99, s97, s98
    s_lshl_b32 s96, s99, 9
    s_add_u32 s18, s96, 131072
    s_waitcnt lgkmcnt(0)
    v_add_f32 v196, v196, v197
    v_add_f32 v198, v198, v199
    v_mov_b32 v197, s4
    v_add_f32 v196, v196, v198
    buffer_store_dwordx2 v[196:197], v250, s[32:35], s18 offen sc1
L_M2F:
    s_waitcnt vmcnt(1)
    s_xor_b32 s96, s95, 262144
    s_add_u32 s82, s96, s90
    s_add_u32 m0, s83, 16384
    s_nop 0
    buffer_load_dwordx4 v26, s[44:47], s82 offen lds
    v_permlane32_swap_b32 v192, v194
    v_permlane32_swap_b32 v193, v195
    v_pk_add_f32 v[192:193], v[192:193], v[194:195]
    s_nop 1
    v_add_f32_dpp v192, v192, v192 row_ror:4 row_mask:0xf bank_mask:0xf
    s_xor_b32 s96, s95, 393216
    s_add_u32 s82, s96, s90
    s_add_u32 m0, s83, 24576
    s_nop 0
    buffer_load_dwordx4 v26, s[44:47], s82 offen lds
    v_add_f32_dpp v193, v193, v193 row_ror:4 row_mask:0xf bank_mask:0xf
    v_add_f32_dpp v192, v192, v192 row_ror:8 row_mask:0xf bank_mask:0xf
    s_nop 0
    v_add_f32_dpp v193, v193, v193 row_ror:8 row_mask:0xf bank_mask:0xf
    s_xor_b32 s96, s95, 524288
    s_add_u32 s82, s96, s90
    s_add_u32 m0, s83, 32768
    s_nop 0
    buffer_load_dwordx4 v26, s[44:47], s82 offen lds
    v_mov_b32 v194, v192
    v_mov_b32 v195, v193
    s_nop 0
    v_permlane16_swap_b32 v192, v194
    s_xor_b32 s96, s95, 655360
    s_add_u32 s82, s96, s90
    s_add_u32 m0, s83, 40960
    s_nop 0
    buffer_load_dwordx4 v26, s[44:47], s82 offen lds
    v_permlane16_swap_b32 v193, v195
    v_pk_add_f32 v[192:193], v[192:193], v[194:195]
    v_cvt_pk_bf16_f32 v192, v192, v193
    ds_write_b32 v6, v192
    s_waitcnt lgkmcnt(0)
    s_barrier
    ds_read_b128 v[196:199], v7
    ds_read_b128 v[200:203], v7 offset:32
    ds_read_b128 v[204:207], v7 offset:64
    ds_read_b128 v[208:211], v7 offset:96
    s_lshr_b32 s96, s8, 2
    s_lshl1_add_u32 s97, s9, s96
    s_and_b32 s98, s8, 3
    s_lshl2_add_u32 s99, s97, s98
    s_lshl_b32 s96, s99, 9
    s_add_u32 s18, s96, 131072
    s_waitcnt lgkmcnt(0)
    s_lshl3_add_u32 s96, s11, s3
    s_lshl_b32 s97, s96, 11
    s_add_u32 s13, s97, 29360128
    s_load_dwordx2 s[24:25], s[32:33], s92 offset:3584 glc
    v_mfma_f32_32x32x16_bf16 v[136:151], v[196:199], v[152:155], 0
    v_mfma_f32_32x32x16_bf16 v[136:151], v[200:203], v[156:159], v[136:151]
L_PAD7:
    s_cbranch_execz L_RET7
    v_mfma_f32_32x32x16_bf16 v[136:151], v[204:207], v[160:163], v[136:151]
    v_mfma_f32_32x32x16_bf16 v[136:151], v[208:211], v[164:167], v[136:151]
    s_nop 11
    v_cvt_pk_bf16_f32 v136, 0, v136
    v_add_f32 v136, 0x358637bd, v136
    v_cvt_pk_bf16_f32 v136, 0, v136
    v_rcp_f32 v136, v136
    s_branch SCHK_23
SPOLL_22:
    s_load_dwordx2 s[24:25], s[32:33], s92 offset:3584 glc
SCHK_23:
    s_add_u32 s5, s5, 1
    s_cmp_ge_u32 s5, 200000
    s_waitcnt lgkmcnt(0)
    s_cbranch_scc1 SDONE_24
    s_cmp_lg_u32 s24, s4
    s_cbranch_scc1 SPOLL_22
    s_cmp_lg_u32 s25, s4
    s_cbranch_scc1 SPOLL_22
SDONE_24:
    buffer_load_dwordx4 v[228:231], v2, s[32:35], s13 offen sc1
    buffer_load_dwordx4 v[232:235], v2, s[32:35], s13 offen offset:1024 sc1
    s_waitcnt vmcnt(0)
    v_bitop3_b32 v4, v229, v231, s4 bitop3:0x7e
    v_bitop3_b32 v4, v4, v233, s4 bitop3:0xf6
    v_bitop3_b32 v4, v4, v235, s4 bitop3:0xf6
    v_cmp_ne_u32 vcc, 0, v4
    s_cbranch_vccz TOK_26
POLL_27:
    buffer_load_dwordx4 v[228:231], v2, s[32:35], s13 offen sc1
    buffer_load_dwordx4 v[232:235], v2, s[32:35], s13 offen offset:1024 sc1
    s_waitcnt vmcnt(0)
    v_bitop3_b32 v4, v229, v231, s4 bitop3:0x7e
    v_bitop3_b32 v4, v4, v233, s4 bitop3:0xf6
    v_bitop3_b32 v4, v4, v235, s4 bitop3:0xf6
    v_cmp_ne_u32 vcc, 0, v4
    s_cbranch_vccz PDONE_28
    s_add_u32 s5, s5, 1
    s_cmp_lt_u32 s5, 200000
    s_cbranch_scc1 POLL_27
PDONE_28:
TOK_26:
    ds_write2_b32 v5, v228, v230 offset0:0 offset1:1
    ds_write2_b32 v5, v232, v234 offset0:64 offset1:65
    s_waitcnt lgkmcnt(0)
    s_barrier
    ds_read_b128 v[212:215], v44
    ds_read_b128 v[216:219], v44 offset:1024
    ds_read_b128 v[220:223], v44 offset:2048
    ds_read_b128 v[224:227], v44 offset:3072
    s_lshl_b32 s96, s77, 1
    s_lshl3_add_u32 s97, s10, s96
    s_lshl_b32 s98, s97, 5
    s_lshl1_add_u32 s99, s11, s98
    s_add_u32 s96, s99, s76
    s_lshl_b32 s97, s96, 10
    s_add_u32 s13, s97, 8388608
    v_and_b32 v47, 15, v1
    v_lshlrev_b32 v47, 4, v47
    v_bfe_u32 v9, v1, 4, 1
    v_lshl_add_u32 v47, v9, 15, v47
    v_lshrrev_b32 v9, 5, v1
    v_lshl_add_u32 v47, v9, 8, v47
    s_waitcnt lgkmcnt(3)
    v_mfma_f32_32x32x16_bf16 v[120:135], v[212:215], v[152:155], 0
    s_waitcnt lgkmcnt(2)
    v_mfma_f32_32x32x16_bf16 v[120:135], v[216:219], v[156:159], v[120:135]
    s_waitcnt lgkmcnt(1)
    v_mfma_f32_32x32x16_bf16 v[120:135], v[220:223], v[160:163], v[120:135]
    s_waitcnt lgkmcnt(0)
    v_mfma_f32_32x32x16_bf16 v[120:135], v[224:227], v[164:167], v[120:135]
    s_lshr_b32 s96, s3, 1
    s_lshl4_add_u32 s97, s96, s12
    s_lshl_b32 s98, s97, 11
    s_and_b32 s99, s3, 1
    s_lshl_b32 s96, s99, 10
    s_add_u32 s97, s98, s96
    s_add_u32 s18, s97, 131072
    s_lshl_b32 s19, s12, 7
    v_and_b32 v44, 3, v1
    v_lshl_add_u32 v44, v44, 1, s19
    v_lshrrev_b32 v9, 5, v1
    v_lshl_add_u32 v44, v9, 3, v44
    v_bfe_u32 v9, v1, 4, 1
    v_lshl_add_u32 v44, v9, 4, v44
    v_bfe_u32 v9, v1, 2, 2
    v_lshl_add_u32 v44, v9, 5, v44
    global_load_ushort v32, v44, s[78:79]
    v_cvt_pk_bf16_f32 v120, 0, v120
    v_cvt_pk_bf16_f32 v121, 0, v121
    v_cvt_pk_bf16_f32 v122, 0, v122
    v_cvt_pk_bf16_f32 v123, 0, v123
    v_cvt_pk_bf16_f32 v124, 0, v124
    v_cvt_pk_bf16_f32 v125, 0, v125
    v_cvt_pk_bf16_f32 v126, 0, v126
    v_cvt_pk_bf16_f32 v127, 0, v127
    v_pk_mul_f32 v[120:121], v[120:121], v[136:137] op_sel_hi:[1,0]
    v_pk_mul_f32 v[122:123], v[122:123], v[136:137] op_sel_hi:[1,0]
    v_pk_mul_f32 v[124:125], v[124:125], v[136:137] op_sel_hi:[1,0]
    v_pk_mul_f32 v[126:127], v[126:127], v[136:137] op_sel_hi:[1,0]
    v_cvt_pk_bf16_f32 v168, v120, v121
    v_cvt_pk_bf16_f32 v169, v122, v123
    v_cvt_pk_bf16_f32 v170, v124, v125
    v_cvt_pk_bf16_f32 v171, v126, v127
    buffer_store_dwordx4 v[168:171], v47, s[32:35], s13 offen sc1
    v_cvt_pk_bf16_f32 v128, 0, v128
    v_cvt_pk_bf16_f32 v129, 0, v129
    v_cvt_pk_bf16_f32 v130, 0, v130
    v_cvt_pk_bf16_f32 v131, 0, v131
    v_cvt_pk_bf16_f32 v132, 0, v132
    v_cvt_pk_bf16_f32 v133, 0, v133
    v_cvt_pk_bf16_f32 v134, 0, v134
    v_cvt_pk_bf16_f32 v135, 0, v135
    v_pk_mul_f32 v[128:129], v[128:129], v[136:137] op_sel_hi:[1,0]
    v_pk_mul_f32 v[130:131], v[130:131], v[136:137] op_sel_hi:[1,0]
    v_pk_mul_f32 v[132:133], v[132:133], v[136:137] op_sel_hi:[1,0]
    v_pk_mul_f32 v[134:135], v[134:135], v[136:137] op_sel_hi:[1,0]
    v_cvt_pk_bf16_f32 v172, v128, v129
    v_cvt_pk_bf16_f32 v173, v130, v131
    v_cvt_pk_bf16_f32 v174, v132, v133
    v_cvt_pk_bf16_f32 v175, v134, v135
    buffer_store_dwordx4 v[172:175], v47, s[32:35], s13 offen offset:512 sc1
    buffer_load_dwordx4 v[28:31], v2, s[32:35], s18 offen sc1
    v_mov_b32 v50, -1
    v_mov_b32 v51, -1
    v_mov_b32 v52, -1
    v_mov_b32 v53, -1
    s_lshl3_add_u32 s96, s21, s3
    s_lshl4_add_u32 s97, s96, s12
    s_lshl_b32 s98, s97, 8
    s_add_u32 s19, s98, 12582912
    v_lshlrev_b32 v54, 2, v1
    buffer_store_dword v50, v54, s[32:35], s19 offen sc1
    s_lshl_b32 s96, s21, 14
    s_lshl_b32 s97, s12, 9
    s_add_u32 s98, s96, s97
    s_add_u32 s19, s98, 13631488
    v_and_b32 v54, 31, v1
    v_lshlrev_b32 v54, 4, v54
    v_lshrrev_b32 v55, 5, v1
    v_lshl_add_u32 v54, v55, 13, v54
    s_cmp_lg_u32 s3, 5
    s_cbranch_scc1 L_NOPO
    buffer_store_dwordx4 v[50:53], v54, s[32:35], s19 offen sc1
L_NOPO:
    v_bfe_u32 v36, v1, 2, 2
    v_lshlrev_b32 v36, 7, v36
    v_lshrrev_b32 v9, 4, v1
    v_lshl_add_u32 v36, v9, 10, v36
    v_and_b32 v9, 1, v1
    v_lshl_add_u32 v36, v9, 4, v36
    v_bfe_u32 v9, v1, 1, 1
    v_lshl_add_u32 v36, v9, 3, v36
    v_bfe_u32 v9, v1, 3, 2
    v_lshl_add_u32 v36, v9, 5, v36
    s_and_b32 s96, s9, 1
    s_lshl_b32 s97, s96, 2
    s_xor_b32 s98, s3, s97
    s_lshl_b32 s17, s98, 12
    s_lshl_b32 s96, s17, 2
    s_lshr_b32 s97, s95, 4
    s_xor_b32 s14, s96, s97
    v_add_u32 v36, s14, v36
    v_xor_b32 v37, 32, v36
    v_xor_b32 v38, 64, v36
    v_xor_b32 v39, 96, v36
    v_and_b32 v5, 7, v1
    v_lshlrev_b32 v5, 15, v5
    v_bfe_u32 v9, v1, 3, 1
    v_lshl_add_u32 v5, v9, 12, v5
    s_and_b32 s96, s11, 1
    s_lshr_b32 s97, s10, 2
    s_and_b32 s98, s10, 3
    s_lshl_b32 s99, s98, 6
    s_lshl1_add_u32 s98, s97, s99
    s_lshl_b32 s97, s98, 12
    s_lshr_b32 s99, s11, 1
    s_lshl_b32 s98, s99, 6
    s_add_u32 s99, s97, s98
    s_lshl2_add_u32 s97, s96, s99
    s_add_u32 s98, s97, 1048576
    s_add_u32 s15, s98, 1024
    v_lshlrev_b32 v152, 16, v12
    v_and_b32 v153, s6, v12
    v_lshlrev_b32 v154, 16, v13
    v_and_b32 v155, s6, v13
    v_lshlrev_b32 v156, 16, v14
    v_and_b32 v157, s6, v14
    v_lshlrev_b32 v158, 16, v15
    v_and_b32 v159, s6, v15
    v_lshlrev_b32 v160, 16, v16
    v_and_b32 v161, s6, v16
    v_lshlrev_b32 v162, 16, v17
    v_and_b32 v163, s6, v17
    v_lshlrev_b32 v164, 16, v18
    v_and_b32 v165, s6, v18
    v_lshlrev_b32 v166, 16, v19
    v_and_b32 v167, s6, v19
    s_lshl3_add_u32 s96, s21, s3
    s_lshl_b32 s97, s96, 15
    s_add_u32 s19, s97, 8388608
    s_and_b32 s96, s3, 1
    s_lshr_b32 s97, s3, 1
    s_lshl_b32 s98, s97, 10
    s_lshl3_add_u32 s99, s96, s98
    s_add_u32 s14, s99, 159744
    v_and_b32 v4, 31, v1
    v_lshl_add_u32 v4, v4, 5, s14
    v_lshrrev_b32 v9, 5, v1
    v_lshl_add_u32 v4, v9, 2, v4
    v_and_b32 v7, 3, v1
    v_lshlrev_b32 v7, 4, v7
    v_lshrrev_b32 v9, 5, v1
    v_lshl_add_u32 v7, v9, 6, v7
    v_bfe_u32 v9, v1, 4, 1
    v_lshl_add_u32 v7, v9, 7, v7
    v_bfe_u32 v9, v1, 2, 2
    v_lshl_add_u32 v7, v9, 8, v7
    v_add_u32 v7, 159744, v7
    s_waitcnt vmcnt(2)
    s_waitcnt lgkmcnt(0)
    s_barrier
    s_cmp_lg_u32 s3, 0
    s_cbranch_scc1 L_PD
    v_mov_b32 v6, s4
    s_mov_b32 exec_hi, 0
    s_mov_b32 exec_lo, 65535
    buffer_store_dword v6, v5, s[32:35], s15 offen sc1
    s_mov_b64 exec, -1
L_PD:
    s_waitcnt vmcnt(1)
    v_bitop3_b32 v6, v29, v31, s4 bitop3:0x7e
    v_cmp_ne_u32 vcc, 0, v6
    s_cbranch_vccz L_MGOK
POLL_29:
    buffer_load_dwordx4 v[28:31], v2, s[32:35], s18 offen sc1
    s_waitcnt vmcnt(0)
    v_bitop3_b32 v6, v29, v31, s4 bitop3:0x7e
    v_cmp_ne_u32 vcc, 0, v6
    s_cbranch_vccz PDONE_30
    s_add_u32 s5, s5, 1
    s_cmp_lt_u32 s5, 200000
    s_cbranch_scc1 POLL_29
PDONE_30:
L_MGOK:
    ds_write2_b32 v4, v28, v30 offset0:0 offset1:4
    s_waitcnt lgkmcnt(0)
    s_barrier
    s_lshl_b32 s96, s2, 12
    s_lshr_b32 s97, s17, 6
    s_add_u32 s98, s96, s97
    s_add_u32 s99, s98, 1048576
    s_add_u32 s18, s99, 1024
    ds_read_b128 v[192:195], v7
    ds_read_b128 v[196:199], v7 offset:1024
    ds_read_b128 v[200:203], v7 offset:2048
    ds_read_b128 v[204:207], v7 offset:3072
    v_and_b32 v8, 3, v1
    v_lshlrev_b32 v8, 2, v8
    v_lshrrev_b32 v9, 5, v1
    v_lshl_add_u32 v8, v9, 4, v8
    v_bfe_u32 v9, v1, 4, 1
    v_lshl_add_u32 v8, v9, 5, v8
    v_bfe_u32 v9, v1, 2, 2
    v_lshl_add_u32 v8, v9, 6, v8
    v_add_u32 v8, 157184, v8
    s_lshl4_add_u32 s96, s21, s12
    s_lshl_b32 s97, s96, 6
    s_add_u32 s13, s97, 14155776
    s_waitcnt lgkmcnt(0)
    s_load_dwordx2 s[24:25], s[32:33], s18 offset:0 glc
    v_pk_add_f32 v[192:193], v[192:193], v[194:195]
    v_add_f32 v28, v192, v193
    v_pk_add_f32 v[196:197], v[196:197], v[198:199]
    v_add_f32 v29, v196, v197
    v_pk_add_f32 v[200:201], v[200:201], v[202:203]
    v_add_f32 v30, v200, v201
    v_pk_add_f32 v[204:205], v[204:205], v[206:207]
    v_add_f32 v31, v204, v205
    v_cvt_pk_bf16_f32 v28, 0, v28
    v_cvt_pk_bf16_f32 v29, 0, v29
    v_cvt_pk_bf16_f32 v30, 0, v30
    v_cvt_pk_bf16_f32 v31, 0, v31
    v_add_f32 v30, 1.0, v30
    v_lshlrev_b32 v32, 16, v32
    v_cvt_pk_bf16_f32 v30, 0, v30
    ds_write_b32 v8, v31
    v_mul_f32 v192, v30, v32
    v_cvt_pk_bf16_f32 v193, 0, v192
    v_sub_f32 v194, v192, v193
    v_add_f32_dpp v192, v192, v192 quad_perm:[1,0,3,2] row_mask:0xf bank_mask:0xf
    s_nop 1
    v_add_f32_dpp v192, v192, v192 quad_perm:[2,3,0,1] row_mask:0xf bank_mask:0xf
    s_nop 1
    v_add_f32_dpp v192, v192, v192 row_half_mirror row_mask:0xf bank_mask:0xf
    s_nop 1
    v_add_f32_dpp v192, v192, v192 row_ror:8 row_mask:0xf bank_mask:0xf
    v_mov_b32 v199, v192
    s_nop 1
    v_permlane16_swap_b32 v192, v199
    v_add_f32 v192, v192, v199
    v_mov_b32 v199, v192
    s_nop 1
    v_permlane32_swap_b32 v192, v199
    v_add_f32 v192, v192, v199
    v_mov_b32_dpp v196, v193 row_shl:1 row_mask:0xf bank_mask:0xf
    v_mov_b32_dpp v197, v194 row_shl:1 row_mask:0xf bank_mask:0xf
    v_mov_b32_dpp v198, v32 row_shl:1 row_mask:0xf bank_mask:0xf
    v_cvt_pk_bf16_f32 v196, v193, v196
    v_cvt_pk_bf16_f32 v197, v194, v197
    v_cvt_pk_bf16_f32 v198, v32, v198
    v_mov_b32 v193, s4
    v_mov_b32 v194, 0
    s_cmp_lg_u32 s3, 2
    s_cbranch_scc1 L_NOUP
    s_mov_b64 exec, 1
    buffer_store_dwordx2 v[192:193], v194, s[32:35], s13 offen sc1
    s_mov_b64 exec, -1
L_NOUP:
    v_mov_b32 v184, 0x3f803f80
    s_nop 1
    v_mov_b32_dpp v184, v196 row_newbcast:0 row_mask:0xf bank_mask:0x2
    s_nop 1
    v_mov_b32_dpp v184, v197 row_newbcast:0 row_mask:0xf bank_mask:0x4
    s_nop 1
    v_mov_b32_dpp v184, v198 row_newbcast:0 row_mask:0xf bank_mask:0x8
    v_mov_b32 v185, 0x3f803f80
    s_nop 1
    v_mov_b32_dpp v185, v196 row_newbcast:2 row_mask:0xf bank_mask:0x2
    s_nop 1
    v_mov_b32_dpp v185, v197 row_newbcast:2 row_mask:0xf bank_mask:0x4
    s_nop 1
    v_mov_b32_dpp v185, v198 row_newbcast:2 row_mask:0xf bank_mask:0x8
    v_mov_b32 v186, 0x3f803f80
    s_nop 1
    v_mov_b32_dpp v186, v196 row_newbcast:4 row_mask:0xf bank_mask:0x2
    s_nop 1
    v_mov_b32_dpp v186, v197 row_newbcast:4 row_mask:0xf bank_mask:0x4
    s_nop 1
    v_mov_b32_dpp v186, v198 row_newbcast:4 row_mask:0xf bank_mask:0x8
    v_mov_b32 v187, 0x3f803f80
    s_nop 1
    v_mov_b32_dpp v187, v196 row_newbcast:6 row_mask:0xf bank_mask:0x2
    s_nop 1
    v_mov_b32_dpp v187, v197 row_newbcast:6 row_mask:0xf bank_mask:0x4
    s_nop 1
    v_mov_b32_dpp v187, v198 row_newbcast:6 row_mask:0xf bank_mask:0x8
    v_mov_b32 v188, 0x3f803f80
    s_nop 1
    v_mov_b32_dpp v188, v196 row_newbcast:8 row_mask:0xf bank_mask:0x2
    s_nop 1
    v_mov_b32_dpp v188, v197 row_newbcast:8 row_mask:0xf bank_mask:0x4
    s_nop 1
    v_mov_b32_dpp v188, v198 row_newbcast:8 row_mask:0xf bank_mask:0x8
    v_mov_b32 v189, 0x3f803f80
    s_nop 1
    v_mov_b32_dpp v189, v196 row_newbcast:10 row_mask:0xf bank_mask:0x2
    s_nop 1
    v_mov_b32_dpp v189, v197 row_newbcast:10 row_mask:0xf bank_mask:0x4
    s_nop 1
    v_mov_b32_dpp v189, v198 row_newbcast:10 row_mask:0xf bank_mask:0x8
    v_mov_b32 v190, 0x3f803f80
    s_nop 1
    v_mov_b32_dpp v190, v196 row_newbcast:12 row_mask:0xf bank_mask:0x2
    s_nop 1
    v_mov_b32_dpp v190, v197 row_newbcast:12 row_mask:0xf bank_mask:0x4
    s_nop 1
    v_mov_b32_dpp v190, v198 row_newbcast:12 row_mask:0xf bank_mask:0x8
    v_mov_b32 v191, 0x3f803f80
    s_nop 1
    v_mov_b32_dpp v191, v196 row_newbcast:14 row_mask:0xf bank_mask:0x2
    s_nop 1
    v_mov_b32_dpp v191, v197 row_newbcast:14 row_mask:0xf bank_mask:0x4
    s_nop 1
    v_mov_b32_dpp v191, v198 row_newbcast:14 row_mask:0xf bank_mask:0x8
    v_mov_b32 v42, v29
    v_mov_b32 v43, v31
    v_mov_b32 v33, v30
    v_mov_b32_dpp v136, v28 row_newbcast:0 row_mask:0xf bank_mask:0xf
    v_mov_b32_dpp v137, v28 row_newbcast:1 row_mask:0xf bank_mask:0xf
    v_mov_b32_dpp v138, v28 row_newbcast:2 row_mask:0xf bank_mask:0xf
    v_mov_b32_dpp v139, v28 row_newbcast:3 row_mask:0xf bank_mask:0xf
    v_mov_b32_dpp v140, v28 row_newbcast:4 row_mask:0xf bank_mask:0xf
    v_mov_b32_dpp v141, v28 row_newbcast:5 row_mask:0xf bank_mask:0xf
    v_mov_b32_dpp v142, v28 row_newbcast:6 row_mask:0xf bank_mask:0xf
    v_mov_b32_dpp v143, v28 row_newbcast:7 row_mask:0xf bank_mask:0xf
    v_mov_b32_dpp v144, v28 row_newbcast:8 row_mask:0xf bank_mask:0xf
    v_mov_b32_dpp v145, v28 row_newbcast:9 row_mask:0xf bank_mask:0xf
    v_mov_b32_dpp v146, v28 row_newbcast:10 row_mask:0xf bank_mask:0xf
    v_mov_b32_dpp v147, v28 row_newbcast:11 row_mask:0xf bank_mask:0xf
    v_mov_b32_dpp v148, v28 row_newbcast:12 row_mask:0xf bank_mask:0xf
    v_mov_b32_dpp v149, v28 row_newbcast:13 row_mask:0xf bank_mask:0xf
    v_mov_b32_dpp v150, v28 row_newbcast:14 row_mask:0xf bank_mask:0xf
    v_mov_b32_dpp v151, v28 row_newbcast:15 row_mask:0xf bank_mask:0xf
    s_branch SCHK_32
SPOLL_31:
    s_load_dwordx2 s[24:25], s[32:33], s18 offset:0 glc
SCHK_32:
    s_add_u32 s5, s5, 1
    s_cmp_ge_u32 s5, 200000
    s_waitcnt lgkmcnt(0)
    s_cbranch_scc1 SDONE_33
    s_cmp_lg_u32 s24, s4
    s_cbranch_scc1 SPOLL_31
    s_cmp_lg_u32 s25, s4
    s_cbranch_scc1 SPOLL_31
SDONE_33:
    s_add_u32 s20, s17, s19
    buffer_load_dwordx4 v[224:227], v2, s[32:35], s20 offen sc1
    ds_read_b64_tr_b16 v[192:193], v36
    ds_read_b64_tr_b16 v[194:195], v36 offset:512
    ds_read_b64_tr_b16 v[196:197], v37
    ds_read_b64_tr_b16 v[198:199], v37 offset:512
    ds_read_b64_tr_b16 v[200:201], v38
    ds_read_b64_tr_b16 v[202:203], v38 offset:512
    ds_read_b64_tr_b16 v[204:205], v39
    ds_read_b64_tr_b16 v[206:207], v39 offset:512
    ds_read_b64_tr_b16 v[208:209], v36 offset:4096
    ds_read_b64_tr_b16 v[210:211], v36 offset:4608
    ds_read_b64_tr_b16 v[212:213], v37 offset:4096
    ds_read_b64_tr_b16 v[214:215], v37 offset:4608
    ds_read_b64_tr_b16 v[216:217], v38 offset:4096
    ds_read_b64_tr_b16 v[218:219], v38 offset:4608
    buffer_load_dwordx4 v[228:231], v2, s[32:35], s20 offen offset:1024 sc1
    buffer_load_dwordx4 v[232:235], v2, s[32:35], s20 offen offset:2048 sc1
    buffer_load_dwordx4 v[236:239], v2, s[32:35], s20 offen offset:3072 sc1
    s_barrier
    s_xor_b32 s96, s17, 4096
    s_add_u32 s20, s96, s19
    buffer_load_dwordx4 v[240:243], v2, s[32:35], s20 offen sc1
    buffer_load_dwordx4 v[244:247], v2, s[32:35], s20 offen offset:1024 sc1
    buffer_load_dwordx4 v[44:47], v2, s[32:35], s20 offen offset:2048 sc1
    buffer_load_dwordx4 v[48:51], v2, s[32:35], s20 offen offset:3072 sc1
    s_lshl_b32 s96, s21, 10
    s_add_u32 s13, s96, 14155776
    v_and_b32 v10, 15, v1
    v_lshlrev_b32 v10, 6, v10
    s_cmp_lt_u32 s3, 4
    s_cbranch_scc1 L_G2P0
    s_setprio 1
L_G2P0:
    s_waitcnt vmcnt(7)
    s_waitcnt lgkmcnt(6)
    v_mfma_f32_16x16x32_bf16 v[120:123], v[192:195], v[224:227], 0
    ds_read_b64_tr_b16 v[220:221], v39 offset:4096
    ds_read_b64_tr_b16 v[222:223], v39 offset:4608
    v_mfma_f32_16x16x32_bf16 v[124:127], v[196:199], v[224:227], 0
    ds_read_b64_tr_b16 v[192:193], v36 offset:8192
    ds_read_b64_tr_b16 v[194:195], v36 offset:8704
    v_mfma_f32_16x16x32_bf16 v[128:131], v[200:203], v[224:227], 0
    ds_read_b64_tr_b16 v[196:197], v37 offset:8192
    ds_read_b64_tr_b16 v[198:199], v37 offset:8704
    v_mfma_f32_16x16x32_bf16 v[132:135], v[204:207], v[224:227], 0
    ds_read_b64_tr_b16 v[200:201], v38 offset:8192
    ds_read_b64_tr_b16 v[202:203], v38 offset:8704
    s_xor_b32 s96, s17, 8192
    s_add_u32 s20, s96, s19
    buffer_load_dwordx4 v[224:227], v2, s[32:35], s20 offen sc1
    s_waitcnt vmcnt(7)
    s_waitcnt lgkmcnt(6)
    v_mfma_f32_16x16x32_bf16 v[120:123], v[208:211], v[228:231], v[120:123]
    ds_read_b64_tr_b16 v[204:205], v39 offset:8192
    ds_read_b64_tr_b16 v[206:207], v39 offset:8704
    v_mfma_f32_16x16x32_bf16 v[124:127], v[212:215], v[228:231], v[124:127]
    ds_read_b64_tr_b16 v[208:209], v36 offset:12288
    ds_read_b64_tr_b16 v[210:211], v36 offset:12800
    v_xor_b32 v36, 16384, v36
    v_mfma_f32_16x16x32_bf16 v[128:131], v[216:219], v[228:231], v[128:131]
    ds_read_b64_tr_b16 v[212:213], v37 offset:12288
    ds_read_b64_tr_b16 v[214:215], v37 offset:12800
    v_xor_b32 v37, 16384, v37
    v_mfma_f32_16x16x32_bf16 v[132:135], v[220:223], v[228:231], v[132:135]
    ds_read_b64_tr_b16 v[216:217], v38 offset:12288
    ds_read_b64_tr_b16 v[218:219], v38 offset:12800
    v_xor_b32 v38, 16384, v38
    buffer_load_dwordx4 v[228:231], v2, s[32:35], s20 offen offset:1024 sc1
    s_waitcnt vmcnt(7)
    s_waitcnt lgkmcnt(6)
    v_mfma_f32_16x16x32_bf16 v[120:123], v[192:195], v[232:235], v[120:123]
    ds_read_b64_tr_b16 v[220:221], v39 offset:12288
    ds_read_b64_tr_b16 v[222:223], v39 offset:12800
    v_xor_b32 v39, 16384, v39
    v_mfma_f32_16x16x32_bf16 v[124:127], v[196:199], v[232:235], v[124:127]
    ds_read_b64_tr_b16 v[192:193], v36
    ds_read_b64_tr_b16 v[194:195], v36 offset:512
    v_mfma_f32_16x16x32_bf16 v[128:131], v[200:203], v[232:235], v[128:131]
    ds_read_b64_tr_b16 v[196:197], v37
    ds_read_b64_tr_b16 v[198:199], v37 offset:512
    v_mfma_f32_16x16x32_bf16 v[132:135], v[204:207], v[232:235], v[132:135]
    ds_read_b64_tr_b16 v[200:201], v38
    ds_read_b64_tr_b16 v[202:203], v38 offset:512
    buffer_load_dwordx4 v[232:235], v2, s[32:35], s20 offen offset:2048 sc1
    s_waitcnt vmcnt(7)
    s_waitcnt lgkmcnt(6)
    v_mfma_f32_16x16x32_bf16 v[120:123], v[208:211], v[236:239], v[120:123]
    ds_read_b64_tr_b16 v[204:205], v39
    ds_read_b64_tr_b16 v[206:207], v39 offset:512
    v_mfma_f32_16x16x32_bf16 v[124:127], v[212:215], v[236:239], v[124:127]
    ds_read_b64_tr_b16 v[208:209], v36 offset:4096
    ds_read_b64_tr_b16 v[210:211], v36 offset:4608
    v_mfma_f32_16x16x32_bf16 v[128:131], v[216:219], v[236:239], v[128:131]
    ds_read_b64_tr_b16 v[212:213], v37 offset:4096
    ds_read_b64_tr_b16 v[214:215], v37 offset:4608
    v_mfma_f32_16x16x32_bf16 v[132:135], v[220:223], v[236:239], v[132:135]
    ds_read_b64_tr_b16 v[216:217], v38 offset:4096
    ds_read_b64_tr_b16 v[218:219], v38 offset:4608
    buffer_load_dwordx4 v[236:239], v2, s[32:35], s20 offen offset:3072 sc1
    s_waitcnt vmcnt(7)
    s_waitcnt lgkmcnt(6)
    v_mfma_f32_16x16x32_bf16 v[120:123], v[192:195], v[240:243], v[120:123]
    ds_read_b64_tr_b16 v[220:221], v39 offset:4096
    ds_read_b64_tr_b16 v[222:223], v39 offset:4608
    v_mfma_f32_16x16x32_bf16 v[124:127], v[196:199], v[240:243], v[124:127]
    ds_read_b64_tr_b16 v[192:193], v36 offset:8192
    ds_read_b64_tr_b16 v[194:195], v36 offset:8704
    v_mfma_f32_16x16x32_bf16 v[128:131], v[200:203], v[240:243], v[128:131]
    ds_read_b64_tr_b16 v[196:197], v37 offset:8192
    ds_read_b64_tr_b16 v[198:199], v37 offset:8704
    v_mfma_f32_16x16x32_bf16 v[132:135], v[204:207], v[240:243], v[132:135]
    ds_read_b64_tr_b16 v[200:201], v38 offset:8192
    ds_read_b64_tr_b16 v[202:203], v38 offset:8704
    s_xor_b32 s96, s17, 12288
    s_add_u32 s20, s96, s19
    buffer_load_dwordx4 v[240:243], v2, s[32:35], s20 offen sc1
    s_waitcnt vmcnt(7)
    s_waitcnt lgkmcnt(6)
    v_mfma_f32_16x16x32_bf16 v[120:123], v[208:211], v[244:247], v[120:123]
    ds_read_b64_tr_b16 v[204:205], v39 offset:8192
    ds_read_b64_tr_b16 v[206:207], v39 offset:8704
    v_mfma_f32_16x16x32_bf16 v[124:127], v[212:215], v[244:247], v[124:127]
    ds_read_b64_tr_b16 v[208:209], v36 offset:12288
    ds_read_b64_tr_b16 v[210:211], v36 offset:12800
    v_xor_b32 v36, 49152, v36
    v_mfma_f32_16x16x32_bf16 v[128:131], v[216:219], v[244:247], v[128:131]
    ds_read_b64_tr_b16 v[212:213], v37 offset:12288
    ds_read_b64_tr_b16 v[214:215], v37 offset:12800
    v_xor_b32 v37, 49152, v37
    v_mfma_f32_16x16x32_bf16 v[132:135], v[220:223], v[244:247], v[132:135]
    ds_read_b64_tr_b16 v[216:217], v38 offset:12288
    ds_read_b64_tr_b16 v[218:219], v38 offset:12800
    v_xor_b32 v38, 49152, v38
    buffer_load_dwordx4 v[244:247], v2, s[32:35], s20 offen offset:1024 sc1
    s_waitcnt vmcnt(7)
    s_waitcnt lgkmcnt(6)
    v_mfma_f32_16x16x32_bf16 v[120:123], v[192:195], v[44:47], v[120:123]
    ds_read_b64_tr_b16 v[220:221], v39 offset:12288
    ds_read_b64_tr_b16 v[222:223], v39 offset:12800
    v_xor_b32 v39, 49152, v39
    v_mfma_f32_16x16x32_bf16 v[124:127], v[196:199], v[44:47], v[124:127]
    ds_read_b64_tr_b16 v[192:193], v36
    ds_read_b64_tr_b16 v[194:195], v36 offset:512
    v_mfma_f32_16x16x32_bf16 v[128:131], v[200:203], v[44:47], v[128:131]
    ds_read_b64_tr_b16 v[196:197], v37
    ds_read_b64_tr_b16 v[198:199], v37 offset:512
    v_mfma_f32_16x16x32_bf16 v[132:135], v[204:207], v[44:47], v[132:135]
    ds_read_b64_tr_b16 v[200:201], v38
    ds_read_b64_tr_b16 v[202:203], v38 offset:512
    buffer_load_dwordx4 v[44:47], v2, s[32:35], s20 offen offset:2048 sc1
    s_waitcnt vmcnt(7)
    s_waitcnt lgkmcnt(6)
    v_mfma_f32_16x16x32_bf16 v[120:123], v[208:211], v[48:51], v[120:123]
    ds_read_b64_tr_b16 v[204:205], v39
    ds_read_b64_tr_b16 v[206:207], v39 offset:512
    v_mfma_f32_16x16x32_bf16 v[124:127], v[212:215], v[48:51], v[124:127]
    ds_read_b64_tr_b16 v[208:209], v36 offset:4096
    ds_read_b64_tr_b16 v[210:211], v36 offset:4608
    v_mfma_f32_16x16x32_bf16 v[128:131], v[216:219], v[48:51], v[128:131]
    ds_read_b64_tr_b16 v[212:213], v37 offset:4096
    ds_read_b64_tr_b16 v[214:215], v37 offset:4608
    v_mfma_f32_16x16x32_bf16 v[132:135], v[220:223], v[48:51], v[132:135]
    ds_read_b64_tr_b16 v[216:217], v38 offset:4096
    ds_read_b64_tr_b16 v[218:219], v38 offset:4608
    buffer_load_dwordx4 v[48:51], v2, s[32:35], s20 offen offset:3072 sc1
    s_waitcnt vmcnt(7)
    s_waitcnt lgkmcnt(6)
    v_mfma_f32_16x16x32_bf16 v[120:123], v[192:195], v[224:227], v[120:123]
    ds_read_b64_tr_b16 v[220:221], v39 offset:4096
    ds_read_b64_tr_b16 v[222:223], v39 offset:4608
    v_mfma_f32_16x16x32_bf16 v[124:127], v[196:199], v[224:227], v[124:127]
    ds_read_b64_tr_b16 v[192:193], v36 offset:8192
    ds_read_b64_tr_b16 v[194:195], v36 offset:8704
    v_mfma_f32_16x16x32_bf16 v[128:131], v[200:203], v[224:227], v[128:131]
    ds_read_b64_tr_b16 v[196:197], v37 offset:8192
    ds_read_b64_tr_b16 v[198:199], v37 offset:8704
    v_mfma_f32_16x16x32_bf16 v[132:135], v[204:207], v[224:227], v[132:135]
    ds_read_b64_tr_b16 v[200:201], v38 offset:8192
    ds_read_b64_tr_b16 v[202:203], v38 offset:8704
    s_xor_b32 s96, s17, 16384
    s_add_u32 s20, s96, s19
    buffer_load_dwordx4 v[224:227], v2, s[32:35], s20 offen sc1
    s_waitcnt vmcnt(7)
    s_waitcnt lgkmcnt(6)
    v_mfma_f32_16x16x32_bf16 v[120:123], v[208:211], v[228:231], v[120:123]
    ds_read_b64_tr_b16 v[204:205], v39 offset:8192
    ds_read_b64_tr_b16 v[206:207], v39 offset:8704
    v_mfma_f32_16x16x32_bf16 v[124:127], v[212:215], v[228:231], v[124:127]
    ds_read_b64_tr_b16 v[208:209], v36 offset:12288
    ds_read_b64_tr_b16 v[210:211], v36 offset:12800
    v_xor_b32 v36, 16384, v36
    v_mfma_f32_16x16x32_bf16 v[128:131], v[216:219], v[228:231], v[128:131]
    ds_read_b64_tr_b16 v[212:213], v37 offset:12288
    ds_read_b64_tr_b16 v[214:215], v37 offset:12800
    v_xor_b32 v37, 16384, v37
    v_mfma_f32_16x16x32_bf16 v[132:135], v[220:223], v[228:231], v[132:135]
    ds_read_b64_tr_b16 v[216:217], v38 offset:12288
    ds_read_b64_tr_b16 v[218:219], v38 offset:12800
    v_xor_b32 v38, 16384, v38
    buffer_load_dwordx4 v[228:231], v2, s[32:35], s20 offen offset:1024 sc1
    s_waitcnt vmcnt(7)
    s_waitcnt lgkmcnt(6)
    v_mfma_f32_16x16x32_bf16 v[120:123], v[192:195], v[232:235], v[120:123]
    ds_read_b64_tr_b16 v[220:221], v39 offset:12288
    ds_read_b64_tr_b16 v[222:223], v39 offset:12800
    v_xor_b32 v39, 16384, v39
    v_mfma_f32_16x16x32_bf16 v[124:127], v[196:199], v[232:235], v[124:127]
    ds_read_b64_tr_b16 v[192:193], v36
    ds_read_b64_tr_b16 v[194:195], v36 offset:512
    v_mfma_f32_16x16x32_bf16 v[128:131], v[200:203], v[232:235], v[128:131]
    ds_read_b64_tr_b16 v[196:197], v37
    ds_read_b64_tr_b16 v[198:199], v37 offset:512
    v_mfma_f32_16x16x32_bf16 v[132:135], v[204:207], v[232:235], v[132:135]
    ds_read_b64_tr_b16 v[200:201], v38
    ds_read_b64_tr_b16 v[202:203], v38 offset:512
    buffer_load_dwordx4 v[232:235], v2, s[32:35], s20 offen offset:2048 sc1
    s_waitcnt vmcnt(7)
    s_waitcnt lgkmcnt(6)
    v_mfma_f32_16x16x32_bf16 v[120:123], v[208:211], v[236:239], v[120:123]
    ds_read_b64_tr_b16 v[204:205], v39
    ds_read_b64_tr_b16 v[206:207], v39 offset:512
    v_mfma_f32_16x16x32_bf16 v[124:127], v[212:215], v[236:239], v[124:127]
    ds_read_b64_tr_b16 v[208:209], v36 offset:4096
    ds_read_b64_tr_b16 v[210:211], v36 offset:4608
    v_mfma_f32_16x16x32_bf16 v[128:131], v[216:219], v[236:239], v[128:131]
    ds_read_b64_tr_b16 v[212:213], v37 offset:4096
    ds_read_b64_tr_b16 v[214:215], v37 offset:4608
    v_mfma_f32_16x16x32_bf16 v[132:135], v[220:223], v[236:239], v[132:135]
    ds_read_b64_tr_b16 v[216:217], v38 offset:4096
    ds_read_b64_tr_b16 v[218:219], v38 offset:4608
    buffer_load_dwordx4 v[236:239], v2, s[32:35], s20 offen offset:3072 sc1
    s_waitcnt vmcnt(7)
    s_waitcnt lgkmcnt(6)
    v_mfma_f32_16x16x32_bf16 v[120:123], v[192:195], v[240:243], v[120:123]
    ds_read_b64_tr_b16 v[220:221], v39 offset:4096
    ds_read_b64_tr_b16 v[222:223], v39 offset:4608
    v_mfma_f32_16x16x32_bf16 v[124:127], v[196:199], v[240:243], v[124:127]
L_PAD8:
    s_cbranch_execz L_RET8
    ds_read_b64_tr_b16 v[192:193], v36 offset:8192
    ds_read_b64_tr_b16 v[194:195], v36 offset:8704
    v_mfma_f32_16x16x32_bf16 v[128:131], v[200:203], v[240:243], v[128:131]
    ds_read_b64_tr_b16 v[196:197], v37 offset:8192
    ds_read_b64_tr_b16 v[198:199], v37 offset:8704
    v_mfma_f32_16x16x32_bf16 v[132:135], v[204:207], v[240:243], v[132:135]
    ds_read_b64_tr_b16 v[200:201], v38 offset:8192
    ds_read_b64_tr_b16 v[202:203], v38 offset:8704
    s_xor_b32 s96, s17, 20480
    s_add_u32 s20, s96, s19
    buffer_load_dwordx4 v[240:243], v2, s[32:35], s20 offen sc1
    s_waitcnt vmcnt(7)
    s_waitcnt lgkmcnt(6)
    v_mfma_f32_16x16x32_bf16 v[120:123], v[208:211], v[244:247], v[120:123]
    ds_read_b64_tr_b16 v[204:205], v39 offset:8192
    ds_read_b64_tr_b16 v[206:207], v39 offset:8704
    v_mfma_f32_16x16x32_bf16 v[124:127], v[212:215], v[244:247], v[124:127]
    ds_read_b64_tr_b16 v[208:209], v36 offset:12288
    ds_read_b64_tr_b16 v[210:211], v36 offset:12800
    v_xor_b32 v36, 114688, v36
    v_mfma_f32_16x16x32_bf16 v[128:131], v[216:219], v[244:247], v[128:131]
    ds_read_b64_tr_b16 v[212:213], v37 offset:12288
    ds_read_b64_tr_b16 v[214:215], v37 offset:12800
    v_xor_b32 v37, 114688, v37
    v_mfma_f32_16x16x32_bf16 v[132:135], v[220:223], v[244:247], v[132:135]
    ds_read_b64_tr_b16 v[216:217], v38 offset:12288
    ds_read_b64_tr_b16 v[218:219], v38 offset:12800
    v_xor_b32 v38, 114688, v38
    buffer_load_dwordx4 v[244:247], v2, s[32:35], s20 offen offset:1024 sc1
    s_waitcnt vmcnt(7)
    s_waitcnt lgkmcnt(6)
    v_mfma_f32_16x16x32_bf16 v[120:123], v[192:195], v[44:47], v[120:123]
    ds_read_b64_tr_b16 v[220:221], v39 offset:12288
    ds_read_b64_tr_b16 v[222:223], v39 offset:12800
    v_xor_b32 v39, 114688, v39
    v_mfma_f32_16x16x32_bf16 v[124:127], v[196:199], v[44:47], v[124:127]
    ds_read_b64_tr_b16 v[192:193], v36
    ds_read_b64_tr_b16 v[194:195], v36 offset:512
    v_mfma_f32_16x16x32_bf16 v[128:131], v[200:203], v[44:47], v[128:131]
    ds_read_b64_tr_b16 v[196:197], v37
    ds_read_b64_tr_b16 v[198:199], v37 offset:512
    v_mfma_f32_16x16x32_bf16 v[132:135], v[204:207], v[44:47], v[132:135]
    ds_read_b64_tr_b16 v[200:201], v38
    ds_read_b64_tr_b16 v[202:203], v38 offset:512
    buffer_load_dwordx4 v[44:47], v2, s[32:35], s20 offen offset:2048 sc1
    s_waitcnt vmcnt(7)
    s_waitcnt lgkmcnt(6)
    v_mfma_f32_16x16x32_bf16 v[120:123], v[208:211], v[48:51], v[120:123]
    ds_read_b64_tr_b16 v[204:205], v39
    ds_read_b64_tr_b16 v[206:207], v39 offset:512
    v_mfma_f32_16x16x32_bf16 v[124:127], v[212:215], v[48:51], v[124:127]
    ds_read_b64_tr_b16 v[208:209], v36 offset:4096
    ds_read_b64_tr_b16 v[210:211], v36 offset:4608
    v_mfma_f32_16x16x32_bf16 v[128:131], v[216:219], v[48:51], v[128:131]
    ds_read_b64_tr_b16 v[212:213], v37 offset:4096
    ds_read_b64_tr_b16 v[214:215], v37 offset:4608
    v_mfma_f32_16x16x32_bf16 v[132:135], v[220:223], v[48:51], v[132:135]
    ds_read_b64_tr_b16 v[216:217], v38 offset:4096
    ds_read_b64_tr_b16 v[218:219], v38 offset:4608
    buffer_load_dwordx4 v[48:51], v2, s[32:35], s20 offen offset:3072 sc1
    s_waitcnt vmcnt(7)
    s_waitcnt lgkmcnt(6)
    v_mfma_f32_16x16x32_bf16 v[120:123], v[192:195], v[224:227], v[120:123]
    ds_read_b64_tr_b16 v[220:221], v39 offset:4096
    ds_read_b64_tr_b16 v[222:223], v39 offset:4608
    v_mfma_f32_16x16x32_bf16 v[124:127], v[196:199], v[224:227], v[124:127]
    ds_read_b64_tr_b16 v[192:193], v36 offset:8192
    ds_read_b64_tr_b16 v[194:195], v36 offset:8704
    v_mfma_f32_16x16x32_bf16 v[128:131], v[200:203], v[224:227], v[128:131]
    ds_read_b64_tr_b16 v[196:197], v37 offset:8192
    ds_read_b64_tr_b16 v[198:199], v37 offset:8704
    v_mfma_f32_16x16x32_bf16 v[132:135], v[204:207], v[224:227], v[132:135]
    ds_read_b64_tr_b16 v[200:201], v38 offset:8192
    ds_read_b64_tr_b16 v[202:203], v38 offset:8704
    s_xor_b32 s96, s17, 24576
    s_add_u32 s20, s96, s19
    buffer_load_dwordx4 v[224:227], v2, s[32:35], s20 offen sc1
    s_waitcnt vmcnt(7)
    s_waitcnt lgkmcnt(6)
    v_mfma_f32_16x16x32_bf16 v[120:123], v[208:211], v[228:231], v[120:123]
    ds_read_b64_tr_b16 v[204:205], v39 offset:8192
    ds_read_b64_tr_b16 v[206:207], v39 offset:8704
    v_mfma_f32_16x16x32_bf16 v[124:127], v[212:215], v[228:231], v[124:127]
    ds_read_b64_tr_b16 v[208:209], v36 offset:12288
    ds_read_b64_tr_b16 v[210:211], v36 offset:12800
    v_xor_b32 v36, 16384, v36
    v_mfma_f32_16x16x32_bf16 v[128:131], v[216:219], v[228:231], v[128:131]
    ds_read_b64_tr_b16 v[212:213], v37 offset:12288
    ds_read_b64_tr_b16 v[214:215], v37 offset:12800
    v_xor_b32 v37, 16384, v37
    v_mfma_f32_16x16x32_bf16 v[132:135], v[220:223], v[228:231], v[132:135]
    ds_read_b64_tr_b16 v[216:217], v38 offset:12288
    ds_read_b64_tr_b16 v[218:219], v38 offset:12800
    v_xor_b32 v38, 16384, v38
    buffer_load_dwordx4 v[228:231], v2, s[32:35], s20 offen offset:1024 sc1
    s_waitcnt vmcnt(7)
    s_waitcnt lgkmcnt(6)
    v_mfma_f32_16x16x32_bf16 v[120:123], v[192:195], v[232:235], v[120:123]
    ds_read_b64_tr_b16 v[220:221], v39 offset:12288
    ds_read_b64_tr_b16 v[222:223], v39 offset:12800
    v_xor_b32 v39, 16384, v39
    v_mfma_f32_16x16x32_bf16 v[124:127], v[196:199], v[232:235], v[124:127]
    ds_read_b64_tr_b16 v[192:193], v36
    ds_read_b64_tr_b16 v[194:195], v36 offset:512
    v_mfma_f32_16x16x32_bf16 v[128:131], v[200:203], v[232:235], v[128:131]
    ds_read_b64_tr_b16 v[196:197], v37
    ds_read_b64_tr_b16 v[198:199], v37 offset:512
    v_mfma_f32_16x16x32_bf16 v[132:135], v[204:207], v[232:235], v[132:135]
    ds_read_b64_tr_b16 v[200:201], v38
    ds_read_b64_tr_b16 v[202:203], v38 offset:512
    buffer_load_dwordx4 v[232:235], v2, s[32:35], s20 offen offset:2048 sc1
    s_waitcnt vmcnt(7)
    s_waitcnt lgkmcnt(6)
    v_mfma_f32_16x16x32_bf16 v[120:123], v[208:211], v[236:239], v[120:123]
    ds_read_b64_tr_b16 v[204:205], v39
    ds_read_b64_tr_b16 v[206:207], v39 offset:512
    v_mfma_f32_16x16x32_bf16 v[124:127], v[212:215], v[236:239], v[124:127]
    ds_read_b64_tr_b16 v[208:209], v36 offset:4096
    ds_read_b64_tr_b16 v[210:211], v36 offset:4608
    v_mfma_f32_16x16x32_bf16 v[128:131], v[216:219], v[236:239], v[128:131]
    ds_read_b64_tr_b16 v[212:213], v37 offset:4096
    ds_read_b64_tr_b16 v[214:215], v37 offset:4608
    v_mfma_f32_16x16x32_bf16 v[132:135], v[220:223], v[236:239], v[132:135]
    ds_read_b64_tr_b16 v[216:217], v38 offset:4096
    ds_read_b64_tr_b16 v[218:219], v38 offset:4608
    buffer_load_dwordx4 v[236:239], v2, s[32:35], s20 offen offset:3072 sc1
    s_waitcnt vmcnt(7)
    s_waitcnt lgkmcnt(6)
    v_mfma_f32_16x16x32_bf16 v[120:123], v[192:195], v[240:243], v[120:123]
    ds_read_b64_tr_b16 v[220:221], v39 offset:4096
    ds_read_b64_tr_b16 v[222:223], v39 offset:4608
    v_mfma_f32_16x16x32_bf16 v[124:127], v[196:199], v[240:243], v[124:127]
    ds_read_b64_tr_b16 v[192:193], v36 offset:8192
    ds_read_b64_tr_b16 v[194:195], v36 offset:8704
    v_mfma_f32_16x16x32_bf16 v[128:131], v[200:203], v[240:243], v[128:131]
    ds_read_b64_tr_b16 v[196:197], v37 offset:8192
    ds_read_b64_tr_b16 v[198:199], v37 offset:8704
    v_mfma_f32_16x16x32_bf16 v[132:135], v[204:207], v[240:243], v[132:135]
    ds_read_b64_tr_b16 v[200:201], v38 offset:8192
    ds_read_b64_tr_b16 v[202:203], v38 offset:8704
    s_xor_b32 s96, s17, 28672
    s_add_u32 s20, s96, s19
    buffer_load_dwordx4 v[240:243], v2, s[32:35], s20 offen sc1
    s_waitcnt vmcnt(7)
    s_waitcnt lgkmcnt(6)
    v_mfma_f32_16x16x32_bf16 v[120:123], v[208:211], v[244:247], v[120:123]
    ds_read_b64_tr_b16 v[204:205], v39 offset:8192
    ds_read_b64_tr_b16 v[206:207], v39 offset:8704
    v_mfma_f32_16x16x32_bf16 v[124:127], v[212:215], v[244:247], v[124:127]
    ds_read_b64_tr_b16 v[208:209], v36 offset:12288
    ds_read_b64_tr_b16 v[210:211], v36 offset:12800
    v_xor_b32 v36, 49152, v36
    v_mfma_f32_16x16x32_bf16 v[128:131], v[216:219], v[244:247], v[128:131]
    ds_read_b64_tr_b16 v[212:213], v37 offset:12288
    ds_read_b64_tr_b16 v[214:215], v37 offset:12800
    v_xor_b32 v37, 49152, v37
    v_mfma_f32_16x16x32_bf16 v[132:135], v[220:223], v[244:247], v[132:135]
    ds_read_b64_tr_b16 v[216:217], v38 offset:12288
    ds_read_b64_tr_b16 v[218:219], v38 offset:12800
    v_xor_b32 v38, 49152, v38
    buffer_load_dwordx4 v[244:247], v2, s[32:35], s20 offen offset:1024 sc1
    s_waitcnt vmcnt(7)
    s_waitcnt lgkmcnt(6)
    v_mfma_f32_16x16x32_bf16 v[120:123], v[192:195], v[44:47], v[120:123]
    ds_read_b64_tr_b16 v[220:221], v39 offset:12288
    ds_read_b64_tr_b16 v[222:223], v39 offset:12800
    v_xor_b32 v39, 49152, v39
    v_mfma_f32_16x16x32_bf16 v[124:127], v[196:199], v[44:47], v[124:127]
    ds_read_b64_tr_b16 v[192:193], v36
    ds_read_b64_tr_b16 v[194:195], v36 offset:512
    v_mfma_f32_16x16x32_bf16 v[128:131], v[200:203], v[44:47], v[128:131]
    ds_read_b64_tr_b16 v[196:197], v37
    ds_read_b64_tr_b16 v[198:199], v37 offset:512
    v_mfma_f32_16x16x32_bf16 v[132:135], v[204:207], v[44:47], v[132:135]
    ds_read_b64_tr_b16 v[200:201], v38
    ds_read_b64_tr_b16 v[202:203], v38 offset:512
    buffer_load_dwordx4 v[44:47], v2, s[32:35], s20 offen offset:2048 sc1
    s_waitcnt vmcnt(7)
    s_waitcnt lgkmcnt(6)
    v_mfma_f32_16x16x32_bf16 v[120:123], v[208:211], v[48:51], v[120:123]
    ds_read_b64_tr_b16 v[204:205], v39
    ds_read_b64_tr_b16 v[206:207], v39 offset:512
    v_mfma_f32_16x16x32_bf16 v[124:127], v[212:215], v[48:51], v[124:127]
    ds_read_b64_tr_b16 v[208:209], v36 offset:4096
    ds_read_b64_tr_b16 v[210:211], v36 offset:4608
    v_mfma_f32_16x16x32_bf16 v[128:131], v[216:219], v[48:51], v[128:131]
    ds_read_b64_tr_b16 v[212:213], v37 offset:4096
    ds_read_b64_tr_b16 v[214:215], v37 offset:4608
    v_mfma_f32_16x16x32_bf16 v[132:135], v[220:223], v[48:51], v[132:135]
    ds_read_b64_tr_b16 v[216:217], v38 offset:4096
    ds_read_b64_tr_b16 v[218:219], v38 offset:4608
    buffer_load_dwordx4 v[48:51], v2, s[32:35], s20 offen offset:3072 sc1
    buffer_load_dwordx2 v[40:41], v10, s[32:35], s13 offen sc1
    s_add_u32 s82, s80, 114688
    buffer_load_dwordx4 v[72:75], v27, s[52:55], s82 offen nt
    s_add_u32 s82, s80, 172032
    buffer_load_dwordx4 v[76:79], v27, s[52:55], s82 offen nt
    s_mov_b32 s82, s80
    buffer_load_dwordx4 v[80:83], v27, s[56:59], s82 offen nt
    s_waitcnt vmcnt(11)
    s_waitcnt lgkmcnt(6)
    v_mfma_f32_16x16x32_bf16 v[120:123], v[192:195], v[224:227], v[120:123]
    ds_read_b64_tr_b16 v[220:221], v39 offset:4096
    ds_read_b64_tr_b16 v[222:223], v39 offset:4608
    v_mfma_f32_16x16x32_bf16 v[124:127], v[196:199], v[224:227], v[124:127]
    ds_read_b64_tr_b16 v[192:193], v36 offset:8192
    ds_read_b64_tr_b16 v[194:195], v36 offset:8704
    v_mfma_f32_16x16x32_bf16 v[128:131], v[200:203], v[224:227], v[128:131]
    ds_read_b64_tr_b16 v[196:197], v37 offset:8192
    ds_read_b64_tr_b16 v[198:199], v37 offset:8704
    v_mfma_f32_16x16x32_bf16 v[132:135], v[204:207], v[224:227], v[132:135]
    ds_read_b64_tr_b16 v[200:201], v38 offset:8192
    ds_read_b64_tr_b16 v[202:203], v38 offset:8704
    s_waitcnt vmcnt(10)
    s_waitcnt lgkmcnt(6)
    v_mfma_f32_16x16x32_bf16 v[120:123], v[208:211], v[228:231], v[120:123]
    ds_read_b64_tr_b16 v[204:205], v39 offset:8192
    ds_read_b64_tr_b16 v[206:207], v39 offset:8704
    v_mfma_f32_16x16x32_bf16 v[124:127], v[212:215], v[228:231], v[124:127]
    ds_read_b64_tr_b16 v[208:209], v36 offset:12288
    ds_read_b64_tr_b16 v[210:211], v36 offset:12800
    v_xor_b32 v36, 16384, v36
    v_mfma_f32_16x16x32_bf16 v[128:131], v[216:219], v[228:231], v[128:131]
    ds_read_b64_tr_b16 v[212:213], v37 offset:12288
    ds_read_b64_tr_b16 v[214:215], v37 offset:12800
    v_xor_b32 v37, 16384, v37
    v_mfma_f32_16x16x32_bf16 v[132:135], v[220:223], v[228:231], v[132:135]
    ds_read_b64_tr_b16 v[216:217], v38 offset:12288
    ds_read_b64_tr_b16 v[218:219], v38 offset:12800
    v_xor_b32 v38, 16384, v38
    s_waitcnt vmcnt(9)
    s_waitcnt lgkmcnt(6)
    v_mfma_f32_16x16x32_bf16 v[120:123], v[192:195], v[232:235], v[120:123]
    ds_read_b64_tr_b16 v[220:221], v39 offset:12288
    ds_read_b64_tr_b16 v[222:223], v39 offset:12800
    v_xor_b32 v39, 16384, v39
    v_mfma_f32_16x16x32_bf16 v[124:127], v[196:199], v[232:235], v[124:127]
    ds_read_b64_tr_b16 v[192:193], v36
    ds_read_b64_tr_b16 v[194:195], v36 offset:512
    v_mfma_f32_16x16x32_bf16 v[128:131], v[200:203], v[232:235], v[128:131]
    ds_read_b64_tr_b16 v[196:197], v37
    ds_read_b64_tr_b16 v[198:199], v37 offset:512
    v_mfma_f32_16x16x32_bf16 v[132:135], v[204:207], v[232:235], v[132:135]
    ds_read_b64_tr_b16 v[200:201], v38
    ds_read_b64_tr_b16 v[202:203], v38 offset:512
    s_waitcnt vmcnt(8)
    s_waitcnt lgkmcnt(6)
    v_mfma_f32_16x16x32_bf16 v[120:123], v[208:211], v[236:239], v[120:123]
    ds_read_b64_tr_b16 v[204:205], v39
    ds_read_b64_tr_b16 v[206:207], v39 offset:512
    v_mfma_f32_16x16x32_bf16 v[124:127], v[212:215], v[236:239], v[124:127]
    ds_read_b64_tr_b16 v[208:209], v36 offset:4096
    ds_read_b64_tr_b16 v[210:211], v36 offset:4608
    v_mfma_f32_16x16x32_bf16 v[128:131], v[216:219], v[236:239], v[128:131]
    ds_read_b64_tr_b16 v[212:213], v37 offset:4096
    ds_read_b64_tr_b16 v[214:215], v37 offset:4608
    v_mfma_f32_16x16x32_bf16 v[132:135], v[220:223], v[236:239], v[132:135]
    ds_read_b64_tr_b16 v[216:217], v38 offset:4096
    ds_read_b64_tr_b16 v[218:219], v38 offset:4608
    s_cmp_lt_u32 s3, 4
    s_cbranch_scc1 L_G2P28
    s_setprio 0
L_G2P28:
    s_waitcnt vmcnt(7)
    s_waitcnt lgkmcnt(6)
    v_mfma_f32_16x16x32_bf16 v[120:123], v[192:195], v[240:243], v[120:123]
    ds_read_b64_tr_b16 v[220:221], v39 offset:4096
    ds_read_b64_tr_b16 v[222:223], v39 offset:4608
    v_mfma_f32_16x16x32_bf16 v[124:127], v[196:199], v[240:243], v[124:127]
    ds_read_b64_tr_b16 v[192:193], v36 offset:8192
    ds_read_b64_tr_b16 v[194:195], v36 offset:8704
    v_mfma_f32_16x16x32_bf16 v[128:131], v[200:203], v[240:243], v[128:131]
    ds_read_b64_tr_b16 v[196:197], v37 offset:8192
    ds_read_b64_tr_b16 v[198:199], v37 offset:8704
    v_mfma_f32_16x16x32_bf16 v[132:135], v[204:207], v[240:243], v[132:135]
    ds_read_b64_tr_b16 v[200:201], v38 offset:8192
    ds_read_b64_tr_b16 v[202:203], v38 offset:8704
    s_waitcnt vmcnt(6)
    s_waitcnt lgkmcnt(6)
    v_mfma_f32_16x16x32_bf16 v[120:123], v[208:211], v[244:247], v[120:123]
    ds_read_b64_tr_b16 v[204:205], v39 offset:8192
    ds_read_b64_tr_b16 v[206:207], v39 offset:8704
    v_mfma_f32_16x16x32_bf16 v[124:127], v[212:215], v[244:247], v[124:127]
    ds_read_b64_tr_b16 v[208:209], v36 offset:12288
    ds_read_b64_tr_b16 v[210:211], v36 offset:12800
    v_mfma_f32_16x16x32_bf16 v[128:131], v[216:219], v[244:247], v[128:131]
    ds_read_b64_tr_b16 v[212:213], v37 offset:12288
    ds_read_b64_tr_b16 v[214:215], v37 offset:12800
    v_mfma_f32_16x16x32_bf16 v[132:135], v[220:223], v[244:247], v[132:135]
    ds_read_b64_tr_b16 v[216:217], v38 offset:12288
    ds_read_b64_tr_b16 v[218:219], v38 offset:12800
    s_waitcnt vmcnt(5)
    s_waitcnt lgkmcnt(6)
    v_mfma_f32_16x16x32_bf16 v[120:123], v[192:195], v[44:47], v[120:123]
    ds_read_b64_tr_b16 v[220:221], v39 offset:12288
    ds_read_b64_tr_b16 v[222:223], v39 offset:12800
    v_mfma_f32_16x16x32_bf16 v[124:127], v[196:199], v[44:47], v[124:127]
    v_mfma_f32_16x16x32_bf16 v[128:131], v[200:203], v[44:47], v[128:131]
    v_mfma_f32_16x16x32_bf16 v[132:135], v[204:207], v[44:47], v[132:135]
    s_waitcnt vmcnt(4)
    s_waitcnt lgkmcnt(0)
    v_mfma_f32_16x16x32_bf16 v[120:123], v[208:211], v[48:51], v[120:123]
    v_mfma_f32_16x16x32_bf16 v[124:127], v[212:215], v[48:51], v[124:127]
    v_mfma_f32_16x16x32_bf16 v[128:131], v[216:219], v[48:51], v[128:131]
    v_mfma_f32_16x16x32_bf16 v[132:135], v[220:223], v[48:51], v[132:135]
    s_lshl3_add_u32 s96, s21, s3
    s_lshl4_add_u32 s97, s96, s12
    s_lshl_b32 s98, s97, 8
    s_add_u32 s14, s98, 12582912
    v_and_b32 v28, 15, v1
    v_lshlrev_b32 v28, 4, v28
    v_lshrrev_b32 v9, 4, v1
    v_lshl_add_u32 v28, v9, 2, v28
    v_cvt_pk_bf16_f32 v120, 0, v120
    v_cvt_pk_bf16_f32 v121, 0, v121
    v_cvt_pk_bf16_f32 v122, 0, v122
    v_cvt_pk_bf16_f32 v123, 0, v123
    v_cvt_pk_bf16_f32 v124, 0, v124
    v_cvt_pk_bf16_f32 v125, 0, v125
    v_cvt_pk_bf16_f32 v126, 0, v126
    v_cvt_pk_bf16_f32 v127, 0, v127
    v_pk_mul_f32 v[120:121], v[120:121], v[136:137]
    v_pk_mul_f32 v[122:123], v[122:123], v[138:139]
    v_pk_mul_f32 v[124:125], v[124:125], v[140:141]
    v_pk_mul_f32 v[126:127], v[126:127], v[142:143]
    v_cvt_pk_bf16_f32 v120, 0, v120
    v_cvt_pk_bf16_f32 v121, 0, v121
    v_cvt_pk_bf16_f32 v122, 0, v122
    v_cvt_pk_bf16_f32 v123, 0, v123
    v_cvt_pk_bf16_f32 v124, 0, v124
    v_cvt_pk_bf16_f32 v125, 0, v125
    v_cvt_pk_bf16_f32 v126, 0, v126
    v_cvt_pk_bf16_f32 v127, 0, v127
    v_pk_add_f32 v[120:121], v[120:121], v[152:153]
    v_pk_add_f32 v[122:123], v[122:123], v[154:155]
    v_pk_add_f32 v[124:125], v[124:125], v[156:157]
    v_pk_add_f32 v[126:127], v[126:127], v[158:159]
    v_cvt_pk_bf16_f32 v12, v120, v121
    v_cvt_pk_bf16_f32 v13, v122, v123
    v_cvt_pk_bf16_f32 v14, v124, v125
    v_cvt_pk_bf16_f32 v15, v126, v127
    v_dot2_f32_bf16 v4, v12, v12, 0
    v_dot2_f32_bf16 v5, v13, v13, 0
    v_dot2_f32_bf16 v4, v14, v14, v4
    v_dot2_f32_bf16 v5, v15, v15, v5
    v_mfma_f32_16x16x32_bf16 v[240:243], v[184:187], v[12:15], 0
    v_cvt_pk_bf16_f32 v128, 0, v128
    v_cvt_pk_bf16_f32 v129, 0, v129
    v_cvt_pk_bf16_f32 v130, 0, v130
    v_cvt_pk_bf16_f32 v131, 0, v131
    v_cvt_pk_bf16_f32 v132, 0, v132
    v_cvt_pk_bf16_f32 v133, 0, v133
    v_cvt_pk_bf16_f32 v134, 0, v134
    v_cvt_pk_bf16_f32 v135, 0, v135
    v_pk_mul_f32 v[128:129], v[128:129], v[144:145]
    v_pk_mul_f32 v[130:131], v[130:131], v[146:147]
    v_pk_mul_f32 v[132:133], v[132:133], v[148:149]
    v_pk_mul_f32 v[134:135], v[134:135], v[150:151]
    v_cvt_pk_bf16_f32 v128, 0, v128
    v_cvt_pk_bf16_f32 v129, 0, v129
    v_cvt_pk_bf16_f32 v130, 0, v130
    v_cvt_pk_bf16_f32 v131, 0, v131
    v_cvt_pk_bf16_f32 v132, 0, v132
    v_cvt_pk_bf16_f32 v133, 0, v133
    v_cvt_pk_bf16_f32 v134, 0, v134
    v_cvt_pk_bf16_f32 v135, 0, v135
    v_pk_add_f32 v[128:129], v[128:129], v[160:161]
    v_pk_add_f32 v[130:131], v[130:131], v[162:163]
    v_pk_add_f32 v[132:133], v[132:133], v[164:165]
    v_pk_add_f32 v[134:135], v[134:135], v[166:167]
    v_cvt_pk_bf16_f32 v16, v128, v129
    v_cvt_pk_bf16_f32 v17, v130, v131
    v_cvt_pk_bf16_f32 v18, v132, v133
    v_cvt_pk_bf16_f32 v19, v134, v135
    v_dot2_f32_bf16 v4, v16, v16, v4
    v_dot2_f32_bf16 v5, v17, v17, v5
    v_dot2_f32_bf16 v4, v18, v18, v4
    v_dot2_f32_bf16 v5, v19, v19, v5
    v_mfma_f32_16x16x32_bf16 v[240:243], v[188:191], v[16:19], v[240:243]
    v_and_b32 v7, 7, v1
    v_lshlrev_b32 v7, 15, v7
    v_bfe_u32 v9, v1, 3, 1
    v_lshl_add_u32 v7, v9, 12, v7
    v_add_f32 v4, v4, v5
    v_mov_b32 v5, v4
    s_nop 1
    v_permlane32_swap_b32 v4, v5
    v_add_f32 v4, v4, v5
    v_mov_b32 v5, v4
    s_nop 1
    v_permlane16_swap_b32 v4, v5
    v_add_f32 v4, v4, v5
    s_nop 1
    v_mov_b32_dpp v240, v4 quad_perm:[0,1,2,3] row_mask:0x8 bank_mask:0xf
    buffer_store_dword v240, v28, s[32:35], s14 offen sc1
    s_and_b32 s96, s12, 1
    s_lshr_b32 s97, s21, 2
    s_and_b32 s98, s21, 3
    s_lshl_b32 s99, s98, 6
    s_lshl1_add_u32 s98, s97, s99
    s_lshl_b32 s97, s98, 12
    s_lshr_b32 s99, s12, 1
    s_lshl_b32 s98, s99, 6
    s_add_u32 s99, s97, s98
    s_lshl2_add_u32 s97, s96, s99
    s_add_u32 s98, s97, 1048576
    s_add_u32 s16, s98, 1536
    s_barrier
    s_cmp_lg_u32 s3, 0
    s_cbranch_scc1 L_PE
    v_mov_b32 v6, s4
    s_mov_b32 exec_hi, 0
    s_mov_b32 exec_lo, 65535
    buffer_store_dword v6, v7, s[32:35], s16 offen sc1
    s_mov_b64 exec, -1
L_PE:
    s_add_u32 s82, s80, 57344
    s_lshl2_add_u32 m0, s83, 33792
    s_nop 0
    buffer_load_dwordx4 v27, s[56:59], s82 offen nt lds
    s_add_u32 s82, s80, 114688
    s_lshl2_add_u32 m0, s83, 34816
    s_nop 0
    buffer_load_dwordx4 v27, s[56:59], s82 offen nt lds
    s_lshl_b32 s15, s3, 12
    v_add_u32 v4, s15, v2
    v_add_u32 v7, 65536, v4
    s_waitcnt vmcnt(6)
    v_cmp_ne_u32 vcc, s4, v41
    s_cbranch_vccz L_UPOK
POLL_34:
    buffer_load_dwordx2 v[40:41], v10, s[32:35], s13 offen sc1
    s_waitcnt vmcnt(0)
    v_cmp_ne_u32 vcc, s4, v41
    s_cbranch_vccz PDONE_35
    s_add_u32 s5, s5, 1
    s_cmp_lt_u32 s5, 200000
    s_cbranch_scc1 POLL_34
PDONE_35:
L_UPOK:
    s_lshl3_add_u32 s96, s21, s3
    s_lshl_b32 s97, s96, 12
    s_add_u32 s14, s97, 12582912
    s_load_dwordx2 s[24:25], s[32:33], s92 offset:1536 glc
    v_add_f32_dpp v40, v40, v40 quad_perm:[1,0,3,2] row_mask:0xf bank_mask:0xf
    s_nop 1
    v_add_f32_dpp v40, v40, v40 quad_perm:[2,3,0,1] row_mask:0xf bank_mask:0xf
    s_nop 1
    v_add_f32_dpp v40, v40, v40 row_half_mirror row_mask:0xf bank_mask:0xf
    s_nop 1
    v_add_f32_dpp v40, v40, v40 row_mirror row_mask:0xf bank_mask:0xf
    v_lshlrev_b32 v152, 16, v12
    v_and_b32 v153, s6, v12
    v_lshlrev_b32 v154, 16, v13
    v_and_b32 v155, s6, v13
    v_lshlrev_b32 v156, 16, v14
    v_and_b32 v157, s6, v14
    v_lshlrev_b32 v158, 16, v15
    v_and_b32 v159, s6, v15
    v_lshlrev_b32 v160, 16, v16
    v_and_b32 v161, s6, v16
    v_lshlrev_b32 v162, 16, v17
    v_and_b32 v163, s6, v17
    v_lshlrev_b32 v164, 16, v18
    v_and_b32 v165, s6, v18
    v_lshlrev_b32 v166, 16, v19
    v_and_b32 v167, s6, v19
    s_lshl_b32 s96, s3, 9
    s_lshl1_add_u32 s15, s21, s96
    v_and_b32 v29, 15, v1
    v_lshl_add_u32 v29, v29, 5, s15
    v_xor_b32 v5, 0x4000, v4
    v_xor_b32 v8, 0x4000, v7
    s_waitcnt vmcnt(3)
    ds_write_b128 v4, v[72:75] offset:2048
    ds_write_b128 v4, v[76:79] offset:3072
    ds_write_b128 v4, v[80:83] offset:32768
    s_cmp_lt_u32 s3, 4
    s_cbranch_scc1 L_FW1
    ds_write_b128 v4, v[56:59] offset:0
    ds_write_b128 v5, v[60:63] offset:0
    ds_write_b128 v4, v[64:67] offset:1024
    ds_write_b128 v5, v[68:71] offset:1024
L_FW1:
    s_branch SCHK_37
SPOLL_36:
    s_load_dwordx2 s[24:25], s[32:33], s92 offset:1536 glc
SCHK_37:
    s_add_u32 s5, s5, 1
    s_cmp_ge_u32 s5, 200000
    s_waitcnt lgkmcnt(0)
    s_cbranch_scc1 SDONE_38
    s_cmp_lg_u32 s24, s4
    s_cbranch_scc1 SPOLL_36
    s_cmp_lg_u32 s25, s4
    s_cbranch_scc1 SPOLL_36
SDONE_38:
    s_barrier
    buffer_load_dwordx4 v[192:195], v2, s[32:35], s14 offen sc1
    buffer_load_dwordx4 v[196:199], v2, s[32:35], s14 offen offset:1024 sc1
    buffer_load_dwordx4 v[200:203], v2, s[32:35], s14 offen offset:2048 sc1
    buffer_load_dwordx4 v[204:207], v2, s[32:35], s14 offen offset:3072 sc1
    s_barrier
    s_add_u32 s82, s80, 172032
    s_lshl2_add_u32 m0, s83, 35840
    s_nop 0
    buffer_load_dwordx4 v27, s[56:59], s82 offen nt lds
    s_mov_b32 s82, s81
    s_lshl2_add_u32 m0, s83, 65536
    s_nop 0
    buffer_load_dwordx4 v253, s[60:63], s82 offen nt lds
    s_add_u32 s82, s81, 4096
    s_lshl2_add_u32 m0, s83, 66560
    s_nop 0
    buffer_load_dwordx4 v253, s[60:63], s82 offen nt lds
    v_mov_b32_dpp v168, v33 row_newbcast:0 row_mask:0xf bank_mask:0xf
    v_mov_b32_dpp v169, v33 row_newbcast:1 row_mask:0xf bank_mask:0xf
    v_mov_b32_dpp v170, v33 row_newbcast:2 row_mask:0xf bank_mask:0xf
    v_mov_b32_dpp v171, v33 row_newbcast:3 row_mask:0xf bank_mask:0xf
    v_mov_b32_dpp v172, v33 row_newbcast:4 row_mask:0xf bank_mask:0xf
    v_mov_b32_dpp v173, v33 row_newbcast:5 row_mask:0xf bank_mask:0xf
    v_mov_b32_dpp v174, v33 row_newbcast:6 row_mask:0xf bank_mask:0xf
    v_mov_b32_dpp v175, v33 row_newbcast:7 row_mask:0xf bank_mask:0xf
    v_mov_b32_dpp v176, v33 row_newbcast:8 row_mask:0xf bank_mask:0xf
    v_mov_b32_dpp v177, v33 row_newbcast:9 row_mask:0xf bank_mask:0xf
    v_mov_b32_dpp v178, v33 row_newbcast:10 row_mask:0xf bank_mask:0xf
    v_mov_b32_dpp v179, v33 row_newbcast:11 row_mask:0xf bank_mask:0xf
    v_mov_b32_dpp v180, v33 row_newbcast:12 row_mask:0xf bank_mask:0xf
    v_mov_b32_dpp v181, v33 row_newbcast:13 row_mask:0xf bank_mask:0xf
    v_mov_b32_dpp v182, v33 row_newbcast:14 row_mask:0xf bank_mask:0xf
    v_mov_b32_dpp v183, v33 row_newbcast:15 row_mask:0xf bank_mask:0xf
    v_mov_b32_dpp v88, v42 row_newbcast:0 row_mask:0xf bank_mask:0xf
    v_mov_b32_dpp v89, v42 row_newbcast:1 row_mask:0xf bank_mask:0xf
    v_mov_b32_dpp v90, v42 row_newbcast:2 row_mask:0xf bank_mask:0xf
    v_mov_b32_dpp v91, v42 row_newbcast:3 row_mask:0xf bank_mask:0xf
    v_mov_b32_dpp v92, v42 row_newbcast:4 row_mask:0xf bank_mask:0xf
    v_mov_b32_dpp v93, v42 row_newbcast:5 row_mask:0xf bank_mask:0xf
    v_mov_b32_dpp v94, v42 row_newbcast:6 row_mask:0xf bank_mask:0xf
    v_mov_b32_dpp v95, v42 row_newbcast:7 row_mask:0xf bank_mask:0xf
    v_mov_b32_dpp v96, v42 row_newbcast:8 row_mask:0xf bank_mask:0xf
    v_mov_b32_dpp v97, v42 row_newbcast:9 row_mask:0xf bank_mask:0xf
    v_mov_b32_dpp v98, v42 row_newbcast:10 row_mask:0xf bank_mask:0xf
    v_mov_b32_dpp v99, v42 row_newbcast:11 row_mask:0xf bank_mask:0xf
    v_mov_b32_dpp v100, v42 row_newbcast:12 row_mask:0xf bank_mask:0xf
    v_mov_b32_dpp v101, v42 row_newbcast:13 row_mask:0xf bank_mask:0xf
    v_mov_b32_dpp v102, v42 row_newbcast:14 row_mask:0xf bank_mask:0xf
    v_mov_b32_dpp v103, v42 row_newbcast:15 row_mask:0xf bank_mask:0xf
    v_mov_b32_dpp v104, v43 row_newbcast:0 row_mask:0xf bank_mask:0xf
    v_mov_b32_dpp v105, v43 row_newbcast:1 row_mask:0xf bank_mask:0xf
    v_mov_b32_dpp v106, v43 row_newbcast:2 row_mask:0xf bank_mask:0xf
    v_mov_b32_dpp v107, v43 row_newbcast:3 row_mask:0xf bank_mask:0xf
    v_mov_b32_dpp v108, v43 row_newbcast:4 row_mask:0xf bank_mask:0xf
    v_mov_b32_dpp v109, v43 row_newbcast:5 row_mask:0xf bank_mask:0xf
    v_mov_b32_dpp v110, v43 row_newbcast:6 row_mask:0xf bank_mask:0xf
    v_mov_b32_dpp v111, v43 row_newbcast:7 row_mask:0xf bank_mask:0xf
    v_mov_b32_dpp v112, v43 row_newbcast:8 row_mask:0xf bank_mask:0xf
    v_mov_b32_dpp v113, v43 row_newbcast:9 row_mask:0xf bank_mask:0xf
    v_mov_b32_dpp v114, v43 row_newbcast:10 row_mask:0xf bank_mask:0xf
    v_mov_b32_dpp v115, v43 row_newbcast:11 row_mask:0xf bank_mask:0xf
    v_mov_b32_dpp v116, v43 row_newbcast:12 row_mask:0xf bank_mask:0xf
    v_mov_b32_dpp v117, v43 row_newbcast:13 row_mask:0xf bank_mask:0xf
    v_mov_b32_dpp v118, v43 row_newbcast:14 row_mask:0xf bank_mask:0xf
    v_mov_b32_dpp v119, v43 row_newbcast:15 row_mask:0xf bank_mask:0xf
    s_lshl3_add_u32 s15, s3, 156160
    v_mov_b32 v4, s15
    v_and_b32 v5, 7, v1
    v_lshlrev_b32 v5, 3, v5
    v_add_u32 v5, 156160, v5
    v_and_b32 v6, 3, v1
    v_lshlrev_b32 v6, 18, v6
    v_bfe_u32 v9, v1, 2, 2
    v_lshl_add_u32 v6, v9, 13, v6
    s_and_b32 s96, s21, 1
    s_and_b32 s97, s12, 7
    s_lshr_b32 s98, s12, 3
    s_lshl3_add_u32 s99, s97, s98
    s_lshl_b32 s97, s99, 12
    s_lshr_b32 s98, s21, 1
    s_lshl_b32 s99, s98, 6
    s_add_u32 s98, s97, s99
    s_lshl4_add_u32 s97, s96, s98
    s_add_u32 s99, s97, 1048576
    s_add_u32 s16, s99, 2560
    s_waitcnt vmcnt(3)
    v_pk_add_f32 v[192:193], v[192:193], v[196:197]
    v_pk_add_f32 v[200:201], v[200:201], v[204:205]
    v_pk_add_f32 v[194:195], v[194:195], v[198:199]
    v_pk_add_f32 v[202:203], v[202:203], v[206:207]
    v_pk_add_f32 v[192:193], v[192:193], v[200:201]
    v_pk_add_f32 v[194:195], v[194:195], v[202:203]
    v_add_f32 v193, v193, v194
    v_add_f32 v197, v192, v195
    v_cmp_u_f32 vcc, v193, v197
    s_cbranch_vccz POK_40
PRE_41:
    buffer_load_dwordx4 v[192:195], v2, s[32:35], s14 offen sc1
    buffer_load_dwordx4 v[196:199], v2, s[32:35], s14 offen offset:1024 sc1
L_PAD9:
    s_cbranch_execz L_RET9
    buffer_load_dwordx4 v[200:203], v2, s[32:35], s14 offen offset:2048 sc1
    buffer_load_dwordx4 v[204:207], v2, s[32:35], s14 offen offset:3072 sc1
    s_waitcnt vmcnt(0)
    v_pk_add_f32 v[192:193], v[192:193], v[196:197]
    v_pk_add_f32 v[200:201], v[200:201], v[204:205]
    v_pk_add_f32 v[194:195], v[194:195], v[198:199]
    v_pk_add_f32 v[202:203], v[202:203], v[206:207]
    v_pk_add_f32 v[192:193], v[192:193], v[200:201]
    v_pk_add_f32 v[194:195], v[194:195], v[202:203]
    v_add_f32 v193, v193, v194
    v_add_f32 v197, v192, v195
    v_cmp_u_f32 vcc, v193, v197
    s_cbranch_vccz POK_40
    s_add_u32 s5, s5, 1
    s_cmp_lt_u32 s5, 200000
    s_cbranch_scc1 PRE_41
POK_40:
    v_mov_b32 v196, v195
    s_nop 1
    v_permlane32_swap_b32 v195, v196
    v_permlane32_swap_b32 v192, v193
    v_add_f32 v195, v195, v196
    v_add_f32 v192, v192, v193
    s_nop 1
    v_permlane16_swap_b32 v192, v195
    v_add_f32 v193, v192, v195
    v_add_f32 v195, v192, v195
    s_nop 1
    v_permlane16_swap_b32 v193, v195
    v_mov_b32 v192, v193
    v_mul_f32 v195, 0x3a800000, v195
    s_nop 0
    v_permlane32_swap_b32 v192, v193
    v_mul_f32 v192, 0x3a800000, v192
    v_fma_f32 v31, -v192, v192, v195
    v_cvt_pk_bf16_f32 v30, 0, v192
    v_max_f32 v31, 0, v31
    v_cvt_pk_bf16_f32 v31, 0, v31
    v_fma_f32 v193, -v30, v40, v193
    v_add_f32 v31, 0x3727c5ac, v31
    v_cvt_pk_bf16_f32 v31, 0, v31
    v_sqrt_f32 v31, v31
    s_nop 0
    v_cvt_pk_bf16_f32 v31, 0, v31
    v_rcp_f32 v31, v31
    s_nop 0
    v_mul_f32 v32, v193, v31
    v_ashrrev_i32 v196, 31, v32
    v_or_b32 v196, 0x80000000, v196
    v_xor_b32 v32, v32, v196
    s_mov_b32 s15, 0xfffff000
    v_and_or_b32 v32, v32, s15, v29
    s_nop 1
    v_max_u32_dpp v244, v32, v32 quad_perm:[1,0,3,2] row_mask:0xf bank_mask:0xf
    v_min_u32_dpp v245, v32, v32 quad_perm:[1,0,3,2] row_mask:0xf bank_mask:0xf
    s_nop 0
    v_min_u32_dpp v196, v244, v244 quad_perm:[2,3,0,1] row_mask:0xf bank_mask:0xf
    v_max_u32_dpp v245, v245, v245 quad_perm:[2,3,0,1] row_mask:0xf bank_mask:0xf
    v_max_u32_dpp v244, v244, v244 quad_perm:[2,3,0,1] row_mask:0xf bank_mask:0xf
    v_max_u32 v245, v245, v196
    s_nop 0
    v_min_u32_dpp v196, v244, v244 row_half_mirror row_mask:0xf bank_mask:0xf
    v_max_u32_dpp v245, v245, v245 row_half_mirror row_mask:0xf bank_mask:0xf
    v_max_u32_dpp v244, v244, v244 row_half_mirror row_mask:0xf bank_mask:0xf
    v_max_u32 v245, v245, v196
    s_nop 0
    v_min_u32_dpp v196, v244, v244 row_mirror row_mask:0xf bank_mask:0xf
    v_max_u32_dpp v245, v245, v245 row_mirror row_mask:0xf bank_mask:0xf
    v_max_u32_dpp v244, v244, v244 row_mirror row_mask:0xf bank_mask:0xf
    v_max_u32 v245, v245, v196
    ds_write_b64 v4, v[244:245]
    s_waitcnt lgkmcnt(0)
    s_barrier
    ds_read_b64 v[244:245], v5
    v_pk_add_f32 v[208:209], v[152:153], v[30:31] op_sel_hi:[1,0] neg_lo:[0,1] neg_hi:[0,1]
    v_pk_add_f32 v[210:211], v[154:155], v[30:31] op_sel_hi:[1,0] neg_lo:[0,1] neg_hi:[0,1]
    v_pk_add_f32 v[212:213], v[156:157], v[30:31] op_sel_hi:[1,0] neg_lo:[0,1] neg_hi:[0,1]
    v_pk_add_f32 v[214:215], v[158:159], v[30:31] op_sel_hi:[1,0] neg_lo:[0,1] neg_hi:[0,1]
    v_pk_add_f32 v[216:217], v[160:161], v[30:31] op_sel_hi:[1,0] neg_lo:[0,1] neg_hi:[0,1]
    v_pk_add_f32 v[218:219], v[162:163], v[30:31] op_sel_hi:[1,0] neg_lo:[0,1] neg_hi:[0,1]
    v_pk_add_f32 v[220:221], v[164:165], v[30:31] op_sel_hi:[1,0] neg_lo:[0,1] neg_hi:[0,1]
    v_pk_add_f32 v[222:223], v[166:167], v[30:31] op_sel_hi:[1,0] neg_lo:[0,1] neg_hi:[0,1]
    s_waitcnt lgkmcnt(0)
    v_min_u32_dpp v196, v244, v244 quad_perm:[1,0,3,2] row_mask:0xf bank_mask:0xf
    v_max_u32_dpp v245, v245, v245 quad_perm:[1,0,3,2] row_mask:0xf bank_mask:0xf
    v_max_u32_dpp v244, v244, v244 quad_perm:[1,0,3,2] row_mask:0xf bank_mask:0xf
    v_max_u32 v245, v245, v196
    s_nop 0
    v_min_u32_dpp v196, v244, v244 quad_perm:[2,3,0,1] row_mask:0xf bank_mask:0xf
    v_max_u32_dpp v245, v245, v245 quad_perm:[2,3,0,1] row_mask:0xf bank_mask:0xf
    v_max_u32_dpp v244, v244, v244 quad_perm:[2,3,0,1] row_mask:0xf bank_mask:0xf
    v_max_u32 v245, v245, v196
    s_nop 0
    v_min_u32_dpp v196, v244, v244 row_half_mirror row_mask:0xf bank_mask:0xf
    v_max_u32_dpp v245, v245, v245 row_half_mirror row_mask:0xf bank_mask:0xf
    v_max_u32_dpp v244, v244, v244 row_half_mirror row_mask:0xf bank_mask:0xf
    v_max_u32 v245, v245, v196
    v_cmp_eq_u32 s[88:89], v32, v245
    v_cmp_eq_u32 vcc, v32, v244
    v_or_b32 v246, 1, v245
    v_mov_b32 v245, s4
    v_mov_b32 v247, s4
    s_or_b64 s[84:85], vcc, s[88:89]
    s_cmp_lg_u32 s3, 0
    s_cbranch_scc1 L_NOF
    s_mov_b64 exec, 0xffff
    buffer_store_dwordx4 v[244:247], v6, s[32:35], s16 offen sc1
    s_mov_b64 exec, -1
L_NOF:
    s_cmp_eq_u64 s[84:85], 0
    s_cbranch_scc1 L_NOPR
    s_setprio 1
L_NOPR:
    s_lshl4_add_u32 s13, s3, 156288
    v_mov_b32 v4, s13
    v_and_b32 v5, 7, v1
    v_lshlrev_b32 v5, 4, v5
    v_add_u32 v5, 156288, v5
    s_load_dwordx8 s[24:31], s[32:33], s92 offset:2560 glc
    v_cvt_pk_bf16_f32 v208, 0, v208
    v_cvt_pk_bf16_f32 v209, 0, v209
    v_cvt_pk_bf16_f32 v210, 0, v210
    v_cvt_pk_bf16_f32 v211, 0, v211
    v_cvt_pk_bf16_f32 v212, 0, v212
    v_cvt_pk_bf16_f32 v213, 0, v213
    v_cvt_pk_bf16_f32 v214, 0, v214
    v_cvt_pk_bf16_f32 v215, 0, v215
    v_cvt_pk_bf16_f32 v216, 0, v216
    v_cvt_pk_bf16_f32 v217, 0, v217
    v_cvt_pk_bf16_f32 v218, 0, v218
    v_cvt_pk_bf16_f32 v219, 0, v219
    v_cvt_pk_bf16_f32 v220, 0, v220
    v_cvt_pk_bf16_f32 v221, 0, v221
    v_cvt_pk_bf16_f32 v222, 0, v222
    v_cvt_pk_bf16_f32 v223, 0, v223
    v_pk_mul_f32 v[208:209], v[30:31], v[208:209] op_sel:[1,0]
    v_pk_mul_f32 v[210:211], v[30:31], v[210:211] op_sel:[1,0]
    v_pk_mul_f32 v[212:213], v[30:31], v[212:213] op_sel:[1,0]
    v_pk_mul_f32 v[214:215], v[30:31], v[214:215] op_sel:[1,0]
    v_pk_mul_f32 v[216:217], v[30:31], v[216:217] op_sel:[1,0]
    v_pk_mul_f32 v[218:219], v[30:31], v[218:219] op_sel:[1,0]
    v_pk_mul_f32 v[220:221], v[30:31], v[220:221] op_sel:[1,0]
    v_pk_mul_f32 v[222:223], v[30:31], v[222:223] op_sel:[1,0]
    v_cvt_pk_bf16_f32 v208, 0, v208
    v_cvt_pk_bf16_f32 v209, 0, v209
    v_cvt_pk_bf16_f32 v210, 0, v210
    v_cvt_pk_bf16_f32 v211, 0, v211
    v_cvt_pk_bf16_f32 v212, 0, v212
    v_cvt_pk_bf16_f32 v213, 0, v213
    v_cvt_pk_bf16_f32 v214, 0, v214
    v_cvt_pk_bf16_f32 v215, 0, v215
    v_cvt_pk_bf16_f32 v216, 0, v216
    v_cvt_pk_bf16_f32 v217, 0, v217
    v_cvt_pk_bf16_f32 v218, 0, v218
    v_cvt_pk_bf16_f32 v219, 0, v219
    v_cvt_pk_bf16_f32 v220, 0, v220
    v_cvt_pk_bf16_f32 v221, 0, v221
    v_cvt_pk_bf16_f32 v222, 0, v222
    v_cvt_pk_bf16_f32 v223, 0, v223
    v_pk_mul_f32 v[208:209], v[208:209], v[168:169]
    v_pk_mul_f32 v[210:211], v[210:211], v[170:171]
    v_pk_mul_f32 v[212:213], v[212:213], v[172:173]
    v_pk_mul_f32 v[214:215], v[214:215], v[174:175]
    v_pk_mul_f32 v[216:217], v[216:217], v[176:177]
    v_pk_mul_f32 v[218:219], v[218:219], v[178:179]
    v_pk_mul_f32 v[220:221], v[220:221], v[180:181]
    v_pk_mul_f32 v[222:223], v[222:223], v[182:183]
    v_cvt_pk_bf16_f32 v208, 0, v208
    v_cvt_pk_bf16_f32 v209, 0, v209
    v_cvt_pk_bf16_f32 v210, 0, v210
    v_cvt_pk_bf16_f32 v211, 0, v211
    v_cvt_pk_bf16_f32 v212, 0, v212
    v_cvt_pk_bf16_f32 v213, 0, v213
    v_cvt_pk_bf16_f32 v214, 0, v214
    v_cvt_pk_bf16_f32 v215, 0, v215
    v_cvt_pk_bf16_f32 v216, 0, v216
    v_cvt_pk_bf16_f32 v217, 0, v217
    v_cvt_pk_bf16_f32 v218, 0, v218
    v_cvt_pk_bf16_f32 v219, 0, v219
    v_cvt_pk_bf16_f32 v220, 0, v220
    v_cvt_pk_bf16_f32 v221, 0, v221
    v_cvt_pk_bf16_f32 v222, 0, v222
    v_cvt_pk_bf16_f32 v223, 0, v223
    v_pk_add_f32 v[208:209], v[208:209], v[88:89]
    v_pk_add_f32 v[210:211], v[210:211], v[90:91]
    v_pk_add_f32 v[212:213], v[212:213], v[92:93]
    v_pk_add_f32 v[214:215], v[214:215], v[94:95]
    v_pk_add_f32 v[216:217], v[216:217], v[96:97]
    v_pk_add_f32 v[218:219], v[218:219], v[98:99]
    v_pk_add_f32 v[220:221], v[220:221], v[100:101]
    v_pk_add_f32 v[222:223], v[222:223], v[102:103]
    v_cvt_pk_bf16_f32 v224, v208, v209
    v_cvt_pk_bf16_f32 v225, v210, v211
    v_cvt_pk_bf16_f32 v226, v212, v213
    v_cvt_pk_bf16_f32 v227, v214, v215
    v_cvt_pk_bf16_f32 v228, v216, v217
    v_cvt_pk_bf16_f32 v229, v218, v219
    v_cvt_pk_bf16_f32 v230, v220, v221
    v_cvt_pk_bf16_f32 v231, v222, v223
    s_cmp_eq_u64 s[84:85], 0
    s_cbranch_scc1 L_NOCAND
    v_mfma_f32_16x16x32_bf16 v[240:243], v[184:187], v[224:227], 0
    v_mfma_f32_16x16x32_bf16 v[240:243], v[188:191], v[228:231], v[240:243]
    v_mov_b32 v232, v224
    v_mov_b32 v233, v225
    v_mov_b32 v234, v226
    v_mov_b32 v235, v227
    v_mov_b32 v236, v228
    v_mov_b32 v237, v229
    v_mov_b32 v238, v230
    v_mov_b32 v239, v231
    s_lshl_b32 s96, s21, 14
    s_lshl_b32 s97, s12, 9
    s_add_u32 s98, s96, s97
    s_add_u32 s15, s98, 13631488
    v_lshrrev_b32 v7, 4, v1
    v_lshlrev_b32 v7, 4, v7
    v_add_u32 v8, 8192, v7
    v_permlane32_swap_b32 v232, v234
    v_permlane32_swap_b32 v233, v235
    v_permlane32_swap_b32 v236, v238
    v_permlane32_swap_b32 v237, v239
    v_permlane32_swap_b32 v12, v14
    v_permlane32_swap_b32 v13, v15
    v_permlane32_swap_b32 v16, v18
    v_permlane32_swap_b32 v17, v19
    v_cndmask_b32 v7, v7, v8, s[88:89]
    s_mov_b64 exec, s[84:85]
    buffer_store_dwordx4 v[232:235], v7, s[32:35], s15 offen sc1
    buffer_store_dwordx4 v[236:239], v7, s[32:35], s15 offen offset:64 sc1
    s_mov_b32 exec_lo, 0
    s_and_b32 exec_hi, s85, 0xffff0000
    buffer_store_dword v240, v7, s[32:35], s15 offen offset:208 sc1
    s_mov_b64 exec, s[84:85]
    buffer_store_dwordx4 v[12:15], v7, s[32:35], s15 offen offset:128 sc1
    buffer_store_dwordx4 v[16:19], v7, s[32:35], s15 offen offset:192 sc1
    s_mov_b64 exec, -1
    s_setprio 0
L_NOCAND:
    s_add_u32 s82, s81, 8192
    s_lshl2_add_u32 m0, s83, 67584
    s_nop 0
    buffer_load_dwordx4 v253, s[60:63], s82 offen nt lds
    s_add_u32 s82, s81, 12288
    s_lshl2_add_u32 m0, s83, 68608
    s_nop 0
    buffer_load_dwordx4 v253, s[60:63], s82 offen nt lds
    v_lshlrev_b32 v208, 16, v224
    v_and_b32 v209, s6, v224
    v_lshlrev_b32 v210, 16, v225
    v_and_b32 v211, s6, v225
    v_lshlrev_b32 v212, 16, v226
    v_and_b32 v213, s6, v226
    v_lshlrev_b32 v214, 16, v227
    v_and_b32 v215, s6, v227
    v_lshlrev_b32 v216, 16, v228
    v_and_b32 v217, s6, v228
    v_lshlrev_b32 v218, 16, v229
    v_and_b32 v219, s6, v229
    v_lshlrev_b32 v220, 16, v230
    v_and_b32 v221, s6, v230
    v_lshlrev_b32 v222, 16, v231
    v_and_b32 v223, s6, v231
    v_pk_mul_f32 v[208:209], v[208:209], v[104:105]
    v_pk_mul_f32 v[210:211], v[210:211], v[106:107]
    v_pk_mul_f32 v[212:213], v[212:213], v[108:109]
    v_pk_mul_f32 v[214:215], v[214:215], v[110:111]
    v_pk_mul_f32 v[216:217], v[216:217], v[112:113]
    v_pk_mul_f32 v[218:219], v[218:219], v[114:115]
    v_pk_mul_f32 v[220:221], v[220:221], v[116:117]
    v_pk_mul_f32 v[222:223], v[222:223], v[118:119]
    v_cvt_pk_bf16_f32 v208, 0, v208
    v_cvt_pk_bf16_f32 v209, 0, v209
    v_cvt_pk_bf16_f32 v210, 0, v210
    v_cvt_pk_bf16_f32 v211, 0, v211
    v_cvt_pk_bf16_f32 v212, 0, v212
    v_cvt_pk_bf16_f32 v213, 0, v213
    v_cvt_pk_bf16_f32 v214, 0, v214
    v_cvt_pk_bf16_f32 v215, 0, v215
    v_cvt_pk_bf16_f32 v216, 0, v216
    v_cvt_pk_bf16_f32 v217, 0, v217
    v_cvt_pk_bf16_f32 v218, 0, v218
    v_cvt_pk_bf16_f32 v219, 0, v219
    v_cvt_pk_bf16_f32 v220, 0, v220
    v_cvt_pk_bf16_f32 v221, 0, v221
    v_cvt_pk_bf16_f32 v222, 0, v222
    v_cvt_pk_bf16_f32 v223, 0, v223
    s_lshl_b32 s96, s3, 11
    s_add_u32 s13, s96, 98304
    v_lshrrev_b32 v202, 4, v1
    v_lshlrev_b32 v202, 4, v202
    v_and_b32 v203, 7, v1
    v_lshlrev_b32 v203, 4, v203
    v_xor_b32 v202, v202, v203
    v_and_b32 v204, 15, v1
    v_lshl_add_u32 v204, v204, 7, s13
    v_add_u32 v202, v202, v204
    v_xor_b32 v204, 64, v202
    v_lshrrev_b32 v205, 3, v1
    v_lshlrev_b32 v205, 4, v205
    v_xor_b32 v203, v205, v203
    v_lshrrev_b32 v205, 3, v1
    v_lshl_add_u32 v205, v205, 7, s13
    v_add_u32 v203, v203, v205
    s_lshl_b32 s96, s21, 7
    s_sub_u32 s97, 2047, s96
    s_lshl_b32 s98, s3, 4
    s_sub_u32 s13, s97, s98
    v_lshrrev_b32 v43, 3, v1
    v_sub_u32 v42, s13, v43
    v_subrev_u32 v43, 8, v42
    v_lshrrev_b32 v33, 3, v1
    v_lshlrev_b32 v33, 11, v33
    v_and_b32 v9, 7, v1
    v_lshl_add_u32 v33, v9, 4, v33
    s_lshl3_add_u32 s96, s21, s3
    s_lshl_b32 s97, s96, 15
    s_lshl_b32 s98, s12, 7
    s_add_u32 s16, s97, s98
    s_add_u32 s15, s16, 16384
    s_branch SCHK_43
SPOLL_42:
    s_load_dwordx8 s[24:31], s[32:33], s92 offset:2560 glc
SCHK_43:
    s_add_u32 s5, s5, 1
    s_cmp_ge_u32 s5, 200000
    s_waitcnt lgkmcnt(0)
    s_cbranch_scc1 SDONE_44
    s_cmp_lg_u32 s25, s4
    s_cbranch_scc1 SPOLL_42
    s_cmp_lg_u32 s27, s4
    s_cbranch_scc1 SPOLL_42
    s_cmp_lg_u32 s29, s4
    s_cbranch_scc1 SPOLL_42
    s_cmp_lg_u32 s31, s4
    s_cbranch_scc1 SPOLL_42
SDONE_44:
    s_min_u32 s25, s24, s28
    s_min_u32 s27, s26, s28
    s_min_u32 s29, s24, s30
    s_max_u32 s24, s24, s28
    s_max_u32 s26, s26, s30
    s_max_u32 s27, s27, s29
    s_max_u32 s25, s25, s26
    v_mov_b32 v244, s24
    v_mov_b32 v246, s27
    v_mov_b32 v245, s25
    ds_write_b128 v4, v[244:247]
    s_lshr_b32 s96, s3, 2
    s_lshl_b32 s97, s96, 15
    s_and_b32 s98, s3, 3
    s_lshl_b32 s99, s98, 5
    s_add_u32 s13, s97, s99
    v_lshrrev_b32 v34, 4, v1
    v_lshlrev_b32 v34, 13, v34
    v_bfe_u32 v9, v1, 2, 2
    v_lshl_add_u32 v34, v9, 7, v34
    v_bfe_u32 v9, v1, 3, 2
    v_lshl_add_u32 v34, v9, 5, v34
    v_and_b32 v9, 3, v1
    v_lshl_add_u32 v34, v9, 3, v34
    v_xor_b32 v34, s13, v34
    s_lshl_b32 s96, s75, 11
    s_add_u32 s13, s96, 13631488
    v_and_b32 v36, 7, v1
    v_lshl_add_u32 v36, v36, 4, s13
    v_lshrrev_b32 v9, 4, v1
    v_lshl_add_u32 v36, v9, 9, v36
    v_and_b32 v10, 15, v1
    v_lshlrev_b32 v10, 9, v10
    v_add_u32 v10, 13631744, v10
    s_waitcnt vmcnt(0)
    s_waitcnt lgkmcnt(0)
    s_barrier
    ds_read_b128 v[244:247], v5
    v_and_b32 v8, 8, v1
    v_cmp_eq_u32 s[22:23], 0, v8
    v_cmp_gt_u32 s[24:25], 16, v1
    v_cmp_gt_u32 s[26:27], 32, v1
    s_waitcnt lgkmcnt(0)
    v_min_u32_dpp v192, v244, v244 quad_perm:[1,0,3,2] row_mask:0xf bank_mask:0xf
    v_min_u32_dpp v193, v245, v244 quad_perm:[1,0,3,2] row_mask:0xf bank_mask:0xf
    v_min_u32_dpp v194, v244, v245 quad_perm:[1,0,3,2] row_mask:0xf bank_mask:0xf
    v_max_u32_dpp v246, v246, v246 quad_perm:[1,0,3,2] row_mask:0xf bank_mask:0xf
    v_max_u32_dpp v245, v245, v245 quad_perm:[1,0,3,2] row_mask:0xf bank_mask:0xf
    v_max_u32_dpp v244, v244, v244 quad_perm:[1,0,3,2] row_mask:0xf bank_mask:0xf
    v_max3_u32 v246, v246, v193, v194
    v_max_u32 v245, v245, v192
    v_min_u32_dpp v192, v244, v244 quad_perm:[2,3,0,1] row_mask:0xf bank_mask:0xf
    s_nop 0
    v_min_u32_dpp v193, v245, v244 quad_perm:[2,3,0,1] row_mask:0xf bank_mask:0xf
    v_min_u32_dpp v194, v244, v245 quad_perm:[2,3,0,1] row_mask:0xf bank_mask:0xf
    v_max_u32_dpp v246, v246, v246 quad_perm:[2,3,0,1] row_mask:0xf bank_mask:0xf
    v_max_u32_dpp v245, v245, v245 quad_perm:[2,3,0,1] row_mask:0xf bank_mask:0xf
    v_max_u32_dpp v244, v244, v244 quad_perm:[2,3,0,1] row_mask:0xf bank_mask:0xf
    v_max3_u32 v246, v246, v193, v194
    v_max_u32 v245, v245, v192
    v_min_u32_dpp v192, v244, v244 row_half_mirror row_mask:0xf bank_mask:0xf
    s_nop 0
    v_min_u32_dpp v193, v245, v244 row_half_mirror row_mask:0xf bank_mask:0xf
    v_min_u32_dpp v194, v244, v245 row_half_mirror row_mask:0xf bank_mask:0xf
    v_max_u32_dpp v246, v246, v246 row_half_mirror row_mask:0xf bank_mask:0xf
    v_max_u32_dpp v245, v245, v245 row_half_mirror row_mask:0xf bank_mask:0xf
    v_max_u32_dpp v244, v244, v244 row_half_mirror row_mask:0xf bank_mask:0xf
    v_max3_u32 v246, v246, v193, v194
    v_max_u32 v245, v245, v192
    v_cndmask_b32 v192, v245, v244, s[22:23]
    v_cndmask_b32 v201, v246, v245, s[26:27]
    v_and_b32 v193, 31, v246
    v_and_b32 v192, 31, v192
    v_cndmask_b32 v201, v201, v244, s[24:25]
    v_lshl_add_u32 v4, v192, 13, v36
    v_lshl_add_u32 v5, v193, 13, v36
    v_and_b32 v194, 31, v201
    v_lshl_add_u32 v6, v194, 13, v10
    buffer_load_dwordx4 v[192:195], v4, s[32:35], 0 offen sc1
    buffer_load_dwordx4 v[196:199], v5, s[32:35], 0 offen sc1
    buffer_load_dword v200, v6, s[32:35], 0 offen sc1
    v_readfirstlane_b32 s91, v244
    v_readfirstlane_b32 s94, v245
    v_readfirstlane_b32 s95, v246
    ds_read_b64_tr_b16 v[56:57], v34
    ds_read_b64_tr_b16 v[58:59], v34 offset:512
    ds_read_b64_tr_b16 v[60:61], v34 offset:1024
    ds_read_b64_tr_b16 v[62:63], v34 offset:1536
    ds_read_b64_tr_b16 v[64:65], v34 offset:2048
    ds_read_b64_tr_b16 v[66:67], v34 offset:2560
    ds_read_b64_tr_b16 v[68:69], v34 offset:3072
    ds_read_b64_tr_b16 v[70:71], v34 offset:3584
    ds_read_b64_tr_b16 v[72:73], v34 offset:4096
    ds_read_b64_tr_b16 v[74:75], v34 offset:4608
    ds_read_b64_tr_b16 v[76:77], v34 offset:5120
    ds_read_b64_tr_b16 v[78:79], v34 offset:5632
    ds_read_b64_tr_b16 v[80:81], v34 offset:6144
    ds_read_b64_tr_b16 v[82:83], v34 offset:6656
    ds_read_b64_tr_b16 v[84:85], v34 offset:7168
    ds_read_b64_tr_b16 v[86:87], v34 offset:7680
    s_bfe_u32 s96, s91, 262145
    s_lshl_b32 s97, s96, 7
    s_bfe_u32 s98, s91, 458757
    s_add_u32 s99, s97, s98
    s_xor_b32 s17, s99, 2047
    s_bfe_u32 s96, s94, 262145
    s_lshl_b32 s97, s96, 7
    s_bfe_u32 s98, s94, 458757
    s_add_u32 s99, s97, s98
    s_xor_b32 s18, s99, 2047
    s_bfe_u32 s96, s95, 262145
    s_lshl_b32 s97, s96, 7
    s_bfe_u32 s98, s95, 458757
    s_add_u32 s99, s97, s98
    s_xor_b32 s19, s99, 2047
    s_waitcnt lgkmcnt(0)
    s_lshl_b32 s13, s3, 6
    v_bfe_u32 v35, v1, 2, 1
    v_lshlrev_b32 v35, 9, v35
    v_bfe_u32 v9, v1, 3, 1
    v_lshl_add_u32 v35, v9, 12, v35
    v_lshrrev_b32 v9, 5, v1
    v_lshl_add_u32 v35, v9, 11, v35
    v_bfe_u32 v9, v1, 2, 2
    v_lshl_add_u32 v35, v9, 6, v35
    v_bfe_u32 v9, v1, 4, 1
    v_lshl_add_u32 v35, v9, 5, v35
    v_and_b32 v9, 3, v1
    v_lshl_add_u32 v35, v9, 3, v35
    v_xor_b32 v35, s13, v35
    v_add_u32 v35, 65536, v35
    v_and_b32 v8, 15, v1
    v_lshlrev_b32 v8, 4, v8
    v_lshrrev_b32 v9, 5, v1
    v_lshl_add_u32 v8, v9, 3, v8
    s_lshl_b32 s96, s74, 13
    s_add_u32 s14, s96, 20971520
    s_lshl3_add_u32 s96, s75, s3
    s_lshl_b32 s97, s96, 8
    s_add_u32 s20, s97, s14
    v_bfe_u32 v7, v201, 1, 4
    v_bfe_u32 v201, v201, 5, 7
    v_lshl_or_b32 v201, v7, 7, v201
    v_xor_b32 v201, 0x7ff, v201
    s_waitcnt vmcnt(0)
    v_max3_u32 v7, v192, v196, v200
    v_cmp_eq_u32 vcc, -1, v7
    s_cbranch_vccz POK_46
PRE_47:
    buffer_load_dwordx4 v[192:195], v4, s[32:35], 0 offen sc1
    buffer_load_dwordx4 v[196:199], v5, s[32:35], 0 offen sc1
    buffer_load_dword v200, v6, s[32:35], 0 offen sc1
    s_waitcnt vmcnt(0)
    v_max3_u32 v7, v192, v196, v200
    v_cmp_eq_u32 vcc, -1, v7
    s_cbranch_vccz POK_46
    s_add_u32 s5, s5, 1
    s_cmp_lt_u32 s5, 200000
    s_cbranch_scc1 PRE_47
POK_46:
    v_add_f32_dpp v200, v200, v200 quad_perm:[1,0,3,2] row_mask:0xf bank_mask:0xf
    s_nop 1
    v_add_f32_dpp v200, v200, v200 quad_perm:[2,3,0,1] row_mask:0xf bank_mask:0xf
    s_nop 1
    v_add_f32_dpp v200, v200, v200 row_half_mirror row_mask:0xf bank_mask:0xf
    s_nop 1
    v_add_f32_dpp v200, v200, v200 row_mirror row_mask:0xf bank_mask:0xf
    v_cvt_pk_bf16_f32 v200, 0, v200
    v_ashrrev_i32 v7, 31, v200
    v_or_b32 v7, 0x80000000, v7
    v_xor_b32 v200, v200, v7
    v_lshrrev_b32 v200, 16, v200
    v_lshl_or_b32 v200, v200, 11, v201
    s_nop 0
    v_readlane_b32 s24, v200, 0
    v_readlane_b32 s25, v200, 16
    v_readlane_b32 s26, v200, 32
    s_not_b64 s[28:29], s[22:23]
    s_cmp_lt_u32 s24, s25
    s_cselect_b64 s[28:29], s[22:23], s[28:29]
    s_cselect_b32 s27, s24, s25
    s_cmp_gt_u32 s26, s27
    s_cselect_b64 vcc, s[28:29], 0
    v_cndmask_b32 v192, v192, v196, vcc
    v_cndmask_b32 v193, v193, v197, vcc
    v_cndmask_b32 v194, v194, v198, vcc
    v_cndmask_b32 v195, v195, v199, vcc
    s_bitcmp1_b32 vcc_lo, 0
    s_cselect_b32 s24, s26, s24
    s_cselect_b32 s19, s17, s19
    s_cselect_b32 s17, s95, s91
    s_bitcmp1_b32 vcc_lo, 8
    s_cselect_b32 s25, s26, s25
    s_cselect_b32 s19, s18, s19
    s_cselect_b32 s18, s95, s94
    s_waitcnt lgkmcnt(0)
    v_mfma_f32_16x16x32_bf16 v[136:139], v[192:195], v[56:59], 0
    v_mfma_f32_16x16x32_bf16 v[140:143], v[192:195], v[60:63], 0
    v_mfma_f32_16x16x32_bf16 v[144:147], v[192:195], v[64:67], 0
    v_mfma_f32_16x16x32_bf16 v[148:151], v[192:195], v[68:71], 0
    v_mfma_f32_16x16x32_bf16 v[168:171], v[192:195], v[72:75], 0
    v_mfma_f32_16x16x32_bf16 v[172:175], v[192:195], v[76:79], 0
    v_mfma_f32_16x16x32_bf16 v[176:179], v[192:195], v[80:83], 0
    v_mfma_f32_16x16x32_bf16 v[180:183], v[192:195], v[84:87], 0
    s_nop 1
    v_add_f32 v196, v136, v141
    s_nop 0
    v_add_f32 v197, v146, v151
    s_nop 0
    v_add_f32 v198, v168, v173
    s_nop 0
    v_add_f32 v199, v178, v183
    v_add_f32 v196, v196, v197
    v_add_f32 v198, v198, v199
    v_mov_b32 v197, s4
    s_nop 0
    v_permlane16_swap_b32 v198, v199
    s_cmp_ge_u32 s9, 28
    s_cbranch_scc1 L_NOHP
    v_add_f32 v196, v196, v199
    s_mov_b32 exec_lo, 0xffff
    s_mov_b32 exec_hi, 0xffff
    buffer_store_dwordx2 v[196:197], v8, s[32:35], s20 offen sc1
    s_mov_b64 exec, -1
L_NOHP:
    ds_read_b64_tr_b16 v[120:121], v35
    ds_read_b64_tr_b16 v[122:123], v35 offset:1024
    ds_read_b64_tr_b16 v[124:125], v35 offset:8192
    ds_read_b64_tr_b16 v[126:127], v35 offset:9216
    ds_read_b64_tr_b16 v[128:129], v35 offset:16384
    ds_read_b64_tr_b16 v[130:131], v35 offset:17408
    ds_read_b64_tr_b16 v[132:133], v35 offset:24576
    ds_read_b64_tr_b16 v[134:135], v35 offset:25600
    s_and_b32 s68, s24, 2047
    s_and_b32 s69, s25, 2047
    s_mov_b32 s70, s16
    s_mov_b32 s71, s15
    v_pk_add_f32 v[208:209], v[208:209], v[152:153]
    v_pk_add_f32 v[210:211], v[210:211], v[154:155]
    v_pk_add_f32 v[212:213], v[212:213], v[156:157]
    v_pk_add_f32 v[214:215], v[214:215], v[158:159]
    v_pk_add_f32 v[216:217], v[216:217], v[160:161]
    v_pk_add_f32 v[218:219], v[218:219], v[162:163]
    v_pk_add_f32 v[220:221], v[220:221], v[164:165]
    v_pk_add_f32 v[222:223], v[222:223], v[166:167]
    v_cvt_pk_bf16_f32 v232, v208, v209
    v_cvt_pk_bf16_f32 v233, v210, v211
    v_cvt_pk_bf16_f32 v234, v212, v213
    v_cvt_pk_bf16_f32 v235, v214, v215
    v_cvt_pk_bf16_f32 v236, v216, v217
    v_cvt_pk_bf16_f32 v237, v218, v219
    v_cvt_pk_bf16_f32 v238, v220, v221
    v_cvt_pk_bf16_f32 v239, v222, v223
    v_permlane32_swap_b32 v232, v234
    v_permlane32_swap_b32 v233, v235
    v_permlane32_swap_b32 v236, v238
    v_permlane32_swap_b32 v237, v239
    ds_write_b128 v202, v[232:235]
    ds_write_b128 v204, v[236:239]
    ds_read_b128 v[232:235], v203
    ds_read_b128 v[236:239], v203 offset:1024
    s_waitcnt lgkmcnt(0)
    s_cmp_lg_u32 s93, 7
    s_cbranch_scc1 L_NONON
    v_mov_b32 v6, s4
    v_mov_b32 v7, 0
    s_mov_b64 exec, 1
    buffer_store_dword v6, v7, s[32:35], 0 offen sc1
    s_mov_b64 exec, -1
L_NONON:
    s_cmp_ge_u32 s9, 28
    s_cbranch_scc1 L_FIN2
    s_cmp_lg_u32 s3, 7
    s_cbranch_scc1 L_NOFZ
    s_bitcmp1_b32 s9, 3
    s_cselect_b32 s15, s25, s24
    s_cselect_b32 s17, s18, s17
    s_andn2_b32 s18, 2047, s15
    s_lshr_b32 s96, s8, 1
    s_lshl2_add_u32 s19, s12, s96
    s_lshr_b32 s96, s19, 1
    s_lshr_b32 s97, s9, 3
    s_lshl_b32 s98, s97, 1
    s_lshl2_add_u32 s99, s96, s98
    s_and_b32 s97, s19, 1
    s_add_u32 s96, s99, s97
    s_mul_i32 s98, s96, 7168
    s_add_u32 s20, s98, 22020096
    s_lshl_b32 s96, s18, 11
    s_lshl_b32 s97, s19, 5
    s_add_u32 s82, s96, s97
    v_and_b32 v10, 7, v1
    v_lshlrev_b32 v10, 2, v10
    s_lshr_b32 s96, s8, 1
    s_lshl_b32 s97, s96, 6
    s_add_u32 s13, s97, 157184
    v_and_b32 v5, 7, v1
    v_lshl_add_u32 v5, v5, 3, s13
    ds_read_b64 v[206:207], v5
    s_and_b32 s96, s17, 31
    s_lshl_b32 s97, s96, 13
    s_lshl_b32 s98, s12, 9
    s_add_u32 s99, s97, s98
    s_lshr_b32 s96, s8, 1
    s_lshl_b32 s97, s96, 5
    s_add_u32 s98, s99, s97
    s_add_u32 s91, s98, 13631488
    s_lshr_b32 s13, s15, 11
    s_lshl_b32 s13, s13, 16
    s_ashr_i32 s15, s13, 31
    s_andn2_b32 s15, 0x7fff0000, s15
    s_or_b32 s15, s15, 0x80000000
    s_xor_b32 s13, s13, s15
    v_mov_b32 v204, s13
    v_mul_f32 v204, s7, v204
    v_exp_f32 v204, -v204
    s_nop 0
    v_add_f32 v204, 1.0, v204
    v_rcp_f32 v204, v204
    s_nop 0
    v_cvt_pk_bf16_f32 v204, 0, v204
L_NOFZ:
    s_cmp_ge_u32 s3, 4
    s_cbranch_scc1 L_NOH
    s_lshl_b32 s96, s3, 8
    s_add_u32 s13, s96, s14
    v_lshrrev_b32 v4, 4, v1
    v_lshlrev_b32 v4, 11, v4
    v_and_b32 v9, 15, v1
    v_lshl_add_u32 v4, v9, 4, v4
    s_lshl_b32 s96, s3, 5
    s_add_u32 s15, s96, 156672
    v_lshrrev_b32 v5, 5, v1
    v_lshl_add_u32 v5, v5, 7, s15
    v_bfe_u32 v9, v1, 2, 1
    v_lshl_add_u32 v5, v9, 4, v5
    v_bfe_u32 v9, v1, 1, 1
    v_lshl_add_u32 v5, v9, 3, v5
    v_bfe_u32 v9, v1, 3, 1
    v_lshl_add_u32 v5, v9, 2, v5
    v_and_b32 v9, 1, v1
    v_lshl_add_u32 v5, v9, 1, v5
SPOLL_48:
    s_load_dword s24, s[32:33], s13 offset:1276 glc
    s_load_dword s25, s[32:33], s13 offset:3324 glc
    s_load_dword s26, s[32:33], s13 offset:5372 glc
L_PAD10:
    s_cbranch_execz L_RET10
    s_load_dword s27, s[32:33], s13 offset:7420 glc
SCHK_49:
    s_add_u32 s5, s5, 1
    s_cmp_ge_u32 s5, 200000
    s_waitcnt lgkmcnt(0)
    s_cbranch_scc1 SDONE_50
    s_cmp_lg_u32 s24, s4
    s_cbranch_scc1 SPOLL_48
    s_cmp_lg_u32 s25, s4
    s_cbranch_scc1 SPOLL_48
    s_cmp_lg_u32 s26, s4
    s_cbranch_scc1 SPOLL_48
    s_cmp_lg_u32 s27, s4
    s_cbranch_scc1 SPOLL_48
SDONE_50:
POLL_51:
    buffer_load_dwordx4 v[88:91], v4, s[32:35], s13 offen sc1
    buffer_load_dwordx4 v[92:95], v4, s[32:35], s13 offen offset:1024 sc1
    s_waitcnt vmcnt(0)
    v_bitop3_b32 v6, v89, v91, s4 bitop3:0x7e
    v_bitop3_b32 v6, v6, v93, s4 bitop3:0xf6
    v_bitop3_b32 v6, v6, v95, s4 bitop3:0xf6
    v_cmp_ne_u32 vcc, 0, v6
    s_cbranch_vccz PDONE_52
    s_add_u32 s5, s5, 1
    s_cmp_lt_u32 s5, 200000
    s_cbranch_scc1 POLL_51
PDONE_52:
    v_permlane32_swap_b32 v88, v90
    v_permlane32_swap_b32 v92, v94
    v_add_f32 v88, v88, v90
    v_add_f32 v92, v92, v94
    v_mov_b32 v90, v88
    v_mov_b32 v94, v92
    s_nop 0
    v_permlane16_swap_b32 v88, v90
    v_permlane16_swap_b32 v92, v94
    v_add_f32 v88, v88, v90
    v_add_f32 v92, v92, v94
    v_cvt_pk_bf16_f32 v88, 0, v88
    v_cvt_pk_bf16_f32 v92, 0, v92
    v_mul_f32 v6, s7, v88
    v_exp_f32 v6, -v6
    s_nop 0
    v_add_f32 v6, 1.0, v6
    v_rcp_f32 v6, v6
    s_nop 0
    v_mul_f32 v88, v88, v6
    v_cvt_pk_bf16_f32 v88, 0, v88
    v_mul_f32 v88, v88, v92
    v_cvt_pk_bf16_f32 v88, v88, v88
    ds_write_b16 v5, v88
L_NOH:
    v_bfe_u32 v4, v1, 2, 1
    v_lshlrev_b32 v4, 7, v4
    v_lshrrev_b32 v9, 5, v1
    v_lshl_add_u32 v4, v9, 4, v4
    v_add_u32 v4, 156672, v4
    v_lshrrev_b32 v5, 4, v1
    v_mul_u32_u24 v5, 7168, v5
    v_and_b32 v9, 15, v1
    v_lshl_add_u32 v5, v9, 3, v5
    s_lshl3_add_u32 s96, s75, s3
    s_mul_i32 s97, s96, 28672
    s_lshl_b32 s98, s74, 7
    s_add_u32 s99, s97, s98
    s_add_u32 s13, s99, 22020096
    v_and_b32 v6, 1, v1
    v_lshlrev_b32 v6, 13, v6
    v_bfe_u32 v9, v1, 1, 1
    v_lshl_add_u32 v6, v9, 18, v6
    s_lshr_b32 s96, s9, 2
    s_and_b32 s97, s75, 1
    s_lshr_b32 s98, s3, 1
    s_lshl2_add_u32 s99, s97, s98
    s_and_b32 s97, s3, 1
    s_lshr_b32 s98, s75, 1
    s_lshl2_add_u32 s97, s97, s98
    s_lshl3_add_u32 s98, s99, s97
    s_lshl_b32 s99, s98, 12
    s_lshl_b32 s97, s8, 6
    s_add_u32 s98, s99, s97
    s_lshl2_add_u32 s99, s96, s98
    s_add_u32 s97, s99, 1048576
    s_add_u32 s14, s97, 3072
    s_waitcnt lgkmcnt(0)
    s_barrier
    ds_read_b128 v[88:91], v4
    ds_read_b128 v[92:95], v4 offset:32
    ds_read_b128 v[96:99], v4 offset:64
    ds_read_b128 v[100:103], v4 offset:96
    s_waitcnt lgkmcnt(3)
    v_mfma_f32_32x32x16_bf16 v[208:223], v[88:91], v[120:123], 0
    s_waitcnt lgkmcnt(2)
    v_mfma_f32_32x32x16_bf16 v[208:223], v[92:95], v[124:127], v[208:223]
    s_waitcnt lgkmcnt(1)
    v_mfma_f32_32x32x16_bf16 v[208:223], v[96:99], v[128:131], v[208:223]
    s_waitcnt lgkmcnt(0)
    v_mfma_f32_32x32x16_bf16 v[208:223], v[100:103], v[132:135], v[208:223]
    s_nop 11
    v_mov_b32 v209, s4
    buffer_store_dwordx2 v[208:209], v5, s[32:35], s13 offen sc1
    s_mov_b64 exec, 15
    buffer_store_dword v209, v6, s[32:35], s14 offen sc1
    s_mov_b64 exec, -1
    s_barrier
L_FIN2:
    v_cmp_ne_u32 vcc, s68, v42
    v_cmp_ne_u32 s[22:23], s69, v42
    s_nop 0
    s_and_b64 exec, vcc, s[22:23]
    buffer_store_dwordx4 v[232:235], v33, s[64:67], s70 offen sc1
    s_mov_b64 exec, -1
    v_cmp_ne_u32 vcc, s68, v43
    v_cmp_ne_u32 s[22:23], s69, v43
    s_nop 0
    s_and_b64 exec, vcc, s[22:23]
    buffer_store_dwordx4 v[236:239], v33, s[64:67], s71 offen sc1
    s_mov_b64 exec, -1
    s_cmp_ge_u32 s9, 16
    s_cbranch_scc1 L_FIN
SPOLL_53:
    s_load_dwordx8 s[24:31], s[32:33], s92 offset:3072 glc
SCHK_54:
    s_add_u32 s5, s5, 1
    s_cmp_ge_u32 s5, 200000
    s_waitcnt lgkmcnt(0)
    s_cbranch_scc1 SDONE_55
    s_cmp_lg_u32 s24, s4
    s_cbranch_scc1 SPOLL_53
    s_cmp_lg_u32 s25, s4
    s_cbranch_scc1 SPOLL_53
    s_cmp_lg_u32 s26, s4
    s_cbranch_scc1 SPOLL_53
    s_cmp_lg_u32 s27, s4
    s_cbranch_scc1 SPOLL_53
    s_cmp_lg_u32 s28, s4
    s_cbranch_scc1 SPOLL_53
    s_cmp_lg_u32 s29, s4
    s_cbranch_scc1 SPOLL_53
    s_cmp_lg_u32 s30, s4
    s_cbranch_scc1 SPOLL_53
SDONE_55:
    s_barrier
    s_cmp_lg_u32 s3, 7
    s_cbranch_scc1 L_FIN
    s_add_u32 s13, s20, 4096
    v_mov_b32 v5, s4
    v_not_b32 v6, v5
POLL_56:
    buffer_load_dwordx4 v[88:91], v2, s[32:35], s20 offen sc1
    buffer_load_dwordx4 v[92:95], v2, s[32:35], s20 offen offset:1024 sc1
    buffer_load_dwordx4 v[96:99], v2, s[32:35], s20 offen offset:2048 sc1
    buffer_load_dwordx4 v[100:103], v2, s[32:35], s20 offen offset:3072 sc1
    buffer_load_dwordx4 v[104:107], v2, s[32:35], s13 offen sc1
    buffer_load_dwordx4 v[108:111], v2, s[32:35], s13 offen offset:1024 sc1
    buffer_load_dwordx4 v[112:115], v2, s[32:35], s13 offen offset:2048 sc1
    buffer_load_dword v244, v10, s[32:35], s91 offen sc1
    buffer_load_dword v245, v10, s[32:35], s91 offen offset:128 sc1
    s_waitcnt vmcnt(0)
    v_max_u32 v246, v244, v245
    v_cmp_ne_u32 vcc, -1, v246
    s_nop 1
    v_cndmask_b32 v246, v6, v5, vcc
    v_bitop3_b32 v4, v89, v91, s4 bitop3:0x7e
    v_bitop3_b32 v4, v4, v93, s4 bitop3:0xf6
    v_bitop3_b32 v4, v4, v95, s4 bitop3:0xf6
    v_bitop3_b32 v4, v4, v97, s4 bitop3:0xf6
    v_bitop3_b32 v4, v4, v99, s4 bitop3:0xf6
    v_bitop3_b32 v4, v4, v101, s4 bitop3:0xf6
    v_bitop3_b32 v4, v4, v103, s4 bitop3:0xf6
    v_bitop3_b32 v4, v4, v105, s4 bitop3:0xf6
    v_bitop3_b32 v4, v4, v107, s4 bitop3:0xf6
    v_bitop3_b32 v4, v4, v109, s4 bitop3:0xf6
    v_bitop3_b32 v4, v4, v111, s4 bitop3:0xf6
    v_bitop3_b32 v4, v4, v113, s4 bitop3:0xf6
    v_bitop3_b32 v4, v4, v115, s4 bitop3:0xf6
    v_bitop3_b32 v4, v4, v246, s4 bitop3:0xf6
    v_cmp_ne_u32 vcc, 0, v4
    s_cbranch_vccz PDONE_57
    s_add_u32 s5, s5, 1
    s_cmp_lt_u32 s5, 200000
    s_cbranch_scc1 POLL_56
PDONE_57:
    v_add_f32 v88, v88, v92
    v_add_f32 v90, v90, v94
    v_add_f32 v88, v88, v96
    v_add_f32 v90, v90, v98
    v_add_f32 v88, v88, v100
    v_add_f32 v90, v90, v102
    v_add_f32 v88, v88, v104
    v_add_f32 v90, v90, v106
    v_add_f32 v88, v88, v108
    v_add_f32 v90, v90, v110
    v_add_f32 v88, v88, v112
    v_add_f32 v90, v90, v114
    v_mov_b32 v89, v90
    v_add_f32_dpp v88, v88, v88 row_ror:8 row_mask:0xf bank_mask:0xf
    s_nop 0
    v_add_f32_dpp v89, v89, v89 row_ror:8 row_mask:0xf bank_mask:0xf
    v_mov_b32 v90, v88
    v_mov_b32 v91, v89
    s_nop 0
    v_permlane16_swap_b32 v88, v90
    v_permlane16_swap_b32 v89, v91
    v_pk_add_f32 v[88:89], v[88:89], v[90:91]
    v_mov_b32 v90, v88
    v_mov_b32 v91, v89
    s_nop 0
    v_permlane32_swap_b32 v88, v90
    v_permlane32_swap_b32 v89, v91
    v_pk_add_f32 v[88:89], v[88:89], v[90:91]
    v_cvt_pk_bf16_f32 v88, 0, v88
    v_cvt_pk_bf16_f32 v89, 0, v89
    v_pk_mul_f32 v[88:89], v[88:89], v[204:205] op_sel_hi:[1,0]
    v_lshlrev_b32 v4, 16, v244
    v_and_b32 v5, s6, v244
    v_cvt_pk_bf16_f32 v88, 0, v88
    v_cvt_pk_bf16_f32 v89, 0, v89
    v_pk_add_f32 v[88:89], v[88:89], v[4:5]
    v_cvt_pk_bf16_f32 v88, 0, v88
    v_cvt_pk_bf16_f32 v89, 0, v89
    v_pk_mul_f32 v[88:89], v[88:89], v[206:207]
    v_lshlrev_b32 v4, 16, v245
    v_and_b32 v5, s6, v245
    v_cvt_pk_bf16_f32 v88, 0, v88
    v_cvt_pk_bf16_f32 v89, 0, v89
    v_pk_add_f32 v[88:89], v[88:89], v[4:5]
    v_cvt_pk_bf16_f32 v88, v88, v89
    s_mov_b64 exec, 0xff
    buffer_store_dword v88, v10, s[64:67], s82 offen
    s_mov_b64 exec, -1
L_FIN:
L_END:
    s_endpgm
.p2align 10
.fill 768, 4, 0xbf800000
.section .rodata,"a"
.p2align 6
.amdhsa_kernel adaLN_cond__linear_kernel_hedgehog__moe_arch_mod__prompt_kernel
  .amdhsa_next_free_vgpr 256
  .amdhsa_next_free_sgpr 102
  .amdhsa_accum_offset 256
  .amdhsa_group_segment_fixed_size 0
  .amdhsa_kernarg_size 112
  .amdhsa_user_sgpr_count 2
  .amdhsa_user_sgpr_kernarg_segment_ptr 1
  .amdhsa_system_sgpr_workgroup_id_x 1
  .amdhsa_float_denorm_mode_32 3
  .amdhsa_float_denorm_mode_16_64 3
.end_amdhsa_kernel
```

```asm
; @launch grid=(256,1,1) block=(512,1,1) lds=163840
.amdgcn_target "amdgcn-amd-amdhsa--gfx950"
.text
.globl adaLN_cond__linear_kernel_hedgehog__moe_arch_mod__prompt_kernel
.p2align 12
.type adaLN_cond__linear_kernel_hedgehog__moe_arch_mod__prompt_kernel,@function
adaLN_cond__linear_kernel_hedgehog__moe_arch_mod__prompt_kernel:
    s_load_dwordx16 s[68:83], s[0:1], 0
    s_load_dwordx8 s[84:91], s[0:1], 64
    s_load_dwordx2 s[32:33], s[0:1], 104
    s_cmp_ge_u32 s2, 256
    s_cbranch_scc1 L_END
    v_lshrrev_b32 v4, 6, v0
    v_and_b32 v1, 63, v0
    s_nop 0
    v_readfirstlane_b32 s3, v4
    v_lshlrev_b32 v2, 4, v1
    s_mov_b32 s38, 4194304
    s_mov_b32 s39, 0x20000
    s_mov_b32 s50, 12582912
    s_mov_b32 s51, 0x20000
    s_mov_b32 s34, 268435456
    s_mov_b32 s35, 0x20000
    s_mov_b32 s42, 6291456
    s_mov_b32 s43, 0x20000
    s_mov_b32 s46, 2097152
    s_mov_b32 s47, 0x20000
    s_mov_b32 s54, 7340032
    s_mov_b32 s55, 0x20000
    s_mov_b32 s58, 7340032
    s_mov_b32 s59, 0x20000
    s_mov_b32 s62, 7340032
    s_mov_b32 s63, 0x20000
    s_mov_b32 s66, 4194304
    s_mov_b32 s67, 0x20000
    s_mov_b32 s5, 0
    s_mov_b32 s6, 0xffff0000
    s_mov_b32 s7, 0x3fb8aa3b
    s_and_b32 s8, s2, 7
    s_lshr_b32 s9, s2, 3
    s_lshl3_add_u32 s93, s2, s3
    s_and_b32 s96, s8, 4
    s_lshr_b32 s97, s9, 2
    s_lshl1_add_u32 s10, s96, s97
    s_and_b32 s96, s8, 3
    s_and_b32 s97, s9, 3
    s_xor_b32 s98, s97, 2
    s_lshl2_add_u32 s11, s96, s98
    s_and_b32 s96, s8, 1
    s_and_b32 s97, s9, 7
    s_lshl3_add_u32 s12, s96, s97
    s_lshr_b32 s96, s8, 1
    s_lshr_b32 s97, s9, 3
    s_lshl2_add_u32 s21, s96, s97
    s_lshl_b32 s96, s2, 6
    s_add_u32 s97, s96, s3
    s_lshl_b32 s98, s97, 6
    s_add_u32 s92, s98, 1048576
    s_lshr_b32 s96, s8, 1
    s_lshl_b32 s97, s96, 8
    s_lshl3_add_u32 s98, s9, s97
    s_add_u32 s99, s98, s3
    s_lshl_b32 s96, s99, 12
    s_and_b32 s97, s8, 1
    s_lshl_b32 s98, s97, 10
    s_add_u32 s16, s96, s98
    v_and_b32 v8, 31, v1
    v_lshlrev_b32 v8, 4, v8
    v_lshrrev_b32 v9, 5, v1
    v_lshl_add_u32 v8, v9, 11, v8
    s_lshl3_add_u32 s96, s8, s3
    s_lshl_b32 s15, s96, 5
    s_mul_i32 s96, s15, 6144
    s_xor_b32 s97, s9, 1
    s_lshl_b32 s98, s97, 7
    s_add_u32 s13, s96, s98
    s_add_u32 s14, s13, 98304
    s_lshl3_add_u32 s96, s21, s3
    s_lshl_b32 s97, s96, 15
    s_lshl_b32 s98, s12, 7
    s_add_u32 s18, s97, s98
    s_lshr_b32 s96, s8, 1
    s_lshl4_add_u32 s97, s96, s12
    s_lshl4_add_u32 s98, s97, s3
    s_lshl_b32 s99, s98, 9
    s_add_u32 s17, s99, 524288
    v_lshrrev_b32 v248, 3, v1
    v_mul_u32_u24 v248, 12288, v248
    v_and_b32 v9, 7, v1
    v_lshl_add_u32 v248, v9, 4, v248
    v_lshrrev_b32 v249, 3, v1
    v_lshl_add_u32 v249, v249, 1, s15
    v_and_b32 v10, 15, v1
    v_lshlrev_b32 v10, 11, v10
    v_lshrrev_b32 v9, 4, v1
    v_lshl_add_u32 v10, v9, 4, v10
    s_waitcnt lgkmcnt(0)
    s_mov_b64 s[48:49], s[88:89]
    buffer_load_dwordx4 v[160:163], v248, s[48:51], s13 offen nt
    buffer_load_dwordx4 v[164:167], v248, s[48:51], s14 offen nt
    s_load_dword s4, s[32:33], 0
    global_load_ushort v168, v249, s[86:87]
    global_load_ushort v169, v249, s[86:87] offset:16
    s_mov_b64 s[36:37], s[68:69]
    s_load_dword s24, s[32:33], s92 offset:0 glc
    s_load_dword s25, s[32:33], s17 offset:508 glc
    s_load_dword s26, s[32:33], s17 offset:4604 glc
    s_barrier
    buffer_load_dwordx4 v[152:155], v8, s[36:39], s16 offen
    buffer_load_dwordx4 v[156:159], v8, s[36:39], s16 offen offset:512
    s_mov_b64 s[40:41], s[70:71]
    s_mov_b64 s[44:45], s[74:75]
    s_mov_b64 s[52:53], s[80:81]
    s_mov_b64 s[56:57], s[82:83]
    s_mov_b64 s[60:61], s[84:85]
    s_mov_b64 s[64:65], s[90:91]
    s_getpc_b64 s[22:23]
    s_and_b32 s22, s22, 0xfffffc00
    s_lshl3_add_u32 s96, s9, s3
    s_lshl_b32 s19, s96, 7
    v_lshrrev_b32 v4, 5, v1
    v_lshl_add_u32 v4, v4, 15, s19
    v_min_u32 v4, 41984, v4
    global_load_dword v11, v4, s[22:23]
    s_lshr_b32 s76, s3, 2
    s_and_b32 s77, s3, 3
    s_lshl_b32 s83, s3, 10
    s_mul_i32 s96, s8, 7
    s_lshr_b32 s97, s9, 2
    s_add_u32 s74, s96, s97
    s_and_b32 s75, s9, 3
    v_bfe_u32 v6, v1, 4, 1
    v_lshlrev_b32 v6, 6, v6
    v_and_b32 v3, 7, v1
    v_lshlrev_b32 v3, 4, v3
    v_xor_b32 v3, v3, v6
    v_lshrrev_b32 v6, 3, v1
    v_mul_u32_u24 v6, 6144, v6
    v_add_u32 v3, v3, v6
    s_and_b32 s84, s9, 12
    s_mul_i32 s96, s3, 49152
    s_lshl_b32 s97, s11, 7
    s_add_u32 s85, s96, s97
    v_lshlrev_b32 v250, 3, v1
    v_lshlrev_b32 v251, 5, v1
    v_add_u32 v251, 147456, v251
    s_lshl2_add_u32 s13, s3, 147456
    v_lshrrev_b32 v252, 4, v1
    v_lshl_add_u32 v252, v252, 6, s13
    v_and_b32 v9, 7, v1
    v_lshl_add_u32 v252, v9, 8, v252
    v_bfe_u32 v9, v1, 3, 1
    v_lshl_add_u32 v252, v9, 5, v252
    buffer_load_dwordx4 v[12:15], v10, s[36:39], s18 offen
    buffer_load_dwordx4 v[16:19], v10, s[36:39], s18 offen offset:64
    s_lshr_b32 s96, s3, 1
    s_xor_b32 s97, s9, 1
    s_and_b32 s98, s97, 15
    s_lshl4_add_u32 s99, s96, s98
    s_lshr_b32 s97, s9, 4
    s_lshl1_add_u32 s96, s99, s97
    s_lshl3_add_u32 s98, s96, s8
    s_lshl_b32 s99, s98, 9
    s_add_u32 s13, s99, 524288
    s_waitcnt vmcnt(5)
    v_lshlrev_b32 v168, 16, v168
    v_mul_f32 v4, s7, v168
    v_exp_f32 v4, -v4
    s_nop 0
    v_add_f32 v4, 1.0, v4
    v_rcp_f32 v4, v4
    s_nop 0
    v_mul_f32 v168, v168, v4
    v_cvt_pk_bf16_f32 v168, 0, v168
    v_lshlrev_b32 v169, 16, v169
    v_mul_f32 v5, s7, v169
    v_exp_f32 v5, -v5
    s_nop 0
    v_add_f32 v5, 1.0, v5
    v_rcp_f32 v5, v5
    s_nop 0
    v_mul_f32 v169, v169, v5
    v_cvt_pk_bf16_f32 v169, 0, v169
    v_lshlrev_b32 v4, 16, v160
    v_and_b32 v5, s6, v160
    v_pk_mul_f32 v[176:177], v[168:169], v[4:5] op_sel:[0,0] op_sel_hi:[0,1]
    v_lshlrev_b32 v6, 16, v161
    v_and_b32 v7, s6, v161
    v_pk_mul_f32 v[178:179], v[168:169], v[6:7] op_sel:[0,0] op_sel_hi:[0,1]
    v_lshlrev_b32 v4, 16, v162
    v_and_b32 v5, s6, v162
    v_pk_mul_f32 v[180:181], v[168:169], v[4:5] op_sel:[0,0] op_sel_hi:[0,1]
    v_lshlrev_b32 v6, 16, v163
    v_and_b32 v7, s6, v163
    v_pk_mul_f32 v[182:183], v[168:169], v[6:7] op_sel:[0,0] op_sel_hi:[0,1]
    v_lshlrev_b32 v4, 16, v164
    v_and_b32 v5, s6, v164
    v_pk_fma_f32 v[176:177], v[168:169], v[4:5], v[176:177] op_sel:[1,0,0] op_sel_hi:[1,1,1]
    v_lshlrev_b32 v6, 16, v165
    v_and_b32 v7, s6, v165
    v_pk_fma_f32 v[178:179], v[168:169], v[6:7], v[178:179] op_sel:[1,0,0] op_sel_hi:[1,1,1]
    v_lshlrev_b32 v4, 16, v166
    v_and_b32 v5, s6, v166
    v_pk_fma_f32 v[180:181], v[168:169], v[4:5], v[180:181] op_sel:[1,0,0] op_sel_hi:[1,1,1]
    v_lshlrev_b32 v6, 16, v167
    v_and_b32 v7, s6, v167
    v_pk_fma_f32 v[182:183], v[168:169], v[6:7], v[182:183] op_sel:[1,0,0] op_sel_hi:[1,1,1]
    v_permlane32_swap_b32 v176, v180
    v_permlane32_swap_b32 v177, v181
    v_permlane32_swap_b32 v178, v182
    v_permlane32_swap_b32 v179, v183
    v_add_f32 v176, v176, v180
    v_add_f32 v177, v177, v181
    v_add_f32 v178, v178, v182
    v_add_f32 v179, v179, v183
    s_nop 0
    v_permlane16_swap_b32 v176, v178
    v_permlane16_swap_b32 v177, v179
    v_add_f32 v176, v176, v178
    v_add_f32 v177, v177, v179
    s_nop 0
    v_add_f32_dpp v176, v176, v176 row_ror:8 row_mask:0xf bank_mask:0xf
    v_add_f32_dpp v177, v177, v177 row_ror:8 row_mask:0xf bank_mask:0xf
    s_nop 1
    v_mov_b32_dpp v176, v177 quad_perm:[0,1,2,3] row_mask:0xf bank_mask:0xc
    s_waitcnt lgkmcnt(0)
    s_mul_i32 s4, s4, 0x9e3779b1
    s_add_u32 s4, s4, 0x7f4a7c15
    ds_write_b32 v252, v176
    s_waitcnt lgkmcnt(0)
    s_barrier
    ds_read_b128 v[176:179], v251
    ds_read_b128 v[180:183], v251 offset:16
    s_waitcnt lgkmcnt(0)
    v_pk_add_f32 v[176:177], v[176:177], v[178:179]
    v_pk_add_f32 v[180:181], v[180:181], v[182:183]
    v_pk_add_f32 v[176:177], v[176:177], v[180:181]
    v_add_f32 v176, v176, v177
    v_mov_b32 v177, s4
    s_bitcmp1_b32 s3, 0
    s_cselect_b32 exec_lo, 0, -1
    s_cselect_b32 exec_hi, -1, 0
    buffer_store_dwordx2 v[176:177], v250, s[32:35], s13 offen sc1
    s_mov_b64 exec, -1
    s_lshr_b32 s96, s9, 4
    s_lshl_b32 s94, s96, 1
    s_add_u32 s96, s94, s84
    s_and_b32 s97, s96, 15
    s_mul_i32 s98, s97, 393216
    s_add_u32 s91, s98, s85
    s_lshl_b32 s96, s94, 13
    s_add_u32 s94, s96, s83
    s_add_u32 s82, s91, 2048
    s_mov_b32 m0, s94
    s_nop 0
    buffer_load_dwordx4 v3, s[40:43], s82 offen lds
    s_add_u32 s82, s91, 4096
    s_add_u32 m0, s94, 49152
    s_nop 0
    buffer_load_dwordx4 v3, s[40:43], s82 offen lds
    s_waitcnt vmcnt(6)
    v_mov_b32 v8, 0x3f803f80
    v_dot2_f32_bf16 v4, v152, v8, 0
    v_dot2_f32_bf16 v5, v152, v152, 0
    v_dot2_f32_bf16 v6, v153, v8, 0
    v_dot2_f32_bf16 v7, v153, v153, 0
    v_dot2_f32_bf16 v4, v154, v8, v4
    v_dot2_f32_bf16 v5, v154, v154, v5
    v_dot2_f32_bf16 v6, v155, v8, v6
    v_dot2_f32_bf16 v7, v155, v155, v7
    v_dot2_f32_bf16 v4, v156, v8, v4
    v_dot2_f32_bf16 v5, v156, v156, v5
    v_dot2_f32_bf16 v6, v157, v8, v6
    v_dot2_f32_bf16 v7, v157, v157, v7
    v_dot2_f32_bf16 v4, v158, v8, v4
    v_dot2_f32_bf16 v5, v158, v158, v5
    v_dot2_f32_bf16 v6, v159, v8, v6
    v_dot2_f32_bf16 v7, v159, v159, v7
    s_lshl_b32 s96, s3, 5
    s_add_u32 s13, s96, 153600
    v_lshrrev_b32 v8, 5, v1
    v_lshl_add_u32 v8, v8, 4, s13
    v_bfe_u32 v9, v1, 4, 1
    v_lshl_add_u32 v8, v9, 3, v8
    v_pk_add_f32 v[172:173], v[4:5], v[6:7]
    v_and_b32 v5, 15, v1
    v_lshlrev_b32 v5, 4, v5
    v_add_u32 v5, 153600, v5
    v_and_b32 v4, 15, v1
    v_lshlrev_b32 v4, 4, v4
    v_bfe_u32 v9, v1, 4, 1
    v_lshl_add_u32 v4, v9, 12, v4
    v_add_f32_dpp v172, v172, v172 quad_perm:[1,0,3,2] row_mask:0xf bank_mask:0xf
    v_add_f32_dpp v173, v173, v173 quad_perm:[1,0,3,2] row_mask:0xf bank_mask:0xf
    s_nop 0
    v_add_f32_dpp v172, v172, v172 quad_perm:[2,3,0,1] row_mask:0xf bank_mask:0xf
    v_add_f32_dpp v173, v173, v173 quad_perm:[2,3,0,1] row_mask:0xf bank_mask:0xf
    s_nop 0
    v_add_f32_dpp v172, v172, v172 row_half_mirror row_mask:0xf bank_mask:0xf
    v_add_f32_dpp v173, v173, v173 row_half_mirror row_mask:0xf bank_mask:0xf
    s_nop 0
    v_add_f32_dpp v172, v172, v172 row_mirror row_mask:0xf bank_mask:0xf
    v_add_f32_dpp v173, v173, v173 row_mirror row_mask:0xf bank_mask:0xf
    s_and_b32 s96, s9, 24
    s_add_u32 s97, s96, s3
    s_and_b32 s98, s8, 6
    s_lshl3_add_u32 s99, s97, s98
    s_lshl_b32 s96, s99, 12
    s_and_b32 s97, s9, 7
    s_lshl_b32 s98, s97, 9
    s_add_u32 s99, s96, s98
    s_and_b32 s97, s8, 1
    s_lshl_b32 s96, s97, 8
    s_add_u32 s98, s99, s96
    s_add_u32 s13, s98, 2097152
    v_permlane16_swap_b32 v172, v173
    v_add_f32 v172, v172, v173
    v_mov_b32 v173, s4
    ds_write_b64 v8, v[172:173]
    s_waitcnt lgkmcnt(0)
    s_barrier
    ds_read_b128 v[172:175], v5
    s_waitcnt lgkmcnt(0)
    s_mov_b32 exec_hi, 0
    buffer_store_dwordx4 v[172:175], v4, s[32:35], s13 offen sc1
    s_mov_b32 exec_hi, -1
    s_mov_b32 s82, s91
    s_add_u32 m0, s94, 98304
    s_nop 0
    buffer_load_dwordx4 v3, s[40:43], s82 offen lds
    s_lshr_b32 s96, s9, 4
    s_lshl_b32 s97, s96, 1
    s_xor_b32 s94, s97, 1
    s_add_u32 s96, s94, s84
    s_and_b32 s97, s96, 15
    s_mul_i32 s98, s97, 393216
    s_add_u32 s91, s98, s85
    s_lshl_b32 s96, s94, 13
    s_add_u32 s94, s96, s83
    s_add_u32 s82, s91, 2048
    s_mov_b32 m0, s94
    s_nop 0
    buffer_load_dwordx4 v3, s[40:43], s82 offen lds
    s_load_dword s24, s[32:33], s17 offset:508 glc
    s_load_dword s25, s[32:33], s17 offset:4604 glc
    v_and_b32 v4, 31, v1
    v_lshlrev_b32 v4, 4, v4
    v_lshrrev_b32 v9, 5, v1
    v_lshl_add_u32 v4, v9, 12, v4
    s_lshl2_add_u32 s14, s3, 155648
    v_lshl_add_u32 v5, v1, 6, s14
    v_and_b32 v6, 3, v1
    v_lshlrev_b32 v6, 5, v6
    v_lshrrev_b32 v9, 5, v1
    v_lshl_add_u32 v6, v9, 7, v6
    v_bfe_u32 v9, v1, 4, 1
    v_lshl_add_u32 v6, v9, 8, v6
    v_bfe_u32 v9, v1, 2, 2
    v_lshl_add_u32 v6, v9, 9, v6
    v_add_u32 v6, 155648, v6
    s_lshl3_add_u32 s96, s2, s3
    s_lshl_b32 s97, s96, 9
    s_add_u32 s14, s97, 2097152
    v_and_b32 v8, 31, v1
    v_lshlrev_b32 v8, 4, v8
    s_branch SCHK_2
SPOLL_1:
    s_load_dword s24, s[32:33], s17 offset:508 glc
    s_load_dword s25, s[32:33], s17 offset:4604 glc
SCHK_2:
    s_add_u32 s5, s5, 1
    s_cmp_ge_u32 s5, 200000
    s_waitcnt lgkmcnt(0)
    s_cbranch_scc1 SDONE_3
    s_cmp_lg_u32 s24, s4
    s_cbranch_scc1 SPOLL_1
    s_cmp_lg_u32 s25, s4
    s_cbranch_scc1 SPOLL_1
SDONE_3:
    buffer_load_dwordx4 v[176:179], v4, s[32:35], s17 offen sc1
    s_load_dword s24, s[32:33], s14 offset:252 glc
    s_load_dword s25, s[32:33], s14 offset:508 glc
    s_waitcnt vmcnt(7)
    v_permlane32_swap_b32 v12, v14
    v_permlane32_swap_b32 v13, v15
    v_permlane32_swap_b32 v16, v18
    v_permlane32_swap_b32 v17, v19
    v_lshlrev_b32 v184, 16, v12
    v_and_b32 v185, s6, v12
    v_lshlrev_b32 v186, 16, v13
    v_and_b32 v187, s6, v13
    v_lshlrev_b32 v188, 16, v14
    v_and_b32 v189, s6, v14
    v_lshlrev_b32 v190, 16, v15
    v_and_b32 v191, s6, v15
    v_lshlrev_b32 v192, 16, v16
    v_and_b32 v193, s6, v16
    v_lshlrev_b32 v194, 16, v17
    v_and_b32 v195, s6, v17
    v_lshlrev_b32 v196, 16, v18
    v_and_b32 v197, s6, v18
    v_lshlrev_b32 v198, 16, v19
    v_and_b32 v199, s6, v19
    s_branch SCHK_6
SPOLL_5:
    s_load_dword s24, s[32:33], s14 offset:252 glc
    s_load_dword s25, s[32:33], s14 offset:508 glc
SCHK_6:
    s_add_u32 s5, s5, 1
    s_cmp_ge_u32 s5, 200000
    s_waitcnt lgkmcnt(0)
    s_cbranch_scc1 SDONE_7
    s_cmp_lg_u32 s24, s4
    s_cbranch_scc1 SPOLL_5
    s_cmp_lg_u32 s25, s4
    s_cbranch_scc1 SPOLL_5
SDONE_7:
    buffer_load_dwordx4 v[172:175], v8, s[32:35], s14 offen sc1
    s_add_u32 s82, s91, 4096
    s_add_u32 m0, s94, 49152
    s_nop 0
    buffer_load_dwordx4 v3, s[40:43], s82 offen lds
    s_mov_b32 s82, s91
    s_add_u32 m0, s94, 98304
    s_nop 0
    buffer_load_dwordx4 v3, s[40:43], s82 offen lds
    s_waitcnt vmcnt(3)
    v_bitop3_b32 v7, v177, v179, s4 bitop3:0x7e
    v_cmp_ne_u32 vcc, 0, v7
    s_cbranch_vccz TOK_8
POLL_9:
    buffer_load_dwordx4 v[176:179], v4, s[32:35], s17 offen sc1
    s_waitcnt vmcnt(0)
    v_bitop3_b32 v7, v177, v179, s4 bitop3:0x7e
    v_cmp_ne_u32 vcc, 0, v7
    s_cbranch_vccz PDONE_10
    s_add_u32 s5, s5, 1
    s_cmp_lt_u32 s5, 200000
    s_cbranch_scc1 POLL_9
PDONE_10:
TOK_8:
    ds_write2_b32 v5, v176, v178 offset0:0 offset1:8
    s_waitcnt lgkmcnt(0)
    s_barrier
    ds_read_b128 v[208:211], v6 offset:2048
    ds_read_b128 v[212:215], v6 offset:2064
    ds_read_b128 v[200:203], v6
    ds_read_b128 v[204:207], v6 offset:16
    s_lshl_b32 s96, s11, 12
    s_lshl_b32 s97, s3, 9
    s_add_u32 s13, s96, s97
    v_add_u32 v4, s13, v2
    s_lshl_b32 s96, s3, 9
    s_add_u32 m0, s96, 159744
    s_mov_b32 exec_hi, 0
    global_load_lds_dwordx4 v4, s[72:73]
    s_mov_b32 exec_hi, -1
    s_lshl4_add_u32 s96, s21, s12
    s_lshr_b32 s97, s3, 1
    s_lshl2_add_u32 s98, s96, s97
    s_lshl_b32 s99, s98, 12
    s_and_b32 s96, s3, 1
    s_lshl_b32 s97, s96, 8
    s_add_u32 s98, s99, s97
    s_add_u32 s13, s98, 4194304
    v_and_b32 v4, 15, v1
    v_lshlrev_b32 v4, 4, v4
    v_bfe_u32 v9, v1, 4, 1
    v_lshl_add_u32 v4, v9, 10, v4
    v_lshrrev_b32 v9, 5, v1
    v_lshl_add_u32 v4, v9, 9, v4
    s_waitcnt lgkmcnt(2)
    v_pk_add_f32 v[208:209], v[208:209], v[210:211]
    v_pk_add_f32 v[212:213], v[212:213], v[214:215]
    v_pk_add_f32 v[208:209], v[208:209], v[212:213]
    v_add_f32 v208, v208, v209
    v_cvt_pk_bf16_f32 v208, 0, v208
    s_waitcnt lgkmcnt(0)
    v_pk_add_f32 v[200:201], v[200:201], v[202:203]
    v_pk_add_f32 v[204:205], v[204:205], v[206:207]
    v_pk_add_f32 v[200:201], v[200:201], v[204:205]
    v_add_f32 v200, v200, v201
    v_add_f32 v208, 1.0, v208
    v_cvt_pk_bf16_f32 v208, 0, v208
    v_cvt_pk_bf16_f32 v200, 0, v200
    s_waitcnt vmcnt(3)
    v_bitop3_b32 v7, v173, v175, s4 bitop3:0x7e
    v_cmp_ne_u32 vcc, 0, v7
    s_cbranch_vccz L_STOK
POLL_11:
    buffer_load_dwordx4 v[172:175], v8, s[32:35], s14 offen sc1
    s_waitcnt vmcnt(0)
    v_bitop3_b32 v7, v173, v175, s4 bitop3:0x7e
    v_cmp_ne_u32 vcc, 0, v7
    s_cbranch_vccz PDONE_12
    s_add_u32 s5, s5, 1
    s_cmp_lt_u32 s5, 200000
    s_cbranch_scc1 POLL_11
PDONE_12:
L_STOK:
    v_permlane16_swap_b32 v172, v174
    v_add_f32 v175, v172, v174
    v_mul_f32 v174, 0x3a800000, v175
    v_mul_f32 v175, 0x3a800000, v175
    s_nop 1
    v_permlane16_swap_b32 v174, v175
    v_fma_f32 v172, -v174, v174, v175
    v_cvt_pk_bf16_f32 v173, 0, v174
    v_max_f32 v172, 0, v172
    v_cvt_pk_bf16_f32 v172, 0, v172
    v_pk_add_f32 v[184:185], v[172:173], v[184:185] op_sel:[1,0] neg_lo:[1,0] neg_hi:[1,0]
    v_pk_add_f32 v[186:187], v[172:173], v[186:187] op_sel:[1,0] neg_lo:[1,0] neg_hi:[1,0]
    v_pk_add_f32 v[188:189], v[172:173], v[188:189] op_sel:[1,0] neg_lo:[1,0] neg_hi:[1,0]
    v_pk_add_f32 v[190:191], v[172:173], v[190:191] op_sel:[1,0] neg_lo:[1,0] neg_hi:[1,0]
    v_add_f32 v172, 0x3727c5ac, v172
    v_cvt_pk_bf16_f32 v172, 0, v172
    v_sqrt_f32 v172, v172
    s_nop 0
    v_pk_add_f32 v[192:193], v[172:173], v[192:193] op_sel:[1,0] neg_lo:[1,0] neg_hi:[1,0]
    v_pk_add_f32 v[194:195], v[172:173], v[194:195] op_sel:[1,0] neg_lo:[1,0] neg_hi:[1,0]
    v_pk_add_f32 v[196:197], v[172:173], v[196:197] op_sel:[1,0] neg_lo:[1,0] neg_hi:[1,0]
    v_pk_add_f32 v[198:199], v[172:173], v[198:199] op_sel:[1,0] neg_lo:[1,0] neg_hi:[1,0]
    v_cvt_pk_bf16_f32 v172, 0, v172
    v_rcp_f32 v172, v172
    v_cvt_pk_bf16_f32 v184, 0, v184
    v_cvt_pk_bf16_f32 v185, 0, v185
    v_cvt_pk_bf16_f32 v186, 0, v186
    v_cvt_pk_bf16_f32 v187, 0, v187
    v_cvt_pk_bf16_f32 v188, 0, v188
    v_cvt_pk_bf16_f32 v189, 0, v189
    v_cvt_pk_bf16_f32 v190, 0, v190
    v_cvt_pk_bf16_f32 v191, 0, v191
    v_cvt_pk_bf16_f32 v192, 0, v192
    v_cvt_pk_bf16_f32 v193, 0, v193
    v_cvt_pk_bf16_f32 v194, 0, v194
    v_cvt_pk_bf16_f32 v195, 0, v195
    v_cvt_pk_bf16_f32 v196, 0, v196
    v_cvt_pk_bf16_f32 v197, 0, v197
    v_cvt_pk_bf16_f32 v198, 0, v198
    v_cvt_pk_bf16_f32 v199, 0, v199
    v_pk_mul_f32 v[184:185], v[184:185], v[172:173] op_sel_hi:[1,0]
    v_pk_mul_f32 v[186:187], v[186:187], v[172:173] op_sel_hi:[1,0]
    v_pk_mul_f32 v[188:189], v[188:189], v[172:173] op_sel_hi:[1,0]
    v_pk_mul_f32 v[190:191], v[190:191], v[172:173] op_sel_hi:[1,0]
    v_pk_mul_f32 v[192:193], v[192:193], v[172:173] op_sel_hi:[1,0]
    v_pk_mul_f32 v[194:195], v[194:195], v[172:173] op_sel_hi:[1,0]
    v_pk_mul_f32 v[196:197], v[196:197], v[172:173] op_sel_hi:[1,0]
    v_pk_mul_f32 v[198:199], v[198:199], v[172:173] op_sel_hi:[1,0]
    v_cvt_pk_bf16_f32 v184, 0, v184
    v_cvt_pk_bf16_f32 v185, 0, v185
    v_cvt_pk_bf16_f32 v186, 0, v186
    v_cvt_pk_bf16_f32 v187, 0, v187
    v_cvt_pk_bf16_f32 v188, 0, v188
    v_cvt_pk_bf16_f32 v189, 0, v189
    v_cvt_pk_bf16_f32 v190, 0, v190
    v_cvt_pk_bf16_f32 v191, 0, v191
    v_cvt_pk_bf16_f32 v192, 0, v192
    v_cvt_pk_bf16_f32 v193, 0, v193
    v_cvt_pk_bf16_f32 v194, 0, v194
    v_cvt_pk_bf16_f32 v195, 0, v195
    v_cvt_pk_bf16_f32 v196, 0, v196
    v_cvt_pk_bf16_f32 v197, 0, v197
    v_cvt_pk_bf16_f32 v198, 0, v198
    v_cvt_pk_bf16_f32 v199, 0, v199
    v_mul_f32_dpp v184, v208, v184 row_newbcast:0 row_mask:0xf bank_mask:0xf
    v_mul_f32_dpp v185, v208, v185 row_newbcast:1 row_mask:0xf bank_mask:0xf
    v_mul_f32_dpp v186, v208, v186 row_newbcast:2 row_mask:0xf bank_mask:0xf
    v_mul_f32_dpp v187, v208, v187 row_newbcast:3 row_mask:0xf bank_mask:0xf
    v_mul_f32_dpp v188, v208, v188 row_newbcast:4 row_mask:0xf bank_mask:0xf
    v_mul_f32_dpp v189, v208, v189 row_newbcast:5 row_mask:0xf bank_mask:0xf
    v_mul_f32_dpp v190, v208, v190 row_newbcast:6 row_mask:0xf bank_mask:0xf
    v_mul_f32_dpp v191, v208, v191 row_newbcast:7 row_mask:0xf bank_mask:0xf
    v_cvt_pk_bf16_f32 v184, 0, v184
    v_cvt_pk_bf16_f32 v185, 0, v185
    v_cvt_pk_bf16_f32 v186, 0, v186
    v_cvt_pk_bf16_f32 v187, 0, v187
    v_cvt_pk_bf16_f32 v188, 0, v188
    v_cvt_pk_bf16_f32 v189, 0, v189
    v_cvt_pk_bf16_f32 v190, 0, v190
    v_cvt_pk_bf16_f32 v191, 0, v191
    v_add_f32_dpp v184, v200, v184 row_newbcast:0 row_mask:0xf bank_mask:0xf
    v_add_f32_dpp v185, v200, v185 row_newbcast:1 row_mask:0xf bank_mask:0xf
    v_add_f32_dpp v186, v200, v186 row_newbcast:2 row_mask:0xf bank_mask:0xf
    v_add_f32_dpp v187, v200, v187 row_newbcast:3 row_mask:0xf bank_mask:0xf
    v_add_f32_dpp v188, v200, v188 row_newbcast:4 row_mask:0xf bank_mask:0xf
    v_add_f32_dpp v189, v200, v189 row_newbcast:5 row_mask:0xf bank_mask:0xf
    v_add_f32_dpp v190, v200, v190 row_newbcast:6 row_mask:0xf bank_mask:0xf
    v_add_f32_dpp v191, v200, v191 row_newbcast:7 row_mask:0xf bank_mask:0xf
    v_cvt_pk_bf16_f32 v216, v184, v185
    v_cvt_pk_bf16_f32 v217, v186, v187
    v_cvt_pk_bf16_f32 v218, v188, v189
    v_cvt_pk_bf16_f32 v219, v190, v191
    buffer_store_dwordx4 v[216:219], v4, s[32:35], s13 offen sc1
    v_mul_f32_dpp v192, v208, v192 row_newbcast:8 row_mask:0xf bank_mask:0xf
    v_mul_f32_dpp v193, v208, v193 row_newbcast:9 row_mask:0xf bank_mask:0xf
    v_mul_f32_dpp v194, v208, v194 row_newbcast:10 row_mask:0xf bank_mask:0xf
    v_mul_f32_dpp v195, v208, v195 row_newbcast:11 row_mask:0xf bank_mask:0xf
    v_mul_f32_dpp v196, v208, v196 row_newbcast:12 row_mask:0xf bank_mask:0xf
    v_mul_f32_dpp v197, v208, v197 row_newbcast:13 row_mask:0xf bank_mask:0xf
    v_mul_f32_dpp v198, v208, v198 row_newbcast:14 row_mask:0xf bank_mask:0xf
    v_mul_f32_dpp v199, v208, v199 row_newbcast:15 row_mask:0xf bank_mask:0xf
    v_cvt_pk_bf16_f32 v192, 0, v192
    v_cvt_pk_bf16_f32 v193, 0, v193
    v_cvt_pk_bf16_f32 v194, 0, v194
    v_cvt_pk_bf16_f32 v195, 0, v195
    v_cvt_pk_bf16_f32 v196, 0, v196
    v_cvt_pk_bf16_f32 v197, 0, v197
    v_cvt_pk_bf16_f32 v198, 0, v198
    v_cvt_pk_bf16_f32 v199, 0, v199
    v_add_f32_dpp v192, v200, v192 row_newbcast:8 row_mask:0xf bank_mask:0xf
    v_add_f32_dpp v193, v200, v193 row_newbcast:9 row_mask:0xf bank_mask:0xf
    v_add_f32_dpp v194, v200, v194 row_newbcast:10 row_mask:0xf bank_mask:0xf
    v_add_f32_dpp v195, v200, v195 row_newbcast:11 row_mask:0xf bank_mask:0xf
    v_add_f32_dpp v196, v200, v196 row_newbcast:12 row_mask:0xf bank_mask:0xf
    v_add_f32_dpp v197, v200, v197 row_newbcast:13 row_mask:0xf bank_mask:0xf
    v_add_f32_dpp v198, v200, v198 row_newbcast:14 row_mask:0xf bank_mask:0xf
    v_add_f32_dpp v199, v200, v199 row_newbcast:15 row_mask:0xf bank_mask:0xf
    v_cvt_pk_bf16_f32 v220, v192, v193
    v_cvt_pk_bf16_f32 v221, v194, v195
    v_cvt_pk_bf16_f32 v222, v196, v197
    v_cvt_pk_bf16_f32 v223, v198, v199
    buffer_store_dwordx4 v[220:223], v4, s[32:35], s13 offen offset:2048 sc1
    v_bfe_u32 v20, v1, 2, 2
    v_lshlrev_b32 v20, 7, v20
    v_bfe_u32 v9, v1, 3, 1
    v_lshl_add_u32 v20, v9, 6, v20
    v_bfe_u32 v9, v1, 4, 1
    v_lshl_add_u32 v20, v9, 5, v20
    v_and_b32 v9, 3, v1
    v_lshl_add_u32 v20, v9, 3, v20
    v_lshrrev_b32 v9, 5, v1
    v_lshl_add_u32 v20, v9, 9, v20
    v_xor_b32 v21, 64, v20
    v_add_u32 v22, 49152, v20
    v_add_u32 v23, 49152, v21
    v_add_u32 v24, 98304, v20
    v_add_u32 v25, 98304, v21
    v_and_b32 v5, 3, v1
    v_lshlrev_b32 v5, 15, v5
    v_bfe_u32 v9, v1, 2, 2
    v_lshl_add_u32 v5, v9, 12, v5
    s_and_b32 s96, s12, 1
    s_lshr_b32 s97, s21, 3
    s_and_b32 s98, s21, 7
    s_lshl_b32 s99, s98, 5
    s_lshl2_add_u32 s98, s97, s99
    s_lshl_b32 s97, s98, 12
    s_lshr_b32 s99, s12, 1
    s_lshl_b32 s98, s99, 6
    s_add_u32 s99, s97, s98
    s_lshl2_add_u32 s97, s96, s99
    s_add_u32 s13, s97, 1048576
    s_lshl_b32 s96, s10, 18
    s_lshl_b32 s97, s77, 12
    s_add_u32 s98, s96, s97
    s_add_u32 s88, s98, 4194304
    s_cmp_ge_u32 s9, 28
    s_cselect_b32 s54, 0, s54
    s_cselect_b32 s58, 0, s58
    s_cselect_b32 s62, 0, s62
    s_waitcnt vmcnt(0)
    s_barrier
    s_cmp_lg_u32 s3, 0
    s_cbranch_scc1 L_PB
    v_mov_b32 v6, s4
    s_mov_b32 exec_hi, 0
    s_mov_b32 exec_lo, 65535
    buffer_store_dword v6, v5, s[32:35], s13 offen sc1
    s_mov_b64 exec, -1
L_PB:
    s_lshr_b32 s96, s9, 4
    s_lshl_b32 s97, s96, 1
    s_xor_b32 s94, s97, 2
    s_add_u32 s96, s94, s84
    s_and_b32 s97, s96, 15
    s_mul_i32 s98, s97, 393216
    s_add_u32 s91, s98, s85
    s_lshl_b32 s96, s94, 13
    s_add_u32 s94, s96, s83
    s_add_u32 s82, s91, 2048
    s_mov_b32 m0, s94
    s_nop 0
    buffer_load_dwordx4 v3, s[40:43], s82 offen lds
    s_add_u32 s82, s91, 4096
    s_add_u32 m0, s94, 49152
    s_nop 0
    buffer_load_dwordx4 v3, s[40:43], s82 offen lds
    s_mov_b32 s82, s91
    s_add_u32 m0, s94, 98304
    s_nop 0
    buffer_load_dwordx4 v3, s[40:43], s82 offen lds
    s_lshr_b32 s96, s9, 4
    s_lshl_b32 s97, s96, 1
    s_xor_b32 s94, s97, 3
    s_add_u32 s96, s94, s84
    s_and_b32 s97, s96, 15
    s_mul_i32 s98, s97, 393216
    s_add_u32 s91, s98, s85
    s_lshl_b32 s96, s94, 13
    s_add_u32 s94, s96, s83
    s_add_u32 s82, s91, 2048
    s_mov_b32 m0, s94
    s_nop 0
    buffer_load_dwordx4 v3, s[40:43], s82 offen lds
    s_add_u32 s82, s91, 4096
    s_add_u32 m0, s94, 49152
    s_nop 0
    buffer_load_dwordx4 v3, s[40:43], s82 offen lds
    s_mov_b32 s82, s91
    s_add_u32 m0, s94, 98304
    s_nop 0
    buffer_load_dwordx4 v3, s[40:43], s82 offen lds
    s_lshl_b32 s96, s2, 12
    s_add_u32 s19, s96, 1048576
    s_and_b32 s96, s3, 3
    s_lshl_b32 s97, s96, 7
    s_add_u32 s20, s97, s19
    s_lshl_b32 s96, s84, 5
    s_add_u32 s19, s96, s19
    s_cmp_ge_u32 s3, 4
    s_cselect_b32 s19, s20, s19
    s_load_dwordx2 s[24:25], s[32:33], s19 offset:0 glc
    s_load_dwordx2 s[26:27], s[32:33], s19 offset:64 glc
    s_lshl_b32 s96, s3, 14
    s_lshl_b32 s97, s12, 7
    s_add_u32 s90, s96, s97
    s_and_b32 s96, s9, 1
    s_lshr_b32 s97, s9, 3
    s_lshl_b32 s98, s97, 1
    s_lshl3_add_u32 s99, s96, s98
    s_lshl_b32 s95, s99, 17
    s_lshl3_add_u32 s96, s75, s3
    s_mul_i32 s97, s96, 229376
    s_lshl_b32 s98, s74, 7
    s_add_u32 s80, s97, s98
    s_lshl3_add_u32 s96, s74, s3
    s_lshl_b32 s97, s96, 14
    s_lshl_b32 s98, s75, 9
    s_add_u32 s81, s97, s98
    s_and_b32 s96, s8, 3
    s_lshl3_add_u32 s97, s96, s3
    s_mul_i32 s98, s97, 393216
    s_lshr_b32 s99, s8, 2
    s_lshl1_add_u32 s96, s9, s99
    s_lshl_b32 s97, s96, 7
    s_add_u32 s99, s98, s97
    s_add_u32 s89, s99, 4096
    s_and_b32 s96, s3, 1
    s_lshl_b32 s14, s96, 6
    v_bfe_u32 v6, v1, 4, 1
    v_lshl_add_u32 v6, v6, 5, s14
    v_and_b32 v26, 7, v1
    v_lshlrev_b32 v26, 4, v26
    v_xor_b32 v26, v26, v6
    v_lshrrev_b32 v6, 3, v1
    v_lshlrev_b32 v6, 11, v6
    v_add_u32 v26, v26, v6
    s_and_b32 s96, s3, 2
    s_lshl_b32 s14, s96, 5
    v_bfe_u32 v6, v1, 4, 1
    v_lshl_add_u32 v6, v6, 5, s14
    v_and_b32 v27, 7, v1
    v_lshlrev_b32 v27, 4, v27
    v_xor_b32 v27, v27, v6
    v_lshrrev_b32 v6, 3, v1
    v_mul_u32_u24 v6, 7168, v6
    v_add_u32 v27, v27, v6
    s_and_b32 s96, s3, 1
    s_lshl_b32 s14, s96, 7
    v_lshrrev_b32 v6, 5, v1
    v_lshl_add_u32 v6, v6, 6, s14
    v_and_b32 v253, 31, v1
    v_lshlrev_b32 v253, 4, v253
    v_lshrrev_b32 v9, 5, v1
    v_lshl_add_u32 v253, v9, 11, v253
    v_xor_b32 v253, v253, v6
    s_lshl_b32 s16, s84, 14
    v_add_u32 v249, s88, v2
    s_lshl_b32 s96, s77, 11
    s_add_u32 s14, s96, 151552
    v_add_u32 v0, s14, v2
    s_mov_b64 exec, 0
    s_cmp_eq_u32 s3, 4
    s_cbranch_scc1 L_PAD2
    s_cmp_eq_u32 s3, 5
    s_cbranch_scc1 L_PAD3
    s_cmp_eq_u32 s3, 6
    s_cbranch_scc1 L_PAD4
    s_cmp_eq_u32 s3, 7
    s_cbranch_scc1 L_PAD5
    s_branch L_TEND
L_RET2:
    s_branch L_PAD6
L_RET6:
    s_branch L_PAD10
L_RET10:
    s_branch L_TEND
L_RET3:
    s_branch L_PAD7
L_RET7:
    s_branch L_TEND
L_RET4:
    s_branch L_PAD8
L_RET8:
    s_branch L_TEND
L_RET5:
    s_branch L_PAD9
L_RET9:
    s_branch L_TEND
    s_nop 0
    s_nop 0
    s_nop 0
    s_nop 0
    s_nop 0
    s_nop 0
    s_nop 0
    s_nop 0
    s_nop 0
    s_nop 0
    s_nop 0
    s_nop 0
    s_nop 0
    s_nop 0
    s_nop 0
    s_nop 0
    s_nop 0
    s_nop 0
    s_nop 0
    s_nop 0
    s_nop 0
    s_nop 0
    s_nop 0
    s_nop 0
    s_nop 0
    s_nop 0
    s_nop 0
    s_nop 0
L_TEND:
    s_mov_b64 exec, -1
    s_cmp_ge_u32 s3, 4
    s_cbranch_scc1 L_HELP
    s_branch SCHK_14
SPOLL_13:
    s_load_dwordx2 s[24:25], s[32:33], s19 offset:0 glc
    s_load_dwordx2 s[26:27], s[32:33], s19 offset:64 glc
SCHK_14:
    s_add_u32 s5, s5, 1
    s_cmp_ge_u32 s5, 200000
    s_waitcnt lgkmcnt(0)
    s_cbranch_scc1 SDONE_15
    s_cmp_lg_u32 s24, s4
    s_cbranch_scc1 SPOLL_13
    s_cmp_lg_u32 s25, s4
    s_cbranch_scc1 SPOLL_13
    s_cmp_lg_u32 s26, s4
    s_cbranch_scc1 SPOLL_13
    s_cmp_lg_u32 s27, s4
    s_cbranch_scc1 SPOLL_13
SDONE_15:
    s_setprio 2
    buffer_load_dwordx4 v[152:155], v249, s[32:35], s16 offen sc1
    buffer_load_dwordx4 v[156:159], v249, s[32:35], s16 offen offset:1024 sc1
    buffer_load_dwordx4 v[160:163], v249, s[32:35], s16 offen offset:2048 sc1
    buffer_load_dwordx4 v[164:167], v249, s[32:35], s16 offen offset:3072 sc1
    s_add_u32 s16, s16, 16384
    s_and_b32 s16, s16, 0x3ffff
    buffer_load_dwordx4 v[168:171], v249, s[32:35], s16 offen sc1
    buffer_load_dwordx4 v[172:175], v249, s[32:35], s16 offen offset:1024 sc1
    buffer_load_dwordx4 v[176:179], v249, s[32:35], s16 offen offset:2048 sc1
    buffer_load_dwordx4 v[180:183], v249, s[32:35], s16 offen offset:3072 sc1
    s_waitcnt vmcnt(8)
    s_barrier
    ds_read_b64_tr_b16 v[28:29], v20
    ds_read_b64_tr_b16 v[30:31], v20 offset:2048
    ds_read_b64_tr_b16 v[32:33], v21
    ds_read_b64_tr_b16 v[34:35], v21 offset:2048
    ds_read_b64_tr_b16 v[36:37], v24
    ds_read_b64_tr_b16 v[38:39], v24 offset:2048
    ds_read_b64_tr_b16 v[40:41], v25
    ds_read_b64_tr_b16 v[42:43], v25 offset:2048
    ds_read_b64_tr_b16 v[44:45], v22
    ds_read_b64_tr_b16 v[46:47], v22 offset:2048
    ds_read_b64_tr_b16 v[48:49], v23
    ds_read_b64_tr_b16 v[50:51], v23 offset:2048
    s_waitcnt vmcnt(7)
    s_waitcnt lgkmcnt(10)
    v_mfma_f32_32x32x16_bf16 v[56:71], v[28:31], v[152:155], 0
    s_add_u32 s16, s16, 16384
    ds_read_b64_tr_b16 v[52:53], v20 offset:1024
    ds_read_b64_tr_b16 v[54:55], v20 offset:3072
    s_waitcnt lgkmcnt(10)
    v_mfma_f32_32x32x16_bf16 v[72:87], v[32:35], v[152:155], 0
    s_and_b32 s16, s16, 0x3ffff
    ds_read_b64_tr_b16 v[28:29], v21 offset:1024
    ds_read_b64_tr_b16 v[30:31], v21 offset:3072
    s_waitcnt lgkmcnt(10)
    v_mfma_f32_32x32x16_bf16 v[120:135], v[36:39], v[152:155], 0
    ds_read_b64_tr_b16 v[32:33], v24 offset:1024
    ds_read_b64_tr_b16 v[34:35], v24 offset:3072
    s_waitcnt lgkmcnt(10)
    v_mfma_f32_32x32x16_bf16 v[136:151], v[40:43], v[152:155], 0
    buffer_load_dwordx4 v[184:187], v249, s[32:35], s16 offen sc1
    ds_read_b64_tr_b16 v[36:37], v25 offset:1024
    ds_read_b64_tr_b16 v[38:39], v25 offset:3072
    s_waitcnt lgkmcnt(10)
    v_mfma_f32_32x32x16_bf16 v[88:103], v[44:47], v[152:155], 0
    ds_read_b64_tr_b16 v[40:41], v22 offset:1024
    ds_read_b64_tr_b16 v[42:43], v22 offset:3072
    s_waitcnt lgkmcnt(10)
    v_mfma_f32_32x32x16_bf16 v[104:119], v[48:51], v[152:155], 0
    ds_read_b64_tr_b16 v[44:45], v23 offset:1024
    ds_read_b64_tr_b16 v[46:47], v23 offset:3072
    s_waitcnt vmcnt(7)
    s_waitcnt lgkmcnt(10)
    v_mfma_f32_32x32x16_bf16 v[56:71], v[52:55], v[156:159], v[56:71]
    ds_read_b64_tr_b16 v[48:49], v20 offset:4096
    ds_read_b64_tr_b16 v[50:51], v20 offset:6144
    s_waitcnt lgkmcnt(10)
    v_mfma_f32_32x32x16_bf16 v[72:87], v[28:31], v[156:159], v[72:87]
    buffer_load_dwordx4 v[188:191], v249, s[32:35], s16 offen offset:1024 sc1
    ds_read_b64_tr_b16 v[52:53], v21 offset:4096
    ds_read_b64_tr_b16 v[54:55], v21 offset:6144
    s_waitcnt lgkmcnt(10)
    v_mfma_f32_32x32x16_bf16 v[120:135], v[32:35], v[156:159], v[120:135]
    ds_read_b64_tr_b16 v[28:29], v24 offset:4096
    ds_read_b64_tr_b16 v[30:31], v24 offset:6144
    s_waitcnt lgkmcnt(10)
    v_mfma_f32_32x32x16_bf16 v[136:151], v[36:39], v[156:159], v[136:151]
    ds_read_b64_tr_b16 v[32:33], v25 offset:4096
    ds_read_b64_tr_b16 v[34:35], v25 offset:6144
    s_waitcnt lgkmcnt(10)
    v_mfma_f32_32x32x16_bf16 v[88:103], v[40:43], v[156:159], v[88:103]
    ds_read_b64_tr_b16 v[36:37], v22 offset:4096
    ds_read_b64_tr_b16 v[38:39], v22 offset:6144
    s_waitcnt lgkmcnt(10)
    v_mfma_f32_32x32x16_bf16 v[104:119], v[44:47], v[156:159], v[104:119]
    buffer_load_dwordx4 v[192:195], v249, s[32:35], s16 offen offset:2048 sc1
    ds_read_b64_tr_b16 v[40:41], v23 offset:4096
    ds_read_b64_tr_b16 v[42:43], v23 offset:6144
    s_waitcnt vmcnt(8)
    s_waitcnt lgkmcnt(10)
    v_mfma_f32_32x32x16_bf16 v[56:71], v[48:51], v[160:163], v[56:71]
    ds_read_b64_tr_b16 v[44:45], v20 offset:5120
    ds_read_b64_tr_b16 v[46:47], v20 offset:7168
    s_waitcnt lgkmcnt(10)
    v_mfma_f32_32x32x16_bf16 v[72:87], v[52:55], v[160:163], v[72:87]
    ds_read_b64_tr_b16 v[48:49], v21 offset:5120
    ds_read_b64_tr_b16 v[50:51], v21 offset:7168
    s_waitcnt lgkmcnt(10)
    v_mfma_f32_32x32x16_bf16 v[120:135], v[28:31], v[160:163], v[120:135]
    ds_read_b64_tr_b16 v[52:53], v24 offset:5120
    ds_read_b64_tr_b16 v[54:55], v24 offset:7168
    s_waitcnt lgkmcnt(10)
    v_mfma_f32_32x32x16_bf16 v[136:151], v[32:35], v[160:163], v[136:151]
    buffer_load_dwordx4 v[196:199], v249, s[32:35], s16 offen offset:3072 sc1
    ds_read_b64_tr_b16 v[28:29], v25 offset:5120
    ds_read_b64_tr_b16 v[30:31], v25 offset:7168
    s_waitcnt lgkmcnt(10)
    v_mfma_f32_32x32x16_bf16 v[88:103], v[36:39], v[160:163], v[88:103]
    s_add_u32 s16, s16, 16384
    ds_read_b64_tr_b16 v[32:33], v22 offset:5120
    ds_read_b64_tr_b16 v[34:35], v22 offset:7168
    s_waitcnt lgkmcnt(10)
    v_mfma_f32_32x32x16_bf16 v[104:119], v[40:43], v[160:163], v[104:119]
    s_and_b32 s16, s16, 0x3ffff
    ds_read_b64_tr_b16 v[36:37], v23 offset:5120
    ds_read_b64_tr_b16 v[38:39], v23 offset:7168
    s_waitcnt vmcnt(8)
    s_waitcnt lgkmcnt(10)
    v_mfma_f32_32x32x16_bf16 v[56:71], v[44:47], v[164:167], v[56:71]
    ds_read_b64_tr_b16 v[40:41], v20 offset:8192
    ds_read_b64_tr_b16 v[42:43], v20 offset:10240
    s_waitcnt lgkmcnt(10)
    v_mfma_f32_32x32x16_bf16 v[72:87], v[48:51], v[164:167], v[72:87]
    buffer_load_dwordx4 v[200:203], v249, s[32:35], s16 offen sc1
    ds_read_b64_tr_b16 v[44:45], v21 offset:8192
    ds_read_b64_tr_b16 v[46:47], v21 offset:10240
    s_waitcnt lgkmcnt(10)
    v_mfma_f32_32x32x16_bf16 v[120:135], v[52:55], v[164:167], v[120:135]
    ds_read_b64_tr_b16 v[48:49], v24 offset:8192
    ds_read_b64_tr_b16 v[50:51], v24 offset:10240
    s_waitcnt lgkmcnt(10)
    v_mfma_f32_32x32x16_bf16 v[136:151], v[28:31], v[164:167], v[136:151]
    ds_read_b64_tr_b16 v[52:53], v25 offset:8192
    ds_read_b64_tr_b16 v[54:55], v25 offset:10240
    s_waitcnt lgkmcnt(10)
    v_mfma_f32_32x32x16_bf16 v[88:103], v[32:35], v[164:167], v[88:103]
    ds_read_b64_tr_b16 v[28:29], v22 offset:8192
    ds_read_b64_tr_b16 v[30:31], v22 offset:10240
    s_waitcnt lgkmcnt(10)
    v_mfma_f32_32x32x16_bf16 v[104:119], v[36:39], v[164:167], v[104:119]
    buffer_load_dwordx4 v[204:207], v249, s[32:35], s16 offen offset:1024 sc1
    ds_read_b64_tr_b16 v[32:33], v23 offset:8192
    ds_read_b64_tr_b16 v[34:35], v23 offset:10240
    s_barrier
    s_waitcnt vmcnt(9)
    s_waitcnt lgkmcnt(10)
    v_mfma_f32_32x32x16_bf16 v[56:71], v[40:43], v[168:171], v[56:71]
    ds_read_b64_tr_b16 v[36:37], v20 offset:9216
    ds_read_b64_tr_b16 v[38:39], v20 offset:11264
    s_waitcnt lgkmcnt(10)
    v_mfma_f32_32x32x16_bf16 v[72:87], v[44:47], v[168:171], v[72:87]
    ds_read_b64_tr_b16 v[40:41], v21 offset:9216
    ds_read_b64_tr_b16 v[42:43], v21 offset:11264
    s_waitcnt lgkmcnt(10)
    v_mfma_f32_32x32x16_bf16 v[120:135], v[48:51], v[168:171], v[120:135]
    ds_read_b64_tr_b16 v[44:45], v24 offset:9216
    ds_read_b64_tr_b16 v[46:47], v24 offset:11264
    s_waitcnt lgkmcnt(10)
    v_mfma_f32_32x32x16_bf16 v[136:151], v[52:55], v[168:171], v[136:151]
    ds_read_b64_tr_b16 v[48:49], v25 offset:9216
    ds_read_b64_tr_b16 v[50:51], v25 offset:11264
    s_waitcnt lgkmcnt(10)
    v_mfma_f32_32x32x16_bf16 v[88:103], v[28:31], v[168:171], v[88:103]
    ds_read_b64_tr_b16 v[52:53], v22 offset:9216
    ds_read_b64_tr_b16 v[54:55], v22 offset:11264
    s_waitcnt lgkmcnt(10)
    v_mfma_f32_32x32x16_bf16 v[104:119], v[32:35], v[168:171], v[104:119]
    ds_read_b64_tr_b16 v[28:29], v23 offset:9216
    ds_read_b64_tr_b16 v[30:31], v23 offset:11264
    s_waitcnt vmcnt(8)
    s_waitcnt lgkmcnt(10)
    v_mfma_f32_32x32x16_bf16 v[56:71], v[36:39], v[172:175], v[56:71]
    ds_read_b64_tr_b16 v[32:33], v20 offset:12288
    ds_read_b64_tr_b16 v[34:35], v20 offset:14336
    s_waitcnt lgkmcnt(10)
    v_mfma_f32_32x32x16_bf16 v[72:87], v[40:43], v[172:175], v[72:87]
    ds_read_b64_tr_b16 v[36:37], v21 offset:12288
    ds_read_b64_tr_b16 v[38:39], v21 offset:14336
    s_waitcnt lgkmcnt(10)
    v_mfma_f32_32x32x16_bf16 v[120:135], v[44:47], v[172:175], v[120:135]
    buffer_load_dwordx4 v[208:211], v249, s[32:35], s16 offen offset:2048 sc1
    ds_read_b64_tr_b16 v[40:41], v24 offset:12288
    ds_read_b64_tr_b16 v[42:43], v24 offset:14336
    s_waitcnt lgkmcnt(10)
    v_mfma_f32_32x32x16_bf16 v[136:151], v[48:51], v[172:175], v[136:151]
    ds_read_b64_tr_b16 v[44:45], v25 offset:12288
    ds_read_b64_tr_b16 v[46:47], v25 offset:14336
    s_waitcnt lgkmcnt(10)
    v_mfma_f32_32x32x16_bf16 v[88:103], v[52:55], v[172:175], v[88:103]
    ds_read_b64_tr_b16 v[48:49], v22 offset:12288
    ds_read_b64_tr_b16 v[50:51], v22 offset:14336
    s_waitcnt lgkmcnt(10)
    v_mfma_f32_32x32x16_bf16 v[104:119], v[28:31], v[172:175], v[104:119]
    buffer_load_dwordx4 v[212:215], v249, s[32:35], s16 offen offset:3072 sc1
    ds_read_b64_tr_b16 v[52:53], v23 offset:12288
    ds_read_b64_tr_b16 v[54:55], v23 offset:14336
    s_waitcnt vmcnt(9)
    s_waitcnt lgkmcnt(10)
    v_mfma_f32_32x32x16_bf16 v[56:71], v[32:35], v[176:179], v[56:71]
    s_add_u32 s16, s16, 16384
    ds_read_b64_tr_b16 v[28:29], v20 offset:13312
    ds_read_b64_tr_b16 v[30:31], v20 offset:15360
    s_waitcnt lgkmcnt(10)
    v_mfma_f32_32x32x16_bf16 v[72:87], v[36:39], v[176:179], v[72:87]
    s_and_b32 s16, s16, 0x3ffff
    ds_read_b64_tr_b16 v[32:33], v21 offset:13312
    ds_read_b64_tr_b16 v[34:35], v21 offset:15360
    s_waitcnt lgkmcnt(10)
    v_mfma_f32_32x32x16_bf16 v[120:135], v[40:43], v[176:179], v[120:135]
    buffer_load_dwordx4 v[216:219], v249, s[32:35], s16 offen sc1
    ds_read_b64_tr_b16 v[36:37], v24 offset:13312
    ds_read_b64_tr_b16 v[38:39], v24 offset:15360
    s_waitcnt lgkmcnt(10)
    v_mfma_f32_32x32x16_bf16 v[136:151], v[44:47], v[176:179], v[136:151]
    ds_read_b64_tr_b16 v[40:41], v25 offset:13312
    ds_read_b64_tr_b16 v[42:43], v25 offset:15360
    s_waitcnt lgkmcnt(10)
    v_mfma_f32_32x32x16_bf16 v[88:103], v[48:51], v[176:179], v[88:103]
    ds_read_b64_tr_b16 v[44:45], v22 offset:13312
    ds_read_b64_tr_b16 v[46:47], v22 offset:15360
    s_waitcnt lgkmcnt(10)
    v_mfma_f32_32x32x16_bf16 v[104:119], v[52:55], v[176:179], v[104:119]
    buffer_load_dwordx4 v[220:223], v249, s[32:35], s16 offen offset:1024 sc1
    ds_read_b64_tr_b16 v[48:49], v23 offset:13312
    ds_read_b64_tr_b16 v[50:51], v23 offset:15360
    s_waitcnt vmcnt(10)
    s_waitcnt lgkmcnt(10)
    v_mfma_f32_32x32x16_bf16 v[56:71], v[28:31], v[180:183], v[56:71]
    ds_read_b64_tr_b16 v[52:53], v20 offset:16384
    ds_read_b64_tr_b16 v[54:55], v20 offset:18432
    s_waitcnt lgkmcnt(10)
    v_mfma_f32_32x32x16_bf16 v[72:87], v[32:35], v[180:183], v[72:87]
    ds_read_b64_tr_b16 v[28:29], v21 offset:16384
    ds_read_b64_tr_b16 v[30:31], v21 offset:18432
    s_waitcnt lgkmcnt(10)
    v_mfma_f32_32x32x16_bf16 v[120:135], v[36:39], v[180:183], v[120:135]
    buffer_load_dwordx4 v[224:227], v249, s[32:35], s16 offen offset:2048 sc1
    ds_read_b64_tr_b16 v[32:33], v24 offset:16384
    ds_read_b64_tr_b16 v[34:35], v24 offset:18432
    s_waitcnt lgkmcnt(10)
    v_mfma_f32_32x32x16_bf16 v[136:151], v[40:43], v[180:183], v[136:151]
    ds_read_b64_tr_b16 v[36:37], v25 offset:16384
    ds_read_b64_tr_b16 v[38:39], v25 offset:18432
    s_waitcnt lgkmcnt(10)
    v_mfma_f32_32x32x16_bf16 v[88:103], v[44:47], v[180:183], v[88:103]
    ds_read_b64_tr_b16 v[40:41], v22 offset:16384
    ds_read_b64_tr_b16 v[42:43], v22 offset:18432
    s_waitcnt lgkmcnt(10)
    v_mfma_f32_32x32x16_bf16 v[104:119], v[48:51], v[180:183], v[104:119]
    buffer_load_dwordx4 v[228:231], v249, s[32:35], s16 offen offset:3072 sc1
    ds_read_b64_tr_b16 v[44:45], v23 offset:16384
    ds_read_b64_tr_b16 v[46:47], v23 offset:18432
    s_barrier
    s_waitcnt vmcnt(11)
    s_waitcnt lgkmcnt(10)
    v_mfma_f32_32x32x16_bf16 v[56:71], v[52:55], v[184:187], v[56:71]
    s_add_u32 s16, s16, 16384
    ds_read_b64_tr_b16 v[48:49], v20 offset:17408
    ds_read_b64_tr_b16 v[50:51], v20 offset:19456
    s_waitcnt lgkmcnt(10)
    v_mfma_f32_32x32x16_bf16 v[72:87], v[28:31], v[184:187], v[72:87]
    s_and_b32 s16, s16, 0x3ffff
    ds_read_b64_tr_b16 v[52:53], v21 offset:17408
    ds_read_b64_tr_b16 v[54:55], v21 offset:19456
    s_waitcnt lgkmcnt(10)
    v_mfma_f32_32x32x16_bf16 v[120:135], v[32:35], v[184:187], v[120:135]
    ds_read_b64_tr_b16 v[28:29], v24 offset:17408
    ds_read_b64_tr_b16 v[30:31], v24 offset:19456
    s_waitcnt lgkmcnt(10)
    v_mfma_f32_32x32x16_bf16 v[136:151], v[36:39], v[184:187], v[136:151]
    ds_read_b64_tr_b16 v[32:33], v25 offset:17408
    ds_read_b64_tr_b16 v[34:35], v25 offset:19456
    s_waitcnt lgkmcnt(10)
    v_mfma_f32_32x32x16_bf16 v[88:103], v[40:43], v[184:187], v[88:103]
    ds_read_b64_tr_b16 v[36:37], v22 offset:17408
    ds_read_b64_tr_b16 v[38:39], v22 offset:19456
    s_waitcnt lgkmcnt(10)
    v_mfma_f32_32x32x16_bf16 v[104:119], v[44:47], v[184:187], v[104:119]
    ds_read_b64_tr_b16 v[40:41], v23 offset:17408
    ds_read_b64_tr_b16 v[42:43], v23 offset:19456
    s_waitcnt vmcnt(10)
    s_waitcnt lgkmcnt(10)
    v_mfma_f32_32x32x16_bf16 v[56:71], v[48:51], v[188:191], v[56:71]
    ds_read_b64_tr_b16 v[44:45], v20 offset:20480
    ds_read_b64_tr_b16 v[46:47], v20 offset:22528
    s_waitcnt lgkmcnt(10)
    v_mfma_f32_32x32x16_bf16 v[72:87], v[52:55], v[188:191], v[72:87]
    ds_read_b64_tr_b16 v[48:49], v21 offset:20480
    ds_read_b64_tr_b16 v[50:51], v21 offset:22528
    s_waitcnt lgkmcnt(10)
    v_mfma_f32_32x32x16_bf16 v[120:135], v[28:31], v[188:191], v[120:135]
    buffer_load_dwordx4 v[232:235], v249, s[32:35], s16 offen sc1
    ds_read_b64_tr_b16 v[52:53], v24 offset:20480
    ds_read_b64_tr_b16 v[54:55], v24 offset:22528
    s_waitcnt lgkmcnt(10)
    v_mfma_f32_32x32x16_bf16 v[136:151], v[32:35], v[188:191], v[136:151]
    ds_read_b64_tr_b16 v[28:29], v25 offset:20480
    ds_read_b64_tr_b16 v[30:31], v25 offset:22528
    s_waitcnt lgkmcnt(10)
    v_mfma_f32_32x32x16_bf16 v[88:103], v[36:39], v[188:191], v[88:103]
    ds_read_b64_tr_b16 v[32:33], v22 offset:20480
    ds_read_b64_tr_b16 v[34:35], v22 offset:22528
    s_waitcnt lgkmcnt(10)
    v_mfma_f32_32x32x16_bf16 v[104:119], v[40:43], v[188:191], v[104:119]
    buffer_load_dwordx4 v[236:239], v249, s[32:35], s16 offen offset:1024 sc1
    ds_read_b64_tr_b16 v[36:37], v23 offset:20480
    ds_read_b64_tr_b16 v[38:39], v23 offset:22528
    s_waitcnt vmcnt(11)
    s_waitcnt lgkmcnt(10)
    v_mfma_f32_32x32x16_bf16 v[56:71], v[44:47], v[192:195], v[56:71]
    ds_read_b64_tr_b16 v[40:41], v20 offset:21504
    ds_read_b64_tr_b16 v[42:43], v20 offset:23552
    s_waitcnt lgkmcnt(10)
    v_mfma_f32_32x32x16_bf16 v[72:87], v[48:51], v[192:195], v[72:87]
    ds_read_b64_tr_b16 v[44:45], v21 offset:21504
    ds_read_b64_tr_b16 v[46:47], v21 offset:23552
    s_waitcnt lgkmcnt(10)
    v_mfma_f32_32x32x16_bf16 v[120:135], v[52:55], v[192:195], v[120:135]
    buffer_load_dwordx4 v[240:243], v249, s[32:35], s16 offen offset:2048 sc1
    ds_read_b64_tr_b16 v[48:49], v24 offset:21504
    ds_read_b64_tr_b16 v[50:51], v24 offset:23552
    s_waitcnt lgkmcnt(10)
    v_mfma_f32_32x32x16_bf16 v[136:151], v[28:31], v[192:195], v[136:151]
    ds_read_b64_tr_b16 v[52:53], v25 offset:21504
    ds_read_b64_tr_b16 v[54:55], v25 offset:23552
    s_waitcnt lgkmcnt(10)
    v_mfma_f32_32x32x16_bf16 v[88:103], v[32:35], v[192:195], v[88:103]
    ds_read_b64_tr_b16 v[28:29], v22 offset:21504
    ds_read_b64_tr_b16 v[30:31], v22 offset:23552
    s_waitcnt lgkmcnt(10)
    v_mfma_f32_32x32x16_bf16 v[104:119], v[36:39], v[192:195], v[104:119]
    buffer_load_dwordx4 v[244:247], v249, s[32:35], s16 offen offset:3072 sc1
    ds_read_b64_tr_b16 v[32:33], v23 offset:21504
    ds_read_b64_tr_b16 v[34:35], v23 offset:23552
    s_waitcnt vmcnt(12)
    s_waitcnt lgkmcnt(10)
    v_mfma_f32_32x32x16_bf16 v[56:71], v[40:43], v[196:199], v[56:71]
    s_add_u32 s16, s16, 16384
    ds_read_b64_tr_b16 v[36:37], v20 offset:24576
    ds_read_b64_tr_b16 v[38:39], v20 offset:26624
    s_waitcnt lgkmcnt(10)
    v_mfma_f32_32x32x16_bf16 v[72:87], v[44:47], v[196:199], v[72:87]
    s_and_b32 s16, s16, 0x3ffff
    ds_read_b64_tr_b16 v[40:41], v21 offset:24576
    ds_read_b64_tr_b16 v[42:43], v21 offset:26624
    s_waitcnt lgkmcnt(10)
    v_mfma_f32_32x32x16_bf16 v[120:135], v[48:51], v[196:199], v[120:135]
    buffer_load_dwordx4 v[152:155], v249, s[32:35], s16 offen sc1
    ds_read_b64_tr_b16 v[44:45], v24 offset:24576
    ds_read_b64_tr_b16 v[46:47], v24 offset:26624
    s_waitcnt lgkmcnt(10)
    v_mfma_f32_32x32x16_bf16 v[136:151], v[52:55], v[196:199], v[136:151]
    ds_read_b64_tr_b16 v[48:49], v25 offset:24576
    ds_read_b64_tr_b16 v[50:51], v25 offset:26624
    s_waitcnt lgkmcnt(10)
    v_mfma_f32_32x32x16_bf16 v[88:103], v[28:31], v[196:199], v[88:103]
    ds_read_b64_tr_b16 v[52:53], v22 offset:24576
    ds_read_b64_tr_b16 v[54:55], v22 offset:26624
    s_waitcnt lgkmcnt(10)
    v_mfma_f32_32x32x16_bf16 v[104:119], v[32:35], v[196:199], v[104:119]
    buffer_load_dwordx4 v[156:159], v249, s[32:35], s16 offen offset:1024 sc1
    ds_read_b64_tr_b16 v[28:29], v23 offset:24576
    ds_read_b64_tr_b16 v[30:31], v23 offset:26624
    s_barrier
    s_waitcnt vmcnt(13)
    s_waitcnt lgkmcnt(10)
    v_mfma_f32_32x32x16_bf16 v[56:71], v[36:39], v[200:203], v[56:71]
    ds_read_b64_tr_b16 v[32:33], v20 offset:25600
    ds_read_b64_tr_b16 v[34:35], v20 offset:27648
    s_waitcnt lgkmcnt(10)
    v_mfma_f32_32x32x16_bf16 v[72:87], v[40:43], v[200:203], v[72:87]
    ds_read_b64_tr_b16 v[36:37], v21 offset:25600
    ds_read_b64_tr_b16 v[38:39], v21 offset:27648
    s_waitcnt lgkmcnt(10)
    v_mfma_f32_32x32x16_bf16 v[120:135], v[44:47], v[200:203], v[120:135]
    ds_read_b64_tr_b16 v[40:41], v24 offset:25600
    ds_read_b64_tr_b16 v[42:43], v24 offset:27648
    s_waitcnt lgkmcnt(10)
    v_mfma_f32_32x32x16_bf16 v[136:151], v[48:51], v[200:203], v[136:151]
    ds_read_b64_tr_b16 v[44:45], v25 offset:25600
    ds_read_b64_tr_b16 v[46:47], v25 offset:27648
    s_waitcnt lgkmcnt(10)
    v_mfma_f32_32x32x16_bf16 v[88:103], v[52:55], v[200:203], v[88:103]
    ds_read_b64_tr_b16 v[48:49], v22 offset:25600
    ds_read_b64_tr_b16 v[50:51], v22 offset:27648
    s_waitcnt lgkmcnt(10)
    v_mfma_f32_32x32x16_bf16 v[104:119], v[28:31], v[200:203], v[104:119]
    ds_read_b64_tr_b16 v[52:53], v23 offset:25600
    ds_read_b64_tr_b16 v[54:55], v23 offset:27648
    s_waitcnt vmcnt(12)
    s_waitcnt lgkmcnt(10)
    v_mfma_f32_32x32x16_bf16 v[56:71], v[32:35], v[204:207], v[56:71]
    ds_read_b64_tr_b16 v[28:29], v20 offset:28672
    ds_read_b64_tr_b16 v[30:31], v20 offset:30720
    s_waitcnt lgkmcnt(10)
    v_mfma_f32_32x32x16_bf16 v[72:87], v[36:39], v[204:207], v[72:87]
    ds_read_b64_tr_b16 v[32:33], v21 offset:28672
    ds_read_b64_tr_b16 v[34:35], v21 offset:30720
L_PAD2:
    s_cbranch_execz L_RET2
    s_waitcnt lgkmcnt(10)
    v_mfma_f32_32x32x16_bf16 v[120:135], v[40:43], v[204:207], v[120:135]
    buffer_load_dwordx4 v[160:163], v249, s[32:35], s16 offen offset:2048 sc1
    ds_read_b64_tr_b16 v[36:37], v24 offset:28672
    ds_read_b64_tr_b16 v[38:39], v24 offset:30720
    s_waitcnt lgkmcnt(10)
    v_mfma_f32_32x32x16_bf16 v[136:151], v[44:47], v[204:207], v[136:151]
    ds_read_b64_tr_b16 v[40:41], v25 offset:28672
    ds_read_b64_tr_b16 v[42:43], v25 offset:30720
    s_waitcnt lgkmcnt(10)
    v_mfma_f32_32x32x16_bf16 v[88:103], v[48:51], v[204:207], v[88:103]
    ds_read_b64_tr_b16 v[44:45], v22 offset:28672
    ds_read_b64_tr_b16 v[46:47], v22 offset:30720
    s_waitcnt lgkmcnt(10)
    v_mfma_f32_32x32x16_bf16 v[104:119], v[52:55], v[204:207], v[104:119]
    buffer_load_dwordx4 v[164:167], v249, s[32:35], s16 offen offset:3072 sc1
    ds_read_b64_tr_b16 v[48:49], v23 offset:28672
    ds_read_b64_tr_b16 v[50:51], v23 offset:30720
    s_waitcnt vmcnt(13)
    s_waitcnt lgkmcnt(10)
    v_mfma_f32_32x32x16_bf16 v[56:71], v[28:31], v[208:211], v[56:71]
    s_add_u32 s16, s16, 16384
    ds_read_b64_tr_b16 v[52:53], v20 offset:29696
    ds_read_b64_tr_b16 v[54:55], v20 offset:31744
    s_waitcnt lgkmcnt(10)
    v_mfma_f32_32x32x16_bf16 v[72:87], v[32:35], v[208:211], v[72:87]
    s_and_b32 s16, s16, 0x3ffff
    ds_read_b64_tr_b16 v[28:29], v21 offset:29696
    ds_read_b64_tr_b16 v[30:31], v21 offset:31744
    s_waitcnt lgkmcnt(10)
    v_mfma_f32_32x32x16_bf16 v[120:135], v[36:39], v[208:211], v[120:135]
    buffer_load_dwordx4 v[168:171], v249, s[32:35], s16 offen sc1
    ds_read_b64_tr_b16 v[32:33], v24 offset:29696
    ds_read_b64_tr_b16 v[34:35], v24 offset:31744
    s_waitcnt lgkmcnt(10)
    v_mfma_f32_32x32x16_bf16 v[136:151], v[40:43], v[208:211], v[136:151]
    ds_read_b64_tr_b16 v[36:37], v25 offset:29696
    ds_read_b64_tr_b16 v[38:39], v25 offset:31744
    s_waitcnt lgkmcnt(10)
    v_mfma_f32_32x32x16_bf16 v[88:103], v[44:47], v[208:211], v[88:103]
    ds_read_b64_tr_b16 v[40:41], v22 offset:29696
    ds_read_b64_tr_b16 v[42:43], v22 offset:31744
    s_waitcnt lgkmcnt(10)
    v_mfma_f32_32x32x16_bf16 v[104:119], v[48:51], v[208:211], v[104:119]
    buffer_load_dwordx4 v[172:175], v249, s[32:35], s16 offen offset:1024 sc1
    ds_read_b64_tr_b16 v[44:45], v23 offset:29696
    ds_read_b64_tr_b16 v[46:47], v23 offset:31744
    s_waitcnt vmcnt(14)
    s_waitcnt lgkmcnt(10)
    v_mfma_f32_32x32x16_bf16 v[56:71], v[52:55], v[212:215], v[56:71]
    ds_read_b64_tr_b16 v[48:49], v20 offset:32768
    ds_read_b64_tr_b16 v[50:51], v20 offset:34816
    s_waitcnt lgkmcnt(10)
    v_mfma_f32_32x32x16_bf16 v[72:87], v[28:31], v[212:215], v[72:87]
    ds_read_b64_tr_b16 v[52:53], v21 offset:32768
    ds_read_b64_tr_b16 v[54:55], v21 offset:34816
    s_waitcnt lgkmcnt(10)
    v_mfma_f32_32x32x16_bf16 v[120:135], v[32:35], v[212:215], v[120:135]
    buffer_load_dwordx4 v[176:179], v249, s[32:35], s16 offen offset:2048 sc1
    ds_read_b64_tr_b16 v[28:29], v24 offset:32768
    ds_read_b64_tr_b16 v[30:31], v24 offset:34816
    s_waitcnt lgkmcnt(10)
    v_mfma_f32_32x32x16_bf16 v[136:151], v[36:39], v[212:215], v[136:151]
    ds_read_b64_tr_b16 v[32:33], v25 offset:32768
    ds_read_b64_tr_b16 v[34:35], v25 offset:34816
    s_waitcnt lgkmcnt(10)
    v_mfma_f32_32x32x16_bf16 v[88:103], v[40:43], v[212:215], v[88:103]
    ds_read_b64_tr_b16 v[36:37], v22 offset:32768
    ds_read_b64_tr_b16 v[38:39], v22 offset:34816
    s_waitcnt lgkmcnt(10)
    v_mfma_f32_32x32x16_bf16 v[104:119], v[44:47], v[212:215], v[104:119]
    buffer_load_dwordx4 v[180:183], v249, s[32:35], s16 offen offset:3072 sc1
    ds_read_b64_tr_b16 v[40:41], v23 offset:32768
    ds_read_b64_tr_b16 v[42:43], v23 offset:34816
    s_barrier
    s_waitcnt vmcnt(15)
    s_waitcnt lgkmcnt(10)
    v_mfma_f32_32x32x16_bf16 v[56:71], v[48:51], v[216:219], v[56:71]
    s_add_u32 s16, s16, 16384
    ds_read_b64_tr_b16 v[44:45], v20 offset:33792
    ds_read_b64_tr_b16 v[46:47], v20 offset:35840
    s_waitcnt lgkmcnt(10)
    v_mfma_f32_32x32x16_bf16 v[72:87], v[52:55], v[216:219], v[72:87]
    s_and_b32 s16, s16, 0x3ffff
    ds_read_b64_tr_b16 v[48:49], v21 offset:33792
    ds_read_b64_tr_b16 v[50:51], v21 offset:35840
    s_waitcnt lgkmcnt(10)
    v_mfma_f32_32x32x16_bf16 v[120:135], v[28:31], v[216:219], v[120:135]
    ds_read_b64_tr_b16 v[52:53], v24 offset:33792
    ds_read_b64_tr_b16 v[54:55], v24 offset:35840
    s_waitcnt lgkmcnt(10)
    v_mfma_f32_32x32x16_bf16 v[136:151], v[32:35], v[216:219], v[136:151]
    ds_read_b64_tr_b16 v[28:29], v25 offset:33792
    ds_read_b64_tr_b16 v[30:31], v25 offset:35840
    s_waitcnt lgkmcnt(10)
    v_mfma_f32_32x32x16_bf16 v[88:103], v[36:39], v[216:219], v[88:103]
    ds_read_b64_tr_b16 v[32:33], v22 offset:33792
    ds_read_b64_tr_b16 v[34:35], v22 offset:35840
    s_waitcnt lgkmcnt(10)
    v_mfma_f32_32x32x16_bf16 v[104:119], v[40:43], v[216:219], v[104:119]
    ds_read_b64_tr_b16 v[36:37], v23 offset:33792
    ds_read_b64_tr_b16 v[38:39], v23 offset:35840
    s_waitcnt vmcnt(14)
    s_waitcnt lgkmcnt(10)
    v_mfma_f32_32x32x16_bf16 v[56:71], v[44:47], v[220:223], v[56:71]
    ds_read_b64_tr_b16 v[40:41], v20 offset:36864
    ds_read_b64_tr_b16 v[42:43], v20 offset:38912
    s_waitcnt lgkmcnt(10)
    v_mfma_f32_32x32x16_bf16 v[72:87], v[48:51], v[220:223], v[72:87]
    ds_read_b64_tr_b16 v[44:45], v21 offset:36864
    ds_read_b64_tr_b16 v[46:47], v21 offset:38912
    s_waitcnt lgkmcnt(10)
    v_mfma_f32_32x32x16_bf16 v[120:135], v[52:55], v[220:223], v[120:135]
    buffer_load_dwordx4 v[184:187], v249, s[32:35], s16 offen sc1
    ds_read_b64_tr_b16 v[48:49], v24 offset:36864
    ds_read_b64_tr_b16 v[50:51], v24 offset:38912
    s_waitcnt lgkmcnt(10)
    v_mfma_f32_32x32x16_bf16 v[136:151], v[28:31], v[220:223], v[136:151]
    ds_read_b64_tr_b16 v[52:53], v25 offset:36864
    ds_read_b64_tr_b16 v[54:55], v25 offset:38912
    s_waitcnt lgkmcnt(10)
    v_mfma_f32_32x32x16_bf16 v[88:103], v[32:35], v[220:223], v[88:103]
    ds_read_b64_tr_b16 v[28:29], v22 offset:36864
    ds_read_b64_tr_b16 v[30:31], v22 offset:38912
    s_waitcnt lgkmcnt(10)
    v_mfma_f32_32x32x16_bf16 v[104:119], v[36:39], v[220:223], v[104:119]
    buffer_load_dwordx4 v[188:191], v249, s[32:35], s16 offen offset:1024 sc1
    ds_read_b64_tr_b16 v[32:33], v23 offset:36864
    ds_read_b64_tr_b16 v[34:35], v23 offset:38912
    s_waitcnt vmcnt(15)
    s_waitcnt lgkmcnt(10)
    v_mfma_f32_32x32x16_bf16 v[56:71], v[40:43], v[224:227], v[56:71]
    ds_read_b64_tr_b16 v[36:37], v20 offset:37888
    ds_read_b64_tr_b16 v[38:39], v20 offset:39936
    s_waitcnt lgkmcnt(10)
    v_mfma_f32_32x32x16_bf16 v[72:87], v[44:47], v[224:227], v[72:87]
    ds_read_b64_tr_b16 v[40:41], v21 offset:37888
    ds_read_b64_tr_b16 v[42:43], v21 offset:39936
    s_waitcnt lgkmcnt(10)
    v_mfma_f32_32x32x16_bf16 v[120:135], v[48:51], v[224:227], v[120:135]
    buffer_load_dwordx4 v[192:195], v249, s[32:35], s16 offen offset:2048 sc1
    ds_read_b64_tr_b16 v[44:45], v24 offset:37888
    ds_read_b64_tr_b16 v[46:47], v24 offset:39936
    s_waitcnt lgkmcnt(10)
    v_mfma_f32_32x32x16_bf16 v[136:151], v[52:55], v[224:227], v[136:151]
    ds_read_b64_tr_b16 v[48:49], v25 offset:37888
    ds_read_b64_tr_b16 v[50:51], v25 offset:39936
    s_waitcnt lgkmcnt(10)
    v_mfma_f32_32x32x16_bf16 v[88:103], v[28:31], v[224:227], v[88:103]
    ds_read_b64_tr_b16 v[52:53], v22 offset:37888
    ds_read_b64_tr_b16 v[54:55], v22 offset:39936
    s_waitcnt lgkmcnt(10)
    v_mfma_f32_32x32x16_bf16 v[104:119], v[32:35], v[224:227], v[104:119]
    buffer_load_dwordx4 v[196:199], v249, s[32:35], s16 offen offset:3072 sc1
    ds_read_b64_tr_b16 v[28:29], v23 offset:37888
    ds_read_b64_tr_b16 v[30:31], v23 offset:39936
    s_waitcnt vmcnt(16)
    s_waitcnt lgkmcnt(10)
    v_mfma_f32_32x32x16_bf16 v[56:71], v[36:39], v[228:231], v[56:71]
    s_add_u32 s16, s16, 16384
    ds_read_b64_tr_b16 v[32:33], v20 offset:40960
    ds_read_b64_tr_b16 v[34:35], v20 offset:43008
    s_waitcnt lgkmcnt(10)
    v_mfma_f32_32x32x16_bf16 v[72:87], v[40:43], v[228:231], v[72:87]
    s_and_b32 s16, s16, 0x3ffff
    ds_read_b64_tr_b16 v[36:37], v21 offset:40960
    ds_read_b64_tr_b16 v[38:39], v21 offset:43008
    s_waitcnt lgkmcnt(10)
    v_mfma_f32_32x32x16_bf16 v[120:135], v[44:47], v[228:231], v[120:135]
    buffer_load_dwordx4 v[200:203], v249, s[32:35], s16 offen sc1
    ds_read_b64_tr_b16 v[40:41], v24 offset:40960
    ds_read_b64_tr_b16 v[42:43], v24 offset:43008
    s_waitcnt lgkmcnt(10)
    v_mfma_f32_32x32x16_bf16 v[136:151], v[48:51], v[228:231], v[136:151]
    ds_read_b64_tr_b16 v[44:45], v25 offset:40960
    ds_read_b64_tr_b16 v[46:47], v25 offset:43008
    s_waitcnt lgkmcnt(10)
    v_mfma_f32_32x32x16_bf16 v[88:103], v[52:55], v[228:231], v[88:103]
    ds_read_b64_tr_b16 v[48:49], v22 offset:40960
    ds_read_b64_tr_b16 v[50:51], v22 offset:43008
    s_waitcnt lgkmcnt(10)
    v_mfma_f32_32x32x16_bf16 v[104:119], v[28:31], v[228:231], v[104:119]
    buffer_load_dwordx4 v[204:207], v249, s[32:35], s16 offen offset:1024 sc1
    ds_read_b64_tr_b16 v[52:53], v23 offset:40960
    ds_read_b64_tr_b16 v[54:55], v23 offset:43008
    s_barrier
    s_waitcnt vmcnt(17)
    s_waitcnt lgkmcnt(10)
    v_mfma_f32_32x32x16_bf16 v[56:71], v[32:35], v[232:235], v[56:71]
    ds_read_b64_tr_b16 v[28:29], v20 offset:41984
    ds_read_b64_tr_b16 v[30:31], v20 offset:44032
    s_waitcnt lgkmcnt(10)
    v_mfma_f32_32x32x16_bf16 v[72:87], v[36:39], v[232:235], v[72:87]
    ds_read_b64_tr_b16 v[32:33], v21 offset:41984
    ds_read_b64_tr_b16 v[34:35], v21 offset:44032
    s_waitcnt lgkmcnt(10)
    v_mfma_f32_32x32x16_bf16 v[120:135], v[40:43], v[232:235], v[120:135]
    ds_read_b64_tr_b16 v[36:37], v24 offset:41984
    ds_read_b64_tr_b16 v[38:39], v24 offset:44032
    s_waitcnt lgkmcnt(10)
    v_mfma_f32_32x32x16_bf16 v[136:151], v[44:47], v[232:235], v[136:151]
    ds_read_b64_tr_b16 v[40:41], v25 offset:41984
    ds_read_b64_tr_b16 v[42:43], v25 offset:44032
    s_waitcnt lgkmcnt(10)
    v_mfma_f32_32x32x16_bf16 v[88:103], v[48:51], v[232:235], v[88:103]
    ds_read_b64_tr_b16 v[44:45], v22 offset:41984
    ds_read_b64_tr_b16 v[46:47], v22 offset:44032
    s_waitcnt lgkmcnt(10)
    v_mfma_f32_32x32x16_bf16 v[104:119], v[52:55], v[232:235], v[104:119]
    ds_read_b64_tr_b16 v[48:49], v23 offset:41984
    ds_read_b64_tr_b16 v[50:51], v23 offset:44032
    s_waitcnt vmcnt(16)
    s_waitcnt lgkmcnt(10)
    v_mfma_f32_32x32x16_bf16 v[56:71], v[28:31], v[236:239], v[56:71]
    ds_read_b64_tr_b16 v[52:53], v20 offset:45056
    ds_read_b64_tr_b16 v[54:55], v20 offset:47104
    s_waitcnt lgkmcnt(10)
    v_mfma_f32_32x32x16_bf16 v[72:87], v[32:35], v[236:239], v[72:87]
    ds_read_b64_tr_b16 v[28:29], v21 offset:45056
    ds_read_b64_tr_b16 v[30:31], v21 offset:47104
    s_waitcnt lgkmcnt(10)
    v_mfma_f32_32x32x16_bf16 v[120:135], v[36:39], v[236:239], v[120:135]
    buffer_load_dwordx4 v[208:211], v249, s[32:35], s16 offen offset:2048 sc1
    ds_read_b64_tr_b16 v[32:33], v24 offset:45056
    ds_read_b64_tr_b16 v[34:35], v24 offset:47104
    s_waitcnt lgkmcnt(10)
    v_mfma_f32_32x32x16_bf16 v[136:151], v[40:43], v[236:239], v[136:151]
    ds_read_b64_tr_b16 v[36:37], v25 offset:45056
    ds_read_b64_tr_b16 v[38:39], v25 offset:47104
    s_waitcnt lgkmcnt(10)
    v_mfma_f32_32x32x16_bf16 v[88:103], v[44:47], v[236:239], v[88:103]
    ds_read_b64_tr_b16 v[40:41], v22 offset:45056
    ds_read_b64_tr_b16 v[42:43], v22 offset:47104
    s_waitcnt lgkmcnt(10)
    v_mfma_f32_32x32x16_bf16 v[104:119], v[48:51], v[236:239], v[104:119]
    buffer_load_dwordx4 v[212:215], v249, s[32:35], s16 offen offset:3072 sc1
    ds_read_b64_tr_b16 v[44:45], v23 offset:45056
    ds_read_b64_tr_b16 v[46:47], v23 offset:47104
    s_waitcnt vmcnt(17)
    s_waitcnt lgkmcnt(10)
    v_mfma_f32_32x32x16_bf16 v[56:71], v[52:55], v[240:243], v[56:71]
    s_add_u32 s16, s16, 16384
    ds_read_b64_tr_b16 v[48:49], v20 offset:46080
    ds_read_b64_tr_b16 v[50:51], v20 offset:48128
    s_waitcnt lgkmcnt(10)
    v_mfma_f32_32x32x16_bf16 v[72:87], v[28:31], v[240:243], v[72:87]
    s_and_b32 s16, s16, 0x3ffff
    ds_read_b64_tr_b16 v[52:53], v21 offset:46080
    ds_read_b64_tr_b16 v[54:55], v21 offset:48128
    s_waitcnt lgkmcnt(10)
    v_mfma_f32_32x32x16_bf16 v[120:135], v[32:35], v[240:243], v[120:135]
    buffer_load_dwordx4 v[216:219], v249, s[32:35], s16 offen sc1
    ds_read_b64_tr_b16 v[28:29], v24 offset:46080
    ds_read_b64_tr_b16 v[30:31], v24 offset:48128
    s_waitcnt lgkmcnt(10)
    v_mfma_f32_32x32x16_bf16 v[136:151], v[36:39], v[240:243], v[136:151]
    ds_read_b64_tr_b16 v[32:33], v25 offset:46080
    ds_read_b64_tr_b16 v[34:35], v25 offset:48128
    s_waitcnt lgkmcnt(10)
    v_mfma_f32_32x32x16_bf16 v[88:103], v[40:43], v[240:243], v[88:103]
    ds_read_b64_tr_b16 v[36:37], v22 offset:46080
    ds_read_b64_tr_b16 v[38:39], v22 offset:48128
    s_waitcnt lgkmcnt(10)
    v_mfma_f32_32x32x16_bf16 v[104:119], v[44:47], v[240:243], v[104:119]
    buffer_load_dwordx4 v[220:223], v249, s[32:35], s16 offen offset:1024 sc1
    ds_read_b64_tr_b16 v[40:41], v23 offset:46080
    ds_read_b64_tr_b16 v[42:43], v23 offset:48128
    s_waitcnt vmcnt(18)
    s_waitcnt lgkmcnt(10)
    v_mfma_f32_32x32x16_bf16 v[56:71], v[48:51], v[244:247], v[56:71]
    ds_read_b64_tr_b16 v[44:45], v20
    ds_read_b64_tr_b16 v[46:47], v20 offset:2048
    s_waitcnt lgkmcnt(10)
    v_mfma_f32_32x32x16_bf16 v[72:87], v[52:55], v[244:247], v[72:87]
    ds_read_b64_tr_b16 v[48:49], v21
    ds_read_b64_tr_b16 v[50:51], v21 offset:2048
    s_waitcnt lgkmcnt(10)
    v_mfma_f32_32x32x16_bf16 v[120:135], v[28:31], v[244:247], v[120:135]
    buffer_load_dwordx4 v[224:227], v249, s[32:35], s16 offen offset:2048 sc1
    ds_read_b64_tr_b16 v[52:53], v24
    ds_read_b64_tr_b16 v[54:55], v24 offset:2048
    s_waitcnt lgkmcnt(10)
    v_mfma_f32_32x32x16_bf16 v[136:151], v[32:35], v[244:247], v[136:151]
    ds_read_b64_tr_b16 v[28:29], v25
    ds_read_b64_tr_b16 v[30:31], v25 offset:2048
    s_waitcnt lgkmcnt(10)
    v_mfma_f32_32x32x16_bf16 v[88:103], v[36:39], v[244:247], v[88:103]
    ds_read_b64_tr_b16 v[32:33], v22
    ds_read_b64_tr_b16 v[34:35], v22 offset:2048
    s_waitcnt lgkmcnt(10)
    v_mfma_f32_32x32x16_bf16 v[104:119], v[40:43], v[244:247], v[104:119]
    buffer_load_dwordx4 v[228:231], v249, s[32:35], s16 offen offset:3072 sc1
    ds_read_b64_tr_b16 v[36:37], v23
    ds_read_b64_tr_b16 v[38:39], v23 offset:2048
    s_barrier
    s_waitcnt vmcnt(19)
    s_waitcnt lgkmcnt(10)
    v_mfma_f32_32x32x16_bf16 v[56:71], v[44:47], v[152:155], v[56:71]
    s_add_u32 s16, s16, 16384
    ds_read_b64_tr_b16 v[40:41], v20 offset:1024
    ds_read_b64_tr_b16 v[42:43], v20 offset:3072
    s_waitcnt lgkmcnt(10)
    v_mfma_f32_32x32x16_bf16 v[72:87], v[48:51], v[152:155], v[72:87]
    s_and_b32 s16, s16, 0x3ffff
    ds_read_b64_tr_b16 v[44:45], v21 offset:1024
    ds_read_b64_tr_b16 v[46:47], v21 offset:3072
    s_waitcnt lgkmcnt(10)
    v_mfma_f32_32x32x16_bf16 v[120:135], v[52:55], v[152:155], v[120:135]
    ds_read_b64_tr_b16 v[48:49], v24 offset:1024
    ds_read_b64_tr_b16 v[50:51], v24 offset:3072
    s_waitcnt lgkmcnt(10)
    v_mfma_f32_32x32x16_bf16 v[136:151], v[28:31], v[152:155], v[136:151]
    ds_read_b64_tr_b16 v[52:53], v25 offset:1024
    ds_read_b64_tr_b16 v[54:55], v25 offset:3072
    s_waitcnt lgkmcnt(10)
    v_mfma_f32_32x32x16_bf16 v[88:103], v[32:35], v[152:155], v[88:103]
    ds_read_b64_tr_b16 v[28:29], v22 offset:1024
    ds_read_b64_tr_b16 v[30:31], v22 offset:3072
    s_waitcnt lgkmcnt(10)
    v_mfma_f32_32x32x16_bf16 v[104:119], v[36:39], v[152:155], v[104:119]
    ds_read_b64_tr_b16 v[32:33], v23 offset:1024
    ds_read_b64_tr_b16 v[34:35], v23 offset:3072
    s_waitcnt vmcnt(18)
    s_waitcnt lgkmcnt(10)
    v_mfma_f32_32x32x16_bf16 v[56:71], v[40:43], v[156:159], v[56:71]
    ds_read_b64_tr_b16 v[36:37], v20 offset:4096
    ds_read_b64_tr_b16 v[38:39], v20 offset:6144
    s_waitcnt lgkmcnt(10)
    v_mfma_f32_32x32x16_bf16 v[72:87], v[44:47], v[156:159], v[72:87]
    ds_read_b64_tr_b16 v[40:41], v21 offset:4096
    ds_read_b64_tr_b16 v[42:43], v21 offset:6144
    s_waitcnt lgkmcnt(10)
    v_mfma_f32_32x32x16_bf16 v[120:135], v[48:51], v[156:159], v[120:135]
    ds_read_b64_tr_b16 v[44:45], v24 offset:4096
    ds_read_b64_tr_b16 v[46:47], v24 offset:6144
    s_waitcnt lgkmcnt(10)
    v_mfma_f32_32x32x16_bf16 v[136:151], v[52:55], v[156:159], v[136:151]
    buffer_load_dwordx4 v[232:235], v249, s[32:35], s16 offen sc1
    ds_read_b64_tr_b16 v[48:49], v25 offset:4096
    ds_read_b64_tr_b16 v[50:51], v25 offset:6144
    s_waitcnt lgkmcnt(10)
    v_mfma_f32_32x32x16_bf16 v[88:103], v[28:31], v[156:159], v[88:103]
    ds_read_b64_tr_b16 v[52:53], v22 offset:4096
    ds_read_b64_tr_b16 v[54:55], v22 offset:6144
    s_waitcnt lgkmcnt(10)
    v_mfma_f32_32x32x16_bf16 v[104:119], v[32:35], v[156:159], v[104:119]
    ds_read_b64_tr_b16 v[28:29], v23 offset:4096
    ds_read_b64_tr_b16 v[30:31], v23 offset:6144
    s_waitcnt vmcnt(18)
    s_waitcnt lgkmcnt(10)
    v_mfma_f32_32x32x16_bf16 v[56:71], v[36:39], v[160:163], v[56:71]
    ds_read_b64_tr_b16 v[32:33], v20 offset:5120
    ds_read_b64_tr_b16 v[34:35], v20 offset:7168
    s_waitcnt lgkmcnt(10)
    v_mfma_f32_32x32x16_bf16 v[72:87], v[40:43], v[160:163], v[72:87]
    buffer_load_dwordx4 v[236:239], v249, s[32:35], s16 offen offset:1024 sc1
    ds_read_b64_tr_b16 v[36:37], v21 offset:5120
    ds_read_b64_tr_b16 v[38:39], v21 offset:7168
    s_waitcnt lgkmcnt(10)
    v_mfma_f32_32x32x16_bf16 v[120:135], v[44:47], v[160:163], v[120:135]
    ds_read_b64_tr_b16 v[40:41], v24 offset:5120
    ds_read_b64_tr_b16 v[42:43], v24 offset:7168
    s_waitcnt lgkmcnt(10)
    v_mfma_f32_32x32x16_bf16 v[136:151], v[48:51], v[160:163], v[136:151]
    ds_read_b64_tr_b16 v[44:45], v25 offset:5120
    ds_read_b64_tr_b16 v[46:47], v25 offset:7168
    s_waitcnt lgkmcnt(10)
    v_mfma_f32_32x32x16_bf16 v[88:103], v[52:55], v[160:163], v[88:103]
    buffer_load_dwordx4 v[240:243], v249, s[32:35], s16 offen offset:2048 sc1
    ds_read_b64_tr_b16 v[48:49], v22 offset:5120
    ds_read_b64_tr_b16 v[50:51], v22 offset:7168
    s_waitcnt lgkmcnt(10)
    v_mfma_f32_32x32x16_bf16 v[104:119], v[28:31], v[160:163], v[104:119]
    ds_read_b64_tr_b16 v[52:53], v23 offset:5120
    ds_read_b64_tr_b16 v[54:55], v23 offset:7168
    s_waitcnt vmcnt(19)
    s_waitcnt lgkmcnt(10)
    v_mfma_f32_32x32x16_bf16 v[56:71], v[32:35], v[164:167], v[56:71]
    ds_read_b64_tr_b16 v[28:29], v20 offset:8192
    ds_read_b64_tr_b16 v[30:31], v20 offset:10240
    s_waitcnt lgkmcnt(10)
    v_mfma_f32_32x32x16_bf16 v[72:87], v[36:39], v[164:167], v[72:87]
    ds_read_b64_tr_b16 v[32:33], v21 offset:8192
    ds_read_b64_tr_b16 v[34:35], v21 offset:10240
    s_waitcnt lgkmcnt(10)
    v_mfma_f32_32x32x16_bf16 v[120:135], v[40:43], v[164:167], v[120:135]
    buffer_load_dwordx4 v[244:247], v249, s[32:35], s16 offen offset:3072 sc1
    ds_read_b64_tr_b16 v[36:37], v24 offset:8192
    ds_read_b64_tr_b16 v[38:39], v24 offset:10240
    s_waitcnt lgkmcnt(10)
    v_mfma_f32_32x32x16_bf16 v[136:151], v[44:47], v[164:167], v[136:151]
    s_add_u32 s16, s16, 16384
    ds_read_b64_tr_b16 v[40:41], v25 offset:8192
    ds_read_b64_tr_b16 v[42:43], v25 offset:10240
    s_waitcnt lgkmcnt(10)
    v_mfma_f32_32x32x16_bf16 v[88:103], v[48:51], v[164:167], v[88:103]
    s_and_b32 s16, s16, 0x3ffff
    ds_read_b64_tr_b16 v[44:45], v22 offset:8192
    ds_read_b64_tr_b16 v[46:47], v22 offset:10240
    s_waitcnt lgkmcnt(10)
    v_mfma_f32_32x32x16_bf16 v[104:119], v[52:55], v[164:167], v[104:119]
    buffer_load_dwordx4 v[152:155], v249, s[32:35], s16 offen sc1
    ds_read_b64_tr_b16 v[48:49], v23 offset:8192
    ds_read_b64_tr_b16 v[50:51], v23 offset:10240
    s_barrier
    s_waitcnt vmcnt(20)
    s_waitcnt lgkmcnt(10)
    v_mfma_f32_32x32x16_bf16 v[56:71], v[28:31], v[168:171], v[56:71]
    ds_read_b64_tr_b16 v[52:53], v20 offset:9216
    ds_read_b64_tr_b16 v[54:55], v20 offset:11264
    s_waitcnt lgkmcnt(10)
    v_mfma_f32_32x32x16_bf16 v[72:87], v[32:35], v[168:171], v[72:87]
    ds_read_b64_tr_b16 v[28:29], v21 offset:9216
    ds_read_b64_tr_b16 v[30:31], v21 offset:11264
    s_waitcnt lgkmcnt(10)
    v_mfma_f32_32x32x16_bf16 v[120:135], v[36:39], v[168:171], v[120:135]
    ds_read_b64_tr_b16 v[32:33], v24 offset:9216
    ds_read_b64_tr_b16 v[34:35], v24 offset:11264
    s_waitcnt lgkmcnt(10)
    v_mfma_f32_32x32x16_bf16 v[136:151], v[40:43], v[168:171], v[136:151]
    ds_read_b64_tr_b16 v[36:37], v25 offset:9216
    ds_read_b64_tr_b16 v[38:39], v25 offset:11264
    s_waitcnt lgkmcnt(10)
    v_mfma_f32_32x32x16_bf16 v[88:103], v[44:47], v[168:171], v[88:103]
    ds_read_b64_tr_b16 v[40:41], v22 offset:9216
    ds_read_b64_tr_b16 v[42:43], v22 offset:11264
    s_waitcnt lgkmcnt(10)
    v_mfma_f32_32x32x16_bf16 v[104:119], v[48:51], v[168:171], v[104:119]
    ds_read_b64_tr_b16 v[44:45], v23 offset:9216
    ds_read_b64_tr_b16 v[46:47], v23 offset:11264
    s_waitcnt vmcnt(19)
    s_waitcnt lgkmcnt(10)
    v_mfma_f32_32x32x16_bf16 v[56:71], v[52:55], v[172:175], v[56:71]
    ds_read_b64_tr_b16 v[48:49], v20 offset:12288
    ds_read_b64_tr_b16 v[50:51], v20 offset:14336
    s_waitcnt lgkmcnt(10)
    v_mfma_f32_32x32x16_bf16 v[72:87], v[28:31], v[172:175], v[72:87]
    ds_read_b64_tr_b16 v[52:53], v21 offset:12288
    ds_read_b64_tr_b16 v[54:55], v21 offset:14336
    s_waitcnt lgkmcnt(10)
    v_mfma_f32_32x32x16_bf16 v[120:135], v[32:35], v[172:175], v[120:135]
    ds_read_b64_tr_b16 v[28:29], v24 offset:12288
    ds_read_b64_tr_b16 v[30:31], v24 offset:14336
    s_waitcnt lgkmcnt(10)
    v_mfma_f32_32x32x16_bf16 v[136:151], v[36:39], v[172:175], v[136:151]
    buffer_load_dwordx4 v[156:159], v249, s[32:35], s16 offen offset:1024 sc1
    ds_read_b64_tr_b16 v[32:33], v25 offset:12288
    ds_read_b64_tr_b16 v[34:35], v25 offset:14336
    s_waitcnt lgkmcnt(10)
    v_mfma_f32_32x32x16_bf16 v[88:103], v[40:43], v[172:175], v[88:103]
    ds_read_b64_tr_b16 v[36:37], v22 offset:12288
    ds_read_b64_tr_b16 v[38:39], v22 offset:14336
    s_waitcnt lgkmcnt(10)
    v_mfma_f32_32x32x16_bf16 v[104:119], v[44:47], v[172:175], v[104:119]
    ds_read_b64_tr_b16 v[40:41], v23 offset:12288
    ds_read_b64_tr_b16 v[42:43], v23 offset:14336
    s_waitcnt vmcnt(19)
    s_waitcnt lgkmcnt(10)
    v_mfma_f32_32x32x16_bf16 v[56:71], v[48:51], v[176:179], v[56:71]
    ds_read_b64_tr_b16 v[44:45], v20 offset:13312
    ds_read_b64_tr_b16 v[46:47], v20 offset:15360
    s_waitcnt lgkmcnt(10)
    v_mfma_f32_32x32x16_bf16 v[72:87], v[52:55], v[176:179], v[72:87]
    buffer_load_dwordx4 v[160:163], v249, s[32:35], s16 offen offset:2048 sc1
    ds_read_b64_tr_b16 v[48:49], v21 offset:13312
    ds_read_b64_tr_b16 v[50:51], v21 offset:15360
    s_waitcnt lgkmcnt(10)
    v_mfma_f32_32x32x16_bf16 v[120:135], v[28:31], v[176:179], v[120:135]
    ds_read_b64_tr_b16 v[52:53], v24 offset:13312
    ds_read_b64_tr_b16 v[54:55], v24 offset:15360
    s_waitcnt lgkmcnt(10)
    v_mfma_f32_32x32x16_bf16 v[136:151], v[32:35], v[176:179], v[136:151]
    ds_read_b64_tr_b16 v[28:29], v25 offset:13312
    ds_read_b64_tr_b16 v[30:31], v25 offset:15360
    s_waitcnt lgkmcnt(10)
    v_mfma_f32_32x32x16_bf16 v[88:103], v[36:39], v[176:179], v[88:103]
    buffer_load_dwordx4 v[164:167], v249, s[32:35], s16 offen offset:3072 sc1
    ds_read_b64_tr_b16 v[32:33], v22 offset:13312
    ds_read_b64_tr_b16 v[34:35], v22 offset:15360
    s_waitcnt lgkmcnt(10)
    v_mfma_f32_32x32x16_bf16 v[104:119], v[40:43], v[176:179], v[104:119]
    s_add_u32 s16, s16, 16384
    ds_read_b64_tr_b16 v[36:37], v23 offset:13312
    ds_read_b64_tr_b16 v[38:39], v23 offset:15360
    s_waitcnt vmcnt(20)
    s_waitcnt lgkmcnt(10)
    v_mfma_f32_32x32x16_bf16 v[56:71], v[44:47], v[180:183], v[56:71]
    s_and_b32 s16, s16, 0x3ffff
    ds_read_b64_tr_b16 v[40:41], v20 offset:16384
    ds_read_b64_tr_b16 v[42:43], v20 offset:18432
    s_waitcnt lgkmcnt(10)
    v_mfma_f32_32x32x16_bf16 v[72:87], v[48:51], v[180:183], v[72:87]
    ds_read_b64_tr_b16 v[44:45], v21 offset:16384
    ds_read_b64_tr_b16 v[46:47], v21 offset:18432
    s_waitcnt lgkmcnt(10)
    v_mfma_f32_32x32x16_bf16 v[120:135], v[52:55], v[180:183], v[120:135]
    buffer_load_dwordx4 v[168:171], v249, s[32:35], s16 offen sc1
    ds_read_b64_tr_b16 v[48:49], v24 offset:16384
    ds_read_b64_tr_b16 v[50:51], v24 offset:18432
    s_waitcnt lgkmcnt(10)
    v_mfma_f32_32x32x16_bf16 v[136:151], v[28:31], v[180:183], v[136:151]
    ds_read_b64_tr_b16 v[52:53], v25 offset:16384
    ds_read_b64_tr_b16 v[54:55], v25 offset:18432
    s_waitcnt lgkmcnt(10)
    v_mfma_f32_32x32x16_bf16 v[88:103], v[32:35], v[180:183], v[88:103]
    ds_read_b64_tr_b16 v[28:29], v22 offset:16384
    ds_read_b64_tr_b16 v[30:31], v22 offset:18432
    s_waitcnt lgkmcnt(10)
    v_mfma_f32_32x32x16_bf16 v[104:119], v[36:39], v[180:183], v[104:119]
    buffer_load_dwordx4 v[172:175], v249, s[32:35], s16 offen offset:1024 sc1
    ds_read_b64_tr_b16 v[32:33], v23 offset:16384
    ds_read_b64_tr_b16 v[34:35], v23 offset:18432
    s_barrier
    s_waitcnt vmcnt(21)
    s_waitcnt lgkmcnt(10)
    v_mfma_f32_32x32x16_bf16 v[56:71], v[40:43], v[184:187], v[56:71]
    ds_read_b64_tr_b16 v[36:37], v20 offset:17408
    ds_read_b64_tr_b16 v[38:39], v20 offset:19456
    s_waitcnt lgkmcnt(10)
    v_mfma_f32_32x32x16_bf16 v[72:87], v[44:47], v[184:187], v[72:87]
    ds_read_b64_tr_b16 v[40:41], v21 offset:17408
    ds_read_b64_tr_b16 v[42:43], v21 offset:19456
    s_waitcnt lgkmcnt(10)
    v_mfma_f32_32x32x16_bf16 v[120:135], v[48:51], v[184:187], v[120:135]
    ds_read_b64_tr_b16 v[44:45], v24 offset:17408
    ds_read_b64_tr_b16 v[46:47], v24 offset:19456
    s_waitcnt lgkmcnt(10)
    v_mfma_f32_32x32x16_bf16 v[136:151], v[52:55], v[184:187], v[136:151]
    ds_read_b64_tr_b16 v[48:49], v25 offset:17408
    ds_read_b64_tr_b16 v[50:51], v25 offset:19456
    s_waitcnt lgkmcnt(10)
    v_mfma_f32_32x32x16_bf16 v[88:103], v[28:31], v[184:187], v[88:103]
    ds_read_b64_tr_b16 v[52:53], v22 offset:17408
    ds_read_b64_tr_b16 v[54:55], v22 offset:19456
    s_waitcnt lgkmcnt(10)
    v_mfma_f32_32x32x16_bf16 v[104:119], v[32:35], v[184:187], v[104:119]
    ds_read_b64_tr_b16 v[28:29], v23 offset:17408
    ds_read_b64_tr_b16 v[30:31], v23 offset:19456
    s_waitcnt vmcnt(20)
    s_waitcnt lgkmcnt(10)
    v_mfma_f32_32x32x16_bf16 v[56:71], v[36:39], v[188:191], v[56:71]
    ds_read_b64_tr_b16 v[32:33], v20 offset:20480
    ds_read_b64_tr_b16 v[34:35], v20 offset:22528
    s_waitcnt lgkmcnt(10)
    v_mfma_f32_32x32x16_bf16 v[72:87], v[40:43], v[188:191], v[72:87]
    ds_read_b64_tr_b16 v[36:37], v21 offset:20480
    ds_read_b64_tr_b16 v[38:39], v21 offset:22528
    s_waitcnt lgkmcnt(10)
    v_mfma_f32_32x32x16_bf16 v[120:135], v[44:47], v[188:191], v[120:135]
    ds_read_b64_tr_b16 v[40:41], v24 offset:20480
    ds_read_b64_tr_b16 v[42:43], v24 offset:22528
    s_waitcnt lgkmcnt(10)
    v_mfma_f32_32x32x16_bf16 v[136:151], v[48:51], v[188:191], v[136:151]
    buffer_load_dwordx4 v[176:179], v249, s[32:35], s16 offen offset:2048 sc1
    ds_read_b64_tr_b16 v[44:45], v25 offset:20480
    ds_read_b64_tr_b16 v[46:47], v25 offset:22528
    s_waitcnt lgkmcnt(10)
    v_mfma_f32_32x32x16_bf16 v[88:103], v[52:55], v[188:191], v[88:103]
    ds_read_b64_tr_b16 v[48:49], v22 offset:20480
    ds_read_b64_tr_b16 v[50:51], v22 offset:22528
    s_waitcnt lgkmcnt(10)
    v_mfma_f32_32x32x16_bf16 v[104:119], v[28:31], v[188:191], v[104:119]
    ds_read_b64_tr_b16 v[52:53], v23 offset:20480
    ds_read_b64_tr_b16 v[54:55], v23 offset:22528
    s_waitcnt vmcnt(20)
    s_waitcnt lgkmcnt(10)
    v_mfma_f32_32x32x16_bf16 v[56:71], v[32:35], v[192:195], v[56:71]
    ds_read_b64_tr_b16 v[28:29], v20 offset:21504
    ds_read_b64_tr_b16 v[30:31], v20 offset:23552
    s_waitcnt lgkmcnt(10)
    v_mfma_f32_32x32x16_bf16 v[72:87], v[36:39], v[192:195], v[72:87]
    buffer_load_dwordx4 v[180:183], v249, s[32:35], s16 offen offset:3072 sc1
    ds_read_b64_tr_b16 v[32:33], v21 offset:21504
    ds_read_b64_tr_b16 v[34:35], v21 offset:23552
    s_waitcnt lgkmcnt(10)
    v_mfma_f32_32x32x16_bf16 v[120:135], v[40:43], v[192:195], v[120:135]
    s_add_u32 s16, s16, 16384
    ds_read_b64_tr_b16 v[36:37], v24 offset:21504
    ds_read_b64_tr_b16 v[38:39], v24 offset:23552
    s_waitcnt lgkmcnt(10)
    v_mfma_f32_32x32x16_bf16 v[136:151], v[44:47], v[192:195], v[136:151]
    s_and_b32 s16, s16, 0x3ffff
    ds_read_b64_tr_b16 v[40:41], v25 offset:21504
    ds_read_b64_tr_b16 v[42:43], v25 offset:23552
    s_waitcnt lgkmcnt(10)
    v_mfma_f32_32x32x16_bf16 v[88:103], v[48:51], v[192:195], v[88:103]
    buffer_load_dwordx4 v[184:187], v249, s[32:35], s16 offen sc1
    ds_read_b64_tr_b16 v[44:45], v22 offset:21504
    ds_read_b64_tr_b16 v[46:47], v22 offset:23552
L_PAD3:
    s_cbranch_execz L_RET3
    s_waitcnt lgkmcnt(10)
    v_mfma_f32_32x32x16_bf16 v[104:119], v[52:55], v[192:195], v[104:119]
    ds_read_b64_tr_b16 v[48:49], v23 offset:21504
    ds_read_b64_tr_b16 v[50:51], v23 offset:23552
    s_waitcnt vmcnt(21)
    s_waitcnt lgkmcnt(10)
    v_mfma_f32_32x32x16_bf16 v[56:71], v[28:31], v[196:199], v[56:71]
    ds_read_b64_tr_b16 v[52:53], v20 offset:24576
    ds_read_b64_tr_b16 v[54:55], v20 offset:26624
    s_waitcnt lgkmcnt(10)
    v_mfma_f32_32x32x16_bf16 v[72:87], v[32:35], v[196:199], v[72:87]
    ds_read_b64_tr_b16 v[28:29], v21 offset:24576
    ds_read_b64_tr_b16 v[30:31], v21 offset:26624
    s_waitcnt lgkmcnt(10)
    v_mfma_f32_32x32x16_bf16 v[120:135], v[36:39], v[196:199], v[120:135]
    buffer_load_dwordx4 v[188:191], v249, s[32:35], s16 offen offset:1024 sc1
    ds_read_b64_tr_b16 v[32:33], v20 offset:25600
    ds_read_b64_tr_b16 v[34:35], v20 offset:27648
    s_waitcnt lgkmcnt(10)
    v_mfma_f32_32x32x16_bf16 v[136:151], v[40:43], v[196:199], v[136:151]
    ds_read_b64_tr_b16 v[36:37], v21 offset:25600
    ds_read_b64_tr_b16 v[38:39], v21 offset:27648
    s_waitcnt lgkmcnt(10)
    v_mfma_f32_32x32x16_bf16 v[88:103], v[44:47], v[196:199], v[88:103]
    ds_read_b64_tr_b16 v[40:41], v20 offset:28672
    ds_read_b64_tr_b16 v[42:43], v20 offset:30720
    s_waitcnt lgkmcnt(10)
    v_mfma_f32_32x32x16_bf16 v[104:119], v[48:51], v[196:199], v[104:119]
    buffer_load_dwordx4 v[192:195], v249, s[32:35], s16 offen offset:2048 sc1
    ds_read_b64_tr_b16 v[44:45], v21 offset:28672
    ds_read_b64_tr_b16 v[46:47], v21 offset:30720
    s_barrier
    s_waitcnt vmcnt(22)
    s_waitcnt lgkmcnt(10)
    v_mfma_f32_32x32x16_bf16 v[56:71], v[52:55], v[200:203], v[56:71]
    ds_read_b64_tr_b16 v[48:49], v20 offset:29696
    ds_read_b64_tr_b16 v[50:51], v20 offset:31744
    s_waitcnt lgkmcnt(10)
    v_mfma_f32_32x32x16_bf16 v[72:87], v[28:31], v[200:203], v[72:87]
    ds_read_b64_tr_b16 v[52:53], v21 offset:29696
    ds_read_b64_tr_b16 v[54:55], v21 offset:31744
    s_waitcnt vmcnt(21)
    s_waitcnt lgkmcnt(10)
    v_mfma_f32_32x32x16_bf16 v[56:71], v[32:35], v[204:207], v[56:71]
    ds_read_b64_tr_b16 v[28:29], v24 offset:24576
    ds_read_b64_tr_b16 v[30:31], v24 offset:26624
    s_waitcnt lgkmcnt(10)
    v_mfma_f32_32x32x16_bf16 v[72:87], v[36:39], v[204:207], v[72:87]
    ds_read_b64_tr_b16 v[32:33], v25 offset:24576
    ds_read_b64_tr_b16 v[34:35], v25 offset:26624
    s_waitcnt vmcnt(20)
    s_waitcnt lgkmcnt(10)
    v_mfma_f32_32x32x16_bf16 v[56:71], v[40:43], v[208:211], v[56:71]
    ds_read_b64_tr_b16 v[36:37], v22 offset:24576
    ds_read_b64_tr_b16 v[38:39], v22 offset:26624
    s_waitcnt lgkmcnt(10)
    v_mfma_f32_32x32x16_bf16 v[72:87], v[44:47], v[208:211], v[72:87]
    ds_read_b64_tr_b16 v[40:41], v23 offset:24576
    ds_read_b64_tr_b16 v[42:43], v23 offset:26624
    s_waitcnt vmcnt(19)
    s_waitcnt lgkmcnt(10)
    v_mfma_f32_32x32x16_bf16 v[56:71], v[48:51], v[212:215], v[56:71]
    ds_read_b64_tr_b16 v[44:45], v24 offset:25600
    ds_read_b64_tr_b16 v[46:47], v24 offset:27648
    s_waitcnt lgkmcnt(10)
    v_mfma_f32_32x32x16_bf16 v[72:87], v[52:55], v[212:215], v[72:87]
    ds_read_b64_tr_b16 v[48:49], v25 offset:25600
    ds_read_b64_tr_b16 v[50:51], v25 offset:27648
    s_barrier
    s_waitcnt lgkmcnt(10)
    v_mfma_f32_32x32x16_bf16 v[120:135], v[28:31], v[200:203], v[120:135]
    ds_read_b64_tr_b16 v[52:53], v22 offset:25600
    ds_read_b64_tr_b16 v[54:55], v22 offset:27648
    s_waitcnt lgkmcnt(10)
    v_mfma_f32_32x32x16_bf16 v[136:151], v[32:35], v[200:203], v[136:151]
    buffer_load_dwordx4 v[196:199], v249, s[32:35], s16 offen offset:3072 sc1
    ds_read_b64_tr_b16 v[28:29], v23 offset:25600
    ds_read_b64_tr_b16 v[30:31], v23 offset:27648
    s_waitcnt lgkmcnt(10)
    v_mfma_f32_32x32x16_bf16 v[88:103], v[36:39], v[200:203], v[88:103]
    s_add_u32 s16, s16, 16384
    ds_read_b64_tr_b16 v[32:33], v24 offset:28672
    ds_read_b64_tr_b16 v[34:35], v24 offset:30720
    s_waitcnt lgkmcnt(10)
    v_mfma_f32_32x32x16_bf16 v[104:119], v[40:43], v[200:203], v[104:119]
    s_and_b32 s16, s16, 0x3ffff
    ds_read_b64_tr_b16 v[36:37], v25 offset:28672
    ds_read_b64_tr_b16 v[38:39], v25 offset:30720
    s_waitcnt lgkmcnt(10)
    v_mfma_f32_32x32x16_bf16 v[120:135], v[44:47], v[204:207], v[120:135]
    ds_read_b64_tr_b16 v[40:41], v22 offset:28672
    ds_read_b64_tr_b16 v[42:43], v22 offset:30720
    s_waitcnt lgkmcnt(10)
    v_mfma_f32_32x32x16_bf16 v[136:151], v[48:51], v[204:207], v[136:151]
    buffer_load_dwordx4 v[200:203], v249, s[32:35], s16 offen sc1
    ds_read_b64_tr_b16 v[44:45], v23 offset:28672
    ds_read_b64_tr_b16 v[46:47], v23 offset:30720
    s_waitcnt lgkmcnt(10)
    v_mfma_f32_32x32x16_bf16 v[88:103], v[52:55], v[204:207], v[88:103]
    ds_read_b64_tr_b16 v[48:49], v24 offset:29696
    ds_read_b64_tr_b16 v[50:51], v24 offset:31744
    s_waitcnt lgkmcnt(10)
    v_mfma_f32_32x32x16_bf16 v[104:119], v[28:31], v[204:207], v[104:119]
    ds_read_b64_tr_b16 v[52:53], v25 offset:29696
    ds_read_b64_tr_b16 v[54:55], v25 offset:31744
    s_waitcnt lgkmcnt(10)
    v_mfma_f32_32x32x16_bf16 v[120:135], v[32:35], v[208:211], v[120:135]
    buffer_load_dwordx4 v[204:207], v249, s[32:35], s16 offen offset:1024 sc1
    ds_read_b64_tr_b16 v[28:29], v22 offset:29696
    ds_read_b64_tr_b16 v[30:31], v22 offset:31744
    s_waitcnt lgkmcnt(10)
    v_mfma_f32_32x32x16_bf16 v[136:151], v[36:39], v[208:211], v[136:151]
    ds_read_b64_tr_b16 v[32:33], v23 offset:29696
    ds_read_b64_tr_b16 v[34:35], v23 offset:31744
    s_waitcnt lgkmcnt(10)
    v_mfma_f32_32x32x16_bf16 v[88:103], v[40:43], v[208:211], v[88:103]
    ds_read_b64_tr_b16 v[36:37], v20 offset:32768
    ds_read_b64_tr_b16 v[38:39], v20 offset:34816
    s_waitcnt lgkmcnt(10)
    v_mfma_f32_32x32x16_bf16 v[104:119], v[44:47], v[208:211], v[104:119]
    ds_read_b64_tr_b16 v[40:41], v20 offset:33792
    ds_read_b64_tr_b16 v[42:43], v20 offset:35840
    s_waitcnt lgkmcnt(10)
    v_mfma_f32_32x32x16_bf16 v[120:135], v[48:51], v[212:215], v[120:135]
    buffer_load_dwordx4 v[208:211], v249, s[32:35], s16 offen offset:2048 sc1
    ds_read_b64_tr_b16 v[44:45], v20 offset:36864
    ds_read_b64_tr_b16 v[46:47], v20 offset:38912
    s_waitcnt lgkmcnt(10)
    v_mfma_f32_32x32x16_bf16 v[136:151], v[52:55], v[212:215], v[136:151]
    ds_read_b64_tr_b16 v[48:49], v20 offset:37888
    ds_read_b64_tr_b16 v[50:51], v20 offset:39936
    s_waitcnt lgkmcnt(10)
    v_mfma_f32_32x32x16_bf16 v[88:103], v[28:31], v[212:215], v[88:103]
    ds_read_b64_tr_b16 v[52:53], v20 offset:40960
    ds_read_b64_tr_b16 v[54:55], v20 offset:43008
    s_waitcnt lgkmcnt(10)
    v_mfma_f32_32x32x16_bf16 v[104:119], v[32:35], v[212:215], v[104:119]
    buffer_load_dwordx4 v[212:215], v249, s[32:35], s16 offen offset:3072 sc1
    ds_read_b64_tr_b16 v[28:29], v20 offset:41984
    ds_read_b64_tr_b16 v[30:31], v20 offset:44032
    s_barrier
    s_waitcnt vmcnt(23)
    s_waitcnt lgkmcnt(10)
    v_mfma_f32_32x32x16_bf16 v[56:71], v[36:39], v[216:219], v[56:71]
    s_add_u32 s16, s16, 16384
    ds_read_b64_tr_b16 v[32:33], v20 offset:45056
    ds_read_b64_tr_b16 v[34:35], v20 offset:47104
    s_waitcnt vmcnt(22)
    s_waitcnt lgkmcnt(10)
    v_mfma_f32_32x32x16_bf16 v[56:71], v[40:43], v[220:223], v[56:71]
    s_and_b32 s16, s16, 0x3ffff
    ds_read_b64_tr_b16 v[36:37], v20 offset:46080
    ds_read_b64_tr_b16 v[38:39], v20 offset:48128
    s_waitcnt vmcnt(21)
    s_waitcnt lgkmcnt(10)
    v_mfma_f32_32x32x16_bf16 v[56:71], v[44:47], v[224:227], v[56:71]
    ds_read_b64_tr_b16 v[40:41], v20
    ds_read_b64_tr_b16 v[42:43], v20 offset:2048
    s_waitcnt vmcnt(20)
    s_waitcnt lgkmcnt(10)
    v_mfma_f32_32x32x16_bf16 v[56:71], v[48:51], v[228:231], v[56:71]
    ds_read_b64_tr_b16 v[44:45], v20 offset:1024
    ds_read_b64_tr_b16 v[46:47], v20 offset:3072
    s_waitcnt vmcnt(19)
    s_waitcnt lgkmcnt(10)
    v_mfma_f32_32x32x16_bf16 v[56:71], v[52:55], v[232:235], v[56:71]
    ds_read_b64_tr_b16 v[48:49], v20 offset:4096
    ds_read_b64_tr_b16 v[50:51], v20 offset:6144
    s_waitcnt vmcnt(18)
    s_waitcnt lgkmcnt(10)
    v_mfma_f32_32x32x16_bf16 v[56:71], v[28:31], v[236:239], v[56:71]
    ds_read_b64_tr_b16 v[52:53], v20 offset:5120
    ds_read_b64_tr_b16 v[54:55], v20 offset:7168
    s_waitcnt vmcnt(17)
    s_waitcnt lgkmcnt(10)
    v_mfma_f32_32x32x16_bf16 v[56:71], v[32:35], v[240:243], v[56:71]
    ds_read_b64_tr_b16 v[28:29], v20 offset:8192
    ds_read_b64_tr_b16 v[30:31], v20 offset:10240
    s_waitcnt vmcnt(16)
    s_waitcnt lgkmcnt(10)
    v_mfma_f32_32x32x16_bf16 v[56:71], v[36:39], v[244:247], v[56:71]
    ds_read_b64_tr_b16 v[32:33], v20 offset:9216
    ds_read_b64_tr_b16 v[34:35], v20 offset:11264
    s_waitcnt vmcnt(15)
    s_waitcnt lgkmcnt(10)
    v_mfma_f32_32x32x16_bf16 v[56:71], v[40:43], v[152:155], v[56:71]
    ds_read_b64_tr_b16 v[36:37], v20 offset:12288
    ds_read_b64_tr_b16 v[38:39], v20 offset:14336
    s_waitcnt vmcnt(14)
    s_waitcnt lgkmcnt(10)
    v_mfma_f32_32x32x16_bf16 v[56:71], v[44:47], v[156:159], v[56:71]
    ds_read_b64_tr_b16 v[40:41], v20 offset:13312
    ds_read_b64_tr_b16 v[42:43], v20 offset:15360
    s_waitcnt vmcnt(13)
    s_waitcnt lgkmcnt(10)
    v_mfma_f32_32x32x16_bf16 v[56:71], v[48:51], v[160:163], v[56:71]
    ds_read_b64_tr_b16 v[44:45], v20 offset:16384
    ds_read_b64_tr_b16 v[46:47], v20 offset:18432
    s_waitcnt vmcnt(12)
    s_waitcnt lgkmcnt(10)
    v_mfma_f32_32x32x16_bf16 v[56:71], v[52:55], v[164:167], v[56:71]
    ds_read_b64_tr_b16 v[48:49], v20 offset:17408
    ds_read_b64_tr_b16 v[50:51], v20 offset:19456
    s_waitcnt vmcnt(11)
    s_waitcnt lgkmcnt(10)
    v_mfma_f32_32x32x16_bf16 v[56:71], v[28:31], v[168:171], v[56:71]
    ds_read_b64_tr_b16 v[52:53], v20 offset:20480
    ds_read_b64_tr_b16 v[54:55], v20 offset:22528
    s_waitcnt vmcnt(10)
    s_waitcnt lgkmcnt(10)
    v_mfma_f32_32x32x16_bf16 v[56:71], v[32:35], v[172:175], v[56:71]
    ds_read_b64_tr_b16 v[28:29], v20 offset:21504
    ds_read_b64_tr_b16 v[30:31], v20 offset:23552
    s_barrier
    s_waitcnt vmcnt(9)
    s_waitcnt lgkmcnt(10)
    v_mfma_f32_32x32x16_bf16 v[56:71], v[36:39], v[176:179], v[56:71]
    ds_read_b64_tr_b16 v[32:33], v20 offset:24576
    ds_read_b64_tr_b16 v[34:35], v20 offset:26624
    s_waitcnt vmcnt(8)
    s_waitcnt lgkmcnt(10)
    v_mfma_f32_32x32x16_bf16 v[56:71], v[40:43], v[180:183], v[56:71]
    ds_read_b64_tr_b16 v[36:37], v20 offset:25600
    ds_read_b64_tr_b16 v[38:39], v20 offset:27648
    s_waitcnt vmcnt(7)
    s_waitcnt lgkmcnt(10)
    v_mfma_f32_32x32x16_bf16 v[56:71], v[44:47], v[184:187], v[56:71]
    ds_read_b64_tr_b16 v[40:41], v20 offset:28672
    ds_read_b64_tr_b16 v[42:43], v20 offset:30720
    s_waitcnt vmcnt(6)
    s_waitcnt lgkmcnt(10)
    v_mfma_f32_32x32x16_bf16 v[56:71], v[48:51], v[188:191], v[56:71]
    ds_read_b64_tr_b16 v[44:45], v20 offset:29696
    ds_read_b64_tr_b16 v[46:47], v20 offset:31744
    s_waitcnt vmcnt(5)
    s_waitcnt lgkmcnt(10)
    v_mfma_f32_32x32x16_bf16 v[56:71], v[52:55], v[192:195], v[56:71]
    ds_read_b64_tr_b16 v[48:49], v21 offset:32768
    ds_read_b64_tr_b16 v[50:51], v21 offset:34816
    s_waitcnt vmcnt(4)
    s_waitcnt lgkmcnt(10)
    v_mfma_f32_32x32x16_bf16 v[56:71], v[28:31], v[196:199], v[56:71]
    ds_read_b64_tr_b16 v[52:53], v21 offset:33792
    ds_read_b64_tr_b16 v[54:55], v21 offset:35840
    s_waitcnt vmcnt(3)
    s_waitcnt lgkmcnt(10)
    v_mfma_f32_32x32x16_bf16 v[56:71], v[32:35], v[200:203], v[56:71]
    ds_read_b64_tr_b16 v[28:29], v21 offset:36864
    ds_read_b64_tr_b16 v[30:31], v21 offset:38912
    s_waitcnt vmcnt(2)
    s_waitcnt lgkmcnt(10)
    v_mfma_f32_32x32x16_bf16 v[56:71], v[36:39], v[204:207], v[56:71]
    ds_read_b64_tr_b16 v[32:33], v21 offset:37888
    ds_read_b64_tr_b16 v[34:35], v21 offset:39936
    s_waitcnt vmcnt(1)
    s_waitcnt lgkmcnt(10)
    v_mfma_f32_32x32x16_bf16 v[56:71], v[40:43], v[208:211], v[56:71]
    ds_read_b64_tr_b16 v[36:37], v21 offset:40960
    ds_read_b64_tr_b16 v[38:39], v21 offset:43008
    s_waitcnt vmcnt(0)
    s_waitcnt lgkmcnt(10)
    v_mfma_f32_32x32x16_bf16 v[56:71], v[44:47], v[212:215], v[56:71]
    ds_read_b64_tr_b16 v[40:41], v21 offset:41984
    ds_read_b64_tr_b16 v[42:43], v21 offset:44032
    s_waitcnt lgkmcnt(10)
    v_mfma_f32_32x32x16_bf16 v[72:87], v[48:51], v[216:219], v[72:87]
    ds_read_b64_tr_b16 v[44:45], v21 offset:45056
    ds_read_b64_tr_b16 v[46:47], v21 offset:47104
    s_waitcnt lgkmcnt(10)
    v_mfma_f32_32x32x16_bf16 v[72:87], v[52:55], v[220:223], v[72:87]
    s_nop 3
    v_cvt_pk_bf16_f32 v56, v56, v57
    v_cvt_pk_bf16_f32 v57, v58, v59
    ds_read_b64_tr_b16 v[48:49], v21 offset:46080
    ds_read_b64_tr_b16 v[50:51], v21 offset:48128
    s_waitcnt lgkmcnt(10)
    v_mfma_f32_32x32x16_bf16 v[72:87], v[28:31], v[224:227], v[72:87]
    v_cvt_pk_bf16_f32 v58, v60, v61
    v_cvt_pk_bf16_f32 v59, v62, v63
    ds_read_b64_tr_b16 v[52:53], v21
    ds_read_b64_tr_b16 v[54:55], v21 offset:2048
    s_waitcnt lgkmcnt(10)
    v_mfma_f32_32x32x16_bf16 v[72:87], v[32:35], v[228:231], v[72:87]
    ds_write_b128 v0, v[56:59]
    v_cvt_pk_bf16_f32 v60, v64, v65
    ds_read_b64_tr_b16 v[28:29], v21 offset:1024
    ds_read_b64_tr_b16 v[30:31], v21 offset:3072
    s_waitcnt lgkmcnt(11)
    v_mfma_f32_32x32x16_bf16 v[72:87], v[36:39], v[232:235], v[72:87]
    v_cvt_pk_bf16_f32 v61, v66, v67
    v_cvt_pk_bf16_f32 v62, v68, v69
    ds_read_b64_tr_b16 v[32:33], v21 offset:4096
    ds_read_b64_tr_b16 v[34:35], v21 offset:6144
    s_waitcnt lgkmcnt(11)
    v_mfma_f32_32x32x16_bf16 v[72:87], v[40:43], v[236:239], v[72:87]
    v_cvt_pk_bf16_f32 v63, v70, v71
    ds_write_b128 v0, v[60:63] offset:1024
    ds_read_b64_tr_b16 v[36:37], v21 offset:5120
    ds_read_b64_tr_b16 v[38:39], v21 offset:7168
    s_waitcnt lgkmcnt(12)
    v_mfma_f32_32x32x16_bf16 v[72:87], v[44:47], v[240:243], v[72:87]
    v_subrev_u32 v0, 118784, v0
    ds_read_b64_tr_b16 v[40:41], v21 offset:8192
    ds_read_b64_tr_b16 v[42:43], v21 offset:10240
    s_waitcnt lgkmcnt(12)
    v_mfma_f32_32x32x16_bf16 v[72:87], v[48:51], v[244:247], v[72:87]
    ds_read_b64_tr_b16 v[44:45], v21 offset:9216
    ds_read_b64_tr_b16 v[46:47], v21 offset:11264
    s_waitcnt lgkmcnt(6)
    s_barrier
    v_mfma_f32_32x32x16_bf16 v[72:87], v[52:55], v[152:155], v[72:87]
    ds_read_b64_tr_b16 v[48:49], v21 offset:12288
    ds_read_b64_tr_b16 v[50:51], v21 offset:14336
    v_mfma_f32_32x32x16_bf16 v[72:87], v[28:31], v[156:159], v[72:87]
    ds_read_b64_tr_b16 v[52:53], v21 offset:13312
    ds_read_b64_tr_b16 v[54:55], v21 offset:15360
    v_mfma_f32_32x32x16_bf16 v[72:87], v[32:35], v[160:163], v[72:87]
    ds_read_b64_tr_b16 v[28:29], v21 offset:16384
    ds_read_b64_tr_b16 v[30:31], v21 offset:18432
    s_waitcnt lgkmcnt(10)
    v_mfma_f32_32x32x16_bf16 v[72:87], v[36:39], v[164:167], v[72:87]
    ds_read_b64_tr_b16 v[32:33], v21 offset:17408
    ds_read_b64_tr_b16 v[34:35], v21 offset:19456
    s_waitcnt lgkmcnt(10)
    v_mfma_f32_32x32x16_bf16 v[72:87], v[40:43], v[168:171], v[72:87]
    ds_read_b64_tr_b16 v[36:37], v21 offset:20480
    ds_read_b64_tr_b16 v[38:39], v21 offset:22528
    s_waitcnt lgkmcnt(10)
    v_mfma_f32_32x32x16_bf16 v[72:87], v[44:47], v[172:175], v[72:87]
    ds_read_b64_tr_b16 v[40:41], v21 offset:21504
    ds_read_b64_tr_b16 v[42:43], v21 offset:23552
    s_waitcnt lgkmcnt(10)
    v_mfma_f32_32x32x16_bf16 v[72:87], v[48:51], v[176:179], v[72:87]
    ds_read_b64_tr_b16 v[44:45], v21 offset:24576
    ds_read_b64_tr_b16 v[46:47], v21 offset:26624
    s_waitcnt lgkmcnt(10)
    v_mfma_f32_32x32x16_bf16 v[72:87], v[52:55], v[180:183], v[72:87]
    ds_read_b64_tr_b16 v[48:49], v21 offset:25600
    ds_read_b64_tr_b16 v[50:51], v21 offset:27648
    s_waitcnt lgkmcnt(10)
    v_mfma_f32_32x32x16_bf16 v[72:87], v[28:31], v[184:187], v[72:87]
    ds_read_b64_tr_b16 v[52:53], v21 offset:28672
    ds_read_b64_tr_b16 v[54:55], v21 offset:30720
    s_waitcnt lgkmcnt(10)
    v_mfma_f32_32x32x16_bf16 v[72:87], v[32:35], v[188:191], v[72:87]
    ds_read_b64_tr_b16 v[28:29], v21 offset:29696
    ds_read_b64_tr_b16 v[30:31], v21 offset:31744
    s_waitcnt lgkmcnt(10)
    v_mfma_f32_32x32x16_bf16 v[72:87], v[36:39], v[192:195], v[72:87]
    ds_read_b64_tr_b16 v[32:33], v22 offset:32768
    ds_read_b64_tr_b16 v[34:35], v22 offset:34816
    s_waitcnt lgkmcnt(10)
    v_mfma_f32_32x32x16_bf16 v[72:87], v[40:43], v[196:199], v[72:87]
    ds_read_b64_tr_b16 v[36:37], v23 offset:32768
    ds_read_b64_tr_b16 v[38:39], v23 offset:34816
    s_waitcnt lgkmcnt(10)
    v_mfma_f32_32x32x16_bf16 v[72:87], v[44:47], v[200:203], v[72:87]
    ds_read_b64_tr_b16 v[40:41], v22 offset:33792
    ds_read_b64_tr_b16 v[42:43], v22 offset:35840
    s_waitcnt lgkmcnt(10)
    v_mfma_f32_32x32x16_bf16 v[72:87], v[48:51], v[204:207], v[72:87]
    ds_read_b64_tr_b16 v[44:45], v23 offset:33792
    ds_read_b64_tr_b16 v[46:47], v23 offset:35840
    s_waitcnt lgkmcnt(10)
    v_mfma_f32_32x32x16_bf16 v[72:87], v[52:55], v[208:211], v[72:87]
    ds_read_b64_tr_b16 v[48:49], v22 offset:36864
    ds_read_b64_tr_b16 v[50:51], v22 offset:38912
    s_waitcnt lgkmcnt(10)
    v_mfma_f32_32x32x16_bf16 v[72:87], v[28:31], v[212:215], v[72:87]
    ds_read_b64_tr_b16 v[52:53], v23 offset:36864
    ds_read_b64_tr_b16 v[54:55], v23 offset:38912
    s_waitcnt lgkmcnt(10)
    v_mfma_f32_32x32x16_bf16 v[88:103], v[32:35], v[216:219], v[88:103]
    ds_read_b64_tr_b16 v[28:29], v22 offset:37888
    ds_read_b64_tr_b16 v[30:31], v22 offset:39936
    s_waitcnt lgkmcnt(10)
    v_mfma_f32_32x32x16_bf16 v[104:119], v[36:39], v[216:219], v[104:119]
    s_nop 3
    v_cvt_pk_bf16_f32 v72, v72, v73
    v_cvt_pk_bf16_f32 v73, v74, v75
    ds_read_b64_tr_b16 v[32:33], v23 offset:37888
    ds_read_b64_tr_b16 v[34:35], v23 offset:39936
    s_waitcnt lgkmcnt(10)
    v_mfma_f32_32x32x16_bf16 v[88:103], v[40:43], v[220:223], v[88:103]
    v_cvt_pk_bf16_f32 v74, v76, v77
    v_cvt_pk_bf16_f32 v75, v78, v79
    ds_read_b64_tr_b16 v[36:37], v22 offset:40960
    ds_read_b64_tr_b16 v[38:39], v22 offset:43008
    s_waitcnt lgkmcnt(10)
    v_mfma_f32_32x32x16_bf16 v[104:119], v[44:47], v[220:223], v[104:119]
    ds_write_b128 v0, v[72:75]
    v_cvt_pk_bf16_f32 v76, v80, v81
    ds_read_b64_tr_b16 v[40:41], v23 offset:40960
    ds_read_b64_tr_b16 v[42:43], v23 offset:43008
    s_waitcnt lgkmcnt(11)
    v_mfma_f32_32x32x16_bf16 v[88:103], v[48:51], v[224:227], v[88:103]
    v_cvt_pk_bf16_f32 v77, v82, v83
    v_cvt_pk_bf16_f32 v78, v84, v85
    ds_read_b64_tr_b16 v[44:45], v22 offset:41984
    ds_read_b64_tr_b16 v[46:47], v22 offset:44032
    s_waitcnt lgkmcnt(11)
    v_mfma_f32_32x32x16_bf16 v[104:119], v[52:55], v[224:227], v[104:119]
    v_cvt_pk_bf16_f32 v79, v86, v87
    ds_write_b128 v0, v[76:79] offset:1024
    ds_read_b64_tr_b16 v[48:49], v23 offset:41984
    ds_read_b64_tr_b16 v[50:51], v23 offset:44032
    s_waitcnt lgkmcnt(12)
    v_mfma_f32_32x32x16_bf16 v[88:103], v[28:31], v[228:231], v[88:103]
    ds_read_b64_tr_b16 v[52:53], v22 offset:45056
    ds_read_b64_tr_b16 v[54:55], v22 offset:47104
    s_waitcnt lgkmcnt(12)
    v_mfma_f32_32x32x16_bf16 v[104:119], v[32:35], v[228:231], v[104:119]
    ds_read_b64_tr_b16 v[28:29], v23 offset:45056
    ds_read_b64_tr_b16 v[30:31], v23 offset:47104
    s_waitcnt lgkmcnt(6)
    s_barrier
    v_mfma_f32_32x32x16_bf16 v[88:103], v[36:39], v[232:235], v[88:103]
    s_lshl_b32 s96, s77, 11
    s_add_u32 s14, s96, 32768
    v_and_b32 v0, 7, v1
    ds_read_b64_tr_b16 v[32:33], v22 offset:46080
    ds_read_b64_tr_b16 v[34:35], v22 offset:48128
    v_mfma_f32_32x32x16_bf16 v[104:119], v[40:43], v[232:235], v[104:119]
    v_lshl_add_u32 v0, v0, 4, s14
    ds_read_b64_tr_b16 v[36:37], v23 offset:46080
    ds_read_b64_tr_b16 v[38:39], v23 offset:48128
    v_mfma_f32_32x32x16_bf16 v[88:103], v[44:47], v[236:239], v[88:103]
    v_bfe_u32 v4, v1, 3, 2
    ds_read_b64_tr_b16 v[40:41], v22
    ds_read_b64_tr_b16 v[42:43], v22 offset:2048
    s_waitcnt lgkmcnt(10)
    v_mfma_f32_32x32x16_bf16 v[104:119], v[48:51], v[236:239], v[104:119]
    v_lshl_add_u32 v0, v4, 8, v0
    v_lshrrev_b32 v4, 5, v1
    ds_read_b64_tr_b16 v[44:45], v23
    ds_read_b64_tr_b16 v[46:47], v23 offset:2048
    s_waitcnt lgkmcnt(10)
    v_mfma_f32_32x32x16_bf16 v[88:103], v[52:55], v[240:243], v[88:103]
    v_lshl_add_u32 v0, v4, 7, v0
    ds_read_b64_tr_b16 v[48:49], v22 offset:1024
    ds_read_b64_tr_b16 v[50:51], v22 offset:3072
    s_waitcnt lgkmcnt(10)
    v_mfma_f32_32x32x16_bf16 v[104:119], v[28:31], v[240:243], v[104:119]
    ds_read_b64_tr_b16 v[52:53], v23 offset:1024
    ds_read_b64_tr_b16 v[54:55], v23 offset:3072
    s_waitcnt lgkmcnt(10)
    v_mfma_f32_32x32x16_bf16 v[88:103], v[32:35], v[244:247], v[88:103]
    ds_read_b64_tr_b16 v[28:29], v22 offset:4096
    ds_read_b64_tr_b16 v[30:31], v22 offset:6144
    s_waitcnt lgkmcnt(10)
    v_mfma_f32_32x32x16_bf16 v[104:119], v[36:39], v[244:247], v[104:119]
    ds_read_b64_tr_b16 v[32:33], v23 offset:4096
    ds_read_b64_tr_b16 v[34:35], v23 offset:6144
    s_waitcnt lgkmcnt(10)
    v_mfma_f32_32x32x16_bf16 v[88:103], v[40:43], v[152:155], v[88:103]
    ds_read_b64_tr_b16 v[36:37], v22 offset:5120
    ds_read_b64_tr_b16 v[38:39], v22 offset:7168
    s_waitcnt lgkmcnt(10)
    v_mfma_f32_32x32x16_bf16 v[104:119], v[44:47], v[152:155], v[104:119]
    ds_read_b64_tr_b16 v[40:41], v23 offset:5120
    ds_read_b64_tr_b16 v[42:43], v23 offset:7168
    s_waitcnt lgkmcnt(10)
    v_mfma_f32_32x32x16_bf16 v[88:103], v[48:51], v[156:159], v[88:103]
    ds_read_b64_tr_b16 v[44:45], v22 offset:8192
    ds_read_b64_tr_b16 v[46:47], v22 offset:10240
    s_waitcnt lgkmcnt(10)
    v_mfma_f32_32x32x16_bf16 v[104:119], v[52:55], v[156:159], v[104:119]
    ds_read_b64_tr_b16 v[48:49], v23 offset:8192
    ds_read_b64_tr_b16 v[50:51], v23 offset:10240
    s_waitcnt lgkmcnt(10)
    v_mfma_f32_32x32x16_bf16 v[88:103], v[28:31], v[160:163], v[88:103]
    ds_read_b64_tr_b16 v[52:53], v22 offset:9216
    ds_read_b64_tr_b16 v[54:55], v22 offset:11264
    s_waitcnt lgkmcnt(10)
    v_mfma_f32_32x32x16_bf16 v[104:119], v[32:35], v[160:163], v[104:119]
    ds_read_b64_tr_b16 v[28:29], v23 offset:9216
    ds_read_b64_tr_b16 v[30:31], v23 offset:11264
    s_waitcnt lgkmcnt(10)
    v_mfma_f32_32x32x16_bf16 v[88:103], v[36:39], v[164:167], v[88:103]
    ds_read_b64_tr_b16 v[32:33], v22 offset:12288
    ds_read_b64_tr_b16 v[34:35], v22 offset:14336
    s_waitcnt lgkmcnt(10)
    v_mfma_f32_32x32x16_bf16 v[104:119], v[40:43], v[164:167], v[104:119]
    ds_read_b64_tr_b16 v[36:37], v23 offset:12288
    ds_read_b64_tr_b16 v[38:39], v23 offset:14336
    s_waitcnt lgkmcnt(10)
    v_mfma_f32_32x32x16_bf16 v[88:103], v[44:47], v[168:171], v[88:103]
    ds_read_b64_tr_b16 v[40:41], v22 offset:13312
    ds_read_b64_tr_b16 v[42:43], v22 offset:15360
    s_waitcnt lgkmcnt(10)
    v_mfma_f32_32x32x16_bf16 v[104:119], v[48:51], v[168:171], v[104:119]
    ds_read_b64_tr_b16 v[44:45], v23 offset:13312
    ds_read_b64_tr_b16 v[46:47], v23 offset:15360
    s_waitcnt lgkmcnt(10)
    v_mfma_f32_32x32x16_bf16 v[88:103], v[52:55], v[172:175], v[88:103]
    ds_read_b64_tr_b16 v[48:49], v22 offset:16384
    ds_read_b64_tr_b16 v[50:51], v22 offset:18432
    s_waitcnt lgkmcnt(10)
    v_mfma_f32_32x32x16_bf16 v[104:119], v[28:31], v[172:175], v[104:119]
    ds_read_b64_tr_b16 v[52:53], v23 offset:16384
    ds_read_b64_tr_b16 v[54:55], v23 offset:18432
    s_waitcnt lgkmcnt(10)
    v_mfma_f32_32x32x16_bf16 v[88:103], v[32:35], v[176:179], v[88:103]
    ds_read_b64_tr_b16 v[28:29], v22 offset:17408
    ds_read_b64_tr_b16 v[30:31], v22 offset:19456
    s_waitcnt lgkmcnt(10)
    v_mfma_f32_32x32x16_bf16 v[104:119], v[36:39], v[176:179], v[104:119]
    ds_read_b64_tr_b16 v[32:33], v23 offset:17408
    ds_read_b64_tr_b16 v[34:35], v23 offset:19456
    s_waitcnt lgkmcnt(10)
    v_mfma_f32_32x32x16_bf16 v[88:103], v[40:43], v[180:183], v[88:103]
    ds_read_b64_tr_b16 v[36:37], v22 offset:20480
    ds_read_b64_tr_b16 v[38:39], v22 offset:22528
    s_waitcnt lgkmcnt(10)
    v_mfma_f32_32x32x16_bf16 v[104:119], v[44:47], v[180:183], v[104:119]
    ds_read_b64_tr_b16 v[40:41], v23 offset:20480
    ds_read_b64_tr_b16 v[42:43], v23 offset:22528
    s_waitcnt lgkmcnt(10)
    v_mfma_f32_32x32x16_bf16 v[88:103], v[48:51], v[184:187], v[88:103]
    ds_read_b64_tr_b16 v[44:45], v22 offset:21504
    ds_read_b64_tr_b16 v[46:47], v22 offset:23552
    s_waitcnt lgkmcnt(10)
    v_mfma_f32_32x32x16_bf16 v[104:119], v[52:55], v[184:187], v[104:119]
    ds_read_b64_tr_b16 v[48:49], v23 offset:21504
    ds_read_b64_tr_b16 v[50:51], v23 offset:23552
    s_waitcnt lgkmcnt(10)
    v_mfma_f32_32x32x16_bf16 v[88:103], v[28:31], v[188:191], v[88:103]
    ds_read_b64_tr_b16 v[52:53], v22 offset:24576
    ds_read_b64_tr_b16 v[54:55], v22 offset:26624
    s_waitcnt lgkmcnt(10)
    v_mfma_f32_32x32x16_bf16 v[104:119], v[32:35], v[188:191], v[104:119]
    ds_read_b64_tr_b16 v[28:29], v23 offset:24576
    ds_read_b64_tr_b16 v[30:31], v23 offset:26624
    s_waitcnt lgkmcnt(10)
    v_mfma_f32_32x32x16_bf16 v[88:103], v[36:39], v[192:195], v[88:103]
    ds_read_b64_tr_b16 v[32:33], v22 offset:25600
    ds_read_b64_tr_b16 v[34:35], v22 offset:27648
    s_waitcnt lgkmcnt(10)
    v_mfma_f32_32x32x16_bf16 v[104:119], v[40:43], v[192:195], v[104:119]
    ds_read_b64_tr_b16 v[36:37], v23 offset:25600
    ds_read_b64_tr_b16 v[38:39], v23 offset:27648
    s_waitcnt lgkmcnt(10)
    v_mfma_f32_32x32x16_bf16 v[88:103], v[44:47], v[196:199], v[88:103]
    ds_read_b64_tr_b16 v[40:41], v22 offset:28672
    ds_read_b64_tr_b16 v[42:43], v22 offset:30720
    s_waitcnt lgkmcnt(10)
    v_mfma_f32_32x32x16_bf16 v[104:119], v[48:51], v[196:199], v[104:119]
    ds_read_b64_tr_b16 v[44:45], v23 offset:28672
    ds_read_b64_tr_b16 v[46:47], v23 offset:30720
    s_waitcnt lgkmcnt(10)
    v_mfma_f32_32x32x16_bf16 v[88:103], v[52:55], v[200:203], v[88:103]
    ds_read_b64_tr_b16 v[48:49], v22 offset:29696
    ds_read_b64_tr_b16 v[50:51], v22 offset:31744
    s_waitcnt lgkmcnt(10)
    v_mfma_f32_32x32x16_bf16 v[104:119], v[28:31], v[200:203], v[104:119]
    ds_read_b64_tr_b16 v[52:53], v23 offset:29696
    ds_read_b64_tr_b16 v[54:55], v23 offset:31744
    s_waitcnt lgkmcnt(10)
    v_mfma_f32_32x32x16_bf16 v[88:103], v[32:35], v[204:207], v[88:103]
    ds_read_b64_tr_b16 v[28:29], v24 offset:32768
    ds_read_b64_tr_b16 v[30:31], v24 offset:34816
    s_waitcnt lgkmcnt(10)
    v_mfma_f32_32x32x16_bf16 v[104:119], v[36:39], v[204:207], v[104:119]
    ds_read_b64_tr_b16 v[32:33], v25 offset:32768
    ds_read_b64_tr_b16 v[34:35], v25 offset:34816
    s_waitcnt lgkmcnt(10)
    v_mfma_f32_32x32x16_bf16 v[88:103], v[40:43], v[208:211], v[88:103]
    ds_read_b64_tr_b16 v[36:37], v24 offset:33792
    ds_read_b64_tr_b16 v[38:39], v24 offset:35840
    s_waitcnt lgkmcnt(10)
    v_mfma_f32_32x32x16_bf16 v[104:119], v[44:47], v[208:211], v[104:119]
    ds_read_b64_tr_b16 v[40:41], v25 offset:33792
    ds_read_b64_tr_b16 v[42:43], v25 offset:35840
    s_waitcnt lgkmcnt(10)
    v_mfma_f32_32x32x16_bf16 v[88:103], v[48:51], v[212:215], v[88:103]
    ds_read_b64_tr_b16 v[44:45], v24 offset:36864
    ds_read_b64_tr_b16 v[46:47], v24 offset:38912
    s_waitcnt lgkmcnt(10)
    v_mfma_f32_32x32x16_bf16 v[104:119], v[52:55], v[212:215], v[104:119]
    ds_read_b64_tr_b16 v[48:49], v25 offset:36864
    ds_read_b64_tr_b16 v[50:51], v25 offset:38912
    s_barrier
    s_waitcnt lgkmcnt(10)
    v_mfma_f32_32x32x16_bf16 v[120:135], v[28:31], v[216:219], v[120:135]
    ds_read_b64_tr_b16 v[52:53], v24 offset:37888
    ds_read_b64_tr_b16 v[54:55], v24 offset:39936
    s_waitcnt lgkmcnt(10)
    v_mfma_f32_32x32x16_bf16 v[136:151], v[32:35], v[216:219], v[136:151]
    ds_read_b64_tr_b16 v[28:29], v25 offset:37888
    ds_read_b64_tr_b16 v[30:31], v25 offset:39936
    s_waitcnt lgkmcnt(10)
    v_mfma_f32_32x32x16_bf16 v[120:135], v[36:39], v[220:223], v[120:135]
    v_cvt_pk_bf16_f32 v88, v88, v89
    ds_read_b64_tr_b16 v[32:33], v24 offset:40960
    ds_read_b64_tr_b16 v[34:35], v24 offset:43008
L_PAD4:
    s_cbranch_execz L_RET4
    s_waitcnt lgkmcnt(10)
    v_mfma_f32_32x32x16_bf16 v[136:151], v[40:43], v[220:223], v[136:151]
    v_cvt_pk_bf16_f32 v89, v90, v91
    ds_read_b64_tr_b16 v[36:37], v25 offset:40960
    ds_read_b64_tr_b16 v[38:39], v25 offset:43008
    s_waitcnt lgkmcnt(10)
    v_mfma_f32_32x32x16_bf16 v[120:135], v[44:47], v[224:227], v[120:135]
    v_cvt_pk_bf16_f32 v90, v92, v93
    ds_read_b64_tr_b16 v[40:41], v24 offset:41984
    ds_read_b64_tr_b16 v[42:43], v24 offset:44032
    s_waitcnt lgkmcnt(10)
    v_mfma_f32_32x32x16_bf16 v[136:151], v[48:51], v[224:227], v[136:151]
    v_cvt_pk_bf16_f32 v91, v94, v95
    ds_read_b64_tr_b16 v[44:45], v25 offset:41984
    ds_read_b64_tr_b16 v[46:47], v25 offset:44032
    s_waitcnt lgkmcnt(10)
    v_mfma_f32_32x32x16_bf16 v[120:135], v[52:55], v[228:231], v[120:135]
    ds_write_b128 v0, v[88:91]
    ds_read_b64_tr_b16 v[48:49], v24 offset:45056
    ds_read_b64_tr_b16 v[50:51], v24 offset:47104
    s_waitcnt lgkmcnt(11)
    v_mfma_f32_32x32x16_bf16 v[136:151], v[28:31], v[228:231], v[136:151]
    v_cvt_pk_bf16_f32 v92, v96, v97
    ds_read_b64_tr_b16 v[52:53], v25 offset:45056
    ds_read_b64_tr_b16 v[54:55], v25 offset:47104
    s_waitcnt lgkmcnt(11)
    v_mfma_f32_32x32x16_bf16 v[120:135], v[32:35], v[232:235], v[120:135]
    v_cvt_pk_bf16_f32 v93, v98, v99
    ds_read_b64_tr_b16 v[28:29], v24 offset:46080
    ds_read_b64_tr_b16 v[30:31], v24 offset:48128
    s_waitcnt lgkmcnt(11)
    v_mfma_f32_32x32x16_bf16 v[136:151], v[36:39], v[232:235], v[136:151]
    v_cvt_pk_bf16_f32 v94, v100, v101
    ds_read_b64_tr_b16 v[32:33], v25 offset:46080
    ds_read_b64_tr_b16 v[34:35], v25 offset:48128
    s_waitcnt lgkmcnt(11)
    v_mfma_f32_32x32x16_bf16 v[120:135], v[40:43], v[236:239], v[120:135]
    v_cvt_pk_bf16_f32 v95, v102, v103
    ds_read_b64_tr_b16 v[36:37], v24
    ds_read_b64_tr_b16 v[38:39], v24 offset:2048
    s_waitcnt lgkmcnt(11)
    v_mfma_f32_32x32x16_bf16 v[136:151], v[44:47], v[236:239], v[136:151]
    ds_write_b128 v0, v[92:95] offset:1024
    ds_read_b64_tr_b16 v[40:41], v25
    ds_read_b64_tr_b16 v[42:43], v25 offset:2048
    s_waitcnt lgkmcnt(11)
    v_mfma_f32_32x32x16_bf16 v[120:135], v[48:51], v[240:243], v[120:135]
    v_cvt_pk_bf16_f32 v104, v104, v105
    ds_read_b64_tr_b16 v[44:45], v24 offset:1024
    ds_read_b64_tr_b16 v[46:47], v24 offset:3072
    s_waitcnt lgkmcnt(11)
    v_mfma_f32_32x32x16_bf16 v[136:151], v[52:55], v[240:243], v[136:151]
    v_cvt_pk_bf16_f32 v105, v106, v107
    ds_read_b64_tr_b16 v[48:49], v25 offset:1024
    ds_read_b64_tr_b16 v[50:51], v25 offset:3072
    s_waitcnt lgkmcnt(11)
    v_mfma_f32_32x32x16_bf16 v[120:135], v[28:31], v[244:247], v[120:135]
    v_cvt_pk_bf16_f32 v106, v108, v109
    ds_read_b64_tr_b16 v[52:53], v24 offset:4096
    ds_read_b64_tr_b16 v[54:55], v24 offset:6144
    s_waitcnt lgkmcnt(11)
    v_mfma_f32_32x32x16_bf16 v[136:151], v[32:35], v[244:247], v[136:151]
    v_cvt_pk_bf16_f32 v107, v110, v111
    ds_read_b64_tr_b16 v[28:29], v25 offset:4096
    ds_read_b64_tr_b16 v[30:31], v25 offset:6144
    s_waitcnt lgkmcnt(11)
    v_mfma_f32_32x32x16_bf16 v[120:135], v[36:39], v[152:155], v[120:135]
    ds_write_b128 v0, v[104:107] offset:8192
    ds_read_b64_tr_b16 v[32:33], v24 offset:5120
    ds_read_b64_tr_b16 v[34:35], v24 offset:7168
    s_waitcnt lgkmcnt(11)
    v_mfma_f32_32x32x16_bf16 v[136:151], v[40:43], v[152:155], v[136:151]
    v_cvt_pk_bf16_f32 v108, v112, v113
    ds_read_b64_tr_b16 v[36:37], v25 offset:5120
    ds_read_b64_tr_b16 v[38:39], v25 offset:7168
    s_waitcnt lgkmcnt(11)
    v_mfma_f32_32x32x16_bf16 v[120:135], v[44:47], v[156:159], v[120:135]
    v_cvt_pk_bf16_f32 v109, v114, v115
    ds_read_b64_tr_b16 v[40:41], v24 offset:8192
    ds_read_b64_tr_b16 v[42:43], v24 offset:10240
    s_waitcnt lgkmcnt(11)
    v_mfma_f32_32x32x16_bf16 v[136:151], v[48:51], v[156:159], v[136:151]
    v_cvt_pk_bf16_f32 v110, v116, v117
    ds_read_b64_tr_b16 v[44:45], v25 offset:8192
    ds_read_b64_tr_b16 v[46:47], v25 offset:10240
    s_waitcnt lgkmcnt(11)
    v_mfma_f32_32x32x16_bf16 v[120:135], v[52:55], v[160:163], v[120:135]
    v_cvt_pk_bf16_f32 v111, v118, v119
    ds_read_b64_tr_b16 v[48:49], v24 offset:9216
    ds_read_b64_tr_b16 v[50:51], v24 offset:11264
    s_waitcnt lgkmcnt(11)
    v_mfma_f32_32x32x16_bf16 v[136:151], v[28:31], v[160:163], v[136:151]
    ds_write_b128 v0, v[108:111] offset:9216
    ds_read_b64_tr_b16 v[52:53], v25 offset:9216
    ds_read_b64_tr_b16 v[54:55], v25 offset:11264
    s_waitcnt lgkmcnt(11)
    v_mfma_f32_32x32x16_bf16 v[120:135], v[32:35], v[164:167], v[120:135]
    v_and_b32 v85, 1, v1
    ds_read_b64_tr_b16 v[28:29], v24 offset:12288
    ds_read_b64_tr_b16 v[30:31], v24 offset:14336
    s_waitcnt lgkmcnt(11)
    v_mfma_f32_32x32x16_bf16 v[136:151], v[36:39], v[164:167], v[136:151]
    v_lshlrev_b32 v85, 3, v85
    ds_read_b64_tr_b16 v[32:33], v25 offset:12288
    ds_read_b64_tr_b16 v[34:35], v25 offset:14336
    s_waitcnt lgkmcnt(11)
    v_mfma_f32_32x32x16_bf16 v[120:135], v[40:43], v[168:171], v[120:135]
    v_bfe_u32 v84, v1, 2, 2
    ds_read_b64_tr_b16 v[36:37], v24 offset:13312
    ds_read_b64_tr_b16 v[38:39], v24 offset:15360
    s_waitcnt lgkmcnt(11)
    v_mfma_f32_32x32x16_bf16 v[136:151], v[44:47], v[168:171], v[136:151]
    v_lshl_add_u32 v85, v84, 4, v85
    ds_read_b64_tr_b16 v[40:41], v25 offset:13312
    ds_read_b64_tr_b16 v[42:43], v25 offset:15360
    s_waitcnt lgkmcnt(11)
    v_mfma_f32_32x32x16_bf16 v[120:135], v[48:51], v[172:175], v[120:135]
    v_bfe_u32 v84, v1, 4, 1
    ds_read_b64_tr_b16 v[44:45], v24 offset:16384
    ds_read_b64_tr_b16 v[46:47], v24 offset:18432
    s_waitcnt lgkmcnt(10)
    v_mfma_f32_32x32x16_bf16 v[136:151], v[52:55], v[172:175], v[136:151]
    v_lshl_add_u32 v85, v84, 6, v85
    ds_read_b64_tr_b16 v[48:49], v25 offset:16384
    ds_read_b64_tr_b16 v[50:51], v25 offset:18432
    s_waitcnt lgkmcnt(10)
    v_mfma_f32_32x32x16_bf16 v[120:135], v[28:31], v[176:179], v[120:135]
    v_bfe_u32 v84, v1, 1, 1
    ds_read_b64_tr_b16 v[52:53], v24 offset:17408
    ds_read_b64_tr_b16 v[54:55], v24 offset:19456
    s_waitcnt lgkmcnt(10)
    v_mfma_f32_32x32x16_bf16 v[136:151], v[32:35], v[176:179], v[136:151]
    v_lshl_add_u32 v85, v84, 7, v85
    ds_read_b64_tr_b16 v[28:29], v25 offset:17408
    ds_read_b64_tr_b16 v[30:31], v25 offset:19456
    s_waitcnt lgkmcnt(10)
    v_mfma_f32_32x32x16_bf16 v[120:135], v[36:39], v[180:183], v[120:135]
    v_lshrrev_b32 v84, 5, v1
    ds_read_b64_tr_b16 v[32:33], v24 offset:20480
    ds_read_b64_tr_b16 v[34:35], v24 offset:22528
    s_waitcnt lgkmcnt(10)
    v_mfma_f32_32x32x16_bf16 v[136:151], v[40:43], v[180:183], v[136:151]
    v_lshl_add_u32 v85, v84, 8, v85
    ds_read_b64_tr_b16 v[36:37], v25 offset:20480
    ds_read_b64_tr_b16 v[38:39], v25 offset:22528
    s_waitcnt lgkmcnt(10)
    v_mfma_f32_32x32x16_bf16 v[120:135], v[44:47], v[184:187], v[120:135]
    s_lshl_b32 s13, s3, 12
    v_add_u32 v84, s13, v85
    ds_read_b64_tr_b16 v[40:41], v24 offset:21504
    ds_read_b64_tr_b16 v[42:43], v24 offset:23552
    s_waitcnt lgkmcnt(10)
    v_mfma_f32_32x32x16_bf16 v[136:151], v[48:51], v[184:187], v[136:151]
    s_lshl_b32 s96, s76, 13
    s_add_u32 s13, s96, 32768
    v_add_u32 v85, s13, v85
    ds_read_b64_tr_b16 v[44:45], v25 offset:21504
    ds_read_b64_tr_b16 v[46:47], v25 offset:23552
    s_waitcnt lgkmcnt(10)
    v_mfma_f32_32x32x16_bf16 v[120:135], v[52:55], v[188:191], v[120:135]
    v_mov_b32 v80, 0x3f803f80
    ds_read_b64_tr_b16 v[48:49], v24 offset:24576
    ds_read_b64_tr_b16 v[50:51], v24 offset:26624
    s_waitcnt lgkmcnt(10)
    v_mfma_f32_32x32x16_bf16 v[136:151], v[28:31], v[188:191], v[136:151]
    v_mov_b32 v81, 0x3f803f80
    ds_read_b64_tr_b16 v[52:53], v25 offset:24576
    ds_read_b64_tr_b16 v[54:55], v25 offset:26624
    s_waitcnt lgkmcnt(10)
    v_mfma_f32_32x32x16_bf16 v[120:135], v[32:35], v[192:195], v[120:135]
    v_mov_b32 v82, 0x3f803f80
    ds_read_b64_tr_b16 v[28:29], v24 offset:25600
    ds_read_b64_tr_b16 v[30:31], v24 offset:27648
    s_waitcnt lgkmcnt(10)
    v_mfma_f32_32x32x16_bf16 v[136:151], v[36:39], v[192:195], v[136:151]
    v_mov_b32 v83, 0x3f803f80
    ds_read_b64_tr_b16 v[32:33], v25 offset:25600
    ds_read_b64_tr_b16 v[34:35], v25 offset:27648
    s_waitcnt lgkmcnt(10)
    v_mfma_f32_32x32x16_bf16 v[120:135], v[40:43], v[196:199], v[120:135]
    s_lshl3_add_u32 s96, s11, s3
    s_lshl_b32 s97, s96, 5
    s_add_u32 s98, s97, s10
    s_lshl_b32 s99, s98, 10
    s_add_u32 s13, s99, 25165824
    s_add_u32 s15, s13, 16384
    s_lshl3_add_u32 s96, s11, s3
    s_lshl_b32 s97, s96, 10
    s_add_u32 s16, s97, 21495808
    s_lshl_b32 s96, s10, 6
    s_add_u32 s14, s96, s16
    ds_read_b64_tr_b16 v[36:37], v24 offset:28672
    ds_read_b64_tr_b16 v[38:39], v24 offset:30720
    s_waitcnt lgkmcnt(10)
    v_mfma_f32_32x32x16_bf16 v[136:151], v[44:47], v[196:199], v[136:151]
    ds_read_b64_tr_b16 v[40:41], v25 offset:28672
    ds_read_b64_tr_b16 v[42:43], v25 offset:30720
    s_waitcnt lgkmcnt(10)
    v_mfma_f32_32x32x16_bf16 v[120:135], v[48:51], v[200:203], v[120:135]
    ds_read_b64_tr_b16 v[44:45], v25 offset:29696
    ds_read_b64_tr_b16 v[46:47], v25 offset:31744
    s_waitcnt lgkmcnt(10)
    v_mfma_f32_32x32x16_bf16 v[136:151], v[52:55], v[200:203], v[136:151]
    ds_read_b64_tr_b16 v[48:49], v24 offset:29696
    ds_read_b64_tr_b16 v[50:51], v24 offset:31744
    s_waitcnt lgkmcnt(10)
    v_mfma_f32_32x32x16_bf16 v[120:135], v[28:31], v[204:207], v[120:135]
    s_waitcnt lgkmcnt(8)
    v_mfma_f32_32x32x16_bf16 v[136:151], v[32:35], v[204:207], v[136:151]
    s_waitcnt lgkmcnt(6)
    v_mfma_f32_32x32x16_bf16 v[120:135], v[36:39], v[208:211], v[120:135]
    s_waitcnt lgkmcnt(4)
    v_mfma_f32_32x32x16_bf16 v[136:151], v[40:43], v[208:211], v[136:151]
    s_waitcnt lgkmcnt(2)
    v_mfma_f32_32x32x16_bf16 v[136:151], v[44:47], v[212:215], v[136:151]
    s_waitcnt lgkmcnt(0)
    v_mfma_f32_32x32x16_bf16 v[120:135], v[48:51], v[212:215], v[120:135]
    s_lshl_b32 s96, s77, 11
    s_add_u32 s17, s96, 151552
    v_add_u32 v0, s17, v2
    v_bfe_u32 v4, v1, 2, 2
    v_lshlrev_b32 v4, 6, v4
    v_bfe_u32 v9, v1, 4, 1
    v_lshl_add_u32 v4, v9, 5, v4
    v_and_b32 v9, 3, v1
    v_lshl_add_u32 v4, v9, 3, v4
    v_lshrrev_b32 v9, 5, v1
    v_lshl_add_u32 v4, v9, 8, v4
    v_add_u32 v4, 159744, v4
    ds_read_b64_tr_b16 v[176:177], v4
    ds_read_b64_tr_b16 v[178:179], v4 offset:512
    ds_read_b64_tr_b16 v[180:181], v4 offset:1024
    ds_read_b64_tr_b16 v[182:183], v4 offset:1536
    v_cvt_pk_bf16_f32 v152, v136, v137
    v_cvt_pk_bf16_f32 v153, v138, v139
    v_cvt_pk_bf16_f32 v154, v140, v141
    v_cvt_pk_bf16_f32 v155, v142, v143
    v_cvt_pk_bf16_f32 v156, v144, v145
    v_cvt_pk_bf16_f32 v157, v146, v147
    v_cvt_pk_bf16_f32 v158, v148, v149
    v_cvt_pk_bf16_f32 v159, v150, v151
    ds_write_b128 v0, v[152:155]
    ds_write_b128 v0, v[156:159] offset:1024
    v_cvt_pk_bf16_f32 v168, v120, v121
    v_cvt_pk_bf16_f32 v169, v122, v123
    v_cvt_pk_bf16_f32 v170, v124, v125
    v_cvt_pk_bf16_f32 v171, v126, v127
    v_cvt_pk_bf16_f32 v172, v128, v129
    v_cvt_pk_bf16_f32 v173, v130, v131
    v_cvt_pk_bf16_f32 v174, v132, v133
    v_cvt_pk_bf16_f32 v175, v134, v135
    s_setprio 0
    s_branch L_JOIN
L_HELP:
    s_waitcnt vmcnt(0)
    s_barrier
    s_add_u32 s96, s84, 4
    s_and_b32 s97, s96, 15
    s_mul_i32 s98, s97, 393216
    s_add_u32 s99, s98, s85
    s_add_u32 s82, s99, 4294772736
    s_add_u32 m0, s83, 28672
    s_nop 0
    buffer_load_dwordx4 v3, s[40:43], s82 offen lds
    s_add_u32 s96, s84, 4
    s_and_b32 s97, s96, 15
    s_mul_i32 s98, s97, 393216
    s_add_u32 s99, s98, s85
    s_add_u32 s82, s99, 2048
    s_add_u32 m0, s83, 32768
    s_nop 0
    buffer_load_dwordx4 v3, s[40:43], s82 offen lds
    s_add_u32 s96, s84, 4
    s_and_b32 s97, s96, 15
    s_mul_i32 s98, s97, 393216
    s_add_u32 s99, s98, s85
    s_add_u32 s82, s99, 4294774784
    s_add_u32 m0, s83, 77824
    s_nop 0
    buffer_load_dwordx4 v3, s[40:43], s82 offen lds
    s_add_u32 s96, s84, 4
    s_and_b32 s97, s96, 15
    s_mul_i32 s98, s97, 393216
    s_add_u32 s99, s98, s85
    s_add_u32 s82, s99, 4096
    s_add_u32 m0, s83, 81920
    s_nop 0
    buffer_load_dwordx4 v3, s[40:43], s82 offen lds
    s_add_u32 s96, s84, 4
    s_and_b32 s97, s96, 15
    s_mul_i32 s98, s97, 393216
    s_add_u32 s99, s98, s85
    s_add_u32 s82, s99, 4294770688
    s_add_u32 m0, s83, 126976
    s_nop 0
    buffer_load_dwordx4 v3, s[40:43], s82 offen lds
    s_add_u32 s96, s84, 4
    s_and_b32 s97, s96, 15
    s_mul_i32 s98, s97, 393216
    s_add_u32 s82, s98, s85
    s_add_u32 m0, s83, 131072
    s_nop 0
    buffer_load_dwordx4 v3, s[40:43], s82 offen lds
    s_add_u32 s96, s84, 5
    s_and_b32 s97, s96, 15
    s_mul_i32 s98, s97, 393216
    s_add_u32 s99, s98, s85
    s_add_u32 s82, s99, 4294772736
    s_add_u32 m0, s83, 36864
    s_nop 0
    buffer_load_dwordx4 v3, s[40:43], s82 offen lds
    s_add_u32 s96, s84, 5
    s_and_b32 s97, s96, 15
    s_mul_i32 s98, s97, 393216
    s_add_u32 s99, s98, s85
    s_add_u32 s82, s99, 2048
    s_add_u32 m0, s83, 40960
    s_nop 0
    buffer_load_dwordx4 v3, s[40:43], s82 offen lds
    s_add_u32 s96, s84, 5
    s_and_b32 s97, s96, 15
    s_mul_i32 s98, s97, 393216
    s_add_u32 s99, s98, s85
    s_add_u32 s82, s99, 4294774784
    s_add_u32 m0, s83, 86016
    s_nop 0
    buffer_load_dwordx4 v3, s[40:43], s82 offen lds
    s_add_u32 s96, s84, 5
    s_and_b32 s97, s96, 15
    s_mul_i32 s98, s97, 393216
    s_add_u32 s99, s98, s85
    s_add_u32 s82, s99, 4096
    s_add_u32 m0, s83, 90112
    s_nop 0
    buffer_load_dwordx4 v3, s[40:43], s82 offen lds
    s_add_u32 s96, s84, 5
    s_and_b32 s97, s96, 15
    s_mul_i32 s98, s97, 393216
    s_add_u32 s99, s98, s85
    s_add_u32 s82, s99, 4294770688
    s_add_u32 m0, s83, 135168
    s_nop 0
    buffer_load_dwordx4 v3, s[40:43], s82 offen lds
    s_add_u32 s96, s84, 5
    s_and_b32 s97, s96, 15
    s_mul_i32 s98, s97, 393216
    s_add_u32 s82, s98, s85
    s_add_u32 m0, s83, 139264
    s_nop 0
    buffer_load_dwordx4 v3, s[40:43], s82 offen lds
    s_waitcnt lgkmcnt(0)
SPOLL_16:
    s_load_dwordx2 s[24:25], s[32:33], s19 offset:0 glc
    s_load_dwordx2 s[26:27], s[32:33], s19 offset:64 glc
SCHK_17:
    s_add_u32 s5, s5, 1
    s_cmp_ge_u32 s5, 200000
    s_waitcnt lgkmcnt(0)
    s_cbranch_scc1 SDONE_18
    s_cmp_lg_u32 s24, s4
    s_cbranch_scc1 SPOLL_16
    s_cmp_lg_u32 s25, s4
    s_cbranch_scc1 SPOLL_16
    s_cmp_lg_u32 s26, s4
    s_cbranch_scc1 SPOLL_16
    s_cmp_lg_u32 s27, s4
    s_cbranch_scc1 SPOLL_16
SDONE_18:
    v_bfe_u32 v4, v1, 2, 2
    v_lshlrev_b32 v4, 6, v4
    v_bfe_u32 v9, v1, 4, 1
    v_lshl_add_u32 v4, v9, 5, v4
    v_and_b32 v9, 3, v1
    v_lshl_add_u32 v4, v9, 3, v4
    v_lshrrev_b32 v9, 5, v1
    v_lshl_add_u32 v4, v9, 8, v4
    v_add_u32 v4, 159744, v4
    ds_read_b64_tr_b16 v[168:169], v4
    ds_read_b64_tr_b16 v[170:171], v4 offset:512
    ds_read_b64_tr_b16 v[172:173], v4 offset:1024
    ds_read_b64_tr_b16 v[174:175], v4 offset:1536
    ds_read_b64_tr_b16 v[176:177], v4 offset:2048
    ds_read_b64_tr_b16 v[178:179], v4 offset:2560
    ds_read_b64_tr_b16 v[180:181], v4 offset:3072
    ds_read_b64_tr_b16 v[182:183], v4 offset:3584
    s_lshl_b32 s14, s77, 10
    v_and_b32 v232, 7, v1
    v_lshl_add_u32 v232, v232, 4, s14
    v_bfe_u32 v9, v1, 3, 2
    v_lshl_add_u32 v232, v9, 8, v232
    v_lshrrev_b32 v9, 5, v1
    v_lshl_add_u32 v232, v9, 7, v232
    s_and_b32 s96, s9, 1
    s_lshl1_add_u32 s18, s96, 1
    s_and_b32 s96, s8, 3
    s_lshl2_add_u32 s97, s96, s3
    s_sub_u32 s98, s97, 4
    s_lshl_b32 s82, s98, 7
    v_lshrrev_b32 v52, 3, v1
    v_lshl_add_u32 v52, v52, 1, s82
    global_load_ushort v36, v52, s[86:87] offset:0
    global_load_ushort v37, v52, s[86:87] offset:16
    global_load_ushort v38, v52, s[86:87] offset:32
    global_load_ushort v39, v52, s[86:87] offset:48
    global_load_ushort v40, v52, s[86:87] offset:64
    global_load_ushort v41, v52, s[86:87] offset:80
    global_load_ushort v42, v52, s[86:87] offset:96
    global_load_ushort v43, v52, s[86:87] offset:112
    s_and_b32 s96, s8, 3
    s_lshl2_add_u32 s97, s96, s3
    s_sub_u32 s98, s97, 4
    s_mul_i32 s99, s98, 786432
    s_lshr_b32 s96, s8, 2
    s_lshl1_add_u32 s97, s9, s96
    s_lshl_b32 s98, s97, 7
    s_add_u32 s96, s99, s98
    s_add_u32 s19, s96, 4096
    s_barrier
    s_add_u32 s96, s84, 6
    s_and_b32 s97, s96, 15
    s_mul_i32 s98, s97, 393216
    s_add_u32 s99, s98, s85
    s_add_u32 s82, s99, 4294772736
    s_add_u32 m0, s83, 4294963200
    s_nop 0
    buffer_load_dwordx4 v3, s[40:43], s82 offen lds
    s_add_u32 s96, s84, 6
    s_and_b32 s97, s96, 15
    s_mul_i32 s98, s97, 393216
    s_add_u32 s99, s98, s85
    s_add_u32 s82, s99, 2048
    s_mov_b32 m0, s83
    s_nop 0
    buffer_load_dwordx4 v3, s[40:43], s82 offen lds
    s_add_u32 s96, s84, 6
    s_and_b32 s97, s96, 15
    s_mul_i32 s98, s97, 393216
    s_add_u32 s99, s98, s85
    s_add_u32 s82, s99, 4294770688
    s_add_u32 m0, s83, 94208
    s_nop 0
    buffer_load_dwordx4 v3, s[40:43], s82 offen lds
    s_add_u32 s96, s84, 6
    s_and_b32 s97, s96, 15
    s_mul_i32 s98, s97, 393216
    s_add_u32 s82, s98, s85
    s_add_u32 m0, s83, 98304
    s_nop 0
    buffer_load_dwordx4 v3, s[40:43], s82 offen lds
    s_add_u32 s96, s84, 6
    s_and_b32 s97, s96, 15
    s_mul_i32 s98, s97, 393216
    s_add_u32 s99, s98, s85
    s_add_u32 s82, s99, 4294774784
    s_add_u32 m0, s83, 45056
    s_nop 0
    buffer_load_dwordx4 v3, s[40:43], s82 offen lds
    s_add_u32 s96, s84, 6
    s_and_b32 s97, s96, 15
    s_mul_i32 s98, s97, 393216
    s_add_u32 s99, s98, s85
    s_add_u32 s82, s99, 4096
    s_add_u32 m0, s83, 49152
    s_nop 0
    buffer_load_dwordx4 v3, s[40:43], s82 offen lds
    s_waitcnt lgkmcnt(0)
    s_load_dword s24, s[32:33], s92 offset:512 glc
    s_load_dword s25, s[32:33], s92 offset:256 glc
    s_load_dword s26, s[32:33], s92 offset:3584 glc
    s_load_dword s27, s[32:33], s92 offset:3328 glc
    s_barrier
    s_add_u32 s96, s84, 7
    s_and_b32 s97, s96, 15
    s_mul_i32 s98, s97, 393216
    s_add_u32 s99, s98, s85
    s_add_u32 s82, s99, 4294772736
    s_add_u32 m0, s83, 4096
    s_nop 0
    buffer_load_dwordx4 v3, s[40:43], s82 offen lds
    s_add_u32 s96, s84, 7
    s_and_b32 s97, s96, 15
    s_mul_i32 s98, s97, 393216
    s_add_u32 s99, s98, s85
    s_add_u32 s82, s99, 2048
    s_add_u32 m0, s83, 8192
    s_nop 0
    buffer_load_dwordx4 v3, s[40:43], s82 offen lds
    s_add_u32 s96, s84, 7
    s_and_b32 s97, s96, 15
    s_mul_i32 s98, s97, 393216
    s_add_u32 s99, s98, s85
    s_add_u32 s82, s99, 4294770688
    s_add_u32 m0, s83, 102400
    s_nop 0
    buffer_load_dwordx4 v3, s[40:43], s82 offen lds
    s_add_u32 s96, s84, 7
    s_and_b32 s97, s96, 15
    s_mul_i32 s98, s97, 393216
    s_add_u32 s82, s98, s85
    s_add_u32 m0, s83, 106496
    s_nop 0
    buffer_load_dwordx4 v3, s[40:43], s82 offen lds
    s_add_u32 s96, s84, 7
    s_and_b32 s97, s96, 15
    s_mul_i32 s98, s97, 393216
    s_add_u32 s99, s98, s85
    s_add_u32 s82, s99, 4294774784
    s_add_u32 m0, s83, 53248
    s_nop 0
    buffer_load_dwordx4 v3, s[40:43], s82 offen lds
    s_add_u32 s96, s84, 7
    s_and_b32 s97, s96, 15
    s_mul_i32 s98, s97, 393216
    s_add_u32 s99, s98, s85
    s_add_u32 s82, s99, 4096
    s_add_u32 m0, s83, 57344
    s_nop 0
    buffer_load_dwordx4 v3, s[40:43], s82 offen lds
    s_waitcnt vmcnt(30)
    s_waitcnt vmcnt(26)
    s_barrier
    s_add_u32 s96, s84, 8
    s_and_b32 s97, s96, 15
    s_mul_i32 s98, s97, 393216
    s_add_u32 s99, s98, s85
    s_add_u32 s82, s99, 4294772736
    s_add_u32 m0, s83, 12288
    s_nop 0
    buffer_load_dwordx4 v3, s[40:43], s82 offen lds
    s_add_u32 s96, s84, 8
    s_and_b32 s97, s96, 15
    s_mul_i32 s98, s97, 393216
    s_add_u32 s99, s98, s85
    s_add_u32 s82, s99, 2048
    s_add_u32 m0, s83, 16384
    s_nop 0
    buffer_load_dwordx4 v3, s[40:43], s82 offen lds
    s_add_u32 s96, s84, 8
    s_and_b32 s97, s96, 15
    s_mul_i32 s98, s97, 393216
    s_add_u32 s99, s98, s85
    s_add_u32 s82, s99, 4294770688
    s_add_u32 m0, s83, 110592
    s_nop 0
    buffer_load_dwordx4 v3, s[40:43], s82 offen lds
    s_add_u32 s96, s84, 8
    s_and_b32 s97, s96, 15
    s_mul_i32 s98, s97, 393216
    s_add_u32 s82, s98, s85
    s_add_u32 m0, s83, 114688
    s_nop 0
    buffer_load_dwordx4 v3, s[40:43], s82 offen lds
    s_add_u32 s96, s84, 8
    s_and_b32 s97, s96, 15
    s_mul_i32 s98, s97, 393216
    s_add_u32 s99, s98, s85
    s_add_u32 s82, s99, 4294774784
    s_add_u32 m0, s83, 61440
    s_nop 0
    buffer_load_dwordx4 v3, s[40:43], s82 offen lds
    s_add_u32 s96, s84, 8
    s_and_b32 s97, s96, 15
    s_mul_i32 s98, s97, 393216
    s_add_u32 s99, s98, s85
    s_add_u32 s82, s99, 4096
    s_add_u32 m0, s83, 65536
    s_nop 0
    buffer_load_dwordx4 v3, s[40:43], s82 offen lds
    s_waitcnt vmcnt(18)
    v_lshlrev_b32 v36, 16, v36
    v_mul_f32 v52, s7, v36
    v_exp_f32 v52, -v52
    s_nop 0
    v_add_f32 v52, 1.0, v52
    v_rcp_f32 v52, v52
    s_nop 0
    v_mul_f32 v36, v36, v52
    v_cvt_pk_bf16_f32 v36, 0, v36
    v_lshlrev_b32 v37, 16, v37
    v_mul_f32 v53, s7, v37
    v_exp_f32 v53, -v53
    s_nop 0
    v_add_f32 v53, 1.0, v53
    v_rcp_f32 v53, v53
    s_nop 0
    v_mul_f32 v37, v37, v53
    v_cvt_pk_bf16_f32 v37, 0, v37
    v_lshlrev_b32 v38, 16, v38
    v_mul_f32 v52, s7, v38
    v_exp_f32 v52, -v52
    s_nop 0
    v_add_f32 v52, 1.0, v52
    v_rcp_f32 v52, v52
    s_nop 0
    v_mul_f32 v38, v38, v52
    v_cvt_pk_bf16_f32 v38, 0, v38
    v_lshlrev_b32 v39, 16, v39
    v_mul_f32 v53, s7, v39
    v_exp_f32 v53, -v53
    s_nop 0
    v_add_f32 v53, 1.0, v53
    v_rcp_f32 v53, v53
    s_nop 0
    v_mul_f32 v39, v39, v53
    v_cvt_pk_bf16_f32 v39, 0, v39
    v_lshlrev_b32 v40, 16, v40
    v_mul_f32 v52, s7, v40
    v_exp_f32 v52, -v52
    s_nop 0
    v_add_f32 v52, 1.0, v52
    v_rcp_f32 v52, v52
    s_nop 0
    v_mul_f32 v40, v40, v52
    v_cvt_pk_bf16_f32 v40, 0, v40
    v_lshlrev_b32 v41, 16, v41
    v_mul_f32 v53, s7, v41
    v_exp_f32 v53, -v53
    s_nop 0
    v_add_f32 v53, 1.0, v53
    v_rcp_f32 v53, v53
    s_nop 0
    v_mul_f32 v41, v41, v53
    v_cvt_pk_bf16_f32 v41, 0, v41
    v_lshlrev_b32 v42, 16, v42
    v_mul_f32 v52, s7, v42
    v_exp_f32 v52, -v52
    s_nop 0
    v_add_f32 v52, 1.0, v52
    v_rcp_f32 v52, v52
    s_nop 0
    v_mul_f32 v42, v42, v52
    v_cvt_pk_bf16_f32 v42, 0, v42
    v_lshlrev_b32 v43, 16, v43
    v_mul_f32 v53, s7, v43
    v_exp_f32 v53, -v53
    s_nop 0
    v_add_f32 v53, 1.0, v53
    v_rcp_f32 v53, v53
    s_nop 0
    v_mul_f32 v43, v43, v53
    v_cvt_pk_bf16_f32 v43, 0, v43
    s_waitcnt lgkmcnt(0)
    s_load_dword s24, s[32:33], s92 offset:1024 glc
    s_load_dword s25, s[32:33], s92 offset:768 glc
    s_load_dword s26, s[32:33], s92 offset:1536 glc
    s_load_dword s27, s[32:33], s92 offset:1280 glc
    s_barrier
    s_add_u32 s96, s84, 9
    s_and_b32 s97, s96, 15
    s_mul_i32 s98, s97, 393216
    s_add_u32 s99, s98, s85
    s_add_u32 s82, s99, 4294772736
    s_add_u32 m0, s83, 20480
    s_nop 0
    buffer_load_dwordx4 v3, s[40:43], s82 offen lds
    s_add_u32 s96, s84, 9
    s_and_b32 s97, s96, 15
    s_mul_i32 s98, s97, 393216
    s_add_u32 s99, s98, s85
    s_add_u32 s82, s99, 2048
    s_add_u32 m0, s83, 24576
    s_nop 0
    buffer_load_dwordx4 v3, s[40:43], s82 offen lds
L_PAD5:
    s_cbranch_execz L_RET5
    s_add_u32 s96, s84, 9
    s_and_b32 s97, s96, 15
    s_mul_i32 s98, s97, 393216
    s_add_u32 s99, s98, s85
    s_add_u32 s82, s99, 4294770688
    s_add_u32 m0, s83, 118784
    s_nop 0
    buffer_load_dwordx4 v3, s[40:43], s82 offen lds
    s_add_u32 s96, s84, 9
    s_and_b32 s97, s96, 15
    s_mul_i32 s98, s97, 393216
    s_add_u32 s82, s98, s85
    s_add_u32 m0, s83, 122880
    s_nop 0
    buffer_load_dwordx4 v3, s[40:43], s82 offen lds
    s_add_u32 s96, s84, 9
    s_and_b32 s97, s96, 15
    s_mul_i32 s98, s97, 393216
    s_add_u32 s99, s98, s85
    s_add_u32 s82, s99, 4294774784
    s_add_u32 m0, s83, 69632
    s_nop 0
    buffer_load_dwordx4 v3, s[40:43], s82 offen lds
    s_add_u32 s96, s84, 9
    s_and_b32 s97, s96, 15
    s_mul_i32 s98, s97, 393216
    s_add_u32 s99, s98, s85
    s_add_u32 s82, s99, 4096
    s_add_u32 m0, s83, 73728
    s_nop 0
    buffer_load_dwordx4 v3, s[40:43], s82 offen lds
    s_waitcnt vmcnt(22)
    s_waitcnt vmcnt(20)
    s_waitcnt vmcnt(18)
    s_barrier
    s_add_u32 s96, s84, 10
    s_and_b32 s97, s96, 15
    s_mul_i32 s98, s97, 393216
    s_add_u32 s99, s98, s85
    s_add_u32 s82, s99, 4294772736
    s_add_u32 m0, s83, 28672
    s_nop 0
    buffer_load_dwordx4 v3, s[40:43], s82 offen lds
    s_add_u32 s96, s84, 10
    s_and_b32 s97, s96, 15
    s_mul_i32 s98, s97, 393216
    s_add_u32 s99, s98, s85
    s_add_u32 s82, s99, 2048
    s_add_u32 m0, s83, 32768
    s_nop 0
    buffer_load_dwordx4 v3, s[40:43], s82 offen lds
    s_add_u32 s96, s84, 10
    s_and_b32 s97, s96, 15
    s_mul_i32 s98, s97, 393216
    s_add_u32 s99, s98, s85
    s_add_u32 s82, s99, 4294774784
    s_add_u32 m0, s83, 77824
    s_nop 0
    buffer_load_dwordx4 v3, s[40:43], s82 offen lds
    s_add_u32 s96, s84, 10
    s_and_b32 s97, s96, 15
    s_mul_i32 s98, s97, 393216
    s_add_u32 s99, s98, s85
    s_add_u32 s82, s99, 4096
    s_add_u32 m0, s83, 81920
    s_nop 0
    buffer_load_dwordx4 v3, s[40:43], s82 offen lds
    s_waitcnt lgkmcnt(0)
    s_load_dword s24, s[32:33], s92 offset:2560 glc
    s_load_dword s25, s[32:33], s92 offset:2304 glc
    s_load_dword s26, s[32:33], s92 offset:3072 glc
    s_load_dword s27, s[32:33], s92 offset:2816 glc
    s_waitcnt vmcnt(20)
    s_waitcnt vmcnt(18)
    s_waitcnt vmcnt(16)
    s_barrier
    s_add_u32 s96, s84, 11
    s_and_b32 s97, s96, 15
    s_mul_i32 s98, s97, 393216
    s_add_u32 s99, s98, s85
    s_add_u32 s82, s99, 4294772736
    s_add_u32 m0, s83, 36864
    s_nop 0
    buffer_load_dwordx4 v3, s[40:43], s82 offen lds
    s_add_u32 s96, s84, 11
    s_and_b32 s97, s96, 15
    s_mul_i32 s98, s97, 393216
    s_add_u32 s99, s98, s85
    s_add_u32 s82, s99, 2048
    s_add_u32 m0, s83, 40960
    s_nop 0
    buffer_load_dwordx4 v3, s[40:43], s82 offen lds
    s_add_u32 s96, s84, 11
    s_and_b32 s97, s96, 15
    s_mul_i32 s98, s97, 393216
    s_add_u32 s99, s98, s85
    s_add_u32 s82, s99, 4294774784
    s_add_u32 m0, s83, 86016
    s_nop 0
    buffer_load_dwordx4 v3, s[40:43], s82 offen lds
    s_add_u32 s96, s84, 11
    s_and_b32 s97, s96, 15
    s_mul_i32 s98, s97, 393216
    s_add_u32 s99, s98, s85
    s_add_u32 s82, s99, 4096
    s_add_u32 m0, s83, 90112
    s_nop 0
    buffer_load_dwordx4 v3, s[40:43], s82 offen lds
    s_waitcnt vmcnt(18)
    s_waitcnt vmcnt(16)
    s_waitcnt vmcnt(14)
    s_barrier
    s_add_u32 s96, s84, 12
    s_and_b32 s97, s96, 15
    s_mul_i32 s98, s97, 393216
    s_add_u32 s99, s98, s85
    s_add_u32 s82, s99, 4294772736
    s_add_u32 m0, s83, 4294963200
    s_nop 0
    buffer_load_dwordx4 v3, s[40:43], s82 offen lds
    s_add_u32 s96, s84, 12
    s_and_b32 s97, s96, 15
    s_mul_i32 s98, s97, 393216
    s_add_u32 s99, s98, s85
    s_add_u32 s82, s99, 2048
    s_mov_b32 m0, s83
    s_nop 0
    buffer_load_dwordx4 v3, s[40:43], s82 offen lds
    s_add_u32 s96, s84, 12
    s_and_b32 s97, s96, 15
    s_mul_i32 s98, s97, 393216
    s_add_u32 s99, s98, s85
    s_add_u32 s82, s99, 4294774784
    s_add_u32 m0, s83, 45056
    s_nop 0
    buffer_load_dwordx4 v3, s[40:43], s82 offen lds
    s_add_u32 s96, s84, 12
    s_and_b32 s97, s96, 15
    s_mul_i32 s98, s97, 393216
    s_add_u32 s99, s98, s85
    s_add_u32 s82, s99, 4096
    s_add_u32 m0, s83, 49152
    s_nop 0
    buffer_load_dwordx4 v3, s[40:43], s82 offen lds
    s_waitcnt vmcnt(16)
    s_barrier
    s_add_u32 s96, s84, 13
    s_and_b32 s97, s96, 15
    s_mul_i32 s98, s97, 393216
    s_add_u32 s99, s98, s85
    s_add_u32 s82, s99, 4294772736
    s_add_u32 m0, s83, 4096
    s_nop 0
    buffer_load_dwordx4 v3, s[40:43], s82 offen lds
    s_add_u32 s96, s84, 13
    s_and_b32 s97, s96, 15
    s_mul_i32 s98, s97, 393216
    s_add_u32 s99, s98, s85
    s_add_u32 s82, s99, 2048
    s_add_u32 m0, s83, 8192
    s_nop 0
    buffer_load_dwordx4 v3, s[40:43], s82 offen lds
    s_add_u32 s96, s84, 13
    s_and_b32 s97, s96, 15
    s_mul_i32 s98, s97, 393216
    s_add_u32 s99, s98, s85
    s_add_u32 s82, s99, 4294774784
    s_add_u32 m0, s83, 53248
    s_nop 0
    buffer_load_dwordx4 v3, s[40:43], s82 offen lds
    s_add_u32 s96, s84, 13
    s_and_b32 s97, s96, 15
    s_mul_i32 s98, s97, 393216
    s_add_u32 s99, s98, s85
    s_add_u32 s82, s99, 4096
    s_add_u32 m0, s83, 57344
    s_nop 0
    buffer_load_dwordx4 v3, s[40:43], s82 offen lds
    s_lshl_b32 s96, s74, 13
    s_sub_u32 s97, s3, 4
    s_lshl_b32 s98, s97, 8
    s_add_u32 s99, s96, s98
    s_add_u32 s13, s99, 20971520
    s_waitcnt lgkmcnt(0)
    s_load_dword s24, s[32:33], s13 offset:1276 glc
    s_load_dword s25, s[32:33], s13 offset:3324 glc
    s_load_dword s26, s[32:33], s13 offset:5372 glc
    s_load_dword s27, s[32:33], s13 offset:7420 glc
    s_waitcnt vmcnt(18)
    s_waitcnt vmcnt(16)
    s_barrier
    s_add_u32 s96, s84, 14
    s_and_b32 s97, s96, 15
    s_mul_i32 s98, s97, 393216
    s_add_u32 s99, s98, s85
    s_add_u32 s82, s99, 4294772736
    s_add_u32 m0, s83, 12288
    s_nop 0
    buffer_load_dwordx4 v3, s[40:43], s82 offen lds
    s_add_u32 s96, s84, 14
    s_and_b32 s97, s96, 15
    s_mul_i32 s98, s97, 393216
    s_add_u32 s99, s98, s85
    s_add_u32 s82, s99, 2048
    s_add_u32 m0, s83, 16384
    s_nop 0
    buffer_load_dwordx4 v3, s[40:43], s82 offen lds
    s_add_u32 s96, s84, 10
    s_and_b32 s97, s96, 15
    s_mul_i32 s98, s97, 393216
    s_add_u32 s99, s98, s85
    s_add_u32 s82, s99, 4294770688
    s_add_u32 m0, s83, 126976
    s_nop 0
    buffer_load_dwordx4 v3, s[40:43], s82 offen lds
    s_add_u32 s96, s84, 10
    s_and_b32 s97, s96, 15
    s_mul_i32 s98, s97, 393216
    s_add_u32 s82, s98, s85
    s_add_u32 m0, s83, 131072
    s_nop 0
    buffer_load_dwordx4 v3, s[40:43], s82 offen lds
    s_waitcnt vmcnt(18)
    s_waitcnt vmcnt(14)
    s_barrier
    s_add_u32 s96, s84, 15
    s_and_b32 s97, s96, 15
    s_mul_i32 s98, s97, 393216
    s_add_u32 s99, s98, s85
    s_add_u32 s82, s99, 4294772736
    s_add_u32 m0, s83, 20480
    s_nop 0
    buffer_load_dwordx4 v3, s[40:43], s82 offen lds
    s_add_u32 s96, s84, 15
    s_and_b32 s97, s96, 15
    s_mul_i32 s98, s97, 393216
    s_add_u32 s99, s98, s85
    s_add_u32 s82, s99, 2048
    s_add_u32 m0, s83, 24576
    s_nop 0
    buffer_load_dwordx4 v3, s[40:43], s82 offen lds
    s_add_u32 s96, s84, 11
    s_and_b32 s97, s96, 15
    s_mul_i32 s98, s97, 393216
    s_add_u32 s99, s98, s85
    s_add_u32 s82, s99, 4294770688
    s_add_u32 m0, s83, 135168
    s_nop 0
    buffer_load_dwordx4 v3, s[40:43], s82 offen lds
    s_add_u32 s96, s84, 11
    s_and_b32 s97, s96, 15
    s_mul_i32 s98, s97, 393216
    s_add_u32 s82, s98, s85
    s_add_u32 m0, s83, 139264
    s_nop 0
    buffer_load_dwordx4 v3, s[40:43], s82 offen lds
    s_waitcnt vmcnt(14)
    s_waitcnt vmcnt(10)
    s_waitcnt vmcnt(6)
    s_barrier
    s_add_u32 s96, s84, 14
    s_and_b32 s97, s96, 15
    s_mul_i32 s98, s97, 393216
    s_add_u32 s99, s98, s85
    s_add_u32 s82, s99, 4294774784
    s_add_u32 m0, s83, 61440
    s_nop 0
    buffer_load_dwordx4 v3, s[40:43], s82 offen lds
    s_add_u32 s96, s84, 14
    s_and_b32 s97, s96, 15
    s_mul_i32 s98, s97, 393216
    s_add_u32 s99, s98, s85
    s_add_u32 s82, s99, 4096
    s_add_u32 m0, s83, 65536
    s_nop 0
    buffer_load_dwordx4 v3, s[40:43], s82 offen lds
    s_add_u32 s96, s84, 15
    s_and_b32 s97, s96, 15
    s_mul_i32 s98, s97, 393216
    s_add_u32 s99, s98, s85
    s_add_u32 s82, s99, 4294774784
    s_add_u32 m0, s83, 69632
    s_nop 0
    buffer_load_dwordx4 v3, s[40:43], s82 offen lds
    s_add_u32 s96, s84, 15
    s_and_b32 s97, s96, 15
    s_mul_i32 s98, s97, 393216
    s_add_u32 s99, s98, s85
    s_add_u32 s82, s99, 4096
    s_add_u32 m0, s83, 73728
    s_nop 0
    buffer_load_dwordx4 v3, s[40:43], s82 offen lds
    s_add_u32 s96, s84, 12
    s_and_b32 s97, s96, 15
    s_mul_i32 s98, s97, 393216
    s_add_u32 s99, s98, s85
    s_add_u32 s82, s99, 4294770688
    s_add_u32 m0, s83, 94208
    s_nop 0
    buffer_load_dwordx4 v3, s[40:43], s82 offen lds
    s_add_u32 s96, s84, 12
    s_and_b32 s97, s96, 15
    s_mul_i32 s98, s97, 393216
    s_add_u32 s82, s98, s85
    s_add_u32 m0, s83, 98304
    s_nop 0
    buffer_load_dwordx4 v3, s[40:43], s82 offen lds
    s_mov_b32 s82, s19
    buffer_load_dwordx4 v[88:91], v248, s[48:51], s82 offen nt
    s_add_u32 s82, s19, 98304
    buffer_load_dwordx4 v[92:95], v248, s[48:51], s82 offen nt
    s_add_u32 s82, s19, 196608
    buffer_load_dwordx4 v[96:99], v248, s[48:51], s82 offen nt
    s_add_u32 s82, s19, 294912
    buffer_load_dwordx4 v[100:103], v248, s[48:51], s82 offen nt
    s_waitcnt vmcnt(12)
    s_barrier
    s_add_u32 s96, s84, 13
    s_and_b32 s97, s96, 15
    s_mul_i32 s98, s97, 393216
    s_add_u32 s99, s98, s85
    s_add_u32 s82, s99, 4294770688
    s_add_u32 m0, s83, 102400
    s_nop 0
    buffer_load_dwordx4 v3, s[40:43], s82 offen lds
    s_add_u32 s96, s84, 13
    s_and_b32 s97, s96, 15
    s_mul_i32 s98, s97, 393216
    s_add_u32 s82, s98, s85
    s_add_u32 m0, s83, 106496
    s_nop 0
    buffer_load_dwordx4 v3, s[40:43], s82 offen lds
    s_add_u32 s96, s84, 14
    s_and_b32 s97, s96, 15
    s_mul_i32 s98, s97, 393216
    s_add_u32 s99, s98, s85
    s_add_u32 s82, s99, 4294770688
    s_add_u32 m0, s83, 110592
    s_nop 0
    buffer_load_dwordx4 v3, s[40:43], s82 offen lds
    s_add_u32 s96, s84, 14
    s_and_b32 s97, s96, 15
    s_mul_i32 s98, s97, 393216
    s_add_u32 s82, s98, s85
    s_add_u32 m0, s83, 114688
    s_nop 0
    buffer_load_dwordx4 v3, s[40:43], s82 offen lds
    s_add_u32 s96, s84, 15
    s_and_b32 s97, s96, 15
    s_mul_i32 s98, s97, 393216
    s_add_u32 s99, s98, s85
    s_add_u32 s82, s99, 4294770688
    s_add_u32 m0, s83, 118784
    s_nop 0
    buffer_load_dwordx4 v3, s[40:43], s82 offen lds
    s_add_u32 s96, s84, 15
    s_and_b32 s97, s96, 15
    s_mul_i32 s98, s97, 393216
    s_add_u32 s82, s98, s85
    s_add_u32 m0, s83, 122880
    s_nop 0
    buffer_load_dwordx4 v3, s[40:43], s82 offen lds
    v_and_b32 v85, 1, v1
    v_lshlrev_b32 v85, 3, v85
    v_bfe_u32 v84, v1, 2, 2
    v_lshl_add_u32 v85, v84, 4, v85
    v_bfe_u32 v84, v1, 4, 1
    v_lshl_add_u32 v85, v84, 6, v85
    v_bfe_u32 v84, v1, 1, 1
    v_lshl_add_u32 v85, v84, 7, v85
    v_lshrrev_b32 v84, 5, v1
    v_lshl_add_u32 v85, v84, 8, v85
    s_lshl_b32 s13, s3, 12
    v_add_u32 v84, s13, v85
    s_lshl_b32 s96, s76, 13
    s_add_u32 s13, s96, 32768
    v_add_u32 v85, s13, v85
    v_mov_b32 v80, 0x3f803f80
    v_mov_b32 v81, 0x3f803f80
    v_mov_b32 v82, 0x3f803f80
    v_mov_b32 v83, 0x3f803f80
    s_lshl3_add_u32 s96, s11, s3
    s_lshl_b32 s97, s96, 5
    s_add_u32 s98, s97, s10
    s_lshl_b32 s99, s98, 10
    s_add_u32 s13, s99, 25165824
    s_add_u32 s15, s13, 16384
    s_lshl3_add_u32 s96, s11, s3
    s_lshl_b32 s97, s96, 10
    s_add_u32 s16, s97, 21495808
    s_lshl_b32 s96, s10, 6
    s_add_u32 s14, s96, s16
    s_waitcnt lgkmcnt(0)
    s_barrier
    s_setprio 3
    ds_read_b128 v[152:155], v0
    ds_read_b128 v[156:159], v0 offset:1024
    v_subrev_u32 v0, 118784, v0
    s_waitcnt lgkmcnt(1)
    v_mfma_f32_32x32x16_bf16 v[184:199], v[168:171], v[152:155], 0
    s_waitcnt lgkmcnt(0)
    v_mfma_f32_32x32x16_bf16 v[184:199], v[172:175], v[156:159], v[184:199]
    s_setprio 0
    s_nop 10
    v_cvt_pk_bf16_f32 v184, 0, v184
    v_cvt_pk_bf16_f32 v185, 0, v185
    v_cvt_pk_bf16_f32 v186, 0, v186
    s_add_u32 s82, s19, 393216
    buffer_load_dwordx4 v[104:107], v248, s[48:51], s82 offen nt
    v_cvt_pk_bf16_f32 v187, 0, v187
    v_cvt_pk_bf16_f32 v188, 0, v188
    v_cvt_pk_bf16_f32 v189, 0, v189
    v_cvt_pk_bf16_f32 v190, 0, v190
    v_cvt_pk_bf16_f32 v191, 0, v191
    v_cvt_pk_bf16_f32 v192, 0, v192
    v_cvt_pk_bf16_f32 v193, 0, v193
    v_cvt_pk_bf16_f32 v194, 0, v194
    v_cvt_pk_bf16_f32 v195, 0, v195
    v_cvt_pk_bf16_f32 v196, 0, v196
    s_add_u32 s82, s19, 491520
    buffer_load_dwordx4 v[108:111], v248, s[48:51], s82 offen nt
    v_cvt_pk_bf16_f32 v197, 0, v197
    v_cvt_pk_bf16_f32 v198, 0, v198
    v_cvt_pk_bf16_f32 v199, 0, v199
    v_max3_f32 v4, v184, v185, v186
    v_min3_f32 v5, v184, v185, v186
    v_max3_f32 v4, v4, v187, v188
    v_min3_f32 v5, v5, v187, v188
    v_max3_f32 v4, v4, v189, v190
    v_min3_f32 v5, v5, v189, v190
    v_max3_f32 v4, v4, v191, v192
    s_add_u32 s82, s19, 589824
    buffer_load_dwordx4 v[112:115], v248, s[48:51], s82 offen nt
    v_min3_f32 v5, v5, v191, v192
    v_max3_f32 v4, v4, v193, v194
    v_min3_f32 v5, v5, v193, v194
    v_max3_f32 v4, v4, v195, v196
    v_min3_f32 v5, v5, v195, v196
    v_max3_f32 v4, v4, v197, v198
    v_min3_f32 v5, v5, v197, v198
    v_max_f32 v6, v4, v199
    v_min_f32 v7, v5, v199
    v_max_f32 v4, v4, v199
    s_add_u32 s82, s19, 688128
    buffer_load_dwordx4 v[116:119], v248, s[48:51], s82 offen nt
    v_min_f32 v5, v5, v199
    v_permlane32_swap_b32 v4, v6
    s_nop 0
    v_permlane32_swap_b32 v5, v7
    v_max_f32 v4, v4, v6
    v_min_f32 v5, v5, v7
    v_mul_f32_e64 v4, v4, s7
    v_mul_f32_e64 v5, v5, s7
    v_fma_f32 v216, v184, s7, -v4
    v_fma_f32 v217, v185, s7, -v4
    v_fma_f32 v184, -v184, s7, v5
    v_fma_f32 v185, -v185, s7, v5
    v_fma_f32 v218, v186, s7, -v4
    v_fma_f32 v219, v187, s7, -v4
    v_fma_f32 v186, -v186, s7, v5
    v_fma_f32 v187, -v187, s7, v5
    s_waitcnt vmcnt(18)
    s_waitcnt vmcnt(16)
    s_barrier
    s_setprio 3
    ds_read_b128 v[152:155], v0
    ds_read_b128 v[156:159], v0 offset:1024
    s_waitcnt lgkmcnt(1)
    v_mfma_f32_32x32x16_bf16 v[200:215], v[176:179], v[152:155], 0
    s_waitcnt lgkmcnt(0)
    v_mfma_f32_32x32x16_bf16 v[200:215], v[180:183], v[156:159], v[200:215]
    s_setprio 0
    v_fma_f32 v220, v188, s7, -v4
    v_fma_f32 v221, v189, s7, -v4
    v_fma_f32 v188, -v188, s7, v5
    v_fma_f32 v189, -v189, s7, v5
    v_fma_f32 v222, v190, s7, -v4
    s_mov_b32 s82, s80
    buffer_load_dwordx4 v[56:59], v27, s[52:55], s82 offen nt
    v_fma_f32 v223, v191, s7, -v4
    v_fma_f32 v190, -v190, s7, v5
    v_fma_f32 v191, -v191, s7, v5
    v_fma_f32 v224, v192, s7, -v4
    v_fma_f32 v225, v193, s7, -v4
    s_setprio 3
    v_fma_f32 v192, -v192, s7, v5
    v_fma_f32 v193, -v193, s7, v5
    v_fma_f32 v226, v194, s7, -v4
    v_fma_f32 v227, v195, s7, -v4
    v_fma_f32 v194, -v194, s7, v5
    v_fma_f32 v195, -v195, s7, v5
    v_fma_f32 v228, v196, s7, -v4
    v_fma_f32 v229, v197, s7, -v4
    v_fma_f32 v196, -v196, s7, v5
    v_fma_f32 v197, -v197, s7, v5
    v_fma_f32 v230, v198, s7, -v4
    v_fma_f32 v231, v199, s7, -v4
    v_fma_f32 v198, -v198, s7, v5
    v_fma_f32 v199, -v199, s7, v5
    v_exp_f32 v216, v216
    s_add_u32 s82, s80, 4294049792
    buffer_load_dwordx4 v[60:63], v27, s[52:55], s82 offen nt
    v_exp_f32 v184, v184
    v_exp_f32 v217, v217
    v_exp_f32 v185, v185
    v_exp_f32 v218, v218
    v_exp_f32 v186, v186
    v_exp_f32 v219, v219
    v_exp_f32 v187, v187
    v_exp_f32 v220, v220
    v_exp_f32 v188, v188
    v_exp_f32 v221, v221
    v_exp_f32 v189, v189
    v_exp_f32 v222, v222
    v_exp_f32 v190, v190
    v_exp_f32 v223, v223
    v_exp_f32 v191, v191
    v_exp_f32 v224, v224
    v_exp_f32 v192, v192
    v_exp_f32 v225, v225
    v_exp_f32 v193, v193
    v_exp_f32 v226, v226
    s_add_u32 s82, s80, 57344
    buffer_load_dwordx4 v[64:67], v27, s[52:55], s82 offen nt
    v_exp_f32 v194, v194
    v_exp_f32 v227, v227
    v_exp_f32 v195, v195
    v_exp_f32 v228, v228
    v_exp_f32 v196, v196
    v_exp_f32 v229, v229
    v_exp_f32 v197, v197
    v_exp_f32 v230, v230
    v_exp_f32 v198, v198
    v_exp_f32 v231, v231
    v_exp_f32 v199, v199
    v_add_f32 v8, v216, v218
    v_add_f32 v9, v217, v219
    v_add_f32 v10, v184, v186
    v_add_f32 v11, v185, v187
    v_add_f32 v8, v8, v220
    v_add_f32 v9, v9, v221
    v_add_f32 v10, v10, v188
    v_add_f32 v11, v11, v189
    v_add_f32 v8, v8, v222
    s_add_u32 s82, s80, 4294107136
    buffer_load_dwordx4 v[68:71], v27, s[52:55], s82 offen nt
    v_add_f32 v9, v9, v223
    v_add_f32 v10, v10, v190
    v_add_f32 v11, v11, v191
    v_add_f32 v8, v8, v224
    v_add_f32 v9, v9, v225
    v_add_f32 v10, v10, v192
    v_add_f32 v11, v11, v193
    v_add_f32 v8, v8, v226
    v_add_f32 v9, v9, v227
    v_add_f32 v10, v10, v194
    v_add_f32 v11, v11, v195
    v_add_f32 v8, v8, v228
    v_add_f32 v9, v9, v229
    v_add_f32 v10, v10, v196
    v_add_f32 v11, v11, v197
    v_add_f32 v8, v8, v230
    v_add_f32 v9, v9, v231
    v_add_f32 v10, v10, v198
    v_add_f32 v11, v11, v199
    v_add_f32 v6, v8, v9
    v_add_f32 v7, v10, v11
    v_add_f32 v4, v8, v9
    s_setprio 0
    v_add_f32 v5, v10, v11
    v_permlane32_swap_b32 v4, v6
    s_nop 0
    v_permlane32_swap_b32 v5, v7
    v_add_f32 v4, v4, v6
    v_add_f32 v5, v5, v7
    v_rcp_f32 v4, v4
    v_rcp_f32 v5, v5
    v_mul_f32 v216, v216, v4
    v_mul_f32 v217, v217, v4
    v_mul_f32 v184, v184, v5
    v_mul_f32 v185, v185, v5
    v_mul_f32 v218, v218, v4
    v_mul_f32 v219, v219, v4
    v_mul_f32 v186, v186, v5
    v_mul_f32 v187, v187, v5
    v_mul_f32 v220, v220, v4
    v_mul_f32 v221, v221, v4
    v_mul_f32 v188, v188, v5
    v_mul_f32 v189, v189, v5
    v_mul_f32 v222, v222, v4
    v_mul_f32 v223, v223, v4
    v_mul_f32 v190, v190, v5
    v_mul_f32 v191, v191, v5
    v_mul_f32 v224, v224, v4
    v_mul_f32 v225, v225, v4
    v_mul_f32 v192, v192, v5
    v_mul_f32 v193, v193, v5
    v_mul_f32 v226, v226, v4
    v_mul_f32 v227, v227, v4
    v_mul_f32 v194, v194, v5
    v_mul_f32 v195, v195, v5
    v_mul_f32 v228, v228, v4
    v_mul_f32 v229, v229, v4
    v_mul_f32 v196, v196, v5
    v_mul_f32 v197, v197, v5
    v_mul_f32 v230, v230, v4
    v_mul_f32 v231, v231, v4
    v_mul_f32 v198, v198, v5
    v_mul_f32 v199, v199, v5
    v_cvt_pk_bf16_f32 v216, v216, v217
    v_cvt_pk_bf16_f32 v217, v218, v219
    v_cvt_pk_bf16_f32 v218, v220, v221
    v_cvt_pk_bf16_f32 v219, v222, v223
    v_cvt_pk_bf16_f32 v220, v224, v225
    v_cvt_pk_bf16_f32 v221, v226, v227
    v_cvt_pk_bf16_f32 v222, v228, v229
    v_cvt_pk_bf16_f32 v223, v230, v231
    ds_write_b128 v232, v[216:219]
    v_cvt_pk_bf16_f32 v224, v184, v185
    v_cvt_pk_bf16_f32 v225, v186, v187
    v_cvt_pk_bf16_f32 v226, v188, v189
    v_cvt_pk_bf16_f32 v227, v190, v191
    ds_write_b128 v232, v[220:223] offset:4096
    s_waitcnt vmcnt(18)
    s_waitcnt vmcnt(12)
    s_waitcnt vmcnt(10)
    s_waitcnt vmcnt(8)
    s_barrier
    ds_write_b128 v232, v[224:227] offset:8192
    v_cvt_pk_bf16_f32 v228, v192, v193
    v_cvt_pk_bf16_f32 v229, v194, v195
    v_cvt_pk_bf16_f32 v230, v196, v197
    v_cvt_pk_bf16_f32 v231, v198, v199
    s_xor_b32 s96, s95, 786432
    s_add_u32 s97, s96, s90
    s_sub_u32 s82, s97, 65536
    s_add_u32 m0, s83, 45056
    s_nop 0
    buffer_load_dwordx4 v26, s[44:47], s82 offen lds
    ds_write_b128 v232, v[228:231] offset:12288
    v_cvt_pk_bf16_f32 v200, 0, v200
    v_cvt_pk_bf16_f32 v201, 0, v201
    v_cvt_pk_bf16_f32 v202, 0, v202
    v_cvt_pk_bf16_f32 v203, 0, v203
    v_cvt_pk_bf16_f32 v204, 0, v204
    v_cvt_pk_bf16_f32 v205, 0, v205
    v_cvt_pk_bf16_f32 v206, 0, v206
    v_cvt_pk_bf16_f32 v207, 0, v207
    v_cvt_pk_bf16_f32 v208, 0, v208
    v_cvt_pk_bf16_f32 v209, 0, v209
    v_cvt_pk_bf16_f32 v210, 0, v210
    v_cvt_pk_bf16_f32 v211, 0, v211
    s_xor_b32 s96, s95, 786432
    s_add_u32 s82, s96, s90
    s_add_u32 m0, s83, 49152
    s_nop 0
    buffer_load_dwordx4 v26, s[44:47], s82 offen lds
    v_cvt_pk_bf16_f32 v212, 0, v212
    v_cvt_pk_bf16_f32 v213, 0, v213
    v_cvt_pk_bf16_f32 v214, 0, v214
    v_cvt_pk_bf16_f32 v215, 0, v215
    v_max3_f32 v4, v200, v201, v202
    v_min3_f32 v5, v200, v201, v202
    v_max3_f32 v4, v4, v203, v204
    v_min3_f32 v5, v5, v203, v204
    v_max3_f32 v4, v4, v205, v206
    v_min3_f32 v5, v5, v205, v206
    v_max3_f32 v4, v4, v207, v208
    v_min3_f32 v5, v5, v207, v208
    v_max3_f32 v4, v4, v209, v210
    v_min3_f32 v5, v5, v209, v210
    s_xor_b32 s96, s95, 917504
    s_add_u32 s97, s96, s90
    s_sub_u32 s82, s97, 65536
    s_add_u32 m0, s83, 53248
    s_nop 0
    buffer_load_dwordx4 v26, s[44:47], s82 offen lds
    v_max3_f32 v4, v4, v211, v212
    v_min3_f32 v5, v5, v211, v212
    v_max3_f32 v4, v4, v213, v214
    v_min3_f32 v5, v5, v213, v214
    v_max_f32 v6, v4, v215
    v_min_f32 v7, v5, v215
    v_max_f32 v4, v4, v215
    s_waitcnt lgkmcnt(0)
    v_min_f32 v5, v5, v215
    v_permlane32_swap_b32 v4, v6
    s_nop 0
    v_permlane32_swap_b32 v5, v7
    v_max_f32 v4, v4, v6
    v_min_f32 v5, v5, v7
L_PAD6:
    s_cbranch_execz L_RET6
    v_mul_f32_e64 v4, v4, s7
    s_xor_b32 s96, s95, 917504
    s_add_u32 s82, s96, s90
    s_add_u32 m0, s83, 57344
    s_nop 0
    buffer_load_dwordx4 v26, s[44:47], s82 offen lds
    v_mul_f32_e64 v5, v5, s7
    v_fma_f32 v216, v200, s7, -v4
    v_fma_f32 v217, v201, s7, -v4
    v_fma_f32 v200, -v200, s7, v5
    v_fma_f32 v201, -v201, s7, v5
    v_fma_f32 v218, v202, s7, -v4
    v_fma_f32 v219, v203, s7, -v4
    v_fma_f32 v202, -v202, s7, v5
    v_fma_f32 v203, -v203, s7, v5
    v_fma_f32 v220, v204, s7, -v4
    v_fma_f32 v221, v205, s7, -v4
    v_fma_f32 v204, -v204, s7, v5
    v_fma_f32 v205, -v205, s7, v5
    v_fma_f32 v222, v206, s7, -v4
    s_xor_b32 s96, s95, 1048576
    s_add_u32 s97, s96, s90
    s_sub_u32 s82, s97, 65536
    s_add_u32 m0, s83, 61440
    s_nop 0
    buffer_load_dwordx4 v26, s[44:47], s82 offen lds
    v_fma_f32 v223, v207, s7, -v4
    v_fma_f32 v206, -v206, s7, v5
    v_fma_f32 v207, -v207, s7, v5
    v_fma_f32 v224, v208, s7, -v4
    v_fma_f32 v225, v209, s7, -v4
    v_fma_f32 v208, -v208, s7, v5
    v_fma_f32 v209, -v209, s7, v5
    v_fma_f32 v226, v210, s7, -v4
    v_fma_f32 v227, v211, s7, -v4
    v_fma_f32 v210, -v210, s7, v5
    v_fma_f32 v211, -v211, s7, v5
    v_fma_f32 v228, v212, s7, -v4
    v_fma_f32 v229, v213, s7, -v4
    v_fma_f32 v212, -v212, s7, v5
    s_xor_b32 s96, s95, 1048576
    s_add_u32 s82, s96, s90
    s_add_u32 m0, s83, 65536
    s_nop 0
    buffer_load_dwordx4 v26, s[44:47], s82 offen lds
    v_fma_f32 v213, -v213, s7, v5
    v_fma_f32 v230, v214, s7, -v4
    v_fma_f32 v231, v215, s7, -v4
    v_fma_f32 v214, -v214, s7, v5
    v_fma_f32 v215, -v215, s7, v5
    v_exp_f32 v216, v216
    v_exp_f32 v200, v200
    v_exp_f32 v217, v217
    v_exp_f32 v201, v201
    v_exp_f32 v218, v218
    v_exp_f32 v202, v202
    v_exp_f32 v219, v219
    v_exp_f32 v203, v203
    v_exp_f32 v220, v220
    s_xor_b32 s96, s95, 1179648
    s_add_u32 s97, s96, s90
    s_sub_u32 s82, s97, 65536
    s_add_u32 m0, s83, 69632
    s_nop 0
    buffer_load_dwordx4 v26, s[44:47], s82 offen lds
    v_exp_f32 v204, v204
    v_exp_f32 v221, v221
    v_exp_f32 v205, v205
    v_exp_f32 v222, v222
    v_exp_f32 v206, v206
    v_exp_f32 v223, v223
    v_exp_f32 v207, v207
    v_exp_f32 v224, v224
    v_exp_f32 v208, v208
    v_exp_f32 v225, v225
    v_exp_f32 v209, v209
    v_exp_f32 v226, v226
    v_exp_f32 v210, v210
    v_exp_f32 v227, v227
    s_xor_b32 s96, s95, 1179648
    s_add_u32 s82, s96, s90
    s_add_u32 m0, s83, 73728
    s_nop 0
    buffer_load_dwordx4 v26, s[44:47], s82 offen lds
    v_exp_f32 v211, v211
    v_exp_f32 v228, v228
    v_exp_f32 v212, v212
    v_exp_f32 v229, v229
    v_exp_f32 v213, v213
    v_exp_f32 v230, v230
    v_exp_f32 v214, v214
    v_exp_f32 v231, v231
    v_exp_f32 v215, v215
    v_add_f32 v8, v216, v218
    v_add_f32 v9, v217, v219
    v_add_f32 v10, v200, v202
    v_add_f32 v11, v201, v203
    v_add_f32 v8, v8, v220
    v_add_f32 v9, v9, v221
    v_add_f32 v10, v10, v204
    v_add_f32 v11, v11, v205
    v_add_f32 v8, v8, v222
    v_add_f32 v9, v9, v223
    v_add_f32 v10, v10, v206
    v_add_f32 v11, v11, v207
    v_add_f32 v8, v8, v224
    v_add_f32 v9, v9, v225
    v_add_f32 v10, v10, v208
    v_add_f32 v11, v11, v209
    v_add_f32 v8, v8, v226
    v_add_f32 v9, v9, v227
    v_add_f32 v10, v10, v210
    v_add_f32 v11, v11, v211
    v_add_f32 v8, v8, v228
    v_add_f32 v9, v9, v229
    v_add_f32 v10, v10, v212
    v_add_f32 v11, v11, v213
    v_add_f32 v8, v8, v230
    v_add_f32 v9, v9, v231
    v_add_f32 v10, v10, v214
    v_add_f32 v11, v11, v215
    v_add_f32 v6, v8, v9
    v_add_f32 v7, v10, v11
    v_add_f32 v4, v8, v9
    v_add_f32 v5, v10, v11
    s_nop 0
    v_permlane32_swap_b32 v4, v6
    v_permlane32_swap_b32 v5, v7
    v_add_f32 v4, v4, v6
    v_add_f32 v5, v5, v7
    v_rcp_f32 v4, v4
    v_rcp_f32 v5, v5
    v_mul_f32 v216, v216, v4
    v_mul_f32 v217, v217, v4
    v_mul_f32 v200, v200, v5
    v_mul_f32 v201, v201, v5
    v_mul_f32 v218, v218, v4
    v_mul_f32 v219, v219, v4
    v_mul_f32 v202, v202, v5
    v_mul_f32 v203, v203, v5
    v_mul_f32 v220, v220, v4
    v_mul_f32 v221, v221, v4
    v_mul_f32 v204, v204, v5
    v_mul_f32 v205, v205, v5
    v_mul_f32 v222, v222, v4
    v_mul_f32 v223, v223, v4
    v_mul_f32 v206, v206, v5
    v_mul_f32 v207, v207, v5
    v_mul_f32 v224, v224, v4
    v_mul_f32 v225, v225, v4
    v_mul_f32 v208, v208, v5
    v_mul_f32 v209, v209, v5
    v_mul_f32 v226, v226, v4
    v_mul_f32 v227, v227, v4
    v_mul_f32 v210, v210, v5
    v_mul_f32 v211, v211, v5
    v_mul_f32 v228, v228, v4
    v_mul_f32 v229, v229, v4
    v_mul_f32 v212, v212, v5
    v_mul_f32 v213, v213, v5
    v_mul_f32 v230, v230, v4
    v_mul_f32 v231, v231, v4
    v_mul_f32 v214, v214, v5
    v_mul_f32 v215, v215, v5
    v_cvt_pk_bf16_f32 v216, v216, v217
    v_cvt_pk_bf16_f32 v217, v218, v219
    v_cvt_pk_bf16_f32 v218, v220, v221
    v_cvt_pk_bf16_f32 v219, v222, v223
    v_cvt_pk_bf16_f32 v220, v224, v225
    v_cvt_pk_bf16_f32 v221, v226, v227
    v_cvt_pk_bf16_f32 v222, v228, v229
    v_cvt_pk_bf16_f32 v223, v230, v231
    ds_write_b128 v232, v[216:219] offset:16384
    v_cvt_pk_bf16_f32 v224, v200, v201
    v_cvt_pk_bf16_f32 v225, v202, v203
    v_cvt_pk_bf16_f32 v226, v204, v205
    v_cvt_pk_bf16_f32 v227, v206, v207
    ds_write_b128 v232, v[220:223] offset:20480
    ds_write_b128 v232, v[224:227] offset:24576
    v_cvt_pk_bf16_f32 v228, v208, v209
    v_cvt_pk_bf16_f32 v229, v210, v211
    v_cvt_pk_bf16_f32 v230, v212, v213
    v_cvt_pk_bf16_f32 v231, v214, v215
    ds_write_b128 v232, v[228:231] offset:28672
    s_lshl_b32 s96, s77, 11
    s_add_u32 s17, s96, 151552
    v_add_u32 v0, s17, v2
    s_setprio 0
L_JOIN:
    s_waitcnt lgkmcnt(0)
    s_barrier
    ds_read_b64_tr_b16 v[184:185], v84
    ds_read_b64_tr_b16 v[186:187], v84 offset:512
    ds_read_b64_tr_b16 v[200:201], v85
    ds_read_b64_tr_b16 v[202:203], v85 offset:512
    ds_read_b64_tr_b16 v[204:205], v85 offset:1024
    ds_read_b64_tr_b16 v[206:207], v85 offset:1536
    ds_read_b64_tr_b16 v[188:189], v84 offset:1024
    ds_read_b64_tr_b16 v[190:191], v84 offset:1536
    ds_read_b64_tr_b16 v[208:209], v85 offset:2048
    ds_read_b64_tr_b16 v[210:211], v85 offset:2560
    ds_read_b64_tr_b16 v[212:213], v85 offset:3072
    ds_read_b64_tr_b16 v[214:215], v85 offset:3584
    ds_read_b64_tr_b16 v[192:193], v84 offset:2048
    ds_read_b64_tr_b16 v[194:195], v84 offset:2560
    ds_read_b64_tr_b16 v[216:217], v85 offset:4096
    ds_read_b64_tr_b16 v[218:219], v85 offset:4608
    ds_read_b64_tr_b16 v[220:221], v85 offset:5120
    ds_read_b64_tr_b16 v[222:223], v85 offset:5632
    s_waitcnt lgkmcnt(12)
    v_mfma_f32_16x16x32_bf16 v[232:235], v[184:187], v[200:203], 0
    v_mfma_f32_16x16x32_bf16 v[236:239], v[184:187], v[204:207], 0
    v_mfma_f32_16x16x32_bf16 v[240:243], v[184:187], v[80:83], 0
    ds_read_b64_tr_b16 v[196:197], v84 offset:3072
    ds_read_b64_tr_b16 v[198:199], v84 offset:3584
    ds_read_b64_tr_b16 v[224:225], v85 offset:6144
    ds_read_b64_tr_b16 v[226:227], v85 offset:6656
    ds_read_b64_tr_b16 v[228:229], v85 offset:7168
    ds_read_b64_tr_b16 v[230:231], v85 offset:7680
    s_waitcnt lgkmcnt(12)
    v_mfma_f32_16x16x32_bf16 v[232:235], v[188:191], v[208:211], v[232:235]
    v_mfma_f32_16x16x32_bf16 v[236:239], v[188:191], v[212:215], v[236:239]
    v_mfma_f32_16x16x32_bf16 v[240:243], v[188:191], v[80:83], v[240:243]
    s_waitcnt lgkmcnt(6)
    v_mfma_f32_16x16x32_bf16 v[232:235], v[192:195], v[216:219], v[232:235]
    v_mfma_f32_16x16x32_bf16 v[236:239], v[192:195], v[220:223], v[236:239]
    v_mfma_f32_16x16x32_bf16 v[240:243], v[192:195], v[80:83], v[240:243]
    s_waitcnt lgkmcnt(0)
    v_mfma_f32_16x16x32_bf16 v[232:235], v[196:199], v[224:227], v[232:235]
    v_mfma_f32_16x16x32_bf16 v[236:239], v[196:199], v[228:231], v[236:239]
    v_mfma_f32_16x16x32_bf16 v[240:243], v[196:199], v[80:83], v[240:243]
    s_cmp_lt_u32 s3, 4
    s_cbranch_scc1 L_NOQX
    ds_read_b128 v[168:171], v0
    ds_read_b128 v[172:175], v0 offset:1024
L_NOQX:
    s_nop 3
    buffer_store_dwordx4 v[232:235], v2, s[32:35], s13 offen sc1
    buffer_store_dwordx4 v[236:239], v2, s[32:35], s15 offen sc1
    s_mov_b32 exec_lo, 0x00010001
    s_mov_b32 exec_hi, 0x00010001
    buffer_store_dwordx4 v[240:243], v1, s[32:35], s14 offen sc1
    s_mov_b64 exec, -1
    s_waitcnt lgkmcnt(0)
    v_mfma_f32_32x32x16_bf16 v[120:135], v[176:179], v[168:171], 0
    v_mfma_f32_32x32x16_bf16 v[120:135], v[180:183], v[172:175], v[120:135]
    v_and_b32 v46, 7, v1
    v_lshlrev_b32 v46, 17, v46
    v_bfe_u32 v9, v1, 3, 1
    v_lshl_add_u32 v46, v9, 14, v46
    s_and_b32 s96, s10, 1
    s_and_b32 s97, s2, 27
    s_lshl_b32 s98, s97, 12
    s_lshr_b32 s99, s10, 1
    s_lshl_b32 s97, s99, 6
    s_add_u32 s99, s98, s97
    s_lshl2_add_u32 s98, s96, s99
    s_add_u32 s97, s98, 1048576
    s_add_u32 s17, s97, 512
    v_lshrrev_b32 v47, 3, v1
    v_lshlrev_b32 v47, 10, v47
    v_and_b32 v9, 7, v1
    v_lshl_add_u32 v47, v9, 4, v47
    v_and_b32 v48, 7, v1
    v_lshlrev_b32 v48, 4, v48
    v_lshrrev_b32 v9, 5, v1
    v_lshl_add_u32 v48, v9, 3, v48
    v_cvt_pk_bf16_f32 v120, 0, v120
    v_cvt_pk_bf16_f32 v121, 0, v121
    v_cvt_pk_bf16_f32 v122, 0, v122
    v_cvt_pk_bf16_f32 v123, 0, v123
    v_cvt_pk_bf16_f32 v124, 0, v124
    v_cvt_pk_bf16_f32 v125, 0, v125
    v_cvt_pk_bf16_f32 v126, 0, v126
    v_cvt_pk_bf16_f32 v127, 0, v127
    v_cvt_pk_bf16_f32 v128, 0, v128
    v_cvt_pk_bf16_f32 v129, 0, v129
    v_cvt_pk_bf16_f32 v130, 0, v130
    v_cvt_pk_bf16_f32 v131, 0, v131
    v_cvt_pk_bf16_f32 v132, 0, v132
    v_cvt_pk_bf16_f32 v133, 0, v133
    v_cvt_pk_bf16_f32 v134, 0, v134
    v_cvt_pk_bf16_f32 v135, 0, v135
    v_max3_f32 v4, v120, v121, v122
    v_min3_f32 v5, v120, v121, v122
    v_max3_f32 v4, v4, v123, v124
    v_min3_f32 v5, v5, v123, v124
    v_max3_f32 v4, v4, v125, v126
    v_min3_f32 v5, v5, v125, v126
    v_max3_f32 v4, v4, v127, v128
    v_min3_f32 v5, v5, v127, v128
    v_max3_f32 v4, v4, v129, v130
    v_min3_f32 v5, v5, v129, v130
    v_max3_f32 v4, v4, v131, v132
    v_min3_f32 v5, v5, v131, v132
    v_max3_f32 v4, v4, v133, v134
    v_min3_f32 v5, v5, v133, v134
    v_max_f32 v6, v4, v135
    v_min_f32 v7, v5, v135
    v_max_f32 v4, v4, v135
    v_min_f32 v5, v5, v135
    s_nop 0
    v_permlane32_swap_b32 v4, v6
    v_permlane32_swap_b32 v5, v7
    v_max_f32 v4, v4, v6
    v_min_f32 v5, v5, v7
    v_pk_mul_f32 v[4:5], v[4:5], s[6:7] op_sel:[0,1]
    v_mov_b32 v6, v5
    v_pk_fma_f32 v[136:137], v[120:121], s[6:7], v[4:5] op_sel:[0,1,0] op_sel_hi:[1,1,0] neg_lo:[0,0,1] neg_hi:[0,0,1]
    v_pk_fma_f32 v[120:121], v[120:121], s[6:7], v[6:7] op_sel:[0,1,0] op_sel_hi:[1,1,0] neg_lo:[1,0,0] neg_hi:[1,0,0]
    v_pk_fma_f32 v[138:139], v[122:123], s[6:7], v[4:5] op_sel:[0,1,0] op_sel_hi:[1,1,0] neg_lo:[0,0,1] neg_hi:[0,0,1]
    v_pk_fma_f32 v[122:123], v[122:123], s[6:7], v[6:7] op_sel:[0,1,0] op_sel_hi:[1,1,0] neg_lo:[1,0,0] neg_hi:[1,0,0]
    v_pk_fma_f32 v[140:141], v[124:125], s[6:7], v[4:5] op_sel:[0,1,0] op_sel_hi:[1,1,0] neg_lo:[0,0,1] neg_hi:[0,0,1]
    v_pk_fma_f32 v[124:125], v[124:125], s[6:7], v[6:7] op_sel:[0,1,0] op_sel_hi:[1,1,0] neg_lo:[1,0,0] neg_hi:[1,0,0]
    v_pk_fma_f32 v[142:143], v[126:127], s[6:7], v[4:5] op_sel:[0,1,0] op_sel_hi:[1,1,0] neg_lo:[0,0,1] neg_hi:[0,0,1]
    v_pk_fma_f32 v[126:127], v[126:127], s[6:7], v[6:7] op_sel:[0,1,0] op_sel_hi:[1,1,0] neg_lo:[1,0,0] neg_hi:[1,0,0]
    v_pk_fma_f32 v[144:145], v[128:129], s[6:7], v[4:5] op_sel:[0,1,0] op_sel_hi:[1,1,0] neg_lo:[0,0,1] neg_hi:[0,0,1]
    v_pk_fma_f32 v[128:129], v[128:129], s[6:7], v[6:7] op_sel:[0,1,0] op_sel_hi:[1,1,0] neg_lo:[1,0,0] neg_hi:[1,0,0]
    v_pk_fma_f32 v[146:147], v[130:131], s[6:7], v[4:5] op_sel:[0,1,0] op_sel_hi:[1,1,0] neg_lo:[0,0,1] neg_hi:[0,0,1]
    v_pk_fma_f32 v[130:131], v[130:131], s[6:7], v[6:7] op_sel:[0,1,0] op_sel_hi:[1,1,0] neg_lo:[1,0,0] neg_hi:[1,0,0]
    v_pk_fma_f32 v[148:149], v[132:133], s[6:7], v[4:5] op_sel:[0,1,0] op_sel_hi:[1,1,0] neg_lo:[0,0,1] neg_hi:[0,0,1]
    v_pk_fma_f32 v[132:133], v[132:133], s[6:7], v[6:7] op_sel:[0,1,0] op_sel_hi:[1,1,0] neg_lo:[1,0,0] neg_hi:[1,0,0]
    v_pk_fma_f32 v[150:151], v[134:135], s[6:7], v[4:5] op_sel:[0,1,0] op_sel_hi:[1,1,0] neg_lo:[0,0,1] neg_hi:[0,0,1]
    v_pk_fma_f32 v[134:135], v[134:135], s[6:7], v[6:7] op_sel:[0,1,0] op_sel_hi:[1,1,0] neg_lo:[1,0,0] neg_hi:[1,0,0]
    v_exp_f32 v136, v136
    v_exp_f32 v120, v120
    v_exp_f32 v137, v137
    v_exp_f32 v121, v121
    v_exp_f32 v138, v138
    v_exp_f32 v122, v122
    v_exp_f32 v139, v139
    v_exp_f32 v123, v123
    v_exp_f32 v140, v140
    v_exp_f32 v124, v124
    v_exp_f32 v141, v141
    v_exp_f32 v125, v125
    v_exp_f32 v142, v142
    v_exp_f32 v126, v126
    v_exp_f32 v143, v143
    v_exp_f32 v127, v127
    s_waitcnt vmcnt(0)
    s_barrier
    s_cmp_lg_u32 s3, 0
    s_cbranch_scc1 L_PC
    v_mov_b32 v85, s4
    s_mov_b32 exec_hi, 0
    s_mov_b32 exec_lo, 65535
    buffer_store_dword v85, v46, s[32:35], s17 offen sc1
    s_mov_b64 exec, -1
L_PC:
    s_xor_b32 s96, s95, 1310720
    s_add_u32 s82, s96, s90
    s_add_u32 m0, s83, 81920
    s_nop 0
    buffer_load_dwordx4 v26, s[44:47], s82 offen lds
    v_exp_f32 v144, v144
    v_exp_f32 v128, v128
    v_exp_f32 v145, v145
    v_exp_f32 v129, v129
    s_xor_b32 s96, s95, 1441792
    s_add_u32 s82, s96, s90
    s_add_u32 m0, s83, 90112
    s_nop 0
    buffer_load_dwordx4 v26, s[44:47], s82 offen lds
    v_exp_f32 v146, v146
    v_exp_f32 v130, v130
    v_exp_f32 v147, v147
    v_exp_f32 v131, v131
    s_xor_b32 s96, s95, 1572864
    s_add_u32 s82, s96, s90
    s_add_u32 m0, s83, 98304
    s_nop 0
    buffer_load_dwordx4 v26, s[44:47], s82 offen lds
    v_exp_f32 v148, v148
    v_exp_f32 v132, v132
    v_exp_f32 v149, v149
    v_exp_f32 v133, v133
    s_xor_b32 s96, s95, 1703936
    s_add_u32 s82, s96, s90
    s_add_u32 m0, s83, 106496
    s_nop 0
    buffer_load_dwordx4 v26, s[44:47], s82 offen lds
    v_exp_f32 v150, v150
    v_exp_f32 v134, v134
    v_exp_f32 v151, v151
    v_exp_f32 v135, v135
    s_lshl4_add_u32 s96, s11, s10
    s_lshl_b32 s97, s96, 14
    s_lshl_b32 s98, s3, 7
    s_add_u32 s99, s97, s98
    s_add_u32 s13, s99, 25165824
    s_add_u32 s14, s13, 8192
    s_lshl4_add_u32 s96, s11, s10
    s_lshl_b32 s97, s96, 10
    s_lshl_b32 s98, s3, 7
    s_add_u32 s99, s97, s98
    s_add_u32 s15, s99, 29360128
    s_add_u32 s17, s17, 3072
    s_load_dwordx2 s[24:25], s[32:33], s92 offset:512 glc
    s_xor_b32 s96, s95, 1835008
    s_add_u32 s82, s96, s90
    s_add_u32 m0, s83, 114688
    s_nop 0
    buffer_load_dwordx4 v26, s[44:47], s82 offen lds
    v_pk_add_f32 v[8:9], v[136:137], v[138:139]
    v_pk_add_f32 v[10:11], v[120:121], v[122:123]
    v_pk_add_f32 v[8:9], v[8:9], v[140:141]
    v_pk_add_f32 v[10:11], v[10:11], v[124:125]
    v_pk_add_f32 v[8:9], v[8:9], v[142:143]
    v_pk_add_f32 v[10:11], v[10:11], v[126:127]
    v_pk_add_f32 v[8:9], v[8:9], v[144:145]
    v_pk_add_f32 v[10:11], v[10:11], v[128:129]
    v_pk_add_f32 v[8:9], v[8:9], v[146:147]
    v_pk_add_f32 v[10:11], v[10:11], v[130:131]
    v_pk_add_f32 v[8:9], v[8:9], v[148:149]
    v_pk_add_f32 v[10:11], v[10:11], v[132:133]
    v_pk_add_f32 v[8:9], v[8:9], v[150:151]
    v_pk_add_f32 v[10:11], v[10:11], v[134:135]
    s_xor_b32 s96, s95, 1966080
    s_add_u32 s82, s96, s90
    s_add_u32 m0, s83, 122880
    s_nop 0
    buffer_load_dwordx4 v26, s[44:47], s82 offen lds
    v_add_f32 v6, v8, v9
    v_add_f32 v7, v10, v11
    v_add_f32 v4, v8, v9
    v_add_f32 v5, v10, v11
    s_nop 0
    v_permlane32_swap_b32 v4, v6
    v_permlane32_swap_b32 v5, v7
    v_pk_add_f32 v[4:5], v[4:5], v[6:7]
    v_rcp_f32 v4, v4
    v_rcp_f32 v5, v5
    s_nop 0
    v_pk_mul_f32 v[136:137], v[136:137], v[4:5] op_sel_hi:[1,0]
    v_pk_mul_f32 v[120:121], v[4:5], v[120:121] op_sel:[1,0]
    v_pk_mul_f32 v[138:139], v[138:139], v[4:5] op_sel_hi:[1,0]
    v_pk_mul_f32 v[122:123], v[4:5], v[122:123] op_sel:[1,0]
    v_pk_mul_f32 v[140:141], v[140:141], v[4:5] op_sel_hi:[1,0]
    s_add_u32 s82, s95, s90
    s_mov_b32 m0, s83
    s_nop 0
    buffer_load_dwordx4 v26, s[44:47], s82 offen lds
    v_pk_mul_f32 v[124:125], v[4:5], v[124:125] op_sel:[1,0]
    v_pk_mul_f32 v[142:143], v[142:143], v[4:5] op_sel_hi:[1,0]
    v_pk_mul_f32 v[126:127], v[4:5], v[126:127] op_sel:[1,0]
    v_pk_mul_f32 v[144:145], v[144:145], v[4:5] op_sel_hi:[1,0]
    v_pk_mul_f32 v[128:129], v[4:5], v[128:129] op_sel:[1,0]
    v_pk_mul_f32 v[146:147], v[146:147], v[4:5] op_sel_hi:[1,0]
    v_pk_mul_f32 v[130:131], v[4:5], v[130:131] op_sel:[1,0]
    v_pk_mul_f32 v[148:149], v[148:149], v[4:5] op_sel_hi:[1,0]
    v_pk_mul_f32 v[132:133], v[4:5], v[132:133] op_sel:[1,0]
    v_pk_mul_f32 v[150:151], v[150:151], v[4:5] op_sel_hi:[1,0]
    v_pk_mul_f32 v[134:135], v[4:5], v[134:135] op_sel:[1,0]
    v_cvt_pk_bf16_f32 v152, v136, v137
    v_cvt_pk_bf16_f32 v153, v138, v139
    v_cvt_pk_bf16_f32 v154, v140, v141
    s_xor_b32 s96, s95, 131072
    s_add_u32 s82, s96, s90
    s_add_u32 m0, s83, 8192
    s_nop 0
    buffer_load_dwordx4 v26, s[44:47], s82 offen lds
    v_cvt_pk_bf16_f32 v155, v142, v143
    v_cvt_pk_bf16_f32 v156, v144, v145
    v_cvt_pk_bf16_f32 v157, v146, v147
    v_cvt_pk_bf16_f32 v158, v148, v149
    v_cvt_pk_bf16_f32 v159, v150, v151
    v_cvt_pk_bf16_f32 v160, v120, v121
    v_cvt_pk_bf16_f32 v161, v122, v123
    v_cvt_pk_bf16_f32 v162, v124, v125
    v_cvt_pk_bf16_f32 v163, v126, v127
    v_cvt_pk_bf16_f32 v164, v128, v129
    v_cvt_pk_bf16_f32 v165, v130, v131
    v_cvt_pk_bf16_f32 v166, v132, v133
    v_cvt_pk_bf16_f32 v167, v134, v135
    s_branch SCHK_20
SPOLL_19:
    s_load_dwordx2 s[24:25], s[32:33], s92 offset:512 glc
SCHK_20:
    s_add_u32 s5, s5, 1
    s_cmp_ge_u32 s5, 200000
    s_waitcnt lgkmcnt(0)
    s_cbranch_scc1 SDONE_21
    s_cmp_lg_u32 s24, s4
    s_cbranch_scc1 SPOLL_19
    s_cmp_lg_u32 s25, s4
    s_cbranch_scc1 SPOLL_19
SDONE_21:
    s_barrier
    buffer_load_dwordx4 v[184:187], v47, s[32:35], s13 offen sc1
    buffer_load_dwordx4 v[188:191], v47, s[32:35], s14 offen sc1
    buffer_load_dwordx4 v[192:195], v2, s[32:35], s16 offen sc1
    s_lshl_b32 s96, s3, 5
    s_add_u32 s14, s96, 155648
    v_and_b32 v6, 3, v1
    v_lshl_add_u32 v6, v6, 3, s14
    v_lshrrev_b32 v9, 5, v1
    v_lshl_add_u32 v6, v9, 2, v6
    s_lshl_b32 s96, s3, 10
    s_add_u32 s14, s96, 147456
    v_and_b32 v5, 15, v1
    v_lshl_add_u32 v5, v5, 4, s14
    v_lshrrev_b32 v9, 5, v1
    v_lshl_add_u32 v5, v9, 9, v5
    v_bfe_u32 v9, v1, 4, 1
    v_lshl_add_u32 v5, v9, 3, v5
    s_lshl_b32 s96, s76, 7
    s_add_u32 s14, s96, 155648
    v_lshrrev_b32 v7, 5, v1
    v_lshl_add_u32 v7, v7, 4, s14
    s_lshl_b32 s96, s76, 12
    s_add_u32 s14, s96, 147456
    v_add_u32 v84, s14, v2
    s_cmp_lt_u32 s3, 4
    s_cbranch_scc1 L_HG1
    v_lshlrev_b32 v52, 16, v88
    v_and_b32 v53, s6, v88
    v_pk_mul_f32 v[196:197], v[36:37], v[52:53] op_sel:[0,0] op_sel_hi:[0,1]
    v_lshlrev_b32 v54, 16, v89
    v_and_b32 v55, s6, v89
    v_pk_mul_f32 v[198:199], v[36:37], v[54:55] op_sel:[0,0] op_sel_hi:[0,1]
    v_lshlrev_b32 v52, 16, v90
    v_and_b32 v53, s6, v90
    v_pk_mul_f32 v[200:201], v[36:37], v[52:53] op_sel:[0,0] op_sel_hi:[0,1]
    v_lshlrev_b32 v54, 16, v91
    v_and_b32 v55, s6, v91
    v_pk_mul_f32 v[202:203], v[36:37], v[54:55] op_sel:[0,0] op_sel_hi:[0,1]
    v_lshlrev_b32 v52, 16, v92
    v_and_b32 v53, s6, v92
    v_pk_fma_f32 v[196:197], v[36:37], v[52:53], v[196:197] op_sel:[1,0,0] op_sel_hi:[1,1,1]
    v_lshlrev_b32 v54, 16, v93
    v_and_b32 v55, s6, v93
    v_pk_fma_f32 v[198:199], v[36:37], v[54:55], v[198:199] op_sel:[1,0,0] op_sel_hi:[1,1,1]
    v_lshlrev_b32 v52, 16, v94
    v_and_b32 v53, s6, v94
    v_pk_fma_f32 v[200:201], v[36:37], v[52:53], v[200:201] op_sel:[1,0,0] op_sel_hi:[1,1,1]
    v_lshlrev_b32 v54, 16, v95
    v_and_b32 v55, s6, v95
    v_pk_fma_f32 v[202:203], v[36:37], v[54:55], v[202:203] op_sel:[1,0,0] op_sel_hi:[1,1,1]
    v_lshlrev_b32 v52, 16, v96
    v_and_b32 v53, s6, v96
    v_pk_fma_f32 v[196:197], v[38:39], v[52:53], v[196:197] op_sel:[0,0,0] op_sel_hi:[0,1,1]
    v_lshlrev_b32 v54, 16, v97
    v_and_b32 v55, s6, v97
    v_pk_fma_f32 v[198:199], v[38:39], v[54:55], v[198:199] op_sel:[0,0,0] op_sel_hi:[0,1,1]
    v_lshlrev_b32 v52, 16, v98
    v_and_b32 v53, s6, v98
    v_pk_fma_f32 v[200:201], v[38:39], v[52:53], v[200:201] op_sel:[0,0,0] op_sel_hi:[0,1,1]
    v_lshlrev_b32 v54, 16, v99
    v_and_b32 v55, s6, v99
    v_pk_fma_f32 v[202:203], v[38:39], v[54:55], v[202:203] op_sel:[0,0,0] op_sel_hi:[0,1,1]
    v_lshlrev_b32 v52, 16, v100
    v_and_b32 v53, s6, v100
    v_pk_fma_f32 v[196:197], v[38:39], v[52:53], v[196:197] op_sel:[1,0,0] op_sel_hi:[1,1,1]
    v_lshlrev_b32 v54, 16, v101
    v_and_b32 v55, s6, v101
    v_pk_fma_f32 v[198:199], v[38:39], v[54:55], v[198:199] op_sel:[1,0,0] op_sel_hi:[1,1,1]
    v_lshlrev_b32 v52, 16, v102
    v_and_b32 v53, s6, v102
    v_pk_fma_f32 v[200:201], v[38:39], v[52:53], v[200:201] op_sel:[1,0,0] op_sel_hi:[1,1,1]
    v_lshlrev_b32 v54, 16, v103
    v_and_b32 v55, s6, v103
    v_pk_fma_f32 v[202:203], v[38:39], v[54:55], v[202:203] op_sel:[1,0,0] op_sel_hi:[1,1,1]
    v_lshlrev_b32 v52, 16, v104
    v_and_b32 v53, s6, v104
    v_pk_fma_f32 v[196:197], v[40:41], v[52:53], v[196:197] op_sel:[0,0,0] op_sel_hi:[0,1,1]
    v_lshlrev_b32 v54, 16, v105
    v_and_b32 v55, s6, v105
    v_pk_fma_f32 v[198:199], v[40:41], v[54:55], v[198:199] op_sel:[0,0,0] op_sel_hi:[0,1,1]
    v_lshlrev_b32 v52, 16, v106
    v_and_b32 v53, s6, v106
    v_pk_fma_f32 v[200:201], v[40:41], v[52:53], v[200:201] op_sel:[0,0,0] op_sel_hi:[0,1,1]
    v_lshlrev_b32 v54, 16, v107
    v_and_b32 v55, s6, v107
    v_pk_fma_f32 v[202:203], v[40:41], v[54:55], v[202:203] op_sel:[0,0,0] op_sel_hi:[0,1,1]
    v_lshlrev_b32 v52, 16, v108
    v_and_b32 v53, s6, v108
    v_pk_fma_f32 v[196:197], v[40:41], v[52:53], v[196:197] op_sel:[1,0,0] op_sel_hi:[1,1,1]
    v_lshlrev_b32 v54, 16, v109
    v_and_b32 v55, s6, v109
    v_pk_fma_f32 v[198:199], v[40:41], v[54:55], v[198:199] op_sel:[1,0,0] op_sel_hi:[1,1,1]
    v_lshlrev_b32 v52, 16, v110
    v_and_b32 v53, s6, v110
    v_pk_fma_f32 v[200:201], v[40:41], v[52:53], v[200:201] op_sel:[1,0,0] op_sel_hi:[1,1,1]
    v_lshlrev_b32 v54, 16, v111
    v_and_b32 v55, s6, v111
    v_pk_fma_f32 v[202:203], v[40:41], v[54:55], v[202:203] op_sel:[1,0,0] op_sel_hi:[1,1,1]
    v_lshlrev_b32 v52, 16, v112
    v_and_b32 v53, s6, v112
    v_pk_fma_f32 v[196:197], v[42:43], v[52:53], v[196:197] op_sel:[0,0,0] op_sel_hi:[0,1,1]
    v_lshlrev_b32 v54, 16, v113
    v_and_b32 v55, s6, v113
    v_pk_fma_f32 v[198:199], v[42:43], v[54:55], v[198:199] op_sel:[0,0,0] op_sel_hi:[0,1,1]
    v_lshlrev_b32 v52, 16, v114
    v_and_b32 v53, s6, v114
    v_pk_fma_f32 v[200:201], v[42:43], v[52:53], v[200:201] op_sel:[0,0,0] op_sel_hi:[0,1,1]
    v_lshlrev_b32 v54, 16, v115
    v_and_b32 v55, s6, v115
    v_pk_fma_f32 v[202:203], v[42:43], v[54:55], v[202:203] op_sel:[0,0,0] op_sel_hi:[0,1,1]
    v_lshlrev_b32 v52, 16, v116
    v_and_b32 v53, s6, v116
    v_pk_fma_f32 v[196:197], v[42:43], v[52:53], v[196:197] op_sel:[1,0,0] op_sel_hi:[1,1,1]
    v_lshlrev_b32 v54, 16, v117
    v_and_b32 v55, s6, v117
    v_pk_fma_f32 v[198:199], v[42:43], v[54:55], v[198:199] op_sel:[1,0,0] op_sel_hi:[1,1,1]
    v_lshlrev_b32 v52, 16, v118
    v_and_b32 v53, s6, v118
    v_pk_fma_f32 v[200:201], v[42:43], v[52:53], v[200:201] op_sel:[1,0,0] op_sel_hi:[1,1,1]
    v_lshlrev_b32 v54, 16, v119
    v_and_b32 v55, s6, v119
    v_pk_fma_f32 v[202:203], v[42:43], v[54:55], v[202:203] op_sel:[1,0,0] op_sel_hi:[1,1,1]
    v_permlane32_swap_b32 v196, v200
    v_permlane32_swap_b32 v197, v201
    v_permlane32_swap_b32 v198, v202
    v_permlane32_swap_b32 v199, v203
    v_add_f32 v196, v196, v200
    v_add_f32 v197, v197, v201
    v_add_f32 v198, v198, v202
    v_add_f32 v199, v199, v203
    s_nop 0
    v_permlane16_swap_b32 v196, v198
    v_permlane16_swap_b32 v197, v199
    v_add_f32 v196, v196, v198
    v_add_f32 v197, v197, v199
    s_nop 0
    v_add_f32_dpp v196, v196, v196 row_ror:8 row_mask:0xf bank_mask:0xf
    v_add_f32_dpp v197, v197, v197 row_ror:8 row_mask:0xf bank_mask:0xf
    s_nop 1
    v_mov_b32_dpp v196, v197 quad_perm:[0,1,2,3] row_mask:0xf bank_mask:0xc
    ds_write_b32 v252, v196 offset:9984
L_HG1:
    s_waitcnt vmcnt(1)
    v_pk_add_f32 v[184:185], v[184:185], v[188:189]
    v_pk_add_f32 v[186:187], v[186:187], v[190:191]
    s_nop 1
    v_permlane32_swap_b32 v184, v186
    v_permlane32_swap_b32 v185, v187
    v_pk_add_f32 v[184:185], v[184:185], v[186:187]
    s_nop 1
    v_add_f32_dpp v184, v184, v184 row_ror:8 row_mask:0xf bank_mask:0xf
    v_add_f32_dpp v185, v185, v185 row_ror:8 row_mask:0xf bank_mask:0xf
    v_mov_b32 v186, v184
    v_mov_b32 v187, v185
    s_nop 0
    v_permlane16_swap_b32 v184, v186
    v_permlane16_swap_b32 v185, v187
    v_pk_add_f32 v[184:185], v[184:185], v[186:187]
    v_cvt_pk_bf16_f32 v184, v184, v185
    v_mov_b32 v185, s4
    s_mov_b32 exec_lo, 0xff
    s_mov_b32 exec_hi, 0xff
    buffer_store_dwordx2 v[184:185], v48, s[32:35], s15 offen sc1
    s_mov_b64 exec, -1
    s_waitcnt lgkmcnt(0)
    s_barrier
    s_cmp_lg_u32 s3, 0
    s_cbranch_scc1 L_PC2
    v_mov_b32 v85, s4
    s_mov_b32 exec_hi, 0
    s_mov_b32 exec_lo, 65535
    buffer_store_dword v85, v46, s[32:35], s17 offen sc1
    s_mov_b64 exec, -1
L_PC2:
    s_cmp_lg_u32 s3, 3
    s_cbranch_scc1 L_M2F
    ds_read_b128 v[196:199], v251 offset:10000
    s_lshr_b32 s96, s8, 2
    s_lshl1_add_u32 s97, s9, s96
    s_and_b32 s98, s8, 3
    s_lshl2_add_u32 s99, s97, s98
    s_lshl_b32 s96, s99, 9
    s_add_u32 s18, s96, 131072
    s_waitcnt lgkmcnt(0)
    v_add_f32 v196, v196, v197
    v_add_f32 v198, v198, v199
    v_mov_b32 v197, s4
    v_add_f32 v196, v196, v198
    buffer_store_dwordx2 v[196:197], v250, s[32:35], s18 offen sc1
L_M2F:
    s_waitcnt vmcnt(1)
    s_xor_b32 s96, s95, 262144
    s_add_u32 s82, s96, s90
    s_add_u32 m0, s83, 16384
    s_nop 0
    buffer_load_dwordx4 v26, s[44:47], s82 offen lds
    v_permlane32_swap_b32 v192, v194
    v_permlane32_swap_b32 v193, v195
    v_pk_add_f32 v[192:193], v[192:193], v[194:195]
    s_nop 1
    v_add_f32_dpp v192, v192, v192 row_ror:4 row_mask:0xf bank_mask:0xf
    s_xor_b32 s96, s95, 393216
    s_add_u32 s82, s96, s90
    s_add_u32 m0, s83, 24576
    s_nop 0
    buffer_load_dwordx4 v26, s[44:47], s82 offen lds
    v_add_f32_dpp v193, v193, v193 row_ror:4 row_mask:0xf bank_mask:0xf
    v_add_f32_dpp v192, v192, v192 row_ror:8 row_mask:0xf bank_mask:0xf
    s_nop 0
    v_add_f32_dpp v193, v193, v193 row_ror:8 row_mask:0xf bank_mask:0xf
    s_xor_b32 s96, s95, 524288
    s_add_u32 s82, s96, s90
    s_add_u32 m0, s83, 32768
    s_nop 0
    buffer_load_dwordx4 v26, s[44:47], s82 offen lds
    v_mov_b32 v194, v192
L_PAD7:
    s_cbranch_execz L_RET7
    v_mov_b32 v195, v193
    s_nop 0
    v_permlane16_swap_b32 v192, v194
    s_xor_b32 s96, s95, 655360
    s_add_u32 s82, s96, s90
    s_add_u32 m0, s83, 40960
    s_nop 0
    buffer_load_dwordx4 v26, s[44:47], s82 offen lds
    v_permlane16_swap_b32 v193, v195
    v_pk_add_f32 v[192:193], v[192:193], v[194:195]
    v_cvt_pk_bf16_f32 v192, v192, v193
    ds_write_b32 v6, v192
    s_waitcnt lgkmcnt(0)
    s_barrier
    ds_read_b128 v[196:199], v7
    ds_read_b128 v[200:203], v7 offset:32
    ds_read_b128 v[204:207], v7 offset:64
    ds_read_b128 v[208:211], v7 offset:96
    s_lshr_b32 s96, s8, 2
    s_lshl1_add_u32 s97, s9, s96
    s_and_b32 s98, s8, 3
    s_lshl2_add_u32 s99, s97, s98
    s_lshl_b32 s96, s99, 9
    s_add_u32 s18, s96, 131072
    s_waitcnt lgkmcnt(0)
    s_lshl3_add_u32 s96, s11, s3
    s_lshl_b32 s97, s96, 11
    s_add_u32 s13, s97, 29360128
    s_load_dwordx2 s[24:25], s[32:33], s92 offset:3584 glc
    v_mfma_f32_32x32x16_bf16 v[136:151], v[196:199], v[152:155], 0
    v_mfma_f32_32x32x16_bf16 v[136:151], v[200:203], v[156:159], v[136:151]
    v_mfma_f32_32x32x16_bf16 v[136:151], v[204:207], v[160:163], v[136:151]
    v_mfma_f32_32x32x16_bf16 v[136:151], v[208:211], v[164:167], v[136:151]
    s_nop 11
    v_cvt_pk_bf16_f32 v136, 0, v136
    v_add_f32 v136, 0x358637bd, v136
    v_cvt_pk_bf16_f32 v136, 0, v136
    v_rcp_f32 v136, v136
    s_lshr_b32 s96, s3, 2
    s_lshl_b32 s97, s96, 15
    s_and_b32 s98, s3, 3
    s_lshl_b32 s99, s98, 5
    s_add_u32 s19, s97, s99
    v_lshrrev_b32 v34, 4, v1
    v_lshlrev_b32 v34, 13, v34
    v_bfe_u32 v9, v1, 2, 2
    v_lshl_add_u32 v34, v9, 7, v34
    v_bfe_u32 v9, v1, 3, 2
    v_lshl_add_u32 v34, v9, 5, v34
    v_and_b32 v9, 3, v1
    v_lshl_add_u32 v34, v9, 3, v34
    v_xor_b32 v34, s19, v34
    s_lshl_b32 s96, s75, 11
    s_add_u32 s19, s96, 13631488
    v_and_b32 v52, 7, v1
    v_lshl_add_u32 v52, v52, 4, s19
    v_lshrrev_b32 v9, 4, v1
    v_lshl_add_u32 v52, v9, 9, v52
    v_and_b32 v53, 15, v1
    v_lshlrev_b32 v53, 9, v53
    v_add_u32 v53, 13631744, v53
    s_branch SCHK_23
SPOLL_22:
    s_load_dwordx2 s[24:25], s[32:33], s92 offset:3584 glc
SCHK_23:
    s_add_u32 s5, s5, 1
    s_cmp_ge_u32 s5, 200000
    s_waitcnt lgkmcnt(0)
    s_cbranch_scc1 SDONE_24
    s_cmp_lg_u32 s24, s4
    s_cbranch_scc1 SPOLL_22
    s_cmp_lg_u32 s25, s4
    s_cbranch_scc1 SPOLL_22
SDONE_24:
    buffer_load_dwordx4 v[228:231], v2, s[32:35], s13 offen sc1
    buffer_load_dwordx4 v[232:235], v2, s[32:35], s13 offen offset:1024 sc1
    s_waitcnt vmcnt(0)
    v_bitop3_b32 v4, v229, v231, s4 bitop3:0x7e
    v_bitop3_b32 v4, v4, v233, s4 bitop3:0xf6
    v_bitop3_b32 v4, v4, v235, s4 bitop3:0xf6
    v_cmp_ne_u32 vcc, 0, v4
    s_cbranch_vccz TOK_26
POLL_27:
    buffer_load_dwordx4 v[228:231], v2, s[32:35], s13 offen sc1
    buffer_load_dwordx4 v[232:235], v2, s[32:35], s13 offen offset:1024 sc1
    s_waitcnt vmcnt(0)
    v_bitop3_b32 v4, v229, v231, s4 bitop3:0x7e
    v_bitop3_b32 v4, v4, v233, s4 bitop3:0xf6
    v_bitop3_b32 v4, v4, v235, s4 bitop3:0xf6
    v_cmp_ne_u32 vcc, 0, v4
    s_cbranch_vccz PDONE_28
    s_add_u32 s5, s5, 1
    s_cmp_lt_u32 s5, 200000
    s_cbranch_scc1 POLL_27
PDONE_28:
TOK_26:
    ds_write2_b32 v5, v228, v230 offset0:0 offset1:1
    ds_write2_b32 v5, v232, v234 offset0:64 offset1:65
    s_waitcnt lgkmcnt(0)
    s_barrier
    ds_read_b128 v[212:215], v84
    ds_read_b128 v[216:219], v84 offset:1024
    ds_read_b128 v[220:223], v84 offset:2048
    ds_read_b128 v[224:227], v84 offset:3072
    s_lshl_b32 s96, s77, 1
    s_lshl3_add_u32 s97, s10, s96
    s_lshl_b32 s98, s97, 5
    s_lshl1_add_u32 s99, s11, s98
    s_add_u32 s96, s99, s76
    s_lshl_b32 s97, s96, 10
    s_add_u32 s13, s97, 8388608
    v_and_b32 v47, 15, v1
    v_lshlrev_b32 v47, 4, v47
    v_bfe_u32 v9, v1, 4, 1
    v_lshl_add_u32 v47, v9, 15, v47
    v_lshrrev_b32 v9, 5, v1
    v_lshl_add_u32 v47, v9, 8, v47
    s_waitcnt lgkmcnt(3)
    v_mfma_f32_32x32x16_bf16 v[120:135], v[212:215], v[152:155], 0
    s_waitcnt lgkmcnt(2)
    v_mfma_f32_32x32x16_bf16 v[120:135], v[216:219], v[156:159], v[120:135]
    s_waitcnt lgkmcnt(1)
    v_mfma_f32_32x32x16_bf16 v[120:135], v[220:223], v[160:163], v[120:135]
    s_waitcnt lgkmcnt(0)
    v_mfma_f32_32x32x16_bf16 v[120:135], v[224:227], v[164:167], v[120:135]
    s_lshr_b32 s96, s3, 1
    s_lshl4_add_u32 s97, s96, s12
    s_lshl_b32 s98, s97, 11
    s_and_b32 s99, s3, 1
    s_lshl_b32 s96, s99, 10
    s_add_u32 s97, s98, s96
    s_add_u32 s18, s97, 131072
    s_lshl_b32 s19, s12, 7
    v_and_b32 v84, 3, v1
    v_lshl_add_u32 v84, v84, 1, s19
    v_lshrrev_b32 v9, 5, v1
    v_lshl_add_u32 v84, v9, 3, v84
    v_bfe_u32 v9, v1, 4, 1
    v_lshl_add_u32 v84, v9, 4, v84
    v_bfe_u32 v9, v1, 2, 2
    v_lshl_add_u32 v84, v9, 5, v84
    global_load_ushort v32, v84, s[78:79]
    v_cvt_pk_bf16_f32 v120, 0, v120
    v_cvt_pk_bf16_f32 v121, 0, v121
    v_cvt_pk_bf16_f32 v122, 0, v122
    v_cvt_pk_bf16_f32 v123, 0, v123
    v_cvt_pk_bf16_f32 v124, 0, v124
    v_cvt_pk_bf16_f32 v125, 0, v125
    v_cvt_pk_bf16_f32 v126, 0, v126
    v_cvt_pk_bf16_f32 v127, 0, v127
    v_pk_mul_f32 v[120:121], v[120:121], v[136:137] op_sel_hi:[1,0]
    v_pk_mul_f32 v[122:123], v[122:123], v[136:137] op_sel_hi:[1,0]
    v_pk_mul_f32 v[124:125], v[124:125], v[136:137] op_sel_hi:[1,0]
    v_pk_mul_f32 v[126:127], v[126:127], v[136:137] op_sel_hi:[1,0]
    v_cvt_pk_bf16_f32 v168, v120, v121
    v_cvt_pk_bf16_f32 v169, v122, v123
    v_cvt_pk_bf16_f32 v170, v124, v125
    v_cvt_pk_bf16_f32 v171, v126, v127
    buffer_store_dwordx4 v[168:171], v47, s[32:35], s13 offen sc1
    v_cvt_pk_bf16_f32 v128, 0, v128
    v_cvt_pk_bf16_f32 v129, 0, v129
    v_cvt_pk_bf16_f32 v130, 0, v130
    v_cvt_pk_bf16_f32 v131, 0, v131
    v_cvt_pk_bf16_f32 v132, 0, v132
    v_cvt_pk_bf16_f32 v133, 0, v133
    v_cvt_pk_bf16_f32 v134, 0, v134
    v_cvt_pk_bf16_f32 v135, 0, v135
    v_pk_mul_f32 v[128:129], v[128:129], v[136:137] op_sel_hi:[1,0]
    v_pk_mul_f32 v[130:131], v[130:131], v[136:137] op_sel_hi:[1,0]
    v_pk_mul_f32 v[132:133], v[132:133], v[136:137] op_sel_hi:[1,0]
    v_pk_mul_f32 v[134:135], v[134:135], v[136:137] op_sel_hi:[1,0]
    v_cvt_pk_bf16_f32 v172, v128, v129
    v_cvt_pk_bf16_f32 v173, v130, v131
    v_cvt_pk_bf16_f32 v174, v132, v133
    v_cvt_pk_bf16_f32 v175, v134, v135
    buffer_store_dwordx4 v[172:175], v47, s[32:35], s13 offen offset:512 sc1
    buffer_load_dwordx4 v[28:31], v2, s[32:35], s18 offen sc1
    v_mov_b32 v236, -1
    v_mov_b32 v237, -1
    v_mov_b32 v238, -1
    v_mov_b32 v239, -1
    s_lshl3_add_u32 s96, s21, s3
    s_lshl4_add_u32 s97, s96, s12
    s_lshl_b32 s98, s97, 8
    s_add_u32 s19, s98, 12582912
    v_lshlrev_b32 v240, 2, v1
    buffer_store_dword v236, v240, s[32:35], s19 offen sc1
    s_lshl_b32 s96, s21, 14
    s_lshl_b32 s97, s12, 9
    s_add_u32 s98, s96, s97
    s_add_u32 s19, s98, 13631488
    v_and_b32 v240, 31, v1
    v_lshlrev_b32 v240, 4, v240
    v_lshrrev_b32 v241, 5, v1
    v_lshl_add_u32 v240, v241, 13, v240
    s_cmp_lg_u32 s3, 5
    s_cbranch_scc1 L_NOPO
    buffer_store_dwordx4 v[236:239], v240, s[32:35], s19 offen sc1
L_NOPO:
    v_bfe_u32 v36, v1, 2, 2
    v_lshlrev_b32 v36, 7, v36
    v_lshrrev_b32 v9, 4, v1
    v_lshl_add_u32 v36, v9, 10, v36
    v_and_b32 v9, 1, v1
    v_lshl_add_u32 v36, v9, 4, v36
    v_bfe_u32 v9, v1, 1, 1
    v_lshl_add_u32 v36, v9, 3, v36
    v_bfe_u32 v9, v1, 3, 2
    v_lshl_add_u32 v36, v9, 5, v36
    s_and_b32 s96, s9, 1
    s_lshl_b32 s97, s96, 2
    s_xor_b32 s98, s3, s97
    s_lshl_b32 s17, s98, 12
    s_lshl_b32 s96, s17, 2
    s_lshr_b32 s97, s95, 4
    s_xor_b32 s14, s96, s97
    v_add_u32 v36, s14, v36
    v_xor_b32 v37, 32, v36
    v_xor_b32 v38, 64, v36
    v_xor_b32 v39, 96, v36
    v_and_b32 v5, 7, v1
    v_lshlrev_b32 v5, 15, v5
    v_bfe_u32 v9, v1, 3, 1
    v_lshl_add_u32 v5, v9, 12, v5
    s_and_b32 s96, s11, 1
    s_lshr_b32 s97, s10, 2
    s_and_b32 s98, s10, 3
    s_lshl_b32 s99, s98, 6
    s_lshl1_add_u32 s98, s97, s99
    s_lshl_b32 s97, s98, 12
    s_lshr_b32 s99, s11, 1
    s_lshl_b32 s98, s99, 6
    s_add_u32 s99, s97, s98
    s_lshl2_add_u32 s97, s96, s99
    s_add_u32 s98, s97, 1048576
    s_add_u32 s15, s98, 1024
    v_lshlrev_b32 v152, 16, v12
    v_and_b32 v153, s6, v12
    v_lshlrev_b32 v154, 16, v13
    v_and_b32 v155, s6, v13
    v_lshlrev_b32 v156, 16, v14
    v_and_b32 v157, s6, v14
    v_lshlrev_b32 v158, 16, v15
    v_and_b32 v159, s6, v15
    v_lshlrev_b32 v160, 16, v16
    v_and_b32 v161, s6, v16
    v_lshlrev_b32 v162, 16, v17
    v_and_b32 v163, s6, v17
    v_lshlrev_b32 v164, 16, v18
    v_and_b32 v165, s6, v18
    v_lshlrev_b32 v166, 16, v19
    v_and_b32 v167, s6, v19
    s_lshl3_add_u32 s96, s21, s3
    s_lshl_b32 s97, s96, 15
    s_add_u32 s19, s97, 8388608
    s_and_b32 s96, s3, 1
    s_lshr_b32 s97, s3, 1
    s_lshl_b32 s98, s97, 10
    s_lshl3_add_u32 s99, s96, s98
    s_add_u32 s14, s99, 159744
    v_and_b32 v4, 31, v1
    v_lshl_add_u32 v4, v4, 5, s14
    v_lshrrev_b32 v9, 5, v1
    v_lshl_add_u32 v4, v9, 2, v4
    v_and_b32 v7, 3, v1
    v_lshlrev_b32 v7, 4, v7
    v_lshrrev_b32 v9, 5, v1
    v_lshl_add_u32 v7, v9, 6, v7
    v_bfe_u32 v9, v1, 4, 1
    v_lshl_add_u32 v7, v9, 7, v7
    v_bfe_u32 v9, v1, 2, 2
    v_lshl_add_u32 v7, v9, 8, v7
    v_add_u32 v7, 159744, v7
    s_waitcnt vmcnt(2)
    s_waitcnt lgkmcnt(0)
    s_barrier
    s_cmp_lg_u32 s3, 0
    s_cbranch_scc1 L_PD
    v_mov_b32 v6, s4
    s_mov_b32 exec_hi, 0
    s_mov_b32 exec_lo, 65535
    buffer_store_dword v6, v5, s[32:35], s15 offen sc1
    s_mov_b64 exec, -1
L_PD:
    s_waitcnt vmcnt(1)
    v_bitop3_b32 v6, v29, v31, s4 bitop3:0x7e
    v_cmp_ne_u32 vcc, 0, v6
    s_cbranch_vccz L_MGOK
POLL_29:
    buffer_load_dwordx4 v[28:31], v2, s[32:35], s18 offen sc1
    s_waitcnt vmcnt(0)
    v_bitop3_b32 v6, v29, v31, s4 bitop3:0x7e
    v_cmp_ne_u32 vcc, 0, v6
    s_cbranch_vccz PDONE_30
    s_add_u32 s5, s5, 1
    s_cmp_lt_u32 s5, 200000
    s_cbranch_scc1 POLL_29
PDONE_30:
L_MGOK:
    ds_write2_b32 v4, v28, v30 offset0:0 offset1:4
    s_waitcnt lgkmcnt(0)
    s_barrier
    s_lshl_b32 s96, s2, 12
    s_lshr_b32 s97, s17, 6
    s_add_u32 s98, s96, s97
    s_add_u32 s99, s98, 1048576
    s_add_u32 s18, s99, 1024
    ds_read_b128 v[192:195], v7
    ds_read_b128 v[196:199], v7 offset:1024
    ds_read_b128 v[200:203], v7 offset:2048
    ds_read_b128 v[204:207], v7 offset:3072
    v_and_b32 v8, 3, v1
    v_lshlrev_b32 v8, 2, v8
    v_lshrrev_b32 v9, 5, v1
    v_lshl_add_u32 v8, v9, 4, v8
    v_bfe_u32 v9, v1, 4, 1
    v_lshl_add_u32 v8, v9, 5, v8
    v_bfe_u32 v9, v1, 2, 2
    v_lshl_add_u32 v8, v9, 6, v8
    v_add_u32 v8, 157184, v8
    s_lshl4_add_u32 s96, s21, s12
    s_lshl_b32 s97, s96, 6
    s_add_u32 s13, s97, 14155776
    s_waitcnt lgkmcnt(0)
    s_load_dwordx2 s[24:25], s[32:33], s18 offset:0 glc
    v_pk_add_f32 v[192:193], v[192:193], v[194:195]
    v_add_f32 v28, v192, v193
    v_pk_add_f32 v[196:197], v[196:197], v[198:199]
    v_add_f32 v29, v196, v197
    v_pk_add_f32 v[200:201], v[200:201], v[202:203]
    v_add_f32 v30, v200, v201
    v_pk_add_f32 v[204:205], v[204:205], v[206:207]
    v_add_f32 v31, v204, v205
    v_cvt_pk_bf16_f32 v28, 0, v28
    v_cvt_pk_bf16_f32 v29, 0, v29
    v_cvt_pk_bf16_f32 v30, 0, v30
    v_cvt_pk_bf16_f32 v31, 0, v31
    v_add_f32 v30, 1.0, v30
    v_lshlrev_b32 v32, 16, v32
    v_cvt_pk_bf16_f32 v30, 0, v30
    ds_write_b32 v8, v31
    v_mul_f32 v192, v30, v32
    v_cvt_pk_bf16_f32 v193, 0, v192
    v_sub_f32 v194, v192, v193
    v_add_f32_dpp v192, v192, v192 quad_perm:[1,0,3,2] row_mask:0xf bank_mask:0xf
    s_nop 1
    v_add_f32_dpp v192, v192, v192 quad_perm:[2,3,0,1] row_mask:0xf bank_mask:0xf
    s_nop 1
    v_add_f32_dpp v192, v192, v192 row_half_mirror row_mask:0xf bank_mask:0xf
    s_nop 1
    v_add_f32_dpp v192, v192, v192 row_ror:8 row_mask:0xf bank_mask:0xf
    v_mov_b32 v199, v192
    s_nop 1
    v_permlane16_swap_b32 v192, v199
    v_add_f32 v192, v192, v199
    v_mov_b32 v199, v192
    s_nop 1
    v_permlane32_swap_b32 v192, v199
    v_add_f32 v192, v192, v199
    v_mov_b32_dpp v196, v193 row_shl:1 row_mask:0xf bank_mask:0xf
    v_mov_b32_dpp v197, v194 row_shl:1 row_mask:0xf bank_mask:0xf
    v_mov_b32_dpp v198, v32 row_shl:1 row_mask:0xf bank_mask:0xf
    v_cvt_pk_bf16_f32 v196, v193, v196
    v_cvt_pk_bf16_f32 v197, v194, v197
    v_cvt_pk_bf16_f32 v198, v32, v198
    v_mov_b32 v193, s4
    v_mov_b32 v194, 0
    s_cmp_lg_u32 s3, 2
    s_cbranch_scc1 L_NOUP
    s_mov_b64 exec, 1
    buffer_store_dwordx2 v[192:193], v194, s[32:35], s13 offen sc1
    s_mov_b64 exec, -1
L_NOUP:
    v_mov_b32 v184, 0x3f803f80
    s_nop 1
    v_mov_b32_dpp v184, v196 row_newbcast:0 row_mask:0xf bank_mask:0x2
    s_nop 1
    v_mov_b32_dpp v184, v197 row_newbcast:0 row_mask:0xf bank_mask:0x4
    s_nop 1
    v_mov_b32_dpp v184, v198 row_newbcast:0 row_mask:0xf bank_mask:0x8
    v_mov_b32 v185, 0x3f803f80
    s_nop 1
    v_mov_b32_dpp v185, v196 row_newbcast:2 row_mask:0xf bank_mask:0x2
    s_nop 1
    v_mov_b32_dpp v185, v197 row_newbcast:2 row_mask:0xf bank_mask:0x4
    s_nop 1
    v_mov_b32_dpp v185, v198 row_newbcast:2 row_mask:0xf bank_mask:0x8
    v_mov_b32 v186, 0x3f803f80
    s_nop 1
    v_mov_b32_dpp v186, v196 row_newbcast:4 row_mask:0xf bank_mask:0x2
    s_nop 1
    v_mov_b32_dpp v186, v197 row_newbcast:4 row_mask:0xf bank_mask:0x4
    s_nop 1
    v_mov_b32_dpp v186, v198 row_newbcast:4 row_mask:0xf bank_mask:0x8
    v_mov_b32 v187, 0x3f803f80
    s_nop 1
    v_mov_b32_dpp v187, v196 row_newbcast:6 row_mask:0xf bank_mask:0x2
    s_nop 1
    v_mov_b32_dpp v187, v197 row_newbcast:6 row_mask:0xf bank_mask:0x4
    s_nop 1
    v_mov_b32_dpp v187, v198 row_newbcast:6 row_mask:0xf bank_mask:0x8
    v_mov_b32 v188, 0x3f803f80
    s_nop 1
    v_mov_b32_dpp v188, v196 row_newbcast:8 row_mask:0xf bank_mask:0x2
    s_nop 1
    v_mov_b32_dpp v188, v197 row_newbcast:8 row_mask:0xf bank_mask:0x4
    s_nop 1
    v_mov_b32_dpp v188, v198 row_newbcast:8 row_mask:0xf bank_mask:0x8
    v_mov_b32 v189, 0x3f803f80
    s_nop 1
    v_mov_b32_dpp v189, v196 row_newbcast:10 row_mask:0xf bank_mask:0x2
    s_nop 1
    v_mov_b32_dpp v189, v197 row_newbcast:10 row_mask:0xf bank_mask:0x4
    s_nop 1
    v_mov_b32_dpp v189, v198 row_newbcast:10 row_mask:0xf bank_mask:0x8
    v_mov_b32 v190, 0x3f803f80
    s_nop 1
    v_mov_b32_dpp v190, v196 row_newbcast:12 row_mask:0xf bank_mask:0x2
    s_nop 1
    v_mov_b32_dpp v190, v197 row_newbcast:12 row_mask:0xf bank_mask:0x4
    s_nop 1
    v_mov_b32_dpp v190, v198 row_newbcast:12 row_mask:0xf bank_mask:0x8
    v_mov_b32 v191, 0x3f803f80
    s_nop 1
    v_mov_b32_dpp v191, v196 row_newbcast:14 row_mask:0xf bank_mask:0x2
    s_nop 1
    v_mov_b32_dpp v191, v197 row_newbcast:14 row_mask:0xf bank_mask:0x4
    s_nop 1
    v_mov_b32_dpp v191, v198 row_newbcast:14 row_mask:0xf bank_mask:0x8
    v_mov_b32 v42, v29
    v_mov_b32 v43, v31
    v_mov_b32 v33, v30
    v_mov_b32_dpp v136, v28 row_newbcast:0 row_mask:0xf bank_mask:0xf
    v_mov_b32_dpp v137, v28 row_newbcast:1 row_mask:0xf bank_mask:0xf
    v_mov_b32_dpp v138, v28 row_newbcast:2 row_mask:0xf bank_mask:0xf
    v_mov_b32_dpp v139, v28 row_newbcast:3 row_mask:0xf bank_mask:0xf
    v_mov_b32_dpp v140, v28 row_newbcast:4 row_mask:0xf bank_mask:0xf
    v_mov_b32_dpp v141, v28 row_newbcast:5 row_mask:0xf bank_mask:0xf
    v_mov_b32_dpp v142, v28 row_newbcast:6 row_mask:0xf bank_mask:0xf
    v_mov_b32_dpp v143, v28 row_newbcast:7 row_mask:0xf bank_mask:0xf
    v_mov_b32_dpp v144, v28 row_newbcast:8 row_mask:0xf bank_mask:0xf
    v_mov_b32_dpp v145, v28 row_newbcast:9 row_mask:0xf bank_mask:0xf
    v_mov_b32_dpp v146, v28 row_newbcast:10 row_mask:0xf bank_mask:0xf
    v_mov_b32_dpp v147, v28 row_newbcast:11 row_mask:0xf bank_mask:0xf
    v_mov_b32_dpp v148, v28 row_newbcast:12 row_mask:0xf bank_mask:0xf
    v_mov_b32_dpp v149, v28 row_newbcast:13 row_mask:0xf bank_mask:0xf
    v_mov_b32_dpp v150, v28 row_newbcast:14 row_mask:0xf bank_mask:0xf
    v_mov_b32_dpp v151, v28 row_newbcast:15 row_mask:0xf bank_mask:0xf
    s_branch SCHK_32
SPOLL_31:
    s_load_dwordx2 s[24:25], s[32:33], s18 offset:0 glc
SCHK_32:
    s_add_u32 s5, s5, 1
    s_cmp_ge_u32 s5, 200000
    s_waitcnt lgkmcnt(0)
    s_cbranch_scc1 SDONE_33
    s_cmp_lg_u32 s24, s4
    s_cbranch_scc1 SPOLL_31
    s_cmp_lg_u32 s25, s4
    s_cbranch_scc1 SPOLL_31
SDONE_33:
    s_add_u32 s20, s17, s19
    buffer_load_dwordx4 v[224:227], v2, s[32:35], s20 offen sc1
    ds_read_b64_tr_b16 v[192:193], v36
    ds_read_b64_tr_b16 v[194:195], v36 offset:512
    ds_read_b64_tr_b16 v[196:197], v37
    ds_read_b64_tr_b16 v[198:199], v37 offset:512
    ds_read_b64_tr_b16 v[200:201], v38
    ds_read_b64_tr_b16 v[202:203], v38 offset:512
    ds_read_b64_tr_b16 v[204:205], v39
    ds_read_b64_tr_b16 v[206:207], v39 offset:512
    ds_read_b64_tr_b16 v[208:209], v36 offset:4096
    ds_read_b64_tr_b16 v[210:211], v36 offset:4608
    ds_read_b64_tr_b16 v[212:213], v37 offset:4096
    ds_read_b64_tr_b16 v[214:215], v37 offset:4608
    ds_read_b64_tr_b16 v[216:217], v38 offset:4096
    ds_read_b64_tr_b16 v[218:219], v38 offset:4608
    buffer_load_dwordx4 v[228:231], v2, s[32:35], s20 offen offset:1024 sc1
    buffer_load_dwordx4 v[232:235], v2, s[32:35], s20 offen offset:2048 sc1
    buffer_load_dwordx4 v[236:239], v2, s[32:35], s20 offen offset:3072 sc1
    s_barrier
    s_xor_b32 s96, s17, 4096
    s_add_u32 s20, s96, s19
    buffer_load_dwordx4 v[240:243], v2, s[32:35], s20 offen sc1
    buffer_load_dwordx4 v[244:247], v2, s[32:35], s20 offen offset:1024 sc1
    buffer_load_dwordx4 v[44:47], v2, s[32:35], s20 offen offset:2048 sc1
    buffer_load_dwordx4 v[48:51], v2, s[32:35], s20 offen offset:3072 sc1
    s_lshl_b32 s96, s21, 10
    s_add_u32 s13, s96, 14155776
    v_and_b32 v10, 15, v1
    v_lshlrev_b32 v10, 6, v10
    s_cmp_lt_u32 s3, 4
    s_cbranch_scc1 L_G2P0
    s_setprio 1
L_G2P0:
    s_waitcnt vmcnt(7)
    s_waitcnt lgkmcnt(6)
    v_mfma_f32_16x16x32_bf16 v[120:123], v[192:195], v[224:227], 0
    ds_read_b64_tr_b16 v[220:221], v39 offset:4096
    ds_read_b64_tr_b16 v[222:223], v39 offset:4608
    v_mfma_f32_16x16x32_bf16 v[124:127], v[196:199], v[224:227], 0
    ds_read_b64_tr_b16 v[192:193], v36 offset:8192
    ds_read_b64_tr_b16 v[194:195], v36 offset:8704
    v_mfma_f32_16x16x32_bf16 v[128:131], v[200:203], v[224:227], 0
    ds_read_b64_tr_b16 v[196:197], v37 offset:8192
    ds_read_b64_tr_b16 v[198:199], v37 offset:8704
    v_mfma_f32_16x16x32_bf16 v[132:135], v[204:207], v[224:227], 0
    ds_read_b64_tr_b16 v[200:201], v38 offset:8192
    ds_read_b64_tr_b16 v[202:203], v38 offset:8704
    s_xor_b32 s96, s17, 8192
    s_add_u32 s20, s96, s19
    buffer_load_dwordx4 v[224:227], v2, s[32:35], s20 offen sc1
    s_waitcnt vmcnt(7)
    s_waitcnt lgkmcnt(6)
    v_mfma_f32_16x16x32_bf16 v[120:123], v[208:211], v[228:231], v[120:123]
    ds_read_b64_tr_b16 v[204:205], v39 offset:8192
    ds_read_b64_tr_b16 v[206:207], v39 offset:8704
    v_mfma_f32_16x16x32_bf16 v[124:127], v[212:215], v[228:231], v[124:127]
    ds_read_b64_tr_b16 v[208:209], v36 offset:12288
    ds_read_b64_tr_b16 v[210:211], v36 offset:12800
    v_xor_b32 v36, 16384, v36
    v_mfma_f32_16x16x32_bf16 v[128:131], v[216:219], v[228:231], v[128:131]
    ds_read_b64_tr_b16 v[212:213], v37 offset:12288
    ds_read_b64_tr_b16 v[214:215], v37 offset:12800
    v_xor_b32 v37, 16384, v37
    v_mfma_f32_16x16x32_bf16 v[132:135], v[220:223], v[228:231], v[132:135]
    ds_read_b64_tr_b16 v[216:217], v38 offset:12288
    ds_read_b64_tr_b16 v[218:219], v38 offset:12800
    v_xor_b32 v38, 16384, v38
    buffer_load_dwordx4 v[228:231], v2, s[32:35], s20 offen offset:1024 sc1
    s_waitcnt vmcnt(7)
    s_waitcnt lgkmcnt(6)
    v_mfma_f32_16x16x32_bf16 v[120:123], v[192:195], v[232:235], v[120:123]
    ds_read_b64_tr_b16 v[220:221], v39 offset:12288
    ds_read_b64_tr_b16 v[222:223], v39 offset:12800
    v_xor_b32 v39, 16384, v39
    v_mfma_f32_16x16x32_bf16 v[124:127], v[196:199], v[232:235], v[124:127]
    ds_read_b64_tr_b16 v[192:193], v36
    ds_read_b64_tr_b16 v[194:195], v36 offset:512
    v_mfma_f32_16x16x32_bf16 v[128:131], v[200:203], v[232:235], v[128:131]
    ds_read_b64_tr_b16 v[196:197], v37
    ds_read_b64_tr_b16 v[198:199], v37 offset:512
    v_mfma_f32_16x16x32_bf16 v[132:135], v[204:207], v[232:235], v[132:135]
    ds_read_b64_tr_b16 v[200:201], v38
    ds_read_b64_tr_b16 v[202:203], v38 offset:512
    buffer_load_dwordx4 v[232:235], v2, s[32:35], s20 offen offset:2048 sc1
    s_waitcnt vmcnt(7)
    s_waitcnt lgkmcnt(6)
    v_mfma_f32_16x16x32_bf16 v[120:123], v[208:211], v[236:239], v[120:123]
    ds_read_b64_tr_b16 v[204:205], v39
    ds_read_b64_tr_b16 v[206:207], v39 offset:512
    v_mfma_f32_16x16x32_bf16 v[124:127], v[212:215], v[236:239], v[124:127]
    ds_read_b64_tr_b16 v[208:209], v36 offset:4096
    ds_read_b64_tr_b16 v[210:211], v36 offset:4608
    v_mfma_f32_16x16x32_bf16 v[128:131], v[216:219], v[236:239], v[128:131]
    ds_read_b64_tr_b16 v[212:213], v37 offset:4096
    ds_read_b64_tr_b16 v[214:215], v37 offset:4608
    v_mfma_f32_16x16x32_bf16 v[132:135], v[220:223], v[236:239], v[132:135]
    ds_read_b64_tr_b16 v[216:217], v38 offset:4096
    ds_read_b64_tr_b16 v[218:219], v38 offset:4608
    buffer_load_dwordx4 v[236:239], v2, s[32:35], s20 offen offset:3072 sc1
    s_waitcnt vmcnt(7)
    s_waitcnt lgkmcnt(6)
    v_mfma_f32_16x16x32_bf16 v[120:123], v[192:195], v[240:243], v[120:123]
    ds_read_b64_tr_b16 v[220:221], v39 offset:4096
    ds_read_b64_tr_b16 v[222:223], v39 offset:4608
    v_mfma_f32_16x16x32_bf16 v[124:127], v[196:199], v[240:243], v[124:127]
    ds_read_b64_tr_b16 v[192:193], v36 offset:8192
    ds_read_b64_tr_b16 v[194:195], v36 offset:8704
    v_mfma_f32_16x16x32_bf16 v[128:131], v[200:203], v[240:243], v[128:131]
    ds_read_b64_tr_b16 v[196:197], v37 offset:8192
    ds_read_b64_tr_b16 v[198:199], v37 offset:8704
    v_mfma_f32_16x16x32_bf16 v[132:135], v[204:207], v[240:243], v[132:135]
    ds_read_b64_tr_b16 v[200:201], v38 offset:8192
    ds_read_b64_tr_b16 v[202:203], v38 offset:8704
    s_xor_b32 s96, s17, 12288
    s_add_u32 s20, s96, s19
    buffer_load_dwordx4 v[240:243], v2, s[32:35], s20 offen sc1
    s_waitcnt vmcnt(7)
    s_waitcnt lgkmcnt(6)
    v_mfma_f32_16x16x32_bf16 v[120:123], v[208:211], v[244:247], v[120:123]
    ds_read_b64_tr_b16 v[204:205], v39 offset:8192
    ds_read_b64_tr_b16 v[206:207], v39 offset:8704
    v_mfma_f32_16x16x32_bf16 v[124:127], v[212:215], v[244:247], v[124:127]
    ds_read_b64_tr_b16 v[208:209], v36 offset:12288
    ds_read_b64_tr_b16 v[210:211], v36 offset:12800
    v_xor_b32 v36, 49152, v36
    v_mfma_f32_16x16x32_bf16 v[128:131], v[216:219], v[244:247], v[128:131]
    ds_read_b64_tr_b16 v[212:213], v37 offset:12288
    ds_read_b64_tr_b16 v[214:215], v37 offset:12800
    v_xor_b32 v37, 49152, v37
    v_mfma_f32_16x16x32_bf16 v[132:135], v[220:223], v[244:247], v[132:135]
    ds_read_b64_tr_b16 v[216:217], v38 offset:12288
    ds_read_b64_tr_b16 v[218:219], v38 offset:12800
    v_xor_b32 v38, 49152, v38
    buffer_load_dwordx4 v[244:247], v2, s[32:35], s20 offen offset:1024 sc1
    s_waitcnt vmcnt(7)
    s_waitcnt lgkmcnt(6)
    v_mfma_f32_16x16x32_bf16 v[120:123], v[192:195], v[44:47], v[120:123]
    ds_read_b64_tr_b16 v[220:221], v39 offset:12288
    ds_read_b64_tr_b16 v[222:223], v39 offset:12800
    v_xor_b32 v39, 49152, v39
    v_mfma_f32_16x16x32_bf16 v[124:127], v[196:199], v[44:47], v[124:127]
    ds_read_b64_tr_b16 v[192:193], v36
    ds_read_b64_tr_b16 v[194:195], v36 offset:512
    v_mfma_f32_16x16x32_bf16 v[128:131], v[200:203], v[44:47], v[128:131]
    ds_read_b64_tr_b16 v[196:197], v37
    ds_read_b64_tr_b16 v[198:199], v37 offset:512
    v_mfma_f32_16x16x32_bf16 v[132:135], v[204:207], v[44:47], v[132:135]
    ds_read_b64_tr_b16 v[200:201], v38
    ds_read_b64_tr_b16 v[202:203], v38 offset:512
    buffer_load_dwordx4 v[44:47], v2, s[32:35], s20 offen offset:2048 sc1
    s_waitcnt vmcnt(7)
    s_waitcnt lgkmcnt(6)
    v_mfma_f32_16x16x32_bf16 v[120:123], v[208:211], v[48:51], v[120:123]
    ds_read_b64_tr_b16 v[204:205], v39
    ds_read_b64_tr_b16 v[206:207], v39 offset:512
    v_mfma_f32_16x16x32_bf16 v[124:127], v[212:215], v[48:51], v[124:127]
    ds_read_b64_tr_b16 v[208:209], v36 offset:4096
    ds_read_b64_tr_b16 v[210:211], v36 offset:4608
    v_mfma_f32_16x16x32_bf16 v[128:131], v[216:219], v[48:51], v[128:131]
    ds_read_b64_tr_b16 v[212:213], v37 offset:4096
    ds_read_b64_tr_b16 v[214:215], v37 offset:4608
    v_mfma_f32_16x16x32_bf16 v[132:135], v[220:223], v[48:51], v[132:135]
    ds_read_b64_tr_b16 v[216:217], v38 offset:4096
    ds_read_b64_tr_b16 v[218:219], v38 offset:4608
    buffer_load_dwordx4 v[48:51], v2, s[32:35], s20 offen offset:3072 sc1
    s_waitcnt vmcnt(7)
    s_waitcnt lgkmcnt(6)
    v_mfma_f32_16x16x32_bf16 v[120:123], v[192:195], v[224:227], v[120:123]
    ds_read_b64_tr_b16 v[220:221], v39 offset:4096
    ds_read_b64_tr_b16 v[222:223], v39 offset:4608
    v_mfma_f32_16x16x32_bf16 v[124:127], v[196:199], v[224:227], v[124:127]
    ds_read_b64_tr_b16 v[192:193], v36 offset:8192
    ds_read_b64_tr_b16 v[194:195], v36 offset:8704
    v_mfma_f32_16x16x32_bf16 v[128:131], v[200:203], v[224:227], v[128:131]
    ds_read_b64_tr_b16 v[196:197], v37 offset:8192
    ds_read_b64_tr_b16 v[198:199], v37 offset:8704
    v_mfma_f32_16x16x32_bf16 v[132:135], v[204:207], v[224:227], v[132:135]
    ds_read_b64_tr_b16 v[200:201], v38 offset:8192
    ds_read_b64_tr_b16 v[202:203], v38 offset:8704
    s_xor_b32 s96, s17, 16384
    s_add_u32 s20, s96, s19
    buffer_load_dwordx4 v[224:227], v2, s[32:35], s20 offen sc1
    s_waitcnt vmcnt(7)
    s_waitcnt lgkmcnt(6)
    v_mfma_f32_16x16x32_bf16 v[120:123], v[208:211], v[228:231], v[120:123]
    ds_read_b64_tr_b16 v[204:205], v39 offset:8192
    ds_read_b64_tr_b16 v[206:207], v39 offset:8704
    v_mfma_f32_16x16x32_bf16 v[124:127], v[212:215], v[228:231], v[124:127]
    ds_read_b64_tr_b16 v[208:209], v36 offset:12288
    ds_read_b64_tr_b16 v[210:211], v36 offset:12800
    v_xor_b32 v36, 16384, v36
    v_mfma_f32_16x16x32_bf16 v[128:131], v[216:219], v[228:231], v[128:131]
    ds_read_b64_tr_b16 v[212:213], v37 offset:12288
    ds_read_b64_tr_b16 v[214:215], v37 offset:12800
    v_xor_b32 v37, 16384, v37
L_PAD8:
    s_cbranch_execz L_RET8
    v_mfma_f32_16x16x32_bf16 v[132:135], v[220:223], v[228:231], v[132:135]
    ds_read_b64_tr_b16 v[216:217], v38 offset:12288
    ds_read_b64_tr_b16 v[218:219], v38 offset:12800
    v_xor_b32 v38, 16384, v38
    buffer_load_dwordx4 v[228:231], v2, s[32:35], s20 offen offset:1024 sc1
    s_waitcnt vmcnt(7)
    s_waitcnt lgkmcnt(6)
    v_mfma_f32_16x16x32_bf16 v[120:123], v[192:195], v[232:235], v[120:123]
    ds_read_b64_tr_b16 v[220:221], v39 offset:12288
    ds_read_b64_tr_b16 v[222:223], v39 offset:12800
    v_xor_b32 v39, 16384, v39
    v_mfma_f32_16x16x32_bf16 v[124:127], v[196:199], v[232:235], v[124:127]
    ds_read_b64_tr_b16 v[192:193], v36
    ds_read_b64_tr_b16 v[194:195], v36 offset:512
    v_mfma_f32_16x16x32_bf16 v[128:131], v[200:203], v[232:235], v[128:131]
    ds_read_b64_tr_b16 v[196:197], v37
    ds_read_b64_tr_b16 v[198:199], v37 offset:512
    v_mfma_f32_16x16x32_bf16 v[132:135], v[204:207], v[232:235], v[132:135]
    ds_read_b64_tr_b16 v[200:201], v38
    ds_read_b64_tr_b16 v[202:203], v38 offset:512
    buffer_load_dwordx4 v[232:235], v2, s[32:35], s20 offen offset:2048 sc1
    s_waitcnt vmcnt(7)
    s_waitcnt lgkmcnt(6)
    v_mfma_f32_16x16x32_bf16 v[120:123], v[208:211], v[236:239], v[120:123]
    ds_read_b64_tr_b16 v[204:205], v39
    ds_read_b64_tr_b16 v[206:207], v39 offset:512
    v_mfma_f32_16x16x32_bf16 v[124:127], v[212:215], v[236:239], v[124:127]
    ds_read_b64_tr_b16 v[208:209], v36 offset:4096
    ds_read_b64_tr_b16 v[210:211], v36 offset:4608
    v_mfma_f32_16x16x32_bf16 v[128:131], v[216:219], v[236:239], v[128:131]
    ds_read_b64_tr_b16 v[212:213], v37 offset:4096
    ds_read_b64_tr_b16 v[214:215], v37 offset:4608
    v_mfma_f32_16x16x32_bf16 v[132:135], v[220:223], v[236:239], v[132:135]
    ds_read_b64_tr_b16 v[216:217], v38 offset:4096
    ds_read_b64_tr_b16 v[218:219], v38 offset:4608
    buffer_load_dwordx4 v[236:239], v2, s[32:35], s20 offen offset:3072 sc1
    s_waitcnt vmcnt(7)
    s_waitcnt lgkmcnt(6)
    v_mfma_f32_16x16x32_bf16 v[120:123], v[192:195], v[240:243], v[120:123]
    ds_read_b64_tr_b16 v[220:221], v39 offset:4096
    ds_read_b64_tr_b16 v[222:223], v39 offset:4608
    v_mfma_f32_16x16x32_bf16 v[124:127], v[196:199], v[240:243], v[124:127]
    ds_read_b64_tr_b16 v[192:193], v36 offset:8192
    ds_read_b64_tr_b16 v[194:195], v36 offset:8704
    v_mfma_f32_16x16x32_bf16 v[128:131], v[200:203], v[240:243], v[128:131]
    ds_read_b64_tr_b16 v[196:197], v37 offset:8192
    ds_read_b64_tr_b16 v[198:199], v37 offset:8704
    v_mfma_f32_16x16x32_bf16 v[132:135], v[204:207], v[240:243], v[132:135]
    ds_read_b64_tr_b16 v[200:201], v38 offset:8192
    ds_read_b64_tr_b16 v[202:203], v38 offset:8704
    s_xor_b32 s96, s17, 20480
    s_add_u32 s20, s96, s19
    buffer_load_dwordx4 v[240:243], v2, s[32:35], s20 offen sc1
    s_waitcnt vmcnt(7)
    s_waitcnt lgkmcnt(6)
    v_mfma_f32_16x16x32_bf16 v[120:123], v[208:211], v[244:247], v[120:123]
    ds_read_b64_tr_b16 v[204:205], v39 offset:8192
    ds_read_b64_tr_b16 v[206:207], v39 offset:8704
    v_mfma_f32_16x16x32_bf16 v[124:127], v[212:215], v[244:247], v[124:127]
    ds_read_b64_tr_b16 v[208:209], v36 offset:12288
    ds_read_b64_tr_b16 v[210:211], v36 offset:12800
    v_xor_b32 v36, 114688, v36
    v_mfma_f32_16x16x32_bf16 v[128:131], v[216:219], v[244:247], v[128:131]
    ds_read_b64_tr_b16 v[212:213], v37 offset:12288
    ds_read_b64_tr_b16 v[214:215], v37 offset:12800
    v_xor_b32 v37, 114688, v37
    v_mfma_f32_16x16x32_bf16 v[132:135], v[220:223], v[244:247], v[132:135]
    ds_read_b64_tr_b16 v[216:217], v38 offset:12288
    ds_read_b64_tr_b16 v[218:219], v38 offset:12800
    v_xor_b32 v38, 114688, v38
    buffer_load_dwordx4 v[244:247], v2, s[32:35], s20 offen offset:1024 sc1
    s_waitcnt vmcnt(7)
    s_waitcnt lgkmcnt(6)
    v_mfma_f32_16x16x32_bf16 v[120:123], v[192:195], v[44:47], v[120:123]
    ds_read_b64_tr_b16 v[220:221], v39 offset:12288
    ds_read_b64_tr_b16 v[222:223], v39 offset:12800
    v_xor_b32 v39, 114688, v39
    v_mfma_f32_16x16x32_bf16 v[124:127], v[196:199], v[44:47], v[124:127]
    ds_read_b64_tr_b16 v[192:193], v36
    ds_read_b64_tr_b16 v[194:195], v36 offset:512
    v_mfma_f32_16x16x32_bf16 v[128:131], v[200:203], v[44:47], v[128:131]
    ds_read_b64_tr_b16 v[196:197], v37
    ds_read_b64_tr_b16 v[198:199], v37 offset:512
    v_mfma_f32_16x16x32_bf16 v[132:135], v[204:207], v[44:47], v[132:135]
    ds_read_b64_tr_b16 v[200:201], v38
    ds_read_b64_tr_b16 v[202:203], v38 offset:512
    buffer_load_dwordx4 v[44:47], v2, s[32:35], s20 offen offset:2048 sc1
    s_waitcnt vmcnt(7)
    s_waitcnt lgkmcnt(6)
    v_mfma_f32_16x16x32_bf16 v[120:123], v[208:211], v[48:51], v[120:123]
    ds_read_b64_tr_b16 v[204:205], v39
    ds_read_b64_tr_b16 v[206:207], v39 offset:512
    v_mfma_f32_16x16x32_bf16 v[124:127], v[212:215], v[48:51], v[124:127]
    ds_read_b64_tr_b16 v[208:209], v36 offset:4096
    ds_read_b64_tr_b16 v[210:211], v36 offset:4608
    v_mfma_f32_16x16x32_bf16 v[128:131], v[216:219], v[48:51], v[128:131]
    ds_read_b64_tr_b16 v[212:213], v37 offset:4096
    ds_read_b64_tr_b16 v[214:215], v37 offset:4608
    v_mfma_f32_16x16x32_bf16 v[132:135], v[220:223], v[48:51], v[132:135]
    ds_read_b64_tr_b16 v[216:217], v38 offset:4096
    ds_read_b64_tr_b16 v[218:219], v38 offset:4608
    buffer_load_dwordx4 v[48:51], v2, s[32:35], s20 offen offset:3072 sc1
    s_waitcnt vmcnt(7)
    s_waitcnt lgkmcnt(6)
    v_mfma_f32_16x16x32_bf16 v[120:123], v[192:195], v[224:227], v[120:123]
    ds_read_b64_tr_b16 v[220:221], v39 offset:4096
    ds_read_b64_tr_b16 v[222:223], v39 offset:4608
    v_mfma_f32_16x16x32_bf16 v[124:127], v[196:199], v[224:227], v[124:127]
    ds_read_b64_tr_b16 v[192:193], v36 offset:8192
    ds_read_b64_tr_b16 v[194:195], v36 offset:8704
    v_mfma_f32_16x16x32_bf16 v[128:131], v[200:203], v[224:227], v[128:131]
    ds_read_b64_tr_b16 v[196:197], v37 offset:8192
    ds_read_b64_tr_b16 v[198:199], v37 offset:8704
    v_mfma_f32_16x16x32_bf16 v[132:135], v[204:207], v[224:227], v[132:135]
    ds_read_b64_tr_b16 v[200:201], v38 offset:8192
    ds_read_b64_tr_b16 v[202:203], v38 offset:8704
    s_xor_b32 s96, s17, 24576
    s_add_u32 s20, s96, s19
    buffer_load_dwordx4 v[224:227], v2, s[32:35], s20 offen sc1
    s_waitcnt vmcnt(7)
    s_waitcnt lgkmcnt(6)
    v_mfma_f32_16x16x32_bf16 v[120:123], v[208:211], v[228:231], v[120:123]
    ds_read_b64_tr_b16 v[204:205], v39 offset:8192
    ds_read_b64_tr_b16 v[206:207], v39 offset:8704
    v_mfma_f32_16x16x32_bf16 v[124:127], v[212:215], v[228:231], v[124:127]
    ds_read_b64_tr_b16 v[208:209], v36 offset:12288
    ds_read_b64_tr_b16 v[210:211], v36 offset:12800
    v_xor_b32 v36, 16384, v36
    v_mfma_f32_16x16x32_bf16 v[128:131], v[216:219], v[228:231], v[128:131]
    ds_read_b64_tr_b16 v[212:213], v37 offset:12288
    ds_read_b64_tr_b16 v[214:215], v37 offset:12800
    v_xor_b32 v37, 16384, v37
    v_mfma_f32_16x16x32_bf16 v[132:135], v[220:223], v[228:231], v[132:135]
    ds_read_b64_tr_b16 v[216:217], v38 offset:12288
    ds_read_b64_tr_b16 v[218:219], v38 offset:12800
    v_xor_b32 v38, 16384, v38
    buffer_load_dwordx4 v[228:231], v2, s[32:35], s20 offen offset:1024 sc1
    s_waitcnt vmcnt(7)
    s_waitcnt lgkmcnt(6)
    v_mfma_f32_16x16x32_bf16 v[120:123], v[192:195], v[232:235], v[120:123]
    ds_read_b64_tr_b16 v[220:221], v39 offset:12288
    ds_read_b64_tr_b16 v[222:223], v39 offset:12800
    v_xor_b32 v39, 16384, v39
    v_mfma_f32_16x16x32_bf16 v[124:127], v[196:199], v[232:235], v[124:127]
    ds_read_b64_tr_b16 v[192:193], v36
    ds_read_b64_tr_b16 v[194:195], v36 offset:512
    v_mfma_f32_16x16x32_bf16 v[128:131], v[200:203], v[232:235], v[128:131]
    ds_read_b64_tr_b16 v[196:197], v37
    ds_read_b64_tr_b16 v[198:199], v37 offset:512
    v_mfma_f32_16x16x32_bf16 v[132:135], v[204:207], v[232:235], v[132:135]
    ds_read_b64_tr_b16 v[200:201], v38
    ds_read_b64_tr_b16 v[202:203], v38 offset:512
    buffer_load_dwordx4 v[232:235], v2, s[32:35], s20 offen offset:2048 sc1
    s_waitcnt vmcnt(7)
    s_waitcnt lgkmcnt(6)
    v_mfma_f32_16x16x32_bf16 v[120:123], v[208:211], v[236:239], v[120:123]
    ds_read_b64_tr_b16 v[204:205], v39
    ds_read_b64_tr_b16 v[206:207], v39 offset:512
    v_mfma_f32_16x16x32_bf16 v[124:127], v[212:215], v[236:239], v[124:127]
    ds_read_b64_tr_b16 v[208:209], v36 offset:4096
    ds_read_b64_tr_b16 v[210:211], v36 offset:4608
    v_mfma_f32_16x16x32_bf16 v[128:131], v[216:219], v[236:239], v[128:131]
    ds_read_b64_tr_b16 v[212:213], v37 offset:4096
    ds_read_b64_tr_b16 v[214:215], v37 offset:4608
    v_mfma_f32_16x16x32_bf16 v[132:135], v[220:223], v[236:239], v[132:135]
    ds_read_b64_tr_b16 v[216:217], v38 offset:4096
    ds_read_b64_tr_b16 v[218:219], v38 offset:4608
    buffer_load_dwordx4 v[236:239], v2, s[32:35], s20 offen offset:3072 sc1
    s_waitcnt vmcnt(7)
    s_waitcnt lgkmcnt(6)
    v_mfma_f32_16x16x32_bf16 v[120:123], v[192:195], v[240:243], v[120:123]
    ds_read_b64_tr_b16 v[220:221], v39 offset:4096
    ds_read_b64_tr_b16 v[222:223], v39 offset:4608
    v_mfma_f32_16x16x32_bf16 v[124:127], v[196:199], v[240:243], v[124:127]
    ds_read_b64_tr_b16 v[192:193], v36 offset:8192
    ds_read_b64_tr_b16 v[194:195], v36 offset:8704
    v_mfma_f32_16x16x32_bf16 v[128:131], v[200:203], v[240:243], v[128:131]
    ds_read_b64_tr_b16 v[196:197], v37 offset:8192
    ds_read_b64_tr_b16 v[198:199], v37 offset:8704
    v_mfma_f32_16x16x32_bf16 v[132:135], v[204:207], v[240:243], v[132:135]
    ds_read_b64_tr_b16 v[200:201], v38 offset:8192
    ds_read_b64_tr_b16 v[202:203], v38 offset:8704
    s_xor_b32 s96, s17, 28672
    s_add_u32 s20, s96, s19
    buffer_load_dwordx4 v[240:243], v2, s[32:35], s20 offen sc1
    s_waitcnt vmcnt(7)
    s_waitcnt lgkmcnt(6)
    v_mfma_f32_16x16x32_bf16 v[120:123], v[208:211], v[244:247], v[120:123]
    ds_read_b64_tr_b16 v[204:205], v39 offset:8192
    ds_read_b64_tr_b16 v[206:207], v39 offset:8704
    v_mfma_f32_16x16x32_bf16 v[124:127], v[212:215], v[244:247], v[124:127]
    ds_read_b64_tr_b16 v[208:209], v36 offset:12288
    ds_read_b64_tr_b16 v[210:211], v36 offset:12800
    v_xor_b32 v36, 49152, v36
    v_mfma_f32_16x16x32_bf16 v[128:131], v[216:219], v[244:247], v[128:131]
    ds_read_b64_tr_b16 v[212:213], v37 offset:12288
    ds_read_b64_tr_b16 v[214:215], v37 offset:12800
    v_xor_b32 v37, 49152, v37
    v_mfma_f32_16x16x32_bf16 v[132:135], v[220:223], v[244:247], v[132:135]
    ds_read_b64_tr_b16 v[216:217], v38 offset:12288
    ds_read_b64_tr_b16 v[218:219], v38 offset:12800
    v_xor_b32 v38, 49152, v38
    buffer_load_dwordx4 v[244:247], v2, s[32:35], s20 offen offset:1024 sc1
    s_waitcnt vmcnt(7)
    s_waitcnt lgkmcnt(6)
    v_mfma_f32_16x16x32_bf16 v[120:123], v[192:195], v[44:47], v[120:123]
    ds_read_b64_tr_b16 v[220:221], v39 offset:12288
    ds_read_b64_tr_b16 v[222:223], v39 offset:12800
    v_xor_b32 v39, 49152, v39
    v_mfma_f32_16x16x32_bf16 v[124:127], v[196:199], v[44:47], v[124:127]
    ds_read_b64_tr_b16 v[192:193], v36
    ds_read_b64_tr_b16 v[194:195], v36 offset:512
    v_mfma_f32_16x16x32_bf16 v[128:131], v[200:203], v[44:47], v[128:131]
    ds_read_b64_tr_b16 v[196:197], v37
    ds_read_b64_tr_b16 v[198:199], v37 offset:512
    v_mfma_f32_16x16x32_bf16 v[132:135], v[204:207], v[44:47], v[132:135]
    ds_read_b64_tr_b16 v[200:201], v38
    ds_read_b64_tr_b16 v[202:203], v38 offset:512
    buffer_load_dwordx4 v[44:47], v2, s[32:35], s20 offen offset:2048 sc1
    s_waitcnt vmcnt(7)
    s_waitcnt lgkmcnt(6)
    v_mfma_f32_16x16x32_bf16 v[120:123], v[208:211], v[48:51], v[120:123]
    ds_read_b64_tr_b16 v[204:205], v39
    ds_read_b64_tr_b16 v[206:207], v39 offset:512
    v_mfma_f32_16x16x32_bf16 v[124:127], v[212:215], v[48:51], v[124:127]
    ds_read_b64_tr_b16 v[208:209], v36 offset:4096
    ds_read_b64_tr_b16 v[210:211], v36 offset:4608
    v_mfma_f32_16x16x32_bf16 v[128:131], v[216:219], v[48:51], v[128:131]
    ds_read_b64_tr_b16 v[212:213], v37 offset:4096
    ds_read_b64_tr_b16 v[214:215], v37 offset:4608
    v_mfma_f32_16x16x32_bf16 v[132:135], v[220:223], v[48:51], v[132:135]
    ds_read_b64_tr_b16 v[216:217], v38 offset:4096
    ds_read_b64_tr_b16 v[218:219], v38 offset:4608
    buffer_load_dwordx4 v[48:51], v2, s[32:35], s20 offen offset:3072 sc1
    buffer_load_dwordx2 v[40:41], v10, s[32:35], s13 offen sc1
    s_add_u32 s82, s80, 114688
    buffer_load_dwordx4 v[72:75], v27, s[52:55], s82 offen nt
    s_add_u32 s82, s80, 172032
    buffer_load_dwordx4 v[76:79], v27, s[52:55], s82 offen nt
    s_mov_b32 s82, s80
    buffer_load_dwordx4 v[80:83], v27, s[56:59], s82 offen nt
    s_waitcnt vmcnt(11)
    s_waitcnt lgkmcnt(6)
    v_mfma_f32_16x16x32_bf16 v[120:123], v[192:195], v[224:227], v[120:123]
    ds_read_b64_tr_b16 v[220:221], v39 offset:4096
    ds_read_b64_tr_b16 v[222:223], v39 offset:4608
    v_mfma_f32_16x16x32_bf16 v[124:127], v[196:199], v[224:227], v[124:127]
    ds_read_b64_tr_b16 v[192:193], v36 offset:8192
    ds_read_b64_tr_b16 v[194:195], v36 offset:8704
    v_mfma_f32_16x16x32_bf16 v[128:131], v[200:203], v[224:227], v[128:131]
    ds_read_b64_tr_b16 v[196:197], v37 offset:8192
    ds_read_b64_tr_b16 v[198:199], v37 offset:8704
    v_mfma_f32_16x16x32_bf16 v[132:135], v[204:207], v[224:227], v[132:135]
    ds_read_b64_tr_b16 v[200:201], v38 offset:8192
    ds_read_b64_tr_b16 v[202:203], v38 offset:8704
    s_waitcnt vmcnt(10)
    s_waitcnt lgkmcnt(6)
    v_mfma_f32_16x16x32_bf16 v[120:123], v[208:211], v[228:231], v[120:123]
    ds_read_b64_tr_b16 v[204:205], v39 offset:8192
    ds_read_b64_tr_b16 v[206:207], v39 offset:8704
    v_mfma_f32_16x16x32_bf16 v[124:127], v[212:215], v[228:231], v[124:127]
    ds_read_b64_tr_b16 v[208:209], v36 offset:12288
    ds_read_b64_tr_b16 v[210:211], v36 offset:12800
    v_xor_b32 v36, 16384, v36
    v_mfma_f32_16x16x32_bf16 v[128:131], v[216:219], v[228:231], v[128:131]
    ds_read_b64_tr_b16 v[212:213], v37 offset:12288
    ds_read_b64_tr_b16 v[214:215], v37 offset:12800
    v_xor_b32 v37, 16384, v37
    v_mfma_f32_16x16x32_bf16 v[132:135], v[220:223], v[228:231], v[132:135]
    ds_read_b64_tr_b16 v[216:217], v38 offset:12288
    ds_read_b64_tr_b16 v[218:219], v38 offset:12800
    v_xor_b32 v38, 16384, v38
    s_waitcnt vmcnt(9)
    s_waitcnt lgkmcnt(6)
    v_mfma_f32_16x16x32_bf16 v[120:123], v[192:195], v[232:235], v[120:123]
    ds_read_b64_tr_b16 v[220:221], v39 offset:12288
    ds_read_b64_tr_b16 v[222:223], v39 offset:12800
    v_xor_b32 v39, 16384, v39
    v_mfma_f32_16x16x32_bf16 v[124:127], v[196:199], v[232:235], v[124:127]
    ds_read_b64_tr_b16 v[192:193], v36
    ds_read_b64_tr_b16 v[194:195], v36 offset:512
    v_mfma_f32_16x16x32_bf16 v[128:131], v[200:203], v[232:235], v[128:131]
    ds_read_b64_tr_b16 v[196:197], v37
    ds_read_b64_tr_b16 v[198:199], v37 offset:512
    v_mfma_f32_16x16x32_bf16 v[132:135], v[204:207], v[232:235], v[132:135]
    ds_read_b64_tr_b16 v[200:201], v38
    ds_read_b64_tr_b16 v[202:203], v38 offset:512
    s_waitcnt vmcnt(8)
    s_waitcnt lgkmcnt(6)
    v_mfma_f32_16x16x32_bf16 v[120:123], v[208:211], v[236:239], v[120:123]
    ds_read_b64_tr_b16 v[204:205], v39
    ds_read_b64_tr_b16 v[206:207], v39 offset:512
    v_mfma_f32_16x16x32_bf16 v[124:127], v[212:215], v[236:239], v[124:127]
    ds_read_b64_tr_b16 v[208:209], v36 offset:4096
    ds_read_b64_tr_b16 v[210:211], v36 offset:4608
    v_mfma_f32_16x16x32_bf16 v[128:131], v[216:219], v[236:239], v[128:131]
    ds_read_b64_tr_b16 v[212:213], v37 offset:4096
    ds_read_b64_tr_b16 v[214:215], v37 offset:4608
    v_mfma_f32_16x16x32_bf16 v[132:135], v[220:223], v[236:239], v[132:135]
    ds_read_b64_tr_b16 v[216:217], v38 offset:4096
    ds_read_b64_tr_b16 v[218:219], v38 offset:4608
    s_cmp_lt_u32 s3, 4
    s_cbranch_scc1 L_G2P28
    s_setprio 0
L_G2P28:
    s_waitcnt vmcnt(7)
    s_waitcnt lgkmcnt(6)
    v_mfma_f32_16x16x32_bf16 v[120:123], v[192:195], v[240:243], v[120:123]
    ds_read_b64_tr_b16 v[220:221], v39 offset:4096
    ds_read_b64_tr_b16 v[222:223], v39 offset:4608
    v_mfma_f32_16x16x32_bf16 v[124:127], v[196:199], v[240:243], v[124:127]
    ds_read_b64_tr_b16 v[192:193], v36 offset:8192
    ds_read_b64_tr_b16 v[194:195], v36 offset:8704
    v_mfma_f32_16x16x32_bf16 v[128:131], v[200:203], v[240:243], v[128:131]
    ds_read_b64_tr_b16 v[196:197], v37 offset:8192
    ds_read_b64_tr_b16 v[198:199], v37 offset:8704
    v_mfma_f32_16x16x32_bf16 v[132:135], v[204:207], v[240:243], v[132:135]
    ds_read_b64_tr_b16 v[200:201], v38 offset:8192
    ds_read_b64_tr_b16 v[202:203], v38 offset:8704
    s_waitcnt vmcnt(6)
    s_waitcnt lgkmcnt(6)
    v_mfma_f32_16x16x32_bf16 v[120:123], v[208:211], v[244:247], v[120:123]
    ds_read_b64_tr_b16 v[204:205], v39 offset:8192
    ds_read_b64_tr_b16 v[206:207], v39 offset:8704
    v_mfma_f32_16x16x32_bf16 v[124:127], v[212:215], v[244:247], v[124:127]
    ds_read_b64_tr_b16 v[208:209], v36 offset:12288
    ds_read_b64_tr_b16 v[210:211], v36 offset:12800
    v_mfma_f32_16x16x32_bf16 v[128:131], v[216:219], v[244:247], v[128:131]
    ds_read_b64_tr_b16 v[212:213], v37 offset:12288
    ds_read_b64_tr_b16 v[214:215], v37 offset:12800
    v_mfma_f32_16x16x32_bf16 v[132:135], v[220:223], v[244:247], v[132:135]
    ds_read_b64_tr_b16 v[216:217], v38 offset:12288
    ds_read_b64_tr_b16 v[218:219], v38 offset:12800
    s_waitcnt vmcnt(5)
    s_waitcnt lgkmcnt(6)
    v_mfma_f32_16x16x32_bf16 v[120:123], v[192:195], v[44:47], v[120:123]
    ds_read_b64_tr_b16 v[220:221], v39 offset:12288
    ds_read_b64_tr_b16 v[222:223], v39 offset:12800
    v_mfma_f32_16x16x32_bf16 v[124:127], v[196:199], v[44:47], v[124:127]
    v_mfma_f32_16x16x32_bf16 v[128:131], v[200:203], v[44:47], v[128:131]
    v_mfma_f32_16x16x32_bf16 v[132:135], v[204:207], v[44:47], v[132:135]
    s_waitcnt vmcnt(4)
    s_waitcnt lgkmcnt(0)
    v_mfma_f32_16x16x32_bf16 v[120:123], v[208:211], v[48:51], v[120:123]
    v_mfma_f32_16x16x32_bf16 v[124:127], v[212:215], v[48:51], v[124:127]
    v_mfma_f32_16x16x32_bf16 v[128:131], v[216:219], v[48:51], v[128:131]
    v_mfma_f32_16x16x32_bf16 v[132:135], v[220:223], v[48:51], v[132:135]
    s_lshl3_add_u32 s96, s21, s3
    s_lshl4_add_u32 s97, s96, s12
    s_lshl_b32 s98, s97, 8
    s_add_u32 s14, s98, 12582912
    v_and_b32 v28, 15, v1
    v_lshlrev_b32 v28, 4, v28
    v_lshrrev_b32 v9, 4, v1
    v_lshl_add_u32 v28, v9, 2, v28
    v_cvt_pk_bf16_f32 v120, 0, v120
    v_cvt_pk_bf16_f32 v121, 0, v121
    v_cvt_pk_bf16_f32 v122, 0, v122
    v_cvt_pk_bf16_f32 v123, 0, v123
    v_cvt_pk_bf16_f32 v124, 0, v124
    v_cvt_pk_bf16_f32 v125, 0, v125
    v_cvt_pk_bf16_f32 v126, 0, v126
    v_cvt_pk_bf16_f32 v127, 0, v127
    v_pk_mul_f32 v[120:121], v[120:121], v[136:137]
    v_pk_mul_f32 v[122:123], v[122:123], v[138:139]
    v_pk_mul_f32 v[124:125], v[124:125], v[140:141]
    v_pk_mul_f32 v[126:127], v[126:127], v[142:143]
    v_cvt_pk_bf16_f32 v120, 0, v120
    v_cvt_pk_bf16_f32 v121, 0, v121
    v_cvt_pk_bf16_f32 v122, 0, v122
    v_cvt_pk_bf16_f32 v123, 0, v123
    v_cvt_pk_bf16_f32 v124, 0, v124
    v_cvt_pk_bf16_f32 v125, 0, v125
    v_cvt_pk_bf16_f32 v126, 0, v126
    v_cvt_pk_bf16_f32 v127, 0, v127
    v_pk_add_f32 v[120:121], v[120:121], v[152:153]
    v_pk_add_f32 v[122:123], v[122:123], v[154:155]
    v_pk_add_f32 v[124:125], v[124:125], v[156:157]
    v_pk_add_f32 v[126:127], v[126:127], v[158:159]
    v_cvt_pk_bf16_f32 v12, v120, v121
    v_cvt_pk_bf16_f32 v13, v122, v123
    v_cvt_pk_bf16_f32 v14, v124, v125
    v_cvt_pk_bf16_f32 v15, v126, v127
    v_dot2_f32_bf16 v4, v12, v12, 0
    v_dot2_f32_bf16 v5, v13, v13, 0
    v_dot2_f32_bf16 v4, v14, v14, v4
    v_dot2_f32_bf16 v5, v15, v15, v5
    v_mfma_f32_16x16x32_bf16 v[240:243], v[184:187], v[12:15], 0
    v_cvt_pk_bf16_f32 v128, 0, v128
    v_cvt_pk_bf16_f32 v129, 0, v129
    v_cvt_pk_bf16_f32 v130, 0, v130
    v_cvt_pk_bf16_f32 v131, 0, v131
    v_cvt_pk_bf16_f32 v132, 0, v132
    v_cvt_pk_bf16_f32 v133, 0, v133
    v_cvt_pk_bf16_f32 v134, 0, v134
    v_cvt_pk_bf16_f32 v135, 0, v135
    v_pk_mul_f32 v[128:129], v[128:129], v[144:145]
    v_pk_mul_f32 v[130:131], v[130:131], v[146:147]
    v_pk_mul_f32 v[132:133], v[132:133], v[148:149]
    v_pk_mul_f32 v[134:135], v[134:135], v[150:151]
    v_cvt_pk_bf16_f32 v128, 0, v128
    v_cvt_pk_bf16_f32 v129, 0, v129
    v_cvt_pk_bf16_f32 v130, 0, v130
    v_cvt_pk_bf16_f32 v131, 0, v131
    v_cvt_pk_bf16_f32 v132, 0, v132
    v_cvt_pk_bf16_f32 v133, 0, v133
    v_cvt_pk_bf16_f32 v134, 0, v134
    v_cvt_pk_bf16_f32 v135, 0, v135
    v_pk_add_f32 v[128:129], v[128:129], v[160:161]
    v_pk_add_f32 v[130:131], v[130:131], v[162:163]
    v_pk_add_f32 v[132:133], v[132:133], v[164:165]
    v_pk_add_f32 v[134:135], v[134:135], v[166:167]
    v_cvt_pk_bf16_f32 v16, v128, v129
    v_cvt_pk_bf16_f32 v17, v130, v131
    v_cvt_pk_bf16_f32 v18, v132, v133
    v_cvt_pk_bf16_f32 v19, v134, v135
    v_dot2_f32_bf16 v4, v16, v16, v4
    v_dot2_f32_bf16 v5, v17, v17, v5
    v_dot2_f32_bf16 v4, v18, v18, v4
    v_dot2_f32_bf16 v5, v19, v19, v5
    v_mfma_f32_16x16x32_bf16 v[240:243], v[188:191], v[16:19], v[240:243]
    v_and_b32 v7, 7, v1
    v_lshlrev_b32 v7, 15, v7
    v_bfe_u32 v9, v1, 3, 1
    v_lshl_add_u32 v7, v9, 12, v7
    v_add_f32 v4, v4, v5
    v_mov_b32 v5, v4
    s_nop 1
    v_permlane32_swap_b32 v4, v5
    v_add_f32 v4, v4, v5
    v_mov_b32 v5, v4
    s_nop 1
    v_permlane16_swap_b32 v4, v5
    v_add_f32 v4, v4, v5
    s_nop 1
    v_mov_b32_dpp v240, v4 quad_perm:[0,1,2,3] row_mask:0x8 bank_mask:0xf
    buffer_store_dword v240, v28, s[32:35], s14 offen sc1
    s_and_b32 s96, s12, 1
    s_lshr_b32 s97, s21, 2
    s_and_b32 s98, s21, 3
    s_lshl_b32 s99, s98, 6
    s_lshl1_add_u32 s98, s97, s99
    s_lshl_b32 s97, s98, 12
    s_lshr_b32 s99, s12, 1
    s_lshl_b32 s98, s99, 6
    s_add_u32 s99, s97, s98
    s_lshl2_add_u32 s97, s96, s99
    s_add_u32 s98, s97, 1048576
    s_add_u32 s16, s98, 1536
    s_barrier
    s_cmp_lg_u32 s3, 0
    s_cbranch_scc1 L_PE
    v_mov_b32 v6, s4
    s_mov_b32 exec_hi, 0
    s_mov_b32 exec_lo, 65535
    buffer_store_dword v6, v7, s[32:35], s16 offen sc1
    s_mov_b64 exec, -1
L_PE:
    s_add_u32 s82, s80, 57344
    s_lshl2_add_u32 m0, s83, 33792
    s_nop 0
    buffer_load_dwordx4 v27, s[56:59], s82 offen nt lds
    s_add_u32 s82, s80, 114688
    s_lshl2_add_u32 m0, s83, 34816
    s_nop 0
    buffer_load_dwordx4 v27, s[56:59], s82 offen nt lds
    s_lshl_b32 s15, s3, 12
    v_add_u32 v4, s15, v2
    v_add_u32 v7, 65536, v4
    s_waitcnt vmcnt(6)
    v_cmp_ne_u32 vcc, s4, v41
    s_cbranch_vccz L_UPOK
POLL_34:
    buffer_load_dwordx2 v[40:41], v10, s[32:35], s13 offen sc1
    s_waitcnt vmcnt(0)
    v_cmp_ne_u32 vcc, s4, v41
    s_cbranch_vccz PDONE_35
    s_add_u32 s5, s5, 1
    s_cmp_lt_u32 s5, 200000
    s_cbranch_scc1 POLL_34
PDONE_35:
L_UPOK:
    s_lshl3_add_u32 s96, s21, s3
    s_lshl_b32 s97, s96, 12
    s_add_u32 s14, s97, 12582912
    s_load_dwordx2 s[24:25], s[32:33], s92 offset:1536 glc
    v_add_f32_dpp v40, v40, v40 quad_perm:[1,0,3,2] row_mask:0xf bank_mask:0xf
    s_nop 1
    v_add_f32_dpp v40, v40, v40 quad_perm:[2,3,0,1] row_mask:0xf bank_mask:0xf
    s_nop 1
    v_add_f32_dpp v40, v40, v40 row_half_mirror row_mask:0xf bank_mask:0xf
    s_nop 1
    v_add_f32_dpp v40, v40, v40 row_mirror row_mask:0xf bank_mask:0xf
    v_lshlrev_b32 v152, 16, v12
    v_and_b32 v153, s6, v12
    v_lshlrev_b32 v154, 16, v13
    v_and_b32 v155, s6, v13
    v_lshlrev_b32 v156, 16, v14
    v_and_b32 v157, s6, v14
    v_lshlrev_b32 v158, 16, v15
    v_and_b32 v159, s6, v15
    v_lshlrev_b32 v160, 16, v16
    v_and_b32 v161, s6, v16
    v_lshlrev_b32 v162, 16, v17
    v_and_b32 v163, s6, v17
    v_lshlrev_b32 v164, 16, v18
    v_and_b32 v165, s6, v18
    v_lshlrev_b32 v166, 16, v19
    v_and_b32 v167, s6, v19
    s_lshl_b32 s96, s3, 9
    s_lshl1_add_u32 s15, s21, s96
    v_and_b32 v29, 15, v1
    v_lshl_add_u32 v29, v29, 5, s15
    v_xor_b32 v5, 0x4000, v4
    v_xor_b32 v8, 0x4000, v7
    s_waitcnt vmcnt(3)
    ds_write_b128 v4, v[72:75] offset:2048
    ds_write_b128 v4, v[76:79] offset:3072
    ds_write_b128 v4, v[80:83] offset:32768
    s_cmp_lt_u32 s3, 4
    s_cbranch_scc1 L_FW1
    ds_write_b128 v4, v[56:59] offset:0
    ds_write_b128 v5, v[60:63] offset:0
    ds_write_b128 v4, v[64:67] offset:1024
    ds_write_b128 v5, v[68:71] offset:1024
L_FW1:
    s_branch SCHK_37
SPOLL_36:
    s_load_dwordx2 s[24:25], s[32:33], s92 offset:1536 glc
SCHK_37:
    s_add_u32 s5, s5, 1
    s_cmp_ge_u32 s5, 200000
    s_waitcnt lgkmcnt(0)
    s_cbranch_scc1 SDONE_38
    s_cmp_lg_u32 s24, s4
    s_cbranch_scc1 SPOLL_36
    s_cmp_lg_u32 s25, s4
    s_cbranch_scc1 SPOLL_36
SDONE_38:
    s_barrier
    buffer_load_dwordx4 v[192:195], v2, s[32:35], s14 offen sc1
    buffer_load_dwordx4 v[196:199], v2, s[32:35], s14 offen offset:1024 sc1
    buffer_load_dwordx4 v[200:203], v2, s[32:35], s14 offen offset:2048 sc1
    buffer_load_dwordx4 v[204:207], v2, s[32:35], s14 offen offset:3072 sc1
    s_barrier
    s_add_u32 s82, s80, 172032
    s_lshl2_add_u32 m0, s83, 35840
    s_nop 0
    buffer_load_dwordx4 v27, s[56:59], s82 offen nt lds
    s_mov_b32 s82, s81
    s_lshl2_add_u32 m0, s83, 65536
    s_nop 0
    buffer_load_dwordx4 v253, s[60:63], s82 offen nt lds
    s_add_u32 s82, s81, 4096
    s_lshl2_add_u32 m0, s83, 66560
    s_nop 0
    buffer_load_dwordx4 v253, s[60:63], s82 offen nt lds
    v_mov_b32_dpp v168, v33 row_newbcast:0 row_mask:0xf bank_mask:0xf
    v_mov_b32_dpp v169, v33 row_newbcast:1 row_mask:0xf bank_mask:0xf
    v_mov_b32_dpp v170, v33 row_newbcast:2 row_mask:0xf bank_mask:0xf
    v_mov_b32_dpp v171, v33 row_newbcast:3 row_mask:0xf bank_mask:0xf
    v_mov_b32_dpp v172, v33 row_newbcast:4 row_mask:0xf bank_mask:0xf
    v_mov_b32_dpp v173, v33 row_newbcast:5 row_mask:0xf bank_mask:0xf
    v_mov_b32_dpp v174, v33 row_newbcast:6 row_mask:0xf bank_mask:0xf
    v_mov_b32_dpp v175, v33 row_newbcast:7 row_mask:0xf bank_mask:0xf
    v_mov_b32_dpp v176, v33 row_newbcast:8 row_mask:0xf bank_mask:0xf
    v_mov_b32_dpp v177, v33 row_newbcast:9 row_mask:0xf bank_mask:0xf
    v_mov_b32_dpp v178, v33 row_newbcast:10 row_mask:0xf bank_mask:0xf
    v_mov_b32_dpp v179, v33 row_newbcast:11 row_mask:0xf bank_mask:0xf
    v_mov_b32_dpp v180, v33 row_newbcast:12 row_mask:0xf bank_mask:0xf
    v_mov_b32_dpp v181, v33 row_newbcast:13 row_mask:0xf bank_mask:0xf
    v_mov_b32_dpp v182, v33 row_newbcast:14 row_mask:0xf bank_mask:0xf
    v_mov_b32_dpp v183, v33 row_newbcast:15 row_mask:0xf bank_mask:0xf
    v_mov_b32_dpp v88, v42 row_newbcast:0 row_mask:0xf bank_mask:0xf
    v_mov_b32_dpp v89, v42 row_newbcast:1 row_mask:0xf bank_mask:0xf
    v_mov_b32_dpp v90, v42 row_newbcast:2 row_mask:0xf bank_mask:0xf
    v_mov_b32_dpp v91, v42 row_newbcast:3 row_mask:0xf bank_mask:0xf
    v_mov_b32_dpp v92, v42 row_newbcast:4 row_mask:0xf bank_mask:0xf
    v_mov_b32_dpp v93, v42 row_newbcast:5 row_mask:0xf bank_mask:0xf
    v_mov_b32_dpp v94, v42 row_newbcast:6 row_mask:0xf bank_mask:0xf
    v_mov_b32_dpp v95, v42 row_newbcast:7 row_mask:0xf bank_mask:0xf
    v_mov_b32_dpp v96, v42 row_newbcast:8 row_mask:0xf bank_mask:0xf
    v_mov_b32_dpp v97, v42 row_newbcast:9 row_mask:0xf bank_mask:0xf
    v_mov_b32_dpp v98, v42 row_newbcast:10 row_mask:0xf bank_mask:0xf
    v_mov_b32_dpp v99, v42 row_newbcast:11 row_mask:0xf bank_mask:0xf
    v_mov_b32_dpp v100, v42 row_newbcast:12 row_mask:0xf bank_mask:0xf
    v_mov_b32_dpp v101, v42 row_newbcast:13 row_mask:0xf bank_mask:0xf
    v_mov_b32_dpp v102, v42 row_newbcast:14 row_mask:0xf bank_mask:0xf
    v_mov_b32_dpp v103, v42 row_newbcast:15 row_mask:0xf bank_mask:0xf
    v_mov_b32_dpp v104, v43 row_newbcast:0 row_mask:0xf bank_mask:0xf
L_PAD9:
    s_cbranch_execz L_RET9
    v_mov_b32_dpp v105, v43 row_newbcast:1 row_mask:0xf bank_mask:0xf
    v_mov_b32_dpp v106, v43 row_newbcast:2 row_mask:0xf bank_mask:0xf
    v_mov_b32_dpp v107, v43 row_newbcast:3 row_mask:0xf bank_mask:0xf
    v_mov_b32_dpp v108, v43 row_newbcast:4 row_mask:0xf bank_mask:0xf
    v_mov_b32_dpp v109, v43 row_newbcast:5 row_mask:0xf bank_mask:0xf
    v_mov_b32_dpp v110, v43 row_newbcast:6 row_mask:0xf bank_mask:0xf
    v_mov_b32_dpp v111, v43 row_newbcast:7 row_mask:0xf bank_mask:0xf
    v_mov_b32_dpp v112, v43 row_newbcast:8 row_mask:0xf bank_mask:0xf
    v_mov_b32_dpp v113, v43 row_newbcast:9 row_mask:0xf bank_mask:0xf
    v_mov_b32_dpp v114, v43 row_newbcast:10 row_mask:0xf bank_mask:0xf
    v_mov_b32_dpp v115, v43 row_newbcast:11 row_mask:0xf bank_mask:0xf
    v_mov_b32_dpp v116, v43 row_newbcast:12 row_mask:0xf bank_mask:0xf
    v_mov_b32_dpp v117, v43 row_newbcast:13 row_mask:0xf bank_mask:0xf
    v_mov_b32_dpp v118, v43 row_newbcast:14 row_mask:0xf bank_mask:0xf
    v_mov_b32_dpp v119, v43 row_newbcast:15 row_mask:0xf bank_mask:0xf
    s_lshl3_add_u32 s15, s3, 156160
    v_mov_b32 v4, s15
    v_and_b32 v5, 7, v1
    v_lshlrev_b32 v5, 3, v5
    v_add_u32 v5, 156160, v5
    v_and_b32 v6, 3, v1
    v_lshlrev_b32 v6, 18, v6
    v_bfe_u32 v9, v1, 2, 2
    v_lshl_add_u32 v6, v9, 13, v6
    s_and_b32 s96, s21, 1
    s_and_b32 s97, s12, 7
    s_lshr_b32 s98, s12, 3
    s_lshl3_add_u32 s99, s97, s98
    s_lshl_b32 s97, s99, 12
    s_lshr_b32 s98, s21, 1
    s_lshl_b32 s99, s98, 6
    s_add_u32 s98, s97, s99
    s_lshl4_add_u32 s97, s96, s98
    s_add_u32 s99, s97, 1048576
    s_add_u32 s16, s99, 2560
    s_waitcnt vmcnt(3)
    v_pk_add_f32 v[192:193], v[192:193], v[196:197]
    v_pk_add_f32 v[200:201], v[200:201], v[204:205]
    v_pk_add_f32 v[194:195], v[194:195], v[198:199]
    v_pk_add_f32 v[202:203], v[202:203], v[206:207]
    v_pk_add_f32 v[192:193], v[192:193], v[200:201]
    v_pk_add_f32 v[194:195], v[194:195], v[202:203]
    v_add_f32 v193, v193, v194
    v_add_f32 v197, v192, v195
    v_cmp_u_f32 vcc, v193, v197
    s_cbranch_vccz POK_40
PRE_41:
    buffer_load_dwordx4 v[192:195], v2, s[32:35], s14 offen sc1
    buffer_load_dwordx4 v[196:199], v2, s[32:35], s14 offen offset:1024 sc1
    buffer_load_dwordx4 v[200:203], v2, s[32:35], s14 offen offset:2048 sc1
    buffer_load_dwordx4 v[204:207], v2, s[32:35], s14 offen offset:3072 sc1
    s_waitcnt vmcnt(0)
    v_pk_add_f32 v[192:193], v[192:193], v[196:197]
    v_pk_add_f32 v[200:201], v[200:201], v[204:205]
    v_pk_add_f32 v[194:195], v[194:195], v[198:199]
    v_pk_add_f32 v[202:203], v[202:203], v[206:207]
    v_pk_add_f32 v[192:193], v[192:193], v[200:201]
    v_pk_add_f32 v[194:195], v[194:195], v[202:203]
    v_add_f32 v193, v193, v194
    v_add_f32 v197, v192, v195
    v_cmp_u_f32 vcc, v193, v197
    s_cbranch_vccz POK_40
    s_add_u32 s5, s5, 1
    s_cmp_lt_u32 s5, 200000
    s_cbranch_scc1 PRE_41
POK_40:
    v_mov_b32 v196, v195
    s_nop 1
    v_permlane32_swap_b32 v195, v196
    v_permlane32_swap_b32 v192, v193
    v_add_f32 v195, v195, v196
    v_add_f32 v192, v192, v193
    s_nop 1
    v_permlane16_swap_b32 v192, v195
    v_add_f32 v193, v192, v195
    v_add_f32 v195, v192, v195
    s_nop 1
    v_permlane16_swap_b32 v193, v195
    v_mov_b32 v192, v193
    v_mul_f32 v195, 0x3a800000, v195
    s_nop 0
    v_permlane32_swap_b32 v192, v193
    v_mul_f32 v192, 0x3a800000, v192
    v_fma_f32 v31, -v192, v192, v195
    v_cvt_pk_bf16_f32 v30, 0, v192
    v_max_f32 v31, 0, v31
    v_cvt_pk_bf16_f32 v31, 0, v31
    v_fma_f32 v193, -v30, v40, v193
    v_add_f32 v31, 0x3727c5ac, v31
    v_cvt_pk_bf16_f32 v31, 0, v31
    v_sqrt_f32 v31, v31
    s_nop 0
    v_cvt_pk_bf16_f32 v31, 0, v31
    v_rcp_f32 v31, v31
    s_nop 0
    v_mul_f32 v32, v193, v31
    v_ashrrev_i32 v196, 31, v32
    v_or_b32 v196, 0x80000000, v196
    v_xor_b32 v32, v32, v196
    s_mov_b32 s15, 0xfffff000
    v_and_or_b32 v32, v32, s15, v29
    s_nop 1
    v_max_u32_dpp v244, v32, v32 quad_perm:[1,0,3,2] row_mask:0xf bank_mask:0xf
    v_min_u32_dpp v245, v32, v32 quad_perm:[1,0,3,2] row_mask:0xf bank_mask:0xf
    s_nop 0
    v_min_u32_dpp v196, v244, v244 quad_perm:[2,3,0,1] row_mask:0xf bank_mask:0xf
    v_max_u32_dpp v245, v245, v245 quad_perm:[2,3,0,1] row_mask:0xf bank_mask:0xf
    v_max_u32_dpp v244, v244, v244 quad_perm:[2,3,0,1] row_mask:0xf bank_mask:0xf
    v_max_u32 v245, v245, v196
    s_nop 0
    v_min_u32_dpp v196, v244, v244 row_half_mirror row_mask:0xf bank_mask:0xf
    v_max_u32_dpp v245, v245, v245 row_half_mirror row_mask:0xf bank_mask:0xf
    v_max_u32_dpp v244, v244, v244 row_half_mirror row_mask:0xf bank_mask:0xf
    v_max_u32 v245, v245, v196
    s_nop 0
    v_min_u32_dpp v196, v244, v244 row_mirror row_mask:0xf bank_mask:0xf
    v_max_u32_dpp v245, v245, v245 row_mirror row_mask:0xf bank_mask:0xf
    v_max_u32_dpp v244, v244, v244 row_mirror row_mask:0xf bank_mask:0xf
    v_max_u32 v245, v245, v196
    ds_write_b64 v4, v[244:245]
    s_waitcnt lgkmcnt(0)
    s_barrier
    ds_read_b64 v[244:245], v5
    v_pk_add_f32 v[208:209], v[152:153], v[30:31] op_sel_hi:[1,0] neg_lo:[0,1] neg_hi:[0,1]
    v_pk_add_f32 v[210:211], v[154:155], v[30:31] op_sel_hi:[1,0] neg_lo:[0,1] neg_hi:[0,1]
    v_pk_add_f32 v[212:213], v[156:157], v[30:31] op_sel_hi:[1,0] neg_lo:[0,1] neg_hi:[0,1]
    v_pk_add_f32 v[214:215], v[158:159], v[30:31] op_sel_hi:[1,0] neg_lo:[0,1] neg_hi:[0,1]
    v_pk_add_f32 v[216:217], v[160:161], v[30:31] op_sel_hi:[1,0] neg_lo:[0,1] neg_hi:[0,1]
    v_pk_add_f32 v[218:219], v[162:163], v[30:31] op_sel_hi:[1,0] neg_lo:[0,1] neg_hi:[0,1]
    v_pk_add_f32 v[220:221], v[164:165], v[30:31] op_sel_hi:[1,0] neg_lo:[0,1] neg_hi:[0,1]
    v_pk_add_f32 v[222:223], v[166:167], v[30:31] op_sel_hi:[1,0] neg_lo:[0,1] neg_hi:[0,1]
    s_waitcnt lgkmcnt(0)
    v_min_u32_dpp v196, v244, v244 quad_perm:[1,0,3,2] row_mask:0xf bank_mask:0xf
    v_max_u32_dpp v245, v245, v245 quad_perm:[1,0,3,2] row_mask:0xf bank_mask:0xf
    v_max_u32_dpp v244, v244, v244 quad_perm:[1,0,3,2] row_mask:0xf bank_mask:0xf
    v_max_u32 v245, v245, v196
    s_nop 0
    v_min_u32_dpp v196, v244, v244 quad_perm:[2,3,0,1] row_mask:0xf bank_mask:0xf
    v_max_u32_dpp v245, v245, v245 quad_perm:[2,3,0,1] row_mask:0xf bank_mask:0xf
    v_max_u32_dpp v244, v244, v244 quad_perm:[2,3,0,1] row_mask:0xf bank_mask:0xf
    v_max_u32 v245, v245, v196
    s_nop 0
    v_min_u32_dpp v196, v244, v244 row_half_mirror row_mask:0xf bank_mask:0xf
    v_max_u32_dpp v245, v245, v245 row_half_mirror row_mask:0xf bank_mask:0xf
    v_max_u32_dpp v244, v244, v244 row_half_mirror row_mask:0xf bank_mask:0xf
    v_max_u32 v245, v245, v196
    v_cmp_eq_u32 s[88:89], v32, v245
    v_cmp_eq_u32 vcc, v32, v244
    v_or_b32 v246, 1, v245
    v_mov_b32 v245, s4
    v_mov_b32 v247, s4
    s_or_b64 s[84:85], vcc, s[88:89]
    s_cmp_lg_u32 s3, 0
    s_cbranch_scc1 L_NOF
    s_mov_b64 exec, 0xffff
    buffer_store_dwordx4 v[244:247], v6, s[32:35], s16 offen sc1
    s_mov_b64 exec, -1
L_NOF:
    s_cmp_eq_u64 s[84:85], 0
    s_cbranch_scc1 L_NOPR
    s_setprio 1
L_NOPR:
    s_lshl4_add_u32 s13, s3, 156288
    v_mov_b32 v4, s13
    v_and_b32 v5, 7, v1
    v_lshlrev_b32 v5, 4, v5
    v_add_u32 v5, 156288, v5
    s_load_dwordx8 s[24:31], s[32:33], s92 offset:2560 glc
    v_cvt_pk_bf16_f32 v208, 0, v208
    v_cvt_pk_bf16_f32 v209, 0, v209
    v_cvt_pk_bf16_f32 v210, 0, v210
    v_cvt_pk_bf16_f32 v211, 0, v211
    v_cvt_pk_bf16_f32 v212, 0, v212
    v_cvt_pk_bf16_f32 v213, 0, v213
    v_cvt_pk_bf16_f32 v214, 0, v214
    v_cvt_pk_bf16_f32 v215, 0, v215
    v_cvt_pk_bf16_f32 v216, 0, v216
    v_cvt_pk_bf16_f32 v217, 0, v217
    v_cvt_pk_bf16_f32 v218, 0, v218
    v_cvt_pk_bf16_f32 v219, 0, v219
    v_cvt_pk_bf16_f32 v220, 0, v220
    v_cvt_pk_bf16_f32 v221, 0, v221
    v_cvt_pk_bf16_f32 v222, 0, v222
    v_cvt_pk_bf16_f32 v223, 0, v223
    v_pk_mul_f32 v[208:209], v[30:31], v[208:209] op_sel:[1,0]
    v_pk_mul_f32 v[210:211], v[30:31], v[210:211] op_sel:[1,0]
    v_pk_mul_f32 v[212:213], v[30:31], v[212:213] op_sel:[1,0]
    v_pk_mul_f32 v[214:215], v[30:31], v[214:215] op_sel:[1,0]
    v_pk_mul_f32 v[216:217], v[30:31], v[216:217] op_sel:[1,0]
    v_pk_mul_f32 v[218:219], v[30:31], v[218:219] op_sel:[1,0]
    v_pk_mul_f32 v[220:221], v[30:31], v[220:221] op_sel:[1,0]
    v_pk_mul_f32 v[222:223], v[30:31], v[222:223] op_sel:[1,0]
    v_cvt_pk_bf16_f32 v208, 0, v208
    v_cvt_pk_bf16_f32 v209, 0, v209
    v_cvt_pk_bf16_f32 v210, 0, v210
    v_cvt_pk_bf16_f32 v211, 0, v211
    v_cvt_pk_bf16_f32 v212, 0, v212
    v_cvt_pk_bf16_f32 v213, 0, v213
    v_cvt_pk_bf16_f32 v214, 0, v214
    v_cvt_pk_bf16_f32 v215, 0, v215
    v_cvt_pk_bf16_f32 v216, 0, v216
    v_cvt_pk_bf16_f32 v217, 0, v217
    v_cvt_pk_bf16_f32 v218, 0, v218
    v_cvt_pk_bf16_f32 v219, 0, v219
    v_cvt_pk_bf16_f32 v220, 0, v220
    v_cvt_pk_bf16_f32 v221, 0, v221
    v_cvt_pk_bf16_f32 v222, 0, v222
    v_cvt_pk_bf16_f32 v223, 0, v223
    v_pk_mul_f32 v[208:209], v[208:209], v[168:169]
    v_pk_mul_f32 v[210:211], v[210:211], v[170:171]
    v_pk_mul_f32 v[212:213], v[212:213], v[172:173]
    v_pk_mul_f32 v[214:215], v[214:215], v[174:175]
    v_pk_mul_f32 v[216:217], v[216:217], v[176:177]
    v_pk_mul_f32 v[218:219], v[218:219], v[178:179]
    v_pk_mul_f32 v[220:221], v[220:221], v[180:181]
    v_pk_mul_f32 v[222:223], v[222:223], v[182:183]
    v_cvt_pk_bf16_f32 v208, 0, v208
    v_cvt_pk_bf16_f32 v209, 0, v209
    v_cvt_pk_bf16_f32 v210, 0, v210
    v_cvt_pk_bf16_f32 v211, 0, v211
    v_cvt_pk_bf16_f32 v212, 0, v212
    v_cvt_pk_bf16_f32 v213, 0, v213
    v_cvt_pk_bf16_f32 v214, 0, v214
    v_cvt_pk_bf16_f32 v215, 0, v215
    v_cvt_pk_bf16_f32 v216, 0, v216
    v_cvt_pk_bf16_f32 v217, 0, v217
    v_cvt_pk_bf16_f32 v218, 0, v218
    v_cvt_pk_bf16_f32 v219, 0, v219
    v_cvt_pk_bf16_f32 v220, 0, v220
    v_cvt_pk_bf16_f32 v221, 0, v221
    v_cvt_pk_bf16_f32 v222, 0, v222
    v_cvt_pk_bf16_f32 v223, 0, v223
    v_pk_add_f32 v[208:209], v[208:209], v[88:89]
    v_pk_add_f32 v[210:211], v[210:211], v[90:91]
    v_pk_add_f32 v[212:213], v[212:213], v[92:93]
    v_pk_add_f32 v[214:215], v[214:215], v[94:95]
    v_pk_add_f32 v[216:217], v[216:217], v[96:97]
    v_pk_add_f32 v[218:219], v[218:219], v[98:99]
    v_pk_add_f32 v[220:221], v[220:221], v[100:101]
    v_pk_add_f32 v[222:223], v[222:223], v[102:103]
    v_cvt_pk_bf16_f32 v224, v208, v209
    v_cvt_pk_bf16_f32 v225, v210, v211
    v_cvt_pk_bf16_f32 v226, v212, v213
    v_cvt_pk_bf16_f32 v227, v214, v215
    v_cvt_pk_bf16_f32 v228, v216, v217
    v_cvt_pk_bf16_f32 v229, v218, v219
    v_cvt_pk_bf16_f32 v230, v220, v221
    v_cvt_pk_bf16_f32 v231, v222, v223
    s_cmp_eq_u64 s[84:85], 0
    s_cbranch_scc1 L_NOCAND
    v_mfma_f32_16x16x32_bf16 v[240:243], v[184:187], v[224:227], 0
    v_mfma_f32_16x16x32_bf16 v[240:243], v[188:191], v[228:231], v[240:243]
    v_mov_b32 v232, v224
    v_mov_b32 v233, v225
    v_mov_b32 v234, v226
    v_mov_b32 v235, v227
    v_mov_b32 v236, v228
    v_mov_b32 v237, v229
    v_mov_b32 v238, v230
    v_mov_b32 v239, v231
    s_lshl_b32 s96, s21, 14
    s_lshl_b32 s97, s12, 9
    s_add_u32 s98, s96, s97
    s_add_u32 s15, s98, 13631488
    v_lshrrev_b32 v7, 4, v1
    v_lshlrev_b32 v7, 4, v7
    v_add_u32 v8, 8192, v7
    v_permlane32_swap_b32 v232, v234
    v_permlane32_swap_b32 v233, v235
    v_permlane32_swap_b32 v236, v238
    v_permlane32_swap_b32 v237, v239
    v_permlane32_swap_b32 v12, v14
    v_permlane32_swap_b32 v13, v15
    v_permlane32_swap_b32 v16, v18
    v_permlane32_swap_b32 v17, v19
    v_cndmask_b32 v7, v7, v8, s[88:89]
    s_mov_b64 exec, s[84:85]
    buffer_store_dwordx4 v[232:235], v7, s[32:35], s15 offen sc1
    buffer_store_dwordx4 v[236:239], v7, s[32:35], s15 offen offset:64 sc1
    s_mov_b32 exec_lo, 0
    s_and_b32 exec_hi, s85, 0xffff0000
    buffer_store_dword v240, v7, s[32:35], s15 offen offset:208 sc1
    s_mov_b64 exec, s[84:85]
    buffer_store_dwordx4 v[12:15], v7, s[32:35], s15 offen offset:128 sc1
    buffer_store_dwordx4 v[16:19], v7, s[32:35], s15 offen offset:192 sc1
    s_mov_b64 exec, -1
    s_setprio 0
L_NOCAND:
    s_add_u32 s82, s81, 8192
    s_lshl2_add_u32 m0, s83, 67584
    s_nop 0
    buffer_load_dwordx4 v253, s[60:63], s82 offen nt lds
    s_add_u32 s82, s81, 12288
    s_lshl2_add_u32 m0, s83, 68608
    s_nop 0
    buffer_load_dwordx4 v253, s[60:63], s82 offen nt lds
    s_branch SCHK_43
SPOLL_42:
    s_load_dwordx8 s[24:31], s[32:33], s92 offset:2560 glc
SCHK_43:
    s_add_u32 s5, s5, 1
    s_cmp_ge_u32 s5, 200000
    s_waitcnt lgkmcnt(0)
    s_cbranch_scc1 SDONE_44
    s_cmp_lg_u32 s25, s4
    s_cbranch_scc1 SPOLL_42
    s_cmp_lg_u32 s27, s4
    s_cbranch_scc1 SPOLL_42
    s_cmp_lg_u32 s29, s4
    s_cbranch_scc1 SPOLL_42
    s_cmp_lg_u32 s31, s4
    s_cbranch_scc1 SPOLL_42
SDONE_44:
    s_min_u32 s25, s24, s28
    s_min_u32 s27, s26, s28
    s_min_u32 s29, s24, s30
    s_max_u32 s24, s24, s28
    s_max_u32 s26, s26, s30
    s_max_u32 s27, s27, s29
    s_max_u32 s25, s25, s26
    v_mov_b32 v244, s24
    v_mov_b32 v246, s27
    v_mov_b32 v245, s25
    ds_write_b128 v4, v[244:247]
    s_waitcnt vmcnt(4)
    s_waitcnt lgkmcnt(0)
    s_barrier
    ds_read_b128 v[244:247], v5
    v_and_b32 v8, 8, v1
    v_cmp_eq_u32 s[22:23], 0, v8
    v_cmp_gt_u32 s[24:25], 16, v1
    v_cmp_gt_u32 s[26:27], 32, v1
    s_waitcnt lgkmcnt(0)
    v_min_u32_dpp v192, v244, v244 quad_perm:[1,0,3,2] row_mask:0xf bank_mask:0xf
    v_min_u32_dpp v193, v245, v244 quad_perm:[1,0,3,2] row_mask:0xf bank_mask:0xf
    v_min_u32_dpp v194, v244, v245 quad_perm:[1,0,3,2] row_mask:0xf bank_mask:0xf
    v_max_u32_dpp v246, v246, v246 quad_perm:[1,0,3,2] row_mask:0xf bank_mask:0xf
    v_max_u32_dpp v245, v245, v245 quad_perm:[1,0,3,2] row_mask:0xf bank_mask:0xf
    v_max_u32_dpp v244, v244, v244 quad_perm:[1,0,3,2] row_mask:0xf bank_mask:0xf
    v_max3_u32 v246, v246, v193, v194
    v_max_u32 v245, v245, v192
    v_min_u32_dpp v192, v244, v244 quad_perm:[2,3,0,1] row_mask:0xf bank_mask:0xf
    s_nop 0
    v_min_u32_dpp v193, v245, v244 quad_perm:[2,3,0,1] row_mask:0xf bank_mask:0xf
    v_min_u32_dpp v194, v244, v245 quad_perm:[2,3,0,1] row_mask:0xf bank_mask:0xf
    v_max_u32_dpp v246, v246, v246 quad_perm:[2,3,0,1] row_mask:0xf bank_mask:0xf
    v_max_u32_dpp v245, v245, v245 quad_perm:[2,3,0,1] row_mask:0xf bank_mask:0xf
    v_max_u32_dpp v244, v244, v244 quad_perm:[2,3,0,1] row_mask:0xf bank_mask:0xf
    v_max3_u32 v246, v246, v193, v194
    v_max_u32 v245, v245, v192
    v_min_u32_dpp v192, v244, v244 row_half_mirror row_mask:0xf bank_mask:0xf
    s_nop 0
    v_min_u32_dpp v193, v245, v244 row_half_mirror row_mask:0xf bank_mask:0xf
    v_min_u32_dpp v194, v244, v245 row_half_mirror row_mask:0xf bank_mask:0xf
    v_max_u32_dpp v246, v246, v246 row_half_mirror row_mask:0xf bank_mask:0xf
    v_max_u32_dpp v245, v245, v245 row_half_mirror row_mask:0xf bank_mask:0xf
    v_max_u32_dpp v244, v244, v244 row_half_mirror row_mask:0xf bank_mask:0xf
    v_max3_u32 v246, v246, v193, v194
    v_max_u32 v245, v245, v192
    v_cndmask_b32 v192, v245, v244, s[22:23]
    v_cndmask_b32 v201, v246, v245, s[26:27]
    v_and_b32 v193, 31, v246
    v_and_b32 v192, 31, v192
    v_cndmask_b32 v201, v201, v244, s[24:25]
    v_lshl_add_u32 v4, v192, 13, v52
    v_lshl_add_u32 v5, v193, 13, v52
    v_and_b32 v194, 31, v201
    v_lshl_add_u32 v6, v194, 13, v53
    buffer_load_dwordx4 v[192:195], v4, s[32:35], 0 offen sc1
    buffer_load_dwordx4 v[196:199], v5, s[32:35], 0 offen sc1
    buffer_load_dword v200, v6, s[32:35], 0 offen sc1
    v_readfirstlane_b32 s91, v244
    v_readfirstlane_b32 s94, v245
    v_readfirstlane_b32 s95, v246
    ds_read_b64_tr_b16 v[56:57], v34
    ds_read_b64_tr_b16 v[58:59], v34 offset:512
    ds_read_b64_tr_b16 v[60:61], v34 offset:1024
    ds_read_b64_tr_b16 v[62:63], v34 offset:1536
    ds_read_b64_tr_b16 v[64:65], v34 offset:2048
    ds_read_b64_tr_b16 v[66:67], v34 offset:2560
    ds_read_b64_tr_b16 v[68:69], v34 offset:3072
    ds_read_b64_tr_b16 v[70:71], v34 offset:3584
    ds_read_b64_tr_b16 v[72:73], v34 offset:4096
    ds_read_b64_tr_b16 v[74:75], v34 offset:4608
    ds_read_b64_tr_b16 v[76:77], v34 offset:5120
    ds_read_b64_tr_b16 v[78:79], v34 offset:5632
    ds_read_b64_tr_b16 v[80:81], v34 offset:6144
    ds_read_b64_tr_b16 v[82:83], v34 offset:6656
    ds_read_b64_tr_b16 v[84:85], v34 offset:7168
    ds_read_b64_tr_b16 v[86:87], v34 offset:7680
    s_bfe_u32 s96, s91, 262145
    s_lshl_b32 s97, s96, 7
    s_bfe_u32 s98, s91, 458757
    s_add_u32 s99, s97, s98
    s_xor_b32 s17, s99, 2047
    s_bfe_u32 s96, s94, 262145
    s_lshl_b32 s97, s96, 7
    s_bfe_u32 s98, s94, 458757
    s_add_u32 s99, s97, s98
    s_xor_b32 s18, s99, 2047
    s_bfe_u32 s96, s95, 262145
    s_lshl_b32 s97, s96, 7
    s_bfe_u32 s98, s95, 458757
    s_add_u32 s99, s97, s98
    s_xor_b32 s19, s99, 2047
    v_lshlrev_b32 v208, 16, v224
    v_and_b32 v209, s6, v224
    v_lshlrev_b32 v210, 16, v225
    v_and_b32 v211, s6, v225
    v_lshlrev_b32 v212, 16, v226
    v_and_b32 v213, s6, v226
    v_lshlrev_b32 v214, 16, v227
    v_and_b32 v215, s6, v227
    v_lshlrev_b32 v216, 16, v228
    v_and_b32 v217, s6, v228
    v_lshlrev_b32 v218, 16, v229
    v_and_b32 v219, s6, v229
    v_lshlrev_b32 v220, 16, v230
    v_and_b32 v221, s6, v230
    v_lshlrev_b32 v222, 16, v231
    v_and_b32 v223, s6, v231
    v_pk_mul_f32 v[208:209], v[208:209], v[104:105]
    v_pk_mul_f32 v[210:211], v[210:211], v[106:107]
    v_pk_mul_f32 v[212:213], v[212:213], v[108:109]
    v_pk_mul_f32 v[214:215], v[214:215], v[110:111]
    v_pk_mul_f32 v[216:217], v[216:217], v[112:113]
    v_pk_mul_f32 v[218:219], v[218:219], v[114:115]
    v_pk_mul_f32 v[220:221], v[220:221], v[116:117]
    v_pk_mul_f32 v[222:223], v[222:223], v[118:119]
    v_cvt_pk_bf16_f32 v208, 0, v208
    v_cvt_pk_bf16_f32 v209, 0, v209
    v_cvt_pk_bf16_f32 v210, 0, v210
    v_cvt_pk_bf16_f32 v211, 0, v211
    v_cvt_pk_bf16_f32 v212, 0, v212
    v_cvt_pk_bf16_f32 v213, 0, v213
    v_cvt_pk_bf16_f32 v214, 0, v214
    v_cvt_pk_bf16_f32 v215, 0, v215
    v_cvt_pk_bf16_f32 v216, 0, v216
    v_cvt_pk_bf16_f32 v217, 0, v217
    v_cvt_pk_bf16_f32 v218, 0, v218
    v_cvt_pk_bf16_f32 v219, 0, v219
    v_cvt_pk_bf16_f32 v220, 0, v220
    v_cvt_pk_bf16_f32 v221, 0, v221
    v_cvt_pk_bf16_f32 v222, 0, v222
    v_cvt_pk_bf16_f32 v223, 0, v223
    s_lshl_b32 s96, s3, 11
    s_add_u32 s13, s96, 98304
    v_lshrrev_b32 v44, 4, v1
    v_lshlrev_b32 v44, 4, v44
    v_and_b32 v45, 7, v1
    v_lshlrev_b32 v45, 4, v45
    v_xor_b32 v44, v44, v45
    v_and_b32 v46, 15, v1
    v_lshl_add_u32 v46, v46, 7, s13
    v_add_u32 v44, v44, v46
    v_xor_b32 v46, 64, v44
    v_lshrrev_b32 v47, 3, v1
    v_lshlrev_b32 v47, 4, v47
    v_xor_b32 v45, v47, v45
    v_lshrrev_b32 v47, 3, v1
    v_lshl_add_u32 v47, v47, 7, s13
    v_add_u32 v45, v45, v47
    s_lshl_b32 s96, s21, 7
    s_sub_u32 s97, 2047, s96
    s_lshl_b32 s98, s3, 4
    s_sub_u32 s13, s97, s98
    v_lshrrev_b32 v43, 3, v1
    v_sub_u32 v42, s13, v43
    v_subrev_u32 v43, 8, v42
    v_lshrrev_b32 v33, 3, v1
    v_lshlrev_b32 v33, 11, v33
    v_and_b32 v9, 7, v1
    v_lshl_add_u32 v33, v9, 4, v33
    s_lshl3_add_u32 s96, s21, s3
    s_lshl_b32 s97, s96, 15
    s_lshl_b32 s98, s12, 7
    s_add_u32 s70, s97, s98
    s_add_u32 s71, s70, 16384
    s_waitcnt lgkmcnt(0)
    s_lshl_b32 s13, s3, 6
    v_bfe_u32 v35, v1, 2, 1
    v_lshlrev_b32 v35, 9, v35
    v_bfe_u32 v9, v1, 3, 1
    v_lshl_add_u32 v35, v9, 12, v35
    v_lshrrev_b32 v9, 5, v1
    v_lshl_add_u32 v35, v9, 11, v35
    v_bfe_u32 v9, v1, 2, 2
    v_lshl_add_u32 v35, v9, 6, v35
    v_bfe_u32 v9, v1, 4, 1
    v_lshl_add_u32 v35, v9, 5, v35
    v_and_b32 v9, 3, v1
    v_lshl_add_u32 v35, v9, 3, v35
    v_xor_b32 v35, s13, v35
    v_add_u32 v35, 65536, v35
    v_and_b32 v8, 15, v1
    v_lshlrev_b32 v8, 4, v8
    v_lshrrev_b32 v9, 5, v1
    v_lshl_add_u32 v8, v9, 3, v8
    s_lshl_b32 s96, s74, 13
    s_add_u32 s14, s96, 20971520
    s_lshl3_add_u32 s96, s75, s3
    s_lshl_b32 s97, s96, 8
    s_add_u32 s20, s97, s14
    v_bfe_u32 v7, v201, 1, 4
    v_bfe_u32 v201, v201, 5, 7
    v_lshl_or_b32 v201, v7, 7, v201
    v_xor_b32 v201, 0x7ff, v201
    s_waitcnt vmcnt(0)
    v_max3_u32 v7, v192, v196, v200
    v_cmp_eq_u32 vcc, -1, v7
    s_cbranch_vccz POK_46
PRE_47:
    buffer_load_dwordx4 v[192:195], v4, s[32:35], 0 offen sc1
    buffer_load_dwordx4 v[196:199], v5, s[32:35], 0 offen sc1
    buffer_load_dword v200, v6, s[32:35], 0 offen sc1
    s_waitcnt vmcnt(0)
    v_max3_u32 v7, v192, v196, v200
    v_cmp_eq_u32 vcc, -1, v7
    s_cbranch_vccz POK_46
    s_add_u32 s5, s5, 1
    s_cmp_lt_u32 s5, 200000
    s_cbranch_scc1 PRE_47
POK_46:
    v_add_f32_dpp v200, v200, v200 quad_perm:[1,0,3,2] row_mask:0xf bank_mask:0xf
    s_nop 1
    v_add_f32_dpp v200, v200, v200 quad_perm:[2,3,0,1] row_mask:0xf bank_mask:0xf
    s_nop 1
    v_add_f32_dpp v200, v200, v200 row_half_mirror row_mask:0xf bank_mask:0xf
    s_nop 1
    v_add_f32_dpp v200, v200, v200 row_mirror row_mask:0xf bank_mask:0xf
    v_cvt_pk_bf16_f32 v200, 0, v200
    v_ashrrev_i32 v7, 31, v200
    v_or_b32 v7, 0x80000000, v7
    v_xor_b32 v200, v200, v7
    v_lshrrev_b32 v200, 16, v200
    v_lshl_or_b32 v200, v200, 11, v201
    s_nop 0
    v_readlane_b32 s24, v200, 0
    v_readlane_b32 s25, v200, 16
    v_readlane_b32 s26, v200, 32
    s_not_b64 s[28:29], s[22:23]
    s_cmp_lt_u32 s24, s25
    s_cselect_b64 s[28:29], s[22:23], s[28:29]
    s_cselect_b32 s27, s24, s25
    s_cmp_gt_u32 s26, s27
    s_cselect_b64 vcc, s[28:29], 0
    v_cndmask_b32 v192, v192, v196, vcc
    v_cndmask_b32 v193, v193, v197, vcc
    v_cndmask_b32 v194, v194, v198, vcc
    v_cndmask_b32 v195, v195, v199, vcc
    s_bitcmp1_b32 vcc_lo, 0
    s_cselect_b32 s24, s26, s24
    s_cselect_b32 s19, s17, s19
    s_cselect_b32 s17, s95, s91
    s_bitcmp1_b32 vcc_lo, 8
    s_cselect_b32 s25, s26, s25
    s_cselect_b32 s19, s18, s19
    s_cselect_b32 s18, s95, s94
    s_waitcnt lgkmcnt(0)
    v_mfma_f32_16x16x32_bf16 v[136:139], v[192:195], v[56:59], 0
    v_mfma_f32_16x16x32_bf16 v[140:143], v[192:195], v[60:63], 0
    v_mfma_f32_16x16x32_bf16 v[144:147], v[192:195], v[64:67], 0
    v_mfma_f32_16x16x32_bf16 v[148:151], v[192:195], v[68:71], 0
    v_mfma_f32_16x16x32_bf16 v[168:171], v[192:195], v[72:75], 0
    v_mfma_f32_16x16x32_bf16 v[172:175], v[192:195], v[76:79], 0
    v_mfma_f32_16x16x32_bf16 v[176:179], v[192:195], v[80:83], 0
    v_mfma_f32_16x16x32_bf16 v[180:183], v[192:195], v[84:87], 0
    s_nop 1
    v_add_f32 v196, v136, v141
    s_nop 0
    v_add_f32 v197, v146, v151
    s_nop 0
    v_add_f32 v198, v168, v173
    s_nop 0
    v_add_f32 v199, v178, v183
    v_add_f32 v196, v196, v197
    v_add_f32 v198, v198, v199
    v_mov_b32 v197, s4
    s_nop 0
    v_permlane16_swap_b32 v198, v199
    s_cmp_ge_u32 s9, 28
    s_cbranch_scc1 L_NOHP
    v_add_f32 v196, v196, v199
    s_mov_b32 exec_lo, 0xffff
    s_mov_b32 exec_hi, 0xffff
    buffer_store_dwordx2 v[196:197], v8, s[32:35], s20 offen sc1
    s_mov_b64 exec, -1
L_NOHP:
    s_and_b32 s68, s24, 2047
    s_and_b32 s69, s25, 2047
    v_pk_add_f32 v[208:209], v[208:209], v[152:153]
    v_pk_add_f32 v[210:211], v[210:211], v[154:155]
    v_pk_add_f32 v[212:213], v[212:213], v[156:157]
    v_pk_add_f32 v[214:215], v[214:215], v[158:159]
    v_pk_add_f32 v[216:217], v[216:217], v[160:161]
    v_pk_add_f32 v[218:219], v[218:219], v[162:163]
    v_pk_add_f32 v[220:221], v[220:221], v[164:165]
    v_pk_add_f32 v[222:223], v[222:223], v[166:167]
    v_cvt_pk_bf16_f32 v232, v208, v209
    v_cvt_pk_bf16_f32 v233, v210, v211
    v_cvt_pk_bf16_f32 v234, v212, v213
    v_cvt_pk_bf16_f32 v235, v214, v215
    v_cvt_pk_bf16_f32 v236, v216, v217
    v_cvt_pk_bf16_f32 v237, v218, v219
    v_cvt_pk_bf16_f32 v238, v220, v221
    v_cvt_pk_bf16_f32 v239, v222, v223
    v_permlane32_swap_b32 v232, v234
    v_permlane32_swap_b32 v233, v235
    v_permlane32_swap_b32 v236, v238
    v_permlane32_swap_b32 v237, v239
    ds_write_b128 v44, v[232:235]
    ds_write_b128 v46, v[236:239]
    ds_read_b128 v[232:235], v45
    ds_read_b128 v[236:239], v45 offset:1024
    s_waitcnt lgkmcnt(0)
    s_cmp_lg_u32 s93, 7
    s_cbranch_scc1 L_NONON
    v_mov_b32 v6, s4
    v_mov_b32 v7, 0
    s_mov_b64 exec, 1
    buffer_store_dword v6, v7, s[32:35], 0 offen sc1
    s_mov_b64 exec, -1
L_NONON:
    s_cmp_ge_u32 s9, 28
    s_cbranch_scc1 L_FIN3
    v_bfe_u32 v192, v1, 2, 1
    v_lshlrev_b32 v192, 7, v192
    v_lshrrev_b32 v9, 5, v1
    v_lshl_add_u32 v192, v9, 4, v192
    v_add_u32 v192, 156672, v192
    v_lshrrev_b32 v193, 4, v1
    v_mul_u32_u24 v193, 7168, v193
    v_and_b32 v9, 15, v1
    v_lshl_add_u32 v193, v9, 3, v193
    s_lshl3_add_u32 s96, s75, s3
    s_mul_i32 s97, s96, 28672
    s_lshl_b32 s98, s74, 7
    s_add_u32 s99, s97, s98
    s_add_u32 s80, s99, 22020096
    v_and_b32 v194, 1, v1
    v_lshlrev_b32 v194, 13, v194
    v_bfe_u32 v9, v1, 1, 1
    v_lshl_add_u32 v194, v9, 18, v194
    s_lshr_b32 s96, s9, 2
    s_and_b32 s97, s75, 1
    s_lshr_b32 s98, s3, 1
    s_lshl2_add_u32 s99, s97, s98
    s_and_b32 s97, s3, 1
    s_lshr_b32 s98, s75, 1
    s_lshl2_add_u32 s97, s97, s98
    s_lshl3_add_u32 s98, s99, s97
    s_lshl_b32 s99, s98, 12
    s_lshl_b32 s97, s8, 6
    s_add_u32 s98, s99, s97
    s_lshl2_add_u32 s99, s96, s98
    s_add_u32 s97, s99, 1048576
    s_add_u32 s81, s97, 3072
    s_cmp_lt_u32 s3, 4
    s_cbranch_scc1 L_HW
    s_barrier
    ds_read_b64_tr_b16 v[120:121], v35
    ds_read_b64_tr_b16 v[122:123], v35 offset:1024
    ds_read_b64_tr_b16 v[124:125], v35 offset:8192
    ds_read_b64_tr_b16 v[126:127], v35 offset:9216
    ds_read_b64_tr_b16 v[128:129], v35 offset:16384
    ds_read_b64_tr_b16 v[130:131], v35 offset:17408
    ds_read_b64_tr_b16 v[132:133], v35 offset:24576
    ds_read_b64_tr_b16 v[134:135], v35 offset:25600
    s_cmp_lg_u32 s3, 7
    s_cbranch_scc1 L_NOH
    s_bitcmp1_b32 s9, 3
    s_cselect_b32 s15, s25, s24
    s_cselect_b32 s17, s18, s17
    s_andn2_b32 s18, 2047, s15
L_PAD10:
    s_cbranch_execz L_RET10
    s_lshr_b32 s96, s8, 1
    s_lshl2_add_u32 s19, s12, s96
    s_lshr_b32 s96, s19, 1
    s_lshr_b32 s97, s9, 3
    s_lshl_b32 s98, s97, 1
    s_lshl2_add_u32 s99, s96, s98
    s_and_b32 s97, s19, 1
    s_add_u32 s96, s99, s97
    s_mul_i32 s98, s96, 7168
    s_add_u32 s20, s98, 22020096
    s_lshl_b32 s96, s18, 11
    s_lshl_b32 s97, s19, 5
    s_add_u32 s82, s96, s97
    v_and_b32 v10, 7, v1
    v_lshlrev_b32 v10, 2, v10
    s_lshr_b32 s96, s8, 1
    s_lshl_b32 s97, s96, 6
    s_add_u32 s13, s97, 157184
    v_and_b32 v5, 7, v1
    v_lshl_add_u32 v5, v5, 3, s13
    ds_read_b64 v[206:207], v5
    s_and_b32 s96, s17, 31
    s_lshl_b32 s97, s96, 13
    s_lshl_b32 s98, s12, 9
    s_add_u32 s99, s97, s98
    s_lshr_b32 s96, s8, 1
    s_lshl_b32 s97, s96, 5
    s_add_u32 s98, s99, s97
    s_add_u32 s91, s98, 13631488
    s_lshr_b32 s13, s15, 11
    s_lshl_b32 s13, s13, 16
    s_ashr_i32 s15, s13, 31
    s_andn2_b32 s15, 0x7fff0000, s15
    s_or_b32 s15, s15, 0x80000000
    s_xor_b32 s13, s13, s15
    v_mov_b32 v204, s13
    v_mul_f32 v204, s7, v204
    v_exp_f32 v204, -v204
    s_nop 0
    v_add_f32 v204, 1.0, v204
    v_rcp_f32 v204, v204
    s_nop 0
    v_cvt_pk_bf16_f32 v204, 0, v204
    v_mov_b32 v5, s4
    v_not_b32 v6, v5
POLL_48:
    buffer_load_dword v244, v10, s[32:35], s91 offen sc1
    buffer_load_dword v245, v10, s[32:35], s91 offen offset:128 sc1
    s_waitcnt vmcnt(0)
    v_max_u32 v246, v244, v245
    v_cmp_ne_u32 vcc, -1, v246
    s_nop 1
    v_cndmask_b32 v246, v6, v5, vcc
    v_cmp_ne_u32 vcc, s4, v246
    s_cbranch_vccz PDONE_49
    s_add_u32 s5, s5, 1
    s_cmp_lt_u32 s5, 200000
    s_cbranch_scc1 POLL_48
PDONE_49:
    v_lshlrev_b32 v246, 16, v245
    v_and_b32 v247, s6, v245
    v_and_b32 v245, s6, v244
    v_lshlrev_b32 v244, 16, v244
    s_branch L_NOH
L_HW:
    s_lshl_b32 s96, s3, 8
    s_add_u32 s13, s96, s14
    v_lshrrev_b32 v4, 4, v1
    v_lshlrev_b32 v4, 11, v4
    v_and_b32 v9, 15, v1
    v_lshl_add_u32 v4, v9, 4, v4
    s_lshl_b32 s96, s3, 5
    s_add_u32 s15, s96, 156672
    v_lshrrev_b32 v5, 5, v1
    v_lshl_add_u32 v5, v5, 7, s15
    v_bfe_u32 v9, v1, 2, 1
    v_lshl_add_u32 v5, v9, 4, v5
    v_bfe_u32 v9, v1, 1, 1
    v_lshl_add_u32 v5, v9, 3, v5
    v_bfe_u32 v9, v1, 3, 1
    v_lshl_add_u32 v5, v9, 2, v5
    v_and_b32 v9, 1, v1
    v_lshl_add_u32 v5, v9, 1, v5
    s_load_dword s24, s[32:33], s13 offset:1276 glc
    s_load_dword s25, s[32:33], s13 offset:3324 glc
    s_load_dword s26, s[32:33], s13 offset:5372 glc
    s_load_dword s27, s[32:33], s13 offset:7420 glc
    s_barrier
    ds_read_b64_tr_b16 v[120:121], v35
    ds_read_b64_tr_b16 v[122:123], v35 offset:1024
    ds_read_b64_tr_b16 v[124:125], v35 offset:8192
    ds_read_b64_tr_b16 v[126:127], v35 offset:9216
    ds_read_b64_tr_b16 v[128:129], v35 offset:16384
    ds_read_b64_tr_b16 v[130:131], v35 offset:17408
    ds_read_b64_tr_b16 v[132:133], v35 offset:24576
    ds_read_b64_tr_b16 v[134:135], v35 offset:25600
    s_branch SCHK_51
SPOLL_50:
    s_load_dword s24, s[32:33], s13 offset:1276 glc
    s_load_dword s25, s[32:33], s13 offset:3324 glc
    s_load_dword s26, s[32:33], s13 offset:5372 glc
    s_load_dword s27, s[32:33], s13 offset:7420 glc
SCHK_51:
    s_add_u32 s5, s5, 1
    s_cmp_ge_u32 s5, 200000
    s_waitcnt lgkmcnt(0)
    s_cbranch_scc1 SDONE_52
    s_cmp_lg_u32 s24, s4
    s_cbranch_scc1 SPOLL_50
    s_cmp_lg_u32 s25, s4
    s_cbranch_scc1 SPOLL_50
    s_cmp_lg_u32 s26, s4
    s_cbranch_scc1 SPOLL_50
    s_cmp_lg_u32 s27, s4
    s_cbranch_scc1 SPOLL_50
SDONE_52:
POLL_53:
    buffer_load_dwordx4 v[88:91], v4, s[32:35], s13 offen sc1
    buffer_load_dwordx4 v[92:95], v4, s[32:35], s13 offen offset:1024 sc1
    s_waitcnt vmcnt(0)
    v_bitop3_b32 v6, v89, v91, s4 bitop3:0x7e
    v_bitop3_b32 v6, v6, v93, s4 bitop3:0xf6
    v_bitop3_b32 v6, v6, v95, s4 bitop3:0xf6
    v_cmp_ne_u32 vcc, 0, v6
    s_cbranch_vccz PDONE_54
    s_add_u32 s5, s5, 1
    s_cmp_lt_u32 s5, 200000
    s_cbranch_scc1 POLL_53
PDONE_54:
    v_permlane32_swap_b32 v88, v90
    v_permlane32_swap_b32 v92, v94
    v_add_f32 v88, v88, v90
    v_add_f32 v92, v92, v94
    v_mov_b32 v90, v88
    v_mov_b32 v94, v92
    s_nop 0
    v_permlane16_swap_b32 v88, v90
    v_permlane16_swap_b32 v92, v94
    v_add_f32 v88, v88, v90
    v_add_f32 v92, v92, v94
    v_cvt_pk_bf16_f32 v88, 0, v88
    v_cvt_pk_bf16_f32 v92, 0, v92
    v_mul_f32 v6, s7, v88
    v_exp_f32 v6, -v6
    s_nop 0
    v_add_f32 v6, 1.0, v6
    v_rcp_f32 v6, v6
    s_nop 0
    v_mul_f32 v88, v88, v6
    v_cvt_pk_bf16_f32 v88, 0, v88
    v_mul_f32 v88, v88, v92
    v_cvt_pk_bf16_f32 v88, v88, v88
    ds_write_b16 v5, v88
L_NOH:
    s_waitcnt lgkmcnt(0)
    s_barrier
    ds_read_b128 v[88:91], v192
    ds_read_b128 v[92:95], v192 offset:32
    ds_read_b128 v[96:99], v192 offset:64
    ds_read_b128 v[100:103], v192 offset:96
    s_waitcnt lgkmcnt(3)
    v_mfma_f32_32x32x16_bf16 v[208:223], v[88:91], v[120:123], 0
    s_waitcnt lgkmcnt(2)
    v_mfma_f32_32x32x16_bf16 v[208:223], v[92:95], v[124:127], v[208:223]
    s_waitcnt lgkmcnt(1)
    v_mfma_f32_32x32x16_bf16 v[208:223], v[96:99], v[128:131], v[208:223]
    s_waitcnt lgkmcnt(0)
    v_mfma_f32_32x32x16_bf16 v[208:223], v[100:103], v[132:135], v[208:223]
    s_nop 11
    v_mov_b32 v209, s4
    buffer_store_dwordx2 v[208:209], v193, s[32:35], s80 offen sc1
    s_mov_b64 exec, 15
    buffer_store_dword v209, v194, s[32:35], s81 offen sc1
    s_mov_b64 exec, -1
    s_barrier
    s_branch L_FIN2
L_FIN3:
    s_waitcnt lgkmcnt(0)
L_FIN2:
    v_cmp_ne_u32 vcc, s68, v42
    v_cmp_ne_u32 s[22:23], s69, v42
    s_nop 0
    s_and_b64 exec, vcc, s[22:23]
    buffer_store_dwordx4 v[232:235], v33, s[64:67], s70 offen sc1
    s_mov_b64 exec, -1
    v_cmp_ne_u32 vcc, s68, v43
    v_cmp_ne_u32 s[22:23], s69, v43
    s_nop 0
    s_and_b64 exec, vcc, s[22:23]
    buffer_store_dwordx4 v[236:239], v33, s[64:67], s71 offen sc1
    s_mov_b64 exec, -1
    s_cmp_ge_u32 s9, 16
    s_cbranch_scc1 L_FIN
SPOLL_55:
    s_load_dwordx8 s[24:31], s[32:33], s92 offset:3072 glc
SCHK_56:
    s_add_u32 s5, s5, 1
    s_cmp_ge_u32 s5, 200000
    s_waitcnt lgkmcnt(0)
    s_cbranch_scc1 SDONE_57
    s_cmp_lg_u32 s24, s4
    s_cbranch_scc1 SPOLL_55
    s_cmp_lg_u32 s25, s4
    s_cbranch_scc1 SPOLL_55
    s_cmp_lg_u32 s26, s4
    s_cbranch_scc1 SPOLL_55
    s_cmp_lg_u32 s27, s4
    s_cbranch_scc1 SPOLL_55
    s_cmp_lg_u32 s28, s4
    s_cbranch_scc1 SPOLL_55
    s_cmp_lg_u32 s29, s4
    s_cbranch_scc1 SPOLL_55
    s_cmp_lg_u32 s30, s4
    s_cbranch_scc1 SPOLL_55
SDONE_57:
    s_barrier
    s_cmp_lg_u32 s3, 7
    s_cbranch_scc1 L_FIN
    s_add_u32 s13, s20, 4096
POLL_58:
    buffer_load_dwordx4 v[88:91], v2, s[32:35], s20 offen sc1
    buffer_load_dwordx4 v[92:95], v2, s[32:35], s20 offen offset:1024 sc1
    buffer_load_dwordx4 v[96:99], v2, s[32:35], s20 offen offset:2048 sc1
    buffer_load_dwordx4 v[100:103], v2, s[32:35], s20 offen offset:3072 sc1
    buffer_load_dwordx4 v[104:107], v2, s[32:35], s13 offen sc1
    buffer_load_dwordx4 v[108:111], v2, s[32:35], s13 offen offset:1024 sc1
    buffer_load_dwordx4 v[112:115], v2, s[32:35], s13 offen offset:2048 sc1
    s_waitcnt vmcnt(0)
    v_bitop3_b32 v4, v89, v91, s4 bitop3:0x7e
    v_bitop3_b32 v4, v4, v93, s4 bitop3:0xf6
    v_bitop3_b32 v4, v4, v95, s4 bitop3:0xf6
    v_bitop3_b32 v4, v4, v97, s4 bitop3:0xf6
    v_bitop3_b32 v4, v4, v99, s4 bitop3:0xf6
    v_bitop3_b32 v4, v4, v101, s4 bitop3:0xf6
    v_bitop3_b32 v4, v4, v103, s4 bitop3:0xf6
    v_bitop3_b32 v4, v4, v105, s4 bitop3:0xf6
    v_bitop3_b32 v4, v4, v107, s4 bitop3:0xf6
    v_bitop3_b32 v4, v4, v109, s4 bitop3:0xf6
    v_bitop3_b32 v4, v4, v111, s4 bitop3:0xf6
    v_bitop3_b32 v4, v4, v113, s4 bitop3:0xf6
    v_bitop3_b32 v4, v4, v115, s4 bitop3:0xf6
    v_cmp_ne_u32 vcc, 0, v4
    s_cbranch_vccz PDONE_59
    s_add_u32 s5, s5, 1
    s_cmp_lt_u32 s5, 200000
    s_cbranch_scc1 POLL_58
PDONE_59:
    v_add_f32 v88, v88, v92
    v_add_f32 v90, v90, v94
    v_add_f32 v96, v96, v100
    v_add_f32 v98, v98, v102
    v_add_f32 v104, v104, v108
    v_add_f32 v106, v106, v110
    v_add_f32 v88, v88, v96
    v_add_f32 v90, v90, v98
    v_add_f32 v104, v104, v112
    v_add_f32 v106, v106, v114
    v_add_f32 v88, v88, v104
    v_add_f32 v89, v90, v106
    s_nop 1
    v_permlane32_swap_b32 v88, v89
    v_add_f32 v88, v88, v89
    s_nop 1
    v_add_f32_dpp v88, v88, v88 row_ror:8 row_mask:0xf bank_mask:0xf
    v_mov_b32 v89, v88
    s_nop 1
    v_permlane16_swap_b32 v88, v89
    v_add_f32 v89, v88, v89
    v_cvt_pk_bf16_f32 v88, 0, v89
    v_cvt_pk_bf16_f32 v89, 0, v89
    s_nop 1
    v_permlane32_swap_b32 v88, v89
    v_pk_mul_f32 v[88:89], v[88:89], v[204:205] op_sel_hi:[1,0]
    v_cvt_pk_bf16_f32 v88, 0, v88
    v_cvt_pk_bf16_f32 v89, 0, v89
    v_pk_add_f32 v[88:89], v[88:89], v[244:245]
    v_cvt_pk_bf16_f32 v88, 0, v88
    v_cvt_pk_bf16_f32 v89, 0, v89
    v_pk_mul_f32 v[88:89], v[88:89], v[206:207]
    v_cvt_pk_bf16_f32 v88, 0, v88
    v_cvt_pk_bf16_f32 v89, 0, v89
    v_pk_add_f32 v[88:89], v[88:89], v[246:247]
    v_cvt_pk_bf16_f32 v88, v88, v89
    s_mov_b64 exec, 0xff
    buffer_store_dword v88, v10, s[64:67], s82 offen
    s_mov_b64 exec, -1
L_FIN:
L_END:
    s_endpgm
.p2align 10
.fill 768, 4, 0xbf800000
.section .rodata,"a"
.p2align 6
.amdhsa_kernel adaLN_cond__linear_kernel_hedgehog__moe_arch_mod__prompt_kernel
  .amdhsa_next_free_vgpr 256
  .amdhsa_next_free_sgpr 102
  .amdhsa_accum_offset 256
  .amdhsa_group_segment_fixed_size 0
  .amdhsa_kernarg_size 112
  .amdhsa_user_sgpr_count 2
  .amdhsa_user_sgpr_kernarg_segment_ptr 1
  .amdhsa_system_sgpr_workgroup_id_x 1
  .amdhsa_float_denorm_mode_32 3
  .amdhsa_float_denorm_mode_16_64 3
.end_amdhsa_kernel
```

```asm
; @launch grid=(256,1,1) block=(512,1,1) lds=163840
.amdgcn_target "amdgcn-amd-amdhsa--gfx950"
.text
.globl adaLN_cond__linear_kernel_hedgehog__moe_arch_mod__prompt_kernel
.p2align 12
.type adaLN_cond__linear_kernel_hedgehog__moe_arch_mod__prompt_kernel,@function
adaLN_cond__linear_kernel_hedgehog__moe_arch_mod__prompt_kernel:
    s_load_dwordx16 s[68:83], s[0:1], 0
    s_load_dwordx8 s[84:91], s[0:1], 64
    s_load_dwordx2 s[32:33], s[0:1], 104
    s_cmp_ge_u32 s2, 256
    s_cbranch_scc1 L_END
    v_lshrrev_b32 v4, 6, v0
    v_and_b32 v1, 63, v0
    s_nop 0
    v_readfirstlane_b32 s3, v4
    v_lshlrev_b32 v2, 4, v1
    s_mov_b32 s38, 4194304
    s_mov_b32 s39, 0x20000
    s_mov_b32 s50, 12582912
    s_mov_b32 s51, 0x20000
    s_mov_b32 s34, 268435456
    s_mov_b32 s35, 0x20000
    s_mov_b32 s42, 6291456
    s_mov_b32 s43, 0x20000
    s_mov_b32 s46, 2097152
    s_mov_b32 s47, 0x20000
    s_mov_b32 s54, 7340032
    s_mov_b32 s55, 0x20000
    s_mov_b32 s58, 7340032
    s_mov_b32 s59, 0x20000
    s_mov_b32 s62, 7340032
    s_mov_b32 s63, 0x20000
    s_mov_b32 s66, 4194304
    s_mov_b32 s67, 0x20000
    s_mov_b32 s5, 0
    s_mov_b32 s6, 0xffff0000
    s_mov_b32 s7, 0x3fb8aa3b
    s_and_b32 s8, s2, 7
    s_lshr_b32 s9, s2, 3
    s_lshl3_add_u32 s93, s2, s3
    s_and_b32 s96, s8, 4
    s_lshr_b32 s97, s9, 2
    s_lshl1_add_u32 s10, s96, s97
    s_and_b32 s96, s8, 3
    s_and_b32 s97, s9, 3
    s_xor_b32 s98, s97, 2
    s_lshl2_add_u32 s11, s96, s98
    s_and_b32 s96, s8, 1
    s_and_b32 s97, s9, 7
    s_lshl3_add_u32 s12, s96, s97
    s_lshr_b32 s96, s8, 1
    s_lshr_b32 s97, s9, 3
    s_lshl2_add_u32 s21, s96, s97
    s_lshl_b32 s96, s2, 6
    s_add_u32 s97, s96, s3
    s_lshl_b32 s98, s97, 6
    s_add_u32 s92, s98, 1048576
    s_lshr_b32 s96, s8, 1
    s_lshl_b32 s97, s96, 8
    s_lshl3_add_u32 s98, s9, s97
    s_add_u32 s99, s98, s3
    s_lshl_b32 s96, s99, 12
    s_and_b32 s97, s8, 1
    s_lshl_b32 s98, s97, 10
    s_add_u32 s16, s96, s98
    v_and_b32 v8, 31, v1
    v_lshlrev_b32 v8, 4, v8
    v_lshrrev_b32 v9, 5, v1
    v_lshl_add_u32 v8, v9, 11, v8
    s_lshl3_add_u32 s96, s8, s3
    s_lshl_b32 s15, s96, 5
    s_mul_i32 s96, s15, 6144
    s_xor_b32 s97, s9, 1
    s_lshl_b32 s98, s97, 7
    s_add_u32 s13, s96, s98
    s_add_u32 s14, s13, 98304
    s_lshl3_add_u32 s96, s21, s3
    s_lshl_b32 s97, s96, 15
    s_lshl_b32 s98, s12, 7
    s_add_u32 s18, s97, s98
    s_lshr_b32 s96, s8, 1
    s_lshl4_add_u32 s97, s96, s12
    s_lshl4_add_u32 s98, s97, s3
    s_lshl_b32 s99, s98, 9
    s_add_u32 s17, s99, 524288
    v_lshrrev_b32 v248, 3, v1
    v_mul_u32_u24 v248, 12288, v248
    v_and_b32 v9, 7, v1
    v_lshl_add_u32 v248, v9, 4, v248
    v_lshrrev_b32 v249, 3, v1
    v_lshl_add_u32 v249, v249, 1, s15
    v_and_b32 v10, 15, v1
    v_lshlrev_b32 v10, 11, v10
    v_lshrrev_b32 v9, 4, v1
    v_lshl_add_u32 v10, v9, 4, v10
    s_waitcnt lgkmcnt(0)
    s_mov_b64 s[48:49], s[88:89]
    buffer_load_dwordx4 v[160:163], v248, s[48:51], s13 offen nt
    buffer_load_dwordx4 v[164:167], v248, s[48:51], s14 offen nt
    s_load_dword s4, s[32:33], 0
    global_load_ushort v168, v249, s[86:87]
    global_load_ushort v169, v249, s[86:87] offset:16
    s_mov_b64 s[36:37], s[68:69]
    s_load_dword s24, s[32:33], s92 offset:0 glc
    s_load_dword s25, s[32:33], s17 offset:508 glc
    s_load_dword s26, s[32:33], s17 offset:4604 glc
    s_barrier
    buffer_load_dwordx4 v[152:155], v8, s[36:39], s16 offen
    buffer_load_dwordx4 v[156:159], v8, s[36:39], s16 offen offset:512
    s_mov_b64 s[40:41], s[70:71]
    s_mov_b64 s[44:45], s[74:75]
    s_mov_b64 s[52:53], s[80:81]
    s_mov_b64 s[56:57], s[82:83]
    s_mov_b64 s[60:61], s[84:85]
    s_mov_b64 s[64:65], s[90:91]
    s_getpc_b64 s[22:23]
    s_and_b32 s22, s22, 0xfffffc00
    s_lshl3_add_u32 s96, s9, s3
    s_lshl_b32 s19, s96, 7
    v_lshrrev_b32 v4, 5, v1
    v_lshl_add_u32 v4, v4, 15, s19
    v_min_u32 v4, 41984, v4
    global_load_dword v11, v4, s[22:23]
    s_lshr_b32 s76, s3, 2
    s_and_b32 s77, s3, 3
    s_lshl_b32 s83, s3, 10
    s_mul_i32 s96, s8, 7
    s_lshr_b32 s97, s9, 2
    s_add_u32 s74, s96, s97
    s_and_b32 s75, s9, 3
    v_bfe_u32 v6, v1, 4, 1
    v_lshlrev_b32 v6, 6, v6
    v_and_b32 v3, 7, v1
    v_lshlrev_b32 v3, 4, v3
    v_xor_b32 v3, v3, v6
    v_lshrrev_b32 v6, 3, v1
    v_mul_u32_u24 v6, 6144, v6
    v_add_u32 v3, v3, v6
    s_and_b32 s84, s9, 12
    s_mul_i32 s96, s3, 49152
    s_lshl_b32 s97, s11, 7
    s_add_u32 s85, s96, s97
    v_lshlrev_b32 v250, 3, v1
    v_lshlrev_b32 v251, 5, v1
    v_add_u32 v251, 147456, v251
    s_lshl2_add_u32 s13, s3, 147456
    v_lshrrev_b32 v252, 4, v1
    v_lshl_add_u32 v252, v252, 6, s13
    v_and_b32 v9, 7, v1
    v_lshl_add_u32 v252, v9, 8, v252
    v_bfe_u32 v9, v1, 3, 1
    v_lshl_add_u32 v252, v9, 5, v252
    buffer_load_dwordx4 v[12:15], v10, s[36:39], s18 offen
    buffer_load_dwordx4 v[16:19], v10, s[36:39], s18 offen offset:64
    s_lshr_b32 s96, s3, 1
    s_xor_b32 s97, s9, 1
    s_and_b32 s98, s97, 15
    s_lshl4_add_u32 s99, s96, s98
    s_lshr_b32 s97, s9, 4
    s_lshl1_add_u32 s96, s99, s97
    s_lshl3_add_u32 s98, s96, s8
    s_lshl_b32 s99, s98, 9
    s_add_u32 s13, s99, 524288
    s_lshr_b32 s96, s9, 4
    s_lshl_b32 s94, s96, 1
    s_add_u32 s96, s94, s84
    s_and_b32 s97, s96, 15
    s_mul_i32 s98, s97, 393216
    s_add_u32 s91, s98, s85
    s_lshl_b32 s96, s94, 13
    s_add_u32 s94, s96, s83
    s_add_u32 s82, s91, 2048
    s_mov_b32 m0, s94
    s_nop 0
    buffer_load_dwordx4 v3, s[40:43], s82 offen lds
    s_add_u32 s82, s91, 4096
    s_add_u32 m0, s94, 49152
    s_nop 0
    buffer_load_dwordx4 v3, s[40:43], s82 offen lds
    s_waitcnt vmcnt(7)
    v_lshlrev_b32 v168, 16, v168
    v_mul_f32 v4, s7, v168
    v_exp_f32 v4, -v4
    s_nop 0
    v_add_f32 v4, 1.0, v4
    v_rcp_f32 v4, v4
    s_nop 0
    v_mul_f32 v168, v168, v4
    v_cvt_pk_bf16_f32 v168, 0, v168
    v_lshlrev_b32 v169, 16, v169
    v_mul_f32 v5, s7, v169
    v_exp_f32 v5, -v5
    s_nop 0
    v_add_f32 v5, 1.0, v5
    v_rcp_f32 v5, v5
    s_nop 0
    v_mul_f32 v169, v169, v5
    v_cvt_pk_bf16_f32 v169, 0, v169
    v_lshlrev_b32 v4, 16, v160
    v_and_b32 v5, s6, v160
    v_pk_mul_f32 v[176:177], v[168:169], v[4:5] op_sel:[0,0] op_sel_hi:[0,1]
    v_lshlrev_b32 v6, 16, v161
    v_and_b32 v7, s6, v161
    v_pk_mul_f32 v[178:179], v[168:169], v[6:7] op_sel:[0,0] op_sel_hi:[0,1]
    v_lshlrev_b32 v4, 16, v162
    v_and_b32 v5, s6, v162
    v_pk_mul_f32 v[180:181], v[168:169], v[4:5] op_sel:[0,0] op_sel_hi:[0,1]
    v_lshlrev_b32 v6, 16, v163
    v_and_b32 v7, s6, v163
    v_pk_mul_f32 v[182:183], v[168:169], v[6:7] op_sel:[0,0] op_sel_hi:[0,1]
    v_lshlrev_b32 v4, 16, v164
    v_and_b32 v5, s6, v164
    v_pk_fma_f32 v[176:177], v[168:169], v[4:5], v[176:177] op_sel:[1,0,0] op_sel_hi:[1,1,1]
    v_lshlrev_b32 v6, 16, v165
    v_and_b32 v7, s6, v165
    v_pk_fma_f32 v[178:179], v[168:169], v[6:7], v[178:179] op_sel:[1,0,0] op_sel_hi:[1,1,1]
    v_lshlrev_b32 v4, 16, v166
    v_and_b32 v5, s6, v166
    v_pk_fma_f32 v[180:181], v[168:169], v[4:5], v[180:181] op_sel:[1,0,0] op_sel_hi:[1,1,1]
    v_lshlrev_b32 v6, 16, v167
    v_and_b32 v7, s6, v167
    v_pk_fma_f32 v[182:183], v[168:169], v[6:7], v[182:183] op_sel:[1,0,0] op_sel_hi:[1,1,1]
    v_permlane32_swap_b32 v176, v180
    v_permlane32_swap_b32 v177, v181
    v_permlane32_swap_b32 v178, v182
    v_permlane32_swap_b32 v179, v183
    v_add_f32 v176, v176, v180
    v_add_f32 v177, v177, v181
    v_add_f32 v178, v178, v182
    v_add_f32 v179, v179, v183
    s_nop 0
    v_permlane16_swap_b32 v176, v178
    v_permlane16_swap_b32 v177, v179
    v_add_f32 v176, v176, v178
    v_add_f32 v177, v177, v179
    s_nop 0
    v_add_f32_dpp v176, v176, v176 row_ror:8 row_mask:0xf bank_mask:0xf
    v_add_f32_dpp v177, v177, v177 row_ror:8 row_mask:0xf bank_mask:0xf
    s_nop 1
    v_mov_b32_dpp v176, v177 quad_perm:[0,1,2,3] row_mask:0xf bank_mask:0xc
    s_waitcnt lgkmcnt(0)
    s_mul_i32 s4, s4, 0x9e3779b1
    s_add_u32 s4, s4, 0x7f4a7c15
    ds_write_b32 v252, v176
    s_waitcnt lgkmcnt(0)
    s_barrier
    ds_read_b128 v[176:179], v251
    ds_read_b128 v[180:183], v251 offset:16
    s_waitcnt lgkmcnt(0)
    v_pk_add_f32 v[176:177], v[176:177], v[178:179]
    v_pk_add_f32 v[180:181], v[180:181], v[182:183]
    v_pk_add_f32 v[176:177], v[176:177], v[180:181]
    v_add_f32 v176, v176, v177
    v_mov_b32 v177, s4
    s_bitcmp1_b32 s3, 0
    s_cselect_b32 exec_lo, 0, -1
    s_cselect_b32 exec_hi, -1, 0
    buffer_store_dwordx2 v[176:177], v250, s[32:35], s13 offen sc1
    s_mov_b64 exec, -1
    s_waitcnt vmcnt(6)
    v_mov_b32 v8, 0x3f803f80
    v_dot2_f32_bf16 v4, v152, v8, 0
    v_dot2_f32_bf16 v5, v152, v152, 0
    v_dot2_f32_bf16 v6, v153, v8, 0
    v_dot2_f32_bf16 v7, v153, v153, 0
    v_dot2_f32_bf16 v4, v154, v8, v4
    v_dot2_f32_bf16 v5, v154, v154, v5
    v_dot2_f32_bf16 v6, v155, v8, v6
    v_dot2_f32_bf16 v7, v155, v155, v7
    v_dot2_f32_bf16 v4, v156, v8, v4
    v_dot2_f32_bf16 v5, v156, v156, v5
    v_dot2_f32_bf16 v6, v157, v8, v6
    v_dot2_f32_bf16 v7, v157, v157, v7
    v_dot2_f32_bf16 v4, v158, v8, v4
    v_dot2_f32_bf16 v5, v158, v158, v5
    v_dot2_f32_bf16 v6, v159, v8, v6
    v_dot2_f32_bf16 v7, v159, v159, v7
    s_lshl_b32 s96, s3, 5
    s_add_u32 s13, s96, 153600
    v_lshrrev_b32 v8, 5, v1
    v_lshl_add_u32 v8, v8, 4, s13
    v_bfe_u32 v9, v1, 4, 1
    v_lshl_add_u32 v8, v9, 3, v8
    v_pk_add_f32 v[172:173], v[4:5], v[6:7]
    v_and_b32 v5, 15, v1
    v_lshlrev_b32 v5, 4, v5
    v_add_u32 v5, 153600, v5
    v_and_b32 v4, 15, v1
    v_lshlrev_b32 v4, 4, v4
    v_bfe_u32 v9, v1, 4, 1
    v_lshl_add_u32 v4, v9, 12, v4
    v_add_f32_dpp v172, v172, v172 quad_perm:[1,0,3,2] row_mask:0xf bank_mask:0xf
    v_add_f32_dpp v173, v173, v173 quad_perm:[1,0,3,2] row_mask:0xf bank_mask:0xf
    s_nop 0
    v_add_f32_dpp v172, v172, v172 quad_perm:[2,3,0,1] row_mask:0xf bank_mask:0xf
    v_add_f32_dpp v173, v173, v173 quad_perm:[2,3,0,1] row_mask:0xf bank_mask:0xf
    s_nop 0
    v_add_f32_dpp v172, v172, v172 row_half_mirror row_mask:0xf bank_mask:0xf
    v_add_f32_dpp v173, v173, v173 row_half_mirror row_mask:0xf bank_mask:0xf
    s_nop 0
    v_add_f32_dpp v172, v172, v172 row_mirror row_mask:0xf bank_mask:0xf
    v_add_f32_dpp v173, v173, v173 row_mirror row_mask:0xf bank_mask:0xf
    s_and_b32 s96, s9, 24
    s_add_u32 s97, s96, s3
    s_and_b32 s98, s8, 6
    s_lshl3_add_u32 s99, s97, s98
    s_lshl_b32 s96, s99, 12
    s_and_b32 s97, s9, 7
    s_lshl_b32 s98, s97, 9
    s_add_u32 s99, s96, s98
    s_and_b32 s97, s8, 1
    s_lshl_b32 s96, s97, 8
    s_add_u32 s98, s99, s96
    s_add_u32 s13, s98, 2097152
    v_permlane16_swap_b32 v172, v173
    v_add_f32 v172, v172, v173
    v_mov_b32 v173, s4
    ds_write_b64 v8, v[172:173]
    s_waitcnt lgkmcnt(0)
    s_barrier
    ds_read_b128 v[172:175], v5
    s_waitcnt lgkmcnt(0)
    s_mov_b32 exec_hi, 0
    buffer_store_dwordx4 v[172:175], v4, s[32:35], s13 offen sc1
    s_mov_b32 exec_hi, -1
    s_mov_b32 s82, s91
    s_add_u32 m0, s94, 98304
    s_nop 0
    buffer_load_dwordx4 v3, s[40:43], s82 offen lds
    s_lshr_b32 s96, s9, 4
    s_lshl_b32 s97, s96, 1
    s_xor_b32 s94, s97, 1
    s_add_u32 s96, s94, s84
    s_and_b32 s97, s96, 15
    s_mul_i32 s98, s97, 393216
    s_add_u32 s91, s98, s85
    s_lshl_b32 s96, s94, 13
    s_add_u32 s94, s96, s83
    s_add_u32 s82, s91, 2048
    s_mov_b32 m0, s94
    s_nop 0
    buffer_load_dwordx4 v3, s[40:43], s82 offen lds
    s_load_dword s24, s[32:33], s17 offset:508 glc
    s_load_dword s25, s[32:33], s17 offset:4604 glc
    v_and_b32 v4, 31, v1
    v_lshlrev_b32 v4, 4, v4
    v_lshrrev_b32 v9, 5, v1
    v_lshl_add_u32 v4, v9, 12, v4
    s_lshl2_add_u32 s14, s3, 155648
    v_lshl_add_u32 v5, v1, 6, s14
    v_and_b32 v6, 3, v1
    v_lshlrev_b32 v6, 5, v6
    v_lshrrev_b32 v9, 5, v1
    v_lshl_add_u32 v6, v9, 7, v6
    v_bfe_u32 v9, v1, 4, 1
    v_lshl_add_u32 v6, v9, 8, v6
    v_bfe_u32 v9, v1, 2, 2
    v_lshl_add_u32 v6, v9, 9, v6
    v_add_u32 v6, 155648, v6
    s_lshl3_add_u32 s96, s2, s3
    s_lshl_b32 s97, s96, 9
    s_add_u32 s14, s97, 2097152
    v_and_b32 v8, 31, v1
    v_lshlrev_b32 v8, 4, v8
    s_branch SCHK_2
SPOLL_1:
    s_load_dword s24, s[32:33], s17 offset:508 glc
    s_load_dword s25, s[32:33], s17 offset:4604 glc
SCHK_2:
    s_add_u32 s5, s5, 1
    s_cmp_ge_u32 s5, 200000
    s_waitcnt lgkmcnt(0)
    s_cbranch_scc1 SDONE_3
    s_cmp_lg_u32 s24, s4
    s_cbranch_scc1 SPOLL_1
    s_cmp_lg_u32 s25, s4
    s_cbranch_scc1 SPOLL_1
SDONE_3:
    buffer_load_dwordx4 v[176:179], v4, s[32:35], s17 offen sc1
    s_load_dword s24, s[32:33], s14 offset:252 glc
    s_load_dword s25, s[32:33], s14 offset:508 glc
    s_waitcnt vmcnt(7)
    v_permlane32_swap_b32 v12, v14
    v_permlane32_swap_b32 v13, v15
    v_permlane32_swap_b32 v16, v18
    v_permlane32_swap_b32 v17, v19
    v_lshlrev_b32 v184, 16, v12
    v_and_b32 v185, s6, v12
    v_lshlrev_b32 v186, 16, v13
    v_and_b32 v187, s6, v13
    v_lshlrev_b32 v188, 16, v14
    v_and_b32 v189, s6, v14
    v_lshlrev_b32 v190, 16, v15
    v_and_b32 v191, s6, v15
    v_lshlrev_b32 v192, 16, v16
    v_and_b32 v193, s6, v16
    v_lshlrev_b32 v194, 16, v17
    v_and_b32 v195, s6, v17
    v_lshlrev_b32 v196, 16, v18
    v_and_b32 v197, s6, v18
    v_lshlrev_b32 v198, 16, v19
    v_and_b32 v199, s6, v19
    s_branch SCHK_6
SPOLL_5:
    s_load_dword s24, s[32:33], s14 offset:252 glc
    s_load_dword s25, s[32:33], s14 offset:508 glc
SCHK_6:
    s_add_u32 s5, s5, 1
    s_cmp_ge_u32 s5, 200000
    s_waitcnt lgkmcnt(0)
    s_cbranch_scc1 SDONE_7
    s_cmp_lg_u32 s24, s4
    s_cbranch_scc1 SPOLL_5
    s_cmp_lg_u32 s25, s4
    s_cbranch_scc1 SPOLL_5
SDONE_7:
    buffer_load_dwordx4 v[172:175], v8, s[32:35], s14 offen sc1
    s_add_u32 s82, s91, 4096
    s_add_u32 m0, s94, 49152
    s_nop 0
    buffer_load_dwordx4 v3, s[40:43], s82 offen lds
    s_mov_b32 s82, s91
    s_add_u32 m0, s94, 98304
    s_nop 0
    buffer_load_dwordx4 v3, s[40:43], s82 offen lds
    s_waitcnt vmcnt(3)
    v_bitop3_b32 v7, v177, v179, s4 bitop3:0x7e
    v_cmp_ne_u32 vcc, 0, v7
    s_cbranch_vccz TOK_8
POLL_9:
    buffer_load_dwordx4 v[176:179], v4, s[32:35], s17 offen sc1
    s_waitcnt vmcnt(0)
    v_bitop3_b32 v7, v177, v179, s4 bitop3:0x7e
    v_cmp_ne_u32 vcc, 0, v7
    s_cbranch_vccz PDONE_10
    s_add_u32 s5, s5, 1
    s_cmp_lt_u32 s5, 200000
    s_cbranch_scc1 POLL_9
PDONE_10:
TOK_8:
    ds_write2_b32 v5, v176, v178 offset0:0 offset1:8
    s_waitcnt lgkmcnt(0)
    s_barrier
    ds_read_b128 v[208:211], v6 offset:2048
    ds_read_b128 v[212:215], v6 offset:2064
    ds_read_b128 v[200:203], v6
    ds_read_b128 v[204:207], v6 offset:16
    s_lshl_b32 s96, s11, 12
    s_lshl_b32 s97, s3, 9
    s_add_u32 s13, s96, s97
    v_add_u32 v4, s13, v2
    s_lshl_b32 s96, s3, 9
    s_add_u32 m0, s96, 159744
    s_mov_b32 exec_hi, 0
    global_load_lds_dwordx4 v4, s[72:73]
    s_mov_b32 exec_hi, -1
    s_lshl4_add_u32 s96, s21, s12
    s_lshr_b32 s97, s3, 1
    s_lshl2_add_u32 s98, s96, s97
    s_lshl_b32 s99, s98, 12
    s_and_b32 s96, s3, 1
    s_lshl_b32 s97, s96, 8
    s_add_u32 s98, s99, s97
    s_add_u32 s13, s98, 4194304
    v_and_b32 v4, 15, v1
    v_lshlrev_b32 v4, 4, v4
    v_bfe_u32 v9, v1, 4, 1
    v_lshl_add_u32 v4, v9, 10, v4
    v_lshrrev_b32 v9, 5, v1
    v_lshl_add_u32 v4, v9, 9, v4
    s_waitcnt lgkmcnt(2)
    v_pk_add_f32 v[208:209], v[208:209], v[210:211]
    v_pk_add_f32 v[212:213], v[212:213], v[214:215]
    v_pk_add_f32 v[208:209], v[208:209], v[212:213]
    v_add_f32 v208, v208, v209
    v_cvt_pk_bf16_f32 v208, 0, v208
    s_waitcnt lgkmcnt(0)
    v_pk_add_f32 v[200:201], v[200:201], v[202:203]
    v_pk_add_f32 v[204:205], v[204:205], v[206:207]
    v_pk_add_f32 v[200:201], v[200:201], v[204:205]
    v_add_f32 v200, v200, v201
    v_add_f32 v208, 1.0, v208
    v_cvt_pk_bf16_f32 v208, 0, v208
    v_cvt_pk_bf16_f32 v200, 0, v200
    s_waitcnt vmcnt(3)
    v_bitop3_b32 v7, v173, v175, s4 bitop3:0x7e
    v_cmp_ne_u32 vcc, 0, v7
    s_cbranch_vccz L_STOK
POLL_11:
    buffer_load_dwordx4 v[172:175], v8, s[32:35], s14 offen sc1
    s_waitcnt vmcnt(0)
    v_bitop3_b32 v7, v173, v175, s4 bitop3:0x7e
    v_cmp_ne_u32 vcc, 0, v7
    s_cbranch_vccz PDONE_12
    s_add_u32 s5, s5, 1
    s_cmp_lt_u32 s5, 200000
    s_cbranch_scc1 POLL_11
PDONE_12:
L_STOK:
    v_permlane16_swap_b32 v172, v174
    v_add_f32 v175, v172, v174
    v_mul_f32 v174, 0x3a800000, v175
    v_mul_f32 v175, 0x3a800000, v175
    s_nop 1
    v_permlane16_swap_b32 v174, v175
    v_fma_f32 v172, -v174, v174, v175
    v_cvt_pk_bf16_f32 v173, 0, v174
    v_max_f32 v172, 0, v172
    v_cvt_pk_bf16_f32 v172, 0, v172
    v_pk_add_f32 v[184:185], v[172:173], v[184:185] op_sel:[1,0] neg_lo:[1,0] neg_hi:[1,0]
    v_pk_add_f32 v[186:187], v[172:173], v[186:187] op_sel:[1,0] neg_lo:[1,0] neg_hi:[1,0]
    v_pk_add_f32 v[188:189], v[172:173], v[188:189] op_sel:[1,0] neg_lo:[1,0] neg_hi:[1,0]
    v_pk_add_f32 v[190:191], v[172:173], v[190:191] op_sel:[1,0] neg_lo:[1,0] neg_hi:[1,0]
    v_add_f32 v172, 0x3727c5ac, v172
    v_cvt_pk_bf16_f32 v172, 0, v172
    v_sqrt_f32 v172, v172
    s_nop 0
    v_pk_add_f32 v[192:193], v[172:173], v[192:193] op_sel:[1,0] neg_lo:[1,0] neg_hi:[1,0]
    v_pk_add_f32 v[194:195], v[172:173], v[194:195] op_sel:[1,0] neg_lo:[1,0] neg_hi:[1,0]
    v_pk_add_f32 v[196:197], v[172:173], v[196:197] op_sel:[1,0] neg_lo:[1,0] neg_hi:[1,0]
    v_pk_add_f32 v[198:199], v[172:173], v[198:199] op_sel:[1,0] neg_lo:[1,0] neg_hi:[1,0]
    v_cvt_pk_bf16_f32 v172, 0, v172
    v_rcp_f32 v172, v172
    v_cvt_pk_bf16_f32 v184, 0, v184
    v_cvt_pk_bf16_f32 v185, 0, v185
    v_cvt_pk_bf16_f32 v186, 0, v186
    v_cvt_pk_bf16_f32 v187, 0, v187
    v_cvt_pk_bf16_f32 v188, 0, v188
    v_cvt_pk_bf16_f32 v189, 0, v189
    v_cvt_pk_bf16_f32 v190, 0, v190
    v_cvt_pk_bf16_f32 v191, 0, v191
    v_cvt_pk_bf16_f32 v192, 0, v192
    v_cvt_pk_bf16_f32 v193, 0, v193
    v_cvt_pk_bf16_f32 v194, 0, v194
    v_cvt_pk_bf16_f32 v195, 0, v195
    v_cvt_pk_bf16_f32 v196, 0, v196
    v_cvt_pk_bf16_f32 v197, 0, v197
    v_cvt_pk_bf16_f32 v198, 0, v198
    v_cvt_pk_bf16_f32 v199, 0, v199
    v_pk_mul_f32 v[184:185], v[184:185], v[172:173] op_sel_hi:[1,0]
    v_pk_mul_f32 v[186:187], v[186:187], v[172:173] op_sel_hi:[1,0]
    v_pk_mul_f32 v[188:189], v[188:189], v[172:173] op_sel_hi:[1,0]
    v_pk_mul_f32 v[190:191], v[190:191], v[172:173] op_sel_hi:[1,0]
    v_pk_mul_f32 v[192:193], v[192:193], v[172:173] op_sel_hi:[1,0]
    v_pk_mul_f32 v[194:195], v[194:195], v[172:173] op_sel_hi:[1,0]
    v_pk_mul_f32 v[196:197], v[196:197], v[172:173] op_sel_hi:[1,0]
    v_pk_mul_f32 v[198:199], v[198:199], v[172:173] op_sel_hi:[1,0]
    v_cvt_pk_bf16_f32 v184, 0, v184
    v_cvt_pk_bf16_f32 v185, 0, v185
    v_cvt_pk_bf16_f32 v186, 0, v186
    v_cvt_pk_bf16_f32 v187, 0, v187
    v_cvt_pk_bf16_f32 v188, 0, v188
    v_cvt_pk_bf16_f32 v189, 0, v189
    v_cvt_pk_bf16_f32 v190, 0, v190
    v_cvt_pk_bf16_f32 v191, 0, v191
    v_cvt_pk_bf16_f32 v192, 0, v192
    v_cvt_pk_bf16_f32 v193, 0, v193
    v_cvt_pk_bf16_f32 v194, 0, v194
    v_cvt_pk_bf16_f32 v195, 0, v195
    v_cvt_pk_bf16_f32 v196, 0, v196
    v_cvt_pk_bf16_f32 v197, 0, v197
    v_cvt_pk_bf16_f32 v198, 0, v198
    v_cvt_pk_bf16_f32 v199, 0, v199
    v_mul_f32_dpp v184, v208, v184 row_newbcast:0 row_mask:0xf bank_mask:0xf
    v_mul_f32_dpp v185, v208, v185 row_newbcast:1 row_mask:0xf bank_mask:0xf
    v_mul_f32_dpp v186, v208, v186 row_newbcast:2 row_mask:0xf bank_mask:0xf
    v_mul_f32_dpp v187, v208, v187 row_newbcast:3 row_mask:0xf bank_mask:0xf
    v_mul_f32_dpp v188, v208, v188 row_newbcast:4 row_mask:0xf bank_mask:0xf
    v_mul_f32_dpp v189, v208, v189 row_newbcast:5 row_mask:0xf bank_mask:0xf
    v_mul_f32_dpp v190, v208, v190 row_newbcast:6 row_mask:0xf bank_mask:0xf
    v_mul_f32_dpp v191, v208, v191 row_newbcast:7 row_mask:0xf bank_mask:0xf
    v_cvt_pk_bf16_f32 v184, 0, v184
    v_cvt_pk_bf16_f32 v185, 0, v185
    v_cvt_pk_bf16_f32 v186, 0, v186
    v_cvt_pk_bf16_f32 v187, 0, v187
    v_cvt_pk_bf16_f32 v188, 0, v188
    v_cvt_pk_bf16_f32 v189, 0, v189
    v_cvt_pk_bf16_f32 v190, 0, v190
    v_cvt_pk_bf16_f32 v191, 0, v191
    v_add_f32_dpp v184, v200, v184 row_newbcast:0 row_mask:0xf bank_mask:0xf
    v_add_f32_dpp v185, v200, v185 row_newbcast:1 row_mask:0xf bank_mask:0xf
    v_add_f32_dpp v186, v200, v186 row_newbcast:2 row_mask:0xf bank_mask:0xf
    v_add_f32_dpp v187, v200, v187 row_newbcast:3 row_mask:0xf bank_mask:0xf
    v_add_f32_dpp v188, v200, v188 row_newbcast:4 row_mask:0xf bank_mask:0xf
    v_add_f32_dpp v189, v200, v189 row_newbcast:5 row_mask:0xf bank_mask:0xf
    v_add_f32_dpp v190, v200, v190 row_newbcast:6 row_mask:0xf bank_mask:0xf
    v_add_f32_dpp v191, v200, v191 row_newbcast:7 row_mask:0xf bank_mask:0xf
    v_cvt_pk_bf16_f32 v216, v184, v185
    v_cvt_pk_bf16_f32 v217, v186, v187
    v_cvt_pk_bf16_f32 v218, v188, v189
    v_cvt_pk_bf16_f32 v219, v190, v191
    buffer_store_dwordx4 v[216:219], v4, s[32:35], s13 offen sc1
    v_mul_f32_dpp v192, v208, v192 row_newbcast:8 row_mask:0xf bank_mask:0xf
    v_mul_f32_dpp v193, v208, v193 row_newbcast:9 row_mask:0xf bank_mask:0xf
    v_mul_f32_dpp v194, v208, v194 row_newbcast:10 row_mask:0xf bank_mask:0xf
    v_mul_f32_dpp v195, v208, v195 row_newbcast:11 row_mask:0xf bank_mask:0xf
    v_mul_f32_dpp v196, v208, v196 row_newbcast:12 row_mask:0xf bank_mask:0xf
    v_mul_f32_dpp v197, v208, v197 row_newbcast:13 row_mask:0xf bank_mask:0xf
    v_mul_f32_dpp v198, v208, v198 row_newbcast:14 row_mask:0xf bank_mask:0xf
    v_mul_f32_dpp v199, v208, v199 row_newbcast:15 row_mask:0xf bank_mask:0xf
    v_cvt_pk_bf16_f32 v192, 0, v192
    v_cvt_pk_bf16_f32 v193, 0, v193
    v_cvt_pk_bf16_f32 v194, 0, v194
    v_cvt_pk_bf16_f32 v195, 0, v195
    v_cvt_pk_bf16_f32 v196, 0, v196
    v_cvt_pk_bf16_f32 v197, 0, v197
    v_cvt_pk_bf16_f32 v198, 0, v198
    v_cvt_pk_bf16_f32 v199, 0, v199
    v_add_f32_dpp v192, v200, v192 row_newbcast:8 row_mask:0xf bank_mask:0xf
    v_add_f32_dpp v193, v200, v193 row_newbcast:9 row_mask:0xf bank_mask:0xf
    v_add_f32_dpp v194, v200, v194 row_newbcast:10 row_mask:0xf bank_mask:0xf
    v_add_f32_dpp v195, v200, v195 row_newbcast:11 row_mask:0xf bank_mask:0xf
    v_add_f32_dpp v196, v200, v196 row_newbcast:12 row_mask:0xf bank_mask:0xf
    v_add_f32_dpp v197, v200, v197 row_newbcast:13 row_mask:0xf bank_mask:0xf
    v_add_f32_dpp v198, v200, v198 row_newbcast:14 row_mask:0xf bank_mask:0xf
    v_add_f32_dpp v199, v200, v199 row_newbcast:15 row_mask:0xf bank_mask:0xf
    v_cvt_pk_bf16_f32 v220, v192, v193
    v_cvt_pk_bf16_f32 v221, v194, v195
    v_cvt_pk_bf16_f32 v222, v196, v197
    v_cvt_pk_bf16_f32 v223, v198, v199
    buffer_store_dwordx4 v[220:223], v4, s[32:35], s13 offen offset:2048 sc1
    v_bfe_u32 v20, v1, 2, 2
    v_lshlrev_b32 v20, 7, v20
    v_bfe_u32 v9, v1, 3, 1
    v_lshl_add_u32 v20, v9, 6, v20
    v_bfe_u32 v9, v1, 4, 1
    v_lshl_add_u32 v20, v9, 5, v20
    v_and_b32 v9, 3, v1
    v_lshl_add_u32 v20, v9, 3, v20
    v_lshrrev_b32 v9, 5, v1
    v_lshl_add_u32 v20, v9, 9, v20
    v_xor_b32 v21, 64, v20
    v_add_u32 v22, 49152, v20
    v_add_u32 v23, 49152, v21
    v_add_u32 v24, 98304, v20
    v_add_u32 v25, 98304, v21
    v_and_b32 v5, 3, v1
    v_lshlrev_b32 v5, 15, v5
    v_bfe_u32 v9, v1, 2, 2
    v_lshl_add_u32 v5, v9, 12, v5
    s_and_b32 s96, s12, 1
    s_lshr_b32 s97, s21, 3
    s_and_b32 s98, s21, 7
    s_lshl_b32 s99, s98, 5
    s_lshl2_add_u32 s98, s97, s99
    s_lshl_b32 s97, s98, 12
    s_lshr_b32 s99, s12, 1
    s_lshl_b32 s98, s99, 6
    s_add_u32 s99, s97, s98
    s_lshl2_add_u32 s97, s96, s99
    s_add_u32 s13, s97, 1048576
    s_lshl_b32 s96, s10, 18
    s_lshl_b32 s97, s77, 12
    s_add_u32 s98, s96, s97
    s_add_u32 s88, s98, 4194304
    s_cmp_ge_u32 s9, 28
    s_cselect_b32 s54, 0, s54
    s_cselect_b32 s58, 0, s58
    s_cselect_b32 s62, 0, s62
    s_waitcnt vmcnt(0)
    s_barrier
    s_cmp_lg_u32 s3, 0
    s_cbranch_scc1 L_PB
    v_mov_b32 v6, s4
    s_mov_b32 exec_hi, 0
    s_mov_b32 exec_lo, 65535
    buffer_store_dword v6, v5, s[32:35], s13 offen sc1
    s_mov_b64 exec, -1
L_PB:
    s_lshr_b32 s96, s9, 4
    s_lshl_b32 s97, s96, 1
    s_xor_b32 s94, s97, 2
    s_add_u32 s96, s94, s84
    s_and_b32 s97, s96, 15
    s_mul_i32 s98, s97, 393216
    s_add_u32 s91, s98, s85
    s_lshl_b32 s96, s94, 13
    s_add_u32 s94, s96, s83
    s_add_u32 s82, s91, 2048
    s_mov_b32 m0, s94
    s_nop 0
    buffer_load_dwordx4 v3, s[40:43], s82 offen lds
    s_add_u32 s82, s91, 4096
    s_add_u32 m0, s94, 49152
    s_nop 0
    buffer_load_dwordx4 v3, s[40:43], s82 offen lds
    s_mov_b32 s82, s91
    s_add_u32 m0, s94, 98304
    s_nop 0
    buffer_load_dwordx4 v3, s[40:43], s82 offen lds
    s_lshr_b32 s96, s9, 4
    s_lshl_b32 s97, s96, 1
    s_xor_b32 s94, s97, 3
    s_add_u32 s96, s94, s84
    s_and_b32 s97, s96, 15
    s_mul_i32 s98, s97, 393216
    s_add_u32 s91, s98, s85
    s_lshl_b32 s96, s94, 13
    s_add_u32 s94, s96, s83
    s_add_u32 s82, s91, 2048
    s_mov_b32 m0, s94
    s_nop 0
    buffer_load_dwordx4 v3, s[40:43], s82 offen lds
    s_add_u32 s82, s91, 4096
    s_add_u32 m0, s94, 49152
    s_nop 0
    buffer_load_dwordx4 v3, s[40:43], s82 offen lds
    s_mov_b32 s82, s91
    s_add_u32 m0, s94, 98304
    s_nop 0
    buffer_load_dwordx4 v3, s[40:43], s82 offen lds
    s_lshl_b32 s96, s2, 12
    s_add_u32 s19, s96, 1048576
    s_and_b32 s96, s3, 3
    s_lshl_b32 s97, s96, 7
    s_add_u32 s20, s97, s19
    s_lshl_b32 s96, s84, 5
    s_add_u32 s19, s96, s19
    s_cmp_ge_u32 s3, 4
    s_cselect_b32 s19, s20, s19
    s_load_dwordx2 s[24:25], s[32:33], s19 offset:0 glc
    s_load_dwordx2 s[26:27], s[32:33], s19 offset:64 glc
    s_lshl_b32 s96, s3, 14
    s_lshl_b32 s97, s12, 7
    s_add_u32 s90, s96, s97
    s_and_b32 s96, s9, 1
    s_lshr_b32 s97, s9, 3
    s_lshl_b32 s98, s97, 1
    s_lshl3_add_u32 s99, s96, s98
    s_lshl_b32 s95, s99, 17
    s_lshl3_add_u32 s96, s75, s3
    s_mul_i32 s97, s96, 229376
    s_lshl_b32 s98, s74, 7
    s_add_u32 s80, s97, s98
    s_lshl3_add_u32 s96, s74, s3
    s_lshl_b32 s97, s96, 14
    s_lshl_b32 s98, s75, 9
    s_add_u32 s81, s97, s98
    s_and_b32 s96, s8, 3
    s_lshl3_add_u32 s97, s96, s3
    s_mul_i32 s98, s97, 393216
    s_lshr_b32 s99, s8, 2
    s_lshl1_add_u32 s96, s9, s99
    s_lshl_b32 s97, s96, 7
    s_add_u32 s99, s98, s97
    s_add_u32 s89, s99, 4096
    s_and_b32 s96, s3, 1
    s_lshl_b32 s14, s96, 6
    v_bfe_u32 v6, v1, 4, 1
    v_lshl_add_u32 v6, v6, 5, s14
    v_and_b32 v26, 7, v1
    v_lshlrev_b32 v26, 4, v26
    v_xor_b32 v26, v26, v6
    v_lshrrev_b32 v6, 3, v1
    v_lshlrev_b32 v6, 11, v6
    v_add_u32 v26, v26, v6
    s_and_b32 s96, s3, 2
    s_lshl_b32 s14, s96, 5
    v_bfe_u32 v6, v1, 4, 1
    v_lshl_add_u32 v6, v6, 5, s14
    v_and_b32 v27, 7, v1
    v_lshlrev_b32 v27, 4, v27
    v_xor_b32 v27, v27, v6
    v_lshrrev_b32 v6, 3, v1
    v_mul_u32_u24 v6, 7168, v6
    v_add_u32 v27, v27, v6
    s_and_b32 s96, s3, 1
    s_lshl_b32 s14, s96, 7
    v_lshrrev_b32 v6, 5, v1
    v_lshl_add_u32 v6, v6, 6, s14
    v_and_b32 v253, 31, v1
    v_lshlrev_b32 v253, 4, v253
    v_lshrrev_b32 v9, 5, v1
    v_lshl_add_u32 v253, v9, 11, v253
    v_xor_b32 v253, v253, v6
    s_lshl_b32 s16, s84, 14
    v_add_u32 v249, s88, v2
    s_lshl_b32 s96, s77, 11
    s_add_u32 s14, s96, 151552
    v_add_u32 v0, s14, v2
    s_mov_b64 exec, 0
    s_cmp_eq_u32 s3, 4
    s_cbranch_scc1 L_PAD2
    s_cmp_eq_u32 s3, 5
    s_cbranch_scc1 L_PAD3
    s_cmp_eq_u32 s3, 6
    s_cbranch_scc1 L_PAD4
    s_cmp_eq_u32 s3, 7
    s_cbranch_scc1 L_PAD5
    s_branch L_TEND
L_RET2:
    s_branch L_PAD6
L_RET6:
    s_branch L_PAD10
L_RET10:
    s_branch L_TEND
L_RET3:
    s_branch L_PAD7
L_RET7:
    s_branch L_TEND
L_RET4:
    s_branch L_PAD8
L_RET8:
    s_branch L_TEND
L_RET5:
    s_branch L_PAD9
L_RET9:
    s_branch L_TEND
    s_nop 0
    s_nop 0
    s_nop 0
    s_nop 0
    s_nop 0
    s_nop 0
    s_nop 0
    s_nop 0
    s_nop 0
    s_nop 0
    s_nop 0
    s_nop 0
    s_nop 0
    s_nop 0
    s_nop 0
    s_nop 0
    s_nop 0
    s_nop 0
    s_nop 0
    s_nop 0
    s_nop 0
    s_nop 0
    s_nop 0
    s_nop 0
    s_nop 0
    s_nop 0
    s_nop 0
    s_nop 0
L_TEND:
    s_mov_b64 exec, -1
    s_cmp_ge_u32 s3, 4
    s_cbranch_scc1 L_HELP
    s_branch SCHK_14
SPOLL_13:
    s_load_dwordx2 s[24:25], s[32:33], s19 offset:0 glc
    s_load_dwordx2 s[26:27], s[32:33], s19 offset:64 glc
SCHK_14:
    s_add_u32 s5, s5, 1
    s_cmp_ge_u32 s5, 200000
    s_waitcnt lgkmcnt(0)
    s_cbranch_scc1 SDONE_15
    s_cmp_lg_u32 s24, s4
    s_cbranch_scc1 SPOLL_13
    s_cmp_lg_u32 s25, s4
    s_cbranch_scc1 SPOLL_13
    s_cmp_lg_u32 s26, s4
    s_cbranch_scc1 SPOLL_13
    s_cmp_lg_u32 s27, s4
    s_cbranch_scc1 SPOLL_13
SDONE_15:
    s_setprio 2
    buffer_load_dwordx4 v[152:155], v249, s[32:35], s16 offen sc1
    buffer_load_dwordx4 v[156:159], v249, s[32:35], s16 offen offset:1024 sc1
    buffer_load_dwordx4 v[160:163], v249, s[32:35], s16 offen offset:2048 sc1
    buffer_load_dwordx4 v[164:167], v249, s[32:35], s16 offen offset:3072 sc1
    s_add_u32 s16, s16, 16384
    s_and_b32 s16, s16, 0x3ffff
    buffer_load_dwordx4 v[168:171], v249, s[32:35], s16 offen sc1
    buffer_load_dwordx4 v[172:175], v249, s[32:35], s16 offen offset:1024 sc1
    buffer_load_dwordx4 v[176:179], v249, s[32:35], s16 offen offset:2048 sc1
    buffer_load_dwordx4 v[180:183], v249, s[32:35], s16 offen offset:3072 sc1
    s_waitcnt vmcnt(8)
    s_barrier
    ds_read_b64_tr_b16 v[28:29], v20
    ds_read_b64_tr_b16 v[30:31], v20 offset:2048
    ds_read_b64_tr_b16 v[32:33], v21
    ds_read_b64_tr_b16 v[34:35], v21 offset:2048
    ds_read_b64_tr_b16 v[36:37], v24
    ds_read_b64_tr_b16 v[38:39], v24 offset:2048
    ds_read_b64_tr_b16 v[40:41], v25
    ds_read_b64_tr_b16 v[42:43], v25 offset:2048
    ds_read_b64_tr_b16 v[44:45], v22
    ds_read_b64_tr_b16 v[46:47], v22 offset:2048
    ds_read_b64_tr_b16 v[48:49], v23
    ds_read_b64_tr_b16 v[50:51], v23 offset:2048
    s_waitcnt vmcnt(7)
    s_waitcnt lgkmcnt(10)
    v_mfma_f32_32x32x16_bf16 v[56:71], v[28:31], v[152:155], 0
    s_add_u32 s16, s16, 16384
    ds_read_b64_tr_b16 v[52:53], v20 offset:1024
    ds_read_b64_tr_b16 v[54:55], v20 offset:3072
    s_waitcnt lgkmcnt(10)
    v_mfma_f32_32x32x16_bf16 v[72:87], v[32:35], v[152:155], 0
    s_and_b32 s16, s16, 0x3ffff
    ds_read_b64_tr_b16 v[28:29], v21 offset:1024
    ds_read_b64_tr_b16 v[30:31], v21 offset:3072
    s_waitcnt lgkmcnt(10)
    v_mfma_f32_32x32x16_bf16 v[120:135], v[36:39], v[152:155], 0
    ds_read_b64_tr_b16 v[32:33], v24 offset:1024
    ds_read_b64_tr_b16 v[34:35], v24 offset:3072
    s_waitcnt lgkmcnt(10)
    v_mfma_f32_32x32x16_bf16 v[136:151], v[40:43], v[152:155], 0
    buffer_load_dwordx4 v[184:187], v249, s[32:35], s16 offen sc1
    ds_read_b64_tr_b16 v[36:37], v25 offset:1024
    ds_read_b64_tr_b16 v[38:39], v25 offset:3072
    s_waitcnt lgkmcnt(10)
    v_mfma_f32_32x32x16_bf16 v[88:103], v[44:47], v[152:155], 0
    ds_read_b64_tr_b16 v[40:41], v22 offset:1024
    ds_read_b64_tr_b16 v[42:43], v22 offset:3072
    s_waitcnt lgkmcnt(10)
    v_mfma_f32_32x32x16_bf16 v[104:119], v[48:51], v[152:155], 0
    ds_read_b64_tr_b16 v[44:45], v23 offset:1024
    ds_read_b64_tr_b16 v[46:47], v23 offset:3072
    s_waitcnt vmcnt(7)
    s_waitcnt lgkmcnt(10)
    v_mfma_f32_32x32x16_bf16 v[56:71], v[52:55], v[156:159], v[56:71]
    ds_read_b64_tr_b16 v[48:49], v20 offset:4096
    ds_read_b64_tr_b16 v[50:51], v20 offset:6144
    s_waitcnt lgkmcnt(10)
    v_mfma_f32_32x32x16_bf16 v[72:87], v[28:31], v[156:159], v[72:87]
    buffer_load_dwordx4 v[188:191], v249, s[32:35], s16 offen offset:1024 sc1
    ds_read_b64_tr_b16 v[52:53], v21 offset:4096
    ds_read_b64_tr_b16 v[54:55], v21 offset:6144
    s_waitcnt lgkmcnt(10)
    v_mfma_f32_32x32x16_bf16 v[120:135], v[32:35], v[156:159], v[120:135]
    ds_read_b64_tr_b16 v[28:29], v24 offset:4096
    ds_read_b64_tr_b16 v[30:31], v24 offset:6144
    s_waitcnt lgkmcnt(10)
    v_mfma_f32_32x32x16_bf16 v[136:151], v[36:39], v[156:159], v[136:151]
    ds_read_b64_tr_b16 v[32:33], v25 offset:4096
    ds_read_b64_tr_b16 v[34:35], v25 offset:6144
    s_waitcnt lgkmcnt(10)
    v_mfma_f32_32x32x16_bf16 v[88:103], v[40:43], v[156:159], v[88:103]
    ds_read_b64_tr_b16 v[36:37], v22 offset:4096
    ds_read_b64_tr_b16 v[38:39], v22 offset:6144
    s_waitcnt lgkmcnt(10)
    v_mfma_f32_32x32x16_bf16 v[104:119], v[44:47], v[156:159], v[104:119]
    buffer_load_dwordx4 v[192:195], v249, s[32:35], s16 offen offset:2048 sc1
    ds_read_b64_tr_b16 v[40:41], v23 offset:4096
    ds_read_b64_tr_b16 v[42:43], v23 offset:6144
    s_waitcnt vmcnt(8)
    s_waitcnt lgkmcnt(10)
    v_mfma_f32_32x32x16_bf16 v[56:71], v[48:51], v[160:163], v[56:71]
    ds_read_b64_tr_b16 v[44:45], v20 offset:5120
    ds_read_b64_tr_b16 v[46:47], v20 offset:7168
    s_waitcnt lgkmcnt(10)
    v_mfma_f32_32x32x16_bf16 v[72:87], v[52:55], v[160:163], v[72:87]
    ds_read_b64_tr_b16 v[48:49], v21 offset:5120
    ds_read_b64_tr_b16 v[50:51], v21 offset:7168
    s_waitcnt lgkmcnt(10)
    v_mfma_f32_32x32x16_bf16 v[120:135], v[28:31], v[160:163], v[120:135]
    ds_read_b64_tr_b16 v[52:53], v24 offset:5120
    ds_read_b64_tr_b16 v[54:55], v24 offset:7168
    s_waitcnt lgkmcnt(10)
    v_mfma_f32_32x32x16_bf16 v[136:151], v[32:35], v[160:163], v[136:151]
    buffer_load_dwordx4 v[196:199], v249, s[32:35], s16 offen offset:3072 sc1
    ds_read_b64_tr_b16 v[28:29], v25 offset:5120
    ds_read_b64_tr_b16 v[30:31], v25 offset:7168
    s_waitcnt lgkmcnt(10)
    v_mfma_f32_32x32x16_bf16 v[88:103], v[36:39], v[160:163], v[88:103]
    s_add_u32 s16, s16, 16384
    ds_read_b64_tr_b16 v[32:33], v22 offset:5120
    ds_read_b64_tr_b16 v[34:35], v22 offset:7168
    s_waitcnt lgkmcnt(10)
    v_mfma_f32_32x32x16_bf16 v[104:119], v[40:43], v[160:163], v[104:119]
    s_and_b32 s16, s16, 0x3ffff
    ds_read_b64_tr_b16 v[36:37], v23 offset:5120
    ds_read_b64_tr_b16 v[38:39], v23 offset:7168
    s_waitcnt vmcnt(8)
    s_waitcnt lgkmcnt(10)
    v_mfma_f32_32x32x16_bf16 v[56:71], v[44:47], v[164:167], v[56:71]
    ds_read_b64_tr_b16 v[40:41], v20 offset:8192
    ds_read_b64_tr_b16 v[42:43], v20 offset:10240
    s_waitcnt lgkmcnt(10)
    v_mfma_f32_32x32x16_bf16 v[72:87], v[48:51], v[164:167], v[72:87]
    buffer_load_dwordx4 v[200:203], v249, s[32:35], s16 offen sc1
    ds_read_b64_tr_b16 v[44:45], v21 offset:8192
    ds_read_b64_tr_b16 v[46:47], v21 offset:10240
    s_waitcnt lgkmcnt(10)
    v_mfma_f32_32x32x16_bf16 v[120:135], v[52:55], v[164:167], v[120:135]
    ds_read_b64_tr_b16 v[48:49], v24 offset:8192
    ds_read_b64_tr_b16 v[50:51], v24 offset:10240
    s_waitcnt lgkmcnt(10)
    v_mfma_f32_32x32x16_bf16 v[136:151], v[28:31], v[164:167], v[136:151]
    ds_read_b64_tr_b16 v[52:53], v25 offset:8192
    ds_read_b64_tr_b16 v[54:55], v25 offset:10240
    s_waitcnt lgkmcnt(10)
    v_mfma_f32_32x32x16_bf16 v[88:103], v[32:35], v[164:167], v[88:103]
    ds_read_b64_tr_b16 v[28:29], v22 offset:8192
    ds_read_b64_tr_b16 v[30:31], v22 offset:10240
    s_waitcnt lgkmcnt(10)
    v_mfma_f32_32x32x16_bf16 v[104:119], v[36:39], v[164:167], v[104:119]
    buffer_load_dwordx4 v[204:207], v249, s[32:35], s16 offen offset:1024 sc1
    ds_read_b64_tr_b16 v[32:33], v23 offset:8192
    ds_read_b64_tr_b16 v[34:35], v23 offset:10240
    s_barrier
    s_waitcnt vmcnt(9)
    s_waitcnt lgkmcnt(10)
    v_mfma_f32_32x32x16_bf16 v[56:71], v[40:43], v[168:171], v[56:71]
    ds_read_b64_tr_b16 v[36:37], v20 offset:9216
    ds_read_b64_tr_b16 v[38:39], v20 offset:11264
    s_waitcnt lgkmcnt(10)
    v_mfma_f32_32x32x16_bf16 v[72:87], v[44:47], v[168:171], v[72:87]
    ds_read_b64_tr_b16 v[40:41], v21 offset:9216
    ds_read_b64_tr_b16 v[42:43], v21 offset:11264
    s_waitcnt lgkmcnt(10)
    v_mfma_f32_32x32x16_bf16 v[120:135], v[48:51], v[168:171], v[120:135]
    ds_read_b64_tr_b16 v[44:45], v24 offset:9216
    ds_read_b64_tr_b16 v[46:47], v24 offset:11264
    s_waitcnt lgkmcnt(10)
    v_mfma_f32_32x32x16_bf16 v[136:151], v[52:55], v[168:171], v[136:151]
    ds_read_b64_tr_b16 v[48:49], v25 offset:9216
    ds_read_b64_tr_b16 v[50:51], v25 offset:11264
    s_waitcnt lgkmcnt(10)
    v_mfma_f32_32x32x16_bf16 v[88:103], v[28:31], v[168:171], v[88:103]
    ds_read_b64_tr_b16 v[52:53], v22 offset:9216
    ds_read_b64_tr_b16 v[54:55], v22 offset:11264
    s_waitcnt lgkmcnt(10)
    v_mfma_f32_32x32x16_bf16 v[104:119], v[32:35], v[168:171], v[104:119]
    ds_read_b64_tr_b16 v[28:29], v23 offset:9216
    ds_read_b64_tr_b16 v[30:31], v23 offset:11264
    s_waitcnt vmcnt(8)
    s_waitcnt lgkmcnt(10)
    v_mfma_f32_32x32x16_bf16 v[56:71], v[36:39], v[172:175], v[56:71]
    ds_read_b64_tr_b16 v[32:33], v20 offset:12288
    ds_read_b64_tr_b16 v[34:35], v20 offset:14336
    s_waitcnt lgkmcnt(10)
    v_mfma_f32_32x32x16_bf16 v[72:87], v[40:43], v[172:175], v[72:87]
    ds_read_b64_tr_b16 v[36:37], v21 offset:12288
    ds_read_b64_tr_b16 v[38:39], v21 offset:14336
    s_waitcnt lgkmcnt(10)
    v_mfma_f32_32x32x16_bf16 v[120:135], v[44:47], v[172:175], v[120:135]
    buffer_load_dwordx4 v[208:211], v249, s[32:35], s16 offen offset:2048 sc1
    ds_read_b64_tr_b16 v[40:41], v24 offset:12288
    ds_read_b64_tr_b16 v[42:43], v24 offset:14336
    s_waitcnt lgkmcnt(10)
    v_mfma_f32_32x32x16_bf16 v[136:151], v[48:51], v[172:175], v[136:151]
    ds_read_b64_tr_b16 v[44:45], v25 offset:12288
    ds_read_b64_tr_b16 v[46:47], v25 offset:14336
    s_waitcnt lgkmcnt(10)
    v_mfma_f32_32x32x16_bf16 v[88:103], v[52:55], v[172:175], v[88:103]
    ds_read_b64_tr_b16 v[48:49], v22 offset:12288
    ds_read_b64_tr_b16 v[50:51], v22 offset:14336
    s_waitcnt lgkmcnt(10)
    v_mfma_f32_32x32x16_bf16 v[104:119], v[28:31], v[172:175], v[104:119]
    buffer_load_dwordx4 v[212:215], v249, s[32:35], s16 offen offset:3072 sc1
    ds_read_b64_tr_b16 v[52:53], v23 offset:12288
    ds_read_b64_tr_b16 v[54:55], v23 offset:14336
    s_waitcnt vmcnt(9)
    s_waitcnt lgkmcnt(10)
    v_mfma_f32_32x32x16_bf16 v[56:71], v[32:35], v[176:179], v[56:71]
    s_add_u32 s16, s16, 16384
    ds_read_b64_tr_b16 v[28:29], v20 offset:13312
    ds_read_b64_tr_b16 v[30:31], v20 offset:15360
    s_waitcnt lgkmcnt(10)
    v_mfma_f32_32x32x16_bf16 v[72:87], v[36:39], v[176:179], v[72:87]
    s_and_b32 s16, s16, 0x3ffff
    ds_read_b64_tr_b16 v[32:33], v21 offset:13312
    ds_read_b64_tr_b16 v[34:35], v21 offset:15360
    s_waitcnt lgkmcnt(10)
    v_mfma_f32_32x32x16_bf16 v[120:135], v[40:43], v[176:179], v[120:135]
    buffer_load_dwordx4 v[216:219], v249, s[32:35], s16 offen sc1
    ds_read_b64_tr_b16 v[36:37], v24 offset:13312
    ds_read_b64_tr_b16 v[38:39], v24 offset:15360
    s_waitcnt lgkmcnt(10)
    v_mfma_f32_32x32x16_bf16 v[136:151], v[44:47], v[176:179], v[136:151]
    ds_read_b64_tr_b16 v[40:41], v25 offset:13312
    ds_read_b64_tr_b16 v[42:43], v25 offset:15360
    s_waitcnt lgkmcnt(10)
    v_mfma_f32_32x32x16_bf16 v[88:103], v[48:51], v[176:179], v[88:103]
    ds_read_b64_tr_b16 v[44:45], v22 offset:13312
    ds_read_b64_tr_b16 v[46:47], v22 offset:15360
    s_waitcnt lgkmcnt(10)
    v_mfma_f32_32x32x16_bf16 v[104:119], v[52:55], v[176:179], v[104:119]
    buffer_load_dwordx4 v[220:223], v249, s[32:35], s16 offen offset:1024 sc1
    ds_read_b64_tr_b16 v[48:49], v23 offset:13312
    ds_read_b64_tr_b16 v[50:51], v23 offset:15360
    s_waitcnt vmcnt(10)
    s_waitcnt lgkmcnt(10)
    v_mfma_f32_32x32x16_bf16 v[56:71], v[28:31], v[180:183], v[56:71]
    ds_read_b64_tr_b16 v[52:53], v20 offset:16384
    ds_read_b64_tr_b16 v[54:55], v20 offset:18432
    s_waitcnt lgkmcnt(10)
    v_mfma_f32_32x32x16_bf16 v[72:87], v[32:35], v[180:183], v[72:87]
    ds_read_b64_tr_b16 v[28:29], v21 offset:16384
    ds_read_b64_tr_b16 v[30:31], v21 offset:18432
    s_waitcnt lgkmcnt(10)
    v_mfma_f32_32x32x16_bf16 v[120:135], v[36:39], v[180:183], v[120:135]
    buffer_load_dwordx4 v[224:227], v249, s[32:35], s16 offen offset:2048 sc1
    ds_read_b64_tr_b16 v[32:33], v24 offset:16384
    ds_read_b64_tr_b16 v[34:35], v24 offset:18432
    s_waitcnt lgkmcnt(10)
    v_mfma_f32_32x32x16_bf16 v[136:151], v[40:43], v[180:183], v[136:151]
    ds_read_b64_tr_b16 v[36:37], v25 offset:16384
    ds_read_b64_tr_b16 v[38:39], v25 offset:18432
    s_waitcnt lgkmcnt(10)
    v_mfma_f32_32x32x16_bf16 v[88:103], v[44:47], v[180:183], v[88:103]
    ds_read_b64_tr_b16 v[40:41], v22 offset:16384
    ds_read_b64_tr_b16 v[42:43], v22 offset:18432
    s_waitcnt lgkmcnt(10)
    v_mfma_f32_32x32x16_bf16 v[104:119], v[48:51], v[180:183], v[104:119]
    buffer_load_dwordx4 v[228:231], v249, s[32:35], s16 offen offset:3072 sc1
    ds_read_b64_tr_b16 v[44:45], v23 offset:16384
    ds_read_b64_tr_b16 v[46:47], v23 offset:18432
    s_barrier
    s_waitcnt vmcnt(11)
    s_waitcnt lgkmcnt(10)
    v_mfma_f32_32x32x16_bf16 v[56:71], v[52:55], v[184:187], v[56:71]
    s_add_u32 s16, s16, 16384
    ds_read_b64_tr_b16 v[48:49], v20 offset:17408
    ds_read_b64_tr_b16 v[50:51], v20 offset:19456
    s_waitcnt lgkmcnt(10)
    v_mfma_f32_32x32x16_bf16 v[72:87], v[28:31], v[184:187], v[72:87]
    s_and_b32 s16, s16, 0x3ffff
    ds_read_b64_tr_b16 v[52:53], v21 offset:17408
    ds_read_b64_tr_b16 v[54:55], v21 offset:19456
    s_waitcnt lgkmcnt(10)
    v_mfma_f32_32x32x16_bf16 v[120:135], v[32:35], v[184:187], v[120:135]
    ds_read_b64_tr_b16 v[28:29], v24 offset:17408
    ds_read_b64_tr_b16 v[30:31], v24 offset:19456
    s_waitcnt lgkmcnt(10)
    v_mfma_f32_32x32x16_bf16 v[136:151], v[36:39], v[184:187], v[136:151]
    ds_read_b64_tr_b16 v[32:33], v25 offset:17408
    ds_read_b64_tr_b16 v[34:35], v25 offset:19456
    s_waitcnt lgkmcnt(10)
    v_mfma_f32_32x32x16_bf16 v[88:103], v[40:43], v[184:187], v[88:103]
    ds_read_b64_tr_b16 v[36:37], v22 offset:17408
    ds_read_b64_tr_b16 v[38:39], v22 offset:19456
    s_waitcnt lgkmcnt(10)
    v_mfma_f32_32x32x16_bf16 v[104:119], v[44:47], v[184:187], v[104:119]
    ds_read_b64_tr_b16 v[40:41], v23 offset:17408
    ds_read_b64_tr_b16 v[42:43], v23 offset:19456
    s_waitcnt vmcnt(10)
    s_waitcnt lgkmcnt(10)
    v_mfma_f32_32x32x16_bf16 v[56:71], v[48:51], v[188:191], v[56:71]
    ds_read_b64_tr_b16 v[44:45], v20 offset:20480
    ds_read_b64_tr_b16 v[46:47], v20 offset:22528
    s_waitcnt lgkmcnt(10)
    v_mfma_f32_32x32x16_bf16 v[72:87], v[52:55], v[188:191], v[72:87]
    ds_read_b64_tr_b16 v[48:49], v21 offset:20480
    ds_read_b64_tr_b16 v[50:51], v21 offset:22528
    s_waitcnt lgkmcnt(10)
    v_mfma_f32_32x32x16_bf16 v[120:135], v[28:31], v[188:191], v[120:135]
    buffer_load_dwordx4 v[232:235], v249, s[32:35], s16 offen sc1
    ds_read_b64_tr_b16 v[52:53], v24 offset:20480
    ds_read_b64_tr_b16 v[54:55], v24 offset:22528
    s_waitcnt lgkmcnt(10)
    v_mfma_f32_32x32x16_bf16 v[136:151], v[32:35], v[188:191], v[136:151]
    ds_read_b64_tr_b16 v[28:29], v25 offset:20480
    ds_read_b64_tr_b16 v[30:31], v25 offset:22528
    s_waitcnt lgkmcnt(10)
    v_mfma_f32_32x32x16_bf16 v[88:103], v[36:39], v[188:191], v[88:103]
    ds_read_b64_tr_b16 v[32:33], v22 offset:20480
    ds_read_b64_tr_b16 v[34:35], v22 offset:22528
    s_waitcnt lgkmcnt(10)
    v_mfma_f32_32x32x16_bf16 v[104:119], v[40:43], v[188:191], v[104:119]
    buffer_load_dwordx4 v[236:239], v249, s[32:35], s16 offen offset:1024 sc1
    ds_read_b64_tr_b16 v[36:37], v23 offset:20480
    ds_read_b64_tr_b16 v[38:39], v23 offset:22528
    s_waitcnt vmcnt(11)
    s_waitcnt lgkmcnt(10)
    v_mfma_f32_32x32x16_bf16 v[56:71], v[44:47], v[192:195], v[56:71]
    ds_read_b64_tr_b16 v[40:41], v20 offset:21504
    ds_read_b64_tr_b16 v[42:43], v20 offset:23552
    s_waitcnt lgkmcnt(10)
    v_mfma_f32_32x32x16_bf16 v[72:87], v[48:51], v[192:195], v[72:87]
    ds_read_b64_tr_b16 v[44:45], v21 offset:21504
    ds_read_b64_tr_b16 v[46:47], v21 offset:23552
    s_waitcnt lgkmcnt(10)
    v_mfma_f32_32x32x16_bf16 v[120:135], v[52:55], v[192:195], v[120:135]
    buffer_load_dwordx4 v[240:243], v249, s[32:35], s16 offen offset:2048 sc1
    ds_read_b64_tr_b16 v[48:49], v24 offset:21504
    ds_read_b64_tr_b16 v[50:51], v24 offset:23552
    s_waitcnt lgkmcnt(10)
    v_mfma_f32_32x32x16_bf16 v[136:151], v[28:31], v[192:195], v[136:151]
    ds_read_b64_tr_b16 v[52:53], v25 offset:21504
    ds_read_b64_tr_b16 v[54:55], v25 offset:23552
    s_waitcnt lgkmcnt(10)
    v_mfma_f32_32x32x16_bf16 v[88:103], v[32:35], v[192:195], v[88:103]
    ds_read_b64_tr_b16 v[28:29], v22 offset:21504
    ds_read_b64_tr_b16 v[30:31], v22 offset:23552
    s_waitcnt lgkmcnt(10)
    v_mfma_f32_32x32x16_bf16 v[104:119], v[36:39], v[192:195], v[104:119]
    buffer_load_dwordx4 v[244:247], v249, s[32:35], s16 offen offset:3072 sc1
    ds_read_b64_tr_b16 v[32:33], v23 offset:21504
    ds_read_b64_tr_b16 v[34:35], v23 offset:23552
    s_waitcnt vmcnt(12)
    s_waitcnt lgkmcnt(10)
    v_mfma_f32_32x32x16_bf16 v[56:71], v[40:43], v[196:199], v[56:71]
    s_add_u32 s16, s16, 16384
    ds_read_b64_tr_b16 v[36:37], v20 offset:24576
    ds_read_b64_tr_b16 v[38:39], v20 offset:26624
    s_waitcnt lgkmcnt(10)
    v_mfma_f32_32x32x16_bf16 v[72:87], v[44:47], v[196:199], v[72:87]
    s_and_b32 s16, s16, 0x3ffff
    ds_read_b64_tr_b16 v[40:41], v21 offset:24576
    ds_read_b64_tr_b16 v[42:43], v21 offset:26624
    s_waitcnt lgkmcnt(10)
    v_mfma_f32_32x32x16_bf16 v[120:135], v[48:51], v[196:199], v[120:135]
    buffer_load_dwordx4 v[152:155], v249, s[32:35], s16 offen sc1
    ds_read_b64_tr_b16 v[44:45], v24 offset:24576
    ds_read_b64_tr_b16 v[46:47], v24 offset:26624
    s_waitcnt lgkmcnt(10)
    v_mfma_f32_32x32x16_bf16 v[136:151], v[52:55], v[196:199], v[136:151]
    ds_read_b64_tr_b16 v[48:49], v25 offset:24576
    ds_read_b64_tr_b16 v[50:51], v25 offset:26624
    s_waitcnt lgkmcnt(10)
    v_mfma_f32_32x32x16_bf16 v[88:103], v[28:31], v[196:199], v[88:103]
    ds_read_b64_tr_b16 v[52:53], v22 offset:24576
    ds_read_b64_tr_b16 v[54:55], v22 offset:26624
    s_waitcnt lgkmcnt(10)
    v_mfma_f32_32x32x16_bf16 v[104:119], v[32:35], v[196:199], v[104:119]
    buffer_load_dwordx4 v[156:159], v249, s[32:35], s16 offen offset:1024 sc1
    ds_read_b64_tr_b16 v[28:29], v23 offset:24576
    ds_read_b64_tr_b16 v[30:31], v23 offset:26624
    s_barrier
    s_waitcnt vmcnt(13)
    s_waitcnt lgkmcnt(10)
    v_mfma_f32_32x32x16_bf16 v[56:71], v[36:39], v[200:203], v[56:71]
    ds_read_b64_tr_b16 v[32:33], v20 offset:25600
    ds_read_b64_tr_b16 v[34:35], v20 offset:27648
    s_waitcnt lgkmcnt(10)
    v_mfma_f32_32x32x16_bf16 v[72:87], v[40:43], v[200:203], v[72:87]
    ds_read_b64_tr_b16 v[36:37], v21 offset:25600
    ds_read_b64_tr_b16 v[38:39], v21 offset:27648
    s_waitcnt lgkmcnt(10)
    v_mfma_f32_32x32x16_bf16 v[120:135], v[44:47], v[200:203], v[120:135]
    ds_read_b64_tr_b16 v[40:41], v24 offset:25600
    ds_read_b64_tr_b16 v[42:43], v24 offset:27648
    s_waitcnt lgkmcnt(10)
    v_mfma_f32_32x32x16_bf16 v[136:151], v[48:51], v[200:203], v[136:151]
    ds_read_b64_tr_b16 v[44:45], v25 offset:25600
    ds_read_b64_tr_b16 v[46:47], v25 offset:27648
    s_waitcnt lgkmcnt(10)
    v_mfma_f32_32x32x16_bf16 v[88:103], v[52:55], v[200:203], v[88:103]
    ds_read_b64_tr_b16 v[48:49], v22 offset:25600
    ds_read_b64_tr_b16 v[50:51], v22 offset:27648
    s_waitcnt lgkmcnt(10)
    v_mfma_f32_32x32x16_bf16 v[104:119], v[28:31], v[200:203], v[104:119]
    ds_read_b64_tr_b16 v[52:53], v23 offset:25600
    ds_read_b64_tr_b16 v[54:55], v23 offset:27648
    s_waitcnt vmcnt(12)
    s_waitcnt lgkmcnt(10)
    v_mfma_f32_32x32x16_bf16 v[56:71], v[32:35], v[204:207], v[56:71]
    ds_read_b64_tr_b16 v[28:29], v20 offset:28672
    ds_read_b64_tr_b16 v[30:31], v20 offset:30720
    s_waitcnt lgkmcnt(10)
    v_mfma_f32_32x32x16_bf16 v[72:87], v[36:39], v[204:207], v[72:87]
    ds_read_b64_tr_b16 v[32:33], v21 offset:28672
    ds_read_b64_tr_b16 v[34:35], v21 offset:30720
L_PAD2:
    s_cbranch_execz L_RET2
    s_waitcnt lgkmcnt(10)
    v_mfma_f32_32x32x16_bf16 v[120:135], v[40:43], v[204:207], v[120:135]
    buffer_load_dwordx4 v[160:163], v249, s[32:35], s16 offen offset:2048 sc1
    ds_read_b64_tr_b16 v[36:37], v24 offset:28672
    ds_read_b64_tr_b16 v[38:39], v24 offset:30720
    s_waitcnt lgkmcnt(10)
    v_mfma_f32_32x32x16_bf16 v[136:151], v[44:47], v[204:207], v[136:151]
    ds_read_b64_tr_b16 v[40:41], v25 offset:28672
    ds_read_b64_tr_b16 v[42:43], v25 offset:30720
    s_waitcnt lgkmcnt(10)
    v_mfma_f32_32x32x16_bf16 v[88:103], v[48:51], v[204:207], v[88:103]
    ds_read_b64_tr_b16 v[44:45], v22 offset:28672
    ds_read_b64_tr_b16 v[46:47], v22 offset:30720
    s_waitcnt lgkmcnt(10)
    v_mfma_f32_32x32x16_bf16 v[104:119], v[52:55], v[204:207], v[104:119]
    buffer_load_dwordx4 v[164:167], v249, s[32:35], s16 offen offset:3072 sc1
    ds_read_b64_tr_b16 v[48:49], v23 offset:28672
    ds_read_b64_tr_b16 v[50:51], v23 offset:30720
    s_waitcnt vmcnt(13)
    s_waitcnt lgkmcnt(10)
    v_mfma_f32_32x32x16_bf16 v[56:71], v[28:31], v[208:211], v[56:71]
    s_add_u32 s16, s16, 16384
    ds_read_b64_tr_b16 v[52:53], v20 offset:29696
    ds_read_b64_tr_b16 v[54:55], v20 offset:31744
    s_waitcnt lgkmcnt(10)
    v_mfma_f32_32x32x16_bf16 v[72:87], v[32:35], v[208:211], v[72:87]
    s_and_b32 s16, s16, 0x3ffff
    ds_read_b64_tr_b16 v[28:29], v21 offset:29696
    ds_read_b64_tr_b16 v[30:31], v21 offset:31744
    s_waitcnt lgkmcnt(10)
    v_mfma_f32_32x32x16_bf16 v[120:135], v[36:39], v[208:211], v[120:135]
    buffer_load_dwordx4 v[168:171], v249, s[32:35], s16 offen sc1
    ds_read_b64_tr_b16 v[32:33], v24 offset:29696
    ds_read_b64_tr_b16 v[34:35], v24 offset:31744
    s_waitcnt lgkmcnt(10)
    v_mfma_f32_32x32x16_bf16 v[136:151], v[40:43], v[208:211], v[136:151]
    ds_read_b64_tr_b16 v[36:37], v25 offset:29696
    ds_read_b64_tr_b16 v[38:39], v25 offset:31744
    s_waitcnt lgkmcnt(10)
    v_mfma_f32_32x32x16_bf16 v[88:103], v[44:47], v[208:211], v[88:103]
    ds_read_b64_tr_b16 v[40:41], v22 offset:29696
    ds_read_b64_tr_b16 v[42:43], v22 offset:31744
    s_waitcnt lgkmcnt(10)
    v_mfma_f32_32x32x16_bf16 v[104:119], v[48:51], v[208:211], v[104:119]
    buffer_load_dwordx4 v[172:175], v249, s[32:35], s16 offen offset:1024 sc1
    ds_read_b64_tr_b16 v[44:45], v23 offset:29696
    ds_read_b64_tr_b16 v[46:47], v23 offset:31744
    s_waitcnt vmcnt(14)
    s_waitcnt lgkmcnt(10)
    v_mfma_f32_32x32x16_bf16 v[56:71], v[52:55], v[212:215], v[56:71]
    ds_read_b64_tr_b16 v[48:49], v20 offset:32768
    ds_read_b64_tr_b16 v[50:51], v20 offset:34816
    s_waitcnt lgkmcnt(10)
    v_mfma_f32_32x32x16_bf16 v[72:87], v[28:31], v[212:215], v[72:87]
    ds_read_b64_tr_b16 v[52:53], v21 offset:32768
    ds_read_b64_tr_b16 v[54:55], v21 offset:34816
    s_waitcnt lgkmcnt(10)
    v_mfma_f32_32x32x16_bf16 v[120:135], v[32:35], v[212:215], v[120:135]
    buffer_load_dwordx4 v[176:179], v249, s[32:35], s16 offen offset:2048 sc1
    ds_read_b64_tr_b16 v[28:29], v24 offset:32768
    ds_read_b64_tr_b16 v[30:31], v24 offset:34816
    s_waitcnt lgkmcnt(10)
    v_mfma_f32_32x32x16_bf16 v[136:151], v[36:39], v[212:215], v[136:151]
    ds_read_b64_tr_b16 v[32:33], v25 offset:32768
    ds_read_b64_tr_b16 v[34:35], v25 offset:34816
    s_waitcnt lgkmcnt(10)
    v_mfma_f32_32x32x16_bf16 v[88:103], v[40:43], v[212:215], v[88:103]
    ds_read_b64_tr_b16 v[36:37], v22 offset:32768
    ds_read_b64_tr_b16 v[38:39], v22 offset:34816
    s_waitcnt lgkmcnt(10)
    v_mfma_f32_32x32x16_bf16 v[104:119], v[44:47], v[212:215], v[104:119]
    buffer_load_dwordx4 v[180:183], v249, s[32:35], s16 offen offset:3072 sc1
    ds_read_b64_tr_b16 v[40:41], v23 offset:32768
    ds_read_b64_tr_b16 v[42:43], v23 offset:34816
    s_barrier
    s_waitcnt vmcnt(15)
    s_waitcnt lgkmcnt(10)
    v_mfma_f32_32x32x16_bf16 v[56:71], v[48:51], v[216:219], v[56:71]
    s_add_u32 s16, s16, 16384
    ds_read_b64_tr_b16 v[44:45], v20 offset:33792
    ds_read_b64_tr_b16 v[46:47], v20 offset:35840
    s_waitcnt lgkmcnt(10)
    v_mfma_f32_32x32x16_bf16 v[72:87], v[52:55], v[216:219], v[72:87]
    s_and_b32 s16, s16, 0x3ffff
    ds_read_b64_tr_b16 v[48:49], v21 offset:33792
    ds_read_b64_tr_b16 v[50:51], v21 offset:35840
    s_waitcnt lgkmcnt(10)
    v_mfma_f32_32x32x16_bf16 v[120:135], v[28:31], v[216:219], v[120:135]
    ds_read_b64_tr_b16 v[52:53], v24 offset:33792
    ds_read_b64_tr_b16 v[54:55], v24 offset:35840
    s_waitcnt lgkmcnt(10)
    v_mfma_f32_32x32x16_bf16 v[136:151], v[32:35], v[216:219], v[136:151]
    ds_read_b64_tr_b16 v[28:29], v25 offset:33792
    ds_read_b64_tr_b16 v[30:31], v25 offset:35840
    s_waitcnt lgkmcnt(10)
    v_mfma_f32_32x32x16_bf16 v[88:103], v[36:39], v[216:219], v[88:103]
    ds_read_b64_tr_b16 v[32:33], v22 offset:33792
    ds_read_b64_tr_b16 v[34:35], v22 offset:35840
    s_waitcnt lgkmcnt(10)
    v_mfma_f32_32x32x16_bf16 v[104:119], v[40:43], v[216:219], v[104:119]
    ds_read_b64_tr_b16 v[36:37], v23 offset:33792
    ds_read_b64_tr_b16 v[38:39], v23 offset:35840
    s_waitcnt vmcnt(14)
    s_waitcnt lgkmcnt(10)
    v_mfma_f32_32x32x16_bf16 v[56:71], v[44:47], v[220:223], v[56:71]
    ds_read_b64_tr_b16 v[40:41], v20 offset:36864
    ds_read_b64_tr_b16 v[42:43], v20 offset:38912
    s_waitcnt lgkmcnt(10)
    v_mfma_f32_32x32x16_bf16 v[72:87], v[48:51], v[220:223], v[72:87]
    ds_read_b64_tr_b16 v[44:45], v21 offset:36864
    ds_read_b64_tr_b16 v[46:47], v21 offset:38912
    s_waitcnt lgkmcnt(10)
    v_mfma_f32_32x32x16_bf16 v[120:135], v[52:55], v[220:223], v[120:135]
    buffer_load_dwordx4 v[184:187], v249, s[32:35], s16 offen sc1
    ds_read_b64_tr_b16 v[48:49], v24 offset:36864
    ds_read_b64_tr_b16 v[50:51], v24 offset:38912
    s_waitcnt lgkmcnt(10)
    v_mfma_f32_32x32x16_bf16 v[136:151], v[28:31], v[220:223], v[136:151]
    ds_read_b64_tr_b16 v[52:53], v25 offset:36864
    ds_read_b64_tr_b16 v[54:55], v25 offset:38912
    s_waitcnt lgkmcnt(10)
    v_mfma_f32_32x32x16_bf16 v[88:103], v[32:35], v[220:223], v[88:103]
    ds_read_b64_tr_b16 v[28:29], v22 offset:36864
    ds_read_b64_tr_b16 v[30:31], v22 offset:38912
    s_waitcnt lgkmcnt(10)
    v_mfma_f32_32x32x16_bf16 v[104:119], v[36:39], v[220:223], v[104:119]
    buffer_load_dwordx4 v[188:191], v249, s[32:35], s16 offen offset:1024 sc1
    ds_read_b64_tr_b16 v[32:33], v23 offset:36864
    ds_read_b64_tr_b16 v[34:35], v23 offset:38912
    s_waitcnt vmcnt(15)
    s_waitcnt lgkmcnt(10)
    v_mfma_f32_32x32x16_bf16 v[56:71], v[40:43], v[224:227], v[56:71]
    ds_read_b64_tr_b16 v[36:37], v20 offset:37888
    ds_read_b64_tr_b16 v[38:39], v20 offset:39936
    s_waitcnt lgkmcnt(10)
    v_mfma_f32_32x32x16_bf16 v[72:87], v[44:47], v[224:227], v[72:87]
    ds_read_b64_tr_b16 v[40:41], v21 offset:37888
    ds_read_b64_tr_b16 v[42:43], v21 offset:39936
    s_waitcnt lgkmcnt(10)
    v_mfma_f32_32x32x16_bf16 v[120:135], v[48:51], v[224:227], v[120:135]
    buffer_load_dwordx4 v[192:195], v249, s[32:35], s16 offen offset:2048 sc1
    ds_read_b64_tr_b16 v[44:45], v24 offset:37888
    ds_read_b64_tr_b16 v[46:47], v24 offset:39936
    s_waitcnt lgkmcnt(10)
    v_mfma_f32_32x32x16_bf16 v[136:151], v[52:55], v[224:227], v[136:151]
    ds_read_b64_tr_b16 v[48:49], v25 offset:37888
    ds_read_b64_tr_b16 v[50:51], v25 offset:39936
    s_waitcnt lgkmcnt(10)
    v_mfma_f32_32x32x16_bf16 v[88:103], v[28:31], v[224:227], v[88:103]
    ds_read_b64_tr_b16 v[52:53], v22 offset:37888
    ds_read_b64_tr_b16 v[54:55], v22 offset:39936
    s_waitcnt lgkmcnt(10)
    v_mfma_f32_32x32x16_bf16 v[104:119], v[32:35], v[224:227], v[104:119]
    buffer_load_dwordx4 v[196:199], v249, s[32:35], s16 offen offset:3072 sc1
    ds_read_b64_tr_b16 v[28:29], v23 offset:37888
    ds_read_b64_tr_b16 v[30:31], v23 offset:39936
    s_waitcnt vmcnt(16)
    s_waitcnt lgkmcnt(10)
    v_mfma_f32_32x32x16_bf16 v[56:71], v[36:39], v[228:231], v[56:71]
    s_add_u32 s16, s16, 16384
    ds_read_b64_tr_b16 v[32:33], v20 offset:40960
    ds_read_b64_tr_b16 v[34:35], v20 offset:43008
    s_waitcnt lgkmcnt(10)
    v_mfma_f32_32x32x16_bf16 v[72:87], v[40:43], v[228:231], v[72:87]
    s_and_b32 s16, s16, 0x3ffff
    ds_read_b64_tr_b16 v[36:37], v21 offset:40960
    ds_read_b64_tr_b16 v[38:39], v21 offset:43008
    s_waitcnt lgkmcnt(10)
    v_mfma_f32_32x32x16_bf16 v[120:135], v[44:47], v[228:231], v[120:135]
    buffer_load_dwordx4 v[200:203], v249, s[32:35], s16 offen sc1
    ds_read_b64_tr_b16 v[40:41], v24 offset:40960
    ds_read_b64_tr_b16 v[42:43], v24 offset:43008
    s_waitcnt lgkmcnt(10)
    v_mfma_f32_32x32x16_bf16 v[136:151], v[48:51], v[228:231], v[136:151]
    ds_read_b64_tr_b16 v[44:45], v25 offset:40960
    ds_read_b64_tr_b16 v[46:47], v25 offset:43008
    s_waitcnt lgkmcnt(10)
    v_mfma_f32_32x32x16_bf16 v[88:103], v[52:55], v[228:231], v[88:103]
    ds_read_b64_tr_b16 v[48:49], v22 offset:40960
    ds_read_b64_tr_b16 v[50:51], v22 offset:43008
    s_waitcnt lgkmcnt(10)
    v_mfma_f32_32x32x16_bf16 v[104:119], v[28:31], v[228:231], v[104:119]
    buffer_load_dwordx4 v[204:207], v249, s[32:35], s16 offen offset:1024 sc1
    ds_read_b64_tr_b16 v[52:53], v23 offset:40960
    ds_read_b64_tr_b16 v[54:55], v23 offset:43008
    s_barrier
    s_waitcnt vmcnt(17)
    s_waitcnt lgkmcnt(10)
    v_mfma_f32_32x32x16_bf16 v[56:71], v[32:35], v[232:235], v[56:71]
    ds_read_b64_tr_b16 v[28:29], v20 offset:41984
    ds_read_b64_tr_b16 v[30:31], v20 offset:44032
    s_waitcnt lgkmcnt(10)
    v_mfma_f32_32x32x16_bf16 v[72:87], v[36:39], v[232:235], v[72:87]
    ds_read_b64_tr_b16 v[32:33], v21 offset:41984
    ds_read_b64_tr_b16 v[34:35], v21 offset:44032
    s_waitcnt lgkmcnt(10)
    v_mfma_f32_32x32x16_bf16 v[120:135], v[40:43], v[232:235], v[120:135]
    ds_read_b64_tr_b16 v[36:37], v24 offset:41984
    ds_read_b64_tr_b16 v[38:39], v24 offset:44032
    s_waitcnt lgkmcnt(10)
    v_mfma_f32_32x32x16_bf16 v[136:151], v[44:47], v[232:235], v[136:151]
    ds_read_b64_tr_b16 v[40:41], v25 offset:41984
    ds_read_b64_tr_b16 v[42:43], v25 offset:44032
    s_waitcnt lgkmcnt(10)
    v_mfma_f32_32x32x16_bf16 v[88:103], v[48:51], v[232:235], v[88:103]
    ds_read_b64_tr_b16 v[44:45], v22 offset:41984
    ds_read_b64_tr_b16 v[46:47], v22 offset:44032
    s_waitcnt lgkmcnt(10)
    v_mfma_f32_32x32x16_bf16 v[104:119], v[52:55], v[232:235], v[104:119]
    ds_read_b64_tr_b16 v[48:49], v23 offset:41984
    ds_read_b64_tr_b16 v[50:51], v23 offset:44032
    s_waitcnt vmcnt(16)
    s_waitcnt lgkmcnt(10)
    v_mfma_f32_32x32x16_bf16 v[56:71], v[28:31], v[236:239], v[56:71]
    ds_read_b64_tr_b16 v[52:53], v20 offset:45056
    ds_read_b64_tr_b16 v[54:55], v20 offset:47104
    s_waitcnt lgkmcnt(10)
    v_mfma_f32_32x32x16_bf16 v[72:87], v[32:35], v[236:239], v[72:87]
    ds_read_b64_tr_b16 v[28:29], v21 offset:45056
    ds_read_b64_tr_b16 v[30:31], v21 offset:47104
    s_waitcnt lgkmcnt(10)
    v_mfma_f32_32x32x16_bf16 v[120:135], v[36:39], v[236:239], v[120:135]
    buffer_load_dwordx4 v[208:211], v249, s[32:35], s16 offen offset:2048 sc1
    ds_read_b64_tr_b16 v[32:33], v24 offset:45056
    ds_read_b64_tr_b16 v[34:35], v24 offset:47104
    s_waitcnt lgkmcnt(10)
    v_mfma_f32_32x32x16_bf16 v[136:151], v[40:43], v[236:239], v[136:151]
    ds_read_b64_tr_b16 v[36:37], v25 offset:45056
    ds_read_b64_tr_b16 v[38:39], v25 offset:47104
    s_waitcnt lgkmcnt(10)
    v_mfma_f32_32x32x16_bf16 v[88:103], v[44:47], v[236:239], v[88:103]
    ds_read_b64_tr_b16 v[40:41], v22 offset:45056
    ds_read_b64_tr_b16 v[42:43], v22 offset:47104
    s_waitcnt lgkmcnt(10)
    v_mfma_f32_32x32x16_bf16 v[104:119], v[48:51], v[236:239], v[104:119]
    buffer_load_dwordx4 v[212:215], v249, s[32:35], s16 offen offset:3072 sc1
    ds_read_b64_tr_b16 v[44:45], v23 offset:45056
    ds_read_b64_tr_b16 v[46:47], v23 offset:47104
    s_waitcnt vmcnt(17)
    s_waitcnt lgkmcnt(10)
    v_mfma_f32_32x32x16_bf16 v[56:71], v[52:55], v[240:243], v[56:71]
    s_add_u32 s16, s16, 16384
    ds_read_b64_tr_b16 v[48:49], v20 offset:46080
    ds_read_b64_tr_b16 v[50:51], v20 offset:48128
    s_waitcnt lgkmcnt(10)
    v_mfma_f32_32x32x16_bf16 v[72:87], v[28:31], v[240:243], v[72:87]
    s_and_b32 s16, s16, 0x3ffff
    ds_read_b64_tr_b16 v[52:53], v21 offset:46080
    ds_read_b64_tr_b16 v[54:55], v21 offset:48128
    s_waitcnt lgkmcnt(10)
    v_mfma_f32_32x32x16_bf16 v[120:135], v[32:35], v[240:243], v[120:135]
    buffer_load_dwordx4 v[216:219], v249, s[32:35], s16 offen sc1
    ds_read_b64_tr_b16 v[28:29], v24 offset:46080
    ds_read_b64_tr_b16 v[30:31], v24 offset:48128
    s_waitcnt lgkmcnt(10)
    v_mfma_f32_32x32x16_bf16 v[136:151], v[36:39], v[240:243], v[136:151]
    ds_read_b64_tr_b16 v[32:33], v25 offset:46080
    ds_read_b64_tr_b16 v[34:35], v25 offset:48128
    s_waitcnt lgkmcnt(10)
    v_mfma_f32_32x32x16_bf16 v[88:103], v[40:43], v[240:243], v[88:103]
    ds_read_b64_tr_b16 v[36:37], v22 offset:46080
    ds_read_b64_tr_b16 v[38:39], v22 offset:48128
    s_waitcnt lgkmcnt(10)
    v_mfma_f32_32x32x16_bf16 v[104:119], v[44:47], v[240:243], v[104:119]
    buffer_load_dwordx4 v[220:223], v249, s[32:35], s16 offen offset:1024 sc1
    ds_read_b64_tr_b16 v[40:41], v23 offset:46080
    ds_read_b64_tr_b16 v[42:43], v23 offset:48128
    s_waitcnt vmcnt(18)
    s_waitcnt lgkmcnt(10)
    v_mfma_f32_32x32x16_bf16 v[56:71], v[48:51], v[244:247], v[56:71]
    ds_read_b64_tr_b16 v[44:45], v20
    ds_read_b64_tr_b16 v[46:47], v20 offset:2048
    s_waitcnt lgkmcnt(10)
    v_mfma_f32_32x32x16_bf16 v[72:87], v[52:55], v[244:247], v[72:87]
    ds_read_b64_tr_b16 v[48:49], v21
    ds_read_b64_tr_b16 v[50:51], v21 offset:2048
    s_waitcnt lgkmcnt(10)
    v_mfma_f32_32x32x16_bf16 v[120:135], v[28:31], v[244:247], v[120:135]
    buffer_load_dwordx4 v[224:227], v249, s[32:35], s16 offen offset:2048 sc1
    ds_read_b64_tr_b16 v[52:53], v24
    ds_read_b64_tr_b16 v[54:55], v24 offset:2048
    s_waitcnt lgkmcnt(10)
    v_mfma_f32_32x32x16_bf16 v[136:151], v[32:35], v[244:247], v[136:151]
    ds_read_b64_tr_b16 v[28:29], v25
    ds_read_b64_tr_b16 v[30:31], v25 offset:2048
    s_waitcnt lgkmcnt(10)
    v_mfma_f32_32x32x16_bf16 v[88:103], v[36:39], v[244:247], v[88:103]
    ds_read_b64_tr_b16 v[32:33], v22
    ds_read_b64_tr_b16 v[34:35], v22 offset:2048
    s_waitcnt lgkmcnt(10)
    v_mfma_f32_32x32x16_bf16 v[104:119], v[40:43], v[244:247], v[104:119]
    buffer_load_dwordx4 v[228:231], v249, s[32:35], s16 offen offset:3072 sc1
    ds_read_b64_tr_b16 v[36:37], v23
    ds_read_b64_tr_b16 v[38:39], v23 offset:2048
    s_barrier
    s_waitcnt vmcnt(19)
    s_waitcnt lgkmcnt(10)
    v_mfma_f32_32x32x16_bf16 v[56:71], v[44:47], v[152:155], v[56:71]
    s_add_u32 s16, s16, 16384
    ds_read_b64_tr_b16 v[40:41], v20 offset:1024
    ds_read_b64_tr_b16 v[42:43], v20 offset:3072
    s_waitcnt lgkmcnt(10)
    v_mfma_f32_32x32x16_bf16 v[72:87], v[48:51], v[152:155], v[72:87]
    s_and_b32 s16, s16, 0x3ffff
    ds_read_b64_tr_b16 v[44:45], v21 offset:1024
    ds_read_b64_tr_b16 v[46:47], v21 offset:3072
    s_waitcnt lgkmcnt(10)
    v_mfma_f32_32x32x16_bf16 v[120:135], v[52:55], v[152:155], v[120:135]
    ds_read_b64_tr_b16 v[48:49], v24 offset:1024
    ds_read_b64_tr_b16 v[50:51], v24 offset:3072
    s_waitcnt lgkmcnt(10)
    v_mfma_f32_32x32x16_bf16 v[136:151], v[28:31], v[152:155], v[136:151]
    ds_read_b64_tr_b16 v[52:53], v25 offset:1024
    ds_read_b64_tr_b16 v[54:55], v25 offset:3072
    s_waitcnt lgkmcnt(10)
    v_mfma_f32_32x32x16_bf16 v[88:103], v[32:35], v[152:155], v[88:103]
    ds_read_b64_tr_b16 v[28:29], v22 offset:1024
    ds_read_b64_tr_b16 v[30:31], v22 offset:3072
    s_waitcnt lgkmcnt(10)
    v_mfma_f32_32x32x16_bf16 v[104:119], v[36:39], v[152:155], v[104:119]
    ds_read_b64_tr_b16 v[32:33], v23 offset:1024
    ds_read_b64_tr_b16 v[34:35], v23 offset:3072
    s_waitcnt vmcnt(18)
    s_waitcnt lgkmcnt(10)
    v_mfma_f32_32x32x16_bf16 v[56:71], v[40:43], v[156:159], v[56:71]
    ds_read_b64_tr_b16 v[36:37], v20 offset:4096
    ds_read_b64_tr_b16 v[38:39], v20 offset:6144
    s_waitcnt lgkmcnt(10)
    v_mfma_f32_32x32x16_bf16 v[72:87], v[44:47], v[156:159], v[72:87]
    ds_read_b64_tr_b16 v[40:41], v21 offset:4096
    ds_read_b64_tr_b16 v[42:43], v21 offset:6144
    s_waitcnt lgkmcnt(10)
    v_mfma_f32_32x32x16_bf16 v[120:135], v[48:51], v[156:159], v[120:135]
    ds_read_b64_tr_b16 v[44:45], v24 offset:4096
    ds_read_b64_tr_b16 v[46:47], v24 offset:6144
    s_waitcnt lgkmcnt(10)
    v_mfma_f32_32x32x16_bf16 v[136:151], v[52:55], v[156:159], v[136:151]
    buffer_load_dwordx4 v[232:235], v249, s[32:35], s16 offen sc1
    ds_read_b64_tr_b16 v[48:49], v25 offset:4096
    ds_read_b64_tr_b16 v[50:51], v25 offset:6144
    s_waitcnt lgkmcnt(10)
    v_mfma_f32_32x32x16_bf16 v[88:103], v[28:31], v[156:159], v[88:103]
    ds_read_b64_tr_b16 v[52:53], v22 offset:4096
    ds_read_b64_tr_b16 v[54:55], v22 offset:6144
    s_waitcnt lgkmcnt(10)
    v_mfma_f32_32x32x16_bf16 v[104:119], v[32:35], v[156:159], v[104:119]
    ds_read_b64_tr_b16 v[28:29], v23 offset:4096
    ds_read_b64_tr_b16 v[30:31], v23 offset:6144
    s_waitcnt vmcnt(18)
    s_waitcnt lgkmcnt(10)
    v_mfma_f32_32x32x16_bf16 v[56:71], v[36:39], v[160:163], v[56:71]
    ds_read_b64_tr_b16 v[32:33], v20 offset:5120
    ds_read_b64_tr_b16 v[34:35], v20 offset:7168
    s_waitcnt lgkmcnt(10)
    v_mfma_f32_32x32x16_bf16 v[72:87], v[40:43], v[160:163], v[72:87]
    buffer_load_dwordx4 v[236:239], v249, s[32:35], s16 offen offset:1024 sc1
    ds_read_b64_tr_b16 v[36:37], v21 offset:5120
    ds_read_b64_tr_b16 v[38:39], v21 offset:7168
    s_waitcnt lgkmcnt(10)
    v_mfma_f32_32x32x16_bf16 v[120:135], v[44:47], v[160:163], v[120:135]
    ds_read_b64_tr_b16 v[40:41], v24 offset:5120
    ds_read_b64_tr_b16 v[42:43], v24 offset:7168
    s_waitcnt lgkmcnt(10)
    v_mfma_f32_32x32x16_bf16 v[136:151], v[48:51], v[160:163], v[136:151]
    ds_read_b64_tr_b16 v[44:45], v25 offset:5120
    ds_read_b64_tr_b16 v[46:47], v25 offset:7168
    s_waitcnt lgkmcnt(10)
    v_mfma_f32_32x32x16_bf16 v[88:103], v[52:55], v[160:163], v[88:103]
    buffer_load_dwordx4 v[240:243], v249, s[32:35], s16 offen offset:2048 sc1
    ds_read_b64_tr_b16 v[48:49], v22 offset:5120
    ds_read_b64_tr_b16 v[50:51], v22 offset:7168
    s_waitcnt lgkmcnt(10)
    v_mfma_f32_32x32x16_bf16 v[104:119], v[28:31], v[160:163], v[104:119]
    ds_read_b64_tr_b16 v[52:53], v23 offset:5120
    ds_read_b64_tr_b16 v[54:55], v23 offset:7168
    s_waitcnt vmcnt(19)
    s_waitcnt lgkmcnt(10)
    v_mfma_f32_32x32x16_bf16 v[56:71], v[32:35], v[164:167], v[56:71]
    ds_read_b64_tr_b16 v[28:29], v20 offset:8192
    ds_read_b64_tr_b16 v[30:31], v20 offset:10240
    s_waitcnt lgkmcnt(10)
    v_mfma_f32_32x32x16_bf16 v[72:87], v[36:39], v[164:167], v[72:87]
    ds_read_b64_tr_b16 v[32:33], v21 offset:8192
    ds_read_b64_tr_b16 v[34:35], v21 offset:10240
    s_waitcnt lgkmcnt(10)
    v_mfma_f32_32x32x16_bf16 v[120:135], v[40:43], v[164:167], v[120:135]
    buffer_load_dwordx4 v[244:247], v249, s[32:35], s16 offen offset:3072 sc1
    ds_read_b64_tr_b16 v[36:37], v24 offset:8192
    ds_read_b64_tr_b16 v[38:39], v24 offset:10240
    s_waitcnt lgkmcnt(10)
    v_mfma_f32_32x32x16_bf16 v[136:151], v[44:47], v[164:167], v[136:151]
    s_add_u32 s16, s16, 16384
    ds_read_b64_tr_b16 v[40:41], v25 offset:8192
    ds_read_b64_tr_b16 v[42:43], v25 offset:10240
    s_waitcnt lgkmcnt(10)
    v_mfma_f32_32x32x16_bf16 v[88:103], v[48:51], v[164:167], v[88:103]
    s_and_b32 s16, s16, 0x3ffff
    ds_read_b64_tr_b16 v[44:45], v22 offset:8192
    ds_read_b64_tr_b16 v[46:47], v22 offset:10240
    s_waitcnt lgkmcnt(10)
    v_mfma_f32_32x32x16_bf16 v[104:119], v[52:55], v[164:167], v[104:119]
    buffer_load_dwordx4 v[152:155], v249, s[32:35], s16 offen sc1
    ds_read_b64_tr_b16 v[48:49], v23 offset:8192
    ds_read_b64_tr_b16 v[50:51], v23 offset:10240
    s_barrier
    s_waitcnt vmcnt(20)
    s_waitcnt lgkmcnt(10)
    v_mfma_f32_32x32x16_bf16 v[56:71], v[28:31], v[168:171], v[56:71]
    ds_read_b64_tr_b16 v[52:53], v20 offset:9216
    ds_read_b64_tr_b16 v[54:55], v20 offset:11264
    s_waitcnt lgkmcnt(10)
    v_mfma_f32_32x32x16_bf16 v[72:87], v[32:35], v[168:171], v[72:87]
    ds_read_b64_tr_b16 v[28:29], v21 offset:9216
    ds_read_b64_tr_b16 v[30:31], v21 offset:11264
    s_waitcnt lgkmcnt(10)
    v_mfma_f32_32x32x16_bf16 v[120:135], v[36:39], v[168:171], v[120:135]
    ds_read_b64_tr_b16 v[32:33], v24 offset:9216
    ds_read_b64_tr_b16 v[34:35], v24 offset:11264
    s_waitcnt lgkmcnt(10)
    v_mfma_f32_32x32x16_bf16 v[136:151], v[40:43], v[168:171], v[136:151]
    ds_read_b64_tr_b16 v[36:37], v25 offset:9216
    ds_read_b64_tr_b16 v[38:39], v25 offset:11264
    s_waitcnt lgkmcnt(10)
    v_mfma_f32_32x32x16_bf16 v[88:103], v[44:47], v[168:171], v[88:103]
    ds_read_b64_tr_b16 v[40:41], v22 offset:9216
    ds_read_b64_tr_b16 v[42:43], v22 offset:11264
    s_waitcnt lgkmcnt(10)
    v_mfma_f32_32x32x16_bf16 v[104:119], v[48:51], v[168:171], v[104:119]
    ds_read_b64_tr_b16 v[44:45], v23 offset:9216
    ds_read_b64_tr_b16 v[46:47], v23 offset:11264
    s_waitcnt vmcnt(19)
    s_waitcnt lgkmcnt(10)
    v_mfma_f32_32x32x16_bf16 v[56:71], v[52:55], v[172:175], v[56:71]
    ds_read_b64_tr_b16 v[48:49], v20 offset:12288
    ds_read_b64_tr_b16 v[50:51], v20 offset:14336
    s_waitcnt lgkmcnt(10)
    v_mfma_f32_32x32x16_bf16 v[72:87], v[28:31], v[172:175], v[72:87]
    ds_read_b64_tr_b16 v[52:53], v21 offset:12288
    ds_read_b64_tr_b16 v[54:55], v21 offset:14336
    s_waitcnt lgkmcnt(10)
    v_mfma_f32_32x32x16_bf16 v[120:135], v[32:35], v[172:175], v[120:135]
    ds_read_b64_tr_b16 v[28:29], v24 offset:12288
    ds_read_b64_tr_b16 v[30:31], v24 offset:14336
    s_waitcnt lgkmcnt(10)
    v_mfma_f32_32x32x16_bf16 v[136:151], v[36:39], v[172:175], v[136:151]
    buffer_load_dwordx4 v[156:159], v249, s[32:35], s16 offen offset:1024 sc1
    ds_read_b64_tr_b16 v[32:33], v25 offset:12288
    ds_read_b64_tr_b16 v[34:35], v25 offset:14336
    s_waitcnt lgkmcnt(10)
    v_mfma_f32_32x32x16_bf16 v[88:103], v[40:43], v[172:175], v[88:103]
    ds_read_b64_tr_b16 v[36:37], v22 offset:12288
    ds_read_b64_tr_b16 v[38:39], v22 offset:14336
    s_waitcnt lgkmcnt(10)
    v_mfma_f32_32x32x16_bf16 v[104:119], v[44:47], v[172:175], v[104:119]
    ds_read_b64_tr_b16 v[40:41], v23 offset:12288
    ds_read_b64_tr_b16 v[42:43], v23 offset:14336
    s_waitcnt vmcnt(19)
    s_waitcnt lgkmcnt(10)
    v_mfma_f32_32x32x16_bf16 v[56:71], v[48:51], v[176:179], v[56:71]
    ds_read_b64_tr_b16 v[44:45], v20 offset:13312
    ds_read_b64_tr_b16 v[46:47], v20 offset:15360
    s_waitcnt lgkmcnt(10)
    v_mfma_f32_32x32x16_bf16 v[72:87], v[52:55], v[176:179], v[72:87]
    buffer_load_dwordx4 v[160:163], v249, s[32:35], s16 offen offset:2048 sc1
    ds_read_b64_tr_b16 v[48:49], v21 offset:13312
    ds_read_b64_tr_b16 v[50:51], v21 offset:15360
    s_waitcnt lgkmcnt(10)
    v_mfma_f32_32x32x16_bf16 v[120:135], v[28:31], v[176:179], v[120:135]
    ds_read_b64_tr_b16 v[52:53], v24 offset:13312
    ds_read_b64_tr_b16 v[54:55], v24 offset:15360
    s_waitcnt lgkmcnt(10)
    v_mfma_f32_32x32x16_bf16 v[136:151], v[32:35], v[176:179], v[136:151]
    ds_read_b64_tr_b16 v[28:29], v25 offset:13312
    ds_read_b64_tr_b16 v[30:31], v25 offset:15360
    s_waitcnt lgkmcnt(10)
    v_mfma_f32_32x32x16_bf16 v[88:103], v[36:39], v[176:179], v[88:103]
    buffer_load_dwordx4 v[164:167], v249, s[32:35], s16 offen offset:3072 sc1
    ds_read_b64_tr_b16 v[32:33], v22 offset:13312
    ds_read_b64_tr_b16 v[34:35], v22 offset:15360
    s_waitcnt lgkmcnt(10)
    v_mfma_f32_32x32x16_bf16 v[104:119], v[40:43], v[176:179], v[104:119]
    s_add_u32 s16, s16, 16384
    ds_read_b64_tr_b16 v[36:37], v23 offset:13312
    ds_read_b64_tr_b16 v[38:39], v23 offset:15360
    s_waitcnt vmcnt(20)
    s_waitcnt lgkmcnt(10)
    v_mfma_f32_32x32x16_bf16 v[56:71], v[44:47], v[180:183], v[56:71]
    s_and_b32 s16, s16, 0x3ffff
    ds_read_b64_tr_b16 v[40:41], v20 offset:16384
    ds_read_b64_tr_b16 v[42:43], v20 offset:18432
    s_waitcnt lgkmcnt(10)
    v_mfma_f32_32x32x16_bf16 v[72:87], v[48:51], v[180:183], v[72:87]
    ds_read_b64_tr_b16 v[44:45], v21 offset:16384
    ds_read_b64_tr_b16 v[46:47], v21 offset:18432
    s_waitcnt lgkmcnt(10)
    v_mfma_f32_32x32x16_bf16 v[120:135], v[52:55], v[180:183], v[120:135]
    buffer_load_dwordx4 v[168:171], v249, s[32:35], s16 offen sc1
    ds_read_b64_tr_b16 v[48:49], v24 offset:16384
    ds_read_b64_tr_b16 v[50:51], v24 offset:18432
    s_waitcnt lgkmcnt(10)
    v_mfma_f32_32x32x16_bf16 v[136:151], v[28:31], v[180:183], v[136:151]
    ds_read_b64_tr_b16 v[52:53], v25 offset:16384
    ds_read_b64_tr_b16 v[54:55], v25 offset:18432
    s_waitcnt lgkmcnt(10)
    v_mfma_f32_32x32x16_bf16 v[88:103], v[32:35], v[180:183], v[88:103]
    ds_read_b64_tr_b16 v[28:29], v22 offset:16384
    ds_read_b64_tr_b16 v[30:31], v22 offset:18432
    s_waitcnt lgkmcnt(10)
    v_mfma_f32_32x32x16_bf16 v[104:119], v[36:39], v[180:183], v[104:119]
    buffer_load_dwordx4 v[172:175], v249, s[32:35], s16 offen offset:1024 sc1
    ds_read_b64_tr_b16 v[32:33], v23 offset:16384
    ds_read_b64_tr_b16 v[34:35], v23 offset:18432
    s_barrier
    s_waitcnt vmcnt(21)
    s_waitcnt lgkmcnt(10)
    v_mfma_f32_32x32x16_bf16 v[56:71], v[40:43], v[184:187], v[56:71]
    ds_read_b64_tr_b16 v[36:37], v20 offset:17408
    ds_read_b64_tr_b16 v[38:39], v20 offset:19456
    s_waitcnt lgkmcnt(10)
    v_mfma_f32_32x32x16_bf16 v[72:87], v[44:47], v[184:187], v[72:87]
    ds_read_b64_tr_b16 v[40:41], v21 offset:17408
    ds_read_b64_tr_b16 v[42:43], v21 offset:19456
    s_waitcnt lgkmcnt(10)
    v_mfma_f32_32x32x16_bf16 v[120:135], v[48:51], v[184:187], v[120:135]
    ds_read_b64_tr_b16 v[44:45], v24 offset:17408
    ds_read_b64_tr_b16 v[46:47], v24 offset:19456
    s_waitcnt lgkmcnt(10)
    v_mfma_f32_32x32x16_bf16 v[136:151], v[52:55], v[184:187], v[136:151]
    ds_read_b64_tr_b16 v[48:49], v25 offset:17408
    ds_read_b64_tr_b16 v[50:51], v25 offset:19456
    s_waitcnt lgkmcnt(10)
    v_mfma_f32_32x32x16_bf16 v[88:103], v[28:31], v[184:187], v[88:103]
    ds_read_b64_tr_b16 v[52:53], v22 offset:17408
    ds_read_b64_tr_b16 v[54:55], v22 offset:19456
    s_waitcnt lgkmcnt(10)
    v_mfma_f32_32x32x16_bf16 v[104:119], v[32:35], v[184:187], v[104:119]
    ds_read_b64_tr_b16 v[28:29], v23 offset:17408
    ds_read_b64_tr_b16 v[30:31], v23 offset:19456
    s_waitcnt vmcnt(20)
    s_waitcnt lgkmcnt(10)
    v_mfma_f32_32x32x16_bf16 v[56:71], v[36:39], v[188:191], v[56:71]
    ds_read_b64_tr_b16 v[32:33], v20 offset:20480
    ds_read_b64_tr_b16 v[34:35], v20 offset:22528
    s_waitcnt lgkmcnt(10)
    v_mfma_f32_32x32x16_bf16 v[72:87], v[40:43], v[188:191], v[72:87]
    ds_read_b64_tr_b16 v[36:37], v21 offset:20480
    ds_read_b64_tr_b16 v[38:39], v21 offset:22528
    s_waitcnt lgkmcnt(10)
    v_mfma_f32_32x32x16_bf16 v[120:135], v[44:47], v[188:191], v[120:135]
    ds_read_b64_tr_b16 v[40:41], v24 offset:20480
    ds_read_b64_tr_b16 v[42:43], v24 offset:22528
    s_waitcnt lgkmcnt(10)
    v_mfma_f32_32x32x16_bf16 v[136:151], v[48:51], v[188:191], v[136:151]
    buffer_load_dwordx4 v[176:179], v249, s[32:35], s16 offen offset:2048 sc1
    ds_read_b64_tr_b16 v[44:45], v25 offset:20480
    ds_read_b64_tr_b16 v[46:47], v25 offset:22528
    s_waitcnt lgkmcnt(10)
    v_mfma_f32_32x32x16_bf16 v[88:103], v[52:55], v[188:191], v[88:103]
    ds_read_b64_tr_b16 v[48:49], v22 offset:20480
    ds_read_b64_tr_b16 v[50:51], v22 offset:22528
    s_waitcnt lgkmcnt(10)
    v_mfma_f32_32x32x16_bf16 v[104:119], v[28:31], v[188:191], v[104:119]
    ds_read_b64_tr_b16 v[52:53], v23 offset:20480
    ds_read_b64_tr_b16 v[54:55], v23 offset:22528
    s_waitcnt vmcnt(20)
    s_waitcnt lgkmcnt(10)
    v_mfma_f32_32x32x16_bf16 v[56:71], v[32:35], v[192:195], v[56:71]
    ds_read_b64_tr_b16 v[28:29], v20 offset:21504
    ds_read_b64_tr_b16 v[30:31], v20 offset:23552
    s_waitcnt lgkmcnt(10)
    v_mfma_f32_32x32x16_bf16 v[72:87], v[36:39], v[192:195], v[72:87]
    buffer_load_dwordx4 v[180:183], v249, s[32:35], s16 offen offset:3072 sc1
    ds_read_b64_tr_b16 v[32:33], v21 offset:21504
    ds_read_b64_tr_b16 v[34:35], v21 offset:23552
    s_waitcnt lgkmcnt(10)
    v_mfma_f32_32x32x16_bf16 v[120:135], v[40:43], v[192:195], v[120:135]
    s_add_u32 s16, s16, 16384
    ds_read_b64_tr_b16 v[36:37], v24 offset:21504
    ds_read_b64_tr_b16 v[38:39], v24 offset:23552
    s_waitcnt lgkmcnt(10)
    v_mfma_f32_32x32x16_bf16 v[136:151], v[44:47], v[192:195], v[136:151]
    s_and_b32 s16, s16, 0x3ffff
    ds_read_b64_tr_b16 v[40:41], v25 offset:21504
    ds_read_b64_tr_b16 v[42:43], v25 offset:23552
    s_waitcnt lgkmcnt(10)
    v_mfma_f32_32x32x16_bf16 v[88:103], v[48:51], v[192:195], v[88:103]
    buffer_load_dwordx4 v[184:187], v249, s[32:35], s16 offen sc1
    ds_read_b64_tr_b16 v[44:45], v22 offset:21504
    ds_read_b64_tr_b16 v[46:47], v22 offset:23552
L_PAD3:
    s_cbranch_execz L_RET3
    s_waitcnt lgkmcnt(10)
    v_mfma_f32_32x32x16_bf16 v[104:119], v[52:55], v[192:195], v[104:119]
    ds_read_b64_tr_b16 v[48:49], v23 offset:21504
    ds_read_b64_tr_b16 v[50:51], v23 offset:23552
    s_waitcnt vmcnt(21)
    s_waitcnt lgkmcnt(10)
    v_mfma_f32_32x32x16_bf16 v[56:71], v[28:31], v[196:199], v[56:71]
    ds_read_b64_tr_b16 v[52:53], v20 offset:24576
    ds_read_b64_tr_b16 v[54:55], v20 offset:26624
    s_waitcnt lgkmcnt(10)
    v_mfma_f32_32x32x16_bf16 v[72:87], v[32:35], v[196:199], v[72:87]
    ds_read_b64_tr_b16 v[28:29], v21 offset:24576
    ds_read_b64_tr_b16 v[30:31], v21 offset:26624
    s_waitcnt lgkmcnt(10)
    v_mfma_f32_32x32x16_bf16 v[120:135], v[36:39], v[196:199], v[120:135]
    buffer_load_dwordx4 v[188:191], v249, s[32:35], s16 offen offset:1024 sc1
    ds_read_b64_tr_b16 v[32:33], v20 offset:25600
    ds_read_b64_tr_b16 v[34:35], v20 offset:27648
    s_waitcnt lgkmcnt(10)
    v_mfma_f32_32x32x16_bf16 v[136:151], v[40:43], v[196:199], v[136:151]
    ds_read_b64_tr_b16 v[36:37], v21 offset:25600
    ds_read_b64_tr_b16 v[38:39], v21 offset:27648
    s_waitcnt lgkmcnt(10)
    v_mfma_f32_32x32x16_bf16 v[88:103], v[44:47], v[196:199], v[88:103]
    ds_read_b64_tr_b16 v[40:41], v20 offset:28672
    ds_read_b64_tr_b16 v[42:43], v20 offset:30720
    s_waitcnt lgkmcnt(10)
    v_mfma_f32_32x32x16_bf16 v[104:119], v[48:51], v[196:199], v[104:119]
    buffer_load_dwordx4 v[192:195], v249, s[32:35], s16 offen offset:2048 sc1
    ds_read_b64_tr_b16 v[44:45], v21 offset:28672
    ds_read_b64_tr_b16 v[46:47], v21 offset:30720
    s_barrier
    s_waitcnt vmcnt(22)
    s_waitcnt lgkmcnt(10)
    v_mfma_f32_32x32x16_bf16 v[56:71], v[52:55], v[200:203], v[56:71]
    ds_read_b64_tr_b16 v[48:49], v20 offset:29696
    ds_read_b64_tr_b16 v[50:51], v20 offset:31744
    s_waitcnt lgkmcnt(10)
    v_mfma_f32_32x32x16_bf16 v[72:87], v[28:31], v[200:203], v[72:87]
    ds_read_b64_tr_b16 v[52:53], v21 offset:29696
    ds_read_b64_tr_b16 v[54:55], v21 offset:31744
    s_waitcnt vmcnt(21)
    s_waitcnt lgkmcnt(10)
    v_mfma_f32_32x32x16_bf16 v[56:71], v[32:35], v[204:207], v[56:71]
    ds_read_b64_tr_b16 v[28:29], v24 offset:24576
    ds_read_b64_tr_b16 v[30:31], v24 offset:26624
    s_waitcnt lgkmcnt(10)
    v_mfma_f32_32x32x16_bf16 v[72:87], v[36:39], v[204:207], v[72:87]
    ds_read_b64_tr_b16 v[32:33], v25 offset:24576
    ds_read_b64_tr_b16 v[34:35], v25 offset:26624
    s_waitcnt vmcnt(20)
    s_waitcnt lgkmcnt(10)
    v_mfma_f32_32x32x16_bf16 v[56:71], v[40:43], v[208:211], v[56:71]
    ds_read_b64_tr_b16 v[36:37], v22 offset:24576
    ds_read_b64_tr_b16 v[38:39], v22 offset:26624
    s_waitcnt lgkmcnt(10)
    v_mfma_f32_32x32x16_bf16 v[72:87], v[44:47], v[208:211], v[72:87]
    ds_read_b64_tr_b16 v[40:41], v23 offset:24576
    ds_read_b64_tr_b16 v[42:43], v23 offset:26624
    s_waitcnt vmcnt(19)
    s_waitcnt lgkmcnt(10)
    v_mfma_f32_32x32x16_bf16 v[56:71], v[48:51], v[212:215], v[56:71]
    ds_read_b64_tr_b16 v[44:45], v24 offset:25600
    ds_read_b64_tr_b16 v[46:47], v24 offset:27648
    s_waitcnt lgkmcnt(10)
    v_mfma_f32_32x32x16_bf16 v[72:87], v[52:55], v[212:215], v[72:87]
    ds_read_b64_tr_b16 v[48:49], v25 offset:25600
    ds_read_b64_tr_b16 v[50:51], v25 offset:27648
    s_barrier
    s_waitcnt lgkmcnt(10)
    v_mfma_f32_32x32x16_bf16 v[120:135], v[28:31], v[200:203], v[120:135]
    ds_read_b64_tr_b16 v[52:53], v22 offset:25600
    ds_read_b64_tr_b16 v[54:55], v22 offset:27648
    s_waitcnt lgkmcnt(10)
    v_mfma_f32_32x32x16_bf16 v[136:151], v[32:35], v[200:203], v[136:151]
    buffer_load_dwordx4 v[196:199], v249, s[32:35], s16 offen offset:3072 sc1
    ds_read_b64_tr_b16 v[28:29], v23 offset:25600
    ds_read_b64_tr_b16 v[30:31], v23 offset:27648
    s_waitcnt lgkmcnt(10)
    v_mfma_f32_32x32x16_bf16 v[88:103], v[36:39], v[200:203], v[88:103]
    s_add_u32 s16, s16, 16384
    ds_read_b64_tr_b16 v[32:33], v24 offset:28672
    ds_read_b64_tr_b16 v[34:35], v24 offset:30720
    s_waitcnt lgkmcnt(10)
    v_mfma_f32_32x32x16_bf16 v[104:119], v[40:43], v[200:203], v[104:119]
    s_and_b32 s16, s16, 0x3ffff
    ds_read_b64_tr_b16 v[36:37], v25 offset:28672
    ds_read_b64_tr_b16 v[38:39], v25 offset:30720
    s_waitcnt lgkmcnt(10)
    v_mfma_f32_32x32x16_bf16 v[120:135], v[44:47], v[204:207], v[120:135]
    ds_read_b64_tr_b16 v[40:41], v22 offset:28672
    ds_read_b64_tr_b16 v[42:43], v22 offset:30720
    s_waitcnt lgkmcnt(10)
    v_mfma_f32_32x32x16_bf16 v[136:151], v[48:51], v[204:207], v[136:151]
    buffer_load_dwordx4 v[200:203], v249, s[32:35], s16 offen sc1
    ds_read_b64_tr_b16 v[44:45], v23 offset:28672
    ds_read_b64_tr_b16 v[46:47], v23 offset:30720
    s_waitcnt lgkmcnt(10)
    v_mfma_f32_32x32x16_bf16 v[88:103], v[52:55], v[204:207], v[88:103]
    ds_read_b64_tr_b16 v[48:49], v24 offset:29696
    ds_read_b64_tr_b16 v[50:51], v24 offset:31744
    s_waitcnt lgkmcnt(10)
    v_mfma_f32_32x32x16_bf16 v[104:119], v[28:31], v[204:207], v[104:119]
    ds_read_b64_tr_b16 v[52:53], v25 offset:29696
    ds_read_b64_tr_b16 v[54:55], v25 offset:31744
    s_waitcnt lgkmcnt(10)
    v_mfma_f32_32x32x16_bf16 v[120:135], v[32:35], v[208:211], v[120:135]
    buffer_load_dwordx4 v[204:207], v249, s[32:35], s16 offen offset:1024 sc1
    ds_read_b64_tr_b16 v[28:29], v22 offset:29696
    ds_read_b64_tr_b16 v[30:31], v22 offset:31744
    s_waitcnt lgkmcnt(10)
    v_mfma_f32_32x32x16_bf16 v[136:151], v[36:39], v[208:211], v[136:151]
    ds_read_b64_tr_b16 v[32:33], v23 offset:29696
    ds_read_b64_tr_b16 v[34:35], v23 offset:31744
    s_waitcnt lgkmcnt(10)
    v_mfma_f32_32x32x16_bf16 v[88:103], v[40:43], v[208:211], v[88:103]
    ds_read_b64_tr_b16 v[36:37], v20 offset:32768
    ds_read_b64_tr_b16 v[38:39], v20 offset:34816
    s_waitcnt lgkmcnt(10)
    v_mfma_f32_32x32x16_bf16 v[104:119], v[44:47], v[208:211], v[104:119]
    ds_read_b64_tr_b16 v[40:41], v20 offset:33792
    ds_read_b64_tr_b16 v[42:43], v20 offset:35840
    s_waitcnt lgkmcnt(10)
    v_mfma_f32_32x32x16_bf16 v[120:135], v[48:51], v[212:215], v[120:135]
    buffer_load_dwordx4 v[208:211], v249, s[32:35], s16 offen offset:2048 sc1
    ds_read_b64_tr_b16 v[44:45], v20 offset:36864
    ds_read_b64_tr_b16 v[46:47], v20 offset:38912
    s_waitcnt lgkmcnt(10)
    v_mfma_f32_32x32x16_bf16 v[136:151], v[52:55], v[212:215], v[136:151]
    ds_read_b64_tr_b16 v[48:49], v20 offset:37888
    ds_read_b64_tr_b16 v[50:51], v20 offset:39936
    s_waitcnt lgkmcnt(10)
    v_mfma_f32_32x32x16_bf16 v[88:103], v[28:31], v[212:215], v[88:103]
    ds_read_b64_tr_b16 v[52:53], v20 offset:40960
    ds_read_b64_tr_b16 v[54:55], v20 offset:43008
    s_waitcnt lgkmcnt(10)
    v_mfma_f32_32x32x16_bf16 v[104:119], v[32:35], v[212:215], v[104:119]
    buffer_load_dwordx4 v[212:215], v249, s[32:35], s16 offen offset:3072 sc1
    ds_read_b64_tr_b16 v[28:29], v20 offset:41984
    ds_read_b64_tr_b16 v[30:31], v20 offset:44032
    s_barrier
    s_waitcnt vmcnt(23)
    s_waitcnt lgkmcnt(10)
    v_mfma_f32_32x32x16_bf16 v[56:71], v[36:39], v[216:219], v[56:71]
    s_add_u32 s16, s16, 16384
    ds_read_b64_tr_b16 v[32:33], v20 offset:45056
    ds_read_b64_tr_b16 v[34:35], v20 offset:47104
    s_waitcnt vmcnt(22)
    s_waitcnt lgkmcnt(10)
    v_mfma_f32_32x32x16_bf16 v[56:71], v[40:43], v[220:223], v[56:71]
    s_and_b32 s16, s16, 0x3ffff
    ds_read_b64_tr_b16 v[36:37], v20 offset:46080
    ds_read_b64_tr_b16 v[38:39], v20 offset:48128
    s_waitcnt vmcnt(21)
    s_waitcnt lgkmcnt(10)
    v_mfma_f32_32x32x16_bf16 v[56:71], v[44:47], v[224:227], v[56:71]
    ds_read_b64_tr_b16 v[40:41], v20
    ds_read_b64_tr_b16 v[42:43], v20 offset:2048
    s_waitcnt vmcnt(20)
    s_waitcnt lgkmcnt(10)
    v_mfma_f32_32x32x16_bf16 v[56:71], v[48:51], v[228:231], v[56:71]
    ds_read_b64_tr_b16 v[44:45], v20 offset:1024
    ds_read_b64_tr_b16 v[46:47], v20 offset:3072
    s_waitcnt vmcnt(19)
    s_waitcnt lgkmcnt(10)
    v_mfma_f32_32x32x16_bf16 v[56:71], v[52:55], v[232:235], v[56:71]
    ds_read_b64_tr_b16 v[48:49], v20 offset:4096
    ds_read_b64_tr_b16 v[50:51], v20 offset:6144
    s_waitcnt vmcnt(18)
    s_waitcnt lgkmcnt(10)
    v_mfma_f32_32x32x16_bf16 v[56:71], v[28:31], v[236:239], v[56:71]
    ds_read_b64_tr_b16 v[52:53], v20 offset:5120
    ds_read_b64_tr_b16 v[54:55], v20 offset:7168
    s_waitcnt vmcnt(17)
    s_waitcnt lgkmcnt(10)
    v_mfma_f32_32x32x16_bf16 v[56:71], v[32:35], v[240:243], v[56:71]
    ds_read_b64_tr_b16 v[28:29], v20 offset:8192
    ds_read_b64_tr_b16 v[30:31], v20 offset:10240
    s_waitcnt vmcnt(16)
    s_waitcnt lgkmcnt(10)
    v_mfma_f32_32x32x16_bf16 v[56:71], v[36:39], v[244:247], v[56:71]
    ds_read_b64_tr_b16 v[32:33], v20 offset:9216
    ds_read_b64_tr_b16 v[34:35], v20 offset:11264
    s_waitcnt vmcnt(15)
    s_waitcnt lgkmcnt(10)
    v_mfma_f32_32x32x16_bf16 v[56:71], v[40:43], v[152:155], v[56:71]
    ds_read_b64_tr_b16 v[36:37], v20 offset:12288
    ds_read_b64_tr_b16 v[38:39], v20 offset:14336
    s_waitcnt vmcnt(14)
    s_waitcnt lgkmcnt(10)
    v_mfma_f32_32x32x16_bf16 v[56:71], v[44:47], v[156:159], v[56:71]
    ds_read_b64_tr_b16 v[40:41], v20 offset:13312
    ds_read_b64_tr_b16 v[42:43], v20 offset:15360
    s_waitcnt vmcnt(13)
    s_waitcnt lgkmcnt(10)
    v_mfma_f32_32x32x16_bf16 v[56:71], v[48:51], v[160:163], v[56:71]
    ds_read_b64_tr_b16 v[44:45], v20 offset:16384
    ds_read_b64_tr_b16 v[46:47], v20 offset:18432
    s_waitcnt vmcnt(12)
    s_waitcnt lgkmcnt(10)
    v_mfma_f32_32x32x16_bf16 v[56:71], v[52:55], v[164:167], v[56:71]
    ds_read_b64_tr_b16 v[48:49], v20 offset:17408
    ds_read_b64_tr_b16 v[50:51], v20 offset:19456
    s_waitcnt vmcnt(11)
    s_waitcnt lgkmcnt(10)
    v_mfma_f32_32x32x16_bf16 v[56:71], v[28:31], v[168:171], v[56:71]
    ds_read_b64_tr_b16 v[52:53], v20 offset:20480
    ds_read_b64_tr_b16 v[54:55], v20 offset:22528
    s_waitcnt vmcnt(10)
    s_waitcnt lgkmcnt(10)
    v_mfma_f32_32x32x16_bf16 v[56:71], v[32:35], v[172:175], v[56:71]
    ds_read_b64_tr_b16 v[28:29], v20 offset:21504
    ds_read_b64_tr_b16 v[30:31], v20 offset:23552
    s_barrier
    s_waitcnt vmcnt(9)
    s_waitcnt lgkmcnt(10)
    v_mfma_f32_32x32x16_bf16 v[56:71], v[36:39], v[176:179], v[56:71]
    ds_read_b64_tr_b16 v[32:33], v20 offset:24576
    ds_read_b64_tr_b16 v[34:35], v20 offset:26624
    s_waitcnt vmcnt(8)
    s_waitcnt lgkmcnt(10)
    v_mfma_f32_32x32x16_bf16 v[56:71], v[40:43], v[180:183], v[56:71]
    ds_read_b64_tr_b16 v[36:37], v20 offset:25600
    ds_read_b64_tr_b16 v[38:39], v20 offset:27648
    s_waitcnt vmcnt(7)
    s_waitcnt lgkmcnt(10)
    v_mfma_f32_32x32x16_bf16 v[56:71], v[44:47], v[184:187], v[56:71]
    ds_read_b64_tr_b16 v[40:41], v20 offset:28672
    ds_read_b64_tr_b16 v[42:43], v20 offset:30720
    s_waitcnt vmcnt(6)
    s_waitcnt lgkmcnt(10)
    v_mfma_f32_32x32x16_bf16 v[56:71], v[48:51], v[188:191], v[56:71]
    ds_read_b64_tr_b16 v[44:45], v20 offset:29696
    ds_read_b64_tr_b16 v[46:47], v20 offset:31744
    s_waitcnt vmcnt(5)
    s_waitcnt lgkmcnt(10)
    v_mfma_f32_32x32x16_bf16 v[56:71], v[52:55], v[192:195], v[56:71]
    ds_read_b64_tr_b16 v[48:49], v21 offset:32768
    ds_read_b64_tr_b16 v[50:51], v21 offset:34816
    s_waitcnt vmcnt(4)
    s_waitcnt lgkmcnt(10)
    v_mfma_f32_32x32x16_bf16 v[56:71], v[28:31], v[196:199], v[56:71]
    ds_read_b64_tr_b16 v[52:53], v21 offset:33792
    ds_read_b64_tr_b16 v[54:55], v21 offset:35840
    s_waitcnt vmcnt(3)
    s_waitcnt lgkmcnt(10)
    v_mfma_f32_32x32x16_bf16 v[56:71], v[32:35], v[200:203], v[56:71]
    ds_read_b64_tr_b16 v[28:29], v21 offset:36864
    ds_read_b64_tr_b16 v[30:31], v21 offset:38912
    s_waitcnt vmcnt(2)
    s_waitcnt lgkmcnt(10)
    v_mfma_f32_32x32x16_bf16 v[56:71], v[36:39], v[204:207], v[56:71]
    ds_read_b64_tr_b16 v[32:33], v21 offset:37888
    ds_read_b64_tr_b16 v[34:35], v21 offset:39936
    s_waitcnt vmcnt(1)
    s_waitcnt lgkmcnt(10)
    v_mfma_f32_32x32x16_bf16 v[56:71], v[40:43], v[208:211], v[56:71]
    ds_read_b64_tr_b16 v[36:37], v21 offset:40960
    ds_read_b64_tr_b16 v[38:39], v21 offset:43008
    s_waitcnt vmcnt(0)
    s_waitcnt lgkmcnt(10)
    v_mfma_f32_32x32x16_bf16 v[56:71], v[44:47], v[212:215], v[56:71]
    ds_read_b64_tr_b16 v[40:41], v21 offset:41984
    ds_read_b64_tr_b16 v[42:43], v21 offset:44032
    s_waitcnt lgkmcnt(10)
    v_mfma_f32_32x32x16_bf16 v[72:87], v[48:51], v[216:219], v[72:87]
    ds_read_b64_tr_b16 v[44:45], v21 offset:45056
    ds_read_b64_tr_b16 v[46:47], v21 offset:47104
    s_waitcnt lgkmcnt(10)
    v_mfma_f32_32x32x16_bf16 v[72:87], v[52:55], v[220:223], v[72:87]
    s_nop 3
    v_cvt_pk_bf16_f32 v56, v56, v57
    v_cvt_pk_bf16_f32 v57, v58, v59
    ds_read_b64_tr_b16 v[48:49], v21 offset:46080
    ds_read_b64_tr_b16 v[50:51], v21 offset:48128
    s_waitcnt lgkmcnt(10)
    v_mfma_f32_32x32x16_bf16 v[72:87], v[28:31], v[224:227], v[72:87]
    v_cvt_pk_bf16_f32 v58, v60, v61
    v_cvt_pk_bf16_f32 v59, v62, v63
    ds_read_b64_tr_b16 v[52:53], v21
    ds_read_b64_tr_b16 v[54:55], v21 offset:2048
    s_waitcnt lgkmcnt(10)
    v_mfma_f32_32x32x16_bf16 v[72:87], v[32:35], v[228:231], v[72:87]
    ds_write_b128 v0, v[56:59]
    v_cvt_pk_bf16_f32 v60, v64, v65
    ds_read_b64_tr_b16 v[28:29], v21 offset:1024
    ds_read_b64_tr_b16 v[30:31], v21 offset:3072
    s_waitcnt lgkmcnt(11)
    v_mfma_f32_32x32x16_bf16 v[72:87], v[36:39], v[232:235], v[72:87]
    v_cvt_pk_bf16_f32 v61, v66, v67
    v_cvt_pk_bf16_f32 v62, v68, v69
    ds_read_b64_tr_b16 v[32:33], v21 offset:4096
    ds_read_b64_tr_b16 v[34:35], v21 offset:6144
    s_waitcnt lgkmcnt(11)
    v_mfma_f32_32x32x16_bf16 v[72:87], v[40:43], v[236:239], v[72:87]
    v_cvt_pk_bf16_f32 v63, v70, v71
    ds_write_b128 v0, v[60:63] offset:1024
    ds_read_b64_tr_b16 v[36:37], v21 offset:5120
    ds_read_b64_tr_b16 v[38:39], v21 offset:7168
    s_waitcnt lgkmcnt(12)
    v_mfma_f32_32x32x16_bf16 v[72:87], v[44:47], v[240:243], v[72:87]
    v_subrev_u32 v0, 118784, v0
    ds_read_b64_tr_b16 v[40:41], v21 offset:8192
    ds_read_b64_tr_b16 v[42:43], v21 offset:10240
    s_waitcnt lgkmcnt(12)
    v_mfma_f32_32x32x16_bf16 v[72:87], v[48:51], v[244:247], v[72:87]
    ds_read_b64_tr_b16 v[44:45], v21 offset:9216
    ds_read_b64_tr_b16 v[46:47], v21 offset:11264
    s_waitcnt lgkmcnt(6)
    s_barrier
    v_mfma_f32_32x32x16_bf16 v[72:87], v[52:55], v[152:155], v[72:87]
    ds_read_b64_tr_b16 v[48:49], v21 offset:12288
    ds_read_b64_tr_b16 v[50:51], v21 offset:14336
    v_mfma_f32_32x32x16_bf16 v[72:87], v[28:31], v[156:159], v[72:87]
    ds_read_b64_tr_b16 v[52:53], v21 offset:13312
    ds_read_b64_tr_b16 v[54:55], v21 offset:15360
    v_mfma_f32_32x32x16_bf16 v[72:87], v[32:35], v[160:163], v[72:87]
    ds_read_b64_tr_b16 v[28:29], v21 offset:16384
    ds_read_b64_tr_b16 v[30:31], v21 offset:18432
    s_waitcnt lgkmcnt(10)
    v_mfma_f32_32x32x16_bf16 v[72:87], v[36:39], v[164:167], v[72:87]
    ds_read_b64_tr_b16 v[32:33], v21 offset:17408
    ds_read_b64_tr_b16 v[34:35], v21 offset:19456
    s_waitcnt lgkmcnt(10)
    v_mfma_f32_32x32x16_bf16 v[72:87], v[40:43], v[168:171], v[72:87]
    ds_read_b64_tr_b16 v[36:37], v21 offset:20480
    ds_read_b64_tr_b16 v[38:39], v21 offset:22528
    s_waitcnt lgkmcnt(10)
    v_mfma_f32_32x32x16_bf16 v[72:87], v[44:47], v[172:175], v[72:87]
    ds_read_b64_tr_b16 v[40:41], v21 offset:21504
    ds_read_b64_tr_b16 v[42:43], v21 offset:23552
    s_waitcnt lgkmcnt(10)
    v_mfma_f32_32x32x16_bf16 v[72:87], v[48:51], v[176:179], v[72:87]
    ds_read_b64_tr_b16 v[44:45], v21 offset:24576
    ds_read_b64_tr_b16 v[46:47], v21 offset:26624
    s_waitcnt lgkmcnt(10)
    v_mfma_f32_32x32x16_bf16 v[72:87], v[52:55], v[180:183], v[72:87]
    ds_read_b64_tr_b16 v[48:49], v21 offset:25600
    ds_read_b64_tr_b16 v[50:51], v21 offset:27648
    s_waitcnt lgkmcnt(10)
    v_mfma_f32_32x32x16_bf16 v[72:87], v[28:31], v[184:187], v[72:87]
    ds_read_b64_tr_b16 v[52:53], v21 offset:28672
    ds_read_b64_tr_b16 v[54:55], v21 offset:30720
    s_waitcnt lgkmcnt(10)
    v_mfma_f32_32x32x16_bf16 v[72:87], v[32:35], v[188:191], v[72:87]
    ds_read_b64_tr_b16 v[28:29], v21 offset:29696
    ds_read_b64_tr_b16 v[30:31], v21 offset:31744
    s_waitcnt lgkmcnt(10)
    v_mfma_f32_32x32x16_bf16 v[72:87], v[36:39], v[192:195], v[72:87]
    ds_read_b64_tr_b16 v[32:33], v22 offset:32768
    ds_read_b64_tr_b16 v[34:35], v22 offset:34816
    s_waitcnt lgkmcnt(10)
    v_mfma_f32_32x32x16_bf16 v[72:87], v[40:43], v[196:199], v[72:87]
    ds_read_b64_tr_b16 v[36:37], v23 offset:32768
    ds_read_b64_tr_b16 v[38:39], v23 offset:34816
    s_waitcnt lgkmcnt(10)
    v_mfma_f32_32x32x16_bf16 v[72:87], v[44:47], v[200:203], v[72:87]
    ds_read_b64_tr_b16 v[40:41], v22 offset:33792
    ds_read_b64_tr_b16 v[42:43], v22 offset:35840
    s_waitcnt lgkmcnt(10)
    v_mfma_f32_32x32x16_bf16 v[72:87], v[48:51], v[204:207], v[72:87]
    ds_read_b64_tr_b16 v[44:45], v23 offset:33792
    ds_read_b64_tr_b16 v[46:47], v23 offset:35840
    s_waitcnt lgkmcnt(10)
    v_mfma_f32_32x32x16_bf16 v[72:87], v[52:55], v[208:211], v[72:87]
    ds_read_b64_tr_b16 v[48:49], v22 offset:36864
    ds_read_b64_tr_b16 v[50:51], v22 offset:38912
    s_waitcnt lgkmcnt(10)
    v_mfma_f32_32x32x16_bf16 v[72:87], v[28:31], v[212:215], v[72:87]
    ds_read_b64_tr_b16 v[52:53], v23 offset:36864
    ds_read_b64_tr_b16 v[54:55], v23 offset:38912
    s_waitcnt lgkmcnt(10)
    v_mfma_f32_32x32x16_bf16 v[88:103], v[32:35], v[216:219], v[88:103]
    ds_read_b64_tr_b16 v[28:29], v22 offset:37888
    ds_read_b64_tr_b16 v[30:31], v22 offset:39936
    s_waitcnt lgkmcnt(10)
    v_mfma_f32_32x32x16_bf16 v[104:119], v[36:39], v[216:219], v[104:119]
    s_nop 3
    v_cvt_pk_bf16_f32 v72, v72, v73
    v_cvt_pk_bf16_f32 v73, v74, v75
    ds_read_b64_tr_b16 v[32:33], v23 offset:37888
    ds_read_b64_tr_b16 v[34:35], v23 offset:39936
    s_waitcnt lgkmcnt(10)
    v_mfma_f32_32x32x16_bf16 v[88:103], v[40:43], v[220:223], v[88:103]
    v_cvt_pk_bf16_f32 v74, v76, v77
    v_cvt_pk_bf16_f32 v75, v78, v79
    ds_read_b64_tr_b16 v[36:37], v22 offset:40960
    ds_read_b64_tr_b16 v[38:39], v22 offset:43008
    s_waitcnt lgkmcnt(10)
    v_mfma_f32_32x32x16_bf16 v[104:119], v[44:47], v[220:223], v[104:119]
    ds_write_b128 v0, v[72:75]
    v_cvt_pk_bf16_f32 v76, v80, v81
    ds_read_b64_tr_b16 v[40:41], v23 offset:40960
    ds_read_b64_tr_b16 v[42:43], v23 offset:43008
    s_waitcnt lgkmcnt(11)
    v_mfma_f32_32x32x16_bf16 v[88:103], v[48:51], v[224:227], v[88:103]
    v_cvt_pk_bf16_f32 v77, v82, v83
    v_cvt_pk_bf16_f32 v78, v84, v85
    ds_read_b64_tr_b16 v[44:45], v22 offset:41984
    ds_read_b64_tr_b16 v[46:47], v22 offset:44032
    s_waitcnt lgkmcnt(11)
    v_mfma_f32_32x32x16_bf16 v[104:119], v[52:55], v[224:227], v[104:119]
    v_cvt_pk_bf16_f32 v79, v86, v87
    ds_write_b128 v0, v[76:79] offset:1024
    ds_read_b64_tr_b16 v[48:49], v23 offset:41984
    ds_read_b64_tr_b16 v[50:51], v23 offset:44032
    s_waitcnt lgkmcnt(12)
    v_mfma_f32_32x32x16_bf16 v[88:103], v[28:31], v[228:231], v[88:103]
    ds_read_b64_tr_b16 v[52:53], v22 offset:45056
    ds_read_b64_tr_b16 v[54:55], v22 offset:47104
    s_waitcnt lgkmcnt(12)
    v_mfma_f32_32x32x16_bf16 v[104:119], v[32:35], v[228:231], v[104:119]
    ds_read_b64_tr_b16 v[28:29], v23 offset:45056
    ds_read_b64_tr_b16 v[30:31], v23 offset:47104
    s_waitcnt lgkmcnt(6)
    s_barrier
    v_mfma_f32_32x32x16_bf16 v[88:103], v[36:39], v[232:235], v[88:103]
    s_lshl_b32 s96, s77, 11
    s_add_u32 s14, s96, 32768
    v_and_b32 v0, 7, v1
    ds_read_b64_tr_b16 v[32:33], v22 offset:46080
    ds_read_b64_tr_b16 v[34:35], v22 offset:48128
    v_mfma_f32_32x32x16_bf16 v[104:119], v[40:43], v[232:235], v[104:119]
    v_lshl_add_u32 v0, v0, 4, s14
    ds_read_b64_tr_b16 v[36:37], v23 offset:46080
    ds_read_b64_tr_b16 v[38:39], v23 offset:48128
    v_mfma_f32_32x32x16_bf16 v[88:103], v[44:47], v[236:239], v[88:103]
    v_bfe_u32 v4, v1, 3, 2
    ds_read_b64_tr_b16 v[40:41], v22
    ds_read_b64_tr_b16 v[42:43], v22 offset:2048
    s_waitcnt lgkmcnt(10)
    v_mfma_f32_32x32x16_bf16 v[104:119], v[48:51], v[236:239], v[104:119]
    v_lshl_add_u32 v0, v4, 8, v0
    v_lshrrev_b32 v4, 5, v1
    ds_read_b64_tr_b16 v[44:45], v23
    ds_read_b64_tr_b16 v[46:47], v23 offset:2048
    s_waitcnt lgkmcnt(10)
    v_mfma_f32_32x32x16_bf16 v[88:103], v[52:55], v[240:243], v[88:103]
    v_lshl_add_u32 v0, v4, 7, v0
    ds_read_b64_tr_b16 v[48:49], v22 offset:1024
    ds_read_b64_tr_b16 v[50:51], v22 offset:3072
    s_waitcnt lgkmcnt(10)
    v_mfma_f32_32x32x16_bf16 v[104:119], v[28:31], v[240:243], v[104:119]
    ds_read_b64_tr_b16 v[52:53], v23 offset:1024
    ds_read_b64_tr_b16 v[54:55], v23 offset:3072
    s_waitcnt lgkmcnt(10)
    v_mfma_f32_32x32x16_bf16 v[88:103], v[32:35], v[244:247], v[88:103]
    ds_read_b64_tr_b16 v[28:29], v22 offset:4096
    ds_read_b64_tr_b16 v[30:31], v22 offset:6144
    s_waitcnt lgkmcnt(10)
    v_mfma_f32_32x32x16_bf16 v[104:119], v[36:39], v[244:247], v[104:119]
    ds_read_b64_tr_b16 v[32:33], v23 offset:4096
    ds_read_b64_tr_b16 v[34:35], v23 offset:6144
    s_waitcnt lgkmcnt(10)
    v_mfma_f32_32x32x16_bf16 v[88:103], v[40:43], v[152:155], v[88:103]
    ds_read_b64_tr_b16 v[36:37], v22 offset:5120
    ds_read_b64_tr_b16 v[38:39], v22 offset:7168
    s_waitcnt lgkmcnt(10)
    v_mfma_f32_32x32x16_bf16 v[104:119], v[44:47], v[152:155], v[104:119]
    ds_read_b64_tr_b16 v[40:41], v23 offset:5120
    ds_read_b64_tr_b16 v[42:43], v23 offset:7168
    s_waitcnt lgkmcnt(10)
    v_mfma_f32_32x32x16_bf16 v[88:103], v[48:51], v[156:159], v[88:103]
    ds_read_b64_tr_b16 v[44:45], v22 offset:8192
    ds_read_b64_tr_b16 v[46:47], v22 offset:10240
    s_waitcnt lgkmcnt(10)
    v_mfma_f32_32x32x16_bf16 v[104:119], v[52:55], v[156:159], v[104:119]
    ds_read_b64_tr_b16 v[48:49], v23 offset:8192
    ds_read_b64_tr_b16 v[50:51], v23 offset:10240
    s_waitcnt lgkmcnt(10)
    v_mfma_f32_32x32x16_bf16 v[88:103], v[28:31], v[160:163], v[88:103]
    ds_read_b64_tr_b16 v[52:53], v22 offset:9216
    ds_read_b64_tr_b16 v[54:55], v22 offset:11264
    s_waitcnt lgkmcnt(10)
    v_mfma_f32_32x32x16_bf16 v[104:119], v[32:35], v[160:163], v[104:119]
    ds_read_b64_tr_b16 v[28:29], v23 offset:9216
    ds_read_b64_tr_b16 v[30:31], v23 offset:11264
    s_waitcnt lgkmcnt(10)
    v_mfma_f32_32x32x16_bf16 v[88:103], v[36:39], v[164:167], v[88:103]
    ds_read_b64_tr_b16 v[32:33], v22 offset:12288
    ds_read_b64_tr_b16 v[34:35], v22 offset:14336
    s_waitcnt lgkmcnt(10)
    v_mfma_f32_32x32x16_bf16 v[104:119], v[40:43], v[164:167], v[104:119]
    ds_read_b64_tr_b16 v[36:37], v23 offset:12288
    ds_read_b64_tr_b16 v[38:39], v23 offset:14336
    s_waitcnt lgkmcnt(10)
    v_mfma_f32_32x32x16_bf16 v[88:103], v[44:47], v[168:171], v[88:103]
    ds_read_b64_tr_b16 v[40:41], v22 offset:13312
    ds_read_b64_tr_b16 v[42:43], v22 offset:15360
    s_waitcnt lgkmcnt(10)
    v_mfma_f32_32x32x16_bf16 v[104:119], v[48:51], v[168:171], v[104:119]
    ds_read_b64_tr_b16 v[44:45], v23 offset:13312
    ds_read_b64_tr_b16 v[46:47], v23 offset:15360
    s_waitcnt lgkmcnt(10)
    v_mfma_f32_32x32x16_bf16 v[88:103], v[52:55], v[172:175], v[88:103]
    ds_read_b64_tr_b16 v[48:49], v22 offset:16384
    ds_read_b64_tr_b16 v[50:51], v22 offset:18432
    s_waitcnt lgkmcnt(10)
    v_mfma_f32_32x32x16_bf16 v[104:119], v[28:31], v[172:175], v[104:119]
    ds_read_b64_tr_b16 v[52:53], v23 offset:16384
    ds_read_b64_tr_b16 v[54:55], v23 offset:18432
    s_waitcnt lgkmcnt(10)
    v_mfma_f32_32x32x16_bf16 v[88:103], v[32:35], v[176:179], v[88:103]
    ds_read_b64_tr_b16 v[28:29], v22 offset:17408
    ds_read_b64_tr_b16 v[30:31], v22 offset:19456
    s_waitcnt lgkmcnt(10)
    v_mfma_f32_32x32x16_bf16 v[104:119], v[36:39], v[176:179], v[104:119]
    ds_read_b64_tr_b16 v[32:33], v23 offset:17408
    ds_read_b64_tr_b16 v[34:35], v23 offset:19456
    s_waitcnt lgkmcnt(10)
    v_mfma_f32_32x32x16_bf16 v[88:103], v[40:43], v[180:183], v[88:103]
    ds_read_b64_tr_b16 v[36:37], v22 offset:20480
    ds_read_b64_tr_b16 v[38:39], v22 offset:22528
    s_waitcnt lgkmcnt(10)
    v_mfma_f32_32x32x16_bf16 v[104:119], v[44:47], v[180:183], v[104:119]
    ds_read_b64_tr_b16 v[40:41], v23 offset:20480
    ds_read_b64_tr_b16 v[42:43], v23 offset:22528
    s_waitcnt lgkmcnt(10)
    v_mfma_f32_32x32x16_bf16 v[88:103], v[48:51], v[184:187], v[88:103]
    ds_read_b64_tr_b16 v[44:45], v22 offset:21504
    ds_read_b64_tr_b16 v[46:47], v22 offset:23552
    s_waitcnt lgkmcnt(10)
    v_mfma_f32_32x32x16_bf16 v[104:119], v[52:55], v[184:187], v[104:119]
    ds_read_b64_tr_b16 v[48:49], v23 offset:21504
    ds_read_b64_tr_b16 v[50:51], v23 offset:23552
    s_waitcnt lgkmcnt(10)
    v_mfma_f32_32x32x16_bf16 v[88:103], v[28:31], v[188:191], v[88:103]
    ds_read_b64_tr_b16 v[52:53], v22 offset:24576
    ds_read_b64_tr_b16 v[54:55], v22 offset:26624
    s_waitcnt lgkmcnt(10)
    v_mfma_f32_32x32x16_bf16 v[104:119], v[32:35], v[188:191], v[104:119]
    ds_read_b64_tr_b16 v[28:29], v23 offset:24576
    ds_read_b64_tr_b16 v[30:31], v23 offset:26624
    s_waitcnt lgkmcnt(10)
    v_mfma_f32_32x32x16_bf16 v[88:103], v[36:39], v[192:195], v[88:103]
    ds_read_b64_tr_b16 v[32:33], v22 offset:25600
    ds_read_b64_tr_b16 v[34:35], v22 offset:27648
    s_waitcnt lgkmcnt(10)
    v_mfma_f32_32x32x16_bf16 v[104:119], v[40:43], v[192:195], v[104:119]
    ds_read_b64_tr_b16 v[36:37], v23 offset:25600
    ds_read_b64_tr_b16 v[38:39], v23 offset:27648
    s_waitcnt lgkmcnt(10)
    v_mfma_f32_32x32x16_bf16 v[88:103], v[44:47], v[196:199], v[88:103]
    ds_read_b64_tr_b16 v[40:41], v22 offset:28672
    ds_read_b64_tr_b16 v[42:43], v22 offset:30720
    s_waitcnt lgkmcnt(10)
    v_mfma_f32_32x32x16_bf16 v[104:119], v[48:51], v[196:199], v[104:119]
    ds_read_b64_tr_b16 v[44:45], v23 offset:28672
    ds_read_b64_tr_b16 v[46:47], v23 offset:30720
    s_waitcnt lgkmcnt(10)
    v_mfma_f32_32x32x16_bf16 v[88:103], v[52:55], v[200:203], v[88:103]
    ds_read_b64_tr_b16 v[48:49], v22 offset:29696
    ds_read_b64_tr_b16 v[50:51], v22 offset:31744
    s_waitcnt lgkmcnt(10)
    v_mfma_f32_32x32x16_bf16 v[104:119], v[28:31], v[200:203], v[104:119]
    ds_read_b64_tr_b16 v[52:53], v23 offset:29696
    ds_read_b64_tr_b16 v[54:55], v23 offset:31744
    s_waitcnt lgkmcnt(10)
    v_mfma_f32_32x32x16_bf16 v[88:103], v[32:35], v[204:207], v[88:103]
    ds_read_b64_tr_b16 v[28:29], v24 offset:32768
    ds_read_b64_tr_b16 v[30:31], v24 offset:34816
    s_waitcnt lgkmcnt(10)
    v_mfma_f32_32x32x16_bf16 v[104:119], v[36:39], v[204:207], v[104:119]
    ds_read_b64_tr_b16 v[32:33], v25 offset:32768
    ds_read_b64_tr_b16 v[34:35], v25 offset:34816
    s_waitcnt lgkmcnt(10)
    v_mfma_f32_32x32x16_bf16 v[88:103], v[40:43], v[208:211], v[88:103]
    ds_read_b64_tr_b16 v[36:37], v24 offset:33792
    ds_read_b64_tr_b16 v[38:39], v24 offset:35840
    s_waitcnt lgkmcnt(10)
    v_mfma_f32_32x32x16_bf16 v[104:119], v[44:47], v[208:211], v[104:119]
    ds_read_b64_tr_b16 v[40:41], v25 offset:33792
    ds_read_b64_tr_b16 v[42:43], v25 offset:35840
    s_waitcnt lgkmcnt(10)
    v_mfma_f32_32x32x16_bf16 v[88:103], v[48:51], v[212:215], v[88:103]
    ds_read_b64_tr_b16 v[44:45], v24 offset:36864
    ds_read_b64_tr_b16 v[46:47], v24 offset:38912
    s_waitcnt lgkmcnt(10)
    v_mfma_f32_32x32x16_bf16 v[104:119], v[52:55], v[212:215], v[104:119]
    ds_read_b64_tr_b16 v[48:49], v25 offset:36864
    ds_read_b64_tr_b16 v[50:51], v25 offset:38912
    s_barrier
    s_waitcnt lgkmcnt(10)
    v_mfma_f32_32x32x16_bf16 v[120:135], v[28:31], v[216:219], v[120:135]
    ds_read_b64_tr_b16 v[52:53], v24 offset:37888
    ds_read_b64_tr_b16 v[54:55], v24 offset:39936
    s_waitcnt lgkmcnt(10)
    v_mfma_f32_32x32x16_bf16 v[136:151], v[32:35], v[216:219], v[136:151]
    ds_read_b64_tr_b16 v[28:29], v25 offset:37888
    ds_read_b64_tr_b16 v[30:31], v25 offset:39936
    s_waitcnt lgkmcnt(10)
    v_mfma_f32_32x32x16_bf16 v[120:135], v[36:39], v[220:223], v[120:135]
    v_cvt_pk_bf16_f32 v88, v88, v89
    ds_read_b64_tr_b16 v[32:33], v24 offset:40960
    ds_read_b64_tr_b16 v[34:35], v24 offset:43008
L_PAD4:
    s_cbranch_execz L_RET4
    s_waitcnt lgkmcnt(10)
    v_mfma_f32_32x32x16_bf16 v[136:151], v[40:43], v[220:223], v[136:151]
    v_cvt_pk_bf16_f32 v89, v90, v91
    ds_read_b64_tr_b16 v[36:37], v25 offset:40960
    ds_read_b64_tr_b16 v[38:39], v25 offset:43008
    s_waitcnt lgkmcnt(10)
    v_mfma_f32_32x32x16_bf16 v[120:135], v[44:47], v[224:227], v[120:135]
    v_cvt_pk_bf16_f32 v90, v92, v93
    ds_read_b64_tr_b16 v[40:41], v24 offset:41984
    ds_read_b64_tr_b16 v[42:43], v24 offset:44032
    s_waitcnt lgkmcnt(10)
    v_mfma_f32_32x32x16_bf16 v[136:151], v[48:51], v[224:227], v[136:151]
    v_cvt_pk_bf16_f32 v91, v94, v95
    ds_read_b64_tr_b16 v[44:45], v25 offset:41984
    ds_read_b64_tr_b16 v[46:47], v25 offset:44032
    s_waitcnt lgkmcnt(10)
    v_mfma_f32_32x32x16_bf16 v[120:135], v[52:55], v[228:231], v[120:135]
    ds_write_b128 v0, v[88:91]
    ds_read_b64_tr_b16 v[48:49], v24 offset:45056
    ds_read_b64_tr_b16 v[50:51], v24 offset:47104
    s_waitcnt lgkmcnt(11)
    v_mfma_f32_32x32x16_bf16 v[136:151], v[28:31], v[228:231], v[136:151]
    v_cvt_pk_bf16_f32 v92, v96, v97
    ds_read_b64_tr_b16 v[52:53], v25 offset:45056
    ds_read_b64_tr_b16 v[54:55], v25 offset:47104
    s_waitcnt lgkmcnt(11)
    v_mfma_f32_32x32x16_bf16 v[120:135], v[32:35], v[232:235], v[120:135]
    v_cvt_pk_bf16_f32 v93, v98, v99
    ds_read_b64_tr_b16 v[28:29], v24 offset:46080
    ds_read_b64_tr_b16 v[30:31], v24 offset:48128
    s_waitcnt lgkmcnt(11)
    v_mfma_f32_32x32x16_bf16 v[136:151], v[36:39], v[232:235], v[136:151]
    v_cvt_pk_bf16_f32 v94, v100, v101
    ds_read_b64_tr_b16 v[32:33], v25 offset:46080
    ds_read_b64_tr_b16 v[34:35], v25 offset:48128
    s_waitcnt lgkmcnt(11)
    v_mfma_f32_32x32x16_bf16 v[120:135], v[40:43], v[236:239], v[120:135]
    v_cvt_pk_bf16_f32 v95, v102, v103
    ds_read_b64_tr_b16 v[36:37], v24
    ds_read_b64_tr_b16 v[38:39], v24 offset:2048
    s_waitcnt lgkmcnt(11)
    v_mfma_f32_32x32x16_bf16 v[136:151], v[44:47], v[236:239], v[136:151]
    ds_write_b128 v0, v[92:95] offset:1024
    ds_read_b64_tr_b16 v[40:41], v25
    ds_read_b64_tr_b16 v[42:43], v25 offset:2048
    s_waitcnt lgkmcnt(11)
    v_mfma_f32_32x32x16_bf16 v[120:135], v[48:51], v[240:243], v[120:135]
    v_cvt_pk_bf16_f32 v104, v104, v105
    ds_read_b64_tr_b16 v[44:45], v24 offset:1024
    ds_read_b64_tr_b16 v[46:47], v24 offset:3072
    s_waitcnt lgkmcnt(11)
    v_mfma_f32_32x32x16_bf16 v[136:151], v[52:55], v[240:243], v[136:151]
    v_cvt_pk_bf16_f32 v105, v106, v107
    ds_read_b64_tr_b16 v[48:49], v25 offset:1024
    ds_read_b64_tr_b16 v[50:51], v25 offset:3072
    s_waitcnt lgkmcnt(11)
    v_mfma_f32_32x32x16_bf16 v[120:135], v[28:31], v[244:247], v[120:135]
    v_cvt_pk_bf16_f32 v106, v108, v109
    ds_read_b64_tr_b16 v[52:53], v24 offset:4096
    ds_read_b64_tr_b16 v[54:55], v24 offset:6144
    s_waitcnt lgkmcnt(11)
    v_mfma_f32_32x32x16_bf16 v[136:151], v[32:35], v[244:247], v[136:151]
    v_cvt_pk_bf16_f32 v107, v110, v111
    ds_read_b64_tr_b16 v[28:29], v25 offset:4096
    ds_read_b64_tr_b16 v[30:31], v25 offset:6144
    s_waitcnt lgkmcnt(11)
    v_mfma_f32_32x32x16_bf16 v[120:135], v[36:39], v[152:155], v[120:135]
    ds_write_b128 v0, v[104:107] offset:8192
    ds_read_b64_tr_b16 v[32:33], v24 offset:5120
    ds_read_b64_tr_b16 v[34:35], v24 offset:7168
    s_waitcnt lgkmcnt(11)
    v_mfma_f32_32x32x16_bf16 v[136:151], v[40:43], v[152:155], v[136:151]
    v_cvt_pk_bf16_f32 v108, v112, v113
    ds_read_b64_tr_b16 v[36:37], v25 offset:5120
    ds_read_b64_tr_b16 v[38:39], v25 offset:7168
    s_waitcnt lgkmcnt(11)
    v_mfma_f32_32x32x16_bf16 v[120:135], v[44:47], v[156:159], v[120:135]
    v_cvt_pk_bf16_f32 v109, v114, v115
    ds_read_b64_tr_b16 v[40:41], v24 offset:8192
    ds_read_b64_tr_b16 v[42:43], v24 offset:10240
    s_waitcnt lgkmcnt(11)
    v_mfma_f32_32x32x16_bf16 v[136:151], v[48:51], v[156:159], v[136:151]
    v_cvt_pk_bf16_f32 v110, v116, v117
    ds_read_b64_tr_b16 v[44:45], v25 offset:8192
    ds_read_b64_tr_b16 v[46:47], v25 offset:10240
    s_waitcnt lgkmcnt(11)
    v_mfma_f32_32x32x16_bf16 v[120:135], v[52:55], v[160:163], v[120:135]
    v_cvt_pk_bf16_f32 v111, v118, v119
    ds_read_b64_tr_b16 v[48:49], v24 offset:9216
    ds_read_b64_tr_b16 v[50:51], v24 offset:11264
    s_waitcnt lgkmcnt(11)
    v_mfma_f32_32x32x16_bf16 v[136:151], v[28:31], v[160:163], v[136:151]
    ds_write_b128 v0, v[108:111] offset:9216
    ds_read_b64_tr_b16 v[52:53], v25 offset:9216
    ds_read_b64_tr_b16 v[54:55], v25 offset:11264
    s_waitcnt lgkmcnt(11)
    v_mfma_f32_32x32x16_bf16 v[120:135], v[32:35], v[164:167], v[120:135]
    v_and_b32 v85, 1, v1
    ds_read_b64_tr_b16 v[28:29], v24 offset:12288
    ds_read_b64_tr_b16 v[30:31], v24 offset:14336
    s_waitcnt lgkmcnt(11)
    v_mfma_f32_32x32x16_bf16 v[136:151], v[36:39], v[164:167], v[136:151]
    v_lshlrev_b32 v85, 3, v85
    ds_read_b64_tr_b16 v[32:33], v25 offset:12288
    ds_read_b64_tr_b16 v[34:35], v25 offset:14336
    s_waitcnt lgkmcnt(11)
    v_mfma_f32_32x32x16_bf16 v[120:135], v[40:43], v[168:171], v[120:135]
    v_bfe_u32 v84, v1, 2, 2
    ds_read_b64_tr_b16 v[36:37], v24 offset:13312
    ds_read_b64_tr_b16 v[38:39], v24 offset:15360
    s_waitcnt lgkmcnt(11)
    v_mfma_f32_32x32x16_bf16 v[136:151], v[44:47], v[168:171], v[136:151]
    v_lshl_add_u32 v85, v84, 4, v85
    ds_read_b64_tr_b16 v[40:41], v25 offset:13312
    ds_read_b64_tr_b16 v[42:43], v25 offset:15360
    s_waitcnt lgkmcnt(11)
    v_mfma_f32_32x32x16_bf16 v[120:135], v[48:51], v[172:175], v[120:135]
    v_bfe_u32 v84, v1, 4, 1
    ds_read_b64_tr_b16 v[44:45], v24 offset:16384
    ds_read_b64_tr_b16 v[46:47], v24 offset:18432
    s_waitcnt lgkmcnt(10)
    v_mfma_f32_32x32x16_bf16 v[136:151], v[52:55], v[172:175], v[136:151]
    v_lshl_add_u32 v85, v84, 6, v85
    ds_read_b64_tr_b16 v[48:49], v25 offset:16384
    ds_read_b64_tr_b16 v[50:51], v25 offset:18432
    s_waitcnt lgkmcnt(10)
    v_mfma_f32_32x32x16_bf16 v[120:135], v[28:31], v[176:179], v[120:135]
    v_bfe_u32 v84, v1, 1, 1
    ds_read_b64_tr_b16 v[52:53], v24 offset:17408
    ds_read_b64_tr_b16 v[54:55], v24 offset:19456
    s_waitcnt lgkmcnt(10)
    v_mfma_f32_32x32x16_bf16 v[136:151], v[32:35], v[176:179], v[136:151]
    v_lshl_add_u32 v85, v84, 7, v85
    ds_read_b64_tr_b16 v[28:29], v25 offset:17408
    ds_read_b64_tr_b16 v[30:31], v25 offset:19456
    s_waitcnt lgkmcnt(10)
    v_mfma_f32_32x32x16_bf16 v[120:135], v[36:39], v[180:183], v[120:135]
    v_lshrrev_b32 v84, 5, v1
    ds_read_b64_tr_b16 v[32:33], v24 offset:20480
    ds_read_b64_tr_b16 v[34:35], v24 offset:22528
    s_waitcnt lgkmcnt(10)
    v_mfma_f32_32x32x16_bf16 v[136:151], v[40:43], v[180:183], v[136:151]
    v_lshl_add_u32 v85, v84, 8, v85
    ds_read_b64_tr_b16 v[36:37], v25 offset:20480
    ds_read_b64_tr_b16 v[38:39], v25 offset:22528
    s_waitcnt lgkmcnt(10)
    v_mfma_f32_32x32x16_bf16 v[120:135], v[44:47], v[184:187], v[120:135]
    s_lshl_b32 s13, s3, 12
    v_add_u32 v84, s13, v85
    ds_read_b64_tr_b16 v[40:41], v24 offset:21504
    ds_read_b64_tr_b16 v[42:43], v24 offset:23552
    s_waitcnt lgkmcnt(10)
    v_mfma_f32_32x32x16_bf16 v[136:151], v[48:51], v[184:187], v[136:151]
    s_lshl_b32 s96, s76, 13
    s_add_u32 s13, s96, 32768
    v_add_u32 v85, s13, v85
    ds_read_b64_tr_b16 v[44:45], v25 offset:21504
    ds_read_b64_tr_b16 v[46:47], v25 offset:23552
    s_waitcnt lgkmcnt(10)
    v_mfma_f32_32x32x16_bf16 v[120:135], v[52:55], v[188:191], v[120:135]
    v_mov_b32 v80, 0x3f803f80
    ds_read_b64_tr_b16 v[48:49], v24 offset:24576
    ds_read_b64_tr_b16 v[50:51], v24 offset:26624
    s_waitcnt lgkmcnt(10)
    v_mfma_f32_32x32x16_bf16 v[136:151], v[28:31], v[188:191], v[136:151]
    v_mov_b32 v81, 0x3f803f80
    ds_read_b64_tr_b16 v[52:53], v25 offset:24576
    ds_read_b64_tr_b16 v[54:55], v25 offset:26624
    s_waitcnt lgkmcnt(10)
    v_mfma_f32_32x32x16_bf16 v[120:135], v[32:35], v[192:195], v[120:135]
    v_mov_b32 v82, 0x3f803f80
    ds_read_b64_tr_b16 v[28:29], v24 offset:25600
    ds_read_b64_tr_b16 v[30:31], v24 offset:27648
    s_waitcnt lgkmcnt(10)
    v_mfma_f32_32x32x16_bf16 v[136:151], v[36:39], v[192:195], v[136:151]
    v_mov_b32 v83, 0x3f803f80
    ds_read_b64_tr_b16 v[32:33], v25 offset:25600
    ds_read_b64_tr_b16 v[34:35], v25 offset:27648
    s_waitcnt lgkmcnt(10)
    v_mfma_f32_32x32x16_bf16 v[120:135], v[40:43], v[196:199], v[120:135]
    s_lshl3_add_u32 s96, s11, s3
    s_lshl_b32 s97, s96, 5
    s_add_u32 s98, s97, s10
    s_lshl_b32 s99, s98, 10
    s_add_u32 s13, s99, 25165824
    s_add_u32 s15, s13, 16384
    s_lshl3_add_u32 s96, s11, s3
    s_lshl_b32 s97, s96, 10
    s_add_u32 s16, s97, 21495808
    s_lshl_b32 s96, s10, 6
    s_add_u32 s14, s96, s16
    ds_read_b64_tr_b16 v[36:37], v24 offset:28672
    ds_read_b64_tr_b16 v[38:39], v24 offset:30720
    s_waitcnt lgkmcnt(10)
    v_mfma_f32_32x32x16_bf16 v[136:151], v[44:47], v[196:199], v[136:151]
    ds_read_b64_tr_b16 v[40:41], v25 offset:28672
    ds_read_b64_tr_b16 v[42:43], v25 offset:30720
    s_waitcnt lgkmcnt(10)
    v_mfma_f32_32x32x16_bf16 v[120:135], v[48:51], v[200:203], v[120:135]
    ds_read_b64_tr_b16 v[44:45], v25 offset:29696
    ds_read_b64_tr_b16 v[46:47], v25 offset:31744
    s_waitcnt lgkmcnt(10)
    v_mfma_f32_32x32x16_bf16 v[136:151], v[52:55], v[200:203], v[136:151]
    ds_read_b64_tr_b16 v[48:49], v24 offset:29696
    ds_read_b64_tr_b16 v[50:51], v24 offset:31744
    s_waitcnt lgkmcnt(10)
    v_mfma_f32_32x32x16_bf16 v[120:135], v[28:31], v[204:207], v[120:135]
    s_waitcnt lgkmcnt(8)
    v_mfma_f32_32x32x16_bf16 v[136:151], v[32:35], v[204:207], v[136:151]
    s_waitcnt lgkmcnt(6)
    v_mfma_f32_32x32x16_bf16 v[120:135], v[36:39], v[208:211], v[120:135]
    s_waitcnt lgkmcnt(4)
    v_mfma_f32_32x32x16_bf16 v[136:151], v[40:43], v[208:211], v[136:151]
    s_waitcnt lgkmcnt(2)
    v_mfma_f32_32x32x16_bf16 v[136:151], v[44:47], v[212:215], v[136:151]
    s_waitcnt lgkmcnt(0)
    v_mfma_f32_32x32x16_bf16 v[120:135], v[48:51], v[212:215], v[120:135]
    s_lshl_b32 s96, s77, 11
    s_add_u32 s17, s96, 151552
    v_add_u32 v0, s17, v2
    v_bfe_u32 v4, v1, 2, 2
    v_lshlrev_b32 v4, 6, v4
    v_bfe_u32 v9, v1, 4, 1
    v_lshl_add_u32 v4, v9, 5, v4
    v_and_b32 v9, 3, v1
    v_lshl_add_u32 v4, v9, 3, v4
    v_lshrrev_b32 v9, 5, v1
    v_lshl_add_u32 v4, v9, 8, v4
    v_add_u32 v4, 159744, v4
    ds_read_b64_tr_b16 v[176:177], v4
    ds_read_b64_tr_b16 v[178:179], v4 offset:512
    ds_read_b64_tr_b16 v[180:181], v4 offset:1024
    ds_read_b64_tr_b16 v[182:183], v4 offset:1536
    v_cvt_pk_bf16_f32 v152, v136, v137
    v_cvt_pk_bf16_f32 v153, v138, v139
    v_cvt_pk_bf16_f32 v154, v140, v141
    v_cvt_pk_bf16_f32 v155, v142, v143
    v_cvt_pk_bf16_f32 v156, v144, v145
    v_cvt_pk_bf16_f32 v157, v146, v147
    v_cvt_pk_bf16_f32 v158, v148, v149
    v_cvt_pk_bf16_f32 v159, v150, v151
    ds_write_b128 v0, v[152:155]
    ds_write_b128 v0, v[156:159] offset:1024
    v_cvt_pk_bf16_f32 v168, v120, v121
    v_cvt_pk_bf16_f32 v169, v122, v123
    v_cvt_pk_bf16_f32 v170, v124, v125
    v_cvt_pk_bf16_f32 v171, v126, v127
    v_cvt_pk_bf16_f32 v172, v128, v129
    v_cvt_pk_bf16_f32 v173, v130, v131
    v_cvt_pk_bf16_f32 v174, v132, v133
    v_cvt_pk_bf16_f32 v175, v134, v135
    s_setprio 0
    s_branch L_JOIN
L_HELP:
    s_waitcnt vmcnt(0)
    s_barrier
    s_add_u32 s96, s84, 4
    s_and_b32 s97, s96, 15
    s_mul_i32 s98, s97, 393216
    s_add_u32 s99, s98, s85
    s_add_u32 s82, s99, 4294772736
    s_add_u32 m0, s83, 28672
    s_nop 0
    buffer_load_dwordx4 v3, s[40:43], s82 offen lds
    s_add_u32 s96, s84, 4
    s_and_b32 s97, s96, 15
    s_mul_i32 s98, s97, 393216
    s_add_u32 s99, s98, s85
    s_add_u32 s82, s99, 2048
    s_add_u32 m0, s83, 32768
    s_nop 0
    buffer_load_dwordx4 v3, s[40:43], s82 offen lds
    s_add_u32 s96, s84, 4
    s_and_b32 s97, s96, 15
    s_mul_i32 s98, s97, 393216
    s_add_u32 s99, s98, s85
    s_add_u32 s82, s99, 4294774784
    s_add_u32 m0, s83, 77824
    s_nop 0
    buffer_load_dwordx4 v3, s[40:43], s82 offen lds
    s_add_u32 s96, s84, 4
    s_and_b32 s97, s96, 15
    s_mul_i32 s98, s97, 393216
    s_add_u32 s99, s98, s85
    s_add_u32 s82, s99, 4096
    s_add_u32 m0, s83, 81920
    s_nop 0
    buffer_load_dwordx4 v3, s[40:43], s82 offen lds
    s_add_u32 s96, s84, 4
    s_and_b32 s97, s96, 15
    s_mul_i32 s98, s97, 393216
    s_add_u32 s99, s98, s85
    s_add_u32 s82, s99, 4294770688
    s_add_u32 m0, s83, 126976
    s_nop 0
    buffer_load_dwordx4 v3, s[40:43], s82 offen lds
    s_add_u32 s96, s84, 4
    s_and_b32 s97, s96, 15
    s_mul_i32 s98, s97, 393216
    s_add_u32 s82, s98, s85
    s_add_u32 m0, s83, 131072
    s_nop 0
    buffer_load_dwordx4 v3, s[40:43], s82 offen lds
    s_add_u32 s96, s84, 5
    s_and_b32 s97, s96, 15
    s_mul_i32 s98, s97, 393216
    s_add_u32 s99, s98, s85
    s_add_u32 s82, s99, 4294772736
    s_add_u32 m0, s83, 36864
    s_nop 0
    buffer_load_dwordx4 v3, s[40:43], s82 offen lds
    s_add_u32 s96, s84, 5
    s_and_b32 s97, s96, 15
    s_mul_i32 s98, s97, 393216
    s_add_u32 s99, s98, s85
    s_add_u32 s82, s99, 2048
    s_add_u32 m0, s83, 40960
    s_nop 0
    buffer_load_dwordx4 v3, s[40:43], s82 offen lds
    s_add_u32 s96, s84, 5
    s_and_b32 s97, s96, 15
    s_mul_i32 s98, s97, 393216
    s_add_u32 s99, s98, s85
    s_add_u32 s82, s99, 4294774784
    s_add_u32 m0, s83, 86016
    s_nop 0
    buffer_load_dwordx4 v3, s[40:43], s82 offen lds
    s_add_u32 s96, s84, 5
    s_and_b32 s97, s96, 15
    s_mul_i32 s98, s97, 393216
    s_add_u32 s99, s98, s85
    s_add_u32 s82, s99, 4096
    s_add_u32 m0, s83, 90112
    s_nop 0
    buffer_load_dwordx4 v3, s[40:43], s82 offen lds
    s_add_u32 s96, s84, 5
    s_and_b32 s97, s96, 15
    s_mul_i32 s98, s97, 393216
    s_add_u32 s99, s98, s85
    s_add_u32 s82, s99, 4294770688
    s_add_u32 m0, s83, 135168
    s_nop 0
    buffer_load_dwordx4 v3, s[40:43], s82 offen lds
    s_add_u32 s96, s84, 5
    s_and_b32 s97, s96, 15
    s_mul_i32 s98, s97, 393216
    s_add_u32 s82, s98, s85
    s_add_u32 m0, s83, 139264
    s_nop 0
    buffer_load_dwordx4 v3, s[40:43], s82 offen lds
    s_waitcnt lgkmcnt(0)
SPOLL_16:
    s_load_dwordx2 s[24:25], s[32:33], s19 offset:0 glc
    s_load_dwordx2 s[26:27], s[32:33], s19 offset:64 glc
SCHK_17:
    s_add_u32 s5, s5, 1
    s_cmp_ge_u32 s5, 200000
    s_waitcnt lgkmcnt(0)
    s_cbranch_scc1 SDONE_18
    s_cmp_lg_u32 s24, s4
    s_cbranch_scc1 SPOLL_16
    s_cmp_lg_u32 s25, s4
    s_cbranch_scc1 SPOLL_16
    s_cmp_lg_u32 s26, s4
    s_cbranch_scc1 SPOLL_16
    s_cmp_lg_u32 s27, s4
    s_cbranch_scc1 SPOLL_16
SDONE_18:
    v_bfe_u32 v4, v1, 2, 2
    v_lshlrev_b32 v4, 6, v4
    v_bfe_u32 v9, v1, 4, 1
    v_lshl_add_u32 v4, v9, 5, v4
    v_and_b32 v9, 3, v1
    v_lshl_add_u32 v4, v9, 3, v4
    v_lshrrev_b32 v9, 5, v1
    v_lshl_add_u32 v4, v9, 8, v4
    v_add_u32 v4, 159744, v4
    ds_read_b64_tr_b16 v[168:169], v4
    ds_read_b64_tr_b16 v[170:171], v4 offset:512
    ds_read_b64_tr_b16 v[172:173], v4 offset:1024
    ds_read_b64_tr_b16 v[174:175], v4 offset:1536
    ds_read_b64_tr_b16 v[176:177], v4 offset:2048
    ds_read_b64_tr_b16 v[178:179], v4 offset:2560
    ds_read_b64_tr_b16 v[180:181], v4 offset:3072
    ds_read_b64_tr_b16 v[182:183], v4 offset:3584
    s_lshl_b32 s14, s77, 10
    v_and_b32 v232, 7, v1
    v_lshl_add_u32 v232, v232, 4, s14
    v_bfe_u32 v9, v1, 3, 2
    v_lshl_add_u32 v232, v9, 8, v232
    v_lshrrev_b32 v9, 5, v1
    v_lshl_add_u32 v232, v9, 7, v232
    s_and_b32 s96, s9, 1
    s_lshl1_add_u32 s18, s96, 1
    s_and_b32 s96, s8, 3
    s_lshl2_add_u32 s97, s96, s3
    s_sub_u32 s98, s97, 4
    s_lshl_b32 s82, s98, 7
    v_lshrrev_b32 v52, 3, v1
    v_lshl_add_u32 v52, v52, 1, s82
    global_load_ushort v36, v52, s[86:87] offset:0
    global_load_ushort v37, v52, s[86:87] offset:16
    global_load_ushort v38, v52, s[86:87] offset:32
    global_load_ushort v39, v52, s[86:87] offset:48
    global_load_ushort v40, v52, s[86:87] offset:64
    global_load_ushort v41, v52, s[86:87] offset:80
    global_load_ushort v42, v52, s[86:87] offset:96
    global_load_ushort v43, v52, s[86:87] offset:112
    s_and_b32 s96, s8, 3
    s_lshl2_add_u32 s97, s96, s3
    s_sub_u32 s98, s97, 4
    s_mul_i32 s99, s98, 786432
    s_lshr_b32 s96, s8, 2
    s_lshl1_add_u32 s97, s9, s96
    s_lshl_b32 s98, s97, 7
    s_add_u32 s96, s99, s98
    s_add_u32 s19, s96, 4096
    s_barrier
    s_add_u32 s96, s84, 6
    s_and_b32 s97, s96, 15
    s_mul_i32 s98, s97, 393216
    s_add_u32 s99, s98, s85
    s_add_u32 s82, s99, 4294772736
    s_add_u32 m0, s83, 4294963200
    s_nop 0
    buffer_load_dwordx4 v3, s[40:43], s82 offen lds
    s_add_u32 s96, s84, 6
    s_and_b32 s97, s96, 15
    s_mul_i32 s98, s97, 393216
    s_add_u32 s99, s98, s85
    s_add_u32 s82, s99, 2048
    s_mov_b32 m0, s83
    s_nop 0
    buffer_load_dwordx4 v3, s[40:43], s82 offen lds
    s_add_u32 s96, s84, 6
    s_and_b32 s97, s96, 15
    s_mul_i32 s98, s97, 393216
    s_add_u32 s99, s98, s85
    s_add_u32 s82, s99, 4294770688
    s_add_u32 m0, s83, 94208
    s_nop 0
    buffer_load_dwordx4 v3, s[40:43], s82 offen lds
    s_add_u32 s96, s84, 6
    s_and_b32 s97, s96, 15
    s_mul_i32 s98, s97, 393216
    s_add_u32 s82, s98, s85
    s_add_u32 m0, s83, 98304
    s_nop 0
    buffer_load_dwordx4 v3, s[40:43], s82 offen lds
    s_add_u32 s96, s84, 6
    s_and_b32 s97, s96, 15
    s_mul_i32 s98, s97, 393216
    s_add_u32 s99, s98, s85
    s_add_u32 s82, s99, 4294774784
    s_add_u32 m0, s83, 45056
    s_nop 0
    buffer_load_dwordx4 v3, s[40:43], s82 offen lds
    s_add_u32 s96, s84, 6
    s_and_b32 s97, s96, 15
    s_mul_i32 s98, s97, 393216
    s_add_u32 s99, s98, s85
    s_add_u32 s82, s99, 4096
    s_add_u32 m0, s83, 49152
    s_nop 0
    buffer_load_dwordx4 v3, s[40:43], s82 offen lds
    s_waitcnt lgkmcnt(0)
    s_load_dword s24, s[32:33], s92 offset:512 glc
    s_load_dword s25, s[32:33], s92 offset:256 glc
    s_load_dword s26, s[32:33], s92 offset:3584 glc
    s_load_dword s27, s[32:33], s92 offset:3328 glc
    s_barrier
    s_add_u32 s96, s84, 7
    s_and_b32 s97, s96, 15
    s_mul_i32 s98, s97, 393216
    s_add_u32 s99, s98, s85
    s_add_u32 s82, s99, 4294772736
    s_add_u32 m0, s83, 4096
    s_nop 0
    buffer_load_dwordx4 v3, s[40:43], s82 offen lds
    s_add_u32 s96, s84, 7
    s_and_b32 s97, s96, 15
    s_mul_i32 s98, s97, 393216
    s_add_u32 s99, s98, s85
    s_add_u32 s82, s99, 2048
    s_add_u32 m0, s83, 8192
    s_nop 0
    buffer_load_dwordx4 v3, s[40:43], s82 offen lds
    s_add_u32 s96, s84, 7
    s_and_b32 s97, s96, 15
    s_mul_i32 s98, s97, 393216
    s_add_u32 s99, s98, s85
    s_add_u32 s82, s99, 4294770688
    s_add_u32 m0, s83, 102400
    s_nop 0
    buffer_load_dwordx4 v3, s[40:43], s82 offen lds
    s_add_u32 s96, s84, 7
    s_and_b32 s97, s96, 15
    s_mul_i32 s98, s97, 393216
    s_add_u32 s82, s98, s85
    s_add_u32 m0, s83, 106496
    s_nop 0
    buffer_load_dwordx4 v3, s[40:43], s82 offen lds
    s_add_u32 s96, s84, 7
    s_and_b32 s97, s96, 15
    s_mul_i32 s98, s97, 393216
    s_add_u32 s99, s98, s85
    s_add_u32 s82, s99, 4294774784
    s_add_u32 m0, s83, 53248
    s_nop 0
    buffer_load_dwordx4 v3, s[40:43], s82 offen lds
    s_add_u32 s96, s84, 7
    s_and_b32 s97, s96, 15
    s_mul_i32 s98, s97, 393216
    s_add_u32 s99, s98, s85
    s_add_u32 s82, s99, 4096
    s_add_u32 m0, s83, 57344
    s_nop 0
    buffer_load_dwordx4 v3, s[40:43], s82 offen lds
    s_waitcnt vmcnt(30)
    s_waitcnt vmcnt(26)
    s_barrier
    s_add_u32 s96, s84, 8
    s_and_b32 s97, s96, 15
    s_mul_i32 s98, s97, 393216
    s_add_u32 s99, s98, s85
    s_add_u32 s82, s99, 4294772736
    s_add_u32 m0, s83, 12288
    s_nop 0
    buffer_load_dwordx4 v3, s[40:43], s82 offen lds
    s_add_u32 s96, s84, 8
    s_and_b32 s97, s96, 15
    s_mul_i32 s98, s97, 393216
    s_add_u32 s99, s98, s85
    s_add_u32 s82, s99, 2048
    s_add_u32 m0, s83, 16384
    s_nop 0
    buffer_load_dwordx4 v3, s[40:43], s82 offen lds
    s_add_u32 s96, s84, 8
    s_and_b32 s97, s96, 15
    s_mul_i32 s98, s97, 393216
    s_add_u32 s99, s98, s85
    s_add_u32 s82, s99, 4294770688
    s_add_u32 m0, s83, 110592
    s_nop 0
    buffer_load_dwordx4 v3, s[40:43], s82 offen lds
    s_add_u32 s96, s84, 8
    s_and_b32 s97, s96, 15
    s_mul_i32 s98, s97, 393216
    s_add_u32 s82, s98, s85
    s_add_u32 m0, s83, 114688
    s_nop 0
    buffer_load_dwordx4 v3, s[40:43], s82 offen lds
    s_add_u32 s96, s84, 8
    s_and_b32 s97, s96, 15
    s_mul_i32 s98, s97, 393216
    s_add_u32 s99, s98, s85
    s_add_u32 s82, s99, 4294774784
    s_add_u32 m0, s83, 61440
    s_nop 0
    buffer_load_dwordx4 v3, s[40:43], s82 offen lds
    s_add_u32 s96, s84, 8
    s_and_b32 s97, s96, 15
    s_mul_i32 s98, s97, 393216
    s_add_u32 s99, s98, s85
    s_add_u32 s82, s99, 4096
    s_add_u32 m0, s83, 65536
    s_nop 0
    buffer_load_dwordx4 v3, s[40:43], s82 offen lds
    s_waitcnt vmcnt(18)
    v_lshlrev_b32 v36, 16, v36
    v_mul_f32 v52, s7, v36
    v_exp_f32 v52, -v52
    s_nop 0
    v_add_f32 v52, 1.0, v52
    v_rcp_f32 v52, v52
    s_nop 0
    v_mul_f32 v36, v36, v52
    v_cvt_pk_bf16_f32 v36, 0, v36
    v_lshlrev_b32 v37, 16, v37
    v_mul_f32 v53, s7, v37
    v_exp_f32 v53, -v53
    s_nop 0
    v_add_f32 v53, 1.0, v53
    v_rcp_f32 v53, v53
    s_nop 0
    v_mul_f32 v37, v37, v53
    v_cvt_pk_bf16_f32 v37, 0, v37
    v_lshlrev_b32 v38, 16, v38
    v_mul_f32 v52, s7, v38
    v_exp_f32 v52, -v52
    s_nop 0
    v_add_f32 v52, 1.0, v52
    v_rcp_f32 v52, v52
    s_nop 0
    v_mul_f32 v38, v38, v52
    v_cvt_pk_bf16_f32 v38, 0, v38
    v_lshlrev_b32 v39, 16, v39
    v_mul_f32 v53, s7, v39
    v_exp_f32 v53, -v53
    s_nop 0
    v_add_f32 v53, 1.0, v53
    v_rcp_f32 v53, v53
    s_nop 0
    v_mul_f32 v39, v39, v53
    v_cvt_pk_bf16_f32 v39, 0, v39
    v_lshlrev_b32 v40, 16, v40
    v_mul_f32 v52, s7, v40
    v_exp_f32 v52, -v52
    s_nop 0
    v_add_f32 v52, 1.0, v52
    v_rcp_f32 v52, v52
    s_nop 0
    v_mul_f32 v40, v40, v52
    v_cvt_pk_bf16_f32 v40, 0, v40
    v_lshlrev_b32 v41, 16, v41
    v_mul_f32 v53, s7, v41
    v_exp_f32 v53, -v53
    s_nop 0
    v_add_f32 v53, 1.0, v53
    v_rcp_f32 v53, v53
    s_nop 0
    v_mul_f32 v41, v41, v53
    v_cvt_pk_bf16_f32 v41, 0, v41
    v_lshlrev_b32 v42, 16, v42
    v_mul_f32 v52, s7, v42
    v_exp_f32 v52, -v52
    s_nop 0
    v_add_f32 v52, 1.0, v52
    v_rcp_f32 v52, v52
    s_nop 0
    v_mul_f32 v42, v42, v52
    v_cvt_pk_bf16_f32 v42, 0, v42
    v_lshlrev_b32 v43, 16, v43
    v_mul_f32 v53, s7, v43
    v_exp_f32 v53, -v53
    s_nop 0
    v_add_f32 v53, 1.0, v53
    v_rcp_f32 v53, v53
    s_nop 0
    v_mul_f32 v43, v43, v53
    v_cvt_pk_bf16_f32 v43, 0, v43
    s_waitcnt lgkmcnt(0)
    s_load_dword s24, s[32:33], s92 offset:1024 glc
    s_load_dword s25, s[32:33], s92 offset:768 glc
    s_load_dword s26, s[32:33], s92 offset:1536 glc
    s_load_dword s27, s[32:33], s92 offset:1280 glc
    s_barrier
    s_add_u32 s96, s84, 9
    s_and_b32 s97, s96, 15
    s_mul_i32 s98, s97, 393216
    s_add_u32 s99, s98, s85
    s_add_u32 s82, s99, 4294772736
    s_add_u32 m0, s83, 20480
    s_nop 0
    buffer_load_dwordx4 v3, s[40:43], s82 offen lds
    s_add_u32 s96, s84, 9
    s_and_b32 s97, s96, 15
    s_mul_i32 s98, s97, 393216
    s_add_u32 s99, s98, s85
    s_add_u32 s82, s99, 2048
    s_add_u32 m0, s83, 24576
    s_nop 0
    buffer_load_dwordx4 v3, s[40:43], s82 offen lds
L_PAD5:
    s_cbranch_execz L_RET5
    s_add_u32 s96, s84, 9
    s_and_b32 s97, s96, 15
    s_mul_i32 s98, s97, 393216
    s_add_u32 s99, s98, s85
    s_add_u32 s82, s99, 4294770688
    s_add_u32 m0, s83, 118784
    s_nop 0
    buffer_load_dwordx4 v3, s[40:43], s82 offen lds
    s_add_u32 s96, s84, 9
    s_and_b32 s97, s96, 15
    s_mul_i32 s98, s97, 393216
    s_add_u32 s82, s98, s85
    s_add_u32 m0, s83, 122880
    s_nop 0
    buffer_load_dwordx4 v3, s[40:43], s82 offen lds
    s_add_u32 s96, s84, 9
    s_and_b32 s97, s96, 15
    s_mul_i32 s98, s97, 393216
    s_add_u32 s99, s98, s85
    s_add_u32 s82, s99, 4294774784
    s_add_u32 m0, s83, 69632
    s_nop 0
    buffer_load_dwordx4 v3, s[40:43], s82 offen lds
    s_add_u32 s96, s84, 9
    s_and_b32 s97, s96, 15
    s_mul_i32 s98, s97, 393216
    s_add_u32 s99, s98, s85
    s_add_u32 s82, s99, 4096
    s_add_u32 m0, s83, 73728
    s_nop 0
    buffer_load_dwordx4 v3, s[40:43], s82 offen lds
    s_waitcnt vmcnt(22)
    s_waitcnt vmcnt(20)
    s_waitcnt vmcnt(18)
    s_barrier
    s_add_u32 s96, s84, 10
    s_and_b32 s97, s96, 15
    s_mul_i32 s98, s97, 393216
    s_add_u32 s99, s98, s85
    s_add_u32 s82, s99, 4294772736
    s_add_u32 m0, s83, 28672
    s_nop 0
    buffer_load_dwordx4 v3, s[40:43], s82 offen lds
    s_add_u32 s96, s84, 10
    s_and_b32 s97, s96, 15
    s_mul_i32 s98, s97, 393216
    s_add_u32 s99, s98, s85
    s_add_u32 s82, s99, 2048
    s_add_u32 m0, s83, 32768
    s_nop 0
    buffer_load_dwordx4 v3, s[40:43], s82 offen lds
    s_add_u32 s96, s84, 10
    s_and_b32 s97, s96, 15
    s_mul_i32 s98, s97, 393216
    s_add_u32 s99, s98, s85
    s_add_u32 s82, s99, 4294774784
    s_add_u32 m0, s83, 77824
    s_nop 0
    buffer_load_dwordx4 v3, s[40:43], s82 offen lds
    s_add_u32 s96, s84, 10
    s_and_b32 s97, s96, 15
    s_mul_i32 s98, s97, 393216
    s_add_u32 s99, s98, s85
    s_add_u32 s82, s99, 4096
    s_add_u32 m0, s83, 81920
    s_nop 0
    buffer_load_dwordx4 v3, s[40:43], s82 offen lds
    s_waitcnt lgkmcnt(0)
    s_load_dword s24, s[32:33], s92 offset:2560 glc
    s_load_dword s25, s[32:33], s92 offset:2304 glc
    s_load_dword s26, s[32:33], s92 offset:3072 glc
    s_load_dword s27, s[32:33], s92 offset:2816 glc
    s_waitcnt vmcnt(20)
    s_waitcnt vmcnt(18)
    s_waitcnt vmcnt(16)
    s_barrier
    s_add_u32 s96, s84, 11
    s_and_b32 s97, s96, 15
    s_mul_i32 s98, s97, 393216
    s_add_u32 s99, s98, s85
    s_add_u32 s82, s99, 4294772736
    s_add_u32 m0, s83, 36864
    s_nop 0
    buffer_load_dwordx4 v3, s[40:43], s82 offen lds
    s_add_u32 s96, s84, 11
    s_and_b32 s97, s96, 15
    s_mul_i32 s98, s97, 393216
    s_add_u32 s99, s98, s85
    s_add_u32 s82, s99, 2048
    s_add_u32 m0, s83, 40960
    s_nop 0
    buffer_load_dwordx4 v3, s[40:43], s82 offen lds
    s_add_u32 s96, s84, 11
    s_and_b32 s97, s96, 15
    s_mul_i32 s98, s97, 393216
    s_add_u32 s99, s98, s85
    s_add_u32 s82, s99, 4294774784
    s_add_u32 m0, s83, 86016
    s_nop 0
    buffer_load_dwordx4 v3, s[40:43], s82 offen lds
    s_add_u32 s96, s84, 11
    s_and_b32 s97, s96, 15
    s_mul_i32 s98, s97, 393216
    s_add_u32 s99, s98, s85
    s_add_u32 s82, s99, 4096
    s_add_u32 m0, s83, 90112
    s_nop 0
    buffer_load_dwordx4 v3, s[40:43], s82 offen lds
    s_waitcnt vmcnt(18)
    s_waitcnt vmcnt(16)
    s_waitcnt vmcnt(14)
    s_barrier
    s_add_u32 s96, s84, 12
    s_and_b32 s97, s96, 15
    s_mul_i32 s98, s97, 393216
    s_add_u32 s99, s98, s85
    s_add_u32 s82, s99, 4294772736
    s_add_u32 m0, s83, 4294963200
    s_nop 0
    buffer_load_dwordx4 v3, s[40:43], s82 offen lds
    s_add_u32 s96, s84, 12
    s_and_b32 s97, s96, 15
    s_mul_i32 s98, s97, 393216
    s_add_u32 s99, s98, s85
    s_add_u32 s82, s99, 2048
    s_mov_b32 m0, s83
    s_nop 0
    buffer_load_dwordx4 v3, s[40:43], s82 offen lds
    s_add_u32 s96, s84, 12
    s_and_b32 s97, s96, 15
    s_mul_i32 s98, s97, 393216
    s_add_u32 s99, s98, s85
    s_add_u32 s82, s99, 4294774784
    s_add_u32 m0, s83, 45056
    s_nop 0
    buffer_load_dwordx4 v3, s[40:43], s82 offen lds
    s_add_u32 s96, s84, 12
    s_and_b32 s97, s96, 15
    s_mul_i32 s98, s97, 393216
    s_add_u32 s99, s98, s85
    s_add_u32 s82, s99, 4096
    s_add_u32 m0, s83, 49152
    s_nop 0
    buffer_load_dwordx4 v3, s[40:43], s82 offen lds
    s_waitcnt vmcnt(16)
    s_barrier
    s_add_u32 s96, s84, 13
    s_and_b32 s97, s96, 15
    s_mul_i32 s98, s97, 393216
    s_add_u32 s99, s98, s85
    s_add_u32 s82, s99, 4294772736
    s_add_u32 m0, s83, 4096
    s_nop 0
    buffer_load_dwordx4 v3, s[40:43], s82 offen lds
    s_add_u32 s96, s84, 13
    s_and_b32 s97, s96, 15
    s_mul_i32 s98, s97, 393216
    s_add_u32 s99, s98, s85
    s_add_u32 s82, s99, 2048
    s_add_u32 m0, s83, 8192
    s_nop 0
    buffer_load_dwordx4 v3, s[40:43], s82 offen lds
    s_add_u32 s96, s84, 13
    s_and_b32 s97, s96, 15
    s_mul_i32 s98, s97, 393216
    s_add_u32 s99, s98, s85
    s_add_u32 s82, s99, 4294774784
    s_add_u32 m0, s83, 53248
    s_nop 0
    buffer_load_dwordx4 v3, s[40:43], s82 offen lds
    s_add_u32 s96, s84, 13
    s_and_b32 s97, s96, 15
    s_mul_i32 s98, s97, 393216
    s_add_u32 s99, s98, s85
    s_add_u32 s82, s99, 4096
    s_add_u32 m0, s83, 57344
    s_nop 0
    buffer_load_dwordx4 v3, s[40:43], s82 offen lds
    s_lshl_b32 s96, s74, 13
    s_sub_u32 s97, s3, 4
    s_lshl_b32 s98, s97, 8
    s_add_u32 s99, s96, s98
    s_add_u32 s13, s99, 20971520
    s_waitcnt lgkmcnt(0)
    s_load_dword s24, s[32:33], s13 offset:1276 glc
    s_load_dword s25, s[32:33], s13 offset:3324 glc
    s_load_dword s26, s[32:33], s13 offset:5372 glc
    s_load_dword s27, s[32:33], s13 offset:7420 glc
    s_waitcnt vmcnt(18)
    s_waitcnt vmcnt(16)
    s_barrier
    s_add_u32 s96, s84, 14
    s_and_b32 s97, s96, 15
    s_mul_i32 s98, s97, 393216
    s_add_u32 s99, s98, s85
    s_add_u32 s82, s99, 4294772736
    s_add_u32 m0, s83, 12288
    s_nop 0
    buffer_load_dwordx4 v3, s[40:43], s82 offen lds
    s_add_u32 s96, s84, 14
    s_and_b32 s97, s96, 15
    s_mul_i32 s98, s97, 393216
    s_add_u32 s99, s98, s85
    s_add_u32 s82, s99, 2048
    s_add_u32 m0, s83, 16384
    s_nop 0
    buffer_load_dwordx4 v3, s[40:43], s82 offen lds
    s_add_u32 s96, s84, 10
    s_and_b32 s97, s96, 15
    s_mul_i32 s98, s97, 393216
    s_add_u32 s99, s98, s85
    s_add_u32 s82, s99, 4294770688
    s_add_u32 m0, s83, 126976
    s_nop 0
    buffer_load_dwordx4 v3, s[40:43], s82 offen lds
    s_add_u32 s96, s84, 10
    s_and_b32 s97, s96, 15
    s_mul_i32 s98, s97, 393216
    s_add_u32 s82, s98, s85
    s_add_u32 m0, s83, 131072
    s_nop 0
    buffer_load_dwordx4 v3, s[40:43], s82 offen lds
    s_waitcnt vmcnt(18)
    s_waitcnt vmcnt(14)
    s_barrier
    s_add_u32 s96, s84, 15
    s_and_b32 s97, s96, 15
    s_mul_i32 s98, s97, 393216
    s_add_u32 s99, s98, s85
    s_add_u32 s82, s99, 4294772736
    s_add_u32 m0, s83, 20480
    s_nop 0
    buffer_load_dwordx4 v3, s[40:43], s82 offen lds
    s_add_u32 s96, s84, 15
    s_and_b32 s97, s96, 15
    s_mul_i32 s98, s97, 393216
    s_add_u32 s99, s98, s85
    s_add_u32 s82, s99, 2048
    s_add_u32 m0, s83, 24576
    s_nop 0
    buffer_load_dwordx4 v3, s[40:43], s82 offen lds
    s_add_u32 s96, s84, 11
    s_and_b32 s97, s96, 15
    s_mul_i32 s98, s97, 393216
    s_add_u32 s99, s98, s85
    s_add_u32 s82, s99, 4294770688
    s_add_u32 m0, s83, 135168
    s_nop 0
    buffer_load_dwordx4 v3, s[40:43], s82 offen lds
    s_add_u32 s96, s84, 11
    s_and_b32 s97, s96, 15
    s_mul_i32 s98, s97, 393216
    s_add_u32 s82, s98, s85
    s_add_u32 m0, s83, 139264
    s_nop 0
    buffer_load_dwordx4 v3, s[40:43], s82 offen lds
    s_waitcnt vmcnt(14)
    s_waitcnt vmcnt(10)
    s_waitcnt vmcnt(6)
    s_barrier
    s_add_u32 s96, s84, 14
    s_and_b32 s97, s96, 15
    s_mul_i32 s98, s97, 393216
    s_add_u32 s99, s98, s85
    s_add_u32 s82, s99, 4294774784
    s_add_u32 m0, s83, 61440
    s_nop 0
    buffer_load_dwordx4 v3, s[40:43], s82 offen lds
    s_add_u32 s96, s84, 14
    s_and_b32 s97, s96, 15
    s_mul_i32 s98, s97, 393216
    s_add_u32 s99, s98, s85
    s_add_u32 s82, s99, 4096
    s_add_u32 m0, s83, 65536
    s_nop 0
    buffer_load_dwordx4 v3, s[40:43], s82 offen lds
    s_add_u32 s96, s84, 15
    s_and_b32 s97, s96, 15
    s_mul_i32 s98, s97, 393216
    s_add_u32 s99, s98, s85
    s_add_u32 s82, s99, 4294774784
    s_add_u32 m0, s83, 69632
    s_nop 0
    buffer_load_dwordx4 v3, s[40:43], s82 offen lds
    s_add_u32 s96, s84, 15
    s_and_b32 s97, s96, 15
    s_mul_i32 s98, s97, 393216
    s_add_u32 s99, s98, s85
    s_add_u32 s82, s99, 4096
    s_add_u32 m0, s83, 73728
    s_nop 0
    buffer_load_dwordx4 v3, s[40:43], s82 offen lds
    s_add_u32 s96, s84, 12
    s_and_b32 s97, s96, 15
    s_mul_i32 s98, s97, 393216
    s_add_u32 s99, s98, s85
    s_add_u32 s82, s99, 4294770688
    s_add_u32 m0, s83, 94208
    s_nop 0
    buffer_load_dwordx4 v3, s[40:43], s82 offen lds
    s_add_u32 s96, s84, 12
    s_and_b32 s97, s96, 15
    s_mul_i32 s98, s97, 393216
    s_add_u32 s82, s98, s85
    s_add_u32 m0, s83, 98304
    s_nop 0
    buffer_load_dwordx4 v3, s[40:43], s82 offen lds
    s_mov_b32 s82, s19
    buffer_load_dwordx4 v[88:91], v248, s[48:51], s82 offen nt
    s_add_u32 s82, s19, 98304
    buffer_load_dwordx4 v[92:95], v248, s[48:51], s82 offen nt
    s_add_u32 s82, s19, 196608
    buffer_load_dwordx4 v[96:99], v248, s[48:51], s82 offen nt
    s_add_u32 s82, s19, 294912
    buffer_load_dwordx4 v[100:103], v248, s[48:51], s82 offen nt
    s_waitcnt vmcnt(12)
    s_barrier
    s_add_u32 s96, s84, 13
    s_and_b32 s97, s96, 15
    s_mul_i32 s98, s97, 393216
    s_add_u32 s99, s98, s85
    s_add_u32 s82, s99, 4294770688
    s_add_u32 m0, s83, 102400
    s_nop 0
    buffer_load_dwordx4 v3, s[40:43], s82 offen lds
    s_add_u32 s96, s84, 13
    s_and_b32 s97, s96, 15
    s_mul_i32 s98, s97, 393216
    s_add_u32 s82, s98, s85
    s_add_u32 m0, s83, 106496
    s_nop 0
    buffer_load_dwordx4 v3, s[40:43], s82 offen lds
    s_add_u32 s96, s84, 14
    s_and_b32 s97, s96, 15
    s_mul_i32 s98, s97, 393216
    s_add_u32 s99, s98, s85
    s_add_u32 s82, s99, 4294770688
    s_add_u32 m0, s83, 110592
    s_nop 0
    buffer_load_dwordx4 v3, s[40:43], s82 offen lds
    s_add_u32 s96, s84, 14
    s_and_b32 s97, s96, 15
    s_mul_i32 s98, s97, 393216
    s_add_u32 s82, s98, s85
    s_add_u32 m0, s83, 114688
    s_nop 0
    buffer_load_dwordx4 v3, s[40:43], s82 offen lds
    s_add_u32 s96, s84, 15
    s_and_b32 s97, s96, 15
    s_mul_i32 s98, s97, 393216
    s_add_u32 s99, s98, s85
    s_add_u32 s82, s99, 4294770688
    s_add_u32 m0, s83, 118784
    s_nop 0
    buffer_load_dwordx4 v3, s[40:43], s82 offen lds
    s_add_u32 s96, s84, 15
    s_and_b32 s97, s96, 15
    s_mul_i32 s98, s97, 393216
    s_add_u32 s82, s98, s85
    s_add_u32 m0, s83, 122880
    s_nop 0
    buffer_load_dwordx4 v3, s[40:43], s82 offen lds
    v_and_b32 v85, 1, v1
    v_lshlrev_b32 v85, 3, v85
    v_bfe_u32 v84, v1, 2, 2
    v_lshl_add_u32 v85, v84, 4, v85
    v_bfe_u32 v84, v1, 4, 1
    v_lshl_add_u32 v85, v84, 6, v85
    v_bfe_u32 v84, v1, 1, 1
    v_lshl_add_u32 v85, v84, 7, v85
    v_lshrrev_b32 v84, 5, v1
    v_lshl_add_u32 v85, v84, 8, v85
    s_lshl_b32 s13, s3, 12
    v_add_u32 v84, s13, v85
    s_lshl_b32 s96, s76, 13
    s_add_u32 s13, s96, 32768
    v_add_u32 v85, s13, v85
    v_mov_b32 v80, 0x3f803f80
    v_mov_b32 v81, 0x3f803f80
    v_mov_b32 v82, 0x3f803f80
    v_mov_b32 v83, 0x3f803f80
    s_lshl3_add_u32 s96, s11, s3
    s_lshl_b32 s97, s96, 5
    s_add_u32 s98, s97, s10
    s_lshl_b32 s99, s98, 10
    s_add_u32 s13, s99, 25165824
    s_add_u32 s15, s13, 16384
    s_lshl3_add_u32 s96, s11, s3
    s_lshl_b32 s97, s96, 10
    s_add_u32 s16, s97, 21495808
    s_lshl_b32 s96, s10, 6
    s_add_u32 s14, s96, s16
    s_waitcnt lgkmcnt(0)
    s_barrier
    s_setprio 3
    ds_read_b128 v[152:155], v0
    ds_read_b128 v[156:159], v0 offset:1024
    v_subrev_u32 v0, 118784, v0
    s_waitcnt lgkmcnt(1)
    v_mfma_f32_32x32x16_bf16 v[184:199], v[168:171], v[152:155], 0
    s_waitcnt lgkmcnt(0)
    v_mfma_f32_32x32x16_bf16 v[184:199], v[172:175], v[156:159], v[184:199]
    s_setprio 0
    s_nop 10
    v_cvt_pk_bf16_f32 v184, 0, v184
    v_cvt_pk_bf16_f32 v185, 0, v185
    v_cvt_pk_bf16_f32 v186, 0, v186
    s_add_u32 s82, s19, 393216
    buffer_load_dwordx4 v[104:107], v248, s[48:51], s82 offen nt
    v_cvt_pk_bf16_f32 v187, 0, v187
    v_cvt_pk_bf16_f32 v188, 0, v188
    v_cvt_pk_bf16_f32 v189, 0, v189
    v_cvt_pk_bf16_f32 v190, 0, v190
    v_cvt_pk_bf16_f32 v191, 0, v191
    v_cvt_pk_bf16_f32 v192, 0, v192
    v_cvt_pk_bf16_f32 v193, 0, v193
    v_cvt_pk_bf16_f32 v194, 0, v194
    v_cvt_pk_bf16_f32 v195, 0, v195
    v_cvt_pk_bf16_f32 v196, 0, v196
    s_add_u32 s82, s19, 491520
    buffer_load_dwordx4 v[108:111], v248, s[48:51], s82 offen nt
    v_cvt_pk_bf16_f32 v197, 0, v197
    v_cvt_pk_bf16_f32 v198, 0, v198
    v_cvt_pk_bf16_f32 v199, 0, v199
    v_max3_f32 v4, v184, v185, v186
    v_min3_f32 v5, v184, v185, v186
    v_max3_f32 v4, v4, v187, v188
    v_min3_f32 v5, v5, v187, v188
    v_max3_f32 v4, v4, v189, v190
    v_min3_f32 v5, v5, v189, v190
    v_max3_f32 v4, v4, v191, v192
    s_add_u32 s82, s19, 589824
    buffer_load_dwordx4 v[112:115], v248, s[48:51], s82 offen nt
    v_min3_f32 v5, v5, v191, v192
    v_max3_f32 v4, v4, v193, v194
    v_min3_f32 v5, v5, v193, v194
    v_max3_f32 v4, v4, v195, v196
    v_min3_f32 v5, v5, v195, v196
    v_max3_f32 v4, v4, v197, v198
    v_min3_f32 v5, v5, v197, v198
    v_max_f32 v6, v4, v199
    v_min_f32 v7, v5, v199
    v_max_f32 v4, v4, v199
    s_add_u32 s82, s19, 688128
    buffer_load_dwordx4 v[116:119], v248, s[48:51], s82 offen nt
    v_min_f32 v5, v5, v199
    v_permlane32_swap_b32 v4, v6
    s_nop 0
    v_permlane32_swap_b32 v5, v7
    v_max_f32 v4, v4, v6
    v_min_f32 v5, v5, v7
    v_mul_f32_e64 v4, v4, s7
    v_mul_f32_e64 v5, v5, s7
    v_fma_f32 v216, v184, s7, -v4
    v_fma_f32 v217, v185, s7, -v4
    v_fma_f32 v184, -v184, s7, v5
    v_fma_f32 v185, -v185, s7, v5
    v_fma_f32 v218, v186, s7, -v4
    v_fma_f32 v219, v187, s7, -v4
    v_fma_f32 v186, -v186, s7, v5
    v_fma_f32 v187, -v187, s7, v5
    s_waitcnt vmcnt(18)
    s_waitcnt vmcnt(16)
    s_barrier
    s_setprio 3
    ds_read_b128 v[152:155], v0
    ds_read_b128 v[156:159], v0 offset:1024
    s_waitcnt lgkmcnt(1)
    v_mfma_f32_32x32x16_bf16 v[200:215], v[176:179], v[152:155], 0
    s_waitcnt lgkmcnt(0)
    v_mfma_f32_32x32x16_bf16 v[200:215], v[180:183], v[156:159], v[200:215]
    s_setprio 0
    v_fma_f32 v220, v188, s7, -v4
    v_fma_f32 v221, v189, s7, -v4
    v_fma_f32 v188, -v188, s7, v5
    v_fma_f32 v189, -v189, s7, v5
    v_fma_f32 v222, v190, s7, -v4
    s_mov_b32 s82, s80
    buffer_load_dwordx4 v[56:59], v27, s[52:55], s82 offen nt
    v_fma_f32 v223, v191, s7, -v4
    v_fma_f32 v190, -v190, s7, v5
    v_fma_f32 v191, -v191, s7, v5
    v_fma_f32 v224, v192, s7, -v4
    v_fma_f32 v225, v193, s7, -v4
    s_setprio 3
    v_fma_f32 v192, -v192, s7, v5
    v_fma_f32 v193, -v193, s7, v5
    v_fma_f32 v226, v194, s7, -v4
    v_fma_f32 v227, v195, s7, -v4
    v_fma_f32 v194, -v194, s7, v5
    v_fma_f32 v195, -v195, s7, v5
    v_fma_f32 v228, v196, s7, -v4
    v_fma_f32 v229, v197, s7, -v4
    v_fma_f32 v196, -v196, s7, v5
    v_fma_f32 v197, -v197, s7, v5
    v_fma_f32 v230, v198, s7, -v4
    v_fma_f32 v231, v199, s7, -v4
    v_fma_f32 v198, -v198, s7, v5
    v_fma_f32 v199, -v199, s7, v5
    v_exp_f32 v216, v216
    s_add_u32 s82, s80, 4294049792
    buffer_load_dwordx4 v[60:63], v27, s[52:55], s82 offen nt
    v_exp_f32 v184, v184
    v_exp_f32 v217, v217
    v_exp_f32 v185, v185
    v_exp_f32 v218, v218
    v_exp_f32 v186, v186
    v_exp_f32 v219, v219
    v_exp_f32 v187, v187
    v_exp_f32 v220, v220
    v_exp_f32 v188, v188
    v_exp_f32 v221, v221
    v_exp_f32 v189, v189
    v_exp_f32 v222, v222
    v_exp_f32 v190, v190
    v_exp_f32 v223, v223
    v_exp_f32 v191, v191
    v_exp_f32 v224, v224
    v_exp_f32 v192, v192
    v_exp_f32 v225, v225
    v_exp_f32 v193, v193
    v_exp_f32 v226, v226
    s_add_u32 s82, s80, 57344
    buffer_load_dwordx4 v[64:67], v27, s[52:55], s82 offen nt
    v_exp_f32 v194, v194
    v_exp_f32 v227, v227
    v_exp_f32 v195, v195
    v_exp_f32 v228, v228
    v_exp_f32 v196, v196
    v_exp_f32 v229, v229
    v_exp_f32 v197, v197
    v_exp_f32 v230, v230
    v_exp_f32 v198, v198
    v_exp_f32 v231, v231
    v_exp_f32 v199, v199
    v_add_f32 v8, v216, v218
    v_add_f32 v9, v217, v219
    v_add_f32 v10, v184, v186
    v_add_f32 v11, v185, v187
    v_add_f32 v8, v8, v220
    v_add_f32 v9, v9, v221
    v_add_f32 v10, v10, v188
    v_add_f32 v11, v11, v189
    v_add_f32 v8, v8, v222
    s_add_u32 s82, s80, 4294107136
    buffer_load_dwordx4 v[68:71], v27, s[52:55], s82 offen nt
    v_add_f32 v9, v9, v223
    v_add_f32 v10, v10, v190
    v_add_f32 v11, v11, v191
    v_add_f32 v8, v8, v224
    v_add_f32 v9, v9, v225
    v_add_f32 v10, v10, v192
    v_add_f32 v11, v11, v193
    v_add_f32 v8, v8, v226
    v_add_f32 v9, v9, v227
    v_add_f32 v10, v10, v194
    v_add_f32 v11, v11, v195
    v_add_f32 v8, v8, v228
    v_add_f32 v9, v9, v229
    v_add_f32 v10, v10, v196
    v_add_f32 v11, v11, v197
    v_add_f32 v8, v8, v230
    v_add_f32 v9, v9, v231
    v_add_f32 v10, v10, v198
    v_add_f32 v11, v11, v199
    v_add_f32 v6, v8, v9
    v_add_f32 v7, v10, v11
    v_add_f32 v4, v8, v9
    s_setprio 0
    v_add_f32 v5, v10, v11
    v_permlane32_swap_b32 v4, v6
    s_nop 0
    v_permlane32_swap_b32 v5, v7
    v_add_f32 v4, v4, v6
    v_add_f32 v5, v5, v7
    v_rcp_f32 v4, v4
    v_rcp_f32 v5, v5
    v_mul_f32 v216, v216, v4
    v_mul_f32 v217, v217, v4
    v_mul_f32 v184, v184, v5
    v_mul_f32 v185, v185, v5
    v_mul_f32 v218, v218, v4
    v_mul_f32 v219, v219, v4
    v_mul_f32 v186, v186, v5
    v_mul_f32 v187, v187, v5
    v_mul_f32 v220, v220, v4
    v_mul_f32 v221, v221, v4
    v_mul_f32 v188, v188, v5
    v_mul_f32 v189, v189, v5
    v_mul_f32 v222, v222, v4
    v_mul_f32 v223, v223, v4
    v_mul_f32 v190, v190, v5
    v_mul_f32 v191, v191, v5
    v_mul_f32 v224, v224, v4
    v_mul_f32 v225, v225, v4
    v_mul_f32 v192, v192, v5
    v_mul_f32 v193, v193, v5
    v_mul_f32 v226, v226, v4
    v_mul_f32 v227, v227, v4
    v_mul_f32 v194, v194, v5
    v_mul_f32 v195, v195, v5
    v_mul_f32 v228, v228, v4
    v_mul_f32 v229, v229, v4
    v_mul_f32 v196, v196, v5
    v_mul_f32 v197, v197, v5
    v_mul_f32 v230, v230, v4
    v_mul_f32 v231, v231, v4
    v_mul_f32 v198, v198, v5
    v_mul_f32 v199, v199, v5
    v_cvt_pk_bf16_f32 v216, v216, v217
    v_cvt_pk_bf16_f32 v217, v218, v219
    v_cvt_pk_bf16_f32 v218, v220, v221
    v_cvt_pk_bf16_f32 v219, v222, v223
    v_cvt_pk_bf16_f32 v220, v224, v225
    v_cvt_pk_bf16_f32 v221, v226, v227
    v_cvt_pk_bf16_f32 v222, v228, v229
    v_cvt_pk_bf16_f32 v223, v230, v231
    ds_write_b128 v232, v[216:219]
    v_cvt_pk_bf16_f32 v224, v184, v185
    v_cvt_pk_bf16_f32 v225, v186, v187
    v_cvt_pk_bf16_f32 v226, v188, v189
    v_cvt_pk_bf16_f32 v227, v190, v191
    ds_write_b128 v232, v[220:223] offset:4096
    s_waitcnt vmcnt(18)
    s_waitcnt vmcnt(12)
    s_waitcnt vmcnt(10)
    s_waitcnt vmcnt(8)
    s_barrier
    ds_write_b128 v232, v[224:227] offset:8192
    v_cvt_pk_bf16_f32 v228, v192, v193
    v_cvt_pk_bf16_f32 v229, v194, v195
    v_cvt_pk_bf16_f32 v230, v196, v197
    v_cvt_pk_bf16_f32 v231, v198, v199
    s_xor_b32 s96, s95, 786432
    s_add_u32 s97, s96, s90
    s_sub_u32 s82, s97, 65536
    s_add_u32 m0, s83, 45056
    s_nop 0
    buffer_load_dwordx4 v26, s[44:47], s82 offen lds
    ds_write_b128 v232, v[228:231] offset:12288
    v_cvt_pk_bf16_f32 v200, 0, v200
    v_cvt_pk_bf16_f32 v201, 0, v201
    v_cvt_pk_bf16_f32 v202, 0, v202
    v_cvt_pk_bf16_f32 v203, 0, v203
    v_cvt_pk_bf16_f32 v204, 0, v204
    v_cvt_pk_bf16_f32 v205, 0, v205
    v_cvt_pk_bf16_f32 v206, 0, v206
    v_cvt_pk_bf16_f32 v207, 0, v207
    v_cvt_pk_bf16_f32 v208, 0, v208
    v_cvt_pk_bf16_f32 v209, 0, v209
    v_cvt_pk_bf16_f32 v210, 0, v210
    v_cvt_pk_bf16_f32 v211, 0, v211
    s_xor_b32 s96, s95, 786432
    s_add_u32 s82, s96, s90
    s_add_u32 m0, s83, 49152
    s_nop 0
    buffer_load_dwordx4 v26, s[44:47], s82 offen lds
    v_cvt_pk_bf16_f32 v212, 0, v212
    v_cvt_pk_bf16_f32 v213, 0, v213
    v_cvt_pk_bf16_f32 v214, 0, v214
    v_cvt_pk_bf16_f32 v215, 0, v215
    v_max3_f32 v4, v200, v201, v202
    v_min3_f32 v5, v200, v201, v202
    v_max3_f32 v4, v4, v203, v204
    v_min3_f32 v5, v5, v203, v204
    v_max3_f32 v4, v4, v205, v206
    v_min3_f32 v5, v5, v205, v206
    v_max3_f32 v4, v4, v207, v208
    v_min3_f32 v5, v5, v207, v208
    v_max3_f32 v4, v4, v209, v210
    v_min3_f32 v5, v5, v209, v210
    s_xor_b32 s96, s95, 917504
    s_add_u32 s97, s96, s90
    s_sub_u32 s82, s97, 65536
    s_add_u32 m0, s83, 53248
    s_nop 0
    buffer_load_dwordx4 v26, s[44:47], s82 offen lds
    v_max3_f32 v4, v4, v211, v212
    v_min3_f32 v5, v5, v211, v212
    v_max3_f32 v4, v4, v213, v214
    v_min3_f32 v5, v5, v213, v214
    v_max_f32 v6, v4, v215
    v_min_f32 v7, v5, v215
    v_max_f32 v4, v4, v215
    s_waitcnt lgkmcnt(0)
    v_min_f32 v5, v5, v215
    v_permlane32_swap_b32 v4, v6
    s_nop 0
    v_permlane32_swap_b32 v5, v7
    v_max_f32 v4, v4, v6
    v_min_f32 v5, v5, v7
L_PAD6:
    s_cbranch_execz L_RET6
    v_mul_f32_e64 v4, v4, s7
    s_xor_b32 s96, s95, 917504
    s_add_u32 s82, s96, s90
    s_add_u32 m0, s83, 57344
    s_nop 0
    buffer_load_dwordx4 v26, s[44:47], s82 offen lds
    v_mul_f32_e64 v5, v5, s7
    v_fma_f32 v216, v200, s7, -v4
    v_fma_f32 v217, v201, s7, -v4
    v_fma_f32 v200, -v200, s7, v5
    v_fma_f32 v201, -v201, s7, v5
    v_fma_f32 v218, v202, s7, -v4
    v_fma_f32 v219, v203, s7, -v4
    v_fma_f32 v202, -v202, s7, v5
    v_fma_f32 v203, -v203, s7, v5
    v_fma_f32 v220, v204, s7, -v4
    v_fma_f32 v221, v205, s7, -v4
    v_fma_f32 v204, -v204, s7, v5
    v_fma_f32 v205, -v205, s7, v5
    v_fma_f32 v222, v206, s7, -v4
    s_xor_b32 s96, s95, 1048576
    s_add_u32 s97, s96, s90
    s_sub_u32 s82, s97, 65536
    s_add_u32 m0, s83, 61440
    s_nop 0
    buffer_load_dwordx4 v26, s[44:47], s82 offen lds
    v_fma_f32 v223, v207, s7, -v4
    v_fma_f32 v206, -v206, s7, v5
    v_fma_f32 v207, -v207, s7, v5
    v_fma_f32 v224, v208, s7, -v4
    v_fma_f32 v225, v209, s7, -v4
    v_fma_f32 v208, -v208, s7, v5
    v_fma_f32 v209, -v209, s7, v5
    v_fma_f32 v226, v210, s7, -v4
    v_fma_f32 v227, v211, s7, -v4
    v_fma_f32 v210, -v210, s7, v5
    v_fma_f32 v211, -v211, s7, v5
    v_fma_f32 v228, v212, s7, -v4
    v_fma_f32 v229, v213, s7, -v4
    v_fma_f32 v212, -v212, s7, v5
    s_xor_b32 s96, s95, 1048576
    s_add_u32 s82, s96, s90
    s_add_u32 m0, s83, 65536
    s_nop 0
    buffer_load_dwordx4 v26, s[44:47], s82 offen lds
    v_fma_f32 v213, -v213, s7, v5
    v_fma_f32 v230, v214, s7, -v4
    v_fma_f32 v231, v215, s7, -v4
    v_fma_f32 v214, -v214, s7, v5
    v_fma_f32 v215, -v215, s7, v5
    v_exp_f32 v216, v216
    v_exp_f32 v200, v200
    v_exp_f32 v217, v217
    v_exp_f32 v201, v201
    v_exp_f32 v218, v218
    v_exp_f32 v202, v202
    v_exp_f32 v219, v219
    v_exp_f32 v203, v203
    v_exp_f32 v220, v220
    s_xor_b32 s96, s95, 1179648
    s_add_u32 s97, s96, s90
    s_sub_u32 s82, s97, 65536
    s_add_u32 m0, s83, 69632
    s_nop 0
    buffer_load_dwordx4 v26, s[44:47], s82 offen lds
    v_exp_f32 v204, v204
    v_exp_f32 v221, v221
    v_exp_f32 v205, v205
    v_exp_f32 v222, v222
    v_exp_f32 v206, v206
    v_exp_f32 v223, v223
    v_exp_f32 v207, v207
    v_exp_f32 v224, v224
    v_exp_f32 v208, v208
    v_exp_f32 v225, v225
    v_exp_f32 v209, v209
    v_exp_f32 v226, v226
    v_exp_f32 v210, v210
    v_exp_f32 v227, v227
    s_xor_b32 s96, s95, 1179648
    s_add_u32 s82, s96, s90
    s_add_u32 m0, s83, 73728
    s_nop 0
    buffer_load_dwordx4 v26, s[44:47], s82 offen lds
    v_exp_f32 v211, v211
    v_exp_f32 v228, v228
    v_exp_f32 v212, v212
    v_exp_f32 v229, v229
    v_exp_f32 v213, v213
    v_exp_f32 v230, v230
    v_exp_f32 v214, v214
    v_exp_f32 v231, v231
    v_exp_f32 v215, v215
    v_add_f32 v8, v216, v218
    v_add_f32 v9, v217, v219
    v_add_f32 v10, v200, v202
    v_add_f32 v11, v201, v203
    v_add_f32 v8, v8, v220
    v_add_f32 v9, v9, v221
    v_add_f32 v10, v10, v204
    v_add_f32 v11, v11, v205
    v_add_f32 v8, v8, v222
    v_add_f32 v9, v9, v223
    v_add_f32 v10, v10, v206
    v_add_f32 v11, v11, v207
    v_add_f32 v8, v8, v224
    v_add_f32 v9, v9, v225
    v_add_f32 v10, v10, v208
    v_add_f32 v11, v11, v209
    v_add_f32 v8, v8, v226
    v_add_f32 v9, v9, v227
    v_add_f32 v10, v10, v210
    v_add_f32 v11, v11, v211
    v_add_f32 v8, v8, v228
    v_add_f32 v9, v9, v229
    v_add_f32 v10, v10, v212
    v_add_f32 v11, v11, v213
    v_add_f32 v8, v8, v230
    v_add_f32 v9, v9, v231
    v_add_f32 v10, v10, v214
    v_add_f32 v11, v11, v215
    v_add_f32 v6, v8, v9
    v_add_f32 v7, v10, v11
    v_add_f32 v4, v8, v9
    v_add_f32 v5, v10, v11
    s_nop 0
    v_permlane32_swap_b32 v4, v6
    v_permlane32_swap_b32 v5, v7
    v_add_f32 v4, v4, v6
    v_add_f32 v5, v5, v7
    v_rcp_f32 v4, v4
    v_rcp_f32 v5, v5
    v_mul_f32 v216, v216, v4
    v_mul_f32 v217, v217, v4
    v_mul_f32 v200, v200, v5
    v_mul_f32 v201, v201, v5
    v_mul_f32 v218, v218, v4
    v_mul_f32 v219, v219, v4
    v_mul_f32 v202, v202, v5
    v_mul_f32 v203, v203, v5
    v_mul_f32 v220, v220, v4
    v_mul_f32 v221, v221, v4
    v_mul_f32 v204, v204, v5
    v_mul_f32 v205, v205, v5
    v_mul_f32 v222, v222, v4
    v_mul_f32 v223, v223, v4
    v_mul_f32 v206, v206, v5
    v_mul_f32 v207, v207, v5
    v_mul_f32 v224, v224, v4
    v_mul_f32 v225, v225, v4
    v_mul_f32 v208, v208, v5
    v_mul_f32 v209, v209, v5
    v_mul_f32 v226, v226, v4
    v_mul_f32 v227, v227, v4
    v_mul_f32 v210, v210, v5
    v_mul_f32 v211, v211, v5
    v_mul_f32 v228, v228, v4
    v_mul_f32 v229, v229, v4
    v_mul_f32 v212, v212, v5
    v_mul_f32 v213, v213, v5
    v_mul_f32 v230, v230, v4
    v_mul_f32 v231, v231, v4
    v_mul_f32 v214, v214, v5
    v_mul_f32 v215, v215, v5
    v_cvt_pk_bf16_f32 v216, v216, v217
    v_cvt_pk_bf16_f32 v217, v218, v219
    v_cvt_pk_bf16_f32 v218, v220, v221
    v_cvt_pk_bf16_f32 v219, v222, v223
    v_cvt_pk_bf16_f32 v220, v224, v225
    v_cvt_pk_bf16_f32 v221, v226, v227
    v_cvt_pk_bf16_f32 v222, v228, v229
    v_cvt_pk_bf16_f32 v223, v230, v231
    ds_write_b128 v232, v[216:219] offset:16384
    v_cvt_pk_bf16_f32 v224, v200, v201
    v_cvt_pk_bf16_f32 v225, v202, v203
    v_cvt_pk_bf16_f32 v226, v204, v205
    v_cvt_pk_bf16_f32 v227, v206, v207
    ds_write_b128 v232, v[220:223] offset:20480
    ds_write_b128 v232, v[224:227] offset:24576
    v_cvt_pk_bf16_f32 v228, v208, v209
    v_cvt_pk_bf16_f32 v229, v210, v211
    v_cvt_pk_bf16_f32 v230, v212, v213
    v_cvt_pk_bf16_f32 v231, v214, v215
    ds_write_b128 v232, v[228:231] offset:28672
    s_lshl_b32 s96, s77, 11
    s_add_u32 s17, s96, 151552
    v_add_u32 v0, s17, v2
    s_setprio 0
L_JOIN:
    s_waitcnt lgkmcnt(0)
    s_barrier
    ds_read_b64_tr_b16 v[184:185], v84
    ds_read_b64_tr_b16 v[186:187], v84 offset:512
    ds_read_b64_tr_b16 v[200:201], v85
    ds_read_b64_tr_b16 v[202:203], v85 offset:512
    ds_read_b64_tr_b16 v[204:205], v85 offset:1024
    ds_read_b64_tr_b16 v[206:207], v85 offset:1536
    ds_read_b64_tr_b16 v[188:189], v84 offset:1024
    ds_read_b64_tr_b16 v[190:191], v84 offset:1536
    ds_read_b64_tr_b16 v[208:209], v85 offset:2048
    ds_read_b64_tr_b16 v[210:211], v85 offset:2560
    ds_read_b64_tr_b16 v[212:213], v85 offset:3072
    ds_read_b64_tr_b16 v[214:215], v85 offset:3584
    ds_read_b64_tr_b16 v[192:193], v84 offset:2048
    ds_read_b64_tr_b16 v[194:195], v84 offset:2560
    ds_read_b64_tr_b16 v[216:217], v85 offset:4096
    ds_read_b64_tr_b16 v[218:219], v85 offset:4608
    ds_read_b64_tr_b16 v[220:221], v85 offset:5120
    ds_read_b64_tr_b16 v[222:223], v85 offset:5632
    s_waitcnt lgkmcnt(12)
    v_mfma_f32_16x16x32_bf16 v[232:235], v[184:187], v[200:203], 0
    v_mfma_f32_16x16x32_bf16 v[236:239], v[184:187], v[204:207], 0
    v_mfma_f32_16x16x32_bf16 v[240:243], v[184:187], v[80:83], 0
    ds_read_b64_tr_b16 v[196:197], v84 offset:3072
    ds_read_b64_tr_b16 v[198:199], v84 offset:3584
    ds_read_b64_tr_b16 v[224:225], v85 offset:6144
    ds_read_b64_tr_b16 v[226:227], v85 offset:6656
    ds_read_b64_tr_b16 v[228:229], v85 offset:7168
    ds_read_b64_tr_b16 v[230:231], v85 offset:7680
    s_waitcnt lgkmcnt(12)
    v_mfma_f32_16x16x32_bf16 v[232:235], v[188:191], v[208:211], v[232:235]
    v_mfma_f32_16x16x32_bf16 v[236:239], v[188:191], v[212:215], v[236:239]
    v_mfma_f32_16x16x32_bf16 v[240:243], v[188:191], v[80:83], v[240:243]
    s_waitcnt lgkmcnt(6)
    v_mfma_f32_16x16x32_bf16 v[232:235], v[192:195], v[216:219], v[232:235]
    v_mfma_f32_16x16x32_bf16 v[236:239], v[192:195], v[220:223], v[236:239]
    v_mfma_f32_16x16x32_bf16 v[240:243], v[192:195], v[80:83], v[240:243]
    s_waitcnt lgkmcnt(0)
    v_mfma_f32_16x16x32_bf16 v[232:235], v[196:199], v[224:227], v[232:235]
    v_mfma_f32_16x16x32_bf16 v[236:239], v[196:199], v[228:231], v[236:239]
    v_mfma_f32_16x16x32_bf16 v[240:243], v[196:199], v[80:83], v[240:243]
    s_cmp_lt_u32 s3, 4
    s_cbranch_scc1 L_NOQX
    ds_read_b128 v[168:171], v0
    ds_read_b128 v[172:175], v0 offset:1024
L_NOQX:
    s_nop 3
    buffer_store_dwordx4 v[232:235], v2, s[32:35], s13 offen sc1
    buffer_store_dwordx4 v[236:239], v2, s[32:35], s15 offen sc1
    s_mov_b32 exec_lo, 0x00010001
    s_mov_b32 exec_hi, 0x00010001
    buffer_store_dwordx4 v[240:243], v1, s[32:35], s14 offen sc1
    s_mov_b64 exec, -1
    s_waitcnt lgkmcnt(0)
    v_mfma_f32_32x32x16_bf16 v[120:135], v[176:179], v[168:171], 0
    v_mfma_f32_32x32x16_bf16 v[120:135], v[180:183], v[172:175], v[120:135]
    v_and_b32 v46, 7, v1
    v_lshlrev_b32 v46, 17, v46
    v_bfe_u32 v9, v1, 3, 1
    v_lshl_add_u32 v46, v9, 14, v46
    s_and_b32 s96, s10, 1
    s_and_b32 s97, s2, 27
    s_lshl_b32 s98, s97, 12
    s_lshr_b32 s99, s10, 1
    s_lshl_b32 s97, s99, 6
    s_add_u32 s99, s98, s97
    s_lshl2_add_u32 s98, s96, s99
    s_add_u32 s97, s98, 1048576
    s_add_u32 s17, s97, 512
    v_lshrrev_b32 v47, 3, v1
    v_lshlrev_b32 v47, 10, v47
    v_and_b32 v9, 7, v1
    v_lshl_add_u32 v47, v9, 4, v47
    v_and_b32 v48, 7, v1
    v_lshlrev_b32 v48, 4, v48
    v_lshrrev_b32 v9, 5, v1
    v_lshl_add_u32 v48, v9, 3, v48
    v_cvt_pk_bf16_f32 v120, 0, v120
    v_cvt_pk_bf16_f32 v121, 0, v121
    v_cvt_pk_bf16_f32 v122, 0, v122
    v_cvt_pk_bf16_f32 v123, 0, v123
    v_cvt_pk_bf16_f32 v124, 0, v124
    v_cvt_pk_bf16_f32 v125, 0, v125
    v_cvt_pk_bf16_f32 v126, 0, v126
    v_cvt_pk_bf16_f32 v127, 0, v127
    v_cvt_pk_bf16_f32 v128, 0, v128
    v_cvt_pk_bf16_f32 v129, 0, v129
    v_cvt_pk_bf16_f32 v130, 0, v130
    v_cvt_pk_bf16_f32 v131, 0, v131
    v_cvt_pk_bf16_f32 v132, 0, v132
    v_cvt_pk_bf16_f32 v133, 0, v133
    v_cvt_pk_bf16_f32 v134, 0, v134
    v_cvt_pk_bf16_f32 v135, 0, v135
    v_max3_f32 v4, v120, v121, v122
    v_min3_f32 v5, v120, v121, v122
    v_max3_f32 v4, v4, v123, v124
    v_min3_f32 v5, v5, v123, v124
    v_max3_f32 v4, v4, v125, v126
    v_min3_f32 v5, v5, v125, v126
    v_max3_f32 v4, v4, v127, v128
    v_min3_f32 v5, v5, v127, v128
    v_max3_f32 v4, v4, v129, v130
    v_min3_f32 v5, v5, v129, v130
    v_max3_f32 v4, v4, v131, v132
    v_min3_f32 v5, v5, v131, v132
    v_max3_f32 v4, v4, v133, v134
    v_min3_f32 v5, v5, v133, v134
    v_max_f32 v6, v4, v135
    v_min_f32 v7, v5, v135
    v_max_f32 v4, v4, v135
    v_min_f32 v5, v5, v135
    s_nop 0
    v_permlane32_swap_b32 v4, v6
    v_permlane32_swap_b32 v5, v7
    v_max_f32 v4, v4, v6
    v_min_f32 v5, v5, v7
    v_pk_mul_f32 v[4:5], v[4:5], s[6:7] op_sel:[0,1]
    v_mov_b32 v6, v5
    v_pk_fma_f32 v[136:137], v[120:121], s[6:7], v[4:5] op_sel:[0,1,0] op_sel_hi:[1,1,0] neg_lo:[0,0,1] neg_hi:[0,0,1]
    v_pk_fma_f32 v[120:121], v[120:121], s[6:7], v[6:7] op_sel:[0,1,0] op_sel_hi:[1,1,0] neg_lo:[1,0,0] neg_hi:[1,0,0]
    v_pk_fma_f32 v[138:139], v[122:123], s[6:7], v[4:5] op_sel:[0,1,0] op_sel_hi:[1,1,0] neg_lo:[0,0,1] neg_hi:[0,0,1]
    v_pk_fma_f32 v[122:123], v[122:123], s[6:7], v[6:7] op_sel:[0,1,0] op_sel_hi:[1,1,0] neg_lo:[1,0,0] neg_hi:[1,0,0]
    v_pk_fma_f32 v[140:141], v[124:125], s[6:7], v[4:5] op_sel:[0,1,0] op_sel_hi:[1,1,0] neg_lo:[0,0,1] neg_hi:[0,0,1]
    v_pk_fma_f32 v[124:125], v[124:125], s[6:7], v[6:7] op_sel:[0,1,0] op_sel_hi:[1,1,0] neg_lo:[1,0,0] neg_hi:[1,0,0]
    v_pk_fma_f32 v[142:143], v[126:127], s[6:7], v[4:5] op_sel:[0,1,0] op_sel_hi:[1,1,0] neg_lo:[0,0,1] neg_hi:[0,0,1]
    v_pk_fma_f32 v[126:127], v[126:127], s[6:7], v[6:7] op_sel:[0,1,0] op_sel_hi:[1,1,0] neg_lo:[1,0,0] neg_hi:[1,0,0]
    v_pk_fma_f32 v[144:145], v[128:129], s[6:7], v[4:5] op_sel:[0,1,0] op_sel_hi:[1,1,0] neg_lo:[0,0,1] neg_hi:[0,0,1]
    v_pk_fma_f32 v[128:129], v[128:129], s[6:7], v[6:7] op_sel:[0,1,0] op_sel_hi:[1,1,0] neg_lo:[1,0,0] neg_hi:[1,0,0]
    v_pk_fma_f32 v[146:147], v[130:131], s[6:7], v[4:5] op_sel:[0,1,0] op_sel_hi:[1,1,0] neg_lo:[0,0,1] neg_hi:[0,0,1]
    v_pk_fma_f32 v[130:131], v[130:131], s[6:7], v[6:7] op_sel:[0,1,0] op_sel_hi:[1,1,0] neg_lo:[1,0,0] neg_hi:[1,0,0]
    v_pk_fma_f32 v[148:149], v[132:133], s[6:7], v[4:5] op_sel:[0,1,0] op_sel_hi:[1,1,0] neg_lo:[0,0,1] neg_hi:[0,0,1]
    v_pk_fma_f32 v[132:133], v[132:133], s[6:7], v[6:7] op_sel:[0,1,0] op_sel_hi:[1,1,0] neg_lo:[1,0,0] neg_hi:[1,0,0]
    v_pk_fma_f32 v[150:151], v[134:135], s[6:7], v[4:5] op_sel:[0,1,0] op_sel_hi:[1,1,0] neg_lo:[0,0,1] neg_hi:[0,0,1]
    v_pk_fma_f32 v[134:135], v[134:135], s[6:7], v[6:7] op_sel:[0,1,0] op_sel_hi:[1,1,0] neg_lo:[1,0,0] neg_hi:[1,0,0]
    v_exp_f32 v136, v136
    v_exp_f32 v120, v120
    v_exp_f32 v137, v137
    v_exp_f32 v121, v121
    v_exp_f32 v138, v138
    v_exp_f32 v122, v122
    v_exp_f32 v139, v139
    v_exp_f32 v123, v123
    v_exp_f32 v140, v140
    v_exp_f32 v124, v124
    v_exp_f32 v141, v141
    v_exp_f32 v125, v125
    v_exp_f32 v142, v142
    v_exp_f32 v126, v126
    v_exp_f32 v143, v143
    v_exp_f32 v127, v127
    s_waitcnt vmcnt(0)
    s_barrier
    s_cmp_lg_u32 s3, 0
    s_cbranch_scc1 L_PC
    v_mov_b32 v85, s4
    s_mov_b32 exec_hi, 0
    s_mov_b32 exec_lo, 65535
    buffer_store_dword v85, v46, s[32:35], s17 offen sc1
    s_mov_b64 exec, -1
L_PC:
    s_xor_b32 s96, s95, 1310720
    s_add_u32 s82, s96, s90
    s_add_u32 m0, s83, 81920
    s_nop 0
    buffer_load_dwordx4 v26, s[44:47], s82 offen lds
    v_exp_f32 v144, v144
    v_exp_f32 v128, v128
    v_exp_f32 v145, v145
    v_exp_f32 v129, v129
    s_xor_b32 s96, s95, 1441792
    s_add_u32 s82, s96, s90
    s_add_u32 m0, s83, 90112
    s_nop 0
    buffer_load_dwordx4 v26, s[44:47], s82 offen lds
    v_exp_f32 v146, v146
    v_exp_f32 v130, v130
    v_exp_f32 v147, v147
    v_exp_f32 v131, v131
    s_xor_b32 s96, s95, 1572864
    s_add_u32 s82, s96, s90
    s_add_u32 m0, s83, 98304
    s_nop 0
    buffer_load_dwordx4 v26, s[44:47], s82 offen lds
    v_exp_f32 v148, v148
    v_exp_f32 v132, v132
    v_exp_f32 v149, v149
    v_exp_f32 v133, v133
    s_xor_b32 s96, s95, 1703936
    s_add_u32 s82, s96, s90
    s_add_u32 m0, s83, 106496
    s_nop 0
    buffer_load_dwordx4 v26, s[44:47], s82 offen lds
    v_exp_f32 v150, v150
    v_exp_f32 v134, v134
    v_exp_f32 v151, v151
    v_exp_f32 v135, v135
    s_lshl4_add_u32 s96, s11, s10
    s_lshl_b32 s97, s96, 14
    s_lshl_b32 s98, s3, 7
    s_add_u32 s99, s97, s98
    s_add_u32 s13, s99, 25165824
    s_add_u32 s14, s13, 8192
    s_lshl4_add_u32 s96, s11, s10
    s_lshl_b32 s97, s96, 10
    s_lshl_b32 s98, s3, 7
    s_add_u32 s99, s97, s98
    s_add_u32 s15, s99, 29360128
    s_add_u32 s17, s17, 3072
    s_load_dwordx2 s[24:25], s[32:33], s92 offset:512 glc
    s_xor_b32 s96, s95, 1835008
    s_add_u32 s82, s96, s90
    s_add_u32 m0, s83, 114688
    s_nop 0
    buffer_load_dwordx4 v26, s[44:47], s82 offen lds
    v_pk_add_f32 v[8:9], v[136:137], v[138:139]
    v_pk_add_f32 v[10:11], v[120:121], v[122:123]
    v_pk_add_f32 v[8:9], v[8:9], v[140:141]
    v_pk_add_f32 v[10:11], v[10:11], v[124:125]
    v_pk_add_f32 v[8:9], v[8:9], v[142:143]
    v_pk_add_f32 v[10:11], v[10:11], v[126:127]
    v_pk_add_f32 v[8:9], v[8:9], v[144:145]
    v_pk_add_f32 v[10:11], v[10:11], v[128:129]
    v_pk_add_f32 v[8:9], v[8:9], v[146:147]
    v_pk_add_f32 v[10:11], v[10:11], v[130:131]
    v_pk_add_f32 v[8:9], v[8:9], v[148:149]
    v_pk_add_f32 v[10:11], v[10:11], v[132:133]
    v_pk_add_f32 v[8:9], v[8:9], v[150:151]
    v_pk_add_f32 v[10:11], v[10:11], v[134:135]
    s_xor_b32 s96, s95, 1966080
    s_add_u32 s82, s96, s90
    s_add_u32 m0, s83, 122880
    s_nop 0
    buffer_load_dwordx4 v26, s[44:47], s82 offen lds
    v_add_f32 v6, v8, v9
    v_add_f32 v7, v10, v11
    v_add_f32 v4, v8, v9
    v_add_f32 v5, v10, v11
    s_nop 0
    v_permlane32_swap_b32 v4, v6
    v_permlane32_swap_b32 v5, v7
    v_pk_add_f32 v[4:5], v[4:5], v[6:7]
    v_rcp_f32 v4, v4
    v_rcp_f32 v5, v5
    s_nop 0
    v_pk_mul_f32 v[136:137], v[136:137], v[4:5] op_sel_hi:[1,0]
    v_pk_mul_f32 v[120:121], v[4:5], v[120:121] op_sel:[1,0]
    v_pk_mul_f32 v[138:139], v[138:139], v[4:5] op_sel_hi:[1,0]
    v_pk_mul_f32 v[122:123], v[4:5], v[122:123] op_sel:[1,0]
    v_pk_mul_f32 v[140:141], v[140:141], v[4:5] op_sel_hi:[1,0]
    s_add_u32 s82, s95, s90
    s_mov_b32 m0, s83
    s_nop 0
    buffer_load_dwordx4 v26, s[44:47], s82 offen lds
    v_pk_mul_f32 v[124:125], v[4:5], v[124:125] op_sel:[1,0]
    v_pk_mul_f32 v[142:143], v[142:143], v[4:5] op_sel_hi:[1,0]
    v_pk_mul_f32 v[126:127], v[4:5], v[126:127] op_sel:[1,0]
    v_pk_mul_f32 v[144:145], v[144:145], v[4:5] op_sel_hi:[1,0]
    v_pk_mul_f32 v[128:129], v[4:5], v[128:129] op_sel:[1,0]
    v_pk_mul_f32 v[146:147], v[146:147], v[4:5] op_sel_hi:[1,0]
    v_pk_mul_f32 v[130:131], v[4:5], v[130:131] op_sel:[1,0]
    v_pk_mul_f32 v[148:149], v[148:149], v[4:5] op_sel_hi:[1,0]
    v_pk_mul_f32 v[132:133], v[4:5], v[132:133] op_sel:[1,0]
    v_pk_mul_f32 v[150:151], v[150:151], v[4:5] op_sel_hi:[1,0]
    v_pk_mul_f32 v[134:135], v[4:5], v[134:135] op_sel:[1,0]
    v_cvt_pk_bf16_f32 v152, v136, v137
    v_cvt_pk_bf16_f32 v153, v138, v139
    v_cvt_pk_bf16_f32 v154, v140, v141
    s_xor_b32 s96, s95, 131072
    s_add_u32 s82, s96, s90
    s_add_u32 m0, s83, 8192
    s_nop 0
    buffer_load_dwordx4 v26, s[44:47], s82 offen lds
    v_cvt_pk_bf16_f32 v155, v142, v143
    v_cvt_pk_bf16_f32 v156, v144, v145
    v_cvt_pk_bf16_f32 v157, v146, v147
    v_cvt_pk_bf16_f32 v158, v148, v149
    v_cvt_pk_bf16_f32 v159, v150, v151
    v_cvt_pk_bf16_f32 v160, v120, v121
    v_cvt_pk_bf16_f32 v161, v122, v123
    v_cvt_pk_bf16_f32 v162, v124, v125
    v_cvt_pk_bf16_f32 v163, v126, v127
    v_cvt_pk_bf16_f32 v164, v128, v129
    v_cvt_pk_bf16_f32 v165, v130, v131
    v_cvt_pk_bf16_f32 v166, v132, v133
    v_cvt_pk_bf16_f32 v167, v134, v135
    s_branch SCHK_20
SPOLL_19:
    s_load_dwordx2 s[24:25], s[32:33], s92 offset:512 glc
SCHK_20:
    s_add_u32 s5, s5, 1
    s_cmp_ge_u32 s5, 200000
    s_waitcnt lgkmcnt(0)
    s_cbranch_scc1 SDONE_21
    s_cmp_lg_u32 s24, s4
    s_cbranch_scc1 SPOLL_19
    s_cmp_lg_u32 s25, s4
    s_cbranch_scc1 SPOLL_19
SDONE_21:
    s_barrier
    buffer_load_dwordx4 v[184:187], v47, s[32:35], s13 offen sc1
    buffer_load_dwordx4 v[188:191], v47, s[32:35], s14 offen sc1
    buffer_load_dwordx4 v[192:195], v2, s[32:35], s16 offen sc1
    s_lshl_b32 s96, s3, 5
    s_add_u32 s14, s96, 155648
    v_and_b32 v6, 3, v1
    v_lshl_add_u32 v6, v6, 3, s14
    v_lshrrev_b32 v9, 5, v1
    v_lshl_add_u32 v6, v9, 2, v6
    s_lshl_b32 s96, s3, 10
    s_add_u32 s14, s96, 147456
    v_and_b32 v5, 15, v1
    v_lshl_add_u32 v5, v5, 4, s14
    v_lshrrev_b32 v9, 5, v1
    v_lshl_add_u32 v5, v9, 9, v5
    v_bfe_u32 v9, v1, 4, 1
    v_lshl_add_u32 v5, v9, 3, v5
    s_lshl_b32 s96, s76, 7
    s_add_u32 s14, s96, 155648
    v_lshrrev_b32 v7, 5, v1
    v_lshl_add_u32 v7, v7, 4, s14
    s_lshl_b32 s96, s76, 12
    s_add_u32 s14, s96, 147456
    v_add_u32 v84, s14, v2
    s_cmp_lt_u32 s3, 4
    s_cbranch_scc1 L_HG1
    v_lshlrev_b32 v52, 16, v88
    v_and_b32 v53, s6, v88
    v_pk_mul_f32 v[196:197], v[36:37], v[52:53] op_sel:[0,0] op_sel_hi:[0,1]
    v_lshlrev_b32 v54, 16, v89
    v_and_b32 v55, s6, v89
    v_pk_mul_f32 v[198:199], v[36:37], v[54:55] op_sel:[0,0] op_sel_hi:[0,1]
    v_lshlrev_b32 v52, 16, v90
    v_and_b32 v53, s6, v90
    v_pk_mul_f32 v[200:201], v[36:37], v[52:53] op_sel:[0,0] op_sel_hi:[0,1]
    v_lshlrev_b32 v54, 16, v91
    v_and_b32 v55, s6, v91
    v_pk_mul_f32 v[202:203], v[36:37], v[54:55] op_sel:[0,0] op_sel_hi:[0,1]
    v_lshlrev_b32 v52, 16, v92
    v_and_b32 v53, s6, v92
    v_pk_fma_f32 v[196:197], v[36:37], v[52:53], v[196:197] op_sel:[1,0,0] op_sel_hi:[1,1,1]
    v_lshlrev_b32 v54, 16, v93
    v_and_b32 v55, s6, v93
    v_pk_fma_f32 v[198:199], v[36:37], v[54:55], v[198:199] op_sel:[1,0,0] op_sel_hi:[1,1,1]
    v_lshlrev_b32 v52, 16, v94
    v_and_b32 v53, s6, v94
    v_pk_fma_f32 v[200:201], v[36:37], v[52:53], v[200:201] op_sel:[1,0,0] op_sel_hi:[1,1,1]
    v_lshlrev_b32 v54, 16, v95
    v_and_b32 v55, s6, v95
    v_pk_fma_f32 v[202:203], v[36:37], v[54:55], v[202:203] op_sel:[1,0,0] op_sel_hi:[1,1,1]
    v_lshlrev_b32 v52, 16, v96
    v_and_b32 v53, s6, v96
    v_pk_fma_f32 v[196:197], v[38:39], v[52:53], v[196:197] op_sel:[0,0,0] op_sel_hi:[0,1,1]
    v_lshlrev_b32 v54, 16, v97
    v_and_b32 v55, s6, v97
    v_pk_fma_f32 v[198:199], v[38:39], v[54:55], v[198:199] op_sel:[0,0,0] op_sel_hi:[0,1,1]
    v_lshlrev_b32 v52, 16, v98
    v_and_b32 v53, s6, v98
    v_pk_fma_f32 v[200:201], v[38:39], v[52:53], v[200:201] op_sel:[0,0,0] op_sel_hi:[0,1,1]
    v_lshlrev_b32 v54, 16, v99
    v_and_b32 v55, s6, v99
    v_pk_fma_f32 v[202:203], v[38:39], v[54:55], v[202:203] op_sel:[0,0,0] op_sel_hi:[0,1,1]
    v_lshlrev_b32 v52, 16, v100
    v_and_b32 v53, s6, v100
    v_pk_fma_f32 v[196:197], v[38:39], v[52:53], v[196:197] op_sel:[1,0,0] op_sel_hi:[1,1,1]
    v_lshlrev_b32 v54, 16, v101
    v_and_b32 v55, s6, v101
    v_pk_fma_f32 v[198:199], v[38:39], v[54:55], v[198:199] op_sel:[1,0,0] op_sel_hi:[1,1,1]
    v_lshlrev_b32 v52, 16, v102
    v_and_b32 v53, s6, v102
    v_pk_fma_f32 v[200:201], v[38:39], v[52:53], v[200:201] op_sel:[1,0,0] op_sel_hi:[1,1,1]
    v_lshlrev_b32 v54, 16, v103
    v_and_b32 v55, s6, v103
    v_pk_fma_f32 v[202:203], v[38:39], v[54:55], v[202:203] op_sel:[1,0,0] op_sel_hi:[1,1,1]
    v_lshlrev_b32 v52, 16, v104
    v_and_b32 v53, s6, v104
    v_pk_fma_f32 v[196:197], v[40:41], v[52:53], v[196:197] op_sel:[0,0,0] op_sel_hi:[0,1,1]
    v_lshlrev_b32 v54, 16, v105
    v_and_b32 v55, s6, v105
    v_pk_fma_f32 v[198:199], v[40:41], v[54:55], v[198:199] op_sel:[0,0,0] op_sel_hi:[0,1,1]
    v_lshlrev_b32 v52, 16, v106
    v_and_b32 v53, s6, v106
    v_pk_fma_f32 v[200:201], v[40:41], v[52:53], v[200:201] op_sel:[0,0,0] op_sel_hi:[0,1,1]
    v_lshlrev_b32 v54, 16, v107
    v_and_b32 v55, s6, v107
    v_pk_fma_f32 v[202:203], v[40:41], v[54:55], v[202:203] op_sel:[0,0,0] op_sel_hi:[0,1,1]
    v_lshlrev_b32 v52, 16, v108
    v_and_b32 v53, s6, v108
    v_pk_fma_f32 v[196:197], v[40:41], v[52:53], v[196:197] op_sel:[1,0,0] op_sel_hi:[1,1,1]
    v_lshlrev_b32 v54, 16, v109
    v_and_b32 v55, s6, v109
    v_pk_fma_f32 v[198:199], v[40:41], v[54:55], v[198:199] op_sel:[1,0,0] op_sel_hi:[1,1,1]
    v_lshlrev_b32 v52, 16, v110
    v_and_b32 v53, s6, v110
    v_pk_fma_f32 v[200:201], v[40:41], v[52:53], v[200:201] op_sel:[1,0,0] op_sel_hi:[1,1,1]
    v_lshlrev_b32 v54, 16, v111
    v_and_b32 v55, s6, v111
    v_pk_fma_f32 v[202:203], v[40:41], v[54:55], v[202:203] op_sel:[1,0,0] op_sel_hi:[1,1,1]
    v_lshlrev_b32 v52, 16, v112
    v_and_b32 v53, s6, v112
    v_pk_fma_f32 v[196:197], v[42:43], v[52:53], v[196:197] op_sel:[0,0,0] op_sel_hi:[0,1,1]
    v_lshlrev_b32 v54, 16, v113
    v_and_b32 v55, s6, v113
    v_pk_fma_f32 v[198:199], v[42:43], v[54:55], v[198:199] op_sel:[0,0,0] op_sel_hi:[0,1,1]
    v_lshlrev_b32 v52, 16, v114
    v_and_b32 v53, s6, v114
    v_pk_fma_f32 v[200:201], v[42:43], v[52:53], v[200:201] op_sel:[0,0,0] op_sel_hi:[0,1,1]
    v_lshlrev_b32 v54, 16, v115
    v_and_b32 v55, s6, v115
    v_pk_fma_f32 v[202:203], v[42:43], v[54:55], v[202:203] op_sel:[0,0,0] op_sel_hi:[0,1,1]
    v_lshlrev_b32 v52, 16, v116
    v_and_b32 v53, s6, v116
    v_pk_fma_f32 v[196:197], v[42:43], v[52:53], v[196:197] op_sel:[1,0,0] op_sel_hi:[1,1,1]
    v_lshlrev_b32 v54, 16, v117
    v_and_b32 v55, s6, v117
    v_pk_fma_f32 v[198:199], v[42:43], v[54:55], v[198:199] op_sel:[1,0,0] op_sel_hi:[1,1,1]
    v_lshlrev_b32 v52, 16, v118
    v_and_b32 v53, s6, v118
    v_pk_fma_f32 v[200:201], v[42:43], v[52:53], v[200:201] op_sel:[1,0,0] op_sel_hi:[1,1,1]
    v_lshlrev_b32 v54, 16, v119
    v_and_b32 v55, s6, v119
    v_pk_fma_f32 v[202:203], v[42:43], v[54:55], v[202:203] op_sel:[1,0,0] op_sel_hi:[1,1,1]
    v_permlane32_swap_b32 v196, v200
    v_permlane32_swap_b32 v197, v201
    v_permlane32_swap_b32 v198, v202
    v_permlane32_swap_b32 v199, v203
    v_add_f32 v196, v196, v200
    v_add_f32 v197, v197, v201
    v_add_f32 v198, v198, v202
    v_add_f32 v199, v199, v203
    s_nop 0
    v_permlane16_swap_b32 v196, v198
    v_permlane16_swap_b32 v197, v199
    v_add_f32 v196, v196, v198
    v_add_f32 v197, v197, v199
    s_nop 0
    v_add_f32_dpp v196, v196, v196 row_ror:8 row_mask:0xf bank_mask:0xf
    v_add_f32_dpp v197, v197, v197 row_ror:8 row_mask:0xf bank_mask:0xf
    s_nop 1
    v_mov_b32_dpp v196, v197 quad_perm:[0,1,2,3] row_mask:0xf bank_mask:0xc
    ds_write_b32 v252, v196 offset:9984
L_HG1:
    s_waitcnt vmcnt(1)
    v_pk_add_f32 v[184:185], v[184:185], v[188:189]
    v_pk_add_f32 v[186:187], v[186:187], v[190:191]
    s_nop 1
    v_permlane32_swap_b32 v184, v186
    v_permlane32_swap_b32 v185, v187
    v_pk_add_f32 v[184:185], v[184:185], v[186:187]
    s_nop 1
    v_add_f32_dpp v184, v184, v184 row_ror:8 row_mask:0xf bank_mask:0xf
    v_add_f32_dpp v185, v185, v185 row_ror:8 row_mask:0xf bank_mask:0xf
    v_mov_b32 v186, v184
    v_mov_b32 v187, v185
    s_nop 0
    v_permlane16_swap_b32 v184, v186
    v_permlane16_swap_b32 v185, v187
    v_pk_add_f32 v[184:185], v[184:185], v[186:187]
    v_cvt_pk_bf16_f32 v184, v184, v185
    v_mov_b32 v185, s4
    s_mov_b32 exec_lo, 0xff
    s_mov_b32 exec_hi, 0xff
    buffer_store_dwordx2 v[184:185], v48, s[32:35], s15 offen sc1
    s_mov_b64 exec, -1
    s_waitcnt lgkmcnt(0)
    s_barrier
    s_cmp_lg_u32 s3, 0
    s_cbranch_scc1 L_PC2
    v_mov_b32 v85, s4
    s_mov_b32 exec_hi, 0
    s_mov_b32 exec_lo, 65535
    buffer_store_dword v85, v46, s[32:35], s17 offen sc1
    s_mov_b64 exec, -1
L_PC2:
    s_cmp_lg_u32 s3, 3
    s_cbranch_scc1 L_M2F
    ds_read_b128 v[196:199], v251 offset:10000
    s_lshr_b32 s96, s8, 2
    s_lshl1_add_u32 s97, s9, s96
    s_and_b32 s98, s8, 3
    s_lshl2_add_u32 s99, s97, s98
    s_lshl_b32 s96, s99, 9
    s_add_u32 s18, s96, 131072
    s_waitcnt lgkmcnt(0)
    v_add_f32 v196, v196, v197
    v_add_f32 v198, v198, v199
    v_mov_b32 v197, s4
    v_add_f32 v196, v196, v198
    buffer_store_dwordx2 v[196:197], v250, s[32:35], s18 offen sc1
L_M2F:
    s_waitcnt vmcnt(1)
    s_xor_b32 s96, s95, 262144
    s_add_u32 s82, s96, s90
    s_add_u32 m0, s83, 16384
    s_nop 0
    buffer_load_dwordx4 v26, s[44:47], s82 offen lds
    v_permlane32_swap_b32 v192, v194
    v_permlane32_swap_b32 v193, v195
    v_pk_add_f32 v[192:193], v[192:193], v[194:195]
    s_nop 1
    v_add_f32_dpp v192, v192, v192 row_ror:4 row_mask:0xf bank_mask:0xf
    s_xor_b32 s96, s95, 393216
    s_add_u32 s82, s96, s90
    s_add_u32 m0, s83, 24576
    s_nop 0
    buffer_load_dwordx4 v26, s[44:47], s82 offen lds
    v_add_f32_dpp v193, v193, v193 row_ror:4 row_mask:0xf bank_mask:0xf
    v_add_f32_dpp v192, v192, v192 row_ror:8 row_mask:0xf bank_mask:0xf
    s_nop 0
    v_add_f32_dpp v193, v193, v193 row_ror:8 row_mask:0xf bank_mask:0xf
    s_xor_b32 s96, s95, 524288
    s_add_u32 s82, s96, s90
    s_add_u32 m0, s83, 32768
    s_nop 0
    buffer_load_dwordx4 v26, s[44:47], s82 offen lds
    v_mov_b32 v194, v192
L_PAD7:
    s_cbranch_execz L_RET7
    v_mov_b32 v195, v193
    s_nop 0
    v_permlane16_swap_b32 v192, v194
    s_xor_b32 s96, s95, 655360
    s_add_u32 s82, s96, s90
    s_add_u32 m0, s83, 40960
    s_nop 0
    buffer_load_dwordx4 v26, s[44:47], s82 offen lds
    v_permlane16_swap_b32 v193, v195
    v_pk_add_f32 v[192:193], v[192:193], v[194:195]
    v_cvt_pk_bf16_f32 v192, v192, v193
    ds_write_b32 v6, v192
    s_waitcnt lgkmcnt(0)
    s_barrier
    ds_read_b128 v[196:199], v7
    ds_read_b128 v[200:203], v7 offset:32
    ds_read_b128 v[204:207], v7 offset:64
    ds_read_b128 v[208:211], v7 offset:96
    s_lshr_b32 s96, s8, 2
    s_lshl1_add_u32 s97, s9, s96
    s_and_b32 s98, s8, 3
    s_lshl2_add_u32 s99, s97, s98
    s_lshl_b32 s96, s99, 9
    s_add_u32 s18, s96, 131072
    s_waitcnt lgkmcnt(0)
    s_lshl3_add_u32 s96, s11, s3
    s_lshl_b32 s97, s96, 11
    s_add_u32 s13, s97, 29360128
    s_load_dwordx2 s[24:25], s[32:33], s92 offset:3584 glc
    v_mfma_f32_32x32x16_bf16 v[136:151], v[196:199], v[152:155], 0
    v_mfma_f32_32x32x16_bf16 v[136:151], v[200:203], v[156:159], v[136:151]
    v_mfma_f32_32x32x16_bf16 v[136:151], v[204:207], v[160:163], v[136:151]
    v_mfma_f32_32x32x16_bf16 v[136:151], v[208:211], v[164:167], v[136:151]
    s_nop 11
    v_cvt_pk_bf16_f32 v136, 0, v136
    v_add_f32 v136, 0x358637bd, v136
    v_cvt_pk_bf16_f32 v136, 0, v136
    v_rcp_f32 v136, v136
    s_lshr_b32 s96, s3, 2
    s_lshl_b32 s97, s96, 15
    s_and_b32 s98, s3, 3
    s_lshl_b32 s99, s98, 5
    s_add_u32 s19, s97, s99
    v_lshrrev_b32 v34, 4, v1
    v_lshlrev_b32 v34, 13, v34
    v_bfe_u32 v9, v1, 2, 2
    v_lshl_add_u32 v34, v9, 7, v34
    v_bfe_u32 v9, v1, 3, 2
    v_lshl_add_u32 v34, v9, 5, v34
    v_and_b32 v9, 3, v1
    v_lshl_add_u32 v34, v9, 3, v34
    v_xor_b32 v34, s19, v34
    s_lshl_b32 s96, s75, 11
    s_add_u32 s19, s96, 13631488
    v_and_b32 v52, 7, v1
    v_lshl_add_u32 v52, v52, 4, s19
    v_lshrrev_b32 v9, 4, v1
    v_lshl_add_u32 v52, v9, 9, v52
    v_and_b32 v53, 15, v1
    v_lshlrev_b32 v53, 9, v53
    v_add_u32 v53, 13631744, v53
    s_branch SCHK_23
SPOLL_22:
    s_load_dwordx2 s[24:25], s[32:33], s92 offset:3584 glc
SCHK_23:
    s_add_u32 s5, s5, 1
    s_cmp_ge_u32 s5, 200000
    s_waitcnt lgkmcnt(0)
    s_cbranch_scc1 SDONE_24
    s_cmp_lg_u32 s24, s4
    s_cbranch_scc1 SPOLL_22
    s_cmp_lg_u32 s25, s4
    s_cbranch_scc1 SPOLL_22
SDONE_24:
    buffer_load_dwordx4 v[228:231], v2, s[32:35], s13 offen sc1
    buffer_load_dwordx4 v[232:235], v2, s[32:35], s13 offen offset:1024 sc1
    s_waitcnt vmcnt(0)
    v_bitop3_b32 v4, v229, v231, s4 bitop3:0x7e
    v_bitop3_b32 v4, v4, v233, s4 bitop3:0xf6
    v_bitop3_b32 v4, v4, v235, s4 bitop3:0xf6
    v_cmp_ne_u32 vcc, 0, v4
    s_cbranch_vccz TOK_26
POLL_27:
    buffer_load_dwordx4 v[228:231], v2, s[32:35], s13 offen sc1
    buffer_load_dwordx4 v[232:235], v2, s[32:35], s13 offen offset:1024 sc1
    s_waitcnt vmcnt(0)
    v_bitop3_b32 v4, v229, v231, s4 bitop3:0x7e
    v_bitop3_b32 v4, v4, v233, s4 bitop3:0xf6
    v_bitop3_b32 v4, v4, v235, s4 bitop3:0xf6
    v_cmp_ne_u32 vcc, 0, v4
    s_cbranch_vccz PDONE_28
    s_add_u32 s5, s5, 1
    s_cmp_lt_u32 s5, 200000
    s_cbranch_scc1 POLL_27
PDONE_28:
TOK_26:
    ds_write2_b32 v5, v228, v230 offset0:0 offset1:1
    ds_write2_b32 v5, v232, v234 offset0:64 offset1:65
    s_waitcnt lgkmcnt(0)
    s_barrier
    ds_read_b128 v[212:215], v84
    ds_read_b128 v[216:219], v84 offset:1024
    ds_read_b128 v[220:223], v84 offset:2048
    ds_read_b128 v[224:227], v84 offset:3072
    s_lshl_b32 s96, s77, 1
    s_lshl3_add_u32 s97, s10, s96
    s_lshl_b32 s98, s97, 5
    s_lshl1_add_u32 s99, s11, s98
    s_add_u32 s96, s99, s76
    s_lshl_b32 s97, s96, 10
    s_add_u32 s13, s97, 8388608
    v_and_b32 v47, 15, v1
    v_lshlrev_b32 v47, 4, v47
    v_bfe_u32 v9, v1, 4, 1
    v_lshl_add_u32 v47, v9, 15, v47
    v_lshrrev_b32 v9, 5, v1
    v_lshl_add_u32 v47, v9, 8, v47
    s_waitcnt lgkmcnt(3)
    v_mfma_f32_32x32x16_bf16 v[120:135], v[212:215], v[152:155], 0
    s_waitcnt lgkmcnt(2)
    v_mfma_f32_32x32x16_bf16 v[120:135], v[216:219], v[156:159], v[120:135]
    s_waitcnt lgkmcnt(1)
    v_mfma_f32_32x32x16_bf16 v[120:135], v[220:223], v[160:163], v[120:135]
    s_waitcnt lgkmcnt(0)
    v_mfma_f32_32x32x16_bf16 v[120:135], v[224:227], v[164:167], v[120:135]
    s_lshr_b32 s96, s3, 1
    s_lshl4_add_u32 s97, s96, s12
    s_lshl_b32 s98, s97, 11
    s_and_b32 s99, s3, 1
    s_lshl_b32 s96, s99, 10
    s_add_u32 s97, s98, s96
    s_add_u32 s18, s97, 131072
    s_lshl_b32 s19, s12, 7
    v_and_b32 v84, 3, v1
    v_lshl_add_u32 v84, v84, 1, s19
    v_lshrrev_b32 v9, 5, v1
    v_lshl_add_u32 v84, v9, 3, v84
    v_bfe_u32 v9, v1, 4, 1
    v_lshl_add_u32 v84, v9, 4, v84
    v_bfe_u32 v9, v1, 2, 2
    v_lshl_add_u32 v84, v9, 5, v84
    global_load_ushort v32, v84, s[78:79]
    v_cvt_pk_bf16_f32 v120, 0, v120
    v_cvt_pk_bf16_f32 v121, 0, v121
    v_cvt_pk_bf16_f32 v122, 0, v122
    v_cvt_pk_bf16_f32 v123, 0, v123
    v_cvt_pk_bf16_f32 v124, 0, v124
    v_cvt_pk_bf16_f32 v125, 0, v125
    v_cvt_pk_bf16_f32 v126, 0, v126
    v_cvt_pk_bf16_f32 v127, 0, v127
    v_pk_mul_f32 v[120:121], v[120:121], v[136:137] op_sel_hi:[1,0]
    v_pk_mul_f32 v[122:123], v[122:123], v[136:137] op_sel_hi:[1,0]
    v_pk_mul_f32 v[124:125], v[124:125], v[136:137] op_sel_hi:[1,0]
    v_pk_mul_f32 v[126:127], v[126:127], v[136:137] op_sel_hi:[1,0]
    v_cvt_pk_bf16_f32 v168, v120, v121
    v_cvt_pk_bf16_f32 v169, v122, v123
    v_cvt_pk_bf16_f32 v170, v124, v125
    v_cvt_pk_bf16_f32 v171, v126, v127
    buffer_store_dwordx4 v[168:171], v47, s[32:35], s13 offen sc1
    v_cvt_pk_bf16_f32 v128, 0, v128
    v_cvt_pk_bf16_f32 v129, 0, v129
    v_cvt_pk_bf16_f32 v130, 0, v130
    v_cvt_pk_bf16_f32 v131, 0, v131
    v_cvt_pk_bf16_f32 v132, 0, v132
    v_cvt_pk_bf16_f32 v133, 0, v133
    v_cvt_pk_bf16_f32 v134, 0, v134
    v_cvt_pk_bf16_f32 v135, 0, v135
    v_pk_mul_f32 v[128:129], v[128:129], v[136:137] op_sel_hi:[1,0]
    v_pk_mul_f32 v[130:131], v[130:131], v[136:137] op_sel_hi:[1,0]
    v_pk_mul_f32 v[132:133], v[132:133], v[136:137] op_sel_hi:[1,0]
    v_pk_mul_f32 v[134:135], v[134:135], v[136:137] op_sel_hi:[1,0]
    v_cvt_pk_bf16_f32 v172, v128, v129
    v_cvt_pk_bf16_f32 v173, v130, v131
    v_cvt_pk_bf16_f32 v174, v132, v133
    v_cvt_pk_bf16_f32 v175, v134, v135
    buffer_store_dwordx4 v[172:175], v47, s[32:35], s13 offen offset:512 sc1
    buffer_load_dwordx4 v[28:31], v2, s[32:35], s18 offen sc1
    v_mov_b32 v236, -1
    v_mov_b32 v237, -1
    v_mov_b32 v238, -1
    v_mov_b32 v239, -1
    s_lshl3_add_u32 s96, s21, s3
    s_lshl4_add_u32 s97, s96, s12
    s_lshl_b32 s98, s97, 8
    s_add_u32 s19, s98, 12582912
    v_lshlrev_b32 v240, 2, v1
    buffer_store_dword v236, v240, s[32:35], s19 offen sc1
    s_lshl_b32 s96, s21, 14
    s_lshl_b32 s97, s12, 9
    s_add_u32 s98, s96, s97
    s_add_u32 s19, s98, 13631488
    v_and_b32 v240, 31, v1
    v_lshlrev_b32 v240, 4, v240
    v_lshrrev_b32 v241, 5, v1
    v_lshl_add_u32 v240, v241, 13, v240
    s_cmp_lg_u32 s3, 5
    s_cbranch_scc1 L_NOPO
    buffer_store_dwordx4 v[236:239], v240, s[32:35], s19 offen sc1
L_NOPO:
    v_bfe_u32 v36, v1, 2, 2
    v_lshlrev_b32 v36, 7, v36
    v_lshrrev_b32 v9, 4, v1
    v_lshl_add_u32 v36, v9, 10, v36
    v_and_b32 v9, 1, v1
    v_lshl_add_u32 v36, v9, 4, v36
    v_bfe_u32 v9, v1, 1, 1
    v_lshl_add_u32 v36, v9, 3, v36
    v_bfe_u32 v9, v1, 3, 2
    v_lshl_add_u32 v36, v9, 5, v36
    s_and_b32 s96, s9, 1
    s_lshl_b32 s97, s96, 2
    s_xor_b32 s98, s3, s97
    s_lshl_b32 s17, s98, 12
    s_lshl_b32 s96, s17, 2
    s_lshr_b32 s97, s95, 4
    s_xor_b32 s14, s96, s97
    v_add_u32 v36, s14, v36
    v_xor_b32 v37, 32, v36
    v_xor_b32 v38, 64, v36
    v_xor_b32 v39, 96, v36
    v_and_b32 v5, 7, v1
    v_lshlrev_b32 v5, 15, v5
    v_bfe_u32 v9, v1, 3, 1
    v_lshl_add_u32 v5, v9, 12, v5
    s_and_b32 s96, s11, 1
    s_lshr_b32 s97, s10, 2
    s_and_b32 s98, s10, 3
    s_lshl_b32 s99, s98, 6
    s_lshl1_add_u32 s98, s97, s99
    s_lshl_b32 s97, s98, 12
    s_lshr_b32 s99, s11, 1
    s_lshl_b32 s98, s99, 6
    s_add_u32 s99, s97, s98
    s_lshl2_add_u32 s97, s96, s99
    s_add_u32 s98, s97, 1048576
    s_add_u32 s15, s98, 1024
    v_lshlrev_b32 v152, 16, v12
    v_and_b32 v153, s6, v12
    v_lshlrev_b32 v154, 16, v13
    v_and_b32 v155, s6, v13
    v_lshlrev_b32 v156, 16, v14
    v_and_b32 v157, s6, v14
    v_lshlrev_b32 v158, 16, v15
    v_and_b32 v159, s6, v15
    v_lshlrev_b32 v160, 16, v16
    v_and_b32 v161, s6, v16
    v_lshlrev_b32 v162, 16, v17
    v_and_b32 v163, s6, v17
    v_lshlrev_b32 v164, 16, v18
    v_and_b32 v165, s6, v18
    v_lshlrev_b32 v166, 16, v19
    v_and_b32 v167, s6, v19
    s_lshl3_add_u32 s96, s21, s3
    s_lshl_b32 s97, s96, 15
    s_add_u32 s19, s97, 8388608
    s_and_b32 s96, s3, 1
    s_lshr_b32 s97, s3, 1
    s_lshl_b32 s98, s97, 10
    s_lshl3_add_u32 s99, s96, s98
    s_add_u32 s14, s99, 159744
    v_and_b32 v4, 31, v1
    v_lshl_add_u32 v4, v4, 5, s14
    v_lshrrev_b32 v9, 5, v1
    v_lshl_add_u32 v4, v9, 2, v4
    v_and_b32 v7, 3, v1
    v_lshlrev_b32 v7, 4, v7
    v_lshrrev_b32 v9, 5, v1
    v_lshl_add_u32 v7, v9, 6, v7
    v_bfe_u32 v9, v1, 4, 1
    v_lshl_add_u32 v7, v9, 7, v7
    v_bfe_u32 v9, v1, 2, 2
    v_lshl_add_u32 v7, v9, 8, v7
    v_add_u32 v7, 159744, v7
    s_waitcnt vmcnt(2)
    s_waitcnt lgkmcnt(0)
    s_barrier
    s_cmp_lg_u32 s3, 0
    s_cbranch_scc1 L_PD
    v_mov_b32 v6, s4
    s_mov_b32 exec_hi, 0
    s_mov_b32 exec_lo, 65535
    buffer_store_dword v6, v5, s[32:35], s15 offen sc1
    s_mov_b64 exec, -1
L_PD:
    s_waitcnt vmcnt(1)
    v_bitop3_b32 v6, v29, v31, s4 bitop3:0x7e
    v_cmp_ne_u32 vcc, 0, v6
    s_cbranch_vccz L_MGOK
POLL_29:
    buffer_load_dwordx4 v[28:31], v2, s[32:35], s18 offen sc1
    s_waitcnt vmcnt(0)
    v_bitop3_b32 v6, v29, v31, s4 bitop3:0x7e
    v_cmp_ne_u32 vcc, 0, v6
    s_cbranch_vccz PDONE_30
    s_add_u32 s5, s5, 1
    s_cmp_lt_u32 s5, 200000
    s_cbranch_scc1 POLL_29
PDONE_30:
L_MGOK:
    ds_write2_b32 v4, v28, v30 offset0:0 offset1:4
    s_waitcnt lgkmcnt(0)
    s_barrier
    s_lshl_b32 s96, s2, 12
    s_lshr_b32 s97, s17, 6
    s_add_u32 s98, s96, s97
    s_add_u32 s99, s98, 1048576
    s_add_u32 s18, s99, 1024
    ds_read_b128 v[192:195], v7
    ds_read_b128 v[196:199], v7 offset:1024
    ds_read_b128 v[200:203], v7 offset:2048
    ds_read_b128 v[204:207], v7 offset:3072
    v_and_b32 v8, 3, v1
    v_lshlrev_b32 v8, 2, v8
    v_lshrrev_b32 v9, 5, v1
    v_lshl_add_u32 v8, v9, 4, v8
    v_bfe_u32 v9, v1, 4, 1
    v_lshl_add_u32 v8, v9, 5, v8
    v_bfe_u32 v9, v1, 2, 2
    v_lshl_add_u32 v8, v9, 6, v8
    v_add_u32 v8, 157184, v8
    s_lshl4_add_u32 s96, s21, s12
    s_lshl_b32 s97, s96, 6
    s_add_u32 s13, s97, 14155776
    s_waitcnt lgkmcnt(0)
    s_load_dwordx2 s[24:25], s[32:33], s18 offset:0 glc
    v_pk_add_f32 v[192:193], v[192:193], v[194:195]
    v_add_f32 v28, v192, v193
    v_pk_add_f32 v[196:197], v[196:197], v[198:199]
    v_add_f32 v29, v196, v197
    v_pk_add_f32 v[200:201], v[200:201], v[202:203]
    v_add_f32 v30, v200, v201
    v_pk_add_f32 v[204:205], v[204:205], v[206:207]
    v_add_f32 v31, v204, v205
    v_cvt_pk_bf16_f32 v28, 0, v28
    v_cvt_pk_bf16_f32 v29, 0, v29
    v_cvt_pk_bf16_f32 v30, 0, v30
    v_cvt_pk_bf16_f32 v31, 0, v31
    v_add_f32 v30, 1.0, v30
    v_lshlrev_b32 v32, 16, v32
    v_cvt_pk_bf16_f32 v30, 0, v30
    ds_write_b32 v8, v31
    v_mul_f32 v192, v30, v32
    v_cvt_pk_bf16_f32 v193, 0, v192
    v_sub_f32 v194, v192, v193
    v_add_f32_dpp v192, v192, v192 quad_perm:[1,0,3,2] row_mask:0xf bank_mask:0xf
    s_nop 1
    v_add_f32_dpp v192, v192, v192 quad_perm:[2,3,0,1] row_mask:0xf bank_mask:0xf
    s_nop 1
    v_add_f32_dpp v192, v192, v192 row_half_mirror row_mask:0xf bank_mask:0xf
    s_nop 1
    v_add_f32_dpp v192, v192, v192 row_ror:8 row_mask:0xf bank_mask:0xf
    v_mov_b32 v199, v192
    s_nop 1
    v_permlane16_swap_b32 v192, v199
    v_add_f32 v192, v192, v199
    v_mov_b32 v199, v192
    s_nop 1
    v_permlane32_swap_b32 v192, v199
    v_add_f32 v192, v192, v199
    v_mov_b32_dpp v196, v193 row_shl:1 row_mask:0xf bank_mask:0xf
    v_mov_b32_dpp v197, v194 row_shl:1 row_mask:0xf bank_mask:0xf
    v_mov_b32_dpp v198, v32 row_shl:1 row_mask:0xf bank_mask:0xf
    v_cvt_pk_bf16_f32 v196, v193, v196
    v_cvt_pk_bf16_f32 v197, v194, v197
    v_cvt_pk_bf16_f32 v198, v32, v198
    v_mov_b32 v193, s4
    v_mov_b32 v194, 0
    s_cmp_lg_u32 s3, 2
    s_cbranch_scc1 L_NOUP
    s_mov_b64 exec, 1
    buffer_store_dwordx2 v[192:193], v194, s[32:35], s13 offen sc1
    s_mov_b64 exec, -1
L_NOUP:
    v_mov_b32 v184, 0x3f803f80
    s_nop 1
    v_mov_b32_dpp v184, v196 row_newbcast:0 row_mask:0xf bank_mask:0x2
    s_nop 1
    v_mov_b32_dpp v184, v197 row_newbcast:0 row_mask:0xf bank_mask:0x4
    s_nop 1
    v_mov_b32_dpp v184, v198 row_newbcast:0 row_mask:0xf bank_mask:0x8
    v_mov_b32 v185, 0x3f803f80
    s_nop 1
    v_mov_b32_dpp v185, v196 row_newbcast:2 row_mask:0xf bank_mask:0x2
    s_nop 1
    v_mov_b32_dpp v185, v197 row_newbcast:2 row_mask:0xf bank_mask:0x4
    s_nop 1
    v_mov_b32_dpp v185, v198 row_newbcast:2 row_mask:0xf bank_mask:0x8
    v_mov_b32 v186, 0x3f803f80
    s_nop 1
    v_mov_b32_dpp v186, v196 row_newbcast:4 row_mask:0xf bank_mask:0x2
    s_nop 1
    v_mov_b32_dpp v186, v197 row_newbcast:4 row_mask:0xf bank_mask:0x4
    s_nop 1
    v_mov_b32_dpp v186, v198 row_newbcast:4 row_mask:0xf bank_mask:0x8
    v_mov_b32 v187, 0x3f803f80
    s_nop 1
    v_mov_b32_dpp v187, v196 row_newbcast:6 row_mask:0xf bank_mask:0x2
    s_nop 1
    v_mov_b32_dpp v187, v197 row_newbcast:6 row_mask:0xf bank_mask:0x4
    s_nop 1
    v_mov_b32_dpp v187, v198 row_newbcast:6 row_mask:0xf bank_mask:0x8
    v_mov_b32 v188, 0x3f803f80
    s_nop 1
    v_mov_b32_dpp v188, v196 row_newbcast:8 row_mask:0xf bank_mask:0x2
    s_nop 1
    v_mov_b32_dpp v188, v197 row_newbcast:8 row_mask:0xf bank_mask:0x4
    s_nop 1
    v_mov_b32_dpp v188, v198 row_newbcast:8 row_mask:0xf bank_mask:0x8
    v_mov_b32 v189, 0x3f803f80
    s_nop 1
    v_mov_b32_dpp v189, v196 row_newbcast:10 row_mask:0xf bank_mask:0x2
    s_nop 1
    v_mov_b32_dpp v189, v197 row_newbcast:10 row_mask:0xf bank_mask:0x4
    s_nop 1
    v_mov_b32_dpp v189, v198 row_newbcast:10 row_mask:0xf bank_mask:0x8
    v_mov_b32 v190, 0x3f803f80
    s_nop 1
    v_mov_b32_dpp v190, v196 row_newbcast:12 row_mask:0xf bank_mask:0x2
    s_nop 1
    v_mov_b32_dpp v190, v197 row_newbcast:12 row_mask:0xf bank_mask:0x4
    s_nop 1
    v_mov_b32_dpp v190, v198 row_newbcast:12 row_mask:0xf bank_mask:0x8
    v_mov_b32 v191, 0x3f803f80
    s_nop 1
    v_mov_b32_dpp v191, v196 row_newbcast:14 row_mask:0xf bank_mask:0x2
    s_nop 1
    v_mov_b32_dpp v191, v197 row_newbcast:14 row_mask:0xf bank_mask:0x4
    s_nop 1
    v_mov_b32_dpp v191, v198 row_newbcast:14 row_mask:0xf bank_mask:0x8
    v_mov_b32 v42, v29
    v_mov_b32 v43, v31
    v_mov_b32 v33, v30
    v_mov_b32_dpp v136, v28 row_newbcast:0 row_mask:0xf bank_mask:0xf
    v_mov_b32_dpp v137, v28 row_newbcast:1 row_mask:0xf bank_mask:0xf
    v_mov_b32_dpp v138, v28 row_newbcast:2 row_mask:0xf bank_mask:0xf
    v_mov_b32_dpp v139, v28 row_newbcast:3 row_mask:0xf bank_mask:0xf
    v_mov_b32_dpp v140, v28 row_newbcast:4 row_mask:0xf bank_mask:0xf
    v_mov_b32_dpp v141, v28 row_newbcast:5 row_mask:0xf bank_mask:0xf
    v_mov_b32_dpp v142, v28 row_newbcast:6 row_mask:0xf bank_mask:0xf
    v_mov_b32_dpp v143, v28 row_newbcast:7 row_mask:0xf bank_mask:0xf
    v_mov_b32_dpp v144, v28 row_newbcast:8 row_mask:0xf bank_mask:0xf
    v_mov_b32_dpp v145, v28 row_newbcast:9 row_mask:0xf bank_mask:0xf
    v_mov_b32_dpp v146, v28 row_newbcast:10 row_mask:0xf bank_mask:0xf
    v_mov_b32_dpp v147, v28 row_newbcast:11 row_mask:0xf bank_mask:0xf
    v_mov_b32_dpp v148, v28 row_newbcast:12 row_mask:0xf bank_mask:0xf
    v_mov_b32_dpp v149, v28 row_newbcast:13 row_mask:0xf bank_mask:0xf
    v_mov_b32_dpp v150, v28 row_newbcast:14 row_mask:0xf bank_mask:0xf
    v_mov_b32_dpp v151, v28 row_newbcast:15 row_mask:0xf bank_mask:0xf
    s_branch SCHK_32
SPOLL_31:
    s_load_dwordx2 s[24:25], s[32:33], s18 offset:0 glc
SCHK_32:
    s_add_u32 s5, s5, 1
    s_cmp_ge_u32 s5, 200000
    s_waitcnt lgkmcnt(0)
    s_cbranch_scc1 SDONE_33
    s_cmp_lg_u32 s24, s4
    s_cbranch_scc1 SPOLL_31
    s_cmp_lg_u32 s25, s4
    s_cbranch_scc1 SPOLL_31
SDONE_33:
    s_add_u32 s20, s17, s19
    buffer_load_dwordx4 v[224:227], v2, s[32:35], s20 offen sc1
    ds_read_b64_tr_b16 v[192:193], v36
    ds_read_b64_tr_b16 v[194:195], v36 offset:512
    ds_read_b64_tr_b16 v[196:197], v37
    ds_read_b64_tr_b16 v[198:199], v37 offset:512
    ds_read_b64_tr_b16 v[200:201], v38
    ds_read_b64_tr_b16 v[202:203], v38 offset:512
    ds_read_b64_tr_b16 v[204:205], v39
    ds_read_b64_tr_b16 v[206:207], v39 offset:512
    ds_read_b64_tr_b16 v[208:209], v36 offset:4096
    ds_read_b64_tr_b16 v[210:211], v36 offset:4608
    ds_read_b64_tr_b16 v[212:213], v37 offset:4096
    ds_read_b64_tr_b16 v[214:215], v37 offset:4608
    ds_read_b64_tr_b16 v[216:217], v38 offset:4096
    ds_read_b64_tr_b16 v[218:219], v38 offset:4608
    buffer_load_dwordx4 v[228:231], v2, s[32:35], s20 offen offset:1024 sc1
    buffer_load_dwordx4 v[232:235], v2, s[32:35], s20 offen offset:2048 sc1
    buffer_load_dwordx4 v[236:239], v2, s[32:35], s20 offen offset:3072 sc1
    s_barrier
    s_xor_b32 s96, s17, 4096
    s_add_u32 s20, s96, s19
    buffer_load_dwordx4 v[240:243], v2, s[32:35], s20 offen sc1
    buffer_load_dwordx4 v[244:247], v2, s[32:35], s20 offen offset:1024 sc1
    buffer_load_dwordx4 v[44:47], v2, s[32:35], s20 offen offset:2048 sc1
    buffer_load_dwordx4 v[48:51], v2, s[32:35], s20 offen offset:3072 sc1
    s_lshl_b32 s96, s21, 10
    s_add_u32 s13, s96, 14155776
    v_and_b32 v10, 15, v1
    v_lshlrev_b32 v10, 6, v10
    s_cmp_lt_u32 s3, 4
    s_cbranch_scc1 L_G2P0
    s_setprio 1
L_G2P0:
    s_waitcnt vmcnt(7)
    s_waitcnt lgkmcnt(6)
    v_mfma_f32_16x16x32_bf16 v[120:123], v[192:195], v[224:227], 0
    ds_read_b64_tr_b16 v[220:221], v39 offset:4096
    ds_read_b64_tr_b16 v[222:223], v39 offset:4608
    v_mfma_f32_16x16x32_bf16 v[124:127], v[196:199], v[224:227], 0
    ds_read_b64_tr_b16 v[192:193], v36 offset:8192
    ds_read_b64_tr_b16 v[194:195], v36 offset:8704
    v_mfma_f32_16x16x32_bf16 v[128:131], v[200:203], v[224:227], 0
    ds_read_b64_tr_b16 v[196:197], v37 offset:8192
    ds_read_b64_tr_b16 v[198:199], v37 offset:8704
    v_mfma_f32_16x16x32_bf16 v[132:135], v[204:207], v[224:227], 0
    ds_read_b64_tr_b16 v[200:201], v38 offset:8192
    ds_read_b64_tr_b16 v[202:203], v38 offset:8704
    s_xor_b32 s96, s17, 8192
    s_add_u32 s20, s96, s19
    buffer_load_dwordx4 v[224:227], v2, s[32:35], s20 offen sc1
    s_waitcnt vmcnt(7)
    s_waitcnt lgkmcnt(6)
    v_mfma_f32_16x16x32_bf16 v[120:123], v[208:211], v[228:231], v[120:123]
    ds_read_b64_tr_b16 v[204:205], v39 offset:8192
    ds_read_b64_tr_b16 v[206:207], v39 offset:8704
    v_mfma_f32_16x16x32_bf16 v[124:127], v[212:215], v[228:231], v[124:127]
    ds_read_b64_tr_b16 v[208:209], v36 offset:12288
    ds_read_b64_tr_b16 v[210:211], v36 offset:12800
    v_xor_b32 v36, 16384, v36
    v_mfma_f32_16x16x32_bf16 v[128:131], v[216:219], v[228:231], v[128:131]
    ds_read_b64_tr_b16 v[212:213], v37 offset:12288
    ds_read_b64_tr_b16 v[214:215], v37 offset:12800
    v_xor_b32 v37, 16384, v37
    v_mfma_f32_16x16x32_bf16 v[132:135], v[220:223], v[228:231], v[132:135]
    ds_read_b64_tr_b16 v[216:217], v38 offset:12288
    ds_read_b64_tr_b16 v[218:219], v38 offset:12800
    v_xor_b32 v38, 16384, v38
    buffer_load_dwordx4 v[228:231], v2, s[32:35], s20 offen offset:1024 sc1
    s_waitcnt vmcnt(7)
    s_waitcnt lgkmcnt(6)
    v_mfma_f32_16x16x32_bf16 v[120:123], v[192:195], v[232:235], v[120:123]
    ds_read_b64_tr_b16 v[220:221], v39 offset:12288
    ds_read_b64_tr_b16 v[222:223], v39 offset:12800
    v_xor_b32 v39, 16384, v39
    v_mfma_f32_16x16x32_bf16 v[124:127], v[196:199], v[232:235], v[124:127]
    ds_read_b64_tr_b16 v[192:193], v36
    ds_read_b64_tr_b16 v[194:195], v36 offset:512
    v_mfma_f32_16x16x32_bf16 v[128:131], v[200:203], v[232:235], v[128:131]
    ds_read_b64_tr_b16 v[196:197], v37
    ds_read_b64_tr_b16 v[198:199], v37 offset:512
    v_mfma_f32_16x16x32_bf16 v[132:135], v[204:207], v[232:235], v[132:135]
    ds_read_b64_tr_b16 v[200:201], v38
    ds_read_b64_tr_b16 v[202:203], v38 offset:512
    buffer_load_dwordx4 v[232:235], v2, s[32:35], s20 offen offset:2048 sc1
    s_waitcnt vmcnt(7)
    s_waitcnt lgkmcnt(6)
    v_mfma_f32_16x16x32_bf16 v[120:123], v[208:211], v[236:239], v[120:123]
    ds_read_b64_tr_b16 v[204:205], v39
    ds_read_b64_tr_b16 v[206:207], v39 offset:512
    v_mfma_f32_16x16x32_bf16 v[124:127], v[212:215], v[236:239], v[124:127]
    ds_read_b64_tr_b16 v[208:209], v36 offset:4096
    ds_read_b64_tr_b16 v[210:211], v36 offset:4608
    v_mfma_f32_16x16x32_bf16 v[128:131], v[216:219], v[236:239], v[128:131]
    ds_read_b64_tr_b16 v[212:213], v37 offset:4096
    ds_read_b64_tr_b16 v[214:215], v37 offset:4608
    v_mfma_f32_16x16x32_bf16 v[132:135], v[220:223], v[236:239], v[132:135]
    ds_read_b64_tr_b16 v[216:217], v38 offset:4096
    ds_read_b64_tr_b16 v[218:219], v38 offset:4608
    buffer_load_dwordx4 v[236:239], v2, s[32:35], s20 offen offset:3072 sc1
    s_waitcnt vmcnt(7)
    s_waitcnt lgkmcnt(6)
    v_mfma_f32_16x16x32_bf16 v[120:123], v[192:195], v[240:243], v[120:123]
    ds_read_b64_tr_b16 v[220:221], v39 offset:4096
    ds_read_b64_tr_b16 v[222:223], v39 offset:4608
    v_mfma_f32_16x16x32_bf16 v[124:127], v[196:199], v[240:243], v[124:127]
    ds_read_b64_tr_b16 v[192:193], v36 offset:8192
    ds_read_b64_tr_b16 v[194:195], v36 offset:8704
    v_mfma_f32_16x16x32_bf16 v[128:131], v[200:203], v[240:243], v[128:131]
    ds_read_b64_tr_b16 v[196:197], v37 offset:8192
    ds_read_b64_tr_b16 v[198:199], v37 offset:8704
    v_mfma_f32_16x16x32_bf16 v[132:135], v[204:207], v[240:243], v[132:135]
    ds_read_b64_tr_b16 v[200:201], v38 offset:8192
    ds_read_b64_tr_b16 v[202:203], v38 offset:8704
    s_xor_b32 s96, s17, 12288
    s_add_u32 s20, s96, s19
    buffer_load_dwordx4 v[240:243], v2, s[32:35], s20 offen sc1
    s_waitcnt vmcnt(7)
    s_waitcnt lgkmcnt(6)
    v_mfma_f32_16x16x32_bf16 v[120:123], v[208:211], v[244:247], v[120:123]
    ds_read_b64_tr_b16 v[204:205], v39 offset:8192
    ds_read_b64_tr_b16 v[206:207], v39 offset:8704
    v_mfma_f32_16x16x32_bf16 v[124:127], v[212:215], v[244:247], v[124:127]
    ds_read_b64_tr_b16 v[208:209], v36 offset:12288
    ds_read_b64_tr_b16 v[210:211], v36 offset:12800
    v_xor_b32 v36, 49152, v36
    v_mfma_f32_16x16x32_bf16 v[128:131], v[216:219], v[244:247], v[128:131]
    ds_read_b64_tr_b16 v[212:213], v37 offset:12288
    ds_read_b64_tr_b16 v[214:215], v37 offset:12800
    v_xor_b32 v37, 49152, v37
    v_mfma_f32_16x16x32_bf16 v[132:135], v[220:223], v[244:247], v[132:135]
    ds_read_b64_tr_b16 v[216:217], v38 offset:12288
    ds_read_b64_tr_b16 v[218:219], v38 offset:12800
    v_xor_b32 v38, 49152, v38
    buffer_load_dwordx4 v[244:247], v2, s[32:35], s20 offen offset:1024 sc1
    s_waitcnt vmcnt(7)
    s_waitcnt lgkmcnt(6)
    v_mfma_f32_16x16x32_bf16 v[120:123], v[192:195], v[44:47], v[120:123]
    ds_read_b64_tr_b16 v[220:221], v39 offset:12288
    ds_read_b64_tr_b16 v[222:223], v39 offset:12800
    v_xor_b32 v39, 49152, v39
    v_mfma_f32_16x16x32_bf16 v[124:127], v[196:199], v[44:47], v[124:127]
    ds_read_b64_tr_b16 v[192:193], v36
    ds_read_b64_tr_b16 v[194:195], v36 offset:512
    v_mfma_f32_16x16x32_bf16 v[128:131], v[200:203], v[44:47], v[128:131]
    ds_read_b64_tr_b16 v[196:197], v37
    ds_read_b64_tr_b16 v[198:199], v37 offset:512
    v_mfma_f32_16x16x32_bf16 v[132:135], v[204:207], v[44:47], v[132:135]
    ds_read_b64_tr_b16 v[200:201], v38
    ds_read_b64_tr_b16 v[202:203], v38 offset:512
    buffer_load_dwordx4 v[44:47], v2, s[32:35], s20 offen offset:2048 sc1
    s_waitcnt vmcnt(7)
    s_waitcnt lgkmcnt(6)
    v_mfma_f32_16x16x32_bf16 v[120:123], v[208:211], v[48:51], v[120:123]
    ds_read_b64_tr_b16 v[204:205], v39
    ds_read_b64_tr_b16 v[206:207], v39 offset:512
    v_mfma_f32_16x16x32_bf16 v[124:127], v[212:215], v[48:51], v[124:127]
    ds_read_b64_tr_b16 v[208:209], v36 offset:4096
    ds_read_b64_tr_b16 v[210:211], v36 offset:4608
    v_mfma_f32_16x16x32_bf16 v[128:131], v[216:219], v[48:51], v[128:131]
    ds_read_b64_tr_b16 v[212:213], v37 offset:4096
    ds_read_b64_tr_b16 v[214:215], v37 offset:4608
    v_mfma_f32_16x16x32_bf16 v[132:135], v[220:223], v[48:51], v[132:135]
    ds_read_b64_tr_b16 v[216:217], v38 offset:4096
    ds_read_b64_tr_b16 v[218:219], v38 offset:4608
    buffer_load_dwordx4 v[48:51], v2, s[32:35], s20 offen offset:3072 sc1
    s_waitcnt vmcnt(7)
    s_waitcnt lgkmcnt(6)
    v_mfma_f32_16x16x32_bf16 v[120:123], v[192:195], v[224:227], v[120:123]
    ds_read_b64_tr_b16 v[220:221], v39 offset:4096
    ds_read_b64_tr_b16 v[222:223], v39 offset:4608
    v_mfma_f32_16x16x32_bf16 v[124:127], v[196:199], v[224:227], v[124:127]
    ds_read_b64_tr_b16 v[192:193], v36 offset:8192
    ds_read_b64_tr_b16 v[194:195], v36 offset:8704
    v_mfma_f32_16x16x32_bf16 v[128:131], v[200:203], v[224:227], v[128:131]
    ds_read_b64_tr_b16 v[196:197], v37 offset:8192
    ds_read_b64_tr_b16 v[198:199], v37 offset:8704
    v_mfma_f32_16x16x32_bf16 v[132:135], v[204:207], v[224:227], v[132:135]
    ds_read_b64_tr_b16 v[200:201], v38 offset:8192
    ds_read_b64_tr_b16 v[202:203], v38 offset:8704
    s_xor_b32 s96, s17, 16384
    s_add_u32 s20, s96, s19
    buffer_load_dwordx4 v[224:227], v2, s[32:35], s20 offen sc1
    s_waitcnt vmcnt(7)
    s_waitcnt lgkmcnt(6)
    v_mfma_f32_16x16x32_bf16 v[120:123], v[208:211], v[228:231], v[120:123]
    ds_read_b64_tr_b16 v[204:205], v39 offset:8192
    ds_read_b64_tr_b16 v[206:207], v39 offset:8704
    v_mfma_f32_16x16x32_bf16 v[124:127], v[212:215], v[228:231], v[124:127]
    ds_read_b64_tr_b16 v[208:209], v36 offset:12288
    ds_read_b64_tr_b16 v[210:211], v36 offset:12800
    v_xor_b32 v36, 16384, v36
    v_mfma_f32_16x16x32_bf16 v[128:131], v[216:219], v[228:231], v[128:131]
    ds_read_b64_tr_b16 v[212:213], v37 offset:12288
    ds_read_b64_tr_b16 v[214:215], v37 offset:12800
    v_xor_b32 v37, 16384, v37
L_PAD8:
    s_cbranch_execz L_RET8
    v_mfma_f32_16x16x32_bf16 v[132:135], v[220:223], v[228:231], v[132:135]
    ds_read_b64_tr_b16 v[216:217], v38 offset:12288
    ds_read_b64_tr_b16 v[218:219], v38 offset:12800
    v_xor_b32 v38, 16384, v38
    buffer_load_dwordx4 v[228:231], v2, s[32:35], s20 offen offset:1024 sc1
    s_waitcnt vmcnt(7)
    s_waitcnt lgkmcnt(6)
    v_mfma_f32_16x16x32_bf16 v[120:123], v[192:195], v[232:235], v[120:123]
    ds_read_b64_tr_b16 v[220:221], v39 offset:12288
    ds_read_b64_tr_b16 v[222:223], v39 offset:12800
    v_xor_b32 v39, 16384, v39
    v_mfma_f32_16x16x32_bf16 v[124:127], v[196:199], v[232:235], v[124:127]
    ds_read_b64_tr_b16 v[192:193], v36
    ds_read_b64_tr_b16 v[194:195], v36 offset:512
    v_mfma_f32_16x16x32_bf16 v[128:131], v[200:203], v[232:235], v[128:131]
    ds_read_b64_tr_b16 v[196:197], v37
    ds_read_b64_tr_b16 v[198:199], v37 offset:512
    v_mfma_f32_16x16x32_bf16 v[132:135], v[204:207], v[232:235], v[132:135]
    ds_read_b64_tr_b16 v[200:201], v38
    ds_read_b64_tr_b16 v[202:203], v38 offset:512
    buffer_load_dwordx4 v[232:235], v2, s[32:35], s20 offen offset:2048 sc1
    s_waitcnt vmcnt(7)
    s_waitcnt lgkmcnt(6)
    v_mfma_f32_16x16x32_bf16 v[120:123], v[208:211], v[236:239], v[120:123]
    ds_read_b64_tr_b16 v[204:205], v39
    ds_read_b64_tr_b16 v[206:207], v39 offset:512
    v_mfma_f32_16x16x32_bf16 v[124:127], v[212:215], v[236:239], v[124:127]
    ds_read_b64_tr_b16 v[208:209], v36 offset:4096
    ds_read_b64_tr_b16 v[210:211], v36 offset:4608
    v_mfma_f32_16x16x32_bf16 v[128:131], v[216:219], v[236:239], v[128:131]
    ds_read_b64_tr_b16 v[212:213], v37 offset:4096
    ds_read_b64_tr_b16 v[214:215], v37 offset:4608
    v_mfma_f32_16x16x32_bf16 v[132:135], v[220:223], v[236:239], v[132:135]
    ds_read_b64_tr_b16 v[216:217], v38 offset:4096
    ds_read_b64_tr_b16 v[218:219], v38 offset:4608
    buffer_load_dwordx4 v[236:239], v2, s[32:35], s20 offen offset:3072 sc1
    s_waitcnt vmcnt(7)
    s_waitcnt lgkmcnt(6)
    v_mfma_f32_16x16x32_bf16 v[120:123], v[192:195], v[240:243], v[120:123]
    ds_read_b64_tr_b16 v[220:221], v39 offset:4096
    ds_read_b64_tr_b16 v[222:223], v39 offset:4608
    v_mfma_f32_16x16x32_bf16 v[124:127], v[196:199], v[240:243], v[124:127]
    ds_read_b64_tr_b16 v[192:193], v36 offset:8192
    ds_read_b64_tr_b16 v[194:195], v36 offset:8704
    v_mfma_f32_16x16x32_bf16 v[128:131], v[200:203], v[240:243], v[128:131]
    ds_read_b64_tr_b16 v[196:197], v37 offset:8192
    ds_read_b64_tr_b16 v[198:199], v37 offset:8704
    v_mfma_f32_16x16x32_bf16 v[132:135], v[204:207], v[240:243], v[132:135]
    ds_read_b64_tr_b16 v[200:201], v38 offset:8192
    ds_read_b64_tr_b16 v[202:203], v38 offset:8704
    s_xor_b32 s96, s17, 20480
    s_add_u32 s20, s96, s19
    buffer_load_dwordx4 v[240:243], v2, s[32:35], s20 offen sc1
    s_waitcnt vmcnt(7)
    s_waitcnt lgkmcnt(6)
    v_mfma_f32_16x16x32_bf16 v[120:123], v[208:211], v[244:247], v[120:123]
    ds_read_b64_tr_b16 v[204:205], v39 offset:8192
    ds_read_b64_tr_b16 v[206:207], v39 offset:8704
    v_mfma_f32_16x16x32_bf16 v[124:127], v[212:215], v[244:247], v[124:127]
    ds_read_b64_tr_b16 v[208:209], v36 offset:12288
    ds_read_b64_tr_b16 v[210:211], v36 offset:12800
    v_xor_b32 v36, 114688, v36
    v_mfma_f32_16x16x32_bf16 v[128:131], v[216:219], v[244:247], v[128:131]
    ds_read_b64_tr_b16 v[212:213], v37 offset:12288
    ds_read_b64_tr_b16 v[214:215], v37 offset:12800
    v_xor_b32 v37, 114688, v37
    v_mfma_f32_16x16x32_bf16 v[132:135], v[220:223], v[244:247], v[132:135]
    ds_read_b64_tr_b16 v[216:217], v38 offset:12288
    ds_read_b64_tr_b16 v[218:219], v38 offset:12800
    v_xor_b32 v38, 114688, v38
    buffer_load_dwordx4 v[244:247], v2, s[32:35], s20 offen offset:1024 sc1
    s_waitcnt vmcnt(7)
    s_waitcnt lgkmcnt(6)
    v_mfma_f32_16x16x32_bf16 v[120:123], v[192:195], v[44:47], v[120:123]
    ds_read_b64_tr_b16 v[220:221], v39 offset:12288
    ds_read_b64_tr_b16 v[222:223], v39 offset:12800
    v_xor_b32 v39, 114688, v39
    v_mfma_f32_16x16x32_bf16 v[124:127], v[196:199], v[44:47], v[124:127]
    ds_read_b64_tr_b16 v[192:193], v36
    ds_read_b64_tr_b16 v[194:195], v36 offset:512
    v_mfma_f32_16x16x32_bf16 v[128:131], v[200:203], v[44:47], v[128:131]
    ds_read_b64_tr_b16 v[196:197], v37
    ds_read_b64_tr_b16 v[198:199], v37 offset:512
    v_mfma_f32_16x16x32_bf16 v[132:135], v[204:207], v[44:47], v[132:135]
    ds_read_b64_tr_b16 v[200:201], v38
    ds_read_b64_tr_b16 v[202:203], v38 offset:512
    buffer_load_dwordx4 v[44:47], v2, s[32:35], s20 offen offset:2048 sc1
    s_waitcnt vmcnt(7)
    s_waitcnt lgkmcnt(6)
    v_mfma_f32_16x16x32_bf16 v[120:123], v[208:211], v[48:51], v[120:123]
    ds_read_b64_tr_b16 v[204:205], v39
    ds_read_b64_tr_b16 v[206:207], v39 offset:512
    v_mfma_f32_16x16x32_bf16 v[124:127], v[212:215], v[48:51], v[124:127]
    ds_read_b64_tr_b16 v[208:209], v36 offset:4096
    ds_read_b64_tr_b16 v[210:211], v36 offset:4608
    v_mfma_f32_16x16x32_bf16 v[128:131], v[216:219], v[48:51], v[128:131]
    ds_read_b64_tr_b16 v[212:213], v37 offset:4096
    ds_read_b64_tr_b16 v[214:215], v37 offset:4608
    v_mfma_f32_16x16x32_bf16 v[132:135], v[220:223], v[48:51], v[132:135]
    ds_read_b64_tr_b16 v[216:217], v38 offset:4096
    ds_read_b64_tr_b16 v[218:219], v38 offset:4608
    buffer_load_dwordx4 v[48:51], v2, s[32:35], s20 offen offset:3072 sc1
    s_waitcnt vmcnt(7)
    s_waitcnt lgkmcnt(6)
    v_mfma_f32_16x16x32_bf16 v[120:123], v[192:195], v[224:227], v[120:123]
    ds_read_b64_tr_b16 v[220:221], v39 offset:4096
    ds_read_b64_tr_b16 v[222:223], v39 offset:4608
    v_mfma_f32_16x16x32_bf16 v[124:127], v[196:199], v[224:227], v[124:127]
    ds_read_b64_tr_b16 v[192:193], v36 offset:8192
    ds_read_b64_tr_b16 v[194:195], v36 offset:8704
    v_mfma_f32_16x16x32_bf16 v[128:131], v[200:203], v[224:227], v[128:131]
    ds_read_b64_tr_b16 v[196:197], v37 offset:8192
    ds_read_b64_tr_b16 v[198:199], v37 offset:8704
    v_mfma_f32_16x16x32_bf16 v[132:135], v[204:207], v[224:227], v[132:135]
    ds_read_b64_tr_b16 v[200:201], v38 offset:8192
    ds_read_b64_tr_b16 v[202:203], v38 offset:8704
    s_xor_b32 s96, s17, 24576
    s_add_u32 s20, s96, s19
    buffer_load_dwordx4 v[224:227], v2, s[32:35], s20 offen sc1
    s_waitcnt vmcnt(7)
    s_waitcnt lgkmcnt(6)
    v_mfma_f32_16x16x32_bf16 v[120:123], v[208:211], v[228:231], v[120:123]
    ds_read_b64_tr_b16 v[204:205], v39 offset:8192
    ds_read_b64_tr_b16 v[206:207], v39 offset:8704
    v_mfma_f32_16x16x32_bf16 v[124:127], v[212:215], v[228:231], v[124:127]
    ds_read_b64_tr_b16 v[208:209], v36 offset:12288
    ds_read_b64_tr_b16 v[210:211], v36 offset:12800
    v_xor_b32 v36, 16384, v36
    v_mfma_f32_16x16x32_bf16 v[128:131], v[216:219], v[228:231], v[128:131]
    ds_read_b64_tr_b16 v[212:213], v37 offset:12288
    ds_read_b64_tr_b16 v[214:215], v37 offset:12800
    v_xor_b32 v37, 16384, v37
    v_mfma_f32_16x16x32_bf16 v[132:135], v[220:223], v[228:231], v[132:135]
    ds_read_b64_tr_b16 v[216:217], v38 offset:12288
    ds_read_b64_tr_b16 v[218:219], v38 offset:12800
    v_xor_b32 v38, 16384, v38
    buffer_load_dwordx4 v[228:231], v2, s[32:35], s20 offen offset:1024 sc1
    s_waitcnt vmcnt(7)
    s_waitcnt lgkmcnt(6)
    v_mfma_f32_16x16x32_bf16 v[120:123], v[192:195], v[232:235], v[120:123]
    ds_read_b64_tr_b16 v[220:221], v39 offset:12288
    ds_read_b64_tr_b16 v[222:223], v39 offset:12800
    v_xor_b32 v39, 16384, v39
    v_mfma_f32_16x16x32_bf16 v[124:127], v[196:199], v[232:235], v[124:127]
    ds_read_b64_tr_b16 v[192:193], v36
    ds_read_b64_tr_b16 v[194:195], v36 offset:512
    v_mfma_f32_16x16x32_bf16 v[128:131], v[200:203], v[232:235], v[128:131]
    ds_read_b64_tr_b16 v[196:197], v37
    ds_read_b64_tr_b16 v[198:199], v37 offset:512
    v_mfma_f32_16x16x32_bf16 v[132:135], v[204:207], v[232:235], v[132:135]
    ds_read_b64_tr_b16 v[200:201], v38
    ds_read_b64_tr_b16 v[202:203], v38 offset:512
    buffer_load_dwordx4 v[232:235], v2, s[32:35], s20 offen offset:2048 sc1
    s_waitcnt vmcnt(7)
    s_waitcnt lgkmcnt(6)
    v_mfma_f32_16x16x32_bf16 v[120:123], v[208:211], v[236:239], v[120:123]
    ds_read_b64_tr_b16 v[204:205], v39
    ds_read_b64_tr_b16 v[206:207], v39 offset:512
    v_mfma_f32_16x16x32_bf16 v[124:127], v[212:215], v[236:239], v[124:127]
    ds_read_b64_tr_b16 v[208:209], v36 offset:4096
    ds_read_b64_tr_b16 v[210:211], v36 offset:4608
    v_mfma_f32_16x16x32_bf16 v[128:131], v[216:219], v[236:239], v[128:131]
    ds_read_b64_tr_b16 v[212:213], v37 offset:4096
    ds_read_b64_tr_b16 v[214:215], v37 offset:4608
    v_mfma_f32_16x16x32_bf16 v[132:135], v[220:223], v[236:239], v[132:135]
    ds_read_b64_tr_b16 v[216:217], v38 offset:4096
    ds_read_b64_tr_b16 v[218:219], v38 offset:4608
    buffer_load_dwordx4 v[236:239], v2, s[32:35], s20 offen offset:3072 sc1
    s_waitcnt vmcnt(7)
    s_waitcnt lgkmcnt(6)
    v_mfma_f32_16x16x32_bf16 v[120:123], v[192:195], v[240:243], v[120:123]
    ds_read_b64_tr_b16 v[220:221], v39 offset:4096
    ds_read_b64_tr_b16 v[222:223], v39 offset:4608
    v_mfma_f32_16x16x32_bf16 v[124:127], v[196:199], v[240:243], v[124:127]
    ds_read_b64_tr_b16 v[192:193], v36 offset:8192
    ds_read_b64_tr_b16 v[194:195], v36 offset:8704
    v_mfma_f32_16x16x32_bf16 v[128:131], v[200:203], v[240:243], v[128:131]
    ds_read_b64_tr_b16 v[196:197], v37 offset:8192
    ds_read_b64_tr_b16 v[198:199], v37 offset:8704
    v_mfma_f32_16x16x32_bf16 v[132:135], v[204:207], v[240:243], v[132:135]
    ds_read_b64_tr_b16 v[200:201], v38 offset:8192
    ds_read_b64_tr_b16 v[202:203], v38 offset:8704
    s_xor_b32 s96, s17, 28672
    s_add_u32 s20, s96, s19
    buffer_load_dwordx4 v[240:243], v2, s[32:35], s20 offen sc1
    s_waitcnt vmcnt(7)
    s_waitcnt lgkmcnt(6)
    v_mfma_f32_16x16x32_bf16 v[120:123], v[208:211], v[244:247], v[120:123]
    ds_read_b64_tr_b16 v[204:205], v39 offset:8192
    ds_read_b64_tr_b16 v[206:207], v39 offset:8704
    v_mfma_f32_16x16x32_bf16 v[124:127], v[212:215], v[244:247], v[124:127]
    ds_read_b64_tr_b16 v[208:209], v36 offset:12288
    ds_read_b64_tr_b16 v[210:211], v36 offset:12800
    v_xor_b32 v36, 49152, v36
    v_mfma_f32_16x16x32_bf16 v[128:131], v[216:219], v[244:247], v[128:131]
    ds_read_b64_tr_b16 v[212:213], v37 offset:12288
    ds_read_b64_tr_b16 v[214:215], v37 offset:12800
    v_xor_b32 v37, 49152, v37
    v_mfma_f32_16x16x32_bf16 v[132:135], v[220:223], v[244:247], v[132:135]
    ds_read_b64_tr_b16 v[216:217], v38 offset:12288
    ds_read_b64_tr_b16 v[218:219], v38 offset:12800
    v_xor_b32 v38, 49152, v38
    buffer_load_dwordx4 v[244:247], v2, s[32:35], s20 offen offset:1024 sc1
    s_waitcnt vmcnt(7)
    s_waitcnt lgkmcnt(6)
    v_mfma_f32_16x16x32_bf16 v[120:123], v[192:195], v[44:47], v[120:123]
    ds_read_b64_tr_b16 v[220:221], v39 offset:12288
    ds_read_b64_tr_b16 v[222:223], v39 offset:12800
    v_xor_b32 v39, 49152, v39
    v_mfma_f32_16x16x32_bf16 v[124:127], v[196:199], v[44:47], v[124:127]
    ds_read_b64_tr_b16 v[192:193], v36
    ds_read_b64_tr_b16 v[194:195], v36 offset:512
    v_mfma_f32_16x16x32_bf16 v[128:131], v[200:203], v[44:47], v[128:131]
    ds_read_b64_tr_b16 v[196:197], v37
    ds_read_b64_tr_b16 v[198:199], v37 offset:512
    v_mfma_f32_16x16x32_bf16 v[132:135], v[204:207], v[44:47], v[132:135]
    ds_read_b64_tr_b16 v[200:201], v38
    ds_read_b64_tr_b16 v[202:203], v38 offset:512
    buffer_load_dwordx4 v[44:47], v2, s[32:35], s20 offen offset:2048 sc1
    s_waitcnt vmcnt(7)
    s_waitcnt lgkmcnt(6)
    v_mfma_f32_16x16x32_bf16 v[120:123], v[208:211], v[48:51], v[120:123]
    ds_read_b64_tr_b16 v[204:205], v39
    ds_read_b64_tr_b16 v[206:207], v39 offset:512
    v_mfma_f32_16x16x32_bf16 v[124:127], v[212:215], v[48:51], v[124:127]
    ds_read_b64_tr_b16 v[208:209], v36 offset:4096
    ds_read_b64_tr_b16 v[210:211], v36 offset:4608
    v_mfma_f32_16x16x32_bf16 v[128:131], v[216:219], v[48:51], v[128:131]
    ds_read_b64_tr_b16 v[212:213], v37 offset:4096
    ds_read_b64_tr_b16 v[214:215], v37 offset:4608
    v_mfma_f32_16x16x32_bf16 v[132:135], v[220:223], v[48:51], v[132:135]
    ds_read_b64_tr_b16 v[216:217], v38 offset:4096
    ds_read_b64_tr_b16 v[218:219], v38 offset:4608
    buffer_load_dwordx4 v[48:51], v2, s[32:35], s20 offen offset:3072 sc1
    buffer_load_dwordx2 v[40:41], v10, s[32:35], s13 offen sc1
    s_add_u32 s82, s80, 114688
    buffer_load_dwordx4 v[72:75], v27, s[52:55], s82 offen nt
    s_add_u32 s82, s80, 172032
    buffer_load_dwordx4 v[76:79], v27, s[52:55], s82 offen nt
    s_mov_b32 s82, s80
    buffer_load_dwordx4 v[80:83], v27, s[56:59], s82 offen nt
    s_waitcnt vmcnt(11)
    s_waitcnt lgkmcnt(6)
    v_mfma_f32_16x16x32_bf16 v[120:123], v[192:195], v[224:227], v[120:123]
    ds_read_b64_tr_b16 v[220:221], v39 offset:4096
    ds_read_b64_tr_b16 v[222:223], v39 offset:4608
    v_mfma_f32_16x16x32_bf16 v[124:127], v[196:199], v[224:227], v[124:127]
    ds_read_b64_tr_b16 v[192:193], v36 offset:8192
    ds_read_b64_tr_b16 v[194:195], v36 offset:8704
    v_mfma_f32_16x16x32_bf16 v[128:131], v[200:203], v[224:227], v[128:131]
    ds_read_b64_tr_b16 v[196:197], v37 offset:8192
    ds_read_b64_tr_b16 v[198:199], v37 offset:8704
    v_mfma_f32_16x16x32_bf16 v[132:135], v[204:207], v[224:227], v[132:135]
    ds_read_b64_tr_b16 v[200:201], v38 offset:8192
    ds_read_b64_tr_b16 v[202:203], v38 offset:8704
    s_waitcnt vmcnt(10)
    s_waitcnt lgkmcnt(6)
    v_mfma_f32_16x16x32_bf16 v[120:123], v[208:211], v[228:231], v[120:123]
    ds_read_b64_tr_b16 v[204:205], v39 offset:8192
    ds_read_b64_tr_b16 v[206:207], v39 offset:8704
    v_mfma_f32_16x16x32_bf16 v[124:127], v[212:215], v[228:231], v[124:127]
    ds_read_b64_tr_b16 v[208:209], v36 offset:12288
    ds_read_b64_tr_b16 v[210:211], v36 offset:12800
    v_xor_b32 v36, 16384, v36
    v_mfma_f32_16x16x32_bf16 v[128:131], v[216:219], v[228:231], v[128:131]
    ds_read_b64_tr_b16 v[212:213], v37 offset:12288
    ds_read_b64_tr_b16 v[214:215], v37 offset:12800
    v_xor_b32 v37, 16384, v37
    v_mfma_f32_16x16x32_bf16 v[132:135], v[220:223], v[228:231], v[132:135]
    ds_read_b64_tr_b16 v[216:217], v38 offset:12288
    ds_read_b64_tr_b16 v[218:219], v38 offset:12800
    v_xor_b32 v38, 16384, v38
    s_waitcnt vmcnt(9)
    s_waitcnt lgkmcnt(6)
    v_mfma_f32_16x16x32_bf16 v[120:123], v[192:195], v[232:235], v[120:123]
    ds_read_b64_tr_b16 v[220:221], v39 offset:12288
    ds_read_b64_tr_b16 v[222:223], v39 offset:12800
    v_xor_b32 v39, 16384, v39
    v_mfma_f32_16x16x32_bf16 v[124:127], v[196:199], v[232:235], v[124:127]
    ds_read_b64_tr_b16 v[192:193], v36
    ds_read_b64_tr_b16 v[194:195], v36 offset:512
    v_mfma_f32_16x16x32_bf16 v[128:131], v[200:203], v[232:235], v[128:131]
    ds_read_b64_tr_b16 v[196:197], v37
    ds_read_b64_tr_b16 v[198:199], v37 offset:512
    v_mfma_f32_16x16x32_bf16 v[132:135], v[204:207], v[232:235], v[132:135]
    ds_read_b64_tr_b16 v[200:201], v38
    ds_read_b64_tr_b16 v[202:203], v38 offset:512
    s_waitcnt vmcnt(8)
    s_waitcnt lgkmcnt(6)
    v_mfma_f32_16x16x32_bf16 v[120:123], v[208:211], v[236:239], v[120:123]
    ds_read_b64_tr_b16 v[204:205], v39
    ds_read_b64_tr_b16 v[206:207], v39 offset:512
    v_mfma_f32_16x16x32_bf16 v[124:127], v[212:215], v[236:239], v[124:127]
    ds_read_b64_tr_b16 v[208:209], v36 offset:4096
    ds_read_b64_tr_b16 v[210:211], v36 offset:4608
    v_mfma_f32_16x16x32_bf16 v[128:131], v[216:219], v[236:239], v[128:131]
    ds_read_b64_tr_b16 v[212:213], v37 offset:4096
    ds_read_b64_tr_b16 v[214:215], v37 offset:4608
    v_mfma_f32_16x16x32_bf16 v[132:135], v[220:223], v[236:239], v[132:135]
    ds_read_b64_tr_b16 v[216:217], v38 offset:4096
    ds_read_b64_tr_b16 v[218:219], v38 offset:4608
    s_cmp_lt_u32 s3, 4
    s_cbranch_scc1 L_G2P28
    s_setprio 0
L_G2P28:
    s_waitcnt vmcnt(7)
    s_waitcnt lgkmcnt(6)
    v_mfma_f32_16x16x32_bf16 v[120:123], v[192:195], v[240:243], v[120:123]
    ds_read_b64_tr_b16 v[220:221], v39 offset:4096
    ds_read_b64_tr_b16 v[222:223], v39 offset:4608
    v_mfma_f32_16x16x32_bf16 v[124:127], v[196:199], v[240:243], v[124:127]
    ds_read_b64_tr_b16 v[192:193], v36 offset:8192
    ds_read_b64_tr_b16 v[194:195], v36 offset:8704
    v_mfma_f32_16x16x32_bf16 v[128:131], v[200:203], v[240:243], v[128:131]
    ds_read_b64_tr_b16 v[196:197], v37 offset:8192
    ds_read_b64_tr_b16 v[198:199], v37 offset:8704
    v_mfma_f32_16x16x32_bf16 v[132:135], v[204:207], v[240:243], v[132:135]
    ds_read_b64_tr_b16 v[200:201], v38 offset:8192
    ds_read_b64_tr_b16 v[202:203], v38 offset:8704
    s_waitcnt vmcnt(6)
    s_waitcnt lgkmcnt(6)
    v_mfma_f32_16x16x32_bf16 v[120:123], v[208:211], v[244:247], v[120:123]
    ds_read_b64_tr_b16 v[204:205], v39 offset:8192
    ds_read_b64_tr_b16 v[206:207], v39 offset:8704
    v_mfma_f32_16x16x32_bf16 v[124:127], v[212:215], v[244:247], v[124:127]
    ds_read_b64_tr_b16 v[208:209], v36 offset:12288
    ds_read_b64_tr_b16 v[210:211], v36 offset:12800
    v_mfma_f32_16x16x32_bf16 v[128:131], v[216:219], v[244:247], v[128:131]
    ds_read_b64_tr_b16 v[212:213], v37 offset:12288
    ds_read_b64_tr_b16 v[214:215], v37 offset:12800
    v_mfma_f32_16x16x32_bf16 v[132:135], v[220:223], v[244:247], v[132:135]
    ds_read_b64_tr_b16 v[216:217], v38 offset:12288
    ds_read_b64_tr_b16 v[218:219], v38 offset:12800
    s_waitcnt vmcnt(5)
    s_waitcnt lgkmcnt(6)
    v_mfma_f32_16x16x32_bf16 v[120:123], v[192:195], v[44:47], v[120:123]
    ds_read_b64_tr_b16 v[220:221], v39 offset:12288
    ds_read_b64_tr_b16 v[222:223], v39 offset:12800
    v_mfma_f32_16x16x32_bf16 v[124:127], v[196:199], v[44:47], v[124:127]
    v_mfma_f32_16x16x32_bf16 v[128:131], v[200:203], v[44:47], v[128:131]
    v_mfma_f32_16x16x32_bf16 v[132:135], v[204:207], v[44:47], v[132:135]
    s_waitcnt vmcnt(4)
    s_waitcnt lgkmcnt(0)
    v_mfma_f32_16x16x32_bf16 v[120:123], v[208:211], v[48:51], v[120:123]
    v_mfma_f32_16x16x32_bf16 v[124:127], v[212:215], v[48:51], v[124:127]
    v_mfma_f32_16x16x32_bf16 v[128:131], v[216:219], v[48:51], v[128:131]
    v_mfma_f32_16x16x32_bf16 v[132:135], v[220:223], v[48:51], v[132:135]
    s_lshl3_add_u32 s96, s21, s3
    s_lshl4_add_u32 s97, s96, s12
    s_lshl_b32 s98, s97, 8
    s_add_u32 s14, s98, 12582912
    v_and_b32 v28, 15, v1
    v_lshlrev_b32 v28, 4, v28
    v_lshrrev_b32 v9, 4, v1
    v_lshl_add_u32 v28, v9, 2, v28
    v_cvt_pk_bf16_f32 v120, 0, v120
    v_cvt_pk_bf16_f32 v121, 0, v121
    v_cvt_pk_bf16_f32 v122, 0, v122
    v_cvt_pk_bf16_f32 v123, 0, v123
    v_cvt_pk_bf16_f32 v124, 0, v124
    v_cvt_pk_bf16_f32 v125, 0, v125
    v_cvt_pk_bf16_f32 v126, 0, v126
    v_cvt_pk_bf16_f32 v127, 0, v127
    v_pk_mul_f32 v[120:121], v[120:121], v[136:137]
    v_pk_mul_f32 v[122:123], v[122:123], v[138:139]
    v_pk_mul_f32 v[124:125], v[124:125], v[140:141]
    v_pk_mul_f32 v[126:127], v[126:127], v[142:143]
    v_cvt_pk_bf16_f32 v120, 0, v120
    v_cvt_pk_bf16_f32 v121, 0, v121
    v_cvt_pk_bf16_f32 v122, 0, v122
    v_cvt_pk_bf16_f32 v123, 0, v123
    v_cvt_pk_bf16_f32 v124, 0, v124
    v_cvt_pk_bf16_f32 v125, 0, v125
    v_cvt_pk_bf16_f32 v126, 0, v126
    v_cvt_pk_bf16_f32 v127, 0, v127
    v_pk_add_f32 v[120:121], v[120:121], v[152:153]
    v_pk_add_f32 v[122:123], v[122:123], v[154:155]
    v_pk_add_f32 v[124:125], v[124:125], v[156:157]
    v_pk_add_f32 v[126:127], v[126:127], v[158:159]
    v_cvt_pk_bf16_f32 v12, v120, v121
    v_cvt_pk_bf16_f32 v13, v122, v123
    v_cvt_pk_bf16_f32 v14, v124, v125
    v_cvt_pk_bf16_f32 v15, v126, v127
    v_dot2_f32_bf16 v4, v12, v12, 0
    v_dot2_f32_bf16 v5, v13, v13, 0
    v_dot2_f32_bf16 v4, v14, v14, v4
    v_dot2_f32_bf16 v5, v15, v15, v5
    v_mfma_f32_16x16x32_bf16 v[240:243], v[184:187], v[12:15], 0
    v_cvt_pk_bf16_f32 v128, 0, v128
    v_cvt_pk_bf16_f32 v129, 0, v129
    v_cvt_pk_bf16_f32 v130, 0, v130
    v_cvt_pk_bf16_f32 v131, 0, v131
    v_cvt_pk_bf16_f32 v132, 0, v132
    v_cvt_pk_bf16_f32 v133, 0, v133
    v_cvt_pk_bf16_f32 v134, 0, v134
    v_cvt_pk_bf16_f32 v135, 0, v135
    v_pk_mul_f32 v[128:129], v[128:129], v[144:145]
    v_pk_mul_f32 v[130:131], v[130:131], v[146:147]
    v_pk_mul_f32 v[132:133], v[132:133], v[148:149]
    v_pk_mul_f32 v[134:135], v[134:135], v[150:151]
    v_cvt_pk_bf16_f32 v128, 0, v128
    v_cvt_pk_bf16_f32 v129, 0, v129
    v_cvt_pk_bf16_f32 v130, 0, v130
    v_cvt_pk_bf16_f32 v131, 0, v131
    v_cvt_pk_bf16_f32 v132, 0, v132
    v_cvt_pk_bf16_f32 v133, 0, v133
    v_cvt_pk_bf16_f32 v134, 0, v134
    v_cvt_pk_bf16_f32 v135, 0, v135
    v_pk_add_f32 v[128:129], v[128:129], v[160:161]
    v_pk_add_f32 v[130:131], v[130:131], v[162:163]
    v_pk_add_f32 v[132:133], v[132:133], v[164:165]
    v_pk_add_f32 v[134:135], v[134:135], v[166:167]
    v_cvt_pk_bf16_f32 v16, v128, v129
    v_cvt_pk_bf16_f32 v17, v130, v131
    v_cvt_pk_bf16_f32 v18, v132, v133
    v_cvt_pk_bf16_f32 v19, v134, v135
    v_dot2_f32_bf16 v4, v16, v16, v4
    v_dot2_f32_bf16 v5, v17, v17, v5
    v_dot2_f32_bf16 v4, v18, v18, v4
    v_dot2_f32_bf16 v5, v19, v19, v5
    v_mfma_f32_16x16x32_bf16 v[240:243], v[188:191], v[16:19], v[240:243]
    v_and_b32 v7, 7, v1
    v_lshlrev_b32 v7, 15, v7
    v_bfe_u32 v9, v1, 3, 1
    v_lshl_add_u32 v7, v9, 12, v7
    v_add_f32 v4, v4, v5
    v_mov_b32 v5, v4
    s_nop 1
    v_permlane32_swap_b32 v4, v5
    v_add_f32 v4, v4, v5
    v_mov_b32 v5, v4
    s_nop 1
    v_permlane16_swap_b32 v4, v5
    v_add_f32 v4, v4, v5
    s_nop 1
    v_mov_b32_dpp v240, v4 quad_perm:[0,1,2,3] row_mask:0x8 bank_mask:0xf
    buffer_store_dword v240, v28, s[32:35], s14 offen sc1
    s_and_b32 s96, s12, 1
    s_lshr_b32 s97, s21, 2
    s_and_b32 s98, s21, 3
    s_lshl_b32 s99, s98, 6
    s_lshl1_add_u32 s98, s97, s99
    s_lshl_b32 s97, s98, 12
    s_lshr_b32 s99, s12, 1
    s_lshl_b32 s98, s99, 6
    s_add_u32 s99, s97, s98
    s_lshl2_add_u32 s97, s96, s99
    s_add_u32 s98, s97, 1048576
    s_add_u32 s16, s98, 1536
    s_barrier
    s_cmp_lg_u32 s3, 0
    s_cbranch_scc1 L_PE
    v_mov_b32 v6, s4
    s_mov_b32 exec_hi, 0
    s_mov_b32 exec_lo, 65535
    buffer_store_dword v6, v7, s[32:35], s16 offen sc1
    s_mov_b64 exec, -1
L_PE:
    s_add_u32 s82, s80, 57344
    s_lshl2_add_u32 m0, s83, 33792
    s_nop 0
    buffer_load_dwordx4 v27, s[56:59], s82 offen nt lds
    s_add_u32 s82, s80, 114688
    s_lshl2_add_u32 m0, s83, 34816
    s_nop 0
    buffer_load_dwordx4 v27, s[56:59], s82 offen nt lds
    s_lshl_b32 s15, s3, 12
    v_add_u32 v4, s15, v2
    v_add_u32 v7, 65536, v4
    s_waitcnt vmcnt(6)
    v_cmp_ne_u32 vcc, s4, v41
    s_cbranch_vccz L_UPOK
POLL_34:
    buffer_load_dwordx2 v[40:41], v10, s[32:35], s13 offen sc1
    s_waitcnt vmcnt(0)
    v_cmp_ne_u32 vcc, s4, v41
    s_cbranch_vccz PDONE_35
    s_add_u32 s5, s5, 1
    s_cmp_lt_u32 s5, 200000
    s_cbranch_scc1 POLL_34
PDONE_35:
L_UPOK:
    s_lshl3_add_u32 s96, s21, s3
    s_lshl_b32 s97, s96, 12
    s_add_u32 s14, s97, 12582912
    s_load_dwordx2 s[24:25], s[32:33], s92 offset:1536 glc
    v_add_f32_dpp v40, v40, v40 quad_perm:[1,0,3,2] row_mask:0xf bank_mask:0xf
    s_nop 1
    v_add_f32_dpp v40, v40, v40 quad_perm:[2,3,0,1] row_mask:0xf bank_mask:0xf
    s_nop 1
    v_add_f32_dpp v40, v40, v40 row_half_mirror row_mask:0xf bank_mask:0xf
    s_nop 1
    v_add_f32_dpp v40, v40, v40 row_mirror row_mask:0xf bank_mask:0xf
    v_lshlrev_b32 v152, 16, v12
    v_and_b32 v153, s6, v12
    v_lshlrev_b32 v154, 16, v13
    v_and_b32 v155, s6, v13
    v_lshlrev_b32 v156, 16, v14
    v_and_b32 v157, s6, v14
    v_lshlrev_b32 v158, 16, v15
    v_and_b32 v159, s6, v15
    v_lshlrev_b32 v160, 16, v16
    v_and_b32 v161, s6, v16
    v_lshlrev_b32 v162, 16, v17
    v_and_b32 v163, s6, v17
    v_lshlrev_b32 v164, 16, v18
    v_and_b32 v165, s6, v18
    v_lshlrev_b32 v166, 16, v19
    v_and_b32 v167, s6, v19
    s_lshl_b32 s96, s3, 9
    s_lshl1_add_u32 s15, s21, s96
    v_and_b32 v29, 15, v1
    v_lshl_add_u32 v29, v29, 5, s15
    v_xor_b32 v5, 0x4000, v4
    v_xor_b32 v8, 0x4000, v7
    s_waitcnt vmcnt(3)
    ds_write_b128 v4, v[72:75] offset:2048
    ds_write_b128 v4, v[76:79] offset:3072
    ds_write_b128 v4, v[80:83] offset:32768
    s_cmp_lt_u32 s3, 4
    s_cbranch_scc1 L_FW1
    ds_write_b128 v4, v[56:59] offset:0
    ds_write_b128 v5, v[60:63] offset:0
    ds_write_b128 v4, v[64:67] offset:1024
    ds_write_b128 v5, v[68:71] offset:1024
L_FW1:
    s_branch SCHK_37
SPOLL_36:
    s_load_dwordx2 s[24:25], s[32:33], s92 offset:1536 glc
SCHK_37:
    s_add_u32 s5, s5, 1
    s_cmp_ge_u32 s5, 200000
    s_waitcnt lgkmcnt(0)
    s_cbranch_scc1 SDONE_38
    s_cmp_lg_u32 s24, s4
    s_cbranch_scc1 SPOLL_36
    s_cmp_lg_u32 s25, s4
    s_cbranch_scc1 SPOLL_36
SDONE_38:
    s_barrier
    buffer_load_dwordx4 v[192:195], v2, s[32:35], s14 offen sc1
    buffer_load_dwordx4 v[196:199], v2, s[32:35], s14 offen offset:1024 sc1
    buffer_load_dwordx4 v[200:203], v2, s[32:35], s14 offen offset:2048 sc1
    buffer_load_dwordx4 v[204:207], v2, s[32:35], s14 offen offset:3072 sc1
    s_barrier
    s_add_u32 s82, s80, 172032
    s_lshl2_add_u32 m0, s83, 35840
    s_nop 0
    buffer_load_dwordx4 v27, s[56:59], s82 offen nt lds
    s_mov_b32 s82, s81
    s_lshl2_add_u32 m0, s83, 65536
    s_nop 0
    buffer_load_dwordx4 v253, s[60:63], s82 offen nt lds
    s_add_u32 s82, s81, 4096
    s_lshl2_add_u32 m0, s83, 66560
    s_nop 0
    buffer_load_dwordx4 v253, s[60:63], s82 offen nt lds
    v_mov_b32_dpp v168, v33 row_newbcast:0 row_mask:0xf bank_mask:0xf
    v_mov_b32_dpp v169, v33 row_newbcast:1 row_mask:0xf bank_mask:0xf
    v_mov_b32_dpp v170, v33 row_newbcast:2 row_mask:0xf bank_mask:0xf
    v_mov_b32_dpp v171, v33 row_newbcast:3 row_mask:0xf bank_mask:0xf
    v_mov_b32_dpp v172, v33 row_newbcast:4 row_mask:0xf bank_mask:0xf
    v_mov_b32_dpp v173, v33 row_newbcast:5 row_mask:0xf bank_mask:0xf
    v_mov_b32_dpp v174, v33 row_newbcast:6 row_mask:0xf bank_mask:0xf
    v_mov_b32_dpp v175, v33 row_newbcast:7 row_mask:0xf bank_mask:0xf
    v_mov_b32_dpp v176, v33 row_newbcast:8 row_mask:0xf bank_mask:0xf
    v_mov_b32_dpp v177, v33 row_newbcast:9 row_mask:0xf bank_mask:0xf
    v_mov_b32_dpp v178, v33 row_newbcast:10 row_mask:0xf bank_mask:0xf
    v_mov_b32_dpp v179, v33 row_newbcast:11 row_mask:0xf bank_mask:0xf
    v_mov_b32_dpp v180, v33 row_newbcast:12 row_mask:0xf bank_mask:0xf
    v_mov_b32_dpp v181, v33 row_newbcast:13 row_mask:0xf bank_mask:0xf
    v_mov_b32_dpp v182, v33 row_newbcast:14 row_mask:0xf bank_mask:0xf
    v_mov_b32_dpp v183, v33 row_newbcast:15 row_mask:0xf bank_mask:0xf
    v_mov_b32_dpp v88, v42 row_newbcast:0 row_mask:0xf bank_mask:0xf
    v_mov_b32_dpp v89, v42 row_newbcast:1 row_mask:0xf bank_mask:0xf
    v_mov_b32_dpp v90, v42 row_newbcast:2 row_mask:0xf bank_mask:0xf
    v_mov_b32_dpp v91, v42 row_newbcast:3 row_mask:0xf bank_mask:0xf
    v_mov_b32_dpp v92, v42 row_newbcast:4 row_mask:0xf bank_mask:0xf
    v_mov_b32_dpp v93, v42 row_newbcast:5 row_mask:0xf bank_mask:0xf
    v_mov_b32_dpp v94, v42 row_newbcast:6 row_mask:0xf bank_mask:0xf
    v_mov_b32_dpp v95, v42 row_newbcast:7 row_mask:0xf bank_mask:0xf
    v_mov_b32_dpp v96, v42 row_newbcast:8 row_mask:0xf bank_mask:0xf
    v_mov_b32_dpp v97, v42 row_newbcast:9 row_mask:0xf bank_mask:0xf
    v_mov_b32_dpp v98, v42 row_newbcast:10 row_mask:0xf bank_mask:0xf
    v_mov_b32_dpp v99, v42 row_newbcast:11 row_mask:0xf bank_mask:0xf
    v_mov_b32_dpp v100, v42 row_newbcast:12 row_mask:0xf bank_mask:0xf
    v_mov_b32_dpp v101, v42 row_newbcast:13 row_mask:0xf bank_mask:0xf
    v_mov_b32_dpp v102, v42 row_newbcast:14 row_mask:0xf bank_mask:0xf
    v_mov_b32_dpp v103, v42 row_newbcast:15 row_mask:0xf bank_mask:0xf
    v_mov_b32_dpp v104, v43 row_newbcast:0 row_mask:0xf bank_mask:0xf
L_PAD9:
    s_cbranch_execz L_RET9
    v_mov_b32_dpp v105, v43 row_newbcast:1 row_mask:0xf bank_mask:0xf
    v_mov_b32_dpp v106, v43 row_newbcast:2 row_mask:0xf bank_mask:0xf
    v_mov_b32_dpp v107, v43 row_newbcast:3 row_mask:0xf bank_mask:0xf
    v_mov_b32_dpp v108, v43 row_newbcast:4 row_mask:0xf bank_mask:0xf
    v_mov_b32_dpp v109, v43 row_newbcast:5 row_mask:0xf bank_mask:0xf
    v_mov_b32_dpp v110, v43 row_newbcast:6 row_mask:0xf bank_mask:0xf
    v_mov_b32_dpp v111, v43 row_newbcast:7 row_mask:0xf bank_mask:0xf
    v_mov_b32_dpp v112, v43 row_newbcast:8 row_mask:0xf bank_mask:0xf
    v_mov_b32_dpp v113, v43 row_newbcast:9 row_mask:0xf bank_mask:0xf
    v_mov_b32_dpp v114, v43 row_newbcast:10 row_mask:0xf bank_mask:0xf
    v_mov_b32_dpp v115, v43 row_newbcast:11 row_mask:0xf bank_mask:0xf
    v_mov_b32_dpp v116, v43 row_newbcast:12 row_mask:0xf bank_mask:0xf
    v_mov_b32_dpp v117, v43 row_newbcast:13 row_mask:0xf bank_mask:0xf
    v_mov_b32_dpp v118, v43 row_newbcast:14 row_mask:0xf bank_mask:0xf
    v_mov_b32_dpp v119, v43 row_newbcast:15 row_mask:0xf bank_mask:0xf
    s_lshl3_add_u32 s15, s3, 156160
    v_mov_b32 v4, s15
    v_and_b32 v5, 7, v1
    v_lshlrev_b32 v5, 3, v5
    v_add_u32 v5, 156160, v5
    v_and_b32 v6, 3, v1
    v_lshlrev_b32 v6, 18, v6
    v_bfe_u32 v9, v1, 2, 2
    v_lshl_add_u32 v6, v9, 13, v6
    s_and_b32 s96, s21, 1
    s_and_b32 s97, s12, 7
    s_lshr_b32 s98, s12, 3
    s_lshl3_add_u32 s99, s97, s98
    s_lshl_b32 s97, s99, 12
    s_lshr_b32 s98, s21, 1
    s_lshl_b32 s99, s98, 6
    s_add_u32 s98, s97, s99
    s_lshl4_add_u32 s97, s96, s98
    s_add_u32 s99, s97, 1048576
    s_add_u32 s16, s99, 2560
    s_waitcnt vmcnt(3)
    v_pk_add_f32 v[192:193], v[192:193], v[196:197]
    v_pk_add_f32 v[200:201], v[200:201], v[204:205]
    v_pk_add_f32 v[194:195], v[194:195], v[198:199]
    v_pk_add_f32 v[202:203], v[202:203], v[206:207]
    v_pk_add_f32 v[192:193], v[192:193], v[200:201]
    v_pk_add_f32 v[194:195], v[194:195], v[202:203]
    v_add_f32 v193, v193, v194
    v_add_f32 v197, v192, v195
    v_cmp_u_f32 vcc, v193, v197
    s_cbranch_vccz POK_40
PRE_41:
    buffer_load_dwordx4 v[192:195], v2, s[32:35], s14 offen sc1
    buffer_load_dwordx4 v[196:199], v2, s[32:35], s14 offen offset:1024 sc1
    buffer_load_dwordx4 v[200:203], v2, s[32:35], s14 offen offset:2048 sc1
    buffer_load_dwordx4 v[204:207], v2, s[32:35], s14 offen offset:3072 sc1
    s_waitcnt vmcnt(0)
    v_pk_add_f32 v[192:193], v[192:193], v[196:197]
    v_pk_add_f32 v[200:201], v[200:201], v[204:205]
    v_pk_add_f32 v[194:195], v[194:195], v[198:199]
    v_pk_add_f32 v[202:203], v[202:203], v[206:207]
    v_pk_add_f32 v[192:193], v[192:193], v[200:201]
    v_pk_add_f32 v[194:195], v[194:195], v[202:203]
    v_add_f32 v193, v193, v194
    v_add_f32 v197, v192, v195
    v_cmp_u_f32 vcc, v193, v197
    s_cbranch_vccz POK_40
    s_add_u32 s5, s5, 1
    s_cmp_lt_u32 s5, 200000
    s_cbranch_scc1 PRE_41
POK_40:
    v_mov_b32 v196, v195
    s_nop 1
    v_permlane32_swap_b32 v195, v196
    v_permlane32_swap_b32 v192, v193
    v_add_f32 v195, v195, v196
    v_add_f32 v192, v192, v193
    s_nop 1
    v_permlane16_swap_b32 v192, v195
    v_add_f32 v193, v192, v195
    v_add_f32 v195, v192, v195
    s_nop 1
    v_permlane16_swap_b32 v193, v195
    v_mov_b32 v192, v193
    v_mul_f32 v195, 0x3a800000, v195
    s_nop 0
    v_permlane32_swap_b32 v192, v193
    v_mul_f32 v192, 0x3a800000, v192
    v_fma_f32 v31, -v192, v192, v195
    v_cvt_pk_bf16_f32 v30, 0, v192
    v_max_f32 v31, 0, v31
    v_cvt_pk_bf16_f32 v31, 0, v31
    v_fma_f32 v193, -v30, v40, v193
    v_add_f32 v31, 0x3727c5ac, v31
    v_cvt_pk_bf16_f32 v31, 0, v31
    v_sqrt_f32 v31, v31
    s_nop 0
    v_cvt_pk_bf16_f32 v31, 0, v31
    v_rcp_f32 v31, v31
    s_nop 0
    v_mul_f32 v32, v193, v31
    v_ashrrev_i32 v196, 31, v32
    v_or_b32 v196, 0x80000000, v196
    v_xor_b32 v32, v32, v196
    s_mov_b32 s15, 0xfffff000
    v_and_or_b32 v32, v32, s15, v29
    s_nop 1
    v_max_u32_dpp v244, v32, v32 quad_perm:[1,0,3,2] row_mask:0xf bank_mask:0xf
    v_min_u32_dpp v245, v32, v32 quad_perm:[1,0,3,2] row_mask:0xf bank_mask:0xf
    s_nop 0
    v_min_u32_dpp v196, v244, v244 quad_perm:[2,3,0,1] row_mask:0xf bank_mask:0xf
    v_max_u32_dpp v245, v245, v245 quad_perm:[2,3,0,1] row_mask:0xf bank_mask:0xf
    v_max_u32_dpp v244, v244, v244 quad_perm:[2,3,0,1] row_mask:0xf bank_mask:0xf
    v_max_u32 v245, v245, v196
    s_nop 0
    v_min_u32_dpp v196, v244, v244 row_half_mirror row_mask:0xf bank_mask:0xf
    v_max_u32_dpp v245, v245, v245 row_half_mirror row_mask:0xf bank_mask:0xf
    v_max_u32_dpp v244, v244, v244 row_half_mirror row_mask:0xf bank_mask:0xf
    v_max_u32 v245, v245, v196
    s_nop 0
    v_min_u32_dpp v196, v244, v244 row_mirror row_mask:0xf bank_mask:0xf
    v_max_u32_dpp v245, v245, v245 row_mirror row_mask:0xf bank_mask:0xf
    v_max_u32_dpp v244, v244, v244 row_mirror row_mask:0xf bank_mask:0xf
    v_max_u32 v245, v245, v196
    ds_write_b64 v4, v[244:245]
    s_waitcnt lgkmcnt(0)
    s_barrier
    ds_read_b64 v[244:245], v5
    v_pk_add_f32 v[208:209], v[152:153], v[30:31] op_sel_hi:[1,0] neg_lo:[0,1] neg_hi:[0,1]
    v_pk_add_f32 v[210:211], v[154:155], v[30:31] op_sel_hi:[1,0] neg_lo:[0,1] neg_hi:[0,1]
    v_pk_add_f32 v[212:213], v[156:157], v[30:31] op_sel_hi:[1,0] neg_lo:[0,1] neg_hi:[0,1]
    v_pk_add_f32 v[214:215], v[158:159], v[30:31] op_sel_hi:[1,0] neg_lo:[0,1] neg_hi:[0,1]
    v_pk_add_f32 v[216:217], v[160:161], v[30:31] op_sel_hi:[1,0] neg_lo:[0,1] neg_hi:[0,1]
    v_pk_add_f32 v[218:219], v[162:163], v[30:31] op_sel_hi:[1,0] neg_lo:[0,1] neg_hi:[0,1]
    v_pk_add_f32 v[220:221], v[164:165], v[30:31] op_sel_hi:[1,0] neg_lo:[0,1] neg_hi:[0,1]
    v_pk_add_f32 v[222:223], v[166:167], v[30:31] op_sel_hi:[1,0] neg_lo:[0,1] neg_hi:[0,1]
    s_waitcnt lgkmcnt(0)
    v_min_u32_dpp v196, v244, v244 quad_perm:[1,0,3,2] row_mask:0xf bank_mask:0xf
    v_max_u32_dpp v245, v245, v245 quad_perm:[1,0,3,2] row_mask:0xf bank_mask:0xf
    v_max_u32_dpp v244, v244, v244 quad_perm:[1,0,3,2] row_mask:0xf bank_mask:0xf
    v_max_u32 v245, v245, v196
    s_nop 0
    v_min_u32_dpp v196, v244, v244 quad_perm:[2,3,0,1] row_mask:0xf bank_mask:0xf
    v_max_u32_dpp v245, v245, v245 quad_perm:[2,3,0,1] row_mask:0xf bank_mask:0xf
    v_max_u32_dpp v244, v244, v244 quad_perm:[2,3,0,1] row_mask:0xf bank_mask:0xf
    v_max_u32 v245, v245, v196
    s_nop 0
    v_min_u32_dpp v196, v244, v244 row_half_mirror row_mask:0xf bank_mask:0xf
    v_max_u32_dpp v245, v245, v245 row_half_mirror row_mask:0xf bank_mask:0xf
    v_max_u32_dpp v244, v244, v244 row_half_mirror row_mask:0xf bank_mask:0xf
    v_max_u32 v245, v245, v196
    v_cmp_eq_u32 s[88:89], v32, v245
    v_cmp_eq_u32 vcc, v32, v244
    v_or_b32 v246, 1, v245
    v_mov_b32 v245, s4
    v_mov_b32 v247, s4
    s_or_b64 s[84:85], vcc, s[88:89]
    s_cmp_lg_u32 s3, 0
    s_cbranch_scc1 L_NOF
    s_mov_b64 exec, 0xffff
    buffer_store_dwordx4 v[244:247], v6, s[32:35], s16 offen sc1
    s_mov_b64 exec, -1
L_NOF:
    s_cmp_eq_u64 s[84:85], 0
    s_cbranch_scc1 L_NOPR
    s_setprio 1
L_NOPR:
    s_lshl4_add_u32 s13, s3, 156288
    v_mov_b32 v4, s13
    v_and_b32 v5, 7, v1
    v_lshlrev_b32 v5, 4, v5
    v_add_u32 v5, 156288, v5
    s_load_dwordx8 s[24:31], s[32:33], s92 offset:2560 glc
    v_cvt_pk_bf16_f32 v208, 0, v208
    v_cvt_pk_bf16_f32 v209, 0, v209
    v_cvt_pk_bf16_f32 v210, 0, v210
    v_cvt_pk_bf16_f32 v211, 0, v211
    v_cvt_pk_bf16_f32 v212, 0, v212
    v_cvt_pk_bf16_f32 v213, 0, v213
    v_cvt_pk_bf16_f32 v214, 0, v214
    v_cvt_pk_bf16_f32 v215, 0, v215
    v_cvt_pk_bf16_f32 v216, 0, v216
    v_cvt_pk_bf16_f32 v217, 0, v217
    v_cvt_pk_bf16_f32 v218, 0, v218
    v_cvt_pk_bf16_f32 v219, 0, v219
    v_cvt_pk_bf16_f32 v220, 0, v220
    v_cvt_pk_bf16_f32 v221, 0, v221
    v_cvt_pk_bf16_f32 v222, 0, v222
    v_cvt_pk_bf16_f32 v223, 0, v223
    v_pk_mul_f32 v[208:209], v[30:31], v[208:209] op_sel:[1,0]
    v_pk_mul_f32 v[210:211], v[30:31], v[210:211] op_sel:[1,0]
    v_pk_mul_f32 v[212:213], v[30:31], v[212:213] op_sel:[1,0]
    v_pk_mul_f32 v[214:215], v[30:31], v[214:215] op_sel:[1,0]
    v_pk_mul_f32 v[216:217], v[30:31], v[216:217] op_sel:[1,0]
    v_pk_mul_f32 v[218:219], v[30:31], v[218:219] op_sel:[1,0]
    v_pk_mul_f32 v[220:221], v[30:31], v[220:221] op_sel:[1,0]
    v_pk_mul_f32 v[222:223], v[30:31], v[222:223] op_sel:[1,0]
    v_cvt_pk_bf16_f32 v208, 0, v208
    v_cvt_pk_bf16_f32 v209, 0, v209
    v_cvt_pk_bf16_f32 v210, 0, v210
    v_cvt_pk_bf16_f32 v211, 0, v211
    v_cvt_pk_bf16_f32 v212, 0, v212
    v_cvt_pk_bf16_f32 v213, 0, v213
    v_cvt_pk_bf16_f32 v214, 0, v214
    v_cvt_pk_bf16_f32 v215, 0, v215
    v_cvt_pk_bf16_f32 v216, 0, v216
    v_cvt_pk_bf16_f32 v217, 0, v217
    v_cvt_pk_bf16_f32 v218, 0, v218
    v_cvt_pk_bf16_f32 v219, 0, v219
    v_cvt_pk_bf16_f32 v220, 0, v220
    v_cvt_pk_bf16_f32 v221, 0, v221
    v_cvt_pk_bf16_f32 v222, 0, v222
    v_cvt_pk_bf16_f32 v223, 0, v223
    v_pk_mul_f32 v[208:209], v[208:209], v[168:169]
    v_pk_mul_f32 v[210:211], v[210:211], v[170:171]
    v_pk_mul_f32 v[212:213], v[212:213], v[172:173]
    v_pk_mul_f32 v[214:215], v[214:215], v[174:175]
    v_pk_mul_f32 v[216:217], v[216:217], v[176:177]
    v_pk_mul_f32 v[218:219], v[218:219], v[178:179]
    v_pk_mul_f32 v[220:221], v[220:221], v[180:181]
    v_pk_mul_f32 v[222:223], v[222:223], v[182:183]
    v_cvt_pk_bf16_f32 v208, 0, v208
    v_cvt_pk_bf16_f32 v209, 0, v209
    v_cvt_pk_bf16_f32 v210, 0, v210
    v_cvt_pk_bf16_f32 v211, 0, v211
    v_cvt_pk_bf16_f32 v212, 0, v212
    v_cvt_pk_bf16_f32 v213, 0, v213
    v_cvt_pk_bf16_f32 v214, 0, v214
    v_cvt_pk_bf16_f32 v215, 0, v215
    v_cvt_pk_bf16_f32 v216, 0, v216
    v_cvt_pk_bf16_f32 v217, 0, v217
    v_cvt_pk_bf16_f32 v218, 0, v218
    v_cvt_pk_bf16_f32 v219, 0, v219
    v_cvt_pk_bf16_f32 v220, 0, v220
    v_cvt_pk_bf16_f32 v221, 0, v221
    v_cvt_pk_bf16_f32 v222, 0, v222
    v_cvt_pk_bf16_f32 v223, 0, v223
    v_pk_add_f32 v[208:209], v[208:209], v[88:89]
    v_pk_add_f32 v[210:211], v[210:211], v[90:91]
    v_pk_add_f32 v[212:213], v[212:213], v[92:93]
    v_pk_add_f32 v[214:215], v[214:215], v[94:95]
    v_pk_add_f32 v[216:217], v[216:217], v[96:97]
    v_pk_add_f32 v[218:219], v[218:219], v[98:99]
    v_pk_add_f32 v[220:221], v[220:221], v[100:101]
    v_pk_add_f32 v[222:223], v[222:223], v[102:103]
    v_cvt_pk_bf16_f32 v224, v208, v209
    v_cvt_pk_bf16_f32 v225, v210, v211
    v_cvt_pk_bf16_f32 v226, v212, v213
    v_cvt_pk_bf16_f32 v227, v214, v215
    v_cvt_pk_bf16_f32 v228, v216, v217
    v_cvt_pk_bf16_f32 v229, v218, v219
    v_cvt_pk_bf16_f32 v230, v220, v221
    v_cvt_pk_bf16_f32 v231, v222, v223
    s_cmp_eq_u64 s[84:85], 0
    s_cbranch_scc1 L_NOCAND
    v_mfma_f32_16x16x32_bf16 v[240:243], v[184:187], v[224:227], 0
    v_mfma_f32_16x16x32_bf16 v[240:243], v[188:191], v[228:231], v[240:243]
    v_mov_b32 v232, v224
    v_mov_b32 v233, v225
    v_mov_b32 v234, v226
    v_mov_b32 v235, v227
    v_mov_b32 v236, v228
    v_mov_b32 v237, v229
    v_mov_b32 v238, v230
    v_mov_b32 v239, v231
    s_lshl_b32 s96, s21, 14
    s_lshl_b32 s97, s12, 9
    s_add_u32 s98, s96, s97
    s_add_u32 s15, s98, 13631488
    v_lshrrev_b32 v7, 4, v1
    v_lshlrev_b32 v7, 4, v7
    v_add_u32 v8, 8192, v7
    v_permlane32_swap_b32 v232, v234
    v_permlane32_swap_b32 v233, v235
    v_permlane32_swap_b32 v236, v238
    v_permlane32_swap_b32 v237, v239
    v_permlane32_swap_b32 v12, v14
    v_permlane32_swap_b32 v13, v15
    v_permlane32_swap_b32 v16, v18
    v_permlane32_swap_b32 v17, v19
    v_cndmask_b32 v7, v7, v8, s[88:89]
    s_mov_b64 exec, s[84:85]
    buffer_store_dwordx4 v[232:235], v7, s[32:35], s15 offen sc1
    buffer_store_dwordx4 v[236:239], v7, s[32:35], s15 offen offset:64 sc1
    s_mov_b32 exec_lo, 0
    s_and_b32 exec_hi, s85, 0xffff0000
    buffer_store_dword v240, v7, s[32:35], s15 offen offset:208 sc1
    s_mov_b64 exec, s[84:85]
    buffer_store_dwordx4 v[12:15], v7, s[32:35], s15 offen offset:128 sc1
    buffer_store_dwordx4 v[16:19], v7, s[32:35], s15 offen offset:192 sc1
    s_mov_b64 exec, -1
    s_setprio 0
L_NOCAND:
    s_add_u32 s82, s81, 8192
    s_lshl2_add_u32 m0, s83, 67584
    s_nop 0
    buffer_load_dwordx4 v253, s[60:63], s82 offen nt lds
    s_add_u32 s82, s81, 12288
    s_lshl2_add_u32 m0, s83, 68608
    s_nop 0
    buffer_load_dwordx4 v253, s[60:63], s82 offen nt lds
    s_branch SCHK_43
SPOLL_42:
    s_load_dwordx8 s[24:31], s[32:33], s92 offset:2560 glc
SCHK_43:
    s_add_u32 s5, s5, 1
    s_cmp_ge_u32 s5, 200000
    s_waitcnt lgkmcnt(0)
    s_cbranch_scc1 SDONE_44
    s_cmp_lg_u32 s25, s4
    s_cbranch_scc1 SPOLL_42
    s_cmp_lg_u32 s27, s4
    s_cbranch_scc1 SPOLL_42
    s_cmp_lg_u32 s29, s4
    s_cbranch_scc1 SPOLL_42
    s_cmp_lg_u32 s31, s4
    s_cbranch_scc1 SPOLL_42
SDONE_44:
    s_min_u32 s25, s24, s28
    s_min_u32 s27, s26, s28
    s_min_u32 s29, s24, s30
    s_max_u32 s24, s24, s28
    s_max_u32 s26, s26, s30
    s_max_u32 s27, s27, s29
    s_max_u32 s25, s25, s26
    v_mov_b32 v244, s24
    v_mov_b32 v246, s27
    v_mov_b32 v245, s25
    ds_write_b128 v4, v[244:247]
    s_waitcnt vmcnt(4)
    s_waitcnt lgkmcnt(0)
    s_barrier
    ds_read_b128 v[244:247], v5
    v_and_b32 v8, 8, v1
    v_cmp_eq_u32 s[22:23], 0, v8
    v_cmp_gt_u32 s[24:25], 16, v1
    v_cmp_gt_u32 s[26:27], 32, v1
    s_waitcnt lgkmcnt(0)
    v_min_u32_dpp v192, v244, v244 quad_perm:[1,0,3,2] row_mask:0xf bank_mask:0xf
    v_min_u32_dpp v193, v245, v244 quad_perm:[1,0,3,2] row_mask:0xf bank_mask:0xf
    v_min_u32_dpp v194, v244, v245 quad_perm:[1,0,3,2] row_mask:0xf bank_mask:0xf
    v_max_u32_dpp v246, v246, v246 quad_perm:[1,0,3,2] row_mask:0xf bank_mask:0xf
    v_max_u32_dpp v245, v245, v245 quad_perm:[1,0,3,2] row_mask:0xf bank_mask:0xf
    v_max_u32_dpp v244, v244, v244 quad_perm:[1,0,3,2] row_mask:0xf bank_mask:0xf
    v_max3_u32 v246, v246, v193, v194
    v_max_u32 v245, v245, v192
    v_min_u32_dpp v192, v244, v244 quad_perm:[2,3,0,1] row_mask:0xf bank_mask:0xf
    s_nop 0
    v_min_u32_dpp v193, v245, v244 quad_perm:[2,3,0,1] row_mask:0xf bank_mask:0xf
    v_min_u32_dpp v194, v244, v245 quad_perm:[2,3,0,1] row_mask:0xf bank_mask:0xf
    v_max_u32_dpp v246, v246, v246 quad_perm:[2,3,0,1] row_mask:0xf bank_mask:0xf
    v_max_u32_dpp v245, v245, v245 quad_perm:[2,3,0,1] row_mask:0xf bank_mask:0xf
    v_max_u32_dpp v244, v244, v244 quad_perm:[2,3,0,1] row_mask:0xf bank_mask:0xf
    v_max3_u32 v246, v246, v193, v194
    v_max_u32 v245, v245, v192
    v_min_u32_dpp v192, v244, v244 row_half_mirror row_mask:0xf bank_mask:0xf
    s_nop 0
    v_min_u32_dpp v193, v245, v244 row_half_mirror row_mask:0xf bank_mask:0xf
    v_min_u32_dpp v194, v244, v245 row_half_mirror row_mask:0xf bank_mask:0xf
    v_max_u32_dpp v246, v246, v246 row_half_mirror row_mask:0xf bank_mask:0xf
    v_max_u32_dpp v245, v245, v245 row_half_mirror row_mask:0xf bank_mask:0xf
    v_max_u32_dpp v244, v244, v244 row_half_mirror row_mask:0xf bank_mask:0xf
    v_max3_u32 v246, v246, v193, v194
    v_max_u32 v245, v245, v192
    v_cndmask_b32 v192, v245, v244, s[22:23]
    v_cndmask_b32 v201, v246, v245, s[26:27]
    v_and_b32 v193, 31, v246
    v_and_b32 v192, 31, v192
    v_cndmask_b32 v201, v201, v244, s[24:25]
    v_lshl_add_u32 v4, v192, 13, v52
    v_lshl_add_u32 v5, v193, 13, v52
    v_and_b32 v194, 31, v201
    v_lshl_add_u32 v6, v194, 13, v53
    buffer_load_dwordx4 v[192:195], v4, s[32:35], 0 offen sc1
    buffer_load_dwordx4 v[196:199], v5, s[32:35], 0 offen sc1
    buffer_load_dword v200, v6, s[32:35], 0 offen sc1
    v_readfirstlane_b32 s91, v244
    v_readfirstlane_b32 s94, v245
    v_readfirstlane_b32 s95, v246
    ds_read_b64_tr_b16 v[56:57], v34
    ds_read_b64_tr_b16 v[58:59], v34 offset:512
    ds_read_b64_tr_b16 v[60:61], v34 offset:1024
    ds_read_b64_tr_b16 v[62:63], v34 offset:1536
    ds_read_b64_tr_b16 v[64:65], v34 offset:2048
    ds_read_b64_tr_b16 v[66:67], v34 offset:2560
    ds_read_b64_tr_b16 v[68:69], v34 offset:3072
    ds_read_b64_tr_b16 v[70:71], v34 offset:3584
    ds_read_b64_tr_b16 v[72:73], v34 offset:4096
    ds_read_b64_tr_b16 v[74:75], v34 offset:4608
    ds_read_b64_tr_b16 v[76:77], v34 offset:5120
    ds_read_b64_tr_b16 v[78:79], v34 offset:5632
    ds_read_b64_tr_b16 v[80:81], v34 offset:6144
    ds_read_b64_tr_b16 v[82:83], v34 offset:6656
    ds_read_b64_tr_b16 v[84:85], v34 offset:7168
    ds_read_b64_tr_b16 v[86:87], v34 offset:7680
    s_bfe_u32 s96, s91, 262145
    s_lshl_b32 s97, s96, 7
    s_bfe_u32 s98, s91, 458757
    s_add_u32 s99, s97, s98
    s_xor_b32 s17, s99, 2047
    s_bfe_u32 s96, s94, 262145
    s_lshl_b32 s97, s96, 7
    s_bfe_u32 s98, s94, 458757
    s_add_u32 s99, s97, s98
    s_xor_b32 s18, s99, 2047
    s_bfe_u32 s96, s95, 262145
    s_lshl_b32 s97, s96, 7
    s_bfe_u32 s98, s95, 458757
    s_add_u32 s99, s97, s98
    s_xor_b32 s19, s99, 2047
    v_lshlrev_b32 v208, 16, v224
    v_and_b32 v209, s6, v224
    v_lshlrev_b32 v210, 16, v225
    v_and_b32 v211, s6, v225
    v_lshlrev_b32 v212, 16, v226
    v_and_b32 v213, s6, v226
    v_lshlrev_b32 v214, 16, v227
    v_and_b32 v215, s6, v227
    v_lshlrev_b32 v216, 16, v228
    v_and_b32 v217, s6, v228
    v_lshlrev_b32 v218, 16, v229
    v_and_b32 v219, s6, v229
    v_lshlrev_b32 v220, 16, v230
    v_and_b32 v221, s6, v230
    v_lshlrev_b32 v222, 16, v231
    v_and_b32 v223, s6, v231
    v_pk_mul_f32 v[208:209], v[208:209], v[104:105]
    v_pk_mul_f32 v[210:211], v[210:211], v[106:107]
    v_pk_mul_f32 v[212:213], v[212:213], v[108:109]
    v_pk_mul_f32 v[214:215], v[214:215], v[110:111]
    v_pk_mul_f32 v[216:217], v[216:217], v[112:113]
    v_pk_mul_f32 v[218:219], v[218:219], v[114:115]
    v_pk_mul_f32 v[220:221], v[220:221], v[116:117]
    v_pk_mul_f32 v[222:223], v[222:223], v[118:119]
    v_cvt_pk_bf16_f32 v208, 0, v208
    v_cvt_pk_bf16_f32 v209, 0, v209
    v_cvt_pk_bf16_f32 v210, 0, v210
    v_cvt_pk_bf16_f32 v211, 0, v211
    v_cvt_pk_bf16_f32 v212, 0, v212
    v_cvt_pk_bf16_f32 v213, 0, v213
    v_cvt_pk_bf16_f32 v214, 0, v214
    v_cvt_pk_bf16_f32 v215, 0, v215
    v_cvt_pk_bf16_f32 v216, 0, v216
    v_cvt_pk_bf16_f32 v217, 0, v217
    v_cvt_pk_bf16_f32 v218, 0, v218
    v_cvt_pk_bf16_f32 v219, 0, v219
    v_cvt_pk_bf16_f32 v220, 0, v220
    v_cvt_pk_bf16_f32 v221, 0, v221
    v_cvt_pk_bf16_f32 v222, 0, v222
    v_cvt_pk_bf16_f32 v223, 0, v223
    s_lshl_b32 s96, s3, 11
    s_add_u32 s13, s96, 98304
    v_lshrrev_b32 v44, 4, v1
    v_lshlrev_b32 v44, 4, v44
    v_and_b32 v45, 7, v1
    v_lshlrev_b32 v45, 4, v45
    v_xor_b32 v44, v44, v45
    v_and_b32 v46, 15, v1
    v_lshl_add_u32 v46, v46, 7, s13
    v_add_u32 v44, v44, v46
    v_xor_b32 v46, 64, v44
    v_lshrrev_b32 v47, 3, v1
    v_lshlrev_b32 v47, 4, v47
    v_xor_b32 v45, v47, v45
    v_lshrrev_b32 v47, 3, v1
    v_lshl_add_u32 v47, v47, 7, s13
    v_add_u32 v45, v45, v47
    s_lshl_b32 s96, s21, 7
    s_sub_u32 s97, 2047, s96
    s_lshl_b32 s98, s3, 4
    s_sub_u32 s13, s97, s98
    v_lshrrev_b32 v43, 3, v1
    v_sub_u32 v42, s13, v43
    v_subrev_u32 v43, 8, v42
    v_lshrrev_b32 v33, 3, v1
    v_lshlrev_b32 v33, 11, v33
    v_and_b32 v9, 7, v1
    v_lshl_add_u32 v33, v9, 4, v33
    s_lshl3_add_u32 s96, s21, s3
    s_lshl_b32 s97, s96, 15
    s_lshl_b32 s98, s12, 7
    s_add_u32 s70, s97, s98
    s_add_u32 s71, s70, 16384
    s_waitcnt lgkmcnt(0)
    s_lshl_b32 s13, s3, 6
    v_bfe_u32 v35, v1, 2, 1
    v_lshlrev_b32 v35, 9, v35
    v_bfe_u32 v9, v1, 3, 1
    v_lshl_add_u32 v35, v9, 12, v35
    v_lshrrev_b32 v9, 5, v1
    v_lshl_add_u32 v35, v9, 11, v35
    v_bfe_u32 v9, v1, 2, 2
    v_lshl_add_u32 v35, v9, 6, v35
    v_bfe_u32 v9, v1, 4, 1
    v_lshl_add_u32 v35, v9, 5, v35
    v_and_b32 v9, 3, v1
    v_lshl_add_u32 v35, v9, 3, v35
    v_xor_b32 v35, s13, v35
    v_add_u32 v35, 65536, v35
    v_and_b32 v8, 15, v1
    v_lshlrev_b32 v8, 4, v8
    v_lshrrev_b32 v9, 5, v1
    v_lshl_add_u32 v8, v9, 3, v8
    s_lshl_b32 s96, s74, 13
    s_add_u32 s14, s96, 20971520
    s_lshl3_add_u32 s96, s75, s3
    s_lshl_b32 s97, s96, 8
    s_add_u32 s20, s97, s14
    v_bfe_u32 v7, v201, 1, 4
    v_bfe_u32 v201, v201, 5, 7
    v_lshl_or_b32 v201, v7, 7, v201
    v_xor_b32 v201, 0x7ff, v201
    s_waitcnt vmcnt(0)
    v_max3_u32 v7, v192, v196, v200
    v_cmp_eq_u32 vcc, -1, v7
    s_cbranch_vccz POK_46
PRE_47:
    buffer_load_dwordx4 v[192:195], v4, s[32:35], 0 offen sc1
    buffer_load_dwordx4 v[196:199], v5, s[32:35], 0 offen sc1
    buffer_load_dword v200, v6, s[32:35], 0 offen sc1
    s_waitcnt vmcnt(0)
    v_max3_u32 v7, v192, v196, v200
    v_cmp_eq_u32 vcc, -1, v7
    s_cbranch_vccz POK_46
    s_add_u32 s5, s5, 1
    s_cmp_lt_u32 s5, 200000
    s_cbranch_scc1 PRE_47
POK_46:
    v_add_f32_dpp v200, v200, v200 quad_perm:[1,0,3,2] row_mask:0xf bank_mask:0xf
    s_nop 1
    v_add_f32_dpp v200, v200, v200 quad_perm:[2,3,0,1] row_mask:0xf bank_mask:0xf
    s_nop 1
    v_add_f32_dpp v200, v200, v200 row_half_mirror row_mask:0xf bank_mask:0xf
    s_nop 1
    v_add_f32_dpp v200, v200, v200 row_mirror row_mask:0xf bank_mask:0xf
    v_cvt_pk_bf16_f32 v200, 0, v200
    v_ashrrev_i32 v7, 31, v200
    v_or_b32 v7, 0x80000000, v7
    v_xor_b32 v200, v200, v7
    v_lshrrev_b32 v200, 16, v200
    v_lshl_or_b32 v200, v200, 11, v201
    s_nop 0
    v_readlane_b32 s24, v200, 0
    v_readlane_b32 s25, v200, 16
    v_readlane_b32 s26, v200, 32
    s_not_b64 s[28:29], s[22:23]
    s_cmp_lt_u32 s24, s25
    s_cselect_b64 s[28:29], s[22:23], s[28:29]
    s_cselect_b32 s27, s24, s25
    s_cmp_gt_u32 s26, s27
    s_cselect_b64 vcc, s[28:29], 0
    v_cndmask_b32 v192, v192, v196, vcc
    v_cndmask_b32 v193, v193, v197, vcc
    v_cndmask_b32 v194, v194, v198, vcc
    v_cndmask_b32 v195, v195, v199, vcc
    s_bitcmp1_b32 vcc_lo, 0
    s_cselect_b32 s24, s26, s24
    s_cselect_b32 s19, s17, s19
    s_cselect_b32 s17, s95, s91
    s_bitcmp1_b32 vcc_lo, 8
    s_cselect_b32 s25, s26, s25
    s_cselect_b32 s19, s18, s19
    s_cselect_b32 s18, s95, s94
    s_waitcnt lgkmcnt(0)
    v_mfma_f32_16x16x32_bf16 v[136:139], v[192:195], v[56:59], 0
    v_mfma_f32_16x16x32_bf16 v[140:143], v[192:195], v[60:63], 0
    v_mfma_f32_16x16x32_bf16 v[144:147], v[192:195], v[64:67], 0
    v_mfma_f32_16x16x32_bf16 v[148:151], v[192:195], v[68:71], 0
    v_mfma_f32_16x16x32_bf16 v[168:171], v[192:195], v[72:75], 0
    v_mfma_f32_16x16x32_bf16 v[172:175], v[192:195], v[76:79], 0
    v_mfma_f32_16x16x32_bf16 v[176:179], v[192:195], v[80:83], 0
    v_mfma_f32_16x16x32_bf16 v[180:183], v[192:195], v[84:87], 0
    s_nop 1
    v_add_f32 v196, v136, v141
    s_nop 0
    v_add_f32 v197, v146, v151
    s_nop 0
    v_add_f32 v198, v168, v173
    s_nop 0
    v_add_f32 v199, v178, v183
    v_add_f32 v196, v196, v197
    v_add_f32 v198, v198, v199
    v_mov_b32 v197, s4
    s_nop 0
    v_permlane16_swap_b32 v198, v199
    s_cmp_ge_u32 s9, 28
    s_cbranch_scc1 L_NOHP
    v_add_f32 v196, v196, v199
    s_mov_b32 exec_lo, 0xffff
    s_mov_b32 exec_hi, 0xffff
    buffer_store_dwordx2 v[196:197], v8, s[32:35], s20 offen sc1
    s_mov_b64 exec, -1
L_NOHP:
    s_and_b32 s68, s24, 2047
    s_and_b32 s69, s25, 2047
    v_pk_add_f32 v[208:209], v[208:209], v[152:153]
    v_pk_add_f32 v[210:211], v[210:211], v[154:155]
    v_pk_add_f32 v[212:213], v[212:213], v[156:157]
    v_pk_add_f32 v[214:215], v[214:215], v[158:159]
    v_pk_add_f32 v[216:217], v[216:217], v[160:161]
    v_pk_add_f32 v[218:219], v[218:219], v[162:163]
    v_pk_add_f32 v[220:221], v[220:221], v[164:165]
    v_pk_add_f32 v[222:223], v[222:223], v[166:167]
    v_cvt_pk_bf16_f32 v232, v208, v209
    v_cvt_pk_bf16_f32 v233, v210, v211
    v_cvt_pk_bf16_f32 v234, v212, v213
    v_cvt_pk_bf16_f32 v235, v214, v215
    v_cvt_pk_bf16_f32 v236, v216, v217
    v_cvt_pk_bf16_f32 v237, v218, v219
    v_cvt_pk_bf16_f32 v238, v220, v221
    v_cvt_pk_bf16_f32 v239, v222, v223
    v_permlane32_swap_b32 v232, v234
    v_permlane32_swap_b32 v233, v235
    v_permlane32_swap_b32 v236, v238
    v_permlane32_swap_b32 v237, v239
    ds_write_b128 v44, v[232:235]
    ds_write_b128 v46, v[236:239]
    ds_read_b128 v[232:235], v45
    ds_read_b128 v[236:239], v45 offset:1024
    s_waitcnt lgkmcnt(0)
    s_cmp_lg_u32 s93, 7
    s_cbranch_scc1 L_NONON
    v_mov_b32 v6, s4
    v_mov_b32 v7, 0
    s_mov_b64 exec, 1
    buffer_store_dword v6, v7, s[32:35], 0 offen sc1
    s_mov_b64 exec, -1
L_NONON:
    s_cmp_ge_u32 s9, 28
    s_cbranch_scc1 L_FIN3
    v_bfe_u32 v192, v1, 2, 1
    v_lshlrev_b32 v192, 7, v192
    v_lshrrev_b32 v9, 5, v1
    v_lshl_add_u32 v192, v9, 4, v192
    v_add_u32 v192, 156672, v192
    v_lshrrev_b32 v193, 4, v1
    v_mul_u32_u24 v193, 7168, v193
    v_and_b32 v9, 15, v1
    v_lshl_add_u32 v193, v9, 3, v193
    s_lshl3_add_u32 s96, s75, s3
    s_mul_i32 s97, s96, 28672
    s_lshl_b32 s98, s74, 7
    s_add_u32 s99, s97, s98
    s_add_u32 s80, s99, 22020096
    v_and_b32 v194, 1, v1
    v_lshlrev_b32 v194, 13, v194
    v_bfe_u32 v9, v1, 1, 1
    v_lshl_add_u32 v194, v9, 18, v194
    s_lshr_b32 s96, s9, 2
    s_and_b32 s97, s75, 1
    s_lshr_b32 s98, s3, 1
    s_lshl2_add_u32 s99, s97, s98
    s_and_b32 s97, s3, 1
    s_lshr_b32 s98, s75, 1
    s_lshl2_add_u32 s97, s97, s98
    s_lshl3_add_u32 s98, s99, s97
    s_lshl_b32 s99, s98, 12
    s_lshl_b32 s97, s8, 6
    s_add_u32 s98, s99, s97
    s_lshl2_add_u32 s99, s96, s98
    s_add_u32 s97, s99, 1048576
    s_add_u32 s81, s97, 3072
    s_cmp_lt_u32 s3, 4
    s_cbranch_scc1 L_HW
    s_barrier
    ds_read_b64_tr_b16 v[120:121], v35
    ds_read_b64_tr_b16 v[122:123], v35 offset:1024
    ds_read_b64_tr_b16 v[124:125], v35 offset:8192
    ds_read_b64_tr_b16 v[126:127], v35 offset:9216
    ds_read_b64_tr_b16 v[128:129], v35 offset:16384
    ds_read_b64_tr_b16 v[130:131], v35 offset:17408
    ds_read_b64_tr_b16 v[132:133], v35 offset:24576
    ds_read_b64_tr_b16 v[134:135], v35 offset:25600
    s_cmp_lg_u32 s3, 7
    s_cbranch_scc1 L_NOH
    s_bitcmp1_b32 s9, 3
    s_cselect_b32 s15, s25, s24
    s_cselect_b32 s17, s18, s17
    s_andn2_b32 s18, 2047, s15
L_PAD10:
    s_cbranch_execz L_RET10
    s_lshr_b32 s96, s8, 1
    s_lshl2_add_u32 s19, s12, s96
    s_lshr_b32 s96, s19, 1
    s_lshr_b32 s97, s9, 3
    s_lshl_b32 s98, s97, 1
    s_lshl2_add_u32 s99, s96, s98
    s_and_b32 s97, s19, 1
    s_add_u32 s96, s99, s97
    s_mul_i32 s98, s96, 7168
    s_add_u32 s20, s98, 22020096
    s_lshl_b32 s96, s18, 11
    s_lshl_b32 s97, s19, 5
    s_add_u32 s82, s96, s97
    v_and_b32 v10, 7, v1
    v_lshlrev_b32 v10, 2, v10
    s_lshr_b32 s96, s8, 1
    s_lshl_b32 s97, s96, 6
    s_add_u32 s13, s97, 157184
    v_and_b32 v5, 7, v1
    v_lshl_add_u32 v5, v5, 3, s13
    ds_read_b64 v[206:207], v5
    s_and_b32 s96, s17, 31
    s_lshl_b32 s97, s96, 13
    s_lshl_b32 s98, s12, 9
    s_add_u32 s99, s97, s98
    s_lshr_b32 s96, s8, 1
    s_lshl_b32 s97, s96, 5
    s_add_u32 s98, s99, s97
    s_add_u32 s91, s98, 13631488
    s_lshr_b32 s13, s15, 11
    s_lshl_b32 s13, s13, 16
    s_ashr_i32 s15, s13, 31
    s_andn2_b32 s15, 0x7fff0000, s15
    s_or_b32 s15, s15, 0x80000000
    s_xor_b32 s13, s13, s15
    v_mov_b32 v204, s13
    v_mul_f32 v204, s7, v204
    v_exp_f32 v204, -v204
    s_nop 0
    v_add_f32 v204, 1.0, v204
    v_rcp_f32 v204, v204
    s_nop 0
    v_cvt_pk_bf16_f32 v204, 0, v204
    v_mov_b32 v5, s4
    v_not_b32 v6, v5
POLL_48:
    buffer_load_dword v244, v10, s[32:35], s91 offen sc1
    buffer_load_dword v245, v10, s[32:35], s91 offen offset:128 sc1
    s_waitcnt vmcnt(0)
    v_max_u32 v246, v244, v245
    v_cmp_ne_u32 vcc, -1, v246
    s_nop 1
    v_cndmask_b32 v246, v6, v5, vcc
    v_cmp_ne_u32 vcc, s4, v246
    s_cbranch_vccz PDONE_49
    s_add_u32 s5, s5, 1
    s_cmp_lt_u32 s5, 200000
    s_cbranch_scc1 POLL_48
PDONE_49:
    v_lshlrev_b32 v246, 16, v245
    v_and_b32 v247, s6, v245
    v_and_b32 v245, s6, v244
    v_lshlrev_b32 v244, 16, v244
    s_branch L_NOH
L_HW:
    s_lshl_b32 s96, s3, 8
    s_add_u32 s13, s96, s14
    v_lshrrev_b32 v4, 4, v1
    v_lshlrev_b32 v4, 11, v4
    v_and_b32 v9, 15, v1
    v_lshl_add_u32 v4, v9, 4, v4
    s_lshl_b32 s96, s3, 5
    s_add_u32 s15, s96, 156672
    v_lshrrev_b32 v5, 5, v1
    v_lshl_add_u32 v5, v5, 7, s15
    v_bfe_u32 v9, v1, 2, 1
    v_lshl_add_u32 v5, v9, 4, v5
    v_bfe_u32 v9, v1, 1, 1
    v_lshl_add_u32 v5, v9, 3, v5
    v_bfe_u32 v9, v1, 3, 1
    v_lshl_add_u32 v5, v9, 2, v5
    v_and_b32 v9, 1, v1
    v_lshl_add_u32 v5, v9, 1, v5
    s_load_dword s24, s[32:33], s13 offset:1276 glc
    s_load_dword s25, s[32:33], s13 offset:3324 glc
    s_load_dword s26, s[32:33], s13 offset:5372 glc
    s_load_dword s27, s[32:33], s13 offset:7420 glc
    s_barrier
    ds_read_b64_tr_b16 v[120:121], v35
    ds_read_b64_tr_b16 v[122:123], v35 offset:1024
    ds_read_b64_tr_b16 v[124:125], v35 offset:8192
    ds_read_b64_tr_b16 v[126:127], v35 offset:9216
    ds_read_b64_tr_b16 v[128:129], v35 offset:16384
    ds_read_b64_tr_b16 v[130:131], v35 offset:17408
    ds_read_b64_tr_b16 v[132:133], v35 offset:24576
    ds_read_b64_tr_b16 v[134:135], v35 offset:25600
    s_branch SCHK_51
SPOLL_50:
    s_load_dword s24, s[32:33], s13 offset:1276 glc
    s_load_dword s25, s[32:33], s13 offset:3324 glc
    s_load_dword s26, s[32:33], s13 offset:5372 glc
    s_load_dword s27, s[32:33], s13 offset:7420 glc
SCHK_51:
    s_add_u32 s5, s5, 1
    s_cmp_ge_u32 s5, 200000
    s_waitcnt lgkmcnt(0)
    s_cbranch_scc1 SDONE_52
    s_cmp_lg_u32 s24, s4
    s_cbranch_scc1 SPOLL_50
    s_cmp_lg_u32 s25, s4
    s_cbranch_scc1 SPOLL_50
    s_cmp_lg_u32 s26, s4
    s_cbranch_scc1 SPOLL_50
    s_cmp_lg_u32 s27, s4
    s_cbranch_scc1 SPOLL_50
SDONE_52:
POLL_53:
    buffer_load_dwordx4 v[88:91], v4, s[32:35], s13 offen sc1
    buffer_load_dwordx4 v[92:95], v4, s[32:35], s13 offen offset:1024 sc1
    s_waitcnt vmcnt(0)
    v_bitop3_b32 v6, v89, v91, s4 bitop3:0x7e
    v_bitop3_b32 v6, v6, v93, s4 bitop3:0xf6
    v_bitop3_b32 v6, v6, v95, s4 bitop3:0xf6
    v_cmp_ne_u32 vcc, 0, v6
    s_cbranch_vccz PDONE_54
    s_add_u32 s5, s5, 1
    s_cmp_lt_u32 s5, 200000
    s_cbranch_scc1 POLL_53
PDONE_54:
    v_permlane32_swap_b32 v88, v90
    v_permlane32_swap_b32 v92, v94
    v_add_f32 v88, v88, v90
    v_add_f32 v92, v92, v94
    v_mov_b32 v90, v88
    v_mov_b32 v94, v92
    s_nop 0
    v_permlane16_swap_b32 v88, v90
    v_permlane16_swap_b32 v92, v94
    v_add_f32 v88, v88, v90
    v_add_f32 v92, v92, v94
    v_cvt_pk_bf16_f32 v88, 0, v88
    v_cvt_pk_bf16_f32 v92, 0, v92
    v_mul_f32 v6, s7, v88
    v_exp_f32 v6, -v6
    s_nop 0
    v_add_f32 v6, 1.0, v6
    v_rcp_f32 v6, v6
    s_nop 0
    v_mul_f32 v88, v88, v6
    v_cvt_pk_bf16_f32 v88, 0, v88
    v_mul_f32 v88, v88, v92
    v_cvt_pk_bf16_f32 v88, v88, v88
    ds_write_b16 v5, v88
L_NOH:
    s_waitcnt lgkmcnt(0)
    s_barrier
    ds_read_b128 v[88:91], v192
    ds_read_b128 v[92:95], v192 offset:32
    ds_read_b128 v[96:99], v192 offset:64
    ds_read_b128 v[100:103], v192 offset:96
    s_waitcnt lgkmcnt(3)
    v_mfma_f32_32x32x16_bf16 v[208:223], v[88:91], v[120:123], 0
    s_waitcnt lgkmcnt(2)
    v_mfma_f32_32x32x16_bf16 v[208:223], v[92:95], v[124:127], v[208:223]
    s_waitcnt lgkmcnt(1)
    v_mfma_f32_32x32x16_bf16 v[208:223], v[96:99], v[128:131], v[208:223]
    s_waitcnt lgkmcnt(0)
    v_mfma_f32_32x32x16_bf16 v[208:223], v[100:103], v[132:135], v[208:223]
    s_nop 11
    v_mov_b32 v209, s4
    buffer_store_dwordx2 v[208:209], v193, s[32:35], s80 offen sc1
    s_mov_b64 exec, 15
    buffer_store_dword v209, v194, s[32:35], s81 offen sc1
    s_mov_b64 exec, -1
    s_barrier
    s_branch L_FIN2
L_FIN3:
    s_waitcnt lgkmcnt(0)
L_FIN2:
    v_cmp_ne_u32 vcc, s68, v42
    v_cmp_ne_u32 s[22:23], s69, v42
    s_nop 0
    s_and_b64 exec, vcc, s[22:23]
    buffer_store_dwordx4 v[232:235], v33, s[64:67], s70 offen sc1
    s_mov_b64 exec, -1
    v_cmp_ne_u32 vcc, s68, v43
    v_cmp_ne_u32 s[22:23], s69, v43
    s_nop 0
    s_and_b64 exec, vcc, s[22:23]
    buffer_store_dwordx4 v[236:239], v33, s[64:67], s71 offen sc1
    s_mov_b64 exec, -1
    s_cmp_ge_u32 s9, 16
    s_cbranch_scc1 L_FIN
SPOLL_55:
    s_load_dwordx8 s[24:31], s[32:33], s92 offset:3072 glc
SCHK_56:
    s_add_u32 s5, s5, 1
    s_cmp_ge_u32 s5, 200000
    s_waitcnt lgkmcnt(0)
    s_cbranch_scc1 SDONE_57
    s_cmp_lg_u32 s24, s4
    s_cbranch_scc1 SPOLL_55
    s_cmp_lg_u32 s25, s4
    s_cbranch_scc1 SPOLL_55
    s_cmp_lg_u32 s26, s4
    s_cbranch_scc1 SPOLL_55
    s_cmp_lg_u32 s27, s4
    s_cbranch_scc1 SPOLL_55
    s_cmp_lg_u32 s28, s4
    s_cbranch_scc1 SPOLL_55
    s_cmp_lg_u32 s29, s4
    s_cbranch_scc1 SPOLL_55
    s_cmp_lg_u32 s30, s4
    s_cbranch_scc1 SPOLL_55
SDONE_57:
    s_barrier
    s_cmp_lg_u32 s3, 7
    s_cbranch_scc1 L_FIN
    s_add_u32 s13, s20, 4096
POLL_58:
    buffer_load_dwordx4 v[88:91], v2, s[32:35], s20 offen sc1
    buffer_load_dwordx4 v[92:95], v2, s[32:35], s20 offen offset:1024 sc1
    buffer_load_dwordx4 v[96:99], v2, s[32:35], s20 offen offset:2048 sc1
    buffer_load_dwordx4 v[100:103], v2, s[32:35], s20 offen offset:3072 sc1
    buffer_load_dwordx4 v[104:107], v2, s[32:35], s13 offen sc1
    buffer_load_dwordx4 v[108:111], v2, s[32:35], s13 offen offset:1024 sc1
    buffer_load_dwordx4 v[112:115], v2, s[32:35], s13 offen offset:2048 sc1
    s_waitcnt vmcnt(0)
    v_bitop3_b32 v4, v89, v91, s4 bitop3:0x7e
    v_bitop3_b32 v4, v4, v93, s4 bitop3:0xf6
    v_bitop3_b32 v4, v4, v95, s4 bitop3:0xf6
    v_bitop3_b32 v4, v4, v97, s4 bitop3:0xf6
    v_bitop3_b32 v4, v4, v99, s4 bitop3:0xf6
    v_bitop3_b32 v4, v4, v101, s4 bitop3:0xf6
    v_bitop3_b32 v4, v4, v103, s4 bitop3:0xf6
    v_bitop3_b32 v4, v4, v105, s4 bitop3:0xf6
    v_bitop3_b32 v4, v4, v107, s4 bitop3:0xf6
    v_bitop3_b32 v4, v4, v109, s4 bitop3:0xf6
    v_bitop3_b32 v4, v4, v111, s4 bitop3:0xf6
    v_bitop3_b32 v4, v4, v113, s4 bitop3:0xf6
    v_bitop3_b32 v4, v4, v115, s4 bitop3:0xf6
    v_cmp_ne_u32 vcc, 0, v4
    s_cbranch_vccz PDONE_59
    s_add_u32 s5, s5, 1
    s_cmp_lt_u32 s5, 200000
    s_cbranch_scc1 POLL_58
PDONE_59:
    v_add_f32 v88, v88, v92
    v_add_f32 v90, v90, v94
    v_add_f32 v96, v96, v100
    v_add_f32 v98, v98, v102
    v_add_f32 v104, v104, v108
    v_add_f32 v106, v106, v110
    v_add_f32 v88, v88, v96
    v_add_f32 v90, v90, v98
    v_add_f32 v104, v104, v112
    v_add_f32 v106, v106, v114
    v_add_f32 v88, v88, v104
    v_add_f32 v89, v90, v106
    s_nop 1
    v_permlane32_swap_b32 v88, v89
    v_add_f32 v88, v88, v89
    s_nop 1
    v_add_f32_dpp v88, v88, v88 row_ror:8 row_mask:0xf bank_mask:0xf
    v_mov_b32 v89, v88
    s_nop 1
    v_permlane16_swap_b32 v88, v89
    v_add_f32 v89, v88, v89
    v_cvt_pk_bf16_f32 v88, 0, v89
    v_cvt_pk_bf16_f32 v89, 0, v89
    s_nop 1
    v_permlane32_swap_b32 v88, v89
    v_pk_mul_f32 v[88:89], v[88:89], v[204:205] op_sel_hi:[1,0]
    v_cvt_pk_bf16_f32 v88, 0, v88
    v_cvt_pk_bf16_f32 v89, 0, v89
    v_pk_add_f32 v[88:89], v[88:89], v[244:245]
    v_cvt_pk_bf16_f32 v88, 0, v88
    v_cvt_pk_bf16_f32 v89, 0, v89
    v_pk_mul_f32 v[88:89], v[88:89], v[206:207]
    v_cvt_pk_bf16_f32 v88, 0, v88
    v_cvt_pk_bf16_f32 v89, 0, v89
    v_pk_add_f32 v[88:89], v[88:89], v[246:247]
    v_cvt_pk_bf16_f32 v88, v88, v89
    s_mov_b64 exec, 0xff
    buffer_store_dword v88, v10, s[64:67], s82 offen
    s_mov_b64 exec, -1
L_FIN:
L_END:
    s_endpgm
.p2align 10
.fill 768, 4, 0xbf800000
.section .rodata,"a"
.p2align 6
.amdhsa_kernel adaLN_cond__linear_kernel_hedgehog__moe_arch_mod__prompt_kernel
  .amdhsa_next_free_vgpr 256
  .amdhsa_next_free_sgpr 102
  .amdhsa_accum_offset 256
  .amdhsa_group_segment_fixed_size 0
  .amdhsa_kernarg_size 112
  .amdhsa_user_sgpr_count 2
  .amdhsa_user_sgpr_kernarg_segment_ptr 1
  .amdhsa_system_sgpr_workgroup_id_x 1
  .amdhsa_float_denorm_mode_32 3
  .amdhsa_float_denorm_mode_16_64 3
.end_amdhsa_kernel
```

```asm
; @launch grid=(256,1,1) block=(512,1,1) lds=163840
.amdgcn_target "amdgcn-amd-amdhsa--gfx950"
.text
.globl adaLN_cond__linear_kernel_hedgehog__moe_arch_mod__prompt_kernel
.p2align 12
.type adaLN_cond__linear_kernel_hedgehog__moe_arch_mod__prompt_kernel,@function
adaLN_cond__linear_kernel_hedgehog__moe_arch_mod__prompt_kernel:
    s_load_dwordx16 s[68:83], s[0:1], 0
    s_load_dwordx8 s[84:91], s[0:1], 64
    s_load_dwordx2 s[32:33], s[0:1], 104
    s_cmp_ge_u32 s2, 256
    s_cbranch_scc1 L_END
    v_lshrrev_b32 v4, 6, v0
    v_and_b32 v1, 63, v0
    s_nop 0
    v_readfirstlane_b32 s3, v4
    v_lshlrev_b32 v2, 4, v1
    s_mov_b32 s38, 4194304
    s_mov_b32 s39, 0x20000
    s_mov_b32 s50, 12582912
    s_mov_b32 s51, 0x20000
    s_mov_b32 s34, 268435456
    s_mov_b32 s35, 0x20000
    s_mov_b32 s42, 6291456
    s_mov_b32 s43, 0x20000
    s_mov_b32 s46, 2097152
    s_mov_b32 s47, 0x20000
    s_mov_b32 s54, 7340032
    s_mov_b32 s55, 0x20000
    s_mov_b32 s58, 7340032
    s_mov_b32 s59, 0x20000
    s_mov_b32 s62, 7340032
    s_mov_b32 s63, 0x20000
    s_mov_b32 s66, 4194304
    s_mov_b32 s67, 0x20000
    s_mov_b32 s5, 0
    s_mov_b32 s6, 0xffff0000
    s_mov_b32 s7, 0x3fb8aa3b
    s_and_b32 s8, s2, 7
    s_lshr_b32 s9, s2, 3
    s_lshl3_add_u32 s93, s2, s3
    s_and_b32 s96, s8, 4
    s_lshr_b32 s97, s9, 2
    s_lshl1_add_u32 s10, s96, s97
    s_and_b32 s96, s8, 3
    s_and_b32 s97, s9, 3
    s_xor_b32 s98, s97, 2
    s_lshl2_add_u32 s11, s96, s98
    s_and_b32 s96, s8, 1
    s_and_b32 s97, s9, 7
    s_lshl3_add_u32 s12, s96, s97
    s_lshr_b32 s96, s8, 1
    s_lshr_b32 s97, s9, 3
    s_lshl2_add_u32 s21, s96, s97
    s_lshl_b32 s96, s2, 6
    s_add_u32 s97, s96, s3
    s_lshl_b32 s98, s97, 6
    s_add_u32 s92, s98, 1048576
    s_lshr_b32 s96, s8, 1
    s_lshl_b32 s97, s96, 8
    s_lshl3_add_u32 s98, s9, s97
    s_add_u32 s99, s98, s3
    s_lshl_b32 s96, s99, 12
    s_and_b32 s97, s8, 1
    s_lshl_b32 s98, s97, 10
    s_add_u32 s16, s96, s98
    v_and_b32 v8, 31, v1
    v_lshlrev_b32 v8, 4, v8
    v_lshrrev_b32 v9, 5, v1
    v_lshl_add_u32 v8, v9, 11, v8
    s_lshl3_add_u32 s96, s8, s3
    s_lshl_b32 s15, s96, 5
    s_mul_i32 s96, s15, 6144
    s_xor_b32 s97, s9, 1
    s_lshl_b32 s98, s97, 7
    s_add_u32 s13, s96, s98
    s_add_u32 s14, s13, 98304
    s_lshl3_add_u32 s96, s21, s3
    s_lshl_b32 s97, s96, 15
    s_lshl_b32 s98, s12, 7
    s_add_u32 s18, s97, s98
    s_lshr_b32 s96, s8, 1
    s_lshl4_add_u32 s97, s96, s12
    s_lshl4_add_u32 s98, s97, s3
    s_lshl_b32 s99, s98, 9
    s_add_u32 s17, s99, 524288
    v_lshrrev_b32 v248, 3, v1
    v_mul_u32_u24 v248, 12288, v248
    v_and_b32 v9, 7, v1
    v_lshl_add_u32 v248, v9, 4, v248
    v_lshrrev_b32 v249, 3, v1
    v_lshl_add_u32 v249, v249, 1, s15
    v_and_b32 v10, 15, v1
    v_lshlrev_b32 v10, 11, v10
    v_lshrrev_b32 v9, 4, v1
    v_lshl_add_u32 v10, v9, 4, v10
    s_waitcnt lgkmcnt(0)
    s_mov_b64 s[48:49], s[88:89]
    buffer_load_dwordx4 v[160:163], v248, s[48:51], s13 offen nt
    buffer_load_dwordx4 v[164:167], v248, s[48:51], s14 offen nt
    s_load_dword s4, s[32:33], 0
    global_load_ushort v168, v249, s[86:87]
    global_load_ushort v169, v249, s[86:87] offset:16
    s_mov_b64 s[36:37], s[68:69]
    s_load_dword s24, s[32:33], s92 offset:0 glc
    s_load_dword s25, s[32:33], s17 offset:508 glc
    s_load_dword s26, s[32:33], s17 offset:4604 glc
    s_barrier
    buffer_load_dwordx4 v[152:155], v8, s[36:39], s16 offen
    buffer_load_dwordx4 v[156:159], v8, s[36:39], s16 offen offset:512
    s_mov_b64 s[40:41], s[70:71]
    s_mov_b64 s[44:45], s[74:75]
    s_mov_b64 s[52:53], s[80:81]
    s_mov_b64 s[56:57], s[82:83]
    s_mov_b64 s[60:61], s[84:85]
    s_mov_b64 s[64:65], s[90:91]
    s_getpc_b64 s[22:23]
    s_and_b32 s22, s22, 0xfffffc00
    s_lshl3_add_u32 s96, s9, s3
    s_lshl_b32 s19, s96, 7
    v_lshrrev_b32 v4, 5, v1
    v_lshl_add_u32 v4, v4, 15, s19
    v_min_u32 v4, 41984, v4
    global_load_dword v11, v4, s[22:23]
    s_lshr_b32 s76, s3, 2
    s_and_b32 s77, s3, 3
    s_lshl_b32 s83, s3, 10
    s_mul_i32 s96, s8, 7
    s_lshr_b32 s97, s9, 2
    s_add_u32 s74, s96, s97
    s_and_b32 s75, s9, 3
    v_bfe_u32 v6, v1, 4, 1
    v_lshlrev_b32 v6, 6, v6
    v_and_b32 v3, 7, v1
    v_lshlrev_b32 v3, 4, v3
    v_xor_b32 v3, v3, v6
    v_lshrrev_b32 v6, 3, v1
    v_mul_u32_u24 v6, 6144, v6
    v_add_u32 v3, v3, v6
    s_and_b32 s84, s9, 12
    s_mul_i32 s96, s3, 49152
    s_lshl_b32 s97, s11, 7
    s_add_u32 s85, s96, s97
    v_lshlrev_b32 v250, 3, v1
    v_lshlrev_b32 v251, 5, v1
    v_add_u32 v251, 147456, v251
    s_lshl2_add_u32 s13, s3, 147456
    v_lshrrev_b32 v252, 4, v1
    v_lshl_add_u32 v252, v252, 6, s13
    v_and_b32 v9, 7, v1
    v_lshl_add_u32 v252, v9, 8, v252
    v_bfe_u32 v9, v1, 3, 1
    v_lshl_add_u32 v252, v9, 5, v252
    buffer_load_dwordx4 v[12:15], v10, s[36:39], s18 offen
    buffer_load_dwordx4 v[16:19], v10, s[36:39], s18 offen offset:64
    s_lshr_b32 s96, s3, 1
    s_xor_b32 s97, s9, 1
    s_and_b32 s98, s97, 15
    s_lshl4_add_u32 s99, s96, s98
    s_lshr_b32 s97, s9, 4
    s_lshl1_add_u32 s96, s99, s97
    s_lshl3_add_u32 s98, s96, s8
    s_lshl_b32 s99, s98, 9
    s_add_u32 s13, s99, 524288
    s_lshr_b32 s96, s9, 4
    s_lshl_b32 s94, s96, 1
    s_add_u32 s96, s94, s84
    s_and_b32 s97, s96, 15
    s_mul_i32 s98, s97, 393216
    s_add_u32 s91, s98, s85
    s_lshl_b32 s96, s94, 13
    s_add_u32 s94, s96, s83
    s_add_u32 s82, s91, 2048
    s_mov_b32 m0, s94
    s_nop 0
    buffer_load_dwordx4 v3, s[40:43], s82 offen lds
    s_add_u32 s82, s91, 4096
    s_add_u32 m0, s94, 49152
    s_nop 0
    buffer_load_dwordx4 v3, s[40:43], s82 offen lds
    s_waitcnt vmcnt(7)
    v_lshlrev_b32 v168, 16, v168
    v_mul_f32 v4, s7, v168
    v_exp_f32 v4, -v4
    s_nop 0
    v_add_f32 v4, 1.0, v4
    v_rcp_f32 v4, v4
    s_nop 0
    v_mul_f32 v168, v168, v4
    v_cvt_pk_bf16_f32 v168, 0, v168
    v_lshlrev_b32 v169, 16, v169
    v_mul_f32 v5, s7, v169
    v_exp_f32 v5, -v5
    s_nop 0
    v_add_f32 v5, 1.0, v5
    v_rcp_f32 v5, v5
    s_nop 0
    v_mul_f32 v169, v169, v5
    v_cvt_pk_bf16_f32 v169, 0, v169
    v_lshlrev_b32 v4, 16, v160
    v_and_b32 v5, s6, v160
    v_pk_mul_f32 v[176:177], v[168:169], v[4:5] op_sel:[0,0] op_sel_hi:[0,1]
    v_lshlrev_b32 v6, 16, v161
    v_and_b32 v7, s6, v161
    v_pk_mul_f32 v[178:179], v[168:169], v[6:7] op_sel:[0,0] op_sel_hi:[0,1]
    v_lshlrev_b32 v4, 16, v162
    v_and_b32 v5, s6, v162
    v_pk_mul_f32 v[180:181], v[168:169], v[4:5] op_sel:[0,0] op_sel_hi:[0,1]
    v_lshlrev_b32 v6, 16, v163
    v_and_b32 v7, s6, v163
    v_pk_mul_f32 v[182:183], v[168:169], v[6:7] op_sel:[0,0] op_sel_hi:[0,1]
    v_lshlrev_b32 v4, 16, v164
    v_and_b32 v5, s6, v164
    v_pk_fma_f32 v[176:177], v[168:169], v[4:5], v[176:177] op_sel:[1,0,0] op_sel_hi:[1,1,1]
    v_lshlrev_b32 v6, 16, v165
    v_and_b32 v7, s6, v165
    v_pk_fma_f32 v[178:179], v[168:169], v[6:7], v[178:179] op_sel:[1,0,0] op_sel_hi:[1,1,1]
    v_lshlrev_b32 v4, 16, v166
    v_and_b32 v5, s6, v166
    v_pk_fma_f32 v[180:181], v[168:169], v[4:5], v[180:181] op_sel:[1,0,0] op_sel_hi:[1,1,1]
    v_lshlrev_b32 v6, 16, v167
    v_and_b32 v7, s6, v167
    v_pk_fma_f32 v[182:183], v[168:169], v[6:7], v[182:183] op_sel:[1,0,0] op_sel_hi:[1,1,1]
    v_permlane32_swap_b32 v176, v180
    v_permlane32_swap_b32 v177, v181
    v_permlane32_swap_b32 v178, v182
    v_permlane32_swap_b32 v179, v183
    v_add_f32 v176, v176, v180
    v_add_f32 v177, v177, v181
    v_add_f32 v178, v178, v182
    v_add_f32 v179, v179, v183
    s_nop 0
    v_permlane16_swap_b32 v176, v178
    v_permlane16_swap_b32 v177, v179
    v_add_f32 v176, v176, v178
    v_add_f32 v177, v177, v179
    s_nop 0
    v_add_f32_dpp v176, v176, v176 row_ror:8 row_mask:0xf bank_mask:0xf
    v_add_f32_dpp v177, v177, v177 row_ror:8 row_mask:0xf bank_mask:0xf
    s_nop 1
    v_mov_b32_dpp v176, v177 quad_perm:[0,1,2,3] row_mask:0xf bank_mask:0xc
    s_waitcnt lgkmcnt(0)
    s_mul_i32 s4, s4, 0x9e3779b1
    s_add_u32 s4, s4, 0x7f4a7c15
    ds_write_b32 v252, v176
    s_waitcnt lgkmcnt(0)
    s_barrier
    ds_read_b128 v[176:179], v251
    ds_read_b128 v[180:183], v251 offset:16
    s_waitcnt lgkmcnt(0)
    v_pk_add_f32 v[176:177], v[176:177], v[178:179]
    v_pk_add_f32 v[180:181], v[180:181], v[182:183]
    v_pk_add_f32 v[176:177], v[176:177], v[180:181]
    v_add_f32 v176, v176, v177
    v_mov_b32 v177, s4
    s_bitcmp1_b32 s3, 0
    s_cselect_b32 exec_lo, 0, -1
    s_cselect_b32 exec_hi, -1, 0
    buffer_store_dwordx2 v[176:177], v250, s[32:35], s13 offen sc1
    s_mov_b64 exec, -1
    s_waitcnt vmcnt(6)
    v_mov_b32 v8, 0x3f803f80
    v_dot2_f32_bf16 v4, v152, v8, 0
    v_dot2_f32_bf16 v5, v152, v152, 0
    v_dot2_f32_bf16 v6, v153, v8, 0
    v_dot2_f32_bf16 v7, v153, v153, 0
    v_dot2_f32_bf16 v4, v154, v8, v4
    v_dot2_f32_bf16 v5, v154, v154, v5
    v_dot2_f32_bf16 v6, v155, v8, v6
    v_dot2_f32_bf16 v7, v155, v155, v7
    v_dot2_f32_bf16 v4, v156, v8, v4
    v_dot2_f32_bf16 v5, v156, v156, v5
    v_dot2_f32_bf16 v6, v157, v8, v6
    v_dot2_f32_bf16 v7, v157, v157, v7
    v_dot2_f32_bf16 v4, v158, v8, v4
    v_dot2_f32_bf16 v5, v158, v158, v5
    v_dot2_f32_bf16 v6, v159, v8, v6
    v_dot2_f32_bf16 v7, v159, v159, v7
    s_lshl_b32 s96, s3, 5
    s_add_u32 s13, s96, 153600
    v_lshrrev_b32 v8, 5, v1
    v_lshl_add_u32 v8, v8, 4, s13
    v_bfe_u32 v9, v1, 4, 1
    v_lshl_add_u32 v8, v9, 3, v8
    v_pk_add_f32 v[172:173], v[4:5], v[6:7]
    v_and_b32 v5, 15, v1
    v_lshlrev_b32 v5, 4, v5
    v_add_u32 v5, 153600, v5
    v_and_b32 v4, 15, v1
    v_lshlrev_b32 v4, 4, v4
    v_bfe_u32 v9, v1, 4, 1
    v_lshl_add_u32 v4, v9, 12, v4
    v_add_f32_dpp v172, v172, v172 quad_perm:[1,0,3,2] row_mask:0xf bank_mask:0xf
    v_add_f32_dpp v173, v173, v173 quad_perm:[1,0,3,2] row_mask:0xf bank_mask:0xf
    s_nop 0
    v_add_f32_dpp v172, v172, v172 quad_perm:[2,3,0,1] row_mask:0xf bank_mask:0xf
    v_add_f32_dpp v173, v173, v173 quad_perm:[2,3,0,1] row_mask:0xf bank_mask:0xf
    s_nop 0
    v_add_f32_dpp v172, v172, v172 row_half_mirror row_mask:0xf bank_mask:0xf
    v_add_f32_dpp v173, v173, v173 row_half_mirror row_mask:0xf bank_mask:0xf
    s_nop 0
    v_add_f32_dpp v172, v172, v172 row_mirror row_mask:0xf bank_mask:0xf
    v_add_f32_dpp v173, v173, v173 row_mirror row_mask:0xf bank_mask:0xf
    s_and_b32 s96, s9, 24
    s_add_u32 s97, s96, s3
    s_and_b32 s98, s8, 6
    s_lshl3_add_u32 s99, s97, s98
    s_lshl_b32 s96, s99, 12
    s_and_b32 s97, s9, 7
    s_lshl_b32 s98, s97, 9
    s_add_u32 s99, s96, s98
    s_and_b32 s97, s8, 1
    s_lshl_b32 s96, s97, 8
    s_add_u32 s98, s99, s96
    s_add_u32 s13, s98, 2097152
    v_permlane16_swap_b32 v172, v173
    v_add_f32 v172, v172, v173
    v_mov_b32 v173, s4
    ds_write_b64 v8, v[172:173]
    s_waitcnt lgkmcnt(0)
    s_barrier
    ds_read_b128 v[172:175], v5
    s_waitcnt lgkmcnt(0)
    s_mov_b32 exec_hi, 0
    buffer_store_dwordx4 v[172:175], v4, s[32:35], s13 offen sc1
    s_mov_b32 exec_hi, -1
    s_mov_b32 s82, s91
    s_add_u32 m0, s94, 98304
    s_nop 0
    buffer_load_dwordx4 v3, s[40:43], s82 offen lds
    s_lshr_b32 s96, s9, 4
    s_lshl_b32 s97, s96, 1
    s_xor_b32 s94, s97, 1
    s_add_u32 s96, s94, s84
    s_and_b32 s97, s96, 15
    s_mul_i32 s98, s97, 393216
    s_add_u32 s91, s98, s85
    s_lshl_b32 s96, s94, 13
    s_add_u32 s94, s96, s83
    s_add_u32 s82, s91, 2048
    s_mov_b32 m0, s94
    s_nop 0
    buffer_load_dwordx4 v3, s[40:43], s82 offen lds
    s_load_dword s24, s[32:33], s17 offset:508 glc
    s_load_dword s25, s[32:33], s17 offset:4604 glc
    v_and_b32 v4, 31, v1
    v_lshlrev_b32 v4, 4, v4
    v_lshrrev_b32 v9, 5, v1
    v_lshl_add_u32 v4, v9, 12, v4
    s_lshl2_add_u32 s14, s3, 155648
    v_lshl_add_u32 v5, v1, 6, s14
    v_and_b32 v6, 3, v1
    v_lshlrev_b32 v6, 5, v6
    v_lshrrev_b32 v9, 5, v1
    v_lshl_add_u32 v6, v9, 7, v6
    v_bfe_u32 v9, v1, 4, 1
    v_lshl_add_u32 v6, v9, 8, v6
    v_bfe_u32 v9, v1, 2, 2
    v_lshl_add_u32 v6, v9, 9, v6
    v_add_u32 v6, 155648, v6
    s_lshl3_add_u32 s96, s2, s3
    s_lshl_b32 s97, s96, 9
    s_add_u32 s14, s97, 2097152
    v_and_b32 v8, 31, v1
    v_lshlrev_b32 v8, 4, v8
    s_branch SCHK_2
SPOLL_1:
    s_load_dword s24, s[32:33], s17 offset:508 glc
    s_load_dword s25, s[32:33], s17 offset:4604 glc
SCHK_2:
    s_add_u32 s5, s5, 1
    s_cmp_ge_u32 s5, 200000
    s_waitcnt lgkmcnt(0)
    s_cbranch_scc1 SDONE_3
    s_cmp_lg_u32 s24, s4
    s_cbranch_scc1 SPOLL_1
    s_cmp_lg_u32 s25, s4
    s_cbranch_scc1 SPOLL_1
SDONE_3:
    buffer_load_dwordx4 v[176:179], v4, s[32:35], s17 offen sc1
    s_load_dword s24, s[32:33], s14 offset:252 glc
    s_load_dword s25, s[32:33], s14 offset:508 glc
    s_waitcnt vmcnt(7)
    v_permlane32_swap_b32 v12, v14
    v_permlane32_swap_b32 v13, v15
    v_permlane32_swap_b32 v16, v18
    v_permlane32_swap_b32 v17, v19
    v_lshlrev_b32 v184, 16, v12
    v_and_b32 v185, s6, v12
    v_lshlrev_b32 v186, 16, v13
    v_and_b32 v187, s6, v13
    v_lshlrev_b32 v188, 16, v14
    v_and_b32 v189, s6, v14
    v_lshlrev_b32 v190, 16, v15
    v_and_b32 v191, s6, v15
    v_lshlrev_b32 v192, 16, v16
    v_and_b32 v193, s6, v16
    v_lshlrev_b32 v194, 16, v17
    v_and_b32 v195, s6, v17
    v_lshlrev_b32 v196, 16, v18
    v_and_b32 v197, s6, v18
    v_lshlrev_b32 v198, 16, v19
    v_and_b32 v199, s6, v19
    s_branch SCHK_6
SPOLL_5:
    s_load_dword s24, s[32:33], s14 offset:252 glc
    s_load_dword s25, s[32:33], s14 offset:508 glc
SCHK_6:
    s_add_u32 s5, s5, 1
    s_cmp_ge_u32 s5, 200000
    s_waitcnt lgkmcnt(0)
    s_cbranch_scc1 SDONE_7
    s_cmp_lg_u32 s24, s4
    s_cbranch_scc1 SPOLL_5
    s_cmp_lg_u32 s25, s4
    s_cbranch_scc1 SPOLL_5
SDONE_7:
    buffer_load_dwordx4 v[172:175], v8, s[32:35], s14 offen sc1
    s_add_u32 s82, s91, 4096
    s_add_u32 m0, s94, 49152
    s_nop 0
    buffer_load_dwordx4 v3, s[40:43], s82 offen lds
    s_mov_b32 s82, s91
    s_add_u32 m0, s94, 98304
    s_nop 0
    buffer_load_dwordx4 v3, s[40:43], s82 offen lds
    s_waitcnt vmcnt(3)
    v_bitop3_b32 v7, v177, v179, s4 bitop3:0x7e
    v_cmp_ne_u32 vcc, 0, v7
    s_cbranch_vccz TOK_8
POLL_9:
    buffer_load_dwordx4 v[176:179], v4, s[32:35], s17 offen sc1
    s_waitcnt vmcnt(0)
    v_bitop3_b32 v7, v177, v179, s4 bitop3:0x7e
    v_cmp_ne_u32 vcc, 0, v7
    s_cbranch_vccz PDONE_10
    s_add_u32 s5, s5, 1
    s_cmp_lt_u32 s5, 200000
    s_cbranch_scc1 POLL_9
PDONE_10:
TOK_8:
    ds_write2_b32 v5, v176, v178 offset0:0 offset1:8
    s_waitcnt lgkmcnt(0)
    s_barrier
    ds_read_b128 v[208:211], v6 offset:2048
    ds_read_b128 v[212:215], v6 offset:2064
    ds_read_b128 v[200:203], v6
    ds_read_b128 v[204:207], v6 offset:16
    s_lshl_b32 s96, s11, 12
    s_lshl_b32 s97, s3, 9
    s_add_u32 s13, s96, s97
    v_add_u32 v4, s13, v2
    s_lshl_b32 s96, s3, 9
    s_add_u32 m0, s96, 159744
    s_mov_b32 exec_hi, 0
    global_load_lds_dwordx4 v4, s[72:73]
    s_mov_b32 exec_hi, -1
    s_lshl4_add_u32 s96, s21, s12
    s_lshr_b32 s97, s3, 1
    s_lshl2_add_u32 s98, s96, s97
    s_lshl_b32 s99, s98, 12
    s_and_b32 s96, s3, 1
    s_lshl_b32 s97, s96, 8
    s_add_u32 s98, s99, s97
    s_add_u32 s13, s98, 4194304
    v_and_b32 v4, 15, v1
    v_lshlrev_b32 v4, 4, v4
    v_bfe_u32 v9, v1, 4, 1
    v_lshl_add_u32 v4, v9, 10, v4
    v_lshrrev_b32 v9, 5, v1
    v_lshl_add_u32 v4, v9, 9, v4
    s_waitcnt lgkmcnt(2)
    v_pk_add_f32 v[208:209], v[208:209], v[210:211]
    v_pk_add_f32 v[212:213], v[212:213], v[214:215]
    v_pk_add_f32 v[208:209], v[208:209], v[212:213]
    v_add_f32 v208, v208, v209
    v_cvt_pk_bf16_f32 v208, 0, v208
    s_waitcnt lgkmcnt(0)
    v_pk_add_f32 v[200:201], v[200:201], v[202:203]
    v_pk_add_f32 v[204:205], v[204:205], v[206:207]
    v_pk_add_f32 v[200:201], v[200:201], v[204:205]
    v_add_f32 v200, v200, v201
    v_add_f32 v208, 1.0, v208
    v_cvt_pk_bf16_f32 v208, 0, v208
    v_cvt_pk_bf16_f32 v200, 0, v200
    s_waitcnt vmcnt(3)
    v_bitop3_b32 v7, v173, v175, s4 bitop3:0x7e
    v_cmp_ne_u32 vcc, 0, v7
    s_cbranch_vccz L_STOK
POLL_11:
    buffer_load_dwordx4 v[172:175], v8, s[32:35], s14 offen sc1
    s_waitcnt vmcnt(0)
    v_bitop3_b32 v7, v173, v175, s4 bitop3:0x7e
    v_cmp_ne_u32 vcc, 0, v7
    s_cbranch_vccz PDONE_12
    s_add_u32 s5, s5, 1
    s_cmp_lt_u32 s5, 200000
    s_cbranch_scc1 POLL_11
PDONE_12:
L_STOK:
    v_permlane16_swap_b32 v172, v174
    v_add_f32 v175, v172, v174
    v_mul_f32 v174, 0x3a800000, v175
    v_mul_f32 v175, 0x3a800000, v175
    s_nop 1
    v_permlane16_swap_b32 v174, v175
    v_fma_f32 v172, -v174, v174, v175
    v_cvt_pk_bf16_f32 v173, 0, v174
    v_max_f32 v172, 0, v172
    v_cvt_pk_bf16_f32 v172, 0, v172
    v_pk_add_f32 v[184:185], v[172:173], v[184:185] op_sel:[1,0] neg_lo:[1,0] neg_hi:[1,0]
    v_pk_add_f32 v[186:187], v[172:173], v[186:187] op_sel:[1,0] neg_lo:[1,0] neg_hi:[1,0]
    v_pk_add_f32 v[188:189], v[172:173], v[188:189] op_sel:[1,0] neg_lo:[1,0] neg_hi:[1,0]
    v_pk_add_f32 v[190:191], v[172:173], v[190:191] op_sel:[1,0] neg_lo:[1,0] neg_hi:[1,0]
    v_add_f32 v172, 0x3727c5ac, v172
    v_cvt_pk_bf16_f32 v172, 0, v172
    v_sqrt_f32 v172, v172
    s_nop 0
    v_pk_add_f32 v[192:193], v[172:173], v[192:193] op_sel:[1,0] neg_lo:[1,0] neg_hi:[1,0]
    v_pk_add_f32 v[194:195], v[172:173], v[194:195] op_sel:[1,0] neg_lo:[1,0] neg_hi:[1,0]
    v_pk_add_f32 v[196:197], v[172:173], v[196:197] op_sel:[1,0] neg_lo:[1,0] neg_hi:[1,0]
    v_pk_add_f32 v[198:199], v[172:173], v[198:199] op_sel:[1,0] neg_lo:[1,0] neg_hi:[1,0]
    v_cvt_pk_bf16_f32 v172, 0, v172
    v_rcp_f32 v172, v172
    v_cvt_pk_bf16_f32 v184, 0, v184
    v_cvt_pk_bf16_f32 v185, 0, v185
    v_cvt_pk_bf16_f32 v186, 0, v186
    v_cvt_pk_bf16_f32 v187, 0, v187
    v_cvt_pk_bf16_f32 v188, 0, v188
    v_cvt_pk_bf16_f32 v189, 0, v189
    v_cvt_pk_bf16_f32 v190, 0, v190
    v_cvt_pk_bf16_f32 v191, 0, v191
    v_cvt_pk_bf16_f32 v192, 0, v192
    v_cvt_pk_bf16_f32 v193, 0, v193
    v_cvt_pk_bf16_f32 v194, 0, v194
    v_cvt_pk_bf16_f32 v195, 0, v195
    v_cvt_pk_bf16_f32 v196, 0, v196
    v_cvt_pk_bf16_f32 v197, 0, v197
    v_cvt_pk_bf16_f32 v198, 0, v198
    v_cvt_pk_bf16_f32 v199, 0, v199
    v_pk_mul_f32 v[184:185], v[184:185], v[172:173] op_sel_hi:[1,0]
    v_pk_mul_f32 v[186:187], v[186:187], v[172:173] op_sel_hi:[1,0]
    v_pk_mul_f32 v[188:189], v[188:189], v[172:173] op_sel_hi:[1,0]
    v_pk_mul_f32 v[190:191], v[190:191], v[172:173] op_sel_hi:[1,0]
    v_pk_mul_f32 v[192:193], v[192:193], v[172:173] op_sel_hi:[1,0]
    v_pk_mul_f32 v[194:195], v[194:195], v[172:173] op_sel_hi:[1,0]
    v_pk_mul_f32 v[196:197], v[196:197], v[172:173] op_sel_hi:[1,0]
    v_pk_mul_f32 v[198:199], v[198:199], v[172:173] op_sel_hi:[1,0]
    v_cvt_pk_bf16_f32 v184, 0, v184
    v_cvt_pk_bf16_f32 v185, 0, v185
    v_cvt_pk_bf16_f32 v186, 0, v186
    v_cvt_pk_bf16_f32 v187, 0, v187
    v_cvt_pk_bf16_f32 v188, 0, v188
    v_cvt_pk_bf16_f32 v189, 0, v189
    v_cvt_pk_bf16_f32 v190, 0, v190
    v_cvt_pk_bf16_f32 v191, 0, v191
    v_cvt_pk_bf16_f32 v192, 0, v192
    v_cvt_pk_bf16_f32 v193, 0, v193
    v_cvt_pk_bf16_f32 v194, 0, v194
    v_cvt_pk_bf16_f32 v195, 0, v195
    v_cvt_pk_bf16_f32 v196, 0, v196
    v_cvt_pk_bf16_f32 v197, 0, v197
    v_cvt_pk_bf16_f32 v198, 0, v198
    v_cvt_pk_bf16_f32 v199, 0, v199
    v_mul_f32_dpp v184, v208, v184 row_newbcast:0 row_mask:0xf bank_mask:0xf
    v_mul_f32_dpp v185, v208, v185 row_newbcast:1 row_mask:0xf bank_mask:0xf
    v_mul_f32_dpp v186, v208, v186 row_newbcast:2 row_mask:0xf bank_mask:0xf
    v_mul_f32_dpp v187, v208, v187 row_newbcast:3 row_mask:0xf bank_mask:0xf
    v_mul_f32_dpp v188, v208, v188 row_newbcast:4 row_mask:0xf bank_mask:0xf
    v_mul_f32_dpp v189, v208, v189 row_newbcast:5 row_mask:0xf bank_mask:0xf
    v_mul_f32_dpp v190, v208, v190 row_newbcast:6 row_mask:0xf bank_mask:0xf
    v_mul_f32_dpp v191, v208, v191 row_newbcast:7 row_mask:0xf bank_mask:0xf
    v_cvt_pk_bf16_f32 v184, 0, v184
    v_cvt_pk_bf16_f32 v185, 0, v185
    v_cvt_pk_bf16_f32 v186, 0, v186
    v_cvt_pk_bf16_f32 v187, 0, v187
    v_cvt_pk_bf16_f32 v188, 0, v188
    v_cvt_pk_bf16_f32 v189, 0, v189
    v_cvt_pk_bf16_f32 v190, 0, v190
    v_cvt_pk_bf16_f32 v191, 0, v191
    v_add_f32_dpp v184, v200, v184 row_newbcast:0 row_mask:0xf bank_mask:0xf
    v_add_f32_dpp v185, v200, v185 row_newbcast:1 row_mask:0xf bank_mask:0xf
    v_add_f32_dpp v186, v200, v186 row_newbcast:2 row_mask:0xf bank_mask:0xf
    v_add_f32_dpp v187, v200, v187 row_newbcast:3 row_mask:0xf bank_mask:0xf
    v_add_f32_dpp v188, v200, v188 row_newbcast:4 row_mask:0xf bank_mask:0xf
    v_add_f32_dpp v189, v200, v189 row_newbcast:5 row_mask:0xf bank_mask:0xf
    v_add_f32_dpp v190, v200, v190 row_newbcast:6 row_mask:0xf bank_mask:0xf
    v_add_f32_dpp v191, v200, v191 row_newbcast:7 row_mask:0xf bank_mask:0xf
    v_cvt_pk_bf16_f32 v216, v184, v185
    v_cvt_pk_bf16_f32 v217, v186, v187
    v_cvt_pk_bf16_f32 v218, v188, v189
    v_cvt_pk_bf16_f32 v219, v190, v191
    buffer_store_dwordx4 v[216:219], v4, s[32:35], s13 offen sc1
    v_mul_f32_dpp v192, v208, v192 row_newbcast:8 row_mask:0xf bank_mask:0xf
    v_mul_f32_dpp v193, v208, v193 row_newbcast:9 row_mask:0xf bank_mask:0xf
    v_mul_f32_dpp v194, v208, v194 row_newbcast:10 row_mask:0xf bank_mask:0xf
    v_mul_f32_dpp v195, v208, v195 row_newbcast:11 row_mask:0xf bank_mask:0xf
    v_mul_f32_dpp v196, v208, v196 row_newbcast:12 row_mask:0xf bank_mask:0xf
    v_mul_f32_dpp v197, v208, v197 row_newbcast:13 row_mask:0xf bank_mask:0xf
    v_mul_f32_dpp v198, v208, v198 row_newbcast:14 row_mask:0xf bank_mask:0xf
    v_mul_f32_dpp v199, v208, v199 row_newbcast:15 row_mask:0xf bank_mask:0xf
    v_cvt_pk_bf16_f32 v192, 0, v192
    v_cvt_pk_bf16_f32 v193, 0, v193
    v_cvt_pk_bf16_f32 v194, 0, v194
    v_cvt_pk_bf16_f32 v195, 0, v195
    v_cvt_pk_bf16_f32 v196, 0, v196
    v_cvt_pk_bf16_f32 v197, 0, v197
    v_cvt_pk_bf16_f32 v198, 0, v198
    v_cvt_pk_bf16_f32 v199, 0, v199
    v_add_f32_dpp v192, v200, v192 row_newbcast:8 row_mask:0xf bank_mask:0xf
    v_add_f32_dpp v193, v200, v193 row_newbcast:9 row_mask:0xf bank_mask:0xf
    v_add_f32_dpp v194, v200, v194 row_newbcast:10 row_mask:0xf bank_mask:0xf
    v_add_f32_dpp v195, v200, v195 row_newbcast:11 row_mask:0xf bank_mask:0xf
    v_add_f32_dpp v196, v200, v196 row_newbcast:12 row_mask:0xf bank_mask:0xf
    v_add_f32_dpp v197, v200, v197 row_newbcast:13 row_mask:0xf bank_mask:0xf
    v_add_f32_dpp v198, v200, v198 row_newbcast:14 row_mask:0xf bank_mask:0xf
    v_add_f32_dpp v199, v200, v199 row_newbcast:15 row_mask:0xf bank_mask:0xf
    v_cvt_pk_bf16_f32 v220, v192, v193
    v_cvt_pk_bf16_f32 v221, v194, v195
    v_cvt_pk_bf16_f32 v222, v196, v197
    v_cvt_pk_bf16_f32 v223, v198, v199
    buffer_store_dwordx4 v[220:223], v4, s[32:35], s13 offen offset:2048 sc1
    v_bfe_u32 v20, v1, 2, 2
    v_lshlrev_b32 v20, 7, v20
    v_bfe_u32 v9, v1, 3, 1
    v_lshl_add_u32 v20, v9, 6, v20
    v_bfe_u32 v9, v1, 4, 1
    v_lshl_add_u32 v20, v9, 5, v20
    v_and_b32 v9, 3, v1
    v_lshl_add_u32 v20, v9, 3, v20
    v_lshrrev_b32 v9, 5, v1
    v_lshl_add_u32 v20, v9, 9, v20
    v_xor_b32 v21, 64, v20
    v_add_u32 v22, 49152, v20
    v_add_u32 v23, 49152, v21
    v_add_u32 v24, 98304, v20
    v_add_u32 v25, 98304, v21
    v_and_b32 v5, 3, v1
    v_lshlrev_b32 v5, 15, v5
    v_bfe_u32 v9, v1, 2, 2
    v_lshl_add_u32 v5, v9, 12, v5
    s_and_b32 s96, s12, 1
    s_lshr_b32 s97, s21, 3
    s_and_b32 s98, s21, 7
    s_lshl_b32 s99, s98, 5
    s_lshl2_add_u32 s98, s97, s99
    s_lshl_b32 s97, s98, 12
    s_lshr_b32 s99, s12, 1
    s_lshl_b32 s98, s99, 6
    s_add_u32 s99, s97, s98
    s_lshl2_add_u32 s97, s96, s99
    s_add_u32 s13, s97, 1048576
    s_lshl_b32 s96, s10, 18
    s_lshl_b32 s97, s77, 12
    s_add_u32 s98, s96, s97
    s_add_u32 s88, s98, 4194304
    s_cmp_ge_u32 s9, 28
    s_cselect_b32 s54, 0, s54
    s_cselect_b32 s58, 0, s58
    s_cselect_b32 s62, 0, s62
    s_waitcnt vmcnt(0)
    s_barrier
    s_cmp_lg_u32 s3, 0
    s_cbranch_scc1 L_PB
    v_mov_b32 v6, s4
    s_mov_b32 exec_hi, 0
    s_mov_b32 exec_lo, 65535
    buffer_store_dword v6, v5, s[32:35], s13 offen sc1
    s_mov_b64 exec, -1
L_PB:
    s_lshr_b32 s96, s9, 4
    s_lshl_b32 s97, s96, 1
    s_xor_b32 s94, s97, 2
    s_add_u32 s96, s94, s84
    s_and_b32 s97, s96, 15
    s_mul_i32 s98, s97, 393216
    s_add_u32 s91, s98, s85
    s_lshl_b32 s96, s94, 13
    s_add_u32 s94, s96, s83
    s_add_u32 s82, s91, 2048
    s_mov_b32 m0, s94
    s_nop 0
    buffer_load_dwordx4 v3, s[40:43], s82 offen lds
    s_add_u32 s82, s91, 4096
    s_add_u32 m0, s94, 49152
    s_nop 0
    buffer_load_dwordx4 v3, s[40:43], s82 offen lds
    s_mov_b32 s82, s91
    s_add_u32 m0, s94, 98304
    s_nop 0
    buffer_load_dwordx4 v3, s[40:43], s82 offen lds
    s_lshr_b32 s96, s9, 4
    s_lshl_b32 s97, s96, 1
    s_xor_b32 s94, s97, 3
    s_add_u32 s96, s94, s84
    s_and_b32 s97, s96, 15
    s_mul_i32 s98, s97, 393216
    s_add_u32 s91, s98, s85
    s_lshl_b32 s96, s94, 13
    s_add_u32 s94, s96, s83
    s_add_u32 s82, s91, 2048
    s_mov_b32 m0, s94
    s_nop 0
    buffer_load_dwordx4 v3, s[40:43], s82 offen lds
    s_add_u32 s82, s91, 4096
    s_add_u32 m0, s94, 49152
    s_nop 0
    buffer_load_dwordx4 v3, s[40:43], s82 offen lds
    s_mov_b32 s82, s91
    s_add_u32 m0, s94, 98304
    s_nop 0
    buffer_load_dwordx4 v3, s[40:43], s82 offen lds
    s_lshl_b32 s96, s2, 12
    s_add_u32 s19, s96, 1048576
    s_and_b32 s96, s3, 3
    s_lshl_b32 s97, s96, 7
    s_add_u32 s20, s97, s19
    s_lshl_b32 s96, s84, 5
    s_add_u32 s19, s96, s19
    s_cmp_ge_u32 s3, 4
    s_cselect_b32 s19, s20, s19
    s_load_dwordx2 s[24:25], s[32:33], s19 offset:0 glc
    s_load_dwordx2 s[26:27], s[32:33], s19 offset:64 glc
    s_lshl_b32 s96, s3, 14
    s_lshl_b32 s97, s12, 7
    s_add_u32 s90, s96, s97
    s_and_b32 s96, s9, 1
    s_lshr_b32 s97, s9, 3
    s_lshl_b32 s98, s97, 1
    s_lshl3_add_u32 s99, s96, s98
    s_lshl_b32 s95, s99, 17
    s_lshl3_add_u32 s96, s75, s3
    s_mul_i32 s97, s96, 229376
    s_lshl_b32 s98, s74, 7
    s_add_u32 s80, s97, s98
    s_lshl3_add_u32 s96, s74, s3
    s_lshl_b32 s97, s96, 14
    s_lshl_b32 s98, s75, 9
    s_add_u32 s81, s97, s98
    s_and_b32 s96, s8, 3
    s_lshl3_add_u32 s97, s96, s3
    s_mul_i32 s98, s97, 393216
    s_lshr_b32 s99, s8, 2
    s_lshl1_add_u32 s96, s9, s99
    s_lshl_b32 s97, s96, 7
    s_add_u32 s99, s98, s97
    s_add_u32 s89, s99, 4096
    s_and_b32 s96, s3, 1
    s_lshl_b32 s14, s96, 6
    v_bfe_u32 v6, v1, 4, 1
    v_lshl_add_u32 v6, v6, 5, s14
    v_and_b32 v26, 7, v1
    v_lshlrev_b32 v26, 4, v26
    v_xor_b32 v26, v26, v6
    v_lshrrev_b32 v6, 3, v1
    v_lshlrev_b32 v6, 11, v6
    v_add_u32 v26, v26, v6
    s_and_b32 s96, s3, 2
    s_lshl_b32 s14, s96, 5
    v_bfe_u32 v6, v1, 4, 1
    v_lshl_add_u32 v6, v6, 5, s14
    v_and_b32 v27, 7, v1
    v_lshlrev_b32 v27, 4, v27
    v_xor_b32 v27, v27, v6
    v_lshrrev_b32 v6, 3, v1
    v_mul_u32_u24 v6, 7168, v6
    v_add_u32 v27, v27, v6
    s_and_b32 s96, s3, 1
    s_lshl_b32 s14, s96, 7
    v_lshrrev_b32 v6, 5, v1
    v_lshl_add_u32 v6, v6, 6, s14
    v_and_b32 v253, 31, v1
    v_lshlrev_b32 v253, 4, v253
    v_lshrrev_b32 v9, 5, v1
    v_lshl_add_u32 v253, v9, 11, v253
    v_xor_b32 v253, v253, v6
    s_lshl_b32 s16, s84, 14
    v_add_u32 v249, s88, v2
    s_lshl_b32 s96, s77, 11
    s_add_u32 s14, s96, 151552
    v_add_u32 v0, s14, v2
    s_mov_b64 exec, 0
    s_cmp_eq_u32 s3, 4
    s_cbranch_scc1 L_PAD2
    s_cmp_eq_u32 s3, 5
    s_cbranch_scc1 L_PAD3
    s_cmp_eq_u32 s3, 6
    s_cbranch_scc1 L_PAD4
    s_cmp_eq_u32 s3, 7
    s_cbranch_scc1 L_PAD5
    s_branch L_TEND
L_RET2:
    s_branch L_PAD6
L_RET6:
    s_branch L_PAD10
L_RET10:
    s_branch L_TEND
L_RET3:
    s_branch L_PAD7
L_RET7:
    s_branch L_TEND
L_RET4:
    s_branch L_PAD8
L_RET8:
    s_branch L_TEND
L_RET5:
    s_branch L_PAD9
L_RET9:
    s_branch L_TEND
    s_nop 0
    s_nop 0
    s_nop 0
    s_nop 0
    s_nop 0
    s_nop 0
    s_nop 0
    s_nop 0
    s_nop 0
    s_nop 0
    s_nop 0
    s_nop 0
    s_nop 0
    s_nop 0
    s_nop 0
    s_nop 0
    s_nop 0
    s_nop 0
    s_nop 0
    s_nop 0
    s_nop 0
    s_nop 0
    s_nop 0
    s_nop 0
    s_nop 0
    s_nop 0
    s_nop 0
    s_nop 0
L_TEND:
    s_mov_b64 exec, -1
    s_cmp_ge_u32 s3, 4
    s_cbranch_scc1 L_HELP
    s_branch SCHK_14
SPOLL_13:
    s_load_dwordx2 s[24:25], s[32:33], s19 offset:0 glc
    s_load_dwordx2 s[26:27], s[32:33], s19 offset:64 glc
SCHK_14:
    s_add_u32 s5, s5, 1
    s_cmp_ge_u32 s5, 200000
    s_waitcnt lgkmcnt(0)
    s_cbranch_scc1 SDONE_15
    s_cmp_lg_u32 s24, s4
    s_cbranch_scc1 SPOLL_13
    s_cmp_lg_u32 s25, s4
    s_cbranch_scc1 SPOLL_13
    s_cmp_lg_u32 s26, s4
    s_cbranch_scc1 SPOLL_13
    s_cmp_lg_u32 s27, s4
    s_cbranch_scc1 SPOLL_13
SDONE_15:
    s_setprio 2
    buffer_load_dwordx4 v[152:155], v249, s[32:35], s16 offen sc1
    buffer_load_dwordx4 v[156:159], v249, s[32:35], s16 offen offset:1024 sc1
    buffer_load_dwordx4 v[160:163], v249, s[32:35], s16 offen offset:2048 sc1
    buffer_load_dwordx4 v[164:167], v249, s[32:35], s16 offen offset:3072 sc1
    s_add_u32 s16, s16, 16384
    s_and_b32 s16, s16, 0x3ffff
    buffer_load_dwordx4 v[168:171], v249, s[32:35], s16 offen sc1
    buffer_load_dwordx4 v[172:175], v249, s[32:35], s16 offen offset:1024 sc1
    buffer_load_dwordx4 v[176:179], v249, s[32:35], s16 offen offset:2048 sc1
    buffer_load_dwordx4 v[180:183], v249, s[32:35], s16 offen offset:3072 sc1
    s_waitcnt vmcnt(8)
    s_barrier
    ds_read_b64_tr_b16 v[28:29], v20
    ds_read_b64_tr_b16 v[30:31], v20 offset:2048
    ds_read_b64_tr_b16 v[32:33], v21
    ds_read_b64_tr_b16 v[34:35], v21 offset:2048
    ds_read_b64_tr_b16 v[36:37], v24
    ds_read_b64_tr_b16 v[38:39], v24 offset:2048
    ds_read_b64_tr_b16 v[40:41], v25
    ds_read_b64_tr_b16 v[42:43], v25 offset:2048
    ds_read_b64_tr_b16 v[44:45], v22
    ds_read_b64_tr_b16 v[46:47], v22 offset:2048
    ds_read_b64_tr_b16 v[48:49], v23
    ds_read_b64_tr_b16 v[50:51], v23 offset:2048
    s_waitcnt vmcnt(7)
    s_waitcnt lgkmcnt(10)
    v_mfma_f32_32x32x16_bf16 v[56:71], v[28:31], v[152:155], 0
    s_add_u32 s16, s16, 16384
    ds_read_b64_tr_b16 v[52:53], v20 offset:1024
    ds_read_b64_tr_b16 v[54:55], v20 offset:3072
    s_waitcnt lgkmcnt(10)
    v_mfma_f32_32x32x16_bf16 v[72:87], v[32:35], v[152:155], 0
    s_and_b32 s16, s16, 0x3ffff
    ds_read_b64_tr_b16 v[28:29], v21 offset:1024
    ds_read_b64_tr_b16 v[30:31], v21 offset:3072
    s_waitcnt lgkmcnt(10)
    v_mfma_f32_32x32x16_bf16 v[120:135], v[36:39], v[152:155], 0
    ds_read_b64_tr_b16 v[32:33], v24 offset:1024
    ds_read_b64_tr_b16 v[34:35], v24 offset:3072
    s_waitcnt lgkmcnt(10)
    v_mfma_f32_32x32x16_bf16 v[136:151], v[40:43], v[152:155], 0
    buffer_load_dwordx4 v[184:187], v249, s[32:35], s16 offen sc1
    ds_read_b64_tr_b16 v[36:37], v25 offset:1024
    ds_read_b64_tr_b16 v[38:39], v25 offset:3072
    s_waitcnt lgkmcnt(10)
    v_mfma_f32_32x32x16_bf16 v[88:103], v[44:47], v[152:155], 0
    ds_read_b64_tr_b16 v[40:41], v22 offset:1024
    ds_read_b64_tr_b16 v[42:43], v22 offset:3072
    s_waitcnt lgkmcnt(10)
    v_mfma_f32_32x32x16_bf16 v[104:119], v[48:51], v[152:155], 0
    ds_read_b64_tr_b16 v[44:45], v23 offset:1024
    ds_read_b64_tr_b16 v[46:47], v23 offset:3072
    s_waitcnt vmcnt(7)
    s_waitcnt lgkmcnt(10)
    v_mfma_f32_32x32x16_bf16 v[56:71], v[52:55], v[156:159], v[56:71]
    ds_read_b64_tr_b16 v[48:49], v20 offset:4096
    ds_read_b64_tr_b16 v[50:51], v20 offset:6144
    s_waitcnt lgkmcnt(10)
    v_mfma_f32_32x32x16_bf16 v[72:87], v[28:31], v[156:159], v[72:87]
    buffer_load_dwordx4 v[188:191], v249, s[32:35], s16 offen offset:1024 sc1
    ds_read_b64_tr_b16 v[52:53], v21 offset:4096
    ds_read_b64_tr_b16 v[54:55], v21 offset:6144
    s_waitcnt lgkmcnt(10)
    v_mfma_f32_32x32x16_bf16 v[120:135], v[32:35], v[156:159], v[120:135]
    ds_read_b64_tr_b16 v[28:29], v24 offset:4096
    ds_read_b64_tr_b16 v[30:31], v24 offset:6144
    s_waitcnt lgkmcnt(10)
    v_mfma_f32_32x32x16_bf16 v[136:151], v[36:39], v[156:159], v[136:151]
    ds_read_b64_tr_b16 v[32:33], v25 offset:4096
    ds_read_b64_tr_b16 v[34:35], v25 offset:6144
    s_waitcnt lgkmcnt(10)
    v_mfma_f32_32x32x16_bf16 v[88:103], v[40:43], v[156:159], v[88:103]
    ds_read_b64_tr_b16 v[36:37], v22 offset:4096
    ds_read_b64_tr_b16 v[38:39], v22 offset:6144
    s_waitcnt lgkmcnt(10)
    v_mfma_f32_32x32x16_bf16 v[104:119], v[44:47], v[156:159], v[104:119]
    buffer_load_dwordx4 v[192:195], v249, s[32:35], s16 offen offset:2048 sc1
    ds_read_b64_tr_b16 v[40:41], v23 offset:4096
    ds_read_b64_tr_b16 v[42:43], v23 offset:6144
    s_waitcnt vmcnt(8)
    s_waitcnt lgkmcnt(10)
    v_mfma_f32_32x32x16_bf16 v[56:71], v[48:51], v[160:163], v[56:71]
    ds_read_b64_tr_b16 v[44:45], v20 offset:5120
    ds_read_b64_tr_b16 v[46:47], v20 offset:7168
    s_waitcnt lgkmcnt(10)
    v_mfma_f32_32x32x16_bf16 v[72:87], v[52:55], v[160:163], v[72:87]
    ds_read_b64_tr_b16 v[48:49], v21 offset:5120
    ds_read_b64_tr_b16 v[50:51], v21 offset:7168
    s_waitcnt lgkmcnt(10)
    v_mfma_f32_32x32x16_bf16 v[120:135], v[28:31], v[160:163], v[120:135]
    ds_read_b64_tr_b16 v[52:53], v24 offset:5120
    ds_read_b64_tr_b16 v[54:55], v24 offset:7168
    s_waitcnt lgkmcnt(10)
    v_mfma_f32_32x32x16_bf16 v[136:151], v[32:35], v[160:163], v[136:151]
    buffer_load_dwordx4 v[196:199], v249, s[32:35], s16 offen offset:3072 sc1
    ds_read_b64_tr_b16 v[28:29], v25 offset:5120
    ds_read_b64_tr_b16 v[30:31], v25 offset:7168
    s_waitcnt lgkmcnt(10)
    v_mfma_f32_32x32x16_bf16 v[88:103], v[36:39], v[160:163], v[88:103]
    s_add_u32 s16, s16, 16384
    ds_read_b64_tr_b16 v[32:33], v22 offset:5120
    ds_read_b64_tr_b16 v[34:35], v22 offset:7168
    s_waitcnt lgkmcnt(10)
    v_mfma_f32_32x32x16_bf16 v[104:119], v[40:43], v[160:163], v[104:119]
    s_and_b32 s16, s16, 0x3ffff
    ds_read_b64_tr_b16 v[36:37], v23 offset:5120
    ds_read_b64_tr_b16 v[38:39], v23 offset:7168
    s_waitcnt vmcnt(8)
    s_waitcnt lgkmcnt(10)
    v_mfma_f32_32x32x16_bf16 v[56:71], v[44:47], v[164:167], v[56:71]
    ds_read_b64_tr_b16 v[40:41], v20 offset:8192
    ds_read_b64_tr_b16 v[42:43], v20 offset:10240
    s_waitcnt lgkmcnt(10)
    v_mfma_f32_32x32x16_bf16 v[72:87], v[48:51], v[164:167], v[72:87]
    buffer_load_dwordx4 v[200:203], v249, s[32:35], s16 offen sc1
    ds_read_b64_tr_b16 v[44:45], v21 offset:8192
    ds_read_b64_tr_b16 v[46:47], v21 offset:10240
    s_waitcnt lgkmcnt(10)
    v_mfma_f32_32x32x16_bf16 v[120:135], v[52:55], v[164:167], v[120:135]
    ds_read_b64_tr_b16 v[48:49], v24 offset:8192
    ds_read_b64_tr_b16 v[50:51], v24 offset:10240
    s_waitcnt lgkmcnt(10)
    v_mfma_f32_32x32x16_bf16 v[136:151], v[28:31], v[164:167], v[136:151]
    ds_read_b64_tr_b16 v[52:53], v25 offset:8192
    ds_read_b64_tr_b16 v[54:55], v25 offset:10240
    s_waitcnt lgkmcnt(10)
    v_mfma_f32_32x32x16_bf16 v[88:103], v[32:35], v[164:167], v[88:103]
    ds_read_b64_tr_b16 v[28:29], v22 offset:8192
    ds_read_b64_tr_b16 v[30:31], v22 offset:10240
    s_waitcnt lgkmcnt(10)
    v_mfma_f32_32x32x16_bf16 v[104:119], v[36:39], v[164:167], v[104:119]
    buffer_load_dwordx4 v[204:207], v249, s[32:35], s16 offen offset:1024 sc1
    ds_read_b64_tr_b16 v[32:33], v23 offset:8192
    ds_read_b64_tr_b16 v[34:35], v23 offset:10240
    s_barrier
    s_waitcnt vmcnt(9)
    s_waitcnt lgkmcnt(10)
    v_mfma_f32_32x32x16_bf16 v[56:71], v[40:43], v[168:171], v[56:71]
    ds_read_b64_tr_b16 v[36:37], v20 offset:9216
    ds_read_b64_tr_b16 v[38:39], v20 offset:11264
    s_waitcnt lgkmcnt(10)
    v_mfma_f32_32x32x16_bf16 v[72:87], v[44:47], v[168:171], v[72:87]
    ds_read_b64_tr_b16 v[40:41], v21 offset:9216
    ds_read_b64_tr_b16 v[42:43], v21 offset:11264
    s_waitcnt lgkmcnt(10)
    v_mfma_f32_32x32x16_bf16 v[120:135], v[48:51], v[168:171], v[120:135]
    ds_read_b64_tr_b16 v[44:45], v24 offset:9216
    ds_read_b64_tr_b16 v[46:47], v24 offset:11264
    s_waitcnt lgkmcnt(10)
    v_mfma_f32_32x32x16_bf16 v[136:151], v[52:55], v[168:171], v[136:151]
    ds_read_b64_tr_b16 v[48:49], v25 offset:9216
    ds_read_b64_tr_b16 v[50:51], v25 offset:11264
    s_waitcnt lgkmcnt(10)
    v_mfma_f32_32x32x16_bf16 v[88:103], v[28:31], v[168:171], v[88:103]
    ds_read_b64_tr_b16 v[52:53], v22 offset:9216
    ds_read_b64_tr_b16 v[54:55], v22 offset:11264
    s_waitcnt lgkmcnt(10)
    v_mfma_f32_32x32x16_bf16 v[104:119], v[32:35], v[168:171], v[104:119]
    ds_read_b64_tr_b16 v[28:29], v23 offset:9216
    ds_read_b64_tr_b16 v[30:31], v23 offset:11264
    s_waitcnt vmcnt(8)
    s_waitcnt lgkmcnt(10)
    v_mfma_f32_32x32x16_bf16 v[56:71], v[36:39], v[172:175], v[56:71]
    ds_read_b64_tr_b16 v[32:33], v20 offset:12288
    ds_read_b64_tr_b16 v[34:35], v20 offset:14336
    s_waitcnt lgkmcnt(10)
    v_mfma_f32_32x32x16_bf16 v[72:87], v[40:43], v[172:175], v[72:87]
    ds_read_b64_tr_b16 v[36:37], v21 offset:12288
    ds_read_b64_tr_b16 v[38:39], v21 offset:14336
    s_waitcnt lgkmcnt(10)
    v_mfma_f32_32x32x16_bf16 v[120:135], v[44:47], v[172:175], v[120:135]
    buffer_load_dwordx4 v[208:211], v249, s[32:35], s16 offen offset:2048 sc1
    ds_read_b64_tr_b16 v[40:41], v24 offset:12288
    ds_read_b64_tr_b16 v[42:43], v24 offset:14336
    s_waitcnt lgkmcnt(10)
    v_mfma_f32_32x32x16_bf16 v[136:151], v[48:51], v[172:175], v[136:151]
    ds_read_b64_tr_b16 v[44:45], v25 offset:12288
    ds_read_b64_tr_b16 v[46:47], v25 offset:14336
    s_waitcnt lgkmcnt(10)
    v_mfma_f32_32x32x16_bf16 v[88:103], v[52:55], v[172:175], v[88:103]
    ds_read_b64_tr_b16 v[48:49], v22 offset:12288
    ds_read_b64_tr_b16 v[50:51], v22 offset:14336
    s_waitcnt lgkmcnt(10)
    v_mfma_f32_32x32x16_bf16 v[104:119], v[28:31], v[172:175], v[104:119]
    buffer_load_dwordx4 v[212:215], v249, s[32:35], s16 offen offset:3072 sc1
    ds_read_b64_tr_b16 v[52:53], v23 offset:12288
    ds_read_b64_tr_b16 v[54:55], v23 offset:14336
    s_waitcnt vmcnt(9)
    s_waitcnt lgkmcnt(10)
    v_mfma_f32_32x32x16_bf16 v[56:71], v[32:35], v[176:179], v[56:71]
    s_add_u32 s16, s16, 16384
    ds_read_b64_tr_b16 v[28:29], v20 offset:13312
    ds_read_b64_tr_b16 v[30:31], v20 offset:15360
    s_waitcnt lgkmcnt(10)
    v_mfma_f32_32x32x16_bf16 v[72:87], v[36:39], v[176:179], v[72:87]
    s_and_b32 s16, s16, 0x3ffff
    ds_read_b64_tr_b16 v[32:33], v21 offset:13312
    ds_read_b64_tr_b16 v[34:35], v21 offset:15360
    s_waitcnt lgkmcnt(10)
    v_mfma_f32_32x32x16_bf16 v[120:135], v[40:43], v[176:179], v[120:135]
    buffer_load_dwordx4 v[216:219], v249, s[32:35], s16 offen sc1
    ds_read_b64_tr_b16 v[36:37], v24 offset:13312
    ds_read_b64_tr_b16 v[38:39], v24 offset:15360
    s_waitcnt lgkmcnt(10)
    v_mfma_f32_32x32x16_bf16 v[136:151], v[44:47], v[176:179], v[136:151]
    ds_read_b64_tr_b16 v[40:41], v25 offset:13312
    ds_read_b64_tr_b16 v[42:43], v25 offset:15360
    s_waitcnt lgkmcnt(10)
    v_mfma_f32_32x32x16_bf16 v[88:103], v[48:51], v[176:179], v[88:103]
    ds_read_b64_tr_b16 v[44:45], v22 offset:13312
    ds_read_b64_tr_b16 v[46:47], v22 offset:15360
    s_waitcnt lgkmcnt(10)
    v_mfma_f32_32x32x16_bf16 v[104:119], v[52:55], v[176:179], v[104:119]
    buffer_load_dwordx4 v[220:223], v249, s[32:35], s16 offen offset:1024 sc1
    ds_read_b64_tr_b16 v[48:49], v23 offset:13312
    ds_read_b64_tr_b16 v[50:51], v23 offset:15360
    s_waitcnt vmcnt(10)
    s_waitcnt lgkmcnt(10)
    v_mfma_f32_32x32x16_bf16 v[56:71], v[28:31], v[180:183], v[56:71]
    ds_read_b64_tr_b16 v[52:53], v20 offset:16384
    ds_read_b64_tr_b16 v[54:55], v20 offset:18432
    s_waitcnt lgkmcnt(10)
    v_mfma_f32_32x32x16_bf16 v[72:87], v[32:35], v[180:183], v[72:87]
    ds_read_b64_tr_b16 v[28:29], v21 offset:16384
    ds_read_b64_tr_b16 v[30:31], v21 offset:18432
    s_waitcnt lgkmcnt(10)
    v_mfma_f32_32x32x16_bf16 v[120:135], v[36:39], v[180:183], v[120:135]
    buffer_load_dwordx4 v[224:227], v249, s[32:35], s16 offen offset:2048 sc1
    ds_read_b64_tr_b16 v[32:33], v24 offset:16384
    ds_read_b64_tr_b16 v[34:35], v24 offset:18432
    s_waitcnt lgkmcnt(10)
    v_mfma_f32_32x32x16_bf16 v[136:151], v[40:43], v[180:183], v[136:151]
    ds_read_b64_tr_b16 v[36:37], v25 offset:16384
    ds_read_b64_tr_b16 v[38:39], v25 offset:18432
    s_waitcnt lgkmcnt(10)
    v_mfma_f32_32x32x16_bf16 v[88:103], v[44:47], v[180:183], v[88:103]
    ds_read_b64_tr_b16 v[40:41], v22 offset:16384
    ds_read_b64_tr_b16 v[42:43], v22 offset:18432
    s_waitcnt lgkmcnt(10)
    v_mfma_f32_32x32x16_bf16 v[104:119], v[48:51], v[180:183], v[104:119]
    buffer_load_dwordx4 v[228:231], v249, s[32:35], s16 offen offset:3072 sc1
    ds_read_b64_tr_b16 v[44:45], v23 offset:16384
    ds_read_b64_tr_b16 v[46:47], v23 offset:18432
    s_barrier
    s_waitcnt vmcnt(11)
    s_waitcnt lgkmcnt(10)
    v_mfma_f32_32x32x16_bf16 v[56:71], v[52:55], v[184:187], v[56:71]
    s_add_u32 s16, s16, 16384
    ds_read_b64_tr_b16 v[48:49], v20 offset:17408
    ds_read_b64_tr_b16 v[50:51], v20 offset:19456
    s_waitcnt lgkmcnt(10)
    v_mfma_f32_32x32x16_bf16 v[72:87], v[28:31], v[184:187], v[72:87]
    s_and_b32 s16, s16, 0x3ffff
    ds_read_b64_tr_b16 v[52:53], v21 offset:17408
    ds_read_b64_tr_b16 v[54:55], v21 offset:19456
    s_waitcnt lgkmcnt(10)
    v_mfma_f32_32x32x16_bf16 v[120:135], v[32:35], v[184:187], v[120:135]
    ds_read_b64_tr_b16 v[28:29], v24 offset:17408
    ds_read_b64_tr_b16 v[30:31], v24 offset:19456
    s_waitcnt lgkmcnt(10)
    v_mfma_f32_32x32x16_bf16 v[136:151], v[36:39], v[184:187], v[136:151]
    ds_read_b64_tr_b16 v[32:33], v25 offset:17408
    ds_read_b64_tr_b16 v[34:35], v25 offset:19456
    s_waitcnt lgkmcnt(10)
    v_mfma_f32_32x32x16_bf16 v[88:103], v[40:43], v[184:187], v[88:103]
    ds_read_b64_tr_b16 v[36:37], v22 offset:17408
    ds_read_b64_tr_b16 v[38:39], v22 offset:19456
    s_waitcnt lgkmcnt(10)
    v_mfma_f32_32x32x16_bf16 v[104:119], v[44:47], v[184:187], v[104:119]
    ds_read_b64_tr_b16 v[40:41], v23 offset:17408
    ds_read_b64_tr_b16 v[42:43], v23 offset:19456
    s_waitcnt vmcnt(10)
    s_waitcnt lgkmcnt(10)
    v_mfma_f32_32x32x16_bf16 v[56:71], v[48:51], v[188:191], v[56:71]
    ds_read_b64_tr_b16 v[44:45], v20 offset:20480
    ds_read_b64_tr_b16 v[46:47], v20 offset:22528
    s_waitcnt lgkmcnt(10)
    v_mfma_f32_32x32x16_bf16 v[72:87], v[52:55], v[188:191], v[72:87]
    ds_read_b64_tr_b16 v[48:49], v21 offset:20480
    ds_read_b64_tr_b16 v[50:51], v21 offset:22528
    s_waitcnt lgkmcnt(10)
    v_mfma_f32_32x32x16_bf16 v[120:135], v[28:31], v[188:191], v[120:135]
    buffer_load_dwordx4 v[232:235], v249, s[32:35], s16 offen sc1
    ds_read_b64_tr_b16 v[52:53], v24 offset:20480
    ds_read_b64_tr_b16 v[54:55], v24 offset:22528
    s_waitcnt lgkmcnt(10)
    v_mfma_f32_32x32x16_bf16 v[136:151], v[32:35], v[188:191], v[136:151]
    ds_read_b64_tr_b16 v[28:29], v25 offset:20480
    ds_read_b64_tr_b16 v[30:31], v25 offset:22528
    s_waitcnt lgkmcnt(10)
    v_mfma_f32_32x32x16_bf16 v[88:103], v[36:39], v[188:191], v[88:103]
    ds_read_b64_tr_b16 v[32:33], v22 offset:20480
    ds_read_b64_tr_b16 v[34:35], v22 offset:22528
    s_waitcnt lgkmcnt(10)
    v_mfma_f32_32x32x16_bf16 v[104:119], v[40:43], v[188:191], v[104:119]
    buffer_load_dwordx4 v[236:239], v249, s[32:35], s16 offen offset:1024 sc1
    ds_read_b64_tr_b16 v[36:37], v23 offset:20480
    ds_read_b64_tr_b16 v[38:39], v23 offset:22528
    s_waitcnt vmcnt(11)
    s_waitcnt lgkmcnt(10)
    v_mfma_f32_32x32x16_bf16 v[56:71], v[44:47], v[192:195], v[56:71]
    ds_read_b64_tr_b16 v[40:41], v20 offset:21504
    ds_read_b64_tr_b16 v[42:43], v20 offset:23552
    s_waitcnt lgkmcnt(10)
    v_mfma_f32_32x32x16_bf16 v[72:87], v[48:51], v[192:195], v[72:87]
    ds_read_b64_tr_b16 v[44:45], v21 offset:21504
    ds_read_b64_tr_b16 v[46:47], v21 offset:23552
    s_waitcnt lgkmcnt(10)
    v_mfma_f32_32x32x16_bf16 v[120:135], v[52:55], v[192:195], v[120:135]
    buffer_load_dwordx4 v[240:243], v249, s[32:35], s16 offen offset:2048 sc1
    ds_read_b64_tr_b16 v[48:49], v24 offset:21504
    ds_read_b64_tr_b16 v[50:51], v24 offset:23552
    s_waitcnt lgkmcnt(10)
    v_mfma_f32_32x32x16_bf16 v[136:151], v[28:31], v[192:195], v[136:151]
    ds_read_b64_tr_b16 v[52:53], v25 offset:21504
    ds_read_b64_tr_b16 v[54:55], v25 offset:23552
    s_waitcnt lgkmcnt(10)
    v_mfma_f32_32x32x16_bf16 v[88:103], v[32:35], v[192:195], v[88:103]
    ds_read_b64_tr_b16 v[28:29], v22 offset:21504
    ds_read_b64_tr_b16 v[30:31], v22 offset:23552
    s_waitcnt lgkmcnt(10)
    v_mfma_f32_32x32x16_bf16 v[104:119], v[36:39], v[192:195], v[104:119]
    buffer_load_dwordx4 v[244:247], v249, s[32:35], s16 offen offset:3072 sc1
    ds_read_b64_tr_b16 v[32:33], v23 offset:21504
    ds_read_b64_tr_b16 v[34:35], v23 offset:23552
    s_waitcnt vmcnt(12)
    s_waitcnt lgkmcnt(10)
    v_mfma_f32_32x32x16_bf16 v[56:71], v[40:43], v[196:199], v[56:71]
    s_add_u32 s16, s16, 16384
    ds_read_b64_tr_b16 v[36:37], v20 offset:24576
    ds_read_b64_tr_b16 v[38:39], v20 offset:26624
    s_waitcnt lgkmcnt(10)
    v_mfma_f32_32x32x16_bf16 v[72:87], v[44:47], v[196:199], v[72:87]
    s_and_b32 s16, s16, 0x3ffff
    ds_read_b64_tr_b16 v[40:41], v21 offset:24576
    ds_read_b64_tr_b16 v[42:43], v21 offset:26624
    s_waitcnt lgkmcnt(10)
    v_mfma_f32_32x32x16_bf16 v[120:135], v[48:51], v[196:199], v[120:135]
    buffer_load_dwordx4 v[152:155], v249, s[32:35], s16 offen sc1
    ds_read_b64_tr_b16 v[44:45], v24 offset:24576
    ds_read_b64_tr_b16 v[46:47], v24 offset:26624
    s_waitcnt lgkmcnt(10)
    v_mfma_f32_32x32x16_bf16 v[136:151], v[52:55], v[196:199], v[136:151]
    ds_read_b64_tr_b16 v[48:49], v25 offset:24576
    ds_read_b64_tr_b16 v[50:51], v25 offset:26624
    s_waitcnt lgkmcnt(10)
    v_mfma_f32_32x32x16_bf16 v[88:103], v[28:31], v[196:199], v[88:103]
    ds_read_b64_tr_b16 v[52:53], v22 offset:24576
    ds_read_b64_tr_b16 v[54:55], v22 offset:26624
    s_waitcnt lgkmcnt(10)
    v_mfma_f32_32x32x16_bf16 v[104:119], v[32:35], v[196:199], v[104:119]
    buffer_load_dwordx4 v[156:159], v249, s[32:35], s16 offen offset:1024 sc1
    ds_read_b64_tr_b16 v[28:29], v23 offset:24576
    ds_read_b64_tr_b16 v[30:31], v23 offset:26624
    s_barrier
    s_waitcnt vmcnt(13)
    s_waitcnt lgkmcnt(10)
    v_mfma_f32_32x32x16_bf16 v[56:71], v[36:39], v[200:203], v[56:71]
    ds_read_b64_tr_b16 v[32:33], v20 offset:25600
    ds_read_b64_tr_b16 v[34:35], v20 offset:27648
    s_waitcnt lgkmcnt(10)
    v_mfma_f32_32x32x16_bf16 v[72:87], v[40:43], v[200:203], v[72:87]
    ds_read_b64_tr_b16 v[36:37], v21 offset:25600
    ds_read_b64_tr_b16 v[38:39], v21 offset:27648
    s_waitcnt lgkmcnt(10)
    v_mfma_f32_32x32x16_bf16 v[120:135], v[44:47], v[200:203], v[120:135]
    ds_read_b64_tr_b16 v[40:41], v24 offset:25600
    ds_read_b64_tr_b16 v[42:43], v24 offset:27648
    s_waitcnt lgkmcnt(10)
    v_mfma_f32_32x32x16_bf16 v[136:151], v[48:51], v[200:203], v[136:151]
    ds_read_b64_tr_b16 v[44:45], v25 offset:25600
    ds_read_b64_tr_b16 v[46:47], v25 offset:27648
    s_waitcnt lgkmcnt(10)
    v_mfma_f32_32x32x16_bf16 v[88:103], v[52:55], v[200:203], v[88:103]
    ds_read_b64_tr_b16 v[48:49], v22 offset:25600
    ds_read_b64_tr_b16 v[50:51], v22 offset:27648
    s_waitcnt lgkmcnt(10)
    v_mfma_f32_32x32x16_bf16 v[104:119], v[28:31], v[200:203], v[104:119]
    ds_read_b64_tr_b16 v[52:53], v23 offset:25600
    ds_read_b64_tr_b16 v[54:55], v23 offset:27648
    s_waitcnt vmcnt(12)
    s_waitcnt lgkmcnt(10)
    v_mfma_f32_32x32x16_bf16 v[56:71], v[32:35], v[204:207], v[56:71]
    ds_read_b64_tr_b16 v[28:29], v20 offset:28672
    ds_read_b64_tr_b16 v[30:31], v20 offset:30720
    s_waitcnt lgkmcnt(10)
    v_mfma_f32_32x32x16_bf16 v[72:87], v[36:39], v[204:207], v[72:87]
    ds_read_b64_tr_b16 v[32:33], v21 offset:28672
    ds_read_b64_tr_b16 v[34:35], v21 offset:30720
L_PAD2:
    s_cbranch_execz L_RET2
    s_waitcnt lgkmcnt(10)
    v_mfma_f32_32x32x16_bf16 v[120:135], v[40:43], v[204:207], v[120:135]
    buffer_load_dwordx4 v[160:163], v249, s[32:35], s16 offen offset:2048 sc1
    ds_read_b64_tr_b16 v[36:37], v24 offset:28672
    ds_read_b64_tr_b16 v[38:39], v24 offset:30720
    s_waitcnt lgkmcnt(10)
    v_mfma_f32_32x32x16_bf16 v[136:151], v[44:47], v[204:207], v[136:151]
    ds_read_b64_tr_b16 v[40:41], v25 offset:28672
    ds_read_b64_tr_b16 v[42:43], v25 offset:30720
    s_waitcnt lgkmcnt(10)
    v_mfma_f32_32x32x16_bf16 v[88:103], v[48:51], v[204:207], v[88:103]
    ds_read_b64_tr_b16 v[44:45], v22 offset:28672
    ds_read_b64_tr_b16 v[46:47], v22 offset:30720
    s_waitcnt lgkmcnt(10)
    v_mfma_f32_32x32x16_bf16 v[104:119], v[52:55], v[204:207], v[104:119]
    buffer_load_dwordx4 v[164:167], v249, s[32:35], s16 offen offset:3072 sc1
    ds_read_b64_tr_b16 v[48:49], v23 offset:28672
    ds_read_b64_tr_b16 v[50:51], v23 offset:30720
    s_waitcnt vmcnt(13)
    s_waitcnt lgkmcnt(10)
    v_mfma_f32_32x32x16_bf16 v[56:71], v[28:31], v[208:211], v[56:71]
    s_add_u32 s16, s16, 16384
    ds_read_b64_tr_b16 v[52:53], v20 offset:29696
    ds_read_b64_tr_b16 v[54:55], v20 offset:31744
    s_waitcnt lgkmcnt(10)
    v_mfma_f32_32x32x16_bf16 v[72:87], v[32:35], v[208:211], v[72:87]
    s_and_b32 s16, s16, 0x3ffff
    ds_read_b64_tr_b16 v[28:29], v21 offset:29696
    ds_read_b64_tr_b16 v[30:31], v21 offset:31744
    s_waitcnt lgkmcnt(10)
    v_mfma_f32_32x32x16_bf16 v[120:135], v[36:39], v[208:211], v[120:135]
    buffer_load_dwordx4 v[168:171], v249, s[32:35], s16 offen sc1
    ds_read_b64_tr_b16 v[32:33], v24 offset:29696
    ds_read_b64_tr_b16 v[34:35], v24 offset:31744
    s_waitcnt lgkmcnt(10)
    v_mfma_f32_32x32x16_bf16 v[136:151], v[40:43], v[208:211], v[136:151]
    ds_read_b64_tr_b16 v[36:37], v25 offset:29696
    ds_read_b64_tr_b16 v[38:39], v25 offset:31744
    s_waitcnt lgkmcnt(10)
    v_mfma_f32_32x32x16_bf16 v[88:103], v[44:47], v[208:211], v[88:103]
    ds_read_b64_tr_b16 v[40:41], v22 offset:29696
    ds_read_b64_tr_b16 v[42:43], v22 offset:31744
    s_waitcnt lgkmcnt(10)
    v_mfma_f32_32x32x16_bf16 v[104:119], v[48:51], v[208:211], v[104:119]
    buffer_load_dwordx4 v[172:175], v249, s[32:35], s16 offen offset:1024 sc1
    ds_read_b64_tr_b16 v[44:45], v23 offset:29696
    ds_read_b64_tr_b16 v[46:47], v23 offset:31744
    s_waitcnt vmcnt(14)
    s_waitcnt lgkmcnt(10)
    v_mfma_f32_32x32x16_bf16 v[56:71], v[52:55], v[212:215], v[56:71]
    ds_read_b64_tr_b16 v[48:49], v20 offset:32768
    ds_read_b64_tr_b16 v[50:51], v20 offset:34816
    s_waitcnt lgkmcnt(10)
    v_mfma_f32_32x32x16_bf16 v[72:87], v[28:31], v[212:215], v[72:87]
    ds_read_b64_tr_b16 v[52:53], v21 offset:32768
    ds_read_b64_tr_b16 v[54:55], v21 offset:34816
    s_waitcnt lgkmcnt(10)
    v_mfma_f32_32x32x16_bf16 v[120:135], v[32:35], v[212:215], v[120:135]
    buffer_load_dwordx4 v[176:179], v249, s[32:35], s16 offen offset:2048 sc1
    ds_read_b64_tr_b16 v[28:29], v24 offset:32768
    ds_read_b64_tr_b16 v[30:31], v24 offset:34816
    s_waitcnt lgkmcnt(10)
    v_mfma_f32_32x32x16_bf16 v[136:151], v[36:39], v[212:215], v[136:151]
    ds_read_b64_tr_b16 v[32:33], v25 offset:32768
    ds_read_b64_tr_b16 v[34:35], v25 offset:34816
    s_waitcnt lgkmcnt(10)
    v_mfma_f32_32x32x16_bf16 v[88:103], v[40:43], v[212:215], v[88:103]
    ds_read_b64_tr_b16 v[36:37], v22 offset:32768
    ds_read_b64_tr_b16 v[38:39], v22 offset:34816
    s_waitcnt lgkmcnt(10)
    v_mfma_f32_32x32x16_bf16 v[104:119], v[44:47], v[212:215], v[104:119]
    buffer_load_dwordx4 v[180:183], v249, s[32:35], s16 offen offset:3072 sc1
    ds_read_b64_tr_b16 v[40:41], v23 offset:32768
    ds_read_b64_tr_b16 v[42:43], v23 offset:34816
    s_barrier
    s_waitcnt vmcnt(15)
    s_waitcnt lgkmcnt(10)
    v_mfma_f32_32x32x16_bf16 v[56:71], v[48:51], v[216:219], v[56:71]
    s_add_u32 s16, s16, 16384
    ds_read_b64_tr_b16 v[44:45], v20 offset:33792
    ds_read_b64_tr_b16 v[46:47], v20 offset:35840
    s_waitcnt lgkmcnt(10)
    v_mfma_f32_32x32x16_bf16 v[72:87], v[52:55], v[216:219], v[72:87]
    s_and_b32 s16, s16, 0x3ffff
    ds_read_b64_tr_b16 v[48:49], v21 offset:33792
    ds_read_b64_tr_b16 v[50:51], v21 offset:35840
    s_waitcnt lgkmcnt(10)
    v_mfma_f32_32x32x16_bf16 v[120:135], v[28:31], v[216:219], v[120:135]
    ds_read_b64_tr_b16 v[52:53], v24 offset:33792
    ds_read_b64_tr_b16 v[54:55], v24 offset:35840
    s_waitcnt lgkmcnt(10)
    v_mfma_f32_32x32x16_bf16 v[136:151], v[32:35], v[216:219], v[136:151]
    ds_read_b64_tr_b16 v[28:29], v25 offset:33792
    ds_read_b64_tr_b16 v[30:31], v25 offset:35840
    s_waitcnt lgkmcnt(10)
    v_mfma_f32_32x32x16_bf16 v[88:103], v[36:39], v[216:219], v[88:103]
    ds_read_b64_tr_b16 v[32:33], v22 offset:33792
    ds_read_b64_tr_b16 v[34:35], v22 offset:35840
    s_waitcnt lgkmcnt(10)
    v_mfma_f32_32x32x16_bf16 v[104:119], v[40:43], v[216:219], v[104:119]
    ds_read_b64_tr_b16 v[36:37], v23 offset:33792
    ds_read_b64_tr_b16 v[38:39], v23 offset:35840
    s_waitcnt vmcnt(14)
    s_waitcnt lgkmcnt(10)
    v_mfma_f32_32x32x16_bf16 v[56:71], v[44:47], v[220:223], v[56:71]
    ds_read_b64_tr_b16 v[40:41], v20 offset:36864
    ds_read_b64_tr_b16 v[42:43], v20 offset:38912
    s_waitcnt lgkmcnt(10)
    v_mfma_f32_32x32x16_bf16 v[72:87], v[48:51], v[220:223], v[72:87]
    ds_read_b64_tr_b16 v[44:45], v21 offset:36864
    ds_read_b64_tr_b16 v[46:47], v21 offset:38912
    s_waitcnt lgkmcnt(10)
    v_mfma_f32_32x32x16_bf16 v[120:135], v[52:55], v[220:223], v[120:135]
    buffer_load_dwordx4 v[184:187], v249, s[32:35], s16 offen sc1
    ds_read_b64_tr_b16 v[48:49], v24 offset:36864
    ds_read_b64_tr_b16 v[50:51], v24 offset:38912
    s_waitcnt lgkmcnt(10)
    v_mfma_f32_32x32x16_bf16 v[136:151], v[28:31], v[220:223], v[136:151]
    ds_read_b64_tr_b16 v[52:53], v25 offset:36864
    ds_read_b64_tr_b16 v[54:55], v25 offset:38912
    s_waitcnt lgkmcnt(10)
    v_mfma_f32_32x32x16_bf16 v[88:103], v[32:35], v[220:223], v[88:103]
    ds_read_b64_tr_b16 v[28:29], v22 offset:36864
    ds_read_b64_tr_b16 v[30:31], v22 offset:38912
    s_waitcnt lgkmcnt(10)
    v_mfma_f32_32x32x16_bf16 v[104:119], v[36:39], v[220:223], v[104:119]
    buffer_load_dwordx4 v[188:191], v249, s[32:35], s16 offen offset:1024 sc1
    ds_read_b64_tr_b16 v[32:33], v23 offset:36864
    ds_read_b64_tr_b16 v[34:35], v23 offset:38912
    s_waitcnt vmcnt(15)
    s_waitcnt lgkmcnt(10)
    v_mfma_f32_32x32x16_bf16 v[56:71], v[40:43], v[224:227], v[56:71]
    ds_read_b64_tr_b16 v[36:37], v20 offset:37888
    ds_read_b64_tr_b16 v[38:39], v20 offset:39936
    s_waitcnt lgkmcnt(10)
    v_mfma_f32_32x32x16_bf16 v[72:87], v[44:47], v[224:227], v[72:87]
    ds_read_b64_tr_b16 v[40:41], v21 offset:37888
    ds_read_b64_tr_b16 v[42:43], v21 offset:39936
    s_waitcnt lgkmcnt(10)
    v_mfma_f32_32x32x16_bf16 v[120:135], v[48:51], v[224:227], v[120:135]
    buffer_load_dwordx4 v[192:195], v249, s[32:35], s16 offen offset:2048 sc1
    ds_read_b64_tr_b16 v[44:45], v24 offset:37888
    ds_read_b64_tr_b16 v[46:47], v24 offset:39936
    s_waitcnt lgkmcnt(10)
    v_mfma_f32_32x32x16_bf16 v[136:151], v[52:55], v[224:227], v[136:151]
    ds_read_b64_tr_b16 v[48:49], v25 offset:37888
    ds_read_b64_tr_b16 v[50:51], v25 offset:39936
    s_waitcnt lgkmcnt(10)
    v_mfma_f32_32x32x16_bf16 v[88:103], v[28:31], v[224:227], v[88:103]
    ds_read_b64_tr_b16 v[52:53], v22 offset:37888
    ds_read_b64_tr_b16 v[54:55], v22 offset:39936
    s_waitcnt lgkmcnt(10)
    v_mfma_f32_32x32x16_bf16 v[104:119], v[32:35], v[224:227], v[104:119]
    buffer_load_dwordx4 v[196:199], v249, s[32:35], s16 offen offset:3072 sc1
    ds_read_b64_tr_b16 v[28:29], v23 offset:37888
    ds_read_b64_tr_b16 v[30:31], v23 offset:39936
    s_waitcnt vmcnt(16)
    s_waitcnt lgkmcnt(10)
    v_mfma_f32_32x32x16_bf16 v[56:71], v[36:39], v[228:231], v[56:71]
    s_add_u32 s16, s16, 16384
    ds_read_b64_tr_b16 v[32:33], v20 offset:40960
    ds_read_b64_tr_b16 v[34:35], v20 offset:43008
    s_waitcnt lgkmcnt(10)
    v_mfma_f32_32x32x16_bf16 v[72:87], v[40:43], v[228:231], v[72:87]
    s_and_b32 s16, s16, 0x3ffff
    ds_read_b64_tr_b16 v[36:37], v21 offset:40960
    ds_read_b64_tr_b16 v[38:39], v21 offset:43008
    s_waitcnt lgkmcnt(10)
    v_mfma_f32_32x32x16_bf16 v[120:135], v[44:47], v[228:231], v[120:135]
    buffer_load_dwordx4 v[200:203], v249, s[32:35], s16 offen sc1
    ds_read_b64_tr_b16 v[40:41], v24 offset:40960
    ds_read_b64_tr_b16 v[42:43], v24 offset:43008
    s_waitcnt lgkmcnt(10)
    v_mfma_f32_32x32x16_bf16 v[136:151], v[48:51], v[228:231], v[136:151]
    ds_read_b64_tr_b16 v[44:45], v25 offset:40960
    ds_read_b64_tr_b16 v[46:47], v25 offset:43008
    s_waitcnt lgkmcnt(10)
    v_mfma_f32_32x32x16_bf16 v[88:103], v[52:55], v[228:231], v[88:103]
    ds_read_b64_tr_b16 v[48:49], v22 offset:40960
    ds_read_b64_tr_b16 v[50:51], v22 offset:43008
    s_waitcnt lgkmcnt(10)
    v_mfma_f32_32x32x16_bf16 v[104:119], v[28:31], v[228:231], v[104:119]
    buffer_load_dwordx4 v[204:207], v249, s[32:35], s16 offen offset:1024 sc1
    ds_read_b64_tr_b16 v[52:53], v23 offset:40960
    ds_read_b64_tr_b16 v[54:55], v23 offset:43008
    s_barrier
    s_waitcnt vmcnt(17)
    s_waitcnt lgkmcnt(10)
    v_mfma_f32_32x32x16_bf16 v[56:71], v[32:35], v[232:235], v[56:71]
    ds_read_b64_tr_b16 v[28:29], v20 offset:41984
    ds_read_b64_tr_b16 v[30:31], v20 offset:44032
    s_waitcnt lgkmcnt(10)
    v_mfma_f32_32x32x16_bf16 v[72:87], v[36:39], v[232:235], v[72:87]
    ds_read_b64_tr_b16 v[32:33], v21 offset:41984
    ds_read_b64_tr_b16 v[34:35], v21 offset:44032
    s_waitcnt lgkmcnt(10)
    v_mfma_f32_32x32x16_bf16 v[120:135], v[40:43], v[232:235], v[120:135]
    ds_read_b64_tr_b16 v[36:37], v24 offset:41984
    ds_read_b64_tr_b16 v[38:39], v24 offset:44032
    s_waitcnt lgkmcnt(10)
    v_mfma_f32_32x32x16_bf16 v[136:151], v[44:47], v[232:235], v[136:151]
    ds_read_b64_tr_b16 v[40:41], v25 offset:41984
    ds_read_b64_tr_b16 v[42:43], v25 offset:44032
    s_waitcnt lgkmcnt(10)
    v_mfma_f32_32x32x16_bf16 v[88:103], v[48:51], v[232:235], v[88:103]
    ds_read_b64_tr_b16 v[44:45], v22 offset:41984
    ds_read_b64_tr_b16 v[46:47], v22 offset:44032
    s_waitcnt lgkmcnt(10)
    v_mfma_f32_32x32x16_bf16 v[104:119], v[52:55], v[232:235], v[104:119]
    ds_read_b64_tr_b16 v[48:49], v23 offset:41984
    ds_read_b64_tr_b16 v[50:51], v23 offset:44032
    s_waitcnt vmcnt(16)
    s_waitcnt lgkmcnt(10)
    v_mfma_f32_32x32x16_bf16 v[56:71], v[28:31], v[236:239], v[56:71]
    ds_read_b64_tr_b16 v[52:53], v20 offset:45056
    ds_read_b64_tr_b16 v[54:55], v20 offset:47104
    s_waitcnt lgkmcnt(10)
    v_mfma_f32_32x32x16_bf16 v[72:87], v[32:35], v[236:239], v[72:87]
    ds_read_b64_tr_b16 v[28:29], v21 offset:45056
    ds_read_b64_tr_b16 v[30:31], v21 offset:47104
    s_waitcnt lgkmcnt(10)
    v_mfma_f32_32x32x16_bf16 v[120:135], v[36:39], v[236:239], v[120:135]
    buffer_load_dwordx4 v[208:211], v249, s[32:35], s16 offen offset:2048 sc1
    ds_read_b64_tr_b16 v[32:33], v24 offset:45056
    ds_read_b64_tr_b16 v[34:35], v24 offset:47104
    s_waitcnt lgkmcnt(10)
    v_mfma_f32_32x32x16_bf16 v[136:151], v[40:43], v[236:239], v[136:151]
    ds_read_b64_tr_b16 v[36:37], v25 offset:45056
    ds_read_b64_tr_b16 v[38:39], v25 offset:47104
    s_waitcnt lgkmcnt(10)
    v_mfma_f32_32x32x16_bf16 v[88:103], v[44:47], v[236:239], v[88:103]
    ds_read_b64_tr_b16 v[40:41], v22 offset:45056
    ds_read_b64_tr_b16 v[42:43], v22 offset:47104
    s_waitcnt lgkmcnt(10)
    v_mfma_f32_32x32x16_bf16 v[104:119], v[48:51], v[236:239], v[104:119]
    buffer_load_dwordx4 v[212:215], v249, s[32:35], s16 offen offset:3072 sc1
    ds_read_b64_tr_b16 v[44:45], v23 offset:45056
    ds_read_b64_tr_b16 v[46:47], v23 offset:47104
    s_waitcnt vmcnt(17)
    s_waitcnt lgkmcnt(10)
    v_mfma_f32_32x32x16_bf16 v[56:71], v[52:55], v[240:243], v[56:71]
    s_add_u32 s16, s16, 16384
    ds_read_b64_tr_b16 v[48:49], v20 offset:46080
    ds_read_b64_tr_b16 v[50:51], v20 offset:48128
    s_waitcnt lgkmcnt(10)
    v_mfma_f32_32x32x16_bf16 v[72:87], v[28:31], v[240:243], v[72:87]
    s_and_b32 s16, s16, 0x3ffff
    ds_read_b64_tr_b16 v[52:53], v21 offset:46080
    ds_read_b64_tr_b16 v[54:55], v21 offset:48128
    s_waitcnt lgkmcnt(10)
    v_mfma_f32_32x32x16_bf16 v[120:135], v[32:35], v[240:243], v[120:135]
    buffer_load_dwordx4 v[216:219], v249, s[32:35], s16 offen sc1
    ds_read_b64_tr_b16 v[28:29], v24 offset:46080
    ds_read_b64_tr_b16 v[30:31], v24 offset:48128
    s_waitcnt lgkmcnt(10)
    v_mfma_f32_32x32x16_bf16 v[136:151], v[36:39], v[240:243], v[136:151]
    ds_read_b64_tr_b16 v[32:33], v25 offset:46080
    ds_read_b64_tr_b16 v[34:35], v25 offset:48128
    s_waitcnt lgkmcnt(10)
    v_mfma_f32_32x32x16_bf16 v[88:103], v[40:43], v[240:243], v[88:103]
    ds_read_b64_tr_b16 v[36:37], v22 offset:46080
    ds_read_b64_tr_b16 v[38:39], v22 offset:48128
    s_waitcnt lgkmcnt(10)
    v_mfma_f32_32x32x16_bf16 v[104:119], v[44:47], v[240:243], v[104:119]
    buffer_load_dwordx4 v[220:223], v249, s[32:35], s16 offen offset:1024 sc1
    ds_read_b64_tr_b16 v[40:41], v23 offset:46080
    ds_read_b64_tr_b16 v[42:43], v23 offset:48128
    s_waitcnt vmcnt(18)
    s_waitcnt lgkmcnt(10)
    v_mfma_f32_32x32x16_bf16 v[56:71], v[48:51], v[244:247], v[56:71]
    ds_read_b64_tr_b16 v[44:45], v20
    ds_read_b64_tr_b16 v[46:47], v20 offset:2048
    s_waitcnt lgkmcnt(10)
    v_mfma_f32_32x32x16_bf16 v[72:87], v[52:55], v[244:247], v[72:87]
    ds_read_b64_tr_b16 v[48:49], v21
    ds_read_b64_tr_b16 v[50:51], v21 offset:2048
    s_waitcnt lgkmcnt(10)
    v_mfma_f32_32x32x16_bf16 v[120:135], v[28:31], v[244:247], v[120:135]
    buffer_load_dwordx4 v[224:227], v249, s[32:35], s16 offen offset:2048 sc1
    ds_read_b64_tr_b16 v[52:53], v24
    ds_read_b64_tr_b16 v[54:55], v24 offset:2048
    s_waitcnt lgkmcnt(10)
    v_mfma_f32_32x32x16_bf16 v[136:151], v[32:35], v[244:247], v[136:151]
    ds_read_b64_tr_b16 v[28:29], v25
    ds_read_b64_tr_b16 v[30:31], v25 offset:2048
    s_waitcnt lgkmcnt(10)
    v_mfma_f32_32x32x16_bf16 v[88:103], v[36:39], v[244:247], v[88:103]
    ds_read_b64_tr_b16 v[32:33], v22
    ds_read_b64_tr_b16 v[34:35], v22 offset:2048
    s_waitcnt lgkmcnt(10)
    v_mfma_f32_32x32x16_bf16 v[104:119], v[40:43], v[244:247], v[104:119]
    buffer_load_dwordx4 v[228:231], v249, s[32:35], s16 offen offset:3072 sc1
    ds_read_b64_tr_b16 v[36:37], v23
    ds_read_b64_tr_b16 v[38:39], v23 offset:2048
    s_barrier
    s_waitcnt vmcnt(19)
    s_waitcnt lgkmcnt(10)
    v_mfma_f32_32x32x16_bf16 v[56:71], v[44:47], v[152:155], v[56:71]
    s_add_u32 s16, s16, 16384
    ds_read_b64_tr_b16 v[40:41], v20 offset:1024
    ds_read_b64_tr_b16 v[42:43], v20 offset:3072
    s_waitcnt lgkmcnt(10)
    v_mfma_f32_32x32x16_bf16 v[72:87], v[48:51], v[152:155], v[72:87]
    s_and_b32 s16, s16, 0x3ffff
    ds_read_b64_tr_b16 v[44:45], v21 offset:1024
    ds_read_b64_tr_b16 v[46:47], v21 offset:3072
    s_waitcnt lgkmcnt(10)
    v_mfma_f32_32x32x16_bf16 v[120:135], v[52:55], v[152:155], v[120:135]
    ds_read_b64_tr_b16 v[48:49], v24 offset:1024
    ds_read_b64_tr_b16 v[50:51], v24 offset:3072
    s_waitcnt lgkmcnt(10)
    v_mfma_f32_32x32x16_bf16 v[136:151], v[28:31], v[152:155], v[136:151]
    ds_read_b64_tr_b16 v[52:53], v25 offset:1024
    ds_read_b64_tr_b16 v[54:55], v25 offset:3072
    s_waitcnt lgkmcnt(10)
    v_mfma_f32_32x32x16_bf16 v[88:103], v[32:35], v[152:155], v[88:103]
    ds_read_b64_tr_b16 v[28:29], v22 offset:1024
    ds_read_b64_tr_b16 v[30:31], v22 offset:3072
    s_waitcnt lgkmcnt(10)
    v_mfma_f32_32x32x16_bf16 v[104:119], v[36:39], v[152:155], v[104:119]
    ds_read_b64_tr_b16 v[32:33], v23 offset:1024
    ds_read_b64_tr_b16 v[34:35], v23 offset:3072
    s_waitcnt vmcnt(18)
    s_waitcnt lgkmcnt(10)
    v_mfma_f32_32x32x16_bf16 v[56:71], v[40:43], v[156:159], v[56:71]
    ds_read_b64_tr_b16 v[36:37], v20 offset:4096
    ds_read_b64_tr_b16 v[38:39], v20 offset:6144
    s_waitcnt lgkmcnt(10)
    v_mfma_f32_32x32x16_bf16 v[72:87], v[44:47], v[156:159], v[72:87]
    ds_read_b64_tr_b16 v[40:41], v21 offset:4096
    ds_read_b64_tr_b16 v[42:43], v21 offset:6144
    s_waitcnt lgkmcnt(10)
    v_mfma_f32_32x32x16_bf16 v[120:135], v[48:51], v[156:159], v[120:135]
    ds_read_b64_tr_b16 v[44:45], v24 offset:4096
    ds_read_b64_tr_b16 v[46:47], v24 offset:6144
    s_waitcnt lgkmcnt(10)
    v_mfma_f32_32x32x16_bf16 v[136:151], v[52:55], v[156:159], v[136:151]
    buffer_load_dwordx4 v[232:235], v249, s[32:35], s16 offen sc1
    ds_read_b64_tr_b16 v[48:49], v25 offset:4096
    ds_read_b64_tr_b16 v[50:51], v25 offset:6144
    s_waitcnt lgkmcnt(10)
    v_mfma_f32_32x32x16_bf16 v[88:103], v[28:31], v[156:159], v[88:103]
    ds_read_b64_tr_b16 v[52:53], v22 offset:4096
    ds_read_b64_tr_b16 v[54:55], v22 offset:6144
    s_waitcnt lgkmcnt(10)
    v_mfma_f32_32x32x16_bf16 v[104:119], v[32:35], v[156:159], v[104:119]
    ds_read_b64_tr_b16 v[28:29], v23 offset:4096
    ds_read_b64_tr_b16 v[30:31], v23 offset:6144
    s_waitcnt vmcnt(18)
    s_waitcnt lgkmcnt(10)
    v_mfma_f32_32x32x16_bf16 v[56:71], v[36:39], v[160:163], v[56:71]
    ds_read_b64_tr_b16 v[32:33], v20 offset:5120
    ds_read_b64_tr_b16 v[34:35], v20 offset:7168
    s_waitcnt lgkmcnt(10)
    v_mfma_f32_32x32x16_bf16 v[72:87], v[40:43], v[160:163], v[72:87]
    buffer_load_dwordx4 v[236:239], v249, s[32:35], s16 offen offset:1024 sc1
    ds_read_b64_tr_b16 v[36:37], v21 offset:5120
    ds_read_b64_tr_b16 v[38:39], v21 offset:7168
    s_waitcnt lgkmcnt(10)
    v_mfma_f32_32x32x16_bf16 v[120:135], v[44:47], v[160:163], v[120:135]
    ds_read_b64_tr_b16 v[40:41], v24 offset:5120
    ds_read_b64_tr_b16 v[42:43], v24 offset:7168
    s_waitcnt lgkmcnt(10)
    v_mfma_f32_32x32x16_bf16 v[136:151], v[48:51], v[160:163], v[136:151]
    ds_read_b64_tr_b16 v[44:45], v25 offset:5120
    ds_read_b64_tr_b16 v[46:47], v25 offset:7168
    s_waitcnt lgkmcnt(10)
    v_mfma_f32_32x32x16_bf16 v[88:103], v[52:55], v[160:163], v[88:103]
    buffer_load_dwordx4 v[240:243], v249, s[32:35], s16 offen offset:2048 sc1
    ds_read_b64_tr_b16 v[48:49], v22 offset:5120
    ds_read_b64_tr_b16 v[50:51], v22 offset:7168
    s_waitcnt lgkmcnt(10)
    v_mfma_f32_32x32x16_bf16 v[104:119], v[28:31], v[160:163], v[104:119]
    ds_read_b64_tr_b16 v[52:53], v23 offset:5120
    ds_read_b64_tr_b16 v[54:55], v23 offset:7168
    s_waitcnt vmcnt(19)
    s_waitcnt lgkmcnt(10)
    v_mfma_f32_32x32x16_bf16 v[56:71], v[32:35], v[164:167], v[56:71]
    ds_read_b64_tr_b16 v[28:29], v20 offset:8192
    ds_read_b64_tr_b16 v[30:31], v20 offset:10240
    s_waitcnt lgkmcnt(10)
    v_mfma_f32_32x32x16_bf16 v[72:87], v[36:39], v[164:167], v[72:87]
    ds_read_b64_tr_b16 v[32:33], v21 offset:8192
    ds_read_b64_tr_b16 v[34:35], v21 offset:10240
    s_waitcnt lgkmcnt(10)
    v_mfma_f32_32x32x16_bf16 v[120:135], v[40:43], v[164:167], v[120:135]
    buffer_load_dwordx4 v[244:247], v249, s[32:35], s16 offen offset:3072 sc1
    ds_read_b64_tr_b16 v[36:37], v24 offset:8192
    ds_read_b64_tr_b16 v[38:39], v24 offset:10240
    s_waitcnt lgkmcnt(10)
    v_mfma_f32_32x32x16_bf16 v[136:151], v[44:47], v[164:167], v[136:151]
    s_add_u32 s16, s16, 16384
    ds_read_b64_tr_b16 v[40:41], v25 offset:8192
    ds_read_b64_tr_b16 v[42:43], v25 offset:10240
    s_waitcnt lgkmcnt(10)
    v_mfma_f32_32x32x16_bf16 v[88:103], v[48:51], v[164:167], v[88:103]
    s_and_b32 s16, s16, 0x3ffff
    ds_read_b64_tr_b16 v[44:45], v22 offset:8192
    ds_read_b64_tr_b16 v[46:47], v22 offset:10240
    s_waitcnt lgkmcnt(10)
    v_mfma_f32_32x32x16_bf16 v[104:119], v[52:55], v[164:167], v[104:119]
    buffer_load_dwordx4 v[152:155], v249, s[32:35], s16 offen sc1
    ds_read_b64_tr_b16 v[48:49], v23 offset:8192
    ds_read_b64_tr_b16 v[50:51], v23 offset:10240
    s_barrier
    s_waitcnt vmcnt(20)
    s_waitcnt lgkmcnt(10)
    v_mfma_f32_32x32x16_bf16 v[56:71], v[28:31], v[168:171], v[56:71]
    ds_read_b64_tr_b16 v[52:53], v20 offset:9216
    ds_read_b64_tr_b16 v[54:55], v20 offset:11264
    s_waitcnt lgkmcnt(10)
    v_mfma_f32_32x32x16_bf16 v[72:87], v[32:35], v[168:171], v[72:87]
    ds_read_b64_tr_b16 v[28:29], v21 offset:9216
    ds_read_b64_tr_b16 v[30:31], v21 offset:11264
    s_waitcnt lgkmcnt(10)
    v_mfma_f32_32x32x16_bf16 v[120:135], v[36:39], v[168:171], v[120:135]
    ds_read_b64_tr_b16 v[32:33], v24 offset:9216
    ds_read_b64_tr_b16 v[34:35], v24 offset:11264
    s_waitcnt lgkmcnt(10)
    v_mfma_f32_32x32x16_bf16 v[136:151], v[40:43], v[168:171], v[136:151]
    ds_read_b64_tr_b16 v[36:37], v25 offset:9216
    ds_read_b64_tr_b16 v[38:39], v25 offset:11264
    s_waitcnt lgkmcnt(10)
    v_mfma_f32_32x32x16_bf16 v[88:103], v[44:47], v[168:171], v[88:103]
    ds_read_b64_tr_b16 v[40:41], v22 offset:9216
    ds_read_b64_tr_b16 v[42:43], v22 offset:11264
    s_waitcnt lgkmcnt(10)
    v_mfma_f32_32x32x16_bf16 v[104:119], v[48:51], v[168:171], v[104:119]
    ds_read_b64_tr_b16 v[44:45], v23 offset:9216
    ds_read_b64_tr_b16 v[46:47], v23 offset:11264
    s_waitcnt vmcnt(19)
    s_waitcnt lgkmcnt(10)
    v_mfma_f32_32x32x16_bf16 v[56:71], v[52:55], v[172:175], v[56:71]
    ds_read_b64_tr_b16 v[48:49], v20 offset:12288
    ds_read_b64_tr_b16 v[50:51], v20 offset:14336
    s_waitcnt lgkmcnt(10)
    v_mfma_f32_32x32x16_bf16 v[72:87], v[28:31], v[172:175], v[72:87]
    ds_read_b64_tr_b16 v[52:53], v21 offset:12288
    ds_read_b64_tr_b16 v[54:55], v21 offset:14336
    s_waitcnt lgkmcnt(10)
    v_mfma_f32_32x32x16_bf16 v[120:135], v[32:35], v[172:175], v[120:135]
    ds_read_b64_tr_b16 v[28:29], v24 offset:12288
    ds_read_b64_tr_b16 v[30:31], v24 offset:14336
    s_waitcnt lgkmcnt(10)
    v_mfma_f32_32x32x16_bf16 v[136:151], v[36:39], v[172:175], v[136:151]
    buffer_load_dwordx4 v[156:159], v249, s[32:35], s16 offen offset:1024 sc1
    ds_read_b64_tr_b16 v[32:33], v25 offset:12288
    ds_read_b64_tr_b16 v[34:35], v25 offset:14336
    s_waitcnt lgkmcnt(10)
    v_mfma_f32_32x32x16_bf16 v[88:103], v[40:43], v[172:175], v[88:103]
    ds_read_b64_tr_b16 v[36:37], v22 offset:12288
    ds_read_b64_tr_b16 v[38:39], v22 offset:14336
    s_waitcnt lgkmcnt(10)
    v_mfma_f32_32x32x16_bf16 v[104:119], v[44:47], v[172:175], v[104:119]
    ds_read_b64_tr_b16 v[40:41], v23 offset:12288
    ds_read_b64_tr_b16 v[42:43], v23 offset:14336
    s_waitcnt vmcnt(19)
    s_waitcnt lgkmcnt(10)
    v_mfma_f32_32x32x16_bf16 v[56:71], v[48:51], v[176:179], v[56:71]
    ds_read_b64_tr_b16 v[44:45], v20 offset:13312
    ds_read_b64_tr_b16 v[46:47], v20 offset:15360
    s_waitcnt lgkmcnt(10)
    v_mfma_f32_32x32x16_bf16 v[72:87], v[52:55], v[176:179], v[72:87]
    buffer_load_dwordx4 v[160:163], v249, s[32:35], s16 offen offset:2048 sc1
    ds_read_b64_tr_b16 v[48:49], v21 offset:13312
    ds_read_b64_tr_b16 v[50:51], v21 offset:15360
    s_waitcnt lgkmcnt(10)
    v_mfma_f32_32x32x16_bf16 v[120:135], v[28:31], v[176:179], v[120:135]
    ds_read_b64_tr_b16 v[52:53], v24 offset:13312
    ds_read_b64_tr_b16 v[54:55], v24 offset:15360
    s_waitcnt lgkmcnt(10)
    v_mfma_f32_32x32x16_bf16 v[136:151], v[32:35], v[176:179], v[136:151]
    ds_read_b64_tr_b16 v[28:29], v25 offset:13312
    ds_read_b64_tr_b16 v[30:31], v25 offset:15360
    s_waitcnt lgkmcnt(10)
    v_mfma_f32_32x32x16_bf16 v[88:103], v[36:39], v[176:179], v[88:103]
    buffer_load_dwordx4 v[164:167], v249, s[32:35], s16 offen offset:3072 sc1
    ds_read_b64_tr_b16 v[32:33], v22 offset:13312
    ds_read_b64_tr_b16 v[34:35], v22 offset:15360
    s_waitcnt lgkmcnt(10)
    v_mfma_f32_32x32x16_bf16 v[104:119], v[40:43], v[176:179], v[104:119]
    s_add_u32 s16, s16, 16384
    ds_read_b64_tr_b16 v[36:37], v23 offset:13312
    ds_read_b64_tr_b16 v[38:39], v23 offset:15360
    s_waitcnt vmcnt(20)
    s_waitcnt lgkmcnt(10)
    v_mfma_f32_32x32x16_bf16 v[56:71], v[44:47], v[180:183], v[56:71]
    s_and_b32 s16, s16, 0x3ffff
    ds_read_b64_tr_b16 v[40:41], v20 offset:16384
    ds_read_b64_tr_b16 v[42:43], v20 offset:18432
    s_waitcnt lgkmcnt(10)
    v_mfma_f32_32x32x16_bf16 v[72:87], v[48:51], v[180:183], v[72:87]
    ds_read_b64_tr_b16 v[44:45], v21 offset:16384
    ds_read_b64_tr_b16 v[46:47], v21 offset:18432
    s_waitcnt lgkmcnt(10)
    v_mfma_f32_32x32x16_bf16 v[120:135], v[52:55], v[180:183], v[120:135]
    buffer_load_dwordx4 v[168:171], v249, s[32:35], s16 offen sc1
    ds_read_b64_tr_b16 v[48:49], v24 offset:16384
    ds_read_b64_tr_b16 v[50:51], v24 offset:18432
    s_waitcnt lgkmcnt(10)
    v_mfma_f32_32x32x16_bf16 v[136:151], v[28:31], v[180:183], v[136:151]
    ds_read_b64_tr_b16 v[52:53], v25 offset:16384
    ds_read_b64_tr_b16 v[54:55], v25 offset:18432
    s_waitcnt lgkmcnt(10)
    v_mfma_f32_32x32x16_bf16 v[88:103], v[32:35], v[180:183], v[88:103]
    ds_read_b64_tr_b16 v[28:29], v22 offset:16384
    ds_read_b64_tr_b16 v[30:31], v22 offset:18432
    s_waitcnt lgkmcnt(10)
    v_mfma_f32_32x32x16_bf16 v[104:119], v[36:39], v[180:183], v[104:119]
    buffer_load_dwordx4 v[172:175], v249, s[32:35], s16 offen offset:1024 sc1
    ds_read_b64_tr_b16 v[32:33], v23 offset:16384
    ds_read_b64_tr_b16 v[34:35], v23 offset:18432
    s_barrier
    s_waitcnt vmcnt(21)
    s_waitcnt lgkmcnt(10)
    v_mfma_f32_32x32x16_bf16 v[56:71], v[40:43], v[184:187], v[56:71]
    ds_read_b64_tr_b16 v[36:37], v20 offset:17408
    ds_read_b64_tr_b16 v[38:39], v20 offset:19456
    s_waitcnt lgkmcnt(10)
    v_mfma_f32_32x32x16_bf16 v[72:87], v[44:47], v[184:187], v[72:87]
    ds_read_b64_tr_b16 v[40:41], v21 offset:17408
    ds_read_b64_tr_b16 v[42:43], v21 offset:19456
    s_waitcnt lgkmcnt(10)
    v_mfma_f32_32x32x16_bf16 v[120:135], v[48:51], v[184:187], v[120:135]
    ds_read_b64_tr_b16 v[44:45], v24 offset:17408
    ds_read_b64_tr_b16 v[46:47], v24 offset:19456
    s_waitcnt lgkmcnt(10)
    v_mfma_f32_32x32x16_bf16 v[136:151], v[52:55], v[184:187], v[136:151]
    ds_read_b64_tr_b16 v[48:49], v25 offset:17408
    ds_read_b64_tr_b16 v[50:51], v25 offset:19456
    s_waitcnt lgkmcnt(10)
    v_mfma_f32_32x32x16_bf16 v[88:103], v[28:31], v[184:187], v[88:103]
    ds_read_b64_tr_b16 v[52:53], v22 offset:17408
    ds_read_b64_tr_b16 v[54:55], v22 offset:19456
    s_waitcnt lgkmcnt(10)
    v_mfma_f32_32x32x16_bf16 v[104:119], v[32:35], v[184:187], v[104:119]
    ds_read_b64_tr_b16 v[28:29], v23 offset:17408
    ds_read_b64_tr_b16 v[30:31], v23 offset:19456
    s_waitcnt vmcnt(20)
    s_waitcnt lgkmcnt(10)
    v_mfma_f32_32x32x16_bf16 v[56:71], v[36:39], v[188:191], v[56:71]
    ds_read_b64_tr_b16 v[32:33], v20 offset:20480
    ds_read_b64_tr_b16 v[34:35], v20 offset:22528
    s_waitcnt lgkmcnt(10)
    v_mfma_f32_32x32x16_bf16 v[72:87], v[40:43], v[188:191], v[72:87]
    ds_read_b64_tr_b16 v[36:37], v21 offset:20480
    ds_read_b64_tr_b16 v[38:39], v21 offset:22528
    s_waitcnt lgkmcnt(10)
    v_mfma_f32_32x32x16_bf16 v[120:135], v[44:47], v[188:191], v[120:135]
    ds_read_b64_tr_b16 v[40:41], v24 offset:20480
    ds_read_b64_tr_b16 v[42:43], v24 offset:22528
    s_waitcnt lgkmcnt(10)
    v_mfma_f32_32x32x16_bf16 v[136:151], v[48:51], v[188:191], v[136:151]
    buffer_load_dwordx4 v[176:179], v249, s[32:35], s16 offen offset:2048 sc1
    ds_read_b64_tr_b16 v[44:45], v25 offset:20480
    ds_read_b64_tr_b16 v[46:47], v25 offset:22528
    s_waitcnt lgkmcnt(10)
    v_mfma_f32_32x32x16_bf16 v[88:103], v[52:55], v[188:191], v[88:103]
    ds_read_b64_tr_b16 v[48:49], v22 offset:20480
    ds_read_b64_tr_b16 v[50:51], v22 offset:22528
    s_waitcnt lgkmcnt(10)
    v_mfma_f32_32x32x16_bf16 v[104:119], v[28:31], v[188:191], v[104:119]
    ds_read_b64_tr_b16 v[52:53], v23 offset:20480
    ds_read_b64_tr_b16 v[54:55], v23 offset:22528
    s_waitcnt vmcnt(20)
    s_waitcnt lgkmcnt(10)
    v_mfma_f32_32x32x16_bf16 v[56:71], v[32:35], v[192:195], v[56:71]
    ds_read_b64_tr_b16 v[28:29], v20 offset:21504
    ds_read_b64_tr_b16 v[30:31], v20 offset:23552
    s_waitcnt lgkmcnt(10)
    v_mfma_f32_32x32x16_bf16 v[72:87], v[36:39], v[192:195], v[72:87]
    buffer_load_dwordx4 v[180:183], v249, s[32:35], s16 offen offset:3072 sc1
    ds_read_b64_tr_b16 v[32:33], v21 offset:21504
    ds_read_b64_tr_b16 v[34:35], v21 offset:23552
    s_waitcnt lgkmcnt(10)
    v_mfma_f32_32x32x16_bf16 v[120:135], v[40:43], v[192:195], v[120:135]
    s_add_u32 s16, s16, 16384
    ds_read_b64_tr_b16 v[36:37], v24 offset:21504
    ds_read_b64_tr_b16 v[38:39], v24 offset:23552
    s_waitcnt lgkmcnt(10)
    v_mfma_f32_32x32x16_bf16 v[136:151], v[44:47], v[192:195], v[136:151]
    s_and_b32 s16, s16, 0x3ffff
    ds_read_b64_tr_b16 v[40:41], v25 offset:21504
    ds_read_b64_tr_b16 v[42:43], v25 offset:23552
    s_waitcnt lgkmcnt(10)
    v_mfma_f32_32x32x16_bf16 v[88:103], v[48:51], v[192:195], v[88:103]
    buffer_load_dwordx4 v[184:187], v249, s[32:35], s16 offen sc1
    ds_read_b64_tr_b16 v[44:45], v22 offset:21504
    ds_read_b64_tr_b16 v[46:47], v22 offset:23552
L_PAD3:
    s_cbranch_execz L_RET3
    s_waitcnt lgkmcnt(10)
    v_mfma_f32_32x32x16_bf16 v[104:119], v[52:55], v[192:195], v[104:119]
    ds_read_b64_tr_b16 v[48:49], v23 offset:21504
    ds_read_b64_tr_b16 v[50:51], v23 offset:23552
    s_waitcnt vmcnt(21)
    s_waitcnt lgkmcnt(10)
    v_mfma_f32_32x32x16_bf16 v[56:71], v[28:31], v[196:199], v[56:71]
    ds_read_b64_tr_b16 v[52:53], v20 offset:24576
    ds_read_b64_tr_b16 v[54:55], v20 offset:26624
    s_waitcnt lgkmcnt(10)
    v_mfma_f32_32x32x16_bf16 v[72:87], v[32:35], v[196:199], v[72:87]
    ds_read_b64_tr_b16 v[28:29], v21 offset:24576
    ds_read_b64_tr_b16 v[30:31], v21 offset:26624
    s_waitcnt lgkmcnt(10)
    v_mfma_f32_32x32x16_bf16 v[120:135], v[36:39], v[196:199], v[120:135]
    buffer_load_dwordx4 v[188:191], v249, s[32:35], s16 offen offset:1024 sc1
    ds_read_b64_tr_b16 v[32:33], v20 offset:25600
    ds_read_b64_tr_b16 v[34:35], v20 offset:27648
    s_waitcnt lgkmcnt(10)
    v_mfma_f32_32x32x16_bf16 v[136:151], v[40:43], v[196:199], v[136:151]
    ds_read_b64_tr_b16 v[36:37], v21 offset:25600
    ds_read_b64_tr_b16 v[38:39], v21 offset:27648
    s_waitcnt lgkmcnt(10)
    v_mfma_f32_32x32x16_bf16 v[88:103], v[44:47], v[196:199], v[88:103]
    ds_read_b64_tr_b16 v[40:41], v20 offset:28672
    ds_read_b64_tr_b16 v[42:43], v20 offset:30720
    s_waitcnt lgkmcnt(10)
    v_mfma_f32_32x32x16_bf16 v[104:119], v[48:51], v[196:199], v[104:119]
    buffer_load_dwordx4 v[192:195], v249, s[32:35], s16 offen offset:2048 sc1
    ds_read_b64_tr_b16 v[44:45], v21 offset:28672
    ds_read_b64_tr_b16 v[46:47], v21 offset:30720
    s_barrier
    s_waitcnt vmcnt(22)
    s_waitcnt lgkmcnt(10)
    v_mfma_f32_32x32x16_bf16 v[56:71], v[52:55], v[200:203], v[56:71]
    ds_read_b64_tr_b16 v[48:49], v20 offset:29696
    ds_read_b64_tr_b16 v[50:51], v20 offset:31744
    s_waitcnt lgkmcnt(10)
    v_mfma_f32_32x32x16_bf16 v[72:87], v[28:31], v[200:203], v[72:87]
    ds_read_b64_tr_b16 v[52:53], v21 offset:29696
    ds_read_b64_tr_b16 v[54:55], v21 offset:31744
    s_waitcnt vmcnt(21)
    s_waitcnt lgkmcnt(10)
    v_mfma_f32_32x32x16_bf16 v[56:71], v[32:35], v[204:207], v[56:71]
    ds_read_b64_tr_b16 v[28:29], v24 offset:24576
    ds_read_b64_tr_b16 v[30:31], v24 offset:26624
    s_waitcnt lgkmcnt(10)
    v_mfma_f32_32x32x16_bf16 v[72:87], v[36:39], v[204:207], v[72:87]
    ds_read_b64_tr_b16 v[32:33], v25 offset:24576
    ds_read_b64_tr_b16 v[34:35], v25 offset:26624
    s_waitcnt vmcnt(20)
    s_waitcnt lgkmcnt(10)
    v_mfma_f32_32x32x16_bf16 v[56:71], v[40:43], v[208:211], v[56:71]
    ds_read_b64_tr_b16 v[36:37], v22 offset:24576
    ds_read_b64_tr_b16 v[38:39], v22 offset:26624
    s_waitcnt lgkmcnt(10)
    v_mfma_f32_32x32x16_bf16 v[72:87], v[44:47], v[208:211], v[72:87]
    ds_read_b64_tr_b16 v[40:41], v23 offset:24576
    ds_read_b64_tr_b16 v[42:43], v23 offset:26624
    s_waitcnt vmcnt(19)
    s_waitcnt lgkmcnt(10)
    v_mfma_f32_32x32x16_bf16 v[56:71], v[48:51], v[212:215], v[56:71]
    ds_read_b64_tr_b16 v[44:45], v24 offset:25600
    ds_read_b64_tr_b16 v[46:47], v24 offset:27648
    s_waitcnt lgkmcnt(10)
    v_mfma_f32_32x32x16_bf16 v[72:87], v[52:55], v[212:215], v[72:87]
    ds_read_b64_tr_b16 v[48:49], v25 offset:25600
    ds_read_b64_tr_b16 v[50:51], v25 offset:27648
    s_barrier
    s_waitcnt lgkmcnt(10)
    v_mfma_f32_32x32x16_bf16 v[120:135], v[28:31], v[200:203], v[120:135]
    ds_read_b64_tr_b16 v[52:53], v22 offset:25600
    ds_read_b64_tr_b16 v[54:55], v22 offset:27648
    s_waitcnt lgkmcnt(10)
    v_mfma_f32_32x32x16_bf16 v[136:151], v[32:35], v[200:203], v[136:151]
    buffer_load_dwordx4 v[196:199], v249, s[32:35], s16 offen offset:3072 sc1
    ds_read_b64_tr_b16 v[28:29], v23 offset:25600
    ds_read_b64_tr_b16 v[30:31], v23 offset:27648
    s_waitcnt lgkmcnt(10)
    v_mfma_f32_32x32x16_bf16 v[88:103], v[36:39], v[200:203], v[88:103]
    s_add_u32 s16, s16, 16384
    ds_read_b64_tr_b16 v[32:33], v24 offset:28672
    ds_read_b64_tr_b16 v[34:35], v24 offset:30720
    s_waitcnt lgkmcnt(10)
    v_mfma_f32_32x32x16_bf16 v[104:119], v[40:43], v[200:203], v[104:119]
    s_and_b32 s16, s16, 0x3ffff
    ds_read_b64_tr_b16 v[36:37], v25 offset:28672
    ds_read_b64_tr_b16 v[38:39], v25 offset:30720
    s_waitcnt lgkmcnt(10)
    v_mfma_f32_32x32x16_bf16 v[120:135], v[44:47], v[204:207], v[120:135]
    ds_read_b64_tr_b16 v[40:41], v22 offset:28672
    ds_read_b64_tr_b16 v[42:43], v22 offset:30720
    s_waitcnt lgkmcnt(10)
    v_mfma_f32_32x32x16_bf16 v[136:151], v[48:51], v[204:207], v[136:151]
    buffer_load_dwordx4 v[200:203], v249, s[32:35], s16 offen sc1
    ds_read_b64_tr_b16 v[44:45], v23 offset:28672
    ds_read_b64_tr_b16 v[46:47], v23 offset:30720
    s_waitcnt lgkmcnt(10)
    v_mfma_f32_32x32x16_bf16 v[88:103], v[52:55], v[204:207], v[88:103]
    ds_read_b64_tr_b16 v[48:49], v24 offset:29696
    ds_read_b64_tr_b16 v[50:51], v24 offset:31744
    s_waitcnt lgkmcnt(10)
    v_mfma_f32_32x32x16_bf16 v[104:119], v[28:31], v[204:207], v[104:119]
    ds_read_b64_tr_b16 v[52:53], v25 offset:29696
    ds_read_b64_tr_b16 v[54:55], v25 offset:31744
    s_waitcnt lgkmcnt(10)
    v_mfma_f32_32x32x16_bf16 v[120:135], v[32:35], v[208:211], v[120:135]
    buffer_load_dwordx4 v[204:207], v249, s[32:35], s16 offen offset:1024 sc1
    ds_read_b64_tr_b16 v[28:29], v22 offset:29696
    ds_read_b64_tr_b16 v[30:31], v22 offset:31744
    s_waitcnt lgkmcnt(10)
    v_mfma_f32_32x32x16_bf16 v[136:151], v[36:39], v[208:211], v[136:151]
    ds_read_b64_tr_b16 v[32:33], v23 offset:29696
    ds_read_b64_tr_b16 v[34:35], v23 offset:31744
    s_waitcnt lgkmcnt(10)
    v_mfma_f32_32x32x16_bf16 v[88:103], v[40:43], v[208:211], v[88:103]
    ds_read_b64_tr_b16 v[36:37], v20 offset:32768
    ds_read_b64_tr_b16 v[38:39], v20 offset:34816
    s_waitcnt lgkmcnt(10)
    v_mfma_f32_32x32x16_bf16 v[104:119], v[44:47], v[208:211], v[104:119]
    ds_read_b64_tr_b16 v[40:41], v20 offset:33792
    ds_read_b64_tr_b16 v[42:43], v20 offset:35840
    s_waitcnt lgkmcnt(10)
    v_mfma_f32_32x32x16_bf16 v[120:135], v[48:51], v[212:215], v[120:135]
    buffer_load_dwordx4 v[208:211], v249, s[32:35], s16 offen offset:2048 sc1
    ds_read_b64_tr_b16 v[44:45], v20 offset:36864
    ds_read_b64_tr_b16 v[46:47], v20 offset:38912
    s_waitcnt lgkmcnt(10)
    v_mfma_f32_32x32x16_bf16 v[136:151], v[52:55], v[212:215], v[136:151]
    ds_read_b64_tr_b16 v[48:49], v20 offset:37888
    ds_read_b64_tr_b16 v[50:51], v20 offset:39936
    s_waitcnt lgkmcnt(10)
    v_mfma_f32_32x32x16_bf16 v[88:103], v[28:31], v[212:215], v[88:103]
    ds_read_b64_tr_b16 v[52:53], v20 offset:40960
    ds_read_b64_tr_b16 v[54:55], v20 offset:43008
    s_waitcnt lgkmcnt(10)
    v_mfma_f32_32x32x16_bf16 v[104:119], v[32:35], v[212:215], v[104:119]
    buffer_load_dwordx4 v[212:215], v249, s[32:35], s16 offen offset:3072 sc1
    ds_read_b64_tr_b16 v[28:29], v20 offset:41984
    ds_read_b64_tr_b16 v[30:31], v20 offset:44032
    s_barrier
    s_waitcnt vmcnt(23)
    s_waitcnt lgkmcnt(10)
    v_mfma_f32_32x32x16_bf16 v[56:71], v[36:39], v[216:219], v[56:71]
    s_add_u32 s16, s16, 16384
    ds_read_b64_tr_b16 v[32:33], v20 offset:45056
    ds_read_b64_tr_b16 v[34:35], v20 offset:47104
    s_waitcnt vmcnt(22)
    s_waitcnt lgkmcnt(10)
    v_mfma_f32_32x32x16_bf16 v[56:71], v[40:43], v[220:223], v[56:71]
    s_and_b32 s16, s16, 0x3ffff
    ds_read_b64_tr_b16 v[36:37], v20 offset:46080
    ds_read_b64_tr_b16 v[38:39], v20 offset:48128
    s_waitcnt vmcnt(21)
    s_waitcnt lgkmcnt(10)
    v_mfma_f32_32x32x16_bf16 v[56:71], v[44:47], v[224:227], v[56:71]
    ds_read_b64_tr_b16 v[40:41], v20
    ds_read_b64_tr_b16 v[42:43], v20 offset:2048
    s_waitcnt vmcnt(20)
    s_waitcnt lgkmcnt(10)
    v_mfma_f32_32x32x16_bf16 v[56:71], v[48:51], v[228:231], v[56:71]
    ds_read_b64_tr_b16 v[44:45], v20 offset:1024
    ds_read_b64_tr_b16 v[46:47], v20 offset:3072
    s_waitcnt vmcnt(19)
    s_waitcnt lgkmcnt(10)
    v_mfma_f32_32x32x16_bf16 v[56:71], v[52:55], v[232:235], v[56:71]
    ds_read_b64_tr_b16 v[48:49], v20 offset:4096
    ds_read_b64_tr_b16 v[50:51], v20 offset:6144
    s_waitcnt vmcnt(18)
    s_waitcnt lgkmcnt(10)
    v_mfma_f32_32x32x16_bf16 v[56:71], v[28:31], v[236:239], v[56:71]
    ds_read_b64_tr_b16 v[52:53], v20 offset:5120
    ds_read_b64_tr_b16 v[54:55], v20 offset:7168
    s_waitcnt vmcnt(17)
    s_waitcnt lgkmcnt(10)
    v_mfma_f32_32x32x16_bf16 v[56:71], v[32:35], v[240:243], v[56:71]
    ds_read_b64_tr_b16 v[28:29], v20 offset:8192
    ds_read_b64_tr_b16 v[30:31], v20 offset:10240
    s_waitcnt vmcnt(16)
    s_waitcnt lgkmcnt(10)
    v_mfma_f32_32x32x16_bf16 v[56:71], v[36:39], v[244:247], v[56:71]
    ds_read_b64_tr_b16 v[32:33], v20 offset:9216
    ds_read_b64_tr_b16 v[34:35], v20 offset:11264
    s_waitcnt vmcnt(15)
    s_waitcnt lgkmcnt(10)
    v_mfma_f32_32x32x16_bf16 v[56:71], v[40:43], v[152:155], v[56:71]
    ds_read_b64_tr_b16 v[36:37], v20 offset:12288
    ds_read_b64_tr_b16 v[38:39], v20 offset:14336
    s_waitcnt vmcnt(14)
    s_waitcnt lgkmcnt(10)
    v_mfma_f32_32x32x16_bf16 v[56:71], v[44:47], v[156:159], v[56:71]
    ds_read_b64_tr_b16 v[40:41], v20 offset:13312
    ds_read_b64_tr_b16 v[42:43], v20 offset:15360
    s_waitcnt vmcnt(13)
    s_waitcnt lgkmcnt(10)
    v_mfma_f32_32x32x16_bf16 v[56:71], v[48:51], v[160:163], v[56:71]
    ds_read_b64_tr_b16 v[44:45], v20 offset:16384
    ds_read_b64_tr_b16 v[46:47], v20 offset:18432
    s_waitcnt vmcnt(12)
    s_waitcnt lgkmcnt(10)
    v_mfma_f32_32x32x16_bf16 v[56:71], v[52:55], v[164:167], v[56:71]
    ds_read_b64_tr_b16 v[48:49], v20 offset:17408
    ds_read_b64_tr_b16 v[50:51], v20 offset:19456
    s_waitcnt vmcnt(11)
    s_waitcnt lgkmcnt(10)
    v_mfma_f32_32x32x16_bf16 v[56:71], v[28:31], v[168:171], v[56:71]
    ds_read_b64_tr_b16 v[52:53], v20 offset:20480
    ds_read_b64_tr_b16 v[54:55], v20 offset:22528
    s_waitcnt vmcnt(10)
    s_waitcnt lgkmcnt(10)
    v_mfma_f32_32x32x16_bf16 v[56:71], v[32:35], v[172:175], v[56:71]
    ds_read_b64_tr_b16 v[28:29], v20 offset:21504
    ds_read_b64_tr_b16 v[30:31], v20 offset:23552
    s_barrier
    s_waitcnt vmcnt(9)
    s_waitcnt lgkmcnt(10)
    v_mfma_f32_32x32x16_bf16 v[56:71], v[36:39], v[176:179], v[56:71]
    ds_read_b64_tr_b16 v[32:33], v20 offset:24576
    ds_read_b64_tr_b16 v[34:35], v20 offset:26624
    s_waitcnt vmcnt(8)
    s_waitcnt lgkmcnt(10)
    v_mfma_f32_32x32x16_bf16 v[56:71], v[40:43], v[180:183], v[56:71]
    ds_read_b64_tr_b16 v[36:37], v20 offset:25600
    ds_read_b64_tr_b16 v[38:39], v20 offset:27648
    s_waitcnt vmcnt(7)
    s_waitcnt lgkmcnt(10)
    v_mfma_f32_32x32x16_bf16 v[56:71], v[44:47], v[184:187], v[56:71]
    ds_read_b64_tr_b16 v[40:41], v20 offset:28672
    ds_read_b64_tr_b16 v[42:43], v20 offset:30720
    s_waitcnt vmcnt(6)
    s_waitcnt lgkmcnt(10)
    v_mfma_f32_32x32x16_bf16 v[56:71], v[48:51], v[188:191], v[56:71]
    ds_read_b64_tr_b16 v[44:45], v20 offset:29696
    ds_read_b64_tr_b16 v[46:47], v20 offset:31744
    s_waitcnt vmcnt(5)
    s_waitcnt lgkmcnt(10)
    v_mfma_f32_32x32x16_bf16 v[56:71], v[52:55], v[192:195], v[56:71]
    ds_read_b64_tr_b16 v[48:49], v21 offset:32768
    ds_read_b64_tr_b16 v[50:51], v21 offset:34816
    s_waitcnt vmcnt(4)
    s_waitcnt lgkmcnt(10)
    v_mfma_f32_32x32x16_bf16 v[56:71], v[28:31], v[196:199], v[56:71]
    ds_read_b64_tr_b16 v[52:53], v21 offset:33792
    ds_read_b64_tr_b16 v[54:55], v21 offset:35840
    s_waitcnt vmcnt(3)
    s_waitcnt lgkmcnt(10)
    v_mfma_f32_32x32x16_bf16 v[56:71], v[32:35], v[200:203], v[56:71]
    ds_read_b64_tr_b16 v[28:29], v21 offset:36864
    ds_read_b64_tr_b16 v[30:31], v21 offset:38912
    s_waitcnt vmcnt(2)
    s_waitcnt lgkmcnt(10)
    v_mfma_f32_32x32x16_bf16 v[56:71], v[36:39], v[204:207], v[56:71]
    ds_read_b64_tr_b16 v[32:33], v21 offset:37888
    ds_read_b64_tr_b16 v[34:35], v21 offset:39936
    s_waitcnt vmcnt(1)
    s_waitcnt lgkmcnt(10)
    v_mfma_f32_32x32x16_bf16 v[56:71], v[40:43], v[208:211], v[56:71]
    ds_read_b64_tr_b16 v[36:37], v21 offset:40960
    ds_read_b64_tr_b16 v[38:39], v21 offset:43008
    s_waitcnt vmcnt(0)
    s_waitcnt lgkmcnt(10)
    v_mfma_f32_32x32x16_bf16 v[56:71], v[44:47], v[212:215], v[56:71]
    ds_read_b64_tr_b16 v[40:41], v21 offset:41984
    ds_read_b64_tr_b16 v[42:43], v21 offset:44032
    s_waitcnt lgkmcnt(10)
    v_mfma_f32_32x32x16_bf16 v[72:87], v[48:51], v[216:219], v[72:87]
    ds_read_b64_tr_b16 v[44:45], v21 offset:45056
    ds_read_b64_tr_b16 v[46:47], v21 offset:47104
    s_waitcnt lgkmcnt(10)
    v_mfma_f32_32x32x16_bf16 v[72:87], v[52:55], v[220:223], v[72:87]
    s_nop 3
    v_cvt_pk_bf16_f32 v56, v56, v57
    v_cvt_pk_bf16_f32 v57, v58, v59
    ds_read_b64_tr_b16 v[48:49], v21 offset:46080
    ds_read_b64_tr_b16 v[50:51], v21 offset:48128
    s_waitcnt lgkmcnt(10)
    v_mfma_f32_32x32x16_bf16 v[72:87], v[28:31], v[224:227], v[72:87]
    v_cvt_pk_bf16_f32 v58, v60, v61
    v_cvt_pk_bf16_f32 v59, v62, v63
    ds_read_b64_tr_b16 v[52:53], v21
    ds_read_b64_tr_b16 v[54:55], v21 offset:2048
    s_waitcnt lgkmcnt(10)
    v_mfma_f32_32x32x16_bf16 v[72:87], v[32:35], v[228:231], v[72:87]
    ds_write_b128 v0, v[56:59]
    v_cvt_pk_bf16_f32 v60, v64, v65
    ds_read_b64_tr_b16 v[28:29], v21 offset:1024
    ds_read_b64_tr_b16 v[30:31], v21 offset:3072
    s_waitcnt lgkmcnt(11)
    v_mfma_f32_32x32x16_bf16 v[72:87], v[36:39], v[232:235], v[72:87]
    v_cvt_pk_bf16_f32 v61, v66, v67
    v_cvt_pk_bf16_f32 v62, v68, v69
    ds_read_b64_tr_b16 v[32:33], v21 offset:4096
    ds_read_b64_tr_b16 v[34:35], v21 offset:6144
    s_waitcnt lgkmcnt(11)
    v_mfma_f32_32x32x16_bf16 v[72:87], v[40:43], v[236:239], v[72:87]
    v_cvt_pk_bf16_f32 v63, v70, v71
    ds_write_b128 v0, v[60:63] offset:1024
    ds_read_b64_tr_b16 v[36:37], v21 offset:5120
    ds_read_b64_tr_b16 v[38:39], v21 offset:7168
    s_waitcnt lgkmcnt(12)
    v_mfma_f32_32x32x16_bf16 v[72:87], v[44:47], v[240:243], v[72:87]
    v_subrev_u32 v0, 118784, v0
    ds_read_b64_tr_b16 v[40:41], v21 offset:8192
    ds_read_b64_tr_b16 v[42:43], v21 offset:10240
    s_waitcnt lgkmcnt(12)
    v_mfma_f32_32x32x16_bf16 v[72:87], v[48:51], v[244:247], v[72:87]
    ds_read_b64_tr_b16 v[44:45], v21 offset:9216
    ds_read_b64_tr_b16 v[46:47], v21 offset:11264
    s_waitcnt lgkmcnt(6)
    s_barrier
    v_mfma_f32_32x32x16_bf16 v[72:87], v[52:55], v[152:155], v[72:87]
    ds_read_b64_tr_b16 v[48:49], v21 offset:12288
    ds_read_b64_tr_b16 v[50:51], v21 offset:14336
    v_mfma_f32_32x32x16_bf16 v[72:87], v[28:31], v[156:159], v[72:87]
    ds_read_b64_tr_b16 v[52:53], v21 offset:13312
    ds_read_b64_tr_b16 v[54:55], v21 offset:15360
    v_mfma_f32_32x32x16_bf16 v[72:87], v[32:35], v[160:163], v[72:87]
    ds_read_b64_tr_b16 v[28:29], v21 offset:16384
    ds_read_b64_tr_b16 v[30:31], v21 offset:18432
    s_waitcnt lgkmcnt(10)
    v_mfma_f32_32x32x16_bf16 v[72:87], v[36:39], v[164:167], v[72:87]
    ds_read_b64_tr_b16 v[32:33], v21 offset:17408
    ds_read_b64_tr_b16 v[34:35], v21 offset:19456
    s_waitcnt lgkmcnt(10)
    v_mfma_f32_32x32x16_bf16 v[72:87], v[40:43], v[168:171], v[72:87]
    ds_read_b64_tr_b16 v[36:37], v21 offset:20480
    ds_read_b64_tr_b16 v[38:39], v21 offset:22528
    s_waitcnt lgkmcnt(10)
    v_mfma_f32_32x32x16_bf16 v[72:87], v[44:47], v[172:175], v[72:87]
    ds_read_b64_tr_b16 v[40:41], v21 offset:21504
    ds_read_b64_tr_b16 v[42:43], v21 offset:23552
    s_waitcnt lgkmcnt(10)
    v_mfma_f32_32x32x16_bf16 v[72:87], v[48:51], v[176:179], v[72:87]
    ds_read_b64_tr_b16 v[44:45], v21 offset:24576
    ds_read_b64_tr_b16 v[46:47], v21 offset:26624
    s_waitcnt lgkmcnt(10)
    v_mfma_f32_32x32x16_bf16 v[72:87], v[52:55], v[180:183], v[72:87]
    ds_read_b64_tr_b16 v[48:49], v21 offset:25600
    ds_read_b64_tr_b16 v[50:51], v21 offset:27648
    s_waitcnt lgkmcnt(10)
    v_mfma_f32_32x32x16_bf16 v[72:87], v[28:31], v[184:187], v[72:87]
    ds_read_b64_tr_b16 v[52:53], v21 offset:28672
    ds_read_b64_tr_b16 v[54:55], v21 offset:30720
    s_waitcnt lgkmcnt(10)
    v_mfma_f32_32x32x16_bf16 v[72:87], v[32:35], v[188:191], v[72:87]
    ds_read_b64_tr_b16 v[28:29], v21 offset:29696
    ds_read_b64_tr_b16 v[30:31], v21 offset:31744
    s_waitcnt lgkmcnt(10)
    v_mfma_f32_32x32x16_bf16 v[72:87], v[36:39], v[192:195], v[72:87]
    ds_read_b64_tr_b16 v[32:33], v22 offset:32768
    ds_read_b64_tr_b16 v[34:35], v22 offset:34816
    s_waitcnt lgkmcnt(10)
    v_mfma_f32_32x32x16_bf16 v[72:87], v[40:43], v[196:199], v[72:87]
    ds_read_b64_tr_b16 v[36:37], v23 offset:32768
    ds_read_b64_tr_b16 v[38:39], v23 offset:34816
    s_waitcnt lgkmcnt(10)
    v_mfma_f32_32x32x16_bf16 v[72:87], v[44:47], v[200:203], v[72:87]
    ds_read_b64_tr_b16 v[40:41], v22 offset:33792
    ds_read_b64_tr_b16 v[42:43], v22 offset:35840
    s_waitcnt lgkmcnt(10)
    v_mfma_f32_32x32x16_bf16 v[72:87], v[48:51], v[204:207], v[72:87]
    ds_read_b64_tr_b16 v[44:45], v23 offset:33792
    ds_read_b64_tr_b16 v[46:47], v23 offset:35840
    s_waitcnt lgkmcnt(10)
    v_mfma_f32_32x32x16_bf16 v[72:87], v[52:55], v[208:211], v[72:87]
    ds_read_b64_tr_b16 v[48:49], v22 offset:36864
    ds_read_b64_tr_b16 v[50:51], v22 offset:38912
    s_waitcnt lgkmcnt(10)
    v_mfma_f32_32x32x16_bf16 v[72:87], v[28:31], v[212:215], v[72:87]
    ds_read_b64_tr_b16 v[52:53], v23 offset:36864
    ds_read_b64_tr_b16 v[54:55], v23 offset:38912
    s_waitcnt lgkmcnt(10)
    v_mfma_f32_32x32x16_bf16 v[88:103], v[32:35], v[216:219], v[88:103]
    ds_read_b64_tr_b16 v[28:29], v22 offset:37888
    ds_read_b64_tr_b16 v[30:31], v22 offset:39936
    s_waitcnt lgkmcnt(10)
    v_mfma_f32_32x32x16_bf16 v[104:119], v[36:39], v[216:219], v[104:119]
    s_nop 3
    v_cvt_pk_bf16_f32 v72, v72, v73
    v_cvt_pk_bf16_f32 v73, v74, v75
    ds_read_b64_tr_b16 v[32:33], v23 offset:37888
    ds_read_b64_tr_b16 v[34:35], v23 offset:39936
    s_waitcnt lgkmcnt(10)
    v_mfma_f32_32x32x16_bf16 v[88:103], v[40:43], v[220:223], v[88:103]
    v_cvt_pk_bf16_f32 v74, v76, v77
    v_cvt_pk_bf16_f32 v75, v78, v79
    ds_read_b64_tr_b16 v[36:37], v22 offset:40960
    ds_read_b64_tr_b16 v[38:39], v22 offset:43008
    s_waitcnt lgkmcnt(10)
    v_mfma_f32_32x32x16_bf16 v[104:119], v[44:47], v[220:223], v[104:119]
    ds_write_b128 v0, v[72:75]
    v_cvt_pk_bf16_f32 v76, v80, v81
    ds_read_b64_tr_b16 v[40:41], v23 offset:40960
    ds_read_b64_tr_b16 v[42:43], v23 offset:43008
    s_waitcnt lgkmcnt(11)
    v_mfma_f32_32x32x16_bf16 v[88:103], v[48:51], v[224:227], v[88:103]
    v_cvt_pk_bf16_f32 v77, v82, v83
    v_cvt_pk_bf16_f32 v78, v84, v85
    ds_read_b64_tr_b16 v[44:45], v22 offset:41984
    ds_read_b64_tr_b16 v[46:47], v22 offset:44032
    s_waitcnt lgkmcnt(11)
    v_mfma_f32_32x32x16_bf16 v[104:119], v[52:55], v[224:227], v[104:119]
    v_cvt_pk_bf16_f32 v79, v86, v87
    ds_write_b128 v0, v[76:79] offset:1024
    ds_read_b64_tr_b16 v[48:49], v23 offset:41984
    ds_read_b64_tr_b16 v[50:51], v23 offset:44032
    s_waitcnt lgkmcnt(12)
    v_mfma_f32_32x32x16_bf16 v[88:103], v[28:31], v[228:231], v[88:103]
    ds_read_b64_tr_b16 v[52:53], v22 offset:45056
    ds_read_b64_tr_b16 v[54:55], v22 offset:47104
    s_waitcnt lgkmcnt(12)
    v_mfma_f32_32x32x16_bf16 v[104:119], v[32:35], v[228:231], v[104:119]
    ds_read_b64_tr_b16 v[28:29], v23 offset:45056
    ds_read_b64_tr_b16 v[30:31], v23 offset:47104
    s_waitcnt lgkmcnt(6)
    s_barrier
    v_mfma_f32_32x32x16_bf16 v[88:103], v[36:39], v[232:235], v[88:103]
    s_lshl_b32 s96, s77, 11
    s_add_u32 s14, s96, 32768
    v_and_b32 v0, 7, v1
    ds_read_b64_tr_b16 v[32:33], v22 offset:46080
    ds_read_b64_tr_b16 v[34:35], v22 offset:48128
    v_mfma_f32_32x32x16_bf16 v[104:119], v[40:43], v[232:235], v[104:119]
    v_lshl_add_u32 v0, v0, 4, s14
    ds_read_b64_tr_b16 v[36:37], v23 offset:46080
    ds_read_b64_tr_b16 v[38:39], v23 offset:48128
    v_mfma_f32_32x32x16_bf16 v[88:103], v[44:47], v[236:239], v[88:103]
    v_bfe_u32 v4, v1, 3, 2
    ds_read_b64_tr_b16 v[40:41], v22
    ds_read_b64_tr_b16 v[42:43], v22 offset:2048
    s_waitcnt lgkmcnt(10)
    v_mfma_f32_32x32x16_bf16 v[104:119], v[48:51], v[236:239], v[104:119]
    v_lshl_add_u32 v0, v4, 8, v0
    v_lshrrev_b32 v4, 5, v1
    ds_read_b64_tr_b16 v[44:45], v23
    ds_read_b64_tr_b16 v[46:47], v23 offset:2048
    s_waitcnt lgkmcnt(10)
    v_mfma_f32_32x32x16_bf16 v[88:103], v[52:55], v[240:243], v[88:103]
    v_lshl_add_u32 v0, v4, 7, v0
    ds_read_b64_tr_b16 v[48:49], v22 offset:1024
    ds_read_b64_tr_b16 v[50:51], v22 offset:3072
    s_waitcnt lgkmcnt(10)
    v_mfma_f32_32x32x16_bf16 v[104:119], v[28:31], v[240:243], v[104:119]
    ds_read_b64_tr_b16 v[52:53], v23 offset:1024
    ds_read_b64_tr_b16 v[54:55], v23 offset:3072
    s_waitcnt lgkmcnt(10)
    v_mfma_f32_32x32x16_bf16 v[88:103], v[32:35], v[244:247], v[88:103]
    ds_read_b64_tr_b16 v[28:29], v22 offset:4096
    ds_read_b64_tr_b16 v[30:31], v22 offset:6144
    s_waitcnt lgkmcnt(10)
    v_mfma_f32_32x32x16_bf16 v[104:119], v[36:39], v[244:247], v[104:119]
    ds_read_b64_tr_b16 v[32:33], v23 offset:4096
    ds_read_b64_tr_b16 v[34:35], v23 offset:6144
    s_waitcnt lgkmcnt(10)
    v_mfma_f32_32x32x16_bf16 v[88:103], v[40:43], v[152:155], v[88:103]
    ds_read_b64_tr_b16 v[36:37], v22 offset:5120
    ds_read_b64_tr_b16 v[38:39], v22 offset:7168
    s_waitcnt lgkmcnt(10)
    v_mfma_f32_32x32x16_bf16 v[104:119], v[44:47], v[152:155], v[104:119]
    ds_read_b64_tr_b16 v[40:41], v23 offset:5120
    ds_read_b64_tr_b16 v[42:43], v23 offset:7168
    s_waitcnt lgkmcnt(10)
    v_mfma_f32_32x32x16_bf16 v[88:103], v[48:51], v[156:159], v[88:103]
    ds_read_b64_tr_b16 v[44:45], v22 offset:8192
    ds_read_b64_tr_b16 v[46:47], v22 offset:10240
    s_waitcnt lgkmcnt(10)
    v_mfma_f32_32x32x16_bf16 v[104:119], v[52:55], v[156:159], v[104:119]
    ds_read_b64_tr_b16 v[48:49], v23 offset:8192
    ds_read_b64_tr_b16 v[50:51], v23 offset:10240
    s_waitcnt lgkmcnt(10)
    v_mfma_f32_32x32x16_bf16 v[88:103], v[28:31], v[160:163], v[88:103]
    ds_read_b64_tr_b16 v[52:53], v22 offset:9216
    ds_read_b64_tr_b16 v[54:55], v22 offset:11264
    s_waitcnt lgkmcnt(10)
    v_mfma_f32_32x32x16_bf16 v[104:119], v[32:35], v[160:163], v[104:119]
    ds_read_b64_tr_b16 v[28:29], v23 offset:9216
    ds_read_b64_tr_b16 v[30:31], v23 offset:11264
    s_waitcnt lgkmcnt(10)
    v_mfma_f32_32x32x16_bf16 v[88:103], v[36:39], v[164:167], v[88:103]
    ds_read_b64_tr_b16 v[32:33], v22 offset:12288
    ds_read_b64_tr_b16 v[34:35], v22 offset:14336
    s_waitcnt lgkmcnt(10)
    v_mfma_f32_32x32x16_bf16 v[104:119], v[40:43], v[164:167], v[104:119]
    ds_read_b64_tr_b16 v[36:37], v23 offset:12288
    ds_read_b64_tr_b16 v[38:39], v23 offset:14336
    s_waitcnt lgkmcnt(10)
    v_mfma_f32_32x32x16_bf16 v[88:103], v[44:47], v[168:171], v[88:103]
    ds_read_b64_tr_b16 v[40:41], v22 offset:13312
    ds_read_b64_tr_b16 v[42:43], v22 offset:15360
    s_waitcnt lgkmcnt(10)
    v_mfma_f32_32x32x16_bf16 v[104:119], v[48:51], v[168:171], v[104:119]
    ds_read_b64_tr_b16 v[44:45], v23 offset:13312
    ds_read_b64_tr_b16 v[46:47], v23 offset:15360
    s_waitcnt lgkmcnt(10)
    v_mfma_f32_32x32x16_bf16 v[88:103], v[52:55], v[172:175], v[88:103]
    ds_read_b64_tr_b16 v[48:49], v22 offset:16384
    ds_read_b64_tr_b16 v[50:51], v22 offset:18432
    s_waitcnt lgkmcnt(10)
    v_mfma_f32_32x32x16_bf16 v[104:119], v[28:31], v[172:175], v[104:119]
    ds_read_b64_tr_b16 v[52:53], v23 offset:16384
    ds_read_b64_tr_b16 v[54:55], v23 offset:18432
    s_waitcnt lgkmcnt(10)
    v_mfma_f32_32x32x16_bf16 v[88:103], v[32:35], v[176:179], v[88:103]
    ds_read_b64_tr_b16 v[28:29], v22 offset:17408
    ds_read_b64_tr_b16 v[30:31], v22 offset:19456
    s_waitcnt lgkmcnt(10)
    v_mfma_f32_32x32x16_bf16 v[104:119], v[36:39], v[176:179], v[104:119]
    ds_read_b64_tr_b16 v[32:33], v23 offset:17408
    ds_read_b64_tr_b16 v[34:35], v23 offset:19456
    s_waitcnt lgkmcnt(10)
    v_mfma_f32_32x32x16_bf16 v[88:103], v[40:43], v[180:183], v[88:103]
    ds_read_b64_tr_b16 v[36:37], v22 offset:20480
    ds_read_b64_tr_b16 v[38:39], v22 offset:22528
    s_waitcnt lgkmcnt(10)
    v_mfma_f32_32x32x16_bf16 v[104:119], v[44:47], v[180:183], v[104:119]
    ds_read_b64_tr_b16 v[40:41], v23 offset:20480
    ds_read_b64_tr_b16 v[42:43], v23 offset:22528
    s_waitcnt lgkmcnt(10)
    v_mfma_f32_32x32x16_bf16 v[88:103], v[48:51], v[184:187], v[88:103]
    ds_read_b64_tr_b16 v[44:45], v22 offset:21504
    ds_read_b64_tr_b16 v[46:47], v22 offset:23552
    s_waitcnt lgkmcnt(10)
    v_mfma_f32_32x32x16_bf16 v[104:119], v[52:55], v[184:187], v[104:119]
    ds_read_b64_tr_b16 v[48:49], v23 offset:21504
    ds_read_b64_tr_b16 v[50:51], v23 offset:23552
    s_waitcnt lgkmcnt(10)
    v_mfma_f32_32x32x16_bf16 v[88:103], v[28:31], v[188:191], v[88:103]
    ds_read_b64_tr_b16 v[52:53], v22 offset:24576
    ds_read_b64_tr_b16 v[54:55], v22 offset:26624
    s_waitcnt lgkmcnt(10)
    v_mfma_f32_32x32x16_bf16 v[104:119], v[32:35], v[188:191], v[104:119]
    ds_read_b64_tr_b16 v[28:29], v23 offset:24576
    ds_read_b64_tr_b16 v[30:31], v23 offset:26624
    s_waitcnt lgkmcnt(10)
    v_mfma_f32_32x32x16_bf16 v[88:103], v[36:39], v[192:195], v[88:103]
    ds_read_b64_tr_b16 v[32:33], v22 offset:25600
    ds_read_b64_tr_b16 v[34:35], v22 offset:27648
    s_waitcnt lgkmcnt(10)
    v_mfma_f32_32x32x16_bf16 v[104:119], v[40:43], v[192:195], v[104:119]
    ds_read_b64_tr_b16 v[36:37], v23 offset:25600
    ds_read_b64_tr_b16 v[38:39], v23 offset:27648
    s_waitcnt lgkmcnt(10)
    v_mfma_f32_32x32x16_bf16 v[88:103], v[44:47], v[196:199], v[88:103]
    ds_read_b64_tr_b16 v[40:41], v22 offset:28672
    ds_read_b64_tr_b16 v[42:43], v22 offset:30720
    s_waitcnt lgkmcnt(10)
    v_mfma_f32_32x32x16_bf16 v[104:119], v[48:51], v[196:199], v[104:119]
    ds_read_b64_tr_b16 v[44:45], v23 offset:28672
    ds_read_b64_tr_b16 v[46:47], v23 offset:30720
    s_waitcnt lgkmcnt(10)
    v_mfma_f32_32x32x16_bf16 v[88:103], v[52:55], v[200:203], v[88:103]
    ds_read_b64_tr_b16 v[48:49], v22 offset:29696
    ds_read_b64_tr_b16 v[50:51], v22 offset:31744
    s_waitcnt lgkmcnt(10)
    v_mfma_f32_32x32x16_bf16 v[104:119], v[28:31], v[200:203], v[104:119]
    ds_read_b64_tr_b16 v[52:53], v23 offset:29696
    ds_read_b64_tr_b16 v[54:55], v23 offset:31744
    s_waitcnt lgkmcnt(10)
    v_mfma_f32_32x32x16_bf16 v[88:103], v[32:35], v[204:207], v[88:103]
    ds_read_b64_tr_b16 v[28:29], v24 offset:32768
    ds_read_b64_tr_b16 v[30:31], v24 offset:34816
    s_waitcnt lgkmcnt(10)
    v_mfma_f32_32x32x16_bf16 v[104:119], v[36:39], v[204:207], v[104:119]
    ds_read_b64_tr_b16 v[32:33], v25 offset:32768
    ds_read_b64_tr_b16 v[34:35], v25 offset:34816
    s_waitcnt lgkmcnt(10)
    v_mfma_f32_32x32x16_bf16 v[88:103], v[40:43], v[208:211], v[88:103]
    ds_read_b64_tr_b16 v[36:37], v24 offset:33792
    ds_read_b64_tr_b16 v[38:39], v24 offset:35840
    s_waitcnt lgkmcnt(10)
    v_mfma_f32_32x32x16_bf16 v[104:119], v[44:47], v[208:211], v[104:119]
    ds_read_b64_tr_b16 v[40:41], v25 offset:33792
    ds_read_b64_tr_b16 v[42:43], v25 offset:35840
    s_waitcnt lgkmcnt(10)
    v_mfma_f32_32x32x16_bf16 v[88:103], v[48:51], v[212:215], v[88:103]
    ds_read_b64_tr_b16 v[44:45], v24 offset:36864
    ds_read_b64_tr_b16 v[46:47], v24 offset:38912
    s_waitcnt lgkmcnt(10)
    v_mfma_f32_32x32x16_bf16 v[104:119], v[52:55], v[212:215], v[104:119]
    ds_read_b64_tr_b16 v[48:49], v25 offset:36864
    ds_read_b64_tr_b16 v[50:51], v25 offset:38912
    s_barrier
    s_waitcnt lgkmcnt(10)
    v_mfma_f32_32x32x16_bf16 v[120:135], v[28:31], v[216:219], v[120:135]
    ds_read_b64_tr_b16 v[52:53], v24 offset:37888
    ds_read_b64_tr_b16 v[54:55], v24 offset:39936
    s_waitcnt lgkmcnt(10)
    v_mfma_f32_32x32x16_bf16 v[136:151], v[32:35], v[216:219], v[136:151]
    ds_read_b64_tr_b16 v[28:29], v25 offset:37888
    ds_read_b64_tr_b16 v[30:31], v25 offset:39936
    s_waitcnt lgkmcnt(10)
    v_mfma_f32_32x32x16_bf16 v[120:135], v[36:39], v[220:223], v[120:135]
    v_cvt_pk_bf16_f32 v88, v88, v89
    ds_read_b64_tr_b16 v[32:33], v24 offset:40960
    ds_read_b64_tr_b16 v[34:35], v24 offset:43008
L_PAD4:
    s_cbranch_execz L_RET4
    s_waitcnt lgkmcnt(10)
    v_mfma_f32_32x32x16_bf16 v[136:151], v[40:43], v[220:223], v[136:151]
    v_cvt_pk_bf16_f32 v89, v90, v91
    ds_read_b64_tr_b16 v[36:37], v25 offset:40960
    ds_read_b64_tr_b16 v[38:39], v25 offset:43008
    s_waitcnt lgkmcnt(10)
    v_mfma_f32_32x32x16_bf16 v[120:135], v[44:47], v[224:227], v[120:135]
    v_cvt_pk_bf16_f32 v90, v92, v93
    ds_read_b64_tr_b16 v[40:41], v24 offset:41984
    ds_read_b64_tr_b16 v[42:43], v24 offset:44032
    s_waitcnt lgkmcnt(10)
    v_mfma_f32_32x32x16_bf16 v[136:151], v[48:51], v[224:227], v[136:151]
    v_cvt_pk_bf16_f32 v91, v94, v95
    ds_read_b64_tr_b16 v[44:45], v25 offset:41984
    ds_read_b64_tr_b16 v[46:47], v25 offset:44032
    s_waitcnt lgkmcnt(10)
    v_mfma_f32_32x32x16_bf16 v[120:135], v[52:55], v[228:231], v[120:135]
    ds_write_b128 v0, v[88:91]
    ds_read_b64_tr_b16 v[48:49], v24 offset:45056
    ds_read_b64_tr_b16 v[50:51], v24 offset:47104
    s_waitcnt lgkmcnt(11)
    v_mfma_f32_32x32x16_bf16 v[136:151], v[28:31], v[228:231], v[136:151]
    v_cvt_pk_bf16_f32 v92, v96, v97
    ds_read_b64_tr_b16 v[52:53], v25 offset:45056
    ds_read_b64_tr_b16 v[54:55], v25 offset:47104
    s_waitcnt lgkmcnt(11)
    v_mfma_f32_32x32x16_bf16 v[120:135], v[32:35], v[232:235], v[120:135]
    v_cvt_pk_bf16_f32 v93, v98, v99
    ds_read_b64_tr_b16 v[28:29], v24 offset:46080
    ds_read_b64_tr_b16 v[30:31], v24 offset:48128
    s_waitcnt lgkmcnt(11)
    v_mfma_f32_32x32x16_bf16 v[136:151], v[36:39], v[232:235], v[136:151]
    v_cvt_pk_bf16_f32 v94, v100, v101
    ds_read_b64_tr_b16 v[32:33], v25 offset:46080
    ds_read_b64_tr_b16 v[34:35], v25 offset:48128
    s_waitcnt lgkmcnt(11)
    v_mfma_f32_32x32x16_bf16 v[120:135], v[40:43], v[236:239], v[120:135]
    v_cvt_pk_bf16_f32 v95, v102, v103
    ds_read_b64_tr_b16 v[36:37], v24
    ds_read_b64_tr_b16 v[38:39], v24 offset:2048
    s_waitcnt lgkmcnt(11)
    v_mfma_f32_32x32x16_bf16 v[136:151], v[44:47], v[236:239], v[136:151]
    ds_write_b128 v0, v[92:95] offset:1024
    ds_read_b64_tr_b16 v[40:41], v25
    ds_read_b64_tr_b16 v[42:43], v25 offset:2048
    s_waitcnt lgkmcnt(11)
    v_mfma_f32_32x32x16_bf16 v[120:135], v[48:51], v[240:243], v[120:135]
    v_cvt_pk_bf16_f32 v104, v104, v105
    ds_read_b64_tr_b16 v[44:45], v24 offset:1024
    ds_read_b64_tr_b16 v[46:47], v24 offset:3072
    s_waitcnt lgkmcnt(11)
    v_mfma_f32_32x32x16_bf16 v[136:151], v[52:55], v[240:243], v[136:151]
    v_cvt_pk_bf16_f32 v105, v106, v107
    ds_read_b64_tr_b16 v[48:49], v25 offset:1024
    ds_read_b64_tr_b16 v[50:51], v25 offset:3072
    s_waitcnt lgkmcnt(11)
    v_mfma_f32_32x32x16_bf16 v[120:135], v[28:31], v[244:247], v[120:135]
    v_cvt_pk_bf16_f32 v106, v108, v109
    ds_read_b64_tr_b16 v[52:53], v24 offset:4096
    ds_read_b64_tr_b16 v[54:55], v24 offset:6144
    s_waitcnt lgkmcnt(11)
    v_mfma_f32_32x32x16_bf16 v[136:151], v[32:35], v[244:247], v[136:151]
    v_cvt_pk_bf16_f32 v107, v110, v111
    ds_read_b64_tr_b16 v[28:29], v25 offset:4096
    ds_read_b64_tr_b16 v[30:31], v25 offset:6144
    s_waitcnt lgkmcnt(11)
    v_mfma_f32_32x32x16_bf16 v[120:135], v[36:39], v[152:155], v[120:135]
    ds_write_b128 v0, v[104:107] offset:8192
    ds_read_b64_tr_b16 v[32:33], v24 offset:5120
    ds_read_b64_tr_b16 v[34:35], v24 offset:7168
    s_waitcnt lgkmcnt(11)
    v_mfma_f32_32x32x16_bf16 v[136:151], v[40:43], v[152:155], v[136:151]
    v_cvt_pk_bf16_f32 v108, v112, v113
    ds_read_b64_tr_b16 v[36:37], v25 offset:5120
    ds_read_b64_tr_b16 v[38:39], v25 offset:7168
    s_waitcnt lgkmcnt(11)
    v_mfma_f32_32x32x16_bf16 v[120:135], v[44:47], v[156:159], v[120:135]
    v_cvt_pk_bf16_f32 v109, v114, v115
    ds_read_b64_tr_b16 v[40:41], v24 offset:8192
    ds_read_b64_tr_b16 v[42:43], v24 offset:10240
    s_waitcnt lgkmcnt(11)
    v_mfma_f32_32x32x16_bf16 v[136:151], v[48:51], v[156:159], v[136:151]
    v_cvt_pk_bf16_f32 v110, v116, v117
    ds_read_b64_tr_b16 v[44:45], v25 offset:8192
    ds_read_b64_tr_b16 v[46:47], v25 offset:10240
    s_waitcnt lgkmcnt(11)
    v_mfma_f32_32x32x16_bf16 v[120:135], v[52:55], v[160:163], v[120:135]
    v_cvt_pk_bf16_f32 v111, v118, v119
    ds_read_b64_tr_b16 v[48:49], v24 offset:9216
    ds_read_b64_tr_b16 v[50:51], v24 offset:11264
    s_waitcnt lgkmcnt(11)
    v_mfma_f32_32x32x16_bf16 v[136:151], v[28:31], v[160:163], v[136:151]
    ds_write_b128 v0, v[108:111] offset:9216
    ds_read_b64_tr_b16 v[52:53], v25 offset:9216
    ds_read_b64_tr_b16 v[54:55], v25 offset:11264
    s_waitcnt lgkmcnt(11)
    v_mfma_f32_32x32x16_bf16 v[120:135], v[32:35], v[164:167], v[120:135]
    v_and_b32 v85, 1, v1
    ds_read_b64_tr_b16 v[28:29], v24 offset:12288
    ds_read_b64_tr_b16 v[30:31], v24 offset:14336
    s_waitcnt lgkmcnt(11)
    v_mfma_f32_32x32x16_bf16 v[136:151], v[36:39], v[164:167], v[136:151]
    v_lshlrev_b32 v85, 3, v85
    ds_read_b64_tr_b16 v[32:33], v25 offset:12288
    ds_read_b64_tr_b16 v[34:35], v25 offset:14336
    s_waitcnt lgkmcnt(11)
    v_mfma_f32_32x32x16_bf16 v[120:135], v[40:43], v[168:171], v[120:135]
    v_bfe_u32 v84, v1, 2, 2
    ds_read_b64_tr_b16 v[36:37], v24 offset:13312
    ds_read_b64_tr_b16 v[38:39], v24 offset:15360
    s_waitcnt lgkmcnt(11)
    v_mfma_f32_32x32x16_bf16 v[136:151], v[44:47], v[168:171], v[136:151]
    v_lshl_add_u32 v85, v84, 4, v85
    ds_read_b64_tr_b16 v[40:41], v25 offset:13312
    ds_read_b64_tr_b16 v[42:43], v25 offset:15360
    s_waitcnt lgkmcnt(11)
    v_mfma_f32_32x32x16_bf16 v[120:135], v[48:51], v[172:175], v[120:135]
    v_bfe_u32 v84, v1, 4, 1
    ds_read_b64_tr_b16 v[44:45], v24 offset:16384
    ds_read_b64_tr_b16 v[46:47], v24 offset:18432
    s_waitcnt lgkmcnt(10)
    v_mfma_f32_32x32x16_bf16 v[136:151], v[52:55], v[172:175], v[136:151]
    v_lshl_add_u32 v85, v84, 6, v85
    ds_read_b64_tr_b16 v[48:49], v25 offset:16384
    ds_read_b64_tr_b16 v[50:51], v25 offset:18432
    s_waitcnt lgkmcnt(10)
    v_mfma_f32_32x32x16_bf16 v[120:135], v[28:31], v[176:179], v[120:135]
    v_bfe_u32 v84, v1, 1, 1
    ds_read_b64_tr_b16 v[52:53], v24 offset:17408
    ds_read_b64_tr_b16 v[54:55], v24 offset:19456
    s_waitcnt lgkmcnt(10)
    v_mfma_f32_32x32x16_bf16 v[136:151], v[32:35], v[176:179], v[136:151]
    v_lshl_add_u32 v85, v84, 7, v85
    ds_read_b64_tr_b16 v[28:29], v25 offset:17408
    ds_read_b64_tr_b16 v[30:31], v25 offset:19456
    s_waitcnt lgkmcnt(10)
    v_mfma_f32_32x32x16_bf16 v[120:135], v[36:39], v[180:183], v[120:135]
    v_lshrrev_b32 v84, 5, v1
    ds_read_b64_tr_b16 v[32:33], v24 offset:20480
    ds_read_b64_tr_b16 v[34:35], v24 offset:22528
    s_waitcnt lgkmcnt(10)
    v_mfma_f32_32x32x16_bf16 v[136:151], v[40:43], v[180:183], v[136:151]
    v_lshl_add_u32 v85, v84, 8, v85
    ds_read_b64_tr_b16 v[36:37], v25 offset:20480
    ds_read_b64_tr_b16 v[38:39], v25 offset:22528
    s_waitcnt lgkmcnt(10)
    v_mfma_f32_32x32x16_bf16 v[120:135], v[44:47], v[184:187], v[120:135]
    s_lshl_b32 s13, s3, 12
    v_add_u32 v84, s13, v85
    ds_read_b64_tr_b16 v[40:41], v24 offset:21504
    ds_read_b64_tr_b16 v[42:43], v24 offset:23552
    s_waitcnt lgkmcnt(10)
    v_mfma_f32_32x32x16_bf16 v[136:151], v[48:51], v[184:187], v[136:151]
    s_lshl_b32 s96, s76, 13
    s_add_u32 s13, s96, 32768
    v_add_u32 v85, s13, v85
    ds_read_b64_tr_b16 v[44:45], v25 offset:21504
    ds_read_b64_tr_b16 v[46:47], v25 offset:23552
    s_waitcnt lgkmcnt(10)
    v_mfma_f32_32x32x16_bf16 v[120:135], v[52:55], v[188:191], v[120:135]
    v_mov_b32 v80, 0x3f803f80
    ds_read_b64_tr_b16 v[48:49], v24 offset:24576
    ds_read_b64_tr_b16 v[50:51], v24 offset:26624
    s_waitcnt lgkmcnt(10)
    v_mfma_f32_32x32x16_bf16 v[136:151], v[28:31], v[188:191], v[136:151]
    v_mov_b32 v81, 0x3f803f80
    ds_read_b64_tr_b16 v[52:53], v25 offset:24576
    ds_read_b64_tr_b16 v[54:55], v25 offset:26624
    s_waitcnt lgkmcnt(10)
    v_mfma_f32_32x32x16_bf16 v[120:135], v[32:35], v[192:195], v[120:135]
    v_mov_b32 v82, 0x3f803f80
    ds_read_b64_tr_b16 v[28:29], v24 offset:25600
    ds_read_b64_tr_b16 v[30:31], v24 offset:27648
    s_waitcnt lgkmcnt(10)
    v_mfma_f32_32x32x16_bf16 v[136:151], v[36:39], v[192:195], v[136:151]
    v_mov_b32 v83, 0x3f803f80
    ds_read_b64_tr_b16 v[32:33], v25 offset:25600
    ds_read_b64_tr_b16 v[34:35], v25 offset:27648
    s_waitcnt lgkmcnt(10)
    v_mfma_f32_32x32x16_bf16 v[120:135], v[40:43], v[196:199], v[120:135]
    s_lshl3_add_u32 s96, s11, s3
    s_lshl_b32 s97, s96, 5
    s_add_u32 s98, s97, s10
    s_lshl_b32 s99, s98, 10
    s_add_u32 s13, s99, 25165824
    s_add_u32 s15, s13, 16384
    s_lshl3_add_u32 s96, s11, s3
    s_lshl_b32 s97, s96, 10
    s_add_u32 s16, s97, 21495808
    s_lshl_b32 s96, s10, 6
    s_add_u32 s14, s96, s16
    ds_read_b64_tr_b16 v[36:37], v24 offset:28672
    ds_read_b64_tr_b16 v[38:39], v24 offset:30720
    s_waitcnt lgkmcnt(10)
    v_mfma_f32_32x32x16_bf16 v[136:151], v[44:47], v[196:199], v[136:151]
    ds_read_b64_tr_b16 v[40:41], v25 offset:28672
    ds_read_b64_tr_b16 v[42:43], v25 offset:30720
    s_waitcnt lgkmcnt(10)
    v_mfma_f32_32x32x16_bf16 v[120:135], v[48:51], v[200:203], v[120:135]
    ds_read_b64_tr_b16 v[44:45], v25 offset:29696
    ds_read_b64_tr_b16 v[46:47], v25 offset:31744
    s_waitcnt lgkmcnt(10)
    v_mfma_f32_32x32x16_bf16 v[136:151], v[52:55], v[200:203], v[136:151]
    ds_read_b64_tr_b16 v[48:49], v24 offset:29696
    ds_read_b64_tr_b16 v[50:51], v24 offset:31744
    s_waitcnt lgkmcnt(10)
    v_mfma_f32_32x32x16_bf16 v[120:135], v[28:31], v[204:207], v[120:135]
    s_waitcnt lgkmcnt(8)
    v_mfma_f32_32x32x16_bf16 v[136:151], v[32:35], v[204:207], v[136:151]
    s_waitcnt lgkmcnt(6)
    v_mfma_f32_32x32x16_bf16 v[120:135], v[36:39], v[208:211], v[120:135]
    s_waitcnt lgkmcnt(4)
    v_mfma_f32_32x32x16_bf16 v[136:151], v[40:43], v[208:211], v[136:151]
    s_waitcnt lgkmcnt(2)
    v_mfma_f32_32x32x16_bf16 v[136:151], v[44:47], v[212:215], v[136:151]
    s_waitcnt lgkmcnt(0)
    v_mfma_f32_32x32x16_bf16 v[120:135], v[48:51], v[212:215], v[120:135]
    s_lshl_b32 s96, s77, 11
    s_add_u32 s17, s96, 151552
    v_add_u32 v0, s17, v2
    v_bfe_u32 v4, v1, 2, 2
    v_lshlrev_b32 v4, 6, v4
    v_bfe_u32 v9, v1, 4, 1
    v_lshl_add_u32 v4, v9, 5, v4
    v_and_b32 v9, 3, v1
    v_lshl_add_u32 v4, v9, 3, v4
    v_lshrrev_b32 v9, 5, v1
    v_lshl_add_u32 v4, v9, 8, v4
    v_add_u32 v4, 159744, v4
    ds_read_b64_tr_b16 v[176:177], v4
    ds_read_b64_tr_b16 v[178:179], v4 offset:512
    ds_read_b64_tr_b16 v[180:181], v4 offset:1024
    ds_read_b64_tr_b16 v[182:183], v4 offset:1536
    v_cvt_pk_bf16_f32 v152, v136, v137
    v_cvt_pk_bf16_f32 v153, v138, v139
    v_cvt_pk_bf16_f32 v154, v140, v141
    v_cvt_pk_bf16_f32 v155, v142, v143
    v_cvt_pk_bf16_f32 v156, v144, v145
    v_cvt_pk_bf16_f32 v157, v146, v147
    v_cvt_pk_bf16_f32 v158, v148, v149
    v_cvt_pk_bf16_f32 v159, v150, v151
    ds_write_b128 v0, v[152:155]
    ds_write_b128 v0, v[156:159] offset:1024
    v_cvt_pk_bf16_f32 v168, v120, v121
    v_cvt_pk_bf16_f32 v169, v122, v123
    v_cvt_pk_bf16_f32 v170, v124, v125
    v_cvt_pk_bf16_f32 v171, v126, v127
    v_cvt_pk_bf16_f32 v172, v128, v129
    v_cvt_pk_bf16_f32 v173, v130, v131
    v_cvt_pk_bf16_f32 v174, v132, v133
    v_cvt_pk_bf16_f32 v175, v134, v135
    s_setprio 0
    s_branch L_JOIN
L_HELP:
    s_waitcnt vmcnt(0)
    s_barrier
    s_add_u32 s96, s84, 4
    s_and_b32 s97, s96, 15
    s_mul_i32 s98, s97, 393216
    s_add_u32 s99, s98, s85
    s_add_u32 s82, s99, 4294772736
    s_add_u32 m0, s83, 28672
    s_nop 0
    buffer_load_dwordx4 v3, s[40:43], s82 offen lds
    s_add_u32 s96, s84, 4
    s_and_b32 s97, s96, 15
    s_mul_i32 s98, s97, 393216
    s_add_u32 s99, s98, s85
    s_add_u32 s82, s99, 2048
    s_add_u32 m0, s83, 32768
    s_nop 0
    buffer_load_dwordx4 v3, s[40:43], s82 offen lds
    s_add_u32 s96, s84, 4
    s_and_b32 s97, s96, 15
    s_mul_i32 s98, s97, 393216
    s_add_u32 s99, s98, s85
    s_add_u32 s82, s99, 4294774784
    s_add_u32 m0, s83, 77824
    s_nop 0
    buffer_load_dwordx4 v3, s[40:43], s82 offen lds
    s_add_u32 s96, s84, 4
    s_and_b32 s97, s96, 15
    s_mul_i32 s98, s97, 393216
    s_add_u32 s99, s98, s85
    s_add_u32 s82, s99, 4096
    s_add_u32 m0, s83, 81920
    s_nop 0
    buffer_load_dwordx4 v3, s[40:43], s82 offen lds
    s_add_u32 s96, s84, 4
    s_and_b32 s97, s96, 15
    s_mul_i32 s98, s97, 393216
    s_add_u32 s99, s98, s85
    s_add_u32 s82, s99, 4294770688
    s_add_u32 m0, s83, 126976
    s_nop 0
    buffer_load_dwordx4 v3, s[40:43], s82 offen lds
    s_add_u32 s96, s84, 4
    s_and_b32 s97, s96, 15
    s_mul_i32 s98, s97, 393216
    s_add_u32 s82, s98, s85
    s_add_u32 m0, s83, 131072
    s_nop 0
    buffer_load_dwordx4 v3, s[40:43], s82 offen lds
    s_add_u32 s96, s84, 5
    s_and_b32 s97, s96, 15
    s_mul_i32 s98, s97, 393216
    s_add_u32 s99, s98, s85
    s_add_u32 s82, s99, 4294772736
    s_add_u32 m0, s83, 36864
    s_nop 0
    buffer_load_dwordx4 v3, s[40:43], s82 offen lds
    s_add_u32 s96, s84, 5
    s_and_b32 s97, s96, 15
    s_mul_i32 s98, s97, 393216
    s_add_u32 s99, s98, s85
    s_add_u32 s82, s99, 2048
    s_add_u32 m0, s83, 40960
    s_nop 0
    buffer_load_dwordx4 v3, s[40:43], s82 offen lds
    s_add_u32 s96, s84, 5
    s_and_b32 s97, s96, 15
    s_mul_i32 s98, s97, 393216
    s_add_u32 s99, s98, s85
    s_add_u32 s82, s99, 4294774784
    s_add_u32 m0, s83, 86016
    s_nop 0
    buffer_load_dwordx4 v3, s[40:43], s82 offen lds
    s_add_u32 s96, s84, 5
    s_and_b32 s97, s96, 15
    s_mul_i32 s98, s97, 393216
    s_add_u32 s99, s98, s85
    s_add_u32 s82, s99, 4096
    s_add_u32 m0, s83, 90112
    s_nop 0
    buffer_load_dwordx4 v3, s[40:43], s82 offen lds
    s_add_u32 s96, s84, 5
    s_and_b32 s97, s96, 15
    s_mul_i32 s98, s97, 393216
    s_add_u32 s99, s98, s85
    s_add_u32 s82, s99, 4294770688
    s_add_u32 m0, s83, 135168
    s_nop 0
    buffer_load_dwordx4 v3, s[40:43], s82 offen lds
    s_add_u32 s96, s84, 5
    s_and_b32 s97, s96, 15
    s_mul_i32 s98, s97, 393216
    s_add_u32 s82, s98, s85
    s_add_u32 m0, s83, 139264
    s_nop 0
    buffer_load_dwordx4 v3, s[40:43], s82 offen lds
    s_waitcnt lgkmcnt(0)
SPOLL_16:
    s_load_dwordx2 s[24:25], s[32:33], s19 offset:0 glc
    s_load_dwordx2 s[26:27], s[32:33], s19 offset:64 glc
SCHK_17:
    s_add_u32 s5, s5, 1
    s_cmp_ge_u32 s5, 200000
    s_waitcnt lgkmcnt(0)
    s_cbranch_scc1 SDONE_18
    s_cmp_lg_u32 s24, s4
    s_cbranch_scc1 SPOLL_16
    s_cmp_lg_u32 s25, s4
    s_cbranch_scc1 SPOLL_16
    s_cmp_lg_u32 s26, s4
    s_cbranch_scc1 SPOLL_16
    s_cmp_lg_u32 s27, s4
    s_cbranch_scc1 SPOLL_16
SDONE_18:
    v_bfe_u32 v4, v1, 2, 2
    v_lshlrev_b32 v4, 6, v4
    v_bfe_u32 v9, v1, 4, 1
    v_lshl_add_u32 v4, v9, 5, v4
    v_and_b32 v9, 3, v1
    v_lshl_add_u32 v4, v9, 3, v4
    v_lshrrev_b32 v9, 5, v1
    v_lshl_add_u32 v4, v9, 8, v4
    v_add_u32 v4, 159744, v4
    ds_read_b64_tr_b16 v[168:169], v4
    ds_read_b64_tr_b16 v[170:171], v4 offset:512
    ds_read_b64_tr_b16 v[172:173], v4 offset:1024
    ds_read_b64_tr_b16 v[174:175], v4 offset:1536
    ds_read_b64_tr_b16 v[176:177], v4 offset:2048
    ds_read_b64_tr_b16 v[178:179], v4 offset:2560
    ds_read_b64_tr_b16 v[180:181], v4 offset:3072
    ds_read_b64_tr_b16 v[182:183], v4 offset:3584
    s_lshl_b32 s14, s77, 10
    v_and_b32 v232, 7, v1
    v_lshl_add_u32 v232, v232, 4, s14
    v_bfe_u32 v9, v1, 3, 2
    v_lshl_add_u32 v232, v9, 8, v232
    v_lshrrev_b32 v9, 5, v1
    v_lshl_add_u32 v232, v9, 7, v232
    s_and_b32 s96, s9, 1
    s_lshl1_add_u32 s18, s96, 1
    s_and_b32 s96, s8, 3
    s_lshl2_add_u32 s97, s96, s3
    s_sub_u32 s98, s97, 4
    s_lshl_b32 s82, s98, 7
    v_lshrrev_b32 v8, 3, v1
    v_lshl_add_u32 v8, v8, 1, s82
    global_load_ushort v36, v8, s[86:87] offset:0
    global_load_ushort v37, v8, s[86:87] offset:16
    global_load_ushort v38, v8, s[86:87] offset:32
    global_load_ushort v39, v8, s[86:87] offset:48
    global_load_ushort v40, v8, s[86:87] offset:64
    global_load_ushort v41, v8, s[86:87] offset:80
    global_load_ushort v42, v8, s[86:87] offset:96
    global_load_ushort v43, v8, s[86:87] offset:112
    s_and_b32 s96, s8, 3
    s_lshl2_add_u32 s97, s96, s3
    s_sub_u32 s98, s97, 4
    s_mul_i32 s99, s98, 786432
    s_lshr_b32 s96, s8, 2
    s_lshl1_add_u32 s97, s9, s96
    s_lshl_b32 s98, s97, 7
    s_add_u32 s96, s99, s98
    s_add_u32 s19, s96, 4096
    s_barrier
    s_add_u32 s96, s84, 6
    s_and_b32 s97, s96, 15
    s_mul_i32 s98, s97, 393216
    s_add_u32 s99, s98, s85
    s_add_u32 s82, s99, 4294772736
    s_add_u32 m0, s83, 4294963200
    s_nop 0
    buffer_load_dwordx4 v3, s[40:43], s82 offen lds
    s_add_u32 s96, s84, 6
    s_and_b32 s97, s96, 15
    s_mul_i32 s98, s97, 393216
    s_add_u32 s99, s98, s85
    s_add_u32 s82, s99, 2048
    s_mov_b32 m0, s83
    s_nop 0
    buffer_load_dwordx4 v3, s[40:43], s82 offen lds
    s_add_u32 s96, s84, 6
    s_and_b32 s97, s96, 15
    s_mul_i32 s98, s97, 393216
    s_add_u32 s99, s98, s85
    s_add_u32 s82, s99, 4294770688
    s_add_u32 m0, s83, 94208
    s_nop 0
    buffer_load_dwordx4 v3, s[40:43], s82 offen lds
    s_add_u32 s96, s84, 6
    s_and_b32 s97, s96, 15
    s_mul_i32 s98, s97, 393216
    s_add_u32 s82, s98, s85
    s_add_u32 m0, s83, 98304
    s_nop 0
    buffer_load_dwordx4 v3, s[40:43], s82 offen lds
    s_add_u32 s96, s84, 6
    s_and_b32 s97, s96, 15
    s_mul_i32 s98, s97, 393216
    s_add_u32 s99, s98, s85
    s_add_u32 s82, s99, 4294774784
    s_add_u32 m0, s83, 45056
    s_nop 0
    buffer_load_dwordx4 v3, s[40:43], s82 offen lds
    s_add_u32 s96, s84, 6
    s_and_b32 s97, s96, 15
    s_mul_i32 s98, s97, 393216
    s_add_u32 s99, s98, s85
    s_add_u32 s82, s99, 4096
    s_add_u32 m0, s83, 49152
    s_nop 0
    buffer_load_dwordx4 v3, s[40:43], s82 offen lds
    s_waitcnt lgkmcnt(0)
    s_load_dword s24, s[32:33], s92 offset:512 glc
    s_load_dword s25, s[32:33], s92 offset:256 glc
    s_load_dword s26, s[32:33], s92 offset:3584 glc
    s_load_dword s27, s[32:33], s92 offset:3328 glc
    s_barrier
    s_add_u32 s96, s84, 7
    s_and_b32 s97, s96, 15
    s_mul_i32 s98, s97, 393216
    s_add_u32 s99, s98, s85
    s_add_u32 s82, s99, 4294772736
    s_add_u32 m0, s83, 4096
    s_nop 0
    buffer_load_dwordx4 v3, s[40:43], s82 offen lds
    s_add_u32 s96, s84, 7
    s_and_b32 s97, s96, 15
    s_mul_i32 s98, s97, 393216
    s_add_u32 s99, s98, s85
    s_add_u32 s82, s99, 2048
    s_add_u32 m0, s83, 8192
    s_nop 0
    buffer_load_dwordx4 v3, s[40:43], s82 offen lds
    s_add_u32 s96, s84, 7
    s_and_b32 s97, s96, 15
    s_mul_i32 s98, s97, 393216
    s_add_u32 s99, s98, s85
    s_add_u32 s82, s99, 4294770688
    s_add_u32 m0, s83, 102400
    s_nop 0
    buffer_load_dwordx4 v3, s[40:43], s82 offen lds
    s_add_u32 s96, s84, 7
    s_and_b32 s97, s96, 15
    s_mul_i32 s98, s97, 393216
    s_add_u32 s82, s98, s85
    s_add_u32 m0, s83, 106496
    s_nop 0
    buffer_load_dwordx4 v3, s[40:43], s82 offen lds
    s_add_u32 s96, s84, 7
    s_and_b32 s97, s96, 15
    s_mul_i32 s98, s97, 393216
    s_add_u32 s99, s98, s85
    s_add_u32 s82, s99, 4294774784
    s_add_u32 m0, s83, 53248
    s_nop 0
    buffer_load_dwordx4 v3, s[40:43], s82 offen lds
    s_add_u32 s96, s84, 7
    s_and_b32 s97, s96, 15
    s_mul_i32 s98, s97, 393216
    s_add_u32 s99, s98, s85
    s_add_u32 s82, s99, 4096
    s_add_u32 m0, s83, 57344
    s_nop 0
    buffer_load_dwordx4 v3, s[40:43], s82 offen lds
    s_waitcnt vmcnt(30)
    s_waitcnt vmcnt(26)
    s_barrier
    s_add_u32 s96, s84, 8
    s_and_b32 s97, s96, 15
    s_mul_i32 s98, s97, 393216
    s_add_u32 s99, s98, s85
    s_add_u32 s82, s99, 4294772736
    s_add_u32 m0, s83, 12288
    s_nop 0
    buffer_load_dwordx4 v3, s[40:43], s82 offen lds
    s_add_u32 s96, s84, 8
    s_and_b32 s97, s96, 15
    s_mul_i32 s98, s97, 393216
    s_add_u32 s99, s98, s85
    s_add_u32 s82, s99, 2048
    s_add_u32 m0, s83, 16384
    s_nop 0
    buffer_load_dwordx4 v3, s[40:43], s82 offen lds
    s_add_u32 s96, s84, 8
    s_and_b32 s97, s96, 15
    s_mul_i32 s98, s97, 393216
    s_add_u32 s99, s98, s85
    s_add_u32 s82, s99, 4294770688
    s_add_u32 m0, s83, 110592
    s_nop 0
    buffer_load_dwordx4 v3, s[40:43], s82 offen lds
    s_add_u32 s96, s84, 8
    s_and_b32 s97, s96, 15
    s_mul_i32 s98, s97, 393216
    s_add_u32 s82, s98, s85
    s_add_u32 m0, s83, 114688
    s_nop 0
    buffer_load_dwordx4 v3, s[40:43], s82 offen lds
    s_add_u32 s96, s84, 8
    s_and_b32 s97, s96, 15
    s_mul_i32 s98, s97, 393216
    s_add_u32 s99, s98, s85
    s_add_u32 s82, s99, 4294774784
    s_add_u32 m0, s83, 61440
    s_nop 0
    buffer_load_dwordx4 v3, s[40:43], s82 offen lds
    s_add_u32 s96, s84, 8
    s_and_b32 s97, s96, 15
    s_mul_i32 s98, s97, 393216
    s_add_u32 s99, s98, s85
    s_add_u32 s82, s99, 4096
    s_add_u32 m0, s83, 65536
    s_nop 0
    buffer_load_dwordx4 v3, s[40:43], s82 offen lds
    s_waitcnt vmcnt(18)
    v_lshlrev_b32 v36, 16, v36
    v_mul_f32 v8, s7, v36
    v_exp_f32 v8, -v8
    s_nop 0
    v_add_f32 v8, 1.0, v8
    v_rcp_f32 v8, v8
    s_nop 0
    v_mul_f32 v36, v36, v8
    v_cvt_pk_bf16_f32 v36, 0, v36
    v_lshlrev_b32 v37, 16, v37
    v_mul_f32 v9, s7, v37
    v_exp_f32 v9, -v9
    s_nop 0
    v_add_f32 v9, 1.0, v9
    v_rcp_f32 v9, v9
    s_nop 0
    v_mul_f32 v37, v37, v9
    v_cvt_pk_bf16_f32 v37, 0, v37
    v_lshlrev_b32 v38, 16, v38
    v_mul_f32 v8, s7, v38
    v_exp_f32 v8, -v8
    s_nop 0
    v_add_f32 v8, 1.0, v8
    v_rcp_f32 v8, v8
    s_nop 0
    v_mul_f32 v38, v38, v8
    v_cvt_pk_bf16_f32 v38, 0, v38
    v_lshlrev_b32 v39, 16, v39
    v_mul_f32 v9, s7, v39
    v_exp_f32 v9, -v9
    s_nop 0
    v_add_f32 v9, 1.0, v9
    v_rcp_f32 v9, v9
    s_nop 0
    v_mul_f32 v39, v39, v9
    v_cvt_pk_bf16_f32 v39, 0, v39
    v_lshlrev_b32 v40, 16, v40
    v_mul_f32 v8, s7, v40
    v_exp_f32 v8, -v8
    s_nop 0
    v_add_f32 v8, 1.0, v8
    v_rcp_f32 v8, v8
    s_nop 0
    v_mul_f32 v40, v40, v8
    v_cvt_pk_bf16_f32 v40, 0, v40
    v_lshlrev_b32 v41, 16, v41
    v_mul_f32 v9, s7, v41
    v_exp_f32 v9, -v9
    s_nop 0
    v_add_f32 v9, 1.0, v9
    v_rcp_f32 v9, v9
    s_nop 0
    v_mul_f32 v41, v41, v9
    v_cvt_pk_bf16_f32 v41, 0, v41
    v_lshlrev_b32 v42, 16, v42
    v_mul_f32 v8, s7, v42
    v_exp_f32 v8, -v8
    s_nop 0
    v_add_f32 v8, 1.0, v8
    v_rcp_f32 v8, v8
    s_nop 0
    v_mul_f32 v42, v42, v8
    v_cvt_pk_bf16_f32 v42, 0, v42
    v_lshlrev_b32 v43, 16, v43
    v_mul_f32 v9, s7, v43
    v_exp_f32 v9, -v9
    s_nop 0
    v_add_f32 v9, 1.0, v9
    v_rcp_f32 v9, v9
    s_nop 0
    v_mul_f32 v43, v43, v9
    v_cvt_pk_bf16_f32 v43, 0, v43
    s_waitcnt lgkmcnt(0)
    s_load_dword s24, s[32:33], s92 offset:1024 glc
    s_load_dword s25, s[32:33], s92 offset:768 glc
    s_load_dword s26, s[32:33], s92 offset:1536 glc
    s_load_dword s27, s[32:33], s92 offset:1280 glc
    s_barrier
    s_add_u32 s96, s84, 9
    s_and_b32 s97, s96, 15
    s_mul_i32 s98, s97, 393216
    s_add_u32 s99, s98, s85
    s_add_u32 s82, s99, 4294772736
    s_add_u32 m0, s83, 20480
    s_nop 0
    buffer_load_dwordx4 v3, s[40:43], s82 offen lds
    s_add_u32 s96, s84, 9
    s_and_b32 s97, s96, 15
    s_mul_i32 s98, s97, 393216
    s_add_u32 s99, s98, s85
    s_add_u32 s82, s99, 2048
    s_add_u32 m0, s83, 24576
    s_nop 0
    buffer_load_dwordx4 v3, s[40:43], s82 offen lds
L_PAD5:
    s_cbranch_execz L_RET5
    s_add_u32 s96, s84, 9
    s_and_b32 s97, s96, 15
    s_mul_i32 s98, s97, 393216
    s_add_u32 s99, s98, s85
    s_add_u32 s82, s99, 4294770688
    s_add_u32 m0, s83, 118784
    s_nop 0
    buffer_load_dwordx4 v3, s[40:43], s82 offen lds
    s_add_u32 s96, s84, 9
    s_and_b32 s97, s96, 15
    s_mul_i32 s98, s97, 393216
    s_add_u32 s82, s98, s85
    s_add_u32 m0, s83, 122880
    s_nop 0
    buffer_load_dwordx4 v3, s[40:43], s82 offen lds
    s_add_u32 s96, s84, 9
    s_and_b32 s97, s96, 15
    s_mul_i32 s98, s97, 393216
    s_add_u32 s99, s98, s85
    s_add_u32 s82, s99, 4294774784
    s_add_u32 m0, s83, 69632
    s_nop 0
    buffer_load_dwordx4 v3, s[40:43], s82 offen lds
    s_add_u32 s96, s84, 9
    s_and_b32 s97, s96, 15
    s_mul_i32 s98, s97, 393216
    s_add_u32 s99, s98, s85
    s_add_u32 s82, s99, 4096
    s_add_u32 m0, s83, 73728
    s_nop 0
    buffer_load_dwordx4 v3, s[40:43], s82 offen lds
    s_waitcnt vmcnt(22)
    s_waitcnt vmcnt(20)
    s_waitcnt vmcnt(18)
    s_barrier
    s_add_u32 s96, s84, 10
    s_and_b32 s97, s96, 15
    s_mul_i32 s98, s97, 393216
    s_add_u32 s99, s98, s85
    s_add_u32 s82, s99, 4294772736
    s_add_u32 m0, s83, 28672
    s_nop 0
    buffer_load_dwordx4 v3, s[40:43], s82 offen lds
    s_add_u32 s96, s84, 10
    s_and_b32 s97, s96, 15
    s_mul_i32 s98, s97, 393216
    s_add_u32 s99, s98, s85
    s_add_u32 s82, s99, 2048
    s_add_u32 m0, s83, 32768
    s_nop 0
    buffer_load_dwordx4 v3, s[40:43], s82 offen lds
    s_add_u32 s96, s84, 10
    s_and_b32 s97, s96, 15
    s_mul_i32 s98, s97, 393216
    s_add_u32 s99, s98, s85
    s_add_u32 s82, s99, 4294774784
    s_add_u32 m0, s83, 77824
    s_nop 0
    buffer_load_dwordx4 v3, s[40:43], s82 offen lds
    s_add_u32 s96, s84, 10
    s_and_b32 s97, s96, 15
    s_mul_i32 s98, s97, 393216
    s_add_u32 s99, s98, s85
    s_add_u32 s82, s99, 4096
    s_add_u32 m0, s83, 81920
    s_nop 0
    buffer_load_dwordx4 v3, s[40:43], s82 offen lds
    s_waitcnt lgkmcnt(0)
    s_load_dword s24, s[32:33], s92 offset:2560 glc
    s_load_dword s25, s[32:33], s92 offset:2304 glc
    s_load_dword s26, s[32:33], s92 offset:3072 glc
    s_load_dword s27, s[32:33], s92 offset:2816 glc
    s_waitcnt vmcnt(20)
    s_waitcnt vmcnt(18)
    s_waitcnt vmcnt(16)
    s_barrier
    s_add_u32 s96, s84, 11
    s_and_b32 s97, s96, 15
    s_mul_i32 s98, s97, 393216
    s_add_u32 s99, s98, s85
    s_add_u32 s82, s99, 4294772736
    s_add_u32 m0, s83, 36864
    s_nop 0
    buffer_load_dwordx4 v3, s[40:43], s82 offen lds
    s_add_u32 s96, s84, 11
    s_and_b32 s97, s96, 15
    s_mul_i32 s98, s97, 393216
    s_add_u32 s99, s98, s85
    s_add_u32 s82, s99, 2048
    s_add_u32 m0, s83, 40960
    s_nop 0
    buffer_load_dwordx4 v3, s[40:43], s82 offen lds
    s_add_u32 s96, s84, 11
    s_and_b32 s97, s96, 15
    s_mul_i32 s98, s97, 393216
    s_add_u32 s99, s98, s85
    s_add_u32 s82, s99, 4294774784
    s_add_u32 m0, s83, 86016
    s_nop 0
    buffer_load_dwordx4 v3, s[40:43], s82 offen lds
    s_add_u32 s96, s84, 11
    s_and_b32 s97, s96, 15
    s_mul_i32 s98, s97, 393216
    s_add_u32 s99, s98, s85
    s_add_u32 s82, s99, 4096
    s_add_u32 m0, s83, 90112
    s_nop 0
    buffer_load_dwordx4 v3, s[40:43], s82 offen lds
    s_waitcnt vmcnt(18)
    s_waitcnt vmcnt(16)
    s_waitcnt vmcnt(14)
    s_barrier
    s_add_u32 s96, s84, 12
    s_and_b32 s97, s96, 15
    s_mul_i32 s98, s97, 393216
    s_add_u32 s99, s98, s85
    s_add_u32 s82, s99, 4294772736
    s_add_u32 m0, s83, 4294963200
    s_nop 0
    buffer_load_dwordx4 v3, s[40:43], s82 offen lds
    s_add_u32 s96, s84, 12
    s_and_b32 s97, s96, 15
    s_mul_i32 s98, s97, 393216
    s_add_u32 s99, s98, s85
    s_add_u32 s82, s99, 2048
    s_mov_b32 m0, s83
    s_nop 0
    buffer_load_dwordx4 v3, s[40:43], s82 offen lds
    s_add_u32 s96, s84, 12
    s_and_b32 s97, s96, 15
    s_mul_i32 s98, s97, 393216
    s_add_u32 s99, s98, s85
    s_add_u32 s82, s99, 4294774784
    s_add_u32 m0, s83, 45056
    s_nop 0
    buffer_load_dwordx4 v3, s[40:43], s82 offen lds
    s_add_u32 s96, s84, 12
    s_and_b32 s97, s96, 15
    s_mul_i32 s98, s97, 393216
    s_add_u32 s99, s98, s85
    s_add_u32 s82, s99, 4096
    s_add_u32 m0, s83, 49152
    s_nop 0
    buffer_load_dwordx4 v3, s[40:43], s82 offen lds
    s_waitcnt vmcnt(16)
    s_barrier
    s_add_u32 s96, s84, 13
    s_and_b32 s97, s96, 15
    s_mul_i32 s98, s97, 393216
    s_add_u32 s99, s98, s85
    s_add_u32 s82, s99, 4294772736
    s_add_u32 m0, s83, 4096
    s_nop 0
    buffer_load_dwordx4 v3, s[40:43], s82 offen lds
    s_add_u32 s96, s84, 13
    s_and_b32 s97, s96, 15
    s_mul_i32 s98, s97, 393216
    s_add_u32 s99, s98, s85
    s_add_u32 s82, s99, 2048
    s_add_u32 m0, s83, 8192
    s_nop 0
    buffer_load_dwordx4 v3, s[40:43], s82 offen lds
    s_add_u32 s96, s84, 13
    s_and_b32 s97, s96, 15
    s_mul_i32 s98, s97, 393216
    s_add_u32 s99, s98, s85
    s_add_u32 s82, s99, 4294774784
    s_add_u32 m0, s83, 53248
    s_nop 0
    buffer_load_dwordx4 v3, s[40:43], s82 offen lds
    s_add_u32 s96, s84, 13
    s_and_b32 s97, s96, 15
    s_mul_i32 s98, s97, 393216
    s_add_u32 s99, s98, s85
    s_add_u32 s82, s99, 4096
    s_add_u32 m0, s83, 57344
    s_nop 0
    buffer_load_dwordx4 v3, s[40:43], s82 offen lds
    s_lshl_b32 s96, s74, 13
    s_sub_u32 s97, s3, 4
    s_lshl_b32 s98, s97, 8
    s_add_u32 s99, s96, s98
    s_add_u32 s13, s99, 20971520
    s_waitcnt lgkmcnt(0)
    s_load_dword s24, s[32:33], s13 offset:1276 glc
    s_load_dword s25, s[32:33], s13 offset:3324 glc
    s_load_dword s26, s[32:33], s13 offset:5372 glc
    s_load_dword s27, s[32:33], s13 offset:7420 glc
    s_waitcnt vmcnt(18)
    s_waitcnt vmcnt(16)
    s_barrier
    s_add_u32 s96, s84, 14
    s_and_b32 s97, s96, 15
    s_mul_i32 s98, s97, 393216
    s_add_u32 s99, s98, s85
    s_add_u32 s82, s99, 4294772736
    s_add_u32 m0, s83, 12288
    s_nop 0
    buffer_load_dwordx4 v3, s[40:43], s82 offen lds
    s_add_u32 s96, s84, 14
    s_and_b32 s97, s96, 15
    s_mul_i32 s98, s97, 393216
    s_add_u32 s99, s98, s85
    s_add_u32 s82, s99, 2048
    s_add_u32 m0, s83, 16384
    s_nop 0
    buffer_load_dwordx4 v3, s[40:43], s82 offen lds
    s_add_u32 s96, s84, 10
    s_and_b32 s97, s96, 15
    s_mul_i32 s98, s97, 393216
    s_add_u32 s99, s98, s85
    s_add_u32 s82, s99, 4294770688
    s_add_u32 m0, s83, 126976
    s_nop 0
    buffer_load_dwordx4 v3, s[40:43], s82 offen lds
    s_add_u32 s96, s84, 10
    s_and_b32 s97, s96, 15
    s_mul_i32 s98, s97, 393216
    s_add_u32 s82, s98, s85
    s_add_u32 m0, s83, 131072
    s_nop 0
    buffer_load_dwordx4 v3, s[40:43], s82 offen lds
    s_waitcnt vmcnt(18)
    s_waitcnt vmcnt(14)
    s_barrier
    s_add_u32 s96, s84, 15
    s_and_b32 s97, s96, 15
    s_mul_i32 s98, s97, 393216
    s_add_u32 s99, s98, s85
    s_add_u32 s82, s99, 4294772736
    s_add_u32 m0, s83, 20480
    s_nop 0
    buffer_load_dwordx4 v3, s[40:43], s82 offen lds
    s_add_u32 s96, s84, 15
    s_and_b32 s97, s96, 15
    s_mul_i32 s98, s97, 393216
    s_add_u32 s99, s98, s85
    s_add_u32 s82, s99, 2048
    s_add_u32 m0, s83, 24576
    s_nop 0
    buffer_load_dwordx4 v3, s[40:43], s82 offen lds
    s_add_u32 s96, s84, 11
    s_and_b32 s97, s96, 15
    s_mul_i32 s98, s97, 393216
    s_add_u32 s99, s98, s85
    s_add_u32 s82, s99, 4294770688
    s_add_u32 m0, s83, 135168
    s_nop 0
    buffer_load_dwordx4 v3, s[40:43], s82 offen lds
    s_add_u32 s96, s84, 11
    s_and_b32 s97, s96, 15
    s_mul_i32 s98, s97, 393216
    s_add_u32 s82, s98, s85
    s_add_u32 m0, s83, 139264
    s_nop 0
    buffer_load_dwordx4 v3, s[40:43], s82 offen lds
    s_waitcnt vmcnt(14)
    s_waitcnt vmcnt(10)
    s_waitcnt vmcnt(6)
    s_barrier
    s_add_u32 s96, s84, 14
    s_and_b32 s97, s96, 15
    s_mul_i32 s98, s97, 393216
    s_add_u32 s99, s98, s85
    s_add_u32 s82, s99, 4294774784
    s_add_u32 m0, s83, 61440
    s_nop 0
    buffer_load_dwordx4 v3, s[40:43], s82 offen lds
    s_add_u32 s96, s84, 14
    s_and_b32 s97, s96, 15
    s_mul_i32 s98, s97, 393216
    s_add_u32 s99, s98, s85
    s_add_u32 s82, s99, 4096
    s_add_u32 m0, s83, 65536
    s_nop 0
    buffer_load_dwordx4 v3, s[40:43], s82 offen lds
    s_add_u32 s96, s84, 15
    s_and_b32 s97, s96, 15
    s_mul_i32 s98, s97, 393216
    s_add_u32 s99, s98, s85
    s_add_u32 s82, s99, 4294774784
    s_add_u32 m0, s83, 69632
    s_nop 0
    buffer_load_dwordx4 v3, s[40:43], s82 offen lds
    s_add_u32 s96, s84, 15
    s_and_b32 s97, s96, 15
    s_mul_i32 s98, s97, 393216
    s_add_u32 s99, s98, s85
    s_add_u32 s82, s99, 4096
    s_add_u32 m0, s83, 73728
    s_nop 0
    buffer_load_dwordx4 v3, s[40:43], s82 offen lds
    s_add_u32 s96, s84, 12
    s_and_b32 s97, s96, 15
    s_mul_i32 s98, s97, 393216
    s_add_u32 s99, s98, s85
    s_add_u32 s82, s99, 4294770688
    s_add_u32 m0, s83, 94208
    s_nop 0
    buffer_load_dwordx4 v3, s[40:43], s82 offen lds
    s_add_u32 s96, s84, 12
    s_and_b32 s97, s96, 15
    s_mul_i32 s98, s97, 393216
    s_add_u32 s82, s98, s85
    s_add_u32 m0, s83, 98304
    s_nop 0
    buffer_load_dwordx4 v3, s[40:43], s82 offen lds
    s_mov_b32 s82, s19
    buffer_load_dwordx4 v[88:91], v248, s[48:51], s82 offen nt
    s_add_u32 s82, s19, 98304
    buffer_load_dwordx4 v[92:95], v248, s[48:51], s82 offen nt
    s_add_u32 s82, s19, 196608
    buffer_load_dwordx4 v[96:99], v248, s[48:51], s82 offen nt
    s_add_u32 s82, s19, 294912
    buffer_load_dwordx4 v[100:103], v248, s[48:51], s82 offen nt
    s_waitcnt vmcnt(12)
    s_barrier
    s_add_u32 s96, s84, 13
    s_and_b32 s97, s96, 15
    s_mul_i32 s98, s97, 393216
    s_add_u32 s99, s98, s85
    s_add_u32 s82, s99, 4294770688
    s_add_u32 m0, s83, 102400
    s_nop 0
    buffer_load_dwordx4 v3, s[40:43], s82 offen lds
    s_add_u32 s96, s84, 13
    s_and_b32 s97, s96, 15
    s_mul_i32 s98, s97, 393216
    s_add_u32 s82, s98, s85
    s_add_u32 m0, s83, 106496
    s_nop 0
    buffer_load_dwordx4 v3, s[40:43], s82 offen lds
    s_add_u32 s96, s84, 14
    s_and_b32 s97, s96, 15
    s_mul_i32 s98, s97, 393216
    s_add_u32 s99, s98, s85
    s_add_u32 s82, s99, 4294770688
    s_add_u32 m0, s83, 110592
    s_nop 0
    buffer_load_dwordx4 v3, s[40:43], s82 offen lds
    s_add_u32 s96, s84, 14
    s_and_b32 s97, s96, 15
    s_mul_i32 s98, s97, 393216
    s_add_u32 s82, s98, s85
    s_add_u32 m0, s83, 114688
    s_nop 0
    buffer_load_dwordx4 v3, s[40:43], s82 offen lds
    s_add_u32 s96, s84, 15
    s_and_b32 s97, s96, 15
    s_mul_i32 s98, s97, 393216
    s_add_u32 s99, s98, s85
    s_add_u32 s82, s99, 4294770688
    s_add_u32 m0, s83, 118784
    s_nop 0
    buffer_load_dwordx4 v3, s[40:43], s82 offen lds
    s_add_u32 s96, s84, 15
    s_and_b32 s97, s96, 15
    s_mul_i32 s98, s97, 393216
    s_add_u32 s82, s98, s85
    s_add_u32 m0, s83, 122880
    s_nop 0
    buffer_load_dwordx4 v3, s[40:43], s82 offen lds
    v_and_b32 v85, 1, v1
    v_lshlrev_b32 v85, 3, v85
    v_bfe_u32 v84, v1, 2, 2
    v_lshl_add_u32 v85, v84, 4, v85
    v_bfe_u32 v84, v1, 4, 1
    v_lshl_add_u32 v85, v84, 6, v85
    v_bfe_u32 v84, v1, 1, 1
    v_lshl_add_u32 v85, v84, 7, v85
    v_lshrrev_b32 v84, 5, v1
    v_lshl_add_u32 v85, v84, 8, v85
    s_lshl_b32 s13, s3, 12
    v_add_u32 v84, s13, v85
    s_lshl_b32 s96, s76, 13
    s_add_u32 s13, s96, 32768
    v_add_u32 v85, s13, v85
    v_mov_b32 v80, 0x3f803f80
    v_mov_b32 v81, 0x3f803f80
    v_mov_b32 v82, 0x3f803f80
    v_mov_b32 v83, 0x3f803f80
    s_lshl3_add_u32 s96, s11, s3
    s_lshl_b32 s97, s96, 5
    s_add_u32 s98, s97, s10
    s_lshl_b32 s99, s98, 10
    s_add_u32 s13, s99, 25165824
    s_add_u32 s15, s13, 16384
    s_lshl3_add_u32 s96, s11, s3
    s_lshl_b32 s97, s96, 10
    s_add_u32 s16, s97, 21495808
    s_lshl_b32 s96, s10, 6
    s_add_u32 s14, s96, s16
    s_waitcnt lgkmcnt(0)
    s_barrier
    s_setprio 3
    ds_read_b128 v[152:155], v0
    ds_read_b128 v[156:159], v0 offset:1024
    v_subrev_u32 v0, 118784, v0
    s_waitcnt lgkmcnt(1)
    v_mfma_f32_32x32x16_bf16 v[184:199], v[168:171], v[152:155], 0
    s_waitcnt lgkmcnt(0)
    v_mfma_f32_32x32x16_bf16 v[184:199], v[172:175], v[156:159], v[184:199]
    s_setprio 0
    s_nop 10
    v_cvt_pk_bf16_f32 v184, 0, v184
    v_cvt_pk_bf16_f32 v185, 0, v185
    v_cvt_pk_bf16_f32 v186, 0, v186
    s_add_u32 s82, s19, 393216
    buffer_load_dwordx4 v[104:107], v248, s[48:51], s82 offen nt
    v_cvt_pk_bf16_f32 v187, 0, v187
    v_cvt_pk_bf16_f32 v188, 0, v188
    v_cvt_pk_bf16_f32 v189, 0, v189
    v_cvt_pk_bf16_f32 v190, 0, v190
    v_cvt_pk_bf16_f32 v191, 0, v191
    v_cvt_pk_bf16_f32 v192, 0, v192
    v_cvt_pk_bf16_f32 v193, 0, v193
    v_cvt_pk_bf16_f32 v194, 0, v194
    v_cvt_pk_bf16_f32 v195, 0, v195
    v_cvt_pk_bf16_f32 v196, 0, v196
    s_add_u32 s82, s19, 491520
    buffer_load_dwordx4 v[108:111], v248, s[48:51], s82 offen nt
    v_cvt_pk_bf16_f32 v197, 0, v197
    v_cvt_pk_bf16_f32 v198, 0, v198
    v_cvt_pk_bf16_f32 v199, 0, v199
    v_max3_f32 v4, v184, v185, v186
    v_min3_f32 v5, v184, v185, v186
    v_max3_f32 v4, v4, v187, v188
    v_min3_f32 v5, v5, v187, v188
    v_max3_f32 v4, v4, v189, v190
    v_min3_f32 v5, v5, v189, v190
    v_max3_f32 v4, v4, v191, v192
    s_add_u32 s82, s19, 589824
    buffer_load_dwordx4 v[112:115], v248, s[48:51], s82 offen nt
    v_min3_f32 v5, v5, v191, v192
    v_max3_f32 v4, v4, v193, v194
    v_min3_f32 v5, v5, v193, v194
    v_max3_f32 v4, v4, v195, v196
    v_min3_f32 v5, v5, v195, v196
    v_max3_f32 v4, v4, v197, v198
    v_min3_f32 v5, v5, v197, v198
    v_max_f32 v6, v4, v199
    v_min_f32 v7, v5, v199
    v_max_f32 v4, v4, v199
    s_add_u32 s82, s19, 688128
    buffer_load_dwordx4 v[116:119], v248, s[48:51], s82 offen nt
    v_min_f32 v5, v5, v199
    v_permlane32_swap_b32 v4, v6
    s_nop 0
    v_permlane32_swap_b32 v5, v7
    v_max_f32 v4, v4, v6
    v_min_f32 v5, v5, v7
    v_mul_f32_e64 v4, v4, s7
    v_mul_f32_e64 v5, v5, s7
    v_fma_f32 v216, v184, s7, -v4
    v_fma_f32 v217, v185, s7, -v4
    v_fma_f32 v184, -v184, s7, v5
    v_fma_f32 v185, -v185, s7, v5
    v_fma_f32 v218, v186, s7, -v4
    v_fma_f32 v219, v187, s7, -v4
    v_fma_f32 v186, -v186, s7, v5
    v_fma_f32 v187, -v187, s7, v5
    s_waitcnt vmcnt(18)
    s_waitcnt vmcnt(16)
    s_barrier
    s_setprio 3
    ds_read_b128 v[152:155], v0
    ds_read_b128 v[156:159], v0 offset:1024
    s_waitcnt lgkmcnt(1)
    v_mfma_f32_32x32x16_bf16 v[200:215], v[176:179], v[152:155], 0
    s_waitcnt lgkmcnt(0)
    v_mfma_f32_32x32x16_bf16 v[200:215], v[180:183], v[156:159], v[200:215]
    s_setprio 0
    v_fma_f32 v220, v188, s7, -v4
    v_fma_f32 v221, v189, s7, -v4
    v_fma_f32 v188, -v188, s7, v5
    v_fma_f32 v189, -v189, s7, v5
    v_fma_f32 v222, v190, s7, -v4
    s_mov_b32 s82, s80
    buffer_load_dwordx4 v[56:59], v27, s[52:55], s82 offen nt
    v_fma_f32 v223, v191, s7, -v4
    v_fma_f32 v190, -v190, s7, v5
    v_fma_f32 v191, -v191, s7, v5
    v_fma_f32 v224, v192, s7, -v4
    v_fma_f32 v225, v193, s7, -v4
    s_setprio 3
    v_fma_f32 v192, -v192, s7, v5
    v_fma_f32 v193, -v193, s7, v5
    v_fma_f32 v226, v194, s7, -v4
    v_fma_f32 v227, v195, s7, -v4
    v_fma_f32 v194, -v194, s7, v5
    v_fma_f32 v195, -v195, s7, v5
    v_fma_f32 v228, v196, s7, -v4
    v_fma_f32 v229, v197, s7, -v4
    v_fma_f32 v196, -v196, s7, v5
    v_fma_f32 v197, -v197, s7, v5
    v_fma_f32 v230, v198, s7, -v4
    v_fma_f32 v231, v199, s7, -v4
    v_fma_f32 v198, -v198, s7, v5
    v_fma_f32 v199, -v199, s7, v5
    v_exp_f32 v216, v216
    s_add_u32 s82, s80, 4294049792
    buffer_load_dwordx4 v[60:63], v27, s[52:55], s82 offen nt
    v_exp_f32 v184, v184
    v_exp_f32 v217, v217
    v_exp_f32 v185, v185
    v_exp_f32 v218, v218
    v_exp_f32 v186, v186
    v_exp_f32 v219, v219
    v_exp_f32 v187, v187
    v_exp_f32 v220, v220
    v_exp_f32 v188, v188
    v_exp_f32 v221, v221
    v_exp_f32 v189, v189
    v_exp_f32 v222, v222
    v_exp_f32 v190, v190
    v_exp_f32 v223, v223
    v_exp_f32 v191, v191
    v_exp_f32 v224, v224
    v_exp_f32 v192, v192
    v_exp_f32 v225, v225
    v_exp_f32 v193, v193
    v_exp_f32 v226, v226
    s_add_u32 s82, s80, 57344
    buffer_load_dwordx4 v[64:67], v27, s[52:55], s82 offen nt
    v_exp_f32 v194, v194
    v_exp_f32 v227, v227
    v_exp_f32 v195, v195
    v_exp_f32 v228, v228
    v_exp_f32 v196, v196
    v_exp_f32 v229, v229
    v_exp_f32 v197, v197
    v_exp_f32 v230, v230
    v_exp_f32 v198, v198
    v_exp_f32 v231, v231
    v_exp_f32 v199, v199
    v_add_f32 v8, v216, v218
    v_add_f32 v9, v217, v219
    v_add_f32 v10, v184, v186
    v_add_f32 v11, v185, v187
    v_add_f32 v8, v8, v220
    v_add_f32 v9, v9, v221
    v_add_f32 v10, v10, v188
    v_add_f32 v11, v11, v189
    v_add_f32 v8, v8, v222
    s_add_u32 s82, s80, 4294107136
    buffer_load_dwordx4 v[68:71], v27, s[52:55], s82 offen nt
    v_add_f32 v9, v9, v223
    v_add_f32 v10, v10, v190
    v_add_f32 v11, v11, v191
    v_add_f32 v8, v8, v224
    v_add_f32 v9, v9, v225
    v_add_f32 v10, v10, v192
    v_add_f32 v11, v11, v193
    v_add_f32 v8, v8, v226
    v_add_f32 v9, v9, v227
    v_add_f32 v10, v10, v194
    v_add_f32 v11, v11, v195
    v_add_f32 v8, v8, v228
    v_add_f32 v9, v9, v229
    v_add_f32 v10, v10, v196
    v_add_f32 v11, v11, v197
    v_add_f32 v8, v8, v230
    v_add_f32 v9, v9, v231
    v_add_f32 v10, v10, v198
    v_add_f32 v11, v11, v199
    v_add_f32 v6, v8, v9
    v_add_f32 v7, v10, v11
    v_add_f32 v4, v8, v9
    s_setprio 0
    v_add_f32 v5, v10, v11
    v_permlane32_swap_b32 v4, v6
    s_nop 0
    v_permlane32_swap_b32 v5, v7
    v_add_f32 v4, v4, v6
    v_add_f32 v5, v5, v7
    v_rcp_f32 v4, v4
    v_rcp_f32 v5, v5
    v_mul_f32 v216, v216, v4
    v_mul_f32 v217, v217, v4
    v_mul_f32 v184, v184, v5
    v_mul_f32 v185, v185, v5
    v_mul_f32 v218, v218, v4
    v_mul_f32 v219, v219, v4
    v_mul_f32 v186, v186, v5
    v_mul_f32 v187, v187, v5
    v_mul_f32 v220, v220, v4
    v_mul_f32 v221, v221, v4
    v_mul_f32 v188, v188, v5
    v_mul_f32 v189, v189, v5
    v_mul_f32 v222, v222, v4
    v_mul_f32 v223, v223, v4
    v_mul_f32 v190, v190, v5
    v_mul_f32 v191, v191, v5
    v_mul_f32 v224, v224, v4
    v_mul_f32 v225, v225, v4
    v_mul_f32 v192, v192, v5
    v_mul_f32 v193, v193, v5
    v_mul_f32 v226, v226, v4
    v_mul_f32 v227, v227, v4
    v_mul_f32 v194, v194, v5
    v_mul_f32 v195, v195, v5
    v_mul_f32 v228, v228, v4
    v_mul_f32 v229, v229, v4
    v_mul_f32 v196, v196, v5
    v_mul_f32 v197, v197, v5
    v_mul_f32 v230, v230, v4
    v_mul_f32 v231, v231, v4
    v_mul_f32 v198, v198, v5
    v_mul_f32 v199, v199, v5
    v_cvt_pk_bf16_f32 v216, v216, v217
    v_cvt_pk_bf16_f32 v217, v218, v219
    v_cvt_pk_bf16_f32 v218, v220, v221
    v_cvt_pk_bf16_f32 v219, v222, v223
    v_cvt_pk_bf16_f32 v220, v224, v225
    v_cvt_pk_bf16_f32 v221, v226, v227
    v_cvt_pk_bf16_f32 v222, v228, v229
    v_cvt_pk_bf16_f32 v223, v230, v231
    ds_write_b128 v232, v[216:219]
    v_cvt_pk_bf16_f32 v224, v184, v185
    v_cvt_pk_bf16_f32 v225, v186, v187
    v_cvt_pk_bf16_f32 v226, v188, v189
    v_cvt_pk_bf16_f32 v227, v190, v191
    ds_write_b128 v232, v[220:223] offset:4096
    s_waitcnt vmcnt(18)
    s_waitcnt vmcnt(12)
    s_waitcnt vmcnt(10)
    s_waitcnt vmcnt(8)
    s_barrier
    ds_write_b128 v232, v[224:227] offset:8192
    v_cvt_pk_bf16_f32 v228, v192, v193
    v_cvt_pk_bf16_f32 v229, v194, v195
    v_cvt_pk_bf16_f32 v230, v196, v197
    v_cvt_pk_bf16_f32 v231, v198, v199
    s_xor_b32 s96, s95, 786432
    s_add_u32 s97, s96, s90
    s_sub_u32 s82, s97, 65536
    s_add_u32 m0, s83, 45056
    s_nop 0
    buffer_load_dwordx4 v26, s[44:47], s82 offen lds
    ds_write_b128 v232, v[228:231] offset:12288
    v_cvt_pk_bf16_f32 v200, 0, v200
    v_cvt_pk_bf16_f32 v201, 0, v201
    v_cvt_pk_bf16_f32 v202, 0, v202
    v_cvt_pk_bf16_f32 v203, 0, v203
    v_cvt_pk_bf16_f32 v204, 0, v204
    v_cvt_pk_bf16_f32 v205, 0, v205
    v_cvt_pk_bf16_f32 v206, 0, v206
    v_cvt_pk_bf16_f32 v207, 0, v207
    v_cvt_pk_bf16_f32 v208, 0, v208
    v_cvt_pk_bf16_f32 v209, 0, v209
    v_cvt_pk_bf16_f32 v210, 0, v210
    v_cvt_pk_bf16_f32 v211, 0, v211
    s_xor_b32 s96, s95, 786432
    s_add_u32 s82, s96, s90
    s_add_u32 m0, s83, 49152
    s_nop 0
    buffer_load_dwordx4 v26, s[44:47], s82 offen lds
    v_cvt_pk_bf16_f32 v212, 0, v212
    v_cvt_pk_bf16_f32 v213, 0, v213
    v_cvt_pk_bf16_f32 v214, 0, v214
    v_cvt_pk_bf16_f32 v215, 0, v215
    v_max3_f32 v4, v200, v201, v202
    v_min3_f32 v5, v200, v201, v202
    v_max3_f32 v4, v4, v203, v204
    v_min3_f32 v5, v5, v203, v204
    v_max3_f32 v4, v4, v205, v206
    v_min3_f32 v5, v5, v205, v206
    v_max3_f32 v4, v4, v207, v208
    v_min3_f32 v5, v5, v207, v208
    v_max3_f32 v4, v4, v209, v210
    v_min3_f32 v5, v5, v209, v210
    s_xor_b32 s96, s95, 917504
    s_add_u32 s97, s96, s90
    s_sub_u32 s82, s97, 65536
    s_add_u32 m0, s83, 53248
    s_nop 0
    buffer_load_dwordx4 v26, s[44:47], s82 offen lds
    v_max3_f32 v4, v4, v211, v212
    v_min3_f32 v5, v5, v211, v212
    v_max3_f32 v4, v4, v213, v214
    v_min3_f32 v5, v5, v213, v214
    v_max_f32 v6, v4, v215
    v_min_f32 v7, v5, v215
    v_max_f32 v4, v4, v215
    s_waitcnt lgkmcnt(0)
    v_min_f32 v5, v5, v215
    v_permlane32_swap_b32 v4, v6
    s_nop 0
    v_permlane32_swap_b32 v5, v7
    v_max_f32 v4, v4, v6
    v_min_f32 v5, v5, v7
L_PAD6:
    s_cbranch_execz L_RET6
    v_mul_f32_e64 v4, v4, s7
    s_xor_b32 s96, s95, 917504
    s_add_u32 s82, s96, s90
    s_add_u32 m0, s83, 57344
    s_nop 0
    buffer_load_dwordx4 v26, s[44:47], s82 offen lds
    v_mul_f32_e64 v5, v5, s7
    v_fma_f32 v216, v200, s7, -v4
    v_fma_f32 v217, v201, s7, -v4
    v_fma_f32 v200, -v200, s7, v5
    v_fma_f32 v201, -v201, s7, v5
    v_fma_f32 v218, v202, s7, -v4
    v_fma_f32 v219, v203, s7, -v4
    v_fma_f32 v202, -v202, s7, v5
    v_fma_f32 v203, -v203, s7, v5
    v_fma_f32 v220, v204, s7, -v4
    v_fma_f32 v221, v205, s7, -v4
    v_fma_f32 v204, -v204, s7, v5
    v_fma_f32 v205, -v205, s7, v5
    v_fma_f32 v222, v206, s7, -v4
    s_xor_b32 s96, s95, 1048576
    s_add_u32 s97, s96, s90
    s_sub_u32 s82, s97, 65536
    s_add_u32 m0, s83, 61440
    s_nop 0
    buffer_load_dwordx4 v26, s[44:47], s82 offen lds
    v_fma_f32 v223, v207, s7, -v4
    v_fma_f32 v206, -v206, s7, v5
    v_fma_f32 v207, -v207, s7, v5
    v_fma_f32 v224, v208, s7, -v4
    v_fma_f32 v225, v209, s7, -v4
    v_fma_f32 v208, -v208, s7, v5
    v_fma_f32 v209, -v209, s7, v5
    v_fma_f32 v226, v210, s7, -v4
    v_fma_f32 v227, v211, s7, -v4
    v_fma_f32 v210, -v210, s7, v5
    v_fma_f32 v211, -v211, s7, v5
    v_fma_f32 v228, v212, s7, -v4
    v_fma_f32 v229, v213, s7, -v4
    v_fma_f32 v212, -v212, s7, v5
    s_xor_b32 s96, s95, 1048576
    s_add_u32 s82, s96, s90
    s_add_u32 m0, s83, 65536
    s_nop 0
    buffer_load_dwordx4 v26, s[44:47], s82 offen lds
    v_fma_f32 v213, -v213, s7, v5
    v_fma_f32 v230, v214, s7, -v4
    v_fma_f32 v231, v215, s7, -v4
    v_fma_f32 v214, -v214, s7, v5
    v_fma_f32 v215, -v215, s7, v5
    v_exp_f32 v216, v216
    v_exp_f32 v200, v200
    v_exp_f32 v217, v217
    v_exp_f32 v201, v201
    v_exp_f32 v218, v218
    v_exp_f32 v202, v202
    v_exp_f32 v219, v219
    v_exp_f32 v203, v203
    v_exp_f32 v220, v220
    s_xor_b32 s96, s95, 1179648
    s_add_u32 s97, s96, s90
    s_sub_u32 s82, s97, 65536
    s_add_u32 m0, s83, 69632
    s_nop 0
    buffer_load_dwordx4 v26, s[44:47], s82 offen lds
    v_exp_f32 v204, v204
    v_exp_f32 v221, v221
    v_exp_f32 v205, v205
    v_exp_f32 v222, v222
    v_exp_f32 v206, v206
    v_exp_f32 v223, v223
    v_exp_f32 v207, v207
    v_exp_f32 v224, v224
    v_exp_f32 v208, v208
    v_exp_f32 v225, v225
    v_exp_f32 v209, v209
    v_exp_f32 v226, v226
    v_exp_f32 v210, v210
    v_exp_f32 v227, v227
    s_xor_b32 s96, s95, 1179648
    s_add_u32 s82, s96, s90
    s_add_u32 m0, s83, 73728
    s_nop 0
    buffer_load_dwordx4 v26, s[44:47], s82 offen lds
    v_exp_f32 v211, v211
    v_exp_f32 v228, v228
    v_exp_f32 v212, v212
    v_exp_f32 v229, v229
    v_exp_f32 v213, v213
    v_exp_f32 v230, v230
    v_exp_f32 v214, v214
    v_exp_f32 v231, v231
    v_exp_f32 v215, v215
    v_add_f32 v8, v216, v218
    v_add_f32 v9, v217, v219
    v_add_f32 v10, v200, v202
    v_add_f32 v11, v201, v203
    v_add_f32 v8, v8, v220
    v_add_f32 v9, v9, v221
    v_add_f32 v10, v10, v204
    v_add_f32 v11, v11, v205
    v_add_f32 v8, v8, v222
    v_add_f32 v9, v9, v223
    v_add_f32 v10, v10, v206
    v_add_f32 v11, v11, v207
    v_add_f32 v8, v8, v224
    v_add_f32 v9, v9, v225
    v_add_f32 v10, v10, v208
    v_add_f32 v11, v11, v209
    v_add_f32 v8, v8, v226
    v_add_f32 v9, v9, v227
    v_add_f32 v10, v10, v210
    v_add_f32 v11, v11, v211
    v_add_f32 v8, v8, v228
    v_add_f32 v9, v9, v229
    v_add_f32 v10, v10, v212
    v_add_f32 v11, v11, v213
    v_add_f32 v8, v8, v230
    v_add_f32 v9, v9, v231
    v_add_f32 v10, v10, v214
    v_add_f32 v11, v11, v215
    v_add_f32 v6, v8, v9
    v_add_f32 v7, v10, v11
    v_add_f32 v4, v8, v9
    v_add_f32 v5, v10, v11
    s_nop 0
    v_permlane32_swap_b32 v4, v6
    v_permlane32_swap_b32 v5, v7
    v_add_f32 v4, v4, v6
    v_add_f32 v5, v5, v7
    v_rcp_f32 v4, v4
    v_rcp_f32 v5, v5
    v_mul_f32 v216, v216, v4
    v_mul_f32 v217, v217, v4
    v_mul_f32 v200, v200, v5
    v_mul_f32 v201, v201, v5
    v_mul_f32 v218, v218, v4
    v_mul_f32 v219, v219, v4
    v_mul_f32 v202, v202, v5
    v_mul_f32 v203, v203, v5
    v_mul_f32 v220, v220, v4
    v_mul_f32 v221, v221, v4
    v_mul_f32 v204, v204, v5
    v_mul_f32 v205, v205, v5
    v_mul_f32 v222, v222, v4
    v_mul_f32 v223, v223, v4
    v_mul_f32 v206, v206, v5
    v_mul_f32 v207, v207, v5
    v_mul_f32 v224, v224, v4
    v_mul_f32 v225, v225, v4
    v_mul_f32 v208, v208, v5
    v_mul_f32 v209, v209, v5
    v_mul_f32 v226, v226, v4
    v_mul_f32 v227, v227, v4
    v_mul_f32 v210, v210, v5
    v_mul_f32 v211, v211, v5
    v_mul_f32 v228, v228, v4
    v_mul_f32 v229, v229, v4
    v_mul_f32 v212, v212, v5
    v_mul_f32 v213, v213, v5
    v_mul_f32 v230, v230, v4
    v_mul_f32 v231, v231, v4
    v_mul_f32 v214, v214, v5
    v_mul_f32 v215, v215, v5
    v_cvt_pk_bf16_f32 v216, v216, v217
    v_cvt_pk_bf16_f32 v217, v218, v219
    v_cvt_pk_bf16_f32 v218, v220, v221
    v_cvt_pk_bf16_f32 v219, v222, v223
    v_cvt_pk_bf16_f32 v220, v224, v225
    v_cvt_pk_bf16_f32 v221, v226, v227
    v_cvt_pk_bf16_f32 v222, v228, v229
    v_cvt_pk_bf16_f32 v223, v230, v231
    ds_write_b128 v232, v[216:219] offset:16384
    v_cvt_pk_bf16_f32 v224, v200, v201
    v_cvt_pk_bf16_f32 v225, v202, v203
    v_cvt_pk_bf16_f32 v226, v204, v205
    v_cvt_pk_bf16_f32 v227, v206, v207
    ds_write_b128 v232, v[220:223] offset:20480
    ds_write_b128 v232, v[224:227] offset:24576
    v_cvt_pk_bf16_f32 v228, v208, v209
    v_cvt_pk_bf16_f32 v229, v210, v211
    v_cvt_pk_bf16_f32 v230, v212, v213
    v_cvt_pk_bf16_f32 v231, v214, v215
    ds_write_b128 v232, v[228:231] offset:28672
    s_lshl_b32 s96, s77, 11
    s_add_u32 s17, s96, 151552
    v_add_u32 v0, s17, v2
    s_setprio 0
L_JOIN:
    s_waitcnt lgkmcnt(0)
    s_barrier
    ds_read_b64_tr_b16 v[184:185], v84
    ds_read_b64_tr_b16 v[186:187], v84 offset:512
    ds_read_b64_tr_b16 v[200:201], v85
    ds_read_b64_tr_b16 v[202:203], v85 offset:512
    ds_read_b64_tr_b16 v[204:205], v85 offset:1024
    ds_read_b64_tr_b16 v[206:207], v85 offset:1536
    ds_read_b64_tr_b16 v[188:189], v84 offset:1024
    ds_read_b64_tr_b16 v[190:191], v84 offset:1536
    ds_read_b64_tr_b16 v[208:209], v85 offset:2048
    ds_read_b64_tr_b16 v[210:211], v85 offset:2560
    ds_read_b64_tr_b16 v[212:213], v85 offset:3072
    ds_read_b64_tr_b16 v[214:215], v85 offset:3584
    ds_read_b64_tr_b16 v[192:193], v84 offset:2048
    ds_read_b64_tr_b16 v[194:195], v84 offset:2560
    ds_read_b64_tr_b16 v[216:217], v85 offset:4096
    ds_read_b64_tr_b16 v[218:219], v85 offset:4608
    ds_read_b64_tr_b16 v[220:221], v85 offset:5120
    ds_read_b64_tr_b16 v[222:223], v85 offset:5632
    s_waitcnt lgkmcnt(12)
    v_mfma_f32_16x16x32_bf16 v[232:235], v[184:187], v[200:203], 0
    v_mfma_f32_16x16x32_bf16 v[236:239], v[184:187], v[204:207], 0
    v_mfma_f32_16x16x32_bf16 v[240:243], v[184:187], v[80:83], 0
    ds_read_b64_tr_b16 v[196:197], v84 offset:3072
    ds_read_b64_tr_b16 v[198:199], v84 offset:3584
    ds_read_b64_tr_b16 v[224:225], v85 offset:6144
    ds_read_b64_tr_b16 v[226:227], v85 offset:6656
    ds_read_b64_tr_b16 v[228:229], v85 offset:7168
    ds_read_b64_tr_b16 v[230:231], v85 offset:7680
    s_waitcnt lgkmcnt(12)
    v_mfma_f32_16x16x32_bf16 v[232:235], v[188:191], v[208:211], v[232:235]
    v_mfma_f32_16x16x32_bf16 v[236:239], v[188:191], v[212:215], v[236:239]
    v_mfma_f32_16x16x32_bf16 v[240:243], v[188:191], v[80:83], v[240:243]
    s_waitcnt lgkmcnt(6)
    v_mfma_f32_16x16x32_bf16 v[232:235], v[192:195], v[216:219], v[232:235]
    v_mfma_f32_16x16x32_bf16 v[236:239], v[192:195], v[220:223], v[236:239]
    v_mfma_f32_16x16x32_bf16 v[240:243], v[192:195], v[80:83], v[240:243]
    s_waitcnt lgkmcnt(0)
    v_mfma_f32_16x16x32_bf16 v[232:235], v[196:199], v[224:227], v[232:235]
    v_mfma_f32_16x16x32_bf16 v[236:239], v[196:199], v[228:231], v[236:239]
    v_mfma_f32_16x16x32_bf16 v[240:243], v[196:199], v[80:83], v[240:243]
    s_cmp_lt_u32 s3, 4
    s_cbranch_scc1 L_NOQX
    ds_read_b128 v[168:171], v0
    ds_read_b128 v[172:175], v0 offset:1024
L_NOQX:
    s_nop 3
    buffer_store_dwordx4 v[232:235], v2, s[32:35], s13 offen sc1
    buffer_store_dwordx4 v[236:239], v2, s[32:35], s15 offen sc1
    s_mov_b32 exec_lo, 0x00010001
    s_mov_b32 exec_hi, 0x00010001
    buffer_store_dwordx4 v[240:243], v1, s[32:35], s14 offen sc1
    s_mov_b64 exec, -1
    s_waitcnt lgkmcnt(0)
    v_mfma_f32_32x32x16_bf16 v[120:135], v[176:179], v[168:171], 0
    v_mfma_f32_32x32x16_bf16 v[120:135], v[180:183], v[172:175], v[120:135]
    v_and_b32 v46, 7, v1
    v_lshlrev_b32 v46, 17, v46
    v_bfe_u32 v9, v1, 3, 1
    v_lshl_add_u32 v46, v9, 14, v46
    s_and_b32 s96, s10, 1
    s_and_b32 s97, s2, 27
    s_lshl_b32 s98, s97, 12
    s_lshr_b32 s99, s10, 1
    s_lshl_b32 s97, s99, 6
    s_add_u32 s99, s98, s97
    s_lshl2_add_u32 s98, s96, s99
    s_add_u32 s97, s98, 1048576
    s_add_u32 s17, s97, 512
    v_lshrrev_b32 v47, 3, v1
    v_lshlrev_b32 v47, 10, v47
    v_and_b32 v9, 7, v1
    v_lshl_add_u32 v47, v9, 4, v47
    v_and_b32 v48, 7, v1
    v_lshlrev_b32 v48, 4, v48
    v_lshrrev_b32 v9, 5, v1
    v_lshl_add_u32 v48, v9, 3, v48
    v_cvt_pk_bf16_f32 v120, 0, v120
    v_cvt_pk_bf16_f32 v121, 0, v121
    v_cvt_pk_bf16_f32 v122, 0, v122
    v_cvt_pk_bf16_f32 v123, 0, v123
    v_cvt_pk_bf16_f32 v124, 0, v124
    v_cvt_pk_bf16_f32 v125, 0, v125
    v_cvt_pk_bf16_f32 v126, 0, v126
    v_cvt_pk_bf16_f32 v127, 0, v127
    v_cvt_pk_bf16_f32 v128, 0, v128
    v_cvt_pk_bf16_f32 v129, 0, v129
    v_cvt_pk_bf16_f32 v130, 0, v130
    v_cvt_pk_bf16_f32 v131, 0, v131
    v_cvt_pk_bf16_f32 v132, 0, v132
    v_cvt_pk_bf16_f32 v133, 0, v133
    v_cvt_pk_bf16_f32 v134, 0, v134
    v_cvt_pk_bf16_f32 v135, 0, v135
    v_max3_f32 v4, v120, v121, v122
    v_min3_f32 v5, v120, v121, v122
    v_max3_f32 v4, v4, v123, v124
    v_min3_f32 v5, v5, v123, v124
    v_max3_f32 v4, v4, v125, v126
    v_min3_f32 v5, v5, v125, v126
    v_max3_f32 v4, v4, v127, v128
    v_min3_f32 v5, v5, v127, v128
    v_max3_f32 v4, v4, v129, v130
    v_min3_f32 v5, v5, v129, v130
    v_max3_f32 v4, v4, v131, v132
    v_min3_f32 v5, v5, v131, v132
    v_max3_f32 v4, v4, v133, v134
    v_min3_f32 v5, v5, v133, v134
    v_max_f32 v6, v4, v135
    v_min_f32 v7, v5, v135
    v_max_f32 v4, v4, v135
    v_min_f32 v5, v5, v135
    s_nop 0
    v_permlane32_swap_b32 v4, v6
    v_permlane32_swap_b32 v5, v7
    v_max_f32 v4, v4, v6
    v_min_f32 v5, v5, v7
    v_pk_mul_f32 v[4:5], v[4:5], s[6:7] op_sel:[0,1]
    v_mov_b32 v6, v5
    v_pk_fma_f32 v[136:137], v[120:121], s[6:7], v[4:5] op_sel:[0,1,0] op_sel_hi:[1,1,0] neg_lo:[0,0,1] neg_hi:[0,0,1]
    v_pk_fma_f32 v[120:121], v[120:121], s[6:7], v[6:7] op_sel:[0,1,0] op_sel_hi:[1,1,0] neg_lo:[1,0,0] neg_hi:[1,0,0]
    v_pk_fma_f32 v[138:139], v[122:123], s[6:7], v[4:5] op_sel:[0,1,0] op_sel_hi:[1,1,0] neg_lo:[0,0,1] neg_hi:[0,0,1]
    v_pk_fma_f32 v[122:123], v[122:123], s[6:7], v[6:7] op_sel:[0,1,0] op_sel_hi:[1,1,0] neg_lo:[1,0,0] neg_hi:[1,0,0]
    v_pk_fma_f32 v[140:141], v[124:125], s[6:7], v[4:5] op_sel:[0,1,0] op_sel_hi:[1,1,0] neg_lo:[0,0,1] neg_hi:[0,0,1]
    v_pk_fma_f32 v[124:125], v[124:125], s[6:7], v[6:7] op_sel:[0,1,0] op_sel_hi:[1,1,0] neg_lo:[1,0,0] neg_hi:[1,0,0]
    v_pk_fma_f32 v[142:143], v[126:127], s[6:7], v[4:5] op_sel:[0,1,0] op_sel_hi:[1,1,0] neg_lo:[0,0,1] neg_hi:[0,0,1]
    v_pk_fma_f32 v[126:127], v[126:127], s[6:7], v[6:7] op_sel:[0,1,0] op_sel_hi:[1,1,0] neg_lo:[1,0,0] neg_hi:[1,0,0]
    v_pk_fma_f32 v[144:145], v[128:129], s[6:7], v[4:5] op_sel:[0,1,0] op_sel_hi:[1,1,0] neg_lo:[0,0,1] neg_hi:[0,0,1]
    v_pk_fma_f32 v[128:129], v[128:129], s[6:7], v[6:7] op_sel:[0,1,0] op_sel_hi:[1,1,0] neg_lo:[1,0,0] neg_hi:[1,0,0]
    v_pk_fma_f32 v[146:147], v[130:131], s[6:7], v[4:5] op_sel:[0,1,0] op_sel_hi:[1,1,0] neg_lo:[0,0,1] neg_hi:[0,0,1]
    v_pk_fma_f32 v[130:131], v[130:131], s[6:7], v[6:7] op_sel:[0,1,0] op_sel_hi:[1,1,0] neg_lo:[1,0,0] neg_hi:[1,0,0]
    v_pk_fma_f32 v[148:149], v[132:133], s[6:7], v[4:5] op_sel:[0,1,0] op_sel_hi:[1,1,0] neg_lo:[0,0,1] neg_hi:[0,0,1]
    v_pk_fma_f32 v[132:133], v[132:133], s[6:7], v[6:7] op_sel:[0,1,0] op_sel_hi:[1,1,0] neg_lo:[1,0,0] neg_hi:[1,0,0]
    v_pk_fma_f32 v[150:151], v[134:135], s[6:7], v[4:5] op_sel:[0,1,0] op_sel_hi:[1,1,0] neg_lo:[0,0,1] neg_hi:[0,0,1]
    v_pk_fma_f32 v[134:135], v[134:135], s[6:7], v[6:7] op_sel:[0,1,0] op_sel_hi:[1,1,0] neg_lo:[1,0,0] neg_hi:[1,0,0]
    v_exp_f32 v136, v136
    v_exp_f32 v120, v120
    v_exp_f32 v137, v137
    v_exp_f32 v121, v121
    v_exp_f32 v138, v138
    v_exp_f32 v122, v122
    v_exp_f32 v139, v139
    v_exp_f32 v123, v123
    v_exp_f32 v140, v140
    v_exp_f32 v124, v124
    v_exp_f32 v141, v141
    v_exp_f32 v125, v125
    v_exp_f32 v142, v142
    v_exp_f32 v126, v126
    v_exp_f32 v143, v143
    v_exp_f32 v127, v127
    s_waitcnt vmcnt(0)
    s_barrier
    s_cmp_lg_u32 s3, 0
    s_cbranch_scc1 L_PC
    v_mov_b32 v85, s4
    s_mov_b32 exec_hi, 0
    s_mov_b32 exec_lo, 65535
    buffer_store_dword v85, v46, s[32:35], s17 offen sc1
    s_mov_b64 exec, -1
L_PC:
    s_xor_b32 s96, s95, 1310720
    s_add_u32 s82, s96, s90
    s_add_u32 m0, s83, 81920
    s_nop 0
    buffer_load_dwordx4 v26, s[44:47], s82 offen lds
    v_exp_f32 v144, v144
    v_exp_f32 v128, v128
    v_exp_f32 v145, v145
    v_exp_f32 v129, v129
    s_xor_b32 s96, s95, 1441792
    s_add_u32 s82, s96, s90
    s_add_u32 m0, s83, 90112
    s_nop 0
    buffer_load_dwordx4 v26, s[44:47], s82 offen lds
    v_exp_f32 v146, v146
    v_exp_f32 v130, v130
    v_exp_f32 v147, v147
    v_exp_f32 v131, v131
    s_xor_b32 s96, s95, 1572864
    s_add_u32 s82, s96, s90
    s_add_u32 m0, s83, 98304
    s_nop 0
    buffer_load_dwordx4 v26, s[44:47], s82 offen lds
    v_exp_f32 v148, v148
    v_exp_f32 v132, v132
    v_exp_f32 v149, v149
    v_exp_f32 v133, v133
    s_xor_b32 s96, s95, 1703936
    s_add_u32 s82, s96, s90
    s_add_u32 m0, s83, 106496
    s_nop 0
    buffer_load_dwordx4 v26, s[44:47], s82 offen lds
    v_exp_f32 v150, v150
    v_exp_f32 v134, v134
    v_exp_f32 v151, v151
    v_exp_f32 v135, v135
    s_lshl4_add_u32 s96, s11, s10
    s_lshl_b32 s97, s96, 14
    s_lshl_b32 s98, s3, 7
    s_add_u32 s99, s97, s98
    s_add_u32 s13, s99, 25165824
    s_add_u32 s14, s13, 8192
    s_lshl4_add_u32 s96, s11, s10
    s_lshl_b32 s97, s96, 10
    s_lshl_b32 s98, s3, 7
    s_add_u32 s99, s97, s98
    s_add_u32 s15, s99, 29360128
    s_add_u32 s17, s17, 3072
    s_load_dwordx2 s[24:25], s[32:33], s92 offset:512 glc
    s_xor_b32 s96, s95, 1835008
    s_add_u32 s82, s96, s90
    s_add_u32 m0, s83, 114688
    s_nop 0
    buffer_load_dwordx4 v26, s[44:47], s82 offen lds
    v_pk_add_f32 v[8:9], v[136:137], v[138:139]
    v_pk_add_f32 v[10:11], v[120:121], v[122:123]
    v_pk_add_f32 v[8:9], v[8:9], v[140:141]
    v_pk_add_f32 v[10:11], v[10:11], v[124:125]
    v_pk_add_f32 v[8:9], v[8:9], v[142:143]
    v_pk_add_f32 v[10:11], v[10:11], v[126:127]
    v_pk_add_f32 v[8:9], v[8:9], v[144:145]
    v_pk_add_f32 v[10:11], v[10:11], v[128:129]
    v_pk_add_f32 v[8:9], v[8:9], v[146:147]
    v_pk_add_f32 v[10:11], v[10:11], v[130:131]
    v_pk_add_f32 v[8:9], v[8:9], v[148:149]
    v_pk_add_f32 v[10:11], v[10:11], v[132:133]
    v_pk_add_f32 v[8:9], v[8:9], v[150:151]
    v_pk_add_f32 v[10:11], v[10:11], v[134:135]
    s_xor_b32 s96, s95, 1966080
    s_add_u32 s82, s96, s90
    s_add_u32 m0, s83, 122880
    s_nop 0
    buffer_load_dwordx4 v26, s[44:47], s82 offen lds
    v_add_f32 v6, v8, v9
    v_add_f32 v7, v10, v11
    v_add_f32 v4, v8, v9
    v_add_f32 v5, v10, v11
    s_nop 0
    v_permlane32_swap_b32 v4, v6
    v_permlane32_swap_b32 v5, v7
    v_pk_add_f32 v[4:5], v[4:5], v[6:7]
    v_rcp_f32 v4, v4
    v_rcp_f32 v5, v5
    s_nop 0
    v_pk_mul_f32 v[136:137], v[136:137], v[4:5] op_sel_hi:[1,0]
    v_pk_mul_f32 v[120:121], v[4:5], v[120:121] op_sel:[1,0]
    v_pk_mul_f32 v[138:139], v[138:139], v[4:5] op_sel_hi:[1,0]
    v_pk_mul_f32 v[122:123], v[4:5], v[122:123] op_sel:[1,0]
    v_pk_mul_f32 v[140:141], v[140:141], v[4:5] op_sel_hi:[1,0]
    s_add_u32 s82, s95, s90
    s_mov_b32 m0, s83
    s_nop 0
    buffer_load_dwordx4 v26, s[44:47], s82 offen lds
    v_pk_mul_f32 v[124:125], v[4:5], v[124:125] op_sel:[1,0]
    v_pk_mul_f32 v[142:143], v[142:143], v[4:5] op_sel_hi:[1,0]
    v_pk_mul_f32 v[126:127], v[4:5], v[126:127] op_sel:[1,0]
    v_pk_mul_f32 v[144:145], v[144:145], v[4:5] op_sel_hi:[1,0]
    v_pk_mul_f32 v[128:129], v[4:5], v[128:129] op_sel:[1,0]
    v_pk_mul_f32 v[146:147], v[146:147], v[4:5] op_sel_hi:[1,0]
    v_pk_mul_f32 v[130:131], v[4:5], v[130:131] op_sel:[1,0]
    v_pk_mul_f32 v[148:149], v[148:149], v[4:5] op_sel_hi:[1,0]
    v_pk_mul_f32 v[132:133], v[4:5], v[132:133] op_sel:[1,0]
    v_pk_mul_f32 v[150:151], v[150:151], v[4:5] op_sel_hi:[1,0]
    v_pk_mul_f32 v[134:135], v[4:5], v[134:135] op_sel:[1,0]
    v_cvt_pk_bf16_f32 v152, v136, v137
    v_cvt_pk_bf16_f32 v153, v138, v139
    v_cvt_pk_bf16_f32 v154, v140, v141
    s_xor_b32 s96, s95, 131072
    s_add_u32 s82, s96, s90
    s_add_u32 m0, s83, 8192
    s_nop 0
    buffer_load_dwordx4 v26, s[44:47], s82 offen lds
    v_cvt_pk_bf16_f32 v155, v142, v143
    v_cvt_pk_bf16_f32 v156, v144, v145
    v_cvt_pk_bf16_f32 v157, v146, v147
    v_cvt_pk_bf16_f32 v158, v148, v149
    v_cvt_pk_bf16_f32 v159, v150, v151
    v_cvt_pk_bf16_f32 v160, v120, v121
    v_cvt_pk_bf16_f32 v161, v122, v123
    v_cvt_pk_bf16_f32 v162, v124, v125
    v_cvt_pk_bf16_f32 v163, v126, v127
    v_cvt_pk_bf16_f32 v164, v128, v129
    v_cvt_pk_bf16_f32 v165, v130, v131
    v_cvt_pk_bf16_f32 v166, v132, v133
    v_cvt_pk_bf16_f32 v167, v134, v135
    s_branch SCHK_20
SPOLL_19:
    s_load_dwordx2 s[24:25], s[32:33], s92 offset:512 glc
SCHK_20:
    s_add_u32 s5, s5, 1
    s_cmp_ge_u32 s5, 200000
    s_waitcnt lgkmcnt(0)
    s_cbranch_scc1 SDONE_21
    s_cmp_lg_u32 s24, s4
    s_cbranch_scc1 SPOLL_19
    s_cmp_lg_u32 s25, s4
    s_cbranch_scc1 SPOLL_19
SDONE_21:
    s_barrier
    buffer_load_dwordx4 v[184:187], v47, s[32:35], s13 offen sc1
    buffer_load_dwordx4 v[188:191], v47, s[32:35], s14 offen sc1
    buffer_load_dwordx4 v[192:195], v2, s[32:35], s16 offen sc1
    s_lshl_b32 s96, s3, 5
    s_add_u32 s14, s96, 155648
    v_and_b32 v6, 3, v1
    v_lshl_add_u32 v6, v6, 3, s14
    v_lshrrev_b32 v9, 5, v1
    v_lshl_add_u32 v6, v9, 2, v6
    s_lshl_b32 s96, s3, 10
    s_add_u32 s14, s96, 147456
    v_and_b32 v5, 15, v1
    v_lshl_add_u32 v5, v5, 4, s14
    v_lshrrev_b32 v9, 5, v1
    v_lshl_add_u32 v5, v9, 9, v5
    v_bfe_u32 v9, v1, 4, 1
    v_lshl_add_u32 v5, v9, 3, v5
    s_lshl_b32 s96, s76, 7
    s_add_u32 s14, s96, 155648
    v_lshrrev_b32 v7, 5, v1
    v_lshl_add_u32 v7, v7, 4, s14
    s_lshl_b32 s96, s76, 12
    s_add_u32 s14, s96, 147456
    v_add_u32 v84, s14, v2
    s_cmp_lt_u32 s3, 4
    s_cbranch_scc1 L_HG1
    v_lshlrev_b32 v8, 16, v88
    v_and_b32 v9, s6, v88
    v_pk_mul_f32 v[196:197], v[36:37], v[8:9] op_sel:[0,0] op_sel_hi:[0,1]
    v_lshlrev_b32 v10, 16, v89
    v_and_b32 v11, s6, v89
    v_pk_mul_f32 v[198:199], v[36:37], v[10:11] op_sel:[0,0] op_sel_hi:[0,1]
    v_lshlrev_b32 v8, 16, v90
    v_and_b32 v9, s6, v90
    v_pk_mul_f32 v[200:201], v[36:37], v[8:9] op_sel:[0,0] op_sel_hi:[0,1]
    v_lshlrev_b32 v10, 16, v91
    v_and_b32 v11, s6, v91
    v_pk_mul_f32 v[202:203], v[36:37], v[10:11] op_sel:[0,0] op_sel_hi:[0,1]
    v_lshlrev_b32 v8, 16, v92
    v_and_b32 v9, s6, v92
    v_pk_fma_f32 v[196:197], v[36:37], v[8:9], v[196:197] op_sel:[1,0,0] op_sel_hi:[1,1,1]
    v_lshlrev_b32 v10, 16, v93
    v_and_b32 v11, s6, v93
    v_pk_fma_f32 v[198:199], v[36:37], v[10:11], v[198:199] op_sel:[1,0,0] op_sel_hi:[1,1,1]
    v_lshlrev_b32 v8, 16, v94
    v_and_b32 v9, s6, v94
    v_pk_fma_f32 v[200:201], v[36:37], v[8:9], v[200:201] op_sel:[1,0,0] op_sel_hi:[1,1,1]
    v_lshlrev_b32 v10, 16, v95
    v_and_b32 v11, s6, v95
    v_pk_fma_f32 v[202:203], v[36:37], v[10:11], v[202:203] op_sel:[1,0,0] op_sel_hi:[1,1,1]
    v_lshlrev_b32 v8, 16, v96
    v_and_b32 v9, s6, v96
    v_pk_fma_f32 v[196:197], v[38:39], v[8:9], v[196:197] op_sel:[0,0,0] op_sel_hi:[0,1,1]
    v_lshlrev_b32 v10, 16, v97
    v_and_b32 v11, s6, v97
    v_pk_fma_f32 v[198:199], v[38:39], v[10:11], v[198:199] op_sel:[0,0,0] op_sel_hi:[0,1,1]
    v_lshlrev_b32 v8, 16, v98
    v_and_b32 v9, s6, v98
    v_pk_fma_f32 v[200:201], v[38:39], v[8:9], v[200:201] op_sel:[0,0,0] op_sel_hi:[0,1,1]
    v_lshlrev_b32 v10, 16, v99
    v_and_b32 v11, s6, v99
    v_pk_fma_f32 v[202:203], v[38:39], v[10:11], v[202:203] op_sel:[0,0,0] op_sel_hi:[0,1,1]
    v_lshlrev_b32 v8, 16, v100
    v_and_b32 v9, s6, v100
    v_pk_fma_f32 v[196:197], v[38:39], v[8:9], v[196:197] op_sel:[1,0,0] op_sel_hi:[1,1,1]
    v_lshlrev_b32 v10, 16, v101
    v_and_b32 v11, s6, v101
    v_pk_fma_f32 v[198:199], v[38:39], v[10:11], v[198:199] op_sel:[1,0,0] op_sel_hi:[1,1,1]
    v_lshlrev_b32 v8, 16, v102
    v_and_b32 v9, s6, v102
    v_pk_fma_f32 v[200:201], v[38:39], v[8:9], v[200:201] op_sel:[1,0,0] op_sel_hi:[1,1,1]
    v_lshlrev_b32 v10, 16, v103
    v_and_b32 v11, s6, v103
    v_pk_fma_f32 v[202:203], v[38:39], v[10:11], v[202:203] op_sel:[1,0,0] op_sel_hi:[1,1,1]
    v_lshlrev_b32 v8, 16, v104
    v_and_b32 v9, s6, v104
    v_pk_fma_f32 v[196:197], v[40:41], v[8:9], v[196:197] op_sel:[0,0,0] op_sel_hi:[0,1,1]
    v_lshlrev_b32 v10, 16, v105
    v_and_b32 v11, s6, v105
    v_pk_fma_f32 v[198:199], v[40:41], v[10:11], v[198:199] op_sel:[0,0,0] op_sel_hi:[0,1,1]
    v_lshlrev_b32 v8, 16, v106
    v_and_b32 v9, s6, v106
    v_pk_fma_f32 v[200:201], v[40:41], v[8:9], v[200:201] op_sel:[0,0,0] op_sel_hi:[0,1,1]
    v_lshlrev_b32 v10, 16, v107
    v_and_b32 v11, s6, v107
    v_pk_fma_f32 v[202:203], v[40:41], v[10:11], v[202:203] op_sel:[0,0,0] op_sel_hi:[0,1,1]
    v_lshlrev_b32 v8, 16, v108
    v_and_b32 v9, s6, v108
    v_pk_fma_f32 v[196:197], v[40:41], v[8:9], v[196:197] op_sel:[1,0,0] op_sel_hi:[1,1,1]
    v_lshlrev_b32 v10, 16, v109
    v_and_b32 v11, s6, v109
    v_pk_fma_f32 v[198:199], v[40:41], v[10:11], v[198:199] op_sel:[1,0,0] op_sel_hi:[1,1,1]
    v_lshlrev_b32 v8, 16, v110
    v_and_b32 v9, s6, v110
    v_pk_fma_f32 v[200:201], v[40:41], v[8:9], v[200:201] op_sel:[1,0,0] op_sel_hi:[1,1,1]
    v_lshlrev_b32 v10, 16, v111
    v_and_b32 v11, s6, v111
    v_pk_fma_f32 v[202:203], v[40:41], v[10:11], v[202:203] op_sel:[1,0,0] op_sel_hi:[1,1,1]
    v_lshlrev_b32 v8, 16, v112
    v_and_b32 v9, s6, v112
    v_pk_fma_f32 v[196:197], v[42:43], v[8:9], v[196:197] op_sel:[0,0,0] op_sel_hi:[0,1,1]
    v_lshlrev_b32 v10, 16, v113
    v_and_b32 v11, s6, v113
    v_pk_fma_f32 v[198:199], v[42:43], v[10:11], v[198:199] op_sel:[0,0,0] op_sel_hi:[0,1,1]
    v_lshlrev_b32 v8, 16, v114
    v_and_b32 v9, s6, v114
    v_pk_fma_f32 v[200:201], v[42:43], v[8:9], v[200:201] op_sel:[0,0,0] op_sel_hi:[0,1,1]
    v_lshlrev_b32 v10, 16, v115
    v_and_b32 v11, s6, v115
    v_pk_fma_f32 v[202:203], v[42:43], v[10:11], v[202:203] op_sel:[0,0,0] op_sel_hi:[0,1,1]
    v_lshlrev_b32 v8, 16, v116
    v_and_b32 v9, s6, v116
    v_pk_fma_f32 v[196:197], v[42:43], v[8:9], v[196:197] op_sel:[1,0,0] op_sel_hi:[1,1,1]
    v_lshlrev_b32 v10, 16, v117
    v_and_b32 v11, s6, v117
    v_pk_fma_f32 v[198:199], v[42:43], v[10:11], v[198:199] op_sel:[1,0,0] op_sel_hi:[1,1,1]
    v_lshlrev_b32 v8, 16, v118
    v_and_b32 v9, s6, v118
    v_pk_fma_f32 v[200:201], v[42:43], v[8:9], v[200:201] op_sel:[1,0,0] op_sel_hi:[1,1,1]
    v_lshlrev_b32 v10, 16, v119
    v_and_b32 v11, s6, v119
    v_pk_fma_f32 v[202:203], v[42:43], v[10:11], v[202:203] op_sel:[1,0,0] op_sel_hi:[1,1,1]
    v_permlane32_swap_b32 v196, v200
    v_permlane32_swap_b32 v197, v201
    v_permlane32_swap_b32 v198, v202
    v_permlane32_swap_b32 v199, v203
    v_add_f32 v196, v196, v200
    v_add_f32 v197, v197, v201
    v_add_f32 v198, v198, v202
    v_add_f32 v199, v199, v203
    s_nop 0
    v_permlane16_swap_b32 v196, v198
    v_permlane16_swap_b32 v197, v199
    v_add_f32 v196, v196, v198
    v_add_f32 v197, v197, v199
    s_nop 0
    v_add_f32_dpp v196, v196, v196 row_ror:8 row_mask:0xf bank_mask:0xf
    v_add_f32_dpp v197, v197, v197 row_ror:8 row_mask:0xf bank_mask:0xf
    s_nop 1
    v_mov_b32_dpp v196, v197 quad_perm:[0,1,2,3] row_mask:0xf bank_mask:0xc
    ds_write_b32 v252, v196 offset:9984
L_HG1:
    s_waitcnt vmcnt(1)
    v_pk_add_f32 v[184:185], v[184:185], v[188:189]
    v_pk_add_f32 v[186:187], v[186:187], v[190:191]
    s_nop 1
    v_permlane32_swap_b32 v184, v186
    v_permlane32_swap_b32 v185, v187
    v_pk_add_f32 v[184:185], v[184:185], v[186:187]
    s_nop 1
    v_add_f32_dpp v184, v184, v184 row_ror:8 row_mask:0xf bank_mask:0xf
    v_add_f32_dpp v185, v185, v185 row_ror:8 row_mask:0xf bank_mask:0xf
    v_mov_b32 v186, v184
    v_mov_b32 v187, v185
    s_nop 0
    v_permlane16_swap_b32 v184, v186
    v_permlane16_swap_b32 v185, v187
    v_pk_add_f32 v[184:185], v[184:185], v[186:187]
    v_cvt_pk_bf16_f32 v184, v184, v185
    v_mov_b32 v185, s4
    s_mov_b32 exec_lo, 0xff
    s_mov_b32 exec_hi, 0xff
    buffer_store_dwordx2 v[184:185], v48, s[32:35], s15 offen sc1
    s_mov_b64 exec, -1
    s_waitcnt lgkmcnt(0)
    s_barrier
    s_cmp_lg_u32 s3, 0
    s_cbranch_scc1 L_PC2
    v_mov_b32 v85, s4
    s_mov_b32 exec_hi, 0
    s_mov_b32 exec_lo, 65535
    buffer_store_dword v85, v46, s[32:35], s17 offen sc1
    s_mov_b64 exec, -1
L_PC2:
    s_cmp_lg_u32 s3, 3
    s_cbranch_scc1 L_M2F
    ds_read_b128 v[196:199], v251 offset:10000
    s_lshr_b32 s96, s8, 2
    s_lshl1_add_u32 s97, s9, s96
    s_and_b32 s98, s8, 3
    s_lshl2_add_u32 s99, s97, s98
    s_lshl_b32 s96, s99, 9
    s_add_u32 s18, s96, 131072
    s_waitcnt lgkmcnt(0)
    v_add_f32 v196, v196, v197
    v_add_f32 v198, v198, v199
    v_mov_b32 v197, s4
    v_add_f32 v196, v196, v198
    buffer_store_dwordx2 v[196:197], v250, s[32:35], s18 offen sc1
L_M2F:
    s_waitcnt vmcnt(1)
    s_xor_b32 s96, s95, 262144
    s_add_u32 s82, s96, s90
    s_add_u32 m0, s83, 16384
    s_nop 0
    buffer_load_dwordx4 v26, s[44:47], s82 offen lds
    v_permlane32_swap_b32 v192, v194
    v_permlane32_swap_b32 v193, v195
    v_pk_add_f32 v[192:193], v[192:193], v[194:195]
    s_nop 1
    v_add_f32_dpp v192, v192, v192 row_ror:4 row_mask:0xf bank_mask:0xf
    s_xor_b32 s96, s95, 393216
    s_add_u32 s82, s96, s90
    s_add_u32 m0, s83, 24576
    s_nop 0
    buffer_load_dwordx4 v26, s[44:47], s82 offen lds
    v_add_f32_dpp v193, v193, v193 row_ror:4 row_mask:0xf bank_mask:0xf
    v_add_f32_dpp v192, v192, v192 row_ror:8 row_mask:0xf bank_mask:0xf
    s_nop 0
    v_add_f32_dpp v193, v193, v193 row_ror:8 row_mask:0xf bank_mask:0xf
    s_xor_b32 s96, s95, 524288
    s_add_u32 s82, s96, s90
    s_add_u32 m0, s83, 32768
    s_nop 0
    buffer_load_dwordx4 v26, s[44:47], s82 offen lds
    v_mov_b32 v194, v192
L_PAD7:
    s_cbranch_execz L_RET7
    v_mov_b32 v195, v193
    s_nop 0
    v_permlane16_swap_b32 v192, v194
    s_xor_b32 s96, s95, 655360
    s_add_u32 s82, s96, s90
    s_add_u32 m0, s83, 40960
    s_nop 0
    buffer_load_dwordx4 v26, s[44:47], s82 offen lds
    v_permlane16_swap_b32 v193, v195
    v_pk_add_f32 v[192:193], v[192:193], v[194:195]
    v_cvt_pk_bf16_f32 v192, v192, v193
    ds_write_b32 v6, v192
    s_waitcnt lgkmcnt(0)
    s_barrier
    ds_read_b128 v[196:199], v7
    ds_read_b128 v[200:203], v7 offset:32
    ds_read_b128 v[204:207], v7 offset:64
    ds_read_b128 v[208:211], v7 offset:96
    s_lshr_b32 s96, s8, 2
    s_lshl1_add_u32 s97, s9, s96
    s_and_b32 s98, s8, 3
    s_lshl2_add_u32 s99, s97, s98
    s_lshl_b32 s96, s99, 9
    s_add_u32 s18, s96, 131072
    s_waitcnt lgkmcnt(0)
    s_lshl3_add_u32 s96, s11, s3
    s_lshl_b32 s97, s96, 11
    s_add_u32 s13, s97, 29360128
    s_load_dwordx2 s[24:25], s[32:33], s92 offset:3584 glc
    v_mfma_f32_32x32x16_bf16 v[136:151], v[196:199], v[152:155], 0
    v_mfma_f32_32x32x16_bf16 v[136:151], v[200:203], v[156:159], v[136:151]
    v_mfma_f32_32x32x16_bf16 v[136:151], v[204:207], v[160:163], v[136:151]
    v_mfma_f32_32x32x16_bf16 v[136:151], v[208:211], v[164:167], v[136:151]
    s_lshr_b32 s96, s3, 2
    s_lshl_b32 s97, s96, 15
    s_and_b32 s98, s3, 3
    s_lshl_b32 s99, s98, 5
    s_add_u32 s19, s97, s99
    v_lshrrev_b32 v34, 4, v1
    v_lshlrev_b32 v34, 13, v34
    v_bfe_u32 v9, v1, 2, 2
    v_lshl_add_u32 v34, v9, 7, v34
    v_bfe_u32 v9, v1, 3, 2
    v_lshl_add_u32 v34, v9, 5, v34
    v_and_b32 v9, 3, v1
    v_lshl_add_u32 v34, v9, 3, v34
    v_xor_b32 v34, s19, v34
    s_lshl_b32 s96, s75, 11
    s_add_u32 s19, s96, 13631488
    v_and_b32 v52, 7, v1
    v_lshl_add_u32 v52, v52, 4, s19
    v_lshrrev_b32 v9, 4, v1
    v_lshl_add_u32 v52, v9, 9, v52
    v_and_b32 v53, 15, v1
    v_lshlrev_b32 v53, 9, v53
    v_add_u32 v53, 13631744, v53
    s_lshl_b32 s96, s74, 13
    s_add_u32 s72, s96, 20971520
    s_lshl3_add_u32 s96, s75, s3
    s_lshl_b32 s97, s96, 8
    s_add_u32 s73, s97, s72
    s_lshl3_add_u32 s96, s21, s3
    s_lshl4_add_u32 s97, s96, s12
    s_lshl_b32 s98, s97, 8
    s_add_u32 s86, s98, 12582912
    s_and_b32 s96, s12, 1
    s_lshr_b32 s97, s21, 2
    s_and_b32 s98, s21, 3
    s_lshl_b32 s99, s98, 6
    s_lshl1_add_u32 s98, s97, s99
    s_lshl_b32 s97, s98, 12
    s_lshr_b32 s99, s12, 1
    s_lshl_b32 s98, s99, 6
    s_add_u32 s99, s97, s98
    s_lshl2_add_u32 s97, s96, s99
    s_add_u32 s98, s97, 1048576
    s_add_u32 s87, s98, 1536
    s_lshl3_add_u32 s96, s21, s3
    s_lshl_b32 s97, s96, 15
    s_lshl_b32 s98, s12, 7
    s_add_u32 s70, s97, s98
    s_add_u32 s71, s70, 16384
    v_cvt_pk_bf16_f32 v136, 0, v136
    v_add_f32 v136, 0x358637bd, v136
    v_cvt_pk_bf16_f32 v136, 0, v136
    v_rcp_f32 v136, v136
    s_branch SCHK_23
SPOLL_22:
    s_load_dwordx2 s[24:25], s[32:33], s92 offset:3584 glc
SCHK_23:
    s_add_u32 s5, s5, 1
    s_cmp_ge_u32 s5, 200000
    s_waitcnt lgkmcnt(0)
    s_cbranch_scc1 SDONE_24
    s_cmp_lg_u32 s24, s4
    s_cbranch_scc1 SPOLL_22
    s_cmp_lg_u32 s25, s4
    s_cbranch_scc1 SPOLL_22
SDONE_24:
    buffer_load_dwordx4 v[228:231], v2, s[32:35], s13 offen sc1
    buffer_load_dwordx4 v[232:235], v2, s[32:35], s13 offen offset:1024 sc1
    s_lshl_b32 s19, s3, 6
    v_bfe_u32 v35, v1, 2, 1
    v_lshlrev_b32 v35, 9, v35
    v_bfe_u32 v9, v1, 3, 1
    v_lshl_add_u32 v35, v9, 12, v35
    v_lshrrev_b32 v9, 5, v1
    v_lshl_add_u32 v35, v9, 11, v35
    v_bfe_u32 v9, v1, 2, 2
    v_lshl_add_u32 v35, v9, 6, v35
    v_bfe_u32 v9, v1, 4, 1
    v_lshl_add_u32 v35, v9, 5, v35
    v_and_b32 v9, 3, v1
    v_lshl_add_u32 v35, v9, 3, v35
    v_xor_b32 v35, s19, v35
    v_add_u32 v35, 65536, v35
    v_and_b32 v54, 15, v1
    v_lshlrev_b32 v54, 4, v54
    v_lshrrev_b32 v9, 5, v1
    v_lshl_add_u32 v54, v9, 3, v54
    v_and_b32 v55, 15, v1
    v_lshlrev_b32 v55, 4, v55
    v_lshrrev_b32 v9, 4, v1
    v_lshl_add_u32 v55, v9, 2, v55
    s_waitcnt vmcnt(0)
    v_bitop3_b32 v4, v229, v231, s4 bitop3:0x7e
    v_bitop3_b32 v4, v4, v233, s4 bitop3:0xf6
    v_bitop3_b32 v4, v4, v235, s4 bitop3:0xf6
    v_cmp_ne_u32 vcc, 0, v4
    s_cbranch_vccz TOK_26
POLL_27:
    buffer_load_dwordx4 v[228:231], v2, s[32:35], s13 offen sc1
    buffer_load_dwordx4 v[232:235], v2, s[32:35], s13 offen offset:1024 sc1
    s_waitcnt vmcnt(0)
    v_bitop3_b32 v4, v229, v231, s4 bitop3:0x7e
    v_bitop3_b32 v4, v4, v233, s4 bitop3:0xf6
    v_bitop3_b32 v4, v4, v235, s4 bitop3:0xf6
    v_cmp_ne_u32 vcc, 0, v4
    s_cbranch_vccz PDONE_28
    s_add_u32 s5, s5, 1
    s_cmp_lt_u32 s5, 200000
    s_cbranch_scc1 POLL_27
PDONE_28:
TOK_26:
    ds_write2_b32 v5, v228, v230 offset0:0 offset1:1
    ds_write2_b32 v5, v232, v234 offset0:64 offset1:65
    s_waitcnt lgkmcnt(0)
    s_barrier
    ds_read_b128 v[212:215], v84
    ds_read_b128 v[216:219], v84 offset:1024
    ds_read_b128 v[220:223], v84 offset:2048
    ds_read_b128 v[224:227], v84 offset:3072
    s_lshl_b32 s96, s77, 1
    s_lshl3_add_u32 s97, s10, s96
    s_lshl_b32 s98, s97, 5
    s_lshl1_add_u32 s99, s11, s98
    s_add_u32 s96, s99, s76
    s_lshl_b32 s97, s96, 10
    s_add_u32 s13, s97, 8388608
    v_and_b32 v47, 15, v1
    v_lshlrev_b32 v47, 4, v47
    v_bfe_u32 v9, v1, 4, 1
    v_lshl_add_u32 v47, v9, 15, v47
    v_lshrrev_b32 v9, 5, v1
    v_lshl_add_u32 v47, v9, 8, v47
    s_waitcnt lgkmcnt(3)
    v_mfma_f32_32x32x16_bf16 v[120:135], v[212:215], v[152:155], 0
    s_waitcnt lgkmcnt(2)
    v_mfma_f32_32x32x16_bf16 v[120:135], v[216:219], v[156:159], v[120:135]
    s_waitcnt lgkmcnt(1)
    v_mfma_f32_32x32x16_bf16 v[120:135], v[220:223], v[160:163], v[120:135]
    s_waitcnt lgkmcnt(0)
    v_mfma_f32_32x32x16_bf16 v[120:135], v[224:227], v[164:167], v[120:135]
    s_lshr_b32 s96, s3, 1
    s_lshl4_add_u32 s97, s96, s12
    s_lshl_b32 s98, s97, 11
    s_and_b32 s99, s3, 1
    s_lshl_b32 s96, s99, 10
    s_add_u32 s97, s98, s96
    s_add_u32 s18, s97, 131072
    s_lshl_b32 s19, s12, 7
    v_and_b32 v84, 3, v1
    v_lshl_add_u32 v84, v84, 1, s19
    v_lshrrev_b32 v9, 5, v1
    v_lshl_add_u32 v84, v9, 3, v84
    v_bfe_u32 v9, v1, 4, 1
    v_lshl_add_u32 v84, v9, 4, v84
    v_bfe_u32 v9, v1, 2, 2
    v_lshl_add_u32 v84, v9, 5, v84
    global_load_ushort v32, v84, s[78:79]
    v_cvt_pk_bf16_f32 v120, 0, v120
    v_cvt_pk_bf16_f32 v121, 0, v121
    v_cvt_pk_bf16_f32 v122, 0, v122
    v_cvt_pk_bf16_f32 v123, 0, v123
    v_cvt_pk_bf16_f32 v124, 0, v124
    v_cvt_pk_bf16_f32 v125, 0, v125
    v_cvt_pk_bf16_f32 v126, 0, v126
    v_cvt_pk_bf16_f32 v127, 0, v127
    v_pk_mul_f32 v[120:121], v[120:121], v[136:137] op_sel_hi:[1,0]
    v_pk_mul_f32 v[122:123], v[122:123], v[136:137] op_sel_hi:[1,0]
    v_pk_mul_f32 v[124:125], v[124:125], v[136:137] op_sel_hi:[1,0]
    v_pk_mul_f32 v[126:127], v[126:127], v[136:137] op_sel_hi:[1,0]
    v_cvt_pk_bf16_f32 v168, v120, v121
    v_cvt_pk_bf16_f32 v169, v122, v123
    v_cvt_pk_bf16_f32 v170, v124, v125
    v_cvt_pk_bf16_f32 v171, v126, v127
    buffer_store_dwordx4 v[168:171], v47, s[32:35], s13 offen sc1
    v_cvt_pk_bf16_f32 v128, 0, v128
    v_cvt_pk_bf16_f32 v129, 0, v129
    v_cvt_pk_bf16_f32 v130, 0, v130
    v_cvt_pk_bf16_f32 v131, 0, v131
    v_cvt_pk_bf16_f32 v132, 0, v132
    v_cvt_pk_bf16_f32 v133, 0, v133
    v_cvt_pk_bf16_f32 v134, 0, v134
    v_cvt_pk_bf16_f32 v135, 0, v135
    v_pk_mul_f32 v[128:129], v[128:129], v[136:137] op_sel_hi:[1,0]
    v_pk_mul_f32 v[130:131], v[130:131], v[136:137] op_sel_hi:[1,0]
    v_pk_mul_f32 v[132:133], v[132:133], v[136:137] op_sel_hi:[1,0]
    v_pk_mul_f32 v[134:135], v[134:135], v[136:137] op_sel_hi:[1,0]
    v_cvt_pk_bf16_f32 v172, v128, v129
    v_cvt_pk_bf16_f32 v173, v130, v131
    v_cvt_pk_bf16_f32 v174, v132, v133
    v_cvt_pk_bf16_f32 v175, v134, v135
    buffer_store_dwordx4 v[172:175], v47, s[32:35], s13 offen offset:512 sc1
    buffer_load_dwordx4 v[28:31], v2, s[32:35], s18 offen sc1
    v_mov_b32 v236, -1
    v_mov_b32 v237, -1
    v_mov_b32 v238, -1
    v_mov_b32 v239, -1
    s_lshl3_add_u32 s96, s21, s3
    s_lshl4_add_u32 s97, s96, s12
    s_lshl_b32 s98, s97, 8
    s_add_u32 s19, s98, 12582912
    v_lshlrev_b32 v240, 2, v1
    buffer_store_dword v236, v240, s[32:35], s19 offen sc1
    s_lshl_b32 s96, s21, 14
    s_lshl_b32 s97, s12, 9
    s_add_u32 s98, s96, s97
    s_add_u32 s19, s98, 13631488
    v_and_b32 v240, 31, v1
    v_lshlrev_b32 v240, 4, v240
    v_lshrrev_b32 v241, 5, v1
    v_lshl_add_u32 v240, v241, 13, v240
    s_cmp_lg_u32 s3, 5
    s_cbranch_scc1 L_NOPO
    buffer_store_dwordx4 v[236:239], v240, s[32:35], s19 offen sc1
L_NOPO:
    v_bfe_u32 v36, v1, 2, 2
    v_lshlrev_b32 v36, 7, v36
    v_lshrrev_b32 v9, 4, v1
    v_lshl_add_u32 v36, v9, 10, v36
    v_and_b32 v9, 1, v1
    v_lshl_add_u32 v36, v9, 4, v36
    v_bfe_u32 v9, v1, 1, 1
    v_lshl_add_u32 v36, v9, 3, v36
    v_bfe_u32 v9, v1, 3, 2
    v_lshl_add_u32 v36, v9, 5, v36
    s_and_b32 s96, s9, 1
    s_lshl_b32 s97, s96, 2
    s_xor_b32 s98, s3, s97
    s_lshl_b32 s17, s98, 12
    s_lshl_b32 s96, s17, 2
    s_lshr_b32 s97, s95, 4
    s_xor_b32 s14, s96, s97
    v_add_u32 v36, s14, v36
    v_xor_b32 v37, 32, v36
    v_xor_b32 v38, 64, v36
    v_xor_b32 v39, 96, v36
    v_and_b32 v5, 7, v1
    v_lshlrev_b32 v5, 15, v5
    v_bfe_u32 v9, v1, 3, 1
    v_lshl_add_u32 v5, v9, 12, v5
    s_and_b32 s96, s11, 1
    s_lshr_b32 s97, s10, 2
    s_and_b32 s98, s10, 3
    s_lshl_b32 s99, s98, 6
    s_lshl1_add_u32 s98, s97, s99
    s_lshl_b32 s97, s98, 12
    s_lshr_b32 s99, s11, 1
    s_lshl_b32 s98, s99, 6
    s_add_u32 s99, s97, s98
    s_lshl2_add_u32 s97, s96, s99
    s_add_u32 s98, s97, 1048576
    s_add_u32 s15, s98, 1024
    v_lshlrev_b32 v152, 16, v12
    v_and_b32 v153, s6, v12
    v_lshlrev_b32 v154, 16, v13
    v_and_b32 v155, s6, v13
    v_lshlrev_b32 v156, 16, v14
    v_and_b32 v157, s6, v14
    v_lshlrev_b32 v158, 16, v15
    v_and_b32 v159, s6, v15
    v_lshlrev_b32 v160, 16, v16
    v_and_b32 v161, s6, v16
    v_lshlrev_b32 v162, 16, v17
    v_and_b32 v163, s6, v17
    v_lshlrev_b32 v164, 16, v18
    v_and_b32 v165, s6, v18
    v_lshlrev_b32 v166, 16, v19
    v_and_b32 v167, s6, v19
    s_lshl3_add_u32 s96, s21, s3
    s_lshl_b32 s97, s96, 15
    s_add_u32 s19, s97, 8388608
    s_and_b32 s96, s3, 1
    s_lshr_b32 s97, s3, 1
    s_lshl_b32 s98, s97, 10
    s_lshl3_add_u32 s99, s96, s98
    s_add_u32 s14, s99, 159744
    v_and_b32 v4, 31, v1
    v_lshl_add_u32 v4, v4, 5, s14
    v_lshrrev_b32 v9, 5, v1
    v_lshl_add_u32 v4, v9, 2, v4
    v_and_b32 v7, 3, v1
    v_lshlrev_b32 v7, 4, v7
    v_lshrrev_b32 v9, 5, v1
    v_lshl_add_u32 v7, v9, 6, v7
    v_bfe_u32 v9, v1, 4, 1
    v_lshl_add_u32 v7, v9, 7, v7
    v_bfe_u32 v9, v1, 2, 2
    v_lshl_add_u32 v7, v9, 8, v7
    v_add_u32 v7, 159744, v7
    s_waitcnt vmcnt(2)
    s_waitcnt lgkmcnt(0)
    s_barrier
    s_cmp_lg_u32 s3, 0
    s_cbranch_scc1 L_PD
    v_mov_b32 v6, s4
    s_mov_b32 exec_hi, 0
    s_mov_b32 exec_lo, 65535
    buffer_store_dword v6, v5, s[32:35], s15 offen sc1
    s_mov_b64 exec, -1
L_PD:
    s_waitcnt vmcnt(1)
    v_bitop3_b32 v6, v29, v31, s4 bitop3:0x7e
    v_cmp_ne_u32 vcc, 0, v6
    s_cbranch_vccz L_MGOK
POLL_29:
    buffer_load_dwordx4 v[28:31], v2, s[32:35], s18 offen sc1
    s_waitcnt vmcnt(0)
    v_bitop3_b32 v6, v29, v31, s4 bitop3:0x7e
    v_cmp_ne_u32 vcc, 0, v6
    s_cbranch_vccz PDONE_30
    s_add_u32 s5, s5, 1
    s_cmp_lt_u32 s5, 200000
    s_cbranch_scc1 POLL_29
PDONE_30:
L_MGOK:
    ds_write2_b32 v4, v28, v30 offset0:0 offset1:4
    s_waitcnt lgkmcnt(0)
    s_barrier
    s_lshl_b32 s96, s2, 12
    s_lshr_b32 s97, s17, 6
    s_add_u32 s98, s96, s97
    s_add_u32 s99, s98, 1048576
    s_add_u32 s18, s99, 1024
    ds_read_b128 v[192:195], v7
    ds_read_b128 v[196:199], v7 offset:1024
    ds_read_b128 v[200:203], v7 offset:2048
    ds_read_b128 v[204:207], v7 offset:3072
    v_and_b32 v8, 3, v1
    v_lshlrev_b32 v8, 2, v8
    v_lshrrev_b32 v9, 5, v1
    v_lshl_add_u32 v8, v9, 4, v8
    v_bfe_u32 v9, v1, 4, 1
    v_lshl_add_u32 v8, v9, 5, v8
    v_bfe_u32 v9, v1, 2, 2
    v_lshl_add_u32 v8, v9, 6, v8
    v_add_u32 v8, 157184, v8
    s_lshl4_add_u32 s96, s21, s12
    s_lshl_b32 s97, s96, 6
    s_add_u32 s13, s97, 14155776
    s_waitcnt lgkmcnt(0)
    s_load_dwordx2 s[24:25], s[32:33], s18 offset:0 glc
    v_pk_add_f32 v[192:193], v[192:193], v[194:195]
    v_add_f32 v28, v192, v193
    v_pk_add_f32 v[196:197], v[196:197], v[198:199]
    v_add_f32 v29, v196, v197
    v_pk_add_f32 v[200:201], v[200:201], v[202:203]
    v_add_f32 v30, v200, v201
    v_pk_add_f32 v[204:205], v[204:205], v[206:207]
    v_add_f32 v31, v204, v205
    v_cvt_pk_bf16_f32 v28, 0, v28
    v_cvt_pk_bf16_f32 v29, 0, v29
    v_cvt_pk_bf16_f32 v30, 0, v30
    v_cvt_pk_bf16_f32 v31, 0, v31
    v_add_f32 v30, 1.0, v30
    v_lshlrev_b32 v32, 16, v32
    v_cvt_pk_bf16_f32 v30, 0, v30
    ds_write_b32 v8, v31
    v_mul_f32 v192, v30, v32
    v_cvt_pk_bf16_f32 v193, 0, v192
    v_sub_f32 v194, v192, v193
    v_add_f32_dpp v192, v192, v192 quad_perm:[1,0,3,2] row_mask:0xf bank_mask:0xf
    s_nop 1
    v_add_f32_dpp v192, v192, v192 quad_perm:[2,3,0,1] row_mask:0xf bank_mask:0xf
    s_nop 1
    v_add_f32_dpp v192, v192, v192 row_half_mirror row_mask:0xf bank_mask:0xf
    s_nop 1
    v_add_f32_dpp v192, v192, v192 row_ror:8 row_mask:0xf bank_mask:0xf
    v_mov_b32 v199, v192
    s_nop 1
    v_permlane16_swap_b32 v192, v199
    v_add_f32 v192, v192, v199
    v_mov_b32 v199, v192
    s_nop 1
    v_permlane32_swap_b32 v192, v199
    v_add_f32 v192, v192, v199
    v_mov_b32_dpp v196, v193 row_shl:1 row_mask:0xf bank_mask:0xf
    v_mov_b32_dpp v197, v194 row_shl:1 row_mask:0xf bank_mask:0xf
    v_mov_b32_dpp v198, v32 row_shl:1 row_mask:0xf bank_mask:0xf
    v_cvt_pk_bf16_f32 v196, v193, v196
    v_cvt_pk_bf16_f32 v197, v194, v197
    v_cvt_pk_bf16_f32 v198, v32, v198
    v_mov_b32 v193, s4
    v_mov_b32 v194, 0
    s_cmp_lg_u32 s3, 2
    s_cbranch_scc1 L_NOUP
    s_mov_b64 exec, 1
    buffer_store_dwordx2 v[192:193], v194, s[32:35], s13 offen sc1
    s_mov_b64 exec, -1
L_NOUP:
    v_mov_b32 v184, 0x3f803f80
    s_nop 1
    v_mov_b32_dpp v184, v196 row_newbcast:0 row_mask:0xf bank_mask:0x2
    s_nop 1
    v_mov_b32_dpp v184, v197 row_newbcast:0 row_mask:0xf bank_mask:0x4
    s_nop 1
    v_mov_b32_dpp v184, v198 row_newbcast:0 row_mask:0xf bank_mask:0x8
    v_mov_b32 v185, 0x3f803f80
    s_nop 1
    v_mov_b32_dpp v185, v196 row_newbcast:2 row_mask:0xf bank_mask:0x2
    s_nop 1
    v_mov_b32_dpp v185, v197 row_newbcast:2 row_mask:0xf bank_mask:0x4
    s_nop 1
    v_mov_b32_dpp v185, v198 row_newbcast:2 row_mask:0xf bank_mask:0x8
    v_mov_b32 v186, 0x3f803f80
    s_nop 1
    v_mov_b32_dpp v186, v196 row_newbcast:4 row_mask:0xf bank_mask:0x2
    s_nop 1
    v_mov_b32_dpp v186, v197 row_newbcast:4 row_mask:0xf bank_mask:0x4
    s_nop 1
    v_mov_b32_dpp v186, v198 row_newbcast:4 row_mask:0xf bank_mask:0x8
    v_mov_b32 v187, 0x3f803f80
    s_nop 1
    v_mov_b32_dpp v187, v196 row_newbcast:6 row_mask:0xf bank_mask:0x2
    s_nop 1
    v_mov_b32_dpp v187, v197 row_newbcast:6 row_mask:0xf bank_mask:0x4
    s_nop 1
    v_mov_b32_dpp v187, v198 row_newbcast:6 row_mask:0xf bank_mask:0x8
    v_mov_b32 v188, 0x3f803f80
    s_nop 1
    v_mov_b32_dpp v188, v196 row_newbcast:8 row_mask:0xf bank_mask:0x2
    s_nop 1
    v_mov_b32_dpp v188, v197 row_newbcast:8 row_mask:0xf bank_mask:0x4
    s_nop 1
    v_mov_b32_dpp v188, v198 row_newbcast:8 row_mask:0xf bank_mask:0x8
    v_mov_b32 v189, 0x3f803f80
    s_nop 1
    v_mov_b32_dpp v189, v196 row_newbcast:10 row_mask:0xf bank_mask:0x2
    s_nop 1
    v_mov_b32_dpp v189, v197 row_newbcast:10 row_mask:0xf bank_mask:0x4
    s_nop 1
    v_mov_b32_dpp v189, v198 row_newbcast:10 row_mask:0xf bank_mask:0x8
    v_mov_b32 v190, 0x3f803f80
    s_nop 1
    v_mov_b32_dpp v190, v196 row_newbcast:12 row_mask:0xf bank_mask:0x2
    s_nop 1
    v_mov_b32_dpp v190, v197 row_newbcast:12 row_mask:0xf bank_mask:0x4
    s_nop 1
    v_mov_b32_dpp v190, v198 row_newbcast:12 row_mask:0xf bank_mask:0x8
    v_mov_b32 v191, 0x3f803f80
    s_nop 1
    v_mov_b32_dpp v191, v196 row_newbcast:14 row_mask:0xf bank_mask:0x2
    s_nop 1
    v_mov_b32_dpp v191, v197 row_newbcast:14 row_mask:0xf bank_mask:0x4
    s_nop 1
    v_mov_b32_dpp v191, v198 row_newbcast:14 row_mask:0xf bank_mask:0x8
    v_mov_b32 v42, v29
    v_mov_b32 v43, v31
    v_mov_b32 v33, v30
    v_mov_b32_dpp v136, v28 row_newbcast:0 row_mask:0xf bank_mask:0xf
    v_mov_b32_dpp v137, v28 row_newbcast:1 row_mask:0xf bank_mask:0xf
    v_mov_b32_dpp v138, v28 row_newbcast:2 row_mask:0xf bank_mask:0xf
    v_mov_b32_dpp v139, v28 row_newbcast:3 row_mask:0xf bank_mask:0xf
    v_mov_b32_dpp v140, v28 row_newbcast:4 row_mask:0xf bank_mask:0xf
    v_mov_b32_dpp v141, v28 row_newbcast:5 row_mask:0xf bank_mask:0xf
    v_mov_b32_dpp v142, v28 row_newbcast:6 row_mask:0xf bank_mask:0xf
    v_mov_b32_dpp v143, v28 row_newbcast:7 row_mask:0xf bank_mask:0xf
    v_mov_b32_dpp v144, v28 row_newbcast:8 row_mask:0xf bank_mask:0xf
    v_mov_b32_dpp v145, v28 row_newbcast:9 row_mask:0xf bank_mask:0xf
    v_mov_b32_dpp v146, v28 row_newbcast:10 row_mask:0xf bank_mask:0xf
    v_mov_b32_dpp v147, v28 row_newbcast:11 row_mask:0xf bank_mask:0xf
    v_mov_b32_dpp v148, v28 row_newbcast:12 row_mask:0xf bank_mask:0xf
    v_mov_b32_dpp v149, v28 row_newbcast:13 row_mask:0xf bank_mask:0xf
    v_mov_b32_dpp v150, v28 row_newbcast:14 row_mask:0xf bank_mask:0xf
    v_mov_b32_dpp v151, v28 row_newbcast:15 row_mask:0xf bank_mask:0xf
    v_mov_b32 v29, v5
    s_branch SCHK_32
SPOLL_31:
    s_load_dwordx2 s[24:25], s[32:33], s18 offset:0 glc
SCHK_32:
    s_add_u32 s5, s5, 1
    s_cmp_ge_u32 s5, 200000
    s_waitcnt lgkmcnt(0)
    s_cbranch_scc1 SDONE_33
    s_cmp_lg_u32 s24, s4
    s_cbranch_scc1 SPOLL_31
    s_cmp_lg_u32 s25, s4
    s_cbranch_scc1 SPOLL_31
SDONE_33:
    s_add_u32 s20, s17, s19
    buffer_load_dwordx4 v[224:227], v2, s[32:35], s20 offen sc1
    ds_read_b64_tr_b16 v[192:193], v36
    ds_read_b64_tr_b16 v[194:195], v36 offset:512
    ds_read_b64_tr_b16 v[196:197], v37
    ds_read_b64_tr_b16 v[198:199], v37 offset:512
    ds_read_b64_tr_b16 v[200:201], v38
    ds_read_b64_tr_b16 v[202:203], v38 offset:512
    ds_read_b64_tr_b16 v[204:205], v39
    ds_read_b64_tr_b16 v[206:207], v39 offset:512
    ds_read_b64_tr_b16 v[208:209], v36 offset:4096
    ds_read_b64_tr_b16 v[210:211], v36 offset:4608
    ds_read_b64_tr_b16 v[212:213], v37 offset:4096
    ds_read_b64_tr_b16 v[214:215], v37 offset:4608
    ds_read_b64_tr_b16 v[216:217], v38 offset:4096
    ds_read_b64_tr_b16 v[218:219], v38 offset:4608
    buffer_load_dwordx4 v[228:231], v2, s[32:35], s20 offen offset:1024 sc1
    buffer_load_dwordx4 v[232:235], v2, s[32:35], s20 offen offset:2048 sc1
    buffer_load_dwordx4 v[236:239], v2, s[32:35], s20 offen offset:3072 sc1
    s_barrier
    s_xor_b32 s96, s17, 4096
    s_add_u32 s20, s96, s19
    buffer_load_dwordx4 v[240:243], v2, s[32:35], s20 offen sc1
    buffer_load_dwordx4 v[244:247], v2, s[32:35], s20 offen offset:1024 sc1
    buffer_load_dwordx4 v[44:47], v2, s[32:35], s20 offen offset:2048 sc1
    buffer_load_dwordx4 v[48:51], v2, s[32:35], s20 offen offset:3072 sc1
    s_lshl_b32 s96, s21, 10
    s_add_u32 s13, s96, 14155776
    v_and_b32 v10, 15, v1
    v_lshlrev_b32 v10, 6, v10
    s_cmp_lt_u32 s3, 4
    s_cbranch_scc1 L_G2P0
    s_setprio 1
L_G2P0:
    s_waitcnt vmcnt(7)
    s_waitcnt lgkmcnt(6)
    v_mfma_f32_16x16x32_bf16 v[120:123], v[192:195], v[224:227], 0
    ds_read_b64_tr_b16 v[220:221], v39 offset:4096
    ds_read_b64_tr_b16 v[222:223], v39 offset:4608
    v_mfma_f32_16x16x32_bf16 v[124:127], v[196:199], v[224:227], 0
    ds_read_b64_tr_b16 v[192:193], v36 offset:8192
    ds_read_b64_tr_b16 v[194:195], v36 offset:8704
    v_mfma_f32_16x16x32_bf16 v[128:131], v[200:203], v[224:227], 0
    ds_read_b64_tr_b16 v[196:197], v37 offset:8192
    ds_read_b64_tr_b16 v[198:199], v37 offset:8704
    v_mfma_f32_16x16x32_bf16 v[132:135], v[204:207], v[224:227], 0
    ds_read_b64_tr_b16 v[200:201], v38 offset:8192
    ds_read_b64_tr_b16 v[202:203], v38 offset:8704
    s_xor_b32 s96, s17, 8192
    s_add_u32 s20, s96, s19
    buffer_load_dwordx4 v[224:227], v2, s[32:35], s20 offen sc1
    s_waitcnt vmcnt(7)
    s_waitcnt lgkmcnt(6)
    v_mfma_f32_16x16x32_bf16 v[120:123], v[208:211], v[228:231], v[120:123]
    ds_read_b64_tr_b16 v[204:205], v39 offset:8192
    ds_read_b64_tr_b16 v[206:207], v39 offset:8704
    v_mfma_f32_16x16x32_bf16 v[124:127], v[212:215], v[228:231], v[124:127]
    ds_read_b64_tr_b16 v[208:209], v36 offset:12288
    ds_read_b64_tr_b16 v[210:211], v36 offset:12800
    v_xor_b32 v36, 16384, v36
    v_mfma_f32_16x16x32_bf16 v[128:131], v[216:219], v[228:231], v[128:131]
    ds_read_b64_tr_b16 v[212:213], v37 offset:12288
    ds_read_b64_tr_b16 v[214:215], v37 offset:12800
    v_xor_b32 v37, 16384, v37
    v_mfma_f32_16x16x32_bf16 v[132:135], v[220:223], v[228:231], v[132:135]
    ds_read_b64_tr_b16 v[216:217], v38 offset:12288
    ds_read_b64_tr_b16 v[218:219], v38 offset:12800
    v_xor_b32 v38, 16384, v38
    buffer_load_dwordx4 v[228:231], v2, s[32:35], s20 offen offset:1024 sc1
    s_waitcnt vmcnt(7)
    s_waitcnt lgkmcnt(6)
    v_mfma_f32_16x16x32_bf16 v[120:123], v[192:195], v[232:235], v[120:123]
    ds_read_b64_tr_b16 v[220:221], v39 offset:12288
    ds_read_b64_tr_b16 v[222:223], v39 offset:12800
    v_xor_b32 v39, 16384, v39
    v_mfma_f32_16x16x32_bf16 v[124:127], v[196:199], v[232:235], v[124:127]
    ds_read_b64_tr_b16 v[192:193], v36
    ds_read_b64_tr_b16 v[194:195], v36 offset:512
    v_mfma_f32_16x16x32_bf16 v[128:131], v[200:203], v[232:235], v[128:131]
    ds_read_b64_tr_b16 v[196:197], v37
    ds_read_b64_tr_b16 v[198:199], v37 offset:512
    v_mfma_f32_16x16x32_bf16 v[132:135], v[204:207], v[232:235], v[132:135]
    ds_read_b64_tr_b16 v[200:201], v38
    ds_read_b64_tr_b16 v[202:203], v38 offset:512
    buffer_load_dwordx4 v[232:235], v2, s[32:35], s20 offen offset:2048 sc1
    s_waitcnt vmcnt(7)
    s_waitcnt lgkmcnt(6)
    v_mfma_f32_16x16x32_bf16 v[120:123], v[208:211], v[236:239], v[120:123]
    ds_read_b64_tr_b16 v[204:205], v39
    ds_read_b64_tr_b16 v[206:207], v39 offset:512
    v_mfma_f32_16x16x32_bf16 v[124:127], v[212:215], v[236:239], v[124:127]
    ds_read_b64_tr_b16 v[208:209], v36 offset:4096
    ds_read_b64_tr_b16 v[210:211], v36 offset:4608
    v_mfma_f32_16x16x32_bf16 v[128:131], v[216:219], v[236:239], v[128:131]
    ds_read_b64_tr_b16 v[212:213], v37 offset:4096
    ds_read_b64_tr_b16 v[214:215], v37 offset:4608
    v_mfma_f32_16x16x32_bf16 v[132:135], v[220:223], v[236:239], v[132:135]
    ds_read_b64_tr_b16 v[216:217], v38 offset:4096
    ds_read_b64_tr_b16 v[218:219], v38 offset:4608
    buffer_load_dwordx4 v[236:239], v2, s[32:35], s20 offen offset:3072 sc1
    s_waitcnt vmcnt(7)
    s_waitcnt lgkmcnt(6)
    v_mfma_f32_16x16x32_bf16 v[120:123], v[192:195], v[240:243], v[120:123]
    ds_read_b64_tr_b16 v[220:221], v39 offset:4096
    ds_read_b64_tr_b16 v[222:223], v39 offset:4608
    v_mfma_f32_16x16x32_bf16 v[124:127], v[196:199], v[240:243], v[124:127]
    ds_read_b64_tr_b16 v[192:193], v36 offset:8192
    ds_read_b64_tr_b16 v[194:195], v36 offset:8704
    v_mfma_f32_16x16x32_bf16 v[128:131], v[200:203], v[240:243], v[128:131]
    ds_read_b64_tr_b16 v[196:197], v37 offset:8192
    ds_read_b64_tr_b16 v[198:199], v37 offset:8704
    v_mfma_f32_16x16x32_bf16 v[132:135], v[204:207], v[240:243], v[132:135]
    ds_read_b64_tr_b16 v[200:201], v38 offset:8192
    ds_read_b64_tr_b16 v[202:203], v38 offset:8704
    s_xor_b32 s96, s17, 12288
    s_add_u32 s20, s96, s19
    buffer_load_dwordx4 v[240:243], v2, s[32:35], s20 offen sc1
    s_waitcnt vmcnt(7)
    s_waitcnt lgkmcnt(6)
    v_mfma_f32_16x16x32_bf16 v[120:123], v[208:211], v[244:247], v[120:123]
    ds_read_b64_tr_b16 v[204:205], v39 offset:8192
    ds_read_b64_tr_b16 v[206:207], v39 offset:8704
    v_mfma_f32_16x16x32_bf16 v[124:127], v[212:215], v[244:247], v[124:127]
    ds_read_b64_tr_b16 v[208:209], v36 offset:12288
    ds_read_b64_tr_b16 v[210:211], v36 offset:12800
    v_xor_b32 v36, 49152, v36
    v_mfma_f32_16x16x32_bf16 v[128:131], v[216:219], v[244:247], v[128:131]
    ds_read_b64_tr_b16 v[212:213], v37 offset:12288
    ds_read_b64_tr_b16 v[214:215], v37 offset:12800
    v_xor_b32 v37, 49152, v37
    v_mfma_f32_16x16x32_bf16 v[132:135], v[220:223], v[244:247], v[132:135]
    ds_read_b64_tr_b16 v[216:217], v38 offset:12288
    ds_read_b64_tr_b16 v[218:219], v38 offset:12800
    v_xor_b32 v38, 49152, v38
    buffer_load_dwordx4 v[244:247], v2, s[32:35], s20 offen offset:1024 sc1
    s_waitcnt vmcnt(7)
    s_waitcnt lgkmcnt(6)
    v_mfma_f32_16x16x32_bf16 v[120:123], v[192:195], v[44:47], v[120:123]
    ds_read_b64_tr_b16 v[220:221], v39 offset:12288
    ds_read_b64_tr_b16 v[222:223], v39 offset:12800
    v_xor_b32 v39, 49152, v39
    v_mfma_f32_16x16x32_bf16 v[124:127], v[196:199], v[44:47], v[124:127]
    ds_read_b64_tr_b16 v[192:193], v36
    ds_read_b64_tr_b16 v[194:195], v36 offset:512
    v_mfma_f32_16x16x32_bf16 v[128:131], v[200:203], v[44:47], v[128:131]
    ds_read_b64_tr_b16 v[196:197], v37
    ds_read_b64_tr_b16 v[198:199], v37 offset:512
    v_mfma_f32_16x16x32_bf16 v[132:135], v[204:207], v[44:47], v[132:135]
    ds_read_b64_tr_b16 v[200:201], v38
    ds_read_b64_tr_b16 v[202:203], v38 offset:512
    buffer_load_dwordx4 v[44:47], v2, s[32:35], s20 offen offset:2048 sc1
    s_waitcnt vmcnt(7)
    s_waitcnt lgkmcnt(6)
    v_mfma_f32_16x16x32_bf16 v[120:123], v[208:211], v[48:51], v[120:123]
    ds_read_b64_tr_b16 v[204:205], v39
    ds_read_b64_tr_b16 v[206:207], v39 offset:512
    v_mfma_f32_16x16x32_bf16 v[124:127], v[212:215], v[48:51], v[124:127]
    ds_read_b64_tr_b16 v[208:209], v36 offset:4096
    ds_read_b64_tr_b16 v[210:211], v36 offset:4608
    v_mfma_f32_16x16x32_bf16 v[128:131], v[216:219], v[48:51], v[128:131]
    ds_read_b64_tr_b16 v[212:213], v37 offset:4096
L_PAD8:
    s_cbranch_execz L_RET8
    ds_read_b64_tr_b16 v[214:215], v37 offset:4608
    v_mfma_f32_16x16x32_bf16 v[132:135], v[220:223], v[48:51], v[132:135]
    ds_read_b64_tr_b16 v[216:217], v38 offset:4096
    ds_read_b64_tr_b16 v[218:219], v38 offset:4608
    buffer_load_dwordx4 v[48:51], v2, s[32:35], s20 offen offset:3072 sc1
    s_waitcnt vmcnt(7)
    s_waitcnt lgkmcnt(6)
    v_mfma_f32_16x16x32_bf16 v[120:123], v[192:195], v[224:227], v[120:123]
    ds_read_b64_tr_b16 v[220:221], v39 offset:4096
    ds_read_b64_tr_b16 v[222:223], v39 offset:4608
    v_mfma_f32_16x16x32_bf16 v[124:127], v[196:199], v[224:227], v[124:127]
    ds_read_b64_tr_b16 v[192:193], v36 offset:8192
    ds_read_b64_tr_b16 v[194:195], v36 offset:8704
    v_mfma_f32_16x16x32_bf16 v[128:131], v[200:203], v[224:227], v[128:131]
    ds_read_b64_tr_b16 v[196:197], v37 offset:8192
    ds_read_b64_tr_b16 v[198:199], v37 offset:8704
    v_mfma_f32_16x16x32_bf16 v[132:135], v[204:207], v[224:227], v[132:135]
    ds_read_b64_tr_b16 v[200:201], v38 offset:8192
    ds_read_b64_tr_b16 v[202:203], v38 offset:8704
    s_xor_b32 s96, s17, 16384
    s_add_u32 s20, s96, s19
    buffer_load_dwordx4 v[224:227], v2, s[32:35], s20 offen sc1
    s_waitcnt vmcnt(7)
    s_waitcnt lgkmcnt(6)
    v_mfma_f32_16x16x32_bf16 v[120:123], v[208:211], v[228:231], v[120:123]
    ds_read_b64_tr_b16 v[204:205], v39 offset:8192
    ds_read_b64_tr_b16 v[206:207], v39 offset:8704
    v_mfma_f32_16x16x32_bf16 v[124:127], v[212:215], v[228:231], v[124:127]
    ds_read_b64_tr_b16 v[208:209], v36 offset:12288
    ds_read_b64_tr_b16 v[210:211], v36 offset:12800
    v_xor_b32 v36, 16384, v36
    v_mfma_f32_16x16x32_bf16 v[128:131], v[216:219], v[228:231], v[128:131]
    ds_read_b64_tr_b16 v[212:213], v37 offset:12288
    ds_read_b64_tr_b16 v[214:215], v37 offset:12800
    v_xor_b32 v37, 16384, v37
    v_mfma_f32_16x16x32_bf16 v[132:135], v[220:223], v[228:231], v[132:135]
    ds_read_b64_tr_b16 v[216:217], v38 offset:12288
    ds_read_b64_tr_b16 v[218:219], v38 offset:12800
    v_xor_b32 v38, 16384, v38
    buffer_load_dwordx4 v[228:231], v2, s[32:35], s20 offen offset:1024 sc1
    s_waitcnt vmcnt(7)
    s_waitcnt lgkmcnt(6)
    v_mfma_f32_16x16x32_bf16 v[120:123], v[192:195], v[232:235], v[120:123]
    ds_read_b64_tr_b16 v[220:221], v39 offset:12288
    ds_read_b64_tr_b16 v[222:223], v39 offset:12800
    v_xor_b32 v39, 16384, v39
    v_mfma_f32_16x16x32_bf16 v[124:127], v[196:199], v[232:235], v[124:127]
    ds_read_b64_tr_b16 v[192:193], v36
    ds_read_b64_tr_b16 v[194:195], v36 offset:512
    v_mfma_f32_16x16x32_bf16 v[128:131], v[200:203], v[232:235], v[128:131]
    ds_read_b64_tr_b16 v[196:197], v37
    ds_read_b64_tr_b16 v[198:199], v37 offset:512
    v_mfma_f32_16x16x32_bf16 v[132:135], v[204:207], v[232:235], v[132:135]
    ds_read_b64_tr_b16 v[200:201], v38
    ds_read_b64_tr_b16 v[202:203], v38 offset:512
    buffer_load_dwordx4 v[232:235], v2, s[32:35], s20 offen offset:2048 sc1
    s_waitcnt vmcnt(7)
    s_waitcnt lgkmcnt(6)
    v_mfma_f32_16x16x32_bf16 v[120:123], v[208:211], v[236:239], v[120:123]
    ds_read_b64_tr_b16 v[204:205], v39
    ds_read_b64_tr_b16 v[206:207], v39 offset:512
    v_mfma_f32_16x16x32_bf16 v[124:127], v[212:215], v[236:239], v[124:127]
    ds_read_b64_tr_b16 v[208:209], v36 offset:4096
    ds_read_b64_tr_b16 v[210:211], v36 offset:4608
    v_mfma_f32_16x16x32_bf16 v[128:131], v[216:219], v[236:239], v[128:131]
    ds_read_b64_tr_b16 v[212:213], v37 offset:4096
    ds_read_b64_tr_b16 v[214:215], v37 offset:4608
    v_mfma_f32_16x16x32_bf16 v[132:135], v[220:223], v[236:239], v[132:135]
    ds_read_b64_tr_b16 v[216:217], v38 offset:4096
    ds_read_b64_tr_b16 v[218:219], v38 offset:4608
    buffer_load_dwordx4 v[236:239], v2, s[32:35], s20 offen offset:3072 sc1
    s_waitcnt vmcnt(7)
    s_waitcnt lgkmcnt(6)
    v_mfma_f32_16x16x32_bf16 v[120:123], v[192:195], v[240:243], v[120:123]
    ds_read_b64_tr_b16 v[220:221], v39 offset:4096
    ds_read_b64_tr_b16 v[222:223], v39 offset:4608
    v_mfma_f32_16x16x32_bf16 v[124:127], v[196:199], v[240:243], v[124:127]
    ds_read_b64_tr_b16 v[192:193], v36 offset:8192
    ds_read_b64_tr_b16 v[194:195], v36 offset:8704
    v_mfma_f32_16x16x32_bf16 v[128:131], v[200:203], v[240:243], v[128:131]
    ds_read_b64_tr_b16 v[196:197], v37 offset:8192
    ds_read_b64_tr_b16 v[198:199], v37 offset:8704
    v_mfma_f32_16x16x32_bf16 v[132:135], v[204:207], v[240:243], v[132:135]
    ds_read_b64_tr_b16 v[200:201], v38 offset:8192
    ds_read_b64_tr_b16 v[202:203], v38 offset:8704
    s_xor_b32 s96, s17, 20480
    s_add_u32 s20, s96, s19
    buffer_load_dwordx4 v[240:243], v2, s[32:35], s20 offen sc1
    s_waitcnt vmcnt(7)
    s_waitcnt lgkmcnt(6)
    v_mfma_f32_16x16x32_bf16 v[120:123], v[208:211], v[244:247], v[120:123]
    ds_read_b64_tr_b16 v[204:205], v39 offset:8192
    ds_read_b64_tr_b16 v[206:207], v39 offset:8704
    v_mfma_f32_16x16x32_bf16 v[124:127], v[212:215], v[244:247], v[124:127]
    ds_read_b64_tr_b16 v[208:209], v36 offset:12288
    ds_read_b64_tr_b16 v[210:211], v36 offset:12800
    v_xor_b32 v36, 114688, v36
    v_mfma_f32_16x16x32_bf16 v[128:131], v[216:219], v[244:247], v[128:131]
    ds_read_b64_tr_b16 v[212:213], v37 offset:12288
    ds_read_b64_tr_b16 v[214:215], v37 offset:12800
    v_xor_b32 v37, 114688, v37
    v_mfma_f32_16x16x32_bf16 v[132:135], v[220:223], v[244:247], v[132:135]
    ds_read_b64_tr_b16 v[216:217], v38 offset:12288
    ds_read_b64_tr_b16 v[218:219], v38 offset:12800
    v_xor_b32 v38, 114688, v38
    buffer_load_dwordx4 v[244:247], v2, s[32:35], s20 offen offset:1024 sc1
    s_waitcnt vmcnt(7)
    s_waitcnt lgkmcnt(6)
    v_mfma_f32_16x16x32_bf16 v[120:123], v[192:195], v[44:47], v[120:123]
    ds_read_b64_tr_b16 v[220:221], v39 offset:12288
    ds_read_b64_tr_b16 v[222:223], v39 offset:12800
    v_xor_b32 v39, 114688, v39
    v_mfma_f32_16x16x32_bf16 v[124:127], v[196:199], v[44:47], v[124:127]
    ds_read_b64_tr_b16 v[192:193], v36
    ds_read_b64_tr_b16 v[194:195], v36 offset:512
    v_mfma_f32_16x16x32_bf16 v[128:131], v[200:203], v[44:47], v[128:131]
    ds_read_b64_tr_b16 v[196:197], v37
    ds_read_b64_tr_b16 v[198:199], v37 offset:512
    v_mfma_f32_16x16x32_bf16 v[132:135], v[204:207], v[44:47], v[132:135]
    ds_read_b64_tr_b16 v[200:201], v38
    ds_read_b64_tr_b16 v[202:203], v38 offset:512
    buffer_load_dwordx4 v[44:47], v2, s[32:35], s20 offen offset:2048 sc1
    s_waitcnt vmcnt(7)
    s_waitcnt lgkmcnt(6)
    v_mfma_f32_16x16x32_bf16 v[120:123], v[208:211], v[48:51], v[120:123]
    ds_read_b64_tr_b16 v[204:205], v39
    ds_read_b64_tr_b16 v[206:207], v39 offset:512
    v_mfma_f32_16x16x32_bf16 v[124:127], v[212:215], v[48:51], v[124:127]
    ds_read_b64_tr_b16 v[208:209], v36 offset:4096
    ds_read_b64_tr_b16 v[210:211], v36 offset:4608
    v_mfma_f32_16x16x32_bf16 v[128:131], v[216:219], v[48:51], v[128:131]
    ds_read_b64_tr_b16 v[212:213], v37 offset:4096
    ds_read_b64_tr_b16 v[214:215], v37 offset:4608
    v_mfma_f32_16x16x32_bf16 v[132:135], v[220:223], v[48:51], v[132:135]
    ds_read_b64_tr_b16 v[216:217], v38 offset:4096
    ds_read_b64_tr_b16 v[218:219], v38 offset:4608
    buffer_load_dwordx4 v[48:51], v2, s[32:35], s20 offen offset:3072 sc1
    s_waitcnt vmcnt(7)
    s_waitcnt lgkmcnt(6)
    v_mfma_f32_16x16x32_bf16 v[120:123], v[192:195], v[224:227], v[120:123]
    ds_read_b64_tr_b16 v[220:221], v39 offset:4096
    ds_read_b64_tr_b16 v[222:223], v39 offset:4608
    v_mfma_f32_16x16x32_bf16 v[124:127], v[196:199], v[224:227], v[124:127]
    ds_read_b64_tr_b16 v[192:193], v36 offset:8192
    ds_read_b64_tr_b16 v[194:195], v36 offset:8704
    v_mfma_f32_16x16x32_bf16 v[128:131], v[200:203], v[224:227], v[128:131]
    ds_read_b64_tr_b16 v[196:197], v37 offset:8192
    ds_read_b64_tr_b16 v[198:199], v37 offset:8704
    v_mfma_f32_16x16x32_bf16 v[132:135], v[204:207], v[224:227], v[132:135]
    ds_read_b64_tr_b16 v[200:201], v38 offset:8192
    ds_read_b64_tr_b16 v[202:203], v38 offset:8704
    s_xor_b32 s96, s17, 24576
    s_add_u32 s20, s96, s19
    buffer_load_dwordx4 v[224:227], v2, s[32:35], s20 offen sc1
    s_waitcnt vmcnt(7)
    s_waitcnt lgkmcnt(6)
    v_mfma_f32_16x16x32_bf16 v[120:123], v[208:211], v[228:231], v[120:123]
    ds_read_b64_tr_b16 v[204:205], v39 offset:8192
    ds_read_b64_tr_b16 v[206:207], v39 offset:8704
    v_mfma_f32_16x16x32_bf16 v[124:127], v[212:215], v[228:231], v[124:127]
    ds_read_b64_tr_b16 v[208:209], v36 offset:12288
    ds_read_b64_tr_b16 v[210:211], v36 offset:12800
    v_xor_b32 v36, 16384, v36
    v_mfma_f32_16x16x32_bf16 v[128:131], v[216:219], v[228:231], v[128:131]
    ds_read_b64_tr_b16 v[212:213], v37 offset:12288
    ds_read_b64_tr_b16 v[214:215], v37 offset:12800
    v_xor_b32 v37, 16384, v37
    v_mfma_f32_16x16x32_bf16 v[132:135], v[220:223], v[228:231], v[132:135]
    ds_read_b64_tr_b16 v[216:217], v38 offset:12288
    ds_read_b64_tr_b16 v[218:219], v38 offset:12800
    v_xor_b32 v38, 16384, v38
    buffer_load_dwordx4 v[228:231], v2, s[32:35], s20 offen offset:1024 sc1
    s_waitcnt vmcnt(7)
    s_waitcnt lgkmcnt(6)
    v_mfma_f32_16x16x32_bf16 v[120:123], v[192:195], v[232:235], v[120:123]
    ds_read_b64_tr_b16 v[220:221], v39 offset:12288
    ds_read_b64_tr_b16 v[222:223], v39 offset:12800
    v_xor_b32 v39, 16384, v39
    v_mfma_f32_16x16x32_bf16 v[124:127], v[196:199], v[232:235], v[124:127]
    ds_read_b64_tr_b16 v[192:193], v36
    ds_read_b64_tr_b16 v[194:195], v36 offset:512
    v_mfma_f32_16x16x32_bf16 v[128:131], v[200:203], v[232:235], v[128:131]
    ds_read_b64_tr_b16 v[196:197], v37
    ds_read_b64_tr_b16 v[198:199], v37 offset:512
    v_mfma_f32_16x16x32_bf16 v[132:135], v[204:207], v[232:235], v[132:135]
    ds_read_b64_tr_b16 v[200:201], v38
    ds_read_b64_tr_b16 v[202:203], v38 offset:512
    buffer_load_dwordx4 v[232:235], v2, s[32:35], s20 offen offset:2048 sc1
    s_waitcnt vmcnt(7)
    s_waitcnt lgkmcnt(6)
    v_mfma_f32_16x16x32_bf16 v[120:123], v[208:211], v[236:239], v[120:123]
    ds_read_b64_tr_b16 v[204:205], v39
    ds_read_b64_tr_b16 v[206:207], v39 offset:512
    v_mfma_f32_16x16x32_bf16 v[124:127], v[212:215], v[236:239], v[124:127]
    ds_read_b64_tr_b16 v[208:209], v36 offset:4096
    ds_read_b64_tr_b16 v[210:211], v36 offset:4608
    v_mfma_f32_16x16x32_bf16 v[128:131], v[216:219], v[236:239], v[128:131]
    ds_read_b64_tr_b16 v[212:213], v37 offset:4096
    ds_read_b64_tr_b16 v[214:215], v37 offset:4608
    v_mfma_f32_16x16x32_bf16 v[132:135], v[220:223], v[236:239], v[132:135]
    ds_read_b64_tr_b16 v[216:217], v38 offset:4096
    ds_read_b64_tr_b16 v[218:219], v38 offset:4608
    buffer_load_dwordx4 v[236:239], v2, s[32:35], s20 offen offset:3072 sc1
    s_waitcnt vmcnt(7)
    s_waitcnt lgkmcnt(6)
    v_mfma_f32_16x16x32_bf16 v[120:123], v[192:195], v[240:243], v[120:123]
    ds_read_b64_tr_b16 v[220:221], v39 offset:4096
    ds_read_b64_tr_b16 v[222:223], v39 offset:4608
    v_mfma_f32_16x16x32_bf16 v[124:127], v[196:199], v[240:243], v[124:127]
    ds_read_b64_tr_b16 v[192:193], v36 offset:8192
    ds_read_b64_tr_b16 v[194:195], v36 offset:8704
    v_mfma_f32_16x16x32_bf16 v[128:131], v[200:203], v[240:243], v[128:131]
    ds_read_b64_tr_b16 v[196:197], v37 offset:8192
    ds_read_b64_tr_b16 v[198:199], v37 offset:8704
    v_mfma_f32_16x16x32_bf16 v[132:135], v[204:207], v[240:243], v[132:135]
    ds_read_b64_tr_b16 v[200:201], v38 offset:8192
    ds_read_b64_tr_b16 v[202:203], v38 offset:8704
    s_xor_b32 s96, s17, 28672
    s_add_u32 s20, s96, s19
    buffer_load_dwordx4 v[240:243], v2, s[32:35], s20 offen sc1
    s_waitcnt vmcnt(7)
    s_waitcnt lgkmcnt(6)
    v_mfma_f32_16x16x32_bf16 v[120:123], v[208:211], v[244:247], v[120:123]
    ds_read_b64_tr_b16 v[204:205], v39 offset:8192
    ds_read_b64_tr_b16 v[206:207], v39 offset:8704
    v_mfma_f32_16x16x32_bf16 v[124:127], v[212:215], v[244:247], v[124:127]
    ds_read_b64_tr_b16 v[208:209], v36 offset:12288
    ds_read_b64_tr_b16 v[210:211], v36 offset:12800
    v_xor_b32 v36, 49152, v36
    v_mfma_f32_16x16x32_bf16 v[128:131], v[216:219], v[244:247], v[128:131]
    ds_read_b64_tr_b16 v[212:213], v37 offset:12288
    ds_read_b64_tr_b16 v[214:215], v37 offset:12800
    v_xor_b32 v37, 49152, v37
    v_mfma_f32_16x16x32_bf16 v[132:135], v[220:223], v[244:247], v[132:135]
    ds_read_b64_tr_b16 v[216:217], v38 offset:12288
    ds_read_b64_tr_b16 v[218:219], v38 offset:12800
    v_xor_b32 v38, 49152, v38
    buffer_load_dwordx4 v[244:247], v2, s[32:35], s20 offen offset:1024 sc1
    s_waitcnt vmcnt(7)
    s_waitcnt lgkmcnt(6)
    v_mfma_f32_16x16x32_bf16 v[120:123], v[192:195], v[44:47], v[120:123]
    ds_read_b64_tr_b16 v[220:221], v39 offset:12288
    ds_read_b64_tr_b16 v[222:223], v39 offset:12800
    v_xor_b32 v39, 49152, v39
    v_mfma_f32_16x16x32_bf16 v[124:127], v[196:199], v[44:47], v[124:127]
    ds_read_b64_tr_b16 v[192:193], v36
    ds_read_b64_tr_b16 v[194:195], v36 offset:512
    v_mfma_f32_16x16x32_bf16 v[128:131], v[200:203], v[44:47], v[128:131]
    ds_read_b64_tr_b16 v[196:197], v37
    ds_read_b64_tr_b16 v[198:199], v37 offset:512
    v_mfma_f32_16x16x32_bf16 v[132:135], v[204:207], v[44:47], v[132:135]
    ds_read_b64_tr_b16 v[200:201], v38
    ds_read_b64_tr_b16 v[202:203], v38 offset:512
    buffer_load_dwordx4 v[44:47], v2, s[32:35], s20 offen offset:2048 sc1
    s_waitcnt vmcnt(7)
    s_waitcnt lgkmcnt(6)
    v_mfma_f32_16x16x32_bf16 v[120:123], v[208:211], v[48:51], v[120:123]
    ds_read_b64_tr_b16 v[204:205], v39
    ds_read_b64_tr_b16 v[206:207], v39 offset:512
    v_mfma_f32_16x16x32_bf16 v[124:127], v[212:215], v[48:51], v[124:127]
    ds_read_b64_tr_b16 v[208:209], v36 offset:4096
    ds_read_b64_tr_b16 v[210:211], v36 offset:4608
    v_mfma_f32_16x16x32_bf16 v[128:131], v[216:219], v[48:51], v[128:131]
    ds_read_b64_tr_b16 v[212:213], v37 offset:4096
    ds_read_b64_tr_b16 v[214:215], v37 offset:4608
    v_mfma_f32_16x16x32_bf16 v[132:135], v[220:223], v[48:51], v[132:135]
    ds_read_b64_tr_b16 v[216:217], v38 offset:4096
    ds_read_b64_tr_b16 v[218:219], v38 offset:4608
    buffer_load_dwordx4 v[48:51], v2, s[32:35], s20 offen offset:3072 sc1
    buffer_load_dwordx2 v[40:41], v10, s[32:35], s13 offen sc1
    s_add_u32 s82, s80, 114688
    buffer_load_dwordx4 v[72:75], v27, s[52:55], s82 offen nt
    s_add_u32 s82, s80, 172032
    buffer_load_dwordx4 v[76:79], v27, s[52:55], s82 offen nt
    s_mov_b32 s82, s80
    buffer_load_dwordx4 v[80:83], v27, s[56:59], s82 offen nt
    s_waitcnt vmcnt(11)
    s_waitcnt lgkmcnt(6)
    v_mfma_f32_16x16x32_bf16 v[120:123], v[192:195], v[224:227], v[120:123]
    ds_read_b64_tr_b16 v[220:221], v39 offset:4096
    ds_read_b64_tr_b16 v[222:223], v39 offset:4608
    v_mfma_f32_16x16x32_bf16 v[124:127], v[196:199], v[224:227], v[124:127]
    ds_read_b64_tr_b16 v[192:193], v36 offset:8192
    ds_read_b64_tr_b16 v[194:195], v36 offset:8704
    v_mfma_f32_16x16x32_bf16 v[128:131], v[200:203], v[224:227], v[128:131]
    ds_read_b64_tr_b16 v[196:197], v37 offset:8192
    ds_read_b64_tr_b16 v[198:199], v37 offset:8704
    v_mfma_f32_16x16x32_bf16 v[132:135], v[204:207], v[224:227], v[132:135]
    ds_read_b64_tr_b16 v[200:201], v38 offset:8192
    ds_read_b64_tr_b16 v[202:203], v38 offset:8704
    s_waitcnt vmcnt(10)
    s_waitcnt lgkmcnt(6)
    v_mfma_f32_16x16x32_bf16 v[120:123], v[208:211], v[228:231], v[120:123]
    ds_read_b64_tr_b16 v[204:205], v39 offset:8192
    ds_read_b64_tr_b16 v[206:207], v39 offset:8704
    v_mfma_f32_16x16x32_bf16 v[124:127], v[212:215], v[228:231], v[124:127]
    ds_read_b64_tr_b16 v[208:209], v36 offset:12288
    ds_read_b64_tr_b16 v[210:211], v36 offset:12800
    v_xor_b32 v36, 16384, v36
    v_mfma_f32_16x16x32_bf16 v[128:131], v[216:219], v[228:231], v[128:131]
    ds_read_b64_tr_b16 v[212:213], v37 offset:12288
    ds_read_b64_tr_b16 v[214:215], v37 offset:12800
    v_xor_b32 v37, 16384, v37
    v_mfma_f32_16x16x32_bf16 v[132:135], v[220:223], v[228:231], v[132:135]
    ds_read_b64_tr_b16 v[216:217], v38 offset:12288
    ds_read_b64_tr_b16 v[218:219], v38 offset:12800
    v_xor_b32 v38, 16384, v38
    s_waitcnt vmcnt(9)
    s_waitcnt lgkmcnt(6)
    v_mfma_f32_16x16x32_bf16 v[120:123], v[192:195], v[232:235], v[120:123]
    ds_read_b64_tr_b16 v[220:221], v39 offset:12288
    ds_read_b64_tr_b16 v[222:223], v39 offset:12800
    v_xor_b32 v39, 16384, v39
    v_mfma_f32_16x16x32_bf16 v[124:127], v[196:199], v[232:235], v[124:127]
    ds_read_b64_tr_b16 v[192:193], v36
    ds_read_b64_tr_b16 v[194:195], v36 offset:512
    v_mfma_f32_16x16x32_bf16 v[128:131], v[200:203], v[232:235], v[128:131]
    ds_read_b64_tr_b16 v[196:197], v37
    ds_read_b64_tr_b16 v[198:199], v37 offset:512
    v_mfma_f32_16x16x32_bf16 v[132:135], v[204:207], v[232:235], v[132:135]
    ds_read_b64_tr_b16 v[200:201], v38
    ds_read_b64_tr_b16 v[202:203], v38 offset:512
    s_waitcnt vmcnt(8)
    s_waitcnt lgkmcnt(6)
    v_mfma_f32_16x16x32_bf16 v[120:123], v[208:211], v[236:239], v[120:123]
    ds_read_b64_tr_b16 v[204:205], v39
    ds_read_b64_tr_b16 v[206:207], v39 offset:512
    v_mfma_f32_16x16x32_bf16 v[124:127], v[212:215], v[236:239], v[124:127]
    ds_read_b64_tr_b16 v[208:209], v36 offset:4096
    ds_read_b64_tr_b16 v[210:211], v36 offset:4608
    v_mfma_f32_16x16x32_bf16 v[128:131], v[216:219], v[236:239], v[128:131]
    ds_read_b64_tr_b16 v[212:213], v37 offset:4096
    ds_read_b64_tr_b16 v[214:215], v37 offset:4608
    v_mfma_f32_16x16x32_bf16 v[132:135], v[220:223], v[236:239], v[132:135]
    ds_read_b64_tr_b16 v[216:217], v38 offset:4096
    ds_read_b64_tr_b16 v[218:219], v38 offset:4608
    s_cmp_lt_u32 s3, 4
    s_cbranch_scc1 L_G2P28
    s_setprio 0
L_G2P28:
    s_waitcnt vmcnt(7)
    s_waitcnt lgkmcnt(6)
    v_mfma_f32_16x16x32_bf16 v[120:123], v[192:195], v[240:243], v[120:123]
    ds_read_b64_tr_b16 v[220:221], v39 offset:4096
    ds_read_b64_tr_b16 v[222:223], v39 offset:4608
    v_mfma_f32_16x16x32_bf16 v[124:127], v[196:199], v[240:243], v[124:127]
    ds_read_b64_tr_b16 v[192:193], v36 offset:8192
    ds_read_b64_tr_b16 v[194:195], v36 offset:8704
    v_mfma_f32_16x16x32_bf16 v[128:131], v[200:203], v[240:243], v[128:131]
    ds_read_b64_tr_b16 v[196:197], v37 offset:8192
    ds_read_b64_tr_b16 v[198:199], v37 offset:8704
    v_mfma_f32_16x16x32_bf16 v[132:135], v[204:207], v[240:243], v[132:135]
    ds_read_b64_tr_b16 v[200:201], v38 offset:8192
    ds_read_b64_tr_b16 v[202:203], v38 offset:8704
    s_waitcnt vmcnt(6)
    s_waitcnt lgkmcnt(6)
    v_mfma_f32_16x16x32_bf16 v[120:123], v[208:211], v[244:247], v[120:123]
    ds_read_b64_tr_b16 v[204:205], v39 offset:8192
    ds_read_b64_tr_b16 v[206:207], v39 offset:8704
    v_mfma_f32_16x16x32_bf16 v[124:127], v[212:215], v[244:247], v[124:127]
    ds_read_b64_tr_b16 v[208:209], v36 offset:12288
    ds_read_b64_tr_b16 v[210:211], v36 offset:12800
    v_mfma_f32_16x16x32_bf16 v[128:131], v[216:219], v[244:247], v[128:131]
    ds_read_b64_tr_b16 v[212:213], v37 offset:12288
    ds_read_b64_tr_b16 v[214:215], v37 offset:12800
    v_mfma_f32_16x16x32_bf16 v[132:135], v[220:223], v[244:247], v[132:135]
    ds_read_b64_tr_b16 v[216:217], v38 offset:12288
    ds_read_b64_tr_b16 v[218:219], v38 offset:12800
    s_waitcnt vmcnt(5)
    s_waitcnt lgkmcnt(6)
    v_mfma_f32_16x16x32_bf16 v[120:123], v[192:195], v[44:47], v[120:123]
    ds_read_b64_tr_b16 v[220:221], v39 offset:12288
    ds_read_b64_tr_b16 v[222:223], v39 offset:12800
    v_mfma_f32_16x16x32_bf16 v[124:127], v[196:199], v[44:47], v[124:127]
    v_mfma_f32_16x16x32_bf16 v[128:131], v[200:203], v[44:47], v[128:131]
    v_mfma_f32_16x16x32_bf16 v[132:135], v[204:207], v[44:47], v[132:135]
    s_waitcnt vmcnt(4)
    s_waitcnt lgkmcnt(0)
    v_mfma_f32_16x16x32_bf16 v[120:123], v[208:211], v[48:51], v[120:123]
    v_mfma_f32_16x16x32_bf16 v[124:127], v[212:215], v[48:51], v[124:127]
    v_mfma_f32_16x16x32_bf16 v[128:131], v[216:219], v[48:51], v[128:131]
    v_mfma_f32_16x16x32_bf16 v[132:135], v[220:223], v[48:51], v[132:135]
    s_nop 4
    v_cvt_pk_bf16_f32 v120, 0, v120
    v_cvt_pk_bf16_f32 v121, 0, v121
    v_cvt_pk_bf16_f32 v122, 0, v122
    v_cvt_pk_bf16_f32 v123, 0, v123
    v_cvt_pk_bf16_f32 v124, 0, v124
    v_cvt_pk_bf16_f32 v125, 0, v125
    v_cvt_pk_bf16_f32 v126, 0, v126
    v_cvt_pk_bf16_f32 v127, 0, v127
    v_pk_mul_f32 v[120:121], v[120:121], v[136:137]
    v_pk_mul_f32 v[122:123], v[122:123], v[138:139]
    v_pk_mul_f32 v[124:125], v[124:125], v[140:141]
    v_pk_mul_f32 v[126:127], v[126:127], v[142:143]
    v_cvt_pk_bf16_f32 v120, 0, v120
    v_cvt_pk_bf16_f32 v121, 0, v121
    v_cvt_pk_bf16_f32 v122, 0, v122
    v_cvt_pk_bf16_f32 v123, 0, v123
    v_cvt_pk_bf16_f32 v124, 0, v124
    v_cvt_pk_bf16_f32 v125, 0, v125
    v_cvt_pk_bf16_f32 v126, 0, v126
    v_cvt_pk_bf16_f32 v127, 0, v127
    v_pk_add_f32 v[120:121], v[120:121], v[152:153]
    v_pk_add_f32 v[122:123], v[122:123], v[154:155]
    v_pk_add_f32 v[124:125], v[124:125], v[156:157]
    v_pk_add_f32 v[126:127], v[126:127], v[158:159]
    v_cvt_pk_bf16_f32 v12, v120, v121
    v_cvt_pk_bf16_f32 v13, v122, v123
    v_cvt_pk_bf16_f32 v14, v124, v125
    v_cvt_pk_bf16_f32 v15, v126, v127
    v_dot2_f32_bf16 v4, v12, v12, 0
    v_dot2_f32_bf16 v5, v13, v13, 0
    v_dot2_f32_bf16 v4, v14, v14, v4
    v_dot2_f32_bf16 v5, v15, v15, v5
    v_mfma_f32_16x16x32_bf16 v[240:243], v[184:187], v[12:15], 0
    v_cvt_pk_bf16_f32 v128, 0, v128
    v_cvt_pk_bf16_f32 v129, 0, v129
    v_cvt_pk_bf16_f32 v130, 0, v130
    v_cvt_pk_bf16_f32 v131, 0, v131
    v_cvt_pk_bf16_f32 v132, 0, v132
    v_cvt_pk_bf16_f32 v133, 0, v133
    v_cvt_pk_bf16_f32 v134, 0, v134
    v_cvt_pk_bf16_f32 v135, 0, v135
    v_pk_mul_f32 v[128:129], v[128:129], v[144:145]
    v_pk_mul_f32 v[130:131], v[130:131], v[146:147]
    v_pk_mul_f32 v[132:133], v[132:133], v[148:149]
    v_pk_mul_f32 v[134:135], v[134:135], v[150:151]
    v_cvt_pk_bf16_f32 v128, 0, v128
    v_cvt_pk_bf16_f32 v129, 0, v129
    v_cvt_pk_bf16_f32 v130, 0, v130
    v_cvt_pk_bf16_f32 v131, 0, v131
    v_cvt_pk_bf16_f32 v132, 0, v132
    v_cvt_pk_bf16_f32 v133, 0, v133
    v_cvt_pk_bf16_f32 v134, 0, v134
    v_cvt_pk_bf16_f32 v135, 0, v135
    v_pk_add_f32 v[128:129], v[128:129], v[160:161]
    v_pk_add_f32 v[130:131], v[130:131], v[162:163]
    v_pk_add_f32 v[132:133], v[132:133], v[164:165]
    v_pk_add_f32 v[134:135], v[134:135], v[166:167]
    v_cvt_pk_bf16_f32 v16, v128, v129
    v_cvt_pk_bf16_f32 v17, v130, v131
    v_cvt_pk_bf16_f32 v18, v132, v133
    v_cvt_pk_bf16_f32 v19, v134, v135
    v_dot2_f32_bf16 v4, v16, v16, v4
    v_dot2_f32_bf16 v5, v17, v17, v5
    v_dot2_f32_bf16 v4, v18, v18, v4
    v_dot2_f32_bf16 v5, v19, v19, v5
    v_mfma_f32_16x16x32_bf16 v[240:243], v[188:191], v[16:19], v[240:243]
    s_nop 1
    v_add_f32 v4, v4, v5
    v_mov_b32 v5, v4
    s_nop 1
    v_permlane32_swap_b32 v4, v5
    v_add_f32 v4, v4, v5
    v_mov_b32 v5, v4
    s_nop 1
    v_permlane16_swap_b32 v4, v5
    v_add_f32 v4, v4, v5
    s_nop 1
    v_mov_b32_dpp v240, v4 quad_perm:[0,1,2,3] row_mask:0x8 bank_mask:0xf
    buffer_store_dword v240, v55, s[32:35], s86 offen sc1
    s_barrier
    s_cmp_lg_u32 s3, 0
    s_cbranch_scc1 L_PE
    v_mov_b32 v6, s4
    s_mov_b32 exec_hi, 0
    s_mov_b32 exec_lo, 65535
    buffer_store_dword v6, v29, s[32:35], s87 offen sc1
    s_mov_b64 exec, -1
L_PE:
    s_add_u32 s82, s80, 57344
    s_lshl2_add_u32 m0, s83, 33792
    s_nop 0
    buffer_load_dwordx4 v27, s[56:59], s82 offen nt lds
    s_add_u32 s82, s80, 114688
    s_lshl2_add_u32 m0, s83, 34816
    s_nop 0
    buffer_load_dwordx4 v27, s[56:59], s82 offen nt lds
    s_lshl_b32 s15, s3, 12
    v_add_u32 v4, s15, v2
    v_add_u32 v7, 65536, v4
    s_waitcnt vmcnt(6)
    v_cmp_ne_u32 vcc, s4, v41
    s_cbranch_vccz L_UPOK
POLL_34:
    buffer_load_dwordx2 v[40:41], v10, s[32:35], s13 offen sc1
    s_waitcnt vmcnt(0)
    v_cmp_ne_u32 vcc, s4, v41
    s_cbranch_vccz PDONE_35
    s_add_u32 s5, s5, 1
    s_cmp_lt_u32 s5, 200000
    s_cbranch_scc1 POLL_34
PDONE_35:
L_UPOK:
    s_lshl3_add_u32 s96, s21, s3
    s_lshl_b32 s97, s96, 12
    s_add_u32 s14, s97, 12582912
    s_load_dwordx2 s[24:25], s[32:33], s92 offset:1536 glc
    v_add_f32_dpp v40, v40, v40 quad_perm:[1,0,3,2] row_mask:0xf bank_mask:0xf
    s_nop 1
    v_add_f32_dpp v40, v40, v40 quad_perm:[2,3,0,1] row_mask:0xf bank_mask:0xf
    s_nop 1
    v_add_f32_dpp v40, v40, v40 row_half_mirror row_mask:0xf bank_mask:0xf
    s_nop 1
    v_add_f32_dpp v40, v40, v40 row_mirror row_mask:0xf bank_mask:0xf
    v_lshlrev_b32 v152, 16, v12
    v_and_b32 v153, s6, v12
    v_lshlrev_b32 v154, 16, v13
    v_and_b32 v155, s6, v13
    v_lshlrev_b32 v156, 16, v14
    v_and_b32 v157, s6, v14
    v_lshlrev_b32 v158, 16, v15
    v_and_b32 v159, s6, v15
    v_lshlrev_b32 v160, 16, v16
    v_and_b32 v161, s6, v16
    v_lshlrev_b32 v162, 16, v17
    v_and_b32 v163, s6, v17
    v_lshlrev_b32 v164, 16, v18
    v_and_b32 v165, s6, v18
    v_lshlrev_b32 v166, 16, v19
    v_and_b32 v167, s6, v19
    s_lshl_b32 s96, s3, 9
    s_lshl1_add_u32 s15, s21, s96
    v_and_b32 v29, 15, v1
    v_lshl_add_u32 v29, v29, 5, s15
    v_xor_b32 v5, 0x4000, v4
    v_xor_b32 v8, 0x4000, v7
    s_waitcnt vmcnt(3)
    ds_write_b128 v4, v[72:75] offset:2048
    ds_write_b128 v4, v[76:79] offset:3072
    ds_write_b128 v4, v[80:83] offset:32768
    s_cmp_lt_u32 s3, 4
    s_cbranch_scc1 L_FW1
    ds_write_b128 v4, v[56:59] offset:0
    ds_write_b128 v5, v[60:63] offset:0
    ds_write_b128 v4, v[64:67] offset:1024
    ds_write_b128 v5, v[68:71] offset:1024
L_FW1:
    s_branch SCHK_37
SPOLL_36:
    s_load_dwordx2 s[24:25], s[32:33], s92 offset:1536 glc
SCHK_37:
    s_add_u32 s5, s5, 1
    s_cmp_ge_u32 s5, 200000
    s_waitcnt lgkmcnt(0)
    s_cbranch_scc1 SDONE_38
    s_cmp_lg_u32 s24, s4
    s_cbranch_scc1 SPOLL_36
    s_cmp_lg_u32 s25, s4
    s_cbranch_scc1 SPOLL_36
SDONE_38:
    s_barrier
    buffer_load_dwordx4 v[192:195], v2, s[32:35], s14 offen sc1
    buffer_load_dwordx4 v[196:199], v2, s[32:35], s14 offen offset:1024 sc1
    buffer_load_dwordx4 v[200:203], v2, s[32:35], s14 offen offset:2048 sc1
    buffer_load_dwordx4 v[204:207], v2, s[32:35], s14 offen offset:3072 sc1
    s_barrier
    s_add_u32 s82, s80, 172032
    s_lshl2_add_u32 m0, s83, 35840
    s_nop 0
    buffer_load_dwordx4 v27, s[56:59], s82 offen nt lds
    s_mov_b32 s82, s81
    s_lshl2_add_u32 m0, s83, 65536
    s_nop 0
    buffer_load_dwordx4 v253, s[60:63], s82 offen nt lds
    s_add_u32 s82, s81, 4096
    s_lshl2_add_u32 m0, s83, 66560
    s_nop 0
    buffer_load_dwordx4 v253, s[60:63], s82 offen nt lds
    v_mov_b32_dpp v168, v33 row_newbcast:0 row_mask:0xf bank_mask:0xf
    v_mov_b32_dpp v169, v33 row_newbcast:1 row_mask:0xf bank_mask:0xf
    v_mov_b32_dpp v170, v33 row_newbcast:2 row_mask:0xf bank_mask:0xf
    v_mov_b32_dpp v171, v33 row_newbcast:3 row_mask:0xf bank_mask:0xf
    v_mov_b32_dpp v172, v33 row_newbcast:4 row_mask:0xf bank_mask:0xf
    v_mov_b32_dpp v173, v33 row_newbcast:5 row_mask:0xf bank_mask:0xf
    v_mov_b32_dpp v174, v33 row_newbcast:6 row_mask:0xf bank_mask:0xf
    v_mov_b32_dpp v175, v33 row_newbcast:7 row_mask:0xf bank_mask:0xf
    v_mov_b32_dpp v176, v33 row_newbcast:8 row_mask:0xf bank_mask:0xf
    v_mov_b32_dpp v177, v33 row_newbcast:9 row_mask:0xf bank_mask:0xf
    v_mov_b32_dpp v178, v33 row_newbcast:10 row_mask:0xf bank_mask:0xf
    v_mov_b32_dpp v179, v33 row_newbcast:11 row_mask:0xf bank_mask:0xf
    v_mov_b32_dpp v180, v33 row_newbcast:12 row_mask:0xf bank_mask:0xf
    v_mov_b32_dpp v181, v33 row_newbcast:13 row_mask:0xf bank_mask:0xf
L_PAD9:
    s_cbranch_execz L_RET9
    v_mov_b32_dpp v182, v33 row_newbcast:14 row_mask:0xf bank_mask:0xf
    v_mov_b32_dpp v183, v33 row_newbcast:15 row_mask:0xf bank_mask:0xf
    v_mov_b32_dpp v88, v42 row_newbcast:0 row_mask:0xf bank_mask:0xf
    v_mov_b32_dpp v89, v42 row_newbcast:1 row_mask:0xf bank_mask:0xf
    v_mov_b32_dpp v90, v42 row_newbcast:2 row_mask:0xf bank_mask:0xf
    v_mov_b32_dpp v91, v42 row_newbcast:3 row_mask:0xf bank_mask:0xf
    v_mov_b32_dpp v92, v42 row_newbcast:4 row_mask:0xf bank_mask:0xf
    v_mov_b32_dpp v93, v42 row_newbcast:5 row_mask:0xf bank_mask:0xf
    v_mov_b32_dpp v94, v42 row_newbcast:6 row_mask:0xf bank_mask:0xf
    v_mov_b32_dpp v95, v42 row_newbcast:7 row_mask:0xf bank_mask:0xf
    v_mov_b32_dpp v96, v42 row_newbcast:8 row_mask:0xf bank_mask:0xf
    v_mov_b32_dpp v97, v42 row_newbcast:9 row_mask:0xf bank_mask:0xf
    v_mov_b32_dpp v98, v42 row_newbcast:10 row_mask:0xf bank_mask:0xf
    v_mov_b32_dpp v99, v42 row_newbcast:11 row_mask:0xf bank_mask:0xf
    v_mov_b32_dpp v100, v42 row_newbcast:12 row_mask:0xf bank_mask:0xf
    v_mov_b32_dpp v101, v42 row_newbcast:13 row_mask:0xf bank_mask:0xf
    v_mov_b32_dpp v102, v42 row_newbcast:14 row_mask:0xf bank_mask:0xf
    v_mov_b32_dpp v103, v42 row_newbcast:15 row_mask:0xf bank_mask:0xf
    v_mov_b32_dpp v104, v43 row_newbcast:0 row_mask:0xf bank_mask:0xf
    v_mov_b32_dpp v105, v43 row_newbcast:1 row_mask:0xf bank_mask:0xf
    v_mov_b32_dpp v106, v43 row_newbcast:2 row_mask:0xf bank_mask:0xf
    v_mov_b32_dpp v107, v43 row_newbcast:3 row_mask:0xf bank_mask:0xf
    v_mov_b32_dpp v108, v43 row_newbcast:4 row_mask:0xf bank_mask:0xf
    v_mov_b32_dpp v109, v43 row_newbcast:5 row_mask:0xf bank_mask:0xf
    v_mov_b32_dpp v110, v43 row_newbcast:6 row_mask:0xf bank_mask:0xf
    v_mov_b32_dpp v111, v43 row_newbcast:7 row_mask:0xf bank_mask:0xf
    v_mov_b32_dpp v112, v43 row_newbcast:8 row_mask:0xf bank_mask:0xf
    v_mov_b32_dpp v113, v43 row_newbcast:9 row_mask:0xf bank_mask:0xf
    v_mov_b32_dpp v114, v43 row_newbcast:10 row_mask:0xf bank_mask:0xf
    v_mov_b32_dpp v115, v43 row_newbcast:11 row_mask:0xf bank_mask:0xf
    v_mov_b32_dpp v116, v43 row_newbcast:12 row_mask:0xf bank_mask:0xf
    v_mov_b32_dpp v117, v43 row_newbcast:13 row_mask:0xf bank_mask:0xf
    v_mov_b32_dpp v118, v43 row_newbcast:14 row_mask:0xf bank_mask:0xf
    v_mov_b32_dpp v119, v43 row_newbcast:15 row_mask:0xf bank_mask:0xf
    s_lshl3_add_u32 s15, s3, 156160
    v_mov_b32 v4, s15
    v_and_b32 v5, 7, v1
    v_lshlrev_b32 v5, 3, v5
    v_add_u32 v5, 156160, v5
    v_and_b32 v6, 3, v1
    v_lshlrev_b32 v6, 18, v6
    v_bfe_u32 v9, v1, 2, 2
    v_lshl_add_u32 v6, v9, 13, v6
    s_and_b32 s96, s21, 1
    s_and_b32 s97, s12, 7
    s_lshr_b32 s98, s12, 3
    s_lshl3_add_u32 s99, s97, s98
    s_lshl_b32 s97, s99, 12
    s_lshr_b32 s98, s21, 1
    s_lshl_b32 s99, s98, 6
    s_add_u32 s98, s97, s99
    s_lshl4_add_u32 s97, s96, s98
    s_add_u32 s99, s97, 1048576
    s_add_u32 s16, s99, 2560
    s_waitcnt vmcnt(3)
    v_pk_add_f32 v[192:193], v[192:193], v[196:197]
    v_pk_add_f32 v[200:201], v[200:201], v[204:205]
    v_pk_add_f32 v[194:195], v[194:195], v[198:199]
    v_pk_add_f32 v[202:203], v[202:203], v[206:207]
    v_pk_add_f32 v[192:193], v[192:193], v[200:201]
    v_pk_add_f32 v[194:195], v[194:195], v[202:203]
    v_add_f32 v193, v193, v194
    v_add_f32 v197, v192, v195
    v_cmp_u_f32 vcc, v193, v197
    s_cbranch_vccz POK_40
PRE_41:
    buffer_load_dwordx4 v[192:195], v2, s[32:35], s14 offen sc1
    buffer_load_dwordx4 v[196:199], v2, s[32:35], s14 offen offset:1024 sc1
    buffer_load_dwordx4 v[200:203], v2, s[32:35], s14 offen offset:2048 sc1
    buffer_load_dwordx4 v[204:207], v2, s[32:35], s14 offen offset:3072 sc1
    s_waitcnt vmcnt(0)
    v_pk_add_f32 v[192:193], v[192:193], v[196:197]
    v_pk_add_f32 v[200:201], v[200:201], v[204:205]
    v_pk_add_f32 v[194:195], v[194:195], v[198:199]
    v_pk_add_f32 v[202:203], v[202:203], v[206:207]
    v_pk_add_f32 v[192:193], v[192:193], v[200:201]
    v_pk_add_f32 v[194:195], v[194:195], v[202:203]
    v_add_f32 v193, v193, v194
    v_add_f32 v197, v192, v195
    v_cmp_u_f32 vcc, v193, v197
    s_cbranch_vccz POK_40
    s_add_u32 s5, s5, 1
    s_cmp_lt_u32 s5, 200000
    s_cbranch_scc1 PRE_41
POK_40:
    v_mov_b32 v196, v195
    s_nop 1
    v_permlane32_swap_b32 v195, v196
    v_permlane32_swap_b32 v192, v193
    v_add_f32 v195, v195, v196
    v_add_f32 v192, v192, v193
    s_nop 1
    v_permlane16_swap_b32 v192, v195
    v_add_f32 v193, v192, v195
    v_add_f32 v195, v192, v195
    s_nop 1
    v_permlane16_swap_b32 v193, v195
    v_mov_b32 v192, v193
    v_mul_f32 v195, 0x3a800000, v195
    s_nop 0
    v_permlane32_swap_b32 v192, v193
    v_mul_f32 v192, 0x3a800000, v192
    v_fma_f32 v31, -v192, v192, v195
    v_cvt_pk_bf16_f32 v30, 0, v192
    v_max_f32 v31, 0, v31
    v_cvt_pk_bf16_f32 v31, 0, v31
    v_fma_f32 v193, -v30, v40, v193
    v_add_f32 v31, 0x3727c5ac, v31
    v_cvt_pk_bf16_f32 v31, 0, v31
    v_sqrt_f32 v31, v31
    s_nop 0
    v_cvt_pk_bf16_f32 v31, 0, v31
    v_rcp_f32 v31, v31
    s_nop 0
    v_mul_f32 v32, v193, v31
    v_ashrrev_i32 v196, 31, v32
    v_or_b32 v196, 0x80000000, v196
    v_xor_b32 v32, v32, v196
    s_mov_b32 s15, 0xfffff000
    v_and_or_b32 v32, v32, s15, v29
    s_nop 1
    v_max_u32_dpp v244, v32, v32 quad_perm:[1,0,3,2] row_mask:0xf bank_mask:0xf
    v_min_u32_dpp v245, v32, v32 quad_perm:[1,0,3,2] row_mask:0xf bank_mask:0xf
    s_nop 0
    v_min_u32_dpp v196, v244, v244 quad_perm:[2,3,0,1] row_mask:0xf bank_mask:0xf
    v_max_u32_dpp v245, v245, v245 quad_perm:[2,3,0,1] row_mask:0xf bank_mask:0xf
    v_max_u32_dpp v244, v244, v244 quad_perm:[2,3,0,1] row_mask:0xf bank_mask:0xf
    v_max_u32 v245, v245, v196
    s_nop 0
    v_min_u32_dpp v196, v244, v244 row_half_mirror row_mask:0xf bank_mask:0xf
    v_max_u32_dpp v245, v245, v245 row_half_mirror row_mask:0xf bank_mask:0xf
    v_max_u32_dpp v244, v244, v244 row_half_mirror row_mask:0xf bank_mask:0xf
    v_max_u32 v245, v245, v196
    s_nop 0
    v_min_u32_dpp v196, v244, v244 row_mirror row_mask:0xf bank_mask:0xf
    v_max_u32_dpp v245, v245, v245 row_mirror row_mask:0xf bank_mask:0xf
    v_max_u32_dpp v244, v244, v244 row_mirror row_mask:0xf bank_mask:0xf
    v_max_u32 v245, v245, v196
    ds_write_b64 v4, v[244:245]
    s_waitcnt lgkmcnt(0)
    s_barrier
    ds_read_b64 v[244:245], v5
    v_pk_add_f32 v[208:209], v[152:153], v[30:31] op_sel_hi:[1,0] neg_lo:[0,1] neg_hi:[0,1]
    v_pk_add_f32 v[210:211], v[154:155], v[30:31] op_sel_hi:[1,0] neg_lo:[0,1] neg_hi:[0,1]
    v_pk_add_f32 v[212:213], v[156:157], v[30:31] op_sel_hi:[1,0] neg_lo:[0,1] neg_hi:[0,1]
    v_pk_add_f32 v[214:215], v[158:159], v[30:31] op_sel_hi:[1,0] neg_lo:[0,1] neg_hi:[0,1]
    v_pk_add_f32 v[216:217], v[160:161], v[30:31] op_sel_hi:[1,0] neg_lo:[0,1] neg_hi:[0,1]
    v_pk_add_f32 v[218:219], v[162:163], v[30:31] op_sel_hi:[1,0] neg_lo:[0,1] neg_hi:[0,1]
    v_pk_add_f32 v[220:221], v[164:165], v[30:31] op_sel_hi:[1,0] neg_lo:[0,1] neg_hi:[0,1]
    v_pk_add_f32 v[222:223], v[166:167], v[30:31] op_sel_hi:[1,0] neg_lo:[0,1] neg_hi:[0,1]
    s_waitcnt lgkmcnt(0)
    v_min_u32_dpp v196, v244, v244 quad_perm:[1,0,3,2] row_mask:0xf bank_mask:0xf
    v_max_u32_dpp v245, v245, v245 quad_perm:[1,0,3,2] row_mask:0xf bank_mask:0xf
    v_max_u32_dpp v244, v244, v244 quad_perm:[1,0,3,2] row_mask:0xf bank_mask:0xf
    v_max_u32 v245, v245, v196
    s_nop 0
    v_min_u32_dpp v196, v244, v244 quad_perm:[2,3,0,1] row_mask:0xf bank_mask:0xf
    v_max_u32_dpp v245, v245, v245 quad_perm:[2,3,0,1] row_mask:0xf bank_mask:0xf
    v_max_u32_dpp v244, v244, v244 quad_perm:[2,3,0,1] row_mask:0xf bank_mask:0xf
    v_max_u32 v245, v245, v196
    s_nop 0
    v_min_u32_dpp v196, v244, v244 row_half_mirror row_mask:0xf bank_mask:0xf
    v_max_u32_dpp v245, v245, v245 row_half_mirror row_mask:0xf bank_mask:0xf
    v_max_u32_dpp v244, v244, v244 row_half_mirror row_mask:0xf bank_mask:0xf
    v_max_u32 v245, v245, v196
    v_cmp_eq_u32 s[88:89], v32, v245
    v_cmp_eq_u32 vcc, v32, v244
    v_or_b32 v246, 1, v245
    v_mov_b32 v245, s4
    v_mov_b32 v247, s4
    s_or_b64 s[84:85], vcc, s[88:89]
    s_cmp_lg_u32 s3, 0
    s_cbranch_scc1 L_NOF
    s_mov_b64 exec, 0xffff
    buffer_store_dwordx4 v[244:247], v6, s[32:35], s16 offen sc1
    s_mov_b64 exec, -1
L_NOF:
    s_cmp_eq_u64 s[84:85], 0
    s_cbranch_scc1 L_NOPR
    s_setprio 1
L_NOPR:
    s_lshl4_add_u32 s13, s3, 156288
    v_mov_b32 v4, s13
    v_and_b32 v5, 7, v1
    v_lshlrev_b32 v5, 4, v5
    v_add_u32 v5, 156288, v5
    s_load_dwordx8 s[24:31], s[32:33], s92 offset:2560 glc
    v_cvt_pk_bf16_f32 v208, 0, v208
    v_cvt_pk_bf16_f32 v209, 0, v209
    v_cvt_pk_bf16_f32 v210, 0, v210
    v_cvt_pk_bf16_f32 v211, 0, v211
    v_cvt_pk_bf16_f32 v212, 0, v212
    v_cvt_pk_bf16_f32 v213, 0, v213
    v_cvt_pk_bf16_f32 v214, 0, v214
    v_cvt_pk_bf16_f32 v215, 0, v215
    v_cvt_pk_bf16_f32 v216, 0, v216
    v_cvt_pk_bf16_f32 v217, 0, v217
    v_cvt_pk_bf16_f32 v218, 0, v218
    v_cvt_pk_bf16_f32 v219, 0, v219
    v_cvt_pk_bf16_f32 v220, 0, v220
    v_cvt_pk_bf16_f32 v221, 0, v221
    v_cvt_pk_bf16_f32 v222, 0, v222
    v_cvt_pk_bf16_f32 v223, 0, v223
    v_pk_mul_f32 v[208:209], v[30:31], v[208:209] op_sel:[1,0]
    v_pk_mul_f32 v[210:211], v[30:31], v[210:211] op_sel:[1,0]
    v_pk_mul_f32 v[212:213], v[30:31], v[212:213] op_sel:[1,0]
    v_pk_mul_f32 v[214:215], v[30:31], v[214:215] op_sel:[1,0]
    v_pk_mul_f32 v[216:217], v[30:31], v[216:217] op_sel:[1,0]
    v_pk_mul_f32 v[218:219], v[30:31], v[218:219] op_sel:[1,0]
    v_pk_mul_f32 v[220:221], v[30:31], v[220:221] op_sel:[1,0]
    v_pk_mul_f32 v[222:223], v[30:31], v[222:223] op_sel:[1,0]
    v_cvt_pk_bf16_f32 v208, 0, v208
    v_cvt_pk_bf16_f32 v209, 0, v209
    v_cvt_pk_bf16_f32 v210, 0, v210
    v_cvt_pk_bf16_f32 v211, 0, v211
    v_cvt_pk_bf16_f32 v212, 0, v212
    v_cvt_pk_bf16_f32 v213, 0, v213
    v_cvt_pk_bf16_f32 v214, 0, v214
    v_cvt_pk_bf16_f32 v215, 0, v215
    v_cvt_pk_bf16_f32 v216, 0, v216
    v_cvt_pk_bf16_f32 v217, 0, v217
    v_cvt_pk_bf16_f32 v218, 0, v218
    v_cvt_pk_bf16_f32 v219, 0, v219
    v_cvt_pk_bf16_f32 v220, 0, v220
    v_cvt_pk_bf16_f32 v221, 0, v221
    v_cvt_pk_bf16_f32 v222, 0, v222
    v_cvt_pk_bf16_f32 v223, 0, v223
    v_pk_mul_f32 v[208:209], v[208:209], v[168:169]
    v_pk_mul_f32 v[210:211], v[210:211], v[170:171]
    v_pk_mul_f32 v[212:213], v[212:213], v[172:173]
    v_pk_mul_f32 v[214:215], v[214:215], v[174:175]
    v_pk_mul_f32 v[216:217], v[216:217], v[176:177]
    v_pk_mul_f32 v[218:219], v[218:219], v[178:179]
    v_pk_mul_f32 v[220:221], v[220:221], v[180:181]
    v_pk_mul_f32 v[222:223], v[222:223], v[182:183]
    v_cvt_pk_bf16_f32 v208, 0, v208
    v_cvt_pk_bf16_f32 v209, 0, v209
    v_cvt_pk_bf16_f32 v210, 0, v210
    v_cvt_pk_bf16_f32 v211, 0, v211
    v_cvt_pk_bf16_f32 v212, 0, v212
    v_cvt_pk_bf16_f32 v213, 0, v213
    v_cvt_pk_bf16_f32 v214, 0, v214
    v_cvt_pk_bf16_f32 v215, 0, v215
    v_cvt_pk_bf16_f32 v216, 0, v216
    v_cvt_pk_bf16_f32 v217, 0, v217
    v_cvt_pk_bf16_f32 v218, 0, v218
    v_cvt_pk_bf16_f32 v219, 0, v219
    v_cvt_pk_bf16_f32 v220, 0, v220
    v_cvt_pk_bf16_f32 v221, 0, v221
    v_cvt_pk_bf16_f32 v222, 0, v222
    v_cvt_pk_bf16_f32 v223, 0, v223
    v_pk_add_f32 v[208:209], v[208:209], v[88:89]
    v_pk_add_f32 v[210:211], v[210:211], v[90:91]
    v_pk_add_f32 v[212:213], v[212:213], v[92:93]
    v_pk_add_f32 v[214:215], v[214:215], v[94:95]
    v_pk_add_f32 v[216:217], v[216:217], v[96:97]
    v_pk_add_f32 v[218:219], v[218:219], v[98:99]
    v_pk_add_f32 v[220:221], v[220:221], v[100:101]
    v_pk_add_f32 v[222:223], v[222:223], v[102:103]
    v_cvt_pk_bf16_f32 v224, v208, v209
    v_cvt_pk_bf16_f32 v225, v210, v211
    v_cvt_pk_bf16_f32 v226, v212, v213
    v_cvt_pk_bf16_f32 v227, v214, v215
    v_cvt_pk_bf16_f32 v228, v216, v217
    v_cvt_pk_bf16_f32 v229, v218, v219
    v_cvt_pk_bf16_f32 v230, v220, v221
    v_cvt_pk_bf16_f32 v231, v222, v223
    s_cmp_eq_u64 s[84:85], 0
    s_cbranch_scc1 L_NOCAND
    v_mfma_f32_16x16x32_bf16 v[240:243], v[184:187], v[224:227], 0
    v_mfma_f32_16x16x32_bf16 v[240:243], v[188:191], v[228:231], v[240:243]
    v_mov_b32 v232, v224
    v_mov_b32 v233, v225
    v_mov_b32 v234, v226
    v_mov_b32 v235, v227
    v_mov_b32 v236, v228
    v_mov_b32 v237, v229
    v_mov_b32 v238, v230
    v_mov_b32 v239, v231
    s_lshl_b32 s96, s21, 14
    s_lshl_b32 s97, s12, 9
    s_add_u32 s98, s96, s97
    s_add_u32 s15, s98, 13631488
    v_lshrrev_b32 v7, 4, v1
    v_lshlrev_b32 v7, 4, v7
    v_add_u32 v8, 8192, v7
    v_permlane32_swap_b32 v232, v234
    v_permlane32_swap_b32 v233, v235
    v_permlane32_swap_b32 v236, v238
    v_permlane32_swap_b32 v237, v239
    v_permlane32_swap_b32 v12, v14
    v_permlane32_swap_b32 v13, v15
    v_permlane32_swap_b32 v16, v18
    v_permlane32_swap_b32 v17, v19
    v_cndmask_b32 v7, v7, v8, s[88:89]
    s_mov_b64 exec, s[84:85]
    buffer_store_dwordx4 v[232:235], v7, s[32:35], s15 offen sc1
    buffer_store_dwordx4 v[236:239], v7, s[32:35], s15 offen offset:64 sc1
    s_mov_b32 exec_lo, 0
    s_and_b32 exec_hi, s85, 0xffff0000
    buffer_store_dword v240, v7, s[32:35], s15 offen offset:208 sc1
    s_mov_b64 exec, s[84:85]
    buffer_store_dwordx4 v[12:15], v7, s[32:35], s15 offen offset:128 sc1
    buffer_store_dwordx4 v[16:19], v7, s[32:35], s15 offen offset:192 sc1
    s_mov_b64 exec, -1
    s_setprio 0
L_NOCAND:
    s_add_u32 s82, s81, 8192
    s_lshl2_add_u32 m0, s83, 67584
    s_nop 0
    buffer_load_dwordx4 v253, s[60:63], s82 offen nt lds
    s_add_u32 s82, s81, 12288
    s_lshl2_add_u32 m0, s83, 68608
    s_nop 0
    buffer_load_dwordx4 v253, s[60:63], s82 offen nt lds
    v_lshlrev_b32 v208, 16, v224
    v_and_b32 v209, s6, v224
    v_lshlrev_b32 v210, 16, v225
    v_and_b32 v211, s6, v225
    v_lshlrev_b32 v212, 16, v226
    v_and_b32 v213, s6, v226
    v_lshlrev_b32 v214, 16, v227
    v_and_b32 v215, s6, v227
    v_lshlrev_b32 v216, 16, v228
    v_and_b32 v217, s6, v228
    v_lshlrev_b32 v218, 16, v229
    v_and_b32 v219, s6, v229
    v_lshlrev_b32 v220, 16, v230
    v_and_b32 v221, s6, v230
    v_lshlrev_b32 v222, 16, v231
    v_and_b32 v223, s6, v231
    v_pk_mul_f32 v[208:209], v[208:209], v[104:105]
    v_pk_mul_f32 v[210:211], v[210:211], v[106:107]
    v_pk_mul_f32 v[212:213], v[212:213], v[108:109]
    v_pk_mul_f32 v[214:215], v[214:215], v[110:111]
    v_pk_mul_f32 v[216:217], v[216:217], v[112:113]
    v_pk_mul_f32 v[218:219], v[218:219], v[114:115]
    v_pk_mul_f32 v[220:221], v[220:221], v[116:117]
    v_pk_mul_f32 v[222:223], v[222:223], v[118:119]
    v_cvt_pk_bf16_f32 v208, 0, v208
    v_cvt_pk_bf16_f32 v209, 0, v209
    v_cvt_pk_bf16_f32 v210, 0, v210
    v_cvt_pk_bf16_f32 v211, 0, v211
    v_cvt_pk_bf16_f32 v212, 0, v212
    v_cvt_pk_bf16_f32 v213, 0, v213
    v_cvt_pk_bf16_f32 v214, 0, v214
    v_cvt_pk_bf16_f32 v215, 0, v215
    v_cvt_pk_bf16_f32 v216, 0, v216
    v_cvt_pk_bf16_f32 v217, 0, v217
    v_cvt_pk_bf16_f32 v218, 0, v218
    v_cvt_pk_bf16_f32 v219, 0, v219
    v_cvt_pk_bf16_f32 v220, 0, v220
    v_cvt_pk_bf16_f32 v221, 0, v221
    v_cvt_pk_bf16_f32 v222, 0, v222
    v_cvt_pk_bf16_f32 v223, 0, v223
    s_branch SCHK_43
SPOLL_42:
    s_load_dwordx8 s[24:31], s[32:33], s92 offset:2560 glc
SCHK_43:
    s_add_u32 s5, s5, 1
    s_cmp_ge_u32 s5, 200000
    s_waitcnt lgkmcnt(0)
    s_cbranch_scc1 SDONE_44
    s_cmp_lg_u32 s25, s4
    s_cbranch_scc1 SPOLL_42
    s_cmp_lg_u32 s27, s4
    s_cbranch_scc1 SPOLL_42
    s_cmp_lg_u32 s29, s4
    s_cbranch_scc1 SPOLL_42
    s_cmp_lg_u32 s31, s4
    s_cbranch_scc1 SPOLL_42
SDONE_44:
    s_min_u32 s25, s24, s28
    s_min_u32 s27, s26, s28
    s_min_u32 s29, s24, s30
    s_max_u32 s24, s24, s28
    s_max_u32 s26, s26, s30
    s_max_u32 s27, s27, s29
    s_max_u32 s25, s25, s26
    v_mov_b32 v244, s24
    v_mov_b32 v246, s27
    v_mov_b32 v245, s25
    ds_write_b128 v4, v[244:247]
    s_waitcnt vmcnt(4)
    s_waitcnt lgkmcnt(0)
    s_barrier
    ds_read_b128 v[244:247], v5
    v_and_b32 v8, 8, v1
    v_cmp_eq_u32 s[22:23], 0, v8
    v_cmp_gt_u32 s[24:25], 16, v1
    v_cmp_gt_u32 s[26:27], 32, v1
    s_waitcnt lgkmcnt(0)
    v_min_u32_dpp v192, v244, v244 quad_perm:[1,0,3,2] row_mask:0xf bank_mask:0xf
    v_min_u32_dpp v193, v245, v244 quad_perm:[1,0,3,2] row_mask:0xf bank_mask:0xf
    v_min_u32_dpp v194, v244, v245 quad_perm:[1,0,3,2] row_mask:0xf bank_mask:0xf
    v_max_u32_dpp v246, v246, v246 quad_perm:[1,0,3,2] row_mask:0xf bank_mask:0xf
    v_max_u32_dpp v245, v245, v245 quad_perm:[1,0,3,2] row_mask:0xf bank_mask:0xf
    v_max_u32_dpp v244, v244, v244 quad_perm:[1,0,3,2] row_mask:0xf bank_mask:0xf
    v_max3_u32 v246, v246, v193, v194
    v_max_u32 v245, v245, v192
    v_min_u32_dpp v192, v244, v244 quad_perm:[2,3,0,1] row_mask:0xf bank_mask:0xf
    s_nop 0
    v_min_u32_dpp v193, v245, v244 quad_perm:[2,3,0,1] row_mask:0xf bank_mask:0xf
    v_min_u32_dpp v194, v244, v245 quad_perm:[2,3,0,1] row_mask:0xf bank_mask:0xf
    v_max_u32_dpp v246, v246, v246 quad_perm:[2,3,0,1] row_mask:0xf bank_mask:0xf
    v_max_u32_dpp v245, v245, v245 quad_perm:[2,3,0,1] row_mask:0xf bank_mask:0xf
    v_max_u32_dpp v244, v244, v244 quad_perm:[2,3,0,1] row_mask:0xf bank_mask:0xf
    v_max3_u32 v246, v246, v193, v194
    v_max_u32 v245, v245, v192
    v_min_u32_dpp v192, v244, v244 row_half_mirror row_mask:0xf bank_mask:0xf
    s_nop 0
    v_min_u32_dpp v193, v245, v244 row_half_mirror row_mask:0xf bank_mask:0xf
    v_min_u32_dpp v194, v244, v245 row_half_mirror row_mask:0xf bank_mask:0xf
    v_max_u32_dpp v246, v246, v246 row_half_mirror row_mask:0xf bank_mask:0xf
    v_max_u32_dpp v245, v245, v245 row_half_mirror row_mask:0xf bank_mask:0xf
    v_max_u32_dpp v244, v244, v244 row_half_mirror row_mask:0xf bank_mask:0xf
    v_max3_u32 v246, v246, v193, v194
    v_max_u32 v245, v245, v192
    v_cndmask_b32 v192, v245, v244, s[22:23]
    v_cndmask_b32 v201, v246, v245, s[26:27]
    v_and_b32 v193, 31, v246
    v_and_b32 v192, 31, v192
    v_cndmask_b32 v201, v201, v244, s[24:25]
    v_lshl_add_u32 v4, v192, 13, v52
    v_lshl_add_u32 v5, v193, 13, v52
    v_and_b32 v194, 31, v201
    v_lshl_add_u32 v6, v194, 13, v53
    buffer_load_dwordx4 v[192:195], v4, s[32:35], 0 offen sc1
    buffer_load_dwordx4 v[196:199], v5, s[32:35], 0 offen sc1
    buffer_load_dword v200, v6, s[32:35], 0 offen sc1
    v_readfirstlane_b32 s91, v244
    v_readfirstlane_b32 s94, v245
    v_readfirstlane_b32 s95, v246
    ds_read_b64_tr_b16 v[56:57], v34
    ds_read_b64_tr_b16 v[58:59], v34 offset:512
    ds_read_b64_tr_b16 v[60:61], v34 offset:1024
    ds_read_b64_tr_b16 v[62:63], v34 offset:1536
    ds_read_b64_tr_b16 v[64:65], v34 offset:2048
    ds_read_b64_tr_b16 v[66:67], v34 offset:2560
    ds_read_b64_tr_b16 v[68:69], v34 offset:3072
    ds_read_b64_tr_b16 v[70:71], v34 offset:3584
    ds_read_b64_tr_b16 v[72:73], v34 offset:4096
    ds_read_b64_tr_b16 v[74:75], v34 offset:4608
    ds_read_b64_tr_b16 v[76:77], v34 offset:5120
    ds_read_b64_tr_b16 v[78:79], v34 offset:5632
    ds_read_b64_tr_b16 v[80:81], v34 offset:6144
    ds_read_b64_tr_b16 v[82:83], v34 offset:6656
    ds_read_b64_tr_b16 v[84:85], v34 offset:7168
    ds_read_b64_tr_b16 v[86:87], v34 offset:7680
    s_lshl_b32 s96, s3, 11
    s_add_u32 s13, s96, 98304
    v_lshrrev_b32 v44, 4, v1
    v_lshlrev_b32 v44, 4, v44
    v_and_b32 v45, 7, v1
    v_lshlrev_b32 v45, 4, v45
    v_xor_b32 v44, v44, v45
    v_and_b32 v46, 15, v1
    v_lshl_add_u32 v46, v46, 7, s13
    v_add_u32 v44, v44, v46
    v_xor_b32 v46, 64, v44
    v_lshrrev_b32 v47, 3, v1
    v_lshlrev_b32 v47, 4, v47
    v_xor_b32 v45, v47, v45
    v_lshrrev_b32 v47, 3, v1
    v_lshl_add_u32 v47, v47, 7, s13
    v_add_u32 v45, v45, v47
    s_lshl_b32 s96, s21, 7
    s_sub_u32 s97, 2047, s96
    s_lshl_b32 s98, s3, 4
    s_sub_u32 s13, s97, s98
    v_lshrrev_b32 v43, 3, v1
    v_sub_u32 v42, s13, v43
    v_subrev_u32 v43, 8, v42
    v_lshrrev_b32 v33, 3, v1
    v_lshlrev_b32 v33, 11, v33
    v_and_b32 v9, 7, v1
    v_lshl_add_u32 v33, v9, 4, v33
    v_pk_add_f32 v[208:209], v[208:209], v[152:153]
    v_pk_add_f32 v[210:211], v[210:211], v[154:155]
    v_pk_add_f32 v[212:213], v[212:213], v[156:157]
    v_pk_add_f32 v[214:215], v[214:215], v[158:159]
    v_pk_add_f32 v[216:217], v[216:217], v[160:161]
    v_pk_add_f32 v[218:219], v[218:219], v[162:163]
    v_pk_add_f32 v[220:221], v[220:221], v[164:165]
    v_pk_add_f32 v[222:223], v[222:223], v[166:167]
    v_cvt_pk_bf16_f32 v232, v208, v209
    v_cvt_pk_bf16_f32 v233, v210, v211
    v_cvt_pk_bf16_f32 v234, v212, v213
    v_cvt_pk_bf16_f32 v235, v214, v215
    v_cvt_pk_bf16_f32 v236, v216, v217
    v_cvt_pk_bf16_f32 v237, v218, v219
    v_cvt_pk_bf16_f32 v238, v220, v221
    v_cvt_pk_bf16_f32 v239, v222, v223
    v_permlane32_swap_b32 v232, v234
    v_permlane32_swap_b32 v233, v235
    v_permlane32_swap_b32 v236, v238
    v_permlane32_swap_b32 v237, v239
    ds_write_b128 v44, v[232:235]
    ds_write_b128 v46, v[236:239]
    ds_read_b128 v[232:235], v45
    ds_read_b128 v[236:239], v45 offset:1024
    s_waitcnt lgkmcnt(0)
    v_bfe_u32 v7, v201, 1, 4
    v_bfe_u32 v201, v201, 5, 7
    v_lshl_or_b32 v201, v7, 7, v201
    v_xor_b32 v201, 0x7ff, v201
    s_waitcnt vmcnt(0)
    v_max3_u32 v7, v192, v196, v200
    v_cmp_eq_u32 vcc, -1, v7
    s_cbranch_vccz POK_46
PRE_47:
    buffer_load_dwordx4 v[192:195], v4, s[32:35], 0 offen sc1
    buffer_load_dwordx4 v[196:199], v5, s[32:35], 0 offen sc1
    buffer_load_dword v200, v6, s[32:35], 0 offen sc1
    s_waitcnt vmcnt(0)
    v_max3_u32 v7, v192, v196, v200
    v_cmp_eq_u32 vcc, -1, v7
    s_cbranch_vccz POK_46
    s_add_u32 s5, s5, 1
    s_cmp_lt_u32 s5, 200000
    s_cbranch_scc1 PRE_47
POK_46:
    v_add_f32_dpp v200, v200, v200 quad_perm:[1,0,3,2] row_mask:0xf bank_mask:0xf
    s_nop 1
    v_add_f32_dpp v200, v200, v200 quad_perm:[2,3,0,1] row_mask:0xf bank_mask:0xf
    s_nop 1
    v_add_f32_dpp v200, v200, v200 row_half_mirror row_mask:0xf bank_mask:0xf
    s_nop 1
    v_add_f32_dpp v200, v200, v200 row_mirror row_mask:0xf bank_mask:0xf
    v_cvt_pk_bf16_f32 v200, 0, v200
    v_ashrrev_i32 v7, 31, v200
    v_or_b32 v7, 0x80000000, v7
    v_xor_b32 v200, v200, v7
    v_lshrrev_b32 v200, 16, v200
    v_lshl_or_b32 v200, v200, 11, v201
    s_nop 0
    v_readlane_b32 s24, v200, 0
    v_readlane_b32 s25, v200, 16
    v_readlane_b32 s26, v200, 32
    s_not_b64 s[28:29], s[22:23]
    s_cmp_lt_u32 s24, s25
    s_cselect_b64 s[28:29], s[22:23], s[28:29]
    s_cselect_b32 s27, s24, s25
    s_cmp_gt_u32 s26, s27
    s_cselect_b64 vcc, s[28:29], 0
    v_cndmask_b32 v192, v192, v196, vcc
    v_cndmask_b32 v193, v193, v197, vcc
    v_cndmask_b32 v194, v194, v198, vcc
    v_cndmask_b32 v195, v195, v199, vcc
    s_bitcmp1_b32 vcc_lo, 0
    s_cselect_b32 s24, s26, s24
    s_cselect_b32 s19, s17, s19
    s_cselect_b32 s17, s95, s91
    s_bitcmp1_b32 vcc_lo, 8
    s_cselect_b32 s25, s26, s25
    s_cselect_b32 s19, s18, s19
    s_cselect_b32 s18, s95, s94
    s_waitcnt lgkmcnt(0)
    v_mfma_f32_16x16x32_bf16 v[136:139], v[192:195], v[56:59], 0
    v_mfma_f32_16x16x32_bf16 v[140:143], v[192:195], v[60:63], 0
    v_mfma_f32_16x16x32_bf16 v[144:147], v[192:195], v[64:67], 0
    v_mfma_f32_16x16x32_bf16 v[148:151], v[192:195], v[68:71], 0
    v_mfma_f32_16x16x32_bf16 v[168:171], v[192:195], v[72:75], 0
    v_mfma_f32_16x16x32_bf16 v[172:175], v[192:195], v[76:79], 0
    v_mfma_f32_16x16x32_bf16 v[176:179], v[192:195], v[80:83], 0
    v_mfma_f32_16x16x32_bf16 v[180:183], v[192:195], v[84:87], 0
    s_nop 1
    v_add_f32 v196, v136, v141
    s_nop 0
    v_add_f32 v197, v146, v151
    s_nop 0
    v_add_f32 v198, v168, v173
    s_nop 0
    v_add_f32 v199, v178, v183
    v_add_f32 v196, v196, v197
    v_add_f32 v198, v198, v199
    v_mov_b32 v197, s4
    s_nop 0
    v_permlane16_swap_b32 v198, v199
    s_cmp_ge_u32 s9, 28
    s_cbranch_scc1 L_NOHP
    v_add_f32 v196, v196, v199
    s_mov_b32 exec_lo, 0xffff
    s_mov_b32 exec_hi, 0xffff
    buffer_store_dwordx2 v[196:197], v54, s[32:35], s73 offen sc1
    s_mov_b64 exec, -1
L_NOHP:
    s_and_b32 s68, s24, 2047
    s_and_b32 s69, s25, 2047
    s_waitcnt lgkmcnt(0)
    s_cmp_lg_u32 s93, 7
    s_cbranch_scc1 L_NONON
    v_mov_b32 v6, s4
    v_mov_b32 v7, 0
    s_mov_b64 exec, 1
    buffer_store_dword v6, v7, s[32:35], 0 offen sc1
    s_mov_b64 exec, -1
L_NONON:
    s_cmp_ge_u32 s9, 28
    s_cbranch_scc1 L_FIN3
    v_bfe_u32 v192, v1, 2, 1
    v_lshlrev_b32 v192, 7, v192
    v_lshrrev_b32 v9, 5, v1
    v_lshl_add_u32 v192, v9, 4, v192
    v_add_u32 v192, 156672, v192
    v_lshrrev_b32 v193, 4, v1
    v_mul_u32_u24 v193, 7168, v193
    v_and_b32 v9, 15, v1
    v_lshl_add_u32 v193, v9, 3, v193
    s_lshl3_add_u32 s96, s75, s3
    s_mul_i32 s97, s96, 28672
    s_lshl_b32 s98, s74, 7
    s_add_u32 s99, s97, s98
    s_add_u32 s80, s99, 22020096
    v_and_b32 v194, 1, v1
    v_lshlrev_b32 v194, 13, v194
    v_bfe_u32 v9, v1, 1, 1
    v_lshl_add_u32 v194, v9, 18, v194
    s_lshr_b32 s96, s9, 2
    s_and_b32 s97, s75, 1
    s_lshr_b32 s98, s3, 1
    s_lshl2_add_u32 s99, s97, s98
    s_and_b32 s97, s3, 1
    s_lshr_b32 s98, s75, 1
    s_lshl2_add_u32 s97, s97, s98
    s_lshl3_add_u32 s98, s99, s97
    s_lshl_b32 s99, s98, 12
    s_lshl_b32 s97, s8, 6
    s_add_u32 s98, s99, s97
    s_lshl2_add_u32 s99, s96, s98
    s_add_u32 s97, s99, 1048576
    s_add_u32 s81, s97, 3072
    s_cmp_lt_u32 s3, 4
    s_cbranch_scc1 L_HW
    s_barrier
    ds_read_b64_tr_b16 v[120:121], v35
    ds_read_b64_tr_b16 v[122:123], v35 offset:1024
    ds_read_b64_tr_b16 v[124:125], v35 offset:8192
    ds_read_b64_tr_b16 v[126:127], v35 offset:9216
    ds_read_b64_tr_b16 v[128:129], v35 offset:16384
    ds_read_b64_tr_b16 v[130:131], v35 offset:17408
    ds_read_b64_tr_b16 v[132:133], v35 offset:24576
    ds_read_b64_tr_b16 v[134:135], v35 offset:25600
    s_cmp_lg_u32 s3, 7
    s_cbranch_scc1 L_NOH
    s_bitcmp1_b32 s9, 3
    s_cselect_b32 s15, s25, s24
    s_cselect_b32 s17, s18, s17
    s_andn2_b32 s18, 2047, s15
    s_lshr_b32 s96, s8, 1
    s_lshl2_add_u32 s19, s12, s96
    s_lshr_b32 s96, s19, 1
    s_lshr_b32 s97, s9, 3
    s_lshl_b32 s98, s97, 1
    s_lshl2_add_u32 s99, s96, s98
    s_and_b32 s97, s19, 1
    s_add_u32 s96, s99, s97
    s_mul_i32 s98, s96, 7168
    s_add_u32 s20, s98, 22020096
    s_lshl_b32 s96, s18, 11
    s_lshl_b32 s97, s19, 5
    s_add_u32 s82, s96, s97
    v_and_b32 v10, 7, v1
    v_lshlrev_b32 v10, 2, v10
    s_lshr_b32 s96, s8, 1
    s_lshl_b32 s97, s96, 6
    s_add_u32 s13, s97, 157184
    v_and_b32 v5, 7, v1
    v_lshl_add_u32 v5, v5, 3, s13
    ds_read_b64 v[206:207], v5
    s_and_b32 s96, s17, 31
L_PAD10:
    s_cbranch_execz L_RET10
    s_lshl_b32 s97, s96, 13
    s_lshl_b32 s98, s12, 9
    s_add_u32 s99, s97, s98
    s_lshr_b32 s96, s8, 1
    s_lshl_b32 s97, s96, 5
    s_add_u32 s98, s99, s97
    s_add_u32 s91, s98, 13631488
    s_lshr_b32 s13, s15, 11
    s_lshl_b32 s13, s13, 16
    s_ashr_i32 s15, s13, 31
    s_andn2_b32 s15, 0x7fff0000, s15
    s_or_b32 s15, s15, 0x80000000
    s_xor_b32 s13, s13, s15
    v_mov_b32 v204, s13
    v_mul_f32 v204, s7, v204
    v_exp_f32 v204, -v204
    s_nop 0
    v_add_f32 v204, 1.0, v204
    v_rcp_f32 v204, v204
    s_nop 0
    v_cvt_pk_bf16_f32 v204, 0, v204
    v_mov_b32 v5, s4
    v_not_b32 v6, v5
POLL_48:
    buffer_load_dword v244, v10, s[32:35], s91 offen sc1
    buffer_load_dword v245, v10, s[32:35], s91 offen offset:128 sc1
    s_waitcnt vmcnt(0)
    v_max_u32 v246, v244, v245
    v_cmp_ne_u32 vcc, -1, v246
    s_nop 1
    v_cndmask_b32 v246, v6, v5, vcc
    v_cmp_ne_u32 vcc, s4, v246
    s_cbranch_vccz PDONE_49
    s_add_u32 s5, s5, 1
    s_cmp_lt_u32 s5, 200000
    s_cbranch_scc1 POLL_48
PDONE_49:
    v_lshlrev_b32 v246, 16, v245
    v_and_b32 v247, s6, v245
    v_and_b32 v245, s6, v244
    v_lshlrev_b32 v244, 16, v244
    s_branch L_NOH
L_HW:
    s_lshl_b32 s96, s3, 8
    s_add_u32 s13, s96, s72
    v_lshrrev_b32 v4, 4, v1
    v_lshlrev_b32 v4, 11, v4
    v_and_b32 v9, 15, v1
    v_lshl_add_u32 v4, v9, 4, v4
    s_lshl_b32 s96, s3, 5
    s_add_u32 s15, s96, 156672
    v_lshrrev_b32 v5, 5, v1
    v_lshl_add_u32 v5, v5, 7, s15
    v_bfe_u32 v9, v1, 2, 1
    v_lshl_add_u32 v5, v9, 4, v5
    v_bfe_u32 v9, v1, 1, 1
    v_lshl_add_u32 v5, v9, 3, v5
    v_bfe_u32 v9, v1, 3, 1
    v_lshl_add_u32 v5, v9, 2, v5
    v_and_b32 v9, 1, v1
    v_lshl_add_u32 v5, v9, 1, v5
    s_load_dword s24, s[32:33], s13 offset:1276 glc
    s_load_dword s25, s[32:33], s13 offset:3324 glc
    s_load_dword s26, s[32:33], s13 offset:5372 glc
    s_load_dword s27, s[32:33], s13 offset:7420 glc
    s_barrier
    ds_read_b64_tr_b16 v[120:121], v35
    ds_read_b64_tr_b16 v[122:123], v35 offset:1024
    ds_read_b64_tr_b16 v[124:125], v35 offset:8192
    ds_read_b64_tr_b16 v[126:127], v35 offset:9216
    ds_read_b64_tr_b16 v[128:129], v35 offset:16384
    ds_read_b64_tr_b16 v[130:131], v35 offset:17408
    ds_read_b64_tr_b16 v[132:133], v35 offset:24576
    ds_read_b64_tr_b16 v[134:135], v35 offset:25600
    s_branch SCHK_51
SPOLL_50:
    s_load_dword s24, s[32:33], s13 offset:1276 glc
    s_load_dword s25, s[32:33], s13 offset:3324 glc
    s_load_dword s26, s[32:33], s13 offset:5372 glc
    s_load_dword s27, s[32:33], s13 offset:7420 glc
SCHK_51:
    s_add_u32 s5, s5, 1
    s_cmp_ge_u32 s5, 200000
    s_waitcnt lgkmcnt(0)
    s_cbranch_scc1 SDONE_52
    s_cmp_lg_u32 s24, s4
    s_cbranch_scc1 SPOLL_50
    s_cmp_lg_u32 s25, s4
    s_cbranch_scc1 SPOLL_50
    s_cmp_lg_u32 s26, s4
    s_cbranch_scc1 SPOLL_50
    s_cmp_lg_u32 s27, s4
    s_cbranch_scc1 SPOLL_50
SDONE_52:
POLL_53:
    buffer_load_dwordx4 v[88:91], v4, s[32:35], s13 offen sc1
    buffer_load_dwordx4 v[92:95], v4, s[32:35], s13 offen offset:1024 sc1
    s_waitcnt vmcnt(0)
    v_bitop3_b32 v6, v89, v91, s4 bitop3:0x7e
    v_bitop3_b32 v6, v6, v93, s4 bitop3:0xf6
    v_bitop3_b32 v6, v6, v95, s4 bitop3:0xf6
    v_cmp_ne_u32 vcc, 0, v6
    s_cbranch_vccz PDONE_54
    s_add_u32 s5, s5, 1
    s_cmp_lt_u32 s5, 200000
    s_cbranch_scc1 POLL_53
PDONE_54:
    v_permlane32_swap_b32 v88, v90
    v_permlane32_swap_b32 v92, v94
    v_add_f32 v88, v88, v90
    v_add_f32 v92, v92, v94
    v_mov_b32 v90, v88
    v_mov_b32 v94, v92
    s_nop 0
    v_permlane16_swap_b32 v88, v90
    v_permlane16_swap_b32 v92, v94
    v_add_f32 v88, v88, v90
    v_add_f32 v92, v92, v94
    v_cvt_pk_bf16_f32 v88, 0, v88
    v_cvt_pk_bf16_f32 v92, 0, v92
    v_mul_f32 v6, s7, v88
    v_exp_f32 v6, -v6
    s_nop 0
    v_add_f32 v6, 1.0, v6
    v_rcp_f32 v6, v6
    s_nop 0
    v_mul_f32 v88, v88, v6
    v_cvt_pk_bf16_f32 v88, 0, v88
    v_mul_f32 v88, v88, v92
    v_cvt_pk_bf16_f32 v88, v88, v88
    ds_write_b16 v5, v88
L_NOH:
    s_waitcnt lgkmcnt(0)
    s_barrier
    ds_read_b128 v[88:91], v192
    ds_read_b128 v[92:95], v192 offset:32
    ds_read_b128 v[96:99], v192 offset:64
    ds_read_b128 v[100:103], v192 offset:96
    s_waitcnt lgkmcnt(3)
    v_mfma_f32_32x32x16_bf16 v[208:223], v[88:91], v[120:123], 0
    s_waitcnt lgkmcnt(2)
    v_mfma_f32_32x32x16_bf16 v[208:223], v[92:95], v[124:127], v[208:223]
    s_waitcnt lgkmcnt(1)
    v_mfma_f32_32x32x16_bf16 v[208:223], v[96:99], v[128:131], v[208:223]
    s_waitcnt lgkmcnt(0)
    v_mfma_f32_32x32x16_bf16 v[208:223], v[100:103], v[132:135], v[208:223]
    s_nop 11
    v_mov_b32 v209, s4
    buffer_store_dwordx2 v[208:209], v193, s[32:35], s80 offen sc1
    s_mov_b64 exec, 15
    buffer_store_dword v209, v194, s[32:35], s81 offen sc1
    s_mov_b64 exec, -1
    s_barrier
    s_branch L_FIN2
L_FIN3:
    s_waitcnt lgkmcnt(0)
L_FIN2:
    v_cmp_ne_u32 vcc, s68, v42
    v_cmp_ne_u32 s[22:23], s69, v42
    s_nop 0
    s_and_b64 exec, vcc, s[22:23]
    buffer_store_dwordx4 v[232:235], v33, s[64:67], s70 offen sc1
    s_mov_b64 exec, -1
    v_cmp_ne_u32 vcc, s68, v43
    v_cmp_ne_u32 s[22:23], s69, v43
    s_nop 0
    s_and_b64 exec, vcc, s[22:23]
    buffer_store_dwordx4 v[236:239], v33, s[64:67], s71 offen sc1
    s_mov_b64 exec, -1
    s_cmp_ge_u32 s9, 16
    s_cbranch_scc1 L_FIN
SPOLL_55:
    s_load_dwordx8 s[24:31], s[32:33], s92 offset:3072 glc
SCHK_56:
    s_add_u32 s5, s5, 1
    s_cmp_ge_u32 s5, 200000
    s_waitcnt lgkmcnt(0)
    s_cbranch_scc1 SDONE_57
    s_cmp_lg_u32 s24, s4
    s_cbranch_scc1 SPOLL_55
    s_cmp_lg_u32 s25, s4
    s_cbranch_scc1 SPOLL_55
    s_cmp_lg_u32 s26, s4
    s_cbranch_scc1 SPOLL_55
    s_cmp_lg_u32 s27, s4
    s_cbranch_scc1 SPOLL_55
    s_cmp_lg_u32 s28, s4
    s_cbranch_scc1 SPOLL_55
    s_cmp_lg_u32 s29, s4
    s_cbranch_scc1 SPOLL_55
    s_cmp_lg_u32 s30, s4
    s_cbranch_scc1 SPOLL_55
SDONE_57:
    s_barrier
    s_cmp_lg_u32 s3, 7
    s_cbranch_scc1 L_FIN
    s_add_u32 s13, s20, 4096
POLL_58:
    buffer_load_dwordx4 v[88:91], v2, s[32:35], s20 offen sc1
    buffer_load_dwordx4 v[92:95], v2, s[32:35], s20 offen offset:1024 sc1
    buffer_load_dwordx4 v[96:99], v2, s[32:35], s20 offen offset:2048 sc1
    buffer_load_dwordx4 v[100:103], v2, s[32:35], s20 offen offset:3072 sc1
    buffer_load_dwordx4 v[104:107], v2, s[32:35], s13 offen sc1
    buffer_load_dwordx4 v[108:111], v2, s[32:35], s13 offen offset:1024 sc1
    buffer_load_dwordx4 v[112:115], v2, s[32:35], s13 offen offset:2048 sc1
    s_waitcnt vmcnt(0)
    v_bitop3_b32 v4, v89, v91, s4 bitop3:0x7e
    v_bitop3_b32 v4, v4, v93, s4 bitop3:0xf6
    v_bitop3_b32 v4, v4, v95, s4 bitop3:0xf6
    v_bitop3_b32 v4, v4, v97, s4 bitop3:0xf6
    v_bitop3_b32 v4, v4, v99, s4 bitop3:0xf6
    v_bitop3_b32 v4, v4, v101, s4 bitop3:0xf6
    v_bitop3_b32 v4, v4, v103, s4 bitop3:0xf6
    v_bitop3_b32 v4, v4, v105, s4 bitop3:0xf6
    v_bitop3_b32 v4, v4, v107, s4 bitop3:0xf6
    v_bitop3_b32 v4, v4, v109, s4 bitop3:0xf6
    v_bitop3_b32 v4, v4, v111, s4 bitop3:0xf6
    v_bitop3_b32 v4, v4, v113, s4 bitop3:0xf6
    v_bitop3_b32 v4, v4, v115, s4 bitop3:0xf6
    v_cmp_ne_u32 vcc, 0, v4
    s_cbranch_vccz PDONE_59
    s_add_u32 s5, s5, 1
    s_cmp_lt_u32 s5, 200000
    s_cbranch_scc1 POLL_58
PDONE_59:
    v_add_f32 v88, v88, v92
    v_add_f32 v90, v90, v94
    v_add_f32 v96, v96, v100
    v_add_f32 v98, v98, v102
    v_add_f32 v104, v104, v108
    v_add_f32 v106, v106, v110
    v_add_f32 v88, v88, v96
    v_add_f32 v90, v90, v98
    v_add_f32 v104, v104, v112
    v_add_f32 v106, v106, v114
    v_add_f32 v88, v88, v104
    v_add_f32 v89, v90, v106
    s_nop 1
    v_permlane32_swap_b32 v88, v89
    v_add_f32 v88, v88, v89
    s_nop 1
    v_add_f32_dpp v88, v88, v88 row_ror:8 row_mask:0xf bank_mask:0xf
    v_mov_b32 v89, v88
    s_nop 1
    v_permlane16_swap_b32 v88, v89
    v_add_f32 v89, v88, v89
    v_cvt_pk_bf16_f32 v88, 0, v89
    v_cvt_pk_bf16_f32 v89, 0, v89
    s_nop 1
    v_permlane32_swap_b32 v88, v89
    v_pk_mul_f32 v[88:89], v[88:89], v[204:205] op_sel_hi:[1,0]
    v_cvt_pk_bf16_f32 v88, 0, v88
    v_cvt_pk_bf16_f32 v89, 0, v89
    v_pk_add_f32 v[88:89], v[88:89], v[244:245]
    v_cvt_pk_bf16_f32 v88, 0, v88
    v_cvt_pk_bf16_f32 v89, 0, v89
    v_pk_mul_f32 v[88:89], v[88:89], v[206:207]
    v_cvt_pk_bf16_f32 v88, 0, v88
    v_cvt_pk_bf16_f32 v89, 0, v89
    v_pk_add_f32 v[88:89], v[88:89], v[246:247]
    v_cvt_pk_bf16_f32 v88, v88, v89
    s_mov_b64 exec, 0xff
    buffer_store_dword v88, v10, s[64:67], s82 offen
    s_mov_b64 exec, -1
L_FIN:
L_END:
    s_endpgm
.p2align 10
.fill 768, 4, 0xbf800000
.section .rodata,"a"
.p2align 6
.amdhsa_kernel adaLN_cond__linear_kernel_hedgehog__moe_arch_mod__prompt_kernel
  .amdhsa_next_free_vgpr 256
  .amdhsa_next_free_sgpr 102
  .amdhsa_accum_offset 256
  .amdhsa_group_segment_fixed_size 0
  .amdhsa_kernarg_size 112
  .amdhsa_user_sgpr_count 2
  .amdhsa_user_sgpr_kernarg_segment_ptr 1
  .amdhsa_system_sgpr_workgroup_id_x 1
  .amdhsa_float_denorm_mode_32 3
  .amdhsa_float_denorm_mode_16_64 3
.end_amdhsa_kernel
```

```asm
; @launch grid=(256,1,1) block=(512,1,1) lds=163840
.amdgcn_target "amdgcn-amd-amdhsa--gfx950"
.text
.globl adaLN_cond__linear_kernel_hedgehog__moe_arch_mod__prompt_kernel
.p2align 12
.type adaLN_cond__linear_kernel_hedgehog__moe_arch_mod__prompt_kernel,@function
adaLN_cond__linear_kernel_hedgehog__moe_arch_mod__prompt_kernel:
    s_load_dwordx16 s[68:83], s[0:1], 0
    s_load_dwordx8 s[84:91], s[0:1], 64
    s_load_dwordx2 s[32:33], s[0:1], 104
    s_cmp_ge_u32 s2, 256
    s_cbranch_scc1 L_END
    v_lshrrev_b32 v4, 6, v0
    v_and_b32 v1, 63, v0
    s_nop 0
    v_readfirstlane_b32 s3, v4
    v_lshlrev_b32 v2, 4, v1
    s_mov_b32 s38, 4194304
    s_mov_b32 s39, 0x20000
    s_mov_b32 s50, 12582912
    s_mov_b32 s51, 0x20000
    s_mov_b32 s34, 268435456
    s_mov_b32 s35, 0x20000
    s_mov_b32 s42, 6291456
    s_mov_b32 s43, 0x20000
    s_mov_b32 s46, 2097152
    s_mov_b32 s47, 0x20000
    s_mov_b32 s54, 7340032
    s_mov_b32 s55, 0x20000
    s_mov_b32 s58, 7340032
    s_mov_b32 s59, 0x20000
    s_mov_b32 s62, 7340032
    s_mov_b32 s63, 0x20000
    s_mov_b32 s66, 4194304
    s_mov_b32 s67, 0x20000
    s_mov_b32 s5, 0
    s_mov_b32 s6, 0xffff0000
    s_mov_b32 s7, 0x3fb8aa3b
    s_and_b32 s8, s2, 7
    s_lshr_b32 s9, s2, 3
    s_lshl3_add_u32 s93, s2, s3
    s_and_b32 s96, s8, 4
    s_lshr_b32 s97, s9, 2
    s_lshl1_add_u32 s10, s96, s97
    s_and_b32 s96, s8, 3
    s_and_b32 s97, s9, 3
    s_xor_b32 s98, s97, 2
    s_lshl2_add_u32 s11, s96, s98
    s_and_b32 s96, s8, 1
    s_and_b32 s97, s9, 7
    s_lshl3_add_u32 s12, s96, s97
    s_lshr_b32 s96, s8, 1
    s_lshr_b32 s97, s9, 3
    s_lshl2_add_u32 s21, s96, s97
    s_lshl_b32 s96, s2, 6
    s_add_u32 s97, s96, s3
    s_lshl_b32 s98, s97, 6
    s_add_u32 s92, s98, 1048576
    s_lshr_b32 s96, s8, 1
    s_lshl_b32 s97, s96, 8
    s_lshl3_add_u32 s98, s9, s97
    s_add_u32 s99, s98, s3
    s_lshl_b32 s96, s99, 12
    s_and_b32 s97, s8, 1
    s_lshl_b32 s98, s97, 10
    s_add_u32 s16, s96, s98
    v_and_b32 v8, 31, v1
    v_lshlrev_b32 v8, 4, v8
    v_lshrrev_b32 v9, 5, v1
    v_lshl_add_u32 v8, v9, 11, v8
    s_lshl3_add_u32 s96, s8, s3
    s_lshl_b32 s15, s96, 5
    s_mul_i32 s96, s15, 6144
    s_xor_b32 s97, s9, 1
    s_lshl_b32 s98, s97, 7
    s_add_u32 s13, s96, s98
    s_add_u32 s14, s13, 98304
    s_lshl3_add_u32 s96, s21, s3
    s_lshl_b32 s97, s96, 15
    s_lshl_b32 s98, s12, 7
    s_add_u32 s18, s97, s98
    s_lshr_b32 s96, s8, 1
    s_lshl4_add_u32 s97, s96, s12
    s_lshl4_add_u32 s98, s97, s3
    s_lshl_b32 s99, s98, 9
    s_add_u32 s17, s99, 524288
    v_lshrrev_b32 v248, 3, v1
    v_mul_u32_u24 v248, 12288, v248
    v_and_b32 v9, 7, v1
    v_lshl_add_u32 v248, v9, 4, v248
    v_lshrrev_b32 v249, 3, v1
    v_lshl_add_u32 v249, v249, 1, s15
    v_and_b32 v10, 15, v1
    v_lshlrev_b32 v10, 11, v10
    v_lshrrev_b32 v9, 4, v1
    v_lshl_add_u32 v10, v9, 4, v10
    s_waitcnt lgkmcnt(0)
    s_mov_b64 s[48:49], s[88:89]
    buffer_load_dwordx4 v[160:163], v248, s[48:51], s13 offen nt
    buffer_load_dwordx4 v[164:167], v248, s[48:51], s14 offen nt
    s_load_dword s4, s[32:33], 0
    global_load_ushort v168, v249, s[86:87]
    global_load_ushort v169, v249, s[86:87] offset:16
    s_mov_b64 s[36:37], s[68:69]
    s_load_dword s24, s[32:33], s92 offset:0 glc
    s_load_dword s25, s[32:33], s17 offset:508 glc
    s_load_dword s26, s[32:33], s17 offset:4604 glc
    s_barrier
    buffer_load_dwordx4 v[152:155], v8, s[36:39], s16 offen nt
    buffer_load_dwordx4 v[156:159], v8, s[36:39], s16 offen offset:512 nt
    s_mov_b64 s[40:41], s[70:71]
    s_mov_b64 s[44:45], s[74:75]
    s_mov_b64 s[52:53], s[80:81]
    s_mov_b64 s[56:57], s[82:83]
    s_mov_b64 s[60:61], s[84:85]
    s_mov_b64 s[64:65], s[90:91]
    s_getpc_b64 s[22:23]
    s_and_b32 s22, s22, 0xfffffc00
    s_lshl3_add_u32 s96, s9, s3
    s_lshl_b32 s19, s96, 7
    v_lshrrev_b32 v4, 5, v1
    v_lshl_add_u32 v4, v4, 15, s19
    v_min_u32 v4, 41984, v4
    global_load_dword v11, v4, s[22:23]
    s_lshr_b32 s76, s3, 2
    s_and_b32 s77, s3, 3
    s_lshl_b32 s83, s3, 10
    s_mul_i32 s96, s8, 7
    s_lshr_b32 s97, s9, 2
    s_add_u32 s74, s96, s97
    s_and_b32 s75, s9, 3
    v_bfe_u32 v6, v1, 4, 1
    v_lshlrev_b32 v6, 6, v6
    v_and_b32 v3, 7, v1
    v_lshlrev_b32 v3, 4, v3
    v_xor_b32 v3, v3, v6
    v_lshrrev_b32 v6, 3, v1
    v_mul_u32_u24 v6, 6144, v6
    v_add_u32 v3, v3, v6
    s_and_b32 s84, s9, 12
    s_mul_i32 s96, s3, 49152
    s_lshl_b32 s97, s11, 7
    s_add_u32 s85, s96, s97
    v_lshlrev_b32 v250, 3, v1
    v_lshlrev_b32 v251, 5, v1
    v_add_u32 v251, 147456, v251
    s_lshl2_add_u32 s13, s3, 147456
    v_lshrrev_b32 v252, 4, v1
    v_lshl_add_u32 v252, v252, 6, s13
    v_and_b32 v9, 7, v1
    v_lshl_add_u32 v252, v9, 8, v252
    v_bfe_u32 v9, v1, 3, 1
    v_lshl_add_u32 v252, v9, 5, v252
    buffer_load_dwordx4 v[12:15], v10, s[36:39], s18 offen
    buffer_load_dwordx4 v[16:19], v10, s[36:39], s18 offen offset:64
    s_lshr_b32 s96, s3, 1
    s_xor_b32 s97, s9, 1
    s_and_b32 s98, s97, 15
    s_lshl4_add_u32 s99, s96, s98
    s_lshr_b32 s97, s9, 4
    s_lshl1_add_u32 s96, s99, s97
    s_lshl3_add_u32 s98, s96, s8
    s_lshl_b32 s99, s98, 9
    s_add_u32 s13, s99, 524288
    s_lshr_b32 s96, s9, 4
    s_lshl_b32 s94, s96, 1
    s_add_u32 s96, s94, s84
    s_and_b32 s97, s96, 15
    s_mul_i32 s98, s97, 393216
    s_add_u32 s91, s98, s85
    s_lshl_b32 s96, s94, 13
    s_add_u32 s94, s96, s83
    s_add_u32 s82, s91, 2048
    s_mov_b32 m0, s94
    s_nop 0
    buffer_load_dwordx4 v3, s[40:43], s82 offen lds
    s_add_u32 s82, s91, 4096
    s_add_u32 m0, s94, 49152
    s_nop 0
    buffer_load_dwordx4 v3, s[40:43], s82 offen lds
    s_waitcnt vmcnt(7)
    v_lshlrev_b32 v168, 16, v168
    v_mul_f32 v4, s7, v168
    v_exp_f32 v4, -v4
    s_nop 0
    v_add_f32 v4, 1.0, v4
    v_rcp_f32 v4, v4
    s_nop 0
    v_mul_f32 v168, v168, v4
    v_cvt_pk_bf16_f32 v168, 0, v168
    v_lshlrev_b32 v169, 16, v169
    v_mul_f32 v5, s7, v169
    v_exp_f32 v5, -v5
    s_nop 0
    v_add_f32 v5, 1.0, v5
    v_rcp_f32 v5, v5
    s_nop 0
    v_mul_f32 v169, v169, v5
    v_cvt_pk_bf16_f32 v169, 0, v169
    v_lshlrev_b32 v4, 16, v160
    v_and_b32 v5, s6, v160
    v_pk_mul_f32 v[176:177], v[168:169], v[4:5] op_sel:[0,0] op_sel_hi:[0,1]
    v_lshlrev_b32 v6, 16, v161
    v_and_b32 v7, s6, v161
    v_pk_mul_f32 v[178:179], v[168:169], v[6:7] op_sel:[0,0] op_sel_hi:[0,1]
    v_lshlrev_b32 v4, 16, v162
    v_and_b32 v5, s6, v162
    v_pk_mul_f32 v[180:181], v[168:169], v[4:5] op_sel:[0,0] op_sel_hi:[0,1]
    v_lshlrev_b32 v6, 16, v163
    v_and_b32 v7, s6, v163
    v_pk_mul_f32 v[182:183], v[168:169], v[6:7] op_sel:[0,0] op_sel_hi:[0,1]
    v_lshlrev_b32 v4, 16, v164
    v_and_b32 v5, s6, v164
    v_pk_fma_f32 v[176:177], v[168:169], v[4:5], v[176:177] op_sel:[1,0,0] op_sel_hi:[1,1,1]
    v_lshlrev_b32 v6, 16, v165
    v_and_b32 v7, s6, v165
    v_pk_fma_f32 v[178:179], v[168:169], v[6:7], v[178:179] op_sel:[1,0,0] op_sel_hi:[1,1,1]
    v_lshlrev_b32 v4, 16, v166
    v_and_b32 v5, s6, v166
    v_pk_fma_f32 v[180:181], v[168:169], v[4:5], v[180:181] op_sel:[1,0,0] op_sel_hi:[1,1,1]
    v_lshlrev_b32 v6, 16, v167
    v_and_b32 v7, s6, v167
    v_pk_fma_f32 v[182:183], v[168:169], v[6:7], v[182:183] op_sel:[1,0,0] op_sel_hi:[1,1,1]
    v_permlane32_swap_b32 v176, v180
    v_permlane32_swap_b32 v177, v181
    v_permlane32_swap_b32 v178, v182
    v_permlane32_swap_b32 v179, v183
    v_add_f32 v176, v176, v180
    v_add_f32 v177, v177, v181
    v_add_f32 v178, v178, v182
    v_add_f32 v179, v179, v183
    s_nop 0
    v_permlane16_swap_b32 v176, v178
    v_permlane16_swap_b32 v177, v179
    v_add_f32 v176, v176, v178
    v_add_f32 v177, v177, v179
    s_nop 0
    v_add_f32_dpp v176, v176, v176 row_ror:8 row_mask:0xf bank_mask:0xf
    v_add_f32_dpp v177, v177, v177 row_ror:8 row_mask:0xf bank_mask:0xf
    s_nop 1
    v_mov_b32_dpp v176, v177 quad_perm:[0,1,2,3] row_mask:0xf bank_mask:0xc
    s_waitcnt lgkmcnt(0)
    s_mul_i32 s4, s4, 0x9e3779b1
    s_add_u32 s4, s4, 0x7f4a7c15
    ds_write_b32 v252, v176
    s_waitcnt lgkmcnt(0)
    s_barrier
    ds_read_b128 v[176:179], v251
    ds_read_b128 v[180:183], v251 offset:16
    s_waitcnt lgkmcnt(0)
    v_pk_add_f32 v[176:177], v[176:177], v[178:179]
    v_pk_add_f32 v[180:181], v[180:181], v[182:183]
    v_pk_add_f32 v[176:177], v[176:177], v[180:181]
    v_add_f32 v176, v176, v177
    v_mov_b32 v177, s4
    s_bitcmp1_b32 s3, 0
    s_cselect_b32 exec_lo, 0, -1
    s_cselect_b32 exec_hi, -1, 0
    buffer_store_dwordx2 v[176:177], v250, s[32:35], s13 offen sc1
    s_mov_b64 exec, -1
    s_waitcnt vmcnt(6)
    v_mov_b32 v8, 0x3f803f80
    v_dot2_f32_bf16 v4, v152, v8, 0
    v_dot2_f32_bf16 v5, v152, v152, 0
    v_dot2_f32_bf16 v6, v153, v8, 0
    v_dot2_f32_bf16 v7, v153, v153, 0
    v_dot2_f32_bf16 v4, v154, v8, v4
    v_dot2_f32_bf16 v5, v154, v154, v5
    v_dot2_f32_bf16 v6, v155, v8, v6
    v_dot2_f32_bf16 v7, v155, v155, v7
    v_dot2_f32_bf16 v4, v156, v8, v4
    v_dot2_f32_bf16 v5, v156, v156, v5
    v_dot2_f32_bf16 v6, v157, v8, v6
    v_dot2_f32_bf16 v7, v157, v157, v7
    v_dot2_f32_bf16 v4, v158, v8, v4
    v_dot2_f32_bf16 v5, v158, v158, v5
    v_dot2_f32_bf16 v6, v159, v8, v6
    v_dot2_f32_bf16 v7, v159, v159, v7
    s_lshl_b32 s96, s3, 5
    s_add_u32 s13, s96, 153600
    v_lshrrev_b32 v8, 5, v1
    v_lshl_add_u32 v8, v8, 4, s13
    v_bfe_u32 v9, v1, 4, 1
    v_lshl_add_u32 v8, v9, 3, v8
    v_pk_add_f32 v[172:173], v[4:5], v[6:7]
    v_and_b32 v5, 15, v1
    v_lshlrev_b32 v5, 4, v5
    v_add_u32 v5, 153600, v5
    v_and_b32 v4, 15, v1
    v_lshlrev_b32 v4, 4, v4
    v_bfe_u32 v9, v1, 4, 1
    v_lshl_add_u32 v4, v9, 12, v4
    v_add_f32_dpp v172, v172, v172 quad_perm:[1,0,3,2] row_mask:0xf bank_mask:0xf
    v_add_f32_dpp v173, v173, v173 quad_perm:[1,0,3,2] row_mask:0xf bank_mask:0xf
    s_nop 0
    v_add_f32_dpp v172, v172, v172 quad_perm:[2,3,0,1] row_mask:0xf bank_mask:0xf
    v_add_f32_dpp v173, v173, v173 quad_perm:[2,3,0,1] row_mask:0xf bank_mask:0xf
    s_nop 0
    v_add_f32_dpp v172, v172, v172 row_half_mirror row_mask:0xf bank_mask:0xf
    v_add_f32_dpp v173, v173, v173 row_half_mirror row_mask:0xf bank_mask:0xf
    s_nop 0
    v_add_f32_dpp v172, v172, v172 row_mirror row_mask:0xf bank_mask:0xf
    v_add_f32_dpp v173, v173, v173 row_mirror row_mask:0xf bank_mask:0xf
    s_and_b32 s96, s9, 24
    s_add_u32 s97, s96, s3
    s_and_b32 s98, s8, 6
    s_lshl3_add_u32 s99, s97, s98
    s_lshl_b32 s96, s99, 12
    s_and_b32 s97, s9, 7
    s_lshl_b32 s98, s97, 9
    s_add_u32 s99, s96, s98
    s_and_b32 s97, s8, 1
    s_lshl_b32 s96, s97, 8
    s_add_u32 s98, s99, s96
    s_add_u32 s13, s98, 2097152
    v_permlane16_swap_b32 v172, v173
    v_add_f32 v172, v172, v173
    v_mov_b32 v173, s4
    ds_write_b64 v8, v[172:173]
    s_waitcnt lgkmcnt(0)
    s_barrier
    ds_read_b128 v[172:175], v5
    s_waitcnt lgkmcnt(0)
    s_mov_b32 exec_hi, 0
    buffer_store_dwordx4 v[172:175], v4, s[32:35], s13 offen sc1
    s_mov_b32 exec_hi, -1
    s_mov_b32 s82, s91
    s_add_u32 m0, s94, 98304
    s_nop 0
    buffer_load_dwordx4 v3, s[40:43], s82 offen lds
    s_lshr_b32 s96, s9, 4
    s_lshl_b32 s97, s96, 1
    s_xor_b32 s94, s97, 1
    s_add_u32 s96, s94, s84
    s_and_b32 s97, s96, 15
    s_mul_i32 s98, s97, 393216
    s_add_u32 s91, s98, s85
    s_lshl_b32 s96, s94, 13
    s_add_u32 s94, s96, s83
    s_add_u32 s82, s91, 2048
    s_mov_b32 m0, s94
    s_nop 0
    buffer_load_dwordx4 v3, s[40:43], s82 offen lds
    s_load_dword s24, s[32:33], s17 offset:508 glc
    s_load_dword s25, s[32:33], s17 offset:4604 glc
    v_and_b32 v4, 31, v1
    v_lshlrev_b32 v4, 4, v4
    v_lshrrev_b32 v9, 5, v1
    v_lshl_add_u32 v4, v9, 12, v4
    s_lshl2_add_u32 s14, s3, 155648
    v_lshl_add_u32 v5, v1, 6, s14
    v_and_b32 v6, 3, v1
    v_lshlrev_b32 v6, 5, v6
    v_lshrrev_b32 v9, 5, v1
    v_lshl_add_u32 v6, v9, 7, v6
    v_bfe_u32 v9, v1, 4, 1
    v_lshl_add_u32 v6, v9, 8, v6
    v_bfe_u32 v9, v1, 2, 2
    v_lshl_add_u32 v6, v9, 9, v6
    v_add_u32 v6, 155648, v6
    s_lshl3_add_u32 s96, s2, s3
    s_lshl_b32 s97, s96, 9
    s_add_u32 s14, s97, 2097152
    v_and_b32 v8, 31, v1
    v_lshlrev_b32 v8, 4, v8
    s_branch SCHK_2
SPOLL_1:
    s_load_dword s24, s[32:33], s17 offset:508 glc
    s_load_dword s25, s[32:33], s17 offset:4604 glc
SCHK_2:
    s_add_u32 s5, s5, 1
    s_cmp_ge_u32 s5, 200000
    s_waitcnt lgkmcnt(0)
    s_cbranch_scc1 SDONE_3
    s_cmp_lg_u32 s24, s4
    s_cbranch_scc1 SPOLL_1
    s_cmp_lg_u32 s25, s4
    s_cbranch_scc1 SPOLL_1
SDONE_3:
    buffer_load_dwordx4 v[176:179], v4, s[32:35], s17 offen sc1
    s_load_dword s24, s[32:33], s14 offset:252 glc
    s_load_dword s25, s[32:33], s14 offset:508 glc
    s_waitcnt vmcnt(7)
    v_permlane32_swap_b32 v12, v14
    v_permlane32_swap_b32 v13, v15
    v_permlane32_swap_b32 v16, v18
    v_permlane32_swap_b32 v17, v19
    v_lshlrev_b32 v184, 16, v12
    v_and_b32 v185, s6, v12
    v_lshlrev_b32 v186, 16, v13
    v_and_b32 v187, s6, v13
    v_lshlrev_b32 v188, 16, v14
    v_and_b32 v189, s6, v14
    v_lshlrev_b32 v190, 16, v15
    v_and_b32 v191, s6, v15
    v_lshlrev_b32 v192, 16, v16
    v_and_b32 v193, s6, v16
    v_lshlrev_b32 v194, 16, v17
    v_and_b32 v195, s6, v17
    v_lshlrev_b32 v196, 16, v18
    v_and_b32 v197, s6, v18
    v_lshlrev_b32 v198, 16, v19
    v_and_b32 v199, s6, v19
    s_branch SCHK_6
SPOLL_5:
    s_load_dword s24, s[32:33], s14 offset:252 glc
    s_load_dword s25, s[32:33], s14 offset:508 glc
SCHK_6:
    s_add_u32 s5, s5, 1
    s_cmp_ge_u32 s5, 200000
    s_waitcnt lgkmcnt(0)
    s_cbranch_scc1 SDONE_7
    s_cmp_lg_u32 s24, s4
    s_cbranch_scc1 SPOLL_5
    s_cmp_lg_u32 s25, s4
    s_cbranch_scc1 SPOLL_5
SDONE_7:
    buffer_load_dwordx4 v[172:175], v8, s[32:35], s14 offen sc1
    s_add_u32 s82, s91, 4096
    s_add_u32 m0, s94, 49152
    s_nop 0
    buffer_load_dwordx4 v3, s[40:43], s82 offen lds
    s_mov_b32 s82, s91
    s_add_u32 m0, s94, 98304
    s_nop 0
    buffer_load_dwordx4 v3, s[40:43], s82 offen lds
    s_waitcnt vmcnt(3)
    v_bitop3_b32 v7, v177, v179, s4 bitop3:0x7e
    v_cmp_ne_u32 vcc, 0, v7
    s_cbranch_vccz TOK_8
POLL_9:
    buffer_load_dwordx4 v[176:179], v4, s[32:35], s17 offen sc1
    s_waitcnt vmcnt(0)
    v_bitop3_b32 v7, v177, v179, s4 bitop3:0x7e
    v_cmp_ne_u32 vcc, 0, v7
    s_cbranch_vccz PDONE_10
    s_add_u32 s5, s5, 1
    s_cmp_lt_u32 s5, 200000
    s_cbranch_scc1 POLL_9
PDONE_10:
TOK_8:
    ds_write2_b32 v5, v176, v178 offset0:0 offset1:8
    s_waitcnt lgkmcnt(0)
    s_barrier
    ds_read_b128 v[208:211], v6 offset:2048
    ds_read_b128 v[212:215], v6 offset:2064
    ds_read_b128 v[200:203], v6
    ds_read_b128 v[204:207], v6 offset:16
    s_lshl_b32 s96, s11, 12
    s_lshl_b32 s97, s3, 9
    s_add_u32 s13, s96, s97
    v_add_u32 v4, s13, v2
    s_lshl_b32 s96, s3, 9
    s_add_u32 m0, s96, 159744
    s_mov_b32 exec_hi, 0
    global_load_lds_dwordx4 v4, s[72:73]
    s_mov_b32 exec_hi, -1
    s_lshl4_add_u32 s96, s21, s12
    s_lshr_b32 s97, s3, 1
    s_lshl2_add_u32 s98, s96, s97
    s_lshl_b32 s99, s98, 12
    s_and_b32 s96, s3, 1
    s_lshl_b32 s97, s96, 8
    s_add_u32 s98, s99, s97
    s_add_u32 s13, s98, 4194304
    v_and_b32 v4, 15, v1
    v_lshlrev_b32 v4, 4, v4
    v_bfe_u32 v9, v1, 4, 1
    v_lshl_add_u32 v4, v9, 10, v4
    v_lshrrev_b32 v9, 5, v1
    v_lshl_add_u32 v4, v9, 9, v4
    s_waitcnt lgkmcnt(2)
    v_pk_add_f32 v[208:209], v[208:209], v[210:211]
    v_pk_add_f32 v[212:213], v[212:213], v[214:215]
    v_pk_add_f32 v[208:209], v[208:209], v[212:213]
    v_add_f32 v208, v208, v209
    v_cvt_pk_bf16_f32 v208, 0, v208
    s_waitcnt lgkmcnt(0)
    v_pk_add_f32 v[200:201], v[200:201], v[202:203]
    v_pk_add_f32 v[204:205], v[204:205], v[206:207]
    v_pk_add_f32 v[200:201], v[200:201], v[204:205]
    v_add_f32 v200, v200, v201
    v_add_f32 v208, 1.0, v208
    v_cvt_pk_bf16_f32 v208, 0, v208
    v_cvt_pk_bf16_f32 v200, 0, v200
    s_waitcnt vmcnt(3)
    v_bitop3_b32 v7, v173, v175, s4 bitop3:0x7e
    v_cmp_ne_u32 vcc, 0, v7
    s_cbranch_vccz L_STOK
POLL_11:
    buffer_load_dwordx4 v[172:175], v8, s[32:35], s14 offen sc1
    s_waitcnt vmcnt(0)
    v_bitop3_b32 v7, v173, v175, s4 bitop3:0x7e
    v_cmp_ne_u32 vcc, 0, v7
    s_cbranch_vccz PDONE_12
    s_add_u32 s5, s5, 1
    s_cmp_lt_u32 s5, 200000
    s_cbranch_scc1 POLL_11
PDONE_12:
L_STOK:
    v_permlane16_swap_b32 v172, v174
    v_add_f32 v175, v172, v174
    v_mul_f32 v174, 0x3a800000, v175
    v_mul_f32 v175, 0x3a800000, v175
    s_nop 1
    v_permlane16_swap_b32 v174, v175
    v_fma_f32 v172, -v174, v174, v175
    v_cvt_pk_bf16_f32 v173, 0, v174
    v_max_f32 v172, 0, v172
    v_cvt_pk_bf16_f32 v172, 0, v172
    v_pk_add_f32 v[184:185], v[172:173], v[184:185] op_sel:[1,0] neg_lo:[1,0] neg_hi:[1,0]
    v_pk_add_f32 v[186:187], v[172:173], v[186:187] op_sel:[1,0] neg_lo:[1,0] neg_hi:[1,0]
    v_pk_add_f32 v[188:189], v[172:173], v[188:189] op_sel:[1,0] neg_lo:[1,0] neg_hi:[1,0]
    v_pk_add_f32 v[190:191], v[172:173], v[190:191] op_sel:[1,0] neg_lo:[1,0] neg_hi:[1,0]
    v_add_f32 v172, 0x3727c5ac, v172
    v_cvt_pk_bf16_f32 v172, 0, v172
    v_sqrt_f32 v172, v172
    s_nop 0
    v_pk_add_f32 v[192:193], v[172:173], v[192:193] op_sel:[1,0] neg_lo:[1,0] neg_hi:[1,0]
    v_pk_add_f32 v[194:195], v[172:173], v[194:195] op_sel:[1,0] neg_lo:[1,0] neg_hi:[1,0]
    v_pk_add_f32 v[196:197], v[172:173], v[196:197] op_sel:[1,0] neg_lo:[1,0] neg_hi:[1,0]
    v_pk_add_f32 v[198:199], v[172:173], v[198:199] op_sel:[1,0] neg_lo:[1,0] neg_hi:[1,0]
    v_cvt_pk_bf16_f32 v172, 0, v172
    v_rcp_f32 v172, v172
    v_cvt_pk_bf16_f32 v184, 0, v184
    v_cvt_pk_bf16_f32 v185, 0, v185
    v_cvt_pk_bf16_f32 v186, 0, v186
    v_cvt_pk_bf16_f32 v187, 0, v187
    v_cvt_pk_bf16_f32 v188, 0, v188
    v_cvt_pk_bf16_f32 v189, 0, v189
    v_cvt_pk_bf16_f32 v190, 0, v190
    v_cvt_pk_bf16_f32 v191, 0, v191
    v_cvt_pk_bf16_f32 v192, 0, v192
    v_cvt_pk_bf16_f32 v193, 0, v193
    v_cvt_pk_bf16_f32 v194, 0, v194
    v_cvt_pk_bf16_f32 v195, 0, v195
    v_cvt_pk_bf16_f32 v196, 0, v196
    v_cvt_pk_bf16_f32 v197, 0, v197
    v_cvt_pk_bf16_f32 v198, 0, v198
    v_cvt_pk_bf16_f32 v199, 0, v199
    v_pk_mul_f32 v[184:185], v[184:185], v[172:173] op_sel_hi:[1,0]
    v_pk_mul_f32 v[186:187], v[186:187], v[172:173] op_sel_hi:[1,0]
    v_pk_mul_f32 v[188:189], v[188:189], v[172:173] op_sel_hi:[1,0]
    v_pk_mul_f32 v[190:191], v[190:191], v[172:173] op_sel_hi:[1,0]
    v_pk_mul_f32 v[192:193], v[192:193], v[172:173] op_sel_hi:[1,0]
    v_pk_mul_f32 v[194:195], v[194:195], v[172:173] op_sel_hi:[1,0]
    v_pk_mul_f32 v[196:197], v[196:197], v[172:173] op_sel_hi:[1,0]
    v_pk_mul_f32 v[198:199], v[198:199], v[172:173] op_sel_hi:[1,0]
    v_cvt_pk_bf16_f32 v184, 0, v184
    v_cvt_pk_bf16_f32 v185, 0, v185
    v_cvt_pk_bf16_f32 v186, 0, v186
    v_cvt_pk_bf16_f32 v187, 0, v187
    v_cvt_pk_bf16_f32 v188, 0, v188
    v_cvt_pk_bf16_f32 v189, 0, v189
    v_cvt_pk_bf16_f32 v190, 0, v190
    v_cvt_pk_bf16_f32 v191, 0, v191
    v_cvt_pk_bf16_f32 v192, 0, v192
    v_cvt_pk_bf16_f32 v193, 0, v193
    v_cvt_pk_bf16_f32 v194, 0, v194
    v_cvt_pk_bf16_f32 v195, 0, v195
    v_cvt_pk_bf16_f32 v196, 0, v196
    v_cvt_pk_bf16_f32 v197, 0, v197
    v_cvt_pk_bf16_f32 v198, 0, v198
    v_cvt_pk_bf16_f32 v199, 0, v199
    v_mul_f32_dpp v184, v208, v184 row_newbcast:0 row_mask:0xf bank_mask:0xf
    v_mul_f32_dpp v185, v208, v185 row_newbcast:1 row_mask:0xf bank_mask:0xf
    v_mul_f32_dpp v186, v208, v186 row_newbcast:2 row_mask:0xf bank_mask:0xf
    v_mul_f32_dpp v187, v208, v187 row_newbcast:3 row_mask:0xf bank_mask:0xf
    v_mul_f32_dpp v188, v208, v188 row_newbcast:4 row_mask:0xf bank_mask:0xf
    v_mul_f32_dpp v189, v208, v189 row_newbcast:5 row_mask:0xf bank_mask:0xf
    v_mul_f32_dpp v190, v208, v190 row_newbcast:6 row_mask:0xf bank_mask:0xf
    v_mul_f32_dpp v191, v208, v191 row_newbcast:7 row_mask:0xf bank_mask:0xf
    v_cvt_pk_bf16_f32 v184, 0, v184
    v_cvt_pk_bf16_f32 v185, 0, v185
    v_cvt_pk_bf16_f32 v186, 0, v186
    v_cvt_pk_bf16_f32 v187, 0, v187
    v_cvt_pk_bf16_f32 v188, 0, v188
    v_cvt_pk_bf16_f32 v189, 0, v189
    v_cvt_pk_bf16_f32 v190, 0, v190
    v_cvt_pk_bf16_f32 v191, 0, v191
    v_add_f32_dpp v184, v200, v184 row_newbcast:0 row_mask:0xf bank_mask:0xf
    v_add_f32_dpp v185, v200, v185 row_newbcast:1 row_mask:0xf bank_mask:0xf
    v_add_f32_dpp v186, v200, v186 row_newbcast:2 row_mask:0xf bank_mask:0xf
    v_add_f32_dpp v187, v200, v187 row_newbcast:3 row_mask:0xf bank_mask:0xf
    v_add_f32_dpp v188, v200, v188 row_newbcast:4 row_mask:0xf bank_mask:0xf
    v_add_f32_dpp v189, v200, v189 row_newbcast:5 row_mask:0xf bank_mask:0xf
    v_add_f32_dpp v190, v200, v190 row_newbcast:6 row_mask:0xf bank_mask:0xf
    v_add_f32_dpp v191, v200, v191 row_newbcast:7 row_mask:0xf bank_mask:0xf
    v_cvt_pk_bf16_f32 v216, v184, v185
    v_cvt_pk_bf16_f32 v217, v186, v187
    v_cvt_pk_bf16_f32 v218, v188, v189
    v_cvt_pk_bf16_f32 v219, v190, v191
    buffer_store_dwordx4 v[216:219], v4, s[32:35], s13 offen sc1
    v_mul_f32_dpp v192, v208, v192 row_newbcast:8 row_mask:0xf bank_mask:0xf
    v_mul_f32_dpp v193, v208, v193 row_newbcast:9 row_mask:0xf bank_mask:0xf
    v_mul_f32_dpp v194, v208, v194 row_newbcast:10 row_mask:0xf bank_mask:0xf
    v_mul_f32_dpp v195, v208, v195 row_newbcast:11 row_mask:0xf bank_mask:0xf
    v_mul_f32_dpp v196, v208, v196 row_newbcast:12 row_mask:0xf bank_mask:0xf
    v_mul_f32_dpp v197, v208, v197 row_newbcast:13 row_mask:0xf bank_mask:0xf
    v_mul_f32_dpp v198, v208, v198 row_newbcast:14 row_mask:0xf bank_mask:0xf
    v_mul_f32_dpp v199, v208, v199 row_newbcast:15 row_mask:0xf bank_mask:0xf
    v_cvt_pk_bf16_f32 v192, 0, v192
    v_cvt_pk_bf16_f32 v193, 0, v193
    v_cvt_pk_bf16_f32 v194, 0, v194
    v_cvt_pk_bf16_f32 v195, 0, v195
    v_cvt_pk_bf16_f32 v196, 0, v196
    v_cvt_pk_bf16_f32 v197, 0, v197
    v_cvt_pk_bf16_f32 v198, 0, v198
    v_cvt_pk_bf16_f32 v199, 0, v199
    v_add_f32_dpp v192, v200, v192 row_newbcast:8 row_mask:0xf bank_mask:0xf
    v_add_f32_dpp v193, v200, v193 row_newbcast:9 row_mask:0xf bank_mask:0xf
    v_add_f32_dpp v194, v200, v194 row_newbcast:10 row_mask:0xf bank_mask:0xf
    v_add_f32_dpp v195, v200, v195 row_newbcast:11 row_mask:0xf bank_mask:0xf
    v_add_f32_dpp v196, v200, v196 row_newbcast:12 row_mask:0xf bank_mask:0xf
    v_add_f32_dpp v197, v200, v197 row_newbcast:13 row_mask:0xf bank_mask:0xf
    v_add_f32_dpp v198, v200, v198 row_newbcast:14 row_mask:0xf bank_mask:0xf
    v_add_f32_dpp v199, v200, v199 row_newbcast:15 row_mask:0xf bank_mask:0xf
    v_cvt_pk_bf16_f32 v220, v192, v193
    v_cvt_pk_bf16_f32 v221, v194, v195
    v_cvt_pk_bf16_f32 v222, v196, v197
    v_cvt_pk_bf16_f32 v223, v198, v199
    buffer_store_dwordx4 v[220:223], v4, s[32:35], s13 offen offset:2048 sc1
    v_bfe_u32 v20, v1, 2, 2
    v_lshlrev_b32 v20, 7, v20
    v_bfe_u32 v9, v1, 3, 1
    v_lshl_add_u32 v20, v9, 6, v20
    v_bfe_u32 v9, v1, 4, 1
    v_lshl_add_u32 v20, v9, 5, v20
    v_and_b32 v9, 3, v1
    v_lshl_add_u32 v20, v9, 3, v20
    v_lshrrev_b32 v9, 5, v1
    v_lshl_add_u32 v20, v9, 9, v20
    v_xor_b32 v21, 64, v20
    v_add_u32 v22, 49152, v20
    v_add_u32 v23, 49152, v21
    v_add_u32 v24, 98304, v20
    v_add_u32 v25, 98304, v21
    v_and_b32 v5, 3, v1
    v_lshlrev_b32 v5, 15, v5
    v_bfe_u32 v9, v1, 2, 2
    v_lshl_add_u32 v5, v9, 12, v5
    s_and_b32 s96, s12, 1
    s_lshr_b32 s97, s21, 3
    s_and_b32 s98, s21, 7
    s_lshl_b32 s99, s98, 5
    s_lshl2_add_u32 s98, s97, s99
    s_lshl_b32 s97, s98, 12
    s_lshr_b32 s99, s12, 1
    s_lshl_b32 s98, s99, 6
    s_add_u32 s99, s97, s98
    s_lshl2_add_u32 s97, s96, s99
    s_add_u32 s13, s97, 1048576
    s_lshl_b32 s96, s10, 18
    s_lshl_b32 s97, s77, 12
    s_add_u32 s98, s96, s97
    s_add_u32 s88, s98, 4194304
    s_cmp_ge_u32 s9, 28
    s_cselect_b32 s54, 0, s54
    s_cselect_b32 s58, 0, s58
    s_cselect_b32 s62, 0, s62
    s_waitcnt vmcnt(0)
    s_barrier
    s_cmp_lg_u32 s3, 0
    s_cbranch_scc1 L_PB
    v_mov_b32 v6, s4
    s_mov_b32 exec_hi, 0
    s_mov_b32 exec_lo, 65535
    buffer_store_dword v6, v5, s[32:35], s13 offen sc1
    s_mov_b64 exec, -1
L_PB:
    s_lshr_b32 s96, s9, 4
    s_lshl_b32 s97, s96, 1
    s_xor_b32 s94, s97, 2
    s_add_u32 s96, s94, s84
    s_and_b32 s97, s96, 15
    s_mul_i32 s98, s97, 393216
    s_add_u32 s91, s98, s85
    s_lshl_b32 s96, s94, 13
    s_add_u32 s94, s96, s83
    s_add_u32 s82, s91, 2048
    s_mov_b32 m0, s94
    s_nop 0
    buffer_load_dwordx4 v3, s[40:43], s82 offen lds
    s_add_u32 s82, s91, 4096
    s_add_u32 m0, s94, 49152
    s_nop 0
    buffer_load_dwordx4 v3, s[40:43], s82 offen lds
    s_mov_b32 s82, s91
    s_add_u32 m0, s94, 98304
    s_nop 0
    buffer_load_dwordx4 v3, s[40:43], s82 offen lds
    s_lshr_b32 s96, s9, 4
    s_lshl_b32 s97, s96, 1
    s_xor_b32 s94, s97, 3
    s_add_u32 s96, s94, s84
    s_and_b32 s97, s96, 15
    s_mul_i32 s98, s97, 393216
    s_add_u32 s91, s98, s85
    s_lshl_b32 s96, s94, 13
    s_add_u32 s94, s96, s83
    s_add_u32 s82, s91, 2048
    s_mov_b32 m0, s94
    s_nop 0
    buffer_load_dwordx4 v3, s[40:43], s82 offen lds
    s_add_u32 s82, s91, 4096
    s_add_u32 m0, s94, 49152
    s_nop 0
    buffer_load_dwordx4 v3, s[40:43], s82 offen lds
    s_mov_b32 s82, s91
    s_add_u32 m0, s94, 98304
    s_nop 0
    buffer_load_dwordx4 v3, s[40:43], s82 offen lds
    s_lshl_b32 s96, s2, 12
    s_add_u32 s19, s96, 1048576
    s_and_b32 s96, s3, 3
    s_lshl_b32 s97, s96, 7
    s_add_u32 s20, s97, s19
    s_lshl_b32 s96, s84, 5
    s_add_u32 s19, s96, s19
    s_cmp_ge_u32 s3, 4
    s_cselect_b32 s19, s20, s19
    s_load_dwordx2 s[24:25], s[32:33], s19 offset:0 glc
    s_load_dwordx2 s[26:27], s[32:33], s19 offset:64 glc
    s_lshl_b32 s96, s3, 14
    s_lshl_b32 s97, s12, 7
    s_add_u32 s90, s96, s97
    s_and_b32 s96, s9, 1
    s_lshr_b32 s97, s9, 3
    s_lshl_b32 s98, s97, 1
    s_lshl3_add_u32 s99, s96, s98
    s_lshl_b32 s95, s99, 17
    s_lshl3_add_u32 s96, s75, s3
    s_mul_i32 s97, s96, 229376
    s_lshl_b32 s98, s74, 7
    s_add_u32 s80, s97, s98
    s_lshl3_add_u32 s96, s74, s3
    s_lshl_b32 s97, s96, 14
    s_lshl_b32 s98, s75, 9
    s_add_u32 s81, s97, s98
    s_and_b32 s96, s8, 3
    s_lshl3_add_u32 s97, s96, s3
    s_mul_i32 s98, s97, 393216
    s_lshr_b32 s99, s8, 2
    s_lshl1_add_u32 s96, s9, s99
    s_lshl_b32 s97, s96, 7
    s_add_u32 s99, s98, s97
    s_add_u32 s89, s99, 4096
    s_and_b32 s96, s3, 1
    s_lshl_b32 s14, s96, 6
    v_bfe_u32 v6, v1, 4, 1
    v_lshl_add_u32 v6, v6, 5, s14
    v_and_b32 v26, 7, v1
    v_lshlrev_b32 v26, 4, v26
    v_xor_b32 v26, v26, v6
    v_lshrrev_b32 v6, 3, v1
    v_lshlrev_b32 v6, 11, v6
    v_add_u32 v26, v26, v6
    s_and_b32 s96, s3, 2
    s_lshl_b32 s14, s96, 5
    v_bfe_u32 v6, v1, 4, 1
    v_lshl_add_u32 v6, v6, 5, s14
    v_and_b32 v27, 7, v1
    v_lshlrev_b32 v27, 4, v27
    v_xor_b32 v27, v27, v6
    v_lshrrev_b32 v6, 3, v1
    v_mul_u32_u24 v6, 7168, v6
    v_add_u32 v27, v27, v6
    s_and_b32 s96, s3, 1
    s_lshl_b32 s14, s96, 7
    v_lshrrev_b32 v6, 5, v1
    v_lshl_add_u32 v6, v6, 6, s14
    v_and_b32 v253, 31, v1
    v_lshlrev_b32 v253, 4, v253
    v_lshrrev_b32 v9, 5, v1
    v_lshl_add_u32 v253, v9, 11, v253
    v_xor_b32 v253, v253, v6
    s_lshl_b32 s16, s84, 14
    v_add_u32 v249, s88, v2
    s_lshl_b32 s96, s77, 11
    s_add_u32 s14, s96, 151552
    v_add_u32 v0, s14, v2
    s_mov_b64 exec, 0
    s_cmp_eq_u32 s3, 4
    s_cbranch_scc1 L_PAD2
    s_cmp_eq_u32 s3, 5
    s_cbranch_scc1 L_PAD3
    s_cmp_eq_u32 s3, 6
    s_cbranch_scc1 L_PAD4
    s_cmp_eq_u32 s3, 7
    s_cbranch_scc1 L_PAD5
    s_branch L_TEND
L_RET2:
    s_branch L_PAD6
L_RET6:
    s_branch L_PAD10
L_RET10:
    s_branch L_TEND
L_RET3:
    s_branch L_PAD7
L_RET7:
    s_branch L_TEND
L_RET4:
    s_branch L_PAD8
L_RET8:
    s_branch L_TEND
L_RET5:
    s_branch L_PAD9
L_RET9:
    s_branch L_TEND
    s_nop 0
    s_nop 0
    s_nop 0
    s_nop 0
    s_nop 0
    s_nop 0
    s_nop 0
    s_nop 0
    s_nop 0
    s_nop 0
    s_nop 0
    s_nop 0
    s_nop 0
    s_nop 0
    s_nop 0
    s_nop 0
    s_nop 0
    s_nop 0
    s_nop 0
    s_nop 0
    s_nop 0
    s_nop 0
    s_nop 0
    s_nop 0
    s_nop 0
    s_nop 0
    s_nop 0
    s_nop 0
L_TEND:
    s_mov_b64 exec, -1
    s_cmp_ge_u32 s3, 4
    s_cbranch_scc1 L_HELP
    s_branch SCHK_14
SPOLL_13:
    s_load_dwordx2 s[24:25], s[32:33], s19 offset:0 glc
    s_load_dwordx2 s[26:27], s[32:33], s19 offset:64 glc
SCHK_14:
    s_add_u32 s5, s5, 1
    s_cmp_ge_u32 s5, 200000
    s_waitcnt lgkmcnt(0)
    s_cbranch_scc1 SDONE_15
    s_cmp_lg_u32 s24, s4
    s_cbranch_scc1 SPOLL_13
    s_cmp_lg_u32 s25, s4
    s_cbranch_scc1 SPOLL_13
    s_cmp_lg_u32 s26, s4
    s_cbranch_scc1 SPOLL_13
    s_cmp_lg_u32 s27, s4
    s_cbranch_scc1 SPOLL_13
SDONE_15:
    s_setprio 2
    buffer_load_dwordx4 v[152:155], v249, s[32:35], s16 offen sc1
    buffer_load_dwordx4 v[156:159], v249, s[32:35], s16 offen offset:1024 sc1
    buffer_load_dwordx4 v[160:163], v249, s[32:35], s16 offen offset:2048 sc1
    buffer_load_dwordx4 v[164:167], v249, s[32:35], s16 offen offset:3072 sc1
    s_add_u32 s16, s16, 16384
    s_and_b32 s16, s16, 0x3ffff
    buffer_load_dwordx4 v[168:171], v249, s[32:35], s16 offen sc1
    buffer_load_dwordx4 v[172:175], v249, s[32:35], s16 offen offset:1024 sc1
    buffer_load_dwordx4 v[176:179], v249, s[32:35], s16 offen offset:2048 sc1
    buffer_load_dwordx4 v[180:183], v249, s[32:35], s16 offen offset:3072 sc1
    s_waitcnt vmcnt(8)
    s_barrier
    ds_read_b64_tr_b16 v[28:29], v20
    ds_read_b64_tr_b16 v[30:31], v20 offset:2048
    ds_read_b64_tr_b16 v[32:33], v21
    ds_read_b64_tr_b16 v[34:35], v21 offset:2048
    ds_read_b64_tr_b16 v[36:37], v24
    ds_read_b64_tr_b16 v[38:39], v24 offset:2048
    ds_read_b64_tr_b16 v[40:41], v25
    ds_read_b64_tr_b16 v[42:43], v25 offset:2048
    ds_read_b64_tr_b16 v[44:45], v22
    ds_read_b64_tr_b16 v[46:47], v22 offset:2048
    ds_read_b64_tr_b16 v[48:49], v23
    ds_read_b64_tr_b16 v[50:51], v23 offset:2048
    s_waitcnt vmcnt(7)
    s_waitcnt lgkmcnt(10)
    v_mfma_f32_32x32x16_bf16 v[56:71], v[28:31], v[152:155], 0
    s_add_u32 s16, s16, 16384
    ds_read_b64_tr_b16 v[52:53], v20 offset:1024
    ds_read_b64_tr_b16 v[54:55], v20 offset:3072
    s_waitcnt lgkmcnt(10)
    v_mfma_f32_32x32x16_bf16 v[72:87], v[32:35], v[152:155], 0
    s_and_b32 s16, s16, 0x3ffff
    ds_read_b64_tr_b16 v[28:29], v21 offset:1024
    ds_read_b64_tr_b16 v[30:31], v21 offset:3072
    s_waitcnt lgkmcnt(10)
    v_mfma_f32_32x32x16_bf16 v[120:135], v[36:39], v[152:155], 0
    ds_read_b64_tr_b16 v[32:33], v24 offset:1024
    ds_read_b64_tr_b16 v[34:35], v24 offset:3072
    s_waitcnt lgkmcnt(10)
    v_mfma_f32_32x32x16_bf16 v[136:151], v[40:43], v[152:155], 0
    buffer_load_dwordx4 v[184:187], v249, s[32:35], s16 offen sc1
    ds_read_b64_tr_b16 v[36:37], v25 offset:1024
    ds_read_b64_tr_b16 v[38:39], v25 offset:3072
    s_waitcnt lgkmcnt(10)
    v_mfma_f32_32x32x16_bf16 v[88:103], v[44:47], v[152:155], 0
    ds_read_b64_tr_b16 v[40:41], v22 offset:1024
    ds_read_b64_tr_b16 v[42:43], v22 offset:3072
    s_waitcnt lgkmcnt(10)
    v_mfma_f32_32x32x16_bf16 v[104:119], v[48:51], v[152:155], 0
    ds_read_b64_tr_b16 v[44:45], v23 offset:1024
    ds_read_b64_tr_b16 v[46:47], v23 offset:3072
    s_waitcnt vmcnt(7)
    s_waitcnt lgkmcnt(10)
    v_mfma_f32_32x32x16_bf16 v[56:71], v[52:55], v[156:159], v[56:71]
    ds_read_b64_tr_b16 v[48:49], v20 offset:4096
    ds_read_b64_tr_b16 v[50:51], v20 offset:6144
    s_waitcnt lgkmcnt(10)
    v_mfma_f32_32x32x16_bf16 v[72:87], v[28:31], v[156:159], v[72:87]
    buffer_load_dwordx4 v[188:191], v249, s[32:35], s16 offen offset:1024 sc1
    ds_read_b64_tr_b16 v[52:53], v21 offset:4096
    ds_read_b64_tr_b16 v[54:55], v21 offset:6144
    s_waitcnt lgkmcnt(10)
    v_mfma_f32_32x32x16_bf16 v[120:135], v[32:35], v[156:159], v[120:135]
    ds_read_b64_tr_b16 v[28:29], v24 offset:4096
    ds_read_b64_tr_b16 v[30:31], v24 offset:6144
    s_waitcnt lgkmcnt(10)
    v_mfma_f32_32x32x16_bf16 v[136:151], v[36:39], v[156:159], v[136:151]
    ds_read_b64_tr_b16 v[32:33], v25 offset:4096
    ds_read_b64_tr_b16 v[34:35], v25 offset:6144
    s_waitcnt lgkmcnt(10)
    v_mfma_f32_32x32x16_bf16 v[88:103], v[40:43], v[156:159], v[88:103]
    ds_read_b64_tr_b16 v[36:37], v22 offset:4096
    ds_read_b64_tr_b16 v[38:39], v22 offset:6144
    s_waitcnt lgkmcnt(10)
    v_mfma_f32_32x32x16_bf16 v[104:119], v[44:47], v[156:159], v[104:119]
    buffer_load_dwordx4 v[192:195], v249, s[32:35], s16 offen offset:2048 sc1
    ds_read_b64_tr_b16 v[40:41], v23 offset:4096
    ds_read_b64_tr_b16 v[42:43], v23 offset:6144
    s_waitcnt vmcnt(8)
    s_waitcnt lgkmcnt(10)
    v_mfma_f32_32x32x16_bf16 v[56:71], v[48:51], v[160:163], v[56:71]
    ds_read_b64_tr_b16 v[44:45], v20 offset:5120
    ds_read_b64_tr_b16 v[46:47], v20 offset:7168
    s_waitcnt lgkmcnt(10)
    v_mfma_f32_32x32x16_bf16 v[72:87], v[52:55], v[160:163], v[72:87]
    ds_read_b64_tr_b16 v[48:49], v21 offset:5120
    ds_read_b64_tr_b16 v[50:51], v21 offset:7168
    s_waitcnt lgkmcnt(10)
    v_mfma_f32_32x32x16_bf16 v[120:135], v[28:31], v[160:163], v[120:135]
    ds_read_b64_tr_b16 v[52:53], v24 offset:5120
    ds_read_b64_tr_b16 v[54:55], v24 offset:7168
    s_waitcnt lgkmcnt(10)
    v_mfma_f32_32x32x16_bf16 v[136:151], v[32:35], v[160:163], v[136:151]
    buffer_load_dwordx4 v[196:199], v249, s[32:35], s16 offen offset:3072 sc1
    ds_read_b64_tr_b16 v[28:29], v25 offset:5120
    ds_read_b64_tr_b16 v[30:31], v25 offset:7168
    s_waitcnt lgkmcnt(10)
    v_mfma_f32_32x32x16_bf16 v[88:103], v[36:39], v[160:163], v[88:103]
    s_add_u32 s16, s16, 16384
    ds_read_b64_tr_b16 v[32:33], v22 offset:5120
    ds_read_b64_tr_b16 v[34:35], v22 offset:7168
    s_waitcnt lgkmcnt(10)
    v_mfma_f32_32x32x16_bf16 v[104:119], v[40:43], v[160:163], v[104:119]
    s_and_b32 s16, s16, 0x3ffff
    ds_read_b64_tr_b16 v[36:37], v23 offset:5120
    ds_read_b64_tr_b16 v[38:39], v23 offset:7168
    s_waitcnt vmcnt(8)
    s_waitcnt lgkmcnt(10)
    v_mfma_f32_32x32x16_bf16 v[56:71], v[44:47], v[164:167], v[56:71]
    ds_read_b64_tr_b16 v[40:41], v20 offset:8192
    ds_read_b64_tr_b16 v[42:43], v20 offset:10240
    s_waitcnt lgkmcnt(10)
    v_mfma_f32_32x32x16_bf16 v[72:87], v[48:51], v[164:167], v[72:87]
    buffer_load_dwordx4 v[200:203], v249, s[32:35], s16 offen sc1
    ds_read_b64_tr_b16 v[44:45], v21 offset:8192
    ds_read_b64_tr_b16 v[46:47], v21 offset:10240
    s_waitcnt lgkmcnt(10)
    v_mfma_f32_32x32x16_bf16 v[120:135], v[52:55], v[164:167], v[120:135]
    ds_read_b64_tr_b16 v[48:49], v24 offset:8192
    ds_read_b64_tr_b16 v[50:51], v24 offset:10240
    s_waitcnt lgkmcnt(10)
    v_mfma_f32_32x32x16_bf16 v[136:151], v[28:31], v[164:167], v[136:151]
    ds_read_b64_tr_b16 v[52:53], v25 offset:8192
    ds_read_b64_tr_b16 v[54:55], v25 offset:10240
    s_waitcnt lgkmcnt(10)
    v_mfma_f32_32x32x16_bf16 v[88:103], v[32:35], v[164:167], v[88:103]
    ds_read_b64_tr_b16 v[28:29], v22 offset:8192
    ds_read_b64_tr_b16 v[30:31], v22 offset:10240
    s_waitcnt lgkmcnt(10)
    v_mfma_f32_32x32x16_bf16 v[104:119], v[36:39], v[164:167], v[104:119]
    buffer_load_dwordx4 v[204:207], v249, s[32:35], s16 offen offset:1024 sc1
    ds_read_b64_tr_b16 v[32:33], v23 offset:8192
    ds_read_b64_tr_b16 v[34:35], v23 offset:10240
    s_barrier
    s_waitcnt vmcnt(9)
    s_waitcnt lgkmcnt(10)
    v_mfma_f32_32x32x16_bf16 v[56:71], v[40:43], v[168:171], v[56:71]
    ds_read_b64_tr_b16 v[36:37], v20 offset:9216
    ds_read_b64_tr_b16 v[38:39], v20 offset:11264
    s_waitcnt lgkmcnt(10)
    v_mfma_f32_32x32x16_bf16 v[72:87], v[44:47], v[168:171], v[72:87]
    ds_read_b64_tr_b16 v[40:41], v21 offset:9216
    ds_read_b64_tr_b16 v[42:43], v21 offset:11264
    s_waitcnt lgkmcnt(10)
    v_mfma_f32_32x32x16_bf16 v[120:135], v[48:51], v[168:171], v[120:135]
    ds_read_b64_tr_b16 v[44:45], v24 offset:9216
    ds_read_b64_tr_b16 v[46:47], v24 offset:11264
    s_waitcnt lgkmcnt(10)
    v_mfma_f32_32x32x16_bf16 v[136:151], v[52:55], v[168:171], v[136:151]
    ds_read_b64_tr_b16 v[48:49], v25 offset:9216
    ds_read_b64_tr_b16 v[50:51], v25 offset:11264
    s_waitcnt lgkmcnt(10)
    v_mfma_f32_32x32x16_bf16 v[88:103], v[28:31], v[168:171], v[88:103]
    ds_read_b64_tr_b16 v[52:53], v22 offset:9216
    ds_read_b64_tr_b16 v[54:55], v22 offset:11264
    s_waitcnt lgkmcnt(10)
    v_mfma_f32_32x32x16_bf16 v[104:119], v[32:35], v[168:171], v[104:119]
    ds_read_b64_tr_b16 v[28:29], v23 offset:9216
    ds_read_b64_tr_b16 v[30:31], v23 offset:11264
    s_waitcnt vmcnt(8)
    s_waitcnt lgkmcnt(10)
    v_mfma_f32_32x32x16_bf16 v[56:71], v[36:39], v[172:175], v[56:71]
    ds_read_b64_tr_b16 v[32:33], v20 offset:12288
    ds_read_b64_tr_b16 v[34:35], v20 offset:14336
    s_waitcnt lgkmcnt(10)
    v_mfma_f32_32x32x16_bf16 v[72:87], v[40:43], v[172:175], v[72:87]
    ds_read_b64_tr_b16 v[36:37], v21 offset:12288
    ds_read_b64_tr_b16 v[38:39], v21 offset:14336
    s_waitcnt lgkmcnt(10)
    v_mfma_f32_32x32x16_bf16 v[120:135], v[44:47], v[172:175], v[120:135]
    buffer_load_dwordx4 v[208:211], v249, s[32:35], s16 offen offset:2048 sc1
    ds_read_b64_tr_b16 v[40:41], v24 offset:12288
    ds_read_b64_tr_b16 v[42:43], v24 offset:14336
    s_waitcnt lgkmcnt(10)
    v_mfma_f32_32x32x16_bf16 v[136:151], v[48:51], v[172:175], v[136:151]
    ds_read_b64_tr_b16 v[44:45], v25 offset:12288
    ds_read_b64_tr_b16 v[46:47], v25 offset:14336
    s_waitcnt lgkmcnt(10)
    v_mfma_f32_32x32x16_bf16 v[88:103], v[52:55], v[172:175], v[88:103]
    ds_read_b64_tr_b16 v[48:49], v22 offset:12288
    ds_read_b64_tr_b16 v[50:51], v22 offset:14336
    s_waitcnt lgkmcnt(10)
    v_mfma_f32_32x32x16_bf16 v[104:119], v[28:31], v[172:175], v[104:119]
    buffer_load_dwordx4 v[212:215], v249, s[32:35], s16 offen offset:3072 sc1
    ds_read_b64_tr_b16 v[52:53], v23 offset:12288
    ds_read_b64_tr_b16 v[54:55], v23 offset:14336
    s_waitcnt vmcnt(9)
    s_waitcnt lgkmcnt(10)
    v_mfma_f32_32x32x16_bf16 v[56:71], v[32:35], v[176:179], v[56:71]
    s_add_u32 s16, s16, 16384
    ds_read_b64_tr_b16 v[28:29], v20 offset:13312
    ds_read_b64_tr_b16 v[30:31], v20 offset:15360
    s_waitcnt lgkmcnt(10)
    v_mfma_f32_32x32x16_bf16 v[72:87], v[36:39], v[176:179], v[72:87]
    s_and_b32 s16, s16, 0x3ffff
    ds_read_b64_tr_b16 v[32:33], v21 offset:13312
    ds_read_b64_tr_b16 v[34:35], v21 offset:15360
    s_waitcnt lgkmcnt(10)
    v_mfma_f32_32x32x16_bf16 v[120:135], v[40:43], v[176:179], v[120:135]
    buffer_load_dwordx4 v[216:219], v249, s[32:35], s16 offen sc1
    ds_read_b64_tr_b16 v[36:37], v24 offset:13312
    ds_read_b64_tr_b16 v[38:39], v24 offset:15360
    s_waitcnt lgkmcnt(10)
    v_mfma_f32_32x32x16_bf16 v[136:151], v[44:47], v[176:179], v[136:151]
    ds_read_b64_tr_b16 v[40:41], v25 offset:13312
    ds_read_b64_tr_b16 v[42:43], v25 offset:15360
    s_waitcnt lgkmcnt(10)
    v_mfma_f32_32x32x16_bf16 v[88:103], v[48:51], v[176:179], v[88:103]
    ds_read_b64_tr_b16 v[44:45], v22 offset:13312
    ds_read_b64_tr_b16 v[46:47], v22 offset:15360
    s_waitcnt lgkmcnt(10)
    v_mfma_f32_32x32x16_bf16 v[104:119], v[52:55], v[176:179], v[104:119]
    buffer_load_dwordx4 v[220:223], v249, s[32:35], s16 offen offset:1024 sc1
    ds_read_b64_tr_b16 v[48:49], v23 offset:13312
    ds_read_b64_tr_b16 v[50:51], v23 offset:15360
    s_waitcnt vmcnt(10)
    s_waitcnt lgkmcnt(10)
    v_mfma_f32_32x32x16_bf16 v[56:71], v[28:31], v[180:183], v[56:71]
    ds_read_b64_tr_b16 v[52:53], v20 offset:16384
    ds_read_b64_tr_b16 v[54:55], v20 offset:18432
    s_waitcnt lgkmcnt(10)
    v_mfma_f32_32x32x16_bf16 v[72:87], v[32:35], v[180:183], v[72:87]
    ds_read_b64_tr_b16 v[28:29], v21 offset:16384
    ds_read_b64_tr_b16 v[30:31], v21 offset:18432
    s_waitcnt lgkmcnt(10)
    v_mfma_f32_32x32x16_bf16 v[120:135], v[36:39], v[180:183], v[120:135]
    buffer_load_dwordx4 v[224:227], v249, s[32:35], s16 offen offset:2048 sc1
    ds_read_b64_tr_b16 v[32:33], v24 offset:16384
    ds_read_b64_tr_b16 v[34:35], v24 offset:18432
    s_waitcnt lgkmcnt(10)
    v_mfma_f32_32x32x16_bf16 v[136:151], v[40:43], v[180:183], v[136:151]
    ds_read_b64_tr_b16 v[36:37], v25 offset:16384
    ds_read_b64_tr_b16 v[38:39], v25 offset:18432
    s_waitcnt lgkmcnt(10)
    v_mfma_f32_32x32x16_bf16 v[88:103], v[44:47], v[180:183], v[88:103]
    ds_read_b64_tr_b16 v[40:41], v22 offset:16384
    ds_read_b64_tr_b16 v[42:43], v22 offset:18432
    s_waitcnt lgkmcnt(10)
    v_mfma_f32_32x32x16_bf16 v[104:119], v[48:51], v[180:183], v[104:119]
    buffer_load_dwordx4 v[228:231], v249, s[32:35], s16 offen offset:3072 sc1
    ds_read_b64_tr_b16 v[44:45], v23 offset:16384
    ds_read_b64_tr_b16 v[46:47], v23 offset:18432
    s_barrier
    s_waitcnt vmcnt(11)
    s_waitcnt lgkmcnt(10)
    v_mfma_f32_32x32x16_bf16 v[56:71], v[52:55], v[184:187], v[56:71]
    s_add_u32 s16, s16, 16384
    ds_read_b64_tr_b16 v[48:49], v20 offset:17408
    ds_read_b64_tr_b16 v[50:51], v20 offset:19456
    s_waitcnt lgkmcnt(10)
    v_mfma_f32_32x32x16_bf16 v[72:87], v[28:31], v[184:187], v[72:87]
    s_and_b32 s16, s16, 0x3ffff
    ds_read_b64_tr_b16 v[52:53], v21 offset:17408
    ds_read_b64_tr_b16 v[54:55], v21 offset:19456
    s_waitcnt lgkmcnt(10)
    v_mfma_f32_32x32x16_bf16 v[120:135], v[32:35], v[184:187], v[120:135]
    ds_read_b64_tr_b16 v[28:29], v24 offset:17408
    ds_read_b64_tr_b16 v[30:31], v24 offset:19456
    s_waitcnt lgkmcnt(10)
    v_mfma_f32_32x32x16_bf16 v[136:151], v[36:39], v[184:187], v[136:151]
    ds_read_b64_tr_b16 v[32:33], v25 offset:17408
    ds_read_b64_tr_b16 v[34:35], v25 offset:19456
    s_waitcnt lgkmcnt(10)
    v_mfma_f32_32x32x16_bf16 v[88:103], v[40:43], v[184:187], v[88:103]
    ds_read_b64_tr_b16 v[36:37], v22 offset:17408
    ds_read_b64_tr_b16 v[38:39], v22 offset:19456
    s_waitcnt lgkmcnt(10)
    v_mfma_f32_32x32x16_bf16 v[104:119], v[44:47], v[184:187], v[104:119]
    ds_read_b64_tr_b16 v[40:41], v23 offset:17408
    ds_read_b64_tr_b16 v[42:43], v23 offset:19456
    s_waitcnt vmcnt(10)
    s_waitcnt lgkmcnt(10)
    v_mfma_f32_32x32x16_bf16 v[56:71], v[48:51], v[188:191], v[56:71]
    ds_read_b64_tr_b16 v[44:45], v20 offset:20480
    ds_read_b64_tr_b16 v[46:47], v20 offset:22528
    s_waitcnt lgkmcnt(10)
    v_mfma_f32_32x32x16_bf16 v[72:87], v[52:55], v[188:191], v[72:87]
    ds_read_b64_tr_b16 v[48:49], v21 offset:20480
    ds_read_b64_tr_b16 v[50:51], v21 offset:22528
    s_waitcnt lgkmcnt(10)
    v_mfma_f32_32x32x16_bf16 v[120:135], v[28:31], v[188:191], v[120:135]
    buffer_load_dwordx4 v[232:235], v249, s[32:35], s16 offen sc1
    ds_read_b64_tr_b16 v[52:53], v24 offset:20480
    ds_read_b64_tr_b16 v[54:55], v24 offset:22528
    s_waitcnt lgkmcnt(10)
    v_mfma_f32_32x32x16_bf16 v[136:151], v[32:35], v[188:191], v[136:151]
    ds_read_b64_tr_b16 v[28:29], v25 offset:20480
    ds_read_b64_tr_b16 v[30:31], v25 offset:22528
    s_waitcnt lgkmcnt(10)
    v_mfma_f32_32x32x16_bf16 v[88:103], v[36:39], v[188:191], v[88:103]
    ds_read_b64_tr_b16 v[32:33], v22 offset:20480
    ds_read_b64_tr_b16 v[34:35], v22 offset:22528
    s_waitcnt lgkmcnt(10)
    v_mfma_f32_32x32x16_bf16 v[104:119], v[40:43], v[188:191], v[104:119]
    buffer_load_dwordx4 v[236:239], v249, s[32:35], s16 offen offset:1024 sc1
    ds_read_b64_tr_b16 v[36:37], v23 offset:20480
    ds_read_b64_tr_b16 v[38:39], v23 offset:22528
    s_waitcnt vmcnt(11)
    s_waitcnt lgkmcnt(10)
    v_mfma_f32_32x32x16_bf16 v[56:71], v[44:47], v[192:195], v[56:71]
    ds_read_b64_tr_b16 v[40:41], v20 offset:21504
    ds_read_b64_tr_b16 v[42:43], v20 offset:23552
    s_waitcnt lgkmcnt(10)
    v_mfma_f32_32x32x16_bf16 v[72:87], v[48:51], v[192:195], v[72:87]
    ds_read_b64_tr_b16 v[44:45], v21 offset:21504
    ds_read_b64_tr_b16 v[46:47], v21 offset:23552
    s_waitcnt lgkmcnt(10)
    v_mfma_f32_32x32x16_bf16 v[120:135], v[52:55], v[192:195], v[120:135]
    buffer_load_dwordx4 v[240:243], v249, s[32:35], s16 offen offset:2048 sc1
    ds_read_b64_tr_b16 v[48:49], v24 offset:21504
    ds_read_b64_tr_b16 v[50:51], v24 offset:23552
    s_waitcnt lgkmcnt(10)
    v_mfma_f32_32x32x16_bf16 v[136:151], v[28:31], v[192:195], v[136:151]
    ds_read_b64_tr_b16 v[52:53], v25 offset:21504
    ds_read_b64_tr_b16 v[54:55], v25 offset:23552
    s_waitcnt lgkmcnt(10)
    v_mfma_f32_32x32x16_bf16 v[88:103], v[32:35], v[192:195], v[88:103]
    ds_read_b64_tr_b16 v[28:29], v22 offset:21504
    ds_read_b64_tr_b16 v[30:31], v22 offset:23552
    s_waitcnt lgkmcnt(10)
    v_mfma_f32_32x32x16_bf16 v[104:119], v[36:39], v[192:195], v[104:119]
    buffer_load_dwordx4 v[244:247], v249, s[32:35], s16 offen offset:3072 sc1
    ds_read_b64_tr_b16 v[32:33], v23 offset:21504
    ds_read_b64_tr_b16 v[34:35], v23 offset:23552
    s_waitcnt vmcnt(12)
    s_waitcnt lgkmcnt(10)
    v_mfma_f32_32x32x16_bf16 v[56:71], v[40:43], v[196:199], v[56:71]
    s_add_u32 s16, s16, 16384
    ds_read_b64_tr_b16 v[36:37], v20 offset:24576
    ds_read_b64_tr_b16 v[38:39], v20 offset:26624
    s_waitcnt lgkmcnt(10)
    v_mfma_f32_32x32x16_bf16 v[72:87], v[44:47], v[196:199], v[72:87]
    s_and_b32 s16, s16, 0x3ffff
    ds_read_b64_tr_b16 v[40:41], v21 offset:24576
    ds_read_b64_tr_b16 v[42:43], v21 offset:26624
    s_waitcnt lgkmcnt(10)
    v_mfma_f32_32x32x16_bf16 v[120:135], v[48:51], v[196:199], v[120:135]
    buffer_load_dwordx4 v[152:155], v249, s[32:35], s16 offen sc1
    ds_read_b64_tr_b16 v[44:45], v24 offset:24576
    ds_read_b64_tr_b16 v[46:47], v24 offset:26624
    s_waitcnt lgkmcnt(10)
    v_mfma_f32_32x32x16_bf16 v[136:151], v[52:55], v[196:199], v[136:151]
    ds_read_b64_tr_b16 v[48:49], v25 offset:24576
    ds_read_b64_tr_b16 v[50:51], v25 offset:26624
    s_waitcnt lgkmcnt(10)
    v_mfma_f32_32x32x16_bf16 v[88:103], v[28:31], v[196:199], v[88:103]
    ds_read_b64_tr_b16 v[52:53], v22 offset:24576
    ds_read_b64_tr_b16 v[54:55], v22 offset:26624
    s_waitcnt lgkmcnt(10)
    v_mfma_f32_32x32x16_bf16 v[104:119], v[32:35], v[196:199], v[104:119]
    buffer_load_dwordx4 v[156:159], v249, s[32:35], s16 offen offset:1024 sc1
    ds_read_b64_tr_b16 v[28:29], v23 offset:24576
    ds_read_b64_tr_b16 v[30:31], v23 offset:26624
    s_barrier
    s_waitcnt vmcnt(13)
    s_waitcnt lgkmcnt(10)
    v_mfma_f32_32x32x16_bf16 v[56:71], v[36:39], v[200:203], v[56:71]
    ds_read_b64_tr_b16 v[32:33], v20 offset:25600
    ds_read_b64_tr_b16 v[34:35], v20 offset:27648
    s_waitcnt lgkmcnt(10)
    v_mfma_f32_32x32x16_bf16 v[72:87], v[40:43], v[200:203], v[72:87]
    ds_read_b64_tr_b16 v[36:37], v21 offset:25600
    ds_read_b64_tr_b16 v[38:39], v21 offset:27648
    s_waitcnt lgkmcnt(10)
    v_mfma_f32_32x32x16_bf16 v[120:135], v[44:47], v[200:203], v[120:135]
    ds_read_b64_tr_b16 v[40:41], v24 offset:25600
    ds_read_b64_tr_b16 v[42:43], v24 offset:27648
    s_waitcnt lgkmcnt(10)
    v_mfma_f32_32x32x16_bf16 v[136:151], v[48:51], v[200:203], v[136:151]
    ds_read_b64_tr_b16 v[44:45], v25 offset:25600
    ds_read_b64_tr_b16 v[46:47], v25 offset:27648
    s_waitcnt lgkmcnt(10)
    v_mfma_f32_32x32x16_bf16 v[88:103], v[52:55], v[200:203], v[88:103]
    ds_read_b64_tr_b16 v[48:49], v22 offset:25600
    ds_read_b64_tr_b16 v[50:51], v22 offset:27648
    s_waitcnt lgkmcnt(10)
    v_mfma_f32_32x32x16_bf16 v[104:119], v[28:31], v[200:203], v[104:119]
    ds_read_b64_tr_b16 v[52:53], v23 offset:25600
    ds_read_b64_tr_b16 v[54:55], v23 offset:27648
    s_waitcnt vmcnt(12)
    s_waitcnt lgkmcnt(10)
    v_mfma_f32_32x32x16_bf16 v[56:71], v[32:35], v[204:207], v[56:71]
    ds_read_b64_tr_b16 v[28:29], v20 offset:28672
    ds_read_b64_tr_b16 v[30:31], v20 offset:30720
    s_waitcnt lgkmcnt(10)
    v_mfma_f32_32x32x16_bf16 v[72:87], v[36:39], v[204:207], v[72:87]
    ds_read_b64_tr_b16 v[32:33], v21 offset:28672
    ds_read_b64_tr_b16 v[34:35], v21 offset:30720
L_PAD2:
    s_cbranch_execz L_RET2
    s_waitcnt lgkmcnt(10)
    v_mfma_f32_32x32x16_bf16 v[120:135], v[40:43], v[204:207], v[120:135]
    buffer_load_dwordx4 v[160:163], v249, s[32:35], s16 offen offset:2048 sc1
    ds_read_b64_tr_b16 v[36:37], v24 offset:28672
    ds_read_b64_tr_b16 v[38:39], v24 offset:30720
    s_waitcnt lgkmcnt(10)
    v_mfma_f32_32x32x16_bf16 v[136:151], v[44:47], v[204:207], v[136:151]
    ds_read_b64_tr_b16 v[40:41], v25 offset:28672
    ds_read_b64_tr_b16 v[42:43], v25 offset:30720
    s_waitcnt lgkmcnt(10)
    v_mfma_f32_32x32x16_bf16 v[88:103], v[48:51], v[204:207], v[88:103]
    ds_read_b64_tr_b16 v[44:45], v22 offset:28672
    ds_read_b64_tr_b16 v[46:47], v22 offset:30720
    s_waitcnt lgkmcnt(10)
    v_mfma_f32_32x32x16_bf16 v[104:119], v[52:55], v[204:207], v[104:119]
    buffer_load_dwordx4 v[164:167], v249, s[32:35], s16 offen offset:3072 sc1
    ds_read_b64_tr_b16 v[48:49], v23 offset:28672
    ds_read_b64_tr_b16 v[50:51], v23 offset:30720
    s_waitcnt vmcnt(13)
    s_waitcnt lgkmcnt(10)
    v_mfma_f32_32x32x16_bf16 v[56:71], v[28:31], v[208:211], v[56:71]
    s_add_u32 s16, s16, 16384
    ds_read_b64_tr_b16 v[52:53], v20 offset:29696
    ds_read_b64_tr_b16 v[54:55], v20 offset:31744
    s_waitcnt lgkmcnt(10)
    v_mfma_f32_32x32x16_bf16 v[72:87], v[32:35], v[208:211], v[72:87]
    s_and_b32 s16, s16, 0x3ffff
    ds_read_b64_tr_b16 v[28:29], v21 offset:29696
    ds_read_b64_tr_b16 v[30:31], v21 offset:31744
    s_waitcnt lgkmcnt(10)
    v_mfma_f32_32x32x16_bf16 v[120:135], v[36:39], v[208:211], v[120:135]
    buffer_load_dwordx4 v[168:171], v249, s[32:35], s16 offen sc1
    ds_read_b64_tr_b16 v[32:33], v24 offset:29696
    ds_read_b64_tr_b16 v[34:35], v24 offset:31744
    s_waitcnt lgkmcnt(10)
    v_mfma_f32_32x32x16_bf16 v[136:151], v[40:43], v[208:211], v[136:151]
    ds_read_b64_tr_b16 v[36:37], v25 offset:29696
    ds_read_b64_tr_b16 v[38:39], v25 offset:31744
    s_waitcnt lgkmcnt(10)
    v_mfma_f32_32x32x16_bf16 v[88:103], v[44:47], v[208:211], v[88:103]
    ds_read_b64_tr_b16 v[40:41], v22 offset:29696
    ds_read_b64_tr_b16 v[42:43], v22 offset:31744
    s_waitcnt lgkmcnt(10)
    v_mfma_f32_32x32x16_bf16 v[104:119], v[48:51], v[208:211], v[104:119]
    buffer_load_dwordx4 v[172:175], v249, s[32:35], s16 offen offset:1024 sc1
    ds_read_b64_tr_b16 v[44:45], v23 offset:29696
    ds_read_b64_tr_b16 v[46:47], v23 offset:31744
    s_waitcnt vmcnt(14)
    s_waitcnt lgkmcnt(10)
    v_mfma_f32_32x32x16_bf16 v[56:71], v[52:55], v[212:215], v[56:71]
    ds_read_b64_tr_b16 v[48:49], v20 offset:32768
    ds_read_b64_tr_b16 v[50:51], v20 offset:34816
    s_waitcnt lgkmcnt(10)
    v_mfma_f32_32x32x16_bf16 v[72:87], v[28:31], v[212:215], v[72:87]
    ds_read_b64_tr_b16 v[52:53], v21 offset:32768
    ds_read_b64_tr_b16 v[54:55], v21 offset:34816
    s_waitcnt lgkmcnt(10)
    v_mfma_f32_32x32x16_bf16 v[120:135], v[32:35], v[212:215], v[120:135]
    buffer_load_dwordx4 v[176:179], v249, s[32:35], s16 offen offset:2048 sc1
    ds_read_b64_tr_b16 v[28:29], v24 offset:32768
    ds_read_b64_tr_b16 v[30:31], v24 offset:34816
    s_waitcnt lgkmcnt(10)
    v_mfma_f32_32x32x16_bf16 v[136:151], v[36:39], v[212:215], v[136:151]
    ds_read_b64_tr_b16 v[32:33], v25 offset:32768
    ds_read_b64_tr_b16 v[34:35], v25 offset:34816
    s_waitcnt lgkmcnt(10)
    v_mfma_f32_32x32x16_bf16 v[88:103], v[40:43], v[212:215], v[88:103]
    ds_read_b64_tr_b16 v[36:37], v22 offset:32768
    ds_read_b64_tr_b16 v[38:39], v22 offset:34816
    s_waitcnt lgkmcnt(10)
    v_mfma_f32_32x32x16_bf16 v[104:119], v[44:47], v[212:215], v[104:119]
    buffer_load_dwordx4 v[180:183], v249, s[32:35], s16 offen offset:3072 sc1
    ds_read_b64_tr_b16 v[40:41], v23 offset:32768
    ds_read_b64_tr_b16 v[42:43], v23 offset:34816
    s_barrier
    s_waitcnt vmcnt(15)
    s_waitcnt lgkmcnt(10)
    v_mfma_f32_32x32x16_bf16 v[56:71], v[48:51], v[216:219], v[56:71]
    s_add_u32 s16, s16, 16384
    ds_read_b64_tr_b16 v[44:45], v20 offset:33792
    ds_read_b64_tr_b16 v[46:47], v20 offset:35840
    s_waitcnt lgkmcnt(10)
    v_mfma_f32_32x32x16_bf16 v[72:87], v[52:55], v[216:219], v[72:87]
    s_and_b32 s16, s16, 0x3ffff
    ds_read_b64_tr_b16 v[48:49], v21 offset:33792
    ds_read_b64_tr_b16 v[50:51], v21 offset:35840
    s_waitcnt lgkmcnt(10)
    v_mfma_f32_32x32x16_bf16 v[120:135], v[28:31], v[216:219], v[120:135]
    ds_read_b64_tr_b16 v[52:53], v24 offset:33792
    ds_read_b64_tr_b16 v[54:55], v24 offset:35840
    s_waitcnt lgkmcnt(10)
    v_mfma_f32_32x32x16_bf16 v[136:151], v[32:35], v[216:219], v[136:151]
    ds_read_b64_tr_b16 v[28:29], v25 offset:33792
    ds_read_b64_tr_b16 v[30:31], v25 offset:35840
    s_waitcnt lgkmcnt(10)
    v_mfma_f32_32x32x16_bf16 v[88:103], v[36:39], v[216:219], v[88:103]
    ds_read_b64_tr_b16 v[32:33], v22 offset:33792
    ds_read_b64_tr_b16 v[34:35], v22 offset:35840
    s_waitcnt lgkmcnt(10)
    v_mfma_f32_32x32x16_bf16 v[104:119], v[40:43], v[216:219], v[104:119]
    ds_read_b64_tr_b16 v[36:37], v23 offset:33792
    ds_read_b64_tr_b16 v[38:39], v23 offset:35840
    s_waitcnt vmcnt(14)
    s_waitcnt lgkmcnt(10)
    v_mfma_f32_32x32x16_bf16 v[56:71], v[44:47], v[220:223], v[56:71]
    ds_read_b64_tr_b16 v[40:41], v20 offset:36864
    ds_read_b64_tr_b16 v[42:43], v20 offset:38912
    s_waitcnt lgkmcnt(10)
    v_mfma_f32_32x32x16_bf16 v[72:87], v[48:51], v[220:223], v[72:87]
    ds_read_b64_tr_b16 v[44:45], v21 offset:36864
    ds_read_b64_tr_b16 v[46:47], v21 offset:38912
    s_waitcnt lgkmcnt(10)
    v_mfma_f32_32x32x16_bf16 v[120:135], v[52:55], v[220:223], v[120:135]
    buffer_load_dwordx4 v[184:187], v249, s[32:35], s16 offen sc1
    ds_read_b64_tr_b16 v[48:49], v24 offset:36864
    ds_read_b64_tr_b16 v[50:51], v24 offset:38912
    s_waitcnt lgkmcnt(10)
    v_mfma_f32_32x32x16_bf16 v[136:151], v[28:31], v[220:223], v[136:151]
    ds_read_b64_tr_b16 v[52:53], v25 offset:36864
    ds_read_b64_tr_b16 v[54:55], v25 offset:38912
    s_waitcnt lgkmcnt(10)
    v_mfma_f32_32x32x16_bf16 v[88:103], v[32:35], v[220:223], v[88:103]
    ds_read_b64_tr_b16 v[28:29], v22 offset:36864
    ds_read_b64_tr_b16 v[30:31], v22 offset:38912
    s_waitcnt lgkmcnt(10)
    v_mfma_f32_32x32x16_bf16 v[104:119], v[36:39], v[220:223], v[104:119]
    buffer_load_dwordx4 v[188:191], v249, s[32:35], s16 offen offset:1024 sc1
    ds_read_b64_tr_b16 v[32:33], v23 offset:36864
    ds_read_b64_tr_b16 v[34:35], v23 offset:38912
    s_waitcnt vmcnt(15)
    s_waitcnt lgkmcnt(10)
    v_mfma_f32_32x32x16_bf16 v[56:71], v[40:43], v[224:227], v[56:71]
    ds_read_b64_tr_b16 v[36:37], v20 offset:37888
    ds_read_b64_tr_b16 v[38:39], v20 offset:39936
    s_waitcnt lgkmcnt(10)
    v_mfma_f32_32x32x16_bf16 v[72:87], v[44:47], v[224:227], v[72:87]
    ds_read_b64_tr_b16 v[40:41], v21 offset:37888
    ds_read_b64_tr_b16 v[42:43], v21 offset:39936
    s_waitcnt lgkmcnt(10)
    v_mfma_f32_32x32x16_bf16 v[120:135], v[48:51], v[224:227], v[120:135]
    buffer_load_dwordx4 v[192:195], v249, s[32:35], s16 offen offset:2048 sc1
    ds_read_b64_tr_b16 v[44:45], v24 offset:37888
    ds_read_b64_tr_b16 v[46:47], v24 offset:39936
    s_waitcnt lgkmcnt(10)
    v_mfma_f32_32x32x16_bf16 v[136:151], v[52:55], v[224:227], v[136:151]
    ds_read_b64_tr_b16 v[48:49], v25 offset:37888
    ds_read_b64_tr_b16 v[50:51], v25 offset:39936
    s_waitcnt lgkmcnt(10)
    v_mfma_f32_32x32x16_bf16 v[88:103], v[28:31], v[224:227], v[88:103]
    ds_read_b64_tr_b16 v[52:53], v22 offset:37888
    ds_read_b64_tr_b16 v[54:55], v22 offset:39936
    s_waitcnt lgkmcnt(10)
    v_mfma_f32_32x32x16_bf16 v[104:119], v[32:35], v[224:227], v[104:119]
    buffer_load_dwordx4 v[196:199], v249, s[32:35], s16 offen offset:3072 sc1
    ds_read_b64_tr_b16 v[28:29], v23 offset:37888
    ds_read_b64_tr_b16 v[30:31], v23 offset:39936
    s_waitcnt vmcnt(16)
    s_waitcnt lgkmcnt(10)
    v_mfma_f32_32x32x16_bf16 v[56:71], v[36:39], v[228:231], v[56:71]
    s_add_u32 s16, s16, 16384
    ds_read_b64_tr_b16 v[32:33], v20 offset:40960
    ds_read_b64_tr_b16 v[34:35], v20 offset:43008
    s_waitcnt lgkmcnt(10)
    v_mfma_f32_32x32x16_bf16 v[72:87], v[40:43], v[228:231], v[72:87]
    s_and_b32 s16, s16, 0x3ffff
    ds_read_b64_tr_b16 v[36:37], v21 offset:40960
    ds_read_b64_tr_b16 v[38:39], v21 offset:43008
    s_waitcnt lgkmcnt(10)
    v_mfma_f32_32x32x16_bf16 v[120:135], v[44:47], v[228:231], v[120:135]
    buffer_load_dwordx4 v[200:203], v249, s[32:35], s16 offen sc1
    ds_read_b64_tr_b16 v[40:41], v24 offset:40960
    ds_read_b64_tr_b16 v[42:43], v24 offset:43008
    s_waitcnt lgkmcnt(10)
    v_mfma_f32_32x32x16_bf16 v[136:151], v[48:51], v[228:231], v[136:151]
    ds_read_b64_tr_b16 v[44:45], v25 offset:40960
    ds_read_b64_tr_b16 v[46:47], v25 offset:43008
    s_waitcnt lgkmcnt(10)
    v_mfma_f32_32x32x16_bf16 v[88:103], v[52:55], v[228:231], v[88:103]
    ds_read_b64_tr_b16 v[48:49], v22 offset:40960
    ds_read_b64_tr_b16 v[50:51], v22 offset:43008
    s_waitcnt lgkmcnt(10)
    v_mfma_f32_32x32x16_bf16 v[104:119], v[28:31], v[228:231], v[104:119]
    buffer_load_dwordx4 v[204:207], v249, s[32:35], s16 offen offset:1024 sc1
    ds_read_b64_tr_b16 v[52:53], v23 offset:40960
    ds_read_b64_tr_b16 v[54:55], v23 offset:43008
    s_barrier
    s_waitcnt vmcnt(17)
    s_waitcnt lgkmcnt(10)
    v_mfma_f32_32x32x16_bf16 v[56:71], v[32:35], v[232:235], v[56:71]
    ds_read_b64_tr_b16 v[28:29], v20 offset:41984
    ds_read_b64_tr_b16 v[30:31], v20 offset:44032
    s_waitcnt lgkmcnt(10)
    v_mfma_f32_32x32x16_bf16 v[72:87], v[36:39], v[232:235], v[72:87]
    ds_read_b64_tr_b16 v[32:33], v21 offset:41984
    ds_read_b64_tr_b16 v[34:35], v21 offset:44032
    s_waitcnt lgkmcnt(10)
    v_mfma_f32_32x32x16_bf16 v[120:135], v[40:43], v[232:235], v[120:135]
    ds_read_b64_tr_b16 v[36:37], v24 offset:41984
    ds_read_b64_tr_b16 v[38:39], v24 offset:44032
    s_waitcnt lgkmcnt(10)
    v_mfma_f32_32x32x16_bf16 v[136:151], v[44:47], v[232:235], v[136:151]
    ds_read_b64_tr_b16 v[40:41], v25 offset:41984
    ds_read_b64_tr_b16 v[42:43], v25 offset:44032
    s_waitcnt lgkmcnt(10)
    v_mfma_f32_32x32x16_bf16 v[88:103], v[48:51], v[232:235], v[88:103]
    ds_read_b64_tr_b16 v[44:45], v22 offset:41984
    ds_read_b64_tr_b16 v[46:47], v22 offset:44032
    s_waitcnt lgkmcnt(10)
    v_mfma_f32_32x32x16_bf16 v[104:119], v[52:55], v[232:235], v[104:119]
    ds_read_b64_tr_b16 v[48:49], v23 offset:41984
    ds_read_b64_tr_b16 v[50:51], v23 offset:44032
    s_waitcnt vmcnt(16)
    s_waitcnt lgkmcnt(10)
    v_mfma_f32_32x32x16_bf16 v[56:71], v[28:31], v[236:239], v[56:71]
    ds_read_b64_tr_b16 v[52:53], v20 offset:45056
    ds_read_b64_tr_b16 v[54:55], v20 offset:47104
    s_waitcnt lgkmcnt(10)
    v_mfma_f32_32x32x16_bf16 v[72:87], v[32:35], v[236:239], v[72:87]
    ds_read_b64_tr_b16 v[28:29], v21 offset:45056
    ds_read_b64_tr_b16 v[30:31], v21 offset:47104
    s_waitcnt lgkmcnt(10)
    v_mfma_f32_32x32x16_bf16 v[120:135], v[36:39], v[236:239], v[120:135]
    buffer_load_dwordx4 v[208:211], v249, s[32:35], s16 offen offset:2048 sc1
    ds_read_b64_tr_b16 v[32:33], v24 offset:45056
    ds_read_b64_tr_b16 v[34:35], v24 offset:47104
    s_waitcnt lgkmcnt(10)
    v_mfma_f32_32x32x16_bf16 v[136:151], v[40:43], v[236:239], v[136:151]
    ds_read_b64_tr_b16 v[36:37], v25 offset:45056
    ds_read_b64_tr_b16 v[38:39], v25 offset:47104
    s_waitcnt lgkmcnt(10)
    v_mfma_f32_32x32x16_bf16 v[88:103], v[44:47], v[236:239], v[88:103]
    ds_read_b64_tr_b16 v[40:41], v22 offset:45056
    ds_read_b64_tr_b16 v[42:43], v22 offset:47104
    s_waitcnt lgkmcnt(10)
    v_mfma_f32_32x32x16_bf16 v[104:119], v[48:51], v[236:239], v[104:119]
    buffer_load_dwordx4 v[212:215], v249, s[32:35], s16 offen offset:3072 sc1
    ds_read_b64_tr_b16 v[44:45], v23 offset:45056
    ds_read_b64_tr_b16 v[46:47], v23 offset:47104
    s_waitcnt vmcnt(17)
    s_waitcnt lgkmcnt(10)
    v_mfma_f32_32x32x16_bf16 v[56:71], v[52:55], v[240:243], v[56:71]
    s_add_u32 s16, s16, 16384
    ds_read_b64_tr_b16 v[48:49], v20 offset:46080
    ds_read_b64_tr_b16 v[50:51], v20 offset:48128
    s_waitcnt lgkmcnt(10)
    v_mfma_f32_32x32x16_bf16 v[72:87], v[28:31], v[240:243], v[72:87]
    s_and_b32 s16, s16, 0x3ffff
    ds_read_b64_tr_b16 v[52:53], v21 offset:46080
    ds_read_b64_tr_b16 v[54:55], v21 offset:48128
    s_waitcnt lgkmcnt(10)
    v_mfma_f32_32x32x16_bf16 v[120:135], v[32:35], v[240:243], v[120:135]
    buffer_load_dwordx4 v[216:219], v249, s[32:35], s16 offen sc1
    ds_read_b64_tr_b16 v[28:29], v24 offset:46080
    ds_read_b64_tr_b16 v[30:31], v24 offset:48128
    s_waitcnt lgkmcnt(10)
    v_mfma_f32_32x32x16_bf16 v[136:151], v[36:39], v[240:243], v[136:151]
    ds_read_b64_tr_b16 v[32:33], v25 offset:46080
    ds_read_b64_tr_b16 v[34:35], v25 offset:48128
    s_waitcnt lgkmcnt(10)
    v_mfma_f32_32x32x16_bf16 v[88:103], v[40:43], v[240:243], v[88:103]
    ds_read_b64_tr_b16 v[36:37], v22 offset:46080
    ds_read_b64_tr_b16 v[38:39], v22 offset:48128
    s_waitcnt lgkmcnt(10)
    v_mfma_f32_32x32x16_bf16 v[104:119], v[44:47], v[240:243], v[104:119]
    buffer_load_dwordx4 v[220:223], v249, s[32:35], s16 offen offset:1024 sc1
    ds_read_b64_tr_b16 v[40:41], v23 offset:46080
    ds_read_b64_tr_b16 v[42:43], v23 offset:48128
    s_waitcnt vmcnt(18)
    s_waitcnt lgkmcnt(10)
    v_mfma_f32_32x32x16_bf16 v[56:71], v[48:51], v[244:247], v[56:71]
    ds_read_b64_tr_b16 v[44:45], v20
    ds_read_b64_tr_b16 v[46:47], v20 offset:2048
    s_waitcnt lgkmcnt(10)
    v_mfma_f32_32x32x16_bf16 v[72:87], v[52:55], v[244:247], v[72:87]
    ds_read_b64_tr_b16 v[48:49], v21
    ds_read_b64_tr_b16 v[50:51], v21 offset:2048
    s_waitcnt lgkmcnt(10)
    v_mfma_f32_32x32x16_bf16 v[120:135], v[28:31], v[244:247], v[120:135]
    buffer_load_dwordx4 v[224:227], v249, s[32:35], s16 offen offset:2048 sc1
    ds_read_b64_tr_b16 v[52:53], v24
    ds_read_b64_tr_b16 v[54:55], v24 offset:2048
    s_waitcnt lgkmcnt(10)
    v_mfma_f32_32x32x16_bf16 v[136:151], v[32:35], v[244:247], v[136:151]
    ds_read_b64_tr_b16 v[28:29], v25
    ds_read_b64_tr_b16 v[30:31], v25 offset:2048
    s_waitcnt lgkmcnt(10)
    v_mfma_f32_32x32x16_bf16 v[88:103], v[36:39], v[244:247], v[88:103]
    ds_read_b64_tr_b16 v[32:33], v22
    ds_read_b64_tr_b16 v[34:35], v22 offset:2048
    s_waitcnt lgkmcnt(10)
    v_mfma_f32_32x32x16_bf16 v[104:119], v[40:43], v[244:247], v[104:119]
    buffer_load_dwordx4 v[228:231], v249, s[32:35], s16 offen offset:3072 sc1
    ds_read_b64_tr_b16 v[36:37], v23
    ds_read_b64_tr_b16 v[38:39], v23 offset:2048
    s_barrier
    s_waitcnt vmcnt(19)
    s_waitcnt lgkmcnt(10)
    v_mfma_f32_32x32x16_bf16 v[56:71], v[44:47], v[152:155], v[56:71]
    s_add_u32 s16, s16, 16384
    ds_read_b64_tr_b16 v[40:41], v20 offset:1024
    ds_read_b64_tr_b16 v[42:43], v20 offset:3072
    s_waitcnt lgkmcnt(10)
    v_mfma_f32_32x32x16_bf16 v[72:87], v[48:51], v[152:155], v[72:87]
    s_and_b32 s16, s16, 0x3ffff
    ds_read_b64_tr_b16 v[44:45], v21 offset:1024
    ds_read_b64_tr_b16 v[46:47], v21 offset:3072
    s_waitcnt lgkmcnt(10)
    v_mfma_f32_32x32x16_bf16 v[120:135], v[52:55], v[152:155], v[120:135]
    ds_read_b64_tr_b16 v[48:49], v24 offset:1024
    ds_read_b64_tr_b16 v[50:51], v24 offset:3072
    s_waitcnt lgkmcnt(10)
    v_mfma_f32_32x32x16_bf16 v[136:151], v[28:31], v[152:155], v[136:151]
    ds_read_b64_tr_b16 v[52:53], v25 offset:1024
    ds_read_b64_tr_b16 v[54:55], v25 offset:3072
    s_waitcnt lgkmcnt(10)
    v_mfma_f32_32x32x16_bf16 v[88:103], v[32:35], v[152:155], v[88:103]
    ds_read_b64_tr_b16 v[28:29], v22 offset:1024
    ds_read_b64_tr_b16 v[30:31], v22 offset:3072
    s_waitcnt lgkmcnt(10)
    v_mfma_f32_32x32x16_bf16 v[104:119], v[36:39], v[152:155], v[104:119]
    ds_read_b64_tr_b16 v[32:33], v23 offset:1024
    ds_read_b64_tr_b16 v[34:35], v23 offset:3072
    s_waitcnt vmcnt(18)
    s_waitcnt lgkmcnt(10)
    v_mfma_f32_32x32x16_bf16 v[56:71], v[40:43], v[156:159], v[56:71]
    ds_read_b64_tr_b16 v[36:37], v20 offset:4096
    ds_read_b64_tr_b16 v[38:39], v20 offset:6144
    s_waitcnt lgkmcnt(10)
    v_mfma_f32_32x32x16_bf16 v[72:87], v[44:47], v[156:159], v[72:87]
    ds_read_b64_tr_b16 v[40:41], v21 offset:4096
    ds_read_b64_tr_b16 v[42:43], v21 offset:6144
    s_waitcnt lgkmcnt(10)
    v_mfma_f32_32x32x16_bf16 v[120:135], v[48:51], v[156:159], v[120:135]
    ds_read_b64_tr_b16 v[44:45], v24 offset:4096
    ds_read_b64_tr_b16 v[46:47], v24 offset:6144
    s_waitcnt lgkmcnt(10)
    v_mfma_f32_32x32x16_bf16 v[136:151], v[52:55], v[156:159], v[136:151]
    buffer_load_dwordx4 v[232:235], v249, s[32:35], s16 offen sc1
    ds_read_b64_tr_b16 v[48:49], v25 offset:4096
    ds_read_b64_tr_b16 v[50:51], v25 offset:6144
    s_waitcnt lgkmcnt(10)
    v_mfma_f32_32x32x16_bf16 v[88:103], v[28:31], v[156:159], v[88:103]
    ds_read_b64_tr_b16 v[52:53], v22 offset:4096
    ds_read_b64_tr_b16 v[54:55], v22 offset:6144
    s_waitcnt lgkmcnt(10)
    v_mfma_f32_32x32x16_bf16 v[104:119], v[32:35], v[156:159], v[104:119]
    ds_read_b64_tr_b16 v[28:29], v23 offset:4096
    ds_read_b64_tr_b16 v[30:31], v23 offset:6144
    s_waitcnt vmcnt(18)
    s_waitcnt lgkmcnt(10)
    v_mfma_f32_32x32x16_bf16 v[56:71], v[36:39], v[160:163], v[56:71]
    ds_read_b64_tr_b16 v[32:33], v20 offset:5120
    ds_read_b64_tr_b16 v[34:35], v20 offset:7168
    s_waitcnt lgkmcnt(10)
    v_mfma_f32_32x32x16_bf16 v[72:87], v[40:43], v[160:163], v[72:87]
    buffer_load_dwordx4 v[236:239], v249, s[32:35], s16 offen offset:1024 sc1
    ds_read_b64_tr_b16 v[36:37], v21 offset:5120
    ds_read_b64_tr_b16 v[38:39], v21 offset:7168
    s_waitcnt lgkmcnt(10)
    v_mfma_f32_32x32x16_bf16 v[120:135], v[44:47], v[160:163], v[120:135]
    ds_read_b64_tr_b16 v[40:41], v24 offset:5120
    ds_read_b64_tr_b16 v[42:43], v24 offset:7168
    s_waitcnt lgkmcnt(10)
    v_mfma_f32_32x32x16_bf16 v[136:151], v[48:51], v[160:163], v[136:151]
    ds_read_b64_tr_b16 v[44:45], v25 offset:5120
    ds_read_b64_tr_b16 v[46:47], v25 offset:7168
    s_waitcnt lgkmcnt(10)
    v_mfma_f32_32x32x16_bf16 v[88:103], v[52:55], v[160:163], v[88:103]
    buffer_load_dwordx4 v[240:243], v249, s[32:35], s16 offen offset:2048 sc1
    ds_read_b64_tr_b16 v[48:49], v22 offset:5120
    ds_read_b64_tr_b16 v[50:51], v22 offset:7168
    s_waitcnt lgkmcnt(10)
    v_mfma_f32_32x32x16_bf16 v[104:119], v[28:31], v[160:163], v[104:119]
    ds_read_b64_tr_b16 v[52:53], v23 offset:5120
    ds_read_b64_tr_b16 v[54:55], v23 offset:7168
    s_waitcnt vmcnt(19)
    s_waitcnt lgkmcnt(10)
    v_mfma_f32_32x32x16_bf16 v[56:71], v[32:35], v[164:167], v[56:71]
    ds_read_b64_tr_b16 v[28:29], v20 offset:8192
    ds_read_b64_tr_b16 v[30:31], v20 offset:10240
    s_waitcnt lgkmcnt(10)
    v_mfma_f32_32x32x16_bf16 v[72:87], v[36:39], v[164:167], v[72:87]
    ds_read_b64_tr_b16 v[32:33], v21 offset:8192
    ds_read_b64_tr_b16 v[34:35], v21 offset:10240
    s_waitcnt lgkmcnt(10)
    v_mfma_f32_32x32x16_bf16 v[120:135], v[40:43], v[164:167], v[120:135]
    buffer_load_dwordx4 v[244:247], v249, s[32:35], s16 offen offset:3072 sc1
    ds_read_b64_tr_b16 v[36:37], v24 offset:8192
    ds_read_b64_tr_b16 v[38:39], v24 offset:10240
    s_waitcnt lgkmcnt(10)
    v_mfma_f32_32x32x16_bf16 v[136:151], v[44:47], v[164:167], v[136:151]
    s_add_u32 s16, s16, 16384
    ds_read_b64_tr_b16 v[40:41], v25 offset:8192
    ds_read_b64_tr_b16 v[42:43], v25 offset:10240
    s_waitcnt lgkmcnt(10)
    v_mfma_f32_32x32x16_bf16 v[88:103], v[48:51], v[164:167], v[88:103]
    s_and_b32 s16, s16, 0x3ffff
    ds_read_b64_tr_b16 v[44:45], v22 offset:8192
    ds_read_b64_tr_b16 v[46:47], v22 offset:10240
    s_waitcnt lgkmcnt(10)
    v_mfma_f32_32x32x16_bf16 v[104:119], v[52:55], v[164:167], v[104:119]
    buffer_load_dwordx4 v[152:155], v249, s[32:35], s16 offen sc1
    ds_read_b64_tr_b16 v[48:49], v23 offset:8192
    ds_read_b64_tr_b16 v[50:51], v23 offset:10240
    s_barrier
    s_waitcnt vmcnt(20)
    s_waitcnt lgkmcnt(10)
    v_mfma_f32_32x32x16_bf16 v[56:71], v[28:31], v[168:171], v[56:71]
    ds_read_b64_tr_b16 v[52:53], v20 offset:9216
    ds_read_b64_tr_b16 v[54:55], v20 offset:11264
    s_waitcnt lgkmcnt(10)
    v_mfma_f32_32x32x16_bf16 v[72:87], v[32:35], v[168:171], v[72:87]
    ds_read_b64_tr_b16 v[28:29], v21 offset:9216
    ds_read_b64_tr_b16 v[30:31], v21 offset:11264
    s_waitcnt lgkmcnt(10)
    v_mfma_f32_32x32x16_bf16 v[120:135], v[36:39], v[168:171], v[120:135]
    ds_read_b64_tr_b16 v[32:33], v24 offset:9216
    ds_read_b64_tr_b16 v[34:35], v24 offset:11264
    s_waitcnt lgkmcnt(10)
    v_mfma_f32_32x32x16_bf16 v[136:151], v[40:43], v[168:171], v[136:151]
    ds_read_b64_tr_b16 v[36:37], v25 offset:9216
    ds_read_b64_tr_b16 v[38:39], v25 offset:11264
    s_waitcnt lgkmcnt(10)
    v_mfma_f32_32x32x16_bf16 v[88:103], v[44:47], v[168:171], v[88:103]
    ds_read_b64_tr_b16 v[40:41], v22 offset:9216
    ds_read_b64_tr_b16 v[42:43], v22 offset:11264
    s_waitcnt lgkmcnt(10)
    v_mfma_f32_32x32x16_bf16 v[104:119], v[48:51], v[168:171], v[104:119]
    ds_read_b64_tr_b16 v[44:45], v23 offset:9216
    ds_read_b64_tr_b16 v[46:47], v23 offset:11264
    s_waitcnt vmcnt(19)
    s_waitcnt lgkmcnt(10)
    v_mfma_f32_32x32x16_bf16 v[56:71], v[52:55], v[172:175], v[56:71]
    ds_read_b64_tr_b16 v[48:49], v20 offset:12288
    ds_read_b64_tr_b16 v[50:51], v20 offset:14336
    s_waitcnt lgkmcnt(10)
    v_mfma_f32_32x32x16_bf16 v[72:87], v[28:31], v[172:175], v[72:87]
    ds_read_b64_tr_b16 v[52:53], v21 offset:12288
    ds_read_b64_tr_b16 v[54:55], v21 offset:14336
    s_waitcnt lgkmcnt(10)
    v_mfma_f32_32x32x16_bf16 v[120:135], v[32:35], v[172:175], v[120:135]
    ds_read_b64_tr_b16 v[28:29], v24 offset:12288
    ds_read_b64_tr_b16 v[30:31], v24 offset:14336
    s_waitcnt lgkmcnt(10)
    v_mfma_f32_32x32x16_bf16 v[136:151], v[36:39], v[172:175], v[136:151]
    buffer_load_dwordx4 v[156:159], v249, s[32:35], s16 offen offset:1024 sc1
    ds_read_b64_tr_b16 v[32:33], v25 offset:12288
    ds_read_b64_tr_b16 v[34:35], v25 offset:14336
    s_waitcnt lgkmcnt(10)
    v_mfma_f32_32x32x16_bf16 v[88:103], v[40:43], v[172:175], v[88:103]
    ds_read_b64_tr_b16 v[36:37], v22 offset:12288
    ds_read_b64_tr_b16 v[38:39], v22 offset:14336
    s_waitcnt lgkmcnt(10)
    v_mfma_f32_32x32x16_bf16 v[104:119], v[44:47], v[172:175], v[104:119]
    ds_read_b64_tr_b16 v[40:41], v23 offset:12288
    ds_read_b64_tr_b16 v[42:43], v23 offset:14336
    s_waitcnt vmcnt(19)
    s_waitcnt lgkmcnt(10)
    v_mfma_f32_32x32x16_bf16 v[56:71], v[48:51], v[176:179], v[56:71]
    ds_read_b64_tr_b16 v[44:45], v20 offset:13312
    ds_read_b64_tr_b16 v[46:47], v20 offset:15360
    s_waitcnt lgkmcnt(10)
    v_mfma_f32_32x32x16_bf16 v[72:87], v[52:55], v[176:179], v[72:87]
    buffer_load_dwordx4 v[160:163], v249, s[32:35], s16 offen offset:2048 sc1
    ds_read_b64_tr_b16 v[48:49], v21 offset:13312
    ds_read_b64_tr_b16 v[50:51], v21 offset:15360
    s_waitcnt lgkmcnt(10)
    v_mfma_f32_32x32x16_bf16 v[120:135], v[28:31], v[176:179], v[120:135]
    ds_read_b64_tr_b16 v[52:53], v24 offset:13312
    ds_read_b64_tr_b16 v[54:55], v24 offset:15360
    s_waitcnt lgkmcnt(10)
    v_mfma_f32_32x32x16_bf16 v[136:151], v[32:35], v[176:179], v[136:151]
    ds_read_b64_tr_b16 v[28:29], v25 offset:13312
    ds_read_b64_tr_b16 v[30:31], v25 offset:15360
    s_waitcnt lgkmcnt(10)
    v_mfma_f32_32x32x16_bf16 v[88:103], v[36:39], v[176:179], v[88:103]
    buffer_load_dwordx4 v[164:167], v249, s[32:35], s16 offen offset:3072 sc1
    ds_read_b64_tr_b16 v[32:33], v22 offset:13312
    ds_read_b64_tr_b16 v[34:35], v22 offset:15360
    s_waitcnt lgkmcnt(10)
    v_mfma_f32_32x32x16_bf16 v[104:119], v[40:43], v[176:179], v[104:119]
    s_add_u32 s16, s16, 16384
    ds_read_b64_tr_b16 v[36:37], v23 offset:13312
    ds_read_b64_tr_b16 v[38:39], v23 offset:15360
    s_waitcnt vmcnt(20)
    s_waitcnt lgkmcnt(10)
    v_mfma_f32_32x32x16_bf16 v[56:71], v[44:47], v[180:183], v[56:71]
    s_and_b32 s16, s16, 0x3ffff
    ds_read_b64_tr_b16 v[40:41], v20 offset:16384
    ds_read_b64_tr_b16 v[42:43], v20 offset:18432
    s_waitcnt lgkmcnt(10)
    v_mfma_f32_32x32x16_bf16 v[72:87], v[48:51], v[180:183], v[72:87]
    ds_read_b64_tr_b16 v[44:45], v21 offset:16384
    ds_read_b64_tr_b16 v[46:47], v21 offset:18432
    s_waitcnt lgkmcnt(10)
    v_mfma_f32_32x32x16_bf16 v[120:135], v[52:55], v[180:183], v[120:135]
    buffer_load_dwordx4 v[168:171], v249, s[32:35], s16 offen sc1
    ds_read_b64_tr_b16 v[48:49], v24 offset:16384
    ds_read_b64_tr_b16 v[50:51], v24 offset:18432
    s_waitcnt lgkmcnt(10)
    v_mfma_f32_32x32x16_bf16 v[136:151], v[28:31], v[180:183], v[136:151]
    ds_read_b64_tr_b16 v[52:53], v25 offset:16384
    ds_read_b64_tr_b16 v[54:55], v25 offset:18432
    s_waitcnt lgkmcnt(10)
    v_mfma_f32_32x32x16_bf16 v[88:103], v[32:35], v[180:183], v[88:103]
    ds_read_b64_tr_b16 v[28:29], v22 offset:16384
    ds_read_b64_tr_b16 v[30:31], v22 offset:18432
    s_waitcnt lgkmcnt(10)
    v_mfma_f32_32x32x16_bf16 v[104:119], v[36:39], v[180:183], v[104:119]
    buffer_load_dwordx4 v[172:175], v249, s[32:35], s16 offen offset:1024 sc1
    ds_read_b64_tr_b16 v[32:33], v23 offset:16384
    ds_read_b64_tr_b16 v[34:35], v23 offset:18432
    s_barrier
    s_waitcnt vmcnt(21)
    s_waitcnt lgkmcnt(10)
    v_mfma_f32_32x32x16_bf16 v[56:71], v[40:43], v[184:187], v[56:71]
    ds_read_b64_tr_b16 v[36:37], v20 offset:17408
    ds_read_b64_tr_b16 v[38:39], v20 offset:19456
    s_waitcnt lgkmcnt(10)
    v_mfma_f32_32x32x16_bf16 v[72:87], v[44:47], v[184:187], v[72:87]
    ds_read_b64_tr_b16 v[40:41], v21 offset:17408
    ds_read_b64_tr_b16 v[42:43], v21 offset:19456
    s_waitcnt lgkmcnt(10)
    v_mfma_f32_32x32x16_bf16 v[120:135], v[48:51], v[184:187], v[120:135]
    ds_read_b64_tr_b16 v[44:45], v24 offset:17408
    ds_read_b64_tr_b16 v[46:47], v24 offset:19456
    s_waitcnt lgkmcnt(10)
    v_mfma_f32_32x32x16_bf16 v[136:151], v[52:55], v[184:187], v[136:151]
    ds_read_b64_tr_b16 v[48:49], v25 offset:17408
    ds_read_b64_tr_b16 v[50:51], v25 offset:19456
    s_waitcnt lgkmcnt(10)
    v_mfma_f32_32x32x16_bf16 v[88:103], v[28:31], v[184:187], v[88:103]
    ds_read_b64_tr_b16 v[52:53], v22 offset:17408
    ds_read_b64_tr_b16 v[54:55], v22 offset:19456
    s_waitcnt lgkmcnt(10)
    v_mfma_f32_32x32x16_bf16 v[104:119], v[32:35], v[184:187], v[104:119]
    ds_read_b64_tr_b16 v[28:29], v23 offset:17408
    ds_read_b64_tr_b16 v[30:31], v23 offset:19456
    s_waitcnt vmcnt(20)
    s_waitcnt lgkmcnt(10)
    v_mfma_f32_32x32x16_bf16 v[56:71], v[36:39], v[188:191], v[56:71]
    ds_read_b64_tr_b16 v[32:33], v20 offset:20480
    ds_read_b64_tr_b16 v[34:35], v20 offset:22528
    s_waitcnt lgkmcnt(10)
    v_mfma_f32_32x32x16_bf16 v[72:87], v[40:43], v[188:191], v[72:87]
    ds_read_b64_tr_b16 v[36:37], v21 offset:20480
    ds_read_b64_tr_b16 v[38:39], v21 offset:22528
    s_waitcnt lgkmcnt(10)
    v_mfma_f32_32x32x16_bf16 v[120:135], v[44:47], v[188:191], v[120:135]
    ds_read_b64_tr_b16 v[40:41], v24 offset:20480
    ds_read_b64_tr_b16 v[42:43], v24 offset:22528
    s_waitcnt lgkmcnt(10)
    v_mfma_f32_32x32x16_bf16 v[136:151], v[48:51], v[188:191], v[136:151]
    buffer_load_dwordx4 v[176:179], v249, s[32:35], s16 offen offset:2048 sc1
    ds_read_b64_tr_b16 v[44:45], v25 offset:20480
    ds_read_b64_tr_b16 v[46:47], v25 offset:22528
    s_waitcnt lgkmcnt(10)
    v_mfma_f32_32x32x16_bf16 v[88:103], v[52:55], v[188:191], v[88:103]
    ds_read_b64_tr_b16 v[48:49], v22 offset:20480
    ds_read_b64_tr_b16 v[50:51], v22 offset:22528
    s_waitcnt lgkmcnt(10)
    v_mfma_f32_32x32x16_bf16 v[104:119], v[28:31], v[188:191], v[104:119]
    ds_read_b64_tr_b16 v[52:53], v23 offset:20480
    ds_read_b64_tr_b16 v[54:55], v23 offset:22528
    s_waitcnt vmcnt(20)
    s_waitcnt lgkmcnt(10)
    v_mfma_f32_32x32x16_bf16 v[56:71], v[32:35], v[192:195], v[56:71]
    ds_read_b64_tr_b16 v[28:29], v20 offset:21504
    ds_read_b64_tr_b16 v[30:31], v20 offset:23552
    s_waitcnt lgkmcnt(10)
    v_mfma_f32_32x32x16_bf16 v[72:87], v[36:39], v[192:195], v[72:87]
    buffer_load_dwordx4 v[180:183], v249, s[32:35], s16 offen offset:3072 sc1
    ds_read_b64_tr_b16 v[32:33], v21 offset:21504
    ds_read_b64_tr_b16 v[34:35], v21 offset:23552
    s_waitcnt lgkmcnt(10)
    v_mfma_f32_32x32x16_bf16 v[120:135], v[40:43], v[192:195], v[120:135]
    s_add_u32 s16, s16, 16384
    ds_read_b64_tr_b16 v[36:37], v24 offset:21504
    ds_read_b64_tr_b16 v[38:39], v24 offset:23552
    s_waitcnt lgkmcnt(10)
    v_mfma_f32_32x32x16_bf16 v[136:151], v[44:47], v[192:195], v[136:151]
    s_and_b32 s16, s16, 0x3ffff
    ds_read_b64_tr_b16 v[40:41], v25 offset:21504
    ds_read_b64_tr_b16 v[42:43], v25 offset:23552
    s_waitcnt lgkmcnt(10)
    v_mfma_f32_32x32x16_bf16 v[88:103], v[48:51], v[192:195], v[88:103]
    buffer_load_dwordx4 v[184:187], v249, s[32:35], s16 offen sc1
    ds_read_b64_tr_b16 v[44:45], v22 offset:21504
    ds_read_b64_tr_b16 v[46:47], v22 offset:23552
L_PAD3:
    s_cbranch_execz L_RET3
    s_waitcnt lgkmcnt(10)
    v_mfma_f32_32x32x16_bf16 v[104:119], v[52:55], v[192:195], v[104:119]
    ds_read_b64_tr_b16 v[48:49], v23 offset:21504
    ds_read_b64_tr_b16 v[50:51], v23 offset:23552
    s_waitcnt vmcnt(21)
    s_waitcnt lgkmcnt(10)
    v_mfma_f32_32x32x16_bf16 v[56:71], v[28:31], v[196:199], v[56:71]
    ds_read_b64_tr_b16 v[52:53], v20 offset:24576
    ds_read_b64_tr_b16 v[54:55], v20 offset:26624
    s_waitcnt lgkmcnt(10)
    v_mfma_f32_32x32x16_bf16 v[72:87], v[32:35], v[196:199], v[72:87]
    ds_read_b64_tr_b16 v[28:29], v21 offset:24576
    ds_read_b64_tr_b16 v[30:31], v21 offset:26624
    s_waitcnt lgkmcnt(10)
    v_mfma_f32_32x32x16_bf16 v[120:135], v[36:39], v[196:199], v[120:135]
    buffer_load_dwordx4 v[188:191], v249, s[32:35], s16 offen offset:1024 sc1
    ds_read_b64_tr_b16 v[32:33], v20 offset:25600
    ds_read_b64_tr_b16 v[34:35], v20 offset:27648
    s_waitcnt lgkmcnt(10)
    v_mfma_f32_32x32x16_bf16 v[136:151], v[40:43], v[196:199], v[136:151]
    ds_read_b64_tr_b16 v[36:37], v21 offset:25600
    ds_read_b64_tr_b16 v[38:39], v21 offset:27648
    s_waitcnt lgkmcnt(10)
    v_mfma_f32_32x32x16_bf16 v[88:103], v[44:47], v[196:199], v[88:103]
    ds_read_b64_tr_b16 v[40:41], v20 offset:28672
    ds_read_b64_tr_b16 v[42:43], v20 offset:30720
    s_waitcnt lgkmcnt(10)
    v_mfma_f32_32x32x16_bf16 v[104:119], v[48:51], v[196:199], v[104:119]
    buffer_load_dwordx4 v[192:195], v249, s[32:35], s16 offen offset:2048 sc1
    ds_read_b64_tr_b16 v[44:45], v21 offset:28672
    ds_read_b64_tr_b16 v[46:47], v21 offset:30720
    s_barrier
    s_waitcnt vmcnt(22)
    s_waitcnt lgkmcnt(10)
    v_mfma_f32_32x32x16_bf16 v[56:71], v[52:55], v[200:203], v[56:71]
    ds_read_b64_tr_b16 v[48:49], v20 offset:29696
    ds_read_b64_tr_b16 v[50:51], v20 offset:31744
    s_waitcnt lgkmcnt(10)
    v_mfma_f32_32x32x16_bf16 v[72:87], v[28:31], v[200:203], v[72:87]
    ds_read_b64_tr_b16 v[52:53], v21 offset:29696
    ds_read_b64_tr_b16 v[54:55], v21 offset:31744
    s_waitcnt vmcnt(21)
    s_waitcnt lgkmcnt(10)
    v_mfma_f32_32x32x16_bf16 v[56:71], v[32:35], v[204:207], v[56:71]
    ds_read_b64_tr_b16 v[28:29], v24 offset:24576
    ds_read_b64_tr_b16 v[30:31], v24 offset:26624
    s_waitcnt lgkmcnt(10)
    v_mfma_f32_32x32x16_bf16 v[72:87], v[36:39], v[204:207], v[72:87]
    ds_read_b64_tr_b16 v[32:33], v25 offset:24576
    ds_read_b64_tr_b16 v[34:35], v25 offset:26624
    s_waitcnt vmcnt(20)
    s_waitcnt lgkmcnt(10)
    v_mfma_f32_32x32x16_bf16 v[56:71], v[40:43], v[208:211], v[56:71]
    ds_read_b64_tr_b16 v[36:37], v22 offset:24576
    ds_read_b64_tr_b16 v[38:39], v22 offset:26624
    s_waitcnt lgkmcnt(10)
    v_mfma_f32_32x32x16_bf16 v[72:87], v[44:47], v[208:211], v[72:87]
    ds_read_b64_tr_b16 v[40:41], v23 offset:24576
    ds_read_b64_tr_b16 v[42:43], v23 offset:26624
    s_waitcnt vmcnt(19)
    s_waitcnt lgkmcnt(10)
    v_mfma_f32_32x32x16_bf16 v[56:71], v[48:51], v[212:215], v[56:71]
    ds_read_b64_tr_b16 v[44:45], v24 offset:25600
    ds_read_b64_tr_b16 v[46:47], v24 offset:27648
    s_waitcnt lgkmcnt(10)
    v_mfma_f32_32x32x16_bf16 v[72:87], v[52:55], v[212:215], v[72:87]
    ds_read_b64_tr_b16 v[48:49], v25 offset:25600
    ds_read_b64_tr_b16 v[50:51], v25 offset:27648
    s_barrier
    s_waitcnt lgkmcnt(10)
    v_mfma_f32_32x32x16_bf16 v[120:135], v[28:31], v[200:203], v[120:135]
    ds_read_b64_tr_b16 v[52:53], v22 offset:25600
    ds_read_b64_tr_b16 v[54:55], v22 offset:27648
    s_waitcnt lgkmcnt(10)
    v_mfma_f32_32x32x16_bf16 v[136:151], v[32:35], v[200:203], v[136:151]
    buffer_load_dwordx4 v[196:199], v249, s[32:35], s16 offen offset:3072 sc1
    ds_read_b64_tr_b16 v[28:29], v23 offset:25600
    ds_read_b64_tr_b16 v[30:31], v23 offset:27648
    s_waitcnt lgkmcnt(10)
    v_mfma_f32_32x32x16_bf16 v[88:103], v[36:39], v[200:203], v[88:103]
    s_add_u32 s16, s16, 16384
    ds_read_b64_tr_b16 v[32:33], v24 offset:28672
    ds_read_b64_tr_b16 v[34:35], v24 offset:30720
    s_waitcnt lgkmcnt(10)
    v_mfma_f32_32x32x16_bf16 v[104:119], v[40:43], v[200:203], v[104:119]
    s_and_b32 s16, s16, 0x3ffff
    ds_read_b64_tr_b16 v[36:37], v25 offset:28672
    ds_read_b64_tr_b16 v[38:39], v25 offset:30720
    s_waitcnt lgkmcnt(10)
    v_mfma_f32_32x32x16_bf16 v[120:135], v[44:47], v[204:207], v[120:135]
    ds_read_b64_tr_b16 v[40:41], v22 offset:28672
    ds_read_b64_tr_b16 v[42:43], v22 offset:30720
    s_waitcnt lgkmcnt(10)
    v_mfma_f32_32x32x16_bf16 v[136:151], v[48:51], v[204:207], v[136:151]
    buffer_load_dwordx4 v[200:203], v249, s[32:35], s16 offen sc1
    ds_read_b64_tr_b16 v[44:45], v23 offset:28672
    ds_read_b64_tr_b16 v[46:47], v23 offset:30720
    s_waitcnt lgkmcnt(10)
    v_mfma_f32_32x32x16_bf16 v[88:103], v[52:55], v[204:207], v[88:103]
    ds_read_b64_tr_b16 v[48:49], v24 offset:29696
    ds_read_b64_tr_b16 v[50:51], v24 offset:31744
    s_waitcnt lgkmcnt(10)
    v_mfma_f32_32x32x16_bf16 v[104:119], v[28:31], v[204:207], v[104:119]
    ds_read_b64_tr_b16 v[52:53], v25 offset:29696
    ds_read_b64_tr_b16 v[54:55], v25 offset:31744
    s_waitcnt lgkmcnt(10)
    v_mfma_f32_32x32x16_bf16 v[120:135], v[32:35], v[208:211], v[120:135]
    buffer_load_dwordx4 v[204:207], v249, s[32:35], s16 offen offset:1024 sc1
    ds_read_b64_tr_b16 v[28:29], v22 offset:29696
    ds_read_b64_tr_b16 v[30:31], v22 offset:31744
    s_waitcnt lgkmcnt(10)
    v_mfma_f32_32x32x16_bf16 v[136:151], v[36:39], v[208:211], v[136:151]
    ds_read_b64_tr_b16 v[32:33], v23 offset:29696
    ds_read_b64_tr_b16 v[34:35], v23 offset:31744
    s_waitcnt lgkmcnt(10)
    v_mfma_f32_32x32x16_bf16 v[88:103], v[40:43], v[208:211], v[88:103]
    ds_read_b64_tr_b16 v[36:37], v20 offset:32768
    ds_read_b64_tr_b16 v[38:39], v20 offset:34816
    s_waitcnt lgkmcnt(10)
    v_mfma_f32_32x32x16_bf16 v[104:119], v[44:47], v[208:211], v[104:119]
    ds_read_b64_tr_b16 v[40:41], v20 offset:33792
    ds_read_b64_tr_b16 v[42:43], v20 offset:35840
    s_waitcnt lgkmcnt(10)
    v_mfma_f32_32x32x16_bf16 v[120:135], v[48:51], v[212:215], v[120:135]
    buffer_load_dwordx4 v[208:211], v249, s[32:35], s16 offen offset:2048 sc1
    ds_read_b64_tr_b16 v[44:45], v20 offset:36864
    ds_read_b64_tr_b16 v[46:47], v20 offset:38912
    s_waitcnt lgkmcnt(10)
    v_mfma_f32_32x32x16_bf16 v[136:151], v[52:55], v[212:215], v[136:151]
    ds_read_b64_tr_b16 v[48:49], v20 offset:37888
    ds_read_b64_tr_b16 v[50:51], v20 offset:39936
    s_waitcnt lgkmcnt(10)
    v_mfma_f32_32x32x16_bf16 v[88:103], v[28:31], v[212:215], v[88:103]
    ds_read_b64_tr_b16 v[52:53], v20 offset:40960
    ds_read_b64_tr_b16 v[54:55], v20 offset:43008
    s_waitcnt lgkmcnt(10)
    v_mfma_f32_32x32x16_bf16 v[104:119], v[32:35], v[212:215], v[104:119]
    buffer_load_dwordx4 v[212:215], v249, s[32:35], s16 offen offset:3072 sc1
    ds_read_b64_tr_b16 v[28:29], v20 offset:41984
    ds_read_b64_tr_b16 v[30:31], v20 offset:44032
    s_barrier
    s_waitcnt vmcnt(23)
    s_waitcnt lgkmcnt(10)
    v_mfma_f32_32x32x16_bf16 v[56:71], v[36:39], v[216:219], v[56:71]
    s_add_u32 s16, s16, 16384
    ds_read_b64_tr_b16 v[32:33], v20 offset:45056
    ds_read_b64_tr_b16 v[34:35], v20 offset:47104
    s_waitcnt vmcnt(22)
    s_waitcnt lgkmcnt(10)
    v_mfma_f32_32x32x16_bf16 v[56:71], v[40:43], v[220:223], v[56:71]
    s_and_b32 s16, s16, 0x3ffff
    ds_read_b64_tr_b16 v[36:37], v20 offset:46080
    ds_read_b64_tr_b16 v[38:39], v20 offset:48128
    s_waitcnt vmcnt(21)
    s_waitcnt lgkmcnt(10)
    v_mfma_f32_32x32x16_bf16 v[56:71], v[44:47], v[224:227], v[56:71]
    ds_read_b64_tr_b16 v[40:41], v20
    ds_read_b64_tr_b16 v[42:43], v20 offset:2048
    s_waitcnt vmcnt(20)
    s_waitcnt lgkmcnt(10)
    v_mfma_f32_32x32x16_bf16 v[56:71], v[48:51], v[228:231], v[56:71]
    ds_read_b64_tr_b16 v[44:45], v20 offset:1024
    ds_read_b64_tr_b16 v[46:47], v20 offset:3072
    s_waitcnt vmcnt(19)
    s_waitcnt lgkmcnt(10)
    v_mfma_f32_32x32x16_bf16 v[56:71], v[52:55], v[232:235], v[56:71]
    ds_read_b64_tr_b16 v[48:49], v20 offset:4096
    ds_read_b64_tr_b16 v[50:51], v20 offset:6144
    s_waitcnt vmcnt(18)
    s_waitcnt lgkmcnt(10)
    v_mfma_f32_32x32x16_bf16 v[56:71], v[28:31], v[236:239], v[56:71]
    ds_read_b64_tr_b16 v[52:53], v20 offset:5120
    ds_read_b64_tr_b16 v[54:55], v20 offset:7168
    s_waitcnt vmcnt(17)
    s_waitcnt lgkmcnt(10)
    v_mfma_f32_32x32x16_bf16 v[56:71], v[32:35], v[240:243], v[56:71]
    ds_read_b64_tr_b16 v[28:29], v20 offset:8192
    ds_read_b64_tr_b16 v[30:31], v20 offset:10240
    s_waitcnt vmcnt(16)
    s_waitcnt lgkmcnt(10)
    v_mfma_f32_32x32x16_bf16 v[56:71], v[36:39], v[244:247], v[56:71]
    ds_read_b64_tr_b16 v[32:33], v20 offset:9216
    ds_read_b64_tr_b16 v[34:35], v20 offset:11264
    s_waitcnt vmcnt(15)
    s_waitcnt lgkmcnt(10)
    v_mfma_f32_32x32x16_bf16 v[56:71], v[40:43], v[152:155], v[56:71]
    ds_read_b64_tr_b16 v[36:37], v20 offset:12288
    ds_read_b64_tr_b16 v[38:39], v20 offset:14336
    s_waitcnt vmcnt(14)
    s_waitcnt lgkmcnt(10)
    v_mfma_f32_32x32x16_bf16 v[56:71], v[44:47], v[156:159], v[56:71]
    ds_read_b64_tr_b16 v[40:41], v20 offset:13312
    ds_read_b64_tr_b16 v[42:43], v20 offset:15360
    s_waitcnt vmcnt(13)
    s_waitcnt lgkmcnt(10)
    v_mfma_f32_32x32x16_bf16 v[56:71], v[48:51], v[160:163], v[56:71]
    ds_read_b64_tr_b16 v[44:45], v20 offset:16384
    ds_read_b64_tr_b16 v[46:47], v20 offset:18432
    s_waitcnt vmcnt(12)
    s_waitcnt lgkmcnt(10)
    v_mfma_f32_32x32x16_bf16 v[56:71], v[52:55], v[164:167], v[56:71]
    ds_read_b64_tr_b16 v[48:49], v20 offset:17408
    ds_read_b64_tr_b16 v[50:51], v20 offset:19456
    s_waitcnt vmcnt(11)
    s_waitcnt lgkmcnt(10)
    v_mfma_f32_32x32x16_bf16 v[56:71], v[28:31], v[168:171], v[56:71]
    ds_read_b64_tr_b16 v[52:53], v20 offset:20480
    ds_read_b64_tr_b16 v[54:55], v20 offset:22528
    s_waitcnt vmcnt(10)
    s_waitcnt lgkmcnt(10)
    v_mfma_f32_32x32x16_bf16 v[56:71], v[32:35], v[172:175], v[56:71]
    ds_read_b64_tr_b16 v[28:29], v20 offset:21504
    ds_read_b64_tr_b16 v[30:31], v20 offset:23552
    s_barrier
    s_waitcnt vmcnt(9)
    s_waitcnt lgkmcnt(10)
    v_mfma_f32_32x32x16_bf16 v[56:71], v[36:39], v[176:179], v[56:71]
    ds_read_b64_tr_b16 v[32:33], v20 offset:24576
    ds_read_b64_tr_b16 v[34:35], v20 offset:26624
    s_waitcnt vmcnt(8)
    s_waitcnt lgkmcnt(10)
    v_mfma_f32_32x32x16_bf16 v[56:71], v[40:43], v[180:183], v[56:71]
    ds_read_b64_tr_b16 v[36:37], v20 offset:25600
    ds_read_b64_tr_b16 v[38:39], v20 offset:27648
    s_waitcnt vmcnt(7)
    s_waitcnt lgkmcnt(10)
    v_mfma_f32_32x32x16_bf16 v[56:71], v[44:47], v[184:187], v[56:71]
    ds_read_b64_tr_b16 v[40:41], v20 offset:28672
    ds_read_b64_tr_b16 v[42:43], v20 offset:30720
    s_waitcnt vmcnt(6)
    s_waitcnt lgkmcnt(10)
    v_mfma_f32_32x32x16_bf16 v[56:71], v[48:51], v[188:191], v[56:71]
    ds_read_b64_tr_b16 v[44:45], v20 offset:29696
    ds_read_b64_tr_b16 v[46:47], v20 offset:31744
    s_waitcnt vmcnt(5)
    s_waitcnt lgkmcnt(10)
    v_mfma_f32_32x32x16_bf16 v[56:71], v[52:55], v[192:195], v[56:71]
    ds_read_b64_tr_b16 v[48:49], v21 offset:32768
    ds_read_b64_tr_b16 v[50:51], v21 offset:34816
    s_waitcnt vmcnt(4)
    s_waitcnt lgkmcnt(10)
    v_mfma_f32_32x32x16_bf16 v[56:71], v[28:31], v[196:199], v[56:71]
    ds_read_b64_tr_b16 v[52:53], v21 offset:33792
    ds_read_b64_tr_b16 v[54:55], v21 offset:35840
    s_waitcnt vmcnt(3)
    s_waitcnt lgkmcnt(10)
    v_mfma_f32_32x32x16_bf16 v[56:71], v[32:35], v[200:203], v[56:71]
    ds_read_b64_tr_b16 v[28:29], v21 offset:36864
    ds_read_b64_tr_b16 v[30:31], v21 offset:38912
    s_waitcnt vmcnt(2)
    s_waitcnt lgkmcnt(10)
    v_mfma_f32_32x32x16_bf16 v[56:71], v[36:39], v[204:207], v[56:71]
    ds_read_b64_tr_b16 v[32:33], v21 offset:37888
    ds_read_b64_tr_b16 v[34:35], v21 offset:39936
    s_waitcnt vmcnt(1)
    s_waitcnt lgkmcnt(10)
    v_mfma_f32_32x32x16_bf16 v[56:71], v[40:43], v[208:211], v[56:71]
    ds_read_b64_tr_b16 v[36:37], v21 offset:40960
    ds_read_b64_tr_b16 v[38:39], v21 offset:43008
    s_waitcnt vmcnt(0)
    s_waitcnt lgkmcnt(10)
    v_mfma_f32_32x32x16_bf16 v[56:71], v[44:47], v[212:215], v[56:71]
    ds_read_b64_tr_b16 v[40:41], v21 offset:41984
    ds_read_b64_tr_b16 v[42:43], v21 offset:44032
    s_waitcnt lgkmcnt(10)
    v_mfma_f32_32x32x16_bf16 v[72:87], v[48:51], v[216:219], v[72:87]
    ds_read_b64_tr_b16 v[44:45], v21 offset:45056
    ds_read_b64_tr_b16 v[46:47], v21 offset:47104
    s_waitcnt lgkmcnt(10)
    v_mfma_f32_32x32x16_bf16 v[72:87], v[52:55], v[220:223], v[72:87]
    s_nop 3
    v_cvt_pk_bf16_f32 v56, v56, v57
    v_cvt_pk_bf16_f32 v57, v58, v59
    ds_read_b64_tr_b16 v[48:49], v21 offset:46080
    ds_read_b64_tr_b16 v[50:51], v21 offset:48128
    s_waitcnt lgkmcnt(10)
    v_mfma_f32_32x32x16_bf16 v[72:87], v[28:31], v[224:227], v[72:87]
    v_cvt_pk_bf16_f32 v58, v60, v61
    v_cvt_pk_bf16_f32 v59, v62, v63
    ds_read_b64_tr_b16 v[52:53], v21
    ds_read_b64_tr_b16 v[54:55], v21 offset:2048
    s_waitcnt lgkmcnt(10)
    v_mfma_f32_32x32x16_bf16 v[72:87], v[32:35], v[228:231], v[72:87]
    ds_write_b128 v0, v[56:59]
    v_cvt_pk_bf16_f32 v60, v64, v65
    ds_read_b64_tr_b16 v[28:29], v21 offset:1024
    ds_read_b64_tr_b16 v[30:31], v21 offset:3072
    s_waitcnt lgkmcnt(11)
    v_mfma_f32_32x32x16_bf16 v[72:87], v[36:39], v[232:235], v[72:87]
    v_cvt_pk_bf16_f32 v61, v66, v67
    v_cvt_pk_bf16_f32 v62, v68, v69
    ds_read_b64_tr_b16 v[32:33], v21 offset:4096
    ds_read_b64_tr_b16 v[34:35], v21 offset:6144
    s_waitcnt lgkmcnt(11)
    v_mfma_f32_32x32x16_bf16 v[72:87], v[40:43], v[236:239], v[72:87]
    v_cvt_pk_bf16_f32 v63, v70, v71
    ds_write_b128 v0, v[60:63] offset:1024
    ds_read_b64_tr_b16 v[36:37], v21 offset:5120
    ds_read_b64_tr_b16 v[38:39], v21 offset:7168
    s_waitcnt lgkmcnt(12)
    v_mfma_f32_32x32x16_bf16 v[72:87], v[44:47], v[240:243], v[72:87]
    v_subrev_u32 v0, 118784, v0
    ds_read_b64_tr_b16 v[40:41], v21 offset:8192
    ds_read_b64_tr_b16 v[42:43], v21 offset:10240
    s_waitcnt lgkmcnt(12)
    v_mfma_f32_32x32x16_bf16 v[72:87], v[48:51], v[244:247], v[72:87]
    ds_read_b64_tr_b16 v[44:45], v21 offset:9216
    ds_read_b64_tr_b16 v[46:47], v21 offset:11264
    s_waitcnt lgkmcnt(6)
    s_barrier
    v_mfma_f32_32x32x16_bf16 v[72:87], v[52:55], v[152:155], v[72:87]
    ds_read_b64_tr_b16 v[48:49], v21 offset:12288
    ds_read_b64_tr_b16 v[50:51], v21 offset:14336
    v_mfma_f32_32x32x16_bf16 v[72:87], v[28:31], v[156:159], v[72:87]
    ds_read_b64_tr_b16 v[52:53], v21 offset:13312
    ds_read_b64_tr_b16 v[54:55], v21 offset:15360
    v_mfma_f32_32x32x16_bf16 v[72:87], v[32:35], v[160:163], v[72:87]
    ds_read_b64_tr_b16 v[28:29], v21 offset:16384
    ds_read_b64_tr_b16 v[30:31], v21 offset:18432
    s_waitcnt lgkmcnt(10)
    v_mfma_f32_32x32x16_bf16 v[72:87], v[36:39], v[164:167], v[72:87]
    ds_read_b64_tr_b16 v[32:33], v21 offset:17408
    ds_read_b64_tr_b16 v[34:35], v21 offset:19456
    s_waitcnt lgkmcnt(10)
    v_mfma_f32_32x32x16_bf16 v[72:87], v[40:43], v[168:171], v[72:87]
    ds_read_b64_tr_b16 v[36:37], v21 offset:20480
    ds_read_b64_tr_b16 v[38:39], v21 offset:22528
    s_waitcnt lgkmcnt(10)
    v_mfma_f32_32x32x16_bf16 v[72:87], v[44:47], v[172:175], v[72:87]
    ds_read_b64_tr_b16 v[40:41], v21 offset:21504
    ds_read_b64_tr_b16 v[42:43], v21 offset:23552
    s_waitcnt lgkmcnt(10)
    v_mfma_f32_32x32x16_bf16 v[72:87], v[48:51], v[176:179], v[72:87]
    ds_read_b64_tr_b16 v[44:45], v21 offset:24576
    ds_read_b64_tr_b16 v[46:47], v21 offset:26624
    s_waitcnt lgkmcnt(10)
    v_mfma_f32_32x32x16_bf16 v[72:87], v[52:55], v[180:183], v[72:87]
    ds_read_b64_tr_b16 v[48:49], v21 offset:25600
    ds_read_b64_tr_b16 v[50:51], v21 offset:27648
    s_waitcnt lgkmcnt(10)
    v_mfma_f32_32x32x16_bf16 v[72:87], v[28:31], v[184:187], v[72:87]
    ds_read_b64_tr_b16 v[52:53], v21 offset:28672
    ds_read_b64_tr_b16 v[54:55], v21 offset:30720
    s_waitcnt lgkmcnt(10)
    v_mfma_f32_32x32x16_bf16 v[72:87], v[32:35], v[188:191], v[72:87]
    ds_read_b64_tr_b16 v[28:29], v21 offset:29696
    ds_read_b64_tr_b16 v[30:31], v21 offset:31744
    s_waitcnt lgkmcnt(10)
    v_mfma_f32_32x32x16_bf16 v[72:87], v[36:39], v[192:195], v[72:87]
    ds_read_b64_tr_b16 v[32:33], v22 offset:32768
    ds_read_b64_tr_b16 v[34:35], v22 offset:34816
    s_waitcnt lgkmcnt(10)
    v_mfma_f32_32x32x16_bf16 v[72:87], v[40:43], v[196:199], v[72:87]
    ds_read_b64_tr_b16 v[36:37], v23 offset:32768
    ds_read_b64_tr_b16 v[38:39], v23 offset:34816
    s_waitcnt lgkmcnt(10)
    v_mfma_f32_32x32x16_bf16 v[72:87], v[44:47], v[200:203], v[72:87]
    ds_read_b64_tr_b16 v[40:41], v22 offset:33792
    ds_read_b64_tr_b16 v[42:43], v22 offset:35840
    s_waitcnt lgkmcnt(10)
    v_mfma_f32_32x32x16_bf16 v[72:87], v[48:51], v[204:207], v[72:87]
    ds_read_b64_tr_b16 v[44:45], v23 offset:33792
    ds_read_b64_tr_b16 v[46:47], v23 offset:35840
    s_waitcnt lgkmcnt(10)
    v_mfma_f32_32x32x16_bf16 v[72:87], v[52:55], v[208:211], v[72:87]
    ds_read_b64_tr_b16 v[48:49], v22 offset:36864
    ds_read_b64_tr_b16 v[50:51], v22 offset:38912
    s_waitcnt lgkmcnt(10)
    v_mfma_f32_32x32x16_bf16 v[72:87], v[28:31], v[212:215], v[72:87]
    ds_read_b64_tr_b16 v[52:53], v23 offset:36864
    ds_read_b64_tr_b16 v[54:55], v23 offset:38912
    s_waitcnt lgkmcnt(10)
    v_mfma_f32_32x32x16_bf16 v[88:103], v[32:35], v[216:219], v[88:103]
    ds_read_b64_tr_b16 v[28:29], v22 offset:37888
    ds_read_b64_tr_b16 v[30:31], v22 offset:39936
    s_waitcnt lgkmcnt(10)
    v_mfma_f32_32x32x16_bf16 v[104:119], v[36:39], v[216:219], v[104:119]
    s_nop 3
    v_cvt_pk_bf16_f32 v72, v72, v73
    v_cvt_pk_bf16_f32 v73, v74, v75
    ds_read_b64_tr_b16 v[32:33], v23 offset:37888
    ds_read_b64_tr_b16 v[34:35], v23 offset:39936
    s_waitcnt lgkmcnt(10)
    v_mfma_f32_32x32x16_bf16 v[88:103], v[40:43], v[220:223], v[88:103]
    v_cvt_pk_bf16_f32 v74, v76, v77
    v_cvt_pk_bf16_f32 v75, v78, v79
    ds_read_b64_tr_b16 v[36:37], v22 offset:40960
    ds_read_b64_tr_b16 v[38:39], v22 offset:43008
    s_waitcnt lgkmcnt(10)
    v_mfma_f32_32x32x16_bf16 v[104:119], v[44:47], v[220:223], v[104:119]
    ds_write_b128 v0, v[72:75]
    v_cvt_pk_bf16_f32 v76, v80, v81
    ds_read_b64_tr_b16 v[40:41], v23 offset:40960
    ds_read_b64_tr_b16 v[42:43], v23 offset:43008
    s_waitcnt lgkmcnt(11)
    v_mfma_f32_32x32x16_bf16 v[88:103], v[48:51], v[224:227], v[88:103]
    v_cvt_pk_bf16_f32 v77, v82, v83
    v_cvt_pk_bf16_f32 v78, v84, v85
    ds_read_b64_tr_b16 v[44:45], v22 offset:41984
    ds_read_b64_tr_b16 v[46:47], v22 offset:44032
    s_waitcnt lgkmcnt(11)
    v_mfma_f32_32x32x16_bf16 v[104:119], v[52:55], v[224:227], v[104:119]
    v_cvt_pk_bf16_f32 v79, v86, v87
    ds_write_b128 v0, v[76:79] offset:1024
    ds_read_b64_tr_b16 v[48:49], v23 offset:41984
    ds_read_b64_tr_b16 v[50:51], v23 offset:44032
    s_waitcnt lgkmcnt(12)
    v_mfma_f32_32x32x16_bf16 v[88:103], v[28:31], v[228:231], v[88:103]
    ds_read_b64_tr_b16 v[52:53], v22 offset:45056
    ds_read_b64_tr_b16 v[54:55], v22 offset:47104
    s_waitcnt lgkmcnt(12)
    v_mfma_f32_32x32x16_bf16 v[104:119], v[32:35], v[228:231], v[104:119]
    ds_read_b64_tr_b16 v[28:29], v23 offset:45056
    ds_read_b64_tr_b16 v[30:31], v23 offset:47104
    s_waitcnt lgkmcnt(6)
    s_barrier
    v_mfma_f32_32x32x16_bf16 v[88:103], v[36:39], v[232:235], v[88:103]
    s_lshl_b32 s96, s77, 11
    s_add_u32 s14, s96, 32768
    v_and_b32 v0, 7, v1
    ds_read_b64_tr_b16 v[32:33], v22 offset:46080
    ds_read_b64_tr_b16 v[34:35], v22 offset:48128
    v_mfma_f32_32x32x16_bf16 v[104:119], v[40:43], v[232:235], v[104:119]
    v_lshl_add_u32 v0, v0, 4, s14
    ds_read_b64_tr_b16 v[36:37], v23 offset:46080
    ds_read_b64_tr_b16 v[38:39], v23 offset:48128
    v_mfma_f32_32x32x16_bf16 v[88:103], v[44:47], v[236:239], v[88:103]
    v_bfe_u32 v4, v1, 3, 2
    ds_read_b64_tr_b16 v[40:41], v22
    ds_read_b64_tr_b16 v[42:43], v22 offset:2048
    s_waitcnt lgkmcnt(10)
    v_mfma_f32_32x32x16_bf16 v[104:119], v[48:51], v[236:239], v[104:119]
    v_lshl_add_u32 v0, v4, 8, v0
    v_lshrrev_b32 v4, 5, v1
    ds_read_b64_tr_b16 v[44:45], v23
    ds_read_b64_tr_b16 v[46:47], v23 offset:2048
    s_waitcnt lgkmcnt(10)
    v_mfma_f32_32x32x16_bf16 v[88:103], v[52:55], v[240:243], v[88:103]
    v_lshl_add_u32 v0, v4, 7, v0
    ds_read_b64_tr_b16 v[48:49], v22 offset:1024
    ds_read_b64_tr_b16 v[50:51], v22 offset:3072
    s_waitcnt lgkmcnt(10)
    v_mfma_f32_32x32x16_bf16 v[104:119], v[28:31], v[240:243], v[104:119]
    ds_read_b64_tr_b16 v[52:53], v23 offset:1024
    ds_read_b64_tr_b16 v[54:55], v23 offset:3072
    s_waitcnt lgkmcnt(10)
    v_mfma_f32_32x32x16_bf16 v[88:103], v[32:35], v[244:247], v[88:103]
    ds_read_b64_tr_b16 v[28:29], v22 offset:4096
    ds_read_b64_tr_b16 v[30:31], v22 offset:6144
    s_waitcnt lgkmcnt(10)
    v_mfma_f32_32x32x16_bf16 v[104:119], v[36:39], v[244:247], v[104:119]
    ds_read_b64_tr_b16 v[32:33], v23 offset:4096
    ds_read_b64_tr_b16 v[34:35], v23 offset:6144
    s_waitcnt lgkmcnt(10)
    v_mfma_f32_32x32x16_bf16 v[88:103], v[40:43], v[152:155], v[88:103]
    ds_read_b64_tr_b16 v[36:37], v22 offset:5120
    ds_read_b64_tr_b16 v[38:39], v22 offset:7168
    s_waitcnt lgkmcnt(10)
    v_mfma_f32_32x32x16_bf16 v[104:119], v[44:47], v[152:155], v[104:119]
    ds_read_b64_tr_b16 v[40:41], v23 offset:5120
    ds_read_b64_tr_b16 v[42:43], v23 offset:7168
    s_waitcnt lgkmcnt(10)
    v_mfma_f32_32x32x16_bf16 v[88:103], v[48:51], v[156:159], v[88:103]
    ds_read_b64_tr_b16 v[44:45], v22 offset:8192
    ds_read_b64_tr_b16 v[46:47], v22 offset:10240
    s_waitcnt lgkmcnt(10)
    v_mfma_f32_32x32x16_bf16 v[104:119], v[52:55], v[156:159], v[104:119]
    ds_read_b64_tr_b16 v[48:49], v23 offset:8192
    ds_read_b64_tr_b16 v[50:51], v23 offset:10240
    s_waitcnt lgkmcnt(10)
    v_mfma_f32_32x32x16_bf16 v[88:103], v[28:31], v[160:163], v[88:103]
    ds_read_b64_tr_b16 v[52:53], v22 offset:9216
    ds_read_b64_tr_b16 v[54:55], v22 offset:11264
    s_waitcnt lgkmcnt(10)
    v_mfma_f32_32x32x16_bf16 v[104:119], v[32:35], v[160:163], v[104:119]
    ds_read_b64_tr_b16 v[28:29], v23 offset:9216
    ds_read_b64_tr_b16 v[30:31], v23 offset:11264
    s_waitcnt lgkmcnt(10)
    v_mfma_f32_32x32x16_bf16 v[88:103], v[36:39], v[164:167], v[88:103]
    ds_read_b64_tr_b16 v[32:33], v22 offset:12288
    ds_read_b64_tr_b16 v[34:35], v22 offset:14336
    s_waitcnt lgkmcnt(10)
    v_mfma_f32_32x32x16_bf16 v[104:119], v[40:43], v[164:167], v[104:119]
    ds_read_b64_tr_b16 v[36:37], v23 offset:12288
    ds_read_b64_tr_b16 v[38:39], v23 offset:14336
    s_waitcnt lgkmcnt(10)
    v_mfma_f32_32x32x16_bf16 v[88:103], v[44:47], v[168:171], v[88:103]
    ds_read_b64_tr_b16 v[40:41], v22 offset:13312
    ds_read_b64_tr_b16 v[42:43], v22 offset:15360
    s_waitcnt lgkmcnt(10)
    v_mfma_f32_32x32x16_bf16 v[104:119], v[48:51], v[168:171], v[104:119]
    ds_read_b64_tr_b16 v[44:45], v23 offset:13312
    ds_read_b64_tr_b16 v[46:47], v23 offset:15360
    s_waitcnt lgkmcnt(10)
    v_mfma_f32_32x32x16_bf16 v[88:103], v[52:55], v[172:175], v[88:103]
    ds_read_b64_tr_b16 v[48:49], v22 offset:16384
    ds_read_b64_tr_b16 v[50:51], v22 offset:18432
    s_waitcnt lgkmcnt(10)
    v_mfma_f32_32x32x16_bf16 v[104:119], v[28:31], v[172:175], v[104:119]
    ds_read_b64_tr_b16 v[52:53], v23 offset:16384
    ds_read_b64_tr_b16 v[54:55], v23 offset:18432
    s_waitcnt lgkmcnt(10)
    v_mfma_f32_32x32x16_bf16 v[88:103], v[32:35], v[176:179], v[88:103]
    ds_read_b64_tr_b16 v[28:29], v22 offset:17408
    ds_read_b64_tr_b16 v[30:31], v22 offset:19456
    s_waitcnt lgkmcnt(10)
    v_mfma_f32_32x32x16_bf16 v[104:119], v[36:39], v[176:179], v[104:119]
    ds_read_b64_tr_b16 v[32:33], v23 offset:17408
    ds_read_b64_tr_b16 v[34:35], v23 offset:19456
    s_waitcnt lgkmcnt(10)
    v_mfma_f32_32x32x16_bf16 v[88:103], v[40:43], v[180:183], v[88:103]
    ds_read_b64_tr_b16 v[36:37], v22 offset:20480
    ds_read_b64_tr_b16 v[38:39], v22 offset:22528
    s_waitcnt lgkmcnt(10)
    v_mfma_f32_32x32x16_bf16 v[104:119], v[44:47], v[180:183], v[104:119]
    ds_read_b64_tr_b16 v[40:41], v23 offset:20480
    ds_read_b64_tr_b16 v[42:43], v23 offset:22528
    s_waitcnt lgkmcnt(10)
    v_mfma_f32_32x32x16_bf16 v[88:103], v[48:51], v[184:187], v[88:103]
    ds_read_b64_tr_b16 v[44:45], v22 offset:21504
    ds_read_b64_tr_b16 v[46:47], v22 offset:23552
    s_waitcnt lgkmcnt(10)
    v_mfma_f32_32x32x16_bf16 v[104:119], v[52:55], v[184:187], v[104:119]
    ds_read_b64_tr_b16 v[48:49], v23 offset:21504
    ds_read_b64_tr_b16 v[50:51], v23 offset:23552
    s_waitcnt lgkmcnt(10)
    v_mfma_f32_32x32x16_bf16 v[88:103], v[28:31], v[188:191], v[88:103]
    ds_read_b64_tr_b16 v[52:53], v22 offset:24576
    ds_read_b64_tr_b16 v[54:55], v22 offset:26624
    s_waitcnt lgkmcnt(10)
    v_mfma_f32_32x32x16_bf16 v[104:119], v[32:35], v[188:191], v[104:119]
    ds_read_b64_tr_b16 v[28:29], v23 offset:24576
    ds_read_b64_tr_b16 v[30:31], v23 offset:26624
    s_waitcnt lgkmcnt(10)
    v_mfma_f32_32x32x16_bf16 v[88:103], v[36:39], v[192:195], v[88:103]
    ds_read_b64_tr_b16 v[32:33], v22 offset:25600
    ds_read_b64_tr_b16 v[34:35], v22 offset:27648
    s_waitcnt lgkmcnt(10)
    v_mfma_f32_32x32x16_bf16 v[104:119], v[40:43], v[192:195], v[104:119]
    ds_read_b64_tr_b16 v[36:37], v23 offset:25600
    ds_read_b64_tr_b16 v[38:39], v23 offset:27648
    s_waitcnt lgkmcnt(10)
    v_mfma_f32_32x32x16_bf16 v[88:103], v[44:47], v[196:199], v[88:103]
    ds_read_b64_tr_b16 v[40:41], v22 offset:28672
    ds_read_b64_tr_b16 v[42:43], v22 offset:30720
    s_waitcnt lgkmcnt(10)
    v_mfma_f32_32x32x16_bf16 v[104:119], v[48:51], v[196:199], v[104:119]
    ds_read_b64_tr_b16 v[44:45], v23 offset:28672
    ds_read_b64_tr_b16 v[46:47], v23 offset:30720
    s_waitcnt lgkmcnt(10)
    v_mfma_f32_32x32x16_bf16 v[88:103], v[52:55], v[200:203], v[88:103]
    ds_read_b64_tr_b16 v[48:49], v22 offset:29696
    ds_read_b64_tr_b16 v[50:51], v22 offset:31744
    s_waitcnt lgkmcnt(10)
    v_mfma_f32_32x32x16_bf16 v[104:119], v[28:31], v[200:203], v[104:119]
    ds_read_b64_tr_b16 v[52:53], v23 offset:29696
    ds_read_b64_tr_b16 v[54:55], v23 offset:31744
    s_waitcnt lgkmcnt(10)
    v_mfma_f32_32x32x16_bf16 v[88:103], v[32:35], v[204:207], v[88:103]
    ds_read_b64_tr_b16 v[28:29], v24 offset:32768
    ds_read_b64_tr_b16 v[30:31], v24 offset:34816
    s_waitcnt lgkmcnt(10)
    v_mfma_f32_32x32x16_bf16 v[104:119], v[36:39], v[204:207], v[104:119]
    ds_read_b64_tr_b16 v[32:33], v25 offset:32768
    ds_read_b64_tr_b16 v[34:35], v25 offset:34816
    s_waitcnt lgkmcnt(10)
    v_mfma_f32_32x32x16_bf16 v[88:103], v[40:43], v[208:211], v[88:103]
    ds_read_b64_tr_b16 v[36:37], v24 offset:33792
    ds_read_b64_tr_b16 v[38:39], v24 offset:35840
    s_waitcnt lgkmcnt(10)
    v_mfma_f32_32x32x16_bf16 v[104:119], v[44:47], v[208:211], v[104:119]
    ds_read_b64_tr_b16 v[40:41], v25 offset:33792
    ds_read_b64_tr_b16 v[42:43], v25 offset:35840
    s_waitcnt lgkmcnt(10)
    v_mfma_f32_32x32x16_bf16 v[88:103], v[48:51], v[212:215], v[88:103]
    ds_read_b64_tr_b16 v[44:45], v24 offset:36864
    ds_read_b64_tr_b16 v[46:47], v24 offset:38912
    s_waitcnt lgkmcnt(10)
    v_mfma_f32_32x32x16_bf16 v[104:119], v[52:55], v[212:215], v[104:119]
    ds_read_b64_tr_b16 v[48:49], v25 offset:36864
    ds_read_b64_tr_b16 v[50:51], v25 offset:38912
    s_barrier
    s_waitcnt lgkmcnt(10)
    v_mfma_f32_32x32x16_bf16 v[120:135], v[28:31], v[216:219], v[120:135]
    ds_read_b64_tr_b16 v[52:53], v24 offset:37888
    ds_read_b64_tr_b16 v[54:55], v24 offset:39936
    s_waitcnt lgkmcnt(10)
    v_mfma_f32_32x32x16_bf16 v[136:151], v[32:35], v[216:219], v[136:151]
    ds_read_b64_tr_b16 v[28:29], v25 offset:37888
    ds_read_b64_tr_b16 v[30:31], v25 offset:39936
    s_waitcnt lgkmcnt(10)
    v_mfma_f32_32x32x16_bf16 v[120:135], v[36:39], v[220:223], v[120:135]
    v_cvt_pk_bf16_f32 v88, v88, v89
    ds_read_b64_tr_b16 v[32:33], v24 offset:40960
    ds_read_b64_tr_b16 v[34:35], v24 offset:43008
L_PAD4:
    s_cbranch_execz L_RET4
    s_waitcnt lgkmcnt(10)
    v_mfma_f32_32x32x16_bf16 v[136:151], v[40:43], v[220:223], v[136:151]
    v_cvt_pk_bf16_f32 v89, v90, v91
    ds_read_b64_tr_b16 v[36:37], v25 offset:40960
    ds_read_b64_tr_b16 v[38:39], v25 offset:43008
    s_waitcnt lgkmcnt(10)
    v_mfma_f32_32x32x16_bf16 v[120:135], v[44:47], v[224:227], v[120:135]
    v_cvt_pk_bf16_f32 v90, v92, v93
    ds_read_b64_tr_b16 v[40:41], v24 offset:41984
    ds_read_b64_tr_b16 v[42:43], v24 offset:44032
    s_waitcnt lgkmcnt(10)
    v_mfma_f32_32x32x16_bf16 v[136:151], v[48:51], v[224:227], v[136:151]
    v_cvt_pk_bf16_f32 v91, v94, v95
    ds_read_b64_tr_b16 v[44:45], v25 offset:41984
    ds_read_b64_tr_b16 v[46:47], v25 offset:44032
    s_waitcnt lgkmcnt(10)
    v_mfma_f32_32x32x16_bf16 v[120:135], v[52:55], v[228:231], v[120:135]
    ds_write_b128 v0, v[88:91]
    ds_read_b64_tr_b16 v[48:49], v24 offset:45056
    ds_read_b64_tr_b16 v[50:51], v24 offset:47104
    s_waitcnt lgkmcnt(11)
    v_mfma_f32_32x32x16_bf16 v[136:151], v[28:31], v[228:231], v[136:151]
    v_cvt_pk_bf16_f32 v92, v96, v97
    ds_read_b64_tr_b16 v[52:53], v25 offset:45056
    ds_read_b64_tr_b16 v[54:55], v25 offset:47104
    s_waitcnt lgkmcnt(11)
    v_mfma_f32_32x32x16_bf16 v[120:135], v[32:35], v[232:235], v[120:135]
    v_cvt_pk_bf16_f32 v93, v98, v99
    ds_read_b64_tr_b16 v[28:29], v24 offset:46080
    ds_read_b64_tr_b16 v[30:31], v24 offset:48128
    s_waitcnt lgkmcnt(11)
    v_mfma_f32_32x32x16_bf16 v[136:151], v[36:39], v[232:235], v[136:151]
    v_cvt_pk_bf16_f32 v94, v100, v101
    ds_read_b64_tr_b16 v[32:33], v25 offset:46080
    ds_read_b64_tr_b16 v[34:35], v25 offset:48128
    s_waitcnt lgkmcnt(11)
    v_mfma_f32_32x32x16_bf16 v[120:135], v[40:43], v[236:239], v[120:135]
    v_cvt_pk_bf16_f32 v95, v102, v103
    ds_read_b64_tr_b16 v[36:37], v24
    ds_read_b64_tr_b16 v[38:39], v24 offset:2048
    s_waitcnt lgkmcnt(11)
    v_mfma_f32_32x32x16_bf16 v[136:151], v[44:47], v[236:239], v[136:151]
    ds_write_b128 v0, v[92:95] offset:1024
    ds_read_b64_tr_b16 v[40:41], v25
    ds_read_b64_tr_b16 v[42:43], v25 offset:2048
    s_waitcnt lgkmcnt(11)
    v_mfma_f32_32x32x16_bf16 v[120:135], v[48:51], v[240:243], v[120:135]
    v_cvt_pk_bf16_f32 v104, v104, v105
    ds_read_b64_tr_b16 v[44:45], v24 offset:1024
    ds_read_b64_tr_b16 v[46:47], v24 offset:3072
    s_waitcnt lgkmcnt(11)
    v_mfma_f32_32x32x16_bf16 v[136:151], v[52:55], v[240:243], v[136:151]
    v_cvt_pk_bf16_f32 v105, v106, v107
    ds_read_b64_tr_b16 v[48:49], v25 offset:1024
    ds_read_b64_tr_b16 v[50:51], v25 offset:3072
    s_waitcnt lgkmcnt(11)
    v_mfma_f32_32x32x16_bf16 v[120:135], v[28:31], v[244:247], v[120:135]
    v_cvt_pk_bf16_f32 v106, v108, v109
    ds_read_b64_tr_b16 v[52:53], v24 offset:4096
    ds_read_b64_tr_b16 v[54:55], v24 offset:6144
    s_waitcnt lgkmcnt(11)
    v_mfma_f32_32x32x16_bf16 v[136:151], v[32:35], v[244:247], v[136:151]
    v_cvt_pk_bf16_f32 v107, v110, v111
    ds_read_b64_tr_b16 v[28:29], v25 offset:4096
    ds_read_b64_tr_b16 v[30:31], v25 offset:6144
    s_waitcnt lgkmcnt(11)
    v_mfma_f32_32x32x16_bf16 v[120:135], v[36:39], v[152:155], v[120:135]
    ds_write_b128 v0, v[104:107] offset:8192
    ds_read_b64_tr_b16 v[32:33], v24 offset:5120
    ds_read_b64_tr_b16 v[34:35], v24 offset:7168
    s_waitcnt lgkmcnt(11)
    v_mfma_f32_32x32x16_bf16 v[136:151], v[40:43], v[152:155], v[136:151]
    v_cvt_pk_bf16_f32 v108, v112, v113
    ds_read_b64_tr_b16 v[36:37], v25 offset:5120
    ds_read_b64_tr_b16 v[38:39], v25 offset:7168
    s_waitcnt lgkmcnt(11)
    v_mfma_f32_32x32x16_bf16 v[120:135], v[44:47], v[156:159], v[120:135]
    v_cvt_pk_bf16_f32 v109, v114, v115
    ds_read_b64_tr_b16 v[40:41], v24 offset:8192
    ds_read_b64_tr_b16 v[42:43], v24 offset:10240
    s_waitcnt lgkmcnt(11)
    v_mfma_f32_32x32x16_bf16 v[136:151], v[48:51], v[156:159], v[136:151]
    v_cvt_pk_bf16_f32 v110, v116, v117
    ds_read_b64_tr_b16 v[44:45], v25 offset:8192
    ds_read_b64_tr_b16 v[46:47], v25 offset:10240
    s_waitcnt lgkmcnt(11)
    v_mfma_f32_32x32x16_bf16 v[120:135], v[52:55], v[160:163], v[120:135]
    v_cvt_pk_bf16_f32 v111, v118, v119
    ds_read_b64_tr_b16 v[48:49], v24 offset:9216
    ds_read_b64_tr_b16 v[50:51], v24 offset:11264
    s_waitcnt lgkmcnt(11)
    v_mfma_f32_32x32x16_bf16 v[136:151], v[28:31], v[160:163], v[136:151]
    ds_write_b128 v0, v[108:111] offset:9216
    ds_read_b64_tr_b16 v[52:53], v25 offset:9216
    ds_read_b64_tr_b16 v[54:55], v25 offset:11264
    s_waitcnt lgkmcnt(11)
    v_mfma_f32_32x32x16_bf16 v[120:135], v[32:35], v[164:167], v[120:135]
    v_and_b32 v85, 1, v1
    ds_read_b64_tr_b16 v[28:29], v24 offset:12288
    ds_read_b64_tr_b16 v[30:31], v24 offset:14336
    s_waitcnt lgkmcnt(11)
    v_mfma_f32_32x32x16_bf16 v[136:151], v[36:39], v[164:167], v[136:151]
    v_lshlrev_b32 v85, 3, v85
    ds_read_b64_tr_b16 v[32:33], v25 offset:12288
    ds_read_b64_tr_b16 v[34:35], v25 offset:14336
    s_waitcnt lgkmcnt(11)
    v_mfma_f32_32x32x16_bf16 v[120:135], v[40:43], v[168:171], v[120:135]
    v_bfe_u32 v84, v1, 2, 2
    ds_read_b64_tr_b16 v[36:37], v24 offset:13312
    ds_read_b64_tr_b16 v[38:39], v24 offset:15360
    s_waitcnt lgkmcnt(11)
    v_mfma_f32_32x32x16_bf16 v[136:151], v[44:47], v[168:171], v[136:151]
    v_lshl_add_u32 v85, v84, 4, v85
    ds_read_b64_tr_b16 v[40:41], v25 offset:13312
    ds_read_b64_tr_b16 v[42:43], v25 offset:15360
    s_waitcnt lgkmcnt(11)
    v_mfma_f32_32x32x16_bf16 v[120:135], v[48:51], v[172:175], v[120:135]
    v_bfe_u32 v84, v1, 4, 1
    ds_read_b64_tr_b16 v[44:45], v24 offset:16384
    ds_read_b64_tr_b16 v[46:47], v24 offset:18432
    s_waitcnt lgkmcnt(10)
    v_mfma_f32_32x32x16_bf16 v[136:151], v[52:55], v[172:175], v[136:151]
    v_lshl_add_u32 v85, v84, 6, v85
    ds_read_b64_tr_b16 v[48:49], v25 offset:16384
    ds_read_b64_tr_b16 v[50:51], v25 offset:18432
    s_waitcnt lgkmcnt(10)
    v_mfma_f32_32x32x16_bf16 v[120:135], v[28:31], v[176:179], v[120:135]
    v_bfe_u32 v84, v1, 1, 1
    ds_read_b64_tr_b16 v[52:53], v24 offset:17408
    ds_read_b64_tr_b16 v[54:55], v24 offset:19456
    s_waitcnt lgkmcnt(10)
    v_mfma_f32_32x32x16_bf16 v[136:151], v[32:35], v[176:179], v[136:151]
    v_lshl_add_u32 v85, v84, 7, v85
    ds_read_b64_tr_b16 v[28:29], v25 offset:17408
    ds_read_b64_tr_b16 v[30:31], v25 offset:19456
    s_waitcnt lgkmcnt(10)
    v_mfma_f32_32x32x16_bf16 v[120:135], v[36:39], v[180:183], v[120:135]
    v_lshrrev_b32 v84, 5, v1
    ds_read_b64_tr_b16 v[32:33], v24 offset:20480
    ds_read_b64_tr_b16 v[34:35], v24 offset:22528
    s_waitcnt lgkmcnt(10)
    v_mfma_f32_32x32x16_bf16 v[136:151], v[40:43], v[180:183], v[136:151]
    v_lshl_add_u32 v85, v84, 8, v85
    ds_read_b64_tr_b16 v[36:37], v25 offset:20480
    ds_read_b64_tr_b16 v[38:39], v25 offset:22528
    s_waitcnt lgkmcnt(10)
    v_mfma_f32_32x32x16_bf16 v[120:135], v[44:47], v[184:187], v[120:135]
    s_lshl_b32 s13, s3, 12
    v_add_u32 v84, s13, v85
    ds_read_b64_tr_b16 v[40:41], v24 offset:21504
    ds_read_b64_tr_b16 v[42:43], v24 offset:23552
    s_waitcnt lgkmcnt(10)
    v_mfma_f32_32x32x16_bf16 v[136:151], v[48:51], v[184:187], v[136:151]
    s_lshl_b32 s96, s76, 13
    s_add_u32 s13, s96, 32768
    v_add_u32 v85, s13, v85
    ds_read_b64_tr_b16 v[44:45], v25 offset:21504
    ds_read_b64_tr_b16 v[46:47], v25 offset:23552
    s_waitcnt lgkmcnt(10)
    v_mfma_f32_32x32x16_bf16 v[120:135], v[52:55], v[188:191], v[120:135]
    v_mov_b32 v80, 0x3f803f80
    ds_read_b64_tr_b16 v[48:49], v24 offset:24576
    ds_read_b64_tr_b16 v[50:51], v24 offset:26624
    s_waitcnt lgkmcnt(10)
    v_mfma_f32_32x32x16_bf16 v[136:151], v[28:31], v[188:191], v[136:151]
    v_mov_b32 v81, 0x3f803f80
    ds_read_b64_tr_b16 v[52:53], v25 offset:24576
    ds_read_b64_tr_b16 v[54:55], v25 offset:26624
    s_waitcnt lgkmcnt(10)
    v_mfma_f32_32x32x16_bf16 v[120:135], v[32:35], v[192:195], v[120:135]
    v_mov_b32 v82, 0x3f803f80
    ds_read_b64_tr_b16 v[28:29], v24 offset:25600
    ds_read_b64_tr_b16 v[30:31], v24 offset:27648
    s_waitcnt lgkmcnt(10)
    v_mfma_f32_32x32x16_bf16 v[136:151], v[36:39], v[192:195], v[136:151]
    v_mov_b32 v83, 0x3f803f80
    ds_read_b64_tr_b16 v[32:33], v25 offset:25600
    ds_read_b64_tr_b16 v[34:35], v25 offset:27648
    s_waitcnt lgkmcnt(10)
    v_mfma_f32_32x32x16_bf16 v[120:135], v[40:43], v[196:199], v[120:135]
    s_lshl3_add_u32 s96, s11, s3
    s_lshl_b32 s97, s96, 5
    s_add_u32 s98, s97, s10
    s_lshl_b32 s99, s98, 10
    s_add_u32 s13, s99, 25165824
    s_add_u32 s15, s13, 16384
    s_lshl3_add_u32 s96, s11, s3
    s_lshl_b32 s97, s96, 10
    s_add_u32 s16, s97, 21495808
    s_lshl_b32 s96, s10, 6
    s_add_u32 s14, s96, s16
    ds_read_b64_tr_b16 v[36:37], v24 offset:28672
    ds_read_b64_tr_b16 v[38:39], v24 offset:30720
    s_waitcnt lgkmcnt(10)
    v_mfma_f32_32x32x16_bf16 v[136:151], v[44:47], v[196:199], v[136:151]
    ds_read_b64_tr_b16 v[40:41], v25 offset:28672
    ds_read_b64_tr_b16 v[42:43], v25 offset:30720
    s_waitcnt lgkmcnt(10)
    v_mfma_f32_32x32x16_bf16 v[120:135], v[48:51], v[200:203], v[120:135]
    ds_read_b64_tr_b16 v[44:45], v25 offset:29696
    ds_read_b64_tr_b16 v[46:47], v25 offset:31744
    s_waitcnt lgkmcnt(10)
    v_mfma_f32_32x32x16_bf16 v[136:151], v[52:55], v[200:203], v[136:151]
    ds_read_b64_tr_b16 v[48:49], v24 offset:29696
    ds_read_b64_tr_b16 v[50:51], v24 offset:31744
    s_waitcnt lgkmcnt(10)
    v_mfma_f32_32x32x16_bf16 v[120:135], v[28:31], v[204:207], v[120:135]
    s_waitcnt lgkmcnt(8)
    v_mfma_f32_32x32x16_bf16 v[136:151], v[32:35], v[204:207], v[136:151]
    s_waitcnt lgkmcnt(6)
    v_mfma_f32_32x32x16_bf16 v[120:135], v[36:39], v[208:211], v[120:135]
    s_waitcnt lgkmcnt(4)
    v_mfma_f32_32x32x16_bf16 v[136:151], v[40:43], v[208:211], v[136:151]
    s_waitcnt lgkmcnt(2)
    v_mfma_f32_32x32x16_bf16 v[136:151], v[44:47], v[212:215], v[136:151]
    s_waitcnt lgkmcnt(0)
    v_mfma_f32_32x32x16_bf16 v[120:135], v[48:51], v[212:215], v[120:135]
    s_lshl_b32 s96, s77, 11
    s_add_u32 s17, s96, 151552
    v_add_u32 v0, s17, v2
    v_bfe_u32 v4, v1, 2, 2
    v_lshlrev_b32 v4, 6, v4
    v_bfe_u32 v9, v1, 4, 1
    v_lshl_add_u32 v4, v9, 5, v4
    v_and_b32 v9, 3, v1
    v_lshl_add_u32 v4, v9, 3, v4
    v_lshrrev_b32 v9, 5, v1
    v_lshl_add_u32 v4, v9, 8, v4
    v_add_u32 v4, 159744, v4
    ds_read_b64_tr_b16 v[176:177], v4
    ds_read_b64_tr_b16 v[178:179], v4 offset:512
    ds_read_b64_tr_b16 v[180:181], v4 offset:1024
    ds_read_b64_tr_b16 v[182:183], v4 offset:1536
    v_cvt_pk_bf16_f32 v152, v136, v137
    v_cvt_pk_bf16_f32 v153, v138, v139
    v_cvt_pk_bf16_f32 v154, v140, v141
    v_cvt_pk_bf16_f32 v155, v142, v143
    v_cvt_pk_bf16_f32 v156, v144, v145
    v_cvt_pk_bf16_f32 v157, v146, v147
    v_cvt_pk_bf16_f32 v158, v148, v149
    v_cvt_pk_bf16_f32 v159, v150, v151
    ds_write_b128 v0, v[152:155]
    ds_write_b128 v0, v[156:159] offset:1024
    v_cvt_pk_bf16_f32 v168, v120, v121
    v_cvt_pk_bf16_f32 v169, v122, v123
    v_cvt_pk_bf16_f32 v170, v124, v125
    v_cvt_pk_bf16_f32 v171, v126, v127
    v_cvt_pk_bf16_f32 v172, v128, v129
    v_cvt_pk_bf16_f32 v173, v130, v131
    v_cvt_pk_bf16_f32 v174, v132, v133
    v_cvt_pk_bf16_f32 v175, v134, v135
    s_setprio 0
    s_branch L_JOIN
L_HELP:
    s_waitcnt vmcnt(0)
    s_barrier
    s_add_u32 s96, s84, 4
    s_and_b32 s97, s96, 15
    s_mul_i32 s98, s97, 393216
    s_add_u32 s99, s98, s85
    s_add_u32 s82, s99, 4294772736
    s_add_u32 m0, s83, 28672
    s_nop 0
    buffer_load_dwordx4 v3, s[40:43], s82 offen lds
    s_add_u32 s96, s84, 4
    s_and_b32 s97, s96, 15
    s_mul_i32 s98, s97, 393216
    s_add_u32 s99, s98, s85
    s_add_u32 s82, s99, 2048
    s_add_u32 m0, s83, 32768
    s_nop 0
    buffer_load_dwordx4 v3, s[40:43], s82 offen lds
    s_add_u32 s96, s84, 4
    s_and_b32 s97, s96, 15
    s_mul_i32 s98, s97, 393216
    s_add_u32 s99, s98, s85
    s_add_u32 s82, s99, 4294774784
    s_add_u32 m0, s83, 77824
    s_nop 0
    buffer_load_dwordx4 v3, s[40:43], s82 offen lds
    s_add_u32 s96, s84, 4
    s_and_b32 s97, s96, 15
    s_mul_i32 s98, s97, 393216
    s_add_u32 s99, s98, s85
    s_add_u32 s82, s99, 4096
    s_add_u32 m0, s83, 81920
    s_nop 0
    buffer_load_dwordx4 v3, s[40:43], s82 offen lds
    s_add_u32 s96, s84, 4
    s_and_b32 s97, s96, 15
    s_mul_i32 s98, s97, 393216
    s_add_u32 s99, s98, s85
    s_add_u32 s82, s99, 4294770688
    s_add_u32 m0, s83, 126976
    s_nop 0
    buffer_load_dwordx4 v3, s[40:43], s82 offen lds
    s_add_u32 s96, s84, 4
    s_and_b32 s97, s96, 15
    s_mul_i32 s98, s97, 393216
    s_add_u32 s82, s98, s85
    s_add_u32 m0, s83, 131072
    s_nop 0
    buffer_load_dwordx4 v3, s[40:43], s82 offen lds
    s_add_u32 s96, s84, 5
    s_and_b32 s97, s96, 15
    s_mul_i32 s98, s97, 393216
    s_add_u32 s99, s98, s85
    s_add_u32 s82, s99, 4294772736
    s_add_u32 m0, s83, 36864
    s_nop 0
    buffer_load_dwordx4 v3, s[40:43], s82 offen lds
    s_add_u32 s96, s84, 5
    s_and_b32 s97, s96, 15
    s_mul_i32 s98, s97, 393216
    s_add_u32 s99, s98, s85
    s_add_u32 s82, s99, 2048
    s_add_u32 m0, s83, 40960
    s_nop 0
    buffer_load_dwordx4 v3, s[40:43], s82 offen lds
    s_add_u32 s96, s84, 5
    s_and_b32 s97, s96, 15
    s_mul_i32 s98, s97, 393216
    s_add_u32 s99, s98, s85
    s_add_u32 s82, s99, 4294774784
    s_add_u32 m0, s83, 86016
    s_nop 0
    buffer_load_dwordx4 v3, s[40:43], s82 offen lds
    s_add_u32 s96, s84, 5
    s_and_b32 s97, s96, 15
    s_mul_i32 s98, s97, 393216
    s_add_u32 s99, s98, s85
    s_add_u32 s82, s99, 4096
    s_add_u32 m0, s83, 90112
    s_nop 0
    buffer_load_dwordx4 v3, s[40:43], s82 offen lds
    s_add_u32 s96, s84, 5
    s_and_b32 s97, s96, 15
    s_mul_i32 s98, s97, 393216
    s_add_u32 s99, s98, s85
    s_add_u32 s82, s99, 4294770688
    s_add_u32 m0, s83, 135168
    s_nop 0
    buffer_load_dwordx4 v3, s[40:43], s82 offen lds
    s_add_u32 s96, s84, 5
    s_and_b32 s97, s96, 15
    s_mul_i32 s98, s97, 393216
    s_add_u32 s82, s98, s85
    s_add_u32 m0, s83, 139264
    s_nop 0
    buffer_load_dwordx4 v3, s[40:43], s82 offen lds
    s_waitcnt lgkmcnt(0)
SPOLL_16:
    s_load_dwordx2 s[24:25], s[32:33], s19 offset:0 glc
    s_load_dwordx2 s[26:27], s[32:33], s19 offset:64 glc
SCHK_17:
    s_add_u32 s5, s5, 1
    s_cmp_ge_u32 s5, 200000
    s_waitcnt lgkmcnt(0)
    s_cbranch_scc1 SDONE_18
    s_cmp_lg_u32 s24, s4
    s_cbranch_scc1 SPOLL_16
    s_cmp_lg_u32 s25, s4
    s_cbranch_scc1 SPOLL_16
    s_cmp_lg_u32 s26, s4
    s_cbranch_scc1 SPOLL_16
    s_cmp_lg_u32 s27, s4
    s_cbranch_scc1 SPOLL_16
SDONE_18:
    v_bfe_u32 v4, v1, 2, 2
    v_lshlrev_b32 v4, 6, v4
    v_bfe_u32 v9, v1, 4, 1
    v_lshl_add_u32 v4, v9, 5, v4
    v_and_b32 v9, 3, v1
    v_lshl_add_u32 v4, v9, 3, v4
    v_lshrrev_b32 v9, 5, v1
    v_lshl_add_u32 v4, v9, 8, v4
    v_add_u32 v4, 159744, v4
    ds_read_b64_tr_b16 v[168:169], v4
    ds_read_b64_tr_b16 v[170:171], v4 offset:512
    ds_read_b64_tr_b16 v[172:173], v4 offset:1024
    ds_read_b64_tr_b16 v[174:175], v4 offset:1536
    ds_read_b64_tr_b16 v[176:177], v4 offset:2048
    ds_read_b64_tr_b16 v[178:179], v4 offset:2560
    ds_read_b64_tr_b16 v[180:181], v4 offset:3072
    ds_read_b64_tr_b16 v[182:183], v4 offset:3584
    s_lshl_b32 s14, s77, 10
    v_and_b32 v232, 7, v1
    v_lshl_add_u32 v232, v232, 4, s14
    v_bfe_u32 v9, v1, 3, 2
    v_lshl_add_u32 v232, v9, 8, v232
    v_lshrrev_b32 v9, 5, v1
    v_lshl_add_u32 v232, v9, 7, v232
    s_and_b32 s96, s9, 1
    s_lshl1_add_u32 s18, s96, 1
    s_and_b32 s96, s8, 3
    s_lshl2_add_u32 s97, s96, s3
    s_sub_u32 s98, s97, 4
    s_lshl_b32 s82, s98, 7
    v_lshrrev_b32 v8, 3, v1
    v_lshl_add_u32 v8, v8, 1, s82
    global_load_ushort v36, v8, s[86:87] offset:0
    global_load_ushort v37, v8, s[86:87] offset:16
    global_load_ushort v38, v8, s[86:87] offset:32
    global_load_ushort v39, v8, s[86:87] offset:48
    global_load_ushort v40, v8, s[86:87] offset:64
    global_load_ushort v41, v8, s[86:87] offset:80
    global_load_ushort v42, v8, s[86:87] offset:96
    global_load_ushort v43, v8, s[86:87] offset:112
    s_and_b32 s96, s8, 3
    s_lshl2_add_u32 s97, s96, s3
    s_sub_u32 s98, s97, 4
    s_mul_i32 s99, s98, 786432
    s_lshr_b32 s96, s8, 2
    s_lshl1_add_u32 s97, s9, s96
    s_lshl_b32 s98, s97, 7
    s_add_u32 s96, s99, s98
    s_add_u32 s19, s96, 4096
    s_barrier
    s_add_u32 s96, s84, 6
    s_and_b32 s97, s96, 15
    s_mul_i32 s98, s97, 393216
    s_add_u32 s99, s98, s85
    s_add_u32 s82, s99, 4294772736
    s_add_u32 m0, s83, 4294963200
    s_nop 0
    buffer_load_dwordx4 v3, s[40:43], s82 offen lds
    s_add_u32 s96, s84, 6
    s_and_b32 s97, s96, 15
    s_mul_i32 s98, s97, 393216
    s_add_u32 s99, s98, s85
    s_add_u32 s82, s99, 2048
    s_mov_b32 m0, s83
    s_nop 0
    buffer_load_dwordx4 v3, s[40:43], s82 offen lds
    s_add_u32 s96, s84, 6
    s_and_b32 s97, s96, 15
    s_mul_i32 s98, s97, 393216
    s_add_u32 s99, s98, s85
    s_add_u32 s82, s99, 4294770688
    s_add_u32 m0, s83, 94208
    s_nop 0
    buffer_load_dwordx4 v3, s[40:43], s82 offen lds
    s_add_u32 s96, s84, 6
    s_and_b32 s97, s96, 15
    s_mul_i32 s98, s97, 393216
    s_add_u32 s82, s98, s85
    s_add_u32 m0, s83, 98304
    s_nop 0
    buffer_load_dwordx4 v3, s[40:43], s82 offen lds
    s_add_u32 s96, s84, 6
    s_and_b32 s97, s96, 15
    s_mul_i32 s98, s97, 393216
    s_add_u32 s99, s98, s85
    s_add_u32 s82, s99, 4294774784
    s_add_u32 m0, s83, 45056
    s_nop 0
    buffer_load_dwordx4 v3, s[40:43], s82 offen lds
    s_add_u32 s96, s84, 6
    s_and_b32 s97, s96, 15
    s_mul_i32 s98, s97, 393216
    s_add_u32 s99, s98, s85
    s_add_u32 s82, s99, 4096
    s_add_u32 m0, s83, 49152
    s_nop 0
    buffer_load_dwordx4 v3, s[40:43], s82 offen lds
    s_waitcnt lgkmcnt(0)
    s_load_dword s24, s[32:33], s92 offset:512 glc
    s_load_dword s25, s[32:33], s92 offset:256 glc
    s_load_dword s26, s[32:33], s92 offset:3584 glc
    s_load_dword s27, s[32:33], s92 offset:3328 glc
    s_barrier
    s_add_u32 s96, s84, 7
    s_and_b32 s97, s96, 15
    s_mul_i32 s98, s97, 393216
    s_add_u32 s99, s98, s85
    s_add_u32 s82, s99, 4294772736
    s_add_u32 m0, s83, 4096
    s_nop 0
    buffer_load_dwordx4 v3, s[40:43], s82 offen lds
    s_add_u32 s96, s84, 7
    s_and_b32 s97, s96, 15
    s_mul_i32 s98, s97, 393216
    s_add_u32 s99, s98, s85
    s_add_u32 s82, s99, 2048
    s_add_u32 m0, s83, 8192
    s_nop 0
    buffer_load_dwordx4 v3, s[40:43], s82 offen lds
    s_add_u32 s96, s84, 7
    s_and_b32 s97, s96, 15
    s_mul_i32 s98, s97, 393216
    s_add_u32 s99, s98, s85
    s_add_u32 s82, s99, 4294770688
    s_add_u32 m0, s83, 102400
    s_nop 0
    buffer_load_dwordx4 v3, s[40:43], s82 offen lds
    s_add_u32 s96, s84, 7
    s_and_b32 s97, s96, 15
    s_mul_i32 s98, s97, 393216
    s_add_u32 s82, s98, s85
    s_add_u32 m0, s83, 106496
    s_nop 0
    buffer_load_dwordx4 v3, s[40:43], s82 offen lds
    s_add_u32 s96, s84, 7
    s_and_b32 s97, s96, 15
    s_mul_i32 s98, s97, 393216
    s_add_u32 s99, s98, s85
    s_add_u32 s82, s99, 4294774784
    s_add_u32 m0, s83, 53248
    s_nop 0
    buffer_load_dwordx4 v3, s[40:43], s82 offen lds
    s_add_u32 s96, s84, 7
    s_and_b32 s97, s96, 15
    s_mul_i32 s98, s97, 393216
    s_add_u32 s99, s98, s85
    s_add_u32 s82, s99, 4096
    s_add_u32 m0, s83, 57344
    s_nop 0
    buffer_load_dwordx4 v3, s[40:43], s82 offen lds
    s_waitcnt vmcnt(30)
    s_waitcnt vmcnt(26)
    s_barrier
    s_add_u32 s96, s84, 8
    s_and_b32 s97, s96, 15
    s_mul_i32 s98, s97, 393216
    s_add_u32 s99, s98, s85
    s_add_u32 s82, s99, 4294772736
    s_add_u32 m0, s83, 12288
    s_nop 0
    buffer_load_dwordx4 v3, s[40:43], s82 offen lds
    s_add_u32 s96, s84, 8
    s_and_b32 s97, s96, 15
    s_mul_i32 s98, s97, 393216
    s_add_u32 s99, s98, s85
    s_add_u32 s82, s99, 2048
    s_add_u32 m0, s83, 16384
    s_nop 0
    buffer_load_dwordx4 v3, s[40:43], s82 offen lds
    s_add_u32 s96, s84, 8
    s_and_b32 s97, s96, 15
    s_mul_i32 s98, s97, 393216
    s_add_u32 s99, s98, s85
    s_add_u32 s82, s99, 4294770688
    s_add_u32 m0, s83, 110592
    s_nop 0
    buffer_load_dwordx4 v3, s[40:43], s82 offen lds
    s_add_u32 s96, s84, 8
    s_and_b32 s97, s96, 15
    s_mul_i32 s98, s97, 393216
    s_add_u32 s82, s98, s85
    s_add_u32 m0, s83, 114688
    s_nop 0
    buffer_load_dwordx4 v3, s[40:43], s82 offen lds
    s_add_u32 s96, s84, 8
    s_and_b32 s97, s96, 15
    s_mul_i32 s98, s97, 393216
    s_add_u32 s99, s98, s85
    s_add_u32 s82, s99, 4294774784
    s_add_u32 m0, s83, 61440
    s_nop 0
    buffer_load_dwordx4 v3, s[40:43], s82 offen lds
    s_add_u32 s96, s84, 8
    s_and_b32 s97, s96, 15
    s_mul_i32 s98, s97, 393216
    s_add_u32 s99, s98, s85
    s_add_u32 s82, s99, 4096
    s_add_u32 m0, s83, 65536
    s_nop 0
    buffer_load_dwordx4 v3, s[40:43], s82 offen lds
    s_waitcnt vmcnt(18)
    v_lshlrev_b32 v36, 16, v36
    v_mul_f32 v8, s7, v36
    v_exp_f32 v8, -v8
    s_nop 0
    v_add_f32 v8, 1.0, v8
    v_rcp_f32 v8, v8
    s_nop 0
    v_mul_f32 v36, v36, v8
    v_cvt_pk_bf16_f32 v36, 0, v36
    v_lshlrev_b32 v37, 16, v37
    v_mul_f32 v9, s7, v37
    v_exp_f32 v9, -v9
    s_nop 0
    v_add_f32 v9, 1.0, v9
    v_rcp_f32 v9, v9
    s_nop 0
    v_mul_f32 v37, v37, v9
    v_cvt_pk_bf16_f32 v37, 0, v37
    v_lshlrev_b32 v38, 16, v38
    v_mul_f32 v8, s7, v38
    v_exp_f32 v8, -v8
    s_nop 0
    v_add_f32 v8, 1.0, v8
    v_rcp_f32 v8, v8
    s_nop 0
    v_mul_f32 v38, v38, v8
    v_cvt_pk_bf16_f32 v38, 0, v38
    v_lshlrev_b32 v39, 16, v39
    v_mul_f32 v9, s7, v39
    v_exp_f32 v9, -v9
    s_nop 0
    v_add_f32 v9, 1.0, v9
    v_rcp_f32 v9, v9
    s_nop 0
    v_mul_f32 v39, v39, v9
    v_cvt_pk_bf16_f32 v39, 0, v39
    v_lshlrev_b32 v40, 16, v40
    v_mul_f32 v8, s7, v40
    v_exp_f32 v8, -v8
    s_nop 0
    v_add_f32 v8, 1.0, v8
    v_rcp_f32 v8, v8
    s_nop 0
    v_mul_f32 v40, v40, v8
    v_cvt_pk_bf16_f32 v40, 0, v40
    v_lshlrev_b32 v41, 16, v41
    v_mul_f32 v9, s7, v41
    v_exp_f32 v9, -v9
    s_nop 0
    v_add_f32 v9, 1.0, v9
    v_rcp_f32 v9, v9
    s_nop 0
    v_mul_f32 v41, v41, v9
    v_cvt_pk_bf16_f32 v41, 0, v41
    v_lshlrev_b32 v42, 16, v42
    v_mul_f32 v8, s7, v42
    v_exp_f32 v8, -v8
    s_nop 0
    v_add_f32 v8, 1.0, v8
    v_rcp_f32 v8, v8
    s_nop 0
    v_mul_f32 v42, v42, v8
    v_cvt_pk_bf16_f32 v42, 0, v42
    v_lshlrev_b32 v43, 16, v43
    v_mul_f32 v9, s7, v43
    v_exp_f32 v9, -v9
    s_nop 0
    v_add_f32 v9, 1.0, v9
    v_rcp_f32 v9, v9
    s_nop 0
    v_mul_f32 v43, v43, v9
    v_cvt_pk_bf16_f32 v43, 0, v43
    s_waitcnt lgkmcnt(0)
    s_load_dword s24, s[32:33], s92 offset:1024 glc
    s_load_dword s25, s[32:33], s92 offset:768 glc
    s_load_dword s26, s[32:33], s92 offset:1536 glc
    s_load_dword s27, s[32:33], s92 offset:1280 glc
    s_barrier
    s_add_u32 s96, s84, 9
    s_and_b32 s97, s96, 15
    s_mul_i32 s98, s97, 393216
    s_add_u32 s99, s98, s85
    s_add_u32 s82, s99, 4294772736
    s_add_u32 m0, s83, 20480
    s_nop 0
    buffer_load_dwordx4 v3, s[40:43], s82 offen lds
    s_add_u32 s96, s84, 9
    s_and_b32 s97, s96, 15
    s_mul_i32 s98, s97, 393216
    s_add_u32 s99, s98, s85
    s_add_u32 s82, s99, 2048
    s_add_u32 m0, s83, 24576
    s_nop 0
    buffer_load_dwordx4 v3, s[40:43], s82 offen lds
L_PAD5:
    s_cbranch_execz L_RET5
    s_add_u32 s96, s84, 9
    s_and_b32 s97, s96, 15
    s_mul_i32 s98, s97, 393216
    s_add_u32 s99, s98, s85
    s_add_u32 s82, s99, 4294770688
    s_add_u32 m0, s83, 118784
    s_nop 0
    buffer_load_dwordx4 v3, s[40:43], s82 offen lds
    s_add_u32 s96, s84, 9
    s_and_b32 s97, s96, 15
    s_mul_i32 s98, s97, 393216
    s_add_u32 s82, s98, s85
    s_add_u32 m0, s83, 122880
    s_nop 0
    buffer_load_dwordx4 v3, s[40:43], s82 offen lds
    s_add_u32 s96, s84, 9
    s_and_b32 s97, s96, 15
    s_mul_i32 s98, s97, 393216
    s_add_u32 s99, s98, s85
    s_add_u32 s82, s99, 4294774784
    s_add_u32 m0, s83, 69632
    s_nop 0
    buffer_load_dwordx4 v3, s[40:43], s82 offen lds
    s_add_u32 s96, s84, 9
    s_and_b32 s97, s96, 15
    s_mul_i32 s98, s97, 393216
    s_add_u32 s99, s98, s85
    s_add_u32 s82, s99, 4096
    s_add_u32 m0, s83, 73728
    s_nop 0
    buffer_load_dwordx4 v3, s[40:43], s82 offen lds
    s_waitcnt vmcnt(22)
    s_waitcnt vmcnt(20)
    s_waitcnt vmcnt(18)
    s_barrier
    s_add_u32 s96, s84, 10
    s_and_b32 s97, s96, 15
    s_mul_i32 s98, s97, 393216
    s_add_u32 s99, s98, s85
    s_add_u32 s82, s99, 4294772736
    s_add_u32 m0, s83, 28672
    s_nop 0
    buffer_load_dwordx4 v3, s[40:43], s82 offen lds
    s_add_u32 s96, s84, 10
    s_and_b32 s97, s96, 15
    s_mul_i32 s98, s97, 393216
    s_add_u32 s99, s98, s85
    s_add_u32 s82, s99, 2048
    s_add_u32 m0, s83, 32768
    s_nop 0
    buffer_load_dwordx4 v3, s[40:43], s82 offen lds
    s_add_u32 s96, s84, 10
    s_and_b32 s97, s96, 15
    s_mul_i32 s98, s97, 393216
    s_add_u32 s99, s98, s85
    s_add_u32 s82, s99, 4294774784
    s_add_u32 m0, s83, 77824
    s_nop 0
    buffer_load_dwordx4 v3, s[40:43], s82 offen lds
    s_add_u32 s96, s84, 10
    s_and_b32 s97, s96, 15
    s_mul_i32 s98, s97, 393216
    s_add_u32 s99, s98, s85
    s_add_u32 s82, s99, 4096
    s_add_u32 m0, s83, 81920
    s_nop 0
    buffer_load_dwordx4 v3, s[40:43], s82 offen lds
    s_waitcnt lgkmcnt(0)
    s_load_dword s24, s[32:33], s92 offset:2560 glc
    s_load_dword s25, s[32:33], s92 offset:2304 glc
    s_load_dword s26, s[32:33], s92 offset:3072 glc
    s_load_dword s27, s[32:33], s92 offset:2816 glc
    s_waitcnt vmcnt(20)
    s_waitcnt vmcnt(18)
    s_waitcnt vmcnt(16)
    s_barrier
    s_add_u32 s96, s84, 11
    s_and_b32 s97, s96, 15
    s_mul_i32 s98, s97, 393216
    s_add_u32 s99, s98, s85
    s_add_u32 s82, s99, 4294772736
    s_add_u32 m0, s83, 36864
    s_nop 0
    buffer_load_dwordx4 v3, s[40:43], s82 offen lds
    s_add_u32 s96, s84, 11
    s_and_b32 s97, s96, 15
    s_mul_i32 s98, s97, 393216
    s_add_u32 s99, s98, s85
    s_add_u32 s82, s99, 2048
    s_add_u32 m0, s83, 40960
    s_nop 0
    buffer_load_dwordx4 v3, s[40:43], s82 offen lds
    s_add_u32 s96, s84, 11
    s_and_b32 s97, s96, 15
    s_mul_i32 s98, s97, 393216
    s_add_u32 s99, s98, s85
    s_add_u32 s82, s99, 4294774784
    s_add_u32 m0, s83, 86016
    s_nop 0
    buffer_load_dwordx4 v3, s[40:43], s82 offen lds
    s_add_u32 s96, s84, 11
    s_and_b32 s97, s96, 15
    s_mul_i32 s98, s97, 393216
    s_add_u32 s99, s98, s85
    s_add_u32 s82, s99, 4096
    s_add_u32 m0, s83, 90112
    s_nop 0
    buffer_load_dwordx4 v3, s[40:43], s82 offen lds
    s_waitcnt vmcnt(18)
    s_waitcnt vmcnt(16)
    s_waitcnt vmcnt(14)
    s_barrier
    s_add_u32 s96, s84, 12
    s_and_b32 s97, s96, 15
    s_mul_i32 s98, s97, 393216
    s_add_u32 s99, s98, s85
    s_add_u32 s82, s99, 4294772736
    s_add_u32 m0, s83, 4294963200
    s_nop 0
    buffer_load_dwordx4 v3, s[40:43], s82 offen lds
    s_add_u32 s96, s84, 12
    s_and_b32 s97, s96, 15
    s_mul_i32 s98, s97, 393216
    s_add_u32 s99, s98, s85
    s_add_u32 s82, s99, 2048
    s_mov_b32 m0, s83
    s_nop 0
    buffer_load_dwordx4 v3, s[40:43], s82 offen lds
    s_add_u32 s96, s84, 12
    s_and_b32 s97, s96, 15
    s_mul_i32 s98, s97, 393216
    s_add_u32 s99, s98, s85
    s_add_u32 s82, s99, 4294774784
    s_add_u32 m0, s83, 45056
    s_nop 0
    buffer_load_dwordx4 v3, s[40:43], s82 offen lds
    s_add_u32 s96, s84, 12
    s_and_b32 s97, s96, 15
    s_mul_i32 s98, s97, 393216
    s_add_u32 s99, s98, s85
    s_add_u32 s82, s99, 4096
    s_add_u32 m0, s83, 49152
    s_nop 0
    buffer_load_dwordx4 v3, s[40:43], s82 offen lds
    s_waitcnt vmcnt(16)
    s_barrier
    s_add_u32 s96, s84, 13
    s_and_b32 s97, s96, 15
    s_mul_i32 s98, s97, 393216
    s_add_u32 s99, s98, s85
    s_add_u32 s82, s99, 4294772736
    s_add_u32 m0, s83, 4096
    s_nop 0
    buffer_load_dwordx4 v3, s[40:43], s82 offen lds
    s_add_u32 s96, s84, 13
    s_and_b32 s97, s96, 15
    s_mul_i32 s98, s97, 393216
    s_add_u32 s99, s98, s85
    s_add_u32 s82, s99, 2048
    s_add_u32 m0, s83, 8192
    s_nop 0
    buffer_load_dwordx4 v3, s[40:43], s82 offen lds
    s_add_u32 s96, s84, 13
    s_and_b32 s97, s96, 15
    s_mul_i32 s98, s97, 393216
    s_add_u32 s99, s98, s85
    s_add_u32 s82, s99, 4294774784
    s_add_u32 m0, s83, 53248
    s_nop 0
    buffer_load_dwordx4 v3, s[40:43], s82 offen lds
    s_add_u32 s96, s84, 13
    s_and_b32 s97, s96, 15
    s_mul_i32 s98, s97, 393216
    s_add_u32 s99, s98, s85
    s_add_u32 s82, s99, 4096
    s_add_u32 m0, s83, 57344
    s_nop 0
    buffer_load_dwordx4 v3, s[40:43], s82 offen lds
    s_lshl_b32 s96, s74, 13
    s_sub_u32 s97, s3, 4
    s_lshl_b32 s98, s97, 8
    s_add_u32 s99, s96, s98
    s_add_u32 s13, s99, 20971520
    s_waitcnt lgkmcnt(0)
    s_load_dword s24, s[32:33], s13 offset:1276 glc
    s_load_dword s25, s[32:33], s13 offset:3324 glc
    s_load_dword s26, s[32:33], s13 offset:5372 glc
    s_load_dword s27, s[32:33], s13 offset:7420 glc
    s_waitcnt vmcnt(18)
    s_waitcnt vmcnt(16)
    s_barrier
    s_add_u32 s96, s84, 14
    s_and_b32 s97, s96, 15
    s_mul_i32 s98, s97, 393216
    s_add_u32 s99, s98, s85
    s_add_u32 s82, s99, 4294772736
    s_add_u32 m0, s83, 12288
    s_nop 0
    buffer_load_dwordx4 v3, s[40:43], s82 offen lds
    s_add_u32 s96, s84, 14
    s_and_b32 s97, s96, 15
    s_mul_i32 s98, s97, 393216
    s_add_u32 s99, s98, s85
    s_add_u32 s82, s99, 2048
    s_add_u32 m0, s83, 16384
    s_nop 0
    buffer_load_dwordx4 v3, s[40:43], s82 offen lds
    s_add_u32 s96, s84, 10
    s_and_b32 s97, s96, 15
    s_mul_i32 s98, s97, 393216
    s_add_u32 s99, s98, s85
    s_add_u32 s82, s99, 4294770688
    s_add_u32 m0, s83, 126976
    s_nop 0
    buffer_load_dwordx4 v3, s[40:43], s82 offen lds
    s_add_u32 s96, s84, 10
    s_and_b32 s97, s96, 15
    s_mul_i32 s98, s97, 393216
    s_add_u32 s82, s98, s85
    s_add_u32 m0, s83, 131072
    s_nop 0
    buffer_load_dwordx4 v3, s[40:43], s82 offen lds
    s_waitcnt vmcnt(18)
    s_waitcnt vmcnt(14)
    s_barrier
    s_add_u32 s96, s84, 15
    s_and_b32 s97, s96, 15
    s_mul_i32 s98, s97, 393216
    s_add_u32 s99, s98, s85
    s_add_u32 s82, s99, 4294772736
    s_add_u32 m0, s83, 20480
    s_nop 0
    buffer_load_dwordx4 v3, s[40:43], s82 offen lds
    s_add_u32 s96, s84, 15
    s_and_b32 s97, s96, 15
    s_mul_i32 s98, s97, 393216
    s_add_u32 s99, s98, s85
    s_add_u32 s82, s99, 2048
    s_add_u32 m0, s83, 24576
    s_nop 0
    buffer_load_dwordx4 v3, s[40:43], s82 offen lds
    s_add_u32 s96, s84, 11
    s_and_b32 s97, s96, 15
    s_mul_i32 s98, s97, 393216
    s_add_u32 s99, s98, s85
    s_add_u32 s82, s99, 4294770688
    s_add_u32 m0, s83, 135168
    s_nop 0
    buffer_load_dwordx4 v3, s[40:43], s82 offen lds
    s_add_u32 s96, s84, 11
    s_and_b32 s97, s96, 15
    s_mul_i32 s98, s97, 393216
    s_add_u32 s82, s98, s85
    s_add_u32 m0, s83, 139264
    s_nop 0
    buffer_load_dwordx4 v3, s[40:43], s82 offen lds
    s_waitcnt vmcnt(14)
    s_waitcnt vmcnt(10)
    s_waitcnt vmcnt(6)
    s_barrier
    s_add_u32 s96, s84, 14
    s_and_b32 s97, s96, 15
    s_mul_i32 s98, s97, 393216
    s_add_u32 s99, s98, s85
    s_add_u32 s82, s99, 4294774784
    s_add_u32 m0, s83, 61440
    s_nop 0
    buffer_load_dwordx4 v3, s[40:43], s82 offen lds
    s_add_u32 s96, s84, 14
    s_and_b32 s97, s96, 15
    s_mul_i32 s98, s97, 393216
    s_add_u32 s99, s98, s85
    s_add_u32 s82, s99, 4096
    s_add_u32 m0, s83, 65536
    s_nop 0
    buffer_load_dwordx4 v3, s[40:43], s82 offen lds
    s_add_u32 s96, s84, 15
    s_and_b32 s97, s96, 15
    s_mul_i32 s98, s97, 393216
    s_add_u32 s99, s98, s85
    s_add_u32 s82, s99, 4294774784
    s_add_u32 m0, s83, 69632
    s_nop 0
    buffer_load_dwordx4 v3, s[40:43], s82 offen lds
    s_add_u32 s96, s84, 15
    s_and_b32 s97, s96, 15
    s_mul_i32 s98, s97, 393216
    s_add_u32 s99, s98, s85
    s_add_u32 s82, s99, 4096
    s_add_u32 m0, s83, 73728
    s_nop 0
    buffer_load_dwordx4 v3, s[40:43], s82 offen lds
    s_add_u32 s96, s84, 12
    s_and_b32 s97, s96, 15
    s_mul_i32 s98, s97, 393216
    s_add_u32 s99, s98, s85
    s_add_u32 s82, s99, 4294770688
    s_add_u32 m0, s83, 94208
    s_nop 0
    buffer_load_dwordx4 v3, s[40:43], s82 offen lds
    s_add_u32 s96, s84, 12
    s_and_b32 s97, s96, 15
    s_mul_i32 s98, s97, 393216
    s_add_u32 s82, s98, s85
    s_add_u32 m0, s83, 98304
    s_nop 0
    buffer_load_dwordx4 v3, s[40:43], s82 offen lds
    s_mov_b32 s82, s19
    buffer_load_dwordx4 v[88:91], v248, s[48:51], s82 offen nt
    s_add_u32 s82, s19, 98304
    buffer_load_dwordx4 v[92:95], v248, s[48:51], s82 offen nt
    s_add_u32 s82, s19, 196608
    buffer_load_dwordx4 v[96:99], v248, s[48:51], s82 offen nt
    s_add_u32 s82, s19, 294912
    buffer_load_dwordx4 v[100:103], v248, s[48:51], s82 offen nt
    s_waitcnt vmcnt(12)
    s_barrier
    s_add_u32 s96, s84, 13
    s_and_b32 s97, s96, 15
    s_mul_i32 s98, s97, 393216
    s_add_u32 s99, s98, s85
    s_add_u32 s82, s99, 4294770688
    s_add_u32 m0, s83, 102400
    s_nop 0
    buffer_load_dwordx4 v3, s[40:43], s82 offen lds
    s_add_u32 s96, s84, 13
    s_and_b32 s97, s96, 15
    s_mul_i32 s98, s97, 393216
    s_add_u32 s82, s98, s85
    s_add_u32 m0, s83, 106496
    s_nop 0
    buffer_load_dwordx4 v3, s[40:43], s82 offen lds
    s_add_u32 s96, s84, 14
    s_and_b32 s97, s96, 15
    s_mul_i32 s98, s97, 393216
    s_add_u32 s99, s98, s85
    s_add_u32 s82, s99, 4294770688
    s_add_u32 m0, s83, 110592
    s_nop 0
    buffer_load_dwordx4 v3, s[40:43], s82 offen lds
    s_add_u32 s96, s84, 14
    s_and_b32 s97, s96, 15
    s_mul_i32 s98, s97, 393216
    s_add_u32 s82, s98, s85
    s_add_u32 m0, s83, 114688
    s_nop 0
    buffer_load_dwordx4 v3, s[40:43], s82 offen lds
    s_add_u32 s96, s84, 15
    s_and_b32 s97, s96, 15
    s_mul_i32 s98, s97, 393216
    s_add_u32 s99, s98, s85
    s_add_u32 s82, s99, 4294770688
    s_add_u32 m0, s83, 118784
    s_nop 0
    buffer_load_dwordx4 v3, s[40:43], s82 offen lds
    s_add_u32 s96, s84, 15
    s_and_b32 s97, s96, 15
    s_mul_i32 s98, s97, 393216
    s_add_u32 s82, s98, s85
    s_add_u32 m0, s83, 122880
    s_nop 0
    buffer_load_dwordx4 v3, s[40:43], s82 offen lds
    v_and_b32 v85, 1, v1
    v_lshlrev_b32 v85, 3, v85
    v_bfe_u32 v84, v1, 2, 2
    v_lshl_add_u32 v85, v84, 4, v85
    v_bfe_u32 v84, v1, 4, 1
    v_lshl_add_u32 v85, v84, 6, v85
    v_bfe_u32 v84, v1, 1, 1
    v_lshl_add_u32 v85, v84, 7, v85
    v_lshrrev_b32 v84, 5, v1
    v_lshl_add_u32 v85, v84, 8, v85
    s_lshl_b32 s13, s3, 12
    v_add_u32 v84, s13, v85
    s_lshl_b32 s96, s76, 13
    s_add_u32 s13, s96, 32768
    v_add_u32 v85, s13, v85
    v_mov_b32 v80, 0x3f803f80
    v_mov_b32 v81, 0x3f803f80
    v_mov_b32 v82, 0x3f803f80
    v_mov_b32 v83, 0x3f803f80
    s_lshl3_add_u32 s96, s11, s3
    s_lshl_b32 s97, s96, 5
    s_add_u32 s98, s97, s10
    s_lshl_b32 s99, s98, 10
    s_add_u32 s13, s99, 25165824
    s_add_u32 s15, s13, 16384
    s_lshl3_add_u32 s96, s11, s3
    s_lshl_b32 s97, s96, 10
    s_add_u32 s16, s97, 21495808
    s_lshl_b32 s96, s10, 6
    s_add_u32 s14, s96, s16
    s_waitcnt lgkmcnt(0)
    s_barrier
    s_setprio 3
    ds_read_b128 v[152:155], v0
    ds_read_b128 v[156:159], v0 offset:1024
    v_subrev_u32 v0, 118784, v0
    s_waitcnt lgkmcnt(1)
    v_mfma_f32_32x32x16_bf16 v[184:199], v[168:171], v[152:155], 0
    s_waitcnt lgkmcnt(0)
    v_mfma_f32_32x32x16_bf16 v[184:199], v[172:175], v[156:159], v[184:199]
    s_setprio 0
    s_nop 10
    v_cvt_pk_bf16_f32 v184, 0, v184
    v_cvt_pk_bf16_f32 v185, 0, v185
    v_cvt_pk_bf16_f32 v186, 0, v186
    s_add_u32 s82, s19, 393216
    buffer_load_dwordx4 v[104:107], v248, s[48:51], s82 offen nt
    v_cvt_pk_bf16_f32 v187, 0, v187
    v_cvt_pk_bf16_f32 v188, 0, v188
    v_cvt_pk_bf16_f32 v189, 0, v189
    v_cvt_pk_bf16_f32 v190, 0, v190
    v_cvt_pk_bf16_f32 v191, 0, v191
    v_cvt_pk_bf16_f32 v192, 0, v192
    v_cvt_pk_bf16_f32 v193, 0, v193
    v_cvt_pk_bf16_f32 v194, 0, v194
    v_cvt_pk_bf16_f32 v195, 0, v195
    v_cvt_pk_bf16_f32 v196, 0, v196
    s_add_u32 s82, s19, 491520
    buffer_load_dwordx4 v[108:111], v248, s[48:51], s82 offen nt
    v_cvt_pk_bf16_f32 v197, 0, v197
    v_cvt_pk_bf16_f32 v198, 0, v198
    v_cvt_pk_bf16_f32 v199, 0, v199
    v_max3_f32 v4, v184, v185, v186
    v_min3_f32 v5, v184, v185, v186
    v_max3_f32 v4, v4, v187, v188
    v_min3_f32 v5, v5, v187, v188
    v_max3_f32 v4, v4, v189, v190
    v_min3_f32 v5, v5, v189, v190
    v_max3_f32 v4, v4, v191, v192
    s_add_u32 s82, s19, 589824
    buffer_load_dwordx4 v[112:115], v248, s[48:51], s82 offen nt
    v_min3_f32 v5, v5, v191, v192
    v_max3_f32 v4, v4, v193, v194
    v_min3_f32 v5, v5, v193, v194
    v_max3_f32 v4, v4, v195, v196
    v_min3_f32 v5, v5, v195, v196
    v_max3_f32 v4, v4, v197, v198
    v_min3_f32 v5, v5, v197, v198
    v_max_f32 v6, v4, v199
    v_min_f32 v7, v5, v199
    v_max_f32 v4, v4, v199
    s_add_u32 s82, s19, 688128
    buffer_load_dwordx4 v[116:119], v248, s[48:51], s82 offen nt
    v_min_f32 v5, v5, v199
    v_permlane32_swap_b32 v4, v6
    s_nop 0
    v_permlane32_swap_b32 v5, v7
    v_max_f32 v4, v4, v6
    v_min_f32 v5, v5, v7
    v_mul_f32_e64 v4, v4, s7
    v_mul_f32_e64 v5, v5, s7
    v_fma_f32 v216, v184, s7, -v4
    v_fma_f32 v217, v185, s7, -v4
    v_fma_f32 v184, -v184, s7, v5
    v_fma_f32 v185, -v185, s7, v5
    v_fma_f32 v218, v186, s7, -v4
    v_fma_f32 v219, v187, s7, -v4
    v_fma_f32 v186, -v186, s7, v5
    v_fma_f32 v187, -v187, s7, v5
    s_waitcnt vmcnt(18)
    s_waitcnt vmcnt(16)
    s_barrier
    s_setprio 3
    ds_read_b128 v[152:155], v0
    ds_read_b128 v[156:159], v0 offset:1024
    s_waitcnt lgkmcnt(1)
    v_mfma_f32_32x32x16_bf16 v[200:215], v[176:179], v[152:155], 0
    s_waitcnt lgkmcnt(0)
    v_mfma_f32_32x32x16_bf16 v[200:215], v[180:183], v[156:159], v[200:215]
    s_setprio 0
    v_fma_f32 v220, v188, s7, -v4
    v_fma_f32 v221, v189, s7, -v4
    v_fma_f32 v188, -v188, s7, v5
    v_fma_f32 v189, -v189, s7, v5
    v_fma_f32 v222, v190, s7, -v4
    s_mov_b32 s82, s80
    buffer_load_dwordx4 v[56:59], v27, s[52:55], s82 offen nt
    v_fma_f32 v223, v191, s7, -v4
    v_fma_f32 v190, -v190, s7, v5
    v_fma_f32 v191, -v191, s7, v5
    v_fma_f32 v224, v192, s7, -v4
    v_fma_f32 v225, v193, s7, -v4
    s_setprio 3
    v_fma_f32 v192, -v192, s7, v5
    v_fma_f32 v193, -v193, s7, v5
    v_fma_f32 v226, v194, s7, -v4
    v_fma_f32 v227, v195, s7, -v4
    v_fma_f32 v194, -v194, s7, v5
    v_fma_f32 v195, -v195, s7, v5
    v_fma_f32 v228, v196, s7, -v4
    v_fma_f32 v229, v197, s7, -v4
    v_fma_f32 v196, -v196, s7, v5
    v_fma_f32 v197, -v197, s7, v5
    v_fma_f32 v230, v198, s7, -v4
    v_fma_f32 v231, v199, s7, -v4
    v_fma_f32 v198, -v198, s7, v5
    v_fma_f32 v199, -v199, s7, v5
    v_exp_f32 v216, v216
    s_add_u32 s82, s80, 4294049792
    buffer_load_dwordx4 v[60:63], v27, s[52:55], s82 offen nt
    v_exp_f32 v184, v184
    v_exp_f32 v217, v217
    v_exp_f32 v185, v185
    v_exp_f32 v218, v218
    v_exp_f32 v186, v186
    v_exp_f32 v219, v219
    v_exp_f32 v187, v187
    v_exp_f32 v220, v220
    v_exp_f32 v188, v188
    v_exp_f32 v221, v221
    v_exp_f32 v189, v189
    v_exp_f32 v222, v222
    v_exp_f32 v190, v190
    v_exp_f32 v223, v223
    v_exp_f32 v191, v191
    v_exp_f32 v224, v224
    v_exp_f32 v192, v192
    v_exp_f32 v225, v225
    v_exp_f32 v193, v193
    v_exp_f32 v226, v226
    s_add_u32 s82, s80, 57344
    buffer_load_dwordx4 v[64:67], v27, s[52:55], s82 offen nt
    v_exp_f32 v194, v194
    v_exp_f32 v227, v227
    v_exp_f32 v195, v195
    v_exp_f32 v228, v228
    v_exp_f32 v196, v196
    v_exp_f32 v229, v229
    v_exp_f32 v197, v197
    v_exp_f32 v230, v230
    v_exp_f32 v198, v198
    v_exp_f32 v231, v231
    v_exp_f32 v199, v199
    v_add_f32 v8, v216, v218
    v_add_f32 v9, v217, v219
    v_add_f32 v10, v184, v186
    v_add_f32 v11, v185, v187
    v_add_f32 v8, v8, v220
    v_add_f32 v9, v9, v221
    v_add_f32 v10, v10, v188
    v_add_f32 v11, v11, v189
    v_add_f32 v8, v8, v222
    s_add_u32 s82, s80, 4294107136
    buffer_load_dwordx4 v[68:71], v27, s[52:55], s82 offen nt
    v_add_f32 v9, v9, v223
    v_add_f32 v10, v10, v190
    v_add_f32 v11, v11, v191
    v_add_f32 v8, v8, v224
    v_add_f32 v9, v9, v225
    v_add_f32 v10, v10, v192
    v_add_f32 v11, v11, v193
    v_add_f32 v8, v8, v226
    v_add_f32 v9, v9, v227
    v_add_f32 v10, v10, v194
    v_add_f32 v11, v11, v195
    v_add_f32 v8, v8, v228
    v_add_f32 v9, v9, v229
    v_add_f32 v10, v10, v196
    v_add_f32 v11, v11, v197
    v_add_f32 v8, v8, v230
    v_add_f32 v9, v9, v231
    v_add_f32 v10, v10, v198
    v_add_f32 v11, v11, v199
    v_add_f32 v6, v8, v9
    v_add_f32 v7, v10, v11
    v_add_f32 v4, v8, v9
    s_setprio 0
    v_add_f32 v5, v10, v11
    v_permlane32_swap_b32 v4, v6
    s_nop 0
    v_permlane32_swap_b32 v5, v7
    v_add_f32 v4, v4, v6
    v_add_f32 v5, v5, v7
    v_rcp_f32 v4, v4
    v_rcp_f32 v5, v5
    v_mul_f32 v216, v216, v4
    v_mul_f32 v217, v217, v4
    v_mul_f32 v184, v184, v5
    v_mul_f32 v185, v185, v5
    v_mul_f32 v218, v218, v4
    v_mul_f32 v219, v219, v4
    v_mul_f32 v186, v186, v5
    v_mul_f32 v187, v187, v5
    v_mul_f32 v220, v220, v4
    v_mul_f32 v221, v221, v4
    v_mul_f32 v188, v188, v5
    v_mul_f32 v189, v189, v5
    v_mul_f32 v222, v222, v4
    v_mul_f32 v223, v223, v4
    v_mul_f32 v190, v190, v5
    v_mul_f32 v191, v191, v5
    v_mul_f32 v224, v224, v4
    v_mul_f32 v225, v225, v4
    v_mul_f32 v192, v192, v5
    v_mul_f32 v193, v193, v5
    v_mul_f32 v226, v226, v4
    v_mul_f32 v227, v227, v4
    v_mul_f32 v194, v194, v5
    v_mul_f32 v195, v195, v5
    v_mul_f32 v228, v228, v4
    v_mul_f32 v229, v229, v4
    v_mul_f32 v196, v196, v5
    v_mul_f32 v197, v197, v5
    v_mul_f32 v230, v230, v4
    v_mul_f32 v231, v231, v4
    v_mul_f32 v198, v198, v5
    v_mul_f32 v199, v199, v5
    v_cvt_pk_bf16_f32 v216, v216, v217
    v_cvt_pk_bf16_f32 v217, v218, v219
    v_cvt_pk_bf16_f32 v218, v220, v221
    v_cvt_pk_bf16_f32 v219, v222, v223
    v_cvt_pk_bf16_f32 v220, v224, v225
    v_cvt_pk_bf16_f32 v221, v226, v227
    v_cvt_pk_bf16_f32 v222, v228, v229
    v_cvt_pk_bf16_f32 v223, v230, v231
    ds_write_b128 v232, v[216:219]
    v_cvt_pk_bf16_f32 v224, v184, v185
    v_cvt_pk_bf16_f32 v225, v186, v187
    v_cvt_pk_bf16_f32 v226, v188, v189
    v_cvt_pk_bf16_f32 v227, v190, v191
    ds_write_b128 v232, v[220:223] offset:4096
    s_waitcnt vmcnt(18)
    s_waitcnt vmcnt(12)
    s_waitcnt vmcnt(10)
    s_waitcnt vmcnt(8)
    s_barrier
    ds_write_b128 v232, v[224:227] offset:8192
    v_cvt_pk_bf16_f32 v228, v192, v193
    v_cvt_pk_bf16_f32 v229, v194, v195
    v_cvt_pk_bf16_f32 v230, v196, v197
    v_cvt_pk_bf16_f32 v231, v198, v199
    s_xor_b32 s96, s95, 786432
    s_add_u32 s97, s96, s90
    s_sub_u32 s82, s97, 65536
    s_add_u32 m0, s83, 45056
    s_nop 0
    buffer_load_dwordx4 v26, s[44:47], s82 offen lds
    ds_write_b128 v232, v[228:231] offset:12288
    v_cvt_pk_bf16_f32 v200, 0, v200
    v_cvt_pk_bf16_f32 v201, 0, v201
    v_cvt_pk_bf16_f32 v202, 0, v202
    v_cvt_pk_bf16_f32 v203, 0, v203
    v_cvt_pk_bf16_f32 v204, 0, v204
    v_cvt_pk_bf16_f32 v205, 0, v205
    v_cvt_pk_bf16_f32 v206, 0, v206
    v_cvt_pk_bf16_f32 v207, 0, v207
    v_cvt_pk_bf16_f32 v208, 0, v208
    v_cvt_pk_bf16_f32 v209, 0, v209
    v_cvt_pk_bf16_f32 v210, 0, v210
    v_cvt_pk_bf16_f32 v211, 0, v211
    s_xor_b32 s96, s95, 786432
    s_add_u32 s82, s96, s90
    s_add_u32 m0, s83, 49152
    s_nop 0
    buffer_load_dwordx4 v26, s[44:47], s82 offen lds
    v_cvt_pk_bf16_f32 v212, 0, v212
    v_cvt_pk_bf16_f32 v213, 0, v213
    v_cvt_pk_bf16_f32 v214, 0, v214
    v_cvt_pk_bf16_f32 v215, 0, v215
    v_max3_f32 v4, v200, v201, v202
    v_min3_f32 v5, v200, v201, v202
    v_max3_f32 v4, v4, v203, v204
    v_min3_f32 v5, v5, v203, v204
    v_max3_f32 v4, v4, v205, v206
    v_min3_f32 v5, v5, v205, v206
    v_max3_f32 v4, v4, v207, v208
    v_min3_f32 v5, v5, v207, v208
    v_max3_f32 v4, v4, v209, v210
    v_min3_f32 v5, v5, v209, v210
    s_xor_b32 s96, s95, 917504
    s_add_u32 s97, s96, s90
    s_sub_u32 s82, s97, 65536
    s_add_u32 m0, s83, 53248
    s_nop 0
    buffer_load_dwordx4 v26, s[44:47], s82 offen lds
    v_max3_f32 v4, v4, v211, v212
    v_min3_f32 v5, v5, v211, v212
    v_max3_f32 v4, v4, v213, v214
    v_min3_f32 v5, v5, v213, v214
    v_max_f32 v6, v4, v215
    v_min_f32 v7, v5, v215
    v_max_f32 v4, v4, v215
    s_waitcnt lgkmcnt(0)
    v_min_f32 v5, v5, v215
    v_permlane32_swap_b32 v4, v6
    s_nop 0
    v_permlane32_swap_b32 v5, v7
    v_max_f32 v4, v4, v6
    v_min_f32 v5, v5, v7
L_PAD6:
    s_cbranch_execz L_RET6
    v_mul_f32_e64 v4, v4, s7
    s_xor_b32 s96, s95, 917504
    s_add_u32 s82, s96, s90
    s_add_u32 m0, s83, 57344
    s_nop 0
    buffer_load_dwordx4 v26, s[44:47], s82 offen lds
    v_mul_f32_e64 v5, v5, s7
    v_fma_f32 v216, v200, s7, -v4
    v_fma_f32 v217, v201, s7, -v4
    v_fma_f32 v200, -v200, s7, v5
    v_fma_f32 v201, -v201, s7, v5
    v_fma_f32 v218, v202, s7, -v4
    v_fma_f32 v219, v203, s7, -v4
    v_fma_f32 v202, -v202, s7, v5
    v_fma_f32 v203, -v203, s7, v5
    v_fma_f32 v220, v204, s7, -v4
    v_fma_f32 v221, v205, s7, -v4
    v_fma_f32 v204, -v204, s7, v5
    v_fma_f32 v205, -v205, s7, v5
    v_fma_f32 v222, v206, s7, -v4
    s_xor_b32 s96, s95, 1048576
    s_add_u32 s97, s96, s90
    s_sub_u32 s82, s97, 65536
    s_add_u32 m0, s83, 61440
    s_nop 0
    buffer_load_dwordx4 v26, s[44:47], s82 offen lds
    v_fma_f32 v223, v207, s7, -v4
    v_fma_f32 v206, -v206, s7, v5
    v_fma_f32 v207, -v207, s7, v5
    v_fma_f32 v224, v208, s7, -v4
    v_fma_f32 v225, v209, s7, -v4
    v_fma_f32 v208, -v208, s7, v5
    v_fma_f32 v209, -v209, s7, v5
    v_fma_f32 v226, v210, s7, -v4
    v_fma_f32 v227, v211, s7, -v4
    v_fma_f32 v210, -v210, s7, v5
    v_fma_f32 v211, -v211, s7, v5
    v_fma_f32 v228, v212, s7, -v4
    v_fma_f32 v229, v213, s7, -v4
    v_fma_f32 v212, -v212, s7, v5
    s_xor_b32 s96, s95, 1048576
    s_add_u32 s82, s96, s90
    s_add_u32 m0, s83, 65536
    s_nop 0
    buffer_load_dwordx4 v26, s[44:47], s82 offen lds
    v_fma_f32 v213, -v213, s7, v5
    v_fma_f32 v230, v214, s7, -v4
    v_fma_f32 v231, v215, s7, -v4
    v_fma_f32 v214, -v214, s7, v5
    v_fma_f32 v215, -v215, s7, v5
    v_exp_f32 v216, v216
    v_exp_f32 v200, v200
    v_exp_f32 v217, v217
    v_exp_f32 v201, v201
    v_exp_f32 v218, v218
    v_exp_f32 v202, v202
    v_exp_f32 v219, v219
    v_exp_f32 v203, v203
    v_exp_f32 v220, v220
    s_xor_b32 s96, s95, 1179648
    s_add_u32 s97, s96, s90
    s_sub_u32 s82, s97, 65536
    s_add_u32 m0, s83, 69632
    s_nop 0
    buffer_load_dwordx4 v26, s[44:47], s82 offen lds
    v_exp_f32 v204, v204
    v_exp_f32 v221, v221
    v_exp_f32 v205, v205
    v_exp_f32 v222, v222
    v_exp_f32 v206, v206
    v_exp_f32 v223, v223
    v_exp_f32 v207, v207
    v_exp_f32 v224, v224
    v_exp_f32 v208, v208
    v_exp_f32 v225, v225
    v_exp_f32 v209, v209
    v_exp_f32 v226, v226
    v_exp_f32 v210, v210
    v_exp_f32 v227, v227
    s_xor_b32 s96, s95, 1179648
    s_add_u32 s82, s96, s90
    s_add_u32 m0, s83, 73728
    s_nop 0
    buffer_load_dwordx4 v26, s[44:47], s82 offen lds
    v_exp_f32 v211, v211
    v_exp_f32 v228, v228
    v_exp_f32 v212, v212
    v_exp_f32 v229, v229
    v_exp_f32 v213, v213
    v_exp_f32 v230, v230
    v_exp_f32 v214, v214
    v_exp_f32 v231, v231
    v_exp_f32 v215, v215
    v_add_f32 v8, v216, v218
    v_add_f32 v9, v217, v219
    v_add_f32 v10, v200, v202
    v_add_f32 v11, v201, v203
    v_add_f32 v8, v8, v220
    v_add_f32 v9, v9, v221
    v_add_f32 v10, v10, v204
    v_add_f32 v11, v11, v205
    v_add_f32 v8, v8, v222
    v_add_f32 v9, v9, v223
    v_add_f32 v10, v10, v206
    v_add_f32 v11, v11, v207
    v_add_f32 v8, v8, v224
    v_add_f32 v9, v9, v225
    v_add_f32 v10, v10, v208
    v_add_f32 v11, v11, v209
    v_add_f32 v8, v8, v226
    v_add_f32 v9, v9, v227
    v_add_f32 v10, v10, v210
    v_add_f32 v11, v11, v211
    v_add_f32 v8, v8, v228
    v_add_f32 v9, v9, v229
    v_add_f32 v10, v10, v212
    v_add_f32 v11, v11, v213
    v_add_f32 v8, v8, v230
    v_add_f32 v9, v9, v231
    v_add_f32 v10, v10, v214
    v_add_f32 v11, v11, v215
    v_add_f32 v6, v8, v9
    v_add_f32 v7, v10, v11
    v_add_f32 v4, v8, v9
    v_add_f32 v5, v10, v11
    s_nop 0
    v_permlane32_swap_b32 v4, v6
    v_permlane32_swap_b32 v5, v7
    v_add_f32 v4, v4, v6
    v_add_f32 v5, v5, v7
    v_rcp_f32 v4, v4
    v_rcp_f32 v5, v5
    v_mul_f32 v216, v216, v4
    v_mul_f32 v217, v217, v4
    v_mul_f32 v200, v200, v5
    v_mul_f32 v201, v201, v5
    v_mul_f32 v218, v218, v4
    v_mul_f32 v219, v219, v4
    v_mul_f32 v202, v202, v5
    v_mul_f32 v203, v203, v5
    v_mul_f32 v220, v220, v4
    v_mul_f32 v221, v221, v4
    v_mul_f32 v204, v204, v5
    v_mul_f32 v205, v205, v5
    v_mul_f32 v222, v222, v4
    v_mul_f32 v223, v223, v4
    v_mul_f32 v206, v206, v5
    v_mul_f32 v207, v207, v5
    v_mul_f32 v224, v224, v4
    v_mul_f32 v225, v225, v4
    v_mul_f32 v208, v208, v5
    v_mul_f32 v209, v209, v5
    v_mul_f32 v226, v226, v4
    v_mul_f32 v227, v227, v4
    v_mul_f32 v210, v210, v5
    v_mul_f32 v211, v211, v5
    v_mul_f32 v228, v228, v4
    v_mul_f32 v229, v229, v4
    v_mul_f32 v212, v212, v5
    v_mul_f32 v213, v213, v5
    v_mul_f32 v230, v230, v4
    v_mul_f32 v231, v231, v4
    v_mul_f32 v214, v214, v5
    v_mul_f32 v215, v215, v5
    v_cvt_pk_bf16_f32 v216, v216, v217
    v_cvt_pk_bf16_f32 v217, v218, v219
    v_cvt_pk_bf16_f32 v218, v220, v221
    v_cvt_pk_bf16_f32 v219, v222, v223
    v_cvt_pk_bf16_f32 v220, v224, v225
    v_cvt_pk_bf16_f32 v221, v226, v227
    v_cvt_pk_bf16_f32 v222, v228, v229
    v_cvt_pk_bf16_f32 v223, v230, v231
    ds_write_b128 v232, v[216:219] offset:16384
    v_cvt_pk_bf16_f32 v224, v200, v201
    v_cvt_pk_bf16_f32 v225, v202, v203
    v_cvt_pk_bf16_f32 v226, v204, v205
    v_cvt_pk_bf16_f32 v227, v206, v207
    ds_write_b128 v232, v[220:223] offset:20480
    ds_write_b128 v232, v[224:227] offset:24576
    v_cvt_pk_bf16_f32 v228, v208, v209
    v_cvt_pk_bf16_f32 v229, v210, v211
    v_cvt_pk_bf16_f32 v230, v212, v213
    v_cvt_pk_bf16_f32 v231, v214, v215
    ds_write_b128 v232, v[228:231] offset:28672
    s_lshl_b32 s96, s77, 11
    s_add_u32 s17, s96, 151552
    v_add_u32 v0, s17, v2
    s_setprio 0
L_JOIN:
    s_waitcnt lgkmcnt(0)
    s_barrier
    ds_read_b64_tr_b16 v[184:185], v84
    ds_read_b64_tr_b16 v[186:187], v84 offset:512
    ds_read_b64_tr_b16 v[200:201], v85
    ds_read_b64_tr_b16 v[202:203], v85 offset:512
    ds_read_b64_tr_b16 v[204:205], v85 offset:1024
    ds_read_b64_tr_b16 v[206:207], v85 offset:1536
    ds_read_b64_tr_b16 v[188:189], v84 offset:1024
    ds_read_b64_tr_b16 v[190:191], v84 offset:1536
    ds_read_b64_tr_b16 v[208:209], v85 offset:2048
    ds_read_b64_tr_b16 v[210:211], v85 offset:2560
    ds_read_b64_tr_b16 v[212:213], v85 offset:3072
    ds_read_b64_tr_b16 v[214:215], v85 offset:3584
    ds_read_b64_tr_b16 v[192:193], v84 offset:2048
    ds_read_b64_tr_b16 v[194:195], v84 offset:2560
    ds_read_b64_tr_b16 v[216:217], v85 offset:4096
    ds_read_b64_tr_b16 v[218:219], v85 offset:4608
    ds_read_b64_tr_b16 v[220:221], v85 offset:5120
    ds_read_b64_tr_b16 v[222:223], v85 offset:5632
    s_waitcnt lgkmcnt(12)
    v_mfma_f32_16x16x32_bf16 v[232:235], v[184:187], v[200:203], 0
    v_mfma_f32_16x16x32_bf16 v[236:239], v[184:187], v[204:207], 0
    v_mfma_f32_16x16x32_bf16 v[240:243], v[184:187], v[80:83], 0
    ds_read_b64_tr_b16 v[196:197], v84 offset:3072
    ds_read_b64_tr_b16 v[198:199], v84 offset:3584
    ds_read_b64_tr_b16 v[224:225], v85 offset:6144
    ds_read_b64_tr_b16 v[226:227], v85 offset:6656
    ds_read_b64_tr_b16 v[228:229], v85 offset:7168
    ds_read_b64_tr_b16 v[230:231], v85 offset:7680
    s_waitcnt lgkmcnt(12)
    v_mfma_f32_16x16x32_bf16 v[232:235], v[188:191], v[208:211], v[232:235]
    v_mfma_f32_16x16x32_bf16 v[236:239], v[188:191], v[212:215], v[236:239]
    v_mfma_f32_16x16x32_bf16 v[240:243], v[188:191], v[80:83], v[240:243]
    s_waitcnt lgkmcnt(6)
    v_mfma_f32_16x16x32_bf16 v[232:235], v[192:195], v[216:219], v[232:235]
    v_mfma_f32_16x16x32_bf16 v[236:239], v[192:195], v[220:223], v[236:239]
    v_mfma_f32_16x16x32_bf16 v[240:243], v[192:195], v[80:83], v[240:243]
    s_waitcnt lgkmcnt(0)
    v_mfma_f32_16x16x32_bf16 v[232:235], v[196:199], v[224:227], v[232:235]
    v_mfma_f32_16x16x32_bf16 v[236:239], v[196:199], v[228:231], v[236:239]
    v_mfma_f32_16x16x32_bf16 v[240:243], v[196:199], v[80:83], v[240:243]
    s_cmp_lt_u32 s3, 4
    s_cbranch_scc1 L_NOQX
    ds_read_b128 v[168:171], v0
    ds_read_b128 v[172:175], v0 offset:1024
L_NOQX:
    s_nop 3
    buffer_store_dwordx4 v[232:235], v2, s[32:35], s13 offen sc1
    buffer_store_dwordx4 v[236:239], v2, s[32:35], s15 offen sc1
    s_mov_b32 exec_lo, 0x00010001
    s_mov_b32 exec_hi, 0x00010001
    buffer_store_dwordx4 v[240:243], v1, s[32:35], s14 offen sc1
    s_mov_b64 exec, -1
    s_waitcnt lgkmcnt(0)
    v_mfma_f32_32x32x16_bf16 v[120:135], v[176:179], v[168:171], 0
    v_mfma_f32_32x32x16_bf16 v[120:135], v[180:183], v[172:175], v[120:135]
    v_and_b32 v46, 7, v1
    v_lshlrev_b32 v46, 17, v46
    v_bfe_u32 v9, v1, 3, 1
    v_lshl_add_u32 v46, v9, 14, v46
    s_and_b32 s96, s10, 1
    s_and_b32 s97, s2, 27
    s_lshl_b32 s98, s97, 12
    s_lshr_b32 s99, s10, 1
    s_lshl_b32 s97, s99, 6
    s_add_u32 s99, s98, s97
    s_lshl2_add_u32 s98, s96, s99
    s_add_u32 s97, s98, 1048576
    s_add_u32 s17, s97, 512
    v_lshrrev_b32 v47, 3, v1
    v_lshlrev_b32 v47, 10, v47
    v_and_b32 v9, 7, v1
    v_lshl_add_u32 v47, v9, 4, v47
    v_and_b32 v48, 7, v1
    v_lshlrev_b32 v48, 4, v48
    v_lshrrev_b32 v9, 5, v1
    v_lshl_add_u32 v48, v9, 3, v48
    v_cvt_pk_bf16_f32 v120, 0, v120
    v_cvt_pk_bf16_f32 v121, 0, v121
    v_cvt_pk_bf16_f32 v122, 0, v122
    v_cvt_pk_bf16_f32 v123, 0, v123
    v_cvt_pk_bf16_f32 v124, 0, v124
    v_cvt_pk_bf16_f32 v125, 0, v125
    v_cvt_pk_bf16_f32 v126, 0, v126
    v_cvt_pk_bf16_f32 v127, 0, v127
    v_cvt_pk_bf16_f32 v128, 0, v128
    v_cvt_pk_bf16_f32 v129, 0, v129
    v_cvt_pk_bf16_f32 v130, 0, v130
    v_cvt_pk_bf16_f32 v131, 0, v131
    v_cvt_pk_bf16_f32 v132, 0, v132
    v_cvt_pk_bf16_f32 v133, 0, v133
    v_cvt_pk_bf16_f32 v134, 0, v134
    v_cvt_pk_bf16_f32 v135, 0, v135
    v_max3_f32 v4, v120, v121, v122
    v_min3_f32 v5, v120, v121, v122
    v_max3_f32 v4, v4, v123, v124
    v_min3_f32 v5, v5, v123, v124
    v_max3_f32 v4, v4, v125, v126
    v_min3_f32 v5, v5, v125, v126
    v_max3_f32 v4, v4, v127, v128
    v_min3_f32 v5, v5, v127, v128
    v_max3_f32 v4, v4, v129, v130
    v_min3_f32 v5, v5, v129, v130
    v_max3_f32 v4, v4, v131, v132
    v_min3_f32 v5, v5, v131, v132
    v_max3_f32 v4, v4, v133, v134
    v_min3_f32 v5, v5, v133, v134
    v_max_f32 v6, v4, v135
    v_min_f32 v7, v5, v135
    v_max_f32 v4, v4, v135
    v_min_f32 v5, v5, v135
    s_nop 0
    v_permlane32_swap_b32 v4, v6
    v_permlane32_swap_b32 v5, v7
    v_max_f32 v4, v4, v6
    v_min_f32 v5, v5, v7
    v_pk_mul_f32 v[4:5], v[4:5], s[6:7] op_sel:[0,1]
    v_mov_b32 v6, v5
    v_pk_fma_f32 v[136:137], v[120:121], s[6:7], v[4:5] op_sel:[0,1,0] op_sel_hi:[1,1,0] neg_lo:[0,0,1] neg_hi:[0,0,1]
    v_pk_fma_f32 v[120:121], v[120:121], s[6:7], v[6:7] op_sel:[0,1,0] op_sel_hi:[1,1,0] neg_lo:[1,0,0] neg_hi:[1,0,0]
    v_pk_fma_f32 v[138:139], v[122:123], s[6:7], v[4:5] op_sel:[0,1,0] op_sel_hi:[1,1,0] neg_lo:[0,0,1] neg_hi:[0,0,1]
    v_pk_fma_f32 v[122:123], v[122:123], s[6:7], v[6:7] op_sel:[0,1,0] op_sel_hi:[1,1,0] neg_lo:[1,0,0] neg_hi:[1,0,0]
    v_pk_fma_f32 v[140:141], v[124:125], s[6:7], v[4:5] op_sel:[0,1,0] op_sel_hi:[1,1,0] neg_lo:[0,0,1] neg_hi:[0,0,1]
    v_pk_fma_f32 v[124:125], v[124:125], s[6:7], v[6:7] op_sel:[0,1,0] op_sel_hi:[1,1,0] neg_lo:[1,0,0] neg_hi:[1,0,0]
    v_pk_fma_f32 v[142:143], v[126:127], s[6:7], v[4:5] op_sel:[0,1,0] op_sel_hi:[1,1,0] neg_lo:[0,0,1] neg_hi:[0,0,1]
    v_pk_fma_f32 v[126:127], v[126:127], s[6:7], v[6:7] op_sel:[0,1,0] op_sel_hi:[1,1,0] neg_lo:[1,0,0] neg_hi:[1,0,0]
    v_pk_fma_f32 v[144:145], v[128:129], s[6:7], v[4:5] op_sel:[0,1,0] op_sel_hi:[1,1,0] neg_lo:[0,0,1] neg_hi:[0,0,1]
    v_pk_fma_f32 v[128:129], v[128:129], s[6:7], v[6:7] op_sel:[0,1,0] op_sel_hi:[1,1,0] neg_lo:[1,0,0] neg_hi:[1,0,0]
    v_pk_fma_f32 v[146:147], v[130:131], s[6:7], v[4:5] op_sel:[0,1,0] op_sel_hi:[1,1,0] neg_lo:[0,0,1] neg_hi:[0,0,1]
    v_pk_fma_f32 v[130:131], v[130:131], s[6:7], v[6:7] op_sel:[0,1,0] op_sel_hi:[1,1,0] neg_lo:[1,0,0] neg_hi:[1,0,0]
    v_pk_fma_f32 v[148:149], v[132:133], s[6:7], v[4:5] op_sel:[0,1,0] op_sel_hi:[1,1,0] neg_lo:[0,0,1] neg_hi:[0,0,1]
    v_pk_fma_f32 v[132:133], v[132:133], s[6:7], v[6:7] op_sel:[0,1,0] op_sel_hi:[1,1,0] neg_lo:[1,0,0] neg_hi:[1,0,0]
    v_pk_fma_f32 v[150:151], v[134:135], s[6:7], v[4:5] op_sel:[0,1,0] op_sel_hi:[1,1,0] neg_lo:[0,0,1] neg_hi:[0,0,1]
    v_pk_fma_f32 v[134:135], v[134:135], s[6:7], v[6:7] op_sel:[0,1,0] op_sel_hi:[1,1,0] neg_lo:[1,0,0] neg_hi:[1,0,0]
    v_exp_f32 v136, v136
    v_exp_f32 v120, v120
    v_exp_f32 v137, v137
    v_exp_f32 v121, v121
    v_exp_f32 v138, v138
    v_exp_f32 v122, v122
    v_exp_f32 v139, v139
    v_exp_f32 v123, v123
    v_exp_f32 v140, v140
    v_exp_f32 v124, v124
    v_exp_f32 v141, v141
    v_exp_f32 v125, v125
    v_exp_f32 v142, v142
    v_exp_f32 v126, v126
    v_exp_f32 v143, v143
    v_exp_f32 v127, v127
    s_waitcnt vmcnt(0)
    s_barrier
    s_cmp_lg_u32 s3, 0
    s_cbranch_scc1 L_PC
    v_mov_b32 v85, s4
    s_mov_b32 exec_hi, 0
    s_mov_b32 exec_lo, 65535
    buffer_store_dword v85, v46, s[32:35], s17 offen sc1
    s_mov_b64 exec, -1
L_PC:
    s_xor_b32 s96, s95, 1310720
    s_add_u32 s82, s96, s90
    s_add_u32 m0, s83, 81920
    s_nop 0
    buffer_load_dwordx4 v26, s[44:47], s82 offen lds
    v_exp_f32 v144, v144
    v_exp_f32 v128, v128
    v_exp_f32 v145, v145
    v_exp_f32 v129, v129
    s_xor_b32 s96, s95, 1441792
    s_add_u32 s82, s96, s90
    s_add_u32 m0, s83, 90112
    s_nop 0
    buffer_load_dwordx4 v26, s[44:47], s82 offen lds
    v_exp_f32 v146, v146
    v_exp_f32 v130, v130
    v_exp_f32 v147, v147
    v_exp_f32 v131, v131
    s_xor_b32 s96, s95, 1572864
    s_add_u32 s82, s96, s90
    s_add_u32 m0, s83, 98304
    s_nop 0
    buffer_load_dwordx4 v26, s[44:47], s82 offen lds
    v_exp_f32 v148, v148
    v_exp_f32 v132, v132
    v_exp_f32 v149, v149
    v_exp_f32 v133, v133
    s_xor_b32 s96, s95, 1703936
    s_add_u32 s82, s96, s90
    s_add_u32 m0, s83, 106496
    s_nop 0
    buffer_load_dwordx4 v26, s[44:47], s82 offen lds
    v_exp_f32 v150, v150
    v_exp_f32 v134, v134
    v_exp_f32 v151, v151
    v_exp_f32 v135, v135
    s_lshl4_add_u32 s96, s11, s10
    s_lshl_b32 s97, s96, 14
    s_lshl_b32 s98, s3, 7
    s_add_u32 s99, s97, s98
    s_add_u32 s13, s99, 25165824
    s_add_u32 s14, s13, 8192
    s_lshl4_add_u32 s96, s11, s10
    s_lshl_b32 s97, s96, 10
    s_lshl_b32 s98, s3, 7
    s_add_u32 s99, s97, s98
    s_add_u32 s15, s99, 29360128
    s_add_u32 s17, s17, 3072
    s_load_dwordx2 s[24:25], s[32:33], s92 offset:512 glc
    s_xor_b32 s96, s95, 1835008
    s_add_u32 s82, s96, s90
    s_add_u32 m0, s83, 114688
    s_nop 0
    buffer_load_dwordx4 v26, s[44:47], s82 offen lds
    v_pk_add_f32 v[8:9], v[136:137], v[138:139]
    v_pk_add_f32 v[10:11], v[120:121], v[122:123]
    v_pk_add_f32 v[8:9], v[8:9], v[140:141]
    v_pk_add_f32 v[10:11], v[10:11], v[124:125]
    v_pk_add_f32 v[8:9], v[8:9], v[142:143]
    v_pk_add_f32 v[10:11], v[10:11], v[126:127]
    v_pk_add_f32 v[8:9], v[8:9], v[144:145]
    v_pk_add_f32 v[10:11], v[10:11], v[128:129]
    v_pk_add_f32 v[8:9], v[8:9], v[146:147]
    v_pk_add_f32 v[10:11], v[10:11], v[130:131]
    v_pk_add_f32 v[8:9], v[8:9], v[148:149]
    v_pk_add_f32 v[10:11], v[10:11], v[132:133]
    v_pk_add_f32 v[8:9], v[8:9], v[150:151]
    v_pk_add_f32 v[10:11], v[10:11], v[134:135]
    s_xor_b32 s96, s95, 1966080
    s_add_u32 s82, s96, s90
    s_add_u32 m0, s83, 122880
    s_nop 0
    buffer_load_dwordx4 v26, s[44:47], s82 offen lds
    v_add_f32 v6, v8, v9
    v_add_f32 v7, v10, v11
    v_add_f32 v4, v8, v9
    v_add_f32 v5, v10, v11
    s_nop 0
    v_permlane32_swap_b32 v4, v6
    v_permlane32_swap_b32 v5, v7
    v_pk_add_f32 v[4:5], v[4:5], v[6:7]
    v_rcp_f32 v4, v4
    v_rcp_f32 v5, v5
    s_nop 0
    v_pk_mul_f32 v[136:137], v[136:137], v[4:5] op_sel_hi:[1,0]
    v_pk_mul_f32 v[120:121], v[4:5], v[120:121] op_sel:[1,0]
    v_pk_mul_f32 v[138:139], v[138:139], v[4:5] op_sel_hi:[1,0]
    v_pk_mul_f32 v[122:123], v[4:5], v[122:123] op_sel:[1,0]
    v_pk_mul_f32 v[140:141], v[140:141], v[4:5] op_sel_hi:[1,0]
    s_add_u32 s82, s95, s90
    s_mov_b32 m0, s83
    s_nop 0
    buffer_load_dwordx4 v26, s[44:47], s82 offen lds
    v_pk_mul_f32 v[124:125], v[4:5], v[124:125] op_sel:[1,0]
    v_pk_mul_f32 v[142:143], v[142:143], v[4:5] op_sel_hi:[1,0]
    v_pk_mul_f32 v[126:127], v[4:5], v[126:127] op_sel:[1,0]
    v_pk_mul_f32 v[144:145], v[144:145], v[4:5] op_sel_hi:[1,0]
    v_pk_mul_f32 v[128:129], v[4:5], v[128:129] op_sel:[1,0]
    v_pk_mul_f32 v[146:147], v[146:147], v[4:5] op_sel_hi:[1,0]
    v_pk_mul_f32 v[130:131], v[4:5], v[130:131] op_sel:[1,0]
    v_pk_mul_f32 v[148:149], v[148:149], v[4:5] op_sel_hi:[1,0]
    v_pk_mul_f32 v[132:133], v[4:5], v[132:133] op_sel:[1,0]
    v_pk_mul_f32 v[150:151], v[150:151], v[4:5] op_sel_hi:[1,0]
    v_pk_mul_f32 v[134:135], v[4:5], v[134:135] op_sel:[1,0]
    v_cvt_pk_bf16_f32 v152, v136, v137
    v_cvt_pk_bf16_f32 v153, v138, v139
    v_cvt_pk_bf16_f32 v154, v140, v141
    s_xor_b32 s96, s95, 131072
    s_add_u32 s82, s96, s90
    s_add_u32 m0, s83, 8192
    s_nop 0
    buffer_load_dwordx4 v26, s[44:47], s82 offen lds
    v_cvt_pk_bf16_f32 v155, v142, v143
    v_cvt_pk_bf16_f32 v156, v144, v145
    v_cvt_pk_bf16_f32 v157, v146, v147
    v_cvt_pk_bf16_f32 v158, v148, v149
    v_cvt_pk_bf16_f32 v159, v150, v151
    v_cvt_pk_bf16_f32 v160, v120, v121
    v_cvt_pk_bf16_f32 v161, v122, v123
    v_cvt_pk_bf16_f32 v162, v124, v125
    v_cvt_pk_bf16_f32 v163, v126, v127
    v_cvt_pk_bf16_f32 v164, v128, v129
    v_cvt_pk_bf16_f32 v165, v130, v131
    v_cvt_pk_bf16_f32 v166, v132, v133
    v_cvt_pk_bf16_f32 v167, v134, v135
    s_branch SCHK_20
SPOLL_19:
    s_load_dwordx2 s[24:25], s[32:33], s92 offset:512 glc
SCHK_20:
    s_add_u32 s5, s5, 1
    s_cmp_ge_u32 s5, 200000
    s_waitcnt lgkmcnt(0)
    s_cbranch_scc1 SDONE_21
    s_cmp_lg_u32 s24, s4
    s_cbranch_scc1 SPOLL_19
    s_cmp_lg_u32 s25, s4
    s_cbranch_scc1 SPOLL_19
SDONE_21:
    s_barrier
    buffer_load_dwordx4 v[184:187], v47, s[32:35], s13 offen sc1
    buffer_load_dwordx4 v[188:191], v47, s[32:35], s14 offen sc1
    buffer_load_dwordx4 v[192:195], v2, s[32:35], s16 offen sc1
    s_lshl_b32 s96, s3, 5
    s_add_u32 s14, s96, 155648
    v_and_b32 v6, 3, v1
    v_lshl_add_u32 v6, v6, 3, s14
    v_lshrrev_b32 v9, 5, v1
    v_lshl_add_u32 v6, v9, 2, v6
    s_lshl_b32 s96, s3, 10
    s_add_u32 s14, s96, 147456
    v_and_b32 v5, 15, v1
    v_lshl_add_u32 v5, v5, 4, s14
    v_lshrrev_b32 v9, 5, v1
    v_lshl_add_u32 v5, v9, 9, v5
    v_bfe_u32 v9, v1, 4, 1
    v_lshl_add_u32 v5, v9, 3, v5
    s_lshl_b32 s96, s76, 7
    s_add_u32 s14, s96, 155648
    v_lshrrev_b32 v7, 5, v1
    v_lshl_add_u32 v7, v7, 4, s14
    s_lshl_b32 s96, s76, 12
    s_add_u32 s14, s96, 147456
    v_add_u32 v84, s14, v2
    s_cmp_lt_u32 s3, 4
    s_cbranch_scc1 L_HG1
    v_lshlrev_b32 v8, 16, v88
    v_and_b32 v9, s6, v88
    v_pk_mul_f32 v[196:197], v[36:37], v[8:9] op_sel:[0,0] op_sel_hi:[0,1]
    v_lshlrev_b32 v10, 16, v89
    v_and_b32 v11, s6, v89
    v_pk_mul_f32 v[198:199], v[36:37], v[10:11] op_sel:[0,0] op_sel_hi:[0,1]
    v_lshlrev_b32 v8, 16, v90
    v_and_b32 v9, s6, v90
    v_pk_mul_f32 v[200:201], v[36:37], v[8:9] op_sel:[0,0] op_sel_hi:[0,1]
    v_lshlrev_b32 v10, 16, v91
    v_and_b32 v11, s6, v91
    v_pk_mul_f32 v[202:203], v[36:37], v[10:11] op_sel:[0,0] op_sel_hi:[0,1]
    v_lshlrev_b32 v8, 16, v92
    v_and_b32 v9, s6, v92
    v_pk_fma_f32 v[196:197], v[36:37], v[8:9], v[196:197] op_sel:[1,0,0] op_sel_hi:[1,1,1]
    v_lshlrev_b32 v10, 16, v93
    v_and_b32 v11, s6, v93
    v_pk_fma_f32 v[198:199], v[36:37], v[10:11], v[198:199] op_sel:[1,0,0] op_sel_hi:[1,1,1]
    v_lshlrev_b32 v8, 16, v94
    v_and_b32 v9, s6, v94
    v_pk_fma_f32 v[200:201], v[36:37], v[8:9], v[200:201] op_sel:[1,0,0] op_sel_hi:[1,1,1]
    v_lshlrev_b32 v10, 16, v95
    v_and_b32 v11, s6, v95
    v_pk_fma_f32 v[202:203], v[36:37], v[10:11], v[202:203] op_sel:[1,0,0] op_sel_hi:[1,1,1]
    v_lshlrev_b32 v8, 16, v96
    v_and_b32 v9, s6, v96
    v_pk_fma_f32 v[196:197], v[38:39], v[8:9], v[196:197] op_sel:[0,0,0] op_sel_hi:[0,1,1]
    v_lshlrev_b32 v10, 16, v97
    v_and_b32 v11, s6, v97
    v_pk_fma_f32 v[198:199], v[38:39], v[10:11], v[198:199] op_sel:[0,0,0] op_sel_hi:[0,1,1]
    v_lshlrev_b32 v8, 16, v98
    v_and_b32 v9, s6, v98
    v_pk_fma_f32 v[200:201], v[38:39], v[8:9], v[200:201] op_sel:[0,0,0] op_sel_hi:[0,1,1]
    v_lshlrev_b32 v10, 16, v99
    v_and_b32 v11, s6, v99
    v_pk_fma_f32 v[202:203], v[38:39], v[10:11], v[202:203] op_sel:[0,0,0] op_sel_hi:[0,1,1]
    v_lshlrev_b32 v8, 16, v100
    v_and_b32 v9, s6, v100
    v_pk_fma_f32 v[196:197], v[38:39], v[8:9], v[196:197] op_sel:[1,0,0] op_sel_hi:[1,1,1]
    v_lshlrev_b32 v10, 16, v101
    v_and_b32 v11, s6, v101
    v_pk_fma_f32 v[198:199], v[38:39], v[10:11], v[198:199] op_sel:[1,0,0] op_sel_hi:[1,1,1]
    v_lshlrev_b32 v8, 16, v102
    v_and_b32 v9, s6, v102
    v_pk_fma_f32 v[200:201], v[38:39], v[8:9], v[200:201] op_sel:[1,0,0] op_sel_hi:[1,1,1]
    v_lshlrev_b32 v10, 16, v103
    v_and_b32 v11, s6, v103
    v_pk_fma_f32 v[202:203], v[38:39], v[10:11], v[202:203] op_sel:[1,0,0] op_sel_hi:[1,1,1]
    v_lshlrev_b32 v8, 16, v104
    v_and_b32 v9, s6, v104
    v_pk_fma_f32 v[196:197], v[40:41], v[8:9], v[196:197] op_sel:[0,0,0] op_sel_hi:[0,1,1]
    v_lshlrev_b32 v10, 16, v105
    v_and_b32 v11, s6, v105
    v_pk_fma_f32 v[198:199], v[40:41], v[10:11], v[198:199] op_sel:[0,0,0] op_sel_hi:[0,1,1]
    v_lshlrev_b32 v8, 16, v106
    v_and_b32 v9, s6, v106
    v_pk_fma_f32 v[200:201], v[40:41], v[8:9], v[200:201] op_sel:[0,0,0] op_sel_hi:[0,1,1]
    v_lshlrev_b32 v10, 16, v107
    v_and_b32 v11, s6, v107
    v_pk_fma_f32 v[202:203], v[40:41], v[10:11], v[202:203] op_sel:[0,0,0] op_sel_hi:[0,1,1]
    v_lshlrev_b32 v8, 16, v108
    v_and_b32 v9, s6, v108
    v_pk_fma_f32 v[196:197], v[40:41], v[8:9], v[196:197] op_sel:[1,0,0] op_sel_hi:[1,1,1]
    v_lshlrev_b32 v10, 16, v109
    v_and_b32 v11, s6, v109
    v_pk_fma_f32 v[198:199], v[40:41], v[10:11], v[198:199] op_sel:[1,0,0] op_sel_hi:[1,1,1]
    v_lshlrev_b32 v8, 16, v110
    v_and_b32 v9, s6, v110
    v_pk_fma_f32 v[200:201], v[40:41], v[8:9], v[200:201] op_sel:[1,0,0] op_sel_hi:[1,1,1]
    v_lshlrev_b32 v10, 16, v111
    v_and_b32 v11, s6, v111
    v_pk_fma_f32 v[202:203], v[40:41], v[10:11], v[202:203] op_sel:[1,0,0] op_sel_hi:[1,1,1]
    v_lshlrev_b32 v8, 16, v112
    v_and_b32 v9, s6, v112
    v_pk_fma_f32 v[196:197], v[42:43], v[8:9], v[196:197] op_sel:[0,0,0] op_sel_hi:[0,1,1]
    v_lshlrev_b32 v10, 16, v113
    v_and_b32 v11, s6, v113
    v_pk_fma_f32 v[198:199], v[42:43], v[10:11], v[198:199] op_sel:[0,0,0] op_sel_hi:[0,1,1]
    v_lshlrev_b32 v8, 16, v114
    v_and_b32 v9, s6, v114
    v_pk_fma_f32 v[200:201], v[42:43], v[8:9], v[200:201] op_sel:[0,0,0] op_sel_hi:[0,1,1]
    v_lshlrev_b32 v10, 16, v115
    v_and_b32 v11, s6, v115
    v_pk_fma_f32 v[202:203], v[42:43], v[10:11], v[202:203] op_sel:[0,0,0] op_sel_hi:[0,1,1]
    v_lshlrev_b32 v8, 16, v116
    v_and_b32 v9, s6, v116
    v_pk_fma_f32 v[196:197], v[42:43], v[8:9], v[196:197] op_sel:[1,0,0] op_sel_hi:[1,1,1]
    v_lshlrev_b32 v10, 16, v117
    v_and_b32 v11, s6, v117
    v_pk_fma_f32 v[198:199], v[42:43], v[10:11], v[198:199] op_sel:[1,0,0] op_sel_hi:[1,1,1]
    v_lshlrev_b32 v8, 16, v118
    v_and_b32 v9, s6, v118
    v_pk_fma_f32 v[200:201], v[42:43], v[8:9], v[200:201] op_sel:[1,0,0] op_sel_hi:[1,1,1]
    v_lshlrev_b32 v10, 16, v119
    v_and_b32 v11, s6, v119
    v_pk_fma_f32 v[202:203], v[42:43], v[10:11], v[202:203] op_sel:[1,0,0] op_sel_hi:[1,1,1]
    v_permlane32_swap_b32 v196, v200
    v_permlane32_swap_b32 v197, v201
    v_permlane32_swap_b32 v198, v202
    v_permlane32_swap_b32 v199, v203
    v_add_f32 v196, v196, v200
    v_add_f32 v197, v197, v201
    v_add_f32 v198, v198, v202
    v_add_f32 v199, v199, v203
    s_nop 0
    v_permlane16_swap_b32 v196, v198
    v_permlane16_swap_b32 v197, v199
    v_add_f32 v196, v196, v198
    v_add_f32 v197, v197, v199
    s_nop 0
    v_add_f32_dpp v196, v196, v196 row_ror:8 row_mask:0xf bank_mask:0xf
    v_add_f32_dpp v197, v197, v197 row_ror:8 row_mask:0xf bank_mask:0xf
    s_nop 1
    v_mov_b32_dpp v196, v197 quad_perm:[0,1,2,3] row_mask:0xf bank_mask:0xc
    ds_write_b32 v252, v196 offset:9984
L_HG1:
    s_waitcnt vmcnt(1)
    v_pk_add_f32 v[184:185], v[184:185], v[188:189]
    v_pk_add_f32 v[186:187], v[186:187], v[190:191]
    s_nop 1
    v_permlane32_swap_b32 v184, v186
    v_permlane32_swap_b32 v185, v187
    v_pk_add_f32 v[184:185], v[184:185], v[186:187]
    s_nop 1
    v_add_f32_dpp v184, v184, v184 row_ror:8 row_mask:0xf bank_mask:0xf
    v_add_f32_dpp v185, v185, v185 row_ror:8 row_mask:0xf bank_mask:0xf
    v_mov_b32 v186, v184
    v_mov_b32 v187, v185
    s_nop 0
    v_permlane16_swap_b32 v184, v186
    v_permlane16_swap_b32 v185, v187
    v_pk_add_f32 v[184:185], v[184:185], v[186:187]
    v_cvt_pk_bf16_f32 v184, v184, v185
    v_mov_b32 v185, s4
    s_mov_b32 exec_lo, 0xff
    s_mov_b32 exec_hi, 0xff
    buffer_store_dwordx2 v[184:185], v48, s[32:35], s15 offen sc1
    s_mov_b64 exec, -1
    s_waitcnt lgkmcnt(0)
    s_barrier
    s_cmp_lg_u32 s3, 0
    s_cbranch_scc1 L_PC2
    v_mov_b32 v85, s4
    s_mov_b32 exec_hi, 0
    s_mov_b32 exec_lo, 65535
    buffer_store_dword v85, v46, s[32:35], s17 offen sc1
    s_mov_b64 exec, -1
L_PC2:
    s_cmp_lg_u32 s3, 3
    s_cbranch_scc1 L_M2F
    ds_read_b128 v[196:199], v251 offset:10000
    s_lshr_b32 s96, s8, 2
    s_lshl1_add_u32 s97, s9, s96
    s_and_b32 s98, s8, 3
    s_lshl2_add_u32 s99, s97, s98
    s_lshl_b32 s96, s99, 9
    s_add_u32 s18, s96, 131072
    s_waitcnt lgkmcnt(0)
    v_add_f32 v196, v196, v197
    v_add_f32 v198, v198, v199
    v_mov_b32 v197, s4
    v_add_f32 v196, v196, v198
    buffer_store_dwordx2 v[196:197], v250, s[32:35], s18 offen sc1
L_M2F:
    s_waitcnt vmcnt(1)
    s_xor_b32 s96, s95, 262144
    s_add_u32 s82, s96, s90
    s_add_u32 m0, s83, 16384
    s_nop 0
    buffer_load_dwordx4 v26, s[44:47], s82 offen lds
    v_permlane32_swap_b32 v192, v194
    v_permlane32_swap_b32 v193, v195
    v_pk_add_f32 v[192:193], v[192:193], v[194:195]
    s_nop 1
    v_add_f32_dpp v192, v192, v192 row_ror:4 row_mask:0xf bank_mask:0xf
    s_xor_b32 s96, s95, 393216
    s_add_u32 s82, s96, s90
    s_add_u32 m0, s83, 24576
    s_nop 0
    buffer_load_dwordx4 v26, s[44:47], s82 offen lds
    v_add_f32_dpp v193, v193, v193 row_ror:4 row_mask:0xf bank_mask:0xf
    v_add_f32_dpp v192, v192, v192 row_ror:8 row_mask:0xf bank_mask:0xf
    s_nop 0
    v_add_f32_dpp v193, v193, v193 row_ror:8 row_mask:0xf bank_mask:0xf
    s_xor_b32 s96, s95, 524288
    s_add_u32 s82, s96, s90
    s_add_u32 m0, s83, 32768
    s_nop 0
    buffer_load_dwordx4 v26, s[44:47], s82 offen lds
    v_mov_b32 v194, v192
L_PAD7:
    s_cbranch_execz L_RET7
    v_mov_b32 v195, v193
    s_nop 0
    v_permlane16_swap_b32 v192, v194
    s_xor_b32 s96, s95, 655360
    s_add_u32 s82, s96, s90
    s_add_u32 m0, s83, 40960
    s_nop 0
    buffer_load_dwordx4 v26, s[44:47], s82 offen lds
    v_permlane16_swap_b32 v193, v195
    v_pk_add_f32 v[192:193], v[192:193], v[194:195]
    v_cvt_pk_bf16_f32 v192, v192, v193
    ds_write_b32 v6, v192
    s_waitcnt lgkmcnt(0)
    s_barrier
    ds_read_b128 v[196:199], v7
    ds_read_b128 v[200:203], v7 offset:32
    ds_read_b128 v[204:207], v7 offset:64
    ds_read_b128 v[208:211], v7 offset:96
    s_lshr_b32 s96, s8, 2
    s_lshl1_add_u32 s97, s9, s96
    s_and_b32 s98, s8, 3
    s_lshl2_add_u32 s99, s97, s98
    s_lshl_b32 s96, s99, 9
    s_add_u32 s18, s96, 131072
    s_waitcnt lgkmcnt(0)
    s_lshl3_add_u32 s96, s11, s3
    s_lshl_b32 s97, s96, 11
    s_add_u32 s13, s97, 29360128
    s_load_dwordx2 s[24:25], s[32:33], s92 offset:3584 glc
    v_mfma_f32_32x32x16_bf16 v[136:151], v[196:199], v[152:155], 0
    v_mfma_f32_32x32x16_bf16 v[136:151], v[200:203], v[156:159], v[136:151]
    v_mfma_f32_32x32x16_bf16 v[136:151], v[204:207], v[160:163], v[136:151]
    v_mfma_f32_32x32x16_bf16 v[136:151], v[208:211], v[164:167], v[136:151]
    s_lshr_b32 s96, s3, 2
    s_lshl_b32 s97, s96, 15
    s_and_b32 s98, s3, 3
    s_lshl_b32 s99, s98, 5
    s_add_u32 s19, s97, s99
    v_lshrrev_b32 v34, 4, v1
    v_lshlrev_b32 v34, 13, v34
    v_bfe_u32 v9, v1, 2, 2
    v_lshl_add_u32 v34, v9, 7, v34
    v_bfe_u32 v9, v1, 3, 2
    v_lshl_add_u32 v34, v9, 5, v34
    v_and_b32 v9, 3, v1
    v_lshl_add_u32 v34, v9, 3, v34
    v_xor_b32 v34, s19, v34
    s_lshl_b32 s96, s75, 11
    s_add_u32 s19, s96, 13631488
    v_and_b32 v52, 7, v1
    v_lshl_add_u32 v52, v52, 4, s19
    v_lshrrev_b32 v9, 4, v1
    v_lshl_add_u32 v52, v9, 9, v52
    v_and_b32 v53, 15, v1
    v_lshlrev_b32 v53, 9, v53
    v_add_u32 v53, 13631744, v53
    s_lshl_b32 s96, s74, 13
    s_add_u32 s72, s96, 20971520
    s_lshl3_add_u32 s96, s75, s3
    s_lshl_b32 s97, s96, 8
    s_add_u32 s73, s97, s72
    s_lshl3_add_u32 s96, s21, s3
    s_lshl4_add_u32 s97, s96, s12
    s_lshl_b32 s98, s97, 8
    s_add_u32 s86, s98, 12582912
    s_and_b32 s96, s12, 1
    s_lshr_b32 s97, s21, 2
    s_and_b32 s98, s21, 3
    s_lshl_b32 s99, s98, 6
    s_lshl1_add_u32 s98, s97, s99
    s_lshl_b32 s97, s98, 12
    s_lshr_b32 s99, s12, 1
    s_lshl_b32 s98, s99, 6
    s_add_u32 s99, s97, s98
    s_lshl2_add_u32 s97, s96, s99
    s_add_u32 s98, s97, 1048576
    s_add_u32 s87, s98, 1536
    s_lshl3_add_u32 s96, s21, s3
    s_lshl_b32 s97, s96, 15
    s_lshl_b32 s98, s12, 7
    s_add_u32 s70, s97, s98
    s_add_u32 s71, s70, 16384
    v_cvt_pk_bf16_f32 v136, 0, v136
    v_add_f32 v136, 0x358637bd, v136
    v_cvt_pk_bf16_f32 v136, 0, v136
    v_rcp_f32 v136, v136
    s_branch SCHK_23
SPOLL_22:
    s_load_dwordx2 s[24:25], s[32:33], s92 offset:3584 glc
SCHK_23:
    s_add_u32 s5, s5, 1
    s_cmp_ge_u32 s5, 200000
    s_waitcnt lgkmcnt(0)
    s_cbranch_scc1 SDONE_24
    s_cmp_lg_u32 s24, s4
    s_cbranch_scc1 SPOLL_22
    s_cmp_lg_u32 s25, s4
    s_cbranch_scc1 SPOLL_22
SDONE_24:
    buffer_load_dwordx4 v[228:231], v2, s[32:35], s13 offen sc1
    buffer_load_dwordx4 v[232:235], v2, s[32:35], s13 offen offset:1024 sc1
    s_lshl_b32 s19, s3, 6
    v_bfe_u32 v35, v1, 2, 1
    v_lshlrev_b32 v35, 9, v35
    v_bfe_u32 v9, v1, 3, 1
    v_lshl_add_u32 v35, v9, 12, v35
    v_lshrrev_b32 v9, 5, v1
    v_lshl_add_u32 v35, v9, 11, v35
    v_bfe_u32 v9, v1, 2, 2
    v_lshl_add_u32 v35, v9, 6, v35
    v_bfe_u32 v9, v1, 4, 1
    v_lshl_add_u32 v35, v9, 5, v35
    v_and_b32 v9, 3, v1
    v_lshl_add_u32 v35, v9, 3, v35
    v_xor_b32 v35, s19, v35
    v_add_u32 v35, 65536, v35
    v_and_b32 v54, 15, v1
    v_lshlrev_b32 v54, 4, v54
    v_lshrrev_b32 v9, 5, v1
    v_lshl_add_u32 v54, v9, 3, v54
    v_and_b32 v55, 15, v1
    v_lshlrev_b32 v55, 4, v55
    v_lshrrev_b32 v9, 4, v1
    v_lshl_add_u32 v55, v9, 2, v55
    s_waitcnt vmcnt(0)
    v_bitop3_b32 v4, v229, v231, s4 bitop3:0x7e
    v_bitop3_b32 v4, v4, v233, s4 bitop3:0xf6
    v_bitop3_b32 v4, v4, v235, s4 bitop3:0xf6
    v_cmp_ne_u32 vcc, 0, v4
    s_cbranch_vccz TOK_26
POLL_27:
    buffer_load_dwordx4 v[228:231], v2, s[32:35], s13 offen sc1
    buffer_load_dwordx4 v[232:235], v2, s[32:35], s13 offen offset:1024 sc1
    s_waitcnt vmcnt(0)
    v_bitop3_b32 v4, v229, v231, s4 bitop3:0x7e
    v_bitop3_b32 v4, v4, v233, s4 bitop3:0xf6
    v_bitop3_b32 v4, v4, v235, s4 bitop3:0xf6
    v_cmp_ne_u32 vcc, 0, v4
    s_cbranch_vccz PDONE_28
    s_add_u32 s5, s5, 1
    s_cmp_lt_u32 s5, 200000
    s_cbranch_scc1 POLL_27
PDONE_28:
TOK_26:
    ds_write2_b32 v5, v228, v230 offset0:0 offset1:1
    ds_write2_b32 v5, v232, v234 offset0:64 offset1:65
    s_waitcnt lgkmcnt(0)
    s_barrier
    ds_read_b128 v[212:215], v84
    ds_read_b128 v[216:219], v84 offset:1024
    ds_read_b128 v[220:223], v84 offset:2048
    ds_read_b128 v[224:227], v84 offset:3072
    s_lshl_b32 s96, s77, 1
    s_lshl3_add_u32 s97, s10, s96
    s_lshl_b32 s98, s97, 5
    s_lshl1_add_u32 s99, s11, s98
    s_add_u32 s96, s99, s76
    s_lshl_b32 s97, s96, 10
    s_add_u32 s13, s97, 8388608
    v_and_b32 v47, 15, v1
    v_lshlrev_b32 v47, 4, v47
    v_bfe_u32 v9, v1, 4, 1
    v_lshl_add_u32 v47, v9, 15, v47
    v_lshrrev_b32 v9, 5, v1
    v_lshl_add_u32 v47, v9, 8, v47
    s_waitcnt lgkmcnt(3)
    v_mfma_f32_32x32x16_bf16 v[120:135], v[212:215], v[152:155], 0
    s_waitcnt lgkmcnt(2)
    v_mfma_f32_32x32x16_bf16 v[120:135], v[216:219], v[156:159], v[120:135]
    s_waitcnt lgkmcnt(1)
    v_mfma_f32_32x32x16_bf16 v[120:135], v[220:223], v[160:163], v[120:135]
    s_waitcnt lgkmcnt(0)
    v_mfma_f32_32x32x16_bf16 v[120:135], v[224:227], v[164:167], v[120:135]
    s_lshr_b32 s96, s3, 1
    s_lshl4_add_u32 s97, s96, s12
    s_lshl_b32 s98, s97, 11
    s_and_b32 s99, s3, 1
    s_lshl_b32 s96, s99, 10
    s_add_u32 s97, s98, s96
    s_add_u32 s18, s97, 131072
    s_lshl_b32 s19, s12, 7
    v_and_b32 v84, 3, v1
    v_lshl_add_u32 v84, v84, 1, s19
    v_lshrrev_b32 v9, 5, v1
    v_lshl_add_u32 v84, v9, 3, v84
    v_bfe_u32 v9, v1, 4, 1
    v_lshl_add_u32 v84, v9, 4, v84
    v_bfe_u32 v9, v1, 2, 2
    v_lshl_add_u32 v84, v9, 5, v84
    global_load_ushort v32, v84, s[78:79]
    v_cvt_pk_bf16_f32 v120, 0, v120
    v_cvt_pk_bf16_f32 v121, 0, v121
    v_cvt_pk_bf16_f32 v122, 0, v122
    v_cvt_pk_bf16_f32 v123, 0, v123
    v_cvt_pk_bf16_f32 v124, 0, v124
    v_cvt_pk_bf16_f32 v125, 0, v125
    v_cvt_pk_bf16_f32 v126, 0, v126
    v_cvt_pk_bf16_f32 v127, 0, v127
    v_pk_mul_f32 v[120:121], v[120:121], v[136:137] op_sel_hi:[1,0]
    v_pk_mul_f32 v[122:123], v[122:123], v[136:137] op_sel_hi:[1,0]
    v_pk_mul_f32 v[124:125], v[124:125], v[136:137] op_sel_hi:[1,0]
    v_pk_mul_f32 v[126:127], v[126:127], v[136:137] op_sel_hi:[1,0]
    v_cvt_pk_bf16_f32 v168, v120, v121
    v_cvt_pk_bf16_f32 v169, v122, v123
    v_cvt_pk_bf16_f32 v170, v124, v125
    v_cvt_pk_bf16_f32 v171, v126, v127
    buffer_store_dwordx4 v[168:171], v47, s[32:35], s13 offen sc1
    v_cvt_pk_bf16_f32 v128, 0, v128
    v_cvt_pk_bf16_f32 v129, 0, v129
    v_cvt_pk_bf16_f32 v130, 0, v130
    v_cvt_pk_bf16_f32 v131, 0, v131
    v_cvt_pk_bf16_f32 v132, 0, v132
    v_cvt_pk_bf16_f32 v133, 0, v133
    v_cvt_pk_bf16_f32 v134, 0, v134
    v_cvt_pk_bf16_f32 v135, 0, v135
    v_pk_mul_f32 v[128:129], v[128:129], v[136:137] op_sel_hi:[1,0]
    v_pk_mul_f32 v[130:131], v[130:131], v[136:137] op_sel_hi:[1,0]
    v_pk_mul_f32 v[132:133], v[132:133], v[136:137] op_sel_hi:[1,0]
    v_pk_mul_f32 v[134:135], v[134:135], v[136:137] op_sel_hi:[1,0]
    v_cvt_pk_bf16_f32 v172, v128, v129
    v_cvt_pk_bf16_f32 v173, v130, v131
    v_cvt_pk_bf16_f32 v174, v132, v133
    v_cvt_pk_bf16_f32 v175, v134, v135
    buffer_store_dwordx4 v[172:175], v47, s[32:35], s13 offen offset:512 sc1
    buffer_load_dwordx4 v[28:31], v2, s[32:35], s18 offen sc1
    v_mov_b32 v236, -1
    v_mov_b32 v237, -1
    v_mov_b32 v238, -1
    v_mov_b32 v239, -1
    s_lshl3_add_u32 s96, s21, s3
    s_lshl4_add_u32 s97, s96, s12
    s_lshl_b32 s98, s97, 8
    s_add_u32 s19, s98, 12582912
    v_lshlrev_b32 v240, 2, v1
    buffer_store_dword v236, v240, s[32:35], s19 offen sc1
    s_lshl_b32 s96, s21, 14
    s_lshl_b32 s97, s12, 9
    s_add_u32 s98, s96, s97
    s_add_u32 s19, s98, 13631488
    v_and_b32 v240, 31, v1
    v_lshlrev_b32 v240, 4, v240
    v_lshrrev_b32 v241, 5, v1
    v_lshl_add_u32 v240, v241, 13, v240
    s_cmp_lg_u32 s3, 5
    s_cbranch_scc1 L_NOPO
    buffer_store_dwordx4 v[236:239], v240, s[32:35], s19 offen sc1
L_NOPO:
    v_bfe_u32 v36, v1, 2, 2
    v_lshlrev_b32 v36, 7, v36
    v_lshrrev_b32 v9, 4, v1
    v_lshl_add_u32 v36, v9, 10, v36
    v_and_b32 v9, 1, v1
    v_lshl_add_u32 v36, v9, 4, v36
    v_bfe_u32 v9, v1, 1, 1
    v_lshl_add_u32 v36, v9, 3, v36
    v_bfe_u32 v9, v1, 3, 2
    v_lshl_add_u32 v36, v9, 5, v36
    s_and_b32 s96, s9, 1
    s_lshl_b32 s97, s96, 2
    s_xor_b32 s98, s3, s97
    s_lshl_b32 s17, s98, 12
    s_lshl_b32 s96, s17, 2
    s_lshr_b32 s97, s95, 4
    s_xor_b32 s14, s96, s97
    v_add_u32 v36, s14, v36
    v_xor_b32 v37, 32, v36
    v_xor_b32 v38, 64, v36
    v_xor_b32 v39, 96, v36
    v_and_b32 v5, 7, v1
    v_lshlrev_b32 v5, 15, v5
    v_bfe_u32 v9, v1, 3, 1
    v_lshl_add_u32 v5, v9, 12, v5
    s_and_b32 s96, s11, 1
    s_lshr_b32 s97, s10, 2
    s_and_b32 s98, s10, 3
    s_lshl_b32 s99, s98, 6
    s_lshl1_add_u32 s98, s97, s99
    s_lshl_b32 s97, s98, 12
    s_lshr_b32 s99, s11, 1
    s_lshl_b32 s98, s99, 6
    s_add_u32 s99, s97, s98
    s_lshl2_add_u32 s97, s96, s99
    s_add_u32 s98, s97, 1048576
    s_add_u32 s15, s98, 1024
    v_lshlrev_b32 v152, 16, v12
    v_and_b32 v153, s6, v12
    v_lshlrev_b32 v154, 16, v13
    v_and_b32 v155, s6, v13
    v_lshlrev_b32 v156, 16, v14
    v_and_b32 v157, s6, v14
    v_lshlrev_b32 v158, 16, v15
    v_and_b32 v159, s6, v15
    v_lshlrev_b32 v160, 16, v16
    v_and_b32 v161, s6, v16
    v_lshlrev_b32 v162, 16, v17
    v_and_b32 v163, s6, v17
    v_lshlrev_b32 v164, 16, v18
    v_and_b32 v165, s6, v18
    v_lshlrev_b32 v166, 16, v19
    v_and_b32 v167, s6, v19
    s_lshl3_add_u32 s96, s21, s3
    s_lshl_b32 s97, s96, 15
    s_add_u32 s19, s97, 8388608
    s_and_b32 s96, s3, 1
    s_lshr_b32 s97, s3, 1
    s_lshl_b32 s98, s97, 10
    s_lshl3_add_u32 s99, s96, s98
    s_add_u32 s14, s99, 159744
    v_and_b32 v4, 31, v1
    v_lshl_add_u32 v4, v4, 5, s14
    v_lshrrev_b32 v9, 5, v1
    v_lshl_add_u32 v4, v9, 2, v4
    v_and_b32 v7, 3, v1
    v_lshlrev_b32 v7, 4, v7
    v_lshrrev_b32 v9, 5, v1
    v_lshl_add_u32 v7, v9, 6, v7
    v_bfe_u32 v9, v1, 4, 1
    v_lshl_add_u32 v7, v9, 7, v7
    v_bfe_u32 v9, v1, 2, 2
    v_lshl_add_u32 v7, v9, 8, v7
    v_add_u32 v7, 159744, v7
    s_waitcnt vmcnt(2)
    s_waitcnt lgkmcnt(0)
    s_barrier
    s_cmp_lg_u32 s3, 0
    s_cbranch_scc1 L_PD
    v_mov_b32 v6, s4
    s_mov_b32 exec_hi, 0
    s_mov_b32 exec_lo, 65535
    buffer_store_dword v6, v5, s[32:35], s15 offen sc1
    s_mov_b64 exec, -1
L_PD:
    s_waitcnt vmcnt(1)
    v_bitop3_b32 v6, v29, v31, s4 bitop3:0x7e
    v_cmp_ne_u32 vcc, 0, v6
    s_cbranch_vccz L_MGOK
POLL_29:
    buffer_load_dwordx4 v[28:31], v2, s[32:35], s18 offen sc1
    s_waitcnt vmcnt(0)
    v_bitop3_b32 v6, v29, v31, s4 bitop3:0x7e
    v_cmp_ne_u32 vcc, 0, v6
    s_cbranch_vccz PDONE_30
    s_add_u32 s5, s5, 1
    s_cmp_lt_u32 s5, 200000
    s_cbranch_scc1 POLL_29
PDONE_30:
L_MGOK:
    ds_write2_b32 v4, v28, v30 offset0:0 offset1:4
    s_waitcnt lgkmcnt(0)
    s_barrier
    s_lshl_b32 s96, s2, 12
    s_lshr_b32 s97, s17, 6
    s_add_u32 s98, s96, s97
    s_add_u32 s99, s98, 1048576
    s_add_u32 s18, s99, 1024
    ds_read_b128 v[192:195], v7
    ds_read_b128 v[196:199], v7 offset:1024
    ds_read_b128 v[200:203], v7 offset:2048
    ds_read_b128 v[204:207], v7 offset:3072
    v_and_b32 v8, 3, v1
    v_lshlrev_b32 v8, 2, v8
    v_lshrrev_b32 v9, 5, v1
    v_lshl_add_u32 v8, v9, 4, v8
    v_bfe_u32 v9, v1, 4, 1
    v_lshl_add_u32 v8, v9, 5, v8
    v_bfe_u32 v9, v1, 2, 2
    v_lshl_add_u32 v8, v9, 6, v8
    v_add_u32 v8, 157184, v8
    s_lshl4_add_u32 s96, s21, s12
    s_lshl_b32 s97, s96, 6
    s_add_u32 s13, s97, 14155776
    s_waitcnt lgkmcnt(0)
    s_load_dwordx2 s[24:25], s[32:33], s18 offset:0 glc
    v_pk_add_f32 v[192:193], v[192:193], v[194:195]
    v_add_f32 v28, v192, v193
    v_pk_add_f32 v[196:197], v[196:197], v[198:199]
    v_add_f32 v29, v196, v197
    v_pk_add_f32 v[200:201], v[200:201], v[202:203]
    v_add_f32 v30, v200, v201
    v_pk_add_f32 v[204:205], v[204:205], v[206:207]
    v_add_f32 v31, v204, v205
    v_cvt_pk_bf16_f32 v28, 0, v28
    v_cvt_pk_bf16_f32 v29, 0, v29
    v_cvt_pk_bf16_f32 v30, 0, v30
    v_cvt_pk_bf16_f32 v31, 0, v31
    v_add_f32 v30, 1.0, v30
    v_lshlrev_b32 v32, 16, v32
    v_cvt_pk_bf16_f32 v30, 0, v30
    ds_write_b32 v8, v31
    v_mul_f32 v192, v30, v32
    v_cvt_pk_bf16_f32 v193, 0, v192
    v_sub_f32 v194, v192, v193
    v_add_f32_dpp v192, v192, v192 quad_perm:[1,0,3,2] row_mask:0xf bank_mask:0xf
    s_nop 1
    v_add_f32_dpp v192, v192, v192 quad_perm:[2,3,0,1] row_mask:0xf bank_mask:0xf
    s_nop 1
    v_add_f32_dpp v192, v192, v192 row_half_mirror row_mask:0xf bank_mask:0xf
    s_nop 1
    v_add_f32_dpp v192, v192, v192 row_ror:8 row_mask:0xf bank_mask:0xf
    v_mov_b32 v199, v192
    s_nop 1
    v_permlane16_swap_b32 v192, v199
    v_add_f32 v192, v192, v199
    v_mov_b32 v199, v192
    s_nop 1
    v_permlane32_swap_b32 v192, v199
    v_add_f32 v192, v192, v199
    v_mov_b32_dpp v196, v193 row_shl:1 row_mask:0xf bank_mask:0xf
    v_mov_b32_dpp v197, v194 row_shl:1 row_mask:0xf bank_mask:0xf
    v_mov_b32_dpp v198, v32 row_shl:1 row_mask:0xf bank_mask:0xf
    v_cvt_pk_bf16_f32 v196, v193, v196
    v_cvt_pk_bf16_f32 v197, v194, v197
    v_cvt_pk_bf16_f32 v198, v32, v198
    v_mov_b32 v193, s4
    v_mov_b32 v194, 0
    s_cmp_lg_u32 s3, 2
    s_cbranch_scc1 L_NOUP
    s_mov_b64 exec, 1
    buffer_store_dwordx2 v[192:193], v194, s[32:35], s13 offen sc1
    s_mov_b64 exec, -1
L_NOUP:
    v_mov_b32 v184, 0x3f803f80
    s_nop 1
    v_mov_b32_dpp v184, v196 row_newbcast:0 row_mask:0xf bank_mask:0x2
    s_nop 1
    v_mov_b32_dpp v184, v197 row_newbcast:0 row_mask:0xf bank_mask:0x4
    s_nop 1
    v_mov_b32_dpp v184, v198 row_newbcast:0 row_mask:0xf bank_mask:0x8
    v_mov_b32 v185, 0x3f803f80
    s_nop 1
    v_mov_b32_dpp v185, v196 row_newbcast:2 row_mask:0xf bank_mask:0x2
    s_nop 1
    v_mov_b32_dpp v185, v197 row_newbcast:2 row_mask:0xf bank_mask:0x4
    s_nop 1
    v_mov_b32_dpp v185, v198 row_newbcast:2 row_mask:0xf bank_mask:0x8
    v_mov_b32 v186, 0x3f803f80
    s_nop 1
    v_mov_b32_dpp v186, v196 row_newbcast:4 row_mask:0xf bank_mask:0x2
    s_nop 1
    v_mov_b32_dpp v186, v197 row_newbcast:4 row_mask:0xf bank_mask:0x4
    s_nop 1
    v_mov_b32_dpp v186, v198 row_newbcast:4 row_mask:0xf bank_mask:0x8
    v_mov_b32 v187, 0x3f803f80
    s_nop 1
    v_mov_b32_dpp v187, v196 row_newbcast:6 row_mask:0xf bank_mask:0x2
    s_nop 1
    v_mov_b32_dpp v187, v197 row_newbcast:6 row_mask:0xf bank_mask:0x4
    s_nop 1
    v_mov_b32_dpp v187, v198 row_newbcast:6 row_mask:0xf bank_mask:0x8
    v_mov_b32 v188, 0x3f803f80
    s_nop 1
    v_mov_b32_dpp v188, v196 row_newbcast:8 row_mask:0xf bank_mask:0x2
    s_nop 1
    v_mov_b32_dpp v188, v197 row_newbcast:8 row_mask:0xf bank_mask:0x4
    s_nop 1
    v_mov_b32_dpp v188, v198 row_newbcast:8 row_mask:0xf bank_mask:0x8
    v_mov_b32 v189, 0x3f803f80
    s_nop 1
    v_mov_b32_dpp v189, v196 row_newbcast:10 row_mask:0xf bank_mask:0x2
    s_nop 1
    v_mov_b32_dpp v189, v197 row_newbcast:10 row_mask:0xf bank_mask:0x4
    s_nop 1
    v_mov_b32_dpp v189, v198 row_newbcast:10 row_mask:0xf bank_mask:0x8
    v_mov_b32 v190, 0x3f803f80
    s_nop 1
    v_mov_b32_dpp v190, v196 row_newbcast:12 row_mask:0xf bank_mask:0x2
    s_nop 1
    v_mov_b32_dpp v190, v197 row_newbcast:12 row_mask:0xf bank_mask:0x4
    s_nop 1
    v_mov_b32_dpp v190, v198 row_newbcast:12 row_mask:0xf bank_mask:0x8
    v_mov_b32 v191, 0x3f803f80
    s_nop 1
    v_mov_b32_dpp v191, v196 row_newbcast:14 row_mask:0xf bank_mask:0x2
    s_nop 1
    v_mov_b32_dpp v191, v197 row_newbcast:14 row_mask:0xf bank_mask:0x4
    s_nop 1
    v_mov_b32_dpp v191, v198 row_newbcast:14 row_mask:0xf bank_mask:0x8
    v_mov_b32 v42, v29
    v_mov_b32 v43, v31
    v_mov_b32 v33, v30
    v_mov_b32_dpp v136, v28 row_newbcast:0 row_mask:0xf bank_mask:0xf
    v_mov_b32_dpp v137, v28 row_newbcast:1 row_mask:0xf bank_mask:0xf
    v_mov_b32_dpp v138, v28 row_newbcast:2 row_mask:0xf bank_mask:0xf
    v_mov_b32_dpp v139, v28 row_newbcast:3 row_mask:0xf bank_mask:0xf
    v_mov_b32_dpp v140, v28 row_newbcast:4 row_mask:0xf bank_mask:0xf
    v_mov_b32_dpp v141, v28 row_newbcast:5 row_mask:0xf bank_mask:0xf
    v_mov_b32_dpp v142, v28 row_newbcast:6 row_mask:0xf bank_mask:0xf
    v_mov_b32_dpp v143, v28 row_newbcast:7 row_mask:0xf bank_mask:0xf
    v_mov_b32_dpp v144, v28 row_newbcast:8 row_mask:0xf bank_mask:0xf
    v_mov_b32_dpp v145, v28 row_newbcast:9 row_mask:0xf bank_mask:0xf
    v_mov_b32_dpp v146, v28 row_newbcast:10 row_mask:0xf bank_mask:0xf
    v_mov_b32_dpp v147, v28 row_newbcast:11 row_mask:0xf bank_mask:0xf
    v_mov_b32_dpp v148, v28 row_newbcast:12 row_mask:0xf bank_mask:0xf
    v_mov_b32_dpp v149, v28 row_newbcast:13 row_mask:0xf bank_mask:0xf
    v_mov_b32_dpp v150, v28 row_newbcast:14 row_mask:0xf bank_mask:0xf
    v_mov_b32_dpp v151, v28 row_newbcast:15 row_mask:0xf bank_mask:0xf
    v_mov_b32 v29, v5
    s_branch SCHK_32
SPOLL_31:
    s_load_dwordx2 s[24:25], s[32:33], s18 offset:0 glc
SCHK_32:
    s_add_u32 s5, s5, 1
    s_cmp_ge_u32 s5, 200000
    s_waitcnt lgkmcnt(0)
    s_cbranch_scc1 SDONE_33
    s_cmp_lg_u32 s24, s4
    s_cbranch_scc1 SPOLL_31
    s_cmp_lg_u32 s25, s4
    s_cbranch_scc1 SPOLL_31
SDONE_33:
    s_add_u32 s20, s17, s19
    buffer_load_dwordx4 v[224:227], v2, s[32:35], s20 offen sc1
    ds_read_b64_tr_b16 v[192:193], v36
    ds_read_b64_tr_b16 v[194:195], v36 offset:512
    ds_read_b64_tr_b16 v[196:197], v37
    ds_read_b64_tr_b16 v[198:199], v37 offset:512
    ds_read_b64_tr_b16 v[200:201], v38
    ds_read_b64_tr_b16 v[202:203], v38 offset:512
    ds_read_b64_tr_b16 v[204:205], v39
    ds_read_b64_tr_b16 v[206:207], v39 offset:512
    ds_read_b64_tr_b16 v[208:209], v36 offset:4096
    ds_read_b64_tr_b16 v[210:211], v36 offset:4608
    ds_read_b64_tr_b16 v[212:213], v37 offset:4096
    ds_read_b64_tr_b16 v[214:215], v37 offset:4608
    ds_read_b64_tr_b16 v[216:217], v38 offset:4096
    ds_read_b64_tr_b16 v[218:219], v38 offset:4608
    buffer_load_dwordx4 v[228:231], v2, s[32:35], s20 offen offset:1024 sc1
    buffer_load_dwordx4 v[232:235], v2, s[32:35], s20 offen offset:2048 sc1
    buffer_load_dwordx4 v[236:239], v2, s[32:35], s20 offen offset:3072 sc1
    s_barrier
    s_xor_b32 s96, s17, 4096
    s_add_u32 s20, s96, s19
    buffer_load_dwordx4 v[240:243], v2, s[32:35], s20 offen sc1
    buffer_load_dwordx4 v[244:247], v2, s[32:35], s20 offen offset:1024 sc1
    buffer_load_dwordx4 v[44:47], v2, s[32:35], s20 offen offset:2048 sc1
    buffer_load_dwordx4 v[48:51], v2, s[32:35], s20 offen offset:3072 sc1
    s_lshl_b32 s96, s21, 10
    s_add_u32 s13, s96, 14155776
    v_and_b32 v10, 15, v1
    v_lshlrev_b32 v10, 6, v10
    s_cmp_lt_u32 s3, 4
    s_cbranch_scc1 L_G2P0
    s_setprio 1
L_G2P0:
    s_waitcnt vmcnt(7)
    s_waitcnt lgkmcnt(6)
    v_mfma_f32_16x16x32_bf16 v[120:123], v[192:195], v[224:227], 0
    ds_read_b64_tr_b16 v[220:221], v39 offset:4096
    ds_read_b64_tr_b16 v[222:223], v39 offset:4608
    v_mfma_f32_16x16x32_bf16 v[124:127], v[196:199], v[224:227], 0
    ds_read_b64_tr_b16 v[192:193], v36 offset:8192
    ds_read_b64_tr_b16 v[194:195], v36 offset:8704
    v_mfma_f32_16x16x32_bf16 v[128:131], v[200:203], v[224:227], 0
    ds_read_b64_tr_b16 v[196:197], v37 offset:8192
    ds_read_b64_tr_b16 v[198:199], v37 offset:8704
    v_mfma_f32_16x16x32_bf16 v[132:135], v[204:207], v[224:227], 0
    ds_read_b64_tr_b16 v[200:201], v38 offset:8192
    ds_read_b64_tr_b16 v[202:203], v38 offset:8704
    s_xor_b32 s96, s17, 8192
    s_add_u32 s20, s96, s19
    buffer_load_dwordx4 v[224:227], v2, s[32:35], s20 offen sc1
    s_waitcnt vmcnt(7)
    s_waitcnt lgkmcnt(6)
    v_mfma_f32_16x16x32_bf16 v[120:123], v[208:211], v[228:231], v[120:123]
    ds_read_b64_tr_b16 v[204:205], v39 offset:8192
    ds_read_b64_tr_b16 v[206:207], v39 offset:8704
    v_mfma_f32_16x16x32_bf16 v[124:127], v[212:215], v[228:231], v[124:127]
    ds_read_b64_tr_b16 v[208:209], v36 offset:12288
    ds_read_b64_tr_b16 v[210:211], v36 offset:12800
    v_xor_b32 v36, 16384, v36
    v_mfma_f32_16x16x32_bf16 v[128:131], v[216:219], v[228:231], v[128:131]
    ds_read_b64_tr_b16 v[212:213], v37 offset:12288
    ds_read_b64_tr_b16 v[214:215], v37 offset:12800
    v_xor_b32 v37, 16384, v37
    v_mfma_f32_16x16x32_bf16 v[132:135], v[220:223], v[228:231], v[132:135]
    ds_read_b64_tr_b16 v[216:217], v38 offset:12288
    ds_read_b64_tr_b16 v[218:219], v38 offset:12800
    v_xor_b32 v38, 16384, v38
    buffer_load_dwordx4 v[228:231], v2, s[32:35], s20 offen offset:1024 sc1
    s_waitcnt vmcnt(7)
    s_waitcnt lgkmcnt(6)
    v_mfma_f32_16x16x32_bf16 v[120:123], v[192:195], v[232:235], v[120:123]
    ds_read_b64_tr_b16 v[220:221], v39 offset:12288
    ds_read_b64_tr_b16 v[222:223], v39 offset:12800
    v_xor_b32 v39, 16384, v39
    v_mfma_f32_16x16x32_bf16 v[124:127], v[196:199], v[232:235], v[124:127]
    ds_read_b64_tr_b16 v[192:193], v36
    ds_read_b64_tr_b16 v[194:195], v36 offset:512
    v_mfma_f32_16x16x32_bf16 v[128:131], v[200:203], v[232:235], v[128:131]
    ds_read_b64_tr_b16 v[196:197], v37
    ds_read_b64_tr_b16 v[198:199], v37 offset:512
    v_mfma_f32_16x16x32_bf16 v[132:135], v[204:207], v[232:235], v[132:135]
    ds_read_b64_tr_b16 v[200:201], v38
    ds_read_b64_tr_b16 v[202:203], v38 offset:512
    buffer_load_dwordx4 v[232:235], v2, s[32:35], s20 offen offset:2048 sc1
    s_waitcnt vmcnt(7)
    s_waitcnt lgkmcnt(6)
    v_mfma_f32_16x16x32_bf16 v[120:123], v[208:211], v[236:239], v[120:123]
    ds_read_b64_tr_b16 v[204:205], v39
    ds_read_b64_tr_b16 v[206:207], v39 offset:512
    v_mfma_f32_16x16x32_bf16 v[124:127], v[212:215], v[236:239], v[124:127]
    ds_read_b64_tr_b16 v[208:209], v36 offset:4096
    ds_read_b64_tr_b16 v[210:211], v36 offset:4608
    v_mfma_f32_16x16x32_bf16 v[128:131], v[216:219], v[236:239], v[128:131]
    ds_read_b64_tr_b16 v[212:213], v37 offset:4096
    ds_read_b64_tr_b16 v[214:215], v37 offset:4608
    v_mfma_f32_16x16x32_bf16 v[132:135], v[220:223], v[236:239], v[132:135]
    ds_read_b64_tr_b16 v[216:217], v38 offset:4096
    ds_read_b64_tr_b16 v[218:219], v38 offset:4608
    buffer_load_dwordx4 v[236:239], v2, s[32:35], s20 offen offset:3072 sc1
    s_waitcnt vmcnt(7)
    s_waitcnt lgkmcnt(6)
    v_mfma_f32_16x16x32_bf16 v[120:123], v[192:195], v[240:243], v[120:123]
    ds_read_b64_tr_b16 v[220:221], v39 offset:4096
    ds_read_b64_tr_b16 v[222:223], v39 offset:4608
    v_mfma_f32_16x16x32_bf16 v[124:127], v[196:199], v[240:243], v[124:127]
    ds_read_b64_tr_b16 v[192:193], v36 offset:8192
    ds_read_b64_tr_b16 v[194:195], v36 offset:8704
    v_mfma_f32_16x16x32_bf16 v[128:131], v[200:203], v[240:243], v[128:131]
    ds_read_b64_tr_b16 v[196:197], v37 offset:8192
    ds_read_b64_tr_b16 v[198:199], v37 offset:8704
    v_mfma_f32_16x16x32_bf16 v[132:135], v[204:207], v[240:243], v[132:135]
    ds_read_b64_tr_b16 v[200:201], v38 offset:8192
    ds_read_b64_tr_b16 v[202:203], v38 offset:8704
    s_xor_b32 s96, s17, 12288
    s_add_u32 s20, s96, s19
    buffer_load_dwordx4 v[240:243], v2, s[32:35], s20 offen sc1
    s_waitcnt vmcnt(7)
    s_waitcnt lgkmcnt(6)
    v_mfma_f32_16x16x32_bf16 v[120:123], v[208:211], v[244:247], v[120:123]
    ds_read_b64_tr_b16 v[204:205], v39 offset:8192
    ds_read_b64_tr_b16 v[206:207], v39 offset:8704
    v_mfma_f32_16x16x32_bf16 v[124:127], v[212:215], v[244:247], v[124:127]
    ds_read_b64_tr_b16 v[208:209], v36 offset:12288
    ds_read_b64_tr_b16 v[210:211], v36 offset:12800
    v_xor_b32 v36, 49152, v36
    v_mfma_f32_16x16x32_bf16 v[128:131], v[216:219], v[244:247], v[128:131]
    ds_read_b64_tr_b16 v[212:213], v37 offset:12288
    ds_read_b64_tr_b16 v[214:215], v37 offset:12800
    v_xor_b32 v37, 49152, v37
    v_mfma_f32_16x16x32_bf16 v[132:135], v[220:223], v[244:247], v[132:135]
    ds_read_b64_tr_b16 v[216:217], v38 offset:12288
    ds_read_b64_tr_b16 v[218:219], v38 offset:12800
    v_xor_b32 v38, 49152, v38
    buffer_load_dwordx4 v[244:247], v2, s[32:35], s20 offen offset:1024 sc1
    s_waitcnt vmcnt(7)
    s_waitcnt lgkmcnt(6)
    v_mfma_f32_16x16x32_bf16 v[120:123], v[192:195], v[44:47], v[120:123]
    ds_read_b64_tr_b16 v[220:221], v39 offset:12288
    ds_read_b64_tr_b16 v[222:223], v39 offset:12800
    v_xor_b32 v39, 49152, v39
    v_mfma_f32_16x16x32_bf16 v[124:127], v[196:199], v[44:47], v[124:127]
    ds_read_b64_tr_b16 v[192:193], v36
    ds_read_b64_tr_b16 v[194:195], v36 offset:512
    v_mfma_f32_16x16x32_bf16 v[128:131], v[200:203], v[44:47], v[128:131]
    ds_read_b64_tr_b16 v[196:197], v37
    ds_read_b64_tr_b16 v[198:199], v37 offset:512
    v_mfma_f32_16x16x32_bf16 v[132:135], v[204:207], v[44:47], v[132:135]
    ds_read_b64_tr_b16 v[200:201], v38
    ds_read_b64_tr_b16 v[202:203], v38 offset:512
    buffer_load_dwordx4 v[44:47], v2, s[32:35], s20 offen offset:2048 sc1
    s_waitcnt vmcnt(7)
    s_waitcnt lgkmcnt(6)
    v_mfma_f32_16x16x32_bf16 v[120:123], v[208:211], v[48:51], v[120:123]
    ds_read_b64_tr_b16 v[204:205], v39
    ds_read_b64_tr_b16 v[206:207], v39 offset:512
    v_mfma_f32_16x16x32_bf16 v[124:127], v[212:215], v[48:51], v[124:127]
    ds_read_b64_tr_b16 v[208:209], v36 offset:4096
    ds_read_b64_tr_b16 v[210:211], v36 offset:4608
    v_mfma_f32_16x16x32_bf16 v[128:131], v[216:219], v[48:51], v[128:131]
    ds_read_b64_tr_b16 v[212:213], v37 offset:4096
L_PAD8:
    s_cbranch_execz L_RET8
    ds_read_b64_tr_b16 v[214:215], v37 offset:4608
    v_mfma_f32_16x16x32_bf16 v[132:135], v[220:223], v[48:51], v[132:135]
    ds_read_b64_tr_b16 v[216:217], v38 offset:4096
    ds_read_b64_tr_b16 v[218:219], v38 offset:4608
    buffer_load_dwordx4 v[48:51], v2, s[32:35], s20 offen offset:3072 sc1
    s_waitcnt vmcnt(7)
    s_waitcnt lgkmcnt(6)
    v_mfma_f32_16x16x32_bf16 v[120:123], v[192:195], v[224:227], v[120:123]
    ds_read_b64_tr_b16 v[220:221], v39 offset:4096
    ds_read_b64_tr_b16 v[222:223], v39 offset:4608
    v_mfma_f32_16x16x32_bf16 v[124:127], v[196:199], v[224:227], v[124:127]
    ds_read_b64_tr_b16 v[192:193], v36 offset:8192
    ds_read_b64_tr_b16 v[194:195], v36 offset:8704
    v_mfma_f32_16x16x32_bf16 v[128:131], v[200:203], v[224:227], v[128:131]
    ds_read_b64_tr_b16 v[196:197], v37 offset:8192
    ds_read_b64_tr_b16 v[198:199], v37 offset:8704
    v_mfma_f32_16x16x32_bf16 v[132:135], v[204:207], v[224:227], v[132:135]
    ds_read_b64_tr_b16 v[200:201], v38 offset:8192
    ds_read_b64_tr_b16 v[202:203], v38 offset:8704
    s_xor_b32 s96, s17, 16384
    s_add_u32 s20, s96, s19
    buffer_load_dwordx4 v[224:227], v2, s[32:35], s20 offen sc1
    s_waitcnt vmcnt(7)
    s_waitcnt lgkmcnt(6)
    v_mfma_f32_16x16x32_bf16 v[120:123], v[208:211], v[228:231], v[120:123]
    ds_read_b64_tr_b16 v[204:205], v39 offset:8192
    ds_read_b64_tr_b16 v[206:207], v39 offset:8704
    v_mfma_f32_16x16x32_bf16 v[124:127], v[212:215], v[228:231], v[124:127]
    ds_read_b64_tr_b16 v[208:209], v36 offset:12288
    ds_read_b64_tr_b16 v[210:211], v36 offset:12800
    v_xor_b32 v36, 16384, v36
    v_mfma_f32_16x16x32_bf16 v[128:131], v[216:219], v[228:231], v[128:131]
    ds_read_b64_tr_b16 v[212:213], v37 offset:12288
    ds_read_b64_tr_b16 v[214:215], v37 offset:12800
    v_xor_b32 v37, 16384, v37
    v_mfma_f32_16x16x32_bf16 v[132:135], v[220:223], v[228:231], v[132:135]
    ds_read_b64_tr_b16 v[216:217], v38 offset:12288
    ds_read_b64_tr_b16 v[218:219], v38 offset:12800
    v_xor_b32 v38, 16384, v38
    buffer_load_dwordx4 v[228:231], v2, s[32:35], s20 offen offset:1024 sc1
    s_waitcnt vmcnt(7)
    s_waitcnt lgkmcnt(6)
    v_mfma_f32_16x16x32_bf16 v[120:123], v[192:195], v[232:235], v[120:123]
    ds_read_b64_tr_b16 v[220:221], v39 offset:12288
    ds_read_b64_tr_b16 v[222:223], v39 offset:12800
    v_xor_b32 v39, 16384, v39
    v_mfma_f32_16x16x32_bf16 v[124:127], v[196:199], v[232:235], v[124:127]
    ds_read_b64_tr_b16 v[192:193], v36
    ds_read_b64_tr_b16 v[194:195], v36 offset:512
    v_mfma_f32_16x16x32_bf16 v[128:131], v[200:203], v[232:235], v[128:131]
    ds_read_b64_tr_b16 v[196:197], v37
    ds_read_b64_tr_b16 v[198:199], v37 offset:512
    v_mfma_f32_16x16x32_bf16 v[132:135], v[204:207], v[232:235], v[132:135]
    ds_read_b64_tr_b16 v[200:201], v38
    ds_read_b64_tr_b16 v[202:203], v38 offset:512
    buffer_load_dwordx4 v[232:235], v2, s[32:35], s20 offen offset:2048 sc1
    s_waitcnt vmcnt(7)
    s_waitcnt lgkmcnt(6)
    v_mfma_f32_16x16x32_bf16 v[120:123], v[208:211], v[236:239], v[120:123]
    ds_read_b64_tr_b16 v[204:205], v39
    ds_read_b64_tr_b16 v[206:207], v39 offset:512
    v_mfma_f32_16x16x32_bf16 v[124:127], v[212:215], v[236:239], v[124:127]
    ds_read_b64_tr_b16 v[208:209], v36 offset:4096
    ds_read_b64_tr_b16 v[210:211], v36 offset:4608
    v_mfma_f32_16x16x32_bf16 v[128:131], v[216:219], v[236:239], v[128:131]
    ds_read_b64_tr_b16 v[212:213], v37 offset:4096
    ds_read_b64_tr_b16 v[214:215], v37 offset:4608
    v_mfma_f32_16x16x32_bf16 v[132:135], v[220:223], v[236:239], v[132:135]
    ds_read_b64_tr_b16 v[216:217], v38 offset:4096
    ds_read_b64_tr_b16 v[218:219], v38 offset:4608
    buffer_load_dwordx4 v[236:239], v2, s[32:35], s20 offen offset:3072 sc1
    s_waitcnt vmcnt(7)
    s_waitcnt lgkmcnt(6)
    v_mfma_f32_16x16x32_bf16 v[120:123], v[192:195], v[240:243], v[120:123]
    ds_read_b64_tr_b16 v[220:221], v39 offset:4096
    ds_read_b64_tr_b16 v[222:223], v39 offset:4608
    v_mfma_f32_16x16x32_bf16 v[124:127], v[196:199], v[240:243], v[124:127]
    ds_read_b64_tr_b16 v[192:193], v36 offset:8192
    ds_read_b64_tr_b16 v[194:195], v36 offset:8704
    v_mfma_f32_16x16x32_bf16 v[128:131], v[200:203], v[240:243], v[128:131]
    ds_read_b64_tr_b16 v[196:197], v37 offset:8192
    ds_read_b64_tr_b16 v[198:199], v37 offset:8704
    v_mfma_f32_16x16x32_bf16 v[132:135], v[204:207], v[240:243], v[132:135]
    ds_read_b64_tr_b16 v[200:201], v38 offset:8192
    ds_read_b64_tr_b16 v[202:203], v38 offset:8704
    s_xor_b32 s96, s17, 20480
    s_add_u32 s20, s96, s19
    buffer_load_dwordx4 v[240:243], v2, s[32:35], s20 offen sc1
    s_waitcnt vmcnt(7)
    s_waitcnt lgkmcnt(6)
    v_mfma_f32_16x16x32_bf16 v[120:123], v[208:211], v[244:247], v[120:123]
    ds_read_b64_tr_b16 v[204:205], v39 offset:8192
    ds_read_b64_tr_b16 v[206:207], v39 offset:8704
    v_mfma_f32_16x16x32_bf16 v[124:127], v[212:215], v[244:247], v[124:127]
    ds_read_b64_tr_b16 v[208:209], v36 offset:12288
    ds_read_b64_tr_b16 v[210:211], v36 offset:12800
    v_xor_b32 v36, 114688, v36
    v_mfma_f32_16x16x32_bf16 v[128:131], v[216:219], v[244:247], v[128:131]
    ds_read_b64_tr_b16 v[212:213], v37 offset:12288
    ds_read_b64_tr_b16 v[214:215], v37 offset:12800
    v_xor_b32 v37, 114688, v37
    v_mfma_f32_16x16x32_bf16 v[132:135], v[220:223], v[244:247], v[132:135]
    ds_read_b64_tr_b16 v[216:217], v38 offset:12288
    ds_read_b64_tr_b16 v[218:219], v38 offset:12800
    v_xor_b32 v38, 114688, v38
    buffer_load_dwordx4 v[244:247], v2, s[32:35], s20 offen offset:1024 sc1
    s_waitcnt vmcnt(7)
    s_waitcnt lgkmcnt(6)
    v_mfma_f32_16x16x32_bf16 v[120:123], v[192:195], v[44:47], v[120:123]
    ds_read_b64_tr_b16 v[220:221], v39 offset:12288
    ds_read_b64_tr_b16 v[222:223], v39 offset:12800
    v_xor_b32 v39, 114688, v39
    v_mfma_f32_16x16x32_bf16 v[124:127], v[196:199], v[44:47], v[124:127]
    ds_read_b64_tr_b16 v[192:193], v36
    ds_read_b64_tr_b16 v[194:195], v36 offset:512
    v_mfma_f32_16x16x32_bf16 v[128:131], v[200:203], v[44:47], v[128:131]
    ds_read_b64_tr_b16 v[196:197], v37
    ds_read_b64_tr_b16 v[198:199], v37 offset:512
    v_mfma_f32_16x16x32_bf16 v[132:135], v[204:207], v[44:47], v[132:135]
    ds_read_b64_tr_b16 v[200:201], v38
    ds_read_b64_tr_b16 v[202:203], v38 offset:512
    buffer_load_dwordx4 v[44:47], v2, s[32:35], s20 offen offset:2048 sc1
    s_waitcnt vmcnt(7)
    s_waitcnt lgkmcnt(6)
    v_mfma_f32_16x16x32_bf16 v[120:123], v[208:211], v[48:51], v[120:123]
    ds_read_b64_tr_b16 v[204:205], v39
    ds_read_b64_tr_b16 v[206:207], v39 offset:512
    v_mfma_f32_16x16x32_bf16 v[124:127], v[212:215], v[48:51], v[124:127]
    ds_read_b64_tr_b16 v[208:209], v36 offset:4096
    ds_read_b64_tr_b16 v[210:211], v36 offset:4608
    v_mfma_f32_16x16x32_bf16 v[128:131], v[216:219], v[48:51], v[128:131]
    ds_read_b64_tr_b16 v[212:213], v37 offset:4096
    ds_read_b64_tr_b16 v[214:215], v37 offset:4608
    v_mfma_f32_16x16x32_bf16 v[132:135], v[220:223], v[48:51], v[132:135]
    ds_read_b64_tr_b16 v[216:217], v38 offset:4096
    ds_read_b64_tr_b16 v[218:219], v38 offset:4608
    buffer_load_dwordx4 v[48:51], v2, s[32:35], s20 offen offset:3072 sc1
    s_waitcnt vmcnt(7)
    s_waitcnt lgkmcnt(6)
    v_mfma_f32_16x16x32_bf16 v[120:123], v[192:195], v[224:227], v[120:123]
    ds_read_b64_tr_b16 v[220:221], v39 offset:4096
    ds_read_b64_tr_b16 v[222:223], v39 offset:4608
    v_mfma_f32_16x16x32_bf16 v[124:127], v[196:199], v[224:227], v[124:127]
    ds_read_b64_tr_b16 v[192:193], v36 offset:8192
    ds_read_b64_tr_b16 v[194:195], v36 offset:8704
    v_mfma_f32_16x16x32_bf16 v[128:131], v[200:203], v[224:227], v[128:131]
    ds_read_b64_tr_b16 v[196:197], v37 offset:8192
    ds_read_b64_tr_b16 v[198:199], v37 offset:8704
    v_mfma_f32_16x16x32_bf16 v[132:135], v[204:207], v[224:227], v[132:135]
    ds_read_b64_tr_b16 v[200:201], v38 offset:8192
    ds_read_b64_tr_b16 v[202:203], v38 offset:8704
    s_xor_b32 s96, s17, 24576
    s_add_u32 s20, s96, s19
    buffer_load_dwordx4 v[224:227], v2, s[32:35], s20 offen sc1
    s_waitcnt vmcnt(7)
    s_waitcnt lgkmcnt(6)
    v_mfma_f32_16x16x32_bf16 v[120:123], v[208:211], v[228:231], v[120:123]
    ds_read_b64_tr_b16 v[204:205], v39 offset:8192
    ds_read_b64_tr_b16 v[206:207], v39 offset:8704
    v_mfma_f32_16x16x32_bf16 v[124:127], v[212:215], v[228:231], v[124:127]
    ds_read_b64_tr_b16 v[208:209], v36 offset:12288
    ds_read_b64_tr_b16 v[210:211], v36 offset:12800
    v_xor_b32 v36, 16384, v36
    v_mfma_f32_16x16x32_bf16 v[128:131], v[216:219], v[228:231], v[128:131]
    ds_read_b64_tr_b16 v[212:213], v37 offset:12288
    ds_read_b64_tr_b16 v[214:215], v37 offset:12800
    v_xor_b32 v37, 16384, v37
    v_mfma_f32_16x16x32_bf16 v[132:135], v[220:223], v[228:231], v[132:135]
    ds_read_b64_tr_b16 v[216:217], v38 offset:12288
    ds_read_b64_tr_b16 v[218:219], v38 offset:12800
    v_xor_b32 v38, 16384, v38
    buffer_load_dwordx4 v[228:231], v2, s[32:35], s20 offen offset:1024 sc1
    s_waitcnt vmcnt(7)
    s_waitcnt lgkmcnt(6)
    v_mfma_f32_16x16x32_bf16 v[120:123], v[192:195], v[232:235], v[120:123]
    ds_read_b64_tr_b16 v[220:221], v39 offset:12288
    ds_read_b64_tr_b16 v[222:223], v39 offset:12800
    v_xor_b32 v39, 16384, v39
    v_mfma_f32_16x16x32_bf16 v[124:127], v[196:199], v[232:235], v[124:127]
    ds_read_b64_tr_b16 v[192:193], v36
    ds_read_b64_tr_b16 v[194:195], v36 offset:512
    v_mfma_f32_16x16x32_bf16 v[128:131], v[200:203], v[232:235], v[128:131]
    ds_read_b64_tr_b16 v[196:197], v37
    ds_read_b64_tr_b16 v[198:199], v37 offset:512
    v_mfma_f32_16x16x32_bf16 v[132:135], v[204:207], v[232:235], v[132:135]
    ds_read_b64_tr_b16 v[200:201], v38
    ds_read_b64_tr_b16 v[202:203], v38 offset:512
    buffer_load_dwordx4 v[232:235], v2, s[32:35], s20 offen offset:2048 sc1
    s_waitcnt vmcnt(7)
    s_waitcnt lgkmcnt(6)
    v_mfma_f32_16x16x32_bf16 v[120:123], v[208:211], v[236:239], v[120:123]
    ds_read_b64_tr_b16 v[204:205], v39
    ds_read_b64_tr_b16 v[206:207], v39 offset:512
    v_mfma_f32_16x16x32_bf16 v[124:127], v[212:215], v[236:239], v[124:127]
    ds_read_b64_tr_b16 v[208:209], v36 offset:4096
    ds_read_b64_tr_b16 v[210:211], v36 offset:4608
    v_mfma_f32_16x16x32_bf16 v[128:131], v[216:219], v[236:239], v[128:131]
    ds_read_b64_tr_b16 v[212:213], v37 offset:4096
    ds_read_b64_tr_b16 v[214:215], v37 offset:4608
    v_mfma_f32_16x16x32_bf16 v[132:135], v[220:223], v[236:239], v[132:135]
    ds_read_b64_tr_b16 v[216:217], v38 offset:4096
    ds_read_b64_tr_b16 v[218:219], v38 offset:4608
    buffer_load_dwordx4 v[236:239], v2, s[32:35], s20 offen offset:3072 sc1
    s_waitcnt vmcnt(7)
    s_waitcnt lgkmcnt(6)
    v_mfma_f32_16x16x32_bf16 v[120:123], v[192:195], v[240:243], v[120:123]
    ds_read_b64_tr_b16 v[220:221], v39 offset:4096
    ds_read_b64_tr_b16 v[222:223], v39 offset:4608
    v_mfma_f32_16x16x32_bf16 v[124:127], v[196:199], v[240:243], v[124:127]
    ds_read_b64_tr_b16 v[192:193], v36 offset:8192
    ds_read_b64_tr_b16 v[194:195], v36 offset:8704
    v_mfma_f32_16x16x32_bf16 v[128:131], v[200:203], v[240:243], v[128:131]
    ds_read_b64_tr_b16 v[196:197], v37 offset:8192
    ds_read_b64_tr_b16 v[198:199], v37 offset:8704
    v_mfma_f32_16x16x32_bf16 v[132:135], v[204:207], v[240:243], v[132:135]
    ds_read_b64_tr_b16 v[200:201], v38 offset:8192
    ds_read_b64_tr_b16 v[202:203], v38 offset:8704
    s_xor_b32 s96, s17, 28672
    s_add_u32 s20, s96, s19
    buffer_load_dwordx4 v[240:243], v2, s[32:35], s20 offen sc1
    s_waitcnt vmcnt(7)
    s_waitcnt lgkmcnt(6)
    v_mfma_f32_16x16x32_bf16 v[120:123], v[208:211], v[244:247], v[120:123]
    ds_read_b64_tr_b16 v[204:205], v39 offset:8192
    ds_read_b64_tr_b16 v[206:207], v39 offset:8704
    v_mfma_f32_16x16x32_bf16 v[124:127], v[212:215], v[244:247], v[124:127]
    ds_read_b64_tr_b16 v[208:209], v36 offset:12288
    ds_read_b64_tr_b16 v[210:211], v36 offset:12800
    v_xor_b32 v36, 49152, v36
    v_mfma_f32_16x16x32_bf16 v[128:131], v[216:219], v[244:247], v[128:131]
    ds_read_b64_tr_b16 v[212:213], v37 offset:12288
    ds_read_b64_tr_b16 v[214:215], v37 offset:12800
    v_xor_b32 v37, 49152, v37
    v_mfma_f32_16x16x32_bf16 v[132:135], v[220:223], v[244:247], v[132:135]
    ds_read_b64_tr_b16 v[216:217], v38 offset:12288
    ds_read_b64_tr_b16 v[218:219], v38 offset:12800
    v_xor_b32 v38, 49152, v38
    buffer_load_dwordx4 v[244:247], v2, s[32:35], s20 offen offset:1024 sc1
    s_cmp_lt_u32 s3, 4
    s_cbranch_scc1 L_G2P22
    s_setprio 0
L_G2P22:
    s_waitcnt vmcnt(7)
    s_waitcnt lgkmcnt(6)
    v_mfma_f32_16x16x32_bf16 v[120:123], v[192:195], v[44:47], v[120:123]
    ds_read_b64_tr_b16 v[220:221], v39 offset:12288
    ds_read_b64_tr_b16 v[222:223], v39 offset:12800
    v_xor_b32 v39, 49152, v39
    v_mfma_f32_16x16x32_bf16 v[124:127], v[196:199], v[44:47], v[124:127]
    ds_read_b64_tr_b16 v[192:193], v36
    ds_read_b64_tr_b16 v[194:195], v36 offset:512
    v_mfma_f32_16x16x32_bf16 v[128:131], v[200:203], v[44:47], v[128:131]
    ds_read_b64_tr_b16 v[196:197], v37
    ds_read_b64_tr_b16 v[198:199], v37 offset:512
    v_mfma_f32_16x16x32_bf16 v[132:135], v[204:207], v[44:47], v[132:135]
    ds_read_b64_tr_b16 v[200:201], v38
    ds_read_b64_tr_b16 v[202:203], v38 offset:512
    buffer_load_dwordx4 v[44:47], v2, s[32:35], s20 offen offset:2048 sc1
    s_waitcnt vmcnt(7)
    s_waitcnt lgkmcnt(6)
    v_mfma_f32_16x16x32_bf16 v[120:123], v[208:211], v[48:51], v[120:123]
    ds_read_b64_tr_b16 v[204:205], v39
    ds_read_b64_tr_b16 v[206:207], v39 offset:512
    v_mfma_f32_16x16x32_bf16 v[124:127], v[212:215], v[48:51], v[124:127]
    ds_read_b64_tr_b16 v[208:209], v36 offset:4096
    ds_read_b64_tr_b16 v[210:211], v36 offset:4608
    v_mfma_f32_16x16x32_bf16 v[128:131], v[216:219], v[48:51], v[128:131]
    ds_read_b64_tr_b16 v[212:213], v37 offset:4096
    ds_read_b64_tr_b16 v[214:215], v37 offset:4608
    v_mfma_f32_16x16x32_bf16 v[132:135], v[220:223], v[48:51], v[132:135]
    ds_read_b64_tr_b16 v[216:217], v38 offset:4096
    ds_read_b64_tr_b16 v[218:219], v38 offset:4608
    buffer_load_dwordx4 v[48:51], v2, s[32:35], s20 offen offset:3072 sc1
    buffer_load_dwordx2 v[40:41], v10, s[32:35], s13 offen sc1
    s_waitcnt vmcnt(8)
    s_waitcnt lgkmcnt(6)
    v_mfma_f32_16x16x32_bf16 v[120:123], v[192:195], v[224:227], v[120:123]
    ds_read_b64_tr_b16 v[220:221], v39 offset:4096
    ds_read_b64_tr_b16 v[222:223], v39 offset:4608
    v_mfma_f32_16x16x32_bf16 v[124:127], v[196:199], v[224:227], v[124:127]
    ds_read_b64_tr_b16 v[192:193], v36 offset:8192
    ds_read_b64_tr_b16 v[194:195], v36 offset:8704
    v_mfma_f32_16x16x32_bf16 v[128:131], v[200:203], v[224:227], v[128:131]
    ds_read_b64_tr_b16 v[196:197], v37 offset:8192
    ds_read_b64_tr_b16 v[198:199], v37 offset:8704
    v_mfma_f32_16x16x32_bf16 v[132:135], v[204:207], v[224:227], v[132:135]
    ds_read_b64_tr_b16 v[200:201], v38 offset:8192
    ds_read_b64_tr_b16 v[202:203], v38 offset:8704
    s_waitcnt vmcnt(7)
    s_waitcnt lgkmcnt(6)
    v_mfma_f32_16x16x32_bf16 v[120:123], v[208:211], v[228:231], v[120:123]
    ds_read_b64_tr_b16 v[204:205], v39 offset:8192
    ds_read_b64_tr_b16 v[206:207], v39 offset:8704
    v_mfma_f32_16x16x32_bf16 v[124:127], v[212:215], v[228:231], v[124:127]
    ds_read_b64_tr_b16 v[208:209], v36 offset:12288
    ds_read_b64_tr_b16 v[210:211], v36 offset:12800
    v_xor_b32 v36, 16384, v36
    v_mfma_f32_16x16x32_bf16 v[128:131], v[216:219], v[228:231], v[128:131]
    ds_read_b64_tr_b16 v[212:213], v37 offset:12288
    ds_read_b64_tr_b16 v[214:215], v37 offset:12800
    v_xor_b32 v37, 16384, v37
    v_mfma_f32_16x16x32_bf16 v[132:135], v[220:223], v[228:231], v[132:135]
    ds_read_b64_tr_b16 v[216:217], v38 offset:12288
    ds_read_b64_tr_b16 v[218:219], v38 offset:12800
    v_xor_b32 v38, 16384, v38
    s_waitcnt vmcnt(6)
    s_waitcnt lgkmcnt(6)
    v_mfma_f32_16x16x32_bf16 v[120:123], v[192:195], v[232:235], v[120:123]
    ds_read_b64_tr_b16 v[220:221], v39 offset:12288
    ds_read_b64_tr_b16 v[222:223], v39 offset:12800
    v_xor_b32 v39, 16384, v39
    v_mfma_f32_16x16x32_bf16 v[124:127], v[196:199], v[232:235], v[124:127]
    ds_read_b64_tr_b16 v[192:193], v36
    ds_read_b64_tr_b16 v[194:195], v36 offset:512
    v_mfma_f32_16x16x32_bf16 v[128:131], v[200:203], v[232:235], v[128:131]
    ds_read_b64_tr_b16 v[196:197], v37
    ds_read_b64_tr_b16 v[198:199], v37 offset:512
    v_mfma_f32_16x16x32_bf16 v[132:135], v[204:207], v[232:235], v[132:135]
    ds_read_b64_tr_b16 v[200:201], v38
    ds_read_b64_tr_b16 v[202:203], v38 offset:512
    s_waitcnt vmcnt(5)
    s_waitcnt lgkmcnt(6)
    v_mfma_f32_16x16x32_bf16 v[120:123], v[208:211], v[236:239], v[120:123]
    ds_read_b64_tr_b16 v[204:205], v39
    ds_read_b64_tr_b16 v[206:207], v39 offset:512
    v_mfma_f32_16x16x32_bf16 v[124:127], v[212:215], v[236:239], v[124:127]
    ds_read_b64_tr_b16 v[208:209], v36 offset:4096
    ds_read_b64_tr_b16 v[210:211], v36 offset:4608
    v_mfma_f32_16x16x32_bf16 v[128:131], v[216:219], v[236:239], v[128:131]
    ds_read_b64_tr_b16 v[212:213], v37 offset:4096
    ds_read_b64_tr_b16 v[214:215], v37 offset:4608
    v_mfma_f32_16x16x32_bf16 v[132:135], v[220:223], v[236:239], v[132:135]
    ds_read_b64_tr_b16 v[216:217], v38 offset:4096
    ds_read_b64_tr_b16 v[218:219], v38 offset:4608
    s_add_u32 s82, s80, 114688
    buffer_load_dwordx4 v[72:75], v27, s[52:55], s82 offen nt
    s_add_u32 s82, s80, 172032
    buffer_load_dwordx4 v[76:79], v27, s[52:55], s82 offen nt
    s_mov_b32 s82, s80
    buffer_load_dwordx4 v[80:83], v27, s[56:59], s82 offen nt
    s_waitcnt vmcnt(7)
    s_waitcnt lgkmcnt(6)
    v_mfma_f32_16x16x32_bf16 v[120:123], v[192:195], v[240:243], v[120:123]
    ds_read_b64_tr_b16 v[220:221], v39 offset:4096
    ds_read_b64_tr_b16 v[222:223], v39 offset:4608
    v_mfma_f32_16x16x32_bf16 v[124:127], v[196:199], v[240:243], v[124:127]
    ds_read_b64_tr_b16 v[192:193], v36 offset:8192
    ds_read_b64_tr_b16 v[194:195], v36 offset:8704
    v_mfma_f32_16x16x32_bf16 v[128:131], v[200:203], v[240:243], v[128:131]
    ds_read_b64_tr_b16 v[196:197], v37 offset:8192
    ds_read_b64_tr_b16 v[198:199], v37 offset:8704
    v_mfma_f32_16x16x32_bf16 v[132:135], v[204:207], v[240:243], v[132:135]
    ds_read_b64_tr_b16 v[200:201], v38 offset:8192
    ds_read_b64_tr_b16 v[202:203], v38 offset:8704
    s_waitcnt vmcnt(6)
    s_waitcnt lgkmcnt(6)
    v_mfma_f32_16x16x32_bf16 v[120:123], v[208:211], v[244:247], v[120:123]
    ds_read_b64_tr_b16 v[204:205], v39 offset:8192
    ds_read_b64_tr_b16 v[206:207], v39 offset:8704
    v_mfma_f32_16x16x32_bf16 v[124:127], v[212:215], v[244:247], v[124:127]
    ds_read_b64_tr_b16 v[208:209], v36 offset:12288
    ds_read_b64_tr_b16 v[210:211], v36 offset:12800
    v_mfma_f32_16x16x32_bf16 v[128:131], v[216:219], v[244:247], v[128:131]
    ds_read_b64_tr_b16 v[212:213], v37 offset:12288
    ds_read_b64_tr_b16 v[214:215], v37 offset:12800
    v_mfma_f32_16x16x32_bf16 v[132:135], v[220:223], v[244:247], v[132:135]
    ds_read_b64_tr_b16 v[216:217], v38 offset:12288
    ds_read_b64_tr_b16 v[218:219], v38 offset:12800
    s_waitcnt vmcnt(5)
    s_waitcnt lgkmcnt(6)
    v_mfma_f32_16x16x32_bf16 v[120:123], v[192:195], v[44:47], v[120:123]
    ds_read_b64_tr_b16 v[220:221], v39 offset:12288
    ds_read_b64_tr_b16 v[222:223], v39 offset:12800
    v_mfma_f32_16x16x32_bf16 v[124:127], v[196:199], v[44:47], v[124:127]
    v_mfma_f32_16x16x32_bf16 v[128:131], v[200:203], v[44:47], v[128:131]
    v_mfma_f32_16x16x32_bf16 v[132:135], v[204:207], v[44:47], v[132:135]
    s_waitcnt vmcnt(4)
    s_waitcnt lgkmcnt(0)
    v_mfma_f32_16x16x32_bf16 v[120:123], v[208:211], v[48:51], v[120:123]
    v_mfma_f32_16x16x32_bf16 v[124:127], v[212:215], v[48:51], v[124:127]
    v_mfma_f32_16x16x32_bf16 v[128:131], v[216:219], v[48:51], v[128:131]
    v_mfma_f32_16x16x32_bf16 v[132:135], v[220:223], v[48:51], v[132:135]
    s_nop 4
    v_cvt_pk_bf16_f32 v120, 0, v120
    v_cvt_pk_bf16_f32 v121, 0, v121
    v_cvt_pk_bf16_f32 v122, 0, v122
    v_cvt_pk_bf16_f32 v123, 0, v123
    v_cvt_pk_bf16_f32 v124, 0, v124
    v_cvt_pk_bf16_f32 v125, 0, v125
    v_cvt_pk_bf16_f32 v126, 0, v126
    v_cvt_pk_bf16_f32 v127, 0, v127
    v_pk_mul_f32 v[120:121], v[120:121], v[136:137]
    v_pk_mul_f32 v[122:123], v[122:123], v[138:139]
    v_pk_mul_f32 v[124:125], v[124:125], v[140:141]
    v_pk_mul_f32 v[126:127], v[126:127], v[142:143]
    v_cvt_pk_bf16_f32 v120, 0, v120
    v_cvt_pk_bf16_f32 v121, 0, v121
    v_cvt_pk_bf16_f32 v122, 0, v122
    v_cvt_pk_bf16_f32 v123, 0, v123
    v_cvt_pk_bf16_f32 v124, 0, v124
    v_cvt_pk_bf16_f32 v125, 0, v125
    v_cvt_pk_bf16_f32 v126, 0, v126
    v_cvt_pk_bf16_f32 v127, 0, v127
    v_pk_add_f32 v[120:121], v[120:121], v[152:153]
    v_pk_add_f32 v[122:123], v[122:123], v[154:155]
    v_pk_add_f32 v[124:125], v[124:125], v[156:157]
    v_pk_add_f32 v[126:127], v[126:127], v[158:159]
    v_cvt_pk_bf16_f32 v12, v120, v121
    v_cvt_pk_bf16_f32 v13, v122, v123
    v_cvt_pk_bf16_f32 v14, v124, v125
    v_cvt_pk_bf16_f32 v15, v126, v127
    v_dot2_f32_bf16 v4, v12, v12, 0
    v_dot2_f32_bf16 v5, v13, v13, 0
    v_dot2_f32_bf16 v4, v14, v14, v4
    v_dot2_f32_bf16 v5, v15, v15, v5
    v_mfma_f32_16x16x32_bf16 v[240:243], v[184:187], v[12:15], 0
    v_cvt_pk_bf16_f32 v128, 0, v128
    v_cvt_pk_bf16_f32 v129, 0, v129
    v_cvt_pk_bf16_f32 v130, 0, v130
    v_cvt_pk_bf16_f32 v131, 0, v131
    v_cvt_pk_bf16_f32 v132, 0, v132
    v_cvt_pk_bf16_f32 v133, 0, v133
    v_cvt_pk_bf16_f32 v134, 0, v134
    v_cvt_pk_bf16_f32 v135, 0, v135
    v_pk_mul_f32 v[128:129], v[128:129], v[144:145]
    v_pk_mul_f32 v[130:131], v[130:131], v[146:147]
    v_pk_mul_f32 v[132:133], v[132:133], v[148:149]
    v_pk_mul_f32 v[134:135], v[134:135], v[150:151]
    v_cvt_pk_bf16_f32 v128, 0, v128
    v_cvt_pk_bf16_f32 v129, 0, v129
    v_cvt_pk_bf16_f32 v130, 0, v130
    v_cvt_pk_bf16_f32 v131, 0, v131
    v_cvt_pk_bf16_f32 v132, 0, v132
    v_cvt_pk_bf16_f32 v133, 0, v133
    v_cvt_pk_bf16_f32 v134, 0, v134
    v_cvt_pk_bf16_f32 v135, 0, v135
    v_pk_add_f32 v[128:129], v[128:129], v[160:161]
    v_pk_add_f32 v[130:131], v[130:131], v[162:163]
    v_pk_add_f32 v[132:133], v[132:133], v[164:165]
    v_pk_add_f32 v[134:135], v[134:135], v[166:167]
    v_cvt_pk_bf16_f32 v16, v128, v129
    v_cvt_pk_bf16_f32 v17, v130, v131
    v_cvt_pk_bf16_f32 v18, v132, v133
    v_cvt_pk_bf16_f32 v19, v134, v135
    v_dot2_f32_bf16 v4, v16, v16, v4
    v_dot2_f32_bf16 v5, v17, v17, v5
    v_dot2_f32_bf16 v4, v18, v18, v4
    v_dot2_f32_bf16 v5, v19, v19, v5
    v_mfma_f32_16x16x32_bf16 v[240:243], v[188:191], v[16:19], v[240:243]
    s_nop 1
    v_add_f32 v4, v4, v5
    v_mov_b32 v5, v4
    s_nop 1
    v_permlane32_swap_b32 v4, v5
    v_add_f32 v4, v4, v5
    v_mov_b32 v5, v4
    s_nop 1
    v_permlane16_swap_b32 v4, v5
    v_add_f32 v4, v4, v5
    s_nop 1
    v_mov_b32_dpp v240, v4 quad_perm:[0,1,2,3] row_mask:0x8 bank_mask:0xf
    buffer_store_dword v240, v55, s[32:35], s86 offen sc1
    s_barrier
    s_cmp_lg_u32 s3, 0
    s_cbranch_scc1 L_PE
    v_mov_b32 v6, s4
    s_mov_b32 exec_hi, 0
    s_mov_b32 exec_lo, 65535
    buffer_store_dword v6, v29, s[32:35], s87 offen sc1
    s_mov_b64 exec, -1
L_PE:
    s_add_u32 s82, s80, 57344
    s_lshl2_add_u32 m0, s83, 33792
    s_nop 0
    buffer_load_dwordx4 v27, s[56:59], s82 offen nt lds
    s_add_u32 s82, s80, 114688
    s_lshl2_add_u32 m0, s83, 34816
    s_nop 0
    buffer_load_dwordx4 v27, s[56:59], s82 offen nt lds
    s_lshl_b32 s15, s3, 12
    v_add_u32 v4, s15, v2
    v_add_u32 v7, 65536, v4
    s_waitcnt vmcnt(6)
    v_cmp_ne_u32 vcc, s4, v41
    s_cbranch_vccz L_UPOK
POLL_34:
    buffer_load_dwordx2 v[40:41], v10, s[32:35], s13 offen sc1
    s_waitcnt vmcnt(0)
    v_cmp_ne_u32 vcc, s4, v41
    s_cbranch_vccz PDONE_35
    s_add_u32 s5, s5, 1
    s_cmp_lt_u32 s5, 200000
    s_cbranch_scc1 POLL_34
PDONE_35:
L_UPOK:
    s_lshl3_add_u32 s96, s21, s3
    s_lshl_b32 s97, s96, 12
    s_add_u32 s14, s97, 12582912
    s_load_dwordx2 s[24:25], s[32:33], s92 offset:1536 glc
    v_add_f32_dpp v40, v40, v40 quad_perm:[1,0,3,2] row_mask:0xf bank_mask:0xf
    s_nop 1
    v_add_f32_dpp v40, v40, v40 quad_perm:[2,3,0,1] row_mask:0xf bank_mask:0xf
    s_nop 1
    v_add_f32_dpp v40, v40, v40 row_half_mirror row_mask:0xf bank_mask:0xf
    s_nop 1
    v_add_f32_dpp v40, v40, v40 row_mirror row_mask:0xf bank_mask:0xf
    v_lshlrev_b32 v152, 16, v12
    v_and_b32 v153, s6, v12
    v_lshlrev_b32 v154, 16, v13
    v_and_b32 v155, s6, v13
    v_lshlrev_b32 v156, 16, v14
    v_and_b32 v157, s6, v14
    v_lshlrev_b32 v158, 16, v15
    v_and_b32 v159, s6, v15
    v_lshlrev_b32 v160, 16, v16
    v_and_b32 v161, s6, v16
    v_lshlrev_b32 v162, 16, v17
    v_and_b32 v163, s6, v17
    v_lshlrev_b32 v164, 16, v18
    v_and_b32 v165, s6, v18
    v_lshlrev_b32 v166, 16, v19
    v_and_b32 v167, s6, v19
    s_lshl_b32 s96, s3, 9
    s_lshl1_add_u32 s15, s21, s96
    v_and_b32 v29, 15, v1
    v_lshl_add_u32 v29, v29, 5, s15
    v_xor_b32 v5, 0x4000, v4
    v_xor_b32 v8, 0x4000, v7
    s_waitcnt vmcnt(3)
    ds_write_b128 v4, v[72:75] offset:2048
    ds_write_b128 v4, v[76:79] offset:3072
    ds_write_b128 v4, v[80:83] offset:32768
    s_cmp_lt_u32 s3, 4
    s_cbranch_scc1 L_FW1
    ds_write_b128 v4, v[56:59] offset:0
    ds_write_b128 v5, v[60:63] offset:0
    ds_write_b128 v4, v[64:67] offset:1024
    ds_write_b128 v5, v[68:71] offset:1024
L_FW1:
    s_branch SCHK_37
SPOLL_36:
    s_load_dwordx2 s[24:25], s[32:33], s92 offset:1536 glc
SCHK_37:
    s_add_u32 s5, s5, 1
    s_cmp_ge_u32 s5, 200000
    s_waitcnt lgkmcnt(0)
    s_cbranch_scc1 SDONE_38
    s_cmp_lg_u32 s24, s4
    s_cbranch_scc1 SPOLL_36
    s_cmp_lg_u32 s25, s4
    s_cbranch_scc1 SPOLL_36
SDONE_38:
    s_barrier
    buffer_load_dwordx4 v[192:195], v2, s[32:35], s14 offen sc1
    buffer_load_dwordx4 v[196:199], v2, s[32:35], s14 offen offset:1024 sc1
    buffer_load_dwordx4 v[200:203], v2, s[32:35], s14 offen offset:2048 sc1
    buffer_load_dwordx4 v[204:207], v2, s[32:35], s14 offen offset:3072 sc1
    s_barrier
    s_add_u32 s82, s80, 172032
    s_lshl2_add_u32 m0, s83, 35840
    s_nop 0
    buffer_load_dwordx4 v27, s[56:59], s82 offen nt lds
    s_mov_b32 s82, s81
    s_lshl2_add_u32 m0, s83, 65536
    s_nop 0
    buffer_load_dwordx4 v253, s[60:63], s82 offen nt lds
    s_add_u32 s82, s81, 4096
    s_lshl2_add_u32 m0, s83, 66560
    s_nop 0
    buffer_load_dwordx4 v253, s[60:63], s82 offen nt lds
    v_mov_b32_dpp v168, v33 row_newbcast:0 row_mask:0xf bank_mask:0xf
    v_mov_b32_dpp v169, v33 row_newbcast:1 row_mask:0xf bank_mask:0xf
    v_mov_b32_dpp v170, v33 row_newbcast:2 row_mask:0xf bank_mask:0xf
    v_mov_b32_dpp v171, v33 row_newbcast:3 row_mask:0xf bank_mask:0xf
    v_mov_b32_dpp v172, v33 row_newbcast:4 row_mask:0xf bank_mask:0xf
    v_mov_b32_dpp v173, v33 row_newbcast:5 row_mask:0xf bank_mask:0xf
    v_mov_b32_dpp v174, v33 row_newbcast:6 row_mask:0xf bank_mask:0xf
    v_mov_b32_dpp v175, v33 row_newbcast:7 row_mask:0xf bank_mask:0xf
    v_mov_b32_dpp v176, v33 row_newbcast:8 row_mask:0xf bank_mask:0xf
    v_mov_b32_dpp v177, v33 row_newbcast:9 row_mask:0xf bank_mask:0xf
    v_mov_b32_dpp v178, v33 row_newbcast:10 row_mask:0xf bank_mask:0xf
    v_mov_b32_dpp v179, v33 row_newbcast:11 row_mask:0xf bank_mask:0xf
    v_mov_b32_dpp v180, v33 row_newbcast:12 row_mask:0xf bank_mask:0xf
    v_mov_b32_dpp v181, v33 row_newbcast:13 row_mask:0xf bank_mask:0xf
L_PAD9:
    s_cbranch_execz L_RET9
    v_mov_b32_dpp v182, v33 row_newbcast:14 row_mask:0xf bank_mask:0xf
    v_mov_b32_dpp v183, v33 row_newbcast:15 row_mask:0xf bank_mask:0xf
    v_mov_b32_dpp v88, v42 row_newbcast:0 row_mask:0xf bank_mask:0xf
    v_mov_b32_dpp v89, v42 row_newbcast:1 row_mask:0xf bank_mask:0xf
    v_mov_b32_dpp v90, v42 row_newbcast:2 row_mask:0xf bank_mask:0xf
    v_mov_b32_dpp v91, v42 row_newbcast:3 row_mask:0xf bank_mask:0xf
    v_mov_b32_dpp v92, v42 row_newbcast:4 row_mask:0xf bank_mask:0xf
    v_mov_b32_dpp v93, v42 row_newbcast:5 row_mask:0xf bank_mask:0xf
    v_mov_b32_dpp v94, v42 row_newbcast:6 row_mask:0xf bank_mask:0xf
    v_mov_b32_dpp v95, v42 row_newbcast:7 row_mask:0xf bank_mask:0xf
    v_mov_b32_dpp v96, v42 row_newbcast:8 row_mask:0xf bank_mask:0xf
    v_mov_b32_dpp v97, v42 row_newbcast:9 row_mask:0xf bank_mask:0xf
    v_mov_b32_dpp v98, v42 row_newbcast:10 row_mask:0xf bank_mask:0xf
    v_mov_b32_dpp v99, v42 row_newbcast:11 row_mask:0xf bank_mask:0xf
    v_mov_b32_dpp v100, v42 row_newbcast:12 row_mask:0xf bank_mask:0xf
    v_mov_b32_dpp v101, v42 row_newbcast:13 row_mask:0xf bank_mask:0xf
    v_mov_b32_dpp v102, v42 row_newbcast:14 row_mask:0xf bank_mask:0xf
    v_mov_b32_dpp v103, v42 row_newbcast:15 row_mask:0xf bank_mask:0xf
    v_mov_b32_dpp v104, v43 row_newbcast:0 row_mask:0xf bank_mask:0xf
    v_mov_b32_dpp v105, v43 row_newbcast:1 row_mask:0xf bank_mask:0xf
    v_mov_b32_dpp v106, v43 row_newbcast:2 row_mask:0xf bank_mask:0xf
    v_mov_b32_dpp v107, v43 row_newbcast:3 row_mask:0xf bank_mask:0xf
    v_mov_b32_dpp v108, v43 row_newbcast:4 row_mask:0xf bank_mask:0xf
    v_mov_b32_dpp v109, v43 row_newbcast:5 row_mask:0xf bank_mask:0xf
    v_mov_b32_dpp v110, v43 row_newbcast:6 row_mask:0xf bank_mask:0xf
    v_mov_b32_dpp v111, v43 row_newbcast:7 row_mask:0xf bank_mask:0xf
    v_mov_b32_dpp v112, v43 row_newbcast:8 row_mask:0xf bank_mask:0xf
    v_mov_b32_dpp v113, v43 row_newbcast:9 row_mask:0xf bank_mask:0xf
    v_mov_b32_dpp v114, v43 row_newbcast:10 row_mask:0xf bank_mask:0xf
    v_mov_b32_dpp v115, v43 row_newbcast:11 row_mask:0xf bank_mask:0xf
    v_mov_b32_dpp v116, v43 row_newbcast:12 row_mask:0xf bank_mask:0xf
    v_mov_b32_dpp v117, v43 row_newbcast:13 row_mask:0xf bank_mask:0xf
    v_mov_b32_dpp v118, v43 row_newbcast:14 row_mask:0xf bank_mask:0xf
    v_mov_b32_dpp v119, v43 row_newbcast:15 row_mask:0xf bank_mask:0xf
    s_lshl3_add_u32 s15, s3, 156160
    v_mov_b32 v4, s15
    v_and_b32 v5, 7, v1
    v_lshlrev_b32 v5, 3, v5
    v_add_u32 v5, 156160, v5
    v_and_b32 v6, 3, v1
    v_lshlrev_b32 v6, 18, v6
    v_bfe_u32 v9, v1, 2, 2
    v_lshl_add_u32 v6, v9, 13, v6
    s_and_b32 s96, s21, 1
    s_and_b32 s97, s12, 7
    s_lshr_b32 s98, s12, 3
    s_lshl3_add_u32 s99, s97, s98
    s_lshl_b32 s97, s99, 12
    s_lshr_b32 s98, s21, 1
    s_lshl_b32 s99, s98, 6
    s_add_u32 s98, s97, s99
    s_lshl4_add_u32 s97, s96, s98
    s_add_u32 s99, s97, 1048576
    s_add_u32 s16, s99, 2560
    s_waitcnt vmcnt(3)
    v_pk_add_f32 v[192:193], v[192:193], v[196:197]
    v_pk_add_f32 v[200:201], v[200:201], v[204:205]
    v_pk_add_f32 v[194:195], v[194:195], v[198:199]
    v_pk_add_f32 v[202:203], v[202:203], v[206:207]
    v_pk_add_f32 v[192:193], v[192:193], v[200:201]
    v_pk_add_f32 v[194:195], v[194:195], v[202:203]
    v_add_f32 v193, v193, v194
    v_add_f32 v197, v192, v195
    v_cmp_u_f32 vcc, v193, v197
    s_cbranch_vccz POK_40
PRE_41:
    buffer_load_dwordx4 v[192:195], v2, s[32:35], s14 offen sc1
    buffer_load_dwordx4 v[196:199], v2, s[32:35], s14 offen offset:1024 sc1
    buffer_load_dwordx4 v[200:203], v2, s[32:35], s14 offen offset:2048 sc1
    buffer_load_dwordx4 v[204:207], v2, s[32:35], s14 offen offset:3072 sc1
    s_waitcnt vmcnt(0)
    v_pk_add_f32 v[192:193], v[192:193], v[196:197]
    v_pk_add_f32 v[200:201], v[200:201], v[204:205]
    v_pk_add_f32 v[194:195], v[194:195], v[198:199]
    v_pk_add_f32 v[202:203], v[202:203], v[206:207]
    v_pk_add_f32 v[192:193], v[192:193], v[200:201]
    v_pk_add_f32 v[194:195], v[194:195], v[202:203]
    v_add_f32 v193, v193, v194
    v_add_f32 v197, v192, v195
    v_cmp_u_f32 vcc, v193, v197
    s_cbranch_vccz POK_40
    s_add_u32 s5, s5, 1
    s_cmp_lt_u32 s5, 200000
    s_cbranch_scc1 PRE_41
POK_40:
    v_mov_b32 v196, v195
    s_nop 1
    v_permlane32_swap_b32 v195, v196
    v_permlane32_swap_b32 v192, v193
    v_add_f32 v195, v195, v196
    v_add_f32 v192, v192, v193
    s_nop 1
    v_permlane16_swap_b32 v192, v195
    v_add_f32 v193, v192, v195
    v_add_f32 v195, v192, v195
    s_nop 1
    v_permlane16_swap_b32 v193, v195
    v_mov_b32 v192, v193
    v_mul_f32 v195, 0x3a800000, v195
    s_nop 0
    v_permlane32_swap_b32 v192, v193
    v_mul_f32 v192, 0x3a800000, v192
    v_fma_f32 v31, -v192, v192, v195
    v_cvt_pk_bf16_f32 v30, 0, v192
    v_max_f32 v31, 0, v31
    v_cvt_pk_bf16_f32 v31, 0, v31
    v_fma_f32 v193, -v30, v40, v193
    v_add_f32 v31, 0x3727c5ac, v31
    v_cvt_pk_bf16_f32 v31, 0, v31
    v_sqrt_f32 v31, v31
    s_nop 0
    v_cvt_pk_bf16_f32 v31, 0, v31
    v_rcp_f32 v31, v31
    s_nop 0
    v_mul_f32 v32, v193, v31
    v_ashrrev_i32 v196, 31, v32
    v_or_b32 v196, 0x80000000, v196
    v_xor_b32 v32, v32, v196
    s_mov_b32 s15, 0xfffff000
    v_and_or_b32 v32, v32, s15, v29
    s_nop 1
    v_max_u32_dpp v244, v32, v32 quad_perm:[1,0,3,2] row_mask:0xf bank_mask:0xf
    v_min_u32_dpp v245, v32, v32 quad_perm:[1,0,3,2] row_mask:0xf bank_mask:0xf
    s_nop 0
    v_min_u32_dpp v196, v244, v244 quad_perm:[2,3,0,1] row_mask:0xf bank_mask:0xf
    v_max_u32_dpp v245, v245, v245 quad_perm:[2,3,0,1] row_mask:0xf bank_mask:0xf
    v_max_u32_dpp v244, v244, v244 quad_perm:[2,3,0,1] row_mask:0xf bank_mask:0xf
    v_max_u32 v245, v245, v196
    s_nop 0
    v_min_u32_dpp v196, v244, v244 row_half_mirror row_mask:0xf bank_mask:0xf
    v_max_u32_dpp v245, v245, v245 row_half_mirror row_mask:0xf bank_mask:0xf
    v_max_u32_dpp v244, v244, v244 row_half_mirror row_mask:0xf bank_mask:0xf
    v_max_u32 v245, v245, v196
    s_nop 0
    v_min_u32_dpp v196, v244, v244 row_mirror row_mask:0xf bank_mask:0xf
    v_max_u32_dpp v245, v245, v245 row_mirror row_mask:0xf bank_mask:0xf
    v_max_u32_dpp v244, v244, v244 row_mirror row_mask:0xf bank_mask:0xf
    v_max_u32 v245, v245, v196
    ds_write_b64 v4, v[244:245]
    s_waitcnt lgkmcnt(0)
    s_barrier
    ds_read_b64 v[244:245], v5
    v_pk_add_f32 v[208:209], v[152:153], v[30:31] op_sel_hi:[1,0] neg_lo:[0,1] neg_hi:[0,1]
    v_pk_add_f32 v[210:211], v[154:155], v[30:31] op_sel_hi:[1,0] neg_lo:[0,1] neg_hi:[0,1]
    v_pk_add_f32 v[212:213], v[156:157], v[30:31] op_sel_hi:[1,0] neg_lo:[0,1] neg_hi:[0,1]
    v_pk_add_f32 v[214:215], v[158:159], v[30:31] op_sel_hi:[1,0] neg_lo:[0,1] neg_hi:[0,1]
    v_pk_add_f32 v[216:217], v[160:161], v[30:31] op_sel_hi:[1,0] neg_lo:[0,1] neg_hi:[0,1]
    v_pk_add_f32 v[218:219], v[162:163], v[30:31] op_sel_hi:[1,0] neg_lo:[0,1] neg_hi:[0,1]
    v_pk_add_f32 v[220:221], v[164:165], v[30:31] op_sel_hi:[1,0] neg_lo:[0,1] neg_hi:[0,1]
    v_pk_add_f32 v[222:223], v[166:167], v[30:31] op_sel_hi:[1,0] neg_lo:[0,1] neg_hi:[0,1]
    s_waitcnt lgkmcnt(0)
    v_min_u32_dpp v196, v244, v244 quad_perm:[1,0,3,2] row_mask:0xf bank_mask:0xf
    v_max_u32_dpp v245, v245, v245 quad_perm:[1,0,3,2] row_mask:0xf bank_mask:0xf
    v_max_u32_dpp v244, v244, v244 quad_perm:[1,0,3,2] row_mask:0xf bank_mask:0xf
    v_max_u32 v245, v245, v196
    s_nop 0
    v_min_u32_dpp v196, v244, v244 quad_perm:[2,3,0,1] row_mask:0xf bank_mask:0xf
    v_max_u32_dpp v245, v245, v245 quad_perm:[2,3,0,1] row_mask:0xf bank_mask:0xf
    v_max_u32_dpp v244, v244, v244 quad_perm:[2,3,0,1] row_mask:0xf bank_mask:0xf
    v_max_u32 v245, v245, v196
    s_nop 0
    v_min_u32_dpp v196, v244, v244 row_half_mirror row_mask:0xf bank_mask:0xf
    v_max_u32_dpp v245, v245, v245 row_half_mirror row_mask:0xf bank_mask:0xf
    v_max_u32_dpp v244, v244, v244 row_half_mirror row_mask:0xf bank_mask:0xf
    v_max_u32 v245, v245, v196
    v_cmp_eq_u32 s[88:89], v32, v245
    v_cmp_eq_u32 vcc, v32, v244
    v_or_b32 v246, 1, v245
    v_mov_b32 v245, s4
    v_mov_b32 v247, s4
    s_or_b64 s[84:85], vcc, s[88:89]
    s_cmp_lg_u32 s3, 0
    s_cbranch_scc1 L_NOF
    s_mov_b64 exec, 0xffff
    buffer_store_dwordx4 v[244:247], v6, s[32:35], s16 offen sc1
    s_mov_b64 exec, -1
L_NOF:
    s_cmp_eq_u64 s[84:85], 0
    s_cbranch_scc1 L_NOPR
    s_setprio 1
L_NOPR:
    s_lshl4_add_u32 s13, s3, 156288
    v_mov_b32 v4, s13
    v_and_b32 v5, 7, v1
    v_lshlrev_b32 v5, 4, v5
    v_add_u32 v5, 156288, v5
    s_load_dwordx8 s[24:31], s[32:33], s92 offset:2560 glc
    v_cvt_pk_bf16_f32 v208, 0, v208
    v_cvt_pk_bf16_f32 v209, 0, v209
    v_cvt_pk_bf16_f32 v210, 0, v210
    v_cvt_pk_bf16_f32 v211, 0, v211
    v_cvt_pk_bf16_f32 v212, 0, v212
    v_cvt_pk_bf16_f32 v213, 0, v213
    v_cvt_pk_bf16_f32 v214, 0, v214
    v_cvt_pk_bf16_f32 v215, 0, v215
    v_cvt_pk_bf16_f32 v216, 0, v216
    v_cvt_pk_bf16_f32 v217, 0, v217
    v_cvt_pk_bf16_f32 v218, 0, v218
    v_cvt_pk_bf16_f32 v219, 0, v219
    v_cvt_pk_bf16_f32 v220, 0, v220
    v_cvt_pk_bf16_f32 v221, 0, v221
    v_cvt_pk_bf16_f32 v222, 0, v222
    v_cvt_pk_bf16_f32 v223, 0, v223
    v_pk_mul_f32 v[208:209], v[30:31], v[208:209] op_sel:[1,0]
    v_pk_mul_f32 v[210:211], v[30:31], v[210:211] op_sel:[1,0]
    v_pk_mul_f32 v[212:213], v[30:31], v[212:213] op_sel:[1,0]
    v_pk_mul_f32 v[214:215], v[30:31], v[214:215] op_sel:[1,0]
    v_pk_mul_f32 v[216:217], v[30:31], v[216:217] op_sel:[1,0]
    v_pk_mul_f32 v[218:219], v[30:31], v[218:219] op_sel:[1,0]
    v_pk_mul_f32 v[220:221], v[30:31], v[220:221] op_sel:[1,0]
    v_pk_mul_f32 v[222:223], v[30:31], v[222:223] op_sel:[1,0]
    v_cvt_pk_bf16_f32 v208, 0, v208
    v_cvt_pk_bf16_f32 v209, 0, v209
    v_cvt_pk_bf16_f32 v210, 0, v210
    v_cvt_pk_bf16_f32 v211, 0, v211
    v_cvt_pk_bf16_f32 v212, 0, v212
    v_cvt_pk_bf16_f32 v213, 0, v213
    v_cvt_pk_bf16_f32 v214, 0, v214
    v_cvt_pk_bf16_f32 v215, 0, v215
    v_cvt_pk_bf16_f32 v216, 0, v216
    v_cvt_pk_bf16_f32 v217, 0, v217
    v_cvt_pk_bf16_f32 v218, 0, v218
    v_cvt_pk_bf16_f32 v219, 0, v219
    v_cvt_pk_bf16_f32 v220, 0, v220
    v_cvt_pk_bf16_f32 v221, 0, v221
    v_cvt_pk_bf16_f32 v222, 0, v222
    v_cvt_pk_bf16_f32 v223, 0, v223
    v_pk_mul_f32 v[208:209], v[208:209], v[168:169]
    v_pk_mul_f32 v[210:211], v[210:211], v[170:171]
    v_pk_mul_f32 v[212:213], v[212:213], v[172:173]
    v_pk_mul_f32 v[214:215], v[214:215], v[174:175]
    v_pk_mul_f32 v[216:217], v[216:217], v[176:177]
    v_pk_mul_f32 v[218:219], v[218:219], v[178:179]
    v_pk_mul_f32 v[220:221], v[220:221], v[180:181]
    v_pk_mul_f32 v[222:223], v[222:223], v[182:183]
    v_cvt_pk_bf16_f32 v208, 0, v208
    v_cvt_pk_bf16_f32 v209, 0, v209
    v_cvt_pk_bf16_f32 v210, 0, v210
    v_cvt_pk_bf16_f32 v211, 0, v211
    v_cvt_pk_bf16_f32 v212, 0, v212
    v_cvt_pk_bf16_f32 v213, 0, v213
    v_cvt_pk_bf16_f32 v214, 0, v214
    v_cvt_pk_bf16_f32 v215, 0, v215
    v_cvt_pk_bf16_f32 v216, 0, v216
    v_cvt_pk_bf16_f32 v217, 0, v217
    v_cvt_pk_bf16_f32 v218, 0, v218
    v_cvt_pk_bf16_f32 v219, 0, v219
    v_cvt_pk_bf16_f32 v220, 0, v220
    v_cvt_pk_bf16_f32 v221, 0, v221
    v_cvt_pk_bf16_f32 v222, 0, v222
    v_cvt_pk_bf16_f32 v223, 0, v223
    v_pk_add_f32 v[208:209], v[208:209], v[88:89]
    v_pk_add_f32 v[210:211], v[210:211], v[90:91]
    v_pk_add_f32 v[212:213], v[212:213], v[92:93]
    v_pk_add_f32 v[214:215], v[214:215], v[94:95]
    v_pk_add_f32 v[216:217], v[216:217], v[96:97]
    v_pk_add_f32 v[218:219], v[218:219], v[98:99]
    v_pk_add_f32 v[220:221], v[220:221], v[100:101]
    v_pk_add_f32 v[222:223], v[222:223], v[102:103]
    v_cvt_pk_bf16_f32 v224, v208, v209
    v_cvt_pk_bf16_f32 v225, v210, v211
    v_cvt_pk_bf16_f32 v226, v212, v213
    v_cvt_pk_bf16_f32 v227, v214, v215
    v_cvt_pk_bf16_f32 v228, v216, v217
    v_cvt_pk_bf16_f32 v229, v218, v219
    v_cvt_pk_bf16_f32 v230, v220, v221
    v_cvt_pk_bf16_f32 v231, v222, v223
    s_cmp_eq_u64 s[84:85], 0
    s_cbranch_scc1 L_NOCAND
    v_mfma_f32_16x16x32_bf16 v[240:243], v[184:187], v[224:227], 0
    v_mfma_f32_16x16x32_bf16 v[240:243], v[188:191], v[228:231], v[240:243]
    v_mov_b32 v232, v224
    v_mov_b32 v233, v225
    v_mov_b32 v234, v226
    v_mov_b32 v235, v227
    v_mov_b32 v236, v228
    v_mov_b32 v237, v229
    v_mov_b32 v238, v230
    v_mov_b32 v239, v231
    s_lshl_b32 s96, s21, 14
    s_lshl_b32 s97, s12, 9
    s_add_u32 s98, s96, s97
    s_add_u32 s15, s98, 13631488
    v_lshrrev_b32 v7, 4, v1
    v_lshlrev_b32 v7, 4, v7
    v_add_u32 v8, 8192, v7
    v_permlane32_swap_b32 v232, v234
    v_permlane32_swap_b32 v233, v235
    v_permlane32_swap_b32 v236, v238
    v_permlane32_swap_b32 v237, v239
    v_permlane32_swap_b32 v12, v14
    v_permlane32_swap_b32 v13, v15
    v_permlane32_swap_b32 v16, v18
    v_permlane32_swap_b32 v17, v19
    v_cndmask_b32 v7, v7, v8, s[88:89]
    s_mov_b64 exec, s[84:85]
    buffer_store_dwordx4 v[232:235], v7, s[32:35], s15 offen sc1
    buffer_store_dwordx4 v[236:239], v7, s[32:35], s15 offen offset:64 sc1
    s_mov_b32 exec_lo, 0
    s_and_b32 exec_hi, s85, 0xffff0000
    buffer_store_dword v240, v7, s[32:35], s15 offen offset:208 sc1
    s_mov_b64 exec, s[84:85]
    buffer_store_dwordx4 v[12:15], v7, s[32:35], s15 offen offset:128 sc1
    buffer_store_dwordx4 v[16:19], v7, s[32:35], s15 offen offset:192 sc1
    s_mov_b64 exec, -1
    s_setprio 0
L_NOCAND:
    s_add_u32 s82, s81, 8192
    s_lshl2_add_u32 m0, s83, 67584
    s_nop 0
    buffer_load_dwordx4 v253, s[60:63], s82 offen nt lds
    s_add_u32 s82, s81, 12288
    s_lshl2_add_u32 m0, s83, 68608
    s_nop 0
    buffer_load_dwordx4 v253, s[60:63], s82 offen nt lds
    v_lshlrev_b32 v208, 16, v224
    v_and_b32 v209, s6, v224
    v_lshlrev_b32 v210, 16, v225
    v_and_b32 v211, s6, v225
    v_lshlrev_b32 v212, 16, v226
    v_and_b32 v213, s6, v226
    v_lshlrev_b32 v214, 16, v227
    v_and_b32 v215, s6, v227
    v_lshlrev_b32 v216, 16, v228
    v_and_b32 v217, s6, v228
    v_lshlrev_b32 v218, 16, v229
    v_and_b32 v219, s6, v229
    v_lshlrev_b32 v220, 16, v230
    v_and_b32 v221, s6, v230
    v_lshlrev_b32 v222, 16, v231
    v_and_b32 v223, s6, v231
    v_pk_mul_f32 v[208:209], v[208:209], v[104:105]
    v_pk_mul_f32 v[210:211], v[210:211], v[106:107]
    v_pk_mul_f32 v[212:213], v[212:213], v[108:109]
    v_pk_mul_f32 v[214:215], v[214:215], v[110:111]
    v_pk_mul_f32 v[216:217], v[216:217], v[112:113]
    v_pk_mul_f32 v[218:219], v[218:219], v[114:115]
    v_pk_mul_f32 v[220:221], v[220:221], v[116:117]
    v_pk_mul_f32 v[222:223], v[222:223], v[118:119]
    v_cvt_pk_bf16_f32 v208, 0, v208
    v_cvt_pk_bf16_f32 v209, 0, v209
    v_cvt_pk_bf16_f32 v210, 0, v210
    v_cvt_pk_bf16_f32 v211, 0, v211
    v_cvt_pk_bf16_f32 v212, 0, v212
    v_cvt_pk_bf16_f32 v213, 0, v213
    v_cvt_pk_bf16_f32 v214, 0, v214
    v_cvt_pk_bf16_f32 v215, 0, v215
    v_cvt_pk_bf16_f32 v216, 0, v216
    v_cvt_pk_bf16_f32 v217, 0, v217
    v_cvt_pk_bf16_f32 v218, 0, v218
    v_cvt_pk_bf16_f32 v219, 0, v219
    v_cvt_pk_bf16_f32 v220, 0, v220
    v_cvt_pk_bf16_f32 v221, 0, v221
    v_cvt_pk_bf16_f32 v222, 0, v222
    v_cvt_pk_bf16_f32 v223, 0, v223
    s_branch SCHK_43
SPOLL_42:
    s_load_dwordx8 s[24:31], s[32:33], s92 offset:2560 glc
SCHK_43:
    s_add_u32 s5, s5, 1
    s_cmp_ge_u32 s5, 200000
    s_waitcnt lgkmcnt(0)
    s_cbranch_scc1 SDONE_44
    s_cmp_lg_u32 s25, s4
    s_cbranch_scc1 SPOLL_42
    s_cmp_lg_u32 s27, s4
    s_cbranch_scc1 SPOLL_42
    s_cmp_lg_u32 s29, s4
    s_cbranch_scc1 SPOLL_42
    s_cmp_lg_u32 s31, s4
    s_cbranch_scc1 SPOLL_42
SDONE_44:
    s_min_u32 s25, s24, s28
    s_min_u32 s27, s26, s28
    s_min_u32 s29, s24, s30
    s_max_u32 s24, s24, s28
    s_max_u32 s26, s26, s30
    s_max_u32 s27, s27, s29
    s_max_u32 s25, s25, s26
    v_mov_b32 v244, s24
    v_mov_b32 v246, s27
    v_mov_b32 v245, s25
    ds_write_b128 v4, v[244:247]
    s_waitcnt vmcnt(4)
    s_waitcnt lgkmcnt(0)
    s_barrier
    ds_read_b128 v[244:247], v5
    v_and_b32 v8, 8, v1
    v_cmp_eq_u32 s[22:23], 0, v8
    v_cmp_gt_u32 s[24:25], 16, v1
    v_cmp_gt_u32 s[26:27], 32, v1
    s_waitcnt lgkmcnt(0)
    v_min_u32_dpp v192, v244, v244 quad_perm:[1,0,3,2] row_mask:0xf bank_mask:0xf
    v_min_u32_dpp v193, v245, v244 quad_perm:[1,0,3,2] row_mask:0xf bank_mask:0xf
    v_min_u32_dpp v194, v244, v245 quad_perm:[1,0,3,2] row_mask:0xf bank_mask:0xf
    v_max_u32_dpp v246, v246, v246 quad_perm:[1,0,3,2] row_mask:0xf bank_mask:0xf
    v_max_u32_dpp v245, v245, v245 quad_perm:[1,0,3,2] row_mask:0xf bank_mask:0xf
    v_max_u32_dpp v244, v244, v244 quad_perm:[1,0,3,2] row_mask:0xf bank_mask:0xf
    v_max3_u32 v246, v246, v193, v194
    v_max_u32 v245, v245, v192
    v_min_u32_dpp v192, v244, v244 quad_perm:[2,3,0,1] row_mask:0xf bank_mask:0xf
    s_nop 0
    v_min_u32_dpp v193, v245, v244 quad_perm:[2,3,0,1] row_mask:0xf bank_mask:0xf
    v_min_u32_dpp v194, v244, v245 quad_perm:[2,3,0,1] row_mask:0xf bank_mask:0xf
    v_max_u32_dpp v246, v246, v246 quad_perm:[2,3,0,1] row_mask:0xf bank_mask:0xf
    v_max_u32_dpp v245, v245, v245 quad_perm:[2,3,0,1] row_mask:0xf bank_mask:0xf
    v_max_u32_dpp v244, v244, v244 quad_perm:[2,3,0,1] row_mask:0xf bank_mask:0xf
    v_max3_u32 v246, v246, v193, v194
    v_max_u32 v245, v245, v192
    v_min_u32_dpp v192, v244, v244 row_half_mirror row_mask:0xf bank_mask:0xf
    s_nop 0
    v_min_u32_dpp v193, v245, v244 row_half_mirror row_mask:0xf bank_mask:0xf
    v_min_u32_dpp v194, v244, v245 row_half_mirror row_mask:0xf bank_mask:0xf
    v_max_u32_dpp v246, v246, v246 row_half_mirror row_mask:0xf bank_mask:0xf
    v_max_u32_dpp v245, v245, v245 row_half_mirror row_mask:0xf bank_mask:0xf
    v_max_u32_dpp v244, v244, v244 row_half_mirror row_mask:0xf bank_mask:0xf
    v_max3_u32 v246, v246, v193, v194
    v_max_u32 v245, v245, v192
    v_cndmask_b32 v192, v245, v244, s[22:23]
    v_cndmask_b32 v201, v246, v245, s[26:27]
    v_and_b32 v193, 31, v246
    v_and_b32 v192, 31, v192
    v_cndmask_b32 v201, v201, v244, s[24:25]
    v_lshl_add_u32 v4, v192, 13, v52
    v_lshl_add_u32 v5, v193, 13, v52
    v_and_b32 v194, 31, v201
    v_lshl_add_u32 v6, v194, 13, v53
    buffer_load_dwordx4 v[192:195], v4, s[32:35], 0 offen sc1
    buffer_load_dwordx4 v[196:199], v5, s[32:35], 0 offen sc1
    buffer_load_dword v200, v6, s[32:35], 0 offen sc1
    v_readfirstlane_b32 s91, v244
    v_readfirstlane_b32 s94, v245
    v_readfirstlane_b32 s95, v246
    ds_read_b64_tr_b16 v[56:57], v34
    ds_read_b64_tr_b16 v[58:59], v34 offset:512
    ds_read_b64_tr_b16 v[60:61], v34 offset:1024
    ds_read_b64_tr_b16 v[62:63], v34 offset:1536
    ds_read_b64_tr_b16 v[64:65], v34 offset:2048
    ds_read_b64_tr_b16 v[66:67], v34 offset:2560
    ds_read_b64_tr_b16 v[68:69], v34 offset:3072
    ds_read_b64_tr_b16 v[70:71], v34 offset:3584
    ds_read_b64_tr_b16 v[72:73], v34 offset:4096
    ds_read_b64_tr_b16 v[74:75], v34 offset:4608
    ds_read_b64_tr_b16 v[76:77], v34 offset:5120
    ds_read_b64_tr_b16 v[78:79], v34 offset:5632
    ds_read_b64_tr_b16 v[80:81], v34 offset:6144
    ds_read_b64_tr_b16 v[82:83], v34 offset:6656
    ds_read_b64_tr_b16 v[84:85], v34 offset:7168
    ds_read_b64_tr_b16 v[86:87], v34 offset:7680
    s_lshl_b32 s96, s3, 11
    s_add_u32 s13, s96, 98304
    v_lshrrev_b32 v44, 4, v1
    v_lshlrev_b32 v44, 4, v44
    v_and_b32 v45, 7, v1
    v_lshlrev_b32 v45, 4, v45
    v_xor_b32 v44, v44, v45
    v_and_b32 v46, 15, v1
    v_lshl_add_u32 v46, v46, 7, s13
    v_add_u32 v44, v44, v46
    v_xor_b32 v46, 64, v44
    v_lshrrev_b32 v47, 3, v1
    v_lshlrev_b32 v47, 4, v47
    v_xor_b32 v45, v47, v45
    v_lshrrev_b32 v47, 3, v1
    v_lshl_add_u32 v47, v47, 7, s13
    v_add_u32 v45, v45, v47
    s_lshl_b32 s96, s21, 7
    s_sub_u32 s97, 2047, s96
    s_lshl_b32 s98, s3, 4
    s_sub_u32 s13, s97, s98
    v_lshrrev_b32 v43, 3, v1
    v_sub_u32 v42, s13, v43
    v_subrev_u32 v43, 8, v42
    v_lshrrev_b32 v33, 3, v1
    v_lshlrev_b32 v33, 11, v33
    v_and_b32 v9, 7, v1
    v_lshl_add_u32 v33, v9, 4, v33
    v_pk_add_f32 v[208:209], v[208:209], v[152:153]
    v_pk_add_f32 v[210:211], v[210:211], v[154:155]
    v_pk_add_f32 v[212:213], v[212:213], v[156:157]
    v_pk_add_f32 v[214:215], v[214:215], v[158:159]
    v_pk_add_f32 v[216:217], v[216:217], v[160:161]
    v_pk_add_f32 v[218:219], v[218:219], v[162:163]
    v_pk_add_f32 v[220:221], v[220:221], v[164:165]
    v_pk_add_f32 v[222:223], v[222:223], v[166:167]
    v_cvt_pk_bf16_f32 v232, v208, v209
    v_cvt_pk_bf16_f32 v233, v210, v211
    v_cvt_pk_bf16_f32 v234, v212, v213
    v_cvt_pk_bf16_f32 v235, v214, v215
    v_cvt_pk_bf16_f32 v236, v216, v217
    v_cvt_pk_bf16_f32 v237, v218, v219
    v_cvt_pk_bf16_f32 v238, v220, v221
    v_cvt_pk_bf16_f32 v239, v222, v223
    v_permlane32_swap_b32 v232, v234
    v_permlane32_swap_b32 v233, v235
    v_permlane32_swap_b32 v236, v238
    v_permlane32_swap_b32 v237, v239
    ds_write_b128 v44, v[232:235]
    ds_write_b128 v46, v[236:239]
    ds_read_b128 v[232:235], v45
    ds_read_b128 v[236:239], v45 offset:1024
    s_waitcnt lgkmcnt(0)
    v_bfe_u32 v7, v201, 1, 4
    v_bfe_u32 v201, v201, 5, 7
    v_lshl_or_b32 v201, v7, 7, v201
    v_xor_b32 v201, 0x7ff, v201
    s_waitcnt vmcnt(0)
    v_max3_u32 v7, v192, v196, v200
    v_cmp_eq_u32 vcc, -1, v7
    s_cbranch_vccz POK_46
PRE_47:
    buffer_load_dwordx4 v[192:195], v4, s[32:35], 0 offen sc1
    buffer_load_dwordx4 v[196:199], v5, s[32:35], 0 offen sc1
    buffer_load_dword v200, v6, s[32:35], 0 offen sc1
    s_waitcnt vmcnt(0)
    v_max3_u32 v7, v192, v196, v200
    v_cmp_eq_u32 vcc, -1, v7
    s_cbranch_vccz POK_46
    s_add_u32 s5, s5, 1
    s_cmp_lt_u32 s5, 200000
    s_cbranch_scc1 PRE_47
POK_46:
    v_add_f32_dpp v200, v200, v200 quad_perm:[1,0,3,2] row_mask:0xf bank_mask:0xf
    s_nop 1
    v_add_f32_dpp v200, v200, v200 quad_perm:[2,3,0,1] row_mask:0xf bank_mask:0xf
    s_nop 1
    v_add_f32_dpp v200, v200, v200 row_half_mirror row_mask:0xf bank_mask:0xf
    s_nop 1
    v_add_f32_dpp v200, v200, v200 row_mirror row_mask:0xf bank_mask:0xf
    v_cvt_pk_bf16_f32 v200, 0, v200
    v_ashrrev_i32 v7, 31, v200
    v_or_b32 v7, 0x80000000, v7
    v_xor_b32 v200, v200, v7
    v_lshrrev_b32 v200, 16, v200
    v_lshl_or_b32 v200, v200, 11, v201
    s_nop 0
    v_readlane_b32 s24, v200, 0
    v_readlane_b32 s25, v200, 16
    v_readlane_b32 s26, v200, 32
    s_not_b64 s[28:29], s[22:23]
    s_cmp_lt_u32 s24, s25
    s_cselect_b64 s[28:29], s[22:23], s[28:29]
    s_cselect_b32 s27, s24, s25
    s_cmp_gt_u32 s26, s27
    s_cselect_b64 vcc, s[28:29], 0
    v_cndmask_b32 v192, v192, v196, vcc
    v_cndmask_b32 v193, v193, v197, vcc
    v_cndmask_b32 v194, v194, v198, vcc
    v_cndmask_b32 v195, v195, v199, vcc
    s_bitcmp1_b32 vcc_lo, 0
    s_cselect_b32 s24, s26, s24
    s_cselect_b32 s19, s17, s19
    s_cselect_b32 s17, s95, s91
    s_bitcmp1_b32 vcc_lo, 8
    s_cselect_b32 s25, s26, s25
    s_cselect_b32 s19, s18, s19
    s_cselect_b32 s18, s95, s94
    s_waitcnt lgkmcnt(0)
    v_mfma_f32_16x16x32_bf16 v[136:139], v[192:195], v[56:59], 0
    v_mfma_f32_16x16x32_bf16 v[140:143], v[192:195], v[60:63], 0
    v_mfma_f32_16x16x32_bf16 v[144:147], v[192:195], v[64:67], 0
    v_mfma_f32_16x16x32_bf16 v[148:151], v[192:195], v[68:71], 0
    v_mfma_f32_16x16x32_bf16 v[168:171], v[192:195], v[72:75], 0
    v_mfma_f32_16x16x32_bf16 v[172:175], v[192:195], v[76:79], 0
    v_mfma_f32_16x16x32_bf16 v[176:179], v[192:195], v[80:83], 0
    v_mfma_f32_16x16x32_bf16 v[180:183], v[192:195], v[84:87], 0
    s_nop 1
    v_add_f32 v196, v136, v141
    s_nop 0
    v_add_f32 v197, v146, v151
    s_nop 0
    v_add_f32 v198, v168, v173
    s_nop 0
    v_add_f32 v199, v178, v183
    v_add_f32 v196, v196, v197
    v_add_f32 v198, v198, v199
    v_mov_b32 v197, s4
    s_nop 0
    v_permlane16_swap_b32 v198, v199
    s_cmp_ge_u32 s9, 28
    s_cbranch_scc1 L_NOHP
    v_add_f32 v196, v196, v199
    s_mov_b32 exec_lo, 0xffff
    s_mov_b32 exec_hi, 0xffff
    buffer_store_dwordx2 v[196:197], v54, s[32:35], s73 offen sc1
    s_mov_b64 exec, -1
L_NOHP:
    s_and_b32 s68, s24, 2047
    s_and_b32 s69, s25, 2047
    s_waitcnt lgkmcnt(0)
    s_cmp_lg_u32 s93, 7
    s_cbranch_scc1 L_NONON
    v_mov_b32 v6, s4
    v_mov_b32 v7, 0
    s_mov_b64 exec, 1
    buffer_store_dword v6, v7, s[32:35], 0 offen sc1
    s_mov_b64 exec, -1
L_NONON:
    s_cmp_ge_u32 s9, 28
    s_cbranch_scc1 L_FIN3
    v_bfe_u32 v192, v1, 2, 1
    v_lshlrev_b32 v192, 7, v192
    v_lshrrev_b32 v9, 5, v1
    v_lshl_add_u32 v192, v9, 4, v192
    v_add_u32 v192, 156672, v192
    v_lshrrev_b32 v193, 4, v1
    v_mul_u32_u24 v193, 7168, v193
    v_and_b32 v9, 15, v1
    v_lshl_add_u32 v193, v9, 3, v193
    s_lshl3_add_u32 s96, s75, s3
    s_mul_i32 s97, s96, 28672
    s_lshl_b32 s98, s74, 7
    s_add_u32 s99, s97, s98
    s_add_u32 s80, s99, 22020096
    v_and_b32 v194, 1, v1
    v_lshlrev_b32 v194, 13, v194
    v_bfe_u32 v9, v1, 1, 1
    v_lshl_add_u32 v194, v9, 18, v194
    s_lshr_b32 s96, s9, 2
    s_and_b32 s97, s75, 1
    s_lshr_b32 s98, s3, 1
    s_lshl2_add_u32 s99, s97, s98
    s_and_b32 s97, s3, 1
    s_lshr_b32 s98, s75, 1
    s_lshl2_add_u32 s97, s97, s98
    s_lshl3_add_u32 s98, s99, s97
    s_lshl_b32 s99, s98, 12
    s_lshl_b32 s97, s8, 6
    s_add_u32 s98, s99, s97
    s_lshl2_add_u32 s99, s96, s98
    s_add_u32 s97, s99, 1048576
    s_add_u32 s81, s97, 3072
    s_cmp_lt_u32 s3, 4
    s_cbranch_scc1 L_HW
    s_barrier
    ds_read_b64_tr_b16 v[120:121], v35
    ds_read_b64_tr_b16 v[122:123], v35 offset:1024
    ds_read_b64_tr_b16 v[124:125], v35 offset:8192
    ds_read_b64_tr_b16 v[126:127], v35 offset:9216
    ds_read_b64_tr_b16 v[128:129], v35 offset:16384
    ds_read_b64_tr_b16 v[130:131], v35 offset:17408
    ds_read_b64_tr_b16 v[132:133], v35 offset:24576
    ds_read_b64_tr_b16 v[134:135], v35 offset:25600
    s_cmp_lg_u32 s3, 7
    s_cbranch_scc1 L_NOH
    s_bitcmp1_b32 s9, 3
    s_cselect_b32 s15, s25, s24
    s_cselect_b32 s17, s18, s17
    s_andn2_b32 s18, 2047, s15
    s_lshr_b32 s96, s8, 1
    s_lshl2_add_u32 s19, s12, s96
    s_lshr_b32 s96, s19, 1
    s_lshr_b32 s97, s9, 3
    s_lshl_b32 s98, s97, 1
    s_lshl2_add_u32 s99, s96, s98
    s_and_b32 s97, s19, 1
    s_add_u32 s96, s99, s97
    s_mul_i32 s98, s96, 7168
    s_add_u32 s20, s98, 22020096
    s_lshl_b32 s96, s18, 11
    s_lshl_b32 s97, s19, 5
    s_add_u32 s82, s96, s97
    v_and_b32 v10, 7, v1
    v_lshlrev_b32 v10, 2, v10
    s_lshr_b32 s96, s8, 1
    s_lshl_b32 s97, s96, 6
    s_add_u32 s13, s97, 157184
    v_and_b32 v5, 7, v1
    v_lshl_add_u32 v5, v5, 3, s13
    ds_read_b64 v[206:207], v5
    s_and_b32 s96, s17, 31
L_PAD10:
    s_cbranch_execz L_RET10
    s_lshl_b32 s97, s96, 13
    s_lshl_b32 s98, s12, 9
    s_add_u32 s99, s97, s98
    s_lshr_b32 s96, s8, 1
    s_lshl_b32 s97, s96, 5
    s_add_u32 s98, s99, s97
    s_add_u32 s91, s98, 13631488
    s_lshr_b32 s13, s15, 11
    s_lshl_b32 s13, s13, 16
    s_ashr_i32 s15, s13, 31
    s_andn2_b32 s15, 0x7fff0000, s15
    s_or_b32 s15, s15, 0x80000000
    s_xor_b32 s13, s13, s15
    v_mov_b32 v204, s13
    v_mul_f32 v204, s7, v204
    v_exp_f32 v204, -v204
    s_nop 0
    v_add_f32 v204, 1.0, v204
    v_rcp_f32 v204, v204
    s_nop 0
    v_cvt_pk_bf16_f32 v204, 0, v204
    v_mov_b32 v5, s4
    v_not_b32 v6, v5
POLL_48:
    buffer_load_dword v244, v10, s[32:35], s91 offen sc1
    buffer_load_dword v245, v10, s[32:35], s91 offen offset:128 sc1
    s_waitcnt vmcnt(0)
    v_max_u32 v246, v244, v245
    v_cmp_ne_u32 vcc, -1, v246
    s_nop 1
    v_cndmask_b32 v246, v6, v5, vcc
    v_cmp_ne_u32 vcc, s4, v246
    s_cbranch_vccz PDONE_49
    s_add_u32 s5, s5, 1
    s_cmp_lt_u32 s5, 200000
    s_cbranch_scc1 POLL_48
PDONE_49:
    v_lshlrev_b32 v246, 16, v245
    v_and_b32 v247, s6, v245
    v_and_b32 v245, s6, v244
    v_lshlrev_b32 v244, 16, v244
    s_branch L_NOH
L_HW:
    s_lshl_b32 s96, s3, 8
    s_add_u32 s13, s96, s72
    v_lshrrev_b32 v4, 4, v1
    v_lshlrev_b32 v4, 11, v4
    v_and_b32 v9, 15, v1
    v_lshl_add_u32 v4, v9, 4, v4
    s_lshl_b32 s96, s3, 5
    s_add_u32 s15, s96, 156672
    v_lshrrev_b32 v5, 5, v1
    v_lshl_add_u32 v5, v5, 7, s15
    v_bfe_u32 v9, v1, 2, 1
    v_lshl_add_u32 v5, v9, 4, v5
    v_bfe_u32 v9, v1, 1, 1
    v_lshl_add_u32 v5, v9, 3, v5
    v_bfe_u32 v9, v1, 3, 1
    v_lshl_add_u32 v5, v9, 2, v5
    v_and_b32 v9, 1, v1
    v_lshl_add_u32 v5, v9, 1, v5
    s_load_dword s24, s[32:33], s13 offset:1276 glc
    s_load_dword s25, s[32:33], s13 offset:3324 glc
    s_load_dword s26, s[32:33], s13 offset:5372 glc
    s_load_dword s27, s[32:33], s13 offset:7420 glc
    s_barrier
    ds_read_b64_tr_b16 v[120:121], v35
    ds_read_b64_tr_b16 v[122:123], v35 offset:1024
    ds_read_b64_tr_b16 v[124:125], v35 offset:8192
    ds_read_b64_tr_b16 v[126:127], v35 offset:9216
    ds_read_b64_tr_b16 v[128:129], v35 offset:16384
    ds_read_b64_tr_b16 v[130:131], v35 offset:17408
    ds_read_b64_tr_b16 v[132:133], v35 offset:24576
    ds_read_b64_tr_b16 v[134:135], v35 offset:25600
    s_branch SCHK_51
SPOLL_50:
    s_load_dword s24, s[32:33], s13 offset:1276 glc
    s_load_dword s25, s[32:33], s13 offset:3324 glc
    s_load_dword s26, s[32:33], s13 offset:5372 glc
    s_load_dword s27, s[32:33], s13 offset:7420 glc
SCHK_51:
    s_add_u32 s5, s5, 1
    s_cmp_ge_u32 s5, 200000
    s_waitcnt lgkmcnt(0)
    s_cbranch_scc1 SDONE_52
    s_cmp_lg_u32 s24, s4
    s_cbranch_scc1 SPOLL_50
    s_cmp_lg_u32 s25, s4
    s_cbranch_scc1 SPOLL_50
    s_cmp_lg_u32 s26, s4
    s_cbranch_scc1 SPOLL_50
    s_cmp_lg_u32 s27, s4
    s_cbranch_scc1 SPOLL_50
SDONE_52:
POLL_53:
    buffer_load_dwordx4 v[88:91], v4, s[32:35], s13 offen sc1
    buffer_load_dwordx4 v[92:95], v4, s[32:35], s13 offen offset:1024 sc1
    s_waitcnt vmcnt(0)
    v_bitop3_b32 v6, v89, v91, s4 bitop3:0x7e
    v_bitop3_b32 v6, v6, v93, s4 bitop3:0xf6
    v_bitop3_b32 v6, v6, v95, s4 bitop3:0xf6
    v_cmp_ne_u32 vcc, 0, v6
    s_cbranch_vccz PDONE_54
    s_add_u32 s5, s5, 1
    s_cmp_lt_u32 s5, 200000
    s_cbranch_scc1 POLL_53
PDONE_54:
    v_permlane32_swap_b32 v88, v90
    v_permlane32_swap_b32 v92, v94
    v_add_f32 v88, v88, v90
    v_add_f32 v92, v92, v94
    v_mov_b32 v90, v88
    v_mov_b32 v94, v92
    s_nop 0
    v_permlane16_swap_b32 v88, v90
    v_permlane16_swap_b32 v92, v94
    v_add_f32 v88, v88, v90
    v_add_f32 v92, v92, v94
    v_cvt_pk_bf16_f32 v88, 0, v88
    v_cvt_pk_bf16_f32 v92, 0, v92
    v_mul_f32 v6, s7, v88
    v_exp_f32 v6, -v6
    s_nop 0
    v_add_f32 v6, 1.0, v6
    v_rcp_f32 v6, v6
    s_nop 0
    v_mul_f32 v88, v88, v6
    v_cvt_pk_bf16_f32 v88, 0, v88
    v_mul_f32 v88, v88, v92
    v_cvt_pk_bf16_f32 v88, v88, v88
    ds_write_b16 v5, v88
L_NOH:
    s_waitcnt lgkmcnt(0)
    s_barrier
    ds_read_b128 v[88:91], v192
    ds_read_b128 v[92:95], v192 offset:32
    ds_read_b128 v[96:99], v192 offset:64
    ds_read_b128 v[100:103], v192 offset:96
    s_waitcnt lgkmcnt(3)
    v_mfma_f32_32x32x16_bf16 v[208:223], v[88:91], v[120:123], 0
    s_waitcnt lgkmcnt(2)
    v_mfma_f32_32x32x16_bf16 v[208:223], v[92:95], v[124:127], v[208:223]
    s_waitcnt lgkmcnt(1)
    v_mfma_f32_32x32x16_bf16 v[208:223], v[96:99], v[128:131], v[208:223]
    s_waitcnt lgkmcnt(0)
    v_mfma_f32_32x32x16_bf16 v[208:223], v[100:103], v[132:135], v[208:223]
    s_nop 11
    v_mov_b32 v209, s4
    buffer_store_dwordx2 v[208:209], v193, s[32:35], s80 offen sc1
    s_mov_b64 exec, 15
    buffer_store_dword v209, v194, s[32:35], s81 offen sc1
    s_mov_b64 exec, -1
    s_barrier
    s_branch L_FIN2
L_FIN3:
    s_waitcnt lgkmcnt(0)
L_FIN2:
    v_cmp_ne_u32 vcc, s68, v42
    v_cmp_ne_u32 s[22:23], s69, v42
    s_nop 0
    s_and_b64 exec, vcc, s[22:23]
    buffer_store_dwordx4 v[232:235], v33, s[64:67], s70 offen sc1
    s_mov_b64 exec, -1
    v_cmp_ne_u32 vcc, s68, v43
    v_cmp_ne_u32 s[22:23], s69, v43
    s_nop 0
    s_and_b64 exec, vcc, s[22:23]
    buffer_store_dwordx4 v[236:239], v33, s[64:67], s71 offen sc1
    s_mov_b64 exec, -1
    s_cmp_ge_u32 s9, 16
    s_cbranch_scc1 L_FIN
SPOLL_55:
    s_load_dwordx8 s[24:31], s[32:33], s92 offset:3072 glc
SCHK_56:
    s_add_u32 s5, s5, 1
    s_cmp_ge_u32 s5, 200000
    s_waitcnt lgkmcnt(0)
    s_cbranch_scc1 SDONE_57
    s_cmp_lg_u32 s24, s4
    s_cbranch_scc1 SPOLL_55
    s_cmp_lg_u32 s25, s4
    s_cbranch_scc1 SPOLL_55
    s_cmp_lg_u32 s26, s4
    s_cbranch_scc1 SPOLL_55
    s_cmp_lg_u32 s27, s4
    s_cbranch_scc1 SPOLL_55
    s_cmp_lg_u32 s28, s4
    s_cbranch_scc1 SPOLL_55
    s_cmp_lg_u32 s29, s4
    s_cbranch_scc1 SPOLL_55
    s_cmp_lg_u32 s30, s4
    s_cbranch_scc1 SPOLL_55
SDONE_57:
    s_barrier
    s_cmp_lg_u32 s3, 7
    s_cbranch_scc1 L_FIN
    s_add_u32 s13, s20, 4096
POLL_58:
    buffer_load_dwordx4 v[88:91], v2, s[32:35], s20 offen sc1
    buffer_load_dwordx4 v[92:95], v2, s[32:35], s20 offen offset:1024 sc1
    buffer_load_dwordx4 v[96:99], v2, s[32:35], s20 offen offset:2048 sc1
    buffer_load_dwordx4 v[100:103], v2, s[32:35], s20 offen offset:3072 sc1
    buffer_load_dwordx4 v[104:107], v2, s[32:35], s13 offen sc1
    buffer_load_dwordx4 v[108:111], v2, s[32:35], s13 offen offset:1024 sc1
    buffer_load_dwordx4 v[112:115], v2, s[32:35], s13 offen offset:2048 sc1
    s_waitcnt vmcnt(0)
    v_bitop3_b32 v4, v89, v91, s4 bitop3:0x7e
    v_bitop3_b32 v4, v4, v93, s4 bitop3:0xf6
    v_bitop3_b32 v4, v4, v95, s4 bitop3:0xf6
    v_bitop3_b32 v4, v4, v97, s4 bitop3:0xf6
    v_bitop3_b32 v4, v4, v99, s4 bitop3:0xf6
    v_bitop3_b32 v4, v4, v101, s4 bitop3:0xf6
    v_bitop3_b32 v4, v4, v103, s4 bitop3:0xf6
    v_bitop3_b32 v4, v4, v105, s4 bitop3:0xf6
    v_bitop3_b32 v4, v4, v107, s4 bitop3:0xf6
    v_bitop3_b32 v4, v4, v109, s4 bitop3:0xf6
    v_bitop3_b32 v4, v4, v111, s4 bitop3:0xf6
    v_bitop3_b32 v4, v4, v113, s4 bitop3:0xf6
    v_bitop3_b32 v4, v4, v115, s4 bitop3:0xf6
    v_cmp_ne_u32 vcc, 0, v4
    s_cbranch_vccz PDONE_59
    s_add_u32 s5, s5, 1
    s_cmp_lt_u32 s5, 200000
    s_cbranch_scc1 POLL_58
PDONE_59:
    v_add_f32 v88, v88, v92
    v_add_f32 v90, v90, v94
    v_add_f32 v96, v96, v100
    v_add_f32 v98, v98, v102
    v_add_f32 v104, v104, v108
    v_add_f32 v106, v106, v110
    v_add_f32 v88, v88, v96
    v_add_f32 v90, v90, v98
    v_add_f32 v104, v104, v112
    v_add_f32 v106, v106, v114
    v_add_f32 v88, v88, v104
    v_add_f32 v89, v90, v106
    s_nop 1
    v_permlane32_swap_b32 v88, v89
    v_add_f32 v88, v88, v89
    s_nop 1
    v_add_f32_dpp v88, v88, v88 row_ror:8 row_mask:0xf bank_mask:0xf
    v_mov_b32 v89, v88
    s_nop 1
    v_permlane16_swap_b32 v88, v89
    v_add_f32 v89, v88, v89
    v_cvt_pk_bf16_f32 v88, 0, v89
    v_cvt_pk_bf16_f32 v89, 0, v89
    s_nop 1
    v_permlane32_swap_b32 v88, v89
    v_pk_mul_f32 v[88:89], v[88:89], v[204:205] op_sel_hi:[1,0]
    v_cvt_pk_bf16_f32 v88, 0, v88
    v_cvt_pk_bf16_f32 v89, 0, v89
    v_pk_add_f32 v[88:89], v[88:89], v[244:245]
    v_cvt_pk_bf16_f32 v88, 0, v88
    v_cvt_pk_bf16_f32 v89, 0, v89
    v_pk_mul_f32 v[88:89], v[88:89], v[206:207]
    v_cvt_pk_bf16_f32 v88, 0, v88
    v_cvt_pk_bf16_f32 v89, 0, v89
    v_pk_add_f32 v[88:89], v[88:89], v[246:247]
    v_cvt_pk_bf16_f32 v88, v88, v89
    s_mov_b64 exec, 0xff
    buffer_store_dword v88, v10, s[64:67], s82 offen
    s_mov_b64 exec, -1
L_FIN:
L_END:
    s_endpgm
.p2align 10
.fill 768, 4, 0xbf800000
.section .rodata,"a"
.p2align 6
.amdhsa_kernel adaLN_cond__linear_kernel_hedgehog__moe_arch_mod__prompt_kernel
  .amdhsa_next_free_vgpr 256
  .amdhsa_next_free_sgpr 102
  .amdhsa_accum_offset 256
  .amdhsa_group_segment_fixed_size 0
  .amdhsa_kernarg_size 112
  .amdhsa_user_sgpr_count 2
  .amdhsa_user_sgpr_kernarg_segment_ptr 1
  .amdhsa_system_sgpr_workgroup_id_x 1
  .amdhsa_float_denorm_mode_32 3
  .amdhsa_float_denorm_mode_16_64 3
.end_amdhsa_kernel
```

```asm
; @launch grid=(256,1,1) block=(512,1,1) lds=163840
.amdgcn_target "amdgcn-amd-amdhsa--gfx950"
.text
.globl adaLN_cond__linear_kernel_hedgehog__moe_arch_mod__prompt_kernel
.p2align 12
.type adaLN_cond__linear_kernel_hedgehog__moe_arch_mod__prompt_kernel,@function
adaLN_cond__linear_kernel_hedgehog__moe_arch_mod__prompt_kernel:
    s_load_dwordx16 s[68:83], s[0:1], 0
    s_load_dwordx8 s[84:91], s[0:1], 64
    s_load_dwordx2 s[32:33], s[0:1], 104
    s_cmp_ge_u32 s2, 256
    s_cbranch_scc1 L_END
    v_lshrrev_b32 v4, 6, v0
    v_and_b32 v1, 63, v0
    s_nop 0
    v_readfirstlane_b32 s3, v4
    v_lshlrev_b32 v2, 4, v1
    s_mov_b32 s38, 4194304
    s_mov_b32 s39, 0x20000
    s_mov_b32 s50, 12582912
    s_mov_b32 s51, 0x20000
    s_mov_b32 s34, 268435456
    s_mov_b32 s35, 0x20000
    s_mov_b32 s42, 6291456
    s_mov_b32 s43, 0x20000
    s_mov_b32 s46, 2097152
    s_mov_b32 s47, 0x20000
    s_mov_b32 s54, 7340032
    s_mov_b32 s55, 0x20000
    s_mov_b32 s58, 7340032
    s_mov_b32 s59, 0x20000
    s_mov_b32 s62, 7340032
    s_mov_b32 s63, 0x20000
    s_mov_b32 s66, 4194304
    s_mov_b32 s67, 0x20000
    s_mov_b32 s5, 0
    s_mov_b32 s6, 0xffff0000
    s_mov_b32 s7, 0x3fb8aa3b
    s_and_b32 s8, s2, 7
    s_lshr_b32 s9, s2, 3
    s_lshl3_add_u32 s93, s2, s3
    s_and_b32 s96, s8, 4
    s_lshr_b32 s97, s9, 2
    s_lshl1_add_u32 s10, s96, s97
    s_and_b32 s96, s8, 3
    s_and_b32 s97, s9, 3
    s_xor_b32 s98, s97, 2
    s_lshl2_add_u32 s11, s96, s98
    s_and_b32 s96, s8, 1
    s_and_b32 s97, s9, 7
    s_lshl3_add_u32 s12, s96, s97
    s_lshr_b32 s96, s8, 1
    s_lshr_b32 s97, s9, 3
    s_lshl2_add_u32 s21, s96, s97
    s_lshl_b32 s96, s2, 6
    s_add_u32 s97, s96, s3
    s_lshl_b32 s98, s97, 6
    s_add_u32 s92, s98, 1048576
    s_lshr_b32 s96, s8, 1
    s_lshl_b32 s97, s96, 8
    s_lshl3_add_u32 s98, s9, s97
    s_add_u32 s99, s98, s3
    s_lshl_b32 s96, s99, 12
    s_and_b32 s97, s8, 1
    s_lshl_b32 s98, s97, 10
    s_add_u32 s16, s96, s98
    v_and_b32 v8, 31, v1
    v_lshlrev_b32 v8, 4, v8
    v_lshrrev_b32 v9, 5, v1
    v_lshl_add_u32 v8, v9, 11, v8
    s_lshl3_add_u32 s96, s8, s3
    s_lshl_b32 s15, s96, 5
    s_mul_i32 s96, s15, 6144
    s_xor_b32 s97, s9, 1
    s_lshl_b32 s98, s97, 7
    s_add_u32 s13, s96, s98
    s_add_u32 s14, s13, 12288
    s_lshl3_add_u32 s96, s21, s3
    s_lshl_b32 s97, s96, 15
    s_lshl_b32 s98, s12, 7
    s_add_u32 s18, s97, s98
    s_lshr_b32 s96, s8, 1
    s_lshl4_add_u32 s97, s96, s12
    s_lshl4_add_u32 s98, s97, s3
    s_lshl_b32 s99, s98, 9
    s_add_u32 s17, s99, 524288
    v_lshrrev_b32 v248, 3, v1
    v_mul_u32_u24 v248, 24576, v248
    v_and_b32 v9, 7, v1
    v_lshl_add_u32 v248, v9, 4, v248
    v_lshrrev_b32 v249, 3, v1
    v_lshl_add_u32 v249, v249, 2, s15
    v_and_b32 v10, 7, v1
    v_lshlrev_b32 v10, 4, v10
    v_lshrrev_b32 v11, 3, v1
    v_lshlrev_b32 v11, 4, v11
    v_xor_b32 v10, v10, v11
    v_lshrrev_b32 v11, 3, v1
    v_lshlrev_b32 v11, 11, v11
    v_add_u32 v10, v10, v11
    s_waitcnt lgkmcnt(0)
    s_mov_b64 s[48:49], s[88:89]
    buffer_load_dwordx4 v[160:163], v248, s[48:51], s13 offen nt
    buffer_load_dwordx4 v[164:167], v248, s[48:51], s14 offen nt
    s_load_dword s4, s[32:33], 0
    global_load_dword v169, v249, s[86:87]
    s_mov_b64 s[36:37], s[68:69]
    s_load_dword s24, s[32:33], s92 offset:0 glc
    s_load_dword s25, s[32:33], s17 offset:508 glc
    s_load_dword s26, s[32:33], s17 offset:4604 glc
    s_barrier
    buffer_load_dwordx4 v[152:155], v8, s[36:39], s16 offen nt
    buffer_load_dwordx4 v[156:159], v8, s[36:39], s16 offen offset:512 nt
    s_mov_b64 s[40:41], s[70:71]
    s_mov_b64 s[44:45], s[74:75]
    s_mov_b64 s[52:53], s[80:81]
    s_mov_b64 s[56:57], s[82:83]
    s_mov_b64 s[60:61], s[84:85]
    s_mov_b64 s[64:65], s[90:91]
    s_getpc_b64 s[22:23]
    s_and_b32 s22, s22, 0xfffffc00
    s_lshl3_add_u32 s96, s9, s3
    s_lshl_b32 s19, s96, 7
    v_lshrrev_b32 v4, 5, v1
    v_lshl_add_u32 v4, v4, 15, s19
    v_min_u32 v4, 41984, v4
    global_load_dword v11, v4, s[22:23]
    s_lshr_b32 s76, s3, 2
    s_and_b32 s77, s3, 3
    s_lshl_b32 s83, s3, 10
    s_mul_i32 s96, s8, 7
    s_lshr_b32 s97, s9, 2
    s_add_u32 s74, s96, s97
    s_and_b32 s75, s9, 3
    v_bfe_u32 v6, v1, 4, 1
    v_lshlrev_b32 v6, 6, v6
    v_and_b32 v3, 7, v1
    v_lshlrev_b32 v3, 4, v3
    v_xor_b32 v3, v3, v6
    v_lshrrev_b32 v6, 3, v1
    v_mul_u32_u24 v6, 6144, v6
    v_add_u32 v3, v3, v6
    s_and_b32 s84, s9, 12
    s_mul_i32 s96, s3, 49152
    s_lshl_b32 s97, s11, 7
    s_add_u32 s85, s96, s97
    v_lshlrev_b32 v250, 3, v1
    v_add_u32 v251, 147456, v2
    s_lshr_b32 s96, s3, 2
    s_lshl_b32 s97, s96, 10
    s_add_u32 s13, s97, 147456
    s_and_b32 s14, s3, 3
    v_and_b32 v252, 3, v1
    v_xor_b32 v252, s14, v252
    v_lshl_add_u32 v252, v252, 2, s13
    v_lshrrev_b32 v6, 4, v1
    v_lshlrev_b32 v6, 5, v6
    v_and_b32 v9, 7, v1
    v_lshl_add_u32 v6, v9, 7, v6
    v_bfe_u32 v9, v1, 3, 1
    v_lshl_add_u32 v6, v9, 4, v6
    v_add_u32 v252, v252, v6
    s_lshl_b32 s96, s3, 11
    s_add_u32 m0, s96, 131072
    s_nop 0
    buffer_load_dwordx4 v10, s[36:39], s18 offen lds
    s_add_u32 s18, s18, 16384
    s_lshl_b32 s96, s3, 11
    s_add_u32 m0, s96, 132096
    s_nop 0
    buffer_load_dwordx4 v10, s[36:39], s18 offen lds
    s_lshr_b32 s96, s3, 1
    s_xor_b32 s97, s9, 1
    s_and_b32 s98, s97, 15
    s_lshl4_add_u32 s99, s96, s98
    s_lshr_b32 s97, s9, 4
    s_lshl1_add_u32 s96, s99, s97
    s_lshl3_add_u32 s98, s96, s8
    s_lshl_b32 s99, s98, 9
    s_add_u32 s13, s99, 524288
    s_lshr_b32 s96, s9, 4
    s_lshl_b32 s94, s96, 1
    s_add_u32 s96, s94, s84
    s_and_b32 s97, s96, 15
    s_mul_i32 s98, s97, 393216
    s_add_u32 s91, s98, s85
    s_lshl_b32 s96, s94, 13
    s_add_u32 s94, s96, s83
    s_add_u32 s82, s91, 2048
    s_mov_b32 m0, s94
    s_nop 0
    buffer_load_dwordx4 v3, s[40:43], s82 offen lds
    s_add_u32 s82, s91, 4096
    s_add_u32 m0, s94, 49152
    s_nop 0
    buffer_load_dwordx4 v3, s[40:43], s82 offen lds
    s_waitcnt vmcnt(7)
    v_lshlrev_b32 v168, 16, v169
    v_and_b32 v169, s6, v169
    v_mul_f32 v4, s7, v168
    v_exp_f32 v4, -v4
    s_nop 0
    v_add_f32 v4, 1.0, v4
    v_rcp_f32 v4, v4
    s_nop 0
    v_mul_f32 v168, v168, v4
    v_cvt_pk_bf16_f32 v168, 0, v168
    v_mul_f32 v5, s7, v169
    v_exp_f32 v5, -v5
    s_nop 0
    v_add_f32 v5, 1.0, v5
    v_rcp_f32 v5, v5
    s_nop 0
    v_mul_f32 v169, v169, v5
    v_cvt_pk_bf16_f32 v169, 0, v169
    v_lshlrev_b32 v4, 16, v160
    v_and_b32 v5, s6, v160
    v_pk_mul_f32 v[176:177], v[168:169], v[4:5] op_sel:[0,0] op_sel_hi:[0,1]
    v_lshlrev_b32 v6, 16, v161
    v_and_b32 v7, s6, v161
    v_pk_mul_f32 v[178:179], v[168:169], v[6:7] op_sel:[0,0] op_sel_hi:[0,1]
    v_lshlrev_b32 v4, 16, v162
    v_and_b32 v5, s6, v162
    v_pk_mul_f32 v[180:181], v[168:169], v[4:5] op_sel:[0,0] op_sel_hi:[0,1]
    v_lshlrev_b32 v6, 16, v163
    v_and_b32 v7, s6, v163
    v_pk_mul_f32 v[182:183], v[168:169], v[6:7] op_sel:[0,0] op_sel_hi:[0,1]
    v_lshlrev_b32 v4, 16, v164
    v_and_b32 v5, s6, v164
    v_pk_fma_f32 v[176:177], v[168:169], v[4:5], v[176:177] op_sel:[1,0,0] op_sel_hi:[1,1,1]
    v_lshlrev_b32 v6, 16, v165
    v_and_b32 v7, s6, v165
    v_pk_fma_f32 v[178:179], v[168:169], v[6:7], v[178:179] op_sel:[1,0,0] op_sel_hi:[1,1,1]
    v_lshlrev_b32 v4, 16, v166
    v_and_b32 v5, s6, v166
    v_pk_fma_f32 v[180:181], v[168:169], v[4:5], v[180:181] op_sel:[1,0,0] op_sel_hi:[1,1,1]
    v_lshlrev_b32 v6, 16, v167
    v_and_b32 v7, s6, v167
    v_pk_fma_f32 v[182:183], v[168:169], v[6:7], v[182:183] op_sel:[1,0,0] op_sel_hi:[1,1,1]
    v_permlane32_swap_b32 v176, v180
    v_permlane32_swap_b32 v177, v181
    v_permlane32_swap_b32 v178, v182
    v_permlane32_swap_b32 v179, v183
    v_add_f32 v176, v176, v180
    v_add_f32 v177, v177, v181
    v_add_f32 v178, v178, v182
    v_add_f32 v179, v179, v183
    s_nop 0
    v_permlane16_swap_b32 v176, v178
    v_permlane16_swap_b32 v177, v179
    v_add_f32 v176, v176, v178
    v_add_f32 v177, v177, v179
    s_nop 0
    v_add_f32_dpp v176, v176, v176 row_ror:8 row_mask:0xf bank_mask:0xf
    v_add_f32_dpp v177, v177, v177 row_ror:8 row_mask:0xf bank_mask:0xf
    s_nop 1
    v_mov_b32_dpp v176, v177 quad_perm:[0,1,2,3] row_mask:0xf bank_mask:0xc
    s_waitcnt lgkmcnt(0)
    s_mul_i32 s4, s4, 0x9e3779b1
    s_add_u32 s4, s4, 0x7f4a7c15
    ds_write_b32 v252, v176
    s_waitcnt lgkmcnt(0)
    s_barrier
    ds_read_b128 v[176:179], v251
    ds_read_b128 v[180:183], v251 offset:1024
    s_waitcnt lgkmcnt(0)
    v_pk_add_f32 v[176:177], v[176:177], v[178:179]
    v_pk_add_f32 v[180:181], v[180:181], v[182:183]
    v_pk_add_f32 v[176:177], v[176:177], v[180:181]
    v_add_f32 v176, v176, v177
    v_mov_b32 v177, s4
    s_bitcmp1_b32 s3, 0
    s_cselect_b32 exec_lo, 0, -1
    s_cselect_b32 exec_hi, -1, 0
    buffer_store_dwordx2 v[176:177], v250, s[32:35], s13 offen sc1
    s_mov_b64 exec, -1
    s_waitcnt vmcnt(6)
    v_mov_b32 v8, 0x3f803f80
    v_dot2_f32_bf16 v4, v152, v8, 0
    v_dot2_f32_bf16 v5, v152, v152, 0
    v_dot2_f32_bf16 v6, v153, v8, 0
    v_dot2_f32_bf16 v7, v153, v153, 0
    v_dot2_f32_bf16 v4, v154, v8, v4
    v_dot2_f32_bf16 v5, v154, v154, v5
    v_dot2_f32_bf16 v6, v155, v8, v6
    v_dot2_f32_bf16 v7, v155, v155, v7
    v_dot2_f32_bf16 v4, v156, v8, v4
    v_dot2_f32_bf16 v5, v156, v156, v5
    v_dot2_f32_bf16 v6, v157, v8, v6
    v_dot2_f32_bf16 v7, v157, v157, v7
    v_dot2_f32_bf16 v4, v158, v8, v4
    v_dot2_f32_bf16 v5, v158, v158, v5
    v_dot2_f32_bf16 v6, v159, v8, v6
    v_dot2_f32_bf16 v7, v159, v159, v7
    s_lshl_b32 s96, s3, 5
    s_add_u32 s13, s96, 153600
    v_lshrrev_b32 v8, 5, v1
    v_lshl_add_u32 v8, v8, 4, s13
    v_bfe_u32 v9, v1, 4, 1
    v_lshl_add_u32 v8, v9, 3, v8
    v_pk_add_f32 v[172:173], v[4:5], v[6:7]
    v_and_b32 v5, 15, v1
    v_lshlrev_b32 v5, 4, v5
    v_add_u32 v5, 153600, v5
    v_and_b32 v4, 15, v1
    v_lshlrev_b32 v4, 4, v4
    v_bfe_u32 v9, v1, 4, 1
    v_lshl_add_u32 v4, v9, 12, v4
    v_add_f32_dpp v172, v172, v172 quad_perm:[1,0,3,2] row_mask:0xf bank_mask:0xf
    v_add_f32_dpp v173, v173, v173 quad_perm:[1,0,3,2] row_mask:0xf bank_mask:0xf
    s_nop 0
    v_add_f32_dpp v172, v172, v172 quad_perm:[2,3,0,1] row_mask:0xf bank_mask:0xf
    v_add_f32_dpp v173, v173, v173 quad_perm:[2,3,0,1] row_mask:0xf bank_mask:0xf
    s_nop 0
    v_add_f32_dpp v172, v172, v172 row_half_mirror row_mask:0xf bank_mask:0xf
    v_add_f32_dpp v173, v173, v173 row_half_mirror row_mask:0xf bank_mask:0xf
    s_nop 0
    v_add_f32_dpp v172, v172, v172 row_mirror row_mask:0xf bank_mask:0xf
    v_add_f32_dpp v173, v173, v173 row_mirror row_mask:0xf bank_mask:0xf
    s_and_b32 s96, s9, 24
    s_add_u32 s97, s96, s3
    s_and_b32 s98, s8, 6
    s_lshl3_add_u32 s99, s97, s98
    s_lshl_b32 s96, s99, 12
    s_and_b32 s97, s9, 7
    s_lshl_b32 s98, s97, 9
    s_add_u32 s99, s96, s98
    s_and_b32 s97, s8, 1
    s_lshl_b32 s96, s97, 8
    s_add_u32 s98, s99, s96
    s_add_u32 s13, s98, 2097152
    v_permlane16_swap_b32 v172, v173
    v_add_f32 v172, v172, v173
    v_mov_b32 v173, s4
    ds_write_b64 v8, v[172:173]
    s_waitcnt lgkmcnt(0)
    s_barrier
    ds_read_b128 v[172:175], v5
    s_waitcnt lgkmcnt(0)
    s_mov_b32 exec_hi, 0
    buffer_store_dwordx4 v[172:175], v4, s[32:35], s13 offen sc1
    s_mov_b32 exec_hi, -1
    s_mov_b32 s82, s91
    s_add_u32 m0, s94, 98304
    s_nop 0
    buffer_load_dwordx4 v3, s[40:43], s82 offen lds
    s_lshr_b32 s96, s9, 4
    s_lshl_b32 s97, s96, 1
    s_xor_b32 s94, s97, 1
    s_add_u32 s96, s94, s84
    s_and_b32 s97, s96, 15
    s_mul_i32 s98, s97, 393216
    s_add_u32 s91, s98, s85
    s_lshl_b32 s96, s94, 13
    s_add_u32 s94, s96, s83
    s_add_u32 s82, s91, 2048
    s_mov_b32 m0, s94
    s_nop 0
    buffer_load_dwordx4 v3, s[40:43], s82 offen lds
    s_load_dword s24, s[32:33], s17 offset:508 glc
    s_load_dword s25, s[32:33], s17 offset:4604 glc
    v_and_b32 v4, 31, v1
    v_lshlrev_b32 v4, 4, v4
    v_lshrrev_b32 v9, 5, v1
    v_lshl_add_u32 v4, v9, 12, v4
    s_and_b32 s14, s3, 3
    s_lshr_b32 s96, s3, 2
    s_lshl_b32 s97, s96, 10
    s_add_u32 s15, s97, 155648
    v_bfe_u32 v5, v1, 4, 1
    v_bfe_u32 v9, v1, 2, 1
    v_lshl_add_u32 v5, v9, 1, v5
    v_xor_b32 v5, s14, v5
    v_lshl_add_u32 v5, v5, 2, s15
    v_and_b32 v6, 1, v1
    v_lshlrev_b32 v6, 5, v6
    v_bfe_u32 v9, v1, 3, 2
    v_lshl_add_u32 v6, v9, 6, v6
    v_bfe_u32 v9, v1, 2, 1
    v_lshl_add_u32 v6, v9, 8, v6
    v_bfe_u32 v9, v1, 1, 1
    v_lshl_add_u32 v6, v9, 9, v6
    v_lshrrev_b32 v9, 5, v1
    v_lshl_add_u32 v6, v9, 11, v6
    v_add_u32 v5, v5, v6
    s_lshl3_add_u32 s96, s2, s3
    s_lshl_b32 s97, s96, 9
    s_add_u32 s14, s97, 2097152
    v_and_b32 v8, 31, v1
    v_lshlrev_b32 v8, 4, v8
    s_branch SCHK_2
SPOLL_1:
    s_load_dword s24, s[32:33], s17 offset:508 glc
    s_load_dword s25, s[32:33], s17 offset:4604 glc
SCHK_2:
    s_add_u32 s5, s5, 1
    s_cmp_ge_u32 s5, 200000
    s_waitcnt lgkmcnt(0)
    s_cbranch_scc1 SDONE_3
    s_cmp_lg_u32 s24, s4
    s_cbranch_scc1 SPOLL_1
    s_cmp_lg_u32 s25, s4
    s_cbranch_scc1 SPOLL_1
SDONE_3:
    buffer_load_dwordx4 v[176:179], v4, s[32:35], s17 offen sc1
    s_load_dword s24, s[32:33], s14 offset:252 glc
    s_load_dword s25, s[32:33], s14 offset:508 glc
    s_lshl_b32 s96, s3, 11
    s_add_u32 s15, s96, 131072
    v_lshrrev_b32 v216, 4, v1
    v_lshlrev_b32 v216, 4, v216
    v_and_b32 v217, 7, v1
    v_lshlrev_b32 v217, 4, v217
    v_xor_b32 v216, v216, v217
    v_and_b32 v217, 15, v1
    v_lshl_add_u32 v217, v217, 7, s15
    v_add_u32 v216, v216, v217
    v_xor_b32 v217, 64, v216
    s_waitcnt vmcnt(7)
    ds_read_b128 v[12:15], v216
    ds_read_b128 v[16:19], v217
    s_branch SCHK_6
SPOLL_5:
    s_load_dword s24, s[32:33], s14 offset:252 glc
    s_load_dword s25, s[32:33], s14 offset:508 glc
SCHK_6:
    s_add_u32 s5, s5, 1
    s_cmp_ge_u32 s5, 200000
    s_waitcnt lgkmcnt(0)
    s_cbranch_scc1 SDONE_7
    s_cmp_lg_u32 s24, s4
    s_cbranch_scc1 SPOLL_5
    s_cmp_lg_u32 s25, s4
    s_cbranch_scc1 SPOLL_5
SDONE_7:
    buffer_load_dwordx4 v[172:175], v8, s[32:35], s14 offen sc1
    s_add_u32 s82, s91, 4096
    s_add_u32 m0, s94, 49152
    s_nop 0
    buffer_load_dwordx4 v3, s[40:43], s82 offen lds
    s_mov_b32 s82, s91
    s_add_u32 m0, s94, 98304
    s_nop 0
    buffer_load_dwordx4 v3, s[40:43], s82 offen lds
    v_permlane32_swap_b32 v12, v14
    v_permlane32_swap_b32 v13, v15
    v_permlane32_swap_b32 v16, v18
    v_permlane32_swap_b32 v17, v19
    v_lshlrev_b32 v184, 16, v12
    v_and_b32 v185, s6, v12
    v_lshlrev_b32 v186, 16, v13
    v_and_b32 v187, s6, v13
    v_lshlrev_b32 v188, 16, v14
    v_and_b32 v189, s6, v14
    v_lshlrev_b32 v190, 16, v15
    v_and_b32 v191, s6, v15
    v_lshlrev_b32 v192, 16, v16
    v_and_b32 v193, s6, v16
    v_lshlrev_b32 v194, 16, v17
    v_and_b32 v195, s6, v17
    v_lshlrev_b32 v196, 16, v18
    v_and_b32 v197, s6, v18
    v_lshlrev_b32 v198, 16, v19
    v_and_b32 v199, s6, v19
    s_waitcnt vmcnt(3)
    v_bitop3_b32 v7, v177, v179, s4 bitop3:0x7e
    v_cmp_ne_u32 vcc, 0, v7
    s_cbranch_vccz TOK_8
POLL_9:
    buffer_load_dwordx4 v[176:179], v4, s[32:35], s17 offen sc1
    s_waitcnt vmcnt(0)
    v_bitop3_b32 v7, v177, v179, s4 bitop3:0x7e
    v_cmp_ne_u32 vcc, 0, v7
    s_cbranch_vccz PDONE_10
    s_add_u32 s5, s5, 1
    s_cmp_lt_u32 s5, 200000
    s_cbranch_scc1 POLL_9
PDONE_10:
TOK_8:
    ds_write2_b32 v5, v176, v178 offset0:0 offset1:4
    s_waitcnt lgkmcnt(0)
    s_barrier
    ds_read_b128 v[208:211], v251 offset:10240
    ds_read_b128 v[212:215], v251 offset:11264
    ds_read_b128 v[200:203], v251 offset:8192
    ds_read_b128 v[204:207], v251 offset:9216
    s_lshl_b32 s96, s11, 12
    s_lshl_b32 s97, s3, 9
    s_add_u32 s13, s96, s97
    v_add_u32 v4, s13, v2
    s_lshl_b32 s96, s3, 9
    s_add_u32 m0, s96, 159744
    s_mov_b32 exec_hi, 0
    global_load_lds_dwordx4 v4, s[72:73]
    s_mov_b32 exec_hi, -1
    s_lshl4_add_u32 s96, s21, s12
    s_lshr_b32 s97, s3, 1
    s_lshl2_add_u32 s98, s96, s97
    s_lshl_b32 s99, s98, 12
    s_and_b32 s96, s3, 1
    s_lshl_b32 s97, s96, 8
    s_add_u32 s98, s99, s97
    s_add_u32 s13, s98, 4194304
    v_and_b32 v4, 15, v1
    v_lshlrev_b32 v4, 4, v4
    v_bfe_u32 v9, v1, 4, 1
    v_lshl_add_u32 v4, v9, 10, v4
    v_lshrrev_b32 v9, 5, v1
    v_lshl_add_u32 v4, v9, 9, v4
    s_waitcnt lgkmcnt(2)
    v_pk_add_f32 v[208:209], v[208:209], v[210:211]
    v_pk_add_f32 v[212:213], v[212:213], v[214:215]
    v_pk_add_f32 v[208:209], v[208:209], v[212:213]
    v_add_f32 v208, v208, v209
    v_cvt_pk_bf16_f32 v208, 0, v208
    s_waitcnt lgkmcnt(0)
    v_pk_add_f32 v[200:201], v[200:201], v[202:203]
    v_pk_add_f32 v[204:205], v[204:205], v[206:207]
    v_pk_add_f32 v[200:201], v[200:201], v[204:205]
    v_add_f32 v200, v200, v201
    v_add_f32 v208, 1.0, v208
    v_cvt_pk_bf16_f32 v208, 0, v208
    v_cvt_pk_bf16_f32 v200, 0, v200
    s_waitcnt vmcnt(3)
    v_bitop3_b32 v7, v173, v175, s4 bitop3:0x7e
    v_cmp_ne_u32 vcc, 0, v7
    s_cbranch_vccz L_STOK
POLL_11:
    buffer_load_dwordx4 v[172:175], v8, s[32:35], s14 offen sc1
    s_waitcnt vmcnt(0)
    v_bitop3_b32 v7, v173, v175, s4 bitop3:0x7e
    v_cmp_ne_u32 vcc, 0, v7
    s_cbranch_vccz PDONE_12
    s_add_u32 s5, s5, 1
    s_cmp_lt_u32 s5, 200000
    s_cbranch_scc1 POLL_11
PDONE_12:
L_STOK:
    v_permlane16_swap_b32 v172, v174
    v_add_f32 v175, v172, v174
    v_mul_f32 v174, 0x3a800000, v175
    v_mul_f32 v175, 0x3a800000, v175
    s_nop 1
    v_permlane16_swap_b32 v174, v175
    v_fma_f32 v172, -v174, v174, v175
    v_cvt_pk_bf16_f32 v173, 0, v174
    v_max_f32 v172, 0, v172
    v_cvt_pk_bf16_f32 v172, 0, v172
    v_pk_add_f32 v[184:185], v[172:173], v[184:185] op_sel:[1,0] neg_lo:[1,0] neg_hi:[1,0]
    v_pk_add_f32 v[186:187], v[172:173], v[186:187] op_sel:[1,0] neg_lo:[1,0] neg_hi:[1,0]
    v_pk_add_f32 v[188:189], v[172:173], v[188:189] op_sel:[1,0] neg_lo:[1,0] neg_hi:[1,0]
    v_pk_add_f32 v[190:191], v[172:173], v[190:191] op_sel:[1,0] neg_lo:[1,0] neg_hi:[1,0]
    v_add_f32 v172, 0x3727c5ac, v172
    v_cvt_pk_bf16_f32 v172, 0, v172
    v_sqrt_f32 v172, v172
    s_nop 0
    v_pk_add_f32 v[192:193], v[172:173], v[192:193] op_sel:[1,0] neg_lo:[1,0] neg_hi:[1,0]
    v_pk_add_f32 v[194:195], v[172:173], v[194:195] op_sel:[1,0] neg_lo:[1,0] neg_hi:[1,0]
    v_pk_add_f32 v[196:197], v[172:173], v[196:197] op_sel:[1,0] neg_lo:[1,0] neg_hi:[1,0]
    v_pk_add_f32 v[198:199], v[172:173], v[198:199] op_sel:[1,0] neg_lo:[1,0] neg_hi:[1,0]
    v_cvt_pk_bf16_f32 v172, 0, v172
    v_rcp_f32 v172, v172
    v_cvt_pk_bf16_f32 v184, 0, v184
    v_cvt_pk_bf16_f32 v185, 0, v185
    v_cvt_pk_bf16_f32 v186, 0, v186
    v_cvt_pk_bf16_f32 v187, 0, v187
    v_cvt_pk_bf16_f32 v188, 0, v188
    v_cvt_pk_bf16_f32 v189, 0, v189
    v_cvt_pk_bf16_f32 v190, 0, v190
    v_cvt_pk_bf16_f32 v191, 0, v191
    v_cvt_pk_bf16_f32 v192, 0, v192
    v_cvt_pk_bf16_f32 v193, 0, v193
    v_cvt_pk_bf16_f32 v194, 0, v194
    v_cvt_pk_bf16_f32 v195, 0, v195
    v_cvt_pk_bf16_f32 v196, 0, v196
    v_cvt_pk_bf16_f32 v197, 0, v197
    v_cvt_pk_bf16_f32 v198, 0, v198
    v_cvt_pk_bf16_f32 v199, 0, v199
    v_pk_mul_f32 v[184:185], v[184:185], v[172:173] op_sel_hi:[1,0]
    v_pk_mul_f32 v[186:187], v[186:187], v[172:173] op_sel_hi:[1,0]
    v_pk_mul_f32 v[188:189], v[188:189], v[172:173] op_sel_hi:[1,0]
    v_pk_mul_f32 v[190:191], v[190:191], v[172:173] op_sel_hi:[1,0]
    v_pk_mul_f32 v[192:193], v[192:193], v[172:173] op_sel_hi:[1,0]
    v_pk_mul_f32 v[194:195], v[194:195], v[172:173] op_sel_hi:[1,0]
    v_pk_mul_f32 v[196:197], v[196:197], v[172:173] op_sel_hi:[1,0]
    v_pk_mul_f32 v[198:199], v[198:199], v[172:173] op_sel_hi:[1,0]
    v_cvt_pk_bf16_f32 v184, 0, v184
    v_cvt_pk_bf16_f32 v185, 0, v185
    v_cvt_pk_bf16_f32 v186, 0, v186
    v_cvt_pk_bf16_f32 v187, 0, v187
    v_cvt_pk_bf16_f32 v188, 0, v188
    v_cvt_pk_bf16_f32 v189, 0, v189
    v_cvt_pk_bf16_f32 v190, 0, v190
    v_cvt_pk_bf16_f32 v191, 0, v191
    v_cvt_pk_bf16_f32 v192, 0, v192
    v_cvt_pk_bf16_f32 v193, 0, v193
    v_cvt_pk_bf16_f32 v194, 0, v194
    v_cvt_pk_bf16_f32 v195, 0, v195
    v_cvt_pk_bf16_f32 v196, 0, v196
    v_cvt_pk_bf16_f32 v197, 0, v197
    v_cvt_pk_bf16_f32 v198, 0, v198
    v_cvt_pk_bf16_f32 v199, 0, v199
    v_mul_f32_dpp v184, v208, v184 row_newbcast:0 row_mask:0xf bank_mask:0xf
    v_mul_f32_dpp v185, v208, v185 row_newbcast:1 row_mask:0xf bank_mask:0xf
    v_mul_f32_dpp v186, v208, v186 row_newbcast:2 row_mask:0xf bank_mask:0xf
    v_mul_f32_dpp v187, v208, v187 row_newbcast:3 row_mask:0xf bank_mask:0xf
    v_mul_f32_dpp v188, v208, v188 row_newbcast:4 row_mask:0xf bank_mask:0xf
    v_mul_f32_dpp v189, v208, v189 row_newbcast:5 row_mask:0xf bank_mask:0xf
    v_mul_f32_dpp v190, v208, v190 row_newbcast:6 row_mask:0xf bank_mask:0xf
    v_mul_f32_dpp v191, v208, v191 row_newbcast:7 row_mask:0xf bank_mask:0xf
    v_cvt_pk_bf16_f32 v184, 0, v184
    v_cvt_pk_bf16_f32 v185, 0, v185
    v_cvt_pk_bf16_f32 v186, 0, v186
    v_cvt_pk_bf16_f32 v187, 0, v187
    v_cvt_pk_bf16_f32 v188, 0, v188
    v_cvt_pk_bf16_f32 v189, 0, v189
    v_cvt_pk_bf16_f32 v190, 0, v190
    v_cvt_pk_bf16_f32 v191, 0, v191
    v_add_f32_dpp v184, v200, v184 row_newbcast:0 row_mask:0xf bank_mask:0xf
    v_add_f32_dpp v185, v200, v185 row_newbcast:1 row_mask:0xf bank_mask:0xf
    v_add_f32_dpp v186, v200, v186 row_newbcast:2 row_mask:0xf bank_mask:0xf
    v_add_f32_dpp v187, v200, v187 row_newbcast:3 row_mask:0xf bank_mask:0xf
    v_add_f32_dpp v188, v200, v188 row_newbcast:4 row_mask:0xf bank_mask:0xf
    v_add_f32_dpp v189, v200, v189 row_newbcast:5 row_mask:0xf bank_mask:0xf
    v_add_f32_dpp v190, v200, v190 row_newbcast:6 row_mask:0xf bank_mask:0xf
    v_add_f32_dpp v191, v200, v191 row_newbcast:7 row_mask:0xf bank_mask:0xf
    v_cvt_pk_bf16_f32 v216, v184, v185
    v_cvt_pk_bf16_f32 v217, v186, v187
    v_cvt_pk_bf16_f32 v218, v188, v189
    v_cvt_pk_bf16_f32 v219, v190, v191
    buffer_store_dwordx4 v[216:219], v4, s[32:35], s13 offen sc1
    v_mul_f32_dpp v192, v208, v192 row_newbcast:8 row_mask:0xf bank_mask:0xf
    v_mul_f32_dpp v193, v208, v193 row_newbcast:9 row_mask:0xf bank_mask:0xf
    v_mul_f32_dpp v194, v208, v194 row_newbcast:10 row_mask:0xf bank_mask:0xf
    v_mul_f32_dpp v195, v208, v195 row_newbcast:11 row_mask:0xf bank_mask:0xf
    v_mul_f32_dpp v196, v208, v196 row_newbcast:12 row_mask:0xf bank_mask:0xf
    v_mul_f32_dpp v197, v208, v197 row_newbcast:13 row_mask:0xf bank_mask:0xf
    v_mul_f32_dpp v198, v208, v198 row_newbcast:14 row_mask:0xf bank_mask:0xf
    v_mul_f32_dpp v199, v208, v199 row_newbcast:15 row_mask:0xf bank_mask:0xf
    v_cvt_pk_bf16_f32 v192, 0, v192
    v_cvt_pk_bf16_f32 v193, 0, v193
    v_cvt_pk_bf16_f32 v194, 0, v194
    v_cvt_pk_bf16_f32 v195, 0, v195
    v_cvt_pk_bf16_f32 v196, 0, v196
    v_cvt_pk_bf16_f32 v197, 0, v197
    v_cvt_pk_bf16_f32 v198, 0, v198
    v_cvt_pk_bf16_f32 v199, 0, v199
    v_add_f32_dpp v192, v200, v192 row_newbcast:8 row_mask:0xf bank_mask:0xf
    v_add_f32_dpp v193, v200, v193 row_newbcast:9 row_mask:0xf bank_mask:0xf
    v_add_f32_dpp v194, v200, v194 row_newbcast:10 row_mask:0xf bank_mask:0xf
    v_add_f32_dpp v195, v200, v195 row_newbcast:11 row_mask:0xf bank_mask:0xf
    v_add_f32_dpp v196, v200, v196 row_newbcast:12 row_mask:0xf bank_mask:0xf
    v_add_f32_dpp v197, v200, v197 row_newbcast:13 row_mask:0xf bank_mask:0xf
    v_add_f32_dpp v198, v200, v198 row_newbcast:14 row_mask:0xf bank_mask:0xf
    v_add_f32_dpp v199, v200, v199 row_newbcast:15 row_mask:0xf bank_mask:0xf
    v_cvt_pk_bf16_f32 v220, v192, v193
    v_cvt_pk_bf16_f32 v221, v194, v195
    v_cvt_pk_bf16_f32 v222, v196, v197
    v_cvt_pk_bf16_f32 v223, v198, v199
    buffer_store_dwordx4 v[220:223], v4, s[32:35], s13 offen offset:2048 sc1
    v_bfe_u32 v20, v1, 2, 2
    v_lshlrev_b32 v20, 7, v20
    v_bfe_u32 v9, v1, 3, 1
    v_lshl_add_u32 v20, v9, 6, v20
    v_bfe_u32 v9, v1, 4, 1
    v_lshl_add_u32 v20, v9, 5, v20
    v_and_b32 v9, 3, v1
    v_lshl_add_u32 v20, v9, 3, v20
    v_lshrrev_b32 v9, 5, v1
    v_lshl_add_u32 v20, v9, 9, v20
    v_xor_b32 v21, 64, v20
    v_add_u32 v22, 49152, v20
    v_add_u32 v23, 49152, v21
    v_add_u32 v24, 98304, v20
    v_add_u32 v25, 98304, v21
    v_and_b32 v5, 3, v1
    v_lshlrev_b32 v5, 15, v5
    v_bfe_u32 v9, v1, 2, 2
    v_lshl_add_u32 v5, v9, 12, v5
    s_and_b32 s96, s12, 1
    s_lshr_b32 s97, s21, 3
    s_and_b32 s98, s21, 7
    s_lshl_b32 s99, s98, 5
    s_lshl2_add_u32 s98, s97, s99
    s_lshl_b32 s97, s98, 12
    s_lshr_b32 s99, s12, 1
    s_lshl_b32 s98, s99, 6
    s_add_u32 s99, s97, s98
    s_lshl2_add_u32 s97, s96, s99
    s_add_u32 s13, s97, 1048576
    s_lshl_b32 s96, s10, 18
    s_lshl_b32 s97, s77, 12
    s_add_u32 s98, s96, s97
    s_add_u32 s88, s98, 4194304
    s_cmp_ge_u32 s9, 28
    s_cselect_b32 s54, 0, s54
    s_cselect_b32 s58, 0, s58
    s_cselect_b32 s62, 0, s62
    s_waitcnt vmcnt(0)
    s_barrier
    s_cmp_lg_u32 s3, 0
    s_cbranch_scc1 L_PB
    v_mov_b32 v6, s4
    s_mov_b32 exec_hi, 0
    s_mov_b32 exec_lo, 65535
    buffer_store_dword v6, v5, s[32:35], s13 offen sc1
    s_mov_b64 exec, -1
L_PB:
    s_lshr_b32 s96, s9, 4
    s_lshl_b32 s97, s96, 1
    s_xor_b32 s94, s97, 2
    s_add_u32 s96, s94, s84
    s_and_b32 s97, s96, 15
    s_mul_i32 s98, s97, 393216
    s_add_u32 s91, s98, s85
    s_lshl_b32 s96, s94, 13
    s_add_u32 s94, s96, s83
    s_add_u32 s82, s91, 2048
    s_mov_b32 m0, s94
    s_nop 0
    buffer_load_dwordx4 v3, s[40:43], s82 offen lds
    s_add_u32 s82, s91, 4096
    s_add_u32 m0, s94, 49152
    s_nop 0
    buffer_load_dwordx4 v3, s[40:43], s82 offen lds
    s_mov_b32 s82, s91
    s_add_u32 m0, s94, 98304
    s_nop 0
    buffer_load_dwordx4 v3, s[40:43], s82 offen lds
    s_lshr_b32 s96, s9, 4
    s_lshl_b32 s97, s96, 1
    s_xor_b32 s94, s97, 3
    s_add_u32 s96, s94, s84
    s_and_b32 s97, s96, 15
    s_mul_i32 s98, s97, 393216
    s_add_u32 s91, s98, s85
    s_lshl_b32 s96, s94, 13
    s_add_u32 s94, s96, s83
    s_add_u32 s82, s91, 2048
    s_mov_b32 m0, s94
    s_nop 0
    buffer_load_dwordx4 v3, s[40:43], s82 offen lds
    s_add_u32 s82, s91, 4096
    s_add_u32 m0, s94, 49152
    s_nop 0
    buffer_load_dwordx4 v3, s[40:43], s82 offen lds
    s_mov_b32 s82, s91
    s_add_u32 m0, s94, 98304
    s_nop 0
    buffer_load_dwordx4 v3, s[40:43], s82 offen lds
    s_lshl_b32 s96, s2, 12
    s_add_u32 s19, s96, 1048576
    s_and_b32 s96, s3, 3
    s_lshl_b32 s97, s96, 7
    s_add_u32 s20, s97, s19
    s_lshl_b32 s96, s84, 5
    s_add_u32 s19, s96, s19
    s_cmp_ge_u32 s3, 4
    s_cselect_b32 s19, s20, s19
    s_load_dwordx2 s[24:25], s[32:33], s19 offset:0 glc
    s_load_dwordx2 s[26:27], s[32:33], s19 offset:64 glc
    s_lshl_b32 s96, s3, 14
    s_lshl_b32 s97, s12, 7
    s_add_u32 s90, s96, s97
    s_and_b32 s96, s9, 1
    s_lshr_b32 s97, s9, 3
    s_lshl_b32 s98, s97, 1
    s_lshl3_add_u32 s99, s96, s98
    s_lshl_b32 s95, s99, 17
    s_lshl3_add_u32 s96, s75, s3
    s_mul_i32 s97, s96, 229376
    s_lshl_b32 s98, s74, 7
    s_add_u32 s80, s97, s98
    s_lshl3_add_u32 s96, s74, s3
    s_lshl_b32 s97, s96, 14
    s_lshl_b32 s98, s75, 9
    s_add_u32 s81, s97, s98
    s_and_b32 s96, s8, 3
    s_lshl3_add_u32 s97, s96, s3
    s_mul_i32 s98, s97, 393216
    s_lshr_b32 s99, s8, 2
    s_lshl1_add_u32 s96, s9, s99
    s_lshl_b32 s97, s96, 7
    s_add_u32 s99, s98, s97
    s_add_u32 s89, s99, 4096
    s_and_b32 s96, s3, 1
    s_lshl_b32 s14, s96, 6
    v_bfe_u32 v6, v1, 4, 1
    v_lshl_add_u32 v6, v6, 5, s14
    v_and_b32 v26, 7, v1
    v_lshlrev_b32 v26, 4, v26
    v_xor_b32 v26, v26, v6
    v_lshrrev_b32 v6, 3, v1
    v_lshlrev_b32 v6, 11, v6
    v_add_u32 v26, v26, v6
    s_and_b32 s96, s3, 2
    s_lshl_b32 s14, s96, 5
    v_bfe_u32 v6, v1, 4, 1
    v_lshl_add_u32 v6, v6, 5, s14
    v_and_b32 v27, 7, v1
    v_lshlrev_b32 v27, 4, v27
    v_xor_b32 v27, v27, v6
    v_lshrrev_b32 v6, 3, v1
    v_mul_u32_u24 v6, 7168, v6
    v_add_u32 v27, v27, v6
    s_and_b32 s96, s3, 1
    s_lshl_b32 s14, s96, 7
    v_lshrrev_b32 v6, 5, v1
    v_lshl_add_u32 v6, v6, 6, s14
    v_and_b32 v253, 31, v1
    v_lshlrev_b32 v253, 4, v253
    v_lshrrev_b32 v9, 5, v1
    v_lshl_add_u32 v253, v9, 11, v253
    v_xor_b32 v253, v253, v6
    s_lshl_b32 s16, s84, 14
    v_add_u32 v249, s88, v2
    s_lshl_b32 s96, s77, 11
    s_add_u32 s14, s96, 151552
    v_add_u32 v0, s14, v2
    s_mov_b64 exec, 0
    s_cmp_eq_u32 s3, 4
    s_cbranch_scc1 L_PAD2
    s_cmp_eq_u32 s3, 5
    s_cbranch_scc1 L_PAD3
    s_cmp_eq_u32 s3, 6
    s_cbranch_scc1 L_PAD4
    s_cmp_eq_u32 s3, 7
    s_cbranch_scc1 L_PAD5
    s_branch L_TEND
L_RET2:
    s_branch L_PAD6
L_RET6:
    s_branch L_PAD10
L_RET10:
    s_branch L_TEND
L_RET3:
    s_branch L_PAD7
L_RET7:
    s_branch L_TEND
L_RET4:
    s_branch L_PAD8
L_RET8:
    s_branch L_TEND
L_RET5:
    s_branch L_PAD9
L_RET9:
    s_branch L_TEND
    s_nop 0
    s_nop 0
    s_nop 0
    s_nop 0
    s_nop 0
    s_nop 0
    s_nop 0
    s_nop 0
    s_nop 0
    s_nop 0
    s_nop 0
    s_nop 0
    s_nop 0
    s_nop 0
    s_nop 0
    s_nop 0
    s_nop 0
    s_nop 0
    s_nop 0
    s_nop 0
    s_nop 0
    s_nop 0
    s_nop 0
    s_nop 0
    s_nop 0
    s_nop 0
    s_nop 0
    s_nop 0
L_TEND:
    s_mov_b64 exec, -1
    s_cmp_ge_u32 s3, 4
    s_cbranch_scc1 L_HELP
    s_branch SCHK_14
SPOLL_13:
    s_load_dwordx2 s[24:25], s[32:33], s19 offset:0 glc
    s_load_dwordx2 s[26:27], s[32:33], s19 offset:64 glc
SCHK_14:
    s_add_u32 s5, s5, 1
    s_cmp_ge_u32 s5, 200000
    s_waitcnt lgkmcnt(0)
    s_cbranch_scc1 SDONE_15
    s_cmp_lg_u32 s24, s4
    s_cbranch_scc1 SPOLL_13
    s_cmp_lg_u32 s25, s4
    s_cbranch_scc1 SPOLL_13
    s_cmp_lg_u32 s26, s4
    s_cbranch_scc1 SPOLL_13
    s_cmp_lg_u32 s27, s4
    s_cbranch_scc1 SPOLL_13
SDONE_15:
    s_setprio 2
    buffer_load_dwordx4 v[152:155], v249, s[32:35], s16 offen sc1
    buffer_load_dwordx4 v[156:159], v249, s[32:35], s16 offen offset:1024 sc1
    buffer_load_dwordx4 v[160:163], v249, s[32:35], s16 offen offset:2048 sc1
    buffer_load_dwordx4 v[164:167], v249, s[32:35], s16 offen offset:3072 sc1
    s_add_u32 s16, s16, 16384
    s_and_b32 s16, s16, 0x3ffff
    buffer_load_dwordx4 v[168:171], v249, s[32:35], s16 offen sc1
    buffer_load_dwordx4 v[172:175], v249, s[32:35], s16 offen offset:1024 sc1
    buffer_load_dwordx4 v[176:179], v249, s[32:35], s16 offen offset:2048 sc1
    buffer_load_dwordx4 v[180:183], v249, s[32:35], s16 offen offset:3072 sc1
    s_waitcnt vmcnt(8)
    s_barrier
    ds_read_b64_tr_b16 v[28:29], v20
    ds_read_b64_tr_b16 v[30:31], v20 offset:2048
    ds_read_b64_tr_b16 v[32:33], v21
    ds_read_b64_tr_b16 v[34:35], v21 offset:2048
    ds_read_b64_tr_b16 v[36:37], v24
    ds_read_b64_tr_b16 v[38:39], v24 offset:2048
    ds_read_b64_tr_b16 v[40:41], v25
    ds_read_b64_tr_b16 v[42:43], v25 offset:2048
    ds_read_b64_tr_b16 v[44:45], v22
    ds_read_b64_tr_b16 v[46:47], v22 offset:2048
    ds_read_b64_tr_b16 v[48:49], v23
    ds_read_b64_tr_b16 v[50:51], v23 offset:2048
    s_waitcnt vmcnt(7)
    s_waitcnt lgkmcnt(10)
    v_mfma_f32_32x32x16_bf16 v[56:71], v[28:31], v[152:155], 0
    s_add_u32 s16, s16, 16384
    ds_read_b64_tr_b16 v[52:53], v20 offset:1024
    ds_read_b64_tr_b16 v[54:55], v20 offset:3072
    s_waitcnt lgkmcnt(10)
    v_mfma_f32_32x32x16_bf16 v[72:87], v[32:35], v[152:155], 0
    s_and_b32 s16, s16, 0x3ffff
    ds_read_b64_tr_b16 v[28:29], v21 offset:1024
    ds_read_b64_tr_b16 v[30:31], v21 offset:3072
    s_waitcnt lgkmcnt(10)
    v_mfma_f32_32x32x16_bf16 v[120:135], v[36:39], v[152:155], 0
    ds_read_b64_tr_b16 v[32:33], v24 offset:1024
    ds_read_b64_tr_b16 v[34:35], v24 offset:3072
    s_waitcnt lgkmcnt(10)
    v_mfma_f32_32x32x16_bf16 v[136:151], v[40:43], v[152:155], 0
    buffer_load_dwordx4 v[184:187], v249, s[32:35], s16 offen sc1
    ds_read_b64_tr_b16 v[36:37], v25 offset:1024
    ds_read_b64_tr_b16 v[38:39], v25 offset:3072
    s_waitcnt lgkmcnt(10)
    v_mfma_f32_32x32x16_bf16 v[88:103], v[44:47], v[152:155], 0
    ds_read_b64_tr_b16 v[40:41], v22 offset:1024
    ds_read_b64_tr_b16 v[42:43], v22 offset:3072
    s_waitcnt lgkmcnt(10)
    v_mfma_f32_32x32x16_bf16 v[104:119], v[48:51], v[152:155], 0
    ds_read_b64_tr_b16 v[44:45], v23 offset:1024
    ds_read_b64_tr_b16 v[46:47], v23 offset:3072
    s_waitcnt vmcnt(7)
    s_waitcnt lgkmcnt(10)
    v_mfma_f32_32x32x16_bf16 v[56:71], v[52:55], v[156:159], v[56:71]
    ds_read_b64_tr_b16 v[48:49], v20 offset:4096
    ds_read_b64_tr_b16 v[50:51], v20 offset:6144
    s_waitcnt lgkmcnt(10)
    v_mfma_f32_32x32x16_bf16 v[72:87], v[28:31], v[156:159], v[72:87]
    buffer_load_dwordx4 v[188:191], v249, s[32:35], s16 offen offset:1024 sc1
    ds_read_b64_tr_b16 v[52:53], v21 offset:4096
    ds_read_b64_tr_b16 v[54:55], v21 offset:6144
    s_waitcnt lgkmcnt(10)
    v_mfma_f32_32x32x16_bf16 v[120:135], v[32:35], v[156:159], v[120:135]
    ds_read_b64_tr_b16 v[28:29], v24 offset:4096
    ds_read_b64_tr_b16 v[30:31], v24 offset:6144
    s_waitcnt lgkmcnt(10)
    v_mfma_f32_32x32x16_bf16 v[136:151], v[36:39], v[156:159], v[136:151]
    ds_read_b64_tr_b16 v[32:33], v25 offset:4096
    ds_read_b64_tr_b16 v[34:35], v25 offset:6144
    s_waitcnt lgkmcnt(10)
    v_mfma_f32_32x32x16_bf16 v[88:103], v[40:43], v[156:159], v[88:103]
    ds_read_b64_tr_b16 v[36:37], v22 offset:4096
    ds_read_b64_tr_b16 v[38:39], v22 offset:6144
    s_waitcnt lgkmcnt(10)
    v_mfma_f32_32x32x16_bf16 v[104:119], v[44:47], v[156:159], v[104:119]
    buffer_load_dwordx4 v[192:195], v249, s[32:35], s16 offen offset:2048 sc1
    ds_read_b64_tr_b16 v[40:41], v23 offset:4096
    ds_read_b64_tr_b16 v[42:43], v23 offset:6144
    s_waitcnt vmcnt(8)
    s_waitcnt lgkmcnt(10)
    v_mfma_f32_32x32x16_bf16 v[56:71], v[48:51], v[160:163], v[56:71]
    ds_read_b64_tr_b16 v[44:45], v20 offset:5120
    ds_read_b64_tr_b16 v[46:47], v20 offset:7168
    s_waitcnt lgkmcnt(10)
    v_mfma_f32_32x32x16_bf16 v[72:87], v[52:55], v[160:163], v[72:87]
    ds_read_b64_tr_b16 v[48:49], v21 offset:5120
    ds_read_b64_tr_b16 v[50:51], v21 offset:7168
    s_waitcnt lgkmcnt(10)
    v_mfma_f32_32x32x16_bf16 v[120:135], v[28:31], v[160:163], v[120:135]
    ds_read_b64_tr_b16 v[52:53], v24 offset:5120
    ds_read_b64_tr_b16 v[54:55], v24 offset:7168
    s_waitcnt lgkmcnt(10)
    v_mfma_f32_32x32x16_bf16 v[136:151], v[32:35], v[160:163], v[136:151]
    buffer_load_dwordx4 v[196:199], v249, s[32:35], s16 offen offset:3072 sc1
    ds_read_b64_tr_b16 v[28:29], v25 offset:5120
    ds_read_b64_tr_b16 v[30:31], v25 offset:7168
    s_waitcnt lgkmcnt(10)
    v_mfma_f32_32x32x16_bf16 v[88:103], v[36:39], v[160:163], v[88:103]
    s_add_u32 s16, s16, 16384
    ds_read_b64_tr_b16 v[32:33], v22 offset:5120
    ds_read_b64_tr_b16 v[34:35], v22 offset:7168
    s_waitcnt lgkmcnt(10)
    v_mfma_f32_32x32x16_bf16 v[104:119], v[40:43], v[160:163], v[104:119]
    s_and_b32 s16, s16, 0x3ffff
    ds_read_b64_tr_b16 v[36:37], v23 offset:5120
    ds_read_b64_tr_b16 v[38:39], v23 offset:7168
    s_waitcnt vmcnt(8)
    s_waitcnt lgkmcnt(10)
    v_mfma_f32_32x32x16_bf16 v[56:71], v[44:47], v[164:167], v[56:71]
    ds_read_b64_tr_b16 v[40:41], v20 offset:8192
    ds_read_b64_tr_b16 v[42:43], v20 offset:10240
    s_waitcnt lgkmcnt(10)
    v_mfma_f32_32x32x16_bf16 v[72:87], v[48:51], v[164:167], v[72:87]
    buffer_load_dwordx4 v[200:203], v249, s[32:35], s16 offen sc1
    ds_read_b64_tr_b16 v[44:45], v21 offset:8192
    ds_read_b64_tr_b16 v[46:47], v21 offset:10240
    s_waitcnt lgkmcnt(10)
    v_mfma_f32_32x32x16_bf16 v[120:135], v[52:55], v[164:167], v[120:135]
    ds_read_b64_tr_b16 v[48:49], v24 offset:8192
    ds_read_b64_tr_b16 v[50:51], v24 offset:10240
    s_waitcnt lgkmcnt(10)
    v_mfma_f32_32x32x16_bf16 v[136:151], v[28:31], v[164:167], v[136:151]
    ds_read_b64_tr_b16 v[52:53], v25 offset:8192
    ds_read_b64_tr_b16 v[54:55], v25 offset:10240
    s_waitcnt lgkmcnt(10)
    v_mfma_f32_32x32x16_bf16 v[88:103], v[32:35], v[164:167], v[88:103]
    ds_read_b64_tr_b16 v[28:29], v22 offset:8192
    ds_read_b64_tr_b16 v[30:31], v22 offset:10240
    s_waitcnt lgkmcnt(10)
    v_mfma_f32_32x32x16_bf16 v[104:119], v[36:39], v[164:167], v[104:119]
    buffer_load_dwordx4 v[204:207], v249, s[32:35], s16 offen offset:1024 sc1
    ds_read_b64_tr_b16 v[32:33], v23 offset:8192
    ds_read_b64_tr_b16 v[34:35], v23 offset:10240
    s_barrier
    s_waitcnt vmcnt(9)
    s_waitcnt lgkmcnt(10)
    v_mfma_f32_32x32x16_bf16 v[56:71], v[40:43], v[168:171], v[56:71]
    ds_read_b64_tr_b16 v[36:37], v20 offset:9216
    ds_read_b64_tr_b16 v[38:39], v20 offset:11264
    s_waitcnt lgkmcnt(10)
    v_mfma_f32_32x32x16_bf16 v[72:87], v[44:47], v[168:171], v[72:87]
    ds_read_b64_tr_b16 v[40:41], v21 offset:9216
    ds_read_b64_tr_b16 v[42:43], v21 offset:11264
    s_waitcnt lgkmcnt(10)
    v_mfma_f32_32x32x16_bf16 v[120:135], v[48:51], v[168:171], v[120:135]
    ds_read_b64_tr_b16 v[44:45], v24 offset:9216
    ds_read_b64_tr_b16 v[46:47], v24 offset:11264
    s_waitcnt lgkmcnt(10)
    v_mfma_f32_32x32x16_bf16 v[136:151], v[52:55], v[168:171], v[136:151]
    ds_read_b64_tr_b16 v[48:49], v25 offset:9216
    ds_read_b64_tr_b16 v[50:51], v25 offset:11264
    s_waitcnt lgkmcnt(10)
    v_mfma_f32_32x32x16_bf16 v[88:103], v[28:31], v[168:171], v[88:103]
    ds_read_b64_tr_b16 v[52:53], v22 offset:9216
    ds_read_b64_tr_b16 v[54:55], v22 offset:11264
    s_waitcnt lgkmcnt(10)
    v_mfma_f32_32x32x16_bf16 v[104:119], v[32:35], v[168:171], v[104:119]
    ds_read_b64_tr_b16 v[28:29], v23 offset:9216
    ds_read_b64_tr_b16 v[30:31], v23 offset:11264
    s_waitcnt vmcnt(8)
    s_waitcnt lgkmcnt(10)
    v_mfma_f32_32x32x16_bf16 v[56:71], v[36:39], v[172:175], v[56:71]
    ds_read_b64_tr_b16 v[32:33], v20 offset:12288
    ds_read_b64_tr_b16 v[34:35], v20 offset:14336
    s_waitcnt lgkmcnt(10)
    v_mfma_f32_32x32x16_bf16 v[72:87], v[40:43], v[172:175], v[72:87]
    ds_read_b64_tr_b16 v[36:37], v21 offset:12288
    ds_read_b64_tr_b16 v[38:39], v21 offset:14336
    s_waitcnt lgkmcnt(10)
    v_mfma_f32_32x32x16_bf16 v[120:135], v[44:47], v[172:175], v[120:135]
    buffer_load_dwordx4 v[208:211], v249, s[32:35], s16 offen offset:2048 sc1
    ds_read_b64_tr_b16 v[40:41], v24 offset:12288
    ds_read_b64_tr_b16 v[42:43], v24 offset:14336
    s_waitcnt lgkmcnt(10)
    v_mfma_f32_32x32x16_bf16 v[136:151], v[48:51], v[172:175], v[136:151]
    ds_read_b64_tr_b16 v[44:45], v25 offset:12288
    ds_read_b64_tr_b16 v[46:47], v25 offset:14336
    s_waitcnt lgkmcnt(10)
    v_mfma_f32_32x32x16_bf16 v[88:103], v[52:55], v[172:175], v[88:103]
    ds_read_b64_tr_b16 v[48:49], v22 offset:12288
    ds_read_b64_tr_b16 v[50:51], v22 offset:14336
    s_waitcnt lgkmcnt(10)
    v_mfma_f32_32x32x16_bf16 v[104:119], v[28:31], v[172:175], v[104:119]
    buffer_load_dwordx4 v[212:215], v249, s[32:35], s16 offen offset:3072 sc1
    ds_read_b64_tr_b16 v[52:53], v23 offset:12288
    ds_read_b64_tr_b16 v[54:55], v23 offset:14336
    s_waitcnt vmcnt(9)
    s_waitcnt lgkmcnt(10)
    v_mfma_f32_32x32x16_bf16 v[56:71], v[32:35], v[176:179], v[56:71]
    s_add_u32 s16, s16, 16384
    ds_read_b64_tr_b16 v[28:29], v20 offset:13312
    ds_read_b64_tr_b16 v[30:31], v20 offset:15360
    s_waitcnt lgkmcnt(10)
    v_mfma_f32_32x32x16_bf16 v[72:87], v[36:39], v[176:179], v[72:87]
    s_and_b32 s16, s16, 0x3ffff
    ds_read_b64_tr_b16 v[32:33], v21 offset:13312
    ds_read_b64_tr_b16 v[34:35], v21 offset:15360
    s_waitcnt lgkmcnt(10)
    v_mfma_f32_32x32x16_bf16 v[120:135], v[40:43], v[176:179], v[120:135]
    buffer_load_dwordx4 v[216:219], v249, s[32:35], s16 offen sc1
    ds_read_b64_tr_b16 v[36:37], v24 offset:13312
    ds_read_b64_tr_b16 v[38:39], v24 offset:15360
    s_waitcnt lgkmcnt(10)
    v_mfma_f32_32x32x16_bf16 v[136:151], v[44:47], v[176:179], v[136:151]
    ds_read_b64_tr_b16 v[40:41], v25 offset:13312
    ds_read_b64_tr_b16 v[42:43], v25 offset:15360
    s_waitcnt lgkmcnt(10)
    v_mfma_f32_32x32x16_bf16 v[88:103], v[48:51], v[176:179], v[88:103]
    ds_read_b64_tr_b16 v[44:45], v22 offset:13312
    ds_read_b64_tr_b16 v[46:47], v22 offset:15360
    s_waitcnt lgkmcnt(10)
    v_mfma_f32_32x32x16_bf16 v[104:119], v[52:55], v[176:179], v[104:119]
    buffer_load_dwordx4 v[220:223], v249, s[32:35], s16 offen offset:1024 sc1
    ds_read_b64_tr_b16 v[48:49], v23 offset:13312
    ds_read_b64_tr_b16 v[50:51], v23 offset:15360
    s_waitcnt vmcnt(10)
    s_waitcnt lgkmcnt(10)
    v_mfma_f32_32x32x16_bf16 v[56:71], v[28:31], v[180:183], v[56:71]
    ds_read_b64_tr_b16 v[52:53], v20 offset:16384
    ds_read_b64_tr_b16 v[54:55], v20 offset:18432
    s_waitcnt lgkmcnt(10)
    v_mfma_f32_32x32x16_bf16 v[72:87], v[32:35], v[180:183], v[72:87]
    ds_read_b64_tr_b16 v[28:29], v21 offset:16384
    ds_read_b64_tr_b16 v[30:31], v21 offset:18432
    s_waitcnt lgkmcnt(10)
    v_mfma_f32_32x32x16_bf16 v[120:135], v[36:39], v[180:183], v[120:135]
    buffer_load_dwordx4 v[224:227], v249, s[32:35], s16 offen offset:2048 sc1
    ds_read_b64_tr_b16 v[32:33], v24 offset:16384
    ds_read_b64_tr_b16 v[34:35], v24 offset:18432
    s_waitcnt lgkmcnt(10)
    v_mfma_f32_32x32x16_bf16 v[136:151], v[40:43], v[180:183], v[136:151]
    ds_read_b64_tr_b16 v[36:37], v25 offset:16384
    ds_read_b64_tr_b16 v[38:39], v25 offset:18432
    s_waitcnt lgkmcnt(10)
    v_mfma_f32_32x32x16_bf16 v[88:103], v[44:47], v[180:183], v[88:103]
    ds_read_b64_tr_b16 v[40:41], v22 offset:16384
    ds_read_b64_tr_b16 v[42:43], v22 offset:18432
    s_waitcnt lgkmcnt(10)
    v_mfma_f32_32x32x16_bf16 v[104:119], v[48:51], v[180:183], v[104:119]
    buffer_load_dwordx4 v[228:231], v249, s[32:35], s16 offen offset:3072 sc1
    ds_read_b64_tr_b16 v[44:45], v23 offset:16384
    ds_read_b64_tr_b16 v[46:47], v23 offset:18432
    s_barrier
    s_waitcnt vmcnt(11)
    s_waitcnt lgkmcnt(10)
    v_mfma_f32_32x32x16_bf16 v[56:71], v[52:55], v[184:187], v[56:71]
    s_add_u32 s16, s16, 16384
    ds_read_b64_tr_b16 v[48:49], v20 offset:17408
    ds_read_b64_tr_b16 v[50:51], v20 offset:19456
    s_waitcnt lgkmcnt(10)
    v_mfma_f32_32x32x16_bf16 v[72:87], v[28:31], v[184:187], v[72:87]
    s_and_b32 s16, s16, 0x3ffff
    ds_read_b64_tr_b16 v[52:53], v21 offset:17408
    ds_read_b64_tr_b16 v[54:55], v21 offset:19456
    s_waitcnt lgkmcnt(10)
    v_mfma_f32_32x32x16_bf16 v[120:135], v[32:35], v[184:187], v[120:135]
    ds_read_b64_tr_b16 v[28:29], v24 offset:17408
    ds_read_b64_tr_b16 v[30:31], v24 offset:19456
    s_waitcnt lgkmcnt(10)
    v_mfma_f32_32x32x16_bf16 v[136:151], v[36:39], v[184:187], v[136:151]
    ds_read_b64_tr_b16 v[32:33], v25 offset:17408
    ds_read_b64_tr_b16 v[34:35], v25 offset:19456
    s_waitcnt lgkmcnt(10)
    v_mfma_f32_32x32x16_bf16 v[88:103], v[40:43], v[184:187], v[88:103]
    ds_read_b64_tr_b16 v[36:37], v22 offset:17408
    ds_read_b64_tr_b16 v[38:39], v22 offset:19456
    s_waitcnt lgkmcnt(10)
    v_mfma_f32_32x32x16_bf16 v[104:119], v[44:47], v[184:187], v[104:119]
    ds_read_b64_tr_b16 v[40:41], v23 offset:17408
    ds_read_b64_tr_b16 v[42:43], v23 offset:19456
    s_waitcnt vmcnt(10)
    s_waitcnt lgkmcnt(10)
    v_mfma_f32_32x32x16_bf16 v[56:71], v[48:51], v[188:191], v[56:71]
    ds_read_b64_tr_b16 v[44:45], v20 offset:20480
    ds_read_b64_tr_b16 v[46:47], v20 offset:22528
    s_waitcnt lgkmcnt(10)
    v_mfma_f32_32x32x16_bf16 v[72:87], v[52:55], v[188:191], v[72:87]
    ds_read_b64_tr_b16 v[48:49], v21 offset:20480
    ds_read_b64_tr_b16 v[50:51], v21 offset:22528
    s_waitcnt lgkmcnt(10)
    v_mfma_f32_32x32x16_bf16 v[120:135], v[28:31], v[188:191], v[120:135]
    buffer_load_dwordx4 v[232:235], v249, s[32:35], s16 offen sc1
    ds_read_b64_tr_b16 v[52:53], v24 offset:20480
    ds_read_b64_tr_b16 v[54:55], v24 offset:22528
    s_waitcnt lgkmcnt(10)
    v_mfma_f32_32x32x16_bf16 v[136:151], v[32:35], v[188:191], v[136:151]
    ds_read_b64_tr_b16 v[28:29], v25 offset:20480
    ds_read_b64_tr_b16 v[30:31], v25 offset:22528
    s_waitcnt lgkmcnt(10)
    v_mfma_f32_32x32x16_bf16 v[88:103], v[36:39], v[188:191], v[88:103]
    ds_read_b64_tr_b16 v[32:33], v22 offset:20480
    ds_read_b64_tr_b16 v[34:35], v22 offset:22528
    s_waitcnt lgkmcnt(10)
    v_mfma_f32_32x32x16_bf16 v[104:119], v[40:43], v[188:191], v[104:119]
    buffer_load_dwordx4 v[236:239], v249, s[32:35], s16 offen offset:1024 sc1
    ds_read_b64_tr_b16 v[36:37], v23 offset:20480
    ds_read_b64_tr_b16 v[38:39], v23 offset:22528
    s_waitcnt vmcnt(11)
    s_waitcnt lgkmcnt(10)
    v_mfma_f32_32x32x16_bf16 v[56:71], v[44:47], v[192:195], v[56:71]
    ds_read_b64_tr_b16 v[40:41], v20 offset:21504
    ds_read_b64_tr_b16 v[42:43], v20 offset:23552
    s_waitcnt lgkmcnt(10)
    v_mfma_f32_32x32x16_bf16 v[72:87], v[48:51], v[192:195], v[72:87]
    ds_read_b64_tr_b16 v[44:45], v21 offset:21504
    ds_read_b64_tr_b16 v[46:47], v21 offset:23552
    s_waitcnt lgkmcnt(10)
    v_mfma_f32_32x32x16_bf16 v[120:135], v[52:55], v[192:195], v[120:135]
    buffer_load_dwordx4 v[240:243], v249, s[32:35], s16 offen offset:2048 sc1
    ds_read_b64_tr_b16 v[48:49], v24 offset:21504
    ds_read_b64_tr_b16 v[50:51], v24 offset:23552
    s_waitcnt lgkmcnt(10)
    v_mfma_f32_32x32x16_bf16 v[136:151], v[28:31], v[192:195], v[136:151]
    ds_read_b64_tr_b16 v[52:53], v25 offset:21504
    ds_read_b64_tr_b16 v[54:55], v25 offset:23552
    s_waitcnt lgkmcnt(10)
    v_mfma_f32_32x32x16_bf16 v[88:103], v[32:35], v[192:195], v[88:103]
    ds_read_b64_tr_b16 v[28:29], v22 offset:21504
    ds_read_b64_tr_b16 v[30:31], v22 offset:23552
    s_waitcnt lgkmcnt(10)
    v_mfma_f32_32x32x16_bf16 v[104:119], v[36:39], v[192:195], v[104:119]
    buffer_load_dwordx4 v[244:247], v249, s[32:35], s16 offen offset:3072 sc1
    ds_read_b64_tr_b16 v[32:33], v23 offset:21504
    ds_read_b64_tr_b16 v[34:35], v23 offset:23552
    s_waitcnt vmcnt(12)
    s_waitcnt lgkmcnt(10)
    v_mfma_f32_32x32x16_bf16 v[56:71], v[40:43], v[196:199], v[56:71]
    s_add_u32 s16, s16, 16384
    ds_read_b64_tr_b16 v[36:37], v20 offset:24576
    ds_read_b64_tr_b16 v[38:39], v20 offset:26624
    s_waitcnt lgkmcnt(10)
    v_mfma_f32_32x32x16_bf16 v[72:87], v[44:47], v[196:199], v[72:87]
    s_and_b32 s16, s16, 0x3ffff
    ds_read_b64_tr_b16 v[40:41], v21 offset:24576
    ds_read_b64_tr_b16 v[42:43], v21 offset:26624
    s_waitcnt lgkmcnt(10)
    v_mfma_f32_32x32x16_bf16 v[120:135], v[48:51], v[196:199], v[120:135]
    buffer_load_dwordx4 v[152:155], v249, s[32:35], s16 offen sc1
    ds_read_b64_tr_b16 v[44:45], v24 offset:24576
    ds_read_b64_tr_b16 v[46:47], v24 offset:26624
    s_waitcnt lgkmcnt(10)
    v_mfma_f32_32x32x16_bf16 v[136:151], v[52:55], v[196:199], v[136:151]
    ds_read_b64_tr_b16 v[48:49], v25 offset:24576
    ds_read_b64_tr_b16 v[50:51], v25 offset:26624
    s_waitcnt lgkmcnt(10)
    v_mfma_f32_32x32x16_bf16 v[88:103], v[28:31], v[196:199], v[88:103]
    ds_read_b64_tr_b16 v[52:53], v22 offset:24576
    ds_read_b64_tr_b16 v[54:55], v22 offset:26624
    s_waitcnt lgkmcnt(10)
    v_mfma_f32_32x32x16_bf16 v[104:119], v[32:35], v[196:199], v[104:119]
    buffer_load_dwordx4 v[156:159], v249, s[32:35], s16 offen offset:1024 sc1
    ds_read_b64_tr_b16 v[28:29], v23 offset:24576
    ds_read_b64_tr_b16 v[30:31], v23 offset:26624
    s_barrier
    s_waitcnt vmcnt(13)
    s_waitcnt lgkmcnt(10)
    v_mfma_f32_32x32x16_bf16 v[56:71], v[36:39], v[200:203], v[56:71]
    ds_read_b64_tr_b16 v[32:33], v20 offset:25600
    ds_read_b64_tr_b16 v[34:35], v20 offset:27648
    s_waitcnt lgkmcnt(10)
    v_mfma_f32_32x32x16_bf16 v[72:87], v[40:43], v[200:203], v[72:87]
L_PAD2:
    s_cbranch_execz L_RET2
    ds_read_b64_tr_b16 v[36:37], v21 offset:25600
    ds_read_b64_tr_b16 v[38:39], v21 offset:27648
    s_waitcnt lgkmcnt(10)
    v_mfma_f32_32x32x16_bf16 v[120:135], v[44:47], v[200:203], v[120:135]
    ds_read_b64_tr_b16 v[40:41], v24 offset:25600
    ds_read_b64_tr_b16 v[42:43], v24 offset:27648
    s_waitcnt lgkmcnt(10)
    v_mfma_f32_32x32x16_bf16 v[136:151], v[48:51], v[200:203], v[136:151]
    ds_read_b64_tr_b16 v[44:45], v25 offset:25600
    ds_read_b64_tr_b16 v[46:47], v25 offset:27648
    s_waitcnt lgkmcnt(10)
    v_mfma_f32_32x32x16_bf16 v[88:103], v[52:55], v[200:203], v[88:103]
    ds_read_b64_tr_b16 v[48:49], v22 offset:25600
    ds_read_b64_tr_b16 v[50:51], v22 offset:27648
    s_waitcnt lgkmcnt(10)
    v_mfma_f32_32x32x16_bf16 v[104:119], v[28:31], v[200:203], v[104:119]
    ds_read_b64_tr_b16 v[52:53], v23 offset:25600
    ds_read_b64_tr_b16 v[54:55], v23 offset:27648
    s_waitcnt vmcnt(12)
    s_waitcnt lgkmcnt(10)
    v_mfma_f32_32x32x16_bf16 v[56:71], v[32:35], v[204:207], v[56:71]
    ds_read_b64_tr_b16 v[28:29], v20 offset:28672
    ds_read_b64_tr_b16 v[30:31], v20 offset:30720
    s_waitcnt lgkmcnt(10)
    v_mfma_f32_32x32x16_bf16 v[72:87], v[36:39], v[204:207], v[72:87]
    ds_read_b64_tr_b16 v[32:33], v21 offset:28672
    ds_read_b64_tr_b16 v[34:35], v21 offset:30720
    s_waitcnt lgkmcnt(10)
    v_mfma_f32_32x32x16_bf16 v[120:135], v[40:43], v[204:207], v[120:135]
    buffer_load_dwordx4 v[160:163], v249, s[32:35], s16 offen offset:2048 sc1
    ds_read_b64_tr_b16 v[36:37], v24 offset:28672
    ds_read_b64_tr_b16 v[38:39], v24 offset:30720
    s_waitcnt lgkmcnt(10)
    v_mfma_f32_32x32x16_bf16 v[136:151], v[44:47], v[204:207], v[136:151]
    ds_read_b64_tr_b16 v[40:41], v25 offset:28672
    ds_read_b64_tr_b16 v[42:43], v25 offset:30720
    s_waitcnt lgkmcnt(10)
    v_mfma_f32_32x32x16_bf16 v[88:103], v[48:51], v[204:207], v[88:103]
    ds_read_b64_tr_b16 v[44:45], v22 offset:28672
    ds_read_b64_tr_b16 v[46:47], v22 offset:30720
    s_waitcnt lgkmcnt(10)
    v_mfma_f32_32x32x16_bf16 v[104:119], v[52:55], v[204:207], v[104:119]
    buffer_load_dwordx4 v[164:167], v249, s[32:35], s16 offen offset:3072 sc1
    ds_read_b64_tr_b16 v[48:49], v23 offset:28672
    ds_read_b64_tr_b16 v[50:51], v23 offset:30720
    s_waitcnt vmcnt(13)
    s_waitcnt lgkmcnt(10)
    v_mfma_f32_32x32x16_bf16 v[56:71], v[28:31], v[208:211], v[56:71]
    s_add_u32 s16, s16, 16384
    ds_read_b64_tr_b16 v[52:53], v20 offset:29696
    ds_read_b64_tr_b16 v[54:55], v20 offset:31744
    s_waitcnt lgkmcnt(10)
    v_mfma_f32_32x32x16_bf16 v[72:87], v[32:35], v[208:211], v[72:87]
    s_and_b32 s16, s16, 0x3ffff
    ds_read_b64_tr_b16 v[28:29], v21 offset:29696
    ds_read_b64_tr_b16 v[30:31], v21 offset:31744
    s_waitcnt lgkmcnt(10)
    v_mfma_f32_32x32x16_bf16 v[120:135], v[36:39], v[208:211], v[120:135]
    buffer_load_dwordx4 v[168:171], v249, s[32:35], s16 offen sc1
    ds_read_b64_tr_b16 v[32:33], v24 offset:29696
    ds_read_b64_tr_b16 v[34:35], v24 offset:31744
    s_waitcnt lgkmcnt(10)
    v_mfma_f32_32x32x16_bf16 v[136:151], v[40:43], v[208:211], v[136:151]
    ds_read_b64_tr_b16 v[36:37], v25 offset:29696
    ds_read_b64_tr_b16 v[38:39], v25 offset:31744
    s_waitcnt lgkmcnt(10)
    v_mfma_f32_32x32x16_bf16 v[88:103], v[44:47], v[208:211], v[88:103]
    ds_read_b64_tr_b16 v[40:41], v22 offset:29696
    ds_read_b64_tr_b16 v[42:43], v22 offset:31744
    s_waitcnt lgkmcnt(10)
    v_mfma_f32_32x32x16_bf16 v[104:119], v[48:51], v[208:211], v[104:119]
    buffer_load_dwordx4 v[172:175], v249, s[32:35], s16 offen offset:1024 sc1
    ds_read_b64_tr_b16 v[44:45], v23 offset:29696
    ds_read_b64_tr_b16 v[46:47], v23 offset:31744
    s_waitcnt vmcnt(14)
    s_waitcnt lgkmcnt(10)
    v_mfma_f32_32x32x16_bf16 v[56:71], v[52:55], v[212:215], v[56:71]
    ds_read_b64_tr_b16 v[48:49], v20 offset:32768
    ds_read_b64_tr_b16 v[50:51], v20 offset:34816
    s_waitcnt lgkmcnt(10)
    v_mfma_f32_32x32x16_bf16 v[72:87], v[28:31], v[212:215], v[72:87]
    ds_read_b64_tr_b16 v[52:53], v21 offset:32768
    ds_read_b64_tr_b16 v[54:55], v21 offset:34816
    s_waitcnt lgkmcnt(10)
    v_mfma_f32_32x32x16_bf16 v[120:135], v[32:35], v[212:215], v[120:135]
    buffer_load_dwordx4 v[176:179], v249, s[32:35], s16 offen offset:2048 sc1
    ds_read_b64_tr_b16 v[28:29], v24 offset:32768
    ds_read_b64_tr_b16 v[30:31], v24 offset:34816
    s_waitcnt lgkmcnt(10)
    v_mfma_f32_32x32x16_bf16 v[136:151], v[36:39], v[212:215], v[136:151]
    ds_read_b64_tr_b16 v[32:33], v25 offset:32768
    ds_read_b64_tr_b16 v[34:35], v25 offset:34816
    s_waitcnt lgkmcnt(10)
    v_mfma_f32_32x32x16_bf16 v[88:103], v[40:43], v[212:215], v[88:103]
    ds_read_b64_tr_b16 v[36:37], v22 offset:32768
    ds_read_b64_tr_b16 v[38:39], v22 offset:34816
    s_waitcnt lgkmcnt(10)
    v_mfma_f32_32x32x16_bf16 v[104:119], v[44:47], v[212:215], v[104:119]
    buffer_load_dwordx4 v[180:183], v249, s[32:35], s16 offen offset:3072 sc1
    ds_read_b64_tr_b16 v[40:41], v23 offset:32768
    ds_read_b64_tr_b16 v[42:43], v23 offset:34816
    s_barrier
    s_waitcnt vmcnt(15)
    s_waitcnt lgkmcnt(10)
    v_mfma_f32_32x32x16_bf16 v[56:71], v[48:51], v[216:219], v[56:71]
    s_add_u32 s16, s16, 16384
    ds_read_b64_tr_b16 v[44:45], v20 offset:33792
    ds_read_b64_tr_b16 v[46:47], v20 offset:35840
    s_waitcnt lgkmcnt(10)
    v_mfma_f32_32x32x16_bf16 v[72:87], v[52:55], v[216:219], v[72:87]
    s_and_b32 s16, s16, 0x3ffff
    ds_read_b64_tr_b16 v[48:49], v21 offset:33792
    ds_read_b64_tr_b16 v[50:51], v21 offset:35840
    s_waitcnt lgkmcnt(10)
    v_mfma_f32_32x32x16_bf16 v[120:135], v[28:31], v[216:219], v[120:135]
    ds_read_b64_tr_b16 v[52:53], v24 offset:33792
    ds_read_b64_tr_b16 v[54:55], v24 offset:35840
    s_waitcnt lgkmcnt(10)
    v_mfma_f32_32x32x16_bf16 v[136:151], v[32:35], v[216:219], v[136:151]
    ds_read_b64_tr_b16 v[28:29], v25 offset:33792
    ds_read_b64_tr_b16 v[30:31], v25 offset:35840
    s_waitcnt lgkmcnt(10)
    v_mfma_f32_32x32x16_bf16 v[88:103], v[36:39], v[216:219], v[88:103]
    ds_read_b64_tr_b16 v[32:33], v22 offset:33792
    ds_read_b64_tr_b16 v[34:35], v22 offset:35840
    s_waitcnt lgkmcnt(10)
    v_mfma_f32_32x32x16_bf16 v[104:119], v[40:43], v[216:219], v[104:119]
    ds_read_b64_tr_b16 v[36:37], v23 offset:33792
    ds_read_b64_tr_b16 v[38:39], v23 offset:35840
    s_waitcnt vmcnt(14)
    s_waitcnt lgkmcnt(10)
    v_mfma_f32_32x32x16_bf16 v[56:71], v[44:47], v[220:223], v[56:71]
    ds_read_b64_tr_b16 v[40:41], v20 offset:36864
    ds_read_b64_tr_b16 v[42:43], v20 offset:38912
    s_waitcnt lgkmcnt(10)
    v_mfma_f32_32x32x16_bf16 v[72:87], v[48:51], v[220:223], v[72:87]
    ds_read_b64_tr_b16 v[44:45], v21 offset:36864
    ds_read_b64_tr_b16 v[46:47], v21 offset:38912
    s_waitcnt lgkmcnt(10)
    v_mfma_f32_32x32x16_bf16 v[120:135], v[52:55], v[220:223], v[120:135]
    buffer_load_dwordx4 v[184:187], v249, s[32:35], s16 offen sc1
    ds_read_b64_tr_b16 v[48:49], v24 offset:36864
    ds_read_b64_tr_b16 v[50:51], v24 offset:38912
    s_waitcnt lgkmcnt(10)
    v_mfma_f32_32x32x16_bf16 v[136:151], v[28:31], v[220:223], v[136:151]
    ds_read_b64_tr_b16 v[52:53], v25 offset:36864
    ds_read_b64_tr_b16 v[54:55], v25 offset:38912
    s_waitcnt lgkmcnt(10)
    v_mfma_f32_32x32x16_bf16 v[88:103], v[32:35], v[220:223], v[88:103]
    ds_read_b64_tr_b16 v[28:29], v22 offset:36864
    ds_read_b64_tr_b16 v[30:31], v22 offset:38912
    s_waitcnt lgkmcnt(10)
    v_mfma_f32_32x32x16_bf16 v[104:119], v[36:39], v[220:223], v[104:119]
    buffer_load_dwordx4 v[188:191], v249, s[32:35], s16 offen offset:1024 sc1
    ds_read_b64_tr_b16 v[32:33], v23 offset:36864
    ds_read_b64_tr_b16 v[34:35], v23 offset:38912
    s_waitcnt vmcnt(15)
    s_waitcnt lgkmcnt(10)
    v_mfma_f32_32x32x16_bf16 v[56:71], v[40:43], v[224:227], v[56:71]
    ds_read_b64_tr_b16 v[36:37], v20 offset:37888
    ds_read_b64_tr_b16 v[38:39], v20 offset:39936
    s_waitcnt lgkmcnt(10)
    v_mfma_f32_32x32x16_bf16 v[72:87], v[44:47], v[224:227], v[72:87]
    ds_read_b64_tr_b16 v[40:41], v21 offset:37888
    ds_read_b64_tr_b16 v[42:43], v21 offset:39936
    s_waitcnt lgkmcnt(10)
    v_mfma_f32_32x32x16_bf16 v[120:135], v[48:51], v[224:227], v[120:135]
    buffer_load_dwordx4 v[192:195], v249, s[32:35], s16 offen offset:2048 sc1
    ds_read_b64_tr_b16 v[44:45], v24 offset:37888
    ds_read_b64_tr_b16 v[46:47], v24 offset:39936
    s_waitcnt lgkmcnt(10)
    v_mfma_f32_32x32x16_bf16 v[136:151], v[52:55], v[224:227], v[136:151]
    ds_read_b64_tr_b16 v[48:49], v25 offset:37888
    ds_read_b64_tr_b16 v[50:51], v25 offset:39936
    s_waitcnt lgkmcnt(10)
    v_mfma_f32_32x32x16_bf16 v[88:103], v[28:31], v[224:227], v[88:103]
    ds_read_b64_tr_b16 v[52:53], v22 offset:37888
    ds_read_b64_tr_b16 v[54:55], v22 offset:39936
    s_waitcnt lgkmcnt(10)
    v_mfma_f32_32x32x16_bf16 v[104:119], v[32:35], v[224:227], v[104:119]
    buffer_load_dwordx4 v[196:199], v249, s[32:35], s16 offen offset:3072 sc1
    ds_read_b64_tr_b16 v[28:29], v23 offset:37888
    ds_read_b64_tr_b16 v[30:31], v23 offset:39936
    s_waitcnt vmcnt(16)
    s_waitcnt lgkmcnt(10)
    v_mfma_f32_32x32x16_bf16 v[56:71], v[36:39], v[228:231], v[56:71]
    s_add_u32 s16, s16, 16384
    ds_read_b64_tr_b16 v[32:33], v20 offset:40960
    ds_read_b64_tr_b16 v[34:35], v20 offset:43008
    s_waitcnt lgkmcnt(10)
    v_mfma_f32_32x32x16_bf16 v[72:87], v[40:43], v[228:231], v[72:87]
    s_and_b32 s16, s16, 0x3ffff
    ds_read_b64_tr_b16 v[36:37], v21 offset:40960
    ds_read_b64_tr_b16 v[38:39], v21 offset:43008
    s_waitcnt lgkmcnt(10)
    v_mfma_f32_32x32x16_bf16 v[120:135], v[44:47], v[228:231], v[120:135]
    buffer_load_dwordx4 v[200:203], v249, s[32:35], s16 offen sc1
    ds_read_b64_tr_b16 v[40:41], v24 offset:40960
    ds_read_b64_tr_b16 v[42:43], v24 offset:43008
    s_waitcnt lgkmcnt(10)
    v_mfma_f32_32x32x16_bf16 v[136:151], v[48:51], v[228:231], v[136:151]
    ds_read_b64_tr_b16 v[44:45], v25 offset:40960
    ds_read_b64_tr_b16 v[46:47], v25 offset:43008
    s_waitcnt lgkmcnt(10)
    v_mfma_f32_32x32x16_bf16 v[88:103], v[52:55], v[228:231], v[88:103]
    ds_read_b64_tr_b16 v[48:49], v22 offset:40960
    ds_read_b64_tr_b16 v[50:51], v22 offset:43008
    s_waitcnt lgkmcnt(10)
    v_mfma_f32_32x32x16_bf16 v[104:119], v[28:31], v[228:231], v[104:119]
    buffer_load_dwordx4 v[204:207], v249, s[32:35], s16 offen offset:1024 sc1
    ds_read_b64_tr_b16 v[52:53], v23 offset:40960
    ds_read_b64_tr_b16 v[54:55], v23 offset:43008
    s_barrier
    s_waitcnt vmcnt(17)
    s_waitcnt lgkmcnt(10)
    v_mfma_f32_32x32x16_bf16 v[56:71], v[32:35], v[232:235], v[56:71]
    ds_read_b64_tr_b16 v[28:29], v20 offset:41984
    ds_read_b64_tr_b16 v[30:31], v20 offset:44032
    s_waitcnt lgkmcnt(10)
    v_mfma_f32_32x32x16_bf16 v[72:87], v[36:39], v[232:235], v[72:87]
    ds_read_b64_tr_b16 v[32:33], v21 offset:41984
    ds_read_b64_tr_b16 v[34:35], v21 offset:44032
    s_waitcnt lgkmcnt(10)
    v_mfma_f32_32x32x16_bf16 v[120:135], v[40:43], v[232:235], v[120:135]
    ds_read_b64_tr_b16 v[36:37], v24 offset:41984
    ds_read_b64_tr_b16 v[38:39], v24 offset:44032
    s_waitcnt lgkmcnt(10)
    v_mfma_f32_32x32x16_bf16 v[136:151], v[44:47], v[232:235], v[136:151]
    ds_read_b64_tr_b16 v[40:41], v25 offset:41984
    ds_read_b64_tr_b16 v[42:43], v25 offset:44032
    s_waitcnt lgkmcnt(10)
    v_mfma_f32_32x32x16_bf16 v[88:103], v[48:51], v[232:235], v[88:103]
    ds_read_b64_tr_b16 v[44:45], v22 offset:41984
    ds_read_b64_tr_b16 v[46:47], v22 offset:44032
    s_waitcnt lgkmcnt(10)
    v_mfma_f32_32x32x16_bf16 v[104:119], v[52:55], v[232:235], v[104:119]
    ds_read_b64_tr_b16 v[48:49], v23 offset:41984
    ds_read_b64_tr_b16 v[50:51], v23 offset:44032
    s_waitcnt vmcnt(16)
    s_waitcnt lgkmcnt(10)
    v_mfma_f32_32x32x16_bf16 v[56:71], v[28:31], v[236:239], v[56:71]
    ds_read_b64_tr_b16 v[52:53], v20 offset:45056
    ds_read_b64_tr_b16 v[54:55], v20 offset:47104
    s_waitcnt lgkmcnt(10)
    v_mfma_f32_32x32x16_bf16 v[72:87], v[32:35], v[236:239], v[72:87]
    ds_read_b64_tr_b16 v[28:29], v21 offset:45056
    ds_read_b64_tr_b16 v[30:31], v21 offset:47104
    s_waitcnt lgkmcnt(10)
    v_mfma_f32_32x32x16_bf16 v[120:135], v[36:39], v[236:239], v[120:135]
    buffer_load_dwordx4 v[208:211], v249, s[32:35], s16 offen offset:2048 sc1
    ds_read_b64_tr_b16 v[32:33], v24 offset:45056
    ds_read_b64_tr_b16 v[34:35], v24 offset:47104
    s_waitcnt lgkmcnt(10)
    v_mfma_f32_32x32x16_bf16 v[136:151], v[40:43], v[236:239], v[136:151]
    ds_read_b64_tr_b16 v[36:37], v25 offset:45056
    ds_read_b64_tr_b16 v[38:39], v25 offset:47104
    s_waitcnt lgkmcnt(10)
    v_mfma_f32_32x32x16_bf16 v[88:103], v[44:47], v[236:239], v[88:103]
    ds_read_b64_tr_b16 v[40:41], v22 offset:45056
    ds_read_b64_tr_b16 v[42:43], v22 offset:47104
    s_waitcnt lgkmcnt(10)
    v_mfma_f32_32x32x16_bf16 v[104:119], v[48:51], v[236:239], v[104:119]
    buffer_load_dwordx4 v[212:215], v249, s[32:35], s16 offen offset:3072 sc1
    ds_read_b64_tr_b16 v[44:45], v23 offset:45056
    ds_read_b64_tr_b16 v[46:47], v23 offset:47104
    s_waitcnt vmcnt(17)
    s_waitcnt lgkmcnt(10)
    v_mfma_f32_32x32x16_bf16 v[56:71], v[52:55], v[240:243], v[56:71]
    s_add_u32 s16, s16, 16384
    ds_read_b64_tr_b16 v[48:49], v20 offset:46080
    ds_read_b64_tr_b16 v[50:51], v20 offset:48128
    s_waitcnt lgkmcnt(10)
    v_mfma_f32_32x32x16_bf16 v[72:87], v[28:31], v[240:243], v[72:87]
    s_and_b32 s16, s16, 0x3ffff
    ds_read_b64_tr_b16 v[52:53], v21 offset:46080
    ds_read_b64_tr_b16 v[54:55], v21 offset:48128
    s_waitcnt lgkmcnt(10)
    v_mfma_f32_32x32x16_bf16 v[120:135], v[32:35], v[240:243], v[120:135]
    buffer_load_dwordx4 v[216:219], v249, s[32:35], s16 offen sc1
    ds_read_b64_tr_b16 v[28:29], v24 offset:46080
    ds_read_b64_tr_b16 v[30:31], v24 offset:48128
    s_waitcnt lgkmcnt(10)
    v_mfma_f32_32x32x16_bf16 v[136:151], v[36:39], v[240:243], v[136:151]
    ds_read_b64_tr_b16 v[32:33], v25 offset:46080
    ds_read_b64_tr_b16 v[34:35], v25 offset:48128
    s_waitcnt lgkmcnt(10)
    v_mfma_f32_32x32x16_bf16 v[88:103], v[40:43], v[240:243], v[88:103]
    ds_read_b64_tr_b16 v[36:37], v22 offset:46080
    ds_read_b64_tr_b16 v[38:39], v22 offset:48128
    s_waitcnt lgkmcnt(10)
    v_mfma_f32_32x32x16_bf16 v[104:119], v[44:47], v[240:243], v[104:119]
    buffer_load_dwordx4 v[220:223], v249, s[32:35], s16 offen offset:1024 sc1
    ds_read_b64_tr_b16 v[40:41], v23 offset:46080
    ds_read_b64_tr_b16 v[42:43], v23 offset:48128
    s_waitcnt vmcnt(18)
    s_waitcnt lgkmcnt(10)
    v_mfma_f32_32x32x16_bf16 v[56:71], v[48:51], v[244:247], v[56:71]
    ds_read_b64_tr_b16 v[44:45], v20
    ds_read_b64_tr_b16 v[46:47], v20 offset:2048
    s_waitcnt lgkmcnt(10)
    v_mfma_f32_32x32x16_bf16 v[72:87], v[52:55], v[244:247], v[72:87]
    ds_read_b64_tr_b16 v[48:49], v21
    ds_read_b64_tr_b16 v[50:51], v21 offset:2048
    s_waitcnt lgkmcnt(10)
    v_mfma_f32_32x32x16_bf16 v[120:135], v[28:31], v[244:247], v[120:135]
    buffer_load_dwordx4 v[224:227], v249, s[32:35], s16 offen offset:2048 sc1
    ds_read_b64_tr_b16 v[52:53], v24
    ds_read_b64_tr_b16 v[54:55], v24 offset:2048
    s_waitcnt lgkmcnt(10)
    v_mfma_f32_32x32x16_bf16 v[136:151], v[32:35], v[244:247], v[136:151]
    ds_read_b64_tr_b16 v[28:29], v25
    ds_read_b64_tr_b16 v[30:31], v25 offset:2048
    s_waitcnt lgkmcnt(10)
    v_mfma_f32_32x32x16_bf16 v[88:103], v[36:39], v[244:247], v[88:103]
    ds_read_b64_tr_b16 v[32:33], v22
    ds_read_b64_tr_b16 v[34:35], v22 offset:2048
    s_waitcnt lgkmcnt(10)
    v_mfma_f32_32x32x16_bf16 v[104:119], v[40:43], v[244:247], v[104:119]
    buffer_load_dwordx4 v[228:231], v249, s[32:35], s16 offen offset:3072 sc1
    ds_read_b64_tr_b16 v[36:37], v23
    ds_read_b64_tr_b16 v[38:39], v23 offset:2048
    s_barrier
    s_waitcnt vmcnt(19)
    s_waitcnt lgkmcnt(10)
    v_mfma_f32_32x32x16_bf16 v[56:71], v[44:47], v[152:155], v[56:71]
    s_add_u32 s16, s16, 16384
    ds_read_b64_tr_b16 v[40:41], v20 offset:1024
    ds_read_b64_tr_b16 v[42:43], v20 offset:3072
    s_waitcnt lgkmcnt(10)
    v_mfma_f32_32x32x16_bf16 v[72:87], v[48:51], v[152:155], v[72:87]
    s_and_b32 s16, s16, 0x3ffff
    ds_read_b64_tr_b16 v[44:45], v21 offset:1024
    ds_read_b64_tr_b16 v[46:47], v21 offset:3072
    s_waitcnt lgkmcnt(10)
    v_mfma_f32_32x32x16_bf16 v[120:135], v[52:55], v[152:155], v[120:135]
    ds_read_b64_tr_b16 v[48:49], v24 offset:1024
    ds_read_b64_tr_b16 v[50:51], v24 offset:3072
    s_waitcnt lgkmcnt(10)
    v_mfma_f32_32x32x16_bf16 v[136:151], v[28:31], v[152:155], v[136:151]
    ds_read_b64_tr_b16 v[52:53], v25 offset:1024
    ds_read_b64_tr_b16 v[54:55], v25 offset:3072
    s_waitcnt lgkmcnt(10)
    v_mfma_f32_32x32x16_bf16 v[88:103], v[32:35], v[152:155], v[88:103]
    ds_read_b64_tr_b16 v[28:29], v22 offset:1024
    ds_read_b64_tr_b16 v[30:31], v22 offset:3072
    s_waitcnt lgkmcnt(10)
    v_mfma_f32_32x32x16_bf16 v[104:119], v[36:39], v[152:155], v[104:119]
    ds_read_b64_tr_b16 v[32:33], v23 offset:1024
    ds_read_b64_tr_b16 v[34:35], v23 offset:3072
    s_waitcnt vmcnt(18)
    s_waitcnt lgkmcnt(10)
    v_mfma_f32_32x32x16_bf16 v[56:71], v[40:43], v[156:159], v[56:71]
    ds_read_b64_tr_b16 v[36:37], v20 offset:4096
    ds_read_b64_tr_b16 v[38:39], v20 offset:6144
    s_waitcnt lgkmcnt(10)
    v_mfma_f32_32x32x16_bf16 v[72:87], v[44:47], v[156:159], v[72:87]
    ds_read_b64_tr_b16 v[40:41], v21 offset:4096
    ds_read_b64_tr_b16 v[42:43], v21 offset:6144
    s_waitcnt lgkmcnt(10)
    v_mfma_f32_32x32x16_bf16 v[120:135], v[48:51], v[156:159], v[120:135]
    ds_read_b64_tr_b16 v[44:45], v24 offset:4096
    ds_read_b64_tr_b16 v[46:47], v24 offset:6144
    s_waitcnt lgkmcnt(10)
    v_mfma_f32_32x32x16_bf16 v[136:151], v[52:55], v[156:159], v[136:151]
    buffer_load_dwordx4 v[232:235], v249, s[32:35], s16 offen sc1
    ds_read_b64_tr_b16 v[48:49], v25 offset:4096
    ds_read_b64_tr_b16 v[50:51], v25 offset:6144
    s_waitcnt lgkmcnt(10)
    v_mfma_f32_32x32x16_bf16 v[88:103], v[28:31], v[156:159], v[88:103]
    ds_read_b64_tr_b16 v[52:53], v22 offset:4096
    ds_read_b64_tr_b16 v[54:55], v22 offset:6144
    s_waitcnt lgkmcnt(10)
    v_mfma_f32_32x32x16_bf16 v[104:119], v[32:35], v[156:159], v[104:119]
    ds_read_b64_tr_b16 v[28:29], v23 offset:4096
    ds_read_b64_tr_b16 v[30:31], v23 offset:6144
    s_waitcnt vmcnt(18)
    s_waitcnt lgkmcnt(10)
    v_mfma_f32_32x32x16_bf16 v[56:71], v[36:39], v[160:163], v[56:71]
    ds_read_b64_tr_b16 v[32:33], v20 offset:5120
    ds_read_b64_tr_b16 v[34:35], v20 offset:7168
    s_waitcnt lgkmcnt(10)
    v_mfma_f32_32x32x16_bf16 v[72:87], v[40:43], v[160:163], v[72:87]
    buffer_load_dwordx4 v[236:239], v249, s[32:35], s16 offen offset:1024 sc1
    ds_read_b64_tr_b16 v[36:37], v21 offset:5120
    ds_read_b64_tr_b16 v[38:39], v21 offset:7168
    s_waitcnt lgkmcnt(10)
    v_mfma_f32_32x32x16_bf16 v[120:135], v[44:47], v[160:163], v[120:135]
    ds_read_b64_tr_b16 v[40:41], v24 offset:5120
    ds_read_b64_tr_b16 v[42:43], v24 offset:7168
    s_waitcnt lgkmcnt(10)
    v_mfma_f32_32x32x16_bf16 v[136:151], v[48:51], v[160:163], v[136:151]
    ds_read_b64_tr_b16 v[44:45], v25 offset:5120
    ds_read_b64_tr_b16 v[46:47], v25 offset:7168
    s_waitcnt lgkmcnt(10)
    v_mfma_f32_32x32x16_bf16 v[88:103], v[52:55], v[160:163], v[88:103]
    buffer_load_dwordx4 v[240:243], v249, s[32:35], s16 offen offset:2048 sc1
    ds_read_b64_tr_b16 v[48:49], v22 offset:5120
    ds_read_b64_tr_b16 v[50:51], v22 offset:7168
    s_waitcnt lgkmcnt(10)
    v_mfma_f32_32x32x16_bf16 v[104:119], v[28:31], v[160:163], v[104:119]
    ds_read_b64_tr_b16 v[52:53], v23 offset:5120
    ds_read_b64_tr_b16 v[54:55], v23 offset:7168
    s_waitcnt vmcnt(19)
    s_waitcnt lgkmcnt(10)
    v_mfma_f32_32x32x16_bf16 v[56:71], v[32:35], v[164:167], v[56:71]
    ds_read_b64_tr_b16 v[28:29], v20 offset:8192
    ds_read_b64_tr_b16 v[30:31], v20 offset:10240
    s_waitcnt lgkmcnt(10)
    v_mfma_f32_32x32x16_bf16 v[72:87], v[36:39], v[164:167], v[72:87]
    ds_read_b64_tr_b16 v[32:33], v21 offset:8192
    ds_read_b64_tr_b16 v[34:35], v21 offset:10240
    s_waitcnt lgkmcnt(10)
    v_mfma_f32_32x32x16_bf16 v[120:135], v[40:43], v[164:167], v[120:135]
    buffer_load_dwordx4 v[244:247], v249, s[32:35], s16 offen offset:3072 sc1
    ds_read_b64_tr_b16 v[36:37], v24 offset:8192
    ds_read_b64_tr_b16 v[38:39], v24 offset:10240
    s_waitcnt lgkmcnt(10)
    v_mfma_f32_32x32x16_bf16 v[136:151], v[44:47], v[164:167], v[136:151]
    s_add_u32 s16, s16, 16384
    ds_read_b64_tr_b16 v[40:41], v25 offset:8192
    ds_read_b64_tr_b16 v[42:43], v25 offset:10240
    s_waitcnt lgkmcnt(10)
    v_mfma_f32_32x32x16_bf16 v[88:103], v[48:51], v[164:167], v[88:103]
    s_and_b32 s16, s16, 0x3ffff
    ds_read_b64_tr_b16 v[44:45], v22 offset:8192
    ds_read_b64_tr_b16 v[46:47], v22 offset:10240
    s_waitcnt lgkmcnt(10)
    v_mfma_f32_32x32x16_bf16 v[104:119], v[52:55], v[164:167], v[104:119]
    buffer_load_dwordx4 v[152:155], v249, s[32:35], s16 offen sc1
    ds_read_b64_tr_b16 v[48:49], v23 offset:8192
    ds_read_b64_tr_b16 v[50:51], v23 offset:10240
    s_barrier
    s_waitcnt vmcnt(20)
    s_waitcnt lgkmcnt(10)
    v_mfma_f32_32x32x16_bf16 v[56:71], v[28:31], v[168:171], v[56:71]
    ds_read_b64_tr_b16 v[52:53], v20 offset:9216
    ds_read_b64_tr_b16 v[54:55], v20 offset:11264
    s_waitcnt lgkmcnt(10)
    v_mfma_f32_32x32x16_bf16 v[72:87], v[32:35], v[168:171], v[72:87]
    ds_read_b64_tr_b16 v[28:29], v21 offset:9216
    ds_read_b64_tr_b16 v[30:31], v21 offset:11264
    s_waitcnt lgkmcnt(10)
    v_mfma_f32_32x32x16_bf16 v[120:135], v[36:39], v[168:171], v[120:135]
    ds_read_b64_tr_b16 v[32:33], v24 offset:9216
    ds_read_b64_tr_b16 v[34:35], v24 offset:11264
    s_waitcnt lgkmcnt(10)
    v_mfma_f32_32x32x16_bf16 v[136:151], v[40:43], v[168:171], v[136:151]
    ds_read_b64_tr_b16 v[36:37], v25 offset:9216
    ds_read_b64_tr_b16 v[38:39], v25 offset:11264
    s_waitcnt lgkmcnt(10)
    v_mfma_f32_32x32x16_bf16 v[88:103], v[44:47], v[168:171], v[88:103]
    ds_read_b64_tr_b16 v[40:41], v22 offset:9216
    ds_read_b64_tr_b16 v[42:43], v22 offset:11264
    s_waitcnt lgkmcnt(10)
    v_mfma_f32_32x32x16_bf16 v[104:119], v[48:51], v[168:171], v[104:119]
    ds_read_b64_tr_b16 v[44:45], v23 offset:9216
    ds_read_b64_tr_b16 v[46:47], v23 offset:11264
    s_waitcnt vmcnt(19)
    s_waitcnt lgkmcnt(10)
    v_mfma_f32_32x32x16_bf16 v[56:71], v[52:55], v[172:175], v[56:71]
    ds_read_b64_tr_b16 v[48:49], v20 offset:12288
    ds_read_b64_tr_b16 v[50:51], v20 offset:14336
    s_waitcnt lgkmcnt(10)
    v_mfma_f32_32x32x16_bf16 v[72:87], v[28:31], v[172:175], v[72:87]
    ds_read_b64_tr_b16 v[52:53], v21 offset:12288
    ds_read_b64_tr_b16 v[54:55], v21 offset:14336
    s_waitcnt lgkmcnt(10)
    v_mfma_f32_32x32x16_bf16 v[120:135], v[32:35], v[172:175], v[120:135]
    ds_read_b64_tr_b16 v[28:29], v24 offset:12288
    ds_read_b64_tr_b16 v[30:31], v24 offset:14336
    s_waitcnt lgkmcnt(10)
    v_mfma_f32_32x32x16_bf16 v[136:151], v[36:39], v[172:175], v[136:151]
    buffer_load_dwordx4 v[156:159], v249, s[32:35], s16 offen offset:1024 sc1
    ds_read_b64_tr_b16 v[32:33], v25 offset:12288
    ds_read_b64_tr_b16 v[34:35], v25 offset:14336
    s_waitcnt lgkmcnt(10)
    v_mfma_f32_32x32x16_bf16 v[88:103], v[40:43], v[172:175], v[88:103]
    ds_read_b64_tr_b16 v[36:37], v22 offset:12288
    ds_read_b64_tr_b16 v[38:39], v22 offset:14336
    s_waitcnt lgkmcnt(10)
    v_mfma_f32_32x32x16_bf16 v[104:119], v[44:47], v[172:175], v[104:119]
    ds_read_b64_tr_b16 v[40:41], v23 offset:12288
    ds_read_b64_tr_b16 v[42:43], v23 offset:14336
    s_waitcnt vmcnt(19)
    s_waitcnt lgkmcnt(10)
    v_mfma_f32_32x32x16_bf16 v[56:71], v[48:51], v[176:179], v[56:71]
    ds_read_b64_tr_b16 v[44:45], v20 offset:13312
    ds_read_b64_tr_b16 v[46:47], v20 offset:15360
    s_waitcnt lgkmcnt(10)
    v_mfma_f32_32x32x16_bf16 v[72:87], v[52:55], v[176:179], v[72:87]
    buffer_load_dwordx4 v[160:163], v249, s[32:35], s16 offen offset:2048 sc1
    ds_read_b64_tr_b16 v[48:49], v21 offset:13312
    ds_read_b64_tr_b16 v[50:51], v21 offset:15360
    s_waitcnt lgkmcnt(10)
    v_mfma_f32_32x32x16_bf16 v[120:135], v[28:31], v[176:179], v[120:135]
    ds_read_b64_tr_b16 v[52:53], v24 offset:13312
    ds_read_b64_tr_b16 v[54:55], v24 offset:15360
    s_waitcnt lgkmcnt(10)
    v_mfma_f32_32x32x16_bf16 v[136:151], v[32:35], v[176:179], v[136:151]
    ds_read_b64_tr_b16 v[28:29], v25 offset:13312
    ds_read_b64_tr_b16 v[30:31], v25 offset:15360
    s_waitcnt lgkmcnt(10)
    v_mfma_f32_32x32x16_bf16 v[88:103], v[36:39], v[176:179], v[88:103]
    buffer_load_dwordx4 v[164:167], v249, s[32:35], s16 offen offset:3072 sc1
    ds_read_b64_tr_b16 v[32:33], v22 offset:13312
    ds_read_b64_tr_b16 v[34:35], v22 offset:15360
    s_waitcnt lgkmcnt(10)
    v_mfma_f32_32x32x16_bf16 v[104:119], v[40:43], v[176:179], v[104:119]
    s_add_u32 s16, s16, 16384
    ds_read_b64_tr_b16 v[36:37], v23 offset:13312
    ds_read_b64_tr_b16 v[38:39], v23 offset:15360
    s_waitcnt vmcnt(20)
    s_waitcnt lgkmcnt(10)
    v_mfma_f32_32x32x16_bf16 v[56:71], v[44:47], v[180:183], v[56:71]
    s_and_b32 s16, s16, 0x3ffff
    ds_read_b64_tr_b16 v[40:41], v20 offset:16384
    ds_read_b64_tr_b16 v[42:43], v20 offset:18432
    s_waitcnt lgkmcnt(10)
    v_mfma_f32_32x32x16_bf16 v[72:87], v[48:51], v[180:183], v[72:87]
    ds_read_b64_tr_b16 v[44:45], v21 offset:16384
    ds_read_b64_tr_b16 v[46:47], v21 offset:18432
    s_waitcnt lgkmcnt(10)
    v_mfma_f32_32x32x16_bf16 v[120:135], v[52:55], v[180:183], v[120:135]
    buffer_load_dwordx4 v[168:171], v249, s[32:35], s16 offen sc1
    ds_read_b64_tr_b16 v[48:49], v24 offset:16384
    ds_read_b64_tr_b16 v[50:51], v24 offset:18432
    s_waitcnt lgkmcnt(10)
    v_mfma_f32_32x32x16_bf16 v[136:151], v[28:31], v[180:183], v[136:151]
    ds_read_b64_tr_b16 v[52:53], v25 offset:16384
    ds_read_b64_tr_b16 v[54:55], v25 offset:18432
    s_waitcnt lgkmcnt(10)
    v_mfma_f32_32x32x16_bf16 v[88:103], v[32:35], v[180:183], v[88:103]
    ds_read_b64_tr_b16 v[28:29], v22 offset:16384
    ds_read_b64_tr_b16 v[30:31], v22 offset:18432
    s_waitcnt lgkmcnt(10)
    v_mfma_f32_32x32x16_bf16 v[104:119], v[36:39], v[180:183], v[104:119]
    buffer_load_dwordx4 v[172:175], v249, s[32:35], s16 offen offset:1024 sc1
    ds_read_b64_tr_b16 v[32:33], v23 offset:16384
    ds_read_b64_tr_b16 v[34:35], v23 offset:18432
    s_barrier
    s_waitcnt vmcnt(21)
    s_waitcnt lgkmcnt(10)
    v_mfma_f32_32x32x16_bf16 v[56:71], v[40:43], v[184:187], v[56:71]
    ds_read_b64_tr_b16 v[36:37], v20 offset:17408
    ds_read_b64_tr_b16 v[38:39], v20 offset:19456
    s_waitcnt lgkmcnt(10)
    v_mfma_f32_32x32x16_bf16 v[72:87], v[44:47], v[184:187], v[72:87]
    ds_read_b64_tr_b16 v[40:41], v21 offset:17408
    ds_read_b64_tr_b16 v[42:43], v21 offset:19456
    s_waitcnt lgkmcnt(10)
    v_mfma_f32_32x32x16_bf16 v[120:135], v[48:51], v[184:187], v[120:135]
    ds_read_b64_tr_b16 v[44:45], v24 offset:17408
    ds_read_b64_tr_b16 v[46:47], v24 offset:19456
    s_waitcnt lgkmcnt(10)
    v_mfma_f32_32x32x16_bf16 v[136:151], v[52:55], v[184:187], v[136:151]
    ds_read_b64_tr_b16 v[48:49], v25 offset:17408
    ds_read_b64_tr_b16 v[50:51], v25 offset:19456
    s_waitcnt lgkmcnt(10)
    v_mfma_f32_32x32x16_bf16 v[88:103], v[28:31], v[184:187], v[88:103]
    ds_read_b64_tr_b16 v[52:53], v22 offset:17408
    ds_read_b64_tr_b16 v[54:55], v22 offset:19456
    s_waitcnt lgkmcnt(10)
    v_mfma_f32_32x32x16_bf16 v[104:119], v[32:35], v[184:187], v[104:119]
    ds_read_b64_tr_b16 v[28:29], v23 offset:17408
    ds_read_b64_tr_b16 v[30:31], v23 offset:19456
    s_waitcnt vmcnt(20)
    s_waitcnt lgkmcnt(10)
    v_mfma_f32_32x32x16_bf16 v[56:71], v[36:39], v[188:191], v[56:71]
    ds_read_b64_tr_b16 v[32:33], v20 offset:20480
    ds_read_b64_tr_b16 v[34:35], v20 offset:22528
    s_waitcnt lgkmcnt(10)
    v_mfma_f32_32x32x16_bf16 v[72:87], v[40:43], v[188:191], v[72:87]
    ds_read_b64_tr_b16 v[36:37], v21 offset:20480
    ds_read_b64_tr_b16 v[38:39], v21 offset:22528
    s_waitcnt lgkmcnt(10)
    v_mfma_f32_32x32x16_bf16 v[120:135], v[44:47], v[188:191], v[120:135]
    ds_read_b64_tr_b16 v[40:41], v24 offset:20480
    ds_read_b64_tr_b16 v[42:43], v24 offset:22528
    s_waitcnt lgkmcnt(10)
    v_mfma_f32_32x32x16_bf16 v[136:151], v[48:51], v[188:191], v[136:151]
    buffer_load_dwordx4 v[176:179], v249, s[32:35], s16 offen offset:2048 sc1
    ds_read_b64_tr_b16 v[44:45], v25 offset:20480
    ds_read_b64_tr_b16 v[46:47], v25 offset:22528
    s_waitcnt lgkmcnt(10)
    v_mfma_f32_32x32x16_bf16 v[88:103], v[52:55], v[188:191], v[88:103]
    ds_read_b64_tr_b16 v[48:49], v22 offset:20480
    ds_read_b64_tr_b16 v[50:51], v22 offset:22528
    s_waitcnt lgkmcnt(10)
    v_mfma_f32_32x32x16_bf16 v[104:119], v[28:31], v[188:191], v[104:119]
    ds_read_b64_tr_b16 v[52:53], v23 offset:20480
L_PAD3:
    s_cbranch_execz L_RET3
    ds_read_b64_tr_b16 v[54:55], v23 offset:22528
    s_waitcnt vmcnt(20)
    s_waitcnt lgkmcnt(10)
    v_mfma_f32_32x32x16_bf16 v[56:71], v[32:35], v[192:195], v[56:71]
    ds_read_b64_tr_b16 v[28:29], v20 offset:21504
    ds_read_b64_tr_b16 v[30:31], v20 offset:23552
    s_waitcnt lgkmcnt(10)
    v_mfma_f32_32x32x16_bf16 v[72:87], v[36:39], v[192:195], v[72:87]
    buffer_load_dwordx4 v[180:183], v249, s[32:35], s16 offen offset:3072 sc1
    ds_read_b64_tr_b16 v[32:33], v21 offset:21504
    ds_read_b64_tr_b16 v[34:35], v21 offset:23552
    s_waitcnt lgkmcnt(10)
    v_mfma_f32_32x32x16_bf16 v[120:135], v[40:43], v[192:195], v[120:135]
    s_add_u32 s16, s16, 16384
    ds_read_b64_tr_b16 v[36:37], v24 offset:21504
    ds_read_b64_tr_b16 v[38:39], v24 offset:23552
    s_waitcnt lgkmcnt(10)
    v_mfma_f32_32x32x16_bf16 v[136:151], v[44:47], v[192:195], v[136:151]
    s_and_b32 s16, s16, 0x3ffff
    ds_read_b64_tr_b16 v[40:41], v25 offset:21504
    ds_read_b64_tr_b16 v[42:43], v25 offset:23552
    s_waitcnt lgkmcnt(10)
    v_mfma_f32_32x32x16_bf16 v[88:103], v[48:51], v[192:195], v[88:103]
    buffer_load_dwordx4 v[184:187], v249, s[32:35], s16 offen sc1
    ds_read_b64_tr_b16 v[44:45], v22 offset:21504
    ds_read_b64_tr_b16 v[46:47], v22 offset:23552
    s_waitcnt lgkmcnt(10)
    v_mfma_f32_32x32x16_bf16 v[104:119], v[52:55], v[192:195], v[104:119]
    ds_read_b64_tr_b16 v[48:49], v23 offset:21504
    ds_read_b64_tr_b16 v[50:51], v23 offset:23552
    s_waitcnt vmcnt(21)
    s_waitcnt lgkmcnt(10)
    v_mfma_f32_32x32x16_bf16 v[56:71], v[28:31], v[196:199], v[56:71]
    ds_read_b64_tr_b16 v[52:53], v20 offset:24576
    ds_read_b64_tr_b16 v[54:55], v20 offset:26624
    s_waitcnt lgkmcnt(10)
    v_mfma_f32_32x32x16_bf16 v[72:87], v[32:35], v[196:199], v[72:87]
    ds_read_b64_tr_b16 v[28:29], v21 offset:24576
    ds_read_b64_tr_b16 v[30:31], v21 offset:26624
    s_waitcnt lgkmcnt(10)
    v_mfma_f32_32x32x16_bf16 v[120:135], v[36:39], v[196:199], v[120:135]
    buffer_load_dwordx4 v[188:191], v249, s[32:35], s16 offen offset:1024 sc1
    ds_read_b64_tr_b16 v[32:33], v20 offset:25600
    ds_read_b64_tr_b16 v[34:35], v20 offset:27648
    s_waitcnt lgkmcnt(10)
    v_mfma_f32_32x32x16_bf16 v[136:151], v[40:43], v[196:199], v[136:151]
    ds_read_b64_tr_b16 v[36:37], v21 offset:25600
    ds_read_b64_tr_b16 v[38:39], v21 offset:27648
    s_waitcnt lgkmcnt(10)
    v_mfma_f32_32x32x16_bf16 v[88:103], v[44:47], v[196:199], v[88:103]
    ds_read_b64_tr_b16 v[40:41], v20 offset:28672
    ds_read_b64_tr_b16 v[42:43], v20 offset:30720
    s_waitcnt lgkmcnt(10)
    v_mfma_f32_32x32x16_bf16 v[104:119], v[48:51], v[196:199], v[104:119]
    buffer_load_dwordx4 v[192:195], v249, s[32:35], s16 offen offset:2048 sc1
    ds_read_b64_tr_b16 v[44:45], v21 offset:28672
    ds_read_b64_tr_b16 v[46:47], v21 offset:30720
    s_barrier
    s_waitcnt vmcnt(22)
    s_waitcnt lgkmcnt(10)
    v_mfma_f32_32x32x16_bf16 v[56:71], v[52:55], v[200:203], v[56:71]
    ds_read_b64_tr_b16 v[48:49], v20 offset:29696
    ds_read_b64_tr_b16 v[50:51], v20 offset:31744
    s_waitcnt lgkmcnt(10)
    v_mfma_f32_32x32x16_bf16 v[72:87], v[28:31], v[200:203], v[72:87]
    ds_read_b64_tr_b16 v[52:53], v21 offset:29696
    ds_read_b64_tr_b16 v[54:55], v21 offset:31744
    s_waitcnt vmcnt(21)
    s_waitcnt lgkmcnt(10)
    v_mfma_f32_32x32x16_bf16 v[56:71], v[32:35], v[204:207], v[56:71]
    ds_read_b64_tr_b16 v[28:29], v24 offset:24576
    ds_read_b64_tr_b16 v[30:31], v24 offset:26624
    s_waitcnt lgkmcnt(10)
    v_mfma_f32_32x32x16_bf16 v[72:87], v[36:39], v[204:207], v[72:87]
    ds_read_b64_tr_b16 v[32:33], v25 offset:24576
    ds_read_b64_tr_b16 v[34:35], v25 offset:26624
    s_waitcnt vmcnt(20)
    s_waitcnt lgkmcnt(10)
    v_mfma_f32_32x32x16_bf16 v[56:71], v[40:43], v[208:211], v[56:71]
    ds_read_b64_tr_b16 v[36:37], v22 offset:24576
    ds_read_b64_tr_b16 v[38:39], v22 offset:26624
    s_waitcnt lgkmcnt(10)
    v_mfma_f32_32x32x16_bf16 v[72:87], v[44:47], v[208:211], v[72:87]
    ds_read_b64_tr_b16 v[40:41], v23 offset:24576
    ds_read_b64_tr_b16 v[42:43], v23 offset:26624
    s_waitcnt vmcnt(19)
    s_waitcnt lgkmcnt(10)
    v_mfma_f32_32x32x16_bf16 v[56:71], v[48:51], v[212:215], v[56:71]
    ds_read_b64_tr_b16 v[44:45], v24 offset:25600
    ds_read_b64_tr_b16 v[46:47], v24 offset:27648
    s_waitcnt lgkmcnt(10)
    v_mfma_f32_32x32x16_bf16 v[72:87], v[52:55], v[212:215], v[72:87]
    ds_read_b64_tr_b16 v[48:49], v25 offset:25600
    ds_read_b64_tr_b16 v[50:51], v25 offset:27648
    s_barrier
    s_waitcnt lgkmcnt(10)
    v_mfma_f32_32x32x16_bf16 v[120:135], v[28:31], v[200:203], v[120:135]
    ds_read_b64_tr_b16 v[52:53], v22 offset:25600
    ds_read_b64_tr_b16 v[54:55], v22 offset:27648
    s_waitcnt lgkmcnt(10)
    v_mfma_f32_32x32x16_bf16 v[136:151], v[32:35], v[200:203], v[136:151]
    buffer_load_dwordx4 v[196:199], v249, s[32:35], s16 offen offset:3072 sc1
    ds_read_b64_tr_b16 v[28:29], v23 offset:25600
    ds_read_b64_tr_b16 v[30:31], v23 offset:27648
    s_waitcnt lgkmcnt(10)
    v_mfma_f32_32x32x16_bf16 v[88:103], v[36:39], v[200:203], v[88:103]
    s_add_u32 s16, s16, 16384
    ds_read_b64_tr_b16 v[32:33], v24 offset:28672
    ds_read_b64_tr_b16 v[34:35], v24 offset:30720
    s_waitcnt lgkmcnt(10)
    v_mfma_f32_32x32x16_bf16 v[104:119], v[40:43], v[200:203], v[104:119]
    s_and_b32 s16, s16, 0x3ffff
    ds_read_b64_tr_b16 v[36:37], v25 offset:28672
    ds_read_b64_tr_b16 v[38:39], v25 offset:30720
    s_waitcnt lgkmcnt(10)
    v_mfma_f32_32x32x16_bf16 v[120:135], v[44:47], v[204:207], v[120:135]
    ds_read_b64_tr_b16 v[40:41], v22 offset:28672
    ds_read_b64_tr_b16 v[42:43], v22 offset:30720
    s_waitcnt lgkmcnt(10)
    v_mfma_f32_32x32x16_bf16 v[136:151], v[48:51], v[204:207], v[136:151]
    buffer_load_dwordx4 v[200:203], v249, s[32:35], s16 offen sc1
    ds_read_b64_tr_b16 v[44:45], v23 offset:28672
    ds_read_b64_tr_b16 v[46:47], v23 offset:30720
    s_waitcnt lgkmcnt(10)
    v_mfma_f32_32x32x16_bf16 v[88:103], v[52:55], v[204:207], v[88:103]
    ds_read_b64_tr_b16 v[48:49], v24 offset:29696
    ds_read_b64_tr_b16 v[50:51], v24 offset:31744
    s_waitcnt lgkmcnt(10)
    v_mfma_f32_32x32x16_bf16 v[104:119], v[28:31], v[204:207], v[104:119]
    ds_read_b64_tr_b16 v[52:53], v25 offset:29696
    ds_read_b64_tr_b16 v[54:55], v25 offset:31744
    s_waitcnt lgkmcnt(10)
    v_mfma_f32_32x32x16_bf16 v[120:135], v[32:35], v[208:211], v[120:135]
    buffer_load_dwordx4 v[204:207], v249, s[32:35], s16 offen offset:1024 sc1
    ds_read_b64_tr_b16 v[28:29], v22 offset:29696
    ds_read_b64_tr_b16 v[30:31], v22 offset:31744
    s_waitcnt lgkmcnt(10)
    v_mfma_f32_32x32x16_bf16 v[136:151], v[36:39], v[208:211], v[136:151]
    ds_read_b64_tr_b16 v[32:33], v23 offset:29696
    ds_read_b64_tr_b16 v[34:35], v23 offset:31744
    s_waitcnt lgkmcnt(10)
    v_mfma_f32_32x32x16_bf16 v[88:103], v[40:43], v[208:211], v[88:103]
    ds_read_b64_tr_b16 v[36:37], v20 offset:32768
    ds_read_b64_tr_b16 v[38:39], v20 offset:34816
    s_waitcnt lgkmcnt(10)
    v_mfma_f32_32x32x16_bf16 v[104:119], v[44:47], v[208:211], v[104:119]
    ds_read_b64_tr_b16 v[40:41], v20 offset:33792
    ds_read_b64_tr_b16 v[42:43], v20 offset:35840
    s_waitcnt lgkmcnt(10)
    v_mfma_f32_32x32x16_bf16 v[120:135], v[48:51], v[212:215], v[120:135]
    buffer_load_dwordx4 v[208:211], v249, s[32:35], s16 offen offset:2048 sc1
    ds_read_b64_tr_b16 v[44:45], v20 offset:36864
    ds_read_b64_tr_b16 v[46:47], v20 offset:38912
    s_waitcnt lgkmcnt(10)
    v_mfma_f32_32x32x16_bf16 v[136:151], v[52:55], v[212:215], v[136:151]
    ds_read_b64_tr_b16 v[48:49], v20 offset:37888
    ds_read_b64_tr_b16 v[50:51], v20 offset:39936
    s_waitcnt lgkmcnt(10)
    v_mfma_f32_32x32x16_bf16 v[88:103], v[28:31], v[212:215], v[88:103]
    ds_read_b64_tr_b16 v[52:53], v20 offset:40960
    ds_read_b64_tr_b16 v[54:55], v20 offset:43008
    s_waitcnt lgkmcnt(10)
    v_mfma_f32_32x32x16_bf16 v[104:119], v[32:35], v[212:215], v[104:119]
    buffer_load_dwordx4 v[212:215], v249, s[32:35], s16 offen offset:3072 sc1
    ds_read_b64_tr_b16 v[28:29], v20 offset:41984
    ds_read_b64_tr_b16 v[30:31], v20 offset:44032
    s_barrier
    s_waitcnt vmcnt(23)
    s_waitcnt lgkmcnt(10)
    v_mfma_f32_32x32x16_bf16 v[56:71], v[36:39], v[216:219], v[56:71]
    s_add_u32 s16, s16, 16384
    ds_read_b64_tr_b16 v[32:33], v20 offset:45056
    ds_read_b64_tr_b16 v[34:35], v20 offset:47104
    s_waitcnt vmcnt(22)
    s_waitcnt lgkmcnt(10)
    v_mfma_f32_32x32x16_bf16 v[56:71], v[40:43], v[220:223], v[56:71]
    s_and_b32 s16, s16, 0x3ffff
    ds_read_b64_tr_b16 v[36:37], v20 offset:46080
    ds_read_b64_tr_b16 v[38:39], v20 offset:48128
    s_waitcnt vmcnt(21)
    s_waitcnt lgkmcnt(10)
    v_mfma_f32_32x32x16_bf16 v[56:71], v[44:47], v[224:227], v[56:71]
    ds_read_b64_tr_b16 v[40:41], v20
    ds_read_b64_tr_b16 v[42:43], v20 offset:2048
    s_waitcnt vmcnt(20)
    s_waitcnt lgkmcnt(10)
    v_mfma_f32_32x32x16_bf16 v[56:71], v[48:51], v[228:231], v[56:71]
    ds_read_b64_tr_b16 v[44:45], v20 offset:1024
    ds_read_b64_tr_b16 v[46:47], v20 offset:3072
    s_waitcnt vmcnt(19)
    s_waitcnt lgkmcnt(10)
    v_mfma_f32_32x32x16_bf16 v[56:71], v[52:55], v[232:235], v[56:71]
    ds_read_b64_tr_b16 v[48:49], v20 offset:4096
    ds_read_b64_tr_b16 v[50:51], v20 offset:6144
    s_waitcnt vmcnt(18)
    s_waitcnt lgkmcnt(10)
    v_mfma_f32_32x32x16_bf16 v[56:71], v[28:31], v[236:239], v[56:71]
    ds_read_b64_tr_b16 v[52:53], v20 offset:5120
    ds_read_b64_tr_b16 v[54:55], v20 offset:7168
    s_waitcnt vmcnt(17)
    s_waitcnt lgkmcnt(10)
    v_mfma_f32_32x32x16_bf16 v[56:71], v[32:35], v[240:243], v[56:71]
    ds_read_b64_tr_b16 v[28:29], v20 offset:8192
    ds_read_b64_tr_b16 v[30:31], v20 offset:10240
    s_waitcnt vmcnt(16)
    s_waitcnt lgkmcnt(10)
    v_mfma_f32_32x32x16_bf16 v[56:71], v[36:39], v[244:247], v[56:71]
    ds_read_b64_tr_b16 v[32:33], v20 offset:9216
    ds_read_b64_tr_b16 v[34:35], v20 offset:11264
    s_waitcnt vmcnt(15)
    s_waitcnt lgkmcnt(10)
    v_mfma_f32_32x32x16_bf16 v[56:71], v[40:43], v[152:155], v[56:71]
    ds_read_b64_tr_b16 v[36:37], v20 offset:12288
    ds_read_b64_tr_b16 v[38:39], v20 offset:14336
    s_waitcnt vmcnt(14)
    s_waitcnt lgkmcnt(10)
    v_mfma_f32_32x32x16_bf16 v[56:71], v[44:47], v[156:159], v[56:71]
    ds_read_b64_tr_b16 v[40:41], v20 offset:13312
    ds_read_b64_tr_b16 v[42:43], v20 offset:15360
    s_waitcnt vmcnt(13)
    s_waitcnt lgkmcnt(10)
    v_mfma_f32_32x32x16_bf16 v[56:71], v[48:51], v[160:163], v[56:71]
    ds_read_b64_tr_b16 v[44:45], v20 offset:16384
    ds_read_b64_tr_b16 v[46:47], v20 offset:18432
    s_waitcnt vmcnt(12)
    s_waitcnt lgkmcnt(10)
    v_mfma_f32_32x32x16_bf16 v[56:71], v[52:55], v[164:167], v[56:71]
    ds_read_b64_tr_b16 v[48:49], v20 offset:17408
    ds_read_b64_tr_b16 v[50:51], v20 offset:19456
    s_waitcnt vmcnt(11)
    s_waitcnt lgkmcnt(10)
    v_mfma_f32_32x32x16_bf16 v[56:71], v[28:31], v[168:171], v[56:71]
    ds_read_b64_tr_b16 v[52:53], v20 offset:20480
    ds_read_b64_tr_b16 v[54:55], v20 offset:22528
    s_waitcnt vmcnt(10)
    s_waitcnt lgkmcnt(10)
    v_mfma_f32_32x32x16_bf16 v[56:71], v[32:35], v[172:175], v[56:71]
    ds_read_b64_tr_b16 v[28:29], v20 offset:21504
    ds_read_b64_tr_b16 v[30:31], v20 offset:23552
    s_barrier
    s_waitcnt vmcnt(9)
    s_waitcnt lgkmcnt(10)
    v_mfma_f32_32x32x16_bf16 v[56:71], v[36:39], v[176:179], v[56:71]
    ds_read_b64_tr_b16 v[32:33], v20 offset:24576
    ds_read_b64_tr_b16 v[34:35], v20 offset:26624
    s_waitcnt vmcnt(8)
    s_waitcnt lgkmcnt(10)
    v_mfma_f32_32x32x16_bf16 v[56:71], v[40:43], v[180:183], v[56:71]
    ds_read_b64_tr_b16 v[36:37], v20 offset:25600
    ds_read_b64_tr_b16 v[38:39], v20 offset:27648
    s_waitcnt vmcnt(7)
    s_waitcnt lgkmcnt(10)
    v_mfma_f32_32x32x16_bf16 v[56:71], v[44:47], v[184:187], v[56:71]
    ds_read_b64_tr_b16 v[40:41], v20 offset:28672
    ds_read_b64_tr_b16 v[42:43], v20 offset:30720
    s_waitcnt vmcnt(6)
    s_waitcnt lgkmcnt(10)
    v_mfma_f32_32x32x16_bf16 v[56:71], v[48:51], v[188:191], v[56:71]
    ds_read_b64_tr_b16 v[44:45], v20 offset:29696
    ds_read_b64_tr_b16 v[46:47], v20 offset:31744
    s_waitcnt vmcnt(5)
    s_waitcnt lgkmcnt(10)
    v_mfma_f32_32x32x16_bf16 v[56:71], v[52:55], v[192:195], v[56:71]
    ds_read_b64_tr_b16 v[48:49], v21 offset:32768
    ds_read_b64_tr_b16 v[50:51], v21 offset:34816
    s_waitcnt vmcnt(4)
    s_waitcnt lgkmcnt(10)
    v_mfma_f32_32x32x16_bf16 v[56:71], v[28:31], v[196:199], v[56:71]
    ds_read_b64_tr_b16 v[52:53], v21 offset:33792
    ds_read_b64_tr_b16 v[54:55], v21 offset:35840
    s_waitcnt vmcnt(3)
    s_waitcnt lgkmcnt(10)
    v_mfma_f32_32x32x16_bf16 v[56:71], v[32:35], v[200:203], v[56:71]
    ds_read_b64_tr_b16 v[28:29], v21 offset:36864
    ds_read_b64_tr_b16 v[30:31], v21 offset:38912
    s_waitcnt vmcnt(2)
    s_waitcnt lgkmcnt(10)
    v_mfma_f32_32x32x16_bf16 v[56:71], v[36:39], v[204:207], v[56:71]
    ds_read_b64_tr_b16 v[32:33], v21 offset:37888
    ds_read_b64_tr_b16 v[34:35], v21 offset:39936
    s_waitcnt vmcnt(1)
    s_waitcnt lgkmcnt(10)
    v_mfma_f32_32x32x16_bf16 v[56:71], v[40:43], v[208:211], v[56:71]
    ds_read_b64_tr_b16 v[36:37], v21 offset:40960
    ds_read_b64_tr_b16 v[38:39], v21 offset:43008
    s_waitcnt vmcnt(0)
    s_waitcnt lgkmcnt(10)
    v_mfma_f32_32x32x16_bf16 v[56:71], v[44:47], v[212:215], v[56:71]
    ds_read_b64_tr_b16 v[40:41], v21 offset:41984
    ds_read_b64_tr_b16 v[42:43], v21 offset:44032
    s_waitcnt lgkmcnt(10)
    v_mfma_f32_32x32x16_bf16 v[72:87], v[48:51], v[216:219], v[72:87]
    ds_read_b64_tr_b16 v[44:45], v21 offset:45056
    ds_read_b64_tr_b16 v[46:47], v21 offset:47104
    s_waitcnt lgkmcnt(10)
    v_mfma_f32_32x32x16_bf16 v[72:87], v[52:55], v[220:223], v[72:87]
    s_nop 3
    v_cvt_pk_bf16_f32 v56, v56, v57
    v_cvt_pk_bf16_f32 v57, v58, v59
    ds_read_b64_tr_b16 v[48:49], v21 offset:46080
    ds_read_b64_tr_b16 v[50:51], v21 offset:48128
    s_waitcnt lgkmcnt(10)
    v_mfma_f32_32x32x16_bf16 v[72:87], v[28:31], v[224:227], v[72:87]
    v_cvt_pk_bf16_f32 v58, v60, v61
    v_cvt_pk_bf16_f32 v59, v62, v63
    ds_read_b64_tr_b16 v[52:53], v21
    ds_read_b64_tr_b16 v[54:55], v21 offset:2048
    s_waitcnt lgkmcnt(10)
    v_mfma_f32_32x32x16_bf16 v[72:87], v[32:35], v[228:231], v[72:87]
    ds_write_b128 v0, v[56:59]
    v_cvt_pk_bf16_f32 v60, v64, v65
    ds_read_b64_tr_b16 v[28:29], v21 offset:1024
    ds_read_b64_tr_b16 v[30:31], v21 offset:3072
    s_waitcnt lgkmcnt(11)
    v_mfma_f32_32x32x16_bf16 v[72:87], v[36:39], v[232:235], v[72:87]
    v_cvt_pk_bf16_f32 v61, v66, v67
    v_cvt_pk_bf16_f32 v62, v68, v69
    ds_read_b64_tr_b16 v[32:33], v21 offset:4096
    ds_read_b64_tr_b16 v[34:35], v21 offset:6144
    s_waitcnt lgkmcnt(11)
    v_mfma_f32_32x32x16_bf16 v[72:87], v[40:43], v[236:239], v[72:87]
    v_cvt_pk_bf16_f32 v63, v70, v71
    ds_write_b128 v0, v[60:63] offset:1024
    ds_read_b64_tr_b16 v[36:37], v21 offset:5120
    ds_read_b64_tr_b16 v[38:39], v21 offset:7168
    s_waitcnt lgkmcnt(12)
    v_mfma_f32_32x32x16_bf16 v[72:87], v[44:47], v[240:243], v[72:87]
    v_subrev_u32 v0, 118784, v0
    ds_read_b64_tr_b16 v[40:41], v21 offset:8192
    ds_read_b64_tr_b16 v[42:43], v21 offset:10240
    s_waitcnt lgkmcnt(12)
    v_mfma_f32_32x32x16_bf16 v[72:87], v[48:51], v[244:247], v[72:87]
    ds_read_b64_tr_b16 v[44:45], v21 offset:9216
    ds_read_b64_tr_b16 v[46:47], v21 offset:11264
    s_waitcnt lgkmcnt(6)
    s_barrier
    v_mfma_f32_32x32x16_bf16 v[72:87], v[52:55], v[152:155], v[72:87]
    ds_read_b64_tr_b16 v[48:49], v21 offset:12288
    ds_read_b64_tr_b16 v[50:51], v21 offset:14336
    v_mfma_f32_32x32x16_bf16 v[72:87], v[28:31], v[156:159], v[72:87]
    ds_read_b64_tr_b16 v[52:53], v21 offset:13312
    ds_read_b64_tr_b16 v[54:55], v21 offset:15360
    v_mfma_f32_32x32x16_bf16 v[72:87], v[32:35], v[160:163], v[72:87]
    ds_read_b64_tr_b16 v[28:29], v21 offset:16384
    ds_read_b64_tr_b16 v[30:31], v21 offset:18432
    s_waitcnt lgkmcnt(10)
    v_mfma_f32_32x32x16_bf16 v[72:87], v[36:39], v[164:167], v[72:87]
    ds_read_b64_tr_b16 v[32:33], v21 offset:17408
    ds_read_b64_tr_b16 v[34:35], v21 offset:19456
    s_waitcnt lgkmcnt(10)
    v_mfma_f32_32x32x16_bf16 v[72:87], v[40:43], v[168:171], v[72:87]
    ds_read_b64_tr_b16 v[36:37], v21 offset:20480
    ds_read_b64_tr_b16 v[38:39], v21 offset:22528
    s_waitcnt lgkmcnt(10)
    v_mfma_f32_32x32x16_bf16 v[72:87], v[44:47], v[172:175], v[72:87]
    ds_read_b64_tr_b16 v[40:41], v21 offset:21504
    ds_read_b64_tr_b16 v[42:43], v21 offset:23552
    s_waitcnt lgkmcnt(10)
    v_mfma_f32_32x32x16_bf16 v[72:87], v[48:51], v[176:179], v[72:87]
    ds_read_b64_tr_b16 v[44:45], v21 offset:24576
    ds_read_b64_tr_b16 v[46:47], v21 offset:26624
    s_waitcnt lgkmcnt(10)
    v_mfma_f32_32x32x16_bf16 v[72:87], v[52:55], v[180:183], v[72:87]
    ds_read_b64_tr_b16 v[48:49], v21 offset:25600
    ds_read_b64_tr_b16 v[50:51], v21 offset:27648
    s_waitcnt lgkmcnt(10)
    v_mfma_f32_32x32x16_bf16 v[72:87], v[28:31], v[184:187], v[72:87]
    ds_read_b64_tr_b16 v[52:53], v21 offset:28672
    ds_read_b64_tr_b16 v[54:55], v21 offset:30720
    s_waitcnt lgkmcnt(10)
    v_mfma_f32_32x32x16_bf16 v[72:87], v[32:35], v[188:191], v[72:87]
    ds_read_b64_tr_b16 v[28:29], v21 offset:29696
    ds_read_b64_tr_b16 v[30:31], v21 offset:31744
    s_waitcnt lgkmcnt(10)
    v_mfma_f32_32x32x16_bf16 v[72:87], v[36:39], v[192:195], v[72:87]
    ds_read_b64_tr_b16 v[32:33], v22 offset:32768
    ds_read_b64_tr_b16 v[34:35], v22 offset:34816
    s_waitcnt lgkmcnt(10)
    v_mfma_f32_32x32x16_bf16 v[72:87], v[40:43], v[196:199], v[72:87]
    ds_read_b64_tr_b16 v[36:37], v23 offset:32768
    ds_read_b64_tr_b16 v[38:39], v23 offset:34816
    s_waitcnt lgkmcnt(10)
    v_mfma_f32_32x32x16_bf16 v[72:87], v[44:47], v[200:203], v[72:87]
    ds_read_b64_tr_b16 v[40:41], v22 offset:33792
    ds_read_b64_tr_b16 v[42:43], v22 offset:35840
    s_waitcnt lgkmcnt(10)
    v_mfma_f32_32x32x16_bf16 v[72:87], v[48:51], v[204:207], v[72:87]
    ds_read_b64_tr_b16 v[44:45], v23 offset:33792
    ds_read_b64_tr_b16 v[46:47], v23 offset:35840
    s_waitcnt lgkmcnt(10)
    v_mfma_f32_32x32x16_bf16 v[72:87], v[52:55], v[208:211], v[72:87]
    ds_read_b64_tr_b16 v[48:49], v22 offset:36864
    ds_read_b64_tr_b16 v[50:51], v22 offset:38912
    s_waitcnt lgkmcnt(10)
    v_mfma_f32_32x32x16_bf16 v[72:87], v[28:31], v[212:215], v[72:87]
    ds_read_b64_tr_b16 v[52:53], v23 offset:36864
    ds_read_b64_tr_b16 v[54:55], v23 offset:38912
    s_waitcnt lgkmcnt(10)
    v_mfma_f32_32x32x16_bf16 v[88:103], v[32:35], v[216:219], v[88:103]
    ds_read_b64_tr_b16 v[28:29], v22 offset:37888
    ds_read_b64_tr_b16 v[30:31], v22 offset:39936
    s_waitcnt lgkmcnt(10)
    v_mfma_f32_32x32x16_bf16 v[104:119], v[36:39], v[216:219], v[104:119]
    s_nop 3
    v_cvt_pk_bf16_f32 v72, v72, v73
    v_cvt_pk_bf16_f32 v73, v74, v75
    ds_read_b64_tr_b16 v[32:33], v23 offset:37888
    ds_read_b64_tr_b16 v[34:35], v23 offset:39936
    s_waitcnt lgkmcnt(10)
    v_mfma_f32_32x32x16_bf16 v[88:103], v[40:43], v[220:223], v[88:103]
    v_cvt_pk_bf16_f32 v74, v76, v77
    v_cvt_pk_bf16_f32 v75, v78, v79
    ds_read_b64_tr_b16 v[36:37], v22 offset:40960
    ds_read_b64_tr_b16 v[38:39], v22 offset:43008
    s_waitcnt lgkmcnt(10)
    v_mfma_f32_32x32x16_bf16 v[104:119], v[44:47], v[220:223], v[104:119]
    ds_write_b128 v0, v[72:75]
    v_cvt_pk_bf16_f32 v76, v80, v81
    ds_read_b64_tr_b16 v[40:41], v23 offset:40960
    ds_read_b64_tr_b16 v[42:43], v23 offset:43008
    s_waitcnt lgkmcnt(11)
    v_mfma_f32_32x32x16_bf16 v[88:103], v[48:51], v[224:227], v[88:103]
    v_cvt_pk_bf16_f32 v77, v82, v83
    v_cvt_pk_bf16_f32 v78, v84, v85
    ds_read_b64_tr_b16 v[44:45], v22 offset:41984
    ds_read_b64_tr_b16 v[46:47], v22 offset:44032
    s_waitcnt lgkmcnt(11)
    v_mfma_f32_32x32x16_bf16 v[104:119], v[52:55], v[224:227], v[104:119]
    v_cvt_pk_bf16_f32 v79, v86, v87
    ds_write_b128 v0, v[76:79] offset:1024
    ds_read_b64_tr_b16 v[48:49], v23 offset:41984
    ds_read_b64_tr_b16 v[50:51], v23 offset:44032
    s_waitcnt lgkmcnt(12)
    v_mfma_f32_32x32x16_bf16 v[88:103], v[28:31], v[228:231], v[88:103]
    ds_read_b64_tr_b16 v[52:53], v22 offset:45056
    ds_read_b64_tr_b16 v[54:55], v22 offset:47104
    s_waitcnt lgkmcnt(12)
    v_mfma_f32_32x32x16_bf16 v[104:119], v[32:35], v[228:231], v[104:119]
    ds_read_b64_tr_b16 v[28:29], v23 offset:45056
    ds_read_b64_tr_b16 v[30:31], v23 offset:47104
    s_waitcnt lgkmcnt(6)
    s_barrier
    v_mfma_f32_32x32x16_bf16 v[88:103], v[36:39], v[232:235], v[88:103]
    s_lshl_b32 s96, s77, 11
    s_add_u32 s14, s96, 32768
    v_and_b32 v0, 7, v1
    ds_read_b64_tr_b16 v[32:33], v22 offset:46080
    ds_read_b64_tr_b16 v[34:35], v22 offset:48128
    v_mfma_f32_32x32x16_bf16 v[104:119], v[40:43], v[232:235], v[104:119]
    v_lshl_add_u32 v0, v0, 4, s14
    ds_read_b64_tr_b16 v[36:37], v23 offset:46080
    ds_read_b64_tr_b16 v[38:39], v23 offset:48128
    v_mfma_f32_32x32x16_bf16 v[88:103], v[44:47], v[236:239], v[88:103]
    v_bfe_u32 v4, v1, 3, 2
    ds_read_b64_tr_b16 v[40:41], v22
    ds_read_b64_tr_b16 v[42:43], v22 offset:2048
    s_waitcnt lgkmcnt(10)
    v_mfma_f32_32x32x16_bf16 v[104:119], v[48:51], v[236:239], v[104:119]
    v_lshl_add_u32 v0, v4, 8, v0
    v_lshrrev_b32 v4, 5, v1
    ds_read_b64_tr_b16 v[44:45], v23
    ds_read_b64_tr_b16 v[46:47], v23 offset:2048
    s_waitcnt lgkmcnt(10)
    v_mfma_f32_32x32x16_bf16 v[88:103], v[52:55], v[240:243], v[88:103]
    v_lshl_add_u32 v0, v4, 7, v0
    ds_read_b64_tr_b16 v[48:49], v22 offset:1024
    ds_read_b64_tr_b16 v[50:51], v22 offset:3072
    s_waitcnt lgkmcnt(10)
    v_mfma_f32_32x32x16_bf16 v[104:119], v[28:31], v[240:243], v[104:119]
    ds_read_b64_tr_b16 v[52:53], v23 offset:1024
    ds_read_b64_tr_b16 v[54:55], v23 offset:3072
    s_waitcnt lgkmcnt(10)
    v_mfma_f32_32x32x16_bf16 v[88:103], v[32:35], v[244:247], v[88:103]
    ds_read_b64_tr_b16 v[28:29], v22 offset:4096
    ds_read_b64_tr_b16 v[30:31], v22 offset:6144
    s_waitcnt lgkmcnt(10)
    v_mfma_f32_32x32x16_bf16 v[104:119], v[36:39], v[244:247], v[104:119]
    ds_read_b64_tr_b16 v[32:33], v23 offset:4096
    ds_read_b64_tr_b16 v[34:35], v23 offset:6144
    s_waitcnt lgkmcnt(10)
    v_mfma_f32_32x32x16_bf16 v[88:103], v[40:43], v[152:155], v[88:103]
    ds_read_b64_tr_b16 v[36:37], v22 offset:5120
    ds_read_b64_tr_b16 v[38:39], v22 offset:7168
    s_waitcnt lgkmcnt(10)
    v_mfma_f32_32x32x16_bf16 v[104:119], v[44:47], v[152:155], v[104:119]
    ds_read_b64_tr_b16 v[40:41], v23 offset:5120
    ds_read_b64_tr_b16 v[42:43], v23 offset:7168
    s_waitcnt lgkmcnt(10)
    v_mfma_f32_32x32x16_bf16 v[88:103], v[48:51], v[156:159], v[88:103]
    ds_read_b64_tr_b16 v[44:45], v22 offset:8192
    ds_read_b64_tr_b16 v[46:47], v22 offset:10240
    s_waitcnt lgkmcnt(10)
    v_mfma_f32_32x32x16_bf16 v[104:119], v[52:55], v[156:159], v[104:119]
    ds_read_b64_tr_b16 v[48:49], v23 offset:8192
    ds_read_b64_tr_b16 v[50:51], v23 offset:10240
    s_waitcnt lgkmcnt(10)
    v_mfma_f32_32x32x16_bf16 v[88:103], v[28:31], v[160:163], v[88:103]
    ds_read_b64_tr_b16 v[52:53], v22 offset:9216
    ds_read_b64_tr_b16 v[54:55], v22 offset:11264
    s_waitcnt lgkmcnt(10)
    v_mfma_f32_32x32x16_bf16 v[104:119], v[32:35], v[160:163], v[104:119]
    ds_read_b64_tr_b16 v[28:29], v23 offset:9216
    ds_read_b64_tr_b16 v[30:31], v23 offset:11264
    s_waitcnt lgkmcnt(10)
    v_mfma_f32_32x32x16_bf16 v[88:103], v[36:39], v[164:167], v[88:103]
    ds_read_b64_tr_b16 v[32:33], v22 offset:12288
    ds_read_b64_tr_b16 v[34:35], v22 offset:14336
    s_waitcnt lgkmcnt(10)
    v_mfma_f32_32x32x16_bf16 v[104:119], v[40:43], v[164:167], v[104:119]
    ds_read_b64_tr_b16 v[36:37], v23 offset:12288
    ds_read_b64_tr_b16 v[38:39], v23 offset:14336
    s_waitcnt lgkmcnt(10)
    v_mfma_f32_32x32x16_bf16 v[88:103], v[44:47], v[168:171], v[88:103]
    ds_read_b64_tr_b16 v[40:41], v22 offset:13312
    ds_read_b64_tr_b16 v[42:43], v22 offset:15360
    s_waitcnt lgkmcnt(10)
    v_mfma_f32_32x32x16_bf16 v[104:119], v[48:51], v[168:171], v[104:119]
    ds_read_b64_tr_b16 v[44:45], v23 offset:13312
    ds_read_b64_tr_b16 v[46:47], v23 offset:15360
    s_waitcnt lgkmcnt(10)
    v_mfma_f32_32x32x16_bf16 v[88:103], v[52:55], v[172:175], v[88:103]
    ds_read_b64_tr_b16 v[48:49], v22 offset:16384
    ds_read_b64_tr_b16 v[50:51], v22 offset:18432
    s_waitcnt lgkmcnt(10)
    v_mfma_f32_32x32x16_bf16 v[104:119], v[28:31], v[172:175], v[104:119]
    ds_read_b64_tr_b16 v[52:53], v23 offset:16384
    ds_read_b64_tr_b16 v[54:55], v23 offset:18432
    s_waitcnt lgkmcnt(10)
    v_mfma_f32_32x32x16_bf16 v[88:103], v[32:35], v[176:179], v[88:103]
    ds_read_b64_tr_b16 v[28:29], v22 offset:17408
    ds_read_b64_tr_b16 v[30:31], v22 offset:19456
    s_waitcnt lgkmcnt(10)
    v_mfma_f32_32x32x16_bf16 v[104:119], v[36:39], v[176:179], v[104:119]
    ds_read_b64_tr_b16 v[32:33], v23 offset:17408
    ds_read_b64_tr_b16 v[34:35], v23 offset:19456
    s_waitcnt lgkmcnt(10)
    v_mfma_f32_32x32x16_bf16 v[88:103], v[40:43], v[180:183], v[88:103]
    ds_read_b64_tr_b16 v[36:37], v22 offset:20480
    ds_read_b64_tr_b16 v[38:39], v22 offset:22528
    s_waitcnt lgkmcnt(10)
    v_mfma_f32_32x32x16_bf16 v[104:119], v[44:47], v[180:183], v[104:119]
    ds_read_b64_tr_b16 v[40:41], v23 offset:20480
    ds_read_b64_tr_b16 v[42:43], v23 offset:22528
    s_waitcnt lgkmcnt(10)
    v_mfma_f32_32x32x16_bf16 v[88:103], v[48:51], v[184:187], v[88:103]
    ds_read_b64_tr_b16 v[44:45], v22 offset:21504
    ds_read_b64_tr_b16 v[46:47], v22 offset:23552
    s_waitcnt lgkmcnt(10)
    v_mfma_f32_32x32x16_bf16 v[104:119], v[52:55], v[184:187], v[104:119]
    ds_read_b64_tr_b16 v[48:49], v23 offset:21504
    ds_read_b64_tr_b16 v[50:51], v23 offset:23552
    s_waitcnt lgkmcnt(10)
    v_mfma_f32_32x32x16_bf16 v[88:103], v[28:31], v[188:191], v[88:103]
    ds_read_b64_tr_b16 v[52:53], v22 offset:24576
    ds_read_b64_tr_b16 v[54:55], v22 offset:26624
    s_waitcnt lgkmcnt(10)
    v_mfma_f32_32x32x16_bf16 v[104:119], v[32:35], v[188:191], v[104:119]
    ds_read_b64_tr_b16 v[28:29], v23 offset:24576
    ds_read_b64_tr_b16 v[30:31], v23 offset:26624
    s_waitcnt lgkmcnt(10)
    v_mfma_f32_32x32x16_bf16 v[88:103], v[36:39], v[192:195], v[88:103]
    ds_read_b64_tr_b16 v[32:33], v22 offset:25600
    ds_read_b64_tr_b16 v[34:35], v22 offset:27648
    s_waitcnt lgkmcnt(10)
    v_mfma_f32_32x32x16_bf16 v[104:119], v[40:43], v[192:195], v[104:119]
    ds_read_b64_tr_b16 v[36:37], v23 offset:25600
    ds_read_b64_tr_b16 v[38:39], v23 offset:27648
    s_waitcnt lgkmcnt(10)
    v_mfma_f32_32x32x16_bf16 v[88:103], v[44:47], v[196:199], v[88:103]
    ds_read_b64_tr_b16 v[40:41], v22 offset:28672
    ds_read_b64_tr_b16 v[42:43], v22 offset:30720
    s_waitcnt lgkmcnt(10)
    v_mfma_f32_32x32x16_bf16 v[104:119], v[48:51], v[196:199], v[104:119]
    ds_read_b64_tr_b16 v[44:45], v23 offset:28672
    ds_read_b64_tr_b16 v[46:47], v23 offset:30720
    s_waitcnt lgkmcnt(10)
    v_mfma_f32_32x32x16_bf16 v[88:103], v[52:55], v[200:203], v[88:103]
    ds_read_b64_tr_b16 v[48:49], v22 offset:29696
    ds_read_b64_tr_b16 v[50:51], v22 offset:31744
    s_waitcnt lgkmcnt(10)
    v_mfma_f32_32x32x16_bf16 v[104:119], v[28:31], v[200:203], v[104:119]
    ds_read_b64_tr_b16 v[52:53], v23 offset:29696
    ds_read_b64_tr_b16 v[54:55], v23 offset:31744
    s_waitcnt lgkmcnt(10)
    v_mfma_f32_32x32x16_bf16 v[88:103], v[32:35], v[204:207], v[88:103]
    ds_read_b64_tr_b16 v[28:29], v24 offset:32768
    ds_read_b64_tr_b16 v[30:31], v24 offset:34816
    s_waitcnt lgkmcnt(10)
    v_mfma_f32_32x32x16_bf16 v[104:119], v[36:39], v[204:207], v[104:119]
    ds_read_b64_tr_b16 v[32:33], v25 offset:32768
    ds_read_b64_tr_b16 v[34:35], v25 offset:34816
    s_waitcnt lgkmcnt(10)
    v_mfma_f32_32x32x16_bf16 v[88:103], v[40:43], v[208:211], v[88:103]
    ds_read_b64_tr_b16 v[36:37], v24 offset:33792
L_PAD4:
    s_cbranch_execz L_RET4
    ds_read_b64_tr_b16 v[38:39], v24 offset:35840
    s_waitcnt lgkmcnt(10)
    v_mfma_f32_32x32x16_bf16 v[104:119], v[44:47], v[208:211], v[104:119]
    ds_read_b64_tr_b16 v[40:41], v25 offset:33792
    ds_read_b64_tr_b16 v[42:43], v25 offset:35840
    s_waitcnt lgkmcnt(10)
    v_mfma_f32_32x32x16_bf16 v[88:103], v[48:51], v[212:215], v[88:103]
    ds_read_b64_tr_b16 v[44:45], v24 offset:36864
    ds_read_b64_tr_b16 v[46:47], v24 offset:38912
    s_waitcnt lgkmcnt(10)
    v_mfma_f32_32x32x16_bf16 v[104:119], v[52:55], v[212:215], v[104:119]
    ds_read_b64_tr_b16 v[48:49], v25 offset:36864
    ds_read_b64_tr_b16 v[50:51], v25 offset:38912
    s_barrier
    s_waitcnt lgkmcnt(10)
    v_mfma_f32_32x32x16_bf16 v[120:135], v[28:31], v[216:219], v[120:135]
    ds_read_b64_tr_b16 v[52:53], v24 offset:37888
    ds_read_b64_tr_b16 v[54:55], v24 offset:39936
    s_waitcnt lgkmcnt(10)
    v_mfma_f32_32x32x16_bf16 v[136:151], v[32:35], v[216:219], v[136:151]
    ds_read_b64_tr_b16 v[28:29], v25 offset:37888
    ds_read_b64_tr_b16 v[30:31], v25 offset:39936
    s_waitcnt lgkmcnt(10)
    v_mfma_f32_32x32x16_bf16 v[120:135], v[36:39], v[220:223], v[120:135]
    v_cvt_pk_bf16_f32 v88, v88, v89
    ds_read_b64_tr_b16 v[32:33], v24 offset:40960
    ds_read_b64_tr_b16 v[34:35], v24 offset:43008
    s_waitcnt lgkmcnt(10)
    v_mfma_f32_32x32x16_bf16 v[136:151], v[40:43], v[220:223], v[136:151]
    v_cvt_pk_bf16_f32 v89, v90, v91
    ds_read_b64_tr_b16 v[36:37], v25 offset:40960
    ds_read_b64_tr_b16 v[38:39], v25 offset:43008
    s_waitcnt lgkmcnt(10)
    v_mfma_f32_32x32x16_bf16 v[120:135], v[44:47], v[224:227], v[120:135]
    v_cvt_pk_bf16_f32 v90, v92, v93
    ds_read_b64_tr_b16 v[40:41], v24 offset:41984
    ds_read_b64_tr_b16 v[42:43], v24 offset:44032
    s_waitcnt lgkmcnt(10)
    v_mfma_f32_32x32x16_bf16 v[136:151], v[48:51], v[224:227], v[136:151]
    v_cvt_pk_bf16_f32 v91, v94, v95
    ds_read_b64_tr_b16 v[44:45], v25 offset:41984
    ds_read_b64_tr_b16 v[46:47], v25 offset:44032
    s_waitcnt lgkmcnt(10)
    v_mfma_f32_32x32x16_bf16 v[120:135], v[52:55], v[228:231], v[120:135]
    ds_write_b128 v0, v[88:91]
    ds_read_b64_tr_b16 v[48:49], v24 offset:45056
    ds_read_b64_tr_b16 v[50:51], v24 offset:47104
    s_waitcnt lgkmcnt(11)
    v_mfma_f32_32x32x16_bf16 v[136:151], v[28:31], v[228:231], v[136:151]
    v_cvt_pk_bf16_f32 v92, v96, v97
    ds_read_b64_tr_b16 v[52:53], v25 offset:45056
    ds_read_b64_tr_b16 v[54:55], v25 offset:47104
    s_waitcnt lgkmcnt(11)
    v_mfma_f32_32x32x16_bf16 v[120:135], v[32:35], v[232:235], v[120:135]
    v_cvt_pk_bf16_f32 v93, v98, v99
    ds_read_b64_tr_b16 v[28:29], v24 offset:46080
    ds_read_b64_tr_b16 v[30:31], v24 offset:48128
    s_waitcnt lgkmcnt(11)
    v_mfma_f32_32x32x16_bf16 v[136:151], v[36:39], v[232:235], v[136:151]
    v_cvt_pk_bf16_f32 v94, v100, v101
    ds_read_b64_tr_b16 v[32:33], v25 offset:46080
    ds_read_b64_tr_b16 v[34:35], v25 offset:48128
    s_waitcnt lgkmcnt(11)
    v_mfma_f32_32x32x16_bf16 v[120:135], v[40:43], v[236:239], v[120:135]
    v_cvt_pk_bf16_f32 v95, v102, v103
    ds_read_b64_tr_b16 v[36:37], v24
    ds_read_b64_tr_b16 v[38:39], v24 offset:2048
    s_waitcnt lgkmcnt(11)
    v_mfma_f32_32x32x16_bf16 v[136:151], v[44:47], v[236:239], v[136:151]
    ds_write_b128 v0, v[92:95] offset:1024
    ds_read_b64_tr_b16 v[40:41], v25
    ds_read_b64_tr_b16 v[42:43], v25 offset:2048
    s_waitcnt lgkmcnt(11)
    v_mfma_f32_32x32x16_bf16 v[120:135], v[48:51], v[240:243], v[120:135]
    v_cvt_pk_bf16_f32 v104, v104, v105
    ds_read_b64_tr_b16 v[44:45], v24 offset:1024
    ds_read_b64_tr_b16 v[46:47], v24 offset:3072
    s_waitcnt lgkmcnt(11)
    v_mfma_f32_32x32x16_bf16 v[136:151], v[52:55], v[240:243], v[136:151]
    v_cvt_pk_bf16_f32 v105, v106, v107
    ds_read_b64_tr_b16 v[48:49], v25 offset:1024
    ds_read_b64_tr_b16 v[50:51], v25 offset:3072
    s_waitcnt lgkmcnt(11)
    v_mfma_f32_32x32x16_bf16 v[120:135], v[28:31], v[244:247], v[120:135]
    v_cvt_pk_bf16_f32 v106, v108, v109
    ds_read_b64_tr_b16 v[52:53], v24 offset:4096
    ds_read_b64_tr_b16 v[54:55], v24 offset:6144
    s_waitcnt lgkmcnt(11)
    v_mfma_f32_32x32x16_bf16 v[136:151], v[32:35], v[244:247], v[136:151]
    v_cvt_pk_bf16_f32 v107, v110, v111
    ds_read_b64_tr_b16 v[28:29], v25 offset:4096
    ds_read_b64_tr_b16 v[30:31], v25 offset:6144
    s_waitcnt lgkmcnt(11)
    v_mfma_f32_32x32x16_bf16 v[120:135], v[36:39], v[152:155], v[120:135]
    ds_write_b128 v0, v[104:107] offset:8192
    ds_read_b64_tr_b16 v[32:33], v24 offset:5120
    ds_read_b64_tr_b16 v[34:35], v24 offset:7168
    s_waitcnt lgkmcnt(11)
    v_mfma_f32_32x32x16_bf16 v[136:151], v[40:43], v[152:155], v[136:151]
    v_cvt_pk_bf16_f32 v108, v112, v113
    ds_read_b64_tr_b16 v[36:37], v25 offset:5120
    ds_read_b64_tr_b16 v[38:39], v25 offset:7168
    s_waitcnt lgkmcnt(11)
    v_mfma_f32_32x32x16_bf16 v[120:135], v[44:47], v[156:159], v[120:135]
    v_cvt_pk_bf16_f32 v109, v114, v115
    ds_read_b64_tr_b16 v[40:41], v24 offset:8192
    ds_read_b64_tr_b16 v[42:43], v24 offset:10240
    s_waitcnt lgkmcnt(11)
    v_mfma_f32_32x32x16_bf16 v[136:151], v[48:51], v[156:159], v[136:151]
    v_cvt_pk_bf16_f32 v110, v116, v117
    ds_read_b64_tr_b16 v[44:45], v25 offset:8192
    ds_read_b64_tr_b16 v[46:47], v25 offset:10240
    s_waitcnt lgkmcnt(11)
    v_mfma_f32_32x32x16_bf16 v[120:135], v[52:55], v[160:163], v[120:135]
    v_cvt_pk_bf16_f32 v111, v118, v119
    ds_read_b64_tr_b16 v[48:49], v24 offset:9216
    ds_read_b64_tr_b16 v[50:51], v24 offset:11264
    s_waitcnt lgkmcnt(11)
    v_mfma_f32_32x32x16_bf16 v[136:151], v[28:31], v[160:163], v[136:151]
    ds_write_b128 v0, v[108:111] offset:9216
    ds_read_b64_tr_b16 v[52:53], v25 offset:9216
    ds_read_b64_tr_b16 v[54:55], v25 offset:11264
    s_waitcnt lgkmcnt(11)
    v_mfma_f32_32x32x16_bf16 v[120:135], v[32:35], v[164:167], v[120:135]
    v_and_b32 v85, 1, v1
    ds_read_b64_tr_b16 v[28:29], v24 offset:12288
    ds_read_b64_tr_b16 v[30:31], v24 offset:14336
    s_waitcnt lgkmcnt(11)
    v_mfma_f32_32x32x16_bf16 v[136:151], v[36:39], v[164:167], v[136:151]
    v_lshlrev_b32 v85, 3, v85
    ds_read_b64_tr_b16 v[32:33], v25 offset:12288
    ds_read_b64_tr_b16 v[34:35], v25 offset:14336
    s_waitcnt lgkmcnt(11)
    v_mfma_f32_32x32x16_bf16 v[120:135], v[40:43], v[168:171], v[120:135]
    v_bfe_u32 v84, v1, 2, 2
    ds_read_b64_tr_b16 v[36:37], v24 offset:13312
    ds_read_b64_tr_b16 v[38:39], v24 offset:15360
    s_waitcnt lgkmcnt(11)
    v_mfma_f32_32x32x16_bf16 v[136:151], v[44:47], v[168:171], v[136:151]
    v_lshl_add_u32 v85, v84, 4, v85
    ds_read_b64_tr_b16 v[40:41], v25 offset:13312
    ds_read_b64_tr_b16 v[42:43], v25 offset:15360
    s_waitcnt lgkmcnt(11)
    v_mfma_f32_32x32x16_bf16 v[120:135], v[48:51], v[172:175], v[120:135]
    v_bfe_u32 v84, v1, 4, 1
    ds_read_b64_tr_b16 v[44:45], v24 offset:16384
    ds_read_b64_tr_b16 v[46:47], v24 offset:18432
    s_waitcnt lgkmcnt(10)
    v_mfma_f32_32x32x16_bf16 v[136:151], v[52:55], v[172:175], v[136:151]
    v_lshl_add_u32 v85, v84, 6, v85
    ds_read_b64_tr_b16 v[48:49], v25 offset:16384
    ds_read_b64_tr_b16 v[50:51], v25 offset:18432
    s_waitcnt lgkmcnt(10)
    v_mfma_f32_32x32x16_bf16 v[120:135], v[28:31], v[176:179], v[120:135]
    v_bfe_u32 v84, v1, 1, 1
    ds_read_b64_tr_b16 v[52:53], v24 offset:17408
    ds_read_b64_tr_b16 v[54:55], v24 offset:19456
    s_waitcnt lgkmcnt(10)
    v_mfma_f32_32x32x16_bf16 v[136:151], v[32:35], v[176:179], v[136:151]
    v_lshl_add_u32 v85, v84, 7, v85
    ds_read_b64_tr_b16 v[28:29], v25 offset:17408
    ds_read_b64_tr_b16 v[30:31], v25 offset:19456
    s_waitcnt lgkmcnt(10)
    v_mfma_f32_32x32x16_bf16 v[120:135], v[36:39], v[180:183], v[120:135]
    v_lshrrev_b32 v84, 5, v1
    ds_read_b64_tr_b16 v[32:33], v24 offset:20480
    ds_read_b64_tr_b16 v[34:35], v24 offset:22528
    s_waitcnt lgkmcnt(10)
    v_mfma_f32_32x32x16_bf16 v[136:151], v[40:43], v[180:183], v[136:151]
    v_lshl_add_u32 v85, v84, 8, v85
    ds_read_b64_tr_b16 v[36:37], v25 offset:20480
    ds_read_b64_tr_b16 v[38:39], v25 offset:22528
    s_waitcnt lgkmcnt(10)
    v_mfma_f32_32x32x16_bf16 v[120:135], v[44:47], v[184:187], v[120:135]
    s_lshl_b32 s13, s3, 12
    v_add_u32 v84, s13, v85
    ds_read_b64_tr_b16 v[40:41], v24 offset:21504
    ds_read_b64_tr_b16 v[42:43], v24 offset:23552
    s_waitcnt lgkmcnt(10)
    v_mfma_f32_32x32x16_bf16 v[136:151], v[48:51], v[184:187], v[136:151]
    s_lshl_b32 s96, s76, 13
    s_add_u32 s13, s96, 32768
    v_add_u32 v85, s13, v85
    ds_read_b64_tr_b16 v[44:45], v25 offset:21504
    ds_read_b64_tr_b16 v[46:47], v25 offset:23552
    s_waitcnt lgkmcnt(10)
    v_mfma_f32_32x32x16_bf16 v[120:135], v[52:55], v[188:191], v[120:135]
    v_mov_b32 v80, 0x3f803f80
    ds_read_b64_tr_b16 v[48:49], v24 offset:24576
    ds_read_b64_tr_b16 v[50:51], v24 offset:26624
    s_waitcnt lgkmcnt(10)
    v_mfma_f32_32x32x16_bf16 v[136:151], v[28:31], v[188:191], v[136:151]
    v_mov_b32 v81, 0x3f803f80
    ds_read_b64_tr_b16 v[52:53], v25 offset:24576
    ds_read_b64_tr_b16 v[54:55], v25 offset:26624
    s_waitcnt lgkmcnt(10)
    v_mfma_f32_32x32x16_bf16 v[120:135], v[32:35], v[192:195], v[120:135]
    v_mov_b32 v82, 0x3f803f80
    ds_read_b64_tr_b16 v[28:29], v24 offset:25600
    ds_read_b64_tr_b16 v[30:31], v24 offset:27648
    s_waitcnt lgkmcnt(10)
    v_mfma_f32_32x32x16_bf16 v[136:151], v[36:39], v[192:195], v[136:151]
    v_mov_b32 v83, 0x3f803f80
    ds_read_b64_tr_b16 v[32:33], v25 offset:25600
    ds_read_b64_tr_b16 v[34:35], v25 offset:27648
    s_waitcnt lgkmcnt(10)
    v_mfma_f32_32x32x16_bf16 v[120:135], v[40:43], v[196:199], v[120:135]
    s_lshl3_add_u32 s96, s11, s3
    s_lshl_b32 s97, s96, 5
    s_add_u32 s98, s97, s10
    s_lshl_b32 s99, s98, 10
    s_add_u32 s13, s99, 25165824
    s_add_u32 s15, s13, 16384
    s_lshl3_add_u32 s96, s11, s3
    s_lshl_b32 s97, s96, 10
    s_add_u32 s16, s97, 21495808
    s_lshl_b32 s96, s10, 6
    s_add_u32 s14, s96, s16
    ds_read_b64_tr_b16 v[36:37], v24 offset:28672
    ds_read_b64_tr_b16 v[38:39], v24 offset:30720
    s_waitcnt lgkmcnt(10)
    v_mfma_f32_32x32x16_bf16 v[136:151], v[44:47], v[196:199], v[136:151]
    ds_read_b64_tr_b16 v[40:41], v25 offset:28672
    ds_read_b64_tr_b16 v[42:43], v25 offset:30720
    s_waitcnt lgkmcnt(10)
    v_mfma_f32_32x32x16_bf16 v[120:135], v[48:51], v[200:203], v[120:135]
    ds_read_b64_tr_b16 v[44:45], v25 offset:29696
    ds_read_b64_tr_b16 v[46:47], v25 offset:31744
    s_waitcnt lgkmcnt(10)
    v_mfma_f32_32x32x16_bf16 v[136:151], v[52:55], v[200:203], v[136:151]
    ds_read_b64_tr_b16 v[48:49], v24 offset:29696
    ds_read_b64_tr_b16 v[50:51], v24 offset:31744
    s_waitcnt lgkmcnt(10)
    v_mfma_f32_32x32x16_bf16 v[120:135], v[28:31], v[204:207], v[120:135]
    s_waitcnt lgkmcnt(8)
    v_mfma_f32_32x32x16_bf16 v[136:151], v[32:35], v[204:207], v[136:151]
    s_waitcnt lgkmcnt(6)
    v_mfma_f32_32x32x16_bf16 v[120:135], v[36:39], v[208:211], v[120:135]
    s_waitcnt lgkmcnt(4)
    v_mfma_f32_32x32x16_bf16 v[136:151], v[40:43], v[208:211], v[136:151]
    s_waitcnt lgkmcnt(2)
    v_mfma_f32_32x32x16_bf16 v[136:151], v[44:47], v[212:215], v[136:151]
    s_waitcnt lgkmcnt(0)
    v_mfma_f32_32x32x16_bf16 v[120:135], v[48:51], v[212:215], v[120:135]
    s_lshl_b32 s96, s77, 11
    s_add_u32 s17, s96, 151552
    v_add_u32 v0, s17, v2
    v_bfe_u32 v4, v1, 2, 2
    v_lshlrev_b32 v4, 6, v4
    v_bfe_u32 v9, v1, 4, 1
    v_lshl_add_u32 v4, v9, 5, v4
    v_and_b32 v9, 3, v1
    v_lshl_add_u32 v4, v9, 3, v4
    v_lshrrev_b32 v9, 5, v1
    v_lshl_add_u32 v4, v9, 8, v4
    v_add_u32 v4, 159744, v4
    ds_read_b64_tr_b16 v[176:177], v4
    ds_read_b64_tr_b16 v[178:179], v4 offset:512
    ds_read_b64_tr_b16 v[180:181], v4 offset:1024
    ds_read_b64_tr_b16 v[182:183], v4 offset:1536
    v_cvt_pk_bf16_f32 v152, v136, v137
    v_cvt_pk_bf16_f32 v153, v138, v139
    v_cvt_pk_bf16_f32 v154, v140, v141
    v_cvt_pk_bf16_f32 v155, v142, v143
    v_cvt_pk_bf16_f32 v156, v144, v145
    v_cvt_pk_bf16_f32 v157, v146, v147
    v_cvt_pk_bf16_f32 v158, v148, v149
    v_cvt_pk_bf16_f32 v159, v150, v151
    ds_write_b128 v0, v[152:155]
    ds_write_b128 v0, v[156:159] offset:1024
    v_cvt_pk_bf16_f32 v168, v120, v121
    v_cvt_pk_bf16_f32 v169, v122, v123
    v_cvt_pk_bf16_f32 v170, v124, v125
    v_cvt_pk_bf16_f32 v171, v126, v127
    v_cvt_pk_bf16_f32 v172, v128, v129
    v_cvt_pk_bf16_f32 v173, v130, v131
    v_cvt_pk_bf16_f32 v174, v132, v133
    v_cvt_pk_bf16_f32 v175, v134, v135
    s_setprio 0
    s_branch L_JOIN
L_HELP:
    s_waitcnt vmcnt(0)
    s_barrier
    s_add_u32 s96, s84, 4
    s_and_b32 s97, s96, 15
    s_mul_i32 s98, s97, 393216
    s_add_u32 s99, s98, s85
    s_add_u32 s82, s99, 4294772736
    s_add_u32 m0, s83, 28672
    s_nop 0
    buffer_load_dwordx4 v3, s[40:43], s82 offen lds
    s_add_u32 s96, s84, 4
    s_and_b32 s97, s96, 15
    s_mul_i32 s98, s97, 393216
    s_add_u32 s99, s98, s85
    s_add_u32 s82, s99, 2048
    s_add_u32 m0, s83, 32768
    s_nop 0
    buffer_load_dwordx4 v3, s[40:43], s82 offen lds
    s_add_u32 s96, s84, 4
    s_and_b32 s97, s96, 15
    s_mul_i32 s98, s97, 393216
    s_add_u32 s99, s98, s85
    s_add_u32 s82, s99, 4294774784
    s_add_u32 m0, s83, 77824
    s_nop 0
    buffer_load_dwordx4 v3, s[40:43], s82 offen lds
    s_add_u32 s96, s84, 4
    s_and_b32 s97, s96, 15
    s_mul_i32 s98, s97, 393216
    s_add_u32 s99, s98, s85
    s_add_u32 s82, s99, 4096
    s_add_u32 m0, s83, 81920
    s_nop 0
    buffer_load_dwordx4 v3, s[40:43], s82 offen lds
    s_add_u32 s96, s84, 4
    s_and_b32 s97, s96, 15
    s_mul_i32 s98, s97, 393216
    s_add_u32 s99, s98, s85
    s_add_u32 s82, s99, 4294770688
    s_add_u32 m0, s83, 126976
    s_nop 0
    buffer_load_dwordx4 v3, s[40:43], s82 offen lds
    s_add_u32 s96, s84, 4
    s_and_b32 s97, s96, 15
    s_mul_i32 s98, s97, 393216
    s_add_u32 s82, s98, s85
    s_add_u32 m0, s83, 131072
    s_nop 0
    buffer_load_dwordx4 v3, s[40:43], s82 offen lds
    s_add_u32 s96, s84, 5
    s_and_b32 s97, s96, 15
    s_mul_i32 s98, s97, 393216
    s_add_u32 s99, s98, s85
    s_add_u32 s82, s99, 4294772736
    s_add_u32 m0, s83, 36864
    s_nop 0
    buffer_load_dwordx4 v3, s[40:43], s82 offen lds
    s_add_u32 s96, s84, 5
    s_and_b32 s97, s96, 15
    s_mul_i32 s98, s97, 393216
    s_add_u32 s99, s98, s85
    s_add_u32 s82, s99, 2048
    s_add_u32 m0, s83, 40960
    s_nop 0
    buffer_load_dwordx4 v3, s[40:43], s82 offen lds
    s_add_u32 s96, s84, 5
    s_and_b32 s97, s96, 15
    s_mul_i32 s98, s97, 393216
    s_add_u32 s99, s98, s85
    s_add_u32 s82, s99, 4294774784
    s_add_u32 m0, s83, 86016
    s_nop 0
    buffer_load_dwordx4 v3, s[40:43], s82 offen lds
    s_add_u32 s96, s84, 5
    s_and_b32 s97, s96, 15
    s_mul_i32 s98, s97, 393216
    s_add_u32 s99, s98, s85
    s_add_u32 s82, s99, 4096
    s_add_u32 m0, s83, 90112
    s_nop 0
    buffer_load_dwordx4 v3, s[40:43], s82 offen lds
    s_add_u32 s96, s84, 5
    s_and_b32 s97, s96, 15
    s_mul_i32 s98, s97, 393216
    s_add_u32 s99, s98, s85
    s_add_u32 s82, s99, 4294770688
    s_add_u32 m0, s83, 135168
    s_nop 0
    buffer_load_dwordx4 v3, s[40:43], s82 offen lds
    s_add_u32 s96, s84, 5
    s_and_b32 s97, s96, 15
    s_mul_i32 s98, s97, 393216
    s_add_u32 s82, s98, s85
    s_add_u32 m0, s83, 139264
    s_nop 0
    buffer_load_dwordx4 v3, s[40:43], s82 offen lds
    s_waitcnt lgkmcnt(0)
SPOLL_16:
    s_load_dwordx2 s[24:25], s[32:33], s19 offset:0 glc
    s_load_dwordx2 s[26:27], s[32:33], s19 offset:64 glc
SCHK_17:
    s_add_u32 s5, s5, 1
    s_cmp_ge_u32 s5, 200000
    s_waitcnt lgkmcnt(0)
    s_cbranch_scc1 SDONE_18
    s_cmp_lg_u32 s24, s4
    s_cbranch_scc1 SPOLL_16
    s_cmp_lg_u32 s25, s4
    s_cbranch_scc1 SPOLL_16
    s_cmp_lg_u32 s26, s4
    s_cbranch_scc1 SPOLL_16
    s_cmp_lg_u32 s27, s4
    s_cbranch_scc1 SPOLL_16
SDONE_18:
    v_bfe_u32 v4, v1, 2, 2
    v_lshlrev_b32 v4, 6, v4
    v_bfe_u32 v9, v1, 4, 1
    v_lshl_add_u32 v4, v9, 5, v4
    v_and_b32 v9, 3, v1
    v_lshl_add_u32 v4, v9, 3, v4
    v_lshrrev_b32 v9, 5, v1
    v_lshl_add_u32 v4, v9, 8, v4
    v_add_u32 v4, 159744, v4
    ds_read_b64_tr_b16 v[168:169], v4
    ds_read_b64_tr_b16 v[170:171], v4 offset:512
    ds_read_b64_tr_b16 v[172:173], v4 offset:1024
    ds_read_b64_tr_b16 v[174:175], v4 offset:1536
    ds_read_b64_tr_b16 v[176:177], v4 offset:2048
    ds_read_b64_tr_b16 v[178:179], v4 offset:2560
    ds_read_b64_tr_b16 v[180:181], v4 offset:3072
    ds_read_b64_tr_b16 v[182:183], v4 offset:3584
    s_lshl_b32 s14, s77, 10
    v_and_b32 v232, 7, v1
    v_lshl_add_u32 v232, v232, 4, s14
    v_bfe_u32 v9, v1, 3, 2
    v_lshl_add_u32 v232, v9, 8, v232
    v_lshrrev_b32 v9, 5, v1
    v_lshl_add_u32 v232, v9, 7, v232
    s_and_b32 s96, s9, 1
    s_lshl1_add_u32 s18, s96, 1
    s_and_b32 s96, s8, 3
    s_lshl2_add_u32 s97, s96, s3
    s_sub_u32 s98, s97, 4
    s_lshl_b32 s82, s98, 7
    v_lshrrev_b32 v8, 3, v1
    v_lshl_add_u32 v8, v8, 4, s82
    global_load_dwordx4 v[40:43], v8, s[86:87]
    v_lshrrev_b32 v248, 3, v1
    v_mul_u32_u24 v248, 98304, v248
    v_and_b32 v9, 7, v1
    v_lshl_add_u32 v248, v9, 4, v248
    s_and_b32 s96, s8, 3
    s_lshl2_add_u32 s97, s96, s3
    s_sub_u32 s98, s97, 4
    s_mul_i32 s99, s98, 786432
    s_lshr_b32 s96, s8, 2
    s_lshl1_add_u32 s97, s9, s96
    s_lshl_b32 s98, s97, 7
    s_add_u32 s96, s99, s98
    s_add_u32 s19, s96, 4096
    s_barrier
    s_add_u32 s96, s84, 6
    s_and_b32 s97, s96, 15
    s_mul_i32 s98, s97, 393216
    s_add_u32 s99, s98, s85
    s_add_u32 s82, s99, 4294772736
    s_add_u32 m0, s83, 4294963200
    s_nop 0
    buffer_load_dwordx4 v3, s[40:43], s82 offen lds
    s_add_u32 s96, s84, 6
    s_and_b32 s97, s96, 15
    s_mul_i32 s98, s97, 393216
    s_add_u32 s99, s98, s85
    s_add_u32 s82, s99, 2048
    s_mov_b32 m0, s83
    s_nop 0
    buffer_load_dwordx4 v3, s[40:43], s82 offen lds
    s_add_u32 s96, s84, 6
    s_and_b32 s97, s96, 15
    s_mul_i32 s98, s97, 393216
    s_add_u32 s99, s98, s85
    s_add_u32 s82, s99, 4294770688
    s_add_u32 m0, s83, 94208
    s_nop 0
    buffer_load_dwordx4 v3, s[40:43], s82 offen lds
    s_add_u32 s96, s84, 6
    s_and_b32 s97, s96, 15
    s_mul_i32 s98, s97, 393216
    s_add_u32 s82, s98, s85
    s_add_u32 m0, s83, 98304
    s_nop 0
    buffer_load_dwordx4 v3, s[40:43], s82 offen lds
    s_add_u32 s96, s84, 6
    s_and_b32 s97, s96, 15
    s_mul_i32 s98, s97, 393216
    s_add_u32 s99, s98, s85
    s_add_u32 s82, s99, 4294774784
    s_add_u32 m0, s83, 45056
    s_nop 0
    buffer_load_dwordx4 v3, s[40:43], s82 offen lds
    s_add_u32 s96, s84, 6
    s_and_b32 s97, s96, 15
    s_mul_i32 s98, s97, 393216
    s_add_u32 s99, s98, s85
    s_add_u32 s82, s99, 4096
    s_add_u32 m0, s83, 49152
    s_nop 0
    buffer_load_dwordx4 v3, s[40:43], s82 offen lds
    s_waitcnt lgkmcnt(0)
    s_load_dword s24, s[32:33], s92 offset:512 glc
    s_load_dword s25, s[32:33], s92 offset:256 glc
    s_load_dword s26, s[32:33], s92 offset:3584 glc
    s_load_dword s27, s[32:33], s92 offset:3328 glc
    s_barrier
    s_add_u32 s96, s84, 7
    s_and_b32 s97, s96, 15
    s_mul_i32 s98, s97, 393216
    s_add_u32 s99, s98, s85
    s_add_u32 s82, s99, 4294772736
    s_add_u32 m0, s83, 4096
    s_nop 0
    buffer_load_dwordx4 v3, s[40:43], s82 offen lds
    s_add_u32 s96, s84, 7
    s_and_b32 s97, s96, 15
    s_mul_i32 s98, s97, 393216
    s_add_u32 s99, s98, s85
    s_add_u32 s82, s99, 2048
    s_add_u32 m0, s83, 8192
    s_nop 0
    buffer_load_dwordx4 v3, s[40:43], s82 offen lds
    s_add_u32 s96, s84, 7
    s_and_b32 s97, s96, 15
    s_mul_i32 s98, s97, 393216
    s_add_u32 s99, s98, s85
    s_add_u32 s82, s99, 4294770688
    s_add_u32 m0, s83, 102400
    s_nop 0
    buffer_load_dwordx4 v3, s[40:43], s82 offen lds
    s_add_u32 s96, s84, 7
    s_and_b32 s97, s96, 15
    s_mul_i32 s98, s97, 393216
    s_add_u32 s82, s98, s85
    s_add_u32 m0, s83, 106496
    s_nop 0
    buffer_load_dwordx4 v3, s[40:43], s82 offen lds
    s_add_u32 s96, s84, 7
    s_and_b32 s97, s96, 15
    s_mul_i32 s98, s97, 393216
    s_add_u32 s99, s98, s85
    s_add_u32 s82, s99, 4294774784
    s_add_u32 m0, s83, 53248
    s_nop 0
    buffer_load_dwordx4 v3, s[40:43], s82 offen lds
    s_add_u32 s96, s84, 7
    s_and_b32 s97, s96, 15
    s_mul_i32 s98, s97, 393216
    s_add_u32 s99, s98, s85
    s_add_u32 s82, s99, 4096
    s_add_u32 m0, s83, 57344
    s_nop 0
    buffer_load_dwordx4 v3, s[40:43], s82 offen lds
    s_waitcnt vmcnt(23)
    s_waitcnt vmcnt(19)
    s_barrier
    s_add_u32 s96, s84, 8
    s_and_b32 s97, s96, 15
    s_mul_i32 s98, s97, 393216
    s_add_u32 s99, s98, s85
    s_add_u32 s82, s99, 4294772736
    s_add_u32 m0, s83, 12288
    s_nop 0
    buffer_load_dwordx4 v3, s[40:43], s82 offen lds
    s_add_u32 s96, s84, 8
    s_and_b32 s97, s96, 15
    s_mul_i32 s98, s97, 393216
    s_add_u32 s99, s98, s85
    s_add_u32 s82, s99, 2048
    s_add_u32 m0, s83, 16384
    s_nop 0
    buffer_load_dwordx4 v3, s[40:43], s82 offen lds
    s_add_u32 s96, s84, 8
    s_and_b32 s97, s96, 15
    s_mul_i32 s98, s97, 393216
    s_add_u32 s99, s98, s85
    s_add_u32 s82, s99, 4294770688
    s_add_u32 m0, s83, 110592
    s_nop 0
    buffer_load_dwordx4 v3, s[40:43], s82 offen lds
    s_add_u32 s96, s84, 8
    s_and_b32 s97, s96, 15
    s_mul_i32 s98, s97, 393216
    s_add_u32 s82, s98, s85
    s_add_u32 m0, s83, 114688
    s_nop 0
    buffer_load_dwordx4 v3, s[40:43], s82 offen lds
    s_add_u32 s96, s84, 8
    s_and_b32 s97, s96, 15
    s_mul_i32 s98, s97, 393216
    s_add_u32 s99, s98, s85
    s_add_u32 s82, s99, 4294774784
    s_add_u32 m0, s83, 61440
    s_nop 0
    buffer_load_dwordx4 v3, s[40:43], s82 offen lds
    s_add_u32 s96, s84, 8
    s_and_b32 s97, s96, 15
    s_mul_i32 s98, s97, 393216
    s_add_u32 s99, s98, s85
    s_add_u32 s82, s99, 4096
    s_add_u32 m0, s83, 65536
    s_nop 0
    buffer_load_dwordx4 v3, s[40:43], s82 offen lds
    s_waitcnt vmcnt(18)
    v_lshlrev_b32 v36, 16, v40
    v_and_b32 v37, s6, v40
    v_lshlrev_b32 v38, 16, v41
    v_and_b32 v39, s6, v41
    v_lshlrev_b32 v40, 16, v42
    v_and_b32 v41, s6, v42
    v_lshlrev_b32 v42, 16, v43
    v_and_b32 v43, s6, v43
    v_mul_f32 v8, s7, v36
    v_exp_f32 v8, -v8
    s_nop 0
    v_add_f32 v8, 1.0, v8
    v_rcp_f32 v8, v8
    s_nop 0
    v_mul_f32 v36, v36, v8
    v_cvt_pk_bf16_f32 v36, 0, v36
    v_mul_f32 v9, s7, v37
    v_exp_f32 v9, -v9
    s_nop 0
    v_add_f32 v9, 1.0, v9
    v_rcp_f32 v9, v9
    s_nop 0
    v_mul_f32 v37, v37, v9
    v_cvt_pk_bf16_f32 v37, 0, v37
    v_mul_f32 v8, s7, v38
    v_exp_f32 v8, -v8
    s_nop 0
    v_add_f32 v8, 1.0, v8
    v_rcp_f32 v8, v8
    s_nop 0
    v_mul_f32 v38, v38, v8
    v_cvt_pk_bf16_f32 v38, 0, v38
    v_mul_f32 v9, s7, v39
    v_exp_f32 v9, -v9
    s_nop 0
    v_add_f32 v9, 1.0, v9
    v_rcp_f32 v9, v9
    s_nop 0
    v_mul_f32 v39, v39, v9
    v_cvt_pk_bf16_f32 v39, 0, v39
    v_mul_f32 v8, s7, v40
    v_exp_f32 v8, -v8
    s_nop 0
    v_add_f32 v8, 1.0, v8
    v_rcp_f32 v8, v8
    s_nop 0
    v_mul_f32 v40, v40, v8
    v_cvt_pk_bf16_f32 v40, 0, v40
    v_mul_f32 v9, s7, v41
    v_exp_f32 v9, -v9
    s_nop 0
    v_add_f32 v9, 1.0, v9
    v_rcp_f32 v9, v9
    s_nop 0
    v_mul_f32 v41, v41, v9
    v_cvt_pk_bf16_f32 v41, 0, v41
    v_mul_f32 v8, s7, v42
    v_exp_f32 v8, -v8
    s_nop 0
    v_add_f32 v8, 1.0, v8
    v_rcp_f32 v8, v8
    s_nop 0
    v_mul_f32 v42, v42, v8
    v_cvt_pk_bf16_f32 v42, 0, v42
    v_mul_f32 v9, s7, v43
    v_exp_f32 v9, -v9
    s_nop 0
    v_add_f32 v9, 1.0, v9
L_PAD5:
    s_cbranch_execz L_RET5
    v_rcp_f32 v9, v9
    s_nop 0
    v_mul_f32 v43, v43, v9
    v_cvt_pk_bf16_f32 v43, 0, v43
    s_waitcnt lgkmcnt(0)
    s_load_dword s24, s[32:33], s92 offset:1024 glc
    s_load_dword s25, s[32:33], s92 offset:768 glc
    s_load_dword s26, s[32:33], s92 offset:1536 glc
    s_load_dword s27, s[32:33], s92 offset:1280 glc
    s_barrier
    s_add_u32 s96, s84, 9
    s_and_b32 s97, s96, 15
    s_mul_i32 s98, s97, 393216
    s_add_u32 s99, s98, s85
    s_add_u32 s82, s99, 4294772736
    s_add_u32 m0, s83, 20480
    s_nop 0
    buffer_load_dwordx4 v3, s[40:43], s82 offen lds
    s_add_u32 s96, s84, 9
    s_and_b32 s97, s96, 15
    s_mul_i32 s98, s97, 393216
    s_add_u32 s99, s98, s85
    s_add_u32 s82, s99, 2048
    s_add_u32 m0, s83, 24576
    s_nop 0
    buffer_load_dwordx4 v3, s[40:43], s82 offen lds
    s_add_u32 s96, s84, 9
    s_and_b32 s97, s96, 15
    s_mul_i32 s98, s97, 393216
    s_add_u32 s99, s98, s85
    s_add_u32 s82, s99, 4294770688
    s_add_u32 m0, s83, 118784
    s_nop 0
    buffer_load_dwordx4 v3, s[40:43], s82 offen lds
    s_add_u32 s96, s84, 9
    s_and_b32 s97, s96, 15
    s_mul_i32 s98, s97, 393216
    s_add_u32 s82, s98, s85
    s_add_u32 m0, s83, 122880
    s_nop 0
    buffer_load_dwordx4 v3, s[40:43], s82 offen lds
    s_add_u32 s96, s84, 9
    s_and_b32 s97, s96, 15
    s_mul_i32 s98, s97, 393216
    s_add_u32 s99, s98, s85
    s_add_u32 s82, s99, 4294774784
    s_add_u32 m0, s83, 69632
    s_nop 0
    buffer_load_dwordx4 v3, s[40:43], s82 offen lds
    s_add_u32 s96, s84, 9
    s_and_b32 s97, s96, 15
    s_mul_i32 s98, s97, 393216
    s_add_u32 s99, s98, s85
    s_add_u32 s82, s99, 4096
    s_add_u32 m0, s83, 73728
    s_nop 0
    buffer_load_dwordx4 v3, s[40:43], s82 offen lds
    s_waitcnt vmcnt(22)
    s_waitcnt vmcnt(20)
    s_waitcnt vmcnt(18)
    s_barrier
    s_add_u32 s96, s84, 10
    s_and_b32 s97, s96, 15
    s_mul_i32 s98, s97, 393216
    s_add_u32 s99, s98, s85
    s_add_u32 s82, s99, 4294772736
    s_add_u32 m0, s83, 28672
    s_nop 0
    buffer_load_dwordx4 v3, s[40:43], s82 offen lds
    s_add_u32 s96, s84, 10
    s_and_b32 s97, s96, 15
    s_mul_i32 s98, s97, 393216
    s_add_u32 s99, s98, s85
    s_add_u32 s82, s99, 2048
    s_add_u32 m0, s83, 32768
    s_nop 0
    buffer_load_dwordx4 v3, s[40:43], s82 offen lds
    s_add_u32 s96, s84, 10
    s_and_b32 s97, s96, 15
    s_mul_i32 s98, s97, 393216
    s_add_u32 s99, s98, s85
    s_add_u32 s82, s99, 4294774784
    s_add_u32 m0, s83, 77824
    s_nop 0
    buffer_load_dwordx4 v3, s[40:43], s82 offen lds
    s_add_u32 s96, s84, 10
    s_and_b32 s97, s96, 15
    s_mul_i32 s98, s97, 393216
    s_add_u32 s99, s98, s85
    s_add_u32 s82, s99, 4096
    s_add_u32 m0, s83, 81920
    s_nop 0
    buffer_load_dwordx4 v3, s[40:43], s82 offen lds
    s_waitcnt lgkmcnt(0)
    s_load_dword s24, s[32:33], s92 offset:2560 glc
    s_load_dword s25, s[32:33], s92 offset:2304 glc
    s_load_dword s26, s[32:33], s92 offset:3072 glc
    s_load_dword s27, s[32:33], s92 offset:2816 glc
    s_waitcnt vmcnt(20)
    s_waitcnt vmcnt(18)
    s_waitcnt vmcnt(16)
    s_barrier
    s_add_u32 s96, s84, 11
    s_and_b32 s97, s96, 15
    s_mul_i32 s98, s97, 393216
    s_add_u32 s99, s98, s85
    s_add_u32 s82, s99, 4294772736
    s_add_u32 m0, s83, 36864
    s_nop 0
    buffer_load_dwordx4 v3, s[40:43], s82 offen lds
    s_add_u32 s96, s84, 11
    s_and_b32 s97, s96, 15
    s_mul_i32 s98, s97, 393216
    s_add_u32 s99, s98, s85
    s_add_u32 s82, s99, 2048
    s_add_u32 m0, s83, 40960
    s_nop 0
    buffer_load_dwordx4 v3, s[40:43], s82 offen lds
    s_add_u32 s96, s84, 11
    s_and_b32 s97, s96, 15
    s_mul_i32 s98, s97, 393216
    s_add_u32 s99, s98, s85
    s_add_u32 s82, s99, 4294774784
    s_add_u32 m0, s83, 86016
    s_nop 0
    buffer_load_dwordx4 v3, s[40:43], s82 offen lds
    s_add_u32 s96, s84, 11
    s_and_b32 s97, s96, 15
    s_mul_i32 s98, s97, 393216
    s_add_u32 s99, s98, s85
    s_add_u32 s82, s99, 4096
    s_add_u32 m0, s83, 90112
    s_nop 0
    buffer_load_dwordx4 v3, s[40:43], s82 offen lds
    s_waitcnt vmcnt(18)
    s_waitcnt vmcnt(16)
    s_waitcnt vmcnt(14)
    s_barrier
    s_add_u32 s96, s84, 12
    s_and_b32 s97, s96, 15
    s_mul_i32 s98, s97, 393216
    s_add_u32 s99, s98, s85
    s_add_u32 s82, s99, 4294772736
    s_add_u32 m0, s83, 4294963200
    s_nop 0
    buffer_load_dwordx4 v3, s[40:43], s82 offen lds
    s_add_u32 s96, s84, 12
    s_and_b32 s97, s96, 15
    s_mul_i32 s98, s97, 393216
    s_add_u32 s99, s98, s85
    s_add_u32 s82, s99, 2048
    s_mov_b32 m0, s83
    s_nop 0
    buffer_load_dwordx4 v3, s[40:43], s82 offen lds
    s_add_u32 s96, s84, 12
    s_and_b32 s97, s96, 15
    s_mul_i32 s98, s97, 393216
    s_add_u32 s99, s98, s85
    s_add_u32 s82, s99, 4294774784
    s_add_u32 m0, s83, 45056
    s_nop 0
    buffer_load_dwordx4 v3, s[40:43], s82 offen lds
    s_add_u32 s96, s84, 12
    s_and_b32 s97, s96, 15
    s_mul_i32 s98, s97, 393216
    s_add_u32 s99, s98, s85
    s_add_u32 s82, s99, 4096
    s_add_u32 m0, s83, 49152
    s_nop 0
    buffer_load_dwordx4 v3, s[40:43], s82 offen lds
    s_waitcnt vmcnt(16)
    s_barrier
    s_add_u32 s96, s84, 13
    s_and_b32 s97, s96, 15
    s_mul_i32 s98, s97, 393216
    s_add_u32 s99, s98, s85
    s_add_u32 s82, s99, 4294772736
    s_add_u32 m0, s83, 4096
    s_nop 0
    buffer_load_dwordx4 v3, s[40:43], s82 offen lds
    s_add_u32 s96, s84, 13
    s_and_b32 s97, s96, 15
    s_mul_i32 s98, s97, 393216
    s_add_u32 s99, s98, s85
    s_add_u32 s82, s99, 2048
    s_add_u32 m0, s83, 8192
    s_nop 0
    buffer_load_dwordx4 v3, s[40:43], s82 offen lds
    s_add_u32 s96, s84, 13
    s_and_b32 s97, s96, 15
    s_mul_i32 s98, s97, 393216
    s_add_u32 s99, s98, s85
    s_add_u32 s82, s99, 4294774784
    s_add_u32 m0, s83, 53248
    s_nop 0
    buffer_load_dwordx4 v3, s[40:43], s82 offen lds
    s_add_u32 s96, s84, 13
    s_and_b32 s97, s96, 15
    s_mul_i32 s98, s97, 393216
    s_add_u32 s99, s98, s85
    s_add_u32 s82, s99, 4096
    s_add_u32 m0, s83, 57344
    s_nop 0
    buffer_load_dwordx4 v3, s[40:43], s82 offen lds
    s_lshl_b32 s96, s74, 13
    s_sub_u32 s97, s3, 4
    s_lshl_b32 s98, s97, 8
    s_add_u32 s99, s96, s98
    s_add_u32 s13, s99, 20971520
    s_waitcnt lgkmcnt(0)
    s_load_dword s24, s[32:33], s13 offset:1276 glc
    s_load_dword s25, s[32:33], s13 offset:3324 glc
    s_load_dword s26, s[32:33], s13 offset:5372 glc
    s_load_dword s27, s[32:33], s13 offset:7420 glc
    s_waitcnt vmcnt(18)
    s_waitcnt vmcnt(16)
    s_barrier
    s_add_u32 s96, s84, 14
    s_and_b32 s97, s96, 15
    s_mul_i32 s98, s97, 393216
    s_add_u32 s99, s98, s85
    s_add_u32 s82, s99, 4294772736
    s_add_u32 m0, s83, 12288
    s_nop 0
    buffer_load_dwordx4 v3, s[40:43], s82 offen lds
    s_add_u32 s96, s84, 14
    s_and_b32 s97, s96, 15
    s_mul_i32 s98, s97, 393216
    s_add_u32 s99, s98, s85
    s_add_u32 s82, s99, 2048
    s_add_u32 m0, s83, 16384
    s_nop 0
    buffer_load_dwordx4 v3, s[40:43], s82 offen lds
    s_add_u32 s96, s84, 10
    s_and_b32 s97, s96, 15
    s_mul_i32 s98, s97, 393216
    s_add_u32 s99, s98, s85
    s_add_u32 s82, s99, 4294770688
    s_add_u32 m0, s83, 126976
    s_nop 0
    buffer_load_dwordx4 v3, s[40:43], s82 offen lds
    s_add_u32 s96, s84, 10
    s_and_b32 s97, s96, 15
    s_mul_i32 s98, s97, 393216
    s_add_u32 s82, s98, s85
    s_add_u32 m0, s83, 131072
    s_nop 0
    buffer_load_dwordx4 v3, s[40:43], s82 offen lds
    s_waitcnt vmcnt(18)
    s_waitcnt vmcnt(14)
    s_barrier
    s_add_u32 s96, s84, 15
    s_and_b32 s97, s96, 15
    s_mul_i32 s98, s97, 393216
    s_add_u32 s99, s98, s85
    s_add_u32 s82, s99, 4294772736
    s_add_u32 m0, s83, 20480
    s_nop 0
    buffer_load_dwordx4 v3, s[40:43], s82 offen lds
    s_add_u32 s96, s84, 15
    s_and_b32 s97, s96, 15
    s_mul_i32 s98, s97, 393216
    s_add_u32 s99, s98, s85
    s_add_u32 s82, s99, 2048
    s_add_u32 m0, s83, 24576
    s_nop 0
    buffer_load_dwordx4 v3, s[40:43], s82 offen lds
    s_add_u32 s96, s84, 11
    s_and_b32 s97, s96, 15
    s_mul_i32 s98, s97, 393216
    s_add_u32 s99, s98, s85
    s_add_u32 s82, s99, 4294770688
    s_add_u32 m0, s83, 135168
    s_nop 0
    buffer_load_dwordx4 v3, s[40:43], s82 offen lds
    s_add_u32 s96, s84, 11
    s_and_b32 s97, s96, 15
    s_mul_i32 s98, s97, 393216
    s_add_u32 s82, s98, s85
    s_add_u32 m0, s83, 139264
    s_nop 0
    buffer_load_dwordx4 v3, s[40:43], s82 offen lds
    s_waitcnt vmcnt(14)
    s_waitcnt vmcnt(10)
    s_waitcnt vmcnt(6)
    s_barrier
    s_add_u32 s96, s84, 14
    s_and_b32 s97, s96, 15
    s_mul_i32 s98, s97, 393216
    s_add_u32 s99, s98, s85
    s_add_u32 s82, s99, 4294774784
    s_add_u32 m0, s83, 61440
    s_nop 0
    buffer_load_dwordx4 v3, s[40:43], s82 offen lds
    s_add_u32 s96, s84, 14
    s_and_b32 s97, s96, 15
    s_mul_i32 s98, s97, 393216
    s_add_u32 s99, s98, s85
    s_add_u32 s82, s99, 4096
    s_add_u32 m0, s83, 65536
    s_nop 0
    buffer_load_dwordx4 v3, s[40:43], s82 offen lds
    s_add_u32 s96, s84, 15
    s_and_b32 s97, s96, 15
    s_mul_i32 s98, s97, 393216
    s_add_u32 s99, s98, s85
    s_add_u32 s82, s99, 4294774784
    s_add_u32 m0, s83, 69632
    s_nop 0
    buffer_load_dwordx4 v3, s[40:43], s82 offen lds
    s_add_u32 s96, s84, 15
    s_and_b32 s97, s96, 15
    s_mul_i32 s98, s97, 393216
    s_add_u32 s99, s98, s85
    s_add_u32 s82, s99, 4096
    s_add_u32 m0, s83, 73728
    s_nop 0
    buffer_load_dwordx4 v3, s[40:43], s82 offen lds
    s_add_u32 s96, s84, 12
    s_and_b32 s97, s96, 15
    s_mul_i32 s98, s97, 393216
    s_add_u32 s99, s98, s85
    s_add_u32 s82, s99, 4294770688
    s_add_u32 m0, s83, 94208
    s_nop 0
    buffer_load_dwordx4 v3, s[40:43], s82 offen lds
    s_add_u32 s96, s84, 12
    s_and_b32 s97, s96, 15
    s_mul_i32 s98, s97, 393216
    s_add_u32 s82, s98, s85
    s_add_u32 m0, s83, 98304
    s_nop 0
    buffer_load_dwordx4 v3, s[40:43], s82 offen lds
    s_mov_b32 s82, s19
    buffer_load_dwordx4 v[88:91], v248, s[48:51], s82 offen nt
    s_add_u32 s82, s19, 12288
    buffer_load_dwordx4 v[92:95], v248, s[48:51], s82 offen nt
    s_add_u32 s82, s19, 24576
    buffer_load_dwordx4 v[96:99], v248, s[48:51], s82 offen nt
    s_add_u32 s82, s19, 36864
    buffer_load_dwordx4 v[100:103], v248, s[48:51], s82 offen nt
    s_waitcnt vmcnt(12)
    s_barrier
    s_add_u32 s96, s84, 13
    s_and_b32 s97, s96, 15
    s_mul_i32 s98, s97, 393216
    s_add_u32 s99, s98, s85
    s_add_u32 s82, s99, 4294770688
    s_add_u32 m0, s83, 102400
    s_nop 0
    buffer_load_dwordx4 v3, s[40:43], s82 offen lds
    s_add_u32 s96, s84, 13
    s_and_b32 s97, s96, 15
    s_mul_i32 s98, s97, 393216
    s_add_u32 s82, s98, s85
    s_add_u32 m0, s83, 106496
    s_nop 0
    buffer_load_dwordx4 v3, s[40:43], s82 offen lds
    s_add_u32 s96, s84, 14
    s_and_b32 s97, s96, 15
    s_mul_i32 s98, s97, 393216
    s_add_u32 s99, s98, s85
    s_add_u32 s82, s99, 4294770688
    s_add_u32 m0, s83, 110592
    s_nop 0
    buffer_load_dwordx4 v3, s[40:43], s82 offen lds
    s_add_u32 s96, s84, 14
    s_and_b32 s97, s96, 15
    s_mul_i32 s98, s97, 393216
    s_add_u32 s82, s98, s85
    s_add_u32 m0, s83, 114688
    s_nop 0
    buffer_load_dwordx4 v3, s[40:43], s82 offen lds
    s_add_u32 s96, s84, 15
    s_and_b32 s97, s96, 15
    s_mul_i32 s98, s97, 393216
    s_add_u32 s99, s98, s85
    s_add_u32 s82, s99, 4294770688
    s_add_u32 m0, s83, 118784
    s_nop 0
    buffer_load_dwordx4 v3, s[40:43], s82 offen lds
    s_add_u32 s96, s84, 15
    s_and_b32 s97, s96, 15
    s_mul_i32 s98, s97, 393216
    s_add_u32 s82, s98, s85
    s_add_u32 m0, s83, 122880
    s_nop 0
    buffer_load_dwordx4 v3, s[40:43], s82 offen lds
    v_and_b32 v85, 1, v1
    v_lshlrev_b32 v85, 3, v85
    v_bfe_u32 v84, v1, 2, 2
    v_lshl_add_u32 v85, v84, 4, v85
    v_bfe_u32 v84, v1, 4, 1
    v_lshl_add_u32 v85, v84, 6, v85
    v_bfe_u32 v84, v1, 1, 1
    v_lshl_add_u32 v85, v84, 7, v85
    v_lshrrev_b32 v84, 5, v1
    v_lshl_add_u32 v85, v84, 8, v85
    s_lshl_b32 s13, s3, 12
    v_add_u32 v84, s13, v85
    s_lshl_b32 s96, s76, 13
    s_add_u32 s13, s96, 32768
    v_add_u32 v85, s13, v85
    v_mov_b32 v80, 0x3f803f80
    v_mov_b32 v81, 0x3f803f80
    v_mov_b32 v82, 0x3f803f80
    v_mov_b32 v83, 0x3f803f80
    s_lshl3_add_u32 s96, s11, s3
    s_lshl_b32 s97, s96, 5
    s_add_u32 s98, s97, s10
    s_lshl_b32 s99, s98, 10
    s_add_u32 s13, s99, 25165824
    s_add_u32 s15, s13, 16384
    s_lshl3_add_u32 s96, s11, s3
    s_lshl_b32 s97, s96, 10
    s_add_u32 s16, s97, 21495808
    s_lshl_b32 s96, s10, 6
    s_add_u32 s14, s96, s16
    s_waitcnt lgkmcnt(0)
    s_barrier
    s_setprio 3
    ds_read_b128 v[152:155], v0
    ds_read_b128 v[156:159], v0 offset:1024
    v_subrev_u32 v0, 118784, v0
    s_waitcnt lgkmcnt(1)
    v_mfma_f32_32x32x16_bf16 v[184:199], v[168:171], v[152:155], 0
    s_waitcnt lgkmcnt(0)
    v_mfma_f32_32x32x16_bf16 v[184:199], v[172:175], v[156:159], v[184:199]
    s_setprio 0
    s_nop 10
    v_cvt_pk_bf16_f32 v184, 0, v184
    v_cvt_pk_bf16_f32 v185, 0, v185
    v_cvt_pk_bf16_f32 v186, 0, v186
    s_add_u32 s82, s19, 49152
    buffer_load_dwordx4 v[104:107], v248, s[48:51], s82 offen nt
    v_cvt_pk_bf16_f32 v187, 0, v187
    v_cvt_pk_bf16_f32 v188, 0, v188
    v_cvt_pk_bf16_f32 v189, 0, v189
    v_cvt_pk_bf16_f32 v190, 0, v190
    v_cvt_pk_bf16_f32 v191, 0, v191
    v_cvt_pk_bf16_f32 v192, 0, v192
    v_cvt_pk_bf16_f32 v193, 0, v193
    v_cvt_pk_bf16_f32 v194, 0, v194
    v_cvt_pk_bf16_f32 v195, 0, v195
    v_cvt_pk_bf16_f32 v196, 0, v196
    s_add_u32 s82, s19, 61440
    buffer_load_dwordx4 v[108:111], v248, s[48:51], s82 offen nt
    v_cvt_pk_bf16_f32 v197, 0, v197
    v_cvt_pk_bf16_f32 v198, 0, v198
    v_cvt_pk_bf16_f32 v199, 0, v199
    v_max3_f32 v4, v184, v185, v186
    v_min3_f32 v5, v184, v185, v186
    v_max3_f32 v4, v4, v187, v188
    v_min3_f32 v5, v5, v187, v188
    v_max3_f32 v4, v4, v189, v190
    v_min3_f32 v5, v5, v189, v190
    v_max3_f32 v4, v4, v191, v192
    s_add_u32 s82, s19, 73728
    buffer_load_dwordx4 v[112:115], v248, s[48:51], s82 offen nt
    v_min3_f32 v5, v5, v191, v192
    v_max3_f32 v4, v4, v193, v194
    v_min3_f32 v5, v5, v193, v194
    v_max3_f32 v4, v4, v195, v196
    v_min3_f32 v5, v5, v195, v196
    v_max3_f32 v4, v4, v197, v198
    v_min3_f32 v5, v5, v197, v198
    v_max_f32 v6, v4, v199
    v_min_f32 v7, v5, v199
    v_max_f32 v4, v4, v199
    s_add_u32 s82, s19, 86016
    buffer_load_dwordx4 v[116:119], v248, s[48:51], s82 offen nt
    v_min_f32 v5, v5, v199
    v_permlane32_swap_b32 v4, v6
    s_nop 0
    v_permlane32_swap_b32 v5, v7
    v_max_f32 v4, v4, v6
    v_min_f32 v5, v5, v7
    v_mul_f32_e64 v4, v4, s7
    v_mul_f32_e64 v5, v5, s7
    v_fma_f32 v216, v184, s7, -v4
    v_fma_f32 v217, v185, s7, -v4
    v_fma_f32 v184, -v184, s7, v5
    v_fma_f32 v185, -v185, s7, v5
    v_fma_f32 v218, v186, s7, -v4
    v_fma_f32 v219, v187, s7, -v4
    v_fma_f32 v186, -v186, s7, v5
    v_fma_f32 v187, -v187, s7, v5
    s_waitcnt vmcnt(18)
    s_waitcnt vmcnt(16)
    s_barrier
    s_setprio 3
    ds_read_b128 v[152:155], v0
    ds_read_b128 v[156:159], v0 offset:1024
    s_waitcnt lgkmcnt(1)
    v_mfma_f32_32x32x16_bf16 v[200:215], v[176:179], v[152:155], 0
    s_waitcnt lgkmcnt(0)
    v_mfma_f32_32x32x16_bf16 v[200:215], v[180:183], v[156:159], v[200:215]
    s_setprio 0
    v_fma_f32 v220, v188, s7, -v4
    v_fma_f32 v221, v189, s7, -v4
    v_fma_f32 v188, -v188, s7, v5
    v_fma_f32 v189, -v189, s7, v5
    v_fma_f32 v222, v190, s7, -v4
    s_mov_b32 s82, s80
    buffer_load_dwordx4 v[56:59], v27, s[52:55], s82 offen nt
    v_fma_f32 v223, v191, s7, -v4
    v_fma_f32 v190, -v190, s7, v5
    v_fma_f32 v191, -v191, s7, v5
    v_fma_f32 v224, v192, s7, -v4
    v_fma_f32 v225, v193, s7, -v4
    s_setprio 3
    v_fma_f32 v192, -v192, s7, v5
    v_fma_f32 v193, -v193, s7, v5
    v_fma_f32 v226, v194, s7, -v4
    v_fma_f32 v227, v195, s7, -v4
    v_fma_f32 v194, -v194, s7, v5
    v_fma_f32 v195, -v195, s7, v5
    v_fma_f32 v228, v196, s7, -v4
    v_fma_f32 v229, v197, s7, -v4
    v_fma_f32 v196, -v196, s7, v5
    v_fma_f32 v197, -v197, s7, v5
    v_fma_f32 v230, v198, s7, -v4
    v_fma_f32 v231, v199, s7, -v4
    v_fma_f32 v198, -v198, s7, v5
    v_fma_f32 v199, -v199, s7, v5
    v_exp_f32 v216, v216
    s_add_u32 s82, s80, 4294049792
    buffer_load_dwordx4 v[60:63], v27, s[52:55], s82 offen nt
    v_exp_f32 v184, v184
    v_exp_f32 v217, v217
    v_exp_f32 v185, v185
    v_exp_f32 v218, v218
    v_exp_f32 v186, v186
    v_exp_f32 v219, v219
    v_exp_f32 v187, v187
    v_exp_f32 v220, v220
    v_exp_f32 v188, v188
    v_exp_f32 v221, v221
    v_exp_f32 v189, v189
    v_exp_f32 v222, v222
    v_exp_f32 v190, v190
    v_exp_f32 v223, v223
    v_exp_f32 v191, v191
    v_exp_f32 v224, v224
    v_exp_f32 v192, v192
    v_exp_f32 v225, v225
    v_exp_f32 v193, v193
    v_exp_f32 v226, v226
    s_add_u32 s82, s80, 57344
    buffer_load_dwordx4 v[64:67], v27, s[52:55], s82 offen nt
    v_exp_f32 v194, v194
    v_exp_f32 v227, v227
    v_exp_f32 v195, v195
    v_exp_f32 v228, v228
    v_exp_f32 v196, v196
    v_exp_f32 v229, v229
    v_exp_f32 v197, v197
    v_exp_f32 v230, v230
    v_exp_f32 v198, v198
    v_exp_f32 v231, v231
    v_exp_f32 v199, v199
    v_add_f32 v8, v216, v218
    v_add_f32 v9, v217, v219
    v_add_f32 v10, v184, v186
    v_add_f32 v11, v185, v187
    v_add_f32 v8, v8, v220
    v_add_f32 v9, v9, v221
    v_add_f32 v10, v10, v188
    v_add_f32 v11, v11, v189
    v_add_f32 v8, v8, v222
    s_add_u32 s82, s80, 4294107136
    buffer_load_dwordx4 v[68:71], v27, s[52:55], s82 offen nt
    v_add_f32 v9, v9, v223
    v_add_f32 v10, v10, v190
    v_add_f32 v11, v11, v191
    v_add_f32 v8, v8, v224
    v_add_f32 v9, v9, v225
    v_add_f32 v10, v10, v192
    v_add_f32 v11, v11, v193
    v_add_f32 v8, v8, v226
    v_add_f32 v9, v9, v227
    v_add_f32 v10, v10, v194
    v_add_f32 v11, v11, v195
    v_add_f32 v8, v8, v228
    v_add_f32 v9, v9, v229
    v_add_f32 v10, v10, v196
    v_add_f32 v11, v11, v197
    v_add_f32 v8, v8, v230
    v_add_f32 v9, v9, v231
    v_add_f32 v10, v10, v198
    v_add_f32 v11, v11, v199
    v_add_f32 v6, v8, v9
    v_add_f32 v7, v10, v11
    v_add_f32 v4, v8, v9
    s_setprio 0
    v_add_f32 v5, v10, v11
    v_permlane32_swap_b32 v4, v6
    s_nop 0
    v_permlane32_swap_b32 v5, v7
    v_add_f32 v4, v4, v6
    v_add_f32 v5, v5, v7
    v_rcp_f32 v4, v4
    v_rcp_f32 v5, v5
    v_mul_f32 v216, v216, v4
    v_mul_f32 v217, v217, v4
    v_mul_f32 v184, v184, v5
    v_mul_f32 v185, v185, v5
    v_mul_f32 v218, v218, v4
    v_mul_f32 v219, v219, v4
    v_mul_f32 v186, v186, v5
    v_mul_f32 v187, v187, v5
    v_mul_f32 v220, v220, v4
    v_mul_f32 v221, v221, v4
    v_mul_f32 v188, v188, v5
    v_mul_f32 v189, v189, v5
    v_mul_f32 v222, v222, v4
    v_mul_f32 v223, v223, v4
    v_mul_f32 v190, v190, v5
    v_mul_f32 v191, v191, v5
    v_mul_f32 v224, v224, v4
    v_mul_f32 v225, v225, v4
    v_mul_f32 v192, v192, v5
    v_mul_f32 v193, v193, v5
    v_mul_f32 v226, v226, v4
    v_mul_f32 v227, v227, v4
    v_mul_f32 v194, v194, v5
    v_mul_f32 v195, v195, v5
    v_mul_f32 v228, v228, v4
    v_mul_f32 v229, v229, v4
    v_mul_f32 v196, v196, v5
    v_mul_f32 v197, v197, v5
    v_mul_f32 v230, v230, v4
    v_mul_f32 v231, v231, v4
    v_mul_f32 v198, v198, v5
    v_mul_f32 v199, v199, v5
    v_cvt_pk_bf16_f32 v216, v216, v217
    v_cvt_pk_bf16_f32 v217, v218, v219
    v_cvt_pk_bf16_f32 v218, v220, v221
    v_cvt_pk_bf16_f32 v219, v222, v223
    v_cvt_pk_bf16_f32 v220, v224, v225
    v_cvt_pk_bf16_f32 v221, v226, v227
    v_cvt_pk_bf16_f32 v222, v228, v229
    v_cvt_pk_bf16_f32 v223, v230, v231
    ds_write_b128 v232, v[216:219]
    v_cvt_pk_bf16_f32 v224, v184, v185
    v_cvt_pk_bf16_f32 v225, v186, v187
    v_cvt_pk_bf16_f32 v226, v188, v189
    v_cvt_pk_bf16_f32 v227, v190, v191
    ds_write_b128 v232, v[220:223] offset:4096
    s_waitcnt vmcnt(18)
    s_waitcnt vmcnt(12)
    s_waitcnt vmcnt(10)
    s_waitcnt vmcnt(8)
    s_barrier
    ds_write_b128 v232, v[224:227] offset:8192
    v_cvt_pk_bf16_f32 v228, v192, v193
    v_cvt_pk_bf16_f32 v229, v194, v195
    v_cvt_pk_bf16_f32 v230, v196, v197
    v_cvt_pk_bf16_f32 v231, v198, v199
    s_xor_b32 s96, s95, 786432
    s_add_u32 s97, s96, s90
    s_sub_u32 s82, s97, 65536
    s_add_u32 m0, s83, 45056
    s_nop 0
    buffer_load_dwordx4 v26, s[44:47], s82 offen lds
    ds_write_b128 v232, v[228:231] offset:12288
    v_cvt_pk_bf16_f32 v200, 0, v200
    v_cvt_pk_bf16_f32 v201, 0, v201
    v_cvt_pk_bf16_f32 v202, 0, v202
    v_cvt_pk_bf16_f32 v203, 0, v203
    v_cvt_pk_bf16_f32 v204, 0, v204
    v_cvt_pk_bf16_f32 v205, 0, v205
    v_cvt_pk_bf16_f32 v206, 0, v206
    v_cvt_pk_bf16_f32 v207, 0, v207
    v_cvt_pk_bf16_f32 v208, 0, v208
    v_cvt_pk_bf16_f32 v209, 0, v209
    v_cvt_pk_bf16_f32 v210, 0, v210
    v_cvt_pk_bf16_f32 v211, 0, v211
    s_xor_b32 s96, s95, 786432
    s_add_u32 s82, s96, s90
    s_add_u32 m0, s83, 49152
    s_nop 0
    buffer_load_dwordx4 v26, s[44:47], s82 offen lds
    v_cvt_pk_bf16_f32 v212, 0, v212
    v_cvt_pk_bf16_f32 v213, 0, v213
    v_cvt_pk_bf16_f32 v214, 0, v214
    v_cvt_pk_bf16_f32 v215, 0, v215
    v_max3_f32 v4, v200, v201, v202
    v_min3_f32 v5, v200, v201, v202
    v_max3_f32 v4, v4, v203, v204
    v_min3_f32 v5, v5, v203, v204
    v_max3_f32 v4, v4, v205, v206
L_PAD6:
    s_cbranch_execz L_RET6
    v_min3_f32 v5, v5, v205, v206
    v_max3_f32 v4, v4, v207, v208
    v_min3_f32 v5, v5, v207, v208
    v_max3_f32 v4, v4, v209, v210
    v_min3_f32 v5, v5, v209, v210
    s_xor_b32 s96, s95, 917504
    s_add_u32 s97, s96, s90
    s_sub_u32 s82, s97, 65536
    s_add_u32 m0, s83, 53248
    s_nop 0
    buffer_load_dwordx4 v26, s[44:47], s82 offen lds
    v_max3_f32 v4, v4, v211, v212
    v_min3_f32 v5, v5, v211, v212
    v_max3_f32 v4, v4, v213, v214
    v_min3_f32 v5, v5, v213, v214
    v_max_f32 v6, v4, v215
    v_min_f32 v7, v5, v215
    v_max_f32 v4, v4, v215
    s_waitcnt lgkmcnt(0)
    v_min_f32 v5, v5, v215
    v_permlane32_swap_b32 v4, v6
    s_nop 0
    v_permlane32_swap_b32 v5, v7
    v_max_f32 v4, v4, v6
    v_min_f32 v5, v5, v7
    v_mul_f32_e64 v4, v4, s7
    s_xor_b32 s96, s95, 917504
    s_add_u32 s82, s96, s90
    s_add_u32 m0, s83, 57344
    s_nop 0
    buffer_load_dwordx4 v26, s[44:47], s82 offen lds
    v_mul_f32_e64 v5, v5, s7
    v_fma_f32 v216, v200, s7, -v4
    v_fma_f32 v217, v201, s7, -v4
    v_fma_f32 v200, -v200, s7, v5
    v_fma_f32 v201, -v201, s7, v5
    v_fma_f32 v218, v202, s7, -v4
    v_fma_f32 v219, v203, s7, -v4
    v_fma_f32 v202, -v202, s7, v5
    v_fma_f32 v203, -v203, s7, v5
    v_fma_f32 v220, v204, s7, -v4
    v_fma_f32 v221, v205, s7, -v4
    v_fma_f32 v204, -v204, s7, v5
    v_fma_f32 v205, -v205, s7, v5
    v_fma_f32 v222, v206, s7, -v4
    s_xor_b32 s96, s95, 1048576
    s_add_u32 s97, s96, s90
    s_sub_u32 s82, s97, 65536
    s_add_u32 m0, s83, 61440
    s_nop 0
    buffer_load_dwordx4 v26, s[44:47], s82 offen lds
    v_fma_f32 v223, v207, s7, -v4
    v_fma_f32 v206, -v206, s7, v5
    v_fma_f32 v207, -v207, s7, v5
    v_fma_f32 v224, v208, s7, -v4
    v_fma_f32 v225, v209, s7, -v4
    v_fma_f32 v208, -v208, s7, v5
    v_fma_f32 v209, -v209, s7, v5
    v_fma_f32 v226, v210, s7, -v4
    v_fma_f32 v227, v211, s7, -v4
    v_fma_f32 v210, -v210, s7, v5
    v_fma_f32 v211, -v211, s7, v5
    v_fma_f32 v228, v212, s7, -v4
    v_fma_f32 v229, v213, s7, -v4
    v_fma_f32 v212, -v212, s7, v5
    s_xor_b32 s96, s95, 1048576
    s_add_u32 s82, s96, s90
    s_add_u32 m0, s83, 65536
    s_nop 0
    buffer_load_dwordx4 v26, s[44:47], s82 offen lds
    v_fma_f32 v213, -v213, s7, v5
    v_fma_f32 v230, v214, s7, -v4
    v_fma_f32 v231, v215, s7, -v4
    v_fma_f32 v214, -v214, s7, v5
    v_fma_f32 v215, -v215, s7, v5
    v_exp_f32 v216, v216
    v_exp_f32 v200, v200
    v_exp_f32 v217, v217
    v_exp_f32 v201, v201
    v_exp_f32 v218, v218
    v_exp_f32 v202, v202
    v_exp_f32 v219, v219
    v_exp_f32 v203, v203
    v_exp_f32 v220, v220
    s_xor_b32 s96, s95, 1179648
    s_add_u32 s97, s96, s90
    s_sub_u32 s82, s97, 65536
    s_add_u32 m0, s83, 69632
    s_nop 0
    buffer_load_dwordx4 v26, s[44:47], s82 offen lds
    v_exp_f32 v204, v204
    v_exp_f32 v221, v221
    v_exp_f32 v205, v205
    v_exp_f32 v222, v222
    v_exp_f32 v206, v206
    v_exp_f32 v223, v223
    v_exp_f32 v207, v207
    v_exp_f32 v224, v224
    v_exp_f32 v208, v208
    v_exp_f32 v225, v225
    v_exp_f32 v209, v209
    v_exp_f32 v226, v226
    v_exp_f32 v210, v210
    v_exp_f32 v227, v227
    s_xor_b32 s96, s95, 1179648
    s_add_u32 s82, s96, s90
    s_add_u32 m0, s83, 73728
    s_nop 0
    buffer_load_dwordx4 v26, s[44:47], s82 offen lds
    v_exp_f32 v211, v211
    v_exp_f32 v228, v228
    v_exp_f32 v212, v212
    v_exp_f32 v229, v229
    v_exp_f32 v213, v213
    v_exp_f32 v230, v230
    v_exp_f32 v214, v214
    v_exp_f32 v231, v231
    v_exp_f32 v215, v215
    v_add_f32 v8, v216, v218
    v_add_f32 v9, v217, v219
    v_add_f32 v10, v200, v202
    v_add_f32 v11, v201, v203
    v_add_f32 v8, v8, v220
    v_add_f32 v9, v9, v221
    v_add_f32 v10, v10, v204
    v_add_f32 v11, v11, v205
    v_add_f32 v8, v8, v222
    v_add_f32 v9, v9, v223
    v_add_f32 v10, v10, v206
    v_add_f32 v11, v11, v207
    v_add_f32 v8, v8, v224
    v_add_f32 v9, v9, v225
    v_add_f32 v10, v10, v208
    v_add_f32 v11, v11, v209
    v_add_f32 v8, v8, v226
    v_add_f32 v9, v9, v227
    v_add_f32 v10, v10, v210
    v_add_f32 v11, v11, v211
    v_add_f32 v8, v8, v228
    v_add_f32 v9, v9, v229
    v_add_f32 v10, v10, v212
    v_add_f32 v11, v11, v213
    v_add_f32 v8, v8, v230
    v_add_f32 v9, v9, v231
    v_add_f32 v10, v10, v214
    v_add_f32 v11, v11, v215
    v_add_f32 v6, v8, v9
    v_add_f32 v7, v10, v11
    v_add_f32 v4, v8, v9
    v_add_f32 v5, v10, v11
    s_nop 0
    v_permlane32_swap_b32 v4, v6
    v_permlane32_swap_b32 v5, v7
    v_add_f32 v4, v4, v6
    v_add_f32 v5, v5, v7
    v_rcp_f32 v4, v4
    v_rcp_f32 v5, v5
    v_mul_f32 v216, v216, v4
    v_mul_f32 v217, v217, v4
    v_mul_f32 v200, v200, v5
    v_mul_f32 v201, v201, v5
    v_mul_f32 v218, v218, v4
    v_mul_f32 v219, v219, v4
    v_mul_f32 v202, v202, v5
    v_mul_f32 v203, v203, v5
    v_mul_f32 v220, v220, v4
    v_mul_f32 v221, v221, v4
    v_mul_f32 v204, v204, v5
    v_mul_f32 v205, v205, v5
    v_mul_f32 v222, v222, v4
    v_mul_f32 v223, v223, v4
    v_mul_f32 v206, v206, v5
    v_mul_f32 v207, v207, v5
    v_mul_f32 v224, v224, v4
    v_mul_f32 v225, v225, v4
    v_mul_f32 v208, v208, v5
    v_mul_f32 v209, v209, v5
    v_mul_f32 v226, v226, v4
    v_mul_f32 v227, v227, v4
    v_mul_f32 v210, v210, v5
    v_mul_f32 v211, v211, v5
    v_mul_f32 v228, v228, v4
    v_mul_f32 v229, v229, v4
    v_mul_f32 v212, v212, v5
    v_mul_f32 v213, v213, v5
    v_mul_f32 v230, v230, v4
    v_mul_f32 v231, v231, v4
    v_mul_f32 v214, v214, v5
    v_mul_f32 v215, v215, v5
    v_cvt_pk_bf16_f32 v216, v216, v217
    v_cvt_pk_bf16_f32 v217, v218, v219
    v_cvt_pk_bf16_f32 v218, v220, v221
    v_cvt_pk_bf16_f32 v219, v222, v223
    v_cvt_pk_bf16_f32 v220, v224, v225
    v_cvt_pk_bf16_f32 v221, v226, v227
    v_cvt_pk_bf16_f32 v222, v228, v229
    v_cvt_pk_bf16_f32 v223, v230, v231
    ds_write_b128 v232, v[216:219] offset:16384
    v_cvt_pk_bf16_f32 v224, v200, v201
    v_cvt_pk_bf16_f32 v225, v202, v203
    v_cvt_pk_bf16_f32 v226, v204, v205
    v_cvt_pk_bf16_f32 v227, v206, v207
    ds_write_b128 v232, v[220:223] offset:20480
    ds_write_b128 v232, v[224:227] offset:24576
    v_cvt_pk_bf16_f32 v228, v208, v209
    v_cvt_pk_bf16_f32 v229, v210, v211
    v_cvt_pk_bf16_f32 v230, v212, v213
    v_cvt_pk_bf16_f32 v231, v214, v215
    ds_write_b128 v232, v[228:231] offset:28672
    s_lshl_b32 s96, s77, 11
    s_add_u32 s17, s96, 151552
    v_add_u32 v0, s17, v2
    s_setprio 0
L_JOIN:
    s_waitcnt lgkmcnt(0)
    s_barrier
    ds_read_b64_tr_b16 v[184:185], v84
    ds_read_b64_tr_b16 v[186:187], v84 offset:512
    ds_read_b64_tr_b16 v[200:201], v85
    ds_read_b64_tr_b16 v[202:203], v85 offset:512
    ds_read_b64_tr_b16 v[204:205], v85 offset:1024
    ds_read_b64_tr_b16 v[206:207], v85 offset:1536
    ds_read_b64_tr_b16 v[188:189], v84 offset:1024
    ds_read_b64_tr_b16 v[190:191], v84 offset:1536
    ds_read_b64_tr_b16 v[208:209], v85 offset:2048
    ds_read_b64_tr_b16 v[210:211], v85 offset:2560
    ds_read_b64_tr_b16 v[212:213], v85 offset:3072
    ds_read_b64_tr_b16 v[214:215], v85 offset:3584
    ds_read_b64_tr_b16 v[192:193], v84 offset:2048
    ds_read_b64_tr_b16 v[194:195], v84 offset:2560
    ds_read_b64_tr_b16 v[216:217], v85 offset:4096
    ds_read_b64_tr_b16 v[218:219], v85 offset:4608
    ds_read_b64_tr_b16 v[220:221], v85 offset:5120
    ds_read_b64_tr_b16 v[222:223], v85 offset:5632
    s_waitcnt lgkmcnt(12)
    v_mfma_f32_16x16x32_bf16 v[232:235], v[184:187], v[200:203], 0
    v_mfma_f32_16x16x32_bf16 v[236:239], v[184:187], v[204:207], 0
    v_mfma_f32_16x16x32_bf16 v[240:243], v[184:187], v[80:83], 0
    ds_read_b64_tr_b16 v[196:197], v84 offset:3072
    ds_read_b64_tr_b16 v[198:199], v84 offset:3584
    ds_read_b64_tr_b16 v[224:225], v85 offset:6144
    ds_read_b64_tr_b16 v[226:227], v85 offset:6656
    ds_read_b64_tr_b16 v[228:229], v85 offset:7168
    ds_read_b64_tr_b16 v[230:231], v85 offset:7680
    s_waitcnt lgkmcnt(12)
    v_mfma_f32_16x16x32_bf16 v[232:235], v[188:191], v[208:211], v[232:235]
    v_mfma_f32_16x16x32_bf16 v[236:239], v[188:191], v[212:215], v[236:239]
    v_mfma_f32_16x16x32_bf16 v[240:243], v[188:191], v[80:83], v[240:243]
    s_waitcnt lgkmcnt(6)
    v_mfma_f32_16x16x32_bf16 v[232:235], v[192:195], v[216:219], v[232:235]
    v_mfma_f32_16x16x32_bf16 v[236:239], v[192:195], v[220:223], v[236:239]
    v_mfma_f32_16x16x32_bf16 v[240:243], v[192:195], v[80:83], v[240:243]
    s_waitcnt lgkmcnt(0)
    v_mfma_f32_16x16x32_bf16 v[232:235], v[196:199], v[224:227], v[232:235]
    v_mfma_f32_16x16x32_bf16 v[236:239], v[196:199], v[228:231], v[236:239]
    v_mfma_f32_16x16x32_bf16 v[240:243], v[196:199], v[80:83], v[240:243]
    s_cmp_lt_u32 s3, 4
    s_cbranch_scc1 L_NOQX
    ds_read_b128 v[168:171], v0
    ds_read_b128 v[172:175], v0 offset:1024
L_NOQX:
    s_nop 3
    buffer_store_dwordx4 v[232:235], v2, s[32:35], s13 offen sc1
    buffer_store_dwordx4 v[236:239], v2, s[32:35], s15 offen sc1
    s_mov_b32 exec_lo, 0x00010001
    s_mov_b32 exec_hi, 0x00010001
    buffer_store_dwordx4 v[240:243], v1, s[32:35], s14 offen sc1
    s_mov_b64 exec, -1
    s_waitcnt lgkmcnt(0)
    v_mfma_f32_32x32x16_bf16 v[120:135], v[176:179], v[168:171], 0
    v_mfma_f32_32x32x16_bf16 v[120:135], v[180:183], v[172:175], v[120:135]
    v_and_b32 v46, 7, v1
    v_lshlrev_b32 v46, 17, v46
    v_bfe_u32 v9, v1, 3, 1
    v_lshl_add_u32 v46, v9, 14, v46
    s_and_b32 s96, s10, 1
    s_and_b32 s97, s2, 27
    s_lshl_b32 s98, s97, 12
    s_lshr_b32 s99, s10, 1
    s_lshl_b32 s97, s99, 6
    s_add_u32 s99, s98, s97
    s_lshl2_add_u32 s98, s96, s99
    s_add_u32 s97, s98, 1048576
    s_add_u32 s17, s97, 512
    v_lshrrev_b32 v47, 3, v1
    v_lshlrev_b32 v47, 10, v47
    v_and_b32 v9, 7, v1
    v_lshl_add_u32 v47, v9, 4, v47
    v_and_b32 v48, 7, v1
    v_lshlrev_b32 v48, 4, v48
    v_lshrrev_b32 v9, 5, v1
    v_lshl_add_u32 v48, v9, 3, v48
    v_cvt_pk_bf16_f32 v120, 0, v120
    v_cvt_pk_bf16_f32 v121, 0, v121
    v_cvt_pk_bf16_f32 v122, 0, v122
    v_cvt_pk_bf16_f32 v123, 0, v123
    v_cvt_pk_bf16_f32 v124, 0, v124
    v_cvt_pk_bf16_f32 v125, 0, v125
    v_cvt_pk_bf16_f32 v126, 0, v126
    v_cvt_pk_bf16_f32 v127, 0, v127
    v_cvt_pk_bf16_f32 v128, 0, v128
    v_cvt_pk_bf16_f32 v129, 0, v129
    v_cvt_pk_bf16_f32 v130, 0, v130
    v_cvt_pk_bf16_f32 v131, 0, v131
    v_cvt_pk_bf16_f32 v132, 0, v132
    v_cvt_pk_bf16_f32 v133, 0, v133
    v_cvt_pk_bf16_f32 v134, 0, v134
    v_cvt_pk_bf16_f32 v135, 0, v135
    v_max3_f32 v4, v120, v121, v122
    v_min3_f32 v5, v120, v121, v122
    v_max3_f32 v4, v4, v123, v124
    v_min3_f32 v5, v5, v123, v124
    v_max3_f32 v4, v4, v125, v126
    v_min3_f32 v5, v5, v125, v126
    v_max3_f32 v4, v4, v127, v128
    v_min3_f32 v5, v5, v127, v128
    v_max3_f32 v4, v4, v129, v130
    v_min3_f32 v5, v5, v129, v130
    v_max3_f32 v4, v4, v131, v132
    v_min3_f32 v5, v5, v131, v132
    v_max3_f32 v4, v4, v133, v134
    v_min3_f32 v5, v5, v133, v134
    v_max_f32 v6, v4, v135
    v_min_f32 v7, v5, v135
    v_max_f32 v4, v4, v135
    v_min_f32 v5, v5, v135
    s_nop 0
    v_permlane32_swap_b32 v4, v6
    v_permlane32_swap_b32 v5, v7
    v_max_f32 v4, v4, v6
    v_min_f32 v5, v5, v7
    v_pk_mul_f32 v[4:5], v[4:5], s[6:7] op_sel:[0,1]
    v_mov_b32 v6, v5
    v_pk_fma_f32 v[136:137], v[120:121], s[6:7], v[4:5] op_sel:[0,1,0] op_sel_hi:[1,1,0] neg_lo:[0,0,1] neg_hi:[0,0,1]
    v_pk_fma_f32 v[120:121], v[120:121], s[6:7], v[6:7] op_sel:[0,1,0] op_sel_hi:[1,1,0] neg_lo:[1,0,0] neg_hi:[1,0,0]
    v_pk_fma_f32 v[138:139], v[122:123], s[6:7], v[4:5] op_sel:[0,1,0] op_sel_hi:[1,1,0] neg_lo:[0,0,1] neg_hi:[0,0,1]
    v_pk_fma_f32 v[122:123], v[122:123], s[6:7], v[6:7] op_sel:[0,1,0] op_sel_hi:[1,1,0] neg_lo:[1,0,0] neg_hi:[1,0,0]
    v_pk_fma_f32 v[140:141], v[124:125], s[6:7], v[4:5] op_sel:[0,1,0] op_sel_hi:[1,1,0] neg_lo:[0,0,1] neg_hi:[0,0,1]
    v_pk_fma_f32 v[124:125], v[124:125], s[6:7], v[6:7] op_sel:[0,1,0] op_sel_hi:[1,1,0] neg_lo:[1,0,0] neg_hi:[1,0,0]
    v_pk_fma_f32 v[142:143], v[126:127], s[6:7], v[4:5] op_sel:[0,1,0] op_sel_hi:[1,1,0] neg_lo:[0,0,1] neg_hi:[0,0,1]
    v_pk_fma_f32 v[126:127], v[126:127], s[6:7], v[6:7] op_sel:[0,1,0] op_sel_hi:[1,1,0] neg_lo:[1,0,0] neg_hi:[1,0,0]
    v_pk_fma_f32 v[144:145], v[128:129], s[6:7], v[4:5] op_sel:[0,1,0] op_sel_hi:[1,1,0] neg_lo:[0,0,1] neg_hi:[0,0,1]
    v_pk_fma_f32 v[128:129], v[128:129], s[6:7], v[6:7] op_sel:[0,1,0] op_sel_hi:[1,1,0] neg_lo:[1,0,0] neg_hi:[1,0,0]
    v_pk_fma_f32 v[146:147], v[130:131], s[6:7], v[4:5] op_sel:[0,1,0] op_sel_hi:[1,1,0] neg_lo:[0,0,1] neg_hi:[0,0,1]
    v_pk_fma_f32 v[130:131], v[130:131], s[6:7], v[6:7] op_sel:[0,1,0] op_sel_hi:[1,1,0] neg_lo:[1,0,0] neg_hi:[1,0,0]
    v_pk_fma_f32 v[148:149], v[132:133], s[6:7], v[4:5] op_sel:[0,1,0] op_sel_hi:[1,1,0] neg_lo:[0,0,1] neg_hi:[0,0,1]
    v_pk_fma_f32 v[132:133], v[132:133], s[6:7], v[6:7] op_sel:[0,1,0] op_sel_hi:[1,1,0] neg_lo:[1,0,0] neg_hi:[1,0,0]
    v_pk_fma_f32 v[150:151], v[134:135], s[6:7], v[4:5] op_sel:[0,1,0] op_sel_hi:[1,1,0] neg_lo:[0,0,1] neg_hi:[0,0,1]
    v_pk_fma_f32 v[134:135], v[134:135], s[6:7], v[6:7] op_sel:[0,1,0] op_sel_hi:[1,1,0] neg_lo:[1,0,0] neg_hi:[1,0,0]
    v_exp_f32 v136, v136
    v_exp_f32 v120, v120
    v_exp_f32 v137, v137
    v_exp_f32 v121, v121
    v_exp_f32 v138, v138
    v_exp_f32 v122, v122
    v_exp_f32 v139, v139
    v_exp_f32 v123, v123
    v_exp_f32 v140, v140
    v_exp_f32 v124, v124
    v_exp_f32 v141, v141
    v_exp_f32 v125, v125
    v_exp_f32 v142, v142
    v_exp_f32 v126, v126
    v_exp_f32 v143, v143
    v_exp_f32 v127, v127
    s_waitcnt vmcnt(0)
    s_barrier
    s_cmp_lg_u32 s3, 0
    s_cbranch_scc1 L_PC
    v_mov_b32 v85, s4
    s_mov_b32 exec_hi, 0
    s_mov_b32 exec_lo, 65535
    buffer_store_dword v85, v46, s[32:35], s17 offen sc1
    s_mov_b64 exec, -1
L_PC:
    s_xor_b32 s96, s95, 1310720
    s_add_u32 s82, s96, s90
    s_add_u32 m0, s83, 81920
    s_nop 0
    buffer_load_dwordx4 v26, s[44:47], s82 offen lds
    v_exp_f32 v144, v144
    v_exp_f32 v128, v128
    v_exp_f32 v145, v145
    v_exp_f32 v129, v129
    s_xor_b32 s96, s95, 1441792
    s_add_u32 s82, s96, s90
    s_add_u32 m0, s83, 90112
    s_nop 0
    buffer_load_dwordx4 v26, s[44:47], s82 offen lds
    v_exp_f32 v146, v146
    v_exp_f32 v130, v130
    v_exp_f32 v147, v147
    v_exp_f32 v131, v131
    s_xor_b32 s96, s95, 1572864
    s_add_u32 s82, s96, s90
    s_add_u32 m0, s83, 98304
    s_nop 0
    buffer_load_dwordx4 v26, s[44:47], s82 offen lds
    v_exp_f32 v148, v148
    v_exp_f32 v132, v132
    v_exp_f32 v149, v149
    v_exp_f32 v133, v133
    s_xor_b32 s96, s95, 1703936
    s_add_u32 s82, s96, s90
    s_add_u32 m0, s83, 106496
    s_nop 0
    buffer_load_dwordx4 v26, s[44:47], s82 offen lds
    v_exp_f32 v150, v150
    v_exp_f32 v134, v134
    v_exp_f32 v151, v151
    v_exp_f32 v135, v135
    s_lshl4_add_u32 s96, s11, s10
    s_lshl_b32 s97, s96, 14
    s_lshl_b32 s98, s3, 7
    s_add_u32 s99, s97, s98
    s_add_u32 s13, s99, 25165824
    s_add_u32 s14, s13, 8192
    s_lshl4_add_u32 s96, s11, s10
    s_lshl_b32 s97, s96, 10
    s_lshl_b32 s98, s3, 7
    s_add_u32 s99, s97, s98
    s_add_u32 s15, s99, 29360128
    s_add_u32 s17, s17, 3072
    s_load_dwordx2 s[24:25], s[32:33], s92 offset:512 glc
    s_xor_b32 s96, s95, 1835008
    s_add_u32 s82, s96, s90
    s_add_u32 m0, s83, 114688
    s_nop 0
    buffer_load_dwordx4 v26, s[44:47], s82 offen lds
    v_pk_add_f32 v[8:9], v[136:137], v[138:139]
    v_pk_add_f32 v[10:11], v[120:121], v[122:123]
    v_pk_add_f32 v[8:9], v[8:9], v[140:141]
    v_pk_add_f32 v[10:11], v[10:11], v[124:125]
    v_pk_add_f32 v[8:9], v[8:9], v[142:143]
    v_pk_add_f32 v[10:11], v[10:11], v[126:127]
    v_pk_add_f32 v[8:9], v[8:9], v[144:145]
    v_pk_add_f32 v[10:11], v[10:11], v[128:129]
    v_pk_add_f32 v[8:9], v[8:9], v[146:147]
    v_pk_add_f32 v[10:11], v[10:11], v[130:131]
    v_pk_add_f32 v[8:9], v[8:9], v[148:149]
    v_pk_add_f32 v[10:11], v[10:11], v[132:133]
    v_pk_add_f32 v[8:9], v[8:9], v[150:151]
    v_pk_add_f32 v[10:11], v[10:11], v[134:135]
    s_xor_b32 s96, s95, 1966080
    s_add_u32 s82, s96, s90
    s_add_u32 m0, s83, 122880
    s_nop 0
    buffer_load_dwordx4 v26, s[44:47], s82 offen lds
    v_add_f32 v6, v8, v9
    v_add_f32 v7, v10, v11
    v_add_f32 v4, v8, v9
    v_add_f32 v5, v10, v11
    s_nop 0
    v_permlane32_swap_b32 v4, v6
    v_permlane32_swap_b32 v5, v7
    v_pk_add_f32 v[4:5], v[4:5], v[6:7]
    v_rcp_f32 v4, v4
    v_rcp_f32 v5, v5
    s_nop 0
    v_pk_mul_f32 v[136:137], v[136:137], v[4:5] op_sel_hi:[1,0]
    v_pk_mul_f32 v[120:121], v[4:5], v[120:121] op_sel:[1,0]
    v_pk_mul_f32 v[138:139], v[138:139], v[4:5] op_sel_hi:[1,0]
    v_pk_mul_f32 v[122:123], v[4:5], v[122:123] op_sel:[1,0]
    v_pk_mul_f32 v[140:141], v[140:141], v[4:5] op_sel_hi:[1,0]
    s_add_u32 s82, s95, s90
    s_mov_b32 m0, s83
    s_nop 0
    buffer_load_dwordx4 v26, s[44:47], s82 offen lds
    v_pk_mul_f32 v[124:125], v[4:5], v[124:125] op_sel:[1,0]
    v_pk_mul_f32 v[142:143], v[142:143], v[4:5] op_sel_hi:[1,0]
    v_pk_mul_f32 v[126:127], v[4:5], v[126:127] op_sel:[1,0]
    v_pk_mul_f32 v[144:145], v[144:145], v[4:5] op_sel_hi:[1,0]
    v_pk_mul_f32 v[128:129], v[4:5], v[128:129] op_sel:[1,0]
    v_pk_mul_f32 v[146:147], v[146:147], v[4:5] op_sel_hi:[1,0]
    v_pk_mul_f32 v[130:131], v[4:5], v[130:131] op_sel:[1,0]
    v_pk_mul_f32 v[148:149], v[148:149], v[4:5] op_sel_hi:[1,0]
    v_pk_mul_f32 v[132:133], v[4:5], v[132:133] op_sel:[1,0]
    v_pk_mul_f32 v[150:151], v[150:151], v[4:5] op_sel_hi:[1,0]
    v_pk_mul_f32 v[134:135], v[4:5], v[134:135] op_sel:[1,0]
    v_cvt_pk_bf16_f32 v152, v136, v137
    v_cvt_pk_bf16_f32 v153, v138, v139
    v_cvt_pk_bf16_f32 v154, v140, v141
    s_xor_b32 s96, s95, 131072
    s_add_u32 s82, s96, s90
    s_add_u32 m0, s83, 8192
    s_nop 0
    buffer_load_dwordx4 v26, s[44:47], s82 offen lds
    v_cvt_pk_bf16_f32 v155, v142, v143
    v_cvt_pk_bf16_f32 v156, v144, v145
    v_cvt_pk_bf16_f32 v157, v146, v147
    v_cvt_pk_bf16_f32 v158, v148, v149
    v_cvt_pk_bf16_f32 v159, v150, v151
    v_cvt_pk_bf16_f32 v160, v120, v121
    v_cvt_pk_bf16_f32 v161, v122, v123
    v_cvt_pk_bf16_f32 v162, v124, v125
    v_cvt_pk_bf16_f32 v163, v126, v127
    v_cvt_pk_bf16_f32 v164, v128, v129
    v_cvt_pk_bf16_f32 v165, v130, v131
    v_cvt_pk_bf16_f32 v166, v132, v133
    v_cvt_pk_bf16_f32 v167, v134, v135
    s_branch SCHK_20
SPOLL_19:
    s_load_dwordx2 s[24:25], s[32:33], s92 offset:512 glc
SCHK_20:
    s_add_u32 s5, s5, 1
    s_cmp_ge_u32 s5, 200000
    s_waitcnt lgkmcnt(0)
    s_cbranch_scc1 SDONE_21
    s_cmp_lg_u32 s24, s4
    s_cbranch_scc1 SPOLL_19
    s_cmp_lg_u32 s25, s4
    s_cbranch_scc1 SPOLL_19
SDONE_21:
    s_barrier
    buffer_load_dwordx4 v[184:187], v47, s[32:35], s13 offen sc1
    buffer_load_dwordx4 v[188:191], v47, s[32:35], s14 offen sc1
    buffer_load_dwordx4 v[192:195], v2, s[32:35], s16 offen sc1
    s_lshl_b32 s96, s3, 5
    s_add_u32 s14, s96, 155648
    v_and_b32 v6, 3, v1
    v_lshl_add_u32 v6, v6, 3, s14
    v_lshrrev_b32 v9, 5, v1
    v_lshl_add_u32 v6, v9, 2, v6
    s_lshl_b32 s96, s3, 10
    s_add_u32 s14, s96, 147456
    v_and_b32 v5, 15, v1
    v_lshl_add_u32 v5, v5, 4, s14
    v_lshrrev_b32 v9, 5, v1
    v_lshl_add_u32 v5, v9, 9, v5
    v_bfe_u32 v9, v1, 4, 1
    v_lshl_add_u32 v5, v9, 3, v5
    s_lshl_b32 s96, s76, 7
    s_add_u32 s14, s96, 155648
    v_lshrrev_b32 v7, 5, v1
    v_lshl_add_u32 v7, v7, 4, s14
    s_lshl_b32 s96, s76, 12
    s_add_u32 s14, s96, 147456
    v_add_u32 v84, s14, v2
    s_cmp_lt_u32 s3, 4
    s_cbranch_scc1 L_HG1
    v_lshlrev_b32 v8, 16, v88
    v_and_b32 v9, s6, v88
    v_pk_mul_f32 v[196:197], v[36:37], v[8:9] op_sel:[0,0] op_sel_hi:[0,1]
    v_lshlrev_b32 v10, 16, v89
    v_and_b32 v11, s6, v89
    v_pk_mul_f32 v[198:199], v[36:37], v[10:11] op_sel:[0,0] op_sel_hi:[0,1]
    v_lshlrev_b32 v8, 16, v90
    v_and_b32 v9, s6, v90
    v_pk_mul_f32 v[200:201], v[36:37], v[8:9] op_sel:[0,0] op_sel_hi:[0,1]
    v_lshlrev_b32 v10, 16, v91
    v_and_b32 v11, s6, v91
    v_pk_mul_f32 v[202:203], v[36:37], v[10:11] op_sel:[0,0] op_sel_hi:[0,1]
    v_lshlrev_b32 v8, 16, v92
    v_and_b32 v9, s6, v92
    v_pk_fma_f32 v[196:197], v[36:37], v[8:9], v[196:197] op_sel:[1,0,0] op_sel_hi:[1,1,1]
    v_lshlrev_b32 v10, 16, v93
    v_and_b32 v11, s6, v93
    v_pk_fma_f32 v[198:199], v[36:37], v[10:11], v[198:199] op_sel:[1,0,0] op_sel_hi:[1,1,1]
    v_lshlrev_b32 v8, 16, v94
    v_and_b32 v9, s6, v94
    v_pk_fma_f32 v[200:201], v[36:37], v[8:9], v[200:201] op_sel:[1,0,0] op_sel_hi:[1,1,1]
    v_lshlrev_b32 v10, 16, v95
    v_and_b32 v11, s6, v95
    v_pk_fma_f32 v[202:203], v[36:37], v[10:11], v[202:203] op_sel:[1,0,0] op_sel_hi:[1,1,1]
    v_lshlrev_b32 v8, 16, v96
    v_and_b32 v9, s6, v96
    v_pk_fma_f32 v[196:197], v[38:39], v[8:9], v[196:197] op_sel:[0,0,0] op_sel_hi:[0,1,1]
    v_lshlrev_b32 v10, 16, v97
    v_and_b32 v11, s6, v97
    v_pk_fma_f32 v[198:199], v[38:39], v[10:11], v[198:199] op_sel:[0,0,0] op_sel_hi:[0,1,1]
    v_lshlrev_b32 v8, 16, v98
    v_and_b32 v9, s6, v98
    v_pk_fma_f32 v[200:201], v[38:39], v[8:9], v[200:201] op_sel:[0,0,0] op_sel_hi:[0,1,1]
    v_lshlrev_b32 v10, 16, v99
    v_and_b32 v11, s6, v99
    v_pk_fma_f32 v[202:203], v[38:39], v[10:11], v[202:203] op_sel:[0,0,0] op_sel_hi:[0,1,1]
    v_lshlrev_b32 v8, 16, v100
    v_and_b32 v9, s6, v100
    v_pk_fma_f32 v[196:197], v[38:39], v[8:9], v[196:197] op_sel:[1,0,0] op_sel_hi:[1,1,1]
    v_lshlrev_b32 v10, 16, v101
    v_and_b32 v11, s6, v101
    v_pk_fma_f32 v[198:199], v[38:39], v[10:11], v[198:199] op_sel:[1,0,0] op_sel_hi:[1,1,1]
    v_lshlrev_b32 v8, 16, v102
    v_and_b32 v9, s6, v102
    v_pk_fma_f32 v[200:201], v[38:39], v[8:9], v[200:201] op_sel:[1,0,0] op_sel_hi:[1,1,1]
    v_lshlrev_b32 v10, 16, v103
    v_and_b32 v11, s6, v103
    v_pk_fma_f32 v[202:203], v[38:39], v[10:11], v[202:203] op_sel:[1,0,0] op_sel_hi:[1,1,1]
    v_lshlrev_b32 v8, 16, v104
    v_and_b32 v9, s6, v104
    v_pk_fma_f32 v[196:197], v[40:41], v[8:9], v[196:197] op_sel:[0,0,0] op_sel_hi:[0,1,1]
    v_lshlrev_b32 v10, 16, v105
    v_and_b32 v11, s6, v105
    v_pk_fma_f32 v[198:199], v[40:41], v[10:11], v[198:199] op_sel:[0,0,0] op_sel_hi:[0,1,1]
    v_lshlrev_b32 v8, 16, v106
    v_and_b32 v9, s6, v106
    v_pk_fma_f32 v[200:201], v[40:41], v[8:9], v[200:201] op_sel:[0,0,0] op_sel_hi:[0,1,1]
    v_lshlrev_b32 v10, 16, v107
    v_and_b32 v11, s6, v107
    v_pk_fma_f32 v[202:203], v[40:41], v[10:11], v[202:203] op_sel:[0,0,0] op_sel_hi:[0,1,1]
    v_lshlrev_b32 v8, 16, v108
    v_and_b32 v9, s6, v108
    v_pk_fma_f32 v[196:197], v[40:41], v[8:9], v[196:197] op_sel:[1,0,0] op_sel_hi:[1,1,1]
    v_lshlrev_b32 v10, 16, v109
    v_and_b32 v11, s6, v109
    v_pk_fma_f32 v[198:199], v[40:41], v[10:11], v[198:199] op_sel:[1,0,0] op_sel_hi:[1,1,1]
    v_lshlrev_b32 v8, 16, v110
    v_and_b32 v9, s6, v110
    v_pk_fma_f32 v[200:201], v[40:41], v[8:9], v[200:201] op_sel:[1,0,0] op_sel_hi:[1,1,1]
    v_lshlrev_b32 v10, 16, v111
    v_and_b32 v11, s6, v111
    v_pk_fma_f32 v[202:203], v[40:41], v[10:11], v[202:203] op_sel:[1,0,0] op_sel_hi:[1,1,1]
    v_lshlrev_b32 v8, 16, v112
    v_and_b32 v9, s6, v112
    v_pk_fma_f32 v[196:197], v[42:43], v[8:9], v[196:197] op_sel:[0,0,0] op_sel_hi:[0,1,1]
    v_lshlrev_b32 v10, 16, v113
    v_and_b32 v11, s6, v113
    v_pk_fma_f32 v[198:199], v[42:43], v[10:11], v[198:199] op_sel:[0,0,0] op_sel_hi:[0,1,1]
    v_lshlrev_b32 v8, 16, v114
    v_and_b32 v9, s6, v114
    v_pk_fma_f32 v[200:201], v[42:43], v[8:9], v[200:201] op_sel:[0,0,0] op_sel_hi:[0,1,1]
    v_lshlrev_b32 v10, 16, v115
    v_and_b32 v11, s6, v115
    v_pk_fma_f32 v[202:203], v[42:43], v[10:11], v[202:203] op_sel:[0,0,0] op_sel_hi:[0,1,1]
    v_lshlrev_b32 v8, 16, v116
    v_and_b32 v9, s6, v116
    v_pk_fma_f32 v[196:197], v[42:43], v[8:9], v[196:197] op_sel:[1,0,0] op_sel_hi:[1,1,1]
    v_lshlrev_b32 v10, 16, v117
    v_and_b32 v11, s6, v117
    v_pk_fma_f32 v[198:199], v[42:43], v[10:11], v[198:199] op_sel:[1,0,0] op_sel_hi:[1,1,1]
    v_lshlrev_b32 v8, 16, v118
    v_and_b32 v9, s6, v118
    v_pk_fma_f32 v[200:201], v[42:43], v[8:9], v[200:201] op_sel:[1,0,0] op_sel_hi:[1,1,1]
    v_lshlrev_b32 v10, 16, v119
    v_and_b32 v11, s6, v119
    v_pk_fma_f32 v[202:203], v[42:43], v[10:11], v[202:203] op_sel:[1,0,0] op_sel_hi:[1,1,1]
    v_permlane32_swap_b32 v196, v200
    v_permlane32_swap_b32 v197, v201
    v_permlane32_swap_b32 v198, v202
    v_permlane32_swap_b32 v199, v203
    v_add_f32 v196, v196, v200
    v_add_f32 v197, v197, v201
    v_add_f32 v198, v198, v202
    v_add_f32 v199, v199, v203
    s_nop 0
    v_permlane16_swap_b32 v196, v198
    v_permlane16_swap_b32 v197, v199
    v_add_f32 v196, v196, v198
    v_add_f32 v197, v197, v199
    s_nop 0
    v_add_f32_dpp v196, v196, v196 row_ror:8 row_mask:0xf bank_mask:0xf
    v_add_f32_dpp v197, v197, v197 row_ror:8 row_mask:0xf bank_mask:0xf
    s_nop 1
    v_mov_b32_dpp v196, v197 quad_perm:[0,1,2,3] row_mask:0xf bank_mask:0xc
    ds_write_b32 v252, v196 offset:9984
L_HG1:
    s_waitcnt vmcnt(1)
    v_pk_add_f32 v[184:185], v[184:185], v[188:189]
    v_pk_add_f32 v[186:187], v[186:187], v[190:191]
    s_nop 1
    v_permlane32_swap_b32 v184, v186
    v_permlane32_swap_b32 v185, v187
    v_pk_add_f32 v[184:185], v[184:185], v[186:187]
    s_nop 1
    v_add_f32_dpp v184, v184, v184 row_ror:8 row_mask:0xf bank_mask:0xf
    v_add_f32_dpp v185, v185, v185 row_ror:8 row_mask:0xf bank_mask:0xf
    v_mov_b32 v186, v184
    v_mov_b32 v187, v185
    s_nop 0
    v_permlane16_swap_b32 v184, v186
    v_permlane16_swap_b32 v185, v187
    v_pk_add_f32 v[184:185], v[184:185], v[186:187]
    v_cvt_pk_bf16_f32 v184, v184, v185
    v_mov_b32 v185, s4
    s_mov_b32 exec_lo, 0xff
    s_mov_b32 exec_hi, 0xff
    buffer_store_dwordx2 v[184:185], v48, s[32:35], s15 offen sc1
    s_mov_b64 exec, -1
    s_waitcnt lgkmcnt(0)
    s_barrier
    s_cmp_lg_u32 s3, 0
    s_cbranch_scc1 L_PC2
    v_mov_b32 v85, s4
    s_mov_b32 exec_hi, 0
    s_mov_b32 exec_lo, 65535
    buffer_store_dword v85, v46, s[32:35], s17 offen sc1
    s_mov_b64 exec, -1
L_PC2:
    s_cmp_lg_u32 s3, 3
    s_cbranch_scc1 L_M2F
    ds_read_b128 v[196:199], v251 offset:11008
    s_lshr_b32 s96, s8, 2
    s_lshl1_add_u32 s97, s9, s96
    s_and_b32 s98, s8, 3
    s_lshl2_add_u32 s99, s97, s98
    s_lshl_b32 s96, s99, 9
    s_add_u32 s18, s96, 131072
    s_waitcnt lgkmcnt(0)
    v_add_f32 v196, v196, v197
    v_add_f32 v198, v198, v199
    v_mov_b32 v197, s4
    v_add_f32 v196, v196, v198
    buffer_store_dwordx2 v[196:197], v250, s[32:35], s18 offen sc1
L_M2F:
    s_waitcnt vmcnt(1)
L_PAD7:
    s_cbranch_execz L_RET7
    s_xor_b32 s96, s95, 262144
    s_add_u32 s82, s96, s90
    s_add_u32 m0, s83, 16384
    s_nop 0
    buffer_load_dwordx4 v26, s[44:47], s82 offen lds
    v_permlane32_swap_b32 v192, v194
    v_permlane32_swap_b32 v193, v195
    v_pk_add_f32 v[192:193], v[192:193], v[194:195]
    s_nop 1
    v_add_f32_dpp v192, v192, v192 row_ror:4 row_mask:0xf bank_mask:0xf
    s_xor_b32 s96, s95, 393216
    s_add_u32 s82, s96, s90
    s_add_u32 m0, s83, 24576
    s_nop 0
    buffer_load_dwordx4 v26, s[44:47], s82 offen lds
    v_add_f32_dpp v193, v193, v193 row_ror:4 row_mask:0xf bank_mask:0xf
    v_add_f32_dpp v192, v192, v192 row_ror:8 row_mask:0xf bank_mask:0xf
    s_nop 0
    v_add_f32_dpp v193, v193, v193 row_ror:8 row_mask:0xf bank_mask:0xf
    s_xor_b32 s96, s95, 524288
    s_add_u32 s82, s96, s90
    s_add_u32 m0, s83, 32768
    s_nop 0
    buffer_load_dwordx4 v26, s[44:47], s82 offen lds
    v_mov_b32 v194, v192
    v_mov_b32 v195, v193
    s_nop 0
    v_permlane16_swap_b32 v192, v194
    s_xor_b32 s96, s95, 655360
    s_add_u32 s82, s96, s90
    s_add_u32 m0, s83, 40960
    s_nop 0
    buffer_load_dwordx4 v26, s[44:47], s82 offen lds
    v_permlane16_swap_b32 v193, v195
    v_pk_add_f32 v[192:193], v[192:193], v[194:195]
    v_cvt_pk_bf16_f32 v192, v192, v193
    ds_write_b32 v6, v192
    s_waitcnt lgkmcnt(0)
    s_barrier
    ds_read_b128 v[196:199], v7
    ds_read_b128 v[200:203], v7 offset:32
    ds_read_b128 v[204:207], v7 offset:64
    ds_read_b128 v[208:211], v7 offset:96
    s_lshr_b32 s96, s8, 2
    s_lshl1_add_u32 s97, s9, s96
    s_and_b32 s98, s8, 3
    s_lshl2_add_u32 s99, s97, s98
    s_lshl_b32 s96, s99, 9
    s_add_u32 s18, s96, 131072
    s_waitcnt lgkmcnt(0)
    s_lshl3_add_u32 s96, s11, s3
    s_lshl_b32 s97, s96, 11
    s_add_u32 s13, s97, 29360128
    s_load_dwordx2 s[24:25], s[32:33], s92 offset:3584 glc
    v_mfma_f32_32x32x16_bf16 v[136:151], v[196:199], v[152:155], 0
    v_mfma_f32_32x32x16_bf16 v[136:151], v[200:203], v[156:159], v[136:151]
    v_mfma_f32_32x32x16_bf16 v[136:151], v[204:207], v[160:163], v[136:151]
    v_mfma_f32_32x32x16_bf16 v[136:151], v[208:211], v[164:167], v[136:151]
    s_lshr_b32 s96, s3, 2
    s_lshl_b32 s97, s96, 15
    s_and_b32 s98, s3, 3
    s_lshl_b32 s99, s98, 5
    s_add_u32 s19, s97, s99
    v_lshrrev_b32 v34, 4, v1
    v_lshlrev_b32 v34, 13, v34
    v_bfe_u32 v9, v1, 2, 2
    v_lshl_add_u32 v34, v9, 7, v34
    v_bfe_u32 v9, v1, 3, 2
    v_lshl_add_u32 v34, v9, 5, v34
    v_and_b32 v9, 3, v1
    v_lshl_add_u32 v34, v9, 3, v34
    v_xor_b32 v34, s19, v34
    s_lshl_b32 s96, s75, 11
    s_add_u32 s19, s96, 13631488
    v_and_b32 v52, 7, v1
    v_lshl_add_u32 v52, v52, 4, s19
    v_lshrrev_b32 v9, 4, v1
    v_lshl_add_u32 v52, v9, 9, v52
    v_and_b32 v53, 15, v1
    v_lshlrev_b32 v53, 9, v53
    v_add_u32 v53, 13631744, v53
    s_lshl_b32 s96, s74, 13
    s_add_u32 s72, s96, 20971520
    s_lshl3_add_u32 s96, s75, s3
    s_lshl_b32 s97, s96, 8
    s_add_u32 s73, s97, s72
    s_lshl3_add_u32 s96, s21, s3
    s_lshl4_add_u32 s97, s96, s12
    s_lshl_b32 s98, s97, 8
    s_add_u32 s86, s98, 12582912
    s_and_b32 s96, s12, 1
    s_lshr_b32 s97, s21, 2
    s_and_b32 s98, s21, 3
    s_lshl_b32 s99, s98, 6
    s_lshl1_add_u32 s98, s97, s99
    s_lshl_b32 s97, s98, 12
    s_lshr_b32 s99, s12, 1
    s_lshl_b32 s98, s99, 6
    s_add_u32 s99, s97, s98
    s_lshl2_add_u32 s97, s96, s99
    s_add_u32 s98, s97, 1048576
    s_add_u32 s87, s98, 1536
    s_lshl3_add_u32 s96, s21, s3
    s_lshl_b32 s97, s96, 15
    s_lshl_b32 s98, s12, 7
    s_add_u32 s70, s97, s98
    s_add_u32 s71, s70, 16384
    v_cvt_pk_bf16_f32 v136, 0, v136
    v_add_f32 v136, 0x358637bd, v136
    v_cvt_pk_bf16_f32 v136, 0, v136
    v_rcp_f32 v136, v136
    s_branch SCHK_23
SPOLL_22:
    s_load_dwordx2 s[24:25], s[32:33], s92 offset:3584 glc
SCHK_23:
    s_add_u32 s5, s5, 1
    s_cmp_ge_u32 s5, 200000
    s_waitcnt lgkmcnt(0)
    s_cbranch_scc1 SDONE_24
    s_cmp_lg_u32 s24, s4
    s_cbranch_scc1 SPOLL_22
    s_cmp_lg_u32 s25, s4
    s_cbranch_scc1 SPOLL_22
SDONE_24:
    buffer_load_dwordx4 v[228:231], v2, s[32:35], s13 offen sc1
    buffer_load_dwordx4 v[232:235], v2, s[32:35], s13 offen offset:1024 sc1
    s_lshl_b32 s19, s3, 6
    v_bfe_u32 v35, v1, 2, 1
    v_lshlrev_b32 v35, 9, v35
    v_bfe_u32 v9, v1, 3, 1
    v_lshl_add_u32 v35, v9, 12, v35
    v_lshrrev_b32 v9, 5, v1
    v_lshl_add_u32 v35, v9, 11, v35
    v_bfe_u32 v9, v1, 2, 2
    v_lshl_add_u32 v35, v9, 6, v35
    v_bfe_u32 v9, v1, 4, 1
    v_lshl_add_u32 v35, v9, 5, v35
    v_and_b32 v9, 3, v1
    v_lshl_add_u32 v35, v9, 3, v35
    v_xor_b32 v35, s19, v35
    v_add_u32 v35, 65536, v35
    s_waitcnt vmcnt(0)
    v_bitop3_b32 v4, v229, v231, s4 bitop3:0x7e
    v_bitop3_b32 v4, v4, v233, s4 bitop3:0xf6
    v_bitop3_b32 v4, v4, v235, s4 bitop3:0xf6
    v_cmp_ne_u32 vcc, 0, v4
    s_cbranch_vccz TOK_26
POLL_27:
    buffer_load_dwordx4 v[228:231], v2, s[32:35], s13 offen sc1
    buffer_load_dwordx4 v[232:235], v2, s[32:35], s13 offen offset:1024 sc1
    s_waitcnt vmcnt(0)
    v_bitop3_b32 v4, v229, v231, s4 bitop3:0x7e
    v_bitop3_b32 v4, v4, v233, s4 bitop3:0xf6
    v_bitop3_b32 v4, v4, v235, s4 bitop3:0xf6
    v_cmp_ne_u32 vcc, 0, v4
    s_cbranch_vccz PDONE_28
    s_add_u32 s5, s5, 1
    s_cmp_lt_u32 s5, 200000
    s_cbranch_scc1 POLL_27
PDONE_28:
TOK_26:
    ds_write2_b32 v5, v228, v230 offset0:0 offset1:1
    ds_write2_b32 v5, v232, v234 offset0:64 offset1:65
    s_waitcnt lgkmcnt(0)
    s_barrier
    ds_read_b128 v[212:215], v84
    ds_read_b128 v[216:219], v84 offset:1024
    ds_read_b128 v[220:223], v84 offset:2048
    ds_read_b128 v[224:227], v84 offset:3072
    s_lshl_b32 s96, s77, 1
    s_lshl3_add_u32 s97, s10, s96
    s_lshl_b32 s98, s97, 5
    s_lshl1_add_u32 s99, s11, s98
    s_add_u32 s96, s99, s76
    s_lshl_b32 s97, s96, 10
    s_add_u32 s13, s97, 8388608
    v_and_b32 v47, 15, v1
    v_lshlrev_b32 v47, 4, v47
    v_bfe_u32 v9, v1, 4, 1
    v_lshl_add_u32 v47, v9, 15, v47
    v_lshrrev_b32 v9, 5, v1
    v_lshl_add_u32 v47, v9, 8, v47
    s_waitcnt lgkmcnt(3)
    v_mfma_f32_32x32x16_bf16 v[120:135], v[212:215], v[152:155], 0
    s_waitcnt lgkmcnt(2)
    v_mfma_f32_32x32x16_bf16 v[120:135], v[216:219], v[156:159], v[120:135]
    s_waitcnt lgkmcnt(1)
    v_mfma_f32_32x32x16_bf16 v[120:135], v[220:223], v[160:163], v[120:135]
    s_waitcnt lgkmcnt(0)
    v_mfma_f32_32x32x16_bf16 v[120:135], v[224:227], v[164:167], v[120:135]
    s_lshr_b32 s96, s3, 1
    s_lshl4_add_u32 s97, s96, s12
    s_lshl_b32 s98, s97, 11
    s_and_b32 s99, s3, 1
    s_lshl_b32 s96, s99, 10
    s_add_u32 s97, s98, s96
    s_add_u32 s18, s97, 131072
    s_lshl_b32 s19, s12, 7
    v_and_b32 v84, 3, v1
    v_lshl_add_u32 v84, v84, 1, s19
    v_lshrrev_b32 v9, 5, v1
    v_lshl_add_u32 v84, v9, 3, v84
    v_bfe_u32 v9, v1, 4, 1
    v_lshl_add_u32 v84, v9, 4, v84
    v_bfe_u32 v9, v1, 2, 2
    v_lshl_add_u32 v84, v9, 5, v84
    global_load_ushort v32, v84, s[78:79]
    v_cvt_pk_bf16_f32 v120, 0, v120
    v_cvt_pk_bf16_f32 v121, 0, v121
    v_cvt_pk_bf16_f32 v122, 0, v122
    v_cvt_pk_bf16_f32 v123, 0, v123
    v_cvt_pk_bf16_f32 v124, 0, v124
    v_cvt_pk_bf16_f32 v125, 0, v125
    v_cvt_pk_bf16_f32 v126, 0, v126
    v_cvt_pk_bf16_f32 v127, 0, v127
    v_pk_mul_f32 v[120:121], v[120:121], v[136:137] op_sel_hi:[1,0]
    v_pk_mul_f32 v[122:123], v[122:123], v[136:137] op_sel_hi:[1,0]
    v_pk_mul_f32 v[124:125], v[124:125], v[136:137] op_sel_hi:[1,0]
    v_pk_mul_f32 v[126:127], v[126:127], v[136:137] op_sel_hi:[1,0]
    v_cvt_pk_bf16_f32 v168, v120, v121
    v_cvt_pk_bf16_f32 v169, v122, v123
    v_cvt_pk_bf16_f32 v170, v124, v125
    v_cvt_pk_bf16_f32 v171, v126, v127
    buffer_store_dwordx4 v[168:171], v47, s[32:35], s13 offen sc1
    v_cvt_pk_bf16_f32 v128, 0, v128
    v_cvt_pk_bf16_f32 v129, 0, v129
    v_cvt_pk_bf16_f32 v130, 0, v130
    v_cvt_pk_bf16_f32 v131, 0, v131
    v_cvt_pk_bf16_f32 v132, 0, v132
    v_cvt_pk_bf16_f32 v133, 0, v133
    v_cvt_pk_bf16_f32 v134, 0, v134
    v_cvt_pk_bf16_f32 v135, 0, v135
    v_pk_mul_f32 v[128:129], v[128:129], v[136:137] op_sel_hi:[1,0]
    v_pk_mul_f32 v[130:131], v[130:131], v[136:137] op_sel_hi:[1,0]
    v_pk_mul_f32 v[132:133], v[132:133], v[136:137] op_sel_hi:[1,0]
    v_pk_mul_f32 v[134:135], v[134:135], v[136:137] op_sel_hi:[1,0]
    v_cvt_pk_bf16_f32 v172, v128, v129
    v_cvt_pk_bf16_f32 v173, v130, v131
    v_cvt_pk_bf16_f32 v174, v132, v133
    v_cvt_pk_bf16_f32 v175, v134, v135
    buffer_store_dwordx4 v[172:175], v47, s[32:35], s13 offen offset:512 sc1
    buffer_load_dwordx4 v[28:31], v2, s[32:35], s18 offen sc1
    v_mov_b32 v236, -1
    v_mov_b32 v237, -1
    v_mov_b32 v238, -1
    v_mov_b32 v239, -1
    s_lshl3_add_u32 s96, s21, s3
    s_lshl4_add_u32 s97, s96, s12
    s_lshl_b32 s98, s97, 8
    s_add_u32 s19, s98, 12582912
    v_lshlrev_b32 v240, 2, v1
    buffer_store_dword v236, v240, s[32:35], s19 offen sc1
    s_lshl_b32 s96, s21, 14
    s_lshl_b32 s97, s12, 9
    s_add_u32 s98, s96, s97
    s_add_u32 s19, s98, 13631488
    v_and_b32 v240, 31, v1
    v_lshlrev_b32 v240, 4, v240
    v_lshrrev_b32 v241, 5, v1
    v_lshl_add_u32 v240, v241, 13, v240
    s_cmp_lg_u32 s3, 5
    s_cbranch_scc1 L_NOPO
    buffer_store_dwordx4 v[236:239], v240, s[32:35], s19 offen sc1
L_NOPO:
    v_bfe_u32 v36, v1, 2, 2
    v_lshlrev_b32 v36, 7, v36
    v_lshrrev_b32 v9, 4, v1
    v_lshl_add_u32 v36, v9, 10, v36
    v_and_b32 v9, 1, v1
    v_lshl_add_u32 v36, v9, 4, v36
    v_bfe_u32 v9, v1, 1, 1
    v_lshl_add_u32 v36, v9, 3, v36
    v_bfe_u32 v9, v1, 3, 2
    v_lshl_add_u32 v36, v9, 5, v36
    s_and_b32 s96, s9, 1
    s_lshl_b32 s97, s96, 2
    s_xor_b32 s98, s3, s97
    s_lshl_b32 s17, s98, 12
    s_lshl_b32 s96, s17, 2
    s_lshr_b32 s97, s95, 4
    s_xor_b32 s14, s96, s97
    v_add_u32 v36, s14, v36
    v_xor_b32 v37, 32, v36
    v_xor_b32 v38, 64, v36
    v_xor_b32 v39, 96, v36
    v_and_b32 v5, 7, v1
    v_lshlrev_b32 v5, 15, v5
    v_bfe_u32 v9, v1, 3, 1
    v_lshl_add_u32 v5, v9, 12, v5
    s_and_b32 s96, s11, 1
    s_lshr_b32 s97, s10, 2
    s_and_b32 s98, s10, 3
    s_lshl_b32 s99, s98, 6
    s_lshl1_add_u32 s98, s97, s99
    s_lshl_b32 s97, s98, 12
    s_lshr_b32 s99, s11, 1
    s_lshl_b32 s98, s99, 6
    s_add_u32 s99, s97, s98
    s_lshl2_add_u32 s97, s96, s99
    s_add_u32 s98, s97, 1048576
    s_add_u32 s15, s98, 1024
    v_lshlrev_b32 v152, 16, v12
    v_and_b32 v153, s6, v12
    v_lshlrev_b32 v154, 16, v13
    v_and_b32 v155, s6, v13
    v_lshlrev_b32 v156, 16, v14
    v_and_b32 v157, s6, v14
    v_lshlrev_b32 v158, 16, v15
    v_and_b32 v159, s6, v15
    v_lshlrev_b32 v160, 16, v16
    v_and_b32 v161, s6, v16
    v_lshlrev_b32 v162, 16, v17
    v_and_b32 v163, s6, v17
    v_lshlrev_b32 v164, 16, v18
    v_and_b32 v165, s6, v18
    v_lshlrev_b32 v166, 16, v19
    v_and_b32 v167, s6, v19
    s_lshl3_add_u32 s96, s21, s3
    s_lshl_b32 s97, s96, 15
    s_add_u32 s19, s97, 8388608
    s_and_b32 s96, s3, 1
    s_lshl_b32 s14, s96, 1
    s_lshr_b32 s96, s3, 1
    s_lshl_b32 s97, s96, 10
    s_add_u32 s16, s97, 159744
    v_bfe_u32 v4, v1, 4, 1
    v_bfe_u32 v9, v1, 2, 1
    v_lshl_add_u32 v4, v9, 1, v4
    v_lshrrev_b32 v7, 5, v1
    v_lshl_add_u32 v7, v7, 0, s14
    v_xor_b32 v4, v4, v7
    v_lshl_add_u32 v4, v4, 2, s16
    v_and_b32 v7, 1, v1
    v_lshlrev_b32 v7, 5, v7
    v_bfe_u32 v9, v1, 3, 2
    v_lshl_add_u32 v7, v9, 6, v7
    v_bfe_u32 v9, v1, 2, 1
    v_lshl_add_u32 v7, v9, 8, v7
    v_bfe_u32 v9, v1, 1, 1
    v_lshl_add_u32 v7, v9, 9, v7
    v_add_u32 v4, v4, v7
    s_waitcnt vmcnt(2)
    s_waitcnt lgkmcnt(0)
    s_barrier
    s_cmp_lg_u32 s3, 0
    s_cbranch_scc1 L_PD
    v_mov_b32 v6, s4
    s_mov_b32 exec_hi, 0
    s_mov_b32 exec_lo, 65535
    buffer_store_dword v6, v5, s[32:35], s15 offen sc1
    s_mov_b64 exec, -1
L_PD:
    s_waitcnt vmcnt(1)
    v_bitop3_b32 v6, v29, v31, s4 bitop3:0x7e
    v_cmp_ne_u32 vcc, 0, v6
    s_cbranch_vccz L_MGOK
POLL_29:
    buffer_load_dwordx4 v[28:31], v2, s[32:35], s18 offen sc1
    s_waitcnt vmcnt(0)
    v_bitop3_b32 v6, v29, v31, s4 bitop3:0x7e
    v_cmp_ne_u32 vcc, 0, v6
    s_cbranch_vccz PDONE_30
    s_add_u32 s5, s5, 1
    s_cmp_lt_u32 s5, 200000
    s_cbranch_scc1 POLL_29
PDONE_30:
L_MGOK:
    ds_write2_b32 v4, v28, v30 offset0:0 offset1:4
    s_waitcnt lgkmcnt(0)
    s_barrier
    s_lshl_b32 s96, s2, 12
    s_lshr_b32 s97, s17, 6
    s_add_u32 s98, s96, s97
    s_add_u32 s99, s98, 1048576
    s_add_u32 s18, s99, 1024
    ds_read_b128 v[192:195], v251 offset:12288
    ds_read_b128 v[196:199], v251 offset:13312
    ds_read_b128 v[200:203], v251 offset:14336
    ds_read_b128 v[204:207], v251 offset:15360
    v_and_b32 v8, 3, v1
    v_lshlrev_b32 v8, 2, v8
    v_lshrrev_b32 v9, 5, v1
    v_lshl_add_u32 v8, v9, 4, v8
    v_bfe_u32 v9, v1, 4, 1
    v_lshl_add_u32 v8, v9, 5, v8
    v_bfe_u32 v9, v1, 2, 2
    v_lshl_add_u32 v8, v9, 6, v8
    v_add_u32 v8, 157184, v8
    s_lshl4_add_u32 s96, s21, s12
    s_lshl_b32 s97, s96, 6
    s_add_u32 s13, s97, 14155776
    v_lshlrev_b32 v10, 1, v1
    v_add_u32 v10, 157440, v10
    v_and_b32 v11, 3, v1
    v_lshlrev_b32 v11, 7, v11
    v_lshrrev_b32 v9, 4, v1
    v_lshl_add_u32 v11, v9, 5, v11
    v_add_u32 v11, 157440, v11
    s_waitcnt lgkmcnt(0)
    s_load_dwordx2 s[24:25], s[32:33], s18 offset:0 glc
    v_pk_add_f32 v[192:193], v[192:193], v[194:195]
    v_add_f32 v28, v192, v193
    v_pk_add_f32 v[196:197], v[196:197], v[198:199]
    v_add_f32 v29, v196, v197
    v_pk_add_f32 v[200:201], v[200:201], v[202:203]
    v_add_f32 v30, v200, v201
    v_pk_add_f32 v[204:205], v[204:205], v[206:207]
    v_add_f32 v31, v204, v205
    v_cvt_pk_bf16_f32 v28, 0, v28
    v_cvt_pk_bf16_f32 v29, 0, v29
    v_cvt_pk_bf16_f32 v30, 0, v30
    v_cvt_pk_bf16_f32 v31, 0, v31
    v_add_f32 v30, 1.0, v30
    v_lshlrev_b32 v32, 16, v32
    v_cvt_pk_bf16_f32 v30, 0, v30
    ds_write_b32 v8, v31
    v_mul_f32 v192, v30, v32
    v_cvt_pk_bf16_f32 v193, 0, v192
    v_sub_f32 v194, v192, v193
    v_add_f32_dpp v192, v192, v192 quad_perm:[1,0,3,2] row_mask:0xf bank_mask:0xf
    s_nop 1
    v_add_f32_dpp v192, v192, v192 quad_perm:[2,3,0,1] row_mask:0xf bank_mask:0xf
    s_nop 1
    v_add_f32_dpp v192, v192, v192 row_half_mirror row_mask:0xf bank_mask:0xf
    s_nop 1
    v_add_f32_dpp v192, v192, v192 row_ror:8 row_mask:0xf bank_mask:0xf
    v_mov_b32 v199, v192
    s_nop 1
    v_permlane16_swap_b32 v192, v199
    v_add_f32 v192, v192, v199
    v_mov_b32 v199, v192
    s_nop 1
    v_permlane32_swap_b32 v192, v199
    v_add_f32 v192, v192, v199
    v_mov_b32_dpp v196, v193 row_shl:1 row_mask:0xf bank_mask:0xf
    v_mov_b32_dpp v197, v194 row_shl:1 row_mask:0xf bank_mask:0xf
    v_mov_b32_dpp v198, v32 row_shl:1 row_mask:0xf bank_mask:0xf
    v_cvt_pk_bf16_f32 v196, v193, v196
    v_cvt_pk_bf16_f32 v197, v194, v197
    v_cvt_pk_bf16_f32 v198, v32, v198
    v_mov_b32 v193, s4
    v_mov_b32 v194, 0
    s_cmp_lg_u32 s3, 2
    s_cbranch_scc1 L_NOUP
    s_mov_b64 exec, 1
    buffer_store_dwordx2 v[192:193], v194, s[32:35], s13 offen sc1
    s_mov_b64 exec, -1
L_NOUP:
    v_mov_b32 v199, 0x3f803f80
    s_mov_b32 exec_lo, 0x55555555
    s_mov_b32 exec_hi, 0x55555555
    ds_write_b32 v10, v199 offset:0
    ds_write_b32 v10, v196 offset:128
    ds_write_b32 v10, v197 offset:256
    ds_write_b32 v10, v198 offset:384
    s_mov_b64 exec, -1
    ds_read_b128 v[184:187], v11
    ds_read_b128 v[188:191], v11 offset:16
    v_mov_b32 v42, v29
    v_mov_b32 v43, v31
    v_mov_b32 v33, v30
    v_mov_b32_dpp v136, v28 row_newbcast:0 row_mask:0xf bank_mask:0xf
    v_mov_b32_dpp v137, v28 row_newbcast:1 row_mask:0xf bank_mask:0xf
    v_mov_b32_dpp v138, v28 row_newbcast:2 row_mask:0xf bank_mask:0xf
    v_mov_b32_dpp v139, v28 row_newbcast:3 row_mask:0xf bank_mask:0xf
    v_mov_b32_dpp v140, v28 row_newbcast:4 row_mask:0xf bank_mask:0xf
    v_mov_b32_dpp v141, v28 row_newbcast:5 row_mask:0xf bank_mask:0xf
    v_mov_b32_dpp v142, v28 row_newbcast:6 row_mask:0xf bank_mask:0xf
    v_mov_b32_dpp v143, v28 row_newbcast:7 row_mask:0xf bank_mask:0xf
    v_mov_b32_dpp v144, v28 row_newbcast:8 row_mask:0xf bank_mask:0xf
    v_mov_b32_dpp v145, v28 row_newbcast:9 row_mask:0xf bank_mask:0xf
    v_mov_b32_dpp v146, v28 row_newbcast:10 row_mask:0xf bank_mask:0xf
    v_mov_b32_dpp v147, v28 row_newbcast:11 row_mask:0xf bank_mask:0xf
    v_mov_b32_dpp v148, v28 row_newbcast:12 row_mask:0xf bank_mask:0xf
    v_mov_b32_dpp v149, v28 row_newbcast:13 row_mask:0xf bank_mask:0xf
    v_mov_b32_dpp v150, v28 row_newbcast:14 row_mask:0xf bank_mask:0xf
    v_mov_b32_dpp v151, v28 row_newbcast:15 row_mask:0xf bank_mask:0xf
    v_mov_b32 v29, v5
    s_branch SCHK_32
SPOLL_31:
    s_load_dwordx2 s[24:25], s[32:33], s18 offset:0 glc
SCHK_32:
    s_add_u32 s5, s5, 1
    s_cmp_ge_u32 s5, 200000
    s_waitcnt lgkmcnt(0)
    s_cbranch_scc1 SDONE_33
    s_cmp_lg_u32 s24, s4
    s_cbranch_scc1 SPOLL_31
    s_cmp_lg_u32 s25, s4
    s_cbranch_scc1 SPOLL_31
SDONE_33:
    s_add_u32 s20, s17, s19
    buffer_load_dwordx4 v[224:227], v2, s[32:35], s20 offen sc1
    ds_read_b64_tr_b16 v[192:193], v36
    ds_read_b64_tr_b16 v[194:195], v36 offset:512
    ds_read_b64_tr_b16 v[196:197], v37
    ds_read_b64_tr_b16 v[198:199], v37 offset:512
    ds_read_b64_tr_b16 v[200:201], v38
    ds_read_b64_tr_b16 v[202:203], v38 offset:512
    ds_read_b64_tr_b16 v[204:205], v39
    ds_read_b64_tr_b16 v[206:207], v39 offset:512
    ds_read_b64_tr_b16 v[208:209], v36 offset:4096
    ds_read_b64_tr_b16 v[210:211], v36 offset:4608
    ds_read_b64_tr_b16 v[212:213], v37 offset:4096
    ds_read_b64_tr_b16 v[214:215], v37 offset:4608
    ds_read_b64_tr_b16 v[216:217], v38 offset:4096
    ds_read_b64_tr_b16 v[218:219], v38 offset:4608
    buffer_load_dwordx4 v[228:231], v2, s[32:35], s20 offen offset:1024 sc1
    buffer_load_dwordx4 v[232:235], v2, s[32:35], s20 offen offset:2048 sc1
    buffer_load_dwordx4 v[236:239], v2, s[32:35], s20 offen offset:3072 sc1
    s_barrier
    s_xor_b32 s96, s17, 4096
    s_add_u32 s20, s96, s19
    buffer_load_dwordx4 v[240:243], v2, s[32:35], s20 offen sc1
    buffer_load_dwordx4 v[244:247], v2, s[32:35], s20 offen offset:1024 sc1
    buffer_load_dwordx4 v[44:47], v2, s[32:35], s20 offen offset:2048 sc1
    buffer_load_dwordx4 v[48:51], v2, s[32:35], s20 offen offset:3072 sc1
    s_lshl_b32 s96, s21, 10
    s_add_u32 s13, s96, 14155776
    v_and_b32 v10, 15, v1
    v_lshlrev_b32 v10, 6, v10
    s_cmp_lt_u32 s3, 4
    s_cbranch_scc1 L_G2P0
    s_setprio 1
L_G2P0:
    s_waitcnt vmcnt(7)
    s_waitcnt lgkmcnt(6)
    v_mfma_f32_16x16x32_bf16 v[120:123], v[192:195], v[224:227], 0
    ds_read_b64_tr_b16 v[220:221], v39 offset:4096
    ds_read_b64_tr_b16 v[222:223], v39 offset:4608
    v_mfma_f32_16x16x32_bf16 v[124:127], v[196:199], v[224:227], 0
    ds_read_b64_tr_b16 v[192:193], v36 offset:8192
    ds_read_b64_tr_b16 v[194:195], v36 offset:8704
    v_mfma_f32_16x16x32_bf16 v[128:131], v[200:203], v[224:227], 0
    ds_read_b64_tr_b16 v[196:197], v37 offset:8192
    ds_read_b64_tr_b16 v[198:199], v37 offset:8704
    v_mfma_f32_16x16x32_bf16 v[132:135], v[204:207], v[224:227], 0
    ds_read_b64_tr_b16 v[200:201], v38 offset:8192
    ds_read_b64_tr_b16 v[202:203], v38 offset:8704
    s_xor_b32 s96, s17, 8192
    s_add_u32 s20, s96, s19
    buffer_load_dwordx4 v[224:227], v2, s[32:35], s20 offen sc1
    s_waitcnt vmcnt(7)
    s_waitcnt lgkmcnt(6)
    v_mfma_f32_16x16x32_bf16 v[120:123], v[208:211], v[228:231], v[120:123]
    ds_read_b64_tr_b16 v[204:205], v39 offset:8192
    ds_read_b64_tr_b16 v[206:207], v39 offset:8704
    v_mfma_f32_16x16x32_bf16 v[124:127], v[212:215], v[228:231], v[124:127]
    ds_read_b64_tr_b16 v[208:209], v36 offset:12288
    ds_read_b64_tr_b16 v[210:211], v36 offset:12800
    v_xor_b32 v36, 16384, v36
    v_mfma_f32_16x16x32_bf16 v[128:131], v[216:219], v[228:231], v[128:131]
    ds_read_b64_tr_b16 v[212:213], v37 offset:12288
    ds_read_b64_tr_b16 v[214:215], v37 offset:12800
    v_xor_b32 v37, 16384, v37
    v_mfma_f32_16x16x32_bf16 v[132:135], v[220:223], v[228:231], v[132:135]
    ds_read_b64_tr_b16 v[216:217], v38 offset:12288
    ds_read_b64_tr_b16 v[218:219], v38 offset:12800
    v_xor_b32 v38, 16384, v38
    buffer_load_dwordx4 v[228:231], v2, s[32:35], s20 offen offset:1024 sc1
    s_waitcnt vmcnt(7)
    s_waitcnt lgkmcnt(6)
    v_mfma_f32_16x16x32_bf16 v[120:123], v[192:195], v[232:235], v[120:123]
    ds_read_b64_tr_b16 v[220:221], v39 offset:12288
    ds_read_b64_tr_b16 v[222:223], v39 offset:12800
    v_xor_b32 v39, 16384, v39
    v_mfma_f32_16x16x32_bf16 v[124:127], v[196:199], v[232:235], v[124:127]
    ds_read_b64_tr_b16 v[192:193], v36
    ds_read_b64_tr_b16 v[194:195], v36 offset:512
    v_mfma_f32_16x16x32_bf16 v[128:131], v[200:203], v[232:235], v[128:131]
    ds_read_b64_tr_b16 v[196:197], v37
    ds_read_b64_tr_b16 v[198:199], v37 offset:512
    v_mfma_f32_16x16x32_bf16 v[132:135], v[204:207], v[232:235], v[132:135]
    ds_read_b64_tr_b16 v[200:201], v38
    ds_read_b64_tr_b16 v[202:203], v38 offset:512
    buffer_load_dwordx4 v[232:235], v2, s[32:35], s20 offen offset:2048 sc1
    s_waitcnt vmcnt(7)
    s_waitcnt lgkmcnt(6)
    v_mfma_f32_16x16x32_bf16 v[120:123], v[208:211], v[236:239], v[120:123]
    ds_read_b64_tr_b16 v[204:205], v39
    ds_read_b64_tr_b16 v[206:207], v39 offset:512
    v_mfma_f32_16x16x32_bf16 v[124:127], v[212:215], v[236:239], v[124:127]
    ds_read_b64_tr_b16 v[208:209], v36 offset:4096
    ds_read_b64_tr_b16 v[210:211], v36 offset:4608
    v_mfma_f32_16x16x32_bf16 v[128:131], v[216:219], v[236:239], v[128:131]
    ds_read_b64_tr_b16 v[212:213], v37 offset:4096
    ds_read_b64_tr_b16 v[214:215], v37 offset:4608
    v_mfma_f32_16x16x32_bf16 v[132:135], v[220:223], v[236:239], v[132:135]
    ds_read_b64_tr_b16 v[216:217], v38 offset:4096
    ds_read_b64_tr_b16 v[218:219], v38 offset:4608
    buffer_load_dwordx4 v[236:239], v2, s[32:35], s20 offen offset:3072 sc1
    s_waitcnt vmcnt(7)
    s_waitcnt lgkmcnt(6)
    v_mfma_f32_16x16x32_bf16 v[120:123], v[192:195], v[240:243], v[120:123]
    ds_read_b64_tr_b16 v[220:221], v39 offset:4096
    ds_read_b64_tr_b16 v[222:223], v39 offset:4608
    v_mfma_f32_16x16x32_bf16 v[124:127], v[196:199], v[240:243], v[124:127]
    ds_read_b64_tr_b16 v[192:193], v36 offset:8192
    ds_read_b64_tr_b16 v[194:195], v36 offset:8704
    v_mfma_f32_16x16x32_bf16 v[128:131], v[200:203], v[240:243], v[128:131]
    ds_read_b64_tr_b16 v[196:197], v37 offset:8192
    ds_read_b64_tr_b16 v[198:199], v37 offset:8704
    v_mfma_f32_16x16x32_bf16 v[132:135], v[204:207], v[240:243], v[132:135]
    ds_read_b64_tr_b16 v[200:201], v38 offset:8192
    ds_read_b64_tr_b16 v[202:203], v38 offset:8704
    s_xor_b32 s96, s17, 12288
    s_add_u32 s20, s96, s19
    buffer_load_dwordx4 v[240:243], v2, s[32:35], s20 offen sc1
    s_waitcnt vmcnt(7)
    s_waitcnt lgkmcnt(6)
    v_mfma_f32_16x16x32_bf16 v[120:123], v[208:211], v[244:247], v[120:123]
    ds_read_b64_tr_b16 v[204:205], v39 offset:8192
    ds_read_b64_tr_b16 v[206:207], v39 offset:8704
    v_mfma_f32_16x16x32_bf16 v[124:127], v[212:215], v[244:247], v[124:127]
    ds_read_b64_tr_b16 v[208:209], v36 offset:12288
    ds_read_b64_tr_b16 v[210:211], v36 offset:12800
    v_xor_b32 v36, 49152, v36
    v_mfma_f32_16x16x32_bf16 v[128:131], v[216:219], v[244:247], v[128:131]
    ds_read_b64_tr_b16 v[212:213], v37 offset:12288
    ds_read_b64_tr_b16 v[214:215], v37 offset:12800
    v_xor_b32 v37, 49152, v37
    v_mfma_f32_16x16x32_bf16 v[132:135], v[220:223], v[244:247], v[132:135]
    ds_read_b64_tr_b16 v[216:217], v38 offset:12288
    ds_read_b64_tr_b16 v[218:219], v38 offset:12800
    v_xor_b32 v38, 49152, v38
    buffer_load_dwordx4 v[244:247], v2, s[32:35], s20 offen offset:1024 sc1
    s_waitcnt vmcnt(7)
    s_waitcnt lgkmcnt(6)
    v_mfma_f32_16x16x32_bf16 v[120:123], v[192:195], v[44:47], v[120:123]
    ds_read_b64_tr_b16 v[220:221], v39 offset:12288
    ds_read_b64_tr_b16 v[222:223], v39 offset:12800
    v_xor_b32 v39, 49152, v39
    v_mfma_f32_16x16x32_bf16 v[124:127], v[196:199], v[44:47], v[124:127]
    ds_read_b64_tr_b16 v[192:193], v36
    ds_read_b64_tr_b16 v[194:195], v36 offset:512
    v_mfma_f32_16x16x32_bf16 v[128:131], v[200:203], v[44:47], v[128:131]
    ds_read_b64_tr_b16 v[196:197], v37
    ds_read_b64_tr_b16 v[198:199], v37 offset:512
    v_mfma_f32_16x16x32_bf16 v[132:135], v[204:207], v[44:47], v[132:135]
    ds_read_b64_tr_b16 v[200:201], v38
    ds_read_b64_tr_b16 v[202:203], v38 offset:512
    buffer_load_dwordx4 v[44:47], v2, s[32:35], s20 offen offset:2048 sc1
    s_waitcnt vmcnt(7)
    s_waitcnt lgkmcnt(6)
    v_mfma_f32_16x16x32_bf16 v[120:123], v[208:211], v[48:51], v[120:123]
    ds_read_b64_tr_b16 v[204:205], v39
    ds_read_b64_tr_b16 v[206:207], v39 offset:512
    v_mfma_f32_16x16x32_bf16 v[124:127], v[212:215], v[48:51], v[124:127]
    ds_read_b64_tr_b16 v[208:209], v36 offset:4096
    ds_read_b64_tr_b16 v[210:211], v36 offset:4608
    v_mfma_f32_16x16x32_bf16 v[128:131], v[216:219], v[48:51], v[128:131]
    ds_read_b64_tr_b16 v[212:213], v37 offset:4096
    ds_read_b64_tr_b16 v[214:215], v37 offset:4608
    v_mfma_f32_16x16x32_bf16 v[132:135], v[220:223], v[48:51], v[132:135]
    ds_read_b64_tr_b16 v[216:217], v38 offset:4096
    ds_read_b64_tr_b16 v[218:219], v38 offset:4608
    buffer_load_dwordx4 v[48:51], v2, s[32:35], s20 offen offset:3072 sc1
    s_waitcnt vmcnt(7)
    s_waitcnt lgkmcnt(6)
    v_mfma_f32_16x16x32_bf16 v[120:123], v[192:195], v[224:227], v[120:123]
    ds_read_b64_tr_b16 v[220:221], v39 offset:4096
    ds_read_b64_tr_b16 v[222:223], v39 offset:4608
    v_mfma_f32_16x16x32_bf16 v[124:127], v[196:199], v[224:227], v[124:127]
    ds_read_b64_tr_b16 v[192:193], v36 offset:8192
    ds_read_b64_tr_b16 v[194:195], v36 offset:8704
L_PAD8:
    s_cbranch_execz L_RET8
    v_mfma_f32_16x16x32_bf16 v[128:131], v[200:203], v[224:227], v[128:131]
    ds_read_b64_tr_b16 v[196:197], v37 offset:8192
    ds_read_b64_tr_b16 v[198:199], v37 offset:8704
    v_mfma_f32_16x16x32_bf16 v[132:135], v[204:207], v[224:227], v[132:135]
    ds_read_b64_tr_b16 v[200:201], v38 offset:8192
    ds_read_b64_tr_b16 v[202:203], v38 offset:8704
    s_xor_b32 s96, s17, 16384
    s_add_u32 s20, s96, s19
    buffer_load_dwordx4 v[224:227], v2, s[32:35], s20 offen sc1
    s_waitcnt vmcnt(7)
    s_waitcnt lgkmcnt(6)
    v_mfma_f32_16x16x32_bf16 v[120:123], v[208:211], v[228:231], v[120:123]
    ds_read_b64_tr_b16 v[204:205], v39 offset:8192
    ds_read_b64_tr_b16 v[206:207], v39 offset:8704
    v_mfma_f32_16x16x32_bf16 v[124:127], v[212:215], v[228:231], v[124:127]
    ds_read_b64_tr_b16 v[208:209], v36 offset:12288
    ds_read_b64_tr_b16 v[210:211], v36 offset:12800
    v_xor_b32 v36, 16384, v36
    v_mfma_f32_16x16x32_bf16 v[128:131], v[216:219], v[228:231], v[128:131]
    ds_read_b64_tr_b16 v[212:213], v37 offset:12288
    ds_read_b64_tr_b16 v[214:215], v37 offset:12800
    v_xor_b32 v37, 16384, v37
    v_mfma_f32_16x16x32_bf16 v[132:135], v[220:223], v[228:231], v[132:135]
    ds_read_b64_tr_b16 v[216:217], v38 offset:12288
    ds_read_b64_tr_b16 v[218:219], v38 offset:12800
    v_xor_b32 v38, 16384, v38
    buffer_load_dwordx4 v[228:231], v2, s[32:35], s20 offen offset:1024 sc1
    s_waitcnt vmcnt(7)
    s_waitcnt lgkmcnt(6)
    v_mfma_f32_16x16x32_bf16 v[120:123], v[192:195], v[232:235], v[120:123]
    ds_read_b64_tr_b16 v[220:221], v39 offset:12288
    ds_read_b64_tr_b16 v[222:223], v39 offset:12800
    v_xor_b32 v39, 16384, v39
    v_mfma_f32_16x16x32_bf16 v[124:127], v[196:199], v[232:235], v[124:127]
    ds_read_b64_tr_b16 v[192:193], v36
    ds_read_b64_tr_b16 v[194:195], v36 offset:512
    v_mfma_f32_16x16x32_bf16 v[128:131], v[200:203], v[232:235], v[128:131]
    ds_read_b64_tr_b16 v[196:197], v37
    ds_read_b64_tr_b16 v[198:199], v37 offset:512
    v_mfma_f32_16x16x32_bf16 v[132:135], v[204:207], v[232:235], v[132:135]
    ds_read_b64_tr_b16 v[200:201], v38
    ds_read_b64_tr_b16 v[202:203], v38 offset:512
    buffer_load_dwordx4 v[232:235], v2, s[32:35], s20 offen offset:2048 sc1
    s_waitcnt vmcnt(7)
    s_waitcnt lgkmcnt(6)
    v_mfma_f32_16x16x32_bf16 v[120:123], v[208:211], v[236:239], v[120:123]
    ds_read_b64_tr_b16 v[204:205], v39
    ds_read_b64_tr_b16 v[206:207], v39 offset:512
    v_mfma_f32_16x16x32_bf16 v[124:127], v[212:215], v[236:239], v[124:127]
    ds_read_b64_tr_b16 v[208:209], v36 offset:4096
    ds_read_b64_tr_b16 v[210:211], v36 offset:4608
    v_mfma_f32_16x16x32_bf16 v[128:131], v[216:219], v[236:239], v[128:131]
    ds_read_b64_tr_b16 v[212:213], v37 offset:4096
    ds_read_b64_tr_b16 v[214:215], v37 offset:4608
    v_mfma_f32_16x16x32_bf16 v[132:135], v[220:223], v[236:239], v[132:135]
    ds_read_b64_tr_b16 v[216:217], v38 offset:4096
    ds_read_b64_tr_b16 v[218:219], v38 offset:4608
    buffer_load_dwordx4 v[236:239], v2, s[32:35], s20 offen offset:3072 sc1
    s_waitcnt vmcnt(7)
    s_waitcnt lgkmcnt(6)
    v_mfma_f32_16x16x32_bf16 v[120:123], v[192:195], v[240:243], v[120:123]
    ds_read_b64_tr_b16 v[220:221], v39 offset:4096
    ds_read_b64_tr_b16 v[222:223], v39 offset:4608
    v_mfma_f32_16x16x32_bf16 v[124:127], v[196:199], v[240:243], v[124:127]
    ds_read_b64_tr_b16 v[192:193], v36 offset:8192
    ds_read_b64_tr_b16 v[194:195], v36 offset:8704
    v_mfma_f32_16x16x32_bf16 v[128:131], v[200:203], v[240:243], v[128:131]
    ds_read_b64_tr_b16 v[196:197], v37 offset:8192
    ds_read_b64_tr_b16 v[198:199], v37 offset:8704
    v_mfma_f32_16x16x32_bf16 v[132:135], v[204:207], v[240:243], v[132:135]
    ds_read_b64_tr_b16 v[200:201], v38 offset:8192
    ds_read_b64_tr_b16 v[202:203], v38 offset:8704
    s_xor_b32 s96, s17, 20480
    s_add_u32 s20, s96, s19
    buffer_load_dwordx4 v[240:243], v2, s[32:35], s20 offen sc1
    s_waitcnt vmcnt(7)
    s_waitcnt lgkmcnt(6)
    v_mfma_f32_16x16x32_bf16 v[120:123], v[208:211], v[244:247], v[120:123]
    ds_read_b64_tr_b16 v[204:205], v39 offset:8192
    ds_read_b64_tr_b16 v[206:207], v39 offset:8704
    v_mfma_f32_16x16x32_bf16 v[124:127], v[212:215], v[244:247], v[124:127]
    ds_read_b64_tr_b16 v[208:209], v36 offset:12288
    ds_read_b64_tr_b16 v[210:211], v36 offset:12800
    v_xor_b32 v36, 114688, v36
    v_mfma_f32_16x16x32_bf16 v[128:131], v[216:219], v[244:247], v[128:131]
    ds_read_b64_tr_b16 v[212:213], v37 offset:12288
    ds_read_b64_tr_b16 v[214:215], v37 offset:12800
    v_xor_b32 v37, 114688, v37
    v_mfma_f32_16x16x32_bf16 v[132:135], v[220:223], v[244:247], v[132:135]
    ds_read_b64_tr_b16 v[216:217], v38 offset:12288
    ds_read_b64_tr_b16 v[218:219], v38 offset:12800
    v_xor_b32 v38, 114688, v38
    buffer_load_dwordx4 v[244:247], v2, s[32:35], s20 offen offset:1024 sc1
    s_waitcnt vmcnt(7)
    s_waitcnt lgkmcnt(6)
    v_mfma_f32_16x16x32_bf16 v[120:123], v[192:195], v[44:47], v[120:123]
    ds_read_b64_tr_b16 v[220:221], v39 offset:12288
    ds_read_b64_tr_b16 v[222:223], v39 offset:12800
    v_xor_b32 v39, 114688, v39
    v_mfma_f32_16x16x32_bf16 v[124:127], v[196:199], v[44:47], v[124:127]
    ds_read_b64_tr_b16 v[192:193], v36
    ds_read_b64_tr_b16 v[194:195], v36 offset:512
    v_mfma_f32_16x16x32_bf16 v[128:131], v[200:203], v[44:47], v[128:131]
    ds_read_b64_tr_b16 v[196:197], v37
    ds_read_b64_tr_b16 v[198:199], v37 offset:512
    v_mfma_f32_16x16x32_bf16 v[132:135], v[204:207], v[44:47], v[132:135]
    ds_read_b64_tr_b16 v[200:201], v38
    ds_read_b64_tr_b16 v[202:203], v38 offset:512
    buffer_load_dwordx4 v[44:47], v2, s[32:35], s20 offen offset:2048 sc1
    s_waitcnt vmcnt(7)
    s_waitcnt lgkmcnt(6)
    v_mfma_f32_16x16x32_bf16 v[120:123], v[208:211], v[48:51], v[120:123]
    ds_read_b64_tr_b16 v[204:205], v39
    ds_read_b64_tr_b16 v[206:207], v39 offset:512
    v_mfma_f32_16x16x32_bf16 v[124:127], v[212:215], v[48:51], v[124:127]
    ds_read_b64_tr_b16 v[208:209], v36 offset:4096
    ds_read_b64_tr_b16 v[210:211], v36 offset:4608
    v_mfma_f32_16x16x32_bf16 v[128:131], v[216:219], v[48:51], v[128:131]
    ds_read_b64_tr_b16 v[212:213], v37 offset:4096
    ds_read_b64_tr_b16 v[214:215], v37 offset:4608
    v_mfma_f32_16x16x32_bf16 v[132:135], v[220:223], v[48:51], v[132:135]
    ds_read_b64_tr_b16 v[216:217], v38 offset:4096
    ds_read_b64_tr_b16 v[218:219], v38 offset:4608
    buffer_load_dwordx4 v[48:51], v2, s[32:35], s20 offen offset:3072 sc1
    s_waitcnt vmcnt(7)
    s_waitcnt lgkmcnt(6)
    v_mfma_f32_16x16x32_bf16 v[120:123], v[192:195], v[224:227], v[120:123]
    ds_read_b64_tr_b16 v[220:221], v39 offset:4096
    ds_read_b64_tr_b16 v[222:223], v39 offset:4608
    v_mfma_f32_16x16x32_bf16 v[124:127], v[196:199], v[224:227], v[124:127]
    ds_read_b64_tr_b16 v[192:193], v36 offset:8192
    ds_read_b64_tr_b16 v[194:195], v36 offset:8704
    v_mfma_f32_16x16x32_bf16 v[128:131], v[200:203], v[224:227], v[128:131]
    ds_read_b64_tr_b16 v[196:197], v37 offset:8192
    ds_read_b64_tr_b16 v[198:199], v37 offset:8704
    v_mfma_f32_16x16x32_bf16 v[132:135], v[204:207], v[224:227], v[132:135]
    ds_read_b64_tr_b16 v[200:201], v38 offset:8192
    ds_read_b64_tr_b16 v[202:203], v38 offset:8704
    s_xor_b32 s96, s17, 24576
    s_add_u32 s20, s96, s19
    buffer_load_dwordx4 v[224:227], v2, s[32:35], s20 offen sc1
    s_waitcnt vmcnt(7)
    s_waitcnt lgkmcnt(6)
    v_mfma_f32_16x16x32_bf16 v[120:123], v[208:211], v[228:231], v[120:123]
    ds_read_b64_tr_b16 v[204:205], v39 offset:8192
    ds_read_b64_tr_b16 v[206:207], v39 offset:8704
    v_mfma_f32_16x16x32_bf16 v[124:127], v[212:215], v[228:231], v[124:127]
    ds_read_b64_tr_b16 v[208:209], v36 offset:12288
    ds_read_b64_tr_b16 v[210:211], v36 offset:12800
    v_xor_b32 v36, 16384, v36
    v_mfma_f32_16x16x32_bf16 v[128:131], v[216:219], v[228:231], v[128:131]
    ds_read_b64_tr_b16 v[212:213], v37 offset:12288
    ds_read_b64_tr_b16 v[214:215], v37 offset:12800
    v_xor_b32 v37, 16384, v37
    v_mfma_f32_16x16x32_bf16 v[132:135], v[220:223], v[228:231], v[132:135]
    ds_read_b64_tr_b16 v[216:217], v38 offset:12288
    ds_read_b64_tr_b16 v[218:219], v38 offset:12800
    v_xor_b32 v38, 16384, v38
    buffer_load_dwordx4 v[228:231], v2, s[32:35], s20 offen offset:1024 sc1
    s_waitcnt vmcnt(7)
    s_waitcnt lgkmcnt(6)
    v_mfma_f32_16x16x32_bf16 v[120:123], v[192:195], v[232:235], v[120:123]
    ds_read_b64_tr_b16 v[220:221], v39 offset:12288
    ds_read_b64_tr_b16 v[222:223], v39 offset:12800
    v_xor_b32 v39, 16384, v39
    v_mfma_f32_16x16x32_bf16 v[124:127], v[196:199], v[232:235], v[124:127]
    ds_read_b64_tr_b16 v[192:193], v36
    ds_read_b64_tr_b16 v[194:195], v36 offset:512
    v_mfma_f32_16x16x32_bf16 v[128:131], v[200:203], v[232:235], v[128:131]
    ds_read_b64_tr_b16 v[196:197], v37
    ds_read_b64_tr_b16 v[198:199], v37 offset:512
    v_mfma_f32_16x16x32_bf16 v[132:135], v[204:207], v[232:235], v[132:135]
    ds_read_b64_tr_b16 v[200:201], v38
    ds_read_b64_tr_b16 v[202:203], v38 offset:512
    buffer_load_dwordx4 v[232:235], v2, s[32:35], s20 offen offset:2048 sc1
    s_waitcnt vmcnt(7)
    s_waitcnt lgkmcnt(6)
    v_mfma_f32_16x16x32_bf16 v[120:123], v[208:211], v[236:239], v[120:123]
    ds_read_b64_tr_b16 v[204:205], v39
    ds_read_b64_tr_b16 v[206:207], v39 offset:512
    v_mfma_f32_16x16x32_bf16 v[124:127], v[212:215], v[236:239], v[124:127]
    ds_read_b64_tr_b16 v[208:209], v36 offset:4096
    ds_read_b64_tr_b16 v[210:211], v36 offset:4608
    v_mfma_f32_16x16x32_bf16 v[128:131], v[216:219], v[236:239], v[128:131]
    ds_read_b64_tr_b16 v[212:213], v37 offset:4096
    ds_read_b64_tr_b16 v[214:215], v37 offset:4608
    v_mfma_f32_16x16x32_bf16 v[132:135], v[220:223], v[236:239], v[132:135]
    ds_read_b64_tr_b16 v[216:217], v38 offset:4096
    ds_read_b64_tr_b16 v[218:219], v38 offset:4608
    buffer_load_dwordx4 v[236:239], v2, s[32:35], s20 offen offset:3072 sc1
    s_waitcnt vmcnt(7)
    s_waitcnt lgkmcnt(6)
    v_mfma_f32_16x16x32_bf16 v[120:123], v[192:195], v[240:243], v[120:123]
    ds_read_b64_tr_b16 v[220:221], v39 offset:4096
    ds_read_b64_tr_b16 v[222:223], v39 offset:4608
    v_mfma_f32_16x16x32_bf16 v[124:127], v[196:199], v[240:243], v[124:127]
    ds_read_b64_tr_b16 v[192:193], v36 offset:8192
    ds_read_b64_tr_b16 v[194:195], v36 offset:8704
    v_mfma_f32_16x16x32_bf16 v[128:131], v[200:203], v[240:243], v[128:131]
    ds_read_b64_tr_b16 v[196:197], v37 offset:8192
    ds_read_b64_tr_b16 v[198:199], v37 offset:8704
    v_mfma_f32_16x16x32_bf16 v[132:135], v[204:207], v[240:243], v[132:135]
    ds_read_b64_tr_b16 v[200:201], v38 offset:8192
    ds_read_b64_tr_b16 v[202:203], v38 offset:8704
    s_xor_b32 s96, s17, 28672
    s_add_u32 s20, s96, s19
    buffer_load_dwordx4 v[240:243], v2, s[32:35], s20 offen sc1
    s_waitcnt vmcnt(7)
    s_waitcnt lgkmcnt(6)
    v_mfma_f32_16x16x32_bf16 v[120:123], v[208:211], v[244:247], v[120:123]
    ds_read_b64_tr_b16 v[204:205], v39 offset:8192
    ds_read_b64_tr_b16 v[206:207], v39 offset:8704
    v_mfma_f32_16x16x32_bf16 v[124:127], v[212:215], v[244:247], v[124:127]
    ds_read_b64_tr_b16 v[208:209], v36 offset:12288
    ds_read_b64_tr_b16 v[210:211], v36 offset:12800
    v_xor_b32 v36, 49152, v36
    v_mfma_f32_16x16x32_bf16 v[128:131], v[216:219], v[244:247], v[128:131]
    ds_read_b64_tr_b16 v[212:213], v37 offset:12288
    ds_read_b64_tr_b16 v[214:215], v37 offset:12800
    v_xor_b32 v37, 49152, v37
    v_mfma_f32_16x16x32_bf16 v[132:135], v[220:223], v[244:247], v[132:135]
    ds_read_b64_tr_b16 v[216:217], v38 offset:12288
    ds_read_b64_tr_b16 v[218:219], v38 offset:12800
    v_xor_b32 v38, 49152, v38
    buffer_load_dwordx4 v[244:247], v2, s[32:35], s20 offen offset:1024 sc1
    s_cmp_lt_u32 s3, 4
    s_cbranch_scc1 L_G2P22
    s_setprio 0
L_G2P22:
    s_waitcnt vmcnt(7)
    s_waitcnt lgkmcnt(6)
    v_mfma_f32_16x16x32_bf16 v[120:123], v[192:195], v[44:47], v[120:123]
    ds_read_b64_tr_b16 v[220:221], v39 offset:12288
    ds_read_b64_tr_b16 v[222:223], v39 offset:12800
    v_xor_b32 v39, 49152, v39
    v_mfma_f32_16x16x32_bf16 v[124:127], v[196:199], v[44:47], v[124:127]
    ds_read_b64_tr_b16 v[192:193], v36
    ds_read_b64_tr_b16 v[194:195], v36 offset:512
    v_mfma_f32_16x16x32_bf16 v[128:131], v[200:203], v[44:47], v[128:131]
    ds_read_b64_tr_b16 v[196:197], v37
    ds_read_b64_tr_b16 v[198:199], v37 offset:512
    v_mfma_f32_16x16x32_bf16 v[132:135], v[204:207], v[44:47], v[132:135]
    ds_read_b64_tr_b16 v[200:201], v38
    ds_read_b64_tr_b16 v[202:203], v38 offset:512
    buffer_load_dwordx4 v[44:47], v2, s[32:35], s20 offen offset:2048 sc1
    s_waitcnt vmcnt(7)
    s_waitcnt lgkmcnt(6)
    v_mfma_f32_16x16x32_bf16 v[120:123], v[208:211], v[48:51], v[120:123]
    ds_read_b64_tr_b16 v[204:205], v39
    ds_read_b64_tr_b16 v[206:207], v39 offset:512
    v_mfma_f32_16x16x32_bf16 v[124:127], v[212:215], v[48:51], v[124:127]
    ds_read_b64_tr_b16 v[208:209], v36 offset:4096
    ds_read_b64_tr_b16 v[210:211], v36 offset:4608
    v_mfma_f32_16x16x32_bf16 v[128:131], v[216:219], v[48:51], v[128:131]
    ds_read_b64_tr_b16 v[212:213], v37 offset:4096
    ds_read_b64_tr_b16 v[214:215], v37 offset:4608
    v_mfma_f32_16x16x32_bf16 v[132:135], v[220:223], v[48:51], v[132:135]
    ds_read_b64_tr_b16 v[216:217], v38 offset:4096
    ds_read_b64_tr_b16 v[218:219], v38 offset:4608
    buffer_load_dwordx4 v[48:51], v2, s[32:35], s20 offen offset:3072 sc1
    buffer_load_dwordx2 v[40:41], v10, s[32:35], s13 offen sc1
    s_waitcnt vmcnt(8)
    s_waitcnt lgkmcnt(6)
    v_mfma_f32_16x16x32_bf16 v[120:123], v[192:195], v[224:227], v[120:123]
    ds_read_b64_tr_b16 v[220:221], v39 offset:4096
    ds_read_b64_tr_b16 v[222:223], v39 offset:4608
    v_mfma_f32_16x16x32_bf16 v[124:127], v[196:199], v[224:227], v[124:127]
    ds_read_b64_tr_b16 v[192:193], v36 offset:8192
    ds_read_b64_tr_b16 v[194:195], v36 offset:8704
    v_mfma_f32_16x16x32_bf16 v[128:131], v[200:203], v[224:227], v[128:131]
    ds_read_b64_tr_b16 v[196:197], v37 offset:8192
    ds_read_b64_tr_b16 v[198:199], v37 offset:8704
    v_mfma_f32_16x16x32_bf16 v[132:135], v[204:207], v[224:227], v[132:135]
    ds_read_b64_tr_b16 v[200:201], v38 offset:8192
    ds_read_b64_tr_b16 v[202:203], v38 offset:8704
    s_waitcnt vmcnt(7)
    s_waitcnt lgkmcnt(6)
    v_mfma_f32_16x16x32_bf16 v[120:123], v[208:211], v[228:231], v[120:123]
    ds_read_b64_tr_b16 v[204:205], v39 offset:8192
    ds_read_b64_tr_b16 v[206:207], v39 offset:8704
    v_mfma_f32_16x16x32_bf16 v[124:127], v[212:215], v[228:231], v[124:127]
    ds_read_b64_tr_b16 v[208:209], v36 offset:12288
    ds_read_b64_tr_b16 v[210:211], v36 offset:12800
    v_xor_b32 v36, 16384, v36
    v_mfma_f32_16x16x32_bf16 v[128:131], v[216:219], v[228:231], v[128:131]
    ds_read_b64_tr_b16 v[212:213], v37 offset:12288
    ds_read_b64_tr_b16 v[214:215], v37 offset:12800
    v_xor_b32 v37, 16384, v37
    v_mfma_f32_16x16x32_bf16 v[132:135], v[220:223], v[228:231], v[132:135]
    ds_read_b64_tr_b16 v[216:217], v38 offset:12288
    ds_read_b64_tr_b16 v[218:219], v38 offset:12800
    v_xor_b32 v38, 16384, v38
    s_waitcnt vmcnt(6)
    s_waitcnt lgkmcnt(6)
    v_mfma_f32_16x16x32_bf16 v[120:123], v[192:195], v[232:235], v[120:123]
    ds_read_b64_tr_b16 v[220:221], v39 offset:12288
    ds_read_b64_tr_b16 v[222:223], v39 offset:12800
    v_xor_b32 v39, 16384, v39
    v_mfma_f32_16x16x32_bf16 v[124:127], v[196:199], v[232:235], v[124:127]
    ds_read_b64_tr_b16 v[192:193], v36
    ds_read_b64_tr_b16 v[194:195], v36 offset:512
    v_mfma_f32_16x16x32_bf16 v[128:131], v[200:203], v[232:235], v[128:131]
    ds_read_b64_tr_b16 v[196:197], v37
    ds_read_b64_tr_b16 v[198:199], v37 offset:512
    v_mfma_f32_16x16x32_bf16 v[132:135], v[204:207], v[232:235], v[132:135]
    ds_read_b64_tr_b16 v[200:201], v38
    ds_read_b64_tr_b16 v[202:203], v38 offset:512
    s_waitcnt vmcnt(5)
    s_waitcnt lgkmcnt(6)
    v_mfma_f32_16x16x32_bf16 v[120:123], v[208:211], v[236:239], v[120:123]
    ds_read_b64_tr_b16 v[204:205], v39
    ds_read_b64_tr_b16 v[206:207], v39 offset:512
    v_mfma_f32_16x16x32_bf16 v[124:127], v[212:215], v[236:239], v[124:127]
    ds_read_b64_tr_b16 v[208:209], v36 offset:4096
    ds_read_b64_tr_b16 v[210:211], v36 offset:4608
    v_mfma_f32_16x16x32_bf16 v[128:131], v[216:219], v[236:239], v[128:131]
    ds_read_b64_tr_b16 v[212:213], v37 offset:4096
    ds_read_b64_tr_b16 v[214:215], v37 offset:4608
    v_mfma_f32_16x16x32_bf16 v[132:135], v[220:223], v[236:239], v[132:135]
    ds_read_b64_tr_b16 v[216:217], v38 offset:4096
    ds_read_b64_tr_b16 v[218:219], v38 offset:4608
    s_add_u32 s82, s80, 114688
    buffer_load_dwordx4 v[72:75], v27, s[52:55], s82 offen nt
    s_add_u32 s82, s80, 172032
    buffer_load_dwordx4 v[76:79], v27, s[52:55], s82 offen nt
    s_mov_b32 s82, s80
    buffer_load_dwordx4 v[80:83], v27, s[56:59], s82 offen nt
    s_waitcnt vmcnt(7)
    s_waitcnt lgkmcnt(6)
    v_mfma_f32_16x16x32_bf16 v[120:123], v[192:195], v[240:243], v[120:123]
    ds_read_b64_tr_b16 v[220:221], v39 offset:4096
    ds_read_b64_tr_b16 v[222:223], v39 offset:4608
    v_mfma_f32_16x16x32_bf16 v[124:127], v[196:199], v[240:243], v[124:127]
    ds_read_b64_tr_b16 v[192:193], v36 offset:8192
    ds_read_b64_tr_b16 v[194:195], v36 offset:8704
    v_mfma_f32_16x16x32_bf16 v[128:131], v[200:203], v[240:243], v[128:131]
    ds_read_b64_tr_b16 v[196:197], v37 offset:8192
    ds_read_b64_tr_b16 v[198:199], v37 offset:8704
    v_mfma_f32_16x16x32_bf16 v[132:135], v[204:207], v[240:243], v[132:135]
    ds_read_b64_tr_b16 v[200:201], v38 offset:8192
    ds_read_b64_tr_b16 v[202:203], v38 offset:8704
    s_waitcnt vmcnt(6)
    s_waitcnt lgkmcnt(6)
    v_mfma_f32_16x16x32_bf16 v[120:123], v[208:211], v[244:247], v[120:123]
    ds_read_b64_tr_b16 v[204:205], v39 offset:8192
    ds_read_b64_tr_b16 v[206:207], v39 offset:8704
    v_mfma_f32_16x16x32_bf16 v[124:127], v[212:215], v[244:247], v[124:127]
    ds_read_b64_tr_b16 v[208:209], v36 offset:12288
    ds_read_b64_tr_b16 v[210:211], v36 offset:12800
    v_mfma_f32_16x16x32_bf16 v[128:131], v[216:219], v[244:247], v[128:131]
    ds_read_b64_tr_b16 v[212:213], v37 offset:12288
    ds_read_b64_tr_b16 v[214:215], v37 offset:12800
    v_mfma_f32_16x16x32_bf16 v[132:135], v[220:223], v[244:247], v[132:135]
    ds_read_b64_tr_b16 v[216:217], v38 offset:12288
    ds_read_b64_tr_b16 v[218:219], v38 offset:12800
    s_waitcnt vmcnt(5)
    s_waitcnt lgkmcnt(6)
    v_mfma_f32_16x16x32_bf16 v[120:123], v[192:195], v[44:47], v[120:123]
    ds_read_b64_tr_b16 v[220:221], v39 offset:12288
    ds_read_b64_tr_b16 v[222:223], v39 offset:12800
    v_mfma_f32_16x16x32_bf16 v[124:127], v[196:199], v[44:47], v[124:127]
    v_mfma_f32_16x16x32_bf16 v[128:131], v[200:203], v[44:47], v[128:131]
    v_mfma_f32_16x16x32_bf16 v[132:135], v[204:207], v[44:47], v[132:135]
    s_waitcnt vmcnt(4)
    s_waitcnt lgkmcnt(0)
    v_mfma_f32_16x16x32_bf16 v[120:123], v[208:211], v[48:51], v[120:123]
    v_mfma_f32_16x16x32_bf16 v[124:127], v[212:215], v[48:51], v[124:127]
    v_mfma_f32_16x16x32_bf16 v[128:131], v[216:219], v[48:51], v[128:131]
    v_mfma_f32_16x16x32_bf16 v[132:135], v[220:223], v[48:51], v[132:135]
    s_nop 4
    v_cvt_pk_bf16_f32 v120, 0, v120
    v_cvt_pk_bf16_f32 v121, 0, v121
    v_cvt_pk_bf16_f32 v122, 0, v122
    v_cvt_pk_bf16_f32 v123, 0, v123
    v_cvt_pk_bf16_f32 v124, 0, v124
    v_cvt_pk_bf16_f32 v125, 0, v125
    v_cvt_pk_bf16_f32 v126, 0, v126
    v_cvt_pk_bf16_f32 v127, 0, v127
    v_pk_mul_f32 v[120:121], v[120:121], v[136:137]
    v_pk_mul_f32 v[122:123], v[122:123], v[138:139]
    v_pk_mul_f32 v[124:125], v[124:125], v[140:141]
    v_pk_mul_f32 v[126:127], v[126:127], v[142:143]
    v_cvt_pk_bf16_f32 v120, 0, v120
    v_cvt_pk_bf16_f32 v121, 0, v121
    v_cvt_pk_bf16_f32 v122, 0, v122
    v_cvt_pk_bf16_f32 v123, 0, v123
    v_cvt_pk_bf16_f32 v124, 0, v124
    v_cvt_pk_bf16_f32 v125, 0, v125
    v_cvt_pk_bf16_f32 v126, 0, v126
    v_cvt_pk_bf16_f32 v127, 0, v127
    v_pk_add_f32 v[120:121], v[120:121], v[152:153]
    v_pk_add_f32 v[122:123], v[122:123], v[154:155]
    v_pk_add_f32 v[124:125], v[124:125], v[156:157]
    v_pk_add_f32 v[126:127], v[126:127], v[158:159]
    v_cvt_pk_bf16_f32 v12, v120, v121
    v_cvt_pk_bf16_f32 v13, v122, v123
    v_cvt_pk_bf16_f32 v14, v124, v125
    v_cvt_pk_bf16_f32 v15, v126, v127
    v_dot2_f32_bf16 v4, v12, v12, 0
    v_dot2_f32_bf16 v5, v13, v13, 0
    v_dot2_f32_bf16 v4, v14, v14, v4
    v_dot2_f32_bf16 v5, v15, v15, v5
    v_mfma_f32_16x16x32_bf16 v[240:243], v[184:187], v[12:15], 0
    v_cvt_pk_bf16_f32 v128, 0, v128
    v_cvt_pk_bf16_f32 v129, 0, v129
    v_cvt_pk_bf16_f32 v130, 0, v130
    v_cvt_pk_bf16_f32 v131, 0, v131
    v_cvt_pk_bf16_f32 v132, 0, v132
    v_cvt_pk_bf16_f32 v133, 0, v133
    v_cvt_pk_bf16_f32 v134, 0, v134
    v_cvt_pk_bf16_f32 v135, 0, v135
    v_pk_mul_f32 v[128:129], v[128:129], v[144:145]
    v_pk_mul_f32 v[130:131], v[130:131], v[146:147]
    v_pk_mul_f32 v[132:133], v[132:133], v[148:149]
    v_pk_mul_f32 v[134:135], v[134:135], v[150:151]
    v_cvt_pk_bf16_f32 v128, 0, v128
    v_cvt_pk_bf16_f32 v129, 0, v129
    v_cvt_pk_bf16_f32 v130, 0, v130
    v_cvt_pk_bf16_f32 v131, 0, v131
    v_cvt_pk_bf16_f32 v132, 0, v132
    v_cvt_pk_bf16_f32 v133, 0, v133
    v_cvt_pk_bf16_f32 v134, 0, v134
    v_cvt_pk_bf16_f32 v135, 0, v135
    v_pk_add_f32 v[128:129], v[128:129], v[160:161]
    v_pk_add_f32 v[130:131], v[130:131], v[162:163]
    v_pk_add_f32 v[132:133], v[132:133], v[164:165]
    v_pk_add_f32 v[134:135], v[134:135], v[166:167]
    v_cvt_pk_bf16_f32 v16, v128, v129
    v_cvt_pk_bf16_f32 v17, v130, v131
    v_cvt_pk_bf16_f32 v18, v132, v133
    v_cvt_pk_bf16_f32 v19, v134, v135
    v_dot2_f32_bf16 v4, v16, v16, v4
    v_dot2_f32_bf16 v5, v17, v17, v5
    v_dot2_f32_bf16 v4, v18, v18, v4
    v_dot2_f32_bf16 v5, v19, v19, v5
    v_mfma_f32_16x16x32_bf16 v[240:243], v[188:191], v[16:19], v[240:243]
    s_nop 1
    v_add_f32 v4, v4, v5
    v_mov_b32 v5, v4
    s_nop 1
    v_permlane32_swap_b32 v4, v5
    v_add_f32 v4, v4, v5
    v_mov_b32 v5, v4
    s_nop 1
    v_permlane16_swap_b32 v4, v5
    v_add_f32 v243, v4, v5
    s_mov_b64 exec, 0xffff
    buffer_store_dwordx4 v[240:243], v2, s[32:35], s86 offen sc1
    s_mov_b64 exec, -1
    s_barrier
    s_cmp_lg_u32 s3, 0
    s_cbranch_scc1 L_PE
    v_mov_b32 v6, s4
    s_mov_b32 exec_hi, 0
    s_mov_b32 exec_lo, 65535
    buffer_store_dword v6, v29, s[32:35], s87 offen sc1
    s_mov_b64 exec, -1
L_PE:
    s_add_u32 s82, s80, 57344
    s_lshl2_add_u32 m0, s83, 33792
    s_nop 0
    buffer_load_dwordx4 v27, s[56:59], s82 offen nt lds
    s_add_u32 s82, s80, 114688
    s_lshl2_add_u32 m0, s83, 34816
    s_nop 0
    buffer_load_dwordx4 v27, s[56:59], s82 offen nt lds
    s_lshl_b32 s15, s3, 12
    v_add_u32 v4, s15, v2
    v_add_u32 v7, 65536, v4
    s_waitcnt vmcnt(6)
    v_cmp_ne_u32 vcc, s4, v41
    s_cbranch_vccz L_UPOK
POLL_34:
    buffer_load_dwordx2 v[40:41], v10, s[32:35], s13 offen sc1
    s_waitcnt vmcnt(0)
    v_cmp_ne_u32 vcc, s4, v41
    s_cbranch_vccz PDONE_35
    s_add_u32 s5, s5, 1
    s_cmp_lt_u32 s5, 200000
    s_cbranch_scc1 POLL_34
PDONE_35:
L_UPOK:
    s_lshl3_add_u32 s96, s21, s3
    s_lshl_b32 s97, s96, 12
    s_add_u32 s14, s97, 12582912
    s_load_dwordx2 s[24:25], s[32:33], s92 offset:1536 glc
    v_add_f32_dpp v40, v40, v40 quad_perm:[1,0,3,2] row_mask:0xf bank_mask:0xf
    s_nop 1
    v_add_f32_dpp v40, v40, v40 quad_perm:[2,3,0,1] row_mask:0xf bank_mask:0xf
    s_nop 1
    v_add_f32_dpp v40, v40, v40 row_half_mirror row_mask:0xf bank_mask:0xf
    s_nop 1
    v_add_f32_dpp v40, v40, v40 row_mirror row_mask:0xf bank_mask:0xf
    v_lshlrev_b32 v152, 16, v12
    v_and_b32 v153, s6, v12
    v_lshlrev_b32 v154, 16, v13
    v_and_b32 v155, s6, v13
    v_lshlrev_b32 v156, 16, v14
    v_and_b32 v157, s6, v14
    v_lshlrev_b32 v158, 16, v15
    v_and_b32 v159, s6, v15
    v_lshlrev_b32 v160, 16, v16
    v_and_b32 v161, s6, v16
    v_lshlrev_b32 v162, 16, v17
    v_and_b32 v163, s6, v17
    v_lshlrev_b32 v164, 16, v18
    v_and_b32 v165, s6, v18
    v_lshlrev_b32 v166, 16, v19
    v_and_b32 v167, s6, v19
    s_lshl_b32 s96, s3, 9
    s_lshl1_add_u32 s15, s21, s96
    v_and_b32 v29, 15, v1
    v_lshl_add_u32 v29, v29, 5, s15
    v_xor_b32 v5, 0x4000, v4
    v_xor_b32 v8, 0x4000, v7
    s_waitcnt vmcnt(3)
    ds_write_b128 v4, v[72:75] offset:2048
    ds_write_b128 v4, v[76:79] offset:3072
    ds_write_b128 v4, v[80:83] offset:32768
    s_cmp_lt_u32 s3, 4
    s_cbranch_scc1 L_FW1
    ds_write_b128 v4, v[56:59] offset:0
    ds_write_b128 v5, v[60:63] offset:0
    ds_write_b128 v4, v[64:67] offset:1024
    ds_write_b128 v5, v[68:71] offset:1024
L_FW1:
    s_branch SCHK_37
SPOLL_36:
    s_load_dwordx2 s[24:25], s[32:33], s92 offset:1536 glc
SCHK_37:
    s_add_u32 s5, s5, 1
    s_cmp_ge_u32 s5, 200000
    s_waitcnt lgkmcnt(0)
    s_cbranch_scc1 SDONE_38
    s_cmp_lg_u32 s24, s4
    s_cbranch_scc1 SPOLL_36
    s_cmp_lg_u32 s25, s4
    s_cbranch_scc1 SPOLL_36
SDONE_38:
    s_barrier
    buffer_load_dwordx4 v[192:195], v2, s[32:35], s14 offen sc1
    buffer_load_dwordx4 v[196:199], v2, s[32:35], s14 offen offset:1024 sc1
    buffer_load_dwordx4 v[200:203], v2, s[32:35], s14 offen offset:2048 sc1
    buffer_load_dwordx4 v[204:207], v2, s[32:35], s14 offen offset:3072 sc1
    s_barrier
    s_add_u32 s82, s80, 172032
    s_lshl2_add_u32 m0, s83, 35840
    s_nop 0
    buffer_load_dwordx4 v27, s[56:59], s82 offen nt lds
    s_mov_b32 s82, s81
    s_lshl2_add_u32 m0, s83, 65536
    s_nop 0
    buffer_load_dwordx4 v253, s[60:63], s82 offen nt lds
    s_add_u32 s82, s81, 4096
    s_lshl2_add_u32 m0, s83, 66560
    s_nop 0
    buffer_load_dwordx4 v253, s[60:63], s82 offen nt lds
    v_mov_b32_dpp v168, v33 row_newbcast:0 row_mask:0xf bank_mask:0xf
    v_mov_b32_dpp v169, v33 row_newbcast:1 row_mask:0xf bank_mask:0xf
    v_mov_b32_dpp v170, v33 row_newbcast:2 row_mask:0xf bank_mask:0xf
    v_mov_b32_dpp v171, v33 row_newbcast:3 row_mask:0xf bank_mask:0xf
    v_mov_b32_dpp v172, v33 row_newbcast:4 row_mask:0xf bank_mask:0xf
    v_mov_b32_dpp v173, v33 row_newbcast:5 row_mask:0xf bank_mask:0xf
    v_mov_b32_dpp v174, v33 row_newbcast:6 row_mask:0xf bank_mask:0xf
    v_mov_b32_dpp v175, v33 row_newbcast:7 row_mask:0xf bank_mask:0xf
    v_mov_b32_dpp v176, v33 row_newbcast:8 row_mask:0xf bank_mask:0xf
    v_mov_b32_dpp v177, v33 row_newbcast:9 row_mask:0xf bank_mask:0xf
    v_mov_b32_dpp v178, v33 row_newbcast:10 row_mask:0xf bank_mask:0xf
    v_mov_b32_dpp v179, v33 row_newbcast:11 row_mask:0xf bank_mask:0xf
    v_mov_b32_dpp v180, v33 row_newbcast:12 row_mask:0xf bank_mask:0xf
    v_mov_b32_dpp v181, v33 row_newbcast:13 row_mask:0xf bank_mask:0xf
    v_mov_b32_dpp v182, v33 row_newbcast:14 row_mask:0xf bank_mask:0xf
    v_mov_b32_dpp v183, v33 row_newbcast:15 row_mask:0xf bank_mask:0xf
    v_mov_b32_dpp v88, v42 row_newbcast:0 row_mask:0xf bank_mask:0xf
    v_mov_b32_dpp v89, v42 row_newbcast:1 row_mask:0xf bank_mask:0xf
    v_mov_b32_dpp v90, v42 row_newbcast:2 row_mask:0xf bank_mask:0xf
    v_mov_b32_dpp v91, v42 row_newbcast:3 row_mask:0xf bank_mask:0xf
    v_mov_b32_dpp v92, v42 row_newbcast:4 row_mask:0xf bank_mask:0xf
    v_mov_b32_dpp v93, v42 row_newbcast:5 row_mask:0xf bank_mask:0xf
    v_mov_b32_dpp v94, v42 row_newbcast:6 row_mask:0xf bank_mask:0xf
    v_mov_b32_dpp v95, v42 row_newbcast:7 row_mask:0xf bank_mask:0xf
    v_mov_b32_dpp v96, v42 row_newbcast:8 row_mask:0xf bank_mask:0xf
    v_mov_b32_dpp v97, v42 row_newbcast:9 row_mask:0xf bank_mask:0xf
L_PAD9:
    s_cbranch_execz L_RET9
    v_mov_b32_dpp v98, v42 row_newbcast:10 row_mask:0xf bank_mask:0xf
    v_mov_b32_dpp v99, v42 row_newbcast:11 row_mask:0xf bank_mask:0xf
    v_mov_b32_dpp v100, v42 row_newbcast:12 row_mask:0xf bank_mask:0xf
    v_mov_b32_dpp v101, v42 row_newbcast:13 row_mask:0xf bank_mask:0xf
    v_mov_b32_dpp v102, v42 row_newbcast:14 row_mask:0xf bank_mask:0xf
    v_mov_b32_dpp v103, v42 row_newbcast:15 row_mask:0xf bank_mask:0xf
    v_mov_b32_dpp v104, v43 row_newbcast:0 row_mask:0xf bank_mask:0xf
    v_mov_b32_dpp v105, v43 row_newbcast:1 row_mask:0xf bank_mask:0xf
    v_mov_b32_dpp v106, v43 row_newbcast:2 row_mask:0xf bank_mask:0xf
    v_mov_b32_dpp v107, v43 row_newbcast:3 row_mask:0xf bank_mask:0xf
    v_mov_b32_dpp v108, v43 row_newbcast:4 row_mask:0xf bank_mask:0xf
    v_mov_b32_dpp v109, v43 row_newbcast:5 row_mask:0xf bank_mask:0xf
    v_mov_b32_dpp v110, v43 row_newbcast:6 row_mask:0xf bank_mask:0xf
    v_mov_b32_dpp v111, v43 row_newbcast:7 row_mask:0xf bank_mask:0xf
    v_mov_b32_dpp v112, v43 row_newbcast:8 row_mask:0xf bank_mask:0xf
    v_mov_b32_dpp v113, v43 row_newbcast:9 row_mask:0xf bank_mask:0xf
    v_mov_b32_dpp v114, v43 row_newbcast:10 row_mask:0xf bank_mask:0xf
    v_mov_b32_dpp v115, v43 row_newbcast:11 row_mask:0xf bank_mask:0xf
    v_mov_b32_dpp v116, v43 row_newbcast:12 row_mask:0xf bank_mask:0xf
    v_mov_b32_dpp v117, v43 row_newbcast:13 row_mask:0xf bank_mask:0xf
    v_mov_b32_dpp v118, v43 row_newbcast:14 row_mask:0xf bank_mask:0xf
    v_mov_b32_dpp v119, v43 row_newbcast:15 row_mask:0xf bank_mask:0xf
    s_lshl3_add_u32 s15, s3, 156160
    v_mov_b32 v4, s15
    v_and_b32 v5, 7, v1
    v_lshlrev_b32 v5, 3, v5
    v_add_u32 v5, 156160, v5
    v_and_b32 v6, 3, v1
    v_lshlrev_b32 v6, 18, v6
    v_bfe_u32 v9, v1, 2, 2
    v_lshl_add_u32 v6, v9, 13, v6
    s_and_b32 s96, s21, 1
    s_and_b32 s97, s12, 7
    s_lshr_b32 s98, s12, 3
    s_lshl3_add_u32 s99, s97, s98
    s_lshl_b32 s97, s99, 12
    s_lshr_b32 s98, s21, 1
    s_lshl_b32 s99, s98, 6
    s_add_u32 s98, s97, s99
    s_lshl4_add_u32 s97, s96, s98
    s_add_u32 s99, s97, 1048576
    s_add_u32 s16, s99, 2560
    s_waitcnt vmcnt(3)
    v_pk_add_f32 v[192:193], v[192:193], v[196:197]
    v_pk_add_f32 v[200:201], v[200:201], v[204:205]
    v_pk_add_f32 v[194:195], v[194:195], v[198:199]
    v_pk_add_f32 v[202:203], v[202:203], v[206:207]
    v_pk_add_f32 v[192:193], v[192:193], v[200:201]
    v_pk_add_f32 v[194:195], v[194:195], v[202:203]
    v_add_f32 v193, v193, v194
    v_add_f32 v197, v192, v195
    v_cmp_u_f32 vcc, v193, v197
    s_cbranch_vccz POK_40
PRE_41:
    buffer_load_dwordx4 v[192:195], v2, s[32:35], s14 offen sc1
    buffer_load_dwordx4 v[196:199], v2, s[32:35], s14 offen offset:1024 sc1
    buffer_load_dwordx4 v[200:203], v2, s[32:35], s14 offen offset:2048 sc1
    buffer_load_dwordx4 v[204:207], v2, s[32:35], s14 offen offset:3072 sc1
    s_waitcnt vmcnt(0)
    v_pk_add_f32 v[192:193], v[192:193], v[196:197]
    v_pk_add_f32 v[200:201], v[200:201], v[204:205]
    v_pk_add_f32 v[194:195], v[194:195], v[198:199]
    v_pk_add_f32 v[202:203], v[202:203], v[206:207]
    v_pk_add_f32 v[192:193], v[192:193], v[200:201]
    v_pk_add_f32 v[194:195], v[194:195], v[202:203]
    v_add_f32 v193, v193, v194
    v_add_f32 v197, v192, v195
    v_cmp_u_f32 vcc, v193, v197
    s_cbranch_vccz POK_40
    s_add_u32 s5, s5, 1
    s_cmp_lt_u32 s5, 200000
    s_cbranch_scc1 PRE_41
POK_40:
    v_mov_b32 v196, v195
    s_nop 1
    v_permlane32_swap_b32 v195, v196
    v_permlane32_swap_b32 v192, v193
    v_add_f32 v195, v195, v196
    v_add_f32 v192, v192, v193
    s_nop 1
    v_permlane16_swap_b32 v192, v195
    v_add_f32 v193, v192, v195
    v_add_f32 v195, v192, v195
    s_nop 1
    v_permlane16_swap_b32 v193, v195
    v_mov_b32 v192, v193
    v_mul_f32 v195, 0x3a800000, v195
    s_nop 0
    v_permlane32_swap_b32 v192, v193
    v_mul_f32 v192, 0x3a800000, v192
    v_fma_f32 v31, -v192, v192, v195
    v_cvt_pk_bf16_f32 v30, 0, v192
    v_max_f32 v31, 0, v31
    v_cvt_pk_bf16_f32 v31, 0, v31
    v_fma_f32 v193, -v30, v40, v193
    v_add_f32 v31, 0x3727c5ac, v31
    v_cvt_pk_bf16_f32 v31, 0, v31
    v_sqrt_f32 v31, v31
    s_nop 0
    v_cvt_pk_bf16_f32 v31, 0, v31
    v_rcp_f32 v31, v31
    s_nop 0
    v_mul_f32 v32, v193, v31
    v_ashrrev_i32 v196, 31, v32
    v_or_b32 v196, 0x80000000, v196
    v_xor_b32 v32, v32, v196
    s_mov_b32 s15, 0xfffff000
    v_and_or_b32 v32, v32, s15, v29
    s_nop 1
    v_max_u32_dpp v244, v32, v32 quad_perm:[1,0,3,2] row_mask:0xf bank_mask:0xf
    v_min_u32_dpp v245, v32, v32 quad_perm:[1,0,3,2] row_mask:0xf bank_mask:0xf
    s_nop 0
    v_min_u32_dpp v196, v244, v244 quad_perm:[2,3,0,1] row_mask:0xf bank_mask:0xf
    v_max_u32_dpp v245, v245, v245 quad_perm:[2,3,0,1] row_mask:0xf bank_mask:0xf
    v_max_u32_dpp v244, v244, v244 quad_perm:[2,3,0,1] row_mask:0xf bank_mask:0xf
    v_max_u32 v245, v245, v196
    s_nop 0
    v_min_u32_dpp v196, v244, v244 row_half_mirror row_mask:0xf bank_mask:0xf
    v_max_u32_dpp v245, v245, v245 row_half_mirror row_mask:0xf bank_mask:0xf
    v_max_u32_dpp v244, v244, v244 row_half_mirror row_mask:0xf bank_mask:0xf
    v_max_u32 v245, v245, v196
    s_nop 0
    v_min_u32_dpp v196, v244, v244 row_mirror row_mask:0xf bank_mask:0xf
    v_max_u32_dpp v245, v245, v245 row_mirror row_mask:0xf bank_mask:0xf
    v_max_u32_dpp v244, v244, v244 row_mirror row_mask:0xf bank_mask:0xf
    v_max_u32 v245, v245, v196
    ds_write_b64 v4, v[244:245]
    s_waitcnt lgkmcnt(0)
    s_barrier
    ds_read_b64 v[244:245], v5
    v_pk_add_f32 v[208:209], v[152:153], v[30:31] op_sel_hi:[1,0] neg_lo:[0,1] neg_hi:[0,1]
    v_pk_add_f32 v[210:211], v[154:155], v[30:31] op_sel_hi:[1,0] neg_lo:[0,1] neg_hi:[0,1]
    v_pk_add_f32 v[212:213], v[156:157], v[30:31] op_sel_hi:[1,0] neg_lo:[0,1] neg_hi:[0,1]
    v_pk_add_f32 v[214:215], v[158:159], v[30:31] op_sel_hi:[1,0] neg_lo:[0,1] neg_hi:[0,1]
    v_pk_add_f32 v[216:217], v[160:161], v[30:31] op_sel_hi:[1,0] neg_lo:[0,1] neg_hi:[0,1]
    v_pk_add_f32 v[218:219], v[162:163], v[30:31] op_sel_hi:[1,0] neg_lo:[0,1] neg_hi:[0,1]
    v_pk_add_f32 v[220:221], v[164:165], v[30:31] op_sel_hi:[1,0] neg_lo:[0,1] neg_hi:[0,1]
    v_pk_add_f32 v[222:223], v[166:167], v[30:31] op_sel_hi:[1,0] neg_lo:[0,1] neg_hi:[0,1]
    s_waitcnt lgkmcnt(0)
    v_min_u32_dpp v196, v244, v244 quad_perm:[1,0,3,2] row_mask:0xf bank_mask:0xf
    v_max_u32_dpp v245, v245, v245 quad_perm:[1,0,3,2] row_mask:0xf bank_mask:0xf
    v_max_u32_dpp v244, v244, v244 quad_perm:[1,0,3,2] row_mask:0xf bank_mask:0xf
    v_max_u32 v245, v245, v196
    s_nop 0
    v_min_u32_dpp v196, v244, v244 quad_perm:[2,3,0,1] row_mask:0xf bank_mask:0xf
    v_max_u32_dpp v245, v245, v245 quad_perm:[2,3,0,1] row_mask:0xf bank_mask:0xf
    v_max_u32_dpp v244, v244, v244 quad_perm:[2,3,0,1] row_mask:0xf bank_mask:0xf
    v_max_u32 v245, v245, v196
    s_nop 0
    v_min_u32_dpp v196, v244, v244 row_half_mirror row_mask:0xf bank_mask:0xf
    v_max_u32_dpp v245, v245, v245 row_half_mirror row_mask:0xf bank_mask:0xf
    v_max_u32_dpp v244, v244, v244 row_half_mirror row_mask:0xf bank_mask:0xf
    v_max_u32 v245, v245, v196
    v_cmp_eq_u32 s[88:89], v32, v245
    v_cmp_eq_u32 vcc, v32, v244
    v_or_b32 v246, 1, v245
    v_mov_b32 v245, s4
    v_mov_b32 v247, s4
    s_or_b64 s[84:85], vcc, s[88:89]
    s_cmp_lg_u32 s3, 0
    s_cbranch_scc1 L_NOF
    s_mov_b64 exec, 0xffff
    buffer_store_dwordx4 v[244:247], v6, s[32:35], s16 offen sc1
    s_mov_b64 exec, -1
L_NOF:
    s_cmp_eq_u64 s[84:85], 0
    s_cbranch_scc1 L_NOPR
    s_setprio 1
L_NOPR:
    s_lshl4_add_u32 s13, s3, 156288
    v_mov_b32 v4, s13
    v_and_b32 v5, 7, v1
    v_lshlrev_b32 v5, 4, v5
    v_add_u32 v5, 156288, v5
    s_load_dwordx8 s[24:31], s[32:33], s92 offset:2560 glc
    v_cvt_pk_bf16_f32 v208, 0, v208
    v_cvt_pk_bf16_f32 v209, 0, v209
    v_cvt_pk_bf16_f32 v210, 0, v210
    v_cvt_pk_bf16_f32 v211, 0, v211
    v_cvt_pk_bf16_f32 v212, 0, v212
    v_cvt_pk_bf16_f32 v213, 0, v213
    v_cvt_pk_bf16_f32 v214, 0, v214
    v_cvt_pk_bf16_f32 v215, 0, v215
    v_cvt_pk_bf16_f32 v216, 0, v216
    v_cvt_pk_bf16_f32 v217, 0, v217
    v_cvt_pk_bf16_f32 v218, 0, v218
    v_cvt_pk_bf16_f32 v219, 0, v219
    v_cvt_pk_bf16_f32 v220, 0, v220
    v_cvt_pk_bf16_f32 v221, 0, v221
    v_cvt_pk_bf16_f32 v222, 0, v222
    v_cvt_pk_bf16_f32 v223, 0, v223
    v_pk_mul_f32 v[208:209], v[30:31], v[208:209] op_sel:[1,0]
    v_pk_mul_f32 v[210:211], v[30:31], v[210:211] op_sel:[1,0]
    v_pk_mul_f32 v[212:213], v[30:31], v[212:213] op_sel:[1,0]
    v_pk_mul_f32 v[214:215], v[30:31], v[214:215] op_sel:[1,0]
    v_pk_mul_f32 v[216:217], v[30:31], v[216:217] op_sel:[1,0]
    v_pk_mul_f32 v[218:219], v[30:31], v[218:219] op_sel:[1,0]
    v_pk_mul_f32 v[220:221], v[30:31], v[220:221] op_sel:[1,0]
    v_pk_mul_f32 v[222:223], v[30:31], v[222:223] op_sel:[1,0]
    v_cvt_pk_bf16_f32 v208, 0, v208
    v_cvt_pk_bf16_f32 v209, 0, v209
    v_cvt_pk_bf16_f32 v210, 0, v210
    v_cvt_pk_bf16_f32 v211, 0, v211
    v_cvt_pk_bf16_f32 v212, 0, v212
    v_cvt_pk_bf16_f32 v213, 0, v213
    v_cvt_pk_bf16_f32 v214, 0, v214
    v_cvt_pk_bf16_f32 v215, 0, v215
    v_cvt_pk_bf16_f32 v216, 0, v216
    v_cvt_pk_bf16_f32 v217, 0, v217
    v_cvt_pk_bf16_f32 v218, 0, v218
    v_cvt_pk_bf16_f32 v219, 0, v219
    v_cvt_pk_bf16_f32 v220, 0, v220
    v_cvt_pk_bf16_f32 v221, 0, v221
    v_cvt_pk_bf16_f32 v222, 0, v222
    v_cvt_pk_bf16_f32 v223, 0, v223
    v_pk_mul_f32 v[208:209], v[208:209], v[168:169]
    v_pk_mul_f32 v[210:211], v[210:211], v[170:171]
    v_pk_mul_f32 v[212:213], v[212:213], v[172:173]
    v_pk_mul_f32 v[214:215], v[214:215], v[174:175]
    v_pk_mul_f32 v[216:217], v[216:217], v[176:177]
    v_pk_mul_f32 v[218:219], v[218:219], v[178:179]
    v_pk_mul_f32 v[220:221], v[220:221], v[180:181]
    v_pk_mul_f32 v[222:223], v[222:223], v[182:183]
    v_cvt_pk_bf16_f32 v208, 0, v208
    v_cvt_pk_bf16_f32 v209, 0, v209
    v_cvt_pk_bf16_f32 v210, 0, v210
    v_cvt_pk_bf16_f32 v211, 0, v211
    v_cvt_pk_bf16_f32 v212, 0, v212
    v_cvt_pk_bf16_f32 v213, 0, v213
    v_cvt_pk_bf16_f32 v214, 0, v214
    v_cvt_pk_bf16_f32 v215, 0, v215
    v_cvt_pk_bf16_f32 v216, 0, v216
    v_cvt_pk_bf16_f32 v217, 0, v217
    v_cvt_pk_bf16_f32 v218, 0, v218
    v_cvt_pk_bf16_f32 v219, 0, v219
    v_cvt_pk_bf16_f32 v220, 0, v220
    v_cvt_pk_bf16_f32 v221, 0, v221
    v_cvt_pk_bf16_f32 v222, 0, v222
    v_cvt_pk_bf16_f32 v223, 0, v223
    v_pk_add_f32 v[208:209], v[208:209], v[88:89]
    v_pk_add_f32 v[210:211], v[210:211], v[90:91]
    v_pk_add_f32 v[212:213], v[212:213], v[92:93]
    v_pk_add_f32 v[214:215], v[214:215], v[94:95]
    v_pk_add_f32 v[216:217], v[216:217], v[96:97]
    v_pk_add_f32 v[218:219], v[218:219], v[98:99]
    v_pk_add_f32 v[220:221], v[220:221], v[100:101]
    v_pk_add_f32 v[222:223], v[222:223], v[102:103]
    v_cvt_pk_bf16_f32 v224, v208, v209
    v_cvt_pk_bf16_f32 v225, v210, v211
    v_cvt_pk_bf16_f32 v226, v212, v213
    v_cvt_pk_bf16_f32 v227, v214, v215
    v_cvt_pk_bf16_f32 v228, v216, v217
    v_cvt_pk_bf16_f32 v229, v218, v219
    v_cvt_pk_bf16_f32 v230, v220, v221
    v_cvt_pk_bf16_f32 v231, v222, v223
    s_cmp_eq_u64 s[84:85], 0
    s_cbranch_scc1 L_NOCAND
    v_mfma_f32_16x16x32_bf16 v[240:243], v[184:187], v[224:227], 0
    v_mfma_f32_16x16x32_bf16 v[240:243], v[188:191], v[228:231], v[240:243]
    v_mov_b32 v232, v224
    v_mov_b32 v233, v225
    v_mov_b32 v234, v226
    v_mov_b32 v235, v227
    v_mov_b32 v236, v228
    v_mov_b32 v237, v229
    v_mov_b32 v238, v230
    v_mov_b32 v239, v231
    s_lshl_b32 s96, s21, 14
    s_lshl_b32 s97, s12, 9
    s_add_u32 s98, s96, s97
    s_add_u32 s15, s98, 13631488
    v_lshrrev_b32 v7, 4, v1
    v_lshlrev_b32 v7, 4, v7
    v_add_u32 v8, 8192, v7
    v_permlane32_swap_b32 v232, v234
    v_permlane32_swap_b32 v233, v235
    v_permlane32_swap_b32 v236, v238
    v_permlane32_swap_b32 v237, v239
    v_permlane32_swap_b32 v12, v14
    v_permlane32_swap_b32 v13, v15
    v_permlane32_swap_b32 v16, v18
    v_permlane32_swap_b32 v17, v19
    v_cndmask_b32 v7, v7, v8, s[88:89]
    s_mov_b64 exec, s[84:85]
    buffer_store_dwordx4 v[232:235], v7, s[32:35], s15 offen sc1
    buffer_store_dwordx4 v[236:239], v7, s[32:35], s15 offen offset:64 sc1
    s_mov_b32 exec_hi, 0
    s_and_b32 exec_lo, s84, 0xffff
    buffer_store_dword v243, v7, s[32:35], s15 offen offset:256 sc1
    s_mov_b64 exec, s[84:85]
    buffer_store_dwordx4 v[12:15], v7, s[32:35], s15 offen offset:128 sc1
    buffer_store_dwordx4 v[16:19], v7, s[32:35], s15 offen offset:192 sc1
    s_mov_b64 exec, -1
    s_setprio 0
L_NOCAND:
    s_add_u32 s82, s81, 8192
    s_lshl2_add_u32 m0, s83, 67584
    s_nop 0
    buffer_load_dwordx4 v253, s[60:63], s82 offen nt lds
    s_add_u32 s82, s81, 12288
    s_lshl2_add_u32 m0, s83, 68608
    s_nop 0
    buffer_load_dwordx4 v253, s[60:63], s82 offen nt lds
    v_lshlrev_b32 v208, 16, v224
    v_and_b32 v209, s6, v224
    v_lshlrev_b32 v210, 16, v225
    v_and_b32 v211, s6, v225
    v_lshlrev_b32 v212, 16, v226
    v_and_b32 v213, s6, v226
    v_lshlrev_b32 v214, 16, v227
    v_and_b32 v215, s6, v227
    v_lshlrev_b32 v216, 16, v228
    v_and_b32 v217, s6, v228
    v_lshlrev_b32 v218, 16, v229
    v_and_b32 v219, s6, v229
    v_lshlrev_b32 v220, 16, v230
    v_and_b32 v221, s6, v230
    v_lshlrev_b32 v222, 16, v231
    v_and_b32 v223, s6, v231
    v_pk_mul_f32 v[208:209], v[208:209], v[104:105]
    v_pk_mul_f32 v[210:211], v[210:211], v[106:107]
    v_pk_mul_f32 v[212:213], v[212:213], v[108:109]
    v_pk_mul_f32 v[214:215], v[214:215], v[110:111]
    v_pk_mul_f32 v[216:217], v[216:217], v[112:113]
    v_pk_mul_f32 v[218:219], v[218:219], v[114:115]
    v_pk_mul_f32 v[220:221], v[220:221], v[116:117]
    v_pk_mul_f32 v[222:223], v[222:223], v[118:119]
    v_cvt_pk_bf16_f32 v208, 0, v208
    v_cvt_pk_bf16_f32 v209, 0, v209
    v_cvt_pk_bf16_f32 v210, 0, v210
    v_cvt_pk_bf16_f32 v211, 0, v211
    v_cvt_pk_bf16_f32 v212, 0, v212
    v_cvt_pk_bf16_f32 v213, 0, v213
    v_cvt_pk_bf16_f32 v214, 0, v214
    v_cvt_pk_bf16_f32 v215, 0, v215
    v_cvt_pk_bf16_f32 v216, 0, v216
    v_cvt_pk_bf16_f32 v217, 0, v217
    v_cvt_pk_bf16_f32 v218, 0, v218
    v_cvt_pk_bf16_f32 v219, 0, v219
    v_cvt_pk_bf16_f32 v220, 0, v220
    v_cvt_pk_bf16_f32 v221, 0, v221
    v_cvt_pk_bf16_f32 v222, 0, v222
    v_cvt_pk_bf16_f32 v223, 0, v223
    s_branch SCHK_43
SPOLL_42:
    s_load_dwordx8 s[24:31], s[32:33], s92 offset:2560 glc
SCHK_43:
    s_add_u32 s5, s5, 1
    s_cmp_ge_u32 s5, 200000
    s_waitcnt lgkmcnt(0)
    s_cbranch_scc1 SDONE_44
    s_cmp_lg_u32 s25, s4
    s_cbranch_scc1 SPOLL_42
    s_cmp_lg_u32 s27, s4
    s_cbranch_scc1 SPOLL_42
    s_cmp_lg_u32 s29, s4
    s_cbranch_scc1 SPOLL_42
    s_cmp_lg_u32 s31, s4
    s_cbranch_scc1 SPOLL_42
SDONE_44:
    s_min_u32 s25, s24, s28
    s_min_u32 s27, s26, s28
    s_min_u32 s29, s24, s30
    s_max_u32 s24, s24, s28
    s_max_u32 s26, s26, s30
    s_max_u32 s27, s27, s29
    s_max_u32 s25, s25, s26
    v_mov_b32 v244, s24
    v_mov_b32 v246, s27
    v_mov_b32 v245, s25
    ds_write_b128 v4, v[244:247]
    s_waitcnt vmcnt(4)
    s_waitcnt lgkmcnt(0)
    s_barrier
    ds_read_b128 v[244:247], v5
    v_and_b32 v8, 8, v1
    v_cmp_eq_u32 s[22:23], 0, v8
    v_cmp_gt_u32 s[24:25], 16, v1
    v_cmp_gt_u32 s[26:27], 32, v1
    s_waitcnt lgkmcnt(0)
    v_min_u32_dpp v192, v244, v244 quad_perm:[1,0,3,2] row_mask:0xf bank_mask:0xf
    v_min_u32_dpp v193, v245, v244 quad_perm:[1,0,3,2] row_mask:0xf bank_mask:0xf
    v_min_u32_dpp v194, v244, v245 quad_perm:[1,0,3,2] row_mask:0xf bank_mask:0xf
    v_max_u32_dpp v246, v246, v246 quad_perm:[1,0,3,2] row_mask:0xf bank_mask:0xf
    v_max_u32_dpp v245, v245, v245 quad_perm:[1,0,3,2] row_mask:0xf bank_mask:0xf
    v_max_u32_dpp v244, v244, v244 quad_perm:[1,0,3,2] row_mask:0xf bank_mask:0xf
    v_max3_u32 v246, v246, v193, v194
    v_max_u32 v245, v245, v192
    v_min_u32_dpp v192, v244, v244 quad_perm:[2,3,0,1] row_mask:0xf bank_mask:0xf
    s_nop 0
    v_min_u32_dpp v193, v245, v244 quad_perm:[2,3,0,1] row_mask:0xf bank_mask:0xf
    v_min_u32_dpp v194, v244, v245 quad_perm:[2,3,0,1] row_mask:0xf bank_mask:0xf
    v_max_u32_dpp v246, v246, v246 quad_perm:[2,3,0,1] row_mask:0xf bank_mask:0xf
    v_max_u32_dpp v245, v245, v245 quad_perm:[2,3,0,1] row_mask:0xf bank_mask:0xf
    v_max_u32_dpp v244, v244, v244 quad_perm:[2,3,0,1] row_mask:0xf bank_mask:0xf
    v_max3_u32 v246, v246, v193, v194
    v_max_u32 v245, v245, v192
    v_min_u32_dpp v192, v244, v244 row_half_mirror row_mask:0xf bank_mask:0xf
    s_nop 0
    v_min_u32_dpp v193, v245, v244 row_half_mirror row_mask:0xf bank_mask:0xf
    v_min_u32_dpp v194, v244, v245 row_half_mirror row_mask:0xf bank_mask:0xf
    v_max_u32_dpp v246, v246, v246 row_half_mirror row_mask:0xf bank_mask:0xf
    v_max_u32_dpp v245, v245, v245 row_half_mirror row_mask:0xf bank_mask:0xf
    v_max_u32_dpp v244, v244, v244 row_half_mirror row_mask:0xf bank_mask:0xf
    v_max3_u32 v246, v246, v193, v194
    v_max_u32 v245, v245, v192
    v_cndmask_b32 v192, v245, v244, s[22:23]
    v_cndmask_b32 v201, v246, v245, s[26:27]
    v_and_b32 v193, 31, v246
    v_and_b32 v192, 31, v192
    v_cndmask_b32 v201, v201, v244, s[24:25]
    v_lshl_add_u32 v4, v192, 13, v52
    v_lshl_add_u32 v5, v193, 13, v52
    v_and_b32 v194, 31, v201
    v_lshl_add_u32 v6, v194, 13, v53
    buffer_load_dwordx4 v[192:195], v4, s[32:35], 0 offen sc1
    buffer_load_dwordx4 v[196:199], v5, s[32:35], 0 offen sc1
    buffer_load_dword v200, v6, s[32:35], 0 offen sc1
    v_readfirstlane_b32 s91, v244
    v_readfirstlane_b32 s94, v245
    v_readfirstlane_b32 s95, v246
    ds_read_b64_tr_b16 v[56:57], v34
    ds_read_b64_tr_b16 v[58:59], v34 offset:512
    ds_read_b64_tr_b16 v[60:61], v34 offset:1024
    ds_read_b64_tr_b16 v[62:63], v34 offset:1536
    ds_read_b64_tr_b16 v[64:65], v34 offset:2048
    ds_read_b64_tr_b16 v[66:67], v34 offset:2560
    ds_read_b64_tr_b16 v[68:69], v34 offset:3072
    ds_read_b64_tr_b16 v[70:71], v34 offset:3584
    ds_read_b64_tr_b16 v[72:73], v34 offset:4096
    ds_read_b64_tr_b16 v[74:75], v34 offset:4608
    ds_read_b64_tr_b16 v[76:77], v34 offset:5120
    ds_read_b64_tr_b16 v[78:79], v34 offset:5632
    ds_read_b64_tr_b16 v[80:81], v34 offset:6144
    ds_read_b64_tr_b16 v[82:83], v34 offset:6656
    ds_read_b64_tr_b16 v[84:85], v34 offset:7168
    ds_read_b64_tr_b16 v[86:87], v34 offset:7680
    s_lshl_b32 s96, s3, 11
    s_add_u32 s13, s96, 98304
    v_lshrrev_b32 v44, 4, v1
    v_lshlrev_b32 v44, 4, v44
    v_and_b32 v45, 7, v1
    v_lshlrev_b32 v45, 4, v45
    v_xor_b32 v44, v44, v45
    v_and_b32 v46, 15, v1
    v_lshl_add_u32 v46, v46, 7, s13
    v_add_u32 v44, v44, v46
    v_xor_b32 v46, 64, v44
    v_lshrrev_b32 v47, 3, v1
    v_lshlrev_b32 v47, 4, v47
    v_xor_b32 v45, v47, v45
    v_lshrrev_b32 v47, 3, v1
    v_lshl_add_u32 v47, v47, 7, s13
    v_add_u32 v45, v45, v47
    s_lshl_b32 s96, s21, 7
    s_sub_u32 s97, 2047, s96
    s_lshl_b32 s98, s3, 4
    s_sub_u32 s13, s97, s98
    v_lshrrev_b32 v43, 3, v1
    v_sub_u32 v42, s13, v43
    v_subrev_u32 v43, 8, v42
    v_lshrrev_b32 v33, 3, v1
    v_lshlrev_b32 v33, 11, v33
    v_and_b32 v9, 7, v1
    v_lshl_add_u32 v33, v9, 4, v33
    v_pk_add_f32 v[208:209], v[208:209], v[152:153]
    v_pk_add_f32 v[210:211], v[210:211], v[154:155]
    v_pk_add_f32 v[212:213], v[212:213], v[156:157]
    v_pk_add_f32 v[214:215], v[214:215], v[158:159]
    v_pk_add_f32 v[216:217], v[216:217], v[160:161]
    v_pk_add_f32 v[218:219], v[218:219], v[162:163]
    v_pk_add_f32 v[220:221], v[220:221], v[164:165]
    v_pk_add_f32 v[222:223], v[222:223], v[166:167]
    v_cvt_pk_bf16_f32 v232, v208, v209
    v_cvt_pk_bf16_f32 v233, v210, v211
    v_cvt_pk_bf16_f32 v234, v212, v213
    v_cvt_pk_bf16_f32 v235, v214, v215
    v_cvt_pk_bf16_f32 v236, v216, v217
    v_cvt_pk_bf16_f32 v237, v218, v219
    v_cvt_pk_bf16_f32 v238, v220, v221
    v_cvt_pk_bf16_f32 v239, v222, v223
    v_permlane32_swap_b32 v232, v234
    v_permlane32_swap_b32 v233, v235
    v_permlane32_swap_b32 v236, v238
    v_permlane32_swap_b32 v237, v239
    ds_write_b128 v44, v[232:235]
    ds_write_b128 v46, v[236:239]
    ds_read_b128 v[232:235], v45
    ds_read_b128 v[236:239], v45 offset:1024
    s_waitcnt lgkmcnt(0)
    v_bfe_u32 v7, v201, 1, 4
    v_bfe_u32 v201, v201, 5, 7
    v_lshl_or_b32 v201, v7, 7, v201
    v_xor_b32 v201, 0x7ff, v201
    s_waitcnt vmcnt(0)
    v_max3_u32 v7, v192, v196, v200
    v_cmp_eq_u32 vcc, -1, v7
    s_cbranch_vccz POK_46
PRE_47:
    buffer_load_dwordx4 v[192:195], v4, s[32:35], 0 offen sc1
    buffer_load_dwordx4 v[196:199], v5, s[32:35], 0 offen sc1
    buffer_load_dword v200, v6, s[32:35], 0 offen sc1
    s_waitcnt vmcnt(0)
    v_max3_u32 v7, v192, v196, v200
    v_cmp_eq_u32 vcc, -1, v7
    s_cbranch_vccz POK_46
    s_add_u32 s5, s5, 1
    s_cmp_lt_u32 s5, 200000
    s_cbranch_scc1 PRE_47
POK_46:
    v_add_f32_dpp v200, v200, v200 quad_perm:[1,0,3,2] row_mask:0xf bank_mask:0xf
    s_nop 1
    v_add_f32_dpp v200, v200, v200 quad_perm:[2,3,0,1] row_mask:0xf bank_mask:0xf
    s_nop 1
    v_add_f32_dpp v200, v200, v200 row_half_mirror row_mask:0xf bank_mask:0xf
    s_nop 1
    v_add_f32_dpp v200, v200, v200 row_mirror row_mask:0xf bank_mask:0xf
    v_cvt_pk_bf16_f32 v200, 0, v200
    v_ashrrev_i32 v7, 31, v200
    v_or_b32 v7, 0x80000000, v7
    v_xor_b32 v200, v200, v7
    v_lshrrev_b32 v200, 16, v200
    v_lshl_or_b32 v200, v200, 11, v201
    s_nop 0
    v_readlane_b32 s24, v200, 0
    v_readlane_b32 s25, v200, 16
    v_readlane_b32 s26, v200, 32
    s_not_b64 s[28:29], s[22:23]
    s_cmp_lt_u32 s24, s25
    s_cselect_b64 s[28:29], s[22:23], s[28:29]
    s_cselect_b32 s27, s24, s25
    s_cmp_gt_u32 s26, s27
    s_cselect_b64 vcc, s[28:29], 0
    v_cndmask_b32 v192, v192, v196, vcc
    v_cndmask_b32 v193, v193, v197, vcc
    v_cndmask_b32 v194, v194, v198, vcc
    v_cndmask_b32 v195, v195, v199, vcc
    s_bitcmp1_b32 vcc_lo, 0
    s_cselect_b32 s24, s26, s24
    s_cselect_b32 s19, s17, s19
    s_cselect_b32 s17, s95, s91
    s_bitcmp1_b32 vcc_lo, 8
    s_cselect_b32 s25, s26, s25
    s_cselect_b32 s19, s18, s19
    s_cselect_b32 s18, s95, s94
    s_waitcnt lgkmcnt(0)
    v_mfma_f32_16x16x32_bf16 v[136:139], v[192:195], v[56:59], 0
    v_mfma_f32_16x16x32_bf16 v[140:143], v[192:195], v[60:63], 0
    v_mfma_f32_16x16x32_bf16 v[144:147], v[192:195], v[64:67], 0
    v_mfma_f32_16x16x32_bf16 v[148:151], v[192:195], v[68:71], 0
    v_mfma_f32_16x16x32_bf16 v[168:171], v[192:195], v[72:75], 0
    v_mfma_f32_16x16x32_bf16 v[172:175], v[192:195], v[76:79], 0
    v_mfma_f32_16x16x32_bf16 v[176:179], v[192:195], v[80:83], 0
    v_mfma_f32_16x16x32_bf16 v[180:183], v[192:195], v[84:87], 0
    s_nop 1
    v_add_f32 v196, v136, v141
    s_nop 0
    v_add_f32 v197, v146, v151
    s_nop 0
    v_add_f32 v198, v168, v173
    s_nop 0
    v_add_f32 v199, v178, v183
    v_add_f32 v196, v196, v197
    v_add_f32 v198, v198, v199
    v_mov_b32 v197, s4
    s_nop 0
    v_permlane16_swap_b32 v198, v199
    s_cmp_ge_u32 s9, 28
    s_cbranch_scc1 L_NOHP
    v_add_f32 v196, v196, v199
    v_add_f32 v198, v196, 0
    v_mov_b32 v199, s4
    s_nop 0
    v_permlane32_swap_b32 v196, v198
    s_mov_b64 exec, 0xffff
    buffer_store_dwordx4 v[196:199], v2, s[32:35], s73 offen sc1
    s_mov_b64 exec, -1
L_NOHP:
    s_and_b32 s68, s24, 2047
    s_and_b32 s69, s25, 2047
    s_waitcnt lgkmcnt(0)
    s_cmp_lg_u32 s93, 7
    s_cbranch_scc1 L_NONON
    v_mov_b32 v6, s4
    v_mov_b32 v7, 0
    s_mov_b64 exec, 1
    buffer_store_dword v6, v7, s[32:35], 0 offen sc1
    s_mov_b64 exec, -1
L_NONON:
    s_cmp_ge_u32 s9, 28
    s_cbranch_scc1 L_FIN3
    v_bfe_u32 v192, v1, 2, 1
    v_lshlrev_b32 v192, 7, v192
    v_lshrrev_b32 v9, 5, v1
    v_lshl_add_u32 v192, v9, 4, v192
    v_add_u32 v192, 156672, v192
    v_lshrrev_b32 v193, 4, v1
    v_mul_u32_u24 v193, 7168, v193
    v_and_b32 v9, 15, v1
    v_lshl_add_u32 v193, v9, 3, v193
    s_lshl3_add_u32 s96, s75, s3
    s_mul_i32 s97, s96, 28672
    s_lshl_b32 s98, s74, 7
    s_add_u32 s99, s97, s98
    s_add_u32 s80, s99, 22020096
    v_and_b32 v194, 1, v1
    v_lshlrev_b32 v194, 13, v194
    v_bfe_u32 v9, v1, 1, 1
    v_lshl_add_u32 v194, v9, 18, v194
    s_lshr_b32 s96, s9, 2
    s_and_b32 s97, s75, 1
    s_lshr_b32 s98, s3, 1
    s_lshl2_add_u32 s99, s97, s98
    s_and_b32 s97, s3, 1
    s_lshr_b32 s98, s75, 1
    s_lshl2_add_u32 s97, s97, s98
    s_lshl3_add_u32 s98, s99, s97
    s_lshl_b32 s99, s98, 12
    s_lshl_b32 s97, s8, 6
    s_add_u32 s98, s99, s97
    s_lshl2_add_u32 s99, s96, s98
    s_add_u32 s97, s99, 1048576
    s_add_u32 s81, s97, 3072
    s_cmp_lt_u32 s3, 4
    s_cbranch_scc1 L_HW
    s_barrier
    ds_read_b64_tr_b16 v[120:121], v35
    ds_read_b64_tr_b16 v[122:123], v35 offset:1024
    ds_read_b64_tr_b16 v[124:125], v35 offset:8192
    ds_read_b64_tr_b16 v[126:127], v35 offset:9216
    ds_read_b64_tr_b16 v[128:129], v35 offset:16384
    ds_read_b64_tr_b16 v[130:131], v35 offset:17408
    ds_read_b64_tr_b16 v[132:133], v35 offset:24576
    ds_read_b64_tr_b16 v[134:135], v35 offset:25600
    s_cmp_lg_u32 s3, 7
    s_cbranch_scc1 L_NOH
    s_bitcmp1_b32 s9, 3
    s_cselect_b32 s15, s25, s24
    s_cselect_b32 s17, s18, s17
    s_andn2_b32 s18, 2047, s15
    s_lshr_b32 s96, s8, 1
    s_lshl2_add_u32 s19, s12, s96
    s_lshr_b32 s96, s19, 1
    s_lshr_b32 s97, s9, 3
    s_lshl_b32 s98, s97, 1
    s_lshl2_add_u32 s99, s96, s98
    s_and_b32 s97, s19, 1
    s_add_u32 s96, s99, s97
    s_mul_i32 s98, s96, 7168
    s_add_u32 s20, s98, 22020096
    s_lshl_b32 s96, s18, 11
    s_lshl_b32 s97, s19, 5
    s_add_u32 s82, s96, s97
    v_and_b32 v10, 7, v1
    v_lshlrev_b32 v10, 2, v10
    s_lshr_b32 s96, s8, 1
    s_lshl_b32 s97, s96, 6
    s_add_u32 s13, s97, 157184
    v_and_b32 v5, 7, v1
    v_lshl_add_u32 v5, v5, 3, s13
    ds_read_b64 v[206:207], v5
    s_and_b32 s96, s17, 31
    s_lshl_b32 s97, s96, 13
    s_lshl_b32 s98, s12, 9
    s_add_u32 s99, s97, s98
    s_lshr_b32 s96, s8, 1
    s_lshl_b32 s97, s96, 5
    s_add_u32 s98, s99, s97
    s_add_u32 s91, s98, 13631488
    s_lshr_b32 s13, s15, 11
    s_lshl_b32 s13, s13, 16
    s_ashr_i32 s15, s13, 31
    s_andn2_b32 s15, 0x7fff0000, s15
    s_or_b32 s15, s15, 0x80000000
    s_xor_b32 s13, s13, s15
    v_mov_b32 v204, s13
    v_mul_f32 v204, s7, v204
    v_exp_f32 v204, -v204
    s_nop 0
L_PAD10:
    s_cbranch_execz L_RET10
    v_add_f32 v204, 1.0, v204
    v_rcp_f32 v204, v204
    s_nop 0
    v_cvt_pk_bf16_f32 v204, 0, v204
    v_mov_b32 v5, s4
    v_not_b32 v6, v5
POLL_48:
    buffer_load_dword v244, v10, s[32:35], s91 offen sc1
    buffer_load_dword v245, v10, s[32:35], s91 offen offset:128 sc1
    s_waitcnt vmcnt(0)
    v_max_u32 v246, v244, v245
    v_cmp_ne_u32 vcc, -1, v246
    s_nop 1
    v_cndmask_b32 v246, v6, v5, vcc
    v_cmp_ne_u32 vcc, s4, v246
    s_cbranch_vccz PDONE_49
    s_add_u32 s5, s5, 1
    s_cmp_lt_u32 s5, 200000
    s_cbranch_scc1 POLL_48
PDONE_49:
    v_lshlrev_b32 v246, 16, v245
    v_and_b32 v247, s6, v245
    v_and_b32 v245, s6, v244
    v_lshlrev_b32 v244, 16, v244
    s_branch L_NOH
L_HW:
    s_lshl_b32 s96, s3, 8
    s_add_u32 s13, s96, s72
    v_lshrrev_b32 v4, 4, v1
    v_lshlrev_b32 v4, 11, v4
    v_and_b32 v9, 15, v1
    v_lshl_add_u32 v4, v9, 4, v4
    s_lshl_b32 s96, s3, 5
    s_add_u32 s15, s96, 156672
    v_lshrrev_b32 v5, 5, v1
    v_lshl_add_u32 v5, v5, 7, s15
    v_bfe_u32 v9, v1, 2, 1
    v_lshl_add_u32 v5, v9, 4, v5
    v_bfe_u32 v9, v1, 1, 1
    v_lshl_add_u32 v5, v9, 3, v5
    v_bfe_u32 v9, v1, 3, 1
    v_lshl_add_u32 v5, v9, 2, v5
    v_and_b32 v9, 1, v1
    v_lshl_add_u32 v5, v9, 1, v5
    s_load_dword s24, s[32:33], s13 offset:1276 glc
    s_load_dword s25, s[32:33], s13 offset:3324 glc
    s_load_dword s26, s[32:33], s13 offset:5372 glc
    s_load_dword s27, s[32:33], s13 offset:7420 glc
    s_barrier
    ds_read_b64_tr_b16 v[120:121], v35
    ds_read_b64_tr_b16 v[122:123], v35 offset:1024
    ds_read_b64_tr_b16 v[124:125], v35 offset:8192
    ds_read_b64_tr_b16 v[126:127], v35 offset:9216
    ds_read_b64_tr_b16 v[128:129], v35 offset:16384
    ds_read_b64_tr_b16 v[130:131], v35 offset:17408
    ds_read_b64_tr_b16 v[132:133], v35 offset:24576
    ds_read_b64_tr_b16 v[134:135], v35 offset:25600
    s_branch SCHK_51
SPOLL_50:
    s_load_dword s24, s[32:33], s13 offset:1276 glc
    s_load_dword s25, s[32:33], s13 offset:3324 glc
    s_load_dword s26, s[32:33], s13 offset:5372 glc
    s_load_dword s27, s[32:33], s13 offset:7420 glc
SCHK_51:
    s_add_u32 s5, s5, 1
    s_cmp_ge_u32 s5, 200000
    s_waitcnt lgkmcnt(0)
    s_cbranch_scc1 SDONE_52
    s_cmp_lg_u32 s24, s4
    s_cbranch_scc1 SPOLL_50
    s_cmp_lg_u32 s25, s4
    s_cbranch_scc1 SPOLL_50
    s_cmp_lg_u32 s26, s4
    s_cbranch_scc1 SPOLL_50
    s_cmp_lg_u32 s27, s4
    s_cbranch_scc1 SPOLL_50
SDONE_52:
POLL_53:
    buffer_load_dwordx4 v[88:91], v4, s[32:35], s13 offen sc1
    buffer_load_dwordx4 v[92:95], v4, s[32:35], s13 offen offset:1024 sc1
    s_waitcnt vmcnt(0)
    v_bitop3_b32 v6, v89, v91, s4 bitop3:0x7e
    v_bitop3_b32 v6, v6, v93, s4 bitop3:0xf6
    v_bitop3_b32 v6, v6, v95, s4 bitop3:0xf6
    v_cmp_ne_u32 vcc, 0, v6
    s_cbranch_vccz PDONE_54
    s_add_u32 s5, s5, 1
    s_cmp_lt_u32 s5, 200000
    s_cbranch_scc1 POLL_53
PDONE_54:
    v_permlane32_swap_b32 v88, v90
    v_permlane32_swap_b32 v92, v94
    v_add_f32 v88, v88, v90
    v_add_f32 v92, v92, v94
    v_mov_b32 v90, v88
    v_mov_b32 v94, v92
    s_nop 0
    v_permlane16_swap_b32 v88, v90
    v_permlane16_swap_b32 v92, v94
    v_add_f32 v88, v88, v90
    v_add_f32 v92, v92, v94
    v_cvt_pk_bf16_f32 v88, 0, v88
    v_cvt_pk_bf16_f32 v92, 0, v92
    v_mul_f32 v6, s7, v88
    v_exp_f32 v6, -v6
    s_nop 0
    v_add_f32 v6, 1.0, v6
    v_rcp_f32 v6, v6
    s_nop 0
    v_mul_f32 v88, v88, v6
    v_cvt_pk_bf16_f32 v88, 0, v88
    v_mul_f32 v88, v88, v92
    v_cvt_pk_bf16_f32 v88, v88, v88
    ds_write_b16 v5, v88
L_NOH:
    s_waitcnt lgkmcnt(0)
    s_barrier
    ds_read_b128 v[88:91], v192
    ds_read_b128 v[92:95], v192 offset:32
    ds_read_b128 v[96:99], v192 offset:64
    ds_read_b128 v[100:103], v192 offset:96
    s_waitcnt lgkmcnt(3)
    v_mfma_f32_32x32x16_bf16 v[208:223], v[88:91], v[120:123], 0
    s_waitcnt lgkmcnt(2)
    v_mfma_f32_32x32x16_bf16 v[208:223], v[92:95], v[124:127], v[208:223]
    s_waitcnt lgkmcnt(1)
    v_mfma_f32_32x32x16_bf16 v[208:223], v[96:99], v[128:131], v[208:223]
    s_waitcnt lgkmcnt(0)
    v_mfma_f32_32x32x16_bf16 v[208:223], v[100:103], v[132:135], v[208:223]
    s_nop 11
    v_mov_b32 v209, s4
    buffer_store_dwordx2 v[208:209], v193, s[32:35], s80 offen sc1
    s_mov_b64 exec, 15
    buffer_store_dword v209, v194, s[32:35], s81 offen sc1
    s_mov_b64 exec, -1
    s_barrier
    s_branch L_FIN2
L_FIN3:
    s_waitcnt lgkmcnt(0)
L_FIN2:
    v_cmp_ne_u32 vcc, s68, v42
    v_cmp_ne_u32 s[22:23], s69, v42
    s_nop 0
    s_and_b64 exec, vcc, s[22:23]
    buffer_store_dwordx4 v[232:235], v33, s[64:67], s70 offen sc1
    s_mov_b64 exec, -1
    v_cmp_ne_u32 vcc, s68, v43
    v_cmp_ne_u32 s[22:23], s69, v43
    s_nop 0
    s_and_b64 exec, vcc, s[22:23]
    buffer_store_dwordx4 v[236:239], v33, s[64:67], s71 offen sc1
    s_mov_b64 exec, -1
    s_cmp_ge_u32 s9, 16
    s_cbranch_scc1 L_FIN
SPOLL_55:
    s_load_dwordx8 s[24:31], s[32:33], s92 offset:3072 glc
SCHK_56:
    s_add_u32 s5, s5, 1
    s_cmp_ge_u32 s5, 200000
    s_waitcnt lgkmcnt(0)
    s_cbranch_scc1 SDONE_57
    s_cmp_lg_u32 s24, s4
    s_cbranch_scc1 SPOLL_55
    s_cmp_lg_u32 s25, s4
    s_cbranch_scc1 SPOLL_55
    s_cmp_lg_u32 s26, s4
    s_cbranch_scc1 SPOLL_55
    s_cmp_lg_u32 s27, s4
    s_cbranch_scc1 SPOLL_55
    s_cmp_lg_u32 s28, s4
    s_cbranch_scc1 SPOLL_55
    s_cmp_lg_u32 s29, s4
    s_cbranch_scc1 SPOLL_55
    s_cmp_lg_u32 s30, s4
    s_cbranch_scc1 SPOLL_55
SDONE_57:
    s_barrier
    s_cmp_lg_u32 s3, 7
    s_cbranch_scc1 L_FIN
    s_add_u32 s13, s20, 4096
POLL_58:
    buffer_load_dwordx4 v[88:91], v2, s[32:35], s20 offen sc1
    buffer_load_dwordx4 v[92:95], v2, s[32:35], s20 offen offset:1024 sc1
    buffer_load_dwordx4 v[96:99], v2, s[32:35], s20 offen offset:2048 sc1
    buffer_load_dwordx4 v[100:103], v2, s[32:35], s20 offen offset:3072 sc1
    buffer_load_dwordx4 v[104:107], v2, s[32:35], s13 offen sc1
    buffer_load_dwordx4 v[108:111], v2, s[32:35], s13 offen offset:1024 sc1
    buffer_load_dwordx4 v[112:115], v2, s[32:35], s13 offen offset:2048 sc1
    s_waitcnt vmcnt(0)
    v_bitop3_b32 v4, v89, v91, s4 bitop3:0x7e
    v_bitop3_b32 v4, v4, v93, s4 bitop3:0xf6
    v_bitop3_b32 v4, v4, v95, s4 bitop3:0xf6
    v_bitop3_b32 v4, v4, v97, s4 bitop3:0xf6
    v_bitop3_b32 v4, v4, v99, s4 bitop3:0xf6
    v_bitop3_b32 v4, v4, v101, s4 bitop3:0xf6
    v_bitop3_b32 v4, v4, v103, s4 bitop3:0xf6
    v_bitop3_b32 v4, v4, v105, s4 bitop3:0xf6
    v_bitop3_b32 v4, v4, v107, s4 bitop3:0xf6
    v_bitop3_b32 v4, v4, v109, s4 bitop3:0xf6
    v_bitop3_b32 v4, v4, v111, s4 bitop3:0xf6
    v_bitop3_b32 v4, v4, v113, s4 bitop3:0xf6
    v_bitop3_b32 v4, v4, v115, s4 bitop3:0xf6
    v_cmp_ne_u32 vcc, 0, v4
    s_cbranch_vccz PDONE_59
    s_add_u32 s5, s5, 1
    s_cmp_lt_u32 s5, 200000
    s_cbranch_scc1 POLL_58
PDONE_59:
    v_add_f32 v88, v88, v92
    v_add_f32 v90, v90, v94
    v_add_f32 v96, v96, v100
    v_add_f32 v98, v98, v102
    v_add_f32 v104, v104, v108
    v_add_f32 v106, v106, v110
    v_add_f32 v88, v88, v96
    v_add_f32 v90, v90, v98
    v_add_f32 v104, v104, v112
    v_add_f32 v106, v106, v114
    v_add_f32 v88, v88, v104
    v_add_f32 v89, v90, v106
    s_nop 1
    v_permlane32_swap_b32 v88, v89
    v_add_f32 v88, v88, v89
    s_nop 1
    v_add_f32_dpp v88, v88, v88 row_ror:8 row_mask:0xf bank_mask:0xf
    v_mov_b32 v89, v88
    s_nop 1
    v_permlane16_swap_b32 v88, v89
    v_add_f32 v89, v88, v89
    v_cvt_pk_bf16_f32 v88, 0, v89
    v_cvt_pk_bf16_f32 v89, 0, v89
    s_nop 1
    v_permlane32_swap_b32 v88, v89
    v_pk_mul_f32 v[88:89], v[88:89], v[204:205] op_sel_hi:[1,0]
    v_cvt_pk_bf16_f32 v88, 0, v88
    v_cvt_pk_bf16_f32 v89, 0, v89
    v_pk_add_f32 v[88:89], v[88:89], v[244:245]
    v_cvt_pk_bf16_f32 v88, 0, v88
    v_cvt_pk_bf16_f32 v89, 0, v89
    v_pk_mul_f32 v[88:89], v[88:89], v[206:207]
    v_cvt_pk_bf16_f32 v88, 0, v88
    v_cvt_pk_bf16_f32 v89, 0, v89
    v_pk_add_f32 v[88:89], v[88:89], v[246:247]
    v_cvt_pk_bf16_f32 v88, v88, v89
    s_mov_b64 exec, 0xff
    buffer_store_dword v88, v10, s[64:67], s82 offen
    s_mov_b64 exec, -1
L_FIN:
L_END:
    s_endpgm
.p2align 10
.fill 768, 4, 0xbf800000
.section .rodata,"a"
.p2align 6
.amdhsa_kernel adaLN_cond__linear_kernel_hedgehog__moe_arch_mod__prompt_kernel
  .amdhsa_next_free_vgpr 256
  .amdhsa_next_free_sgpr 102
  .amdhsa_accum_offset 256
  .amdhsa_group_segment_fixed_size 0
  .amdhsa_kernarg_size 112
  .amdhsa_user_sgpr_count 2
  .amdhsa_user_sgpr_kernarg_segment_ptr 1
  .amdhsa_system_sgpr_workgroup_id_x 1
  .amdhsa_float_denorm_mode_32 3
  .amdhsa_float_denorm_mode_16_64 3
.end_amdhsa_kernel
```

```asm
; @launch grid=(256,1,1) block=(512,1,1) lds=163840
.amdgcn_target "amdgcn-amd-amdhsa--gfx950"
.text
.globl adaLN_cond__linear_kernel_hedgehog__moe_arch_mod__prompt_kernel
.p2align 12
.type adaLN_cond__linear_kernel_hedgehog__moe_arch_mod__prompt_kernel,@function
adaLN_cond__linear_kernel_hedgehog__moe_arch_mod__prompt_kernel:
    s_load_dwordx16 s[68:83], s[0:1], 0
    s_load_dwordx8 s[84:91], s[0:1], 64
    s_load_dwordx2 s[32:33], s[0:1], 104
    s_cmp_ge_u32 s2, 256
    s_cbranch_scc1 L_END
    v_lshrrev_b32 v4, 6, v0
    v_and_b32 v1, 63, v0
    s_nop 0
    v_readfirstlane_b32 s3, v4
    v_lshlrev_b32 v2, 4, v1
    s_mov_b32 s38, 4194304
    s_mov_b32 s39, 0x20000
    s_mov_b32 s50, 12582912
    s_mov_b32 s51, 0x20000
    s_mov_b32 s34, 268435456
    s_mov_b32 s35, 0x20000
    s_mov_b32 s42, 6291456
    s_mov_b32 s43, 0x20000
    s_mov_b32 s46, 2097152
    s_mov_b32 s47, 0x20000
    s_mov_b32 s54, 7340032
    s_mov_b32 s55, 0x20000
    s_mov_b32 s58, 7340032
    s_mov_b32 s59, 0x20000
    s_mov_b32 s62, 7340032
    s_mov_b32 s63, 0x20000
    s_mov_b32 s66, 4194304
    s_mov_b32 s67, 0x20000
    s_mov_b32 s5, 0
    s_mov_b32 s6, 0xffff0000
    s_mov_b32 s7, 0x3fb8aa3b
    s_and_b32 s8, s2, 7
    s_lshr_b32 s9, s2, 3
    s_lshl3_add_u32 s93, s2, s3
    s_and_b32 s96, s8, 4
    s_lshr_b32 s97, s9, 2
    s_lshl1_add_u32 s10, s96, s97
    s_and_b32 s96, s8, 3
    s_and_b32 s97, s9, 3
    s_xor_b32 s98, s97, 2
    s_lshl2_add_u32 s11, s96, s98
    s_and_b32 s96, s8, 1
    s_and_b32 s97, s9, 7
    s_lshl3_add_u32 s12, s96, s97
    s_lshr_b32 s96, s8, 1
    s_lshr_b32 s97, s9, 3
    s_lshl2_add_u32 s21, s96, s97
    s_lshl_b32 s96, s2, 6
    s_add_u32 s97, s96, s3
    s_lshl_b32 s98, s97, 6
    s_add_u32 s92, s98, 1048576
    s_lshr_b32 s96, s8, 1
    s_lshl_b32 s97, s96, 8
    s_lshl3_add_u32 s98, s9, s97
    s_add_u32 s99, s98, s3
    s_lshl_b32 s96, s99, 12
    s_and_b32 s97, s8, 1
    s_lshl_b32 s98, s97, 10
    s_add_u32 s16, s96, s98
    v_and_b32 v8, 31, v1
    v_lshlrev_b32 v8, 4, v8
    v_lshrrev_b32 v9, 5, v1
    v_lshl_add_u32 v8, v9, 11, v8
    s_lshl3_add_u32 s96, s8, s3
    s_lshl_b32 s15, s96, 5
    s_mul_i32 s96, s15, 6144
    s_xor_b32 s97, s9, 1
    s_lshl_b32 s98, s97, 7
    s_add_u32 s13, s96, s98
    s_add_u32 s14, s13, 12288
    s_lshl3_add_u32 s96, s21, s3
    s_lshl_b32 s97, s96, 15
    s_lshl_b32 s98, s12, 7
    s_add_u32 s18, s97, s98
    s_lshr_b32 s96, s8, 1
    s_lshl4_add_u32 s97, s96, s12
    s_lshl4_add_u32 s98, s97, s3
    s_lshl_b32 s99, s98, 9
    s_add_u32 s17, s99, 524288
    v_lshrrev_b32 v248, 3, v1
    v_mul_u32_u24 v248, 24576, v248
    v_and_b32 v9, 7, v1
    v_lshl_add_u32 v248, v9, 4, v248
    v_lshrrev_b32 v249, 3, v1
    v_lshl_add_u32 v249, v249, 2, s15
    v_and_b32 v10, 7, v1
    v_lshlrev_b32 v10, 4, v10
    v_lshrrev_b32 v11, 3, v1
    v_lshlrev_b32 v11, 4, v11
    v_xor_b32 v10, v10, v11
    v_lshrrev_b32 v11, 3, v1
    v_lshlrev_b32 v11, 11, v11
    v_add_u32 v10, v10, v11
    s_waitcnt lgkmcnt(0)
    global_load_dword v169, v249, s[86:87]
    s_mov_b64 s[48:49], s[88:89]
    buffer_load_dwordx4 v[160:163], v248, s[48:51], s13 offen nt
    buffer_load_dwordx4 v[164:167], v248, s[48:51], s14 offen nt
    s_load_dword s4, s[32:33], 0
    s_mov_b64 s[36:37], s[68:69]
    s_load_dword s24, s[32:33], s92 offset:0 glc
    s_load_dword s25, s[32:33], s17 offset:508 glc
    s_load_dword s26, s[32:33], s17 offset:4604 glc
    s_barrier
    buffer_load_dwordx4 v[152:155], v8, s[36:39], s16 offen nt
    buffer_load_dwordx4 v[156:159], v8, s[36:39], s16 offen offset:512 nt
    s_mov_b64 s[40:41], s[70:71]
    s_mov_b64 s[44:45], s[74:75]
    s_mov_b64 s[52:53], s[80:81]
    s_mov_b64 s[56:57], s[82:83]
    s_mov_b64 s[60:61], s[84:85]
    s_mov_b64 s[64:65], s[90:91]
    s_getpc_b64 s[22:23]
    s_and_b32 s22, s22, 0xfffffc00
    s_lshl3_add_u32 s96, s9, s3
    s_lshl_b32 s19, s96, 7
    v_lshrrev_b32 v4, 5, v1
    v_lshl_add_u32 v4, v4, 15, s19
    v_min_u32 v4, 41984, v4
    global_load_dword v11, v4, s[22:23]
    s_lshr_b32 s76, s3, 2
    s_and_b32 s77, s3, 3
    s_lshl_b32 s83, s3, 10
    s_mul_i32 s96, s8, 7
    s_lshr_b32 s97, s9, 2
    s_add_u32 s74, s96, s97
    s_and_b32 s75, s9, 3
    v_bfe_u32 v6, v1, 4, 1
    v_lshlrev_b32 v6, 6, v6
    v_and_b32 v3, 7, v1
    v_lshlrev_b32 v3, 4, v3
    v_xor_b32 v3, v3, v6
    v_lshrrev_b32 v6, 3, v1
    v_mul_u32_u24 v6, 6144, v6
    v_add_u32 v3, v3, v6
    s_and_b32 s84, s9, 12
    s_mul_i32 s96, s3, 49152
    s_lshl_b32 s97, s11, 7
    s_add_u32 s85, s96, s97
    v_lshlrev_b32 v250, 3, v1
    v_add_u32 v251, 147456, v2
    s_lshr_b32 s96, s3, 2
    s_lshl_b32 s97, s96, 10
    s_add_u32 s13, s97, 147456
    s_and_b32 s14, s3, 3
    v_and_b32 v252, 3, v1
    v_xor_b32 v252, s14, v252
    v_lshl_add_u32 v252, v252, 2, s13
    v_lshrrev_b32 v6, 4, v1
    v_lshlrev_b32 v6, 5, v6
    v_and_b32 v9, 7, v1
    v_lshl_add_u32 v6, v9, 7, v6
    v_bfe_u32 v9, v1, 3, 1
    v_lshl_add_u32 v6, v9, 4, v6
    v_add_u32 v252, v252, v6
    s_lshl_b32 s96, s3, 11
    s_add_u32 m0, s96, 131072
    s_nop 0
    buffer_load_dwordx4 v10, s[36:39], s18 offen lds
    s_add_u32 s18, s18, 16384
    s_lshl_b32 s96, s3, 11
    s_add_u32 m0, s96, 132096
    s_nop 0
    buffer_load_dwordx4 v10, s[36:39], s18 offen lds
    s_lshr_b32 s96, s3, 1
    s_xor_b32 s97, s9, 1
    s_and_b32 s98, s97, 15
    s_lshl4_add_u32 s99, s96, s98
    s_lshr_b32 s97, s9, 4
    s_lshl1_add_u32 s96, s99, s97
    s_lshl3_add_u32 s98, s96, s8
    s_lshl_b32 s99, s98, 9
    s_add_u32 s13, s99, 524288
    s_and_b32 s96, s9, 24
    s_add_u32 s97, s96, s3
    s_and_b32 s98, s8, 6
    s_lshl3_add_u32 s99, s97, s98
    s_lshl_b32 s96, s99, 12
    s_and_b32 s97, s9, 7
    s_lshl_b32 s98, s97, 9
    s_add_u32 s99, s96, s98
    s_and_b32 s97, s8, 1
    s_lshl_b32 s96, s97, 8
    s_add_u32 s98, s99, s96
    s_add_u32 s20, s98, 2097152
    s_waitcnt vmcnt(7)
    v_lshlrev_b32 v168, 16, v169
    v_and_b32 v169, s6, v169
    v_mul_f32 v4, s7, v168
    v_exp_f32 v4, -v4
    s_nop 0
    v_add_f32 v4, 1.0, v4
    v_rcp_f32 v4, v4
    s_nop 0
    v_mul_f32 v168, v168, v4
    v_cvt_pk_bf16_f32 v168, 0, v168
    v_mul_f32 v5, s7, v169
    v_exp_f32 v5, -v5
    s_nop 0
    v_add_f32 v5, 1.0, v5
    v_rcp_f32 v5, v5
    s_nop 0
    v_mul_f32 v169, v169, v5
    v_cvt_pk_bf16_f32 v169, 0, v169
    s_waitcnt vmcnt(5)
    s_lshr_b32 s96, s9, 4
    s_lshl_b32 s94, s96, 1
    s_add_u32 s96, s94, s84
    s_and_b32 s97, s96, 15
    s_mul_i32 s98, s97, 393216
    s_add_u32 s91, s98, s85
    s_lshl_b32 s96, s94, 13
    s_add_u32 s94, s96, s83
    s_add_u32 s82, s91, 2048
    s_mov_b32 m0, s94
    s_nop 0
    buffer_load_dwordx4 v3, s[40:43], s82 offen lds
    s_add_u32 s82, s91, 4096
    s_add_u32 m0, s94, 49152
    s_nop 0
    buffer_load_dwordx4 v3, s[40:43], s82 offen lds
    v_lshlrev_b32 v4, 16, v160
    v_and_b32 v5, s6, v160
    v_pk_mul_f32 v[176:177], v[168:169], v[4:5] op_sel:[0,0] op_sel_hi:[0,1]
    v_lshlrev_b32 v6, 16, v161
    v_and_b32 v7, s6, v161
    v_pk_mul_f32 v[178:179], v[168:169], v[6:7] op_sel:[0,0] op_sel_hi:[0,1]
    v_lshlrev_b32 v4, 16, v162
    v_and_b32 v5, s6, v162
    v_pk_mul_f32 v[180:181], v[168:169], v[4:5] op_sel:[0,0] op_sel_hi:[0,1]
    v_lshlrev_b32 v6, 16, v163
    v_and_b32 v7, s6, v163
    v_pk_mul_f32 v[182:183], v[168:169], v[6:7] op_sel:[0,0] op_sel_hi:[0,1]
    v_lshlrev_b32 v4, 16, v164
    v_and_b32 v5, s6, v164
    v_pk_fma_f32 v[176:177], v[168:169], v[4:5], v[176:177] op_sel:[1,0,0] op_sel_hi:[1,1,1]
    v_lshlrev_b32 v6, 16, v165
    v_and_b32 v7, s6, v165
    v_pk_fma_f32 v[178:179], v[168:169], v[6:7], v[178:179] op_sel:[1,0,0] op_sel_hi:[1,1,1]
    v_lshlrev_b32 v4, 16, v166
    v_and_b32 v5, s6, v166
    v_pk_fma_f32 v[180:181], v[168:169], v[4:5], v[180:181] op_sel:[1,0,0] op_sel_hi:[1,1,1]
    v_lshlrev_b32 v6, 16, v167
    v_and_b32 v7, s6, v167
    v_pk_fma_f32 v[182:183], v[168:169], v[6:7], v[182:183] op_sel:[1,0,0] op_sel_hi:[1,1,1]
    v_permlane32_swap_b32 v176, v180
    v_permlane32_swap_b32 v177, v181
    v_permlane32_swap_b32 v178, v182
    v_permlane32_swap_b32 v179, v183
    v_add_f32 v176, v176, v180
    v_add_f32 v177, v177, v181
    v_add_f32 v178, v178, v182
    v_add_f32 v179, v179, v183
    s_nop 0
    v_permlane16_swap_b32 v176, v178
    v_permlane16_swap_b32 v177, v179
    v_add_f32 v176, v176, v178
    v_add_f32 v177, v177, v179
    s_nop 0
    v_add_f32_dpp v176, v176, v176 row_ror:8 row_mask:0xf bank_mask:0xf
    v_add_f32_dpp v177, v177, v177 row_ror:8 row_mask:0xf bank_mask:0xf
    s_nop 1
    v_mov_b32_dpp v176, v177 quad_perm:[0,1,2,3] row_mask:0xf bank_mask:0xc
    s_waitcnt lgkmcnt(0)
    s_mul_i32 s4, s4, 0x9e3779b1
    s_add_u32 s4, s4, 0x7f4a7c15
    ds_write_b32 v252, v176
    s_waitcnt lgkmcnt(0)
    s_barrier
    ds_read_b128 v[176:179], v251
    ds_read_b128 v[180:183], v251 offset:1024
    s_waitcnt lgkmcnt(0)
    v_pk_add_f32 v[176:177], v[176:177], v[178:179]
    v_pk_add_f32 v[180:181], v[180:181], v[182:183]
    v_pk_add_f32 v[176:177], v[176:177], v[180:181]
    v_add_f32 v176, v176, v177
    v_mov_b32 v177, s4
    s_bitcmp1_b32 s3, 0
    s_cselect_b32 exec_lo, 0, -1
    s_cselect_b32 exec_hi, -1, 0
    buffer_store_dwordx2 v[176:177], v250, s[32:35], s13 offen sc1
    s_mov_b64 exec, -1
    s_waitcnt vmcnt(6)
    v_mov_b32 v8, 0x3f803f80
    v_dot2_f32_bf16 v4, v152, v8, 0
    v_dot2_f32_bf16 v5, v152, v152, 0
    v_dot2_f32_bf16 v6, v153, v8, 0
    v_dot2_f32_bf16 v7, v153, v153, 0
    v_dot2_f32_bf16 v4, v154, v8, v4
    v_dot2_f32_bf16 v5, v154, v154, v5
    v_dot2_f32_bf16 v6, v155, v8, v6
    v_dot2_f32_bf16 v7, v155, v155, v7
    v_dot2_f32_bf16 v4, v156, v8, v4
    v_dot2_f32_bf16 v5, v156, v156, v5
    v_dot2_f32_bf16 v6, v157, v8, v6
    v_dot2_f32_bf16 v7, v157, v157, v7
    v_dot2_f32_bf16 v4, v158, v8, v4
    v_dot2_f32_bf16 v5, v158, v158, v5
    v_dot2_f32_bf16 v6, v159, v8, v6
    v_dot2_f32_bf16 v7, v159, v159, v7
    s_lshl_b32 s96, s3, 5
    s_add_u32 s13, s96, 153600
    v_lshrrev_b32 v8, 5, v1
    v_lshl_add_u32 v8, v8, 4, s13
    v_bfe_u32 v9, v1, 4, 1
    v_lshl_add_u32 v8, v9, 3, v8
    v_pk_add_f32 v[172:173], v[4:5], v[6:7]
    v_and_b32 v5, 15, v1
    v_lshlrev_b32 v5, 4, v5
    v_add_u32 v5, 153600, v5
    v_and_b32 v4, 15, v1
    v_lshlrev_b32 v4, 4, v4
    v_bfe_u32 v9, v1, 4, 1
    v_lshl_add_u32 v4, v9, 12, v4
    v_add_f32_dpp v172, v172, v172 quad_perm:[1,0,3,2] row_mask:0xf bank_mask:0xf
    v_add_f32_dpp v173, v173, v173 quad_perm:[1,0,3,2] row_mask:0xf bank_mask:0xf
    s_nop 0
    v_add_f32_dpp v172, v172, v172 quad_perm:[2,3,0,1] row_mask:0xf bank_mask:0xf
    v_add_f32_dpp v173, v173, v173 quad_perm:[2,3,0,1] row_mask:0xf bank_mask:0xf
    s_nop 0
    v_add_f32_dpp v172, v172, v172 row_half_mirror row_mask:0xf bank_mask:0xf
    v_add_f32_dpp v173, v173, v173 row_half_mirror row_mask:0xf bank_mask:0xf
    s_nop 0
    v_add_f32_dpp v172, v172, v172 row_mirror row_mask:0xf bank_mask:0xf
    v_add_f32_dpp v173, v173, v173 row_mirror row_mask:0xf bank_mask:0xf
    s_nop 1
    v_permlane16_swap_b32 v172, v173
    v_add_f32 v172, v172, v173
    v_mov_b32 v173, s4
    ds_write_b64 v8, v[172:173]
    s_waitcnt lgkmcnt(0)
    s_barrier
    ds_read_b128 v[172:175], v5
    s_waitcnt lgkmcnt(0)
    s_mov_b32 exec_hi, 0
    buffer_store_dwordx4 v[172:175], v4, s[32:35], s20 offen sc1
    s_mov_b32 exec_hi, -1
    s_mov_b32 s82, s91
    s_add_u32 m0, s94, 98304
    s_nop 0
    buffer_load_dwordx4 v3, s[40:43], s82 offen lds
    s_lshr_b32 s96, s9, 4
    s_lshl_b32 s97, s96, 1
    s_xor_b32 s94, s97, 1
    s_add_u32 s96, s94, s84
    s_and_b32 s97, s96, 15
    s_mul_i32 s98, s97, 393216
    s_add_u32 s91, s98, s85
    s_lshl_b32 s96, s94, 13
    s_add_u32 s94, s96, s83
    s_add_u32 s82, s91, 2048
    s_mov_b32 m0, s94
    s_nop 0
    buffer_load_dwordx4 v3, s[40:43], s82 offen lds
    s_load_dword s24, s[32:33], s17 offset:508 glc
    s_load_dword s25, s[32:33], s17 offset:4604 glc
    v_and_b32 v4, 31, v1
    v_lshlrev_b32 v4, 4, v4
    v_lshrrev_b32 v9, 5, v1
    v_lshl_add_u32 v4, v9, 12, v4
    s_and_b32 s14, s3, 3
    s_lshr_b32 s96, s3, 2
    s_lshl_b32 s97, s96, 10
    s_add_u32 s15, s97, 155648
    v_bfe_u32 v5, v1, 4, 1
    v_bfe_u32 v9, v1, 2, 1
    v_lshl_add_u32 v5, v9, 1, v5
    v_xor_b32 v5, s14, v5
    v_lshl_add_u32 v5, v5, 2, s15
    v_and_b32 v6, 1, v1
    v_lshlrev_b32 v6, 5, v6
    v_bfe_u32 v9, v1, 3, 2
    v_lshl_add_u32 v6, v9, 6, v6
    v_bfe_u32 v9, v1, 2, 1
    v_lshl_add_u32 v6, v9, 8, v6
    v_bfe_u32 v9, v1, 1, 1
    v_lshl_add_u32 v6, v9, 9, v6
    v_lshrrev_b32 v9, 5, v1
    v_lshl_add_u32 v6, v9, 11, v6
    v_add_u32 v5, v5, v6
    s_lshl3_add_u32 s96, s2, s3
    s_lshl_b32 s97, s96, 9
    s_add_u32 s14, s97, 2097152
    v_and_b32 v8, 31, v1
    v_lshlrev_b32 v8, 4, v8
    s_branch SCHK_2
SPOLL_1:
    s_load_dword s24, s[32:33], s17 offset:508 glc
    s_load_dword s25, s[32:33], s17 offset:4604 glc
SCHK_2:
    s_add_u32 s5, s5, 1
    s_cmp_ge_u32 s5, 200000
    s_waitcnt lgkmcnt(0)
    s_cbranch_scc1 SDONE_3
    s_cmp_lg_u32 s24, s4
    s_cbranch_scc1 SPOLL_1
    s_cmp_lg_u32 s25, s4
    s_cbranch_scc1 SPOLL_1
SDONE_3:
    buffer_load_dwordx4 v[176:179], v4, s[32:35], s17 offen sc1
    s_load_dword s24, s[32:33], s14 offset:252 glc
    s_load_dword s25, s[32:33], s14 offset:508 glc
    s_lshl_b32 s96, s3, 11
    s_add_u32 s15, s96, 131072
    v_lshrrev_b32 v216, 4, v1
    v_lshlrev_b32 v216, 4, v216
    v_and_b32 v217, 7, v1
    v_lshlrev_b32 v217, 4, v217
    v_xor_b32 v216, v216, v217
    v_and_b32 v217, 15, v1
    v_lshl_add_u32 v217, v217, 7, s15
    v_add_u32 v216, v216, v217
    v_xor_b32 v217, 64, v216
    s_waitcnt vmcnt(7)
    ds_read_b128 v[12:15], v216
    ds_read_b128 v[16:19], v217
    s_branch SCHK_6
SPOLL_5:
    s_load_dword s24, s[32:33], s14 offset:252 glc
    s_load_dword s25, s[32:33], s14 offset:508 glc
SCHK_6:
    s_add_u32 s5, s5, 1
    s_cmp_ge_u32 s5, 200000
    s_waitcnt lgkmcnt(0)
    s_cbranch_scc1 SDONE_7
    s_cmp_lg_u32 s24, s4
    s_cbranch_scc1 SPOLL_5
    s_cmp_lg_u32 s25, s4
    s_cbranch_scc1 SPOLL_5
SDONE_7:
    buffer_load_dwordx4 v[172:175], v8, s[32:35], s14 offen sc1
    s_add_u32 s82, s91, 4096
    s_add_u32 m0, s94, 49152
    s_nop 0
    buffer_load_dwordx4 v3, s[40:43], s82 offen lds
    s_mov_b32 s82, s91
    s_add_u32 m0, s94, 98304
    s_nop 0
    buffer_load_dwordx4 v3, s[40:43], s82 offen lds
    v_permlane32_swap_b32 v12, v14
    v_permlane32_swap_b32 v13, v15
    v_permlane32_swap_b32 v16, v18
    v_permlane32_swap_b32 v17, v19
    v_lshlrev_b32 v184, 16, v12
    v_and_b32 v185, s6, v12
    v_lshlrev_b32 v186, 16, v13
    v_and_b32 v187, s6, v13
    v_lshlrev_b32 v188, 16, v14
    v_and_b32 v189, s6, v14
    v_lshlrev_b32 v190, 16, v15
    v_and_b32 v191, s6, v15
    v_lshlrev_b32 v192, 16, v16
    v_and_b32 v193, s6, v16
    v_lshlrev_b32 v194, 16, v17
    v_and_b32 v195, s6, v17
    v_lshlrev_b32 v196, 16, v18
    v_and_b32 v197, s6, v18
    v_lshlrev_b32 v198, 16, v19
    v_and_b32 v199, s6, v19
    s_waitcnt vmcnt(3)
    v_bitop3_b32 v7, v177, v179, s4 bitop3:0x7e
    v_cmp_ne_u32 vcc, 0, v7
    s_cbranch_vccz TOK_8
POLL_9:
    buffer_load_dwordx4 v[176:179], v4, s[32:35], s17 offen sc1
    s_waitcnt vmcnt(0)
    v_bitop3_b32 v7, v177, v179, s4 bitop3:0x7e
    v_cmp_ne_u32 vcc, 0, v7
    s_cbranch_vccz PDONE_10
    s_add_u32 s5, s5, 1
    s_cmp_lt_u32 s5, 200000
    s_cbranch_scc1 POLL_9
PDONE_10:
TOK_8:
    ds_write2_b32 v5, v176, v178 offset0:0 offset1:4
    s_waitcnt lgkmcnt(0)
    s_barrier
    ds_read_b128 v[208:211], v251 offset:10240
    ds_read_b128 v[212:215], v251 offset:11264
    ds_read_b128 v[200:203], v251 offset:8192
    ds_read_b128 v[204:207], v251 offset:9216
    s_lshl_b32 s96, s11, 12
    s_lshl_b32 s97, s3, 9
    s_add_u32 s13, s96, s97
    v_add_u32 v4, s13, v2
    s_lshl_b32 s96, s3, 9
    s_add_u32 m0, s96, 159744
    s_mov_b32 exec_hi, 0
    global_load_lds_dwordx4 v4, s[72:73]
    s_mov_b32 exec_hi, -1
    s_lshl4_add_u32 s96, s21, s12
    s_lshr_b32 s97, s3, 1
    s_lshl2_add_u32 s98, s96, s97
    s_lshl_b32 s99, s98, 12
    s_and_b32 s96, s3, 1
    s_lshl_b32 s97, s96, 8
    s_add_u32 s98, s99, s97
    s_add_u32 s13, s98, 4194304
    v_and_b32 v4, 15, v1
    v_lshlrev_b32 v4, 4, v4
    v_bfe_u32 v9, v1, 4, 1
    v_lshl_add_u32 v4, v9, 10, v4
    v_lshrrev_b32 v9, 5, v1
    v_lshl_add_u32 v4, v9, 9, v4
    s_waitcnt lgkmcnt(2)
    v_pk_add_f32 v[208:209], v[208:209], v[210:211]
    v_pk_add_f32 v[212:213], v[212:213], v[214:215]
    v_pk_add_f32 v[208:209], v[208:209], v[212:213]
    v_add_f32 v208, v208, v209
    v_cvt_pk_bf16_f32 v208, 0, v208
    s_waitcnt lgkmcnt(0)
    v_pk_add_f32 v[200:201], v[200:201], v[202:203]
    v_pk_add_f32 v[204:205], v[204:205], v[206:207]
    v_pk_add_f32 v[200:201], v[200:201], v[204:205]
    v_add_f32 v200, v200, v201
    v_add_f32 v208, 1.0, v208
    v_cvt_pk_bf16_f32 v208, 0, v208
    v_cvt_pk_bf16_f32 v200, 0, v200
    s_waitcnt vmcnt(3)
    v_bitop3_b32 v7, v173, v175, s4 bitop3:0x7e
    v_cmp_ne_u32 vcc, 0, v7
    s_cbranch_vccz L_STOK
POLL_11:
    buffer_load_dwordx4 v[172:175], v8, s[32:35], s14 offen sc1
    s_waitcnt vmcnt(0)
    v_bitop3_b32 v7, v173, v175, s4 bitop3:0x7e
    v_cmp_ne_u32 vcc, 0, v7
    s_cbranch_vccz PDONE_12
    s_add_u32 s5, s5, 1
    s_cmp_lt_u32 s5, 200000
    s_cbranch_scc1 POLL_11
PDONE_12:
L_STOK:
    v_permlane16_swap_b32 v172, v174
    v_add_f32 v175, v172, v174
    v_mul_f32 v174, 0x3a800000, v175
    v_mul_f32 v175, 0x3a800000, v175
    s_nop 1
    v_permlane16_swap_b32 v174, v175
    v_fma_f32 v172, -v174, v174, v175
    v_cvt_pk_bf16_f32 v173, 0, v174
    v_max_f32 v172, 0, v172
    v_cvt_pk_bf16_f32 v172, 0, v172
    v_pk_add_f32 v[184:185], v[172:173], v[184:185] op_sel:[1,0] neg_lo:[1,0] neg_hi:[1,0]
    v_pk_add_f32 v[186:187], v[172:173], v[186:187] op_sel:[1,0] neg_lo:[1,0] neg_hi:[1,0]
    v_pk_add_f32 v[188:189], v[172:173], v[188:189] op_sel:[1,0] neg_lo:[1,0] neg_hi:[1,0]
    v_pk_add_f32 v[190:191], v[172:173], v[190:191] op_sel:[1,0] neg_lo:[1,0] neg_hi:[1,0]
    v_add_f32 v172, 0x3727c5ac, v172
    v_cvt_pk_bf16_f32 v172, 0, v172
    v_sqrt_f32 v172, v172
    s_nop 0
    v_pk_add_f32 v[192:193], v[172:173], v[192:193] op_sel:[1,0] neg_lo:[1,0] neg_hi:[1,0]
    v_pk_add_f32 v[194:195], v[172:173], v[194:195] op_sel:[1,0] neg_lo:[1,0] neg_hi:[1,0]
    v_pk_add_f32 v[196:197], v[172:173], v[196:197] op_sel:[1,0] neg_lo:[1,0] neg_hi:[1,0]
    v_pk_add_f32 v[198:199], v[172:173], v[198:199] op_sel:[1,0] neg_lo:[1,0] neg_hi:[1,0]
    v_cvt_pk_bf16_f32 v172, 0, v172
    v_rcp_f32 v172, v172
    v_cvt_pk_bf16_f32 v184, 0, v184
    v_cvt_pk_bf16_f32 v185, 0, v185
    v_cvt_pk_bf16_f32 v186, 0, v186
    v_cvt_pk_bf16_f32 v187, 0, v187
    v_cvt_pk_bf16_f32 v188, 0, v188
    v_cvt_pk_bf16_f32 v189, 0, v189
    v_cvt_pk_bf16_f32 v190, 0, v190
    v_cvt_pk_bf16_f32 v191, 0, v191
    v_cvt_pk_bf16_f32 v192, 0, v192
    v_cvt_pk_bf16_f32 v193, 0, v193
    v_cvt_pk_bf16_f32 v194, 0, v194
    v_cvt_pk_bf16_f32 v195, 0, v195
    v_cvt_pk_bf16_f32 v196, 0, v196
    v_cvt_pk_bf16_f32 v197, 0, v197
    v_cvt_pk_bf16_f32 v198, 0, v198
    v_cvt_pk_bf16_f32 v199, 0, v199
    v_pk_mul_f32 v[184:185], v[184:185], v[172:173] op_sel_hi:[1,0]
    v_pk_mul_f32 v[186:187], v[186:187], v[172:173] op_sel_hi:[1,0]
    v_pk_mul_f32 v[188:189], v[188:189], v[172:173] op_sel_hi:[1,0]
    v_pk_mul_f32 v[190:191], v[190:191], v[172:173] op_sel_hi:[1,0]
    v_pk_mul_f32 v[192:193], v[192:193], v[172:173] op_sel_hi:[1,0]
    v_pk_mul_f32 v[194:195], v[194:195], v[172:173] op_sel_hi:[1,0]
    v_pk_mul_f32 v[196:197], v[196:197], v[172:173] op_sel_hi:[1,0]
    v_pk_mul_f32 v[198:199], v[198:199], v[172:173] op_sel_hi:[1,0]
    v_cvt_pk_bf16_f32 v184, 0, v184
    v_cvt_pk_bf16_f32 v185, 0, v185
    v_cvt_pk_bf16_f32 v186, 0, v186
    v_cvt_pk_bf16_f32 v187, 0, v187
    v_cvt_pk_bf16_f32 v188, 0, v188
    v_cvt_pk_bf16_f32 v189, 0, v189
    v_cvt_pk_bf16_f32 v190, 0, v190
    v_cvt_pk_bf16_f32 v191, 0, v191
    v_cvt_pk_bf16_f32 v192, 0, v192
    v_cvt_pk_bf16_f32 v193, 0, v193
    v_cvt_pk_bf16_f32 v194, 0, v194
    v_cvt_pk_bf16_f32 v195, 0, v195
    v_cvt_pk_bf16_f32 v196, 0, v196
    v_cvt_pk_bf16_f32 v197, 0, v197
    v_cvt_pk_bf16_f32 v198, 0, v198
    v_cvt_pk_bf16_f32 v199, 0, v199
    v_mul_f32_dpp v184, v208, v184 row_newbcast:0 row_mask:0xf bank_mask:0xf
    v_mul_f32_dpp v185, v208, v185 row_newbcast:1 row_mask:0xf bank_mask:0xf
    v_mul_f32_dpp v186, v208, v186 row_newbcast:2 row_mask:0xf bank_mask:0xf
    v_mul_f32_dpp v187, v208, v187 row_newbcast:3 row_mask:0xf bank_mask:0xf
    v_mul_f32_dpp v188, v208, v188 row_newbcast:4 row_mask:0xf bank_mask:0xf
    v_mul_f32_dpp v189, v208, v189 row_newbcast:5 row_mask:0xf bank_mask:0xf
    v_mul_f32_dpp v190, v208, v190 row_newbcast:6 row_mask:0xf bank_mask:0xf
    v_mul_f32_dpp v191, v208, v191 row_newbcast:7 row_mask:0xf bank_mask:0xf
    v_cvt_pk_bf16_f32 v184, 0, v184
    v_cvt_pk_bf16_f32 v185, 0, v185
    v_cvt_pk_bf16_f32 v186, 0, v186
    v_cvt_pk_bf16_f32 v187, 0, v187
    v_cvt_pk_bf16_f32 v188, 0, v188
    v_cvt_pk_bf16_f32 v189, 0, v189
    v_cvt_pk_bf16_f32 v190, 0, v190
    v_cvt_pk_bf16_f32 v191, 0, v191
    v_add_f32_dpp v184, v200, v184 row_newbcast:0 row_mask:0xf bank_mask:0xf
    v_add_f32_dpp v185, v200, v185 row_newbcast:1 row_mask:0xf bank_mask:0xf
    v_add_f32_dpp v186, v200, v186 row_newbcast:2 row_mask:0xf bank_mask:0xf
    v_add_f32_dpp v187, v200, v187 row_newbcast:3 row_mask:0xf bank_mask:0xf
    v_add_f32_dpp v188, v200, v188 row_newbcast:4 row_mask:0xf bank_mask:0xf
    v_add_f32_dpp v189, v200, v189 row_newbcast:5 row_mask:0xf bank_mask:0xf
    v_add_f32_dpp v190, v200, v190 row_newbcast:6 row_mask:0xf bank_mask:0xf
    v_add_f32_dpp v191, v200, v191 row_newbcast:7 row_mask:0xf bank_mask:0xf
    v_cvt_pk_bf16_f32 v216, v184, v185
    v_cvt_pk_bf16_f32 v217, v186, v187
    v_cvt_pk_bf16_f32 v218, v188, v189
    v_cvt_pk_bf16_f32 v219, v190, v191
    buffer_store_dwordx4 v[216:219], v4, s[32:35], s13 offen sc1
    v_mul_f32_dpp v192, v208, v192 row_newbcast:8 row_mask:0xf bank_mask:0xf
    v_mul_f32_dpp v193, v208, v193 row_newbcast:9 row_mask:0xf bank_mask:0xf
    v_mul_f32_dpp v194, v208, v194 row_newbcast:10 row_mask:0xf bank_mask:0xf
    v_mul_f32_dpp v195, v208, v195 row_newbcast:11 row_mask:0xf bank_mask:0xf
    v_mul_f32_dpp v196, v208, v196 row_newbcast:12 row_mask:0xf bank_mask:0xf
    v_mul_f32_dpp v197, v208, v197 row_newbcast:13 row_mask:0xf bank_mask:0xf
    v_mul_f32_dpp v198, v208, v198 row_newbcast:14 row_mask:0xf bank_mask:0xf
    v_mul_f32_dpp v199, v208, v199 row_newbcast:15 row_mask:0xf bank_mask:0xf
    v_cvt_pk_bf16_f32 v192, 0, v192
    v_cvt_pk_bf16_f32 v193, 0, v193
    v_cvt_pk_bf16_f32 v194, 0, v194
    v_cvt_pk_bf16_f32 v195, 0, v195
    v_cvt_pk_bf16_f32 v196, 0, v196
    v_cvt_pk_bf16_f32 v197, 0, v197
    v_cvt_pk_bf16_f32 v198, 0, v198
    v_cvt_pk_bf16_f32 v199, 0, v199
    v_add_f32_dpp v192, v200, v192 row_newbcast:8 row_mask:0xf bank_mask:0xf
    v_add_f32_dpp v193, v200, v193 row_newbcast:9 row_mask:0xf bank_mask:0xf
    v_add_f32_dpp v194, v200, v194 row_newbcast:10 row_mask:0xf bank_mask:0xf
    v_add_f32_dpp v195, v200, v195 row_newbcast:11 row_mask:0xf bank_mask:0xf
    v_add_f32_dpp v196, v200, v196 row_newbcast:12 row_mask:0xf bank_mask:0xf
    v_add_f32_dpp v197, v200, v197 row_newbcast:13 row_mask:0xf bank_mask:0xf
    v_add_f32_dpp v198, v200, v198 row_newbcast:14 row_mask:0xf bank_mask:0xf
    v_add_f32_dpp v199, v200, v199 row_newbcast:15 row_mask:0xf bank_mask:0xf
    v_cvt_pk_bf16_f32 v220, v192, v193
    v_cvt_pk_bf16_f32 v221, v194, v195
    v_cvt_pk_bf16_f32 v222, v196, v197
    v_cvt_pk_bf16_f32 v223, v198, v199
    buffer_store_dwordx4 v[220:223], v4, s[32:35], s13 offen offset:2048 sc1
    v_bfe_u32 v20, v1, 2, 2
    v_lshlrev_b32 v20, 7, v20
    v_bfe_u32 v9, v1, 3, 1
    v_lshl_add_u32 v20, v9, 6, v20
    v_bfe_u32 v9, v1, 4, 1
    v_lshl_add_u32 v20, v9, 5, v20
    v_and_b32 v9, 3, v1
    v_lshl_add_u32 v20, v9, 3, v20
    v_lshrrev_b32 v9, 5, v1
    v_lshl_add_u32 v20, v9, 9, v20
    v_xor_b32 v21, 64, v20
    v_add_u32 v22, 49152, v20
    v_add_u32 v23, 49152, v21
    v_add_u32 v24, 98304, v20
    v_add_u32 v25, 98304, v21
    v_and_b32 v5, 3, v1
    v_lshlrev_b32 v5, 15, v5
    v_bfe_u32 v9, v1, 2, 2
    v_lshl_add_u32 v5, v9, 12, v5
    s_and_b32 s96, s12, 1
    s_lshr_b32 s97, s21, 3
    s_and_b32 s98, s21, 7
    s_lshl_b32 s99, s98, 5
    s_lshl2_add_u32 s98, s97, s99
    s_lshl_b32 s97, s98, 12
    s_lshr_b32 s99, s12, 1
    s_lshl_b32 s98, s99, 6
    s_add_u32 s99, s97, s98
    s_lshl2_add_u32 s97, s96, s99
    s_add_u32 s13, s97, 1048576
    s_lshl_b32 s96, s10, 18
    s_lshl_b32 s97, s77, 12
    s_add_u32 s98, s96, s97
    s_add_u32 s88, s98, 4194304
    s_cmp_ge_u32 s9, 28
    s_cselect_b32 s54, 0, s54
    s_cselect_b32 s58, 0, s58
    s_cselect_b32 s62, 0, s62
    s_waitcnt vmcnt(0)
    s_barrier
    s_cmp_lg_u32 s3, 0
    s_cbranch_scc1 L_PB
    v_mov_b32 v6, s4
    s_mov_b32 exec_hi, 0
    s_mov_b32 exec_lo, 65535
    buffer_store_dword v6, v5, s[32:35], s13 offen sc1
    s_mov_b64 exec, -1
L_PB:
    s_lshr_b32 s96, s9, 4
    s_lshl_b32 s97, s96, 1
    s_xor_b32 s94, s97, 2
    s_add_u32 s96, s94, s84
    s_and_b32 s97, s96, 15
    s_mul_i32 s98, s97, 393216
    s_add_u32 s91, s98, s85
    s_lshl_b32 s96, s94, 13
    s_add_u32 s94, s96, s83
    s_add_u32 s82, s91, 2048
    s_mov_b32 m0, s94
    s_nop 0
    buffer_load_dwordx4 v3, s[40:43], s82 offen lds
    s_add_u32 s82, s91, 4096
    s_add_u32 m0, s94, 49152
    s_nop 0
    buffer_load_dwordx4 v3, s[40:43], s82 offen lds
    s_mov_b32 s82, s91
    s_add_u32 m0, s94, 98304
    s_nop 0
    buffer_load_dwordx4 v3, s[40:43], s82 offen lds
    s_lshr_b32 s96, s9, 4
    s_lshl_b32 s97, s96, 1
    s_xor_b32 s94, s97, 3
    s_add_u32 s96, s94, s84
    s_and_b32 s97, s96, 15
    s_mul_i32 s98, s97, 393216
    s_add_u32 s91, s98, s85
    s_lshl_b32 s96, s94, 13
    s_add_u32 s94, s96, s83
    s_add_u32 s82, s91, 2048
    s_mov_b32 m0, s94
    s_nop 0
    buffer_load_dwordx4 v3, s[40:43], s82 offen lds
    s_add_u32 s82, s91, 4096
    s_add_u32 m0, s94, 49152
    s_nop 0
    buffer_load_dwordx4 v3, s[40:43], s82 offen lds
    s_mov_b32 s82, s91
    s_add_u32 m0, s94, 98304
    s_nop 0
    buffer_load_dwordx4 v3, s[40:43], s82 offen lds
    s_lshl_b32 s96, s2, 12
    s_add_u32 s19, s96, 1048576
    s_and_b32 s96, s3, 3
    s_lshl_b32 s97, s96, 7
    s_add_u32 s20, s97, s19
    s_lshl_b32 s96, s84, 5
    s_add_u32 s19, s96, s19
    s_cmp_ge_u32 s3, 4
    s_cselect_b32 s19, s20, s19
    s_load_dwordx2 s[24:25], s[32:33], s19 offset:0 glc
    s_load_dwordx2 s[26:27], s[32:33], s19 offset:64 glc
    s_lshl_b32 s96, s3, 14
    s_lshl_b32 s97, s12, 7
    s_add_u32 s90, s96, s97
    s_and_b32 s96, s9, 1
    s_lshr_b32 s97, s9, 3
    s_lshl_b32 s98, s97, 1
    s_lshl3_add_u32 s99, s96, s98
    s_lshl_b32 s95, s99, 17
    s_lshl3_add_u32 s96, s75, s3
    s_mul_i32 s97, s96, 229376
    s_lshl_b32 s98, s74, 7
    s_add_u32 s80, s97, s98
    s_lshl3_add_u32 s96, s74, s3
    s_lshl_b32 s97, s96, 14
    s_lshl_b32 s98, s75, 9
    s_add_u32 s81, s97, s98
    s_and_b32 s96, s8, 3
    s_lshl3_add_u32 s97, s96, s3
    s_mul_i32 s98, s97, 393216
    s_lshr_b32 s99, s8, 2
    s_lshl1_add_u32 s96, s9, s99
    s_lshl_b32 s97, s96, 7
    s_add_u32 s99, s98, s97
    s_add_u32 s89, s99, 4096
    s_and_b32 s96, s3, 1
    s_lshl_b32 s14, s96, 6
    v_bfe_u32 v6, v1, 4, 1
    v_lshl_add_u32 v6, v6, 5, s14
    v_and_b32 v26, 7, v1
    v_lshlrev_b32 v26, 4, v26
    v_xor_b32 v26, v26, v6
    v_lshrrev_b32 v6, 3, v1
    v_lshlrev_b32 v6, 11, v6
    v_add_u32 v26, v26, v6
    s_and_b32 s96, s3, 2
    s_lshl_b32 s14, s96, 5
    v_bfe_u32 v6, v1, 4, 1
    v_lshl_add_u32 v6, v6, 5, s14
    v_and_b32 v27, 7, v1
    v_lshlrev_b32 v27, 4, v27
    v_xor_b32 v27, v27, v6
    v_lshrrev_b32 v6, 3, v1
    v_mul_u32_u24 v6, 7168, v6
    v_add_u32 v27, v27, v6
    s_and_b32 s96, s3, 1
    s_lshl_b32 s14, s96, 7
    v_lshrrev_b32 v6, 5, v1
    v_lshl_add_u32 v6, v6, 6, s14
    v_and_b32 v253, 31, v1
    v_lshlrev_b32 v253, 4, v253
    v_lshrrev_b32 v9, 5, v1
    v_lshl_add_u32 v253, v9, 11, v253
    v_xor_b32 v253, v253, v6
    s_lshl_b32 s16, s84, 14
    v_add_u32 v249, s88, v2
    s_lshl_b32 s96, s77, 11
    s_add_u32 s14, s96, 151552
    v_add_u32 v0, s14, v2
    s_mov_b64 exec, 0
    s_cmp_eq_u32 s3, 4
    s_cbranch_scc1 L_PAD2
    s_cmp_eq_u32 s3, 5
    s_cbranch_scc1 L_PAD3
    s_cmp_eq_u32 s3, 6
    s_cbranch_scc1 L_PAD4
    s_cmp_eq_u32 s3, 7
    s_cbranch_scc1 L_PAD5
    s_branch L_TEND
L_RET2:
    s_branch L_PAD6
L_RET6:
    s_branch L_PAD10
L_RET10:
    s_branch L_TEND
L_RET3:
    s_branch L_PAD7
L_RET7:
    s_branch L_TEND
L_RET4:
    s_branch L_PAD8
L_RET8:
    s_branch L_TEND
L_RET5:
    s_branch L_PAD9
L_RET9:
    s_branch L_TEND
    s_nop 0
    s_nop 0
    s_nop 0
    s_nop 0
    s_nop 0
    s_nop 0
    s_nop 0
    s_nop 0
    s_nop 0
    s_nop 0
    s_nop 0
    s_nop 0
    s_nop 0
    s_nop 0
    s_nop 0
    s_nop 0
    s_nop 0
    s_nop 0
    s_nop 0
    s_nop 0
    s_nop 0
    s_nop 0
    s_nop 0
    s_nop 0
    s_nop 0
    s_nop 0
    s_nop 0
    s_nop 0
L_TEND:
    s_mov_b64 exec, -1
    s_cmp_ge_u32 s3, 4
    s_cbranch_scc1 L_HELP
    s_branch SCHK_14
SPOLL_13:
    s_load_dwordx2 s[24:25], s[32:33], s19 offset:0 glc
    s_load_dwordx2 s[26:27], s[32:33], s19 offset:64 glc
SCHK_14:
    s_add_u32 s5, s5, 1
    s_cmp_ge_u32 s5, 200000
    s_waitcnt lgkmcnt(0)
    s_cbranch_scc1 SDONE_15
    s_cmp_lg_u32 s24, s4
    s_cbranch_scc1 SPOLL_13
    s_cmp_lg_u32 s25, s4
    s_cbranch_scc1 SPOLL_13
    s_cmp_lg_u32 s26, s4
    s_cbranch_scc1 SPOLL_13
    s_cmp_lg_u32 s27, s4
    s_cbranch_scc1 SPOLL_13
SDONE_15:
    s_setprio 2
    buffer_load_dwordx4 v[152:155], v249, s[32:35], s16 offen sc1
    buffer_load_dwordx4 v[156:159], v249, s[32:35], s16 offen offset:1024 sc1
    buffer_load_dwordx4 v[160:163], v249, s[32:35], s16 offen offset:2048 sc1
    buffer_load_dwordx4 v[164:167], v249, s[32:35], s16 offen offset:3072 sc1
    s_add_u32 s16, s16, 16384
    s_and_b32 s16, s16, 0x3ffff
    buffer_load_dwordx4 v[168:171], v249, s[32:35], s16 offen sc1
    buffer_load_dwordx4 v[172:175], v249, s[32:35], s16 offen offset:1024 sc1
    buffer_load_dwordx4 v[176:179], v249, s[32:35], s16 offen offset:2048 sc1
    buffer_load_dwordx4 v[180:183], v249, s[32:35], s16 offen offset:3072 sc1
    s_waitcnt vmcnt(8)
    s_barrier
    ds_read_b64_tr_b16 v[28:29], v20
    ds_read_b64_tr_b16 v[30:31], v20 offset:2048
    ds_read_b64_tr_b16 v[32:33], v21
    ds_read_b64_tr_b16 v[34:35], v21 offset:2048
    ds_read_b64_tr_b16 v[36:37], v24
    ds_read_b64_tr_b16 v[38:39], v24 offset:2048
    ds_read_b64_tr_b16 v[40:41], v25
    ds_read_b64_tr_b16 v[42:43], v25 offset:2048
    ds_read_b64_tr_b16 v[44:45], v22
    ds_read_b64_tr_b16 v[46:47], v22 offset:2048
    ds_read_b64_tr_b16 v[48:49], v23
    ds_read_b64_tr_b16 v[50:51], v23 offset:2048
    s_waitcnt vmcnt(7)
    s_waitcnt lgkmcnt(10)
    v_mfma_f32_32x32x16_bf16 v[56:71], v[28:31], v[152:155], 0
    s_add_u32 s16, s16, 16384
    ds_read_b64_tr_b16 v[52:53], v20 offset:1024
    ds_read_b64_tr_b16 v[54:55], v20 offset:3072
    s_waitcnt lgkmcnt(10)
    v_mfma_f32_32x32x16_bf16 v[72:87], v[32:35], v[152:155], 0
    s_and_b32 s16, s16, 0x3ffff
    ds_read_b64_tr_b16 v[28:29], v21 offset:1024
    ds_read_b64_tr_b16 v[30:31], v21 offset:3072
    s_waitcnt lgkmcnt(10)
    v_mfma_f32_32x32x16_bf16 v[120:135], v[36:39], v[152:155], 0
    ds_read_b64_tr_b16 v[32:33], v24 offset:1024
    ds_read_b64_tr_b16 v[34:35], v24 offset:3072
    s_waitcnt lgkmcnt(10)
    v_mfma_f32_32x32x16_bf16 v[136:151], v[40:43], v[152:155], 0
    buffer_load_dwordx4 v[184:187], v249, s[32:35], s16 offen sc1
    ds_read_b64_tr_b16 v[36:37], v25 offset:1024
    ds_read_b64_tr_b16 v[38:39], v25 offset:3072
    s_waitcnt lgkmcnt(10)
    v_mfma_f32_32x32x16_bf16 v[88:103], v[44:47], v[152:155], 0
    ds_read_b64_tr_b16 v[40:41], v22 offset:1024
    ds_read_b64_tr_b16 v[42:43], v22 offset:3072
    s_waitcnt lgkmcnt(10)
    v_mfma_f32_32x32x16_bf16 v[104:119], v[48:51], v[152:155], 0
    ds_read_b64_tr_b16 v[44:45], v23 offset:1024
    ds_read_b64_tr_b16 v[46:47], v23 offset:3072
    s_waitcnt vmcnt(7)
    s_waitcnt lgkmcnt(10)
    v_mfma_f32_32x32x16_bf16 v[56:71], v[52:55], v[156:159], v[56:71]
    ds_read_b64_tr_b16 v[48:49], v20 offset:4096
    ds_read_b64_tr_b16 v[50:51], v20 offset:6144
    s_waitcnt lgkmcnt(10)
    v_mfma_f32_32x32x16_bf16 v[72:87], v[28:31], v[156:159], v[72:87]
    buffer_load_dwordx4 v[188:191], v249, s[32:35], s16 offen offset:1024 sc1
    ds_read_b64_tr_b16 v[52:53], v21 offset:4096
    ds_read_b64_tr_b16 v[54:55], v21 offset:6144
    s_waitcnt lgkmcnt(10)
    v_mfma_f32_32x32x16_bf16 v[120:135], v[32:35], v[156:159], v[120:135]
    ds_read_b64_tr_b16 v[28:29], v24 offset:4096
    ds_read_b64_tr_b16 v[30:31], v24 offset:6144
    s_waitcnt lgkmcnt(10)
    v_mfma_f32_32x32x16_bf16 v[136:151], v[36:39], v[156:159], v[136:151]
    ds_read_b64_tr_b16 v[32:33], v25 offset:4096
    ds_read_b64_tr_b16 v[34:35], v25 offset:6144
    s_waitcnt lgkmcnt(10)
    v_mfma_f32_32x32x16_bf16 v[88:103], v[40:43], v[156:159], v[88:103]
    ds_read_b64_tr_b16 v[36:37], v22 offset:4096
    ds_read_b64_tr_b16 v[38:39], v22 offset:6144
    s_waitcnt lgkmcnt(10)
    v_mfma_f32_32x32x16_bf16 v[104:119], v[44:47], v[156:159], v[104:119]
    buffer_load_dwordx4 v[192:195], v249, s[32:35], s16 offen offset:2048 sc1
    ds_read_b64_tr_b16 v[40:41], v23 offset:4096
    ds_read_b64_tr_b16 v[42:43], v23 offset:6144
    s_waitcnt vmcnt(8)
    s_waitcnt lgkmcnt(10)
    v_mfma_f32_32x32x16_bf16 v[56:71], v[48:51], v[160:163], v[56:71]
    ds_read_b64_tr_b16 v[44:45], v20 offset:5120
    ds_read_b64_tr_b16 v[46:47], v20 offset:7168
    s_waitcnt lgkmcnt(10)
    v_mfma_f32_32x32x16_bf16 v[72:87], v[52:55], v[160:163], v[72:87]
    ds_read_b64_tr_b16 v[48:49], v21 offset:5120
    ds_read_b64_tr_b16 v[50:51], v21 offset:7168
    s_waitcnt lgkmcnt(10)
    v_mfma_f32_32x32x16_bf16 v[120:135], v[28:31], v[160:163], v[120:135]
    ds_read_b64_tr_b16 v[52:53], v24 offset:5120
    ds_read_b64_tr_b16 v[54:55], v24 offset:7168
    s_waitcnt lgkmcnt(10)
    v_mfma_f32_32x32x16_bf16 v[136:151], v[32:35], v[160:163], v[136:151]
    buffer_load_dwordx4 v[196:199], v249, s[32:35], s16 offen offset:3072 sc1
    ds_read_b64_tr_b16 v[28:29], v25 offset:5120
    ds_read_b64_tr_b16 v[30:31], v25 offset:7168
    s_waitcnt lgkmcnt(10)
    v_mfma_f32_32x32x16_bf16 v[88:103], v[36:39], v[160:163], v[88:103]
    s_add_u32 s16, s16, 16384
    ds_read_b64_tr_b16 v[32:33], v22 offset:5120
    ds_read_b64_tr_b16 v[34:35], v22 offset:7168
    s_waitcnt lgkmcnt(10)
    v_mfma_f32_32x32x16_bf16 v[104:119], v[40:43], v[160:163], v[104:119]
    s_and_b32 s16, s16, 0x3ffff
    ds_read_b64_tr_b16 v[36:37], v23 offset:5120
    ds_read_b64_tr_b16 v[38:39], v23 offset:7168
    s_waitcnt vmcnt(8)
    s_waitcnt lgkmcnt(10)
    v_mfma_f32_32x32x16_bf16 v[56:71], v[44:47], v[164:167], v[56:71]
    ds_read_b64_tr_b16 v[40:41], v20 offset:8192
    ds_read_b64_tr_b16 v[42:43], v20 offset:10240
    s_waitcnt lgkmcnt(10)
    v_mfma_f32_32x32x16_bf16 v[72:87], v[48:51], v[164:167], v[72:87]
    buffer_load_dwordx4 v[200:203], v249, s[32:35], s16 offen sc1
    ds_read_b64_tr_b16 v[44:45], v21 offset:8192
    ds_read_b64_tr_b16 v[46:47], v21 offset:10240
    s_waitcnt lgkmcnt(10)
    v_mfma_f32_32x32x16_bf16 v[120:135], v[52:55], v[164:167], v[120:135]
    ds_read_b64_tr_b16 v[48:49], v24 offset:8192
    ds_read_b64_tr_b16 v[50:51], v24 offset:10240
    s_waitcnt lgkmcnt(10)
    v_mfma_f32_32x32x16_bf16 v[136:151], v[28:31], v[164:167], v[136:151]
    ds_read_b64_tr_b16 v[52:53], v25 offset:8192
    ds_read_b64_tr_b16 v[54:55], v25 offset:10240
    s_waitcnt lgkmcnt(10)
    v_mfma_f32_32x32x16_bf16 v[88:103], v[32:35], v[164:167], v[88:103]
    ds_read_b64_tr_b16 v[28:29], v22 offset:8192
    ds_read_b64_tr_b16 v[30:31], v22 offset:10240
    s_waitcnt lgkmcnt(10)
    v_mfma_f32_32x32x16_bf16 v[104:119], v[36:39], v[164:167], v[104:119]
    buffer_load_dwordx4 v[204:207], v249, s[32:35], s16 offen offset:1024 sc1
    ds_read_b64_tr_b16 v[32:33], v23 offset:8192
    ds_read_b64_tr_b16 v[34:35], v23 offset:10240
    s_barrier
    s_waitcnt vmcnt(9)
    s_waitcnt lgkmcnt(10)
    v_mfma_f32_32x32x16_bf16 v[56:71], v[40:43], v[168:171], v[56:71]
    ds_read_b64_tr_b16 v[36:37], v20 offset:9216
    ds_read_b64_tr_b16 v[38:39], v20 offset:11264
    s_waitcnt lgkmcnt(10)
    v_mfma_f32_32x32x16_bf16 v[72:87], v[44:47], v[168:171], v[72:87]
    ds_read_b64_tr_b16 v[40:41], v21 offset:9216
    ds_read_b64_tr_b16 v[42:43], v21 offset:11264
    s_waitcnt lgkmcnt(10)
    v_mfma_f32_32x32x16_bf16 v[120:135], v[48:51], v[168:171], v[120:135]
    ds_read_b64_tr_b16 v[44:45], v24 offset:9216
    ds_read_b64_tr_b16 v[46:47], v24 offset:11264
    s_waitcnt lgkmcnt(10)
    v_mfma_f32_32x32x16_bf16 v[136:151], v[52:55], v[168:171], v[136:151]
    ds_read_b64_tr_b16 v[48:49], v25 offset:9216
    ds_read_b64_tr_b16 v[50:51], v25 offset:11264
    s_waitcnt lgkmcnt(10)
    v_mfma_f32_32x32x16_bf16 v[88:103], v[28:31], v[168:171], v[88:103]
    ds_read_b64_tr_b16 v[52:53], v22 offset:9216
    ds_read_b64_tr_b16 v[54:55], v22 offset:11264
    s_waitcnt lgkmcnt(10)
    v_mfma_f32_32x32x16_bf16 v[104:119], v[32:35], v[168:171], v[104:119]
    ds_read_b64_tr_b16 v[28:29], v23 offset:9216
    ds_read_b64_tr_b16 v[30:31], v23 offset:11264
    s_waitcnt vmcnt(8)
    s_waitcnt lgkmcnt(10)
    v_mfma_f32_32x32x16_bf16 v[56:71], v[36:39], v[172:175], v[56:71]
    ds_read_b64_tr_b16 v[32:33], v20 offset:12288
    ds_read_b64_tr_b16 v[34:35], v20 offset:14336
    s_waitcnt lgkmcnt(10)
    v_mfma_f32_32x32x16_bf16 v[72:87], v[40:43], v[172:175], v[72:87]
    ds_read_b64_tr_b16 v[36:37], v21 offset:12288
    ds_read_b64_tr_b16 v[38:39], v21 offset:14336
    s_waitcnt lgkmcnt(10)
    v_mfma_f32_32x32x16_bf16 v[120:135], v[44:47], v[172:175], v[120:135]
    buffer_load_dwordx4 v[208:211], v249, s[32:35], s16 offen offset:2048 sc1
    ds_read_b64_tr_b16 v[40:41], v24 offset:12288
    ds_read_b64_tr_b16 v[42:43], v24 offset:14336
    s_waitcnt lgkmcnt(10)
    v_mfma_f32_32x32x16_bf16 v[136:151], v[48:51], v[172:175], v[136:151]
    ds_read_b64_tr_b16 v[44:45], v25 offset:12288
    ds_read_b64_tr_b16 v[46:47], v25 offset:14336
    s_waitcnt lgkmcnt(10)
    v_mfma_f32_32x32x16_bf16 v[88:103], v[52:55], v[172:175], v[88:103]
    ds_read_b64_tr_b16 v[48:49], v22 offset:12288
    ds_read_b64_tr_b16 v[50:51], v22 offset:14336
    s_waitcnt lgkmcnt(10)
    v_mfma_f32_32x32x16_bf16 v[104:119], v[28:31], v[172:175], v[104:119]
    buffer_load_dwordx4 v[212:215], v249, s[32:35], s16 offen offset:3072 sc1
    ds_read_b64_tr_b16 v[52:53], v23 offset:12288
    ds_read_b64_tr_b16 v[54:55], v23 offset:14336
    s_waitcnt vmcnt(9)
    s_waitcnt lgkmcnt(10)
    v_mfma_f32_32x32x16_bf16 v[56:71], v[32:35], v[176:179], v[56:71]
    s_add_u32 s16, s16, 16384
    ds_read_b64_tr_b16 v[28:29], v20 offset:13312
    ds_read_b64_tr_b16 v[30:31], v20 offset:15360
    s_waitcnt lgkmcnt(10)
    v_mfma_f32_32x32x16_bf16 v[72:87], v[36:39], v[176:179], v[72:87]
    s_and_b32 s16, s16, 0x3ffff
    ds_read_b64_tr_b16 v[32:33], v21 offset:13312
    ds_read_b64_tr_b16 v[34:35], v21 offset:15360
    s_waitcnt lgkmcnt(10)
    v_mfma_f32_32x32x16_bf16 v[120:135], v[40:43], v[176:179], v[120:135]
    buffer_load_dwordx4 v[216:219], v249, s[32:35], s16 offen sc1
    ds_read_b64_tr_b16 v[36:37], v24 offset:13312
    ds_read_b64_tr_b16 v[38:39], v24 offset:15360
    s_waitcnt lgkmcnt(10)
    v_mfma_f32_32x32x16_bf16 v[136:151], v[44:47], v[176:179], v[136:151]
    ds_read_b64_tr_b16 v[40:41], v25 offset:13312
    ds_read_b64_tr_b16 v[42:43], v25 offset:15360
    s_waitcnt lgkmcnt(10)
    v_mfma_f32_32x32x16_bf16 v[88:103], v[48:51], v[176:179], v[88:103]
    ds_read_b64_tr_b16 v[44:45], v22 offset:13312
    ds_read_b64_tr_b16 v[46:47], v22 offset:15360
    s_waitcnt lgkmcnt(10)
    v_mfma_f32_32x32x16_bf16 v[104:119], v[52:55], v[176:179], v[104:119]
    buffer_load_dwordx4 v[220:223], v249, s[32:35], s16 offen offset:1024 sc1
    ds_read_b64_tr_b16 v[48:49], v23 offset:13312
    ds_read_b64_tr_b16 v[50:51], v23 offset:15360
    s_waitcnt vmcnt(10)
    s_waitcnt lgkmcnt(10)
    v_mfma_f32_32x32x16_bf16 v[56:71], v[28:31], v[180:183], v[56:71]
    ds_read_b64_tr_b16 v[52:53], v20 offset:16384
    ds_read_b64_tr_b16 v[54:55], v20 offset:18432
    s_waitcnt lgkmcnt(10)
    v_mfma_f32_32x32x16_bf16 v[72:87], v[32:35], v[180:183], v[72:87]
    ds_read_b64_tr_b16 v[28:29], v21 offset:16384
    ds_read_b64_tr_b16 v[30:31], v21 offset:18432
    s_waitcnt lgkmcnt(10)
    v_mfma_f32_32x32x16_bf16 v[120:135], v[36:39], v[180:183], v[120:135]
    buffer_load_dwordx4 v[224:227], v249, s[32:35], s16 offen offset:2048 sc1
    ds_read_b64_tr_b16 v[32:33], v24 offset:16384
    ds_read_b64_tr_b16 v[34:35], v24 offset:18432
    s_waitcnt lgkmcnt(10)
    v_mfma_f32_32x32x16_bf16 v[136:151], v[40:43], v[180:183], v[136:151]
    ds_read_b64_tr_b16 v[36:37], v25 offset:16384
    ds_read_b64_tr_b16 v[38:39], v25 offset:18432
    s_waitcnt lgkmcnt(10)
    v_mfma_f32_32x32x16_bf16 v[88:103], v[44:47], v[180:183], v[88:103]
    ds_read_b64_tr_b16 v[40:41], v22 offset:16384
    ds_read_b64_tr_b16 v[42:43], v22 offset:18432
    s_waitcnt lgkmcnt(10)
    v_mfma_f32_32x32x16_bf16 v[104:119], v[48:51], v[180:183], v[104:119]
    buffer_load_dwordx4 v[228:231], v249, s[32:35], s16 offen offset:3072 sc1
    ds_read_b64_tr_b16 v[44:45], v23 offset:16384
    ds_read_b64_tr_b16 v[46:47], v23 offset:18432
    s_barrier
    s_waitcnt vmcnt(11)
    s_waitcnt lgkmcnt(10)
    v_mfma_f32_32x32x16_bf16 v[56:71], v[52:55], v[184:187], v[56:71]
    s_add_u32 s16, s16, 16384
    ds_read_b64_tr_b16 v[48:49], v20 offset:17408
    ds_read_b64_tr_b16 v[50:51], v20 offset:19456
    s_waitcnt lgkmcnt(10)
    v_mfma_f32_32x32x16_bf16 v[72:87], v[28:31], v[184:187], v[72:87]
    s_and_b32 s16, s16, 0x3ffff
    ds_read_b64_tr_b16 v[52:53], v21 offset:17408
    ds_read_b64_tr_b16 v[54:55], v21 offset:19456
    s_waitcnt lgkmcnt(10)
    v_mfma_f32_32x32x16_bf16 v[120:135], v[32:35], v[184:187], v[120:135]
    ds_read_b64_tr_b16 v[28:29], v24 offset:17408
    ds_read_b64_tr_b16 v[30:31], v24 offset:19456
    s_waitcnt lgkmcnt(10)
    v_mfma_f32_32x32x16_bf16 v[136:151], v[36:39], v[184:187], v[136:151]
    ds_read_b64_tr_b16 v[32:33], v25 offset:17408
    ds_read_b64_tr_b16 v[34:35], v25 offset:19456
    s_waitcnt lgkmcnt(10)
    v_mfma_f32_32x32x16_bf16 v[88:103], v[40:43], v[184:187], v[88:103]
    ds_read_b64_tr_b16 v[36:37], v22 offset:17408
    ds_read_b64_tr_b16 v[38:39], v22 offset:19456
    s_waitcnt lgkmcnt(10)
    v_mfma_f32_32x32x16_bf16 v[104:119], v[44:47], v[184:187], v[104:119]
    ds_read_b64_tr_b16 v[40:41], v23 offset:17408
    ds_read_b64_tr_b16 v[42:43], v23 offset:19456
    s_waitcnt vmcnt(10)
    s_waitcnt lgkmcnt(10)
    v_mfma_f32_32x32x16_bf16 v[56:71], v[48:51], v[188:191], v[56:71]
    ds_read_b64_tr_b16 v[44:45], v20 offset:20480
    ds_read_b64_tr_b16 v[46:47], v20 offset:22528
    s_waitcnt lgkmcnt(10)
    v_mfma_f32_32x32x16_bf16 v[72:87], v[52:55], v[188:191], v[72:87]
    ds_read_b64_tr_b16 v[48:49], v21 offset:20480
    ds_read_b64_tr_b16 v[50:51], v21 offset:22528
    s_waitcnt lgkmcnt(10)
    v_mfma_f32_32x32x16_bf16 v[120:135], v[28:31], v[188:191], v[120:135]
    buffer_load_dwordx4 v[232:235], v249, s[32:35], s16 offen sc1
    ds_read_b64_tr_b16 v[52:53], v24 offset:20480
    ds_read_b64_tr_b16 v[54:55], v24 offset:22528
    s_waitcnt lgkmcnt(10)
    v_mfma_f32_32x32x16_bf16 v[136:151], v[32:35], v[188:191], v[136:151]
    ds_read_b64_tr_b16 v[28:29], v25 offset:20480
    ds_read_b64_tr_b16 v[30:31], v25 offset:22528
    s_waitcnt lgkmcnt(10)
    v_mfma_f32_32x32x16_bf16 v[88:103], v[36:39], v[188:191], v[88:103]
    ds_read_b64_tr_b16 v[32:33], v22 offset:20480
    ds_read_b64_tr_b16 v[34:35], v22 offset:22528
    s_waitcnt lgkmcnt(10)
    v_mfma_f32_32x32x16_bf16 v[104:119], v[40:43], v[188:191], v[104:119]
    buffer_load_dwordx4 v[236:239], v249, s[32:35], s16 offen offset:1024 sc1
    ds_read_b64_tr_b16 v[36:37], v23 offset:20480
    ds_read_b64_tr_b16 v[38:39], v23 offset:22528
    s_waitcnt vmcnt(11)
    s_waitcnt lgkmcnt(10)
    v_mfma_f32_32x32x16_bf16 v[56:71], v[44:47], v[192:195], v[56:71]
    ds_read_b64_tr_b16 v[40:41], v20 offset:21504
    ds_read_b64_tr_b16 v[42:43], v20 offset:23552
    s_waitcnt lgkmcnt(10)
    v_mfma_f32_32x32x16_bf16 v[72:87], v[48:51], v[192:195], v[72:87]
    ds_read_b64_tr_b16 v[44:45], v21 offset:21504
    ds_read_b64_tr_b16 v[46:47], v21 offset:23552
    s_waitcnt lgkmcnt(10)
    v_mfma_f32_32x32x16_bf16 v[120:135], v[52:55], v[192:195], v[120:135]
    buffer_load_dwordx4 v[240:243], v249, s[32:35], s16 offen offset:2048 sc1
    ds_read_b64_tr_b16 v[48:49], v24 offset:21504
    ds_read_b64_tr_b16 v[50:51], v24 offset:23552
    s_waitcnt lgkmcnt(10)
    v_mfma_f32_32x32x16_bf16 v[136:151], v[28:31], v[192:195], v[136:151]
    ds_read_b64_tr_b16 v[52:53], v25 offset:21504
    ds_read_b64_tr_b16 v[54:55], v25 offset:23552
    s_waitcnt lgkmcnt(10)
    v_mfma_f32_32x32x16_bf16 v[88:103], v[32:35], v[192:195], v[88:103]
    ds_read_b64_tr_b16 v[28:29], v22 offset:21504
    ds_read_b64_tr_b16 v[30:31], v22 offset:23552
    s_waitcnt lgkmcnt(10)
    v_mfma_f32_32x32x16_bf16 v[104:119], v[36:39], v[192:195], v[104:119]
    buffer_load_dwordx4 v[244:247], v249, s[32:35], s16 offen offset:3072 sc1
    ds_read_b64_tr_b16 v[32:33], v23 offset:21504
    ds_read_b64_tr_b16 v[34:35], v23 offset:23552
    s_waitcnt vmcnt(12)
    s_waitcnt lgkmcnt(10)
    v_mfma_f32_32x32x16_bf16 v[56:71], v[40:43], v[196:199], v[56:71]
    s_add_u32 s16, s16, 16384
    ds_read_b64_tr_b16 v[36:37], v20 offset:24576
    ds_read_b64_tr_b16 v[38:39], v20 offset:26624
    s_waitcnt lgkmcnt(10)
    v_mfma_f32_32x32x16_bf16 v[72:87], v[44:47], v[196:199], v[72:87]
    s_and_b32 s16, s16, 0x3ffff
    ds_read_b64_tr_b16 v[40:41], v21 offset:24576
    ds_read_b64_tr_b16 v[42:43], v21 offset:26624
    s_waitcnt lgkmcnt(10)
    v_mfma_f32_32x32x16_bf16 v[120:135], v[48:51], v[196:199], v[120:135]
    buffer_load_dwordx4 v[152:155], v249, s[32:35], s16 offen sc1
    ds_read_b64_tr_b16 v[44:45], v24 offset:24576
    ds_read_b64_tr_b16 v[46:47], v24 offset:26624
    s_waitcnt lgkmcnt(10)
    v_mfma_f32_32x32x16_bf16 v[136:151], v[52:55], v[196:199], v[136:151]
    ds_read_b64_tr_b16 v[48:49], v25 offset:24576
    ds_read_b64_tr_b16 v[50:51], v25 offset:26624
    s_waitcnt lgkmcnt(10)
    v_mfma_f32_32x32x16_bf16 v[88:103], v[28:31], v[196:199], v[88:103]
    ds_read_b64_tr_b16 v[52:53], v22 offset:24576
    ds_read_b64_tr_b16 v[54:55], v22 offset:26624
    s_waitcnt lgkmcnt(10)
    v_mfma_f32_32x32x16_bf16 v[104:119], v[32:35], v[196:199], v[104:119]
    buffer_load_dwordx4 v[156:159], v249, s[32:35], s16 offen offset:1024 sc1
    ds_read_b64_tr_b16 v[28:29], v23 offset:24576
    ds_read_b64_tr_b16 v[30:31], v23 offset:26624
    s_barrier
    s_waitcnt vmcnt(13)
    s_waitcnt lgkmcnt(10)
    v_mfma_f32_32x32x16_bf16 v[56:71], v[36:39], v[200:203], v[56:71]
    ds_read_b64_tr_b16 v[32:33], v20 offset:25600
    ds_read_b64_tr_b16 v[34:35], v20 offset:27648
    s_waitcnt lgkmcnt(10)
L_PAD2:
    s_cbranch_execz L_RET2
    v_mfma_f32_32x32x16_bf16 v[72:87], v[40:43], v[200:203], v[72:87]
    ds_read_b64_tr_b16 v[36:37], v21 offset:25600
    ds_read_b64_tr_b16 v[38:39], v21 offset:27648
    s_waitcnt lgkmcnt(10)
    v_mfma_f32_32x32x16_bf16 v[120:135], v[44:47], v[200:203], v[120:135]
    ds_read_b64_tr_b16 v[40:41], v24 offset:25600
    ds_read_b64_tr_b16 v[42:43], v24 offset:27648
    s_waitcnt lgkmcnt(10)
    v_mfma_f32_32x32x16_bf16 v[136:151], v[48:51], v[200:203], v[136:151]
    ds_read_b64_tr_b16 v[44:45], v25 offset:25600
    ds_read_b64_tr_b16 v[46:47], v25 offset:27648
    s_waitcnt lgkmcnt(10)
    v_mfma_f32_32x32x16_bf16 v[88:103], v[52:55], v[200:203], v[88:103]
    ds_read_b64_tr_b16 v[48:49], v22 offset:25600
    ds_read_b64_tr_b16 v[50:51], v22 offset:27648
    s_waitcnt lgkmcnt(10)
    v_mfma_f32_32x32x16_bf16 v[104:119], v[28:31], v[200:203], v[104:119]
    ds_read_b64_tr_b16 v[52:53], v23 offset:25600
    ds_read_b64_tr_b16 v[54:55], v23 offset:27648
    s_waitcnt vmcnt(12)
    s_waitcnt lgkmcnt(10)
    v_mfma_f32_32x32x16_bf16 v[56:71], v[32:35], v[204:207], v[56:71]
    ds_read_b64_tr_b16 v[28:29], v20 offset:28672
    ds_read_b64_tr_b16 v[30:31], v20 offset:30720
    s_waitcnt lgkmcnt(10)
    v_mfma_f32_32x32x16_bf16 v[72:87], v[36:39], v[204:207], v[72:87]
    ds_read_b64_tr_b16 v[32:33], v21 offset:28672
    ds_read_b64_tr_b16 v[34:35], v21 offset:30720
    s_waitcnt lgkmcnt(10)
    v_mfma_f32_32x32x16_bf16 v[120:135], v[40:43], v[204:207], v[120:135]
    buffer_load_dwordx4 v[160:163], v249, s[32:35], s16 offen offset:2048 sc1
    ds_read_b64_tr_b16 v[36:37], v24 offset:28672
    ds_read_b64_tr_b16 v[38:39], v24 offset:30720
    s_waitcnt lgkmcnt(10)
    v_mfma_f32_32x32x16_bf16 v[136:151], v[44:47], v[204:207], v[136:151]
    ds_read_b64_tr_b16 v[40:41], v25 offset:28672
    ds_read_b64_tr_b16 v[42:43], v25 offset:30720
    s_waitcnt lgkmcnt(10)
    v_mfma_f32_32x32x16_bf16 v[88:103], v[48:51], v[204:207], v[88:103]
    ds_read_b64_tr_b16 v[44:45], v22 offset:28672
    ds_read_b64_tr_b16 v[46:47], v22 offset:30720
    s_waitcnt lgkmcnt(10)
    v_mfma_f32_32x32x16_bf16 v[104:119], v[52:55], v[204:207], v[104:119]
    buffer_load_dwordx4 v[164:167], v249, s[32:35], s16 offen offset:3072 sc1
    ds_read_b64_tr_b16 v[48:49], v23 offset:28672
    ds_read_b64_tr_b16 v[50:51], v23 offset:30720
    s_waitcnt vmcnt(13)
    s_waitcnt lgkmcnt(10)
    v_mfma_f32_32x32x16_bf16 v[56:71], v[28:31], v[208:211], v[56:71]
    s_add_u32 s16, s16, 16384
    ds_read_b64_tr_b16 v[52:53], v20 offset:29696
    ds_read_b64_tr_b16 v[54:55], v20 offset:31744
    s_waitcnt lgkmcnt(10)
    v_mfma_f32_32x32x16_bf16 v[72:87], v[32:35], v[208:211], v[72:87]
    s_and_b32 s16, s16, 0x3ffff
    ds_read_b64_tr_b16 v[28:29], v21 offset:29696
    ds_read_b64_tr_b16 v[30:31], v21 offset:31744
    s_waitcnt lgkmcnt(10)
    v_mfma_f32_32x32x16_bf16 v[120:135], v[36:39], v[208:211], v[120:135]
    buffer_load_dwordx4 v[168:171], v249, s[32:35], s16 offen sc1
    ds_read_b64_tr_b16 v[32:33], v24 offset:29696
    ds_read_b64_tr_b16 v[34:35], v24 offset:31744
    s_waitcnt lgkmcnt(10)
    v_mfma_f32_32x32x16_bf16 v[136:151], v[40:43], v[208:211], v[136:151]
    ds_read_b64_tr_b16 v[36:37], v25 offset:29696
    ds_read_b64_tr_b16 v[38:39], v25 offset:31744
    s_waitcnt lgkmcnt(10)
    v_mfma_f32_32x32x16_bf16 v[88:103], v[44:47], v[208:211], v[88:103]
    ds_read_b64_tr_b16 v[40:41], v22 offset:29696
    ds_read_b64_tr_b16 v[42:43], v22 offset:31744
    s_waitcnt lgkmcnt(10)
    v_mfma_f32_32x32x16_bf16 v[104:119], v[48:51], v[208:211], v[104:119]
    buffer_load_dwordx4 v[172:175], v249, s[32:35], s16 offen offset:1024 sc1
    ds_read_b64_tr_b16 v[44:45], v23 offset:29696
    ds_read_b64_tr_b16 v[46:47], v23 offset:31744
    s_waitcnt vmcnt(14)
    s_waitcnt lgkmcnt(10)
    v_mfma_f32_32x32x16_bf16 v[56:71], v[52:55], v[212:215], v[56:71]
    ds_read_b64_tr_b16 v[48:49], v20 offset:32768
    ds_read_b64_tr_b16 v[50:51], v20 offset:34816
    s_waitcnt lgkmcnt(10)
    v_mfma_f32_32x32x16_bf16 v[72:87], v[28:31], v[212:215], v[72:87]
    ds_read_b64_tr_b16 v[52:53], v21 offset:32768
    ds_read_b64_tr_b16 v[54:55], v21 offset:34816
    s_waitcnt lgkmcnt(10)
    v_mfma_f32_32x32x16_bf16 v[120:135], v[32:35], v[212:215], v[120:135]
    buffer_load_dwordx4 v[176:179], v249, s[32:35], s16 offen offset:2048 sc1
    ds_read_b64_tr_b16 v[28:29], v24 offset:32768
    ds_read_b64_tr_b16 v[30:31], v24 offset:34816
    s_waitcnt lgkmcnt(10)
    v_mfma_f32_32x32x16_bf16 v[136:151], v[36:39], v[212:215], v[136:151]
    ds_read_b64_tr_b16 v[32:33], v25 offset:32768
    ds_read_b64_tr_b16 v[34:35], v25 offset:34816
    s_waitcnt lgkmcnt(10)
    v_mfma_f32_32x32x16_bf16 v[88:103], v[40:43], v[212:215], v[88:103]
    ds_read_b64_tr_b16 v[36:37], v22 offset:32768
    ds_read_b64_tr_b16 v[38:39], v22 offset:34816
    s_waitcnt lgkmcnt(10)
    v_mfma_f32_32x32x16_bf16 v[104:119], v[44:47], v[212:215], v[104:119]
    buffer_load_dwordx4 v[180:183], v249, s[32:35], s16 offen offset:3072 sc1
    ds_read_b64_tr_b16 v[40:41], v23 offset:32768
    ds_read_b64_tr_b16 v[42:43], v23 offset:34816
    s_barrier
    s_waitcnt vmcnt(15)
    s_waitcnt lgkmcnt(10)
    v_mfma_f32_32x32x16_bf16 v[56:71], v[48:51], v[216:219], v[56:71]
    s_add_u32 s16, s16, 16384
    ds_read_b64_tr_b16 v[44:45], v20 offset:33792
    ds_read_b64_tr_b16 v[46:47], v20 offset:35840
    s_waitcnt lgkmcnt(10)
    v_mfma_f32_32x32x16_bf16 v[72:87], v[52:55], v[216:219], v[72:87]
    s_and_b32 s16, s16, 0x3ffff
    ds_read_b64_tr_b16 v[48:49], v21 offset:33792
    ds_read_b64_tr_b16 v[50:51], v21 offset:35840
    s_waitcnt lgkmcnt(10)
    v_mfma_f32_32x32x16_bf16 v[120:135], v[28:31], v[216:219], v[120:135]
    ds_read_b64_tr_b16 v[52:53], v24 offset:33792
    ds_read_b64_tr_b16 v[54:55], v24 offset:35840
    s_waitcnt lgkmcnt(10)
    v_mfma_f32_32x32x16_bf16 v[136:151], v[32:35], v[216:219], v[136:151]
    ds_read_b64_tr_b16 v[28:29], v25 offset:33792
    ds_read_b64_tr_b16 v[30:31], v25 offset:35840
    s_waitcnt lgkmcnt(10)
    v_mfma_f32_32x32x16_bf16 v[88:103], v[36:39], v[216:219], v[88:103]
    ds_read_b64_tr_b16 v[32:33], v22 offset:33792
    ds_read_b64_tr_b16 v[34:35], v22 offset:35840
    s_waitcnt lgkmcnt(10)
    v_mfma_f32_32x32x16_bf16 v[104:119], v[40:43], v[216:219], v[104:119]
    ds_read_b64_tr_b16 v[36:37], v23 offset:33792
    ds_read_b64_tr_b16 v[38:39], v23 offset:35840
    s_waitcnt vmcnt(14)
    s_waitcnt lgkmcnt(10)
    v_mfma_f32_32x32x16_bf16 v[56:71], v[44:47], v[220:223], v[56:71]
    ds_read_b64_tr_b16 v[40:41], v20 offset:36864
    ds_read_b64_tr_b16 v[42:43], v20 offset:38912
    s_waitcnt lgkmcnt(10)
    v_mfma_f32_32x32x16_bf16 v[72:87], v[48:51], v[220:223], v[72:87]
    ds_read_b64_tr_b16 v[44:45], v21 offset:36864
    ds_read_b64_tr_b16 v[46:47], v21 offset:38912
    s_waitcnt lgkmcnt(10)
    v_mfma_f32_32x32x16_bf16 v[120:135], v[52:55], v[220:223], v[120:135]
    buffer_load_dwordx4 v[184:187], v249, s[32:35], s16 offen sc1
    ds_read_b64_tr_b16 v[48:49], v24 offset:36864
    ds_read_b64_tr_b16 v[50:51], v24 offset:38912
    s_waitcnt lgkmcnt(10)
    v_mfma_f32_32x32x16_bf16 v[136:151], v[28:31], v[220:223], v[136:151]
    ds_read_b64_tr_b16 v[52:53], v25 offset:36864
    ds_read_b64_tr_b16 v[54:55], v25 offset:38912
    s_waitcnt lgkmcnt(10)
    v_mfma_f32_32x32x16_bf16 v[88:103], v[32:35], v[220:223], v[88:103]
    ds_read_b64_tr_b16 v[28:29], v22 offset:36864
    ds_read_b64_tr_b16 v[30:31], v22 offset:38912
    s_waitcnt lgkmcnt(10)
    v_mfma_f32_32x32x16_bf16 v[104:119], v[36:39], v[220:223], v[104:119]
    buffer_load_dwordx4 v[188:191], v249, s[32:35], s16 offen offset:1024 sc1
    ds_read_b64_tr_b16 v[32:33], v23 offset:36864
    ds_read_b64_tr_b16 v[34:35], v23 offset:38912
    s_waitcnt vmcnt(15)
    s_waitcnt lgkmcnt(10)
    v_mfma_f32_32x32x16_bf16 v[56:71], v[40:43], v[224:227], v[56:71]
    ds_read_b64_tr_b16 v[36:37], v20 offset:37888
    ds_read_b64_tr_b16 v[38:39], v20 offset:39936
    s_waitcnt lgkmcnt(10)
    v_mfma_f32_32x32x16_bf16 v[72:87], v[44:47], v[224:227], v[72:87]
    ds_read_b64_tr_b16 v[40:41], v21 offset:37888
    ds_read_b64_tr_b16 v[42:43], v21 offset:39936
    s_waitcnt lgkmcnt(10)
    v_mfma_f32_32x32x16_bf16 v[120:135], v[48:51], v[224:227], v[120:135]
    buffer_load_dwordx4 v[192:195], v249, s[32:35], s16 offen offset:2048 sc1
    ds_read_b64_tr_b16 v[44:45], v24 offset:37888
    ds_read_b64_tr_b16 v[46:47], v24 offset:39936
    s_waitcnt lgkmcnt(10)
    v_mfma_f32_32x32x16_bf16 v[136:151], v[52:55], v[224:227], v[136:151]
    ds_read_b64_tr_b16 v[48:49], v25 offset:37888
    ds_read_b64_tr_b16 v[50:51], v25 offset:39936
    s_waitcnt lgkmcnt(10)
    v_mfma_f32_32x32x16_bf16 v[88:103], v[28:31], v[224:227], v[88:103]
    ds_read_b64_tr_b16 v[52:53], v22 offset:37888
    ds_read_b64_tr_b16 v[54:55], v22 offset:39936
    s_waitcnt lgkmcnt(10)
    v_mfma_f32_32x32x16_bf16 v[104:119], v[32:35], v[224:227], v[104:119]
    buffer_load_dwordx4 v[196:199], v249, s[32:35], s16 offen offset:3072 sc1
    ds_read_b64_tr_b16 v[28:29], v23 offset:37888
    ds_read_b64_tr_b16 v[30:31], v23 offset:39936
    s_waitcnt vmcnt(16)
    s_waitcnt lgkmcnt(10)
    v_mfma_f32_32x32x16_bf16 v[56:71], v[36:39], v[228:231], v[56:71]
    s_add_u32 s16, s16, 16384
    ds_read_b64_tr_b16 v[32:33], v20 offset:40960
    ds_read_b64_tr_b16 v[34:35], v20 offset:43008
    s_waitcnt lgkmcnt(10)
    v_mfma_f32_32x32x16_bf16 v[72:87], v[40:43], v[228:231], v[72:87]
    s_and_b32 s16, s16, 0x3ffff
    ds_read_b64_tr_b16 v[36:37], v21 offset:40960
    ds_read_b64_tr_b16 v[38:39], v21 offset:43008
    s_waitcnt lgkmcnt(10)
    v_mfma_f32_32x32x16_bf16 v[120:135], v[44:47], v[228:231], v[120:135]
    buffer_load_dwordx4 v[200:203], v249, s[32:35], s16 offen sc1
    ds_read_b64_tr_b16 v[40:41], v24 offset:40960
    ds_read_b64_tr_b16 v[42:43], v24 offset:43008
    s_waitcnt lgkmcnt(10)
    v_mfma_f32_32x32x16_bf16 v[136:151], v[48:51], v[228:231], v[136:151]
    ds_read_b64_tr_b16 v[44:45], v25 offset:40960
    ds_read_b64_tr_b16 v[46:47], v25 offset:43008
    s_waitcnt lgkmcnt(10)
    v_mfma_f32_32x32x16_bf16 v[88:103], v[52:55], v[228:231], v[88:103]
    ds_read_b64_tr_b16 v[48:49], v22 offset:40960
    ds_read_b64_tr_b16 v[50:51], v22 offset:43008
    s_waitcnt lgkmcnt(10)
    v_mfma_f32_32x32x16_bf16 v[104:119], v[28:31], v[228:231], v[104:119]
    buffer_load_dwordx4 v[204:207], v249, s[32:35], s16 offen offset:1024 sc1
    ds_read_b64_tr_b16 v[52:53], v23 offset:40960
    ds_read_b64_tr_b16 v[54:55], v23 offset:43008
    s_barrier
    s_waitcnt vmcnt(17)
    s_waitcnt lgkmcnt(10)
    v_mfma_f32_32x32x16_bf16 v[56:71], v[32:35], v[232:235], v[56:71]
    ds_read_b64_tr_b16 v[28:29], v20 offset:41984
    ds_read_b64_tr_b16 v[30:31], v20 offset:44032
    s_waitcnt lgkmcnt(10)
    v_mfma_f32_32x32x16_bf16 v[72:87], v[36:39], v[232:235], v[72:87]
    ds_read_b64_tr_b16 v[32:33], v21 offset:41984
    ds_read_b64_tr_b16 v[34:35], v21 offset:44032
    s_waitcnt lgkmcnt(10)
    v_mfma_f32_32x32x16_bf16 v[120:135], v[40:43], v[232:235], v[120:135]
    ds_read_b64_tr_b16 v[36:37], v24 offset:41984
    ds_read_b64_tr_b16 v[38:39], v24 offset:44032
    s_waitcnt lgkmcnt(10)
    v_mfma_f32_32x32x16_bf16 v[136:151], v[44:47], v[232:235], v[136:151]
    ds_read_b64_tr_b16 v[40:41], v25 offset:41984
    ds_read_b64_tr_b16 v[42:43], v25 offset:44032
    s_waitcnt lgkmcnt(10)
    v_mfma_f32_32x32x16_bf16 v[88:103], v[48:51], v[232:235], v[88:103]
    ds_read_b64_tr_b16 v[44:45], v22 offset:41984
    ds_read_b64_tr_b16 v[46:47], v22 offset:44032
    s_waitcnt lgkmcnt(10)
    v_mfma_f32_32x32x16_bf16 v[104:119], v[52:55], v[232:235], v[104:119]
    ds_read_b64_tr_b16 v[48:49], v23 offset:41984
    ds_read_b64_tr_b16 v[50:51], v23 offset:44032
    s_waitcnt vmcnt(16)
    s_waitcnt lgkmcnt(10)
    v_mfma_f32_32x32x16_bf16 v[56:71], v[28:31], v[236:239], v[56:71]
    ds_read_b64_tr_b16 v[52:53], v20 offset:45056
    ds_read_b64_tr_b16 v[54:55], v20 offset:47104
    s_waitcnt lgkmcnt(10)
    v_mfma_f32_32x32x16_bf16 v[72:87], v[32:35], v[236:239], v[72:87]
    ds_read_b64_tr_b16 v[28:29], v21 offset:45056
    ds_read_b64_tr_b16 v[30:31], v21 offset:47104
    s_waitcnt lgkmcnt(10)
    v_mfma_f32_32x32x16_bf16 v[120:135], v[36:39], v[236:239], v[120:135]
    buffer_load_dwordx4 v[208:211], v249, s[32:35], s16 offen offset:2048 sc1
    ds_read_b64_tr_b16 v[32:33], v24 offset:45056
    ds_read_b64_tr_b16 v[34:35], v24 offset:47104
    s_waitcnt lgkmcnt(10)
    v_mfma_f32_32x32x16_bf16 v[136:151], v[40:43], v[236:239], v[136:151]
    ds_read_b64_tr_b16 v[36:37], v25 offset:45056
    ds_read_b64_tr_b16 v[38:39], v25 offset:47104
    s_waitcnt lgkmcnt(10)
    v_mfma_f32_32x32x16_bf16 v[88:103], v[44:47], v[236:239], v[88:103]
    ds_read_b64_tr_b16 v[40:41], v22 offset:45056
    ds_read_b64_tr_b16 v[42:43], v22 offset:47104
    s_waitcnt lgkmcnt(10)
    v_mfma_f32_32x32x16_bf16 v[104:119], v[48:51], v[236:239], v[104:119]
    buffer_load_dwordx4 v[212:215], v249, s[32:35], s16 offen offset:3072 sc1
    ds_read_b64_tr_b16 v[44:45], v23 offset:45056
    ds_read_b64_tr_b16 v[46:47], v23 offset:47104
    s_waitcnt vmcnt(17)
    s_waitcnt lgkmcnt(10)
    v_mfma_f32_32x32x16_bf16 v[56:71], v[52:55], v[240:243], v[56:71]
    s_add_u32 s16, s16, 16384
    ds_read_b64_tr_b16 v[48:49], v20 offset:46080
    ds_read_b64_tr_b16 v[50:51], v20 offset:48128
    s_waitcnt lgkmcnt(10)
    v_mfma_f32_32x32x16_bf16 v[72:87], v[28:31], v[240:243], v[72:87]
    s_and_b32 s16, s16, 0x3ffff
    ds_read_b64_tr_b16 v[52:53], v21 offset:46080
    ds_read_b64_tr_b16 v[54:55], v21 offset:48128
    s_waitcnt lgkmcnt(10)
    v_mfma_f32_32x32x16_bf16 v[120:135], v[32:35], v[240:243], v[120:135]
    buffer_load_dwordx4 v[216:219], v249, s[32:35], s16 offen sc1
    ds_read_b64_tr_b16 v[28:29], v24 offset:46080
    ds_read_b64_tr_b16 v[30:31], v24 offset:48128
    s_waitcnt lgkmcnt(10)
    v_mfma_f32_32x32x16_bf16 v[136:151], v[36:39], v[240:243], v[136:151]
    ds_read_b64_tr_b16 v[32:33], v25 offset:46080
    ds_read_b64_tr_b16 v[34:35], v25 offset:48128
    s_waitcnt lgkmcnt(10)
    v_mfma_f32_32x32x16_bf16 v[88:103], v[40:43], v[240:243], v[88:103]
    ds_read_b64_tr_b16 v[36:37], v22 offset:46080
    ds_read_b64_tr_b16 v[38:39], v22 offset:48128
    s_waitcnt lgkmcnt(10)
    v_mfma_f32_32x32x16_bf16 v[104:119], v[44:47], v[240:243], v[104:119]
    buffer_load_dwordx4 v[220:223], v249, s[32:35], s16 offen offset:1024 sc1
    ds_read_b64_tr_b16 v[40:41], v23 offset:46080
    ds_read_b64_tr_b16 v[42:43], v23 offset:48128
    s_waitcnt vmcnt(18)
    s_waitcnt lgkmcnt(10)
    v_mfma_f32_32x32x16_bf16 v[56:71], v[48:51], v[244:247], v[56:71]
    ds_read_b64_tr_b16 v[44:45], v20
    ds_read_b64_tr_b16 v[46:47], v20 offset:2048
    s_waitcnt lgkmcnt(10)
    v_mfma_f32_32x32x16_bf16 v[72:87], v[52:55], v[244:247], v[72:87]
    ds_read_b64_tr_b16 v[48:49], v21
    ds_read_b64_tr_b16 v[50:51], v21 offset:2048
    s_waitcnt lgkmcnt(10)
    v_mfma_f32_32x32x16_bf16 v[120:135], v[28:31], v[244:247], v[120:135]
    buffer_load_dwordx4 v[224:227], v249, s[32:35], s16 offen offset:2048 sc1
    ds_read_b64_tr_b16 v[52:53], v24
    ds_read_b64_tr_b16 v[54:55], v24 offset:2048
    s_waitcnt lgkmcnt(10)
    v_mfma_f32_32x32x16_bf16 v[136:151], v[32:35], v[244:247], v[136:151]
    ds_read_b64_tr_b16 v[28:29], v25
    ds_read_b64_tr_b16 v[30:31], v25 offset:2048
    s_waitcnt lgkmcnt(10)
    v_mfma_f32_32x32x16_bf16 v[88:103], v[36:39], v[244:247], v[88:103]
    ds_read_b64_tr_b16 v[32:33], v22
    ds_read_b64_tr_b16 v[34:35], v22 offset:2048
    s_waitcnt lgkmcnt(10)
    v_mfma_f32_32x32x16_bf16 v[104:119], v[40:43], v[244:247], v[104:119]
    buffer_load_dwordx4 v[228:231], v249, s[32:35], s16 offen offset:3072 sc1
    ds_read_b64_tr_b16 v[36:37], v23
    ds_read_b64_tr_b16 v[38:39], v23 offset:2048
    s_barrier
    s_waitcnt vmcnt(19)
    s_waitcnt lgkmcnt(10)
    v_mfma_f32_32x32x16_bf16 v[56:71], v[44:47], v[152:155], v[56:71]
    s_add_u32 s16, s16, 16384
    ds_read_b64_tr_b16 v[40:41], v20 offset:1024
    ds_read_b64_tr_b16 v[42:43], v20 offset:3072
    s_waitcnt lgkmcnt(10)
    v_mfma_f32_32x32x16_bf16 v[72:87], v[48:51], v[152:155], v[72:87]
    s_and_b32 s16, s16, 0x3ffff
    ds_read_b64_tr_b16 v[44:45], v21 offset:1024
    ds_read_b64_tr_b16 v[46:47], v21 offset:3072
    s_waitcnt lgkmcnt(10)
    v_mfma_f32_32x32x16_bf16 v[120:135], v[52:55], v[152:155], v[120:135]
    ds_read_b64_tr_b16 v[48:49], v24 offset:1024
    ds_read_b64_tr_b16 v[50:51], v24 offset:3072
    s_waitcnt lgkmcnt(10)
    v_mfma_f32_32x32x16_bf16 v[136:151], v[28:31], v[152:155], v[136:151]
    ds_read_b64_tr_b16 v[52:53], v25 offset:1024
    ds_read_b64_tr_b16 v[54:55], v25 offset:3072
    s_waitcnt lgkmcnt(10)
    v_mfma_f32_32x32x16_bf16 v[88:103], v[32:35], v[152:155], v[88:103]
    ds_read_b64_tr_b16 v[28:29], v22 offset:1024
    ds_read_b64_tr_b16 v[30:31], v22 offset:3072
    s_waitcnt lgkmcnt(10)
    v_mfma_f32_32x32x16_bf16 v[104:119], v[36:39], v[152:155], v[104:119]
    ds_read_b64_tr_b16 v[32:33], v23 offset:1024
    ds_read_b64_tr_b16 v[34:35], v23 offset:3072
    s_waitcnt vmcnt(18)
    s_waitcnt lgkmcnt(10)
    v_mfma_f32_32x32x16_bf16 v[56:71], v[40:43], v[156:159], v[56:71]
    ds_read_b64_tr_b16 v[36:37], v20 offset:4096
    ds_read_b64_tr_b16 v[38:39], v20 offset:6144
    s_waitcnt lgkmcnt(10)
    v_mfma_f32_32x32x16_bf16 v[72:87], v[44:47], v[156:159], v[72:87]
    ds_read_b64_tr_b16 v[40:41], v21 offset:4096
    ds_read_b64_tr_b16 v[42:43], v21 offset:6144
    s_waitcnt lgkmcnt(10)
    v_mfma_f32_32x32x16_bf16 v[120:135], v[48:51], v[156:159], v[120:135]
    ds_read_b64_tr_b16 v[44:45], v24 offset:4096
    ds_read_b64_tr_b16 v[46:47], v24 offset:6144
    s_waitcnt lgkmcnt(10)
    v_mfma_f32_32x32x16_bf16 v[136:151], v[52:55], v[156:159], v[136:151]
    buffer_load_dwordx4 v[232:235], v249, s[32:35], s16 offen sc1
    ds_read_b64_tr_b16 v[48:49], v25 offset:4096
    ds_read_b64_tr_b16 v[50:51], v25 offset:6144
    s_waitcnt lgkmcnt(10)
    v_mfma_f32_32x32x16_bf16 v[88:103], v[28:31], v[156:159], v[88:103]
    ds_read_b64_tr_b16 v[52:53], v22 offset:4096
    ds_read_b64_tr_b16 v[54:55], v22 offset:6144
    s_waitcnt lgkmcnt(10)
    v_mfma_f32_32x32x16_bf16 v[104:119], v[32:35], v[156:159], v[104:119]
    ds_read_b64_tr_b16 v[28:29], v23 offset:4096
    ds_read_b64_tr_b16 v[30:31], v23 offset:6144
    s_waitcnt vmcnt(18)
    s_waitcnt lgkmcnt(10)
    v_mfma_f32_32x32x16_bf16 v[56:71], v[36:39], v[160:163], v[56:71]
    ds_read_b64_tr_b16 v[32:33], v20 offset:5120
    ds_read_b64_tr_b16 v[34:35], v20 offset:7168
    s_waitcnt lgkmcnt(10)
    v_mfma_f32_32x32x16_bf16 v[72:87], v[40:43], v[160:163], v[72:87]
    buffer_load_dwordx4 v[236:239], v249, s[32:35], s16 offen offset:1024 sc1
    ds_read_b64_tr_b16 v[36:37], v21 offset:5120
    ds_read_b64_tr_b16 v[38:39], v21 offset:7168
    s_waitcnt lgkmcnt(10)
    v_mfma_f32_32x32x16_bf16 v[120:135], v[44:47], v[160:163], v[120:135]
    ds_read_b64_tr_b16 v[40:41], v24 offset:5120
    ds_read_b64_tr_b16 v[42:43], v24 offset:7168
    s_waitcnt lgkmcnt(10)
    v_mfma_f32_32x32x16_bf16 v[136:151], v[48:51], v[160:163], v[136:151]
    ds_read_b64_tr_b16 v[44:45], v25 offset:5120
    ds_read_b64_tr_b16 v[46:47], v25 offset:7168
    s_waitcnt lgkmcnt(10)
    v_mfma_f32_32x32x16_bf16 v[88:103], v[52:55], v[160:163], v[88:103]
    buffer_load_dwordx4 v[240:243], v249, s[32:35], s16 offen offset:2048 sc1
    ds_read_b64_tr_b16 v[48:49], v22 offset:5120
    ds_read_b64_tr_b16 v[50:51], v22 offset:7168
    s_waitcnt lgkmcnt(10)
    v_mfma_f32_32x32x16_bf16 v[104:119], v[28:31], v[160:163], v[104:119]
    ds_read_b64_tr_b16 v[52:53], v23 offset:5120
    ds_read_b64_tr_b16 v[54:55], v23 offset:7168
    s_waitcnt vmcnt(19)
    s_waitcnt lgkmcnt(10)
    v_mfma_f32_32x32x16_bf16 v[56:71], v[32:35], v[164:167], v[56:71]
    ds_read_b64_tr_b16 v[28:29], v20 offset:8192
    ds_read_b64_tr_b16 v[30:31], v20 offset:10240
    s_waitcnt lgkmcnt(10)
    v_mfma_f32_32x32x16_bf16 v[72:87], v[36:39], v[164:167], v[72:87]
    ds_read_b64_tr_b16 v[32:33], v21 offset:8192
    ds_read_b64_tr_b16 v[34:35], v21 offset:10240
    s_waitcnt lgkmcnt(10)
    v_mfma_f32_32x32x16_bf16 v[120:135], v[40:43], v[164:167], v[120:135]
    buffer_load_dwordx4 v[244:247], v249, s[32:35], s16 offen offset:3072 sc1
    ds_read_b64_tr_b16 v[36:37], v24 offset:8192
    ds_read_b64_tr_b16 v[38:39], v24 offset:10240
    s_waitcnt lgkmcnt(10)
    v_mfma_f32_32x32x16_bf16 v[136:151], v[44:47], v[164:167], v[136:151]
    s_add_u32 s16, s16, 16384
    ds_read_b64_tr_b16 v[40:41], v25 offset:8192
    ds_read_b64_tr_b16 v[42:43], v25 offset:10240
    s_waitcnt lgkmcnt(10)
    v_mfma_f32_32x32x16_bf16 v[88:103], v[48:51], v[164:167], v[88:103]
    s_and_b32 s16, s16, 0x3ffff
    ds_read_b64_tr_b16 v[44:45], v22 offset:8192
    ds_read_b64_tr_b16 v[46:47], v22 offset:10240
    s_waitcnt lgkmcnt(10)
    v_mfma_f32_32x32x16_bf16 v[104:119], v[52:55], v[164:167], v[104:119]
    buffer_load_dwordx4 v[152:155], v249, s[32:35], s16 offen sc1
    ds_read_b64_tr_b16 v[48:49], v23 offset:8192
    ds_read_b64_tr_b16 v[50:51], v23 offset:10240
    s_barrier
    s_waitcnt vmcnt(20)
    s_waitcnt lgkmcnt(10)
    v_mfma_f32_32x32x16_bf16 v[56:71], v[28:31], v[168:171], v[56:71]
    ds_read_b64_tr_b16 v[52:53], v20 offset:9216
    ds_read_b64_tr_b16 v[54:55], v20 offset:11264
    s_waitcnt lgkmcnt(10)
    v_mfma_f32_32x32x16_bf16 v[72:87], v[32:35], v[168:171], v[72:87]
    ds_read_b64_tr_b16 v[28:29], v21 offset:9216
    ds_read_b64_tr_b16 v[30:31], v21 offset:11264
    s_waitcnt lgkmcnt(10)
    v_mfma_f32_32x32x16_bf16 v[120:135], v[36:39], v[168:171], v[120:135]
    ds_read_b64_tr_b16 v[32:33], v24 offset:9216
    ds_read_b64_tr_b16 v[34:35], v24 offset:11264
    s_waitcnt lgkmcnt(10)
    v_mfma_f32_32x32x16_bf16 v[136:151], v[40:43], v[168:171], v[136:151]
    ds_read_b64_tr_b16 v[36:37], v25 offset:9216
    ds_read_b64_tr_b16 v[38:39], v25 offset:11264
    s_waitcnt lgkmcnt(10)
    v_mfma_f32_32x32x16_bf16 v[88:103], v[44:47], v[168:171], v[88:103]
    ds_read_b64_tr_b16 v[40:41], v22 offset:9216
    ds_read_b64_tr_b16 v[42:43], v22 offset:11264
    s_waitcnt lgkmcnt(10)
    v_mfma_f32_32x32x16_bf16 v[104:119], v[48:51], v[168:171], v[104:119]
    ds_read_b64_tr_b16 v[44:45], v23 offset:9216
    ds_read_b64_tr_b16 v[46:47], v23 offset:11264
    s_waitcnt vmcnt(19)
    s_waitcnt lgkmcnt(10)
    v_mfma_f32_32x32x16_bf16 v[56:71], v[52:55], v[172:175], v[56:71]
    ds_read_b64_tr_b16 v[48:49], v20 offset:12288
    ds_read_b64_tr_b16 v[50:51], v20 offset:14336
    s_waitcnt lgkmcnt(10)
    v_mfma_f32_32x32x16_bf16 v[72:87], v[28:31], v[172:175], v[72:87]
    ds_read_b64_tr_b16 v[52:53], v21 offset:12288
    ds_read_b64_tr_b16 v[54:55], v21 offset:14336
    s_waitcnt lgkmcnt(10)
    v_mfma_f32_32x32x16_bf16 v[120:135], v[32:35], v[172:175], v[120:135]
    ds_read_b64_tr_b16 v[28:29], v24 offset:12288
    ds_read_b64_tr_b16 v[30:31], v24 offset:14336
    s_waitcnt lgkmcnt(10)
    v_mfma_f32_32x32x16_bf16 v[136:151], v[36:39], v[172:175], v[136:151]
    buffer_load_dwordx4 v[156:159], v249, s[32:35], s16 offen offset:1024 sc1
    ds_read_b64_tr_b16 v[32:33], v25 offset:12288
    ds_read_b64_tr_b16 v[34:35], v25 offset:14336
    s_waitcnt lgkmcnt(10)
    v_mfma_f32_32x32x16_bf16 v[88:103], v[40:43], v[172:175], v[88:103]
    ds_read_b64_tr_b16 v[36:37], v22 offset:12288
    ds_read_b64_tr_b16 v[38:39], v22 offset:14336
    s_waitcnt lgkmcnt(10)
    v_mfma_f32_32x32x16_bf16 v[104:119], v[44:47], v[172:175], v[104:119]
    ds_read_b64_tr_b16 v[40:41], v23 offset:12288
    ds_read_b64_tr_b16 v[42:43], v23 offset:14336
    s_waitcnt vmcnt(19)
    s_waitcnt lgkmcnt(10)
    v_mfma_f32_32x32x16_bf16 v[56:71], v[48:51], v[176:179], v[56:71]
    ds_read_b64_tr_b16 v[44:45], v20 offset:13312
    ds_read_b64_tr_b16 v[46:47], v20 offset:15360
    s_waitcnt lgkmcnt(10)
    v_mfma_f32_32x32x16_bf16 v[72:87], v[52:55], v[176:179], v[72:87]
    buffer_load_dwordx4 v[160:163], v249, s[32:35], s16 offen offset:2048 sc1
    ds_read_b64_tr_b16 v[48:49], v21 offset:13312
    ds_read_b64_tr_b16 v[50:51], v21 offset:15360
    s_waitcnt lgkmcnt(10)
    v_mfma_f32_32x32x16_bf16 v[120:135], v[28:31], v[176:179], v[120:135]
    ds_read_b64_tr_b16 v[52:53], v24 offset:13312
    ds_read_b64_tr_b16 v[54:55], v24 offset:15360
    s_waitcnt lgkmcnt(10)
    v_mfma_f32_32x32x16_bf16 v[136:151], v[32:35], v[176:179], v[136:151]
    ds_read_b64_tr_b16 v[28:29], v25 offset:13312
    ds_read_b64_tr_b16 v[30:31], v25 offset:15360
    s_waitcnt lgkmcnt(10)
    v_mfma_f32_32x32x16_bf16 v[88:103], v[36:39], v[176:179], v[88:103]
    buffer_load_dwordx4 v[164:167], v249, s[32:35], s16 offen offset:3072 sc1
    ds_read_b64_tr_b16 v[32:33], v22 offset:13312
    ds_read_b64_tr_b16 v[34:35], v22 offset:15360
    s_waitcnt lgkmcnt(10)
    v_mfma_f32_32x32x16_bf16 v[104:119], v[40:43], v[176:179], v[104:119]
    s_add_u32 s16, s16, 16384
    ds_read_b64_tr_b16 v[36:37], v23 offset:13312
    ds_read_b64_tr_b16 v[38:39], v23 offset:15360
    s_waitcnt vmcnt(20)
    s_waitcnt lgkmcnt(10)
    v_mfma_f32_32x32x16_bf16 v[56:71], v[44:47], v[180:183], v[56:71]
    s_and_b32 s16, s16, 0x3ffff
    ds_read_b64_tr_b16 v[40:41], v20 offset:16384
    ds_read_b64_tr_b16 v[42:43], v20 offset:18432
    s_waitcnt lgkmcnt(10)
    v_mfma_f32_32x32x16_bf16 v[72:87], v[48:51], v[180:183], v[72:87]
    ds_read_b64_tr_b16 v[44:45], v21 offset:16384
    ds_read_b64_tr_b16 v[46:47], v21 offset:18432
    s_waitcnt lgkmcnt(10)
    v_mfma_f32_32x32x16_bf16 v[120:135], v[52:55], v[180:183], v[120:135]
    buffer_load_dwordx4 v[168:171], v249, s[32:35], s16 offen sc1
    ds_read_b64_tr_b16 v[48:49], v24 offset:16384
    ds_read_b64_tr_b16 v[50:51], v24 offset:18432
    s_waitcnt lgkmcnt(10)
    v_mfma_f32_32x32x16_bf16 v[136:151], v[28:31], v[180:183], v[136:151]
    ds_read_b64_tr_b16 v[52:53], v25 offset:16384
    ds_read_b64_tr_b16 v[54:55], v25 offset:18432
    s_waitcnt lgkmcnt(10)
    v_mfma_f32_32x32x16_bf16 v[88:103], v[32:35], v[180:183], v[88:103]
    ds_read_b64_tr_b16 v[28:29], v22 offset:16384
    ds_read_b64_tr_b16 v[30:31], v22 offset:18432
    s_waitcnt lgkmcnt(10)
    v_mfma_f32_32x32x16_bf16 v[104:119], v[36:39], v[180:183], v[104:119]
    buffer_load_dwordx4 v[172:175], v249, s[32:35], s16 offen offset:1024 sc1
    ds_read_b64_tr_b16 v[32:33], v23 offset:16384
    ds_read_b64_tr_b16 v[34:35], v23 offset:18432
    s_barrier
    s_waitcnt vmcnt(21)
    s_waitcnt lgkmcnt(10)
    v_mfma_f32_32x32x16_bf16 v[56:71], v[40:43], v[184:187], v[56:71]
    ds_read_b64_tr_b16 v[36:37], v20 offset:17408
    ds_read_b64_tr_b16 v[38:39], v20 offset:19456
    s_waitcnt lgkmcnt(10)
    v_mfma_f32_32x32x16_bf16 v[72:87], v[44:47], v[184:187], v[72:87]
    ds_read_b64_tr_b16 v[40:41], v21 offset:17408
    ds_read_b64_tr_b16 v[42:43], v21 offset:19456
    s_waitcnt lgkmcnt(10)
    v_mfma_f32_32x32x16_bf16 v[120:135], v[48:51], v[184:187], v[120:135]
    ds_read_b64_tr_b16 v[44:45], v24 offset:17408
    ds_read_b64_tr_b16 v[46:47], v24 offset:19456
    s_waitcnt lgkmcnt(10)
    v_mfma_f32_32x32x16_bf16 v[136:151], v[52:55], v[184:187], v[136:151]
    ds_read_b64_tr_b16 v[48:49], v25 offset:17408
    ds_read_b64_tr_b16 v[50:51], v25 offset:19456
    s_waitcnt lgkmcnt(10)
    v_mfma_f32_32x32x16_bf16 v[88:103], v[28:31], v[184:187], v[88:103]
    ds_read_b64_tr_b16 v[52:53], v22 offset:17408
    ds_read_b64_tr_b16 v[54:55], v22 offset:19456
    s_waitcnt lgkmcnt(10)
    v_mfma_f32_32x32x16_bf16 v[104:119], v[32:35], v[184:187], v[104:119]
    ds_read_b64_tr_b16 v[28:29], v23 offset:17408
    ds_read_b64_tr_b16 v[30:31], v23 offset:19456
    s_waitcnt vmcnt(20)
    s_waitcnt lgkmcnt(10)
    v_mfma_f32_32x32x16_bf16 v[56:71], v[36:39], v[188:191], v[56:71]
    ds_read_b64_tr_b16 v[32:33], v20 offset:20480
    ds_read_b64_tr_b16 v[34:35], v20 offset:22528
    s_waitcnt lgkmcnt(10)
    v_mfma_f32_32x32x16_bf16 v[72:87], v[40:43], v[188:191], v[72:87]
    ds_read_b64_tr_b16 v[36:37], v21 offset:20480
    ds_read_b64_tr_b16 v[38:39], v21 offset:22528
    s_waitcnt lgkmcnt(10)
    v_mfma_f32_32x32x16_bf16 v[120:135], v[44:47], v[188:191], v[120:135]
    ds_read_b64_tr_b16 v[40:41], v24 offset:20480
    ds_read_b64_tr_b16 v[42:43], v24 offset:22528
    s_waitcnt lgkmcnt(10)
    v_mfma_f32_32x32x16_bf16 v[136:151], v[48:51], v[188:191], v[136:151]
    buffer_load_dwordx4 v[176:179], v249, s[32:35], s16 offen offset:2048 sc1
    ds_read_b64_tr_b16 v[44:45], v25 offset:20480
    ds_read_b64_tr_b16 v[46:47], v25 offset:22528
    s_waitcnt lgkmcnt(10)
    v_mfma_f32_32x32x16_bf16 v[88:103], v[52:55], v[188:191], v[88:103]
    ds_read_b64_tr_b16 v[48:49], v22 offset:20480
    ds_read_b64_tr_b16 v[50:51], v22 offset:22528
    s_waitcnt lgkmcnt(10)
    v_mfma_f32_32x32x16_bf16 v[104:119], v[28:31], v[188:191], v[104:119]
L_PAD3:
    s_cbranch_execz L_RET3
    ds_read_b64_tr_b16 v[52:53], v23 offset:20480
    ds_read_b64_tr_b16 v[54:55], v23 offset:22528
    s_waitcnt vmcnt(20)
    s_waitcnt lgkmcnt(10)
    v_mfma_f32_32x32x16_bf16 v[56:71], v[32:35], v[192:195], v[56:71]
    ds_read_b64_tr_b16 v[28:29], v20 offset:21504
    ds_read_b64_tr_b16 v[30:31], v20 offset:23552
    s_waitcnt lgkmcnt(10)
    v_mfma_f32_32x32x16_bf16 v[72:87], v[36:39], v[192:195], v[72:87]
    buffer_load_dwordx4 v[180:183], v249, s[32:35], s16 offen offset:3072 sc1
    ds_read_b64_tr_b16 v[32:33], v21 offset:21504
    ds_read_b64_tr_b16 v[34:35], v21 offset:23552
    s_waitcnt lgkmcnt(10)
    v_mfma_f32_32x32x16_bf16 v[120:135], v[40:43], v[192:195], v[120:135]
    s_add_u32 s16, s16, 16384
    ds_read_b64_tr_b16 v[36:37], v24 offset:21504
    ds_read_b64_tr_b16 v[38:39], v24 offset:23552
    s_waitcnt lgkmcnt(10)
    v_mfma_f32_32x32x16_bf16 v[136:151], v[44:47], v[192:195], v[136:151]
    s_and_b32 s16, s16, 0x3ffff
    ds_read_b64_tr_b16 v[40:41], v25 offset:21504
    ds_read_b64_tr_b16 v[42:43], v25 offset:23552
    s_waitcnt lgkmcnt(10)
    v_mfma_f32_32x32x16_bf16 v[88:103], v[48:51], v[192:195], v[88:103]
    buffer_load_dwordx4 v[184:187], v249, s[32:35], s16 offen sc1
    ds_read_b64_tr_b16 v[44:45], v22 offset:21504
    ds_read_b64_tr_b16 v[46:47], v22 offset:23552
    s_waitcnt lgkmcnt(10)
    v_mfma_f32_32x32x16_bf16 v[104:119], v[52:55], v[192:195], v[104:119]
    ds_read_b64_tr_b16 v[48:49], v23 offset:21504
    ds_read_b64_tr_b16 v[50:51], v23 offset:23552
    s_waitcnt vmcnt(21)
    s_waitcnt lgkmcnt(10)
    v_mfma_f32_32x32x16_bf16 v[56:71], v[28:31], v[196:199], v[56:71]
    ds_read_b64_tr_b16 v[52:53], v20 offset:24576
    ds_read_b64_tr_b16 v[54:55], v20 offset:26624
    s_waitcnt lgkmcnt(10)
    v_mfma_f32_32x32x16_bf16 v[72:87], v[32:35], v[196:199], v[72:87]
    ds_read_b64_tr_b16 v[28:29], v21 offset:24576
    ds_read_b64_tr_b16 v[30:31], v21 offset:26624
    s_waitcnt lgkmcnt(10)
    v_mfma_f32_32x32x16_bf16 v[120:135], v[36:39], v[196:199], v[120:135]
    buffer_load_dwordx4 v[188:191], v249, s[32:35], s16 offen offset:1024 sc1
    ds_read_b64_tr_b16 v[32:33], v20 offset:25600
    ds_read_b64_tr_b16 v[34:35], v20 offset:27648
    s_waitcnt lgkmcnt(10)
    v_mfma_f32_32x32x16_bf16 v[136:151], v[40:43], v[196:199], v[136:151]
    ds_read_b64_tr_b16 v[36:37], v21 offset:25600
    ds_read_b64_tr_b16 v[38:39], v21 offset:27648
    s_waitcnt lgkmcnt(10)
    v_mfma_f32_32x32x16_bf16 v[88:103], v[44:47], v[196:199], v[88:103]
    ds_read_b64_tr_b16 v[40:41], v20 offset:28672
    ds_read_b64_tr_b16 v[42:43], v20 offset:30720
    s_waitcnt lgkmcnt(10)
    v_mfma_f32_32x32x16_bf16 v[104:119], v[48:51], v[196:199], v[104:119]
    buffer_load_dwordx4 v[192:195], v249, s[32:35], s16 offen offset:2048 sc1
    ds_read_b64_tr_b16 v[44:45], v21 offset:28672
    ds_read_b64_tr_b16 v[46:47], v21 offset:30720
    s_barrier
    s_waitcnt vmcnt(22)
    s_waitcnt lgkmcnt(10)
    v_mfma_f32_32x32x16_bf16 v[56:71], v[52:55], v[200:203], v[56:71]
    ds_read_b64_tr_b16 v[48:49], v20 offset:29696
    ds_read_b64_tr_b16 v[50:51], v20 offset:31744
    s_waitcnt lgkmcnt(10)
    v_mfma_f32_32x32x16_bf16 v[72:87], v[28:31], v[200:203], v[72:87]
    ds_read_b64_tr_b16 v[52:53], v21 offset:29696
    ds_read_b64_tr_b16 v[54:55], v21 offset:31744
    s_waitcnt vmcnt(21)
    s_waitcnt lgkmcnt(10)
    v_mfma_f32_32x32x16_bf16 v[56:71], v[32:35], v[204:207], v[56:71]
    ds_read_b64_tr_b16 v[28:29], v24 offset:24576
    ds_read_b64_tr_b16 v[30:31], v24 offset:26624
    s_waitcnt lgkmcnt(10)
    v_mfma_f32_32x32x16_bf16 v[72:87], v[36:39], v[204:207], v[72:87]
    ds_read_b64_tr_b16 v[32:33], v25 offset:24576
    ds_read_b64_tr_b16 v[34:35], v25 offset:26624
    s_waitcnt vmcnt(20)
    s_waitcnt lgkmcnt(10)
    v_mfma_f32_32x32x16_bf16 v[56:71], v[40:43], v[208:211], v[56:71]
    ds_read_b64_tr_b16 v[36:37], v22 offset:24576
    ds_read_b64_tr_b16 v[38:39], v22 offset:26624
    s_waitcnt lgkmcnt(10)
    v_mfma_f32_32x32x16_bf16 v[72:87], v[44:47], v[208:211], v[72:87]
    ds_read_b64_tr_b16 v[40:41], v23 offset:24576
    ds_read_b64_tr_b16 v[42:43], v23 offset:26624
    s_waitcnt vmcnt(19)
    s_waitcnt lgkmcnt(10)
    v_mfma_f32_32x32x16_bf16 v[56:71], v[48:51], v[212:215], v[56:71]
    ds_read_b64_tr_b16 v[44:45], v24 offset:25600
    ds_read_b64_tr_b16 v[46:47], v24 offset:27648
    s_waitcnt lgkmcnt(10)
    v_mfma_f32_32x32x16_bf16 v[72:87], v[52:55], v[212:215], v[72:87]
    ds_read_b64_tr_b16 v[48:49], v25 offset:25600
    ds_read_b64_tr_b16 v[50:51], v25 offset:27648
    s_barrier
    s_waitcnt lgkmcnt(10)
    v_mfma_f32_32x32x16_bf16 v[120:135], v[28:31], v[200:203], v[120:135]
    ds_read_b64_tr_b16 v[52:53], v22 offset:25600
    ds_read_b64_tr_b16 v[54:55], v22 offset:27648
    s_waitcnt lgkmcnt(10)
    v_mfma_f32_32x32x16_bf16 v[136:151], v[32:35], v[200:203], v[136:151]
    buffer_load_dwordx4 v[196:199], v249, s[32:35], s16 offen offset:3072 sc1
    ds_read_b64_tr_b16 v[28:29], v23 offset:25600
    ds_read_b64_tr_b16 v[30:31], v23 offset:27648
    s_waitcnt lgkmcnt(10)
    v_mfma_f32_32x32x16_bf16 v[88:103], v[36:39], v[200:203], v[88:103]
    s_add_u32 s16, s16, 16384
    ds_read_b64_tr_b16 v[32:33], v24 offset:28672
    ds_read_b64_tr_b16 v[34:35], v24 offset:30720
    s_waitcnt lgkmcnt(10)
    v_mfma_f32_32x32x16_bf16 v[104:119], v[40:43], v[200:203], v[104:119]
    s_and_b32 s16, s16, 0x3ffff
    ds_read_b64_tr_b16 v[36:37], v25 offset:28672
    ds_read_b64_tr_b16 v[38:39], v25 offset:30720
    s_waitcnt lgkmcnt(10)
    v_mfma_f32_32x32x16_bf16 v[120:135], v[44:47], v[204:207], v[120:135]
    ds_read_b64_tr_b16 v[40:41], v22 offset:28672
    ds_read_b64_tr_b16 v[42:43], v22 offset:30720
    s_waitcnt lgkmcnt(10)
    v_mfma_f32_32x32x16_bf16 v[136:151], v[48:51], v[204:207], v[136:151]
    buffer_load_dwordx4 v[200:203], v249, s[32:35], s16 offen sc1
    ds_read_b64_tr_b16 v[44:45], v23 offset:28672
    ds_read_b64_tr_b16 v[46:47], v23 offset:30720
    s_waitcnt lgkmcnt(10)
    v_mfma_f32_32x32x16_bf16 v[88:103], v[52:55], v[204:207], v[88:103]
    ds_read_b64_tr_b16 v[48:49], v24 offset:29696
    ds_read_b64_tr_b16 v[50:51], v24 offset:31744
    s_waitcnt lgkmcnt(10)
    v_mfma_f32_32x32x16_bf16 v[104:119], v[28:31], v[204:207], v[104:119]
    ds_read_b64_tr_b16 v[52:53], v25 offset:29696
    ds_read_b64_tr_b16 v[54:55], v25 offset:31744
    s_waitcnt lgkmcnt(10)
    v_mfma_f32_32x32x16_bf16 v[120:135], v[32:35], v[208:211], v[120:135]
    buffer_load_dwordx4 v[204:207], v249, s[32:35], s16 offen offset:1024 sc1
    ds_read_b64_tr_b16 v[28:29], v22 offset:29696
    ds_read_b64_tr_b16 v[30:31], v22 offset:31744
    s_waitcnt lgkmcnt(10)
    v_mfma_f32_32x32x16_bf16 v[136:151], v[36:39], v[208:211], v[136:151]
    ds_read_b64_tr_b16 v[32:33], v23 offset:29696
    ds_read_b64_tr_b16 v[34:35], v23 offset:31744
    s_waitcnt lgkmcnt(10)
    v_mfma_f32_32x32x16_bf16 v[88:103], v[40:43], v[208:211], v[88:103]
    ds_read_b64_tr_b16 v[36:37], v20 offset:32768
    ds_read_b64_tr_b16 v[38:39], v20 offset:34816
    s_waitcnt lgkmcnt(10)
    v_mfma_f32_32x32x16_bf16 v[104:119], v[44:47], v[208:211], v[104:119]
    ds_read_b64_tr_b16 v[40:41], v20 offset:33792
    ds_read_b64_tr_b16 v[42:43], v20 offset:35840
    s_waitcnt lgkmcnt(10)
    v_mfma_f32_32x32x16_bf16 v[120:135], v[48:51], v[212:215], v[120:135]
    buffer_load_dwordx4 v[208:211], v249, s[32:35], s16 offen offset:2048 sc1
    ds_read_b64_tr_b16 v[44:45], v20 offset:36864
    ds_read_b64_tr_b16 v[46:47], v20 offset:38912
    s_waitcnt lgkmcnt(10)
    v_mfma_f32_32x32x16_bf16 v[136:151], v[52:55], v[212:215], v[136:151]
    ds_read_b64_tr_b16 v[48:49], v20 offset:37888
    ds_read_b64_tr_b16 v[50:51], v20 offset:39936
    s_waitcnt lgkmcnt(10)
    v_mfma_f32_32x32x16_bf16 v[88:103], v[28:31], v[212:215], v[88:103]
    ds_read_b64_tr_b16 v[52:53], v20 offset:40960
    ds_read_b64_tr_b16 v[54:55], v20 offset:43008
    s_waitcnt lgkmcnt(10)
    v_mfma_f32_32x32x16_bf16 v[104:119], v[32:35], v[212:215], v[104:119]
    buffer_load_dwordx4 v[212:215], v249, s[32:35], s16 offen offset:3072 sc1
    ds_read_b64_tr_b16 v[28:29], v20 offset:41984
    ds_read_b64_tr_b16 v[30:31], v20 offset:44032
    s_barrier
    s_waitcnt vmcnt(23)
    s_waitcnt lgkmcnt(10)
    v_mfma_f32_32x32x16_bf16 v[56:71], v[36:39], v[216:219], v[56:71]
    s_add_u32 s16, s16, 16384
    ds_read_b64_tr_b16 v[32:33], v20 offset:45056
    ds_read_b64_tr_b16 v[34:35], v20 offset:47104
    s_waitcnt vmcnt(22)
    s_waitcnt lgkmcnt(10)
    v_mfma_f32_32x32x16_bf16 v[56:71], v[40:43], v[220:223], v[56:71]
    s_and_b32 s16, s16, 0x3ffff
    ds_read_b64_tr_b16 v[36:37], v20 offset:46080
    ds_read_b64_tr_b16 v[38:39], v20 offset:48128
    s_waitcnt vmcnt(21)
    s_waitcnt lgkmcnt(10)
    v_mfma_f32_32x32x16_bf16 v[56:71], v[44:47], v[224:227], v[56:71]
    ds_read_b64_tr_b16 v[40:41], v20
    ds_read_b64_tr_b16 v[42:43], v20 offset:2048
    s_waitcnt vmcnt(20)
    s_waitcnt lgkmcnt(10)
    v_mfma_f32_32x32x16_bf16 v[56:71], v[48:51], v[228:231], v[56:71]
    ds_read_b64_tr_b16 v[44:45], v20 offset:1024
    ds_read_b64_tr_b16 v[46:47], v20 offset:3072
    s_waitcnt vmcnt(19)
    s_waitcnt lgkmcnt(10)
    v_mfma_f32_32x32x16_bf16 v[56:71], v[52:55], v[232:235], v[56:71]
    ds_read_b64_tr_b16 v[48:49], v20 offset:4096
    ds_read_b64_tr_b16 v[50:51], v20 offset:6144
    s_waitcnt vmcnt(18)
    s_waitcnt lgkmcnt(10)
    v_mfma_f32_32x32x16_bf16 v[56:71], v[28:31], v[236:239], v[56:71]
    ds_read_b64_tr_b16 v[52:53], v20 offset:5120
    ds_read_b64_tr_b16 v[54:55], v20 offset:7168
    s_waitcnt vmcnt(17)
    s_waitcnt lgkmcnt(10)
    v_mfma_f32_32x32x16_bf16 v[56:71], v[32:35], v[240:243], v[56:71]
    ds_read_b64_tr_b16 v[28:29], v20 offset:8192
    ds_read_b64_tr_b16 v[30:31], v20 offset:10240
    s_waitcnt vmcnt(16)
    s_waitcnt lgkmcnt(10)
    v_mfma_f32_32x32x16_bf16 v[56:71], v[36:39], v[244:247], v[56:71]
    ds_read_b64_tr_b16 v[32:33], v20 offset:9216
    ds_read_b64_tr_b16 v[34:35], v20 offset:11264
    s_waitcnt vmcnt(15)
    s_waitcnt lgkmcnt(10)
    v_mfma_f32_32x32x16_bf16 v[56:71], v[40:43], v[152:155], v[56:71]
    ds_read_b64_tr_b16 v[36:37], v20 offset:12288
    ds_read_b64_tr_b16 v[38:39], v20 offset:14336
    s_waitcnt vmcnt(14)
    s_waitcnt lgkmcnt(10)
    v_mfma_f32_32x32x16_bf16 v[56:71], v[44:47], v[156:159], v[56:71]
    ds_read_b64_tr_b16 v[40:41], v20 offset:13312
    ds_read_b64_tr_b16 v[42:43], v20 offset:15360
    s_waitcnt vmcnt(13)
    s_waitcnt lgkmcnt(10)
    v_mfma_f32_32x32x16_bf16 v[56:71], v[48:51], v[160:163], v[56:71]
    ds_read_b64_tr_b16 v[44:45], v20 offset:16384
    ds_read_b64_tr_b16 v[46:47], v20 offset:18432
    s_waitcnt vmcnt(12)
    s_waitcnt lgkmcnt(10)
    v_mfma_f32_32x32x16_bf16 v[56:71], v[52:55], v[164:167], v[56:71]
    ds_read_b64_tr_b16 v[48:49], v20 offset:17408
    ds_read_b64_tr_b16 v[50:51], v20 offset:19456
    s_waitcnt vmcnt(11)
    s_waitcnt lgkmcnt(10)
    v_mfma_f32_32x32x16_bf16 v[56:71], v[28:31], v[168:171], v[56:71]
    ds_read_b64_tr_b16 v[52:53], v20 offset:20480
    ds_read_b64_tr_b16 v[54:55], v20 offset:22528
    s_waitcnt vmcnt(10)
    s_waitcnt lgkmcnt(10)
    v_mfma_f32_32x32x16_bf16 v[56:71], v[32:35], v[172:175], v[56:71]
    ds_read_b64_tr_b16 v[28:29], v20 offset:21504
    ds_read_b64_tr_b16 v[30:31], v20 offset:23552
    s_barrier
    s_waitcnt vmcnt(9)
    s_waitcnt lgkmcnt(10)
    v_mfma_f32_32x32x16_bf16 v[56:71], v[36:39], v[176:179], v[56:71]
    ds_read_b64_tr_b16 v[32:33], v20 offset:24576
    ds_read_b64_tr_b16 v[34:35], v20 offset:26624
    s_waitcnt vmcnt(8)
    s_waitcnt lgkmcnt(10)
    v_mfma_f32_32x32x16_bf16 v[56:71], v[40:43], v[180:183], v[56:71]
    ds_read_b64_tr_b16 v[36:37], v20 offset:25600
    ds_read_b64_tr_b16 v[38:39], v20 offset:27648
    s_waitcnt vmcnt(7)
    s_waitcnt lgkmcnt(10)
    v_mfma_f32_32x32x16_bf16 v[56:71], v[44:47], v[184:187], v[56:71]
    ds_read_b64_tr_b16 v[40:41], v20 offset:28672
    ds_read_b64_tr_b16 v[42:43], v20 offset:30720
    s_waitcnt vmcnt(6)
    s_waitcnt lgkmcnt(10)
    v_mfma_f32_32x32x16_bf16 v[56:71], v[48:51], v[188:191], v[56:71]
    ds_read_b64_tr_b16 v[44:45], v20 offset:29696
    ds_read_b64_tr_b16 v[46:47], v20 offset:31744
    s_waitcnt vmcnt(5)
    s_waitcnt lgkmcnt(10)
    v_mfma_f32_32x32x16_bf16 v[56:71], v[52:55], v[192:195], v[56:71]
    ds_read_b64_tr_b16 v[48:49], v21 offset:32768
    ds_read_b64_tr_b16 v[50:51], v21 offset:34816
    s_waitcnt vmcnt(4)
    s_waitcnt lgkmcnt(10)
    v_mfma_f32_32x32x16_bf16 v[56:71], v[28:31], v[196:199], v[56:71]
    ds_read_b64_tr_b16 v[52:53], v21 offset:33792
    ds_read_b64_tr_b16 v[54:55], v21 offset:35840
    s_waitcnt vmcnt(3)
    s_waitcnt lgkmcnt(10)
    v_mfma_f32_32x32x16_bf16 v[56:71], v[32:35], v[200:203], v[56:71]
    ds_read_b64_tr_b16 v[28:29], v21 offset:36864
    ds_read_b64_tr_b16 v[30:31], v21 offset:38912
    s_waitcnt vmcnt(2)
    s_waitcnt lgkmcnt(10)
    v_mfma_f32_32x32x16_bf16 v[56:71], v[36:39], v[204:207], v[56:71]
    ds_read_b64_tr_b16 v[32:33], v21 offset:37888
    ds_read_b64_tr_b16 v[34:35], v21 offset:39936
    s_waitcnt vmcnt(1)
    s_waitcnt lgkmcnt(10)
    v_mfma_f32_32x32x16_bf16 v[56:71], v[40:43], v[208:211], v[56:71]
    ds_read_b64_tr_b16 v[36:37], v21 offset:40960
    ds_read_b64_tr_b16 v[38:39], v21 offset:43008
    s_waitcnt vmcnt(0)
    s_waitcnt lgkmcnt(10)
    v_mfma_f32_32x32x16_bf16 v[56:71], v[44:47], v[212:215], v[56:71]
    ds_read_b64_tr_b16 v[40:41], v21 offset:41984
    ds_read_b64_tr_b16 v[42:43], v21 offset:44032
    s_waitcnt lgkmcnt(10)
    v_mfma_f32_32x32x16_bf16 v[72:87], v[48:51], v[216:219], v[72:87]
    ds_read_b64_tr_b16 v[44:45], v21 offset:45056
    ds_read_b64_tr_b16 v[46:47], v21 offset:47104
    s_waitcnt lgkmcnt(10)
    v_mfma_f32_32x32x16_bf16 v[72:87], v[52:55], v[220:223], v[72:87]
    s_nop 3
    v_cvt_pk_bf16_f32 v56, v56, v57
    v_cvt_pk_bf16_f32 v57, v58, v59
    ds_read_b64_tr_b16 v[48:49], v21 offset:46080
    ds_read_b64_tr_b16 v[50:51], v21 offset:48128
    s_waitcnt lgkmcnt(10)
    v_mfma_f32_32x32x16_bf16 v[72:87], v[28:31], v[224:227], v[72:87]
    v_cvt_pk_bf16_f32 v58, v60, v61
    v_cvt_pk_bf16_f32 v59, v62, v63
    ds_read_b64_tr_b16 v[52:53], v21
    ds_read_b64_tr_b16 v[54:55], v21 offset:2048
    s_waitcnt lgkmcnt(10)
    v_mfma_f32_32x32x16_bf16 v[72:87], v[32:35], v[228:231], v[72:87]
    ds_write_b128 v0, v[56:59]
    v_cvt_pk_bf16_f32 v60, v64, v65
    ds_read_b64_tr_b16 v[28:29], v21 offset:1024
    ds_read_b64_tr_b16 v[30:31], v21 offset:3072
    s_waitcnt lgkmcnt(11)
    v_mfma_f32_32x32x16_bf16 v[72:87], v[36:39], v[232:235], v[72:87]
    v_cvt_pk_bf16_f32 v61, v66, v67
    v_cvt_pk_bf16_f32 v62, v68, v69
    ds_read_b64_tr_b16 v[32:33], v21 offset:4096
    ds_read_b64_tr_b16 v[34:35], v21 offset:6144
    s_waitcnt lgkmcnt(11)
    v_mfma_f32_32x32x16_bf16 v[72:87], v[40:43], v[236:239], v[72:87]
    v_cvt_pk_bf16_f32 v63, v70, v71
    ds_write_b128 v0, v[60:63] offset:1024
    ds_read_b64_tr_b16 v[36:37], v21 offset:5120
    ds_read_b64_tr_b16 v[38:39], v21 offset:7168
    s_waitcnt lgkmcnt(12)
    v_mfma_f32_32x32x16_bf16 v[72:87], v[44:47], v[240:243], v[72:87]
    v_subrev_u32 v0, 118784, v0
    ds_read_b64_tr_b16 v[40:41], v21 offset:8192
    ds_read_b64_tr_b16 v[42:43], v21 offset:10240
    s_waitcnt lgkmcnt(12)
    v_mfma_f32_32x32x16_bf16 v[72:87], v[48:51], v[244:247], v[72:87]
    ds_read_b64_tr_b16 v[44:45], v21 offset:9216
    ds_read_b64_tr_b16 v[46:47], v21 offset:11264
    s_waitcnt lgkmcnt(6)
    s_barrier
    v_mfma_f32_32x32x16_bf16 v[72:87], v[52:55], v[152:155], v[72:87]
    ds_read_b64_tr_b16 v[48:49], v21 offset:12288
    ds_read_b64_tr_b16 v[50:51], v21 offset:14336
    v_mfma_f32_32x32x16_bf16 v[72:87], v[28:31], v[156:159], v[72:87]
    ds_read_b64_tr_b16 v[52:53], v21 offset:13312
    ds_read_b64_tr_b16 v[54:55], v21 offset:15360
    v_mfma_f32_32x32x16_bf16 v[72:87], v[32:35], v[160:163], v[72:87]
    ds_read_b64_tr_b16 v[28:29], v21 offset:16384
    ds_read_b64_tr_b16 v[30:31], v21 offset:18432
    s_waitcnt lgkmcnt(10)
    v_mfma_f32_32x32x16_bf16 v[72:87], v[36:39], v[164:167], v[72:87]
    ds_read_b64_tr_b16 v[32:33], v21 offset:17408
    ds_read_b64_tr_b16 v[34:35], v21 offset:19456
    s_waitcnt lgkmcnt(10)
    v_mfma_f32_32x32x16_bf16 v[72:87], v[40:43], v[168:171], v[72:87]
    ds_read_b64_tr_b16 v[36:37], v21 offset:20480
    ds_read_b64_tr_b16 v[38:39], v21 offset:22528
    s_waitcnt lgkmcnt(10)
    v_mfma_f32_32x32x16_bf16 v[72:87], v[44:47], v[172:175], v[72:87]
    ds_read_b64_tr_b16 v[40:41], v21 offset:21504
    ds_read_b64_tr_b16 v[42:43], v21 offset:23552
    s_waitcnt lgkmcnt(10)
    v_mfma_f32_32x32x16_bf16 v[72:87], v[48:51], v[176:179], v[72:87]
    ds_read_b64_tr_b16 v[44:45], v21 offset:24576
    ds_read_b64_tr_b16 v[46:47], v21 offset:26624
    s_waitcnt lgkmcnt(10)
    v_mfma_f32_32x32x16_bf16 v[72:87], v[52:55], v[180:183], v[72:87]
    ds_read_b64_tr_b16 v[48:49], v21 offset:25600
    ds_read_b64_tr_b16 v[50:51], v21 offset:27648
    s_waitcnt lgkmcnt(10)
    v_mfma_f32_32x32x16_bf16 v[72:87], v[28:31], v[184:187], v[72:87]
    ds_read_b64_tr_b16 v[52:53], v21 offset:28672
    ds_read_b64_tr_b16 v[54:55], v21 offset:30720
    s_waitcnt lgkmcnt(10)
    v_mfma_f32_32x32x16_bf16 v[72:87], v[32:35], v[188:191], v[72:87]
    ds_read_b64_tr_b16 v[28:29], v21 offset:29696
    ds_read_b64_tr_b16 v[30:31], v21 offset:31744
    s_waitcnt lgkmcnt(10)
    v_mfma_f32_32x32x16_bf16 v[72:87], v[36:39], v[192:195], v[72:87]
    ds_read_b64_tr_b16 v[32:33], v22 offset:32768
    ds_read_b64_tr_b16 v[34:35], v22 offset:34816
    s_waitcnt lgkmcnt(10)
    v_mfma_f32_32x32x16_bf16 v[72:87], v[40:43], v[196:199], v[72:87]
    ds_read_b64_tr_b16 v[36:37], v23 offset:32768
    ds_read_b64_tr_b16 v[38:39], v23 offset:34816
    s_waitcnt lgkmcnt(10)
    v_mfma_f32_32x32x16_bf16 v[72:87], v[44:47], v[200:203], v[72:87]
    ds_read_b64_tr_b16 v[40:41], v22 offset:33792
    ds_read_b64_tr_b16 v[42:43], v22 offset:35840
    s_waitcnt lgkmcnt(10)
    v_mfma_f32_32x32x16_bf16 v[72:87], v[48:51], v[204:207], v[72:87]
    ds_read_b64_tr_b16 v[44:45], v23 offset:33792
    ds_read_b64_tr_b16 v[46:47], v23 offset:35840
    s_waitcnt lgkmcnt(10)
    v_mfma_f32_32x32x16_bf16 v[72:87], v[52:55], v[208:211], v[72:87]
    ds_read_b64_tr_b16 v[48:49], v22 offset:36864
    ds_read_b64_tr_b16 v[50:51], v22 offset:38912
    s_waitcnt lgkmcnt(10)
    v_mfma_f32_32x32x16_bf16 v[72:87], v[28:31], v[212:215], v[72:87]
    ds_read_b64_tr_b16 v[52:53], v23 offset:36864
    ds_read_b64_tr_b16 v[54:55], v23 offset:38912
    s_waitcnt lgkmcnt(10)
    v_mfma_f32_32x32x16_bf16 v[88:103], v[32:35], v[216:219], v[88:103]
    ds_read_b64_tr_b16 v[28:29], v22 offset:37888
    ds_read_b64_tr_b16 v[30:31], v22 offset:39936
    s_waitcnt lgkmcnt(10)
    v_mfma_f32_32x32x16_bf16 v[104:119], v[36:39], v[216:219], v[104:119]
    s_nop 3
    v_cvt_pk_bf16_f32 v72, v72, v73
    v_cvt_pk_bf16_f32 v73, v74, v75
    ds_read_b64_tr_b16 v[32:33], v23 offset:37888
    ds_read_b64_tr_b16 v[34:35], v23 offset:39936
    s_waitcnt lgkmcnt(10)
    v_mfma_f32_32x32x16_bf16 v[88:103], v[40:43], v[220:223], v[88:103]
    v_cvt_pk_bf16_f32 v74, v76, v77
    v_cvt_pk_bf16_f32 v75, v78, v79
    ds_read_b64_tr_b16 v[36:37], v22 offset:40960
    ds_read_b64_tr_b16 v[38:39], v22 offset:43008
    s_waitcnt lgkmcnt(10)
    v_mfma_f32_32x32x16_bf16 v[104:119], v[44:47], v[220:223], v[104:119]
    ds_write_b128 v0, v[72:75]
    v_cvt_pk_bf16_f32 v76, v80, v81
    ds_read_b64_tr_b16 v[40:41], v23 offset:40960
    ds_read_b64_tr_b16 v[42:43], v23 offset:43008
    s_waitcnt lgkmcnt(11)
    v_mfma_f32_32x32x16_bf16 v[88:103], v[48:51], v[224:227], v[88:103]
    v_cvt_pk_bf16_f32 v77, v82, v83
    v_cvt_pk_bf16_f32 v78, v84, v85
    ds_read_b64_tr_b16 v[44:45], v22 offset:41984
    ds_read_b64_tr_b16 v[46:47], v22 offset:44032
    s_waitcnt lgkmcnt(11)
    v_mfma_f32_32x32x16_bf16 v[104:119], v[52:55], v[224:227], v[104:119]
    v_cvt_pk_bf16_f32 v79, v86, v87
    ds_write_b128 v0, v[76:79] offset:1024
    ds_read_b64_tr_b16 v[48:49], v23 offset:41984
    ds_read_b64_tr_b16 v[50:51], v23 offset:44032
    s_waitcnt lgkmcnt(12)
    v_mfma_f32_32x32x16_bf16 v[88:103], v[28:31], v[228:231], v[88:103]
    ds_read_b64_tr_b16 v[52:53], v22 offset:45056
    ds_read_b64_tr_b16 v[54:55], v22 offset:47104
    s_waitcnt lgkmcnt(12)
    v_mfma_f32_32x32x16_bf16 v[104:119], v[32:35], v[228:231], v[104:119]
    ds_read_b64_tr_b16 v[28:29], v23 offset:45056
    ds_read_b64_tr_b16 v[30:31], v23 offset:47104
    s_waitcnt lgkmcnt(6)
    s_barrier
    v_mfma_f32_32x32x16_bf16 v[88:103], v[36:39], v[232:235], v[88:103]
    s_lshl_b32 s96, s77, 11
    s_add_u32 s14, s96, 32768
    v_and_b32 v0, 7, v1
    ds_read_b64_tr_b16 v[32:33], v22 offset:46080
    ds_read_b64_tr_b16 v[34:35], v22 offset:48128
    v_mfma_f32_32x32x16_bf16 v[104:119], v[40:43], v[232:235], v[104:119]
    v_lshl_add_u32 v0, v0, 4, s14
    ds_read_b64_tr_b16 v[36:37], v23 offset:46080
    ds_read_b64_tr_b16 v[38:39], v23 offset:48128
    v_mfma_f32_32x32x16_bf16 v[88:103], v[44:47], v[236:239], v[88:103]
    v_bfe_u32 v4, v1, 3, 2
    ds_read_b64_tr_b16 v[40:41], v22
    ds_read_b64_tr_b16 v[42:43], v22 offset:2048
    s_waitcnt lgkmcnt(10)
    v_mfma_f32_32x32x16_bf16 v[104:119], v[48:51], v[236:239], v[104:119]
    v_lshl_add_u32 v0, v4, 8, v0
    v_lshrrev_b32 v4, 5, v1
    ds_read_b64_tr_b16 v[44:45], v23
    ds_read_b64_tr_b16 v[46:47], v23 offset:2048
    s_waitcnt lgkmcnt(10)
    v_mfma_f32_32x32x16_bf16 v[88:103], v[52:55], v[240:243], v[88:103]
    v_lshl_add_u32 v0, v4, 7, v0
    ds_read_b64_tr_b16 v[48:49], v22 offset:1024
    ds_read_b64_tr_b16 v[50:51], v22 offset:3072
    s_waitcnt lgkmcnt(10)
    v_mfma_f32_32x32x16_bf16 v[104:119], v[28:31], v[240:243], v[104:119]
    ds_read_b64_tr_b16 v[52:53], v23 offset:1024
    ds_read_b64_tr_b16 v[54:55], v23 offset:3072
    s_waitcnt lgkmcnt(10)
    v_mfma_f32_32x32x16_bf16 v[88:103], v[32:35], v[244:247], v[88:103]
    ds_read_b64_tr_b16 v[28:29], v22 offset:4096
    ds_read_b64_tr_b16 v[30:31], v22 offset:6144
    s_waitcnt lgkmcnt(10)
    v_mfma_f32_32x32x16_bf16 v[104:119], v[36:39], v[244:247], v[104:119]
    ds_read_b64_tr_b16 v[32:33], v23 offset:4096
    ds_read_b64_tr_b16 v[34:35], v23 offset:6144
    s_waitcnt lgkmcnt(10)
    v_mfma_f32_32x32x16_bf16 v[88:103], v[40:43], v[152:155], v[88:103]
    ds_read_b64_tr_b16 v[36:37], v22 offset:5120
    ds_read_b64_tr_b16 v[38:39], v22 offset:7168
    s_waitcnt lgkmcnt(10)
    v_mfma_f32_32x32x16_bf16 v[104:119], v[44:47], v[152:155], v[104:119]
    ds_read_b64_tr_b16 v[40:41], v23 offset:5120
    ds_read_b64_tr_b16 v[42:43], v23 offset:7168
    s_waitcnt lgkmcnt(10)
    v_mfma_f32_32x32x16_bf16 v[88:103], v[48:51], v[156:159], v[88:103]
    ds_read_b64_tr_b16 v[44:45], v22 offset:8192
    ds_read_b64_tr_b16 v[46:47], v22 offset:10240
    s_waitcnt lgkmcnt(10)
    v_mfma_f32_32x32x16_bf16 v[104:119], v[52:55], v[156:159], v[104:119]
    ds_read_b64_tr_b16 v[48:49], v23 offset:8192
    ds_read_b64_tr_b16 v[50:51], v23 offset:10240
    s_waitcnt lgkmcnt(10)
    v_mfma_f32_32x32x16_bf16 v[88:103], v[28:31], v[160:163], v[88:103]
    ds_read_b64_tr_b16 v[52:53], v22 offset:9216
    ds_read_b64_tr_b16 v[54:55], v22 offset:11264
    s_waitcnt lgkmcnt(10)
    v_mfma_f32_32x32x16_bf16 v[104:119], v[32:35], v[160:163], v[104:119]
    ds_read_b64_tr_b16 v[28:29], v23 offset:9216
    ds_read_b64_tr_b16 v[30:31], v23 offset:11264
    s_waitcnt lgkmcnt(10)
    v_mfma_f32_32x32x16_bf16 v[88:103], v[36:39], v[164:167], v[88:103]
    ds_read_b64_tr_b16 v[32:33], v22 offset:12288
    ds_read_b64_tr_b16 v[34:35], v22 offset:14336
    s_waitcnt lgkmcnt(10)
    v_mfma_f32_32x32x16_bf16 v[104:119], v[40:43], v[164:167], v[104:119]
    ds_read_b64_tr_b16 v[36:37], v23 offset:12288
    ds_read_b64_tr_b16 v[38:39], v23 offset:14336
    s_waitcnt lgkmcnt(10)
    v_mfma_f32_32x32x16_bf16 v[88:103], v[44:47], v[168:171], v[88:103]
    ds_read_b64_tr_b16 v[40:41], v22 offset:13312
    ds_read_b64_tr_b16 v[42:43], v22 offset:15360
    s_waitcnt lgkmcnt(10)
    v_mfma_f32_32x32x16_bf16 v[104:119], v[48:51], v[168:171], v[104:119]
    ds_read_b64_tr_b16 v[44:45], v23 offset:13312
    ds_read_b64_tr_b16 v[46:47], v23 offset:15360
    s_waitcnt lgkmcnt(10)
    v_mfma_f32_32x32x16_bf16 v[88:103], v[52:55], v[172:175], v[88:103]
    ds_read_b64_tr_b16 v[48:49], v22 offset:16384
    ds_read_b64_tr_b16 v[50:51], v22 offset:18432
    s_waitcnt lgkmcnt(10)
    v_mfma_f32_32x32x16_bf16 v[104:119], v[28:31], v[172:175], v[104:119]
    ds_read_b64_tr_b16 v[52:53], v23 offset:16384
    ds_read_b64_tr_b16 v[54:55], v23 offset:18432
    s_waitcnt lgkmcnt(10)
    v_mfma_f32_32x32x16_bf16 v[88:103], v[32:35], v[176:179], v[88:103]
    ds_read_b64_tr_b16 v[28:29], v22 offset:17408
    ds_read_b64_tr_b16 v[30:31], v22 offset:19456
    s_waitcnt lgkmcnt(10)
    v_mfma_f32_32x32x16_bf16 v[104:119], v[36:39], v[176:179], v[104:119]
    ds_read_b64_tr_b16 v[32:33], v23 offset:17408
    ds_read_b64_tr_b16 v[34:35], v23 offset:19456
    s_waitcnt lgkmcnt(10)
    v_mfma_f32_32x32x16_bf16 v[88:103], v[40:43], v[180:183], v[88:103]
    ds_read_b64_tr_b16 v[36:37], v22 offset:20480
    ds_read_b64_tr_b16 v[38:39], v22 offset:22528
    s_waitcnt lgkmcnt(10)
    v_mfma_f32_32x32x16_bf16 v[104:119], v[44:47], v[180:183], v[104:119]
    ds_read_b64_tr_b16 v[40:41], v23 offset:20480
    ds_read_b64_tr_b16 v[42:43], v23 offset:22528
    s_waitcnt lgkmcnt(10)
    v_mfma_f32_32x32x16_bf16 v[88:103], v[48:51], v[184:187], v[88:103]
    ds_read_b64_tr_b16 v[44:45], v22 offset:21504
    ds_read_b64_tr_b16 v[46:47], v22 offset:23552
    s_waitcnt lgkmcnt(10)
    v_mfma_f32_32x32x16_bf16 v[104:119], v[52:55], v[184:187], v[104:119]
    ds_read_b64_tr_b16 v[48:49], v23 offset:21504
    ds_read_b64_tr_b16 v[50:51], v23 offset:23552
    s_waitcnt lgkmcnt(10)
    v_mfma_f32_32x32x16_bf16 v[88:103], v[28:31], v[188:191], v[88:103]
    ds_read_b64_tr_b16 v[52:53], v22 offset:24576
    ds_read_b64_tr_b16 v[54:55], v22 offset:26624
    s_waitcnt lgkmcnt(10)
    v_mfma_f32_32x32x16_bf16 v[104:119], v[32:35], v[188:191], v[104:119]
    ds_read_b64_tr_b16 v[28:29], v23 offset:24576
    ds_read_b64_tr_b16 v[30:31], v23 offset:26624
    s_waitcnt lgkmcnt(10)
    v_mfma_f32_32x32x16_bf16 v[88:103], v[36:39], v[192:195], v[88:103]
    ds_read_b64_tr_b16 v[32:33], v22 offset:25600
    ds_read_b64_tr_b16 v[34:35], v22 offset:27648
    s_waitcnt lgkmcnt(10)
    v_mfma_f32_32x32x16_bf16 v[104:119], v[40:43], v[192:195], v[104:119]
    ds_read_b64_tr_b16 v[36:37], v23 offset:25600
    ds_read_b64_tr_b16 v[38:39], v23 offset:27648
    s_waitcnt lgkmcnt(10)
    v_mfma_f32_32x32x16_bf16 v[88:103], v[44:47], v[196:199], v[88:103]
    ds_read_b64_tr_b16 v[40:41], v22 offset:28672
    ds_read_b64_tr_b16 v[42:43], v22 offset:30720
    s_waitcnt lgkmcnt(10)
    v_mfma_f32_32x32x16_bf16 v[104:119], v[48:51], v[196:199], v[104:119]
    ds_read_b64_tr_b16 v[44:45], v23 offset:28672
    ds_read_b64_tr_b16 v[46:47], v23 offset:30720
    s_waitcnt lgkmcnt(10)
    v_mfma_f32_32x32x16_bf16 v[88:103], v[52:55], v[200:203], v[88:103]
    ds_read_b64_tr_b16 v[48:49], v22 offset:29696
    ds_read_b64_tr_b16 v[50:51], v22 offset:31744
    s_waitcnt lgkmcnt(10)
    v_mfma_f32_32x32x16_bf16 v[104:119], v[28:31], v[200:203], v[104:119]
    ds_read_b64_tr_b16 v[52:53], v23 offset:29696
    ds_read_b64_tr_b16 v[54:55], v23 offset:31744
    s_waitcnt lgkmcnt(10)
    v_mfma_f32_32x32x16_bf16 v[88:103], v[32:35], v[204:207], v[88:103]
    ds_read_b64_tr_b16 v[28:29], v24 offset:32768
    ds_read_b64_tr_b16 v[30:31], v24 offset:34816
    s_waitcnt lgkmcnt(10)
    v_mfma_f32_32x32x16_bf16 v[104:119], v[36:39], v[204:207], v[104:119]
    ds_read_b64_tr_b16 v[32:33], v25 offset:32768
    ds_read_b64_tr_b16 v[34:35], v25 offset:34816
    s_waitcnt lgkmcnt(10)
    v_mfma_f32_32x32x16_bf16 v[88:103], v[40:43], v[208:211], v[88:103]
L_PAD4:
    s_cbranch_execz L_RET4
    ds_read_b64_tr_b16 v[36:37], v24 offset:33792
    ds_read_b64_tr_b16 v[38:39], v24 offset:35840
    s_waitcnt lgkmcnt(10)
    v_mfma_f32_32x32x16_bf16 v[104:119], v[44:47], v[208:211], v[104:119]
    ds_read_b64_tr_b16 v[40:41], v25 offset:33792
    ds_read_b64_tr_b16 v[42:43], v25 offset:35840
    s_waitcnt lgkmcnt(10)
    v_mfma_f32_32x32x16_bf16 v[88:103], v[48:51], v[212:215], v[88:103]
    ds_read_b64_tr_b16 v[44:45], v24 offset:36864
    ds_read_b64_tr_b16 v[46:47], v24 offset:38912
    s_waitcnt lgkmcnt(10)
    v_mfma_f32_32x32x16_bf16 v[104:119], v[52:55], v[212:215], v[104:119]
    ds_read_b64_tr_b16 v[48:49], v25 offset:36864
    ds_read_b64_tr_b16 v[50:51], v25 offset:38912
    s_barrier
    s_waitcnt lgkmcnt(10)
    v_mfma_f32_32x32x16_bf16 v[120:135], v[28:31], v[216:219], v[120:135]
    ds_read_b64_tr_b16 v[52:53], v24 offset:37888
    ds_read_b64_tr_b16 v[54:55], v24 offset:39936
    s_waitcnt lgkmcnt(10)
    v_mfma_f32_32x32x16_bf16 v[136:151], v[32:35], v[216:219], v[136:151]
    ds_read_b64_tr_b16 v[28:29], v25 offset:37888
    ds_read_b64_tr_b16 v[30:31], v25 offset:39936
    s_waitcnt lgkmcnt(10)
    v_mfma_f32_32x32x16_bf16 v[120:135], v[36:39], v[220:223], v[120:135]
    v_cvt_pk_bf16_f32 v88, v88, v89
    ds_read_b64_tr_b16 v[32:33], v24 offset:40960
    ds_read_b64_tr_b16 v[34:35], v24 offset:43008
    s_waitcnt lgkmcnt(10)
    v_mfma_f32_32x32x16_bf16 v[136:151], v[40:43], v[220:223], v[136:151]
    v_cvt_pk_bf16_f32 v89, v90, v91
    ds_read_b64_tr_b16 v[36:37], v25 offset:40960
    ds_read_b64_tr_b16 v[38:39], v25 offset:43008
    s_waitcnt lgkmcnt(10)
    v_mfma_f32_32x32x16_bf16 v[120:135], v[44:47], v[224:227], v[120:135]
    v_cvt_pk_bf16_f32 v90, v92, v93
    ds_read_b64_tr_b16 v[40:41], v24 offset:41984
    ds_read_b64_tr_b16 v[42:43], v24 offset:44032
    s_waitcnt lgkmcnt(10)
    v_mfma_f32_32x32x16_bf16 v[136:151], v[48:51], v[224:227], v[136:151]
    v_cvt_pk_bf16_f32 v91, v94, v95
    ds_read_b64_tr_b16 v[44:45], v25 offset:41984
    ds_read_b64_tr_b16 v[46:47], v25 offset:44032
    s_waitcnt lgkmcnt(10)
    v_mfma_f32_32x32x16_bf16 v[120:135], v[52:55], v[228:231], v[120:135]
    ds_write_b128 v0, v[88:91]
    ds_read_b64_tr_b16 v[48:49], v24 offset:45056
    ds_read_b64_tr_b16 v[50:51], v24 offset:47104
    s_waitcnt lgkmcnt(11)
    v_mfma_f32_32x32x16_bf16 v[136:151], v[28:31], v[228:231], v[136:151]
    v_cvt_pk_bf16_f32 v92, v96, v97
    ds_read_b64_tr_b16 v[52:53], v25 offset:45056
    ds_read_b64_tr_b16 v[54:55], v25 offset:47104
    s_waitcnt lgkmcnt(11)
    v_mfma_f32_32x32x16_bf16 v[120:135], v[32:35], v[232:235], v[120:135]
    v_cvt_pk_bf16_f32 v93, v98, v99
    ds_read_b64_tr_b16 v[28:29], v24 offset:46080
    ds_read_b64_tr_b16 v[30:31], v24 offset:48128
    s_waitcnt lgkmcnt(11)
    v_mfma_f32_32x32x16_bf16 v[136:151], v[36:39], v[232:235], v[136:151]
    v_cvt_pk_bf16_f32 v94, v100, v101
    ds_read_b64_tr_b16 v[32:33], v25 offset:46080
    ds_read_b64_tr_b16 v[34:35], v25 offset:48128
    s_waitcnt lgkmcnt(11)
    v_mfma_f32_32x32x16_bf16 v[120:135], v[40:43], v[236:239], v[120:135]
    v_cvt_pk_bf16_f32 v95, v102, v103
    ds_read_b64_tr_b16 v[36:37], v24
    ds_read_b64_tr_b16 v[38:39], v24 offset:2048
    s_waitcnt lgkmcnt(11)
    v_mfma_f32_32x32x16_bf16 v[136:151], v[44:47], v[236:239], v[136:151]
    ds_write_b128 v0, v[92:95] offset:1024
    ds_read_b64_tr_b16 v[40:41], v25
    ds_read_b64_tr_b16 v[42:43], v25 offset:2048
    s_waitcnt lgkmcnt(11)
    v_mfma_f32_32x32x16_bf16 v[120:135], v[48:51], v[240:243], v[120:135]
    v_cvt_pk_bf16_f32 v104, v104, v105
    ds_read_b64_tr_b16 v[44:45], v24 offset:1024
    ds_read_b64_tr_b16 v[46:47], v24 offset:3072
    s_waitcnt lgkmcnt(11)
    v_mfma_f32_32x32x16_bf16 v[136:151], v[52:55], v[240:243], v[136:151]
    v_cvt_pk_bf16_f32 v105, v106, v107
    ds_read_b64_tr_b16 v[48:49], v25 offset:1024
    ds_read_b64_tr_b16 v[50:51], v25 offset:3072
    s_waitcnt lgkmcnt(11)
    v_mfma_f32_32x32x16_bf16 v[120:135], v[28:31], v[244:247], v[120:135]
    v_cvt_pk_bf16_f32 v106, v108, v109
    ds_read_b64_tr_b16 v[52:53], v24 offset:4096
    ds_read_b64_tr_b16 v[54:55], v24 offset:6144
    s_waitcnt lgkmcnt(11)
    v_mfma_f32_32x32x16_bf16 v[136:151], v[32:35], v[244:247], v[136:151]
    v_cvt_pk_bf16_f32 v107, v110, v111
    ds_read_b64_tr_b16 v[28:29], v25 offset:4096
    ds_read_b64_tr_b16 v[30:31], v25 offset:6144
    s_waitcnt lgkmcnt(11)
    v_mfma_f32_32x32x16_bf16 v[120:135], v[36:39], v[152:155], v[120:135]
    ds_write_b128 v0, v[104:107] offset:8192
    ds_read_b64_tr_b16 v[32:33], v24 offset:5120
    ds_read_b64_tr_b16 v[34:35], v24 offset:7168
    s_waitcnt lgkmcnt(11)
    v_mfma_f32_32x32x16_bf16 v[136:151], v[40:43], v[152:155], v[136:151]
    v_cvt_pk_bf16_f32 v108, v112, v113
    ds_read_b64_tr_b16 v[36:37], v25 offset:5120
    ds_read_b64_tr_b16 v[38:39], v25 offset:7168
    s_waitcnt lgkmcnt(11)
    v_mfma_f32_32x32x16_bf16 v[120:135], v[44:47], v[156:159], v[120:135]
    v_cvt_pk_bf16_f32 v109, v114, v115
    ds_read_b64_tr_b16 v[40:41], v24 offset:8192
    ds_read_b64_tr_b16 v[42:43], v24 offset:10240
    s_waitcnt lgkmcnt(11)
    v_mfma_f32_32x32x16_bf16 v[136:151], v[48:51], v[156:159], v[136:151]
    v_cvt_pk_bf16_f32 v110, v116, v117
    ds_read_b64_tr_b16 v[44:45], v25 offset:8192
    ds_read_b64_tr_b16 v[46:47], v25 offset:10240
    s_waitcnt lgkmcnt(11)
    v_mfma_f32_32x32x16_bf16 v[120:135], v[52:55], v[160:163], v[120:135]
    v_cvt_pk_bf16_f32 v111, v118, v119
    ds_read_b64_tr_b16 v[48:49], v24 offset:9216
    ds_read_b64_tr_b16 v[50:51], v24 offset:11264
    s_waitcnt lgkmcnt(11)
    v_mfma_f32_32x32x16_bf16 v[136:151], v[28:31], v[160:163], v[136:151]
    ds_write_b128 v0, v[108:111] offset:9216
    ds_read_b64_tr_b16 v[52:53], v25 offset:9216
    ds_read_b64_tr_b16 v[54:55], v25 offset:11264
    s_waitcnt lgkmcnt(11)
    v_mfma_f32_32x32x16_bf16 v[120:135], v[32:35], v[164:167], v[120:135]
    v_and_b32 v85, 1, v1
    ds_read_b64_tr_b16 v[28:29], v24 offset:12288
    ds_read_b64_tr_b16 v[30:31], v24 offset:14336
    s_waitcnt lgkmcnt(11)
    v_mfma_f32_32x32x16_bf16 v[136:151], v[36:39], v[164:167], v[136:151]
    v_lshlrev_b32 v85, 3, v85
    ds_read_b64_tr_b16 v[32:33], v25 offset:12288
    ds_read_b64_tr_b16 v[34:35], v25 offset:14336
    s_waitcnt lgkmcnt(11)
    v_mfma_f32_32x32x16_bf16 v[120:135], v[40:43], v[168:171], v[120:135]
    v_bfe_u32 v84, v1, 2, 2
    ds_read_b64_tr_b16 v[36:37], v24 offset:13312
    ds_read_b64_tr_b16 v[38:39], v24 offset:15360
    s_waitcnt lgkmcnt(11)
    v_mfma_f32_32x32x16_bf16 v[136:151], v[44:47], v[168:171], v[136:151]
    v_lshl_add_u32 v85, v84, 4, v85
    ds_read_b64_tr_b16 v[40:41], v25 offset:13312
    ds_read_b64_tr_b16 v[42:43], v25 offset:15360
    s_waitcnt lgkmcnt(11)
    v_mfma_f32_32x32x16_bf16 v[120:135], v[48:51], v[172:175], v[120:135]
    v_bfe_u32 v84, v1, 4, 1
    ds_read_b64_tr_b16 v[44:45], v24 offset:16384
    ds_read_b64_tr_b16 v[46:47], v24 offset:18432
    s_waitcnt lgkmcnt(10)
    v_mfma_f32_32x32x16_bf16 v[136:151], v[52:55], v[172:175], v[136:151]
    v_lshl_add_u32 v85, v84, 6, v85
    ds_read_b64_tr_b16 v[48:49], v25 offset:16384
    ds_read_b64_tr_b16 v[50:51], v25 offset:18432
    s_waitcnt lgkmcnt(10)
    v_mfma_f32_32x32x16_bf16 v[120:135], v[28:31], v[176:179], v[120:135]
    v_bfe_u32 v84, v1, 1, 1
    ds_read_b64_tr_b16 v[52:53], v24 offset:17408
    ds_read_b64_tr_b16 v[54:55], v24 offset:19456
    s_waitcnt lgkmcnt(10)
    v_mfma_f32_32x32x16_bf16 v[136:151], v[32:35], v[176:179], v[136:151]
    v_lshl_add_u32 v85, v84, 7, v85
    ds_read_b64_tr_b16 v[28:29], v25 offset:17408
    ds_read_b64_tr_b16 v[30:31], v25 offset:19456
    s_waitcnt lgkmcnt(10)
    v_mfma_f32_32x32x16_bf16 v[120:135], v[36:39], v[180:183], v[120:135]
    v_lshrrev_b32 v84, 5, v1
    ds_read_b64_tr_b16 v[32:33], v24 offset:20480
    ds_read_b64_tr_b16 v[34:35], v24 offset:22528
    s_waitcnt lgkmcnt(10)
    v_mfma_f32_32x32x16_bf16 v[136:151], v[40:43], v[180:183], v[136:151]
    v_lshl_add_u32 v85, v84, 8, v85
    ds_read_b64_tr_b16 v[36:37], v25 offset:20480
    ds_read_b64_tr_b16 v[38:39], v25 offset:22528
    s_waitcnt lgkmcnt(10)
    v_mfma_f32_32x32x16_bf16 v[120:135], v[44:47], v[184:187], v[120:135]
    s_lshl_b32 s13, s3, 12
    v_add_u32 v84, s13, v85
    ds_read_b64_tr_b16 v[40:41], v24 offset:21504
    ds_read_b64_tr_b16 v[42:43], v24 offset:23552
    s_waitcnt lgkmcnt(10)
    v_mfma_f32_32x32x16_bf16 v[136:151], v[48:51], v[184:187], v[136:151]
    s_lshl_b32 s96, s76, 13
    s_add_u32 s13, s96, 32768
    v_add_u32 v85, s13, v85
    ds_read_b64_tr_b16 v[44:45], v25 offset:21504
    ds_read_b64_tr_b16 v[46:47], v25 offset:23552
    s_waitcnt lgkmcnt(10)
    v_mfma_f32_32x32x16_bf16 v[120:135], v[52:55], v[188:191], v[120:135]
    v_mov_b32 v80, 0x3f803f80
    ds_read_b64_tr_b16 v[48:49], v24 offset:24576
    ds_read_b64_tr_b16 v[50:51], v24 offset:26624
    s_waitcnt lgkmcnt(10)
    v_mfma_f32_32x32x16_bf16 v[136:151], v[28:31], v[188:191], v[136:151]
    v_mov_b32 v81, 0x3f803f80
    ds_read_b64_tr_b16 v[52:53], v25 offset:24576
    ds_read_b64_tr_b16 v[54:55], v25 offset:26624
    s_waitcnt lgkmcnt(10)
    v_mfma_f32_32x32x16_bf16 v[120:135], v[32:35], v[192:195], v[120:135]
    v_mov_b32 v82, 0x3f803f80
    ds_read_b64_tr_b16 v[28:29], v24 offset:25600
    ds_read_b64_tr_b16 v[30:31], v24 offset:27648
    s_waitcnt lgkmcnt(10)
    v_mfma_f32_32x32x16_bf16 v[136:151], v[36:39], v[192:195], v[136:151]
    v_mov_b32 v83, 0x3f803f80
    ds_read_b64_tr_b16 v[32:33], v25 offset:25600
    ds_read_b64_tr_b16 v[34:35], v25 offset:27648
    s_waitcnt lgkmcnt(10)
    v_mfma_f32_32x32x16_bf16 v[120:135], v[40:43], v[196:199], v[120:135]
    s_lshl3_add_u32 s96, s11, s3
    s_lshl_b32 s97, s96, 5
    s_add_u32 s98, s97, s10
    s_lshl_b32 s99, s98, 10
    s_add_u32 s13, s99, 25165824
    s_add_u32 s15, s13, 16384
    s_lshl3_add_u32 s96, s11, s3
    s_lshl_b32 s97, s96, 10
    s_add_u32 s16, s97, 21495808
    s_lshl_b32 s96, s10, 6
    s_add_u32 s14, s96, s16
    ds_read_b64_tr_b16 v[36:37], v24 offset:28672
    ds_read_b64_tr_b16 v[38:39], v24 offset:30720
    s_waitcnt lgkmcnt(10)
    v_mfma_f32_32x32x16_bf16 v[136:151], v[44:47], v[196:199], v[136:151]
    ds_read_b64_tr_b16 v[40:41], v25 offset:28672
    ds_read_b64_tr_b16 v[42:43], v25 offset:30720
    s_waitcnt lgkmcnt(10)
    v_mfma_f32_32x32x16_bf16 v[120:135], v[48:51], v[200:203], v[120:135]
    ds_read_b64_tr_b16 v[44:45], v25 offset:29696
    ds_read_b64_tr_b16 v[46:47], v25 offset:31744
    s_waitcnt lgkmcnt(10)
    v_mfma_f32_32x32x16_bf16 v[136:151], v[52:55], v[200:203], v[136:151]
    ds_read_b64_tr_b16 v[48:49], v24 offset:29696
    ds_read_b64_tr_b16 v[50:51], v24 offset:31744
    s_waitcnt lgkmcnt(10)
    v_mfma_f32_32x32x16_bf16 v[120:135], v[28:31], v[204:207], v[120:135]
    s_waitcnt lgkmcnt(8)
    v_mfma_f32_32x32x16_bf16 v[136:151], v[32:35], v[204:207], v[136:151]
    s_waitcnt lgkmcnt(6)
    v_mfma_f32_32x32x16_bf16 v[120:135], v[36:39], v[208:211], v[120:135]
    s_waitcnt lgkmcnt(4)
    v_mfma_f32_32x32x16_bf16 v[136:151], v[40:43], v[208:211], v[136:151]
    s_waitcnt lgkmcnt(2)
    v_mfma_f32_32x32x16_bf16 v[136:151], v[44:47], v[212:215], v[136:151]
    s_waitcnt lgkmcnt(0)
    v_mfma_f32_32x32x16_bf16 v[120:135], v[48:51], v[212:215], v[120:135]
    s_lshl_b32 s96, s77, 11
    s_add_u32 s17, s96, 151552
    v_add_u32 v0, s17, v2
    v_bfe_u32 v4, v1, 2, 2
    v_lshlrev_b32 v4, 6, v4
    v_bfe_u32 v9, v1, 4, 1
    v_lshl_add_u32 v4, v9, 5, v4
    v_and_b32 v9, 3, v1
    v_lshl_add_u32 v4, v9, 3, v4
    v_lshrrev_b32 v9, 5, v1
    v_lshl_add_u32 v4, v9, 8, v4
    v_add_u32 v4, 159744, v4
    ds_read_b64_tr_b16 v[176:177], v4
    ds_read_b64_tr_b16 v[178:179], v4 offset:512
    ds_read_b64_tr_b16 v[180:181], v4 offset:1024
    ds_read_b64_tr_b16 v[182:183], v4 offset:1536
    v_cvt_pk_bf16_f32 v152, v136, v137
    v_cvt_pk_bf16_f32 v153, v138, v139
    v_cvt_pk_bf16_f32 v154, v140, v141
    v_cvt_pk_bf16_f32 v155, v142, v143
    v_cvt_pk_bf16_f32 v156, v144, v145
    v_cvt_pk_bf16_f32 v157, v146, v147
    v_cvt_pk_bf16_f32 v158, v148, v149
    v_cvt_pk_bf16_f32 v159, v150, v151
    ds_write_b128 v0, v[152:155]
    ds_write_b128 v0, v[156:159] offset:1024
    v_cvt_pk_bf16_f32 v168, v120, v121
    v_cvt_pk_bf16_f32 v169, v122, v123
    v_cvt_pk_bf16_f32 v170, v124, v125
    v_cvt_pk_bf16_f32 v171, v126, v127
    v_cvt_pk_bf16_f32 v172, v128, v129
    v_cvt_pk_bf16_f32 v173, v130, v131
    v_cvt_pk_bf16_f32 v174, v132, v133
    v_cvt_pk_bf16_f32 v175, v134, v135
    s_setprio 0
    s_branch L_JOIN
L_HELP:
    s_waitcnt vmcnt(0)
    s_barrier
    s_add_u32 s96, s84, 4
    s_and_b32 s97, s96, 15
    s_mul_i32 s98, s97, 393216
    s_add_u32 s99, s98, s85
    s_add_u32 s82, s99, 4294772736
    s_add_u32 m0, s83, 28672
    s_nop 0
    buffer_load_dwordx4 v3, s[40:43], s82 offen lds
    s_add_u32 s96, s84, 4
    s_and_b32 s97, s96, 15
    s_mul_i32 s98, s97, 393216
    s_add_u32 s99, s98, s85
    s_add_u32 s82, s99, 2048
    s_add_u32 m0, s83, 32768
    s_nop 0
    buffer_load_dwordx4 v3, s[40:43], s82 offen lds
    s_add_u32 s96, s84, 4
    s_and_b32 s97, s96, 15
    s_mul_i32 s98, s97, 393216
    s_add_u32 s99, s98, s85
    s_add_u32 s82, s99, 4294774784
    s_add_u32 m0, s83, 77824
    s_nop 0
    buffer_load_dwordx4 v3, s[40:43], s82 offen lds
    s_add_u32 s96, s84, 4
    s_and_b32 s97, s96, 15
    s_mul_i32 s98, s97, 393216
    s_add_u32 s99, s98, s85
    s_add_u32 s82, s99, 4096
    s_add_u32 m0, s83, 81920
    s_nop 0
    buffer_load_dwordx4 v3, s[40:43], s82 offen lds
    s_add_u32 s96, s84, 4
    s_and_b32 s97, s96, 15
    s_mul_i32 s98, s97, 393216
    s_add_u32 s99, s98, s85
    s_add_u32 s82, s99, 4294770688
    s_add_u32 m0, s83, 126976
    s_nop 0
    buffer_load_dwordx4 v3, s[40:43], s82 offen lds
    s_add_u32 s96, s84, 4
    s_and_b32 s97, s96, 15
    s_mul_i32 s98, s97, 393216
    s_add_u32 s82, s98, s85
    s_add_u32 m0, s83, 131072
    s_nop 0
    buffer_load_dwordx4 v3, s[40:43], s82 offen lds
    s_add_u32 s96, s84, 5
    s_and_b32 s97, s96, 15
    s_mul_i32 s98, s97, 393216
    s_add_u32 s99, s98, s85
    s_add_u32 s82, s99, 4294772736
    s_add_u32 m0, s83, 36864
    s_nop 0
    buffer_load_dwordx4 v3, s[40:43], s82 offen lds
    s_add_u32 s96, s84, 5
    s_and_b32 s97, s96, 15
    s_mul_i32 s98, s97, 393216
    s_add_u32 s99, s98, s85
    s_add_u32 s82, s99, 2048
    s_add_u32 m0, s83, 40960
    s_nop 0
    buffer_load_dwordx4 v3, s[40:43], s82 offen lds
    s_add_u32 s96, s84, 5
    s_and_b32 s97, s96, 15
    s_mul_i32 s98, s97, 393216
    s_add_u32 s99, s98, s85
    s_add_u32 s82, s99, 4294774784
    s_add_u32 m0, s83, 86016
    s_nop 0
    buffer_load_dwordx4 v3, s[40:43], s82 offen lds
    s_add_u32 s96, s84, 5
    s_and_b32 s97, s96, 15
    s_mul_i32 s98, s97, 393216
    s_add_u32 s99, s98, s85
    s_add_u32 s82, s99, 4096
    s_add_u32 m0, s83, 90112
    s_nop 0
    buffer_load_dwordx4 v3, s[40:43], s82 offen lds
    s_add_u32 s96, s84, 5
    s_and_b32 s97, s96, 15
    s_mul_i32 s98, s97, 393216
    s_add_u32 s99, s98, s85
    s_add_u32 s82, s99, 4294770688
    s_add_u32 m0, s83, 135168
    s_nop 0
    buffer_load_dwordx4 v3, s[40:43], s82 offen lds
    s_add_u32 s96, s84, 5
    s_and_b32 s97, s96, 15
    s_mul_i32 s98, s97, 393216
    s_add_u32 s82, s98, s85
    s_add_u32 m0, s83, 139264
    s_nop 0
    buffer_load_dwordx4 v3, s[40:43], s82 offen lds
    s_waitcnt lgkmcnt(0)
SPOLL_16:
    s_load_dwordx2 s[24:25], s[32:33], s19 offset:0 glc
    s_load_dwordx2 s[26:27], s[32:33], s19 offset:64 glc
SCHK_17:
    s_add_u32 s5, s5, 1
    s_cmp_ge_u32 s5, 200000
    s_waitcnt lgkmcnt(0)
    s_cbranch_scc1 SDONE_18
    s_cmp_lg_u32 s24, s4
    s_cbranch_scc1 SPOLL_16
    s_cmp_lg_u32 s25, s4
    s_cbranch_scc1 SPOLL_16
    s_cmp_lg_u32 s26, s4
    s_cbranch_scc1 SPOLL_16
    s_cmp_lg_u32 s27, s4
    s_cbranch_scc1 SPOLL_16
SDONE_18:
    v_bfe_u32 v4, v1, 2, 2
    v_lshlrev_b32 v4, 6, v4
    v_bfe_u32 v9, v1, 4, 1
    v_lshl_add_u32 v4, v9, 5, v4
    v_and_b32 v9, 3, v1
    v_lshl_add_u32 v4, v9, 3, v4
    v_lshrrev_b32 v9, 5, v1
    v_lshl_add_u32 v4, v9, 8, v4
    v_add_u32 v4, 159744, v4
    ds_read_b64_tr_b16 v[168:169], v4
    ds_read_b64_tr_b16 v[170:171], v4 offset:512
    ds_read_b64_tr_b16 v[172:173], v4 offset:1024
    ds_read_b64_tr_b16 v[174:175], v4 offset:1536
    ds_read_b64_tr_b16 v[176:177], v4 offset:2048
    ds_read_b64_tr_b16 v[178:179], v4 offset:2560
    ds_read_b64_tr_b16 v[180:181], v4 offset:3072
    ds_read_b64_tr_b16 v[182:183], v4 offset:3584
    s_lshl_b32 s14, s77, 10
    v_and_b32 v232, 7, v1
    v_lshl_add_u32 v232, v232, 4, s14
    v_bfe_u32 v9, v1, 3, 2
    v_lshl_add_u32 v232, v9, 8, v232
    v_lshrrev_b32 v9, 5, v1
    v_lshl_add_u32 v232, v9, 7, v232
    s_and_b32 s96, s9, 1
    s_lshl1_add_u32 s18, s96, 1
    s_and_b32 s96, s8, 3
    s_lshl2_add_u32 s97, s96, s3
    s_sub_u32 s98, s97, 4
    s_lshl_b32 s82, s98, 7
    v_lshrrev_b32 v8, 3, v1
    v_lshl_add_u32 v8, v8, 4, s82
    global_load_dwordx4 v[40:43], v8, s[86:87]
    v_lshrrev_b32 v248, 3, v1
    v_mul_u32_u24 v248, 98304, v248
    v_and_b32 v9, 7, v1
    v_lshl_add_u32 v248, v9, 4, v248
    s_and_b32 s96, s8, 3
    s_lshl2_add_u32 s97, s96, s3
    s_sub_u32 s98, s97, 4
    s_mul_i32 s99, s98, 786432
    s_lshr_b32 s96, s8, 2
    s_lshl1_add_u32 s97, s9, s96
    s_lshl_b32 s98, s97, 7
    s_add_u32 s96, s99, s98
    s_add_u32 s19, s96, 4096
    s_barrier
    s_add_u32 s96, s84, 6
    s_and_b32 s97, s96, 15
    s_mul_i32 s98, s97, 393216
    s_add_u32 s99, s98, s85
    s_add_u32 s82, s99, 4294772736
    s_add_u32 m0, s83, 4294963200
    s_nop 0
    buffer_load_dwordx4 v3, s[40:43], s82 offen lds
    s_add_u32 s96, s84, 6
    s_and_b32 s97, s96, 15
    s_mul_i32 s98, s97, 393216
    s_add_u32 s99, s98, s85
    s_add_u32 s82, s99, 2048
    s_mov_b32 m0, s83
    s_nop 0
    buffer_load_dwordx4 v3, s[40:43], s82 offen lds
    s_add_u32 s96, s84, 6
    s_and_b32 s97, s96, 15
    s_mul_i32 s98, s97, 393216
    s_add_u32 s99, s98, s85
    s_add_u32 s82, s99, 4294770688
    s_add_u32 m0, s83, 94208
    s_nop 0
    buffer_load_dwordx4 v3, s[40:43], s82 offen lds
    s_add_u32 s96, s84, 6
    s_and_b32 s97, s96, 15
    s_mul_i32 s98, s97, 393216
    s_add_u32 s82, s98, s85
    s_add_u32 m0, s83, 98304
    s_nop 0
    buffer_load_dwordx4 v3, s[40:43], s82 offen lds
    s_add_u32 s96, s84, 6
    s_and_b32 s97, s96, 15
    s_mul_i32 s98, s97, 393216
    s_add_u32 s99, s98, s85
    s_add_u32 s82, s99, 4294774784
    s_add_u32 m0, s83, 45056
    s_nop 0
    buffer_load_dwordx4 v3, s[40:43], s82 offen lds
    s_add_u32 s96, s84, 6
    s_and_b32 s97, s96, 15
    s_mul_i32 s98, s97, 393216
    s_add_u32 s99, s98, s85
    s_add_u32 s82, s99, 4096
    s_add_u32 m0, s83, 49152
    s_nop 0
    buffer_load_dwordx4 v3, s[40:43], s82 offen lds
    s_waitcnt lgkmcnt(0)
    s_load_dword s24, s[32:33], s92 offset:512 glc
    s_load_dword s25, s[32:33], s92 offset:256 glc
    s_load_dword s26, s[32:33], s92 offset:3584 glc
    s_load_dword s27, s[32:33], s92 offset:3328 glc
    s_barrier
    s_add_u32 s96, s84, 7
    s_and_b32 s97, s96, 15
    s_mul_i32 s98, s97, 393216
    s_add_u32 s99, s98, s85
    s_add_u32 s82, s99, 4294772736
    s_add_u32 m0, s83, 4096
    s_nop 0
    buffer_load_dwordx4 v3, s[40:43], s82 offen lds
    s_add_u32 s96, s84, 7
    s_and_b32 s97, s96, 15
    s_mul_i32 s98, s97, 393216
    s_add_u32 s99, s98, s85
    s_add_u32 s82, s99, 2048
    s_add_u32 m0, s83, 8192
    s_nop 0
    buffer_load_dwordx4 v3, s[40:43], s82 offen lds
    s_add_u32 s96, s84, 7
    s_and_b32 s97, s96, 15
    s_mul_i32 s98, s97, 393216
    s_add_u32 s99, s98, s85
    s_add_u32 s82, s99, 4294770688
    s_add_u32 m0, s83, 102400
    s_nop 0
    buffer_load_dwordx4 v3, s[40:43], s82 offen lds
    s_add_u32 s96, s84, 7
    s_and_b32 s97, s96, 15
    s_mul_i32 s98, s97, 393216
    s_add_u32 s82, s98, s85
    s_add_u32 m0, s83, 106496
    s_nop 0
    buffer_load_dwordx4 v3, s[40:43], s82 offen lds
    s_add_u32 s96, s84, 7
    s_and_b32 s97, s96, 15
    s_mul_i32 s98, s97, 393216
    s_add_u32 s99, s98, s85
    s_add_u32 s82, s99, 4294774784
    s_add_u32 m0, s83, 53248
    s_nop 0
    buffer_load_dwordx4 v3, s[40:43], s82 offen lds
    s_add_u32 s96, s84, 7
    s_and_b32 s97, s96, 15
    s_mul_i32 s98, s97, 393216
    s_add_u32 s99, s98, s85
    s_add_u32 s82, s99, 4096
    s_add_u32 m0, s83, 57344
    s_nop 0
    buffer_load_dwordx4 v3, s[40:43], s82 offen lds
    s_waitcnt vmcnt(23)
    s_waitcnt vmcnt(19)
    s_barrier
    s_add_u32 s96, s84, 8
    s_and_b32 s97, s96, 15
    s_mul_i32 s98, s97, 393216
    s_add_u32 s99, s98, s85
    s_add_u32 s82, s99, 4294772736
    s_add_u32 m0, s83, 12288
    s_nop 0
    buffer_load_dwordx4 v3, s[40:43], s82 offen lds
    s_add_u32 s96, s84, 8
    s_and_b32 s97, s96, 15
    s_mul_i32 s98, s97, 393216
    s_add_u32 s99, s98, s85
    s_add_u32 s82, s99, 2048
    s_add_u32 m0, s83, 16384
    s_nop 0
    buffer_load_dwordx4 v3, s[40:43], s82 offen lds
    s_add_u32 s96, s84, 8
    s_and_b32 s97, s96, 15
    s_mul_i32 s98, s97, 393216
    s_add_u32 s99, s98, s85
    s_add_u32 s82, s99, 4294770688
    s_add_u32 m0, s83, 110592
    s_nop 0
    buffer_load_dwordx4 v3, s[40:43], s82 offen lds
    s_add_u32 s96, s84, 8
    s_and_b32 s97, s96, 15
    s_mul_i32 s98, s97, 393216
    s_add_u32 s82, s98, s85
    s_add_u32 m0, s83, 114688
    s_nop 0
    buffer_load_dwordx4 v3, s[40:43], s82 offen lds
    s_add_u32 s96, s84, 8
    s_and_b32 s97, s96, 15
    s_mul_i32 s98, s97, 393216
    s_add_u32 s99, s98, s85
    s_add_u32 s82, s99, 4294774784
    s_add_u32 m0, s83, 61440
    s_nop 0
    buffer_load_dwordx4 v3, s[40:43], s82 offen lds
    s_add_u32 s96, s84, 8
    s_and_b32 s97, s96, 15
    s_mul_i32 s98, s97, 393216
    s_add_u32 s99, s98, s85
    s_add_u32 s82, s99, 4096
    s_add_u32 m0, s83, 65536
    s_nop 0
    buffer_load_dwordx4 v3, s[40:43], s82 offen lds
    s_waitcnt vmcnt(18)
    v_lshlrev_b32 v36, 16, v40
    v_and_b32 v37, s6, v40
    v_lshlrev_b32 v38, 16, v41
    v_and_b32 v39, s6, v41
    v_lshlrev_b32 v40, 16, v42
    v_and_b32 v41, s6, v42
    v_lshlrev_b32 v42, 16, v43
    v_and_b32 v43, s6, v43
    v_mul_f32 v8, s7, v36
    v_exp_f32 v8, -v8
    s_nop 0
    v_add_f32 v8, 1.0, v8
    v_rcp_f32 v8, v8
    s_nop 0
    v_mul_f32 v36, v36, v8
    v_cvt_pk_bf16_f32 v36, 0, v36
    v_mul_f32 v9, s7, v37
    v_exp_f32 v9, -v9
    s_nop 0
    v_add_f32 v9, 1.0, v9
    v_rcp_f32 v9, v9
    s_nop 0
    v_mul_f32 v37, v37, v9
    v_cvt_pk_bf16_f32 v37, 0, v37
    v_mul_f32 v8, s7, v38
    v_exp_f32 v8, -v8
    s_nop 0
    v_add_f32 v8, 1.0, v8
    v_rcp_f32 v8, v8
    s_nop 0
    v_mul_f32 v38, v38, v8
    v_cvt_pk_bf16_f32 v38, 0, v38
    v_mul_f32 v9, s7, v39
    v_exp_f32 v9, -v9
    s_nop 0
    v_add_f32 v9, 1.0, v9
    v_rcp_f32 v9, v9
    s_nop 0
    v_mul_f32 v39, v39, v9
    v_cvt_pk_bf16_f32 v39, 0, v39
    v_mul_f32 v8, s7, v40
    v_exp_f32 v8, -v8
    s_nop 0
    v_add_f32 v8, 1.0, v8
    v_rcp_f32 v8, v8
    s_nop 0
    v_mul_f32 v40, v40, v8
    v_cvt_pk_bf16_f32 v40, 0, v40
    v_mul_f32 v9, s7, v41
    v_exp_f32 v9, -v9
    s_nop 0
    v_add_f32 v9, 1.0, v9
    v_rcp_f32 v9, v9
    s_nop 0
    v_mul_f32 v41, v41, v9
    v_cvt_pk_bf16_f32 v41, 0, v41
    v_mul_f32 v8, s7, v42
    v_exp_f32 v8, -v8
    s_nop 0
    v_add_f32 v8, 1.0, v8
    v_rcp_f32 v8, v8
    s_nop 0
    v_mul_f32 v42, v42, v8
    v_cvt_pk_bf16_f32 v42, 0, v42
    v_mul_f32 v9, s7, v43
    v_exp_f32 v9, -v9
L_PAD5:
    s_cbranch_execz L_RET5
    s_nop 0
    v_add_f32 v9, 1.0, v9
    v_rcp_f32 v9, v9
    s_nop 0
    v_mul_f32 v43, v43, v9
    v_cvt_pk_bf16_f32 v43, 0, v43
    s_waitcnt lgkmcnt(0)
    s_load_dword s24, s[32:33], s92 offset:1024 glc
    s_load_dword s25, s[32:33], s92 offset:768 glc
    s_load_dword s26, s[32:33], s92 offset:1536 glc
    s_load_dword s27, s[32:33], s92 offset:1280 glc
    s_barrier
    s_add_u32 s96, s84, 9
    s_and_b32 s97, s96, 15
    s_mul_i32 s98, s97, 393216
    s_add_u32 s99, s98, s85
    s_add_u32 s82, s99, 4294772736
    s_add_u32 m0, s83, 20480
    s_nop 0
    buffer_load_dwordx4 v3, s[40:43], s82 offen lds
    s_add_u32 s96, s84, 9
    s_and_b32 s97, s96, 15
    s_mul_i32 s98, s97, 393216
    s_add_u32 s99, s98, s85
    s_add_u32 s82, s99, 2048
    s_add_u32 m0, s83, 24576
    s_nop 0
    buffer_load_dwordx4 v3, s[40:43], s82 offen lds
    s_add_u32 s96, s84, 9
    s_and_b32 s97, s96, 15
    s_mul_i32 s98, s97, 393216
    s_add_u32 s99, s98, s85
    s_add_u32 s82, s99, 4294770688
    s_add_u32 m0, s83, 118784
    s_nop 0
    buffer_load_dwordx4 v3, s[40:43], s82 offen lds
    s_add_u32 s96, s84, 9
    s_and_b32 s97, s96, 15
    s_mul_i32 s98, s97, 393216
    s_add_u32 s82, s98, s85
    s_add_u32 m0, s83, 122880
    s_nop 0
    buffer_load_dwordx4 v3, s[40:43], s82 offen lds
    s_add_u32 s96, s84, 9
    s_and_b32 s97, s96, 15
    s_mul_i32 s98, s97, 393216
    s_add_u32 s99, s98, s85
    s_add_u32 s82, s99, 4294774784
    s_add_u32 m0, s83, 69632
    s_nop 0
    buffer_load_dwordx4 v3, s[40:43], s82 offen lds
    s_add_u32 s96, s84, 9
    s_and_b32 s97, s96, 15
    s_mul_i32 s98, s97, 393216
    s_add_u32 s99, s98, s85
    s_add_u32 s82, s99, 4096
    s_add_u32 m0, s83, 73728
    s_nop 0
    buffer_load_dwordx4 v3, s[40:43], s82 offen lds
    s_waitcnt vmcnt(22)
    s_waitcnt vmcnt(20)
    s_waitcnt vmcnt(18)
    s_barrier
    s_add_u32 s96, s84, 10
    s_and_b32 s97, s96, 15
    s_mul_i32 s98, s97, 393216
    s_add_u32 s99, s98, s85
    s_add_u32 s82, s99, 4294772736
    s_add_u32 m0, s83, 28672
    s_nop 0
    buffer_load_dwordx4 v3, s[40:43], s82 offen lds
    s_add_u32 s96, s84, 10
    s_and_b32 s97, s96, 15
    s_mul_i32 s98, s97, 393216
    s_add_u32 s99, s98, s85
    s_add_u32 s82, s99, 2048
    s_add_u32 m0, s83, 32768
    s_nop 0
    buffer_load_dwordx4 v3, s[40:43], s82 offen lds
    s_add_u32 s96, s84, 10
    s_and_b32 s97, s96, 15
    s_mul_i32 s98, s97, 393216
    s_add_u32 s99, s98, s85
    s_add_u32 s82, s99, 4294774784
    s_add_u32 m0, s83, 77824
    s_nop 0
    buffer_load_dwordx4 v3, s[40:43], s82 offen lds
    s_add_u32 s96, s84, 10
    s_and_b32 s97, s96, 15
    s_mul_i32 s98, s97, 393216
    s_add_u32 s99, s98, s85
    s_add_u32 s82, s99, 4096
    s_add_u32 m0, s83, 81920
    s_nop 0
    buffer_load_dwordx4 v3, s[40:43], s82 offen lds
    s_waitcnt lgkmcnt(0)
    s_load_dword s24, s[32:33], s92 offset:2560 glc
    s_load_dword s25, s[32:33], s92 offset:2304 glc
    s_load_dword s26, s[32:33], s92 offset:3072 glc
    s_load_dword s27, s[32:33], s92 offset:2816 glc
    s_waitcnt vmcnt(20)
    s_waitcnt vmcnt(18)
    s_waitcnt vmcnt(16)
    s_barrier
    s_add_u32 s96, s84, 11
    s_and_b32 s97, s96, 15
    s_mul_i32 s98, s97, 393216
    s_add_u32 s99, s98, s85
    s_add_u32 s82, s99, 4294772736
    s_add_u32 m0, s83, 36864
    s_nop 0
    buffer_load_dwordx4 v3, s[40:43], s82 offen lds
    s_add_u32 s96, s84, 11
    s_and_b32 s97, s96, 15
    s_mul_i32 s98, s97, 393216
    s_add_u32 s99, s98, s85
    s_add_u32 s82, s99, 2048
    s_add_u32 m0, s83, 40960
    s_nop 0
    buffer_load_dwordx4 v3, s[40:43], s82 offen lds
    s_add_u32 s96, s84, 11
    s_and_b32 s97, s96, 15
    s_mul_i32 s98, s97, 393216
    s_add_u32 s99, s98, s85
    s_add_u32 s82, s99, 4294774784
    s_add_u32 m0, s83, 86016
    s_nop 0
    buffer_load_dwordx4 v3, s[40:43], s82 offen lds
    s_add_u32 s96, s84, 11
    s_and_b32 s97, s96, 15
    s_mul_i32 s98, s97, 393216
    s_add_u32 s99, s98, s85
    s_add_u32 s82, s99, 4096
    s_add_u32 m0, s83, 90112
    s_nop 0
    buffer_load_dwordx4 v3, s[40:43], s82 offen lds
    s_waitcnt vmcnt(18)
    s_waitcnt vmcnt(16)
    s_waitcnt vmcnt(14)
    s_barrier
    s_add_u32 s96, s84, 12
    s_and_b32 s97, s96, 15
    s_mul_i32 s98, s97, 393216
    s_add_u32 s99, s98, s85
    s_add_u32 s82, s99, 4294772736
    s_add_u32 m0, s83, 4294963200
    s_nop 0
    buffer_load_dwordx4 v3, s[40:43], s82 offen lds
    s_add_u32 s96, s84, 12
    s_and_b32 s97, s96, 15
    s_mul_i32 s98, s97, 393216
    s_add_u32 s99, s98, s85
    s_add_u32 s82, s99, 2048
    s_mov_b32 m0, s83
    s_nop 0
    buffer_load_dwordx4 v3, s[40:43], s82 offen lds
    s_add_u32 s96, s84, 12
    s_and_b32 s97, s96, 15
    s_mul_i32 s98, s97, 393216
    s_add_u32 s99, s98, s85
    s_add_u32 s82, s99, 4294774784
    s_add_u32 m0, s83, 45056
    s_nop 0
    buffer_load_dwordx4 v3, s[40:43], s82 offen lds
    s_add_u32 s96, s84, 12
    s_and_b32 s97, s96, 15
    s_mul_i32 s98, s97, 393216
    s_add_u32 s99, s98, s85
    s_add_u32 s82, s99, 4096
    s_add_u32 m0, s83, 49152
    s_nop 0
    buffer_load_dwordx4 v3, s[40:43], s82 offen lds
    s_waitcnt vmcnt(16)
    s_barrier
    s_add_u32 s96, s84, 13
    s_and_b32 s97, s96, 15
    s_mul_i32 s98, s97, 393216
    s_add_u32 s99, s98, s85
    s_add_u32 s82, s99, 4294772736
    s_add_u32 m0, s83, 4096
    s_nop 0
    buffer_load_dwordx4 v3, s[40:43], s82 offen lds
    s_add_u32 s96, s84, 13
    s_and_b32 s97, s96, 15
    s_mul_i32 s98, s97, 393216
    s_add_u32 s99, s98, s85
    s_add_u32 s82, s99, 2048
    s_add_u32 m0, s83, 8192
    s_nop 0
    buffer_load_dwordx4 v3, s[40:43], s82 offen lds
    s_add_u32 s96, s84, 13
    s_and_b32 s97, s96, 15
    s_mul_i32 s98, s97, 393216
    s_add_u32 s99, s98, s85
    s_add_u32 s82, s99, 4294774784
    s_add_u32 m0, s83, 53248
    s_nop 0
    buffer_load_dwordx4 v3, s[40:43], s82 offen lds
    s_add_u32 s96, s84, 13
    s_and_b32 s97, s96, 15
    s_mul_i32 s98, s97, 393216
    s_add_u32 s99, s98, s85
    s_add_u32 s82, s99, 4096
    s_add_u32 m0, s83, 57344
    s_nop 0
    buffer_load_dwordx4 v3, s[40:43], s82 offen lds
    s_lshl_b32 s96, s74, 13
    s_sub_u32 s97, s3, 4
    s_lshl_b32 s98, s97, 8
    s_add_u32 s99, s96, s98
    s_add_u32 s13, s99, 20971520
    s_waitcnt lgkmcnt(0)
    s_load_dword s24, s[32:33], s13 offset:1276 glc
    s_load_dword s25, s[32:33], s13 offset:3324 glc
    s_load_dword s26, s[32:33], s13 offset:5372 glc
    s_load_dword s27, s[32:33], s13 offset:7420 glc
    s_waitcnt vmcnt(18)
    s_waitcnt vmcnt(16)
    s_barrier
    s_add_u32 s96, s84, 14
    s_and_b32 s97, s96, 15
    s_mul_i32 s98, s97, 393216
    s_add_u32 s99, s98, s85
    s_add_u32 s82, s99, 4294772736
    s_add_u32 m0, s83, 12288
    s_nop 0
    buffer_load_dwordx4 v3, s[40:43], s82 offen lds
    s_add_u32 s96, s84, 14
    s_and_b32 s97, s96, 15
    s_mul_i32 s98, s97, 393216
    s_add_u32 s99, s98, s85
    s_add_u32 s82, s99, 2048
    s_add_u32 m0, s83, 16384
    s_nop 0
    buffer_load_dwordx4 v3, s[40:43], s82 offen lds
    s_add_u32 s96, s84, 10
    s_and_b32 s97, s96, 15
    s_mul_i32 s98, s97, 393216
    s_add_u32 s99, s98, s85
    s_add_u32 s82, s99, 4294770688
    s_add_u32 m0, s83, 126976
    s_nop 0
    buffer_load_dwordx4 v3, s[40:43], s82 offen lds
    s_add_u32 s96, s84, 10
    s_and_b32 s97, s96, 15
    s_mul_i32 s98, s97, 393216
    s_add_u32 s82, s98, s85
    s_add_u32 m0, s83, 131072
    s_nop 0
    buffer_load_dwordx4 v3, s[40:43], s82 offen lds
    s_waitcnt vmcnt(18)
    s_waitcnt vmcnt(14)
    s_barrier
    s_add_u32 s96, s84, 15
    s_and_b32 s97, s96, 15
    s_mul_i32 s98, s97, 393216
    s_add_u32 s99, s98, s85
    s_add_u32 s82, s99, 4294772736
    s_add_u32 m0, s83, 20480
    s_nop 0
    buffer_load_dwordx4 v3, s[40:43], s82 offen lds
    s_add_u32 s96, s84, 15
    s_and_b32 s97, s96, 15
    s_mul_i32 s98, s97, 393216
    s_add_u32 s99, s98, s85
    s_add_u32 s82, s99, 2048
    s_add_u32 m0, s83, 24576
    s_nop 0
    buffer_load_dwordx4 v3, s[40:43], s82 offen lds
    s_add_u32 s96, s84, 11
    s_and_b32 s97, s96, 15
    s_mul_i32 s98, s97, 393216
    s_add_u32 s99, s98, s85
    s_add_u32 s82, s99, 4294770688
    s_add_u32 m0, s83, 135168
    s_nop 0
    buffer_load_dwordx4 v3, s[40:43], s82 offen lds
    s_add_u32 s96, s84, 11
    s_and_b32 s97, s96, 15
    s_mul_i32 s98, s97, 393216
    s_add_u32 s82, s98, s85
    s_add_u32 m0, s83, 139264
    s_nop 0
    buffer_load_dwordx4 v3, s[40:43], s82 offen lds
    s_waitcnt vmcnt(14)
    s_waitcnt vmcnt(10)
    s_waitcnt vmcnt(6)
    s_barrier
    s_add_u32 s96, s84, 14
    s_and_b32 s97, s96, 15
    s_mul_i32 s98, s97, 393216
    s_add_u32 s99, s98, s85
    s_add_u32 s82, s99, 4294774784
    s_add_u32 m0, s83, 61440
    s_nop 0
    buffer_load_dwordx4 v3, s[40:43], s82 offen lds
    s_add_u32 s96, s84, 14
    s_and_b32 s97, s96, 15
    s_mul_i32 s98, s97, 393216
    s_add_u32 s99, s98, s85
    s_add_u32 s82, s99, 4096
    s_add_u32 m0, s83, 65536
    s_nop 0
    buffer_load_dwordx4 v3, s[40:43], s82 offen lds
    s_add_u32 s96, s84, 15
    s_and_b32 s97, s96, 15
    s_mul_i32 s98, s97, 393216
    s_add_u32 s99, s98, s85
    s_add_u32 s82, s99, 4294774784
    s_add_u32 m0, s83, 69632
    s_nop 0
    buffer_load_dwordx4 v3, s[40:43], s82 offen lds
    s_add_u32 s96, s84, 15
    s_and_b32 s97, s96, 15
    s_mul_i32 s98, s97, 393216
    s_add_u32 s99, s98, s85
    s_add_u32 s82, s99, 4096
    s_add_u32 m0, s83, 73728
    s_nop 0
    buffer_load_dwordx4 v3, s[40:43], s82 offen lds
    s_add_u32 s96, s84, 12
    s_and_b32 s97, s96, 15
    s_mul_i32 s98, s97, 393216
    s_add_u32 s99, s98, s85
    s_add_u32 s82, s99, 4294770688
    s_add_u32 m0, s83, 94208
    s_nop 0
    buffer_load_dwordx4 v3, s[40:43], s82 offen lds
    s_add_u32 s96, s84, 12
    s_and_b32 s97, s96, 15
    s_mul_i32 s98, s97, 393216
    s_add_u32 s82, s98, s85
    s_add_u32 m0, s83, 98304
    s_nop 0
    buffer_load_dwordx4 v3, s[40:43], s82 offen lds
    s_mov_b32 s82, s19
    buffer_load_dwordx4 v[88:91], v248, s[48:51], s82 offen nt
    s_add_u32 s82, s19, 12288
    buffer_load_dwordx4 v[92:95], v248, s[48:51], s82 offen nt
    s_add_u32 s82, s19, 24576
    buffer_load_dwordx4 v[96:99], v248, s[48:51], s82 offen nt
    s_add_u32 s82, s19, 36864
    buffer_load_dwordx4 v[100:103], v248, s[48:51], s82 offen nt
    s_waitcnt vmcnt(12)
    s_barrier
    s_add_u32 s96, s84, 13
    s_and_b32 s97, s96, 15
    s_mul_i32 s98, s97, 393216
    s_add_u32 s99, s98, s85
    s_add_u32 s82, s99, 4294770688
    s_add_u32 m0, s83, 102400
    s_nop 0
    buffer_load_dwordx4 v3, s[40:43], s82 offen lds
    s_add_u32 s96, s84, 13
    s_and_b32 s97, s96, 15
    s_mul_i32 s98, s97, 393216
    s_add_u32 s82, s98, s85
    s_add_u32 m0, s83, 106496
    s_nop 0
    buffer_load_dwordx4 v3, s[40:43], s82 offen lds
    s_add_u32 s96, s84, 14
    s_and_b32 s97, s96, 15
    s_mul_i32 s98, s97, 393216
    s_add_u32 s99, s98, s85
    s_add_u32 s82, s99, 4294770688
    s_add_u32 m0, s83, 110592
    s_nop 0
    buffer_load_dwordx4 v3, s[40:43], s82 offen lds
    s_add_u32 s96, s84, 14
    s_and_b32 s97, s96, 15
    s_mul_i32 s98, s97, 393216
    s_add_u32 s82, s98, s85
    s_add_u32 m0, s83, 114688
    s_nop 0
    buffer_load_dwordx4 v3, s[40:43], s82 offen lds
    s_add_u32 s96, s84, 15
    s_and_b32 s97, s96, 15
    s_mul_i32 s98, s97, 393216
    s_add_u32 s99, s98, s85
    s_add_u32 s82, s99, 4294770688
    s_add_u32 m0, s83, 118784
    s_nop 0
    buffer_load_dwordx4 v3, s[40:43], s82 offen lds
    s_add_u32 s96, s84, 15
    s_and_b32 s97, s96, 15
    s_mul_i32 s98, s97, 393216
    s_add_u32 s82, s98, s85
    s_add_u32 m0, s83, 122880
    s_nop 0
    buffer_load_dwordx4 v3, s[40:43], s82 offen lds
    v_and_b32 v85, 1, v1
    v_lshlrev_b32 v85, 3, v85
    v_bfe_u32 v84, v1, 2, 2
    v_lshl_add_u32 v85, v84, 4, v85
    v_bfe_u32 v84, v1, 4, 1
    v_lshl_add_u32 v85, v84, 6, v85
    v_bfe_u32 v84, v1, 1, 1
    v_lshl_add_u32 v85, v84, 7, v85
    v_lshrrev_b32 v84, 5, v1
    v_lshl_add_u32 v85, v84, 8, v85
    s_lshl_b32 s13, s3, 12
    v_add_u32 v84, s13, v85
    s_lshl_b32 s96, s76, 13
    s_add_u32 s13, s96, 32768
    v_add_u32 v85, s13, v85
    v_mov_b32 v80, 0x3f803f80
    v_mov_b32 v81, 0x3f803f80
    v_mov_b32 v82, 0x3f803f80
    v_mov_b32 v83, 0x3f803f80
    s_lshl3_add_u32 s96, s11, s3
    s_lshl_b32 s97, s96, 5
    s_add_u32 s98, s97, s10
    s_lshl_b32 s99, s98, 10
    s_add_u32 s13, s99, 25165824
    s_add_u32 s15, s13, 16384
    s_lshl3_add_u32 s96, s11, s3
    s_lshl_b32 s97, s96, 10
    s_add_u32 s16, s97, 21495808
    s_lshl_b32 s96, s10, 6
    s_add_u32 s14, s96, s16
    s_waitcnt lgkmcnt(0)
    s_barrier
    s_setprio 3
    ds_read_b128 v[152:155], v0
    ds_read_b128 v[156:159], v0 offset:1024
    v_subrev_u32 v0, 118784, v0
    s_waitcnt lgkmcnt(1)
    v_mfma_f32_32x32x16_bf16 v[184:199], v[168:171], v[152:155], 0
    s_waitcnt lgkmcnt(0)
    v_mfma_f32_32x32x16_bf16 v[184:199], v[172:175], v[156:159], v[184:199]
    s_setprio 0
    s_nop 10
    v_cvt_pk_bf16_f32 v184, 0, v184
    v_cvt_pk_bf16_f32 v185, 0, v185
    v_cvt_pk_bf16_f32 v186, 0, v186
    s_add_u32 s82, s19, 49152
    buffer_load_dwordx4 v[104:107], v248, s[48:51], s82 offen nt
    v_cvt_pk_bf16_f32 v187, 0, v187
    v_cvt_pk_bf16_f32 v188, 0, v188
    v_cvt_pk_bf16_f32 v189, 0, v189
    v_cvt_pk_bf16_f32 v190, 0, v190
    v_cvt_pk_bf16_f32 v191, 0, v191
    v_cvt_pk_bf16_f32 v192, 0, v192
    v_cvt_pk_bf16_f32 v193, 0, v193
    v_cvt_pk_bf16_f32 v194, 0, v194
    v_cvt_pk_bf16_f32 v195, 0, v195
    v_cvt_pk_bf16_f32 v196, 0, v196
    s_add_u32 s82, s19, 61440
    buffer_load_dwordx4 v[108:111], v248, s[48:51], s82 offen nt
    v_cvt_pk_bf16_f32 v197, 0, v197
    v_cvt_pk_bf16_f32 v198, 0, v198
    v_cvt_pk_bf16_f32 v199, 0, v199
    v_max3_f32 v4, v184, v185, v186
    v_min3_f32 v5, v184, v185, v186
    v_max3_f32 v4, v4, v187, v188
    v_min3_f32 v5, v5, v187, v188
    v_max3_f32 v4, v4, v189, v190
    v_min3_f32 v5, v5, v189, v190
    v_max3_f32 v4, v4, v191, v192
    s_add_u32 s82, s19, 73728
    buffer_load_dwordx4 v[112:115], v248, s[48:51], s82 offen nt
    v_min3_f32 v5, v5, v191, v192
    v_max3_f32 v4, v4, v193, v194
    v_min3_f32 v5, v5, v193, v194
    v_max3_f32 v4, v4, v195, v196
    v_min3_f32 v5, v5, v195, v196
    v_max3_f32 v4, v4, v197, v198
    v_min3_f32 v5, v5, v197, v198
    v_max_f32 v6, v4, v199
    v_min_f32 v7, v5, v199
    v_max_f32 v4, v4, v199
    s_add_u32 s82, s19, 86016
    buffer_load_dwordx4 v[116:119], v248, s[48:51], s82 offen nt
    v_min_f32 v5, v5, v199
    v_permlane32_swap_b32 v4, v6
    s_nop 0
    v_permlane32_swap_b32 v5, v7
    v_max_f32 v4, v4, v6
    v_min_f32 v5, v5, v7
    v_mul_f32_e64 v4, v4, s7
    v_mul_f32_e64 v5, v5, s7
    v_fma_f32 v216, v184, s7, -v4
    v_fma_f32 v217, v185, s7, -v4
    v_fma_f32 v184, -v184, s7, v5
    v_fma_f32 v185, -v185, s7, v5
    v_fma_f32 v218, v186, s7, -v4
    v_fma_f32 v219, v187, s7, -v4
    v_fma_f32 v186, -v186, s7, v5
    v_fma_f32 v187, -v187, s7, v5
    s_waitcnt vmcnt(18)
    s_waitcnt vmcnt(16)
    s_barrier
    s_setprio 3
    ds_read_b128 v[152:155], v0
    ds_read_b128 v[156:159], v0 offset:1024
    s_waitcnt lgkmcnt(1)
    v_mfma_f32_32x32x16_bf16 v[200:215], v[176:179], v[152:155], 0
    s_waitcnt lgkmcnt(0)
    v_mfma_f32_32x32x16_bf16 v[200:215], v[180:183], v[156:159], v[200:215]
    s_setprio 0
    v_fma_f32 v220, v188, s7, -v4
    v_fma_f32 v221, v189, s7, -v4
    v_fma_f32 v188, -v188, s7, v5
    v_fma_f32 v189, -v189, s7, v5
    v_fma_f32 v222, v190, s7, -v4
    s_mov_b32 s82, s80
    buffer_load_dwordx4 v[56:59], v27, s[52:55], s82 offen nt
    v_fma_f32 v223, v191, s7, -v4
    v_fma_f32 v190, -v190, s7, v5
    v_fma_f32 v191, -v191, s7, v5
    v_fma_f32 v224, v192, s7, -v4
    v_fma_f32 v225, v193, s7, -v4
    s_setprio 3
    v_fma_f32 v192, -v192, s7, v5
    v_fma_f32 v193, -v193, s7, v5
    v_fma_f32 v226, v194, s7, -v4
    v_fma_f32 v227, v195, s7, -v4
    v_fma_f32 v194, -v194, s7, v5
    v_fma_f32 v195, -v195, s7, v5
    v_fma_f32 v228, v196, s7, -v4
    v_fma_f32 v229, v197, s7, -v4
    v_fma_f32 v196, -v196, s7, v5
    v_fma_f32 v197, -v197, s7, v5
    v_fma_f32 v230, v198, s7, -v4
    v_fma_f32 v231, v199, s7, -v4
    v_fma_f32 v198, -v198, s7, v5
    v_fma_f32 v199, -v199, s7, v5
    v_exp_f32 v216, v216
    s_add_u32 s82, s80, 4294049792
    buffer_load_dwordx4 v[60:63], v27, s[52:55], s82 offen nt
    v_exp_f32 v184, v184
    v_exp_f32 v217, v217
    v_exp_f32 v185, v185
    v_exp_f32 v218, v218
    v_exp_f32 v186, v186
    v_exp_f32 v219, v219
    v_exp_f32 v187, v187
    v_exp_f32 v220, v220
    v_exp_f32 v188, v188
    v_exp_f32 v221, v221
    v_exp_f32 v189, v189
    v_exp_f32 v222, v222
    v_exp_f32 v190, v190
    v_exp_f32 v223, v223
    v_exp_f32 v191, v191
    v_exp_f32 v224, v224
    v_exp_f32 v192, v192
    v_exp_f32 v225, v225
    v_exp_f32 v193, v193
    v_exp_f32 v226, v226
    s_add_u32 s82, s80, 57344
    buffer_load_dwordx4 v[64:67], v27, s[52:55], s82 offen nt
    v_exp_f32 v194, v194
    v_exp_f32 v227, v227
    v_exp_f32 v195, v195
    v_exp_f32 v228, v228
    v_exp_f32 v196, v196
    v_exp_f32 v229, v229
    v_exp_f32 v197, v197
    v_exp_f32 v230, v230
    v_exp_f32 v198, v198
    v_exp_f32 v231, v231
    v_exp_f32 v199, v199
    v_add_f32 v8, v216, v218
    v_add_f32 v9, v217, v219
    v_add_f32 v10, v184, v186
    v_add_f32 v11, v185, v187
    v_add_f32 v8, v8, v220
    v_add_f32 v9, v9, v221
    v_add_f32 v10, v10, v188
    v_add_f32 v11, v11, v189
    v_add_f32 v8, v8, v222
    s_add_u32 s82, s80, 4294107136
    buffer_load_dwordx4 v[68:71], v27, s[52:55], s82 offen nt
    v_add_f32 v9, v9, v223
    v_add_f32 v10, v10, v190
    v_add_f32 v11, v11, v191
    v_add_f32 v8, v8, v224
    v_add_f32 v9, v9, v225
    v_add_f32 v10, v10, v192
    v_add_f32 v11, v11, v193
    v_add_f32 v8, v8, v226
    v_add_f32 v9, v9, v227
    v_add_f32 v10, v10, v194
    v_add_f32 v11, v11, v195
    v_add_f32 v8, v8, v228
    v_add_f32 v9, v9, v229
    v_add_f32 v10, v10, v196
    v_add_f32 v11, v11, v197
    v_add_f32 v8, v8, v230
    v_add_f32 v9, v9, v231
    v_add_f32 v10, v10, v198
    v_add_f32 v11, v11, v199
    v_add_f32 v6, v8, v9
    v_add_f32 v7, v10, v11
    v_add_f32 v4, v8, v9
    s_setprio 0
    v_add_f32 v5, v10, v11
    v_permlane32_swap_b32 v4, v6
    s_nop 0
    v_permlane32_swap_b32 v5, v7
    v_add_f32 v4, v4, v6
    v_add_f32 v5, v5, v7
    v_rcp_f32 v4, v4
    v_rcp_f32 v5, v5
    v_mul_f32 v216, v216, v4
    v_mul_f32 v217, v217, v4
    v_mul_f32 v184, v184, v5
    v_mul_f32 v185, v185, v5
    v_mul_f32 v218, v218, v4
    v_mul_f32 v219, v219, v4
    v_mul_f32 v186, v186, v5
    v_mul_f32 v187, v187, v5
    v_mul_f32 v220, v220, v4
    v_mul_f32 v221, v221, v4
    v_mul_f32 v188, v188, v5
    v_mul_f32 v189, v189, v5
    v_mul_f32 v222, v222, v4
    v_mul_f32 v223, v223, v4
    v_mul_f32 v190, v190, v5
    v_mul_f32 v191, v191, v5
    v_mul_f32 v224, v224, v4
    v_mul_f32 v225, v225, v4
    v_mul_f32 v192, v192, v5
    v_mul_f32 v193, v193, v5
    v_mul_f32 v226, v226, v4
    v_mul_f32 v227, v227, v4
    v_mul_f32 v194, v194, v5
    v_mul_f32 v195, v195, v5
    v_mul_f32 v228, v228, v4
    v_mul_f32 v229, v229, v4
    v_mul_f32 v196, v196, v5
    v_mul_f32 v197, v197, v5
    v_mul_f32 v230, v230, v4
    v_mul_f32 v231, v231, v4
    v_mul_f32 v198, v198, v5
    v_mul_f32 v199, v199, v5
    v_cvt_pk_bf16_f32 v216, v216, v217
    v_cvt_pk_bf16_f32 v217, v218, v219
    v_cvt_pk_bf16_f32 v218, v220, v221
    v_cvt_pk_bf16_f32 v219, v222, v223
    v_cvt_pk_bf16_f32 v220, v224, v225
    v_cvt_pk_bf16_f32 v221, v226, v227
    v_cvt_pk_bf16_f32 v222, v228, v229
    v_cvt_pk_bf16_f32 v223, v230, v231
    ds_write_b128 v232, v[216:219]
    v_cvt_pk_bf16_f32 v224, v184, v185
    v_cvt_pk_bf16_f32 v225, v186, v187
    v_cvt_pk_bf16_f32 v226, v188, v189
    v_cvt_pk_bf16_f32 v227, v190, v191
    ds_write_b128 v232, v[220:223] offset:4096
    s_waitcnt vmcnt(18)
    s_waitcnt vmcnt(12)
    s_waitcnt vmcnt(10)
    s_waitcnt vmcnt(8)
    s_barrier
    ds_write_b128 v232, v[224:227] offset:8192
    v_cvt_pk_bf16_f32 v228, v192, v193
    v_cvt_pk_bf16_f32 v229, v194, v195
    v_cvt_pk_bf16_f32 v230, v196, v197
    v_cvt_pk_bf16_f32 v231, v198, v199
    s_xor_b32 s96, s95, 786432
    s_add_u32 s97, s96, s90
    s_sub_u32 s82, s97, 65536
    s_add_u32 m0, s83, 45056
    s_nop 0
    buffer_load_dwordx4 v26, s[44:47], s82 offen lds
    ds_write_b128 v232, v[228:231] offset:12288
    v_cvt_pk_bf16_f32 v200, 0, v200
    v_cvt_pk_bf16_f32 v201, 0, v201
    v_cvt_pk_bf16_f32 v202, 0, v202
    v_cvt_pk_bf16_f32 v203, 0, v203
    v_cvt_pk_bf16_f32 v204, 0, v204
    v_cvt_pk_bf16_f32 v205, 0, v205
    v_cvt_pk_bf16_f32 v206, 0, v206
    v_cvt_pk_bf16_f32 v207, 0, v207
    v_cvt_pk_bf16_f32 v208, 0, v208
    v_cvt_pk_bf16_f32 v209, 0, v209
    v_cvt_pk_bf16_f32 v210, 0, v210
    v_cvt_pk_bf16_f32 v211, 0, v211
    s_xor_b32 s96, s95, 786432
    s_add_u32 s82, s96, s90
    s_add_u32 m0, s83, 49152
    s_nop 0
    buffer_load_dwordx4 v26, s[44:47], s82 offen lds
    v_cvt_pk_bf16_f32 v212, 0, v212
    v_cvt_pk_bf16_f32 v213, 0, v213
    v_cvt_pk_bf16_f32 v214, 0, v214
    v_cvt_pk_bf16_f32 v215, 0, v215
    v_max3_f32 v4, v200, v201, v202
    v_min3_f32 v5, v200, v201, v202
    v_max3_f32 v4, v4, v203, v204
    v_min3_f32 v5, v5, v203, v204
L_PAD6:
    s_cbranch_execz L_RET6
    v_max3_f32 v4, v4, v205, v206
    v_min3_f32 v5, v5, v205, v206
    v_max3_f32 v4, v4, v207, v208
    v_min3_f32 v5, v5, v207, v208
    v_max3_f32 v4, v4, v209, v210
    v_min3_f32 v5, v5, v209, v210
    s_xor_b32 s96, s95, 917504
    s_add_u32 s97, s96, s90
    s_sub_u32 s82, s97, 65536
    s_add_u32 m0, s83, 53248
    s_nop 0
    buffer_load_dwordx4 v26, s[44:47], s82 offen lds
    v_max3_f32 v4, v4, v211, v212
    v_min3_f32 v5, v5, v211, v212
    v_max3_f32 v4, v4, v213, v214
    v_min3_f32 v5, v5, v213, v214
    v_max_f32 v6, v4, v215
    v_min_f32 v7, v5, v215
    v_max_f32 v4, v4, v215
    s_waitcnt lgkmcnt(0)
    v_min_f32 v5, v5, v215
    v_permlane32_swap_b32 v4, v6
    s_nop 0
    v_permlane32_swap_b32 v5, v7
    v_max_f32 v4, v4, v6
    v_min_f32 v5, v5, v7
    v_mul_f32_e64 v4, v4, s7
    s_xor_b32 s96, s95, 917504
    s_add_u32 s82, s96, s90
    s_add_u32 m0, s83, 57344
    s_nop 0
    buffer_load_dwordx4 v26, s[44:47], s82 offen lds
    v_mul_f32_e64 v5, v5, s7
    v_fma_f32 v216, v200, s7, -v4
    v_fma_f32 v217, v201, s7, -v4
    v_fma_f32 v200, -v200, s7, v5
    v_fma_f32 v201, -v201, s7, v5
    v_fma_f32 v218, v202, s7, -v4
    v_fma_f32 v219, v203, s7, -v4
    v_fma_f32 v202, -v202, s7, v5
    v_fma_f32 v203, -v203, s7, v5
    v_fma_f32 v220, v204, s7, -v4
    v_fma_f32 v221, v205, s7, -v4
    v_fma_f32 v204, -v204, s7, v5
    v_fma_f32 v205, -v205, s7, v5
    v_fma_f32 v222, v206, s7, -v4
    s_xor_b32 s96, s95, 1048576
    s_add_u32 s97, s96, s90
    s_sub_u32 s82, s97, 65536
    s_add_u32 m0, s83, 61440
    s_nop 0
    buffer_load_dwordx4 v26, s[44:47], s82 offen lds
    v_fma_f32 v223, v207, s7, -v4
    v_fma_f32 v206, -v206, s7, v5
    v_fma_f32 v207, -v207, s7, v5
    v_fma_f32 v224, v208, s7, -v4
    v_fma_f32 v225, v209, s7, -v4
    v_fma_f32 v208, -v208, s7, v5
    v_fma_f32 v209, -v209, s7, v5
    v_fma_f32 v226, v210, s7, -v4
    v_fma_f32 v227, v211, s7, -v4
    v_fma_f32 v210, -v210, s7, v5
    v_fma_f32 v211, -v211, s7, v5
    v_fma_f32 v228, v212, s7, -v4
    v_fma_f32 v229, v213, s7, -v4
    v_fma_f32 v212, -v212, s7, v5
    s_xor_b32 s96, s95, 1048576
    s_add_u32 s82, s96, s90
    s_add_u32 m0, s83, 65536
    s_nop 0
    buffer_load_dwordx4 v26, s[44:47], s82 offen lds
    v_fma_f32 v213, -v213, s7, v5
    v_fma_f32 v230, v214, s7, -v4
    v_fma_f32 v231, v215, s7, -v4
    v_fma_f32 v214, -v214, s7, v5
    v_fma_f32 v215, -v215, s7, v5
    v_exp_f32 v216, v216
    v_exp_f32 v200, v200
    v_exp_f32 v217, v217
    v_exp_f32 v201, v201
    v_exp_f32 v218, v218
    v_exp_f32 v202, v202
    v_exp_f32 v219, v219
    v_exp_f32 v203, v203
    v_exp_f32 v220, v220
    s_xor_b32 s96, s95, 1179648
    s_add_u32 s97, s96, s90
    s_sub_u32 s82, s97, 65536
    s_add_u32 m0, s83, 69632
    s_nop 0
    buffer_load_dwordx4 v26, s[44:47], s82 offen lds
    v_exp_f32 v204, v204
    v_exp_f32 v221, v221
    v_exp_f32 v205, v205
    v_exp_f32 v222, v222
    v_exp_f32 v206, v206
    v_exp_f32 v223, v223
    v_exp_f32 v207, v207
    v_exp_f32 v224, v224
    v_exp_f32 v208, v208
    v_exp_f32 v225, v225
    v_exp_f32 v209, v209
    v_exp_f32 v226, v226
    v_exp_f32 v210, v210
    v_exp_f32 v227, v227
    s_xor_b32 s96, s95, 1179648
    s_add_u32 s82, s96, s90
    s_add_u32 m0, s83, 73728
    s_nop 0
    buffer_load_dwordx4 v26, s[44:47], s82 offen lds
    v_exp_f32 v211, v211
    v_exp_f32 v228, v228
    v_exp_f32 v212, v212
    v_exp_f32 v229, v229
    v_exp_f32 v213, v213
    v_exp_f32 v230, v230
    v_exp_f32 v214, v214
    v_exp_f32 v231, v231
    v_exp_f32 v215, v215
    v_add_f32 v8, v216, v218
    v_add_f32 v9, v217, v219
    v_add_f32 v10, v200, v202
    v_add_f32 v11, v201, v203
    v_add_f32 v8, v8, v220
    v_add_f32 v9, v9, v221
    v_add_f32 v10, v10, v204
    v_add_f32 v11, v11, v205
    v_add_f32 v8, v8, v222
    v_add_f32 v9, v9, v223
    v_add_f32 v10, v10, v206
    v_add_f32 v11, v11, v207
    v_add_f32 v8, v8, v224
    v_add_f32 v9, v9, v225
    v_add_f32 v10, v10, v208
    v_add_f32 v11, v11, v209
    v_add_f32 v8, v8, v226
    v_add_f32 v9, v9, v227
    v_add_f32 v10, v10, v210
    v_add_f32 v11, v11, v211
    v_add_f32 v8, v8, v228
    v_add_f32 v9, v9, v229
    v_add_f32 v10, v10, v212
    v_add_f32 v11, v11, v213
    v_add_f32 v8, v8, v230
    v_add_f32 v9, v9, v231
    v_add_f32 v10, v10, v214
    v_add_f32 v11, v11, v215
    v_add_f32 v6, v8, v9
    v_add_f32 v7, v10, v11
    v_add_f32 v4, v8, v9
    v_add_f32 v5, v10, v11
    s_nop 0
    v_permlane32_swap_b32 v4, v6
    v_permlane32_swap_b32 v5, v7
    v_add_f32 v4, v4, v6
    v_add_f32 v5, v5, v7
    v_rcp_f32 v4, v4
    v_rcp_f32 v5, v5
    v_mul_f32 v216, v216, v4
    v_mul_f32 v217, v217, v4
    v_mul_f32 v200, v200, v5
    v_mul_f32 v201, v201, v5
    v_mul_f32 v218, v218, v4
    v_mul_f32 v219, v219, v4
    v_mul_f32 v202, v202, v5
    v_mul_f32 v203, v203, v5
    v_mul_f32 v220, v220, v4
    v_mul_f32 v221, v221, v4
    v_mul_f32 v204, v204, v5
    v_mul_f32 v205, v205, v5
    v_mul_f32 v222, v222, v4
    v_mul_f32 v223, v223, v4
    v_mul_f32 v206, v206, v5
    v_mul_f32 v207, v207, v5
    v_mul_f32 v224, v224, v4
    v_mul_f32 v225, v225, v4
    v_mul_f32 v208, v208, v5
    v_mul_f32 v209, v209, v5
    v_mul_f32 v226, v226, v4
    v_mul_f32 v227, v227, v4
    v_mul_f32 v210, v210, v5
    v_mul_f32 v211, v211, v5
    v_mul_f32 v228, v228, v4
    v_mul_f32 v229, v229, v4
    v_mul_f32 v212, v212, v5
    v_mul_f32 v213, v213, v5
    v_mul_f32 v230, v230, v4
    v_mul_f32 v231, v231, v4
    v_mul_f32 v214, v214, v5
    v_mul_f32 v215, v215, v5
    v_cvt_pk_bf16_f32 v216, v216, v217
    v_cvt_pk_bf16_f32 v217, v218, v219
    v_cvt_pk_bf16_f32 v218, v220, v221
    v_cvt_pk_bf16_f32 v219, v222, v223
    v_cvt_pk_bf16_f32 v220, v224, v225
    v_cvt_pk_bf16_f32 v221, v226, v227
    v_cvt_pk_bf16_f32 v222, v228, v229
    v_cvt_pk_bf16_f32 v223, v230, v231
    ds_write_b128 v232, v[216:219] offset:16384
    v_cvt_pk_bf16_f32 v224, v200, v201
    v_cvt_pk_bf16_f32 v225, v202, v203
    v_cvt_pk_bf16_f32 v226, v204, v205
    v_cvt_pk_bf16_f32 v227, v206, v207
    ds_write_b128 v232, v[220:223] offset:20480
    ds_write_b128 v232, v[224:227] offset:24576
    v_cvt_pk_bf16_f32 v228, v208, v209
    v_cvt_pk_bf16_f32 v229, v210, v211
    v_cvt_pk_bf16_f32 v230, v212, v213
    v_cvt_pk_bf16_f32 v231, v214, v215
    ds_write_b128 v232, v[228:231] offset:28672
    s_lshl_b32 s96, s77, 11
    s_add_u32 s17, s96, 151552
    v_add_u32 v0, s17, v2
    s_setprio 0
L_JOIN:
    s_waitcnt lgkmcnt(0)
    s_barrier
    ds_read_b64_tr_b16 v[184:185], v84
    ds_read_b64_tr_b16 v[186:187], v84 offset:512
    ds_read_b64_tr_b16 v[200:201], v85
    ds_read_b64_tr_b16 v[202:203], v85 offset:512
    ds_read_b64_tr_b16 v[204:205], v85 offset:1024
    ds_read_b64_tr_b16 v[206:207], v85 offset:1536
    ds_read_b64_tr_b16 v[188:189], v84 offset:1024
    ds_read_b64_tr_b16 v[190:191], v84 offset:1536
    ds_read_b64_tr_b16 v[208:209], v85 offset:2048
    ds_read_b64_tr_b16 v[210:211], v85 offset:2560
    ds_read_b64_tr_b16 v[212:213], v85 offset:3072
    ds_read_b64_tr_b16 v[214:215], v85 offset:3584
    ds_read_b64_tr_b16 v[192:193], v84 offset:2048
    ds_read_b64_tr_b16 v[194:195], v84 offset:2560
    ds_read_b64_tr_b16 v[216:217], v85 offset:4096
    ds_read_b64_tr_b16 v[218:219], v85 offset:4608
    ds_read_b64_tr_b16 v[220:221], v85 offset:5120
    ds_read_b64_tr_b16 v[222:223], v85 offset:5632
    s_waitcnt lgkmcnt(12)
    v_mfma_f32_16x16x32_bf16 v[232:235], v[184:187], v[200:203], 0
    v_mfma_f32_16x16x32_bf16 v[236:239], v[184:187], v[204:207], 0
    v_mfma_f32_16x16x32_bf16 v[240:243], v[184:187], v[80:83], 0
    ds_read_b64_tr_b16 v[196:197], v84 offset:3072
    ds_read_b64_tr_b16 v[198:199], v84 offset:3584
    ds_read_b64_tr_b16 v[224:225], v85 offset:6144
    ds_read_b64_tr_b16 v[226:227], v85 offset:6656
    ds_read_b64_tr_b16 v[228:229], v85 offset:7168
    ds_read_b64_tr_b16 v[230:231], v85 offset:7680
    s_waitcnt lgkmcnt(12)
    v_mfma_f32_16x16x32_bf16 v[232:235], v[188:191], v[208:211], v[232:235]
    v_mfma_f32_16x16x32_bf16 v[236:239], v[188:191], v[212:215], v[236:239]
    v_mfma_f32_16x16x32_bf16 v[240:243], v[188:191], v[80:83], v[240:243]
    s_waitcnt lgkmcnt(6)
    v_mfma_f32_16x16x32_bf16 v[232:235], v[192:195], v[216:219], v[232:235]
    v_mfma_f32_16x16x32_bf16 v[236:239], v[192:195], v[220:223], v[236:239]
    v_mfma_f32_16x16x32_bf16 v[240:243], v[192:195], v[80:83], v[240:243]
    s_waitcnt lgkmcnt(0)
    v_mfma_f32_16x16x32_bf16 v[232:235], v[196:199], v[224:227], v[232:235]
    v_mfma_f32_16x16x32_bf16 v[236:239], v[196:199], v[228:231], v[236:239]
    v_mfma_f32_16x16x32_bf16 v[240:243], v[196:199], v[80:83], v[240:243]
    s_cmp_lt_u32 s3, 4
    s_cbranch_scc1 L_NOQX
    ds_read_b128 v[168:171], v0
    ds_read_b128 v[172:175], v0 offset:1024
L_NOQX:
    s_nop 3
    buffer_store_dwordx4 v[232:235], v2, s[32:35], s13 offen sc1
    buffer_store_dwordx4 v[236:239], v2, s[32:35], s15 offen sc1
    s_mov_b32 exec_lo, 0x00010001
    s_mov_b32 exec_hi, 0x00010001
    buffer_store_dwordx4 v[240:243], v1, s[32:35], s14 offen sc1
    s_mov_b64 exec, -1
    s_waitcnt lgkmcnt(0)
    v_mfma_f32_32x32x16_bf16 v[120:135], v[176:179], v[168:171], 0
    v_mfma_f32_32x32x16_bf16 v[120:135], v[180:183], v[172:175], v[120:135]
    v_and_b32 v46, 7, v1
    v_lshlrev_b32 v46, 17, v46
    v_bfe_u32 v9, v1, 3, 1
    v_lshl_add_u32 v46, v9, 14, v46
    s_and_b32 s96, s10, 1
    s_and_b32 s97, s2, 27
    s_lshl_b32 s98, s97, 12
    s_lshr_b32 s99, s10, 1
    s_lshl_b32 s97, s99, 6
    s_add_u32 s99, s98, s97
    s_lshl2_add_u32 s98, s96, s99
    s_add_u32 s97, s98, 1048576
    s_add_u32 s17, s97, 512
    v_lshrrev_b32 v47, 3, v1
    v_lshlrev_b32 v47, 10, v47
    v_and_b32 v9, 7, v1
    v_lshl_add_u32 v47, v9, 4, v47
    v_and_b32 v48, 7, v1
    v_lshlrev_b32 v48, 4, v48
    v_lshrrev_b32 v9, 5, v1
    v_lshl_add_u32 v48, v9, 3, v48
    v_cvt_pk_bf16_f32 v120, 0, v120
    v_cvt_pk_bf16_f32 v121, 0, v121
    v_cvt_pk_bf16_f32 v122, 0, v122
    v_cvt_pk_bf16_f32 v123, 0, v123
    v_cvt_pk_bf16_f32 v124, 0, v124
    v_cvt_pk_bf16_f32 v125, 0, v125
    v_cvt_pk_bf16_f32 v126, 0, v126
    v_cvt_pk_bf16_f32 v127, 0, v127
    v_cvt_pk_bf16_f32 v128, 0, v128
    v_cvt_pk_bf16_f32 v129, 0, v129
    v_cvt_pk_bf16_f32 v130, 0, v130
    v_cvt_pk_bf16_f32 v131, 0, v131
    v_cvt_pk_bf16_f32 v132, 0, v132
    v_cvt_pk_bf16_f32 v133, 0, v133
    v_cvt_pk_bf16_f32 v134, 0, v134
    v_cvt_pk_bf16_f32 v135, 0, v135
    v_max3_f32 v4, v120, v121, v122
    v_min3_f32 v5, v120, v121, v122
    v_max3_f32 v4, v4, v123, v124
    v_min3_f32 v5, v5, v123, v124
    v_max3_f32 v4, v4, v125, v126
    v_min3_f32 v5, v5, v125, v126
    v_max3_f32 v4, v4, v127, v128
    v_min3_f32 v5, v5, v127, v128
    v_max3_f32 v4, v4, v129, v130
    v_min3_f32 v5, v5, v129, v130
    v_max3_f32 v4, v4, v131, v132
    v_min3_f32 v5, v5, v131, v132
    v_max3_f32 v4, v4, v133, v134
    v_min3_f32 v5, v5, v133, v134
    v_max_f32 v6, v4, v135
    v_min_f32 v7, v5, v135
    v_max_f32 v4, v4, v135
    v_min_f32 v5, v5, v135
    s_nop 0
    v_permlane32_swap_b32 v4, v6
    v_permlane32_swap_b32 v5, v7
    v_max_f32 v4, v4, v6
    v_min_f32 v5, v5, v7
    v_pk_mul_f32 v[4:5], v[4:5], s[6:7] op_sel:[0,1]
    v_mov_b32 v6, v5
    v_pk_fma_f32 v[136:137], v[120:121], s[6:7], v[4:5] op_sel:[0,1,0] op_sel_hi:[1,1,0] neg_lo:[0,0,1] neg_hi:[0,0,1]
    v_pk_fma_f32 v[120:121], v[120:121], s[6:7], v[6:7] op_sel:[0,1,0] op_sel_hi:[1,1,0] neg_lo:[1,0,0] neg_hi:[1,0,0]
    v_pk_fma_f32 v[138:139], v[122:123], s[6:7], v[4:5] op_sel:[0,1,0] op_sel_hi:[1,1,0] neg_lo:[0,0,1] neg_hi:[0,0,1]
    v_pk_fma_f32 v[122:123], v[122:123], s[6:7], v[6:7] op_sel:[0,1,0] op_sel_hi:[1,1,0] neg_lo:[1,0,0] neg_hi:[1,0,0]
    v_pk_fma_f32 v[140:141], v[124:125], s[6:7], v[4:5] op_sel:[0,1,0] op_sel_hi:[1,1,0] neg_lo:[0,0,1] neg_hi:[0,0,1]
    v_pk_fma_f32 v[124:125], v[124:125], s[6:7], v[6:7] op_sel:[0,1,0] op_sel_hi:[1,1,0] neg_lo:[1,0,0] neg_hi:[1,0,0]
    v_pk_fma_f32 v[142:143], v[126:127], s[6:7], v[4:5] op_sel:[0,1,0] op_sel_hi:[1,1,0] neg_lo:[0,0,1] neg_hi:[0,0,1]
    v_pk_fma_f32 v[126:127], v[126:127], s[6:7], v[6:7] op_sel:[0,1,0] op_sel_hi:[1,1,0] neg_lo:[1,0,0] neg_hi:[1,0,0]
    v_pk_fma_f32 v[144:145], v[128:129], s[6:7], v[4:5] op_sel:[0,1,0] op_sel_hi:[1,1,0] neg_lo:[0,0,1] neg_hi:[0,0,1]
    v_pk_fma_f32 v[128:129], v[128:129], s[6:7], v[6:7] op_sel:[0,1,0] op_sel_hi:[1,1,0] neg_lo:[1,0,0] neg_hi:[1,0,0]
    v_pk_fma_f32 v[146:147], v[130:131], s[6:7], v[4:5] op_sel:[0,1,0] op_sel_hi:[1,1,0] neg_lo:[0,0,1] neg_hi:[0,0,1]
    v_pk_fma_f32 v[130:131], v[130:131], s[6:7], v[6:7] op_sel:[0,1,0] op_sel_hi:[1,1,0] neg_lo:[1,0,0] neg_hi:[1,0,0]
    v_pk_fma_f32 v[148:149], v[132:133], s[6:7], v[4:5] op_sel:[0,1,0] op_sel_hi:[1,1,0] neg_lo:[0,0,1] neg_hi:[0,0,1]
    v_pk_fma_f32 v[132:133], v[132:133], s[6:7], v[6:7] op_sel:[0,1,0] op_sel_hi:[1,1,0] neg_lo:[1,0,0] neg_hi:[1,0,0]
    v_pk_fma_f32 v[150:151], v[134:135], s[6:7], v[4:5] op_sel:[0,1,0] op_sel_hi:[1,1,0] neg_lo:[0,0,1] neg_hi:[0,0,1]
    v_pk_fma_f32 v[134:135], v[134:135], s[6:7], v[6:7] op_sel:[0,1,0] op_sel_hi:[1,1,0] neg_lo:[1,0,0] neg_hi:[1,0,0]
    v_exp_f32 v136, v136
    v_exp_f32 v120, v120
    v_exp_f32 v137, v137
    v_exp_f32 v121, v121
    v_exp_f32 v138, v138
    v_exp_f32 v122, v122
    v_exp_f32 v139, v139
    v_exp_f32 v123, v123
    v_exp_f32 v140, v140
    v_exp_f32 v124, v124
    v_exp_f32 v141, v141
    v_exp_f32 v125, v125
    v_exp_f32 v142, v142
    v_exp_f32 v126, v126
    v_exp_f32 v143, v143
    v_exp_f32 v127, v127
    s_waitcnt vmcnt(0)
    s_barrier
    s_cmp_lg_u32 s3, 0
    s_cbranch_scc1 L_PC
    v_mov_b32 v85, s4
    s_mov_b32 exec_hi, 0
    s_mov_b32 exec_lo, 65535
    buffer_store_dword v85, v46, s[32:35], s17 offen sc1
    s_mov_b64 exec, -1
L_PC:
    s_xor_b32 s96, s95, 1310720
    s_add_u32 s82, s96, s90
    s_add_u32 m0, s83, 81920
    s_nop 0
    buffer_load_dwordx4 v26, s[44:47], s82 offen lds
    v_exp_f32 v144, v144
    v_exp_f32 v128, v128
    v_exp_f32 v145, v145
    v_exp_f32 v129, v129
    s_xor_b32 s96, s95, 1441792
    s_add_u32 s82, s96, s90
    s_add_u32 m0, s83, 90112
    s_nop 0
    buffer_load_dwordx4 v26, s[44:47], s82 offen lds
    v_exp_f32 v146, v146
    v_exp_f32 v130, v130
    v_exp_f32 v147, v147
    v_exp_f32 v131, v131
    s_xor_b32 s96, s95, 1572864
    s_add_u32 s82, s96, s90
    s_add_u32 m0, s83, 98304
    s_nop 0
    buffer_load_dwordx4 v26, s[44:47], s82 offen lds
    v_exp_f32 v148, v148
    v_exp_f32 v132, v132
    v_exp_f32 v149, v149
    v_exp_f32 v133, v133
    s_xor_b32 s96, s95, 1703936
    s_add_u32 s82, s96, s90
    s_add_u32 m0, s83, 106496
    s_nop 0
    buffer_load_dwordx4 v26, s[44:47], s82 offen lds
    v_exp_f32 v150, v150
    v_exp_f32 v134, v134
    v_exp_f32 v151, v151
    v_exp_f32 v135, v135
    s_lshl4_add_u32 s96, s11, s10
    s_lshl_b32 s97, s96, 14
    s_lshl_b32 s98, s3, 7
    s_add_u32 s99, s97, s98
    s_add_u32 s13, s99, 25165824
    s_add_u32 s14, s13, 8192
    s_lshl4_add_u32 s96, s11, s10
    s_lshl_b32 s97, s96, 10
    s_lshl_b32 s98, s3, 7
    s_add_u32 s99, s97, s98
    s_add_u32 s15, s99, 29360128
    s_add_u32 s17, s17, 3072
    s_load_dwordx2 s[24:25], s[32:33], s92 offset:512 glc
    s_xor_b32 s96, s95, 1835008
    s_add_u32 s82, s96, s90
    s_add_u32 m0, s83, 114688
    s_nop 0
    buffer_load_dwordx4 v26, s[44:47], s82 offen lds
    v_pk_add_f32 v[8:9], v[136:137], v[138:139]
    v_pk_add_f32 v[10:11], v[120:121], v[122:123]
    v_pk_add_f32 v[8:9], v[8:9], v[140:141]
    v_pk_add_f32 v[10:11], v[10:11], v[124:125]
    v_pk_add_f32 v[8:9], v[8:9], v[142:143]
    v_pk_add_f32 v[10:11], v[10:11], v[126:127]
    v_pk_add_f32 v[8:9], v[8:9], v[144:145]
    v_pk_add_f32 v[10:11], v[10:11], v[128:129]
    v_pk_add_f32 v[8:9], v[8:9], v[146:147]
    v_pk_add_f32 v[10:11], v[10:11], v[130:131]
    v_pk_add_f32 v[8:9], v[8:9], v[148:149]
    v_pk_add_f32 v[10:11], v[10:11], v[132:133]
    v_pk_add_f32 v[8:9], v[8:9], v[150:151]
    v_pk_add_f32 v[10:11], v[10:11], v[134:135]
    s_xor_b32 s96, s95, 1966080
    s_add_u32 s82, s96, s90
    s_add_u32 m0, s83, 122880
    s_nop 0
    buffer_load_dwordx4 v26, s[44:47], s82 offen lds
    v_add_f32 v6, v8, v9
    v_add_f32 v7, v10, v11
    v_add_f32 v4, v8, v9
    v_add_f32 v5, v10, v11
    s_nop 0
    v_permlane32_swap_b32 v4, v6
    v_permlane32_swap_b32 v5, v7
    v_pk_add_f32 v[4:5], v[4:5], v[6:7]
    v_rcp_f32 v4, v4
    v_rcp_f32 v5, v5
    s_nop 0
    v_pk_mul_f32 v[136:137], v[136:137], v[4:5] op_sel_hi:[1,0]
    v_pk_mul_f32 v[120:121], v[4:5], v[120:121] op_sel:[1,0]
    v_pk_mul_f32 v[138:139], v[138:139], v[4:5] op_sel_hi:[1,0]
    v_pk_mul_f32 v[122:123], v[4:5], v[122:123] op_sel:[1,0]
    v_pk_mul_f32 v[140:141], v[140:141], v[4:5] op_sel_hi:[1,0]
    s_add_u32 s82, s95, s90
    s_mov_b32 m0, s83
    s_nop 0
    buffer_load_dwordx4 v26, s[44:47], s82 offen lds
    v_pk_mul_f32 v[124:125], v[4:5], v[124:125] op_sel:[1,0]
    v_pk_mul_f32 v[142:143], v[142:143], v[4:5] op_sel_hi:[1,0]
    v_pk_mul_f32 v[126:127], v[4:5], v[126:127] op_sel:[1,0]
    v_pk_mul_f32 v[144:145], v[144:145], v[4:5] op_sel_hi:[1,0]
    v_pk_mul_f32 v[128:129], v[4:5], v[128:129] op_sel:[1,0]
    v_pk_mul_f32 v[146:147], v[146:147], v[4:5] op_sel_hi:[1,0]
    v_pk_mul_f32 v[130:131], v[4:5], v[130:131] op_sel:[1,0]
    v_pk_mul_f32 v[148:149], v[148:149], v[4:5] op_sel_hi:[1,0]
    v_pk_mul_f32 v[132:133], v[4:5], v[132:133] op_sel:[1,0]
    v_pk_mul_f32 v[150:151], v[150:151], v[4:5] op_sel_hi:[1,0]
    v_pk_mul_f32 v[134:135], v[4:5], v[134:135] op_sel:[1,0]
    v_cvt_pk_bf16_f32 v152, v136, v137
    v_cvt_pk_bf16_f32 v153, v138, v139
    v_cvt_pk_bf16_f32 v154, v140, v141
    s_xor_b32 s96, s95, 131072
    s_add_u32 s82, s96, s90
    s_add_u32 m0, s83, 8192
    s_nop 0
    buffer_load_dwordx4 v26, s[44:47], s82 offen lds
    v_cvt_pk_bf16_f32 v155, v142, v143
    v_cvt_pk_bf16_f32 v156, v144, v145
    v_cvt_pk_bf16_f32 v157, v146, v147
    v_cvt_pk_bf16_f32 v158, v148, v149
    v_cvt_pk_bf16_f32 v159, v150, v151
    v_cvt_pk_bf16_f32 v160, v120, v121
    v_cvt_pk_bf16_f32 v161, v122, v123
    v_cvt_pk_bf16_f32 v162, v124, v125
    v_cvt_pk_bf16_f32 v163, v126, v127
    v_cvt_pk_bf16_f32 v164, v128, v129
    v_cvt_pk_bf16_f32 v165, v130, v131
    v_cvt_pk_bf16_f32 v166, v132, v133
    v_cvt_pk_bf16_f32 v167, v134, v135
    s_branch SCHK_20
SPOLL_19:
    s_load_dwordx2 s[24:25], s[32:33], s92 offset:512 glc
SCHK_20:
    s_add_u32 s5, s5, 1
    s_cmp_ge_u32 s5, 200000
    s_waitcnt lgkmcnt(0)
    s_cbranch_scc1 SDONE_21
    s_cmp_lg_u32 s24, s4
    s_cbranch_scc1 SPOLL_19
    s_cmp_lg_u32 s25, s4
    s_cbranch_scc1 SPOLL_19
SDONE_21:
    s_barrier
    buffer_load_dwordx4 v[184:187], v47, s[32:35], s13 offen sc1
    buffer_load_dwordx4 v[188:191], v47, s[32:35], s14 offen sc1
    buffer_load_dwordx4 v[192:195], v2, s[32:35], s16 offen sc1
    s_lshl_b32 s96, s3, 5
    s_add_u32 s14, s96, 155648
    v_and_b32 v6, 3, v1
    v_lshl_add_u32 v6, v6, 3, s14
    v_lshrrev_b32 v9, 5, v1
    v_lshl_add_u32 v6, v9, 2, v6
    s_lshl_b32 s96, s3, 10
    s_add_u32 s14, s96, 147456
    v_and_b32 v5, 15, v1
    v_lshl_add_u32 v5, v5, 4, s14
    v_lshrrev_b32 v9, 5, v1
    v_lshl_add_u32 v5, v9, 9, v5
    v_bfe_u32 v9, v1, 4, 1
    v_lshl_add_u32 v5, v9, 3, v5
    s_lshl_b32 s96, s76, 7
    s_add_u32 s14, s96, 155648
    v_lshrrev_b32 v7, 5, v1
    v_lshl_add_u32 v7, v7, 4, s14
    s_lshl_b32 s96, s76, 12
    s_add_u32 s14, s96, 147456
    v_add_u32 v84, s14, v2
    s_cmp_lt_u32 s3, 4
    s_cbranch_scc1 L_HG1
    v_lshlrev_b32 v8, 16, v88
    v_and_b32 v9, s6, v88
    v_pk_mul_f32 v[196:197], v[36:37], v[8:9] op_sel:[0,0] op_sel_hi:[0,1]
    v_lshlrev_b32 v10, 16, v89
    v_and_b32 v11, s6, v89
    v_pk_mul_f32 v[198:199], v[36:37], v[10:11] op_sel:[0,0] op_sel_hi:[0,1]
    v_lshlrev_b32 v8, 16, v90
    v_and_b32 v9, s6, v90
    v_pk_mul_f32 v[200:201], v[36:37], v[8:9] op_sel:[0,0] op_sel_hi:[0,1]
    v_lshlrev_b32 v10, 16, v91
    v_and_b32 v11, s6, v91
    v_pk_mul_f32 v[202:203], v[36:37], v[10:11] op_sel:[0,0] op_sel_hi:[0,1]
    v_lshlrev_b32 v8, 16, v92
    v_and_b32 v9, s6, v92
    v_pk_fma_f32 v[196:197], v[36:37], v[8:9], v[196:197] op_sel:[1,0,0] op_sel_hi:[1,1,1]
    v_lshlrev_b32 v10, 16, v93
    v_and_b32 v11, s6, v93
    v_pk_fma_f32 v[198:199], v[36:37], v[10:11], v[198:199] op_sel:[1,0,0] op_sel_hi:[1,1,1]
    v_lshlrev_b32 v8, 16, v94
    v_and_b32 v9, s6, v94
    v_pk_fma_f32 v[200:201], v[36:37], v[8:9], v[200:201] op_sel:[1,0,0] op_sel_hi:[1,1,1]
    v_lshlrev_b32 v10, 16, v95
    v_and_b32 v11, s6, v95
    v_pk_fma_f32 v[202:203], v[36:37], v[10:11], v[202:203] op_sel:[1,0,0] op_sel_hi:[1,1,1]
    v_lshlrev_b32 v8, 16, v96
    v_and_b32 v9, s6, v96
    v_pk_fma_f32 v[196:197], v[38:39], v[8:9], v[196:197] op_sel:[0,0,0] op_sel_hi:[0,1,1]
    v_lshlrev_b32 v10, 16, v97
    v_and_b32 v11, s6, v97
    v_pk_fma_f32 v[198:199], v[38:39], v[10:11], v[198:199] op_sel:[0,0,0] op_sel_hi:[0,1,1]
    v_lshlrev_b32 v8, 16, v98
    v_and_b32 v9, s6, v98
    v_pk_fma_f32 v[200:201], v[38:39], v[8:9], v[200:201] op_sel:[0,0,0] op_sel_hi:[0,1,1]
    v_lshlrev_b32 v10, 16, v99
    v_and_b32 v11, s6, v99
    v_pk_fma_f32 v[202:203], v[38:39], v[10:11], v[202:203] op_sel:[0,0,0] op_sel_hi:[0,1,1]
    v_lshlrev_b32 v8, 16, v100
    v_and_b32 v9, s6, v100
    v_pk_fma_f32 v[196:197], v[38:39], v[8:9], v[196:197] op_sel:[1,0,0] op_sel_hi:[1,1,1]
    v_lshlrev_b32 v10, 16, v101
    v_and_b32 v11, s6, v101
    v_pk_fma_f32 v[198:199], v[38:39], v[10:11], v[198:199] op_sel:[1,0,0] op_sel_hi:[1,1,1]
    v_lshlrev_b32 v8, 16, v102
    v_and_b32 v9, s6, v102
    v_pk_fma_f32 v[200:201], v[38:39], v[8:9], v[200:201] op_sel:[1,0,0] op_sel_hi:[1,1,1]
    v_lshlrev_b32 v10, 16, v103
    v_and_b32 v11, s6, v103
    v_pk_fma_f32 v[202:203], v[38:39], v[10:11], v[202:203] op_sel:[1,0,0] op_sel_hi:[1,1,1]
    v_lshlrev_b32 v8, 16, v104
    v_and_b32 v9, s6, v104
    v_pk_fma_f32 v[196:197], v[40:41], v[8:9], v[196:197] op_sel:[0,0,0] op_sel_hi:[0,1,1]
    v_lshlrev_b32 v10, 16, v105
    v_and_b32 v11, s6, v105
    v_pk_fma_f32 v[198:199], v[40:41], v[10:11], v[198:199] op_sel:[0,0,0] op_sel_hi:[0,1,1]
    v_lshlrev_b32 v8, 16, v106
    v_and_b32 v9, s6, v106
    v_pk_fma_f32 v[200:201], v[40:41], v[8:9], v[200:201] op_sel:[0,0,0] op_sel_hi:[0,1,1]
    v_lshlrev_b32 v10, 16, v107
    v_and_b32 v11, s6, v107
    v_pk_fma_f32 v[202:203], v[40:41], v[10:11], v[202:203] op_sel:[0,0,0] op_sel_hi:[0,1,1]
    v_lshlrev_b32 v8, 16, v108
    v_and_b32 v9, s6, v108
    v_pk_fma_f32 v[196:197], v[40:41], v[8:9], v[196:197] op_sel:[1,0,0] op_sel_hi:[1,1,1]
    v_lshlrev_b32 v10, 16, v109
    v_and_b32 v11, s6, v109
    v_pk_fma_f32 v[198:199], v[40:41], v[10:11], v[198:199] op_sel:[1,0,0] op_sel_hi:[1,1,1]
    v_lshlrev_b32 v8, 16, v110
    v_and_b32 v9, s6, v110
    v_pk_fma_f32 v[200:201], v[40:41], v[8:9], v[200:201] op_sel:[1,0,0] op_sel_hi:[1,1,1]
    v_lshlrev_b32 v10, 16, v111
    v_and_b32 v11, s6, v111
    v_pk_fma_f32 v[202:203], v[40:41], v[10:11], v[202:203] op_sel:[1,0,0] op_sel_hi:[1,1,1]
    v_lshlrev_b32 v8, 16, v112
    v_and_b32 v9, s6, v112
    v_pk_fma_f32 v[196:197], v[42:43], v[8:9], v[196:197] op_sel:[0,0,0] op_sel_hi:[0,1,1]
    v_lshlrev_b32 v10, 16, v113
    v_and_b32 v11, s6, v113
    v_pk_fma_f32 v[198:199], v[42:43], v[10:11], v[198:199] op_sel:[0,0,0] op_sel_hi:[0,1,1]
    v_lshlrev_b32 v8, 16, v114
    v_and_b32 v9, s6, v114
    v_pk_fma_f32 v[200:201], v[42:43], v[8:9], v[200:201] op_sel:[0,0,0] op_sel_hi:[0,1,1]
    v_lshlrev_b32 v10, 16, v115
    v_and_b32 v11, s6, v115
    v_pk_fma_f32 v[202:203], v[42:43], v[10:11], v[202:203] op_sel:[0,0,0] op_sel_hi:[0,1,1]
    v_lshlrev_b32 v8, 16, v116
    v_and_b32 v9, s6, v116
    v_pk_fma_f32 v[196:197], v[42:43], v[8:9], v[196:197] op_sel:[1,0,0] op_sel_hi:[1,1,1]
    v_lshlrev_b32 v10, 16, v117
    v_and_b32 v11, s6, v117
    v_pk_fma_f32 v[198:199], v[42:43], v[10:11], v[198:199] op_sel:[1,0,0] op_sel_hi:[1,1,1]
    v_lshlrev_b32 v8, 16, v118
    v_and_b32 v9, s6, v118
    v_pk_fma_f32 v[200:201], v[42:43], v[8:9], v[200:201] op_sel:[1,0,0] op_sel_hi:[1,1,1]
    v_lshlrev_b32 v10, 16, v119
    v_and_b32 v11, s6, v119
    v_pk_fma_f32 v[202:203], v[42:43], v[10:11], v[202:203] op_sel:[1,0,0] op_sel_hi:[1,1,1]
    v_permlane32_swap_b32 v196, v200
    v_permlane32_swap_b32 v197, v201
    v_permlane32_swap_b32 v198, v202
    v_permlane32_swap_b32 v199, v203
    v_add_f32 v196, v196, v200
    v_add_f32 v197, v197, v201
    v_add_f32 v198, v198, v202
    v_add_f32 v199, v199, v203
    s_nop 0
    v_permlane16_swap_b32 v196, v198
    v_permlane16_swap_b32 v197, v199
    v_add_f32 v196, v196, v198
    v_add_f32 v197, v197, v199
    s_nop 0
    v_add_f32_dpp v196, v196, v196 row_ror:8 row_mask:0xf bank_mask:0xf
    v_add_f32_dpp v197, v197, v197 row_ror:8 row_mask:0xf bank_mask:0xf
    s_nop 1
    v_mov_b32_dpp v196, v197 quad_perm:[0,1,2,3] row_mask:0xf bank_mask:0xc
    ds_write_b32 v252, v196 offset:9984
L_HG1:
    s_waitcnt vmcnt(1)
    v_pk_add_f32 v[184:185], v[184:185], v[188:189]
    v_pk_add_f32 v[186:187], v[186:187], v[190:191]
    s_nop 1
    v_permlane32_swap_b32 v184, v186
    v_permlane32_swap_b32 v185, v187
    v_pk_add_f32 v[184:185], v[184:185], v[186:187]
    s_nop 1
    v_add_f32_dpp v184, v184, v184 row_ror:8 row_mask:0xf bank_mask:0xf
    v_add_f32_dpp v185, v185, v185 row_ror:8 row_mask:0xf bank_mask:0xf
    v_mov_b32 v186, v184
    v_mov_b32 v187, v185
    s_nop 0
    v_permlane16_swap_b32 v184, v186
    v_permlane16_swap_b32 v185, v187
    v_pk_add_f32 v[184:185], v[184:185], v[186:187]
    v_cvt_pk_bf16_f32 v184, v184, v185
    v_mov_b32 v185, s4
    s_mov_b32 exec_lo, 0xff
    s_mov_b32 exec_hi, 0xff
    buffer_store_dwordx2 v[184:185], v48, s[32:35], s15 offen sc1
    s_mov_b64 exec, -1
    s_waitcnt lgkmcnt(0)
    s_barrier
    s_cmp_lg_u32 s3, 0
    s_cbranch_scc1 L_PC2
    v_mov_b32 v85, s4
    s_mov_b32 exec_hi, 0
    s_mov_b32 exec_lo, 65535
    buffer_store_dword v85, v46, s[32:35], s17 offen sc1
    s_mov_b64 exec, -1
L_PC2:
    s_cmp_lg_u32 s3, 3
    s_cbranch_scc1 L_M2F
    ds_read_b128 v[196:199], v251 offset:11008
    s_lshr_b32 s96, s8, 2
    s_lshl1_add_u32 s97, s9, s96
    s_and_b32 s98, s8, 3
    s_lshl2_add_u32 s99, s97, s98
    s_lshl_b32 s96, s99, 9
    s_add_u32 s18, s96, 131072
    s_waitcnt lgkmcnt(0)
    v_add_f32 v196, v196, v197
    v_add_f32 v198, v198, v199
    v_mov_b32 v197, s4
    v_add_f32 v196, v196, v198
    buffer_store_dwordx2 v[196:197], v250, s[32:35], s18 offen sc1
L_M2F:
L_PAD7:
    s_cbranch_execz L_RET7
    s_waitcnt vmcnt(1)
    s_xor_b32 s96, s95, 262144
    s_add_u32 s82, s96, s90
    s_add_u32 m0, s83, 16384
    s_nop 0
    buffer_load_dwordx4 v26, s[44:47], s82 offen lds
    v_permlane32_swap_b32 v192, v194
    v_permlane32_swap_b32 v193, v195
    v_pk_add_f32 v[192:193], v[192:193], v[194:195]
    s_nop 1
    v_add_f32_dpp v192, v192, v192 row_ror:4 row_mask:0xf bank_mask:0xf
    s_xor_b32 s96, s95, 393216
    s_add_u32 s82, s96, s90
    s_add_u32 m0, s83, 24576
    s_nop 0
    buffer_load_dwordx4 v26, s[44:47], s82 offen lds
    v_add_f32_dpp v193, v193, v193 row_ror:4 row_mask:0xf bank_mask:0xf
    v_add_f32_dpp v192, v192, v192 row_ror:8 row_mask:0xf bank_mask:0xf
    s_nop 0
    v_add_f32_dpp v193, v193, v193 row_ror:8 row_mask:0xf bank_mask:0xf
    s_xor_b32 s96, s95, 524288
    s_add_u32 s82, s96, s90
    s_add_u32 m0, s83, 32768
    s_nop 0
    buffer_load_dwordx4 v26, s[44:47], s82 offen lds
    v_mov_b32 v194, v192
    v_mov_b32 v195, v193
    s_nop 0
    v_permlane16_swap_b32 v192, v194
    s_xor_b32 s96, s95, 655360
    s_add_u32 s82, s96, s90
    s_add_u32 m0, s83, 40960
    s_nop 0
    buffer_load_dwordx4 v26, s[44:47], s82 offen lds
    v_permlane16_swap_b32 v193, v195
    v_pk_add_f32 v[192:193], v[192:193], v[194:195]
    v_cvt_pk_bf16_f32 v192, v192, v193
    ds_write_b32 v6, v192
    s_waitcnt lgkmcnt(0)
    s_barrier
    ds_read_b128 v[196:199], v7
    ds_read_b128 v[200:203], v7 offset:32
    ds_read_b128 v[204:207], v7 offset:64
    ds_read_b128 v[208:211], v7 offset:96
    s_lshr_b32 s96, s8, 2
    s_lshl1_add_u32 s97, s9, s96
    s_and_b32 s98, s8, 3
    s_lshl2_add_u32 s99, s97, s98
    s_lshl_b32 s96, s99, 9
    s_add_u32 s18, s96, 131072
    s_waitcnt lgkmcnt(0)
    s_lshl3_add_u32 s96, s11, s3
    s_lshl_b32 s97, s96, 11
    s_add_u32 s13, s97, 29360128
    s_load_dwordx2 s[24:25], s[32:33], s92 offset:3584 glc
    v_mfma_f32_32x32x16_bf16 v[136:151], v[196:199], v[152:155], 0
    v_mfma_f32_32x32x16_bf16 v[136:151], v[200:203], v[156:159], v[136:151]
    v_mfma_f32_32x32x16_bf16 v[136:151], v[204:207], v[160:163], v[136:151]
    v_mfma_f32_32x32x16_bf16 v[136:151], v[208:211], v[164:167], v[136:151]
    s_lshr_b32 s96, s3, 2
    s_lshl_b32 s97, s96, 15
    s_and_b32 s98, s3, 3
    s_lshl_b32 s99, s98, 5
    s_add_u32 s19, s97, s99
    v_lshrrev_b32 v34, 4, v1
    v_lshlrev_b32 v34, 13, v34
    v_bfe_u32 v9, v1, 2, 2
    v_lshl_add_u32 v34, v9, 7, v34
    v_bfe_u32 v9, v1, 3, 2
    v_lshl_add_u32 v34, v9, 5, v34
    v_and_b32 v9, 3, v1
    v_lshl_add_u32 v34, v9, 3, v34
    v_xor_b32 v34, s19, v34
    s_lshl_b32 s96, s75, 11
    s_add_u32 s19, s96, 13631488
    v_and_b32 v52, 7, v1
    v_lshl_add_u32 v52, v52, 4, s19
    v_lshrrev_b32 v9, 4, v1
    v_lshl_add_u32 v52, v9, 9, v52
    v_and_b32 v53, 15, v1
    v_lshlrev_b32 v53, 9, v53
    v_add_u32 v53, 13631744, v53
    s_lshl_b32 s96, s74, 13
    s_add_u32 s72, s96, 20971520
    s_lshl3_add_u32 s96, s75, s3
    s_lshl_b32 s97, s96, 8
    s_add_u32 s73, s97, s72
    s_lshl3_add_u32 s96, s21, s3
    s_lshl4_add_u32 s97, s96, s12
    s_lshl_b32 s98, s97, 8
    s_add_u32 s86, s98, 12582912
    s_and_b32 s96, s12, 1
    s_lshr_b32 s97, s21, 2
    s_and_b32 s98, s21, 3
    s_lshl_b32 s99, s98, 6
    s_lshl1_add_u32 s98, s97, s99
    s_lshl_b32 s97, s98, 12
    s_lshr_b32 s99, s12, 1
    s_lshl_b32 s98, s99, 6
    s_add_u32 s99, s97, s98
    s_lshl2_add_u32 s97, s96, s99
    s_add_u32 s98, s97, 1048576
    s_add_u32 s87, s98, 1536
    s_lshl3_add_u32 s96, s21, s3
    s_lshl_b32 s97, s96, 15
    s_lshl_b32 s98, s12, 7
    s_add_u32 s70, s97, s98
    s_add_u32 s71, s70, 16384
    v_cvt_pk_bf16_f32 v136, 0, v136
    v_add_f32 v136, 0x358637bd, v136
    v_cvt_pk_bf16_f32 v136, 0, v136
    v_rcp_f32 v136, v136
    s_branch SCHK_23
SPOLL_22:
    s_load_dwordx2 s[24:25], s[32:33], s92 offset:3584 glc
SCHK_23:
    s_add_u32 s5, s5, 1
    s_cmp_ge_u32 s5, 200000
    s_waitcnt lgkmcnt(0)
    s_cbranch_scc1 SDONE_24
    s_cmp_lg_u32 s24, s4
    s_cbranch_scc1 SPOLL_22
    s_cmp_lg_u32 s25, s4
    s_cbranch_scc1 SPOLL_22
SDONE_24:
    buffer_load_dwordx4 v[228:231], v2, s[32:35], s13 offen sc1
    buffer_load_dwordx4 v[232:235], v2, s[32:35], s13 offen offset:1024 sc1
    s_lshl_b32 s19, s3, 6
    v_bfe_u32 v35, v1, 2, 1
    v_lshlrev_b32 v35, 9, v35
    v_bfe_u32 v9, v1, 3, 1
    v_lshl_add_u32 v35, v9, 12, v35
    v_lshrrev_b32 v9, 5, v1
    v_lshl_add_u32 v35, v9, 11, v35
    v_bfe_u32 v9, v1, 2, 2
    v_lshl_add_u32 v35, v9, 6, v35
    v_bfe_u32 v9, v1, 4, 1
    v_lshl_add_u32 v35, v9, 5, v35
    v_and_b32 v9, 3, v1
    v_lshl_add_u32 v35, v9, 3, v35
    v_xor_b32 v35, s19, v35
    v_add_u32 v35, 65536, v35
    s_waitcnt vmcnt(0)
    v_bitop3_b32 v4, v229, v231, s4 bitop3:0x7e
    v_bitop3_b32 v4, v4, v233, s4 bitop3:0xf6
    v_bitop3_b32 v4, v4, v235, s4 bitop3:0xf6
    v_cmp_ne_u32 vcc, 0, v4
    s_cbranch_vccz TOK_26
POLL_27:
    buffer_load_dwordx4 v[228:231], v2, s[32:35], s13 offen sc1
    buffer_load_dwordx4 v[232:235], v2, s[32:35], s13 offen offset:1024 sc1
    s_waitcnt vmcnt(0)
    v_bitop3_b32 v4, v229, v231, s4 bitop3:0x7e
    v_bitop3_b32 v4, v4, v233, s4 bitop3:0xf6
    v_bitop3_b32 v4, v4, v235, s4 bitop3:0xf6
    v_cmp_ne_u32 vcc, 0, v4
    s_cbranch_vccz PDONE_28
    s_add_u32 s5, s5, 1
    s_cmp_lt_u32 s5, 200000
    s_cbranch_scc1 POLL_27
PDONE_28:
TOK_26:
    ds_write2_b32 v5, v228, v230 offset0:0 offset1:1
    ds_write2_b32 v5, v232, v234 offset0:64 offset1:65
    s_waitcnt lgkmcnt(0)
    s_barrier
    ds_read_b128 v[212:215], v84
    ds_read_b128 v[216:219], v84 offset:1024
    ds_read_b128 v[220:223], v84 offset:2048
    ds_read_b128 v[224:227], v84 offset:3072
    s_lshl_b32 s96, s77, 1
    s_lshl3_add_u32 s97, s10, s96
    s_lshl_b32 s98, s97, 5
    s_lshl1_add_u32 s99, s11, s98
    s_add_u32 s96, s99, s76
    s_lshl_b32 s97, s96, 10
    s_add_u32 s13, s97, 8388608
    v_and_b32 v47, 15, v1
    v_lshlrev_b32 v47, 4, v47
    v_bfe_u32 v9, v1, 4, 1
    v_lshl_add_u32 v47, v9, 15, v47
    v_lshrrev_b32 v9, 5, v1
    v_lshl_add_u32 v47, v9, 8, v47
    s_waitcnt lgkmcnt(3)
    v_mfma_f32_32x32x16_bf16 v[120:135], v[212:215], v[152:155], 0
    s_waitcnt lgkmcnt(2)
    v_mfma_f32_32x32x16_bf16 v[120:135], v[216:219], v[156:159], v[120:135]
    s_waitcnt lgkmcnt(1)
    v_mfma_f32_32x32x16_bf16 v[120:135], v[220:223], v[160:163], v[120:135]
    s_waitcnt lgkmcnt(0)
    v_mfma_f32_32x32x16_bf16 v[120:135], v[224:227], v[164:167], v[120:135]
    s_lshr_b32 s96, s3, 1
    s_lshl4_add_u32 s97, s96, s12
    s_lshl_b32 s98, s97, 11
    s_and_b32 s99, s3, 1
    s_lshl_b32 s96, s99, 10
    s_add_u32 s97, s98, s96
    s_add_u32 s18, s97, 131072
    s_lshl_b32 s19, s12, 7
    v_and_b32 v84, 3, v1
    v_lshl_add_u32 v84, v84, 1, s19
    v_lshrrev_b32 v9, 5, v1
    v_lshl_add_u32 v84, v9, 3, v84
    v_bfe_u32 v9, v1, 4, 1
    v_lshl_add_u32 v84, v9, 4, v84
    v_bfe_u32 v9, v1, 2, 2
    v_lshl_add_u32 v84, v9, 5, v84
    global_load_ushort v32, v84, s[78:79]
    v_cvt_pk_bf16_f32 v120, 0, v120
    v_cvt_pk_bf16_f32 v121, 0, v121
    v_cvt_pk_bf16_f32 v122, 0, v122
    v_cvt_pk_bf16_f32 v123, 0, v123
    v_cvt_pk_bf16_f32 v124, 0, v124
    v_cvt_pk_bf16_f32 v125, 0, v125
    v_cvt_pk_bf16_f32 v126, 0, v126
    v_cvt_pk_bf16_f32 v127, 0, v127
    v_pk_mul_f32 v[120:121], v[120:121], v[136:137] op_sel_hi:[1,0]
    v_pk_mul_f32 v[122:123], v[122:123], v[136:137] op_sel_hi:[1,0]
    v_pk_mul_f32 v[124:125], v[124:125], v[136:137] op_sel_hi:[1,0]
    v_pk_mul_f32 v[126:127], v[126:127], v[136:137] op_sel_hi:[1,0]
    v_cvt_pk_bf16_f32 v168, v120, v121
    v_cvt_pk_bf16_f32 v169, v122, v123
    v_cvt_pk_bf16_f32 v170, v124, v125
    v_cvt_pk_bf16_f32 v171, v126, v127
    buffer_store_dwordx4 v[168:171], v47, s[32:35], s13 offen sc1
    v_cvt_pk_bf16_f32 v128, 0, v128
    v_cvt_pk_bf16_f32 v129, 0, v129
    v_cvt_pk_bf16_f32 v130, 0, v130
    v_cvt_pk_bf16_f32 v131, 0, v131
    v_cvt_pk_bf16_f32 v132, 0, v132
    v_cvt_pk_bf16_f32 v133, 0, v133
    v_cvt_pk_bf16_f32 v134, 0, v134
    v_cvt_pk_bf16_f32 v135, 0, v135
    v_pk_mul_f32 v[128:129], v[128:129], v[136:137] op_sel_hi:[1,0]
    v_pk_mul_f32 v[130:131], v[130:131], v[136:137] op_sel_hi:[1,0]
    v_pk_mul_f32 v[132:133], v[132:133], v[136:137] op_sel_hi:[1,0]
    v_pk_mul_f32 v[134:135], v[134:135], v[136:137] op_sel_hi:[1,0]
    v_cvt_pk_bf16_f32 v172, v128, v129
    v_cvt_pk_bf16_f32 v173, v130, v131
    v_cvt_pk_bf16_f32 v174, v132, v133
    v_cvt_pk_bf16_f32 v175, v134, v135
    buffer_store_dwordx4 v[172:175], v47, s[32:35], s13 offen offset:512 sc1
    buffer_load_dwordx4 v[28:31], v2, s[32:35], s18 offen sc1
    v_mov_b32 v236, -1
    v_mov_b32 v237, -1
    v_mov_b32 v238, -1
    v_mov_b32 v239, -1
    s_lshl3_add_u32 s96, s21, s3
    s_lshl4_add_u32 s97, s96, s12
    s_lshl_b32 s98, s97, 8
    s_add_u32 s19, s98, 12582912
    v_lshlrev_b32 v240, 2, v1
    buffer_store_dword v236, v240, s[32:35], s19 offen sc1
    s_lshl_b32 s96, s21, 14
    s_lshl_b32 s97, s12, 9
    s_add_u32 s98, s96, s97
    s_add_u32 s19, s98, 13631488
    v_and_b32 v240, 31, v1
    v_lshlrev_b32 v240, 4, v240
    v_lshrrev_b32 v241, 5, v1
    v_lshl_add_u32 v240, v241, 13, v240
    s_cmp_lg_u32 s3, 5
    s_cbranch_scc1 L_NOPO
    buffer_store_dwordx4 v[236:239], v240, s[32:35], s19 offen sc1
L_NOPO:
    v_bfe_u32 v36, v1, 2, 2
    v_lshlrev_b32 v36, 7, v36
    v_lshrrev_b32 v9, 4, v1
    v_lshl_add_u32 v36, v9, 10, v36
    v_and_b32 v9, 1, v1
    v_lshl_add_u32 v36, v9, 4, v36
    v_bfe_u32 v9, v1, 1, 1
    v_lshl_add_u32 v36, v9, 3, v36
    v_bfe_u32 v9, v1, 3, 2
    v_lshl_add_u32 v36, v9, 5, v36
    s_and_b32 s96, s9, 1
    s_lshl_b32 s97, s96, 2
    s_xor_b32 s98, s3, s97
    s_lshl_b32 s17, s98, 12
    s_lshl_b32 s96, s17, 2
    s_lshr_b32 s97, s95, 4
    s_xor_b32 s14, s96, s97
    v_add_u32 v36, s14, v36
    v_xor_b32 v37, 32, v36
    v_xor_b32 v38, 64, v36
    v_xor_b32 v39, 96, v36
    v_and_b32 v5, 7, v1
    v_lshlrev_b32 v5, 15, v5
    v_bfe_u32 v9, v1, 3, 1
    v_lshl_add_u32 v5, v9, 12, v5
    s_and_b32 s96, s11, 1
    s_lshr_b32 s97, s10, 2
    s_and_b32 s98, s10, 3
    s_lshl_b32 s99, s98, 6
    s_lshl1_add_u32 s98, s97, s99
    s_lshl_b32 s97, s98, 12
    s_lshr_b32 s99, s11, 1
    s_lshl_b32 s98, s99, 6
    s_add_u32 s99, s97, s98
    s_lshl2_add_u32 s97, s96, s99
    s_add_u32 s98, s97, 1048576
    s_add_u32 s15, s98, 1024
    v_lshlrev_b32 v152, 16, v12
    v_and_b32 v153, s6, v12
    v_lshlrev_b32 v154, 16, v13
    v_and_b32 v155, s6, v13
    v_lshlrev_b32 v156, 16, v14
    v_and_b32 v157, s6, v14
    v_lshlrev_b32 v158, 16, v15
    v_and_b32 v159, s6, v15
    v_lshlrev_b32 v160, 16, v16
    v_and_b32 v161, s6, v16
    v_lshlrev_b32 v162, 16, v17
    v_and_b32 v163, s6, v17
    v_lshlrev_b32 v164, 16, v18
    v_and_b32 v165, s6, v18
    v_lshlrev_b32 v166, 16, v19
    v_and_b32 v167, s6, v19
    s_lshl3_add_u32 s96, s21, s3
    s_lshl_b32 s97, s96, 15
    s_add_u32 s19, s97, 8388608
    s_and_b32 s96, s3, 1
    s_lshl_b32 s14, s96, 1
    s_lshr_b32 s96, s3, 1
    s_lshl_b32 s97, s96, 10
    s_add_u32 s16, s97, 159744
    v_bfe_u32 v4, v1, 4, 1
    v_bfe_u32 v9, v1, 2, 1
    v_lshl_add_u32 v4, v9, 1, v4
    v_lshrrev_b32 v7, 5, v1
    v_lshl_add_u32 v7, v7, 0, s14
    v_xor_b32 v4, v4, v7
    v_lshl_add_u32 v4, v4, 2, s16
    v_and_b32 v7, 1, v1
    v_lshlrev_b32 v7, 5, v7
    v_bfe_u32 v9, v1, 3, 2
    v_lshl_add_u32 v7, v9, 6, v7
    v_bfe_u32 v9, v1, 2, 1
    v_lshl_add_u32 v7, v9, 8, v7
    v_bfe_u32 v9, v1, 1, 1
    v_lshl_add_u32 v7, v9, 9, v7
    v_add_u32 v4, v4, v7
    s_waitcnt vmcnt(2)
    s_waitcnt lgkmcnt(0)
    s_barrier
    s_cmp_lg_u32 s3, 0
    s_cbranch_scc1 L_PD
    v_mov_b32 v6, s4
    s_mov_b32 exec_hi, 0
    s_mov_b32 exec_lo, 65535
    buffer_store_dword v6, v5, s[32:35], s15 offen sc1
    s_mov_b64 exec, -1
L_PD:
    s_waitcnt vmcnt(1)
    v_bitop3_b32 v6, v29, v31, s4 bitop3:0x7e
    v_cmp_ne_u32 vcc, 0, v6
    s_cbranch_vccz L_MGOK
POLL_29:
    buffer_load_dwordx4 v[28:31], v2, s[32:35], s18 offen sc1
    s_waitcnt vmcnt(0)
    v_bitop3_b32 v6, v29, v31, s4 bitop3:0x7e
    v_cmp_ne_u32 vcc, 0, v6
    s_cbranch_vccz PDONE_30
    s_add_u32 s5, s5, 1
    s_cmp_lt_u32 s5, 200000
    s_cbranch_scc1 POLL_29
PDONE_30:
L_MGOK:
    ds_write2_b32 v4, v28, v30 offset0:0 offset1:4
    s_waitcnt lgkmcnt(0)
    s_barrier
    s_lshl_b32 s96, s2, 12
    s_lshr_b32 s97, s17, 6
    s_add_u32 s98, s96, s97
    s_add_u32 s99, s98, 1048576
    s_add_u32 s18, s99, 1024
    ds_read_b128 v[192:195], v251 offset:12288
    ds_read_b128 v[196:199], v251 offset:13312
    ds_read_b128 v[200:203], v251 offset:14336
    ds_read_b128 v[204:207], v251 offset:15360
    v_and_b32 v8, 3, v1
    v_lshlrev_b32 v8, 2, v8
    v_lshrrev_b32 v9, 5, v1
    v_lshl_add_u32 v8, v9, 4, v8
    v_bfe_u32 v9, v1, 4, 1
    v_lshl_add_u32 v8, v9, 5, v8
    v_bfe_u32 v9, v1, 2, 2
    v_lshl_add_u32 v8, v9, 6, v8
    v_add_u32 v8, 157184, v8
    s_lshl4_add_u32 s96, s21, s12
    s_lshl_b32 s97, s96, 6
    s_add_u32 s13, s97, 14155776
    v_lshlrev_b32 v10, 1, v1
    v_add_u32 v10, 157440, v10
    v_and_b32 v11, 3, v1
    v_lshlrev_b32 v11, 7, v11
    v_lshrrev_b32 v9, 4, v1
    v_lshl_add_u32 v11, v9, 5, v11
    v_add_u32 v11, 157440, v11
    s_waitcnt lgkmcnt(0)
    s_load_dwordx2 s[24:25], s[32:33], s18 offset:0 glc
    v_pk_add_f32 v[192:193], v[192:193], v[194:195]
    v_add_f32 v28, v192, v193
    v_pk_add_f32 v[196:197], v[196:197], v[198:199]
    v_add_f32 v29, v196, v197
    v_pk_add_f32 v[200:201], v[200:201], v[202:203]
    v_add_f32 v30, v200, v201
    v_pk_add_f32 v[204:205], v[204:205], v[206:207]
    v_add_f32 v31, v204, v205
    v_cvt_pk_bf16_f32 v28, 0, v28
    v_cvt_pk_bf16_f32 v29, 0, v29
    v_cvt_pk_bf16_f32 v30, 0, v30
    v_cvt_pk_bf16_f32 v31, 0, v31
    v_add_f32 v30, 1.0, v30
    v_lshlrev_b32 v32, 16, v32
    v_cvt_pk_bf16_f32 v30, 0, v30
    ds_write_b32 v8, v31
    v_mul_f32 v192, v30, v32
    v_cvt_pk_bf16_f32 v193, 0, v192
    v_sub_f32 v194, v192, v193
    v_add_f32_dpp v192, v192, v192 quad_perm:[1,0,3,2] row_mask:0xf bank_mask:0xf
    s_nop 1
    v_add_f32_dpp v192, v192, v192 quad_perm:[2,3,0,1] row_mask:0xf bank_mask:0xf
    s_nop 1
    v_add_f32_dpp v192, v192, v192 row_half_mirror row_mask:0xf bank_mask:0xf
    s_nop 1
    v_add_f32_dpp v192, v192, v192 row_ror:8 row_mask:0xf bank_mask:0xf
    v_mov_b32 v199, v192
    s_nop 1
    v_permlane16_swap_b32 v192, v199
    v_add_f32 v192, v192, v199
    v_mov_b32 v199, v192
    s_nop 1
    v_permlane32_swap_b32 v192, v199
    v_add_f32 v192, v192, v199
    v_mov_b32_dpp v196, v193 row_shl:1 row_mask:0xf bank_mask:0xf
    v_mov_b32_dpp v197, v194 row_shl:1 row_mask:0xf bank_mask:0xf
    v_mov_b32_dpp v198, v32 row_shl:1 row_mask:0xf bank_mask:0xf
    v_cvt_pk_bf16_f32 v196, v193, v196
    v_cvt_pk_bf16_f32 v197, v194, v197
    v_cvt_pk_bf16_f32 v198, v32, v198
    v_mov_b32 v193, s4
    v_mov_b32 v194, 0
    s_cmp_lg_u32 s3, 2
    s_cbranch_scc1 L_NOUP
    s_mov_b64 exec, 1
    buffer_store_dwordx2 v[192:193], v194, s[32:35], s13 offen sc1
    s_mov_b64 exec, -1
L_NOUP:
    v_mov_b32 v199, 0x3f803f80
    s_mov_b32 exec_lo, 0x55555555
    s_mov_b32 exec_hi, 0x55555555
    ds_write_b32 v10, v199 offset:0
    ds_write_b32 v10, v196 offset:128
    ds_write_b32 v10, v197 offset:256
    ds_write_b32 v10, v198 offset:384
    s_mov_b64 exec, -1
    ds_read_b128 v[184:187], v11
    ds_read_b128 v[188:191], v11 offset:16
    v_mov_b32 v42, v29
    v_mov_b32 v43, v31
    v_mov_b32 v33, v30
    v_mov_b32_dpp v136, v28 row_newbcast:0 row_mask:0xf bank_mask:0xf
    v_mov_b32_dpp v137, v28 row_newbcast:1 row_mask:0xf bank_mask:0xf
    v_mov_b32_dpp v138, v28 row_newbcast:2 row_mask:0xf bank_mask:0xf
    v_mov_b32_dpp v139, v28 row_newbcast:3 row_mask:0xf bank_mask:0xf
    v_mov_b32_dpp v140, v28 row_newbcast:4 row_mask:0xf bank_mask:0xf
    v_mov_b32_dpp v141, v28 row_newbcast:5 row_mask:0xf bank_mask:0xf
    v_mov_b32_dpp v142, v28 row_newbcast:6 row_mask:0xf bank_mask:0xf
    v_mov_b32_dpp v143, v28 row_newbcast:7 row_mask:0xf bank_mask:0xf
    v_mov_b32_dpp v144, v28 row_newbcast:8 row_mask:0xf bank_mask:0xf
    v_mov_b32_dpp v145, v28 row_newbcast:9 row_mask:0xf bank_mask:0xf
    v_mov_b32_dpp v146, v28 row_newbcast:10 row_mask:0xf bank_mask:0xf
    v_mov_b32_dpp v147, v28 row_newbcast:11 row_mask:0xf bank_mask:0xf
    v_mov_b32_dpp v148, v28 row_newbcast:12 row_mask:0xf bank_mask:0xf
    v_mov_b32_dpp v149, v28 row_newbcast:13 row_mask:0xf bank_mask:0xf
    v_mov_b32_dpp v150, v28 row_newbcast:14 row_mask:0xf bank_mask:0xf
    v_mov_b32_dpp v151, v28 row_newbcast:15 row_mask:0xf bank_mask:0xf
    v_mov_b32 v29, v5
    s_branch SCHK_32
SPOLL_31:
    s_load_dwordx2 s[24:25], s[32:33], s18 offset:0 glc
SCHK_32:
    s_add_u32 s5, s5, 1
    s_cmp_ge_u32 s5, 200000
    s_waitcnt lgkmcnt(0)
    s_cbranch_scc1 SDONE_33
    s_cmp_lg_u32 s24, s4
    s_cbranch_scc1 SPOLL_31
    s_cmp_lg_u32 s25, s4
    s_cbranch_scc1 SPOLL_31
SDONE_33:
    s_add_u32 s20, s17, s19
    buffer_load_dwordx4 v[224:227], v2, s[32:35], s20 offen sc1
    ds_read_b64_tr_b16 v[192:193], v36
    ds_read_b64_tr_b16 v[194:195], v36 offset:512
    ds_read_b64_tr_b16 v[196:197], v37
    ds_read_b64_tr_b16 v[198:199], v37 offset:512
    ds_read_b64_tr_b16 v[200:201], v38
    ds_read_b64_tr_b16 v[202:203], v38 offset:512
    ds_read_b64_tr_b16 v[204:205], v39
    ds_read_b64_tr_b16 v[206:207], v39 offset:512
    ds_read_b64_tr_b16 v[208:209], v36 offset:4096
    ds_read_b64_tr_b16 v[210:211], v36 offset:4608
    ds_read_b64_tr_b16 v[212:213], v37 offset:4096
    ds_read_b64_tr_b16 v[214:215], v37 offset:4608
    ds_read_b64_tr_b16 v[216:217], v38 offset:4096
    ds_read_b64_tr_b16 v[218:219], v38 offset:4608
    buffer_load_dwordx4 v[228:231], v2, s[32:35], s20 offen offset:1024 sc1
    buffer_load_dwordx4 v[232:235], v2, s[32:35], s20 offen offset:2048 sc1
    buffer_load_dwordx4 v[236:239], v2, s[32:35], s20 offen offset:3072 sc1
    s_barrier
    s_xor_b32 s96, s17, 4096
    s_add_u32 s20, s96, s19
    buffer_load_dwordx4 v[240:243], v2, s[32:35], s20 offen sc1
    buffer_load_dwordx4 v[244:247], v2, s[32:35], s20 offen offset:1024 sc1
    buffer_load_dwordx4 v[44:47], v2, s[32:35], s20 offen offset:2048 sc1
    buffer_load_dwordx4 v[48:51], v2, s[32:35], s20 offen offset:3072 sc1
    s_lshl_b32 s96, s21, 10
    s_add_u32 s13, s96, 14155776
    v_and_b32 v10, 15, v1
    v_lshlrev_b32 v10, 6, v10
    s_cmp_lt_u32 s3, 4
    s_cbranch_scc1 L_G2P0
    s_setprio 1
L_G2P0:
    s_waitcnt vmcnt(7)
    s_waitcnt lgkmcnt(6)
    v_mfma_f32_16x16x32_bf16 v[120:123], v[192:195], v[224:227], 0
    ds_read_b64_tr_b16 v[220:221], v39 offset:4096
    ds_read_b64_tr_b16 v[222:223], v39 offset:4608
    v_mfma_f32_16x16x32_bf16 v[124:127], v[196:199], v[224:227], 0
    ds_read_b64_tr_b16 v[192:193], v36 offset:8192
    ds_read_b64_tr_b16 v[194:195], v36 offset:8704
    v_mfma_f32_16x16x32_bf16 v[128:131], v[200:203], v[224:227], 0
    ds_read_b64_tr_b16 v[196:197], v37 offset:8192
    ds_read_b64_tr_b16 v[198:199], v37 offset:8704
    v_mfma_f32_16x16x32_bf16 v[132:135], v[204:207], v[224:227], 0
    ds_read_b64_tr_b16 v[200:201], v38 offset:8192
    ds_read_b64_tr_b16 v[202:203], v38 offset:8704
    s_xor_b32 s96, s17, 8192
    s_add_u32 s20, s96, s19
    buffer_load_dwordx4 v[224:227], v2, s[32:35], s20 offen sc1
    s_waitcnt vmcnt(7)
    s_waitcnt lgkmcnt(6)
    v_mfma_f32_16x16x32_bf16 v[120:123], v[208:211], v[228:231], v[120:123]
    ds_read_b64_tr_b16 v[204:205], v39 offset:8192
    ds_read_b64_tr_b16 v[206:207], v39 offset:8704
    v_mfma_f32_16x16x32_bf16 v[124:127], v[212:215], v[228:231], v[124:127]
    ds_read_b64_tr_b16 v[208:209], v36 offset:12288
    ds_read_b64_tr_b16 v[210:211], v36 offset:12800
    v_xor_b32 v36, 16384, v36
    v_mfma_f32_16x16x32_bf16 v[128:131], v[216:219], v[228:231], v[128:131]
    ds_read_b64_tr_b16 v[212:213], v37 offset:12288
    ds_read_b64_tr_b16 v[214:215], v37 offset:12800
    v_xor_b32 v37, 16384, v37
    v_mfma_f32_16x16x32_bf16 v[132:135], v[220:223], v[228:231], v[132:135]
    ds_read_b64_tr_b16 v[216:217], v38 offset:12288
    ds_read_b64_tr_b16 v[218:219], v38 offset:12800
    v_xor_b32 v38, 16384, v38
    buffer_load_dwordx4 v[228:231], v2, s[32:35], s20 offen offset:1024 sc1
    s_waitcnt vmcnt(7)
    s_waitcnt lgkmcnt(6)
    v_mfma_f32_16x16x32_bf16 v[120:123], v[192:195], v[232:235], v[120:123]
    ds_read_b64_tr_b16 v[220:221], v39 offset:12288
    ds_read_b64_tr_b16 v[222:223], v39 offset:12800
    v_xor_b32 v39, 16384, v39
    v_mfma_f32_16x16x32_bf16 v[124:127], v[196:199], v[232:235], v[124:127]
    ds_read_b64_tr_b16 v[192:193], v36
    ds_read_b64_tr_b16 v[194:195], v36 offset:512
    v_mfma_f32_16x16x32_bf16 v[128:131], v[200:203], v[232:235], v[128:131]
    ds_read_b64_tr_b16 v[196:197], v37
    ds_read_b64_tr_b16 v[198:199], v37 offset:512
    v_mfma_f32_16x16x32_bf16 v[132:135], v[204:207], v[232:235], v[132:135]
    ds_read_b64_tr_b16 v[200:201], v38
    ds_read_b64_tr_b16 v[202:203], v38 offset:512
    buffer_load_dwordx4 v[232:235], v2, s[32:35], s20 offen offset:2048 sc1
    s_waitcnt vmcnt(7)
    s_waitcnt lgkmcnt(6)
    v_mfma_f32_16x16x32_bf16 v[120:123], v[208:211], v[236:239], v[120:123]
    ds_read_b64_tr_b16 v[204:205], v39
    ds_read_b64_tr_b16 v[206:207], v39 offset:512
    v_mfma_f32_16x16x32_bf16 v[124:127], v[212:215], v[236:239], v[124:127]
    ds_read_b64_tr_b16 v[208:209], v36 offset:4096
    ds_read_b64_tr_b16 v[210:211], v36 offset:4608
    v_mfma_f32_16x16x32_bf16 v[128:131], v[216:219], v[236:239], v[128:131]
    ds_read_b64_tr_b16 v[212:213], v37 offset:4096
    ds_read_b64_tr_b16 v[214:215], v37 offset:4608
    v_mfma_f32_16x16x32_bf16 v[132:135], v[220:223], v[236:239], v[132:135]
    ds_read_b64_tr_b16 v[216:217], v38 offset:4096
    ds_read_b64_tr_b16 v[218:219], v38 offset:4608
    buffer_load_dwordx4 v[236:239], v2, s[32:35], s20 offen offset:3072 sc1
    s_waitcnt vmcnt(7)
    s_waitcnt lgkmcnt(6)
    v_mfma_f32_16x16x32_bf16 v[120:123], v[192:195], v[240:243], v[120:123]
    ds_read_b64_tr_b16 v[220:221], v39 offset:4096
    ds_read_b64_tr_b16 v[222:223], v39 offset:4608
    v_mfma_f32_16x16x32_bf16 v[124:127], v[196:199], v[240:243], v[124:127]
    ds_read_b64_tr_b16 v[192:193], v36 offset:8192
    ds_read_b64_tr_b16 v[194:195], v36 offset:8704
    v_mfma_f32_16x16x32_bf16 v[128:131], v[200:203], v[240:243], v[128:131]
    ds_read_b64_tr_b16 v[196:197], v37 offset:8192
    ds_read_b64_tr_b16 v[198:199], v37 offset:8704
    v_mfma_f32_16x16x32_bf16 v[132:135], v[204:207], v[240:243], v[132:135]
    ds_read_b64_tr_b16 v[200:201], v38 offset:8192
    ds_read_b64_tr_b16 v[202:203], v38 offset:8704
    s_xor_b32 s96, s17, 12288
    s_add_u32 s20, s96, s19
    buffer_load_dwordx4 v[240:243], v2, s[32:35], s20 offen sc1
    s_waitcnt vmcnt(7)
    s_waitcnt lgkmcnt(6)
    v_mfma_f32_16x16x32_bf16 v[120:123], v[208:211], v[244:247], v[120:123]
    ds_read_b64_tr_b16 v[204:205], v39 offset:8192
    ds_read_b64_tr_b16 v[206:207], v39 offset:8704
    v_mfma_f32_16x16x32_bf16 v[124:127], v[212:215], v[244:247], v[124:127]
    ds_read_b64_tr_b16 v[208:209], v36 offset:12288
    ds_read_b64_tr_b16 v[210:211], v36 offset:12800
    v_xor_b32 v36, 49152, v36
    v_mfma_f32_16x16x32_bf16 v[128:131], v[216:219], v[244:247], v[128:131]
    ds_read_b64_tr_b16 v[212:213], v37 offset:12288
    ds_read_b64_tr_b16 v[214:215], v37 offset:12800
    v_xor_b32 v37, 49152, v37
    v_mfma_f32_16x16x32_bf16 v[132:135], v[220:223], v[244:247], v[132:135]
    ds_read_b64_tr_b16 v[216:217], v38 offset:12288
    ds_read_b64_tr_b16 v[218:219], v38 offset:12800
    v_xor_b32 v38, 49152, v38
    buffer_load_dwordx4 v[244:247], v2, s[32:35], s20 offen offset:1024 sc1
    s_waitcnt vmcnt(7)
    s_waitcnt lgkmcnt(6)
    v_mfma_f32_16x16x32_bf16 v[120:123], v[192:195], v[44:47], v[120:123]
    ds_read_b64_tr_b16 v[220:221], v39 offset:12288
    ds_read_b64_tr_b16 v[222:223], v39 offset:12800
    v_xor_b32 v39, 49152, v39
    v_mfma_f32_16x16x32_bf16 v[124:127], v[196:199], v[44:47], v[124:127]
    ds_read_b64_tr_b16 v[192:193], v36
    ds_read_b64_tr_b16 v[194:195], v36 offset:512
    v_mfma_f32_16x16x32_bf16 v[128:131], v[200:203], v[44:47], v[128:131]
    ds_read_b64_tr_b16 v[196:197], v37
    ds_read_b64_tr_b16 v[198:199], v37 offset:512
    v_mfma_f32_16x16x32_bf16 v[132:135], v[204:207], v[44:47], v[132:135]
    ds_read_b64_tr_b16 v[200:201], v38
    ds_read_b64_tr_b16 v[202:203], v38 offset:512
    buffer_load_dwordx4 v[44:47], v2, s[32:35], s20 offen offset:2048 sc1
    s_waitcnt vmcnt(7)
    s_waitcnt lgkmcnt(6)
    v_mfma_f32_16x16x32_bf16 v[120:123], v[208:211], v[48:51], v[120:123]
    ds_read_b64_tr_b16 v[204:205], v39
    ds_read_b64_tr_b16 v[206:207], v39 offset:512
    v_mfma_f32_16x16x32_bf16 v[124:127], v[212:215], v[48:51], v[124:127]
    ds_read_b64_tr_b16 v[208:209], v36 offset:4096
    ds_read_b64_tr_b16 v[210:211], v36 offset:4608
    v_mfma_f32_16x16x32_bf16 v[128:131], v[216:219], v[48:51], v[128:131]
    ds_read_b64_tr_b16 v[212:213], v37 offset:4096
    ds_read_b64_tr_b16 v[214:215], v37 offset:4608
    v_mfma_f32_16x16x32_bf16 v[132:135], v[220:223], v[48:51], v[132:135]
    ds_read_b64_tr_b16 v[216:217], v38 offset:4096
    ds_read_b64_tr_b16 v[218:219], v38 offset:4608
    buffer_load_dwordx4 v[48:51], v2, s[32:35], s20 offen offset:3072 sc1
    s_waitcnt vmcnt(7)
    s_waitcnt lgkmcnt(6)
    v_mfma_f32_16x16x32_bf16 v[120:123], v[192:195], v[224:227], v[120:123]
    ds_read_b64_tr_b16 v[220:221], v39 offset:4096
    ds_read_b64_tr_b16 v[222:223], v39 offset:4608
    v_mfma_f32_16x16x32_bf16 v[124:127], v[196:199], v[224:227], v[124:127]
    ds_read_b64_tr_b16 v[192:193], v36 offset:8192
L_PAD8:
    s_cbranch_execz L_RET8
    ds_read_b64_tr_b16 v[194:195], v36 offset:8704
    v_mfma_f32_16x16x32_bf16 v[128:131], v[200:203], v[224:227], v[128:131]
    ds_read_b64_tr_b16 v[196:197], v37 offset:8192
    ds_read_b64_tr_b16 v[198:199], v37 offset:8704
    v_mfma_f32_16x16x32_bf16 v[132:135], v[204:207], v[224:227], v[132:135]
    ds_read_b64_tr_b16 v[200:201], v38 offset:8192
    ds_read_b64_tr_b16 v[202:203], v38 offset:8704
    s_xor_b32 s96, s17, 16384
    s_add_u32 s20, s96, s19
    buffer_load_dwordx4 v[224:227], v2, s[32:35], s20 offen sc1
    s_waitcnt vmcnt(7)
    s_waitcnt lgkmcnt(6)
    v_mfma_f32_16x16x32_bf16 v[120:123], v[208:211], v[228:231], v[120:123]
    ds_read_b64_tr_b16 v[204:205], v39 offset:8192
    ds_read_b64_tr_b16 v[206:207], v39 offset:8704
    v_mfma_f32_16x16x32_bf16 v[124:127], v[212:215], v[228:231], v[124:127]
    ds_read_b64_tr_b16 v[208:209], v36 offset:12288
    ds_read_b64_tr_b16 v[210:211], v36 offset:12800
    v_xor_b32 v36, 16384, v36
    v_mfma_f32_16x16x32_bf16 v[128:131], v[216:219], v[228:231], v[128:131]
    ds_read_b64_tr_b16 v[212:213], v37 offset:12288
    ds_read_b64_tr_b16 v[214:215], v37 offset:12800
    v_xor_b32 v37, 16384, v37
    v_mfma_f32_16x16x32_bf16 v[132:135], v[220:223], v[228:231], v[132:135]
    ds_read_b64_tr_b16 v[216:217], v38 offset:12288
    ds_read_b64_tr_b16 v[218:219], v38 offset:12800
    v_xor_b32 v38, 16384, v38
    buffer_load_dwordx4 v[228:231], v2, s[32:35], s20 offen offset:1024 sc1
    s_waitcnt vmcnt(7)
    s_waitcnt lgkmcnt(6)
    v_mfma_f32_16x16x32_bf16 v[120:123], v[192:195], v[232:235], v[120:123]
    ds_read_b64_tr_b16 v[220:221], v39 offset:12288
    ds_read_b64_tr_b16 v[222:223], v39 offset:12800
    v_xor_b32 v39, 16384, v39
    v_mfma_f32_16x16x32_bf16 v[124:127], v[196:199], v[232:235], v[124:127]
    ds_read_b64_tr_b16 v[192:193], v36
    ds_read_b64_tr_b16 v[194:195], v36 offset:512
    v_mfma_f32_16x16x32_bf16 v[128:131], v[200:203], v[232:235], v[128:131]
    ds_read_b64_tr_b16 v[196:197], v37
    ds_read_b64_tr_b16 v[198:199], v37 offset:512
    v_mfma_f32_16x16x32_bf16 v[132:135], v[204:207], v[232:235], v[132:135]
    ds_read_b64_tr_b16 v[200:201], v38
    ds_read_b64_tr_b16 v[202:203], v38 offset:512
    buffer_load_dwordx4 v[232:235], v2, s[32:35], s20 offen offset:2048 sc1
    s_waitcnt vmcnt(7)
    s_waitcnt lgkmcnt(6)
    v_mfma_f32_16x16x32_bf16 v[120:123], v[208:211], v[236:239], v[120:123]
    ds_read_b64_tr_b16 v[204:205], v39
    ds_read_b64_tr_b16 v[206:207], v39 offset:512
    v_mfma_f32_16x16x32_bf16 v[124:127], v[212:215], v[236:239], v[124:127]
    ds_read_b64_tr_b16 v[208:209], v36 offset:4096
    ds_read_b64_tr_b16 v[210:211], v36 offset:4608
    v_mfma_f32_16x16x32_bf16 v[128:131], v[216:219], v[236:239], v[128:131]
    ds_read_b64_tr_b16 v[212:213], v37 offset:4096
    ds_read_b64_tr_b16 v[214:215], v37 offset:4608
    v_mfma_f32_16x16x32_bf16 v[132:135], v[220:223], v[236:239], v[132:135]
    ds_read_b64_tr_b16 v[216:217], v38 offset:4096
    ds_read_b64_tr_b16 v[218:219], v38 offset:4608
    buffer_load_dwordx4 v[236:239], v2, s[32:35], s20 offen offset:3072 sc1
    s_waitcnt vmcnt(7)
    s_waitcnt lgkmcnt(6)
    v_mfma_f32_16x16x32_bf16 v[120:123], v[192:195], v[240:243], v[120:123]
    ds_read_b64_tr_b16 v[220:221], v39 offset:4096
    ds_read_b64_tr_b16 v[222:223], v39 offset:4608
    v_mfma_f32_16x16x32_bf16 v[124:127], v[196:199], v[240:243], v[124:127]
    ds_read_b64_tr_b16 v[192:193], v36 offset:8192
    ds_read_b64_tr_b16 v[194:195], v36 offset:8704
    v_mfma_f32_16x16x32_bf16 v[128:131], v[200:203], v[240:243], v[128:131]
    ds_read_b64_tr_b16 v[196:197], v37 offset:8192
    ds_read_b64_tr_b16 v[198:199], v37 offset:8704
    v_mfma_f32_16x16x32_bf16 v[132:135], v[204:207], v[240:243], v[132:135]
    ds_read_b64_tr_b16 v[200:201], v38 offset:8192
    ds_read_b64_tr_b16 v[202:203], v38 offset:8704
    s_xor_b32 s96, s17, 20480
    s_add_u32 s20, s96, s19
    buffer_load_dwordx4 v[240:243], v2, s[32:35], s20 offen sc1
    s_waitcnt vmcnt(7)
    s_waitcnt lgkmcnt(6)
    v_mfma_f32_16x16x32_bf16 v[120:123], v[208:211], v[244:247], v[120:123]
    ds_read_b64_tr_b16 v[204:205], v39 offset:8192
    ds_read_b64_tr_b16 v[206:207], v39 offset:8704
    v_mfma_f32_16x16x32_bf16 v[124:127], v[212:215], v[244:247], v[124:127]
    ds_read_b64_tr_b16 v[208:209], v36 offset:12288
    ds_read_b64_tr_b16 v[210:211], v36 offset:12800
    v_xor_b32 v36, 114688, v36
    v_mfma_f32_16x16x32_bf16 v[128:131], v[216:219], v[244:247], v[128:131]
    ds_read_b64_tr_b16 v[212:213], v37 offset:12288
    ds_read_b64_tr_b16 v[214:215], v37 offset:12800
    v_xor_b32 v37, 114688, v37
    v_mfma_f32_16x16x32_bf16 v[132:135], v[220:223], v[244:247], v[132:135]
    ds_read_b64_tr_b16 v[216:217], v38 offset:12288
    ds_read_b64_tr_b16 v[218:219], v38 offset:12800
    v_xor_b32 v38, 114688, v38
    buffer_load_dwordx4 v[244:247], v2, s[32:35], s20 offen offset:1024 sc1
    s_waitcnt vmcnt(7)
    s_waitcnt lgkmcnt(6)
    v_mfma_f32_16x16x32_bf16 v[120:123], v[192:195], v[44:47], v[120:123]
    ds_read_b64_tr_b16 v[220:221], v39 offset:12288
    ds_read_b64_tr_b16 v[222:223], v39 offset:12800
    v_xor_b32 v39, 114688, v39
    v_mfma_f32_16x16x32_bf16 v[124:127], v[196:199], v[44:47], v[124:127]
    ds_read_b64_tr_b16 v[192:193], v36
    ds_read_b64_tr_b16 v[194:195], v36 offset:512
    v_mfma_f32_16x16x32_bf16 v[128:131], v[200:203], v[44:47], v[128:131]
    ds_read_b64_tr_b16 v[196:197], v37
    ds_read_b64_tr_b16 v[198:199], v37 offset:512
    v_mfma_f32_16x16x32_bf16 v[132:135], v[204:207], v[44:47], v[132:135]
    ds_read_b64_tr_b16 v[200:201], v38
    ds_read_b64_tr_b16 v[202:203], v38 offset:512
    buffer_load_dwordx4 v[44:47], v2, s[32:35], s20 offen offset:2048 sc1
    s_waitcnt vmcnt(7)
    s_waitcnt lgkmcnt(6)
    v_mfma_f32_16x16x32_bf16 v[120:123], v[208:211], v[48:51], v[120:123]
    ds_read_b64_tr_b16 v[204:205], v39
    ds_read_b64_tr_b16 v[206:207], v39 offset:512
    v_mfma_f32_16x16x32_bf16 v[124:127], v[212:215], v[48:51], v[124:127]
    ds_read_b64_tr_b16 v[208:209], v36 offset:4096
    ds_read_b64_tr_b16 v[210:211], v36 offset:4608
    v_mfma_f32_16x16x32_bf16 v[128:131], v[216:219], v[48:51], v[128:131]
    ds_read_b64_tr_b16 v[212:213], v37 offset:4096
    ds_read_b64_tr_b16 v[214:215], v37 offset:4608
    v_mfma_f32_16x16x32_bf16 v[132:135], v[220:223], v[48:51], v[132:135]
    ds_read_b64_tr_b16 v[216:217], v38 offset:4096
    ds_read_b64_tr_b16 v[218:219], v38 offset:4608
    buffer_load_dwordx4 v[48:51], v2, s[32:35], s20 offen offset:3072 sc1
    s_waitcnt vmcnt(7)
    s_waitcnt lgkmcnt(6)
    v_mfma_f32_16x16x32_bf16 v[120:123], v[192:195], v[224:227], v[120:123]
    ds_read_b64_tr_b16 v[220:221], v39 offset:4096
    ds_read_b64_tr_b16 v[222:223], v39 offset:4608
    v_mfma_f32_16x16x32_bf16 v[124:127], v[196:199], v[224:227], v[124:127]
    ds_read_b64_tr_b16 v[192:193], v36 offset:8192
    ds_read_b64_tr_b16 v[194:195], v36 offset:8704
    v_mfma_f32_16x16x32_bf16 v[128:131], v[200:203], v[224:227], v[128:131]
    ds_read_b64_tr_b16 v[196:197], v37 offset:8192
    ds_read_b64_tr_b16 v[198:199], v37 offset:8704
    v_mfma_f32_16x16x32_bf16 v[132:135], v[204:207], v[224:227], v[132:135]
    ds_read_b64_tr_b16 v[200:201], v38 offset:8192
    ds_read_b64_tr_b16 v[202:203], v38 offset:8704
    s_xor_b32 s96, s17, 24576
    s_add_u32 s20, s96, s19
    buffer_load_dwordx4 v[224:227], v2, s[32:35], s20 offen sc1
    s_waitcnt vmcnt(7)
    s_waitcnt lgkmcnt(6)
    v_mfma_f32_16x16x32_bf16 v[120:123], v[208:211], v[228:231], v[120:123]
    ds_read_b64_tr_b16 v[204:205], v39 offset:8192
    ds_read_b64_tr_b16 v[206:207], v39 offset:8704
    v_mfma_f32_16x16x32_bf16 v[124:127], v[212:215], v[228:231], v[124:127]
    ds_read_b64_tr_b16 v[208:209], v36 offset:12288
    ds_read_b64_tr_b16 v[210:211], v36 offset:12800
    v_xor_b32 v36, 16384, v36
    v_mfma_f32_16x16x32_bf16 v[128:131], v[216:219], v[228:231], v[128:131]
    ds_read_b64_tr_b16 v[212:213], v37 offset:12288
    ds_read_b64_tr_b16 v[214:215], v37 offset:12800
    v_xor_b32 v37, 16384, v37
    v_mfma_f32_16x16x32_bf16 v[132:135], v[220:223], v[228:231], v[132:135]
    ds_read_b64_tr_b16 v[216:217], v38 offset:12288
    ds_read_b64_tr_b16 v[218:219], v38 offset:12800
    v_xor_b32 v38, 16384, v38
    buffer_load_dwordx4 v[228:231], v2, s[32:35], s20 offen offset:1024 sc1
    s_waitcnt vmcnt(7)
    s_waitcnt lgkmcnt(6)
    v_mfma_f32_16x16x32_bf16 v[120:123], v[192:195], v[232:235], v[120:123]
    ds_read_b64_tr_b16 v[220:221], v39 offset:12288
    ds_read_b64_tr_b16 v[222:223], v39 offset:12800
    v_xor_b32 v39, 16384, v39
    v_mfma_f32_16x16x32_bf16 v[124:127], v[196:199], v[232:235], v[124:127]
    ds_read_b64_tr_b16 v[192:193], v36
    ds_read_b64_tr_b16 v[194:195], v36 offset:512
    v_mfma_f32_16x16x32_bf16 v[128:131], v[200:203], v[232:235], v[128:131]
    ds_read_b64_tr_b16 v[196:197], v37
    ds_read_b64_tr_b16 v[198:199], v37 offset:512
    v_mfma_f32_16x16x32_bf16 v[132:135], v[204:207], v[232:235], v[132:135]
    ds_read_b64_tr_b16 v[200:201], v38
    ds_read_b64_tr_b16 v[202:203], v38 offset:512
    buffer_load_dwordx4 v[232:235], v2, s[32:35], s20 offen offset:2048 sc1
    s_waitcnt vmcnt(7)
    s_waitcnt lgkmcnt(6)
    v_mfma_f32_16x16x32_bf16 v[120:123], v[208:211], v[236:239], v[120:123]
    ds_read_b64_tr_b16 v[204:205], v39
    ds_read_b64_tr_b16 v[206:207], v39 offset:512
    v_mfma_f32_16x16x32_bf16 v[124:127], v[212:215], v[236:239], v[124:127]
    ds_read_b64_tr_b16 v[208:209], v36 offset:4096
    ds_read_b64_tr_b16 v[210:211], v36 offset:4608
    v_mfma_f32_16x16x32_bf16 v[128:131], v[216:219], v[236:239], v[128:131]
    ds_read_b64_tr_b16 v[212:213], v37 offset:4096
    ds_read_b64_tr_b16 v[214:215], v37 offset:4608
    v_mfma_f32_16x16x32_bf16 v[132:135], v[220:223], v[236:239], v[132:135]
    ds_read_b64_tr_b16 v[216:217], v38 offset:4096
    ds_read_b64_tr_b16 v[218:219], v38 offset:4608
    buffer_load_dwordx4 v[236:239], v2, s[32:35], s20 offen offset:3072 sc1
    s_waitcnt vmcnt(7)
    s_waitcnt lgkmcnt(6)
    v_mfma_f32_16x16x32_bf16 v[120:123], v[192:195], v[240:243], v[120:123]
    ds_read_b64_tr_b16 v[220:221], v39 offset:4096
    ds_read_b64_tr_b16 v[222:223], v39 offset:4608
    v_mfma_f32_16x16x32_bf16 v[124:127], v[196:199], v[240:243], v[124:127]
    ds_read_b64_tr_b16 v[192:193], v36 offset:8192
    ds_read_b64_tr_b16 v[194:195], v36 offset:8704
    v_mfma_f32_16x16x32_bf16 v[128:131], v[200:203], v[240:243], v[128:131]
    ds_read_b64_tr_b16 v[196:197], v37 offset:8192
    ds_read_b64_tr_b16 v[198:199], v37 offset:8704
    v_mfma_f32_16x16x32_bf16 v[132:135], v[204:207], v[240:243], v[132:135]
    ds_read_b64_tr_b16 v[200:201], v38 offset:8192
    ds_read_b64_tr_b16 v[202:203], v38 offset:8704
    s_xor_b32 s96, s17, 28672
    s_add_u32 s20, s96, s19
    buffer_load_dwordx4 v[240:243], v2, s[32:35], s20 offen sc1
    s_waitcnt vmcnt(7)
    s_waitcnt lgkmcnt(6)
    v_mfma_f32_16x16x32_bf16 v[120:123], v[208:211], v[244:247], v[120:123]
    ds_read_b64_tr_b16 v[204:205], v39 offset:8192
    ds_read_b64_tr_b16 v[206:207], v39 offset:8704
    v_mfma_f32_16x16x32_bf16 v[124:127], v[212:215], v[244:247], v[124:127]
    ds_read_b64_tr_b16 v[208:209], v36 offset:12288
    ds_read_b64_tr_b16 v[210:211], v36 offset:12800
    v_xor_b32 v36, 49152, v36
    v_mfma_f32_16x16x32_bf16 v[128:131], v[216:219], v[244:247], v[128:131]
    ds_read_b64_tr_b16 v[212:213], v37 offset:12288
    ds_read_b64_tr_b16 v[214:215], v37 offset:12800
    v_xor_b32 v37, 49152, v37
    v_mfma_f32_16x16x32_bf16 v[132:135], v[220:223], v[244:247], v[132:135]
    ds_read_b64_tr_b16 v[216:217], v38 offset:12288
    ds_read_b64_tr_b16 v[218:219], v38 offset:12800
    v_xor_b32 v38, 49152, v38
    buffer_load_dwordx4 v[244:247], v2, s[32:35], s20 offen offset:1024 sc1
    s_cmp_lt_u32 s3, 4
    s_cbranch_scc1 L_G2P22
    s_setprio 0
L_G2P22:
    s_waitcnt vmcnt(7)
    s_waitcnt lgkmcnt(6)
    v_mfma_f32_16x16x32_bf16 v[120:123], v[192:195], v[44:47], v[120:123]
    ds_read_b64_tr_b16 v[220:221], v39 offset:12288
    ds_read_b64_tr_b16 v[222:223], v39 offset:12800
    v_xor_b32 v39, 49152, v39
    v_mfma_f32_16x16x32_bf16 v[124:127], v[196:199], v[44:47], v[124:127]
    ds_read_b64_tr_b16 v[192:193], v36
    ds_read_b64_tr_b16 v[194:195], v36 offset:512
    v_mfma_f32_16x16x32_bf16 v[128:131], v[200:203], v[44:47], v[128:131]
    ds_read_b64_tr_b16 v[196:197], v37
    ds_read_b64_tr_b16 v[198:199], v37 offset:512
    v_mfma_f32_16x16x32_bf16 v[132:135], v[204:207], v[44:47], v[132:135]
    ds_read_b64_tr_b16 v[200:201], v38
    ds_read_b64_tr_b16 v[202:203], v38 offset:512
    buffer_load_dwordx4 v[44:47], v2, s[32:35], s20 offen offset:2048 sc1
    s_waitcnt vmcnt(7)
    s_waitcnt lgkmcnt(6)
    v_mfma_f32_16x16x32_bf16 v[120:123], v[208:211], v[48:51], v[120:123]
    ds_read_b64_tr_b16 v[204:205], v39
    ds_read_b64_tr_b16 v[206:207], v39 offset:512
    v_mfma_f32_16x16x32_bf16 v[124:127], v[212:215], v[48:51], v[124:127]
    ds_read_b64_tr_b16 v[208:209], v36 offset:4096
    ds_read_b64_tr_b16 v[210:211], v36 offset:4608
    v_mfma_f32_16x16x32_bf16 v[128:131], v[216:219], v[48:51], v[128:131]
    ds_read_b64_tr_b16 v[212:213], v37 offset:4096
    ds_read_b64_tr_b16 v[214:215], v37 offset:4608
    v_mfma_f32_16x16x32_bf16 v[132:135], v[220:223], v[48:51], v[132:135]
    ds_read_b64_tr_b16 v[216:217], v38 offset:4096
    ds_read_b64_tr_b16 v[218:219], v38 offset:4608
    buffer_load_dwordx4 v[48:51], v2, s[32:35], s20 offen offset:3072 sc1
    buffer_load_dwordx2 v[40:41], v10, s[32:35], s13 offen sc1
    s_waitcnt vmcnt(8)
    s_waitcnt lgkmcnt(6)
    v_mfma_f32_16x16x32_bf16 v[120:123], v[192:195], v[224:227], v[120:123]
    ds_read_b64_tr_b16 v[220:221], v39 offset:4096
    ds_read_b64_tr_b16 v[222:223], v39 offset:4608
    v_mfma_f32_16x16x32_bf16 v[124:127], v[196:199], v[224:227], v[124:127]
    ds_read_b64_tr_b16 v[192:193], v36 offset:8192
    ds_read_b64_tr_b16 v[194:195], v36 offset:8704
    v_mfma_f32_16x16x32_bf16 v[128:131], v[200:203], v[224:227], v[128:131]
    ds_read_b64_tr_b16 v[196:197], v37 offset:8192
    ds_read_b64_tr_b16 v[198:199], v37 offset:8704
    v_mfma_f32_16x16x32_bf16 v[132:135], v[204:207], v[224:227], v[132:135]
    ds_read_b64_tr_b16 v[200:201], v38 offset:8192
    ds_read_b64_tr_b16 v[202:203], v38 offset:8704
    s_waitcnt vmcnt(7)
    s_waitcnt lgkmcnt(6)
    v_mfma_f32_16x16x32_bf16 v[120:123], v[208:211], v[228:231], v[120:123]
    ds_read_b64_tr_b16 v[204:205], v39 offset:8192
    ds_read_b64_tr_b16 v[206:207], v39 offset:8704
    v_mfma_f32_16x16x32_bf16 v[124:127], v[212:215], v[228:231], v[124:127]
    ds_read_b64_tr_b16 v[208:209], v36 offset:12288
    ds_read_b64_tr_b16 v[210:211], v36 offset:12800
    v_xor_b32 v36, 16384, v36
    v_mfma_f32_16x16x32_bf16 v[128:131], v[216:219], v[228:231], v[128:131]
    ds_read_b64_tr_b16 v[212:213], v37 offset:12288
    ds_read_b64_tr_b16 v[214:215], v37 offset:12800
    v_xor_b32 v37, 16384, v37
    v_mfma_f32_16x16x32_bf16 v[132:135], v[220:223], v[228:231], v[132:135]
    ds_read_b64_tr_b16 v[216:217], v38 offset:12288
    ds_read_b64_tr_b16 v[218:219], v38 offset:12800
    v_xor_b32 v38, 16384, v38
    s_waitcnt vmcnt(6)
    s_waitcnt lgkmcnt(6)
    v_mfma_f32_16x16x32_bf16 v[120:123], v[192:195], v[232:235], v[120:123]
    ds_read_b64_tr_b16 v[220:221], v39 offset:12288
    ds_read_b64_tr_b16 v[222:223], v39 offset:12800
    v_xor_b32 v39, 16384, v39
    v_mfma_f32_16x16x32_bf16 v[124:127], v[196:199], v[232:235], v[124:127]
    ds_read_b64_tr_b16 v[192:193], v36
    ds_read_b64_tr_b16 v[194:195], v36 offset:512
    v_mfma_f32_16x16x32_bf16 v[128:131], v[200:203], v[232:235], v[128:131]
    ds_read_b64_tr_b16 v[196:197], v37
    ds_read_b64_tr_b16 v[198:199], v37 offset:512
    v_mfma_f32_16x16x32_bf16 v[132:135], v[204:207], v[232:235], v[132:135]
    ds_read_b64_tr_b16 v[200:201], v38
    ds_read_b64_tr_b16 v[202:203], v38 offset:512
    s_waitcnt vmcnt(5)
    s_waitcnt lgkmcnt(6)
    v_mfma_f32_16x16x32_bf16 v[120:123], v[208:211], v[236:239], v[120:123]
    ds_read_b64_tr_b16 v[204:205], v39
    ds_read_b64_tr_b16 v[206:207], v39 offset:512
    v_mfma_f32_16x16x32_bf16 v[124:127], v[212:215], v[236:239], v[124:127]
    ds_read_b64_tr_b16 v[208:209], v36 offset:4096
    ds_read_b64_tr_b16 v[210:211], v36 offset:4608
    v_mfma_f32_16x16x32_bf16 v[128:131], v[216:219], v[236:239], v[128:131]
    ds_read_b64_tr_b16 v[212:213], v37 offset:4096
    ds_read_b64_tr_b16 v[214:215], v37 offset:4608
    v_mfma_f32_16x16x32_bf16 v[132:135], v[220:223], v[236:239], v[132:135]
    ds_read_b64_tr_b16 v[216:217], v38 offset:4096
    ds_read_b64_tr_b16 v[218:219], v38 offset:4608
    s_add_u32 s82, s80, 114688
    buffer_load_dwordx4 v[72:75], v27, s[52:55], s82 offen nt
    s_add_u32 s82, s80, 172032
    buffer_load_dwordx4 v[76:79], v27, s[52:55], s82 offen nt
    s_mov_b32 s82, s80
    buffer_load_dwordx4 v[80:83], v27, s[56:59], s82 offen nt
    s_waitcnt vmcnt(7)
    s_waitcnt lgkmcnt(6)
    v_mfma_f32_16x16x32_bf16 v[120:123], v[192:195], v[240:243], v[120:123]
    ds_read_b64_tr_b16 v[220:221], v39 offset:4096
    ds_read_b64_tr_b16 v[222:223], v39 offset:4608
    v_mfma_f32_16x16x32_bf16 v[124:127], v[196:199], v[240:243], v[124:127]
    ds_read_b64_tr_b16 v[192:193], v36 offset:8192
    ds_read_b64_tr_b16 v[194:195], v36 offset:8704
    v_mfma_f32_16x16x32_bf16 v[128:131], v[200:203], v[240:243], v[128:131]
    ds_read_b64_tr_b16 v[196:197], v37 offset:8192
    ds_read_b64_tr_b16 v[198:199], v37 offset:8704
    v_mfma_f32_16x16x32_bf16 v[132:135], v[204:207], v[240:243], v[132:135]
    ds_read_b64_tr_b16 v[200:201], v38 offset:8192
    ds_read_b64_tr_b16 v[202:203], v38 offset:8704
    s_waitcnt vmcnt(6)
    s_waitcnt lgkmcnt(6)
    v_mfma_f32_16x16x32_bf16 v[120:123], v[208:211], v[244:247], v[120:123]
    ds_read_b64_tr_b16 v[204:205], v39 offset:8192
    ds_read_b64_tr_b16 v[206:207], v39 offset:8704
    v_mfma_f32_16x16x32_bf16 v[124:127], v[212:215], v[244:247], v[124:127]
    ds_read_b64_tr_b16 v[208:209], v36 offset:12288
    ds_read_b64_tr_b16 v[210:211], v36 offset:12800
    v_mfma_f32_16x16x32_bf16 v[128:131], v[216:219], v[244:247], v[128:131]
    ds_read_b64_tr_b16 v[212:213], v37 offset:12288
    ds_read_b64_tr_b16 v[214:215], v37 offset:12800
    v_mfma_f32_16x16x32_bf16 v[132:135], v[220:223], v[244:247], v[132:135]
    ds_read_b64_tr_b16 v[216:217], v38 offset:12288
    ds_read_b64_tr_b16 v[218:219], v38 offset:12800
    s_waitcnt vmcnt(5)
    s_waitcnt lgkmcnt(6)
    v_mfma_f32_16x16x32_bf16 v[120:123], v[192:195], v[44:47], v[120:123]
    ds_read_b64_tr_b16 v[220:221], v39 offset:12288
    ds_read_b64_tr_b16 v[222:223], v39 offset:12800
    v_mfma_f32_16x16x32_bf16 v[124:127], v[196:199], v[44:47], v[124:127]
    v_mfma_f32_16x16x32_bf16 v[128:131], v[200:203], v[44:47], v[128:131]
    v_mfma_f32_16x16x32_bf16 v[132:135], v[204:207], v[44:47], v[132:135]
    s_waitcnt vmcnt(4)
    s_waitcnt lgkmcnt(0)
    v_mfma_f32_16x16x32_bf16 v[120:123], v[208:211], v[48:51], v[120:123]
    v_mfma_f32_16x16x32_bf16 v[124:127], v[212:215], v[48:51], v[124:127]
    v_mfma_f32_16x16x32_bf16 v[128:131], v[216:219], v[48:51], v[128:131]
    v_mfma_f32_16x16x32_bf16 v[132:135], v[220:223], v[48:51], v[132:135]
    s_nop 4
    v_cvt_pk_bf16_f32 v120, 0, v120
    v_cvt_pk_bf16_f32 v121, 0, v121
    v_cvt_pk_bf16_f32 v122, 0, v122
    v_cvt_pk_bf16_f32 v123, 0, v123
    v_cvt_pk_bf16_f32 v124, 0, v124
    v_cvt_pk_bf16_f32 v125, 0, v125
    v_cvt_pk_bf16_f32 v126, 0, v126
    v_cvt_pk_bf16_f32 v127, 0, v127
    v_pk_mul_f32 v[120:121], v[120:121], v[136:137]
    v_pk_mul_f32 v[122:123], v[122:123], v[138:139]
    v_pk_mul_f32 v[124:125], v[124:125], v[140:141]
    v_pk_mul_f32 v[126:127], v[126:127], v[142:143]
    v_cvt_pk_bf16_f32 v120, 0, v120
    v_cvt_pk_bf16_f32 v121, 0, v121
    v_cvt_pk_bf16_f32 v122, 0, v122
    v_cvt_pk_bf16_f32 v123, 0, v123
    v_cvt_pk_bf16_f32 v124, 0, v124
    v_cvt_pk_bf16_f32 v125, 0, v125
    v_cvt_pk_bf16_f32 v126, 0, v126
    v_cvt_pk_bf16_f32 v127, 0, v127
    v_pk_add_f32 v[120:121], v[120:121], v[152:153]
    v_pk_add_f32 v[122:123], v[122:123], v[154:155]
    v_pk_add_f32 v[124:125], v[124:125], v[156:157]
    v_pk_add_f32 v[126:127], v[126:127], v[158:159]
    v_cvt_pk_bf16_f32 v12, v120, v121
    v_cvt_pk_bf16_f32 v13, v122, v123
    v_cvt_pk_bf16_f32 v14, v124, v125
    v_cvt_pk_bf16_f32 v15, v126, v127
    v_dot2_f32_bf16 v4, v12, v12, 0
    v_dot2_f32_bf16 v5, v13, v13, 0
    v_dot2_f32_bf16 v4, v14, v14, v4
    v_dot2_f32_bf16 v5, v15, v15, v5
    v_mfma_f32_16x16x32_bf16 v[240:243], v[184:187], v[12:15], 0
    v_cvt_pk_bf16_f32 v128, 0, v128
    v_cvt_pk_bf16_f32 v129, 0, v129
    v_cvt_pk_bf16_f32 v130, 0, v130
    v_cvt_pk_bf16_f32 v131, 0, v131
    v_cvt_pk_bf16_f32 v132, 0, v132
    v_cvt_pk_bf16_f32 v133, 0, v133
    v_cvt_pk_bf16_f32 v134, 0, v134
    v_cvt_pk_bf16_f32 v135, 0, v135
    v_pk_mul_f32 v[128:129], v[128:129], v[144:145]
    v_pk_mul_f32 v[130:131], v[130:131], v[146:147]
    v_pk_mul_f32 v[132:133], v[132:133], v[148:149]
    v_pk_mul_f32 v[134:135], v[134:135], v[150:151]
    v_cvt_pk_bf16_f32 v128, 0, v128
    v_cvt_pk_bf16_f32 v129, 0, v129
    v_cvt_pk_bf16_f32 v130, 0, v130
    v_cvt_pk_bf16_f32 v131, 0, v131
    v_cvt_pk_bf16_f32 v132, 0, v132
    v_cvt_pk_bf16_f32 v133, 0, v133
    v_cvt_pk_bf16_f32 v134, 0, v134
    v_cvt_pk_bf16_f32 v135, 0, v135
    v_pk_add_f32 v[128:129], v[128:129], v[160:161]
    v_pk_add_f32 v[130:131], v[130:131], v[162:163]
    v_pk_add_f32 v[132:133], v[132:133], v[164:165]
    v_pk_add_f32 v[134:135], v[134:135], v[166:167]
    v_cvt_pk_bf16_f32 v16, v128, v129
    v_cvt_pk_bf16_f32 v17, v130, v131
    v_cvt_pk_bf16_f32 v18, v132, v133
    v_cvt_pk_bf16_f32 v19, v134, v135
    v_dot2_f32_bf16 v4, v16, v16, v4
    v_dot2_f32_bf16 v5, v17, v17, v5
    v_dot2_f32_bf16 v4, v18, v18, v4
    v_dot2_f32_bf16 v5, v19, v19, v5
    v_mfma_f32_16x16x32_bf16 v[240:243], v[188:191], v[16:19], v[240:243]
    s_nop 1
    v_add_f32 v4, v4, v5
    v_mov_b32 v5, v4
    s_nop 1
    v_permlane32_swap_b32 v4, v5
    v_add_f32 v4, v4, v5
    v_mov_b32 v5, v4
    s_nop 1
    v_permlane16_swap_b32 v4, v5
    v_add_f32 v243, v4, v5
    s_mov_b64 exec, 0xffff
    buffer_store_dwordx4 v[240:243], v2, s[32:35], s86 offen sc1
    s_mov_b64 exec, -1
    s_barrier
    s_cmp_lg_u32 s3, 0
    s_cbranch_scc1 L_PE
    v_mov_b32 v6, s4
    s_mov_b32 exec_hi, 0
    s_mov_b32 exec_lo, 65535
    buffer_store_dword v6, v29, s[32:35], s87 offen sc1
    s_mov_b64 exec, -1
L_PE:
    s_add_u32 s82, s80, 57344
    s_lshl2_add_u32 m0, s83, 33792
    s_nop 0
    buffer_load_dwordx4 v27, s[56:59], s82 offen nt lds
    s_add_u32 s82, s80, 114688
    s_lshl2_add_u32 m0, s83, 34816
    s_nop 0
    buffer_load_dwordx4 v27, s[56:59], s82 offen nt lds
    s_lshl_b32 s15, s3, 12
    v_add_u32 v4, s15, v2
    v_add_u32 v7, 65536, v4
    s_waitcnt vmcnt(6)
    v_cmp_ne_u32 vcc, s4, v41
    s_cbranch_vccz L_UPOK
POLL_34:
    buffer_load_dwordx2 v[40:41], v10, s[32:35], s13 offen sc1
    s_waitcnt vmcnt(0)
    v_cmp_ne_u32 vcc, s4, v41
    s_cbranch_vccz PDONE_35
    s_add_u32 s5, s5, 1
    s_cmp_lt_u32 s5, 200000
    s_cbranch_scc1 POLL_34
PDONE_35:
L_UPOK:
    s_lshl3_add_u32 s96, s21, s3
    s_lshl_b32 s97, s96, 12
    s_add_u32 s14, s97, 12582912
    s_load_dwordx2 s[24:25], s[32:33], s92 offset:1536 glc
    v_add_f32_dpp v40, v40, v40 quad_perm:[1,0,3,2] row_mask:0xf bank_mask:0xf
    s_nop 1
    v_add_f32_dpp v40, v40, v40 quad_perm:[2,3,0,1] row_mask:0xf bank_mask:0xf
    s_nop 1
    v_add_f32_dpp v40, v40, v40 row_half_mirror row_mask:0xf bank_mask:0xf
    s_nop 1
    v_add_f32_dpp v40, v40, v40 row_mirror row_mask:0xf bank_mask:0xf
    v_lshlrev_b32 v152, 16, v12
    v_and_b32 v153, s6, v12
    v_lshlrev_b32 v154, 16, v13
    v_and_b32 v155, s6, v13
    v_lshlrev_b32 v156, 16, v14
    v_and_b32 v157, s6, v14
    v_lshlrev_b32 v158, 16, v15
    v_and_b32 v159, s6, v15
    v_lshlrev_b32 v160, 16, v16
    v_and_b32 v161, s6, v16
    v_lshlrev_b32 v162, 16, v17
    v_and_b32 v163, s6, v17
    v_lshlrev_b32 v164, 16, v18
    v_and_b32 v165, s6, v18
    v_lshlrev_b32 v166, 16, v19
    v_and_b32 v167, s6, v19
    s_lshl_b32 s96, s3, 9
    s_lshl1_add_u32 s15, s21, s96
    v_and_b32 v29, 15, v1
    v_lshl_add_u32 v29, v29, 5, s15
    v_xor_b32 v5, 0x4000, v4
    v_xor_b32 v8, 0x4000, v7
    s_waitcnt vmcnt(3)
    ds_write_b128 v4, v[72:75] offset:2048
    ds_write_b128 v4, v[76:79] offset:3072
    ds_write_b128 v4, v[80:83] offset:32768
    s_cmp_lt_u32 s3, 4
    s_cbranch_scc1 L_FW1
    ds_write_b128 v4, v[56:59] offset:0
    ds_write_b128 v5, v[60:63] offset:0
    ds_write_b128 v4, v[64:67] offset:1024
    ds_write_b128 v5, v[68:71] offset:1024
L_FW1:
    s_branch SCHK_37
SPOLL_36:
    s_load_dwordx2 s[24:25], s[32:33], s92 offset:1536 glc
SCHK_37:
    s_add_u32 s5, s5, 1
    s_cmp_ge_u32 s5, 200000
    s_waitcnt lgkmcnt(0)
    s_cbranch_scc1 SDONE_38
    s_cmp_lg_u32 s24, s4
    s_cbranch_scc1 SPOLL_36
    s_cmp_lg_u32 s25, s4
    s_cbranch_scc1 SPOLL_36
SDONE_38:
    s_barrier
    buffer_load_dwordx4 v[192:195], v2, s[32:35], s14 offen sc1
    buffer_load_dwordx4 v[196:199], v2, s[32:35], s14 offen offset:1024 sc1
    buffer_load_dwordx4 v[200:203], v2, s[32:35], s14 offen offset:2048 sc1
    buffer_load_dwordx4 v[204:207], v2, s[32:35], s14 offen offset:3072 sc1
    s_barrier
    s_add_u32 s82, s80, 172032
    s_lshl2_add_u32 m0, s83, 35840
    s_nop 0
    buffer_load_dwordx4 v27, s[56:59], s82 offen nt lds
    s_mov_b32 s82, s81
    s_lshl2_add_u32 m0, s83, 65536
    s_nop 0
    buffer_load_dwordx4 v253, s[60:63], s82 offen nt lds
    s_add_u32 s82, s81, 4096
    s_lshl2_add_u32 m0, s83, 66560
    s_nop 0
    buffer_load_dwordx4 v253, s[60:63], s82 offen nt lds
    v_mov_b32_dpp v168, v33 row_newbcast:0 row_mask:0xf bank_mask:0xf
    v_mov_b32_dpp v169, v33 row_newbcast:1 row_mask:0xf bank_mask:0xf
    v_mov_b32_dpp v170, v33 row_newbcast:2 row_mask:0xf bank_mask:0xf
    v_mov_b32_dpp v171, v33 row_newbcast:3 row_mask:0xf bank_mask:0xf
    v_mov_b32_dpp v172, v33 row_newbcast:4 row_mask:0xf bank_mask:0xf
    v_mov_b32_dpp v173, v33 row_newbcast:5 row_mask:0xf bank_mask:0xf
    v_mov_b32_dpp v174, v33 row_newbcast:6 row_mask:0xf bank_mask:0xf
    v_mov_b32_dpp v175, v33 row_newbcast:7 row_mask:0xf bank_mask:0xf
    v_mov_b32_dpp v176, v33 row_newbcast:8 row_mask:0xf bank_mask:0xf
    v_mov_b32_dpp v177, v33 row_newbcast:9 row_mask:0xf bank_mask:0xf
    v_mov_b32_dpp v178, v33 row_newbcast:10 row_mask:0xf bank_mask:0xf
    v_mov_b32_dpp v179, v33 row_newbcast:11 row_mask:0xf bank_mask:0xf
    v_mov_b32_dpp v180, v33 row_newbcast:12 row_mask:0xf bank_mask:0xf
    v_mov_b32_dpp v181, v33 row_newbcast:13 row_mask:0xf bank_mask:0xf
    v_mov_b32_dpp v182, v33 row_newbcast:14 row_mask:0xf bank_mask:0xf
    v_mov_b32_dpp v183, v33 row_newbcast:15 row_mask:0xf bank_mask:0xf
    v_mov_b32_dpp v88, v42 row_newbcast:0 row_mask:0xf bank_mask:0xf
    v_mov_b32_dpp v89, v42 row_newbcast:1 row_mask:0xf bank_mask:0xf
    v_mov_b32_dpp v90, v42 row_newbcast:2 row_mask:0xf bank_mask:0xf
    v_mov_b32_dpp v91, v42 row_newbcast:3 row_mask:0xf bank_mask:0xf
    v_mov_b32_dpp v92, v42 row_newbcast:4 row_mask:0xf bank_mask:0xf
    v_mov_b32_dpp v93, v42 row_newbcast:5 row_mask:0xf bank_mask:0xf
    v_mov_b32_dpp v94, v42 row_newbcast:6 row_mask:0xf bank_mask:0xf
    v_mov_b32_dpp v95, v42 row_newbcast:7 row_mask:0xf bank_mask:0xf
    v_mov_b32_dpp v96, v42 row_newbcast:8 row_mask:0xf bank_mask:0xf
L_PAD9:
    s_cbranch_execz L_RET9
    v_mov_b32_dpp v97, v42 row_newbcast:9 row_mask:0xf bank_mask:0xf
    v_mov_b32_dpp v98, v42 row_newbcast:10 row_mask:0xf bank_mask:0xf
    v_mov_b32_dpp v99, v42 row_newbcast:11 row_mask:0xf bank_mask:0xf
    v_mov_b32_dpp v100, v42 row_newbcast:12 row_mask:0xf bank_mask:0xf
    v_mov_b32_dpp v101, v42 row_newbcast:13 row_mask:0xf bank_mask:0xf
    v_mov_b32_dpp v102, v42 row_newbcast:14 row_mask:0xf bank_mask:0xf
    v_mov_b32_dpp v103, v42 row_newbcast:15 row_mask:0xf bank_mask:0xf
    v_mov_b32_dpp v104, v43 row_newbcast:0 row_mask:0xf bank_mask:0xf
    v_mov_b32_dpp v105, v43 row_newbcast:1 row_mask:0xf bank_mask:0xf
    v_mov_b32_dpp v106, v43 row_newbcast:2 row_mask:0xf bank_mask:0xf
    v_mov_b32_dpp v107, v43 row_newbcast:3 row_mask:0xf bank_mask:0xf
    v_mov_b32_dpp v108, v43 row_newbcast:4 row_mask:0xf bank_mask:0xf
    v_mov_b32_dpp v109, v43 row_newbcast:5 row_mask:0xf bank_mask:0xf
    v_mov_b32_dpp v110, v43 row_newbcast:6 row_mask:0xf bank_mask:0xf
    v_mov_b32_dpp v111, v43 row_newbcast:7 row_mask:0xf bank_mask:0xf
    v_mov_b32_dpp v112, v43 row_newbcast:8 row_mask:0xf bank_mask:0xf
    v_mov_b32_dpp v113, v43 row_newbcast:9 row_mask:0xf bank_mask:0xf
    v_mov_b32_dpp v114, v43 row_newbcast:10 row_mask:0xf bank_mask:0xf
    v_mov_b32_dpp v115, v43 row_newbcast:11 row_mask:0xf bank_mask:0xf
    v_mov_b32_dpp v116, v43 row_newbcast:12 row_mask:0xf bank_mask:0xf
    v_mov_b32_dpp v117, v43 row_newbcast:13 row_mask:0xf bank_mask:0xf
    v_mov_b32_dpp v118, v43 row_newbcast:14 row_mask:0xf bank_mask:0xf
    v_mov_b32_dpp v119, v43 row_newbcast:15 row_mask:0xf bank_mask:0xf
    s_lshl3_add_u32 s15, s3, 156160
    v_mov_b32 v4, s15
    v_and_b32 v5, 7, v1
    v_lshlrev_b32 v5, 3, v5
    v_add_u32 v5, 156160, v5
    v_and_b32 v6, 3, v1
    v_lshlrev_b32 v6, 18, v6
    v_bfe_u32 v9, v1, 2, 2
    v_lshl_add_u32 v6, v9, 13, v6
    s_and_b32 s96, s21, 1
    s_and_b32 s97, s12, 7
    s_lshr_b32 s98, s12, 3
    s_lshl3_add_u32 s99, s97, s98
    s_lshl_b32 s97, s99, 12
    s_lshr_b32 s98, s21, 1
    s_lshl_b32 s99, s98, 6
    s_add_u32 s98, s97, s99
    s_lshl4_add_u32 s97, s96, s98
    s_add_u32 s99, s97, 1048576
    s_add_u32 s16, s99, 2560
    s_waitcnt vmcnt(3)
    v_pk_add_f32 v[192:193], v[192:193], v[196:197]
    v_pk_add_f32 v[200:201], v[200:201], v[204:205]
    v_pk_add_f32 v[194:195], v[194:195], v[198:199]
    v_pk_add_f32 v[202:203], v[202:203], v[206:207]
    v_pk_add_f32 v[192:193], v[192:193], v[200:201]
    v_pk_add_f32 v[194:195], v[194:195], v[202:203]
    v_add_f32 v193, v193, v194
    v_add_f32 v197, v192, v195
    v_cmp_u_f32 vcc, v193, v197
    s_cbranch_vccz POK_40
PRE_41:
    buffer_load_dwordx4 v[192:195], v2, s[32:35], s14 offen sc1
    buffer_load_dwordx4 v[196:199], v2, s[32:35], s14 offen offset:1024 sc1
    buffer_load_dwordx4 v[200:203], v2, s[32:35], s14 offen offset:2048 sc1
    buffer_load_dwordx4 v[204:207], v2, s[32:35], s14 offen offset:3072 sc1
    s_waitcnt vmcnt(0)
    v_pk_add_f32 v[192:193], v[192:193], v[196:197]
    v_pk_add_f32 v[200:201], v[200:201], v[204:205]
    v_pk_add_f32 v[194:195], v[194:195], v[198:199]
    v_pk_add_f32 v[202:203], v[202:203], v[206:207]
    v_pk_add_f32 v[192:193], v[192:193], v[200:201]
    v_pk_add_f32 v[194:195], v[194:195], v[202:203]
    v_add_f32 v193, v193, v194
    v_add_f32 v197, v192, v195
    v_cmp_u_f32 vcc, v193, v197
    s_cbranch_vccz POK_40
    s_add_u32 s5, s5, 1
    s_cmp_lt_u32 s5, 200000
    s_cbranch_scc1 PRE_41
POK_40:
    v_mov_b32 v196, v195
    s_nop 1
    v_permlane32_swap_b32 v195, v196
    v_permlane32_swap_b32 v192, v193
    v_add_f32 v195, v195, v196
    v_add_f32 v192, v192, v193
    s_nop 1
    v_permlane16_swap_b32 v192, v195
    v_add_f32 v193, v192, v195
    v_add_f32 v195, v192, v195
    s_nop 1
    v_permlane16_swap_b32 v193, v195
    v_mov_b32 v192, v193
    v_mul_f32 v195, 0x3a800000, v195
    s_nop 0
    v_permlane32_swap_b32 v192, v193
    v_mul_f32 v192, 0x3a800000, v192
    v_fma_f32 v31, -v192, v192, v195
    v_cvt_pk_bf16_f32 v30, 0, v192
    v_max_f32 v31, 0, v31
    v_cvt_pk_bf16_f32 v31, 0, v31
    v_fma_f32 v193, -v30, v40, v193
    v_add_f32 v31, 0x3727c5ac, v31
    v_cvt_pk_bf16_f32 v31, 0, v31
    v_sqrt_f32 v31, v31
    s_nop 0
    v_cvt_pk_bf16_f32 v31, 0, v31
    v_rcp_f32 v31, v31
    s_nop 0
    v_mul_f32 v32, v193, v31
    v_ashrrev_i32 v196, 31, v32
    v_or_b32 v196, 0x80000000, v196
    v_xor_b32 v32, v32, v196
    s_mov_b32 s15, 0xfffff000
    v_and_or_b32 v32, v32, s15, v29
    s_nop 1
    v_max_u32_dpp v244, v32, v32 quad_perm:[1,0,3,2] row_mask:0xf bank_mask:0xf
    v_min_u32_dpp v245, v32, v32 quad_perm:[1,0,3,2] row_mask:0xf bank_mask:0xf
    s_nop 0
    v_min_u32_dpp v196, v244, v244 quad_perm:[2,3,0,1] row_mask:0xf bank_mask:0xf
    v_max_u32_dpp v245, v245, v245 quad_perm:[2,3,0,1] row_mask:0xf bank_mask:0xf
    v_max_u32_dpp v244, v244, v244 quad_perm:[2,3,0,1] row_mask:0xf bank_mask:0xf
    v_max_u32 v245, v245, v196
    s_nop 0
    v_min_u32_dpp v196, v244, v244 row_half_mirror row_mask:0xf bank_mask:0xf
    v_max_u32_dpp v245, v245, v245 row_half_mirror row_mask:0xf bank_mask:0xf
    v_max_u32_dpp v244, v244, v244 row_half_mirror row_mask:0xf bank_mask:0xf
    v_max_u32 v245, v245, v196
    s_nop 0
    v_min_u32_dpp v196, v244, v244 row_mirror row_mask:0xf bank_mask:0xf
    v_max_u32_dpp v245, v245, v245 row_mirror row_mask:0xf bank_mask:0xf
    v_max_u32_dpp v244, v244, v244 row_mirror row_mask:0xf bank_mask:0xf
    v_max_u32 v245, v245, v196
    ds_write_b64 v4, v[244:245]
    s_waitcnt lgkmcnt(0)
    s_barrier
    ds_read_b64 v[244:245], v5
    v_pk_add_f32 v[208:209], v[152:153], v[30:31] op_sel_hi:[1,0] neg_lo:[0,1] neg_hi:[0,1]
    v_pk_add_f32 v[210:211], v[154:155], v[30:31] op_sel_hi:[1,0] neg_lo:[0,1] neg_hi:[0,1]
    v_pk_add_f32 v[212:213], v[156:157], v[30:31] op_sel_hi:[1,0] neg_lo:[0,1] neg_hi:[0,1]
    v_pk_add_f32 v[214:215], v[158:159], v[30:31] op_sel_hi:[1,0] neg_lo:[0,1] neg_hi:[0,1]
    v_pk_add_f32 v[216:217], v[160:161], v[30:31] op_sel_hi:[1,0] neg_lo:[0,1] neg_hi:[0,1]
    v_pk_add_f32 v[218:219], v[162:163], v[30:31] op_sel_hi:[1,0] neg_lo:[0,1] neg_hi:[0,1]
    v_pk_add_f32 v[220:221], v[164:165], v[30:31] op_sel_hi:[1,0] neg_lo:[0,1] neg_hi:[0,1]
    v_pk_add_f32 v[222:223], v[166:167], v[30:31] op_sel_hi:[1,0] neg_lo:[0,1] neg_hi:[0,1]
    s_waitcnt lgkmcnt(0)
    v_min_u32_dpp v196, v244, v244 quad_perm:[1,0,3,2] row_mask:0xf bank_mask:0xf
    v_max_u32_dpp v245, v245, v245 quad_perm:[1,0,3,2] row_mask:0xf bank_mask:0xf
    v_max_u32_dpp v244, v244, v244 quad_perm:[1,0,3,2] row_mask:0xf bank_mask:0xf
    v_max_u32 v245, v245, v196
    s_nop 0
    v_min_u32_dpp v196, v244, v244 quad_perm:[2,3,0,1] row_mask:0xf bank_mask:0xf
    v_max_u32_dpp v245, v245, v245 quad_perm:[2,3,0,1] row_mask:0xf bank_mask:0xf
    v_max_u32_dpp v244, v244, v244 quad_perm:[2,3,0,1] row_mask:0xf bank_mask:0xf
    v_max_u32 v245, v245, v196
    s_nop 0
    v_min_u32_dpp v196, v244, v244 row_half_mirror row_mask:0xf bank_mask:0xf
    v_max_u32_dpp v245, v245, v245 row_half_mirror row_mask:0xf bank_mask:0xf
    v_max_u32_dpp v244, v244, v244 row_half_mirror row_mask:0xf bank_mask:0xf
    v_max_u32 v245, v245, v196
    v_cmp_eq_u32 s[88:89], v32, v245
    v_cmp_eq_u32 vcc, v32, v244
    v_or_b32 v246, 1, v245
    v_mov_b32 v245, s4
    v_mov_b32 v247, s4
    s_or_b64 s[84:85], vcc, s[88:89]
    s_cmp_lg_u32 s3, 0
    s_cbranch_scc1 L_NOF
    s_mov_b64 exec, 0xffff
    buffer_store_dwordx4 v[244:247], v6, s[32:35], s16 offen sc1
    s_mov_b64 exec, -1
L_NOF:
    s_cmp_eq_u64 s[84:85], 0
    s_cbranch_scc1 L_NOPR
    s_setprio 1
L_NOPR:
    s_lshl4_add_u32 s13, s3, 156288
    v_mov_b32 v4, s13
    v_and_b32 v5, 7, v1
    v_lshlrev_b32 v5, 4, v5
    v_add_u32 v5, 156288, v5
    s_load_dwordx8 s[24:31], s[32:33], s92 offset:2560 glc
    v_cvt_pk_bf16_f32 v208, 0, v208
    v_cvt_pk_bf16_f32 v209, 0, v209
    v_cvt_pk_bf16_f32 v210, 0, v210
    v_cvt_pk_bf16_f32 v211, 0, v211
    v_cvt_pk_bf16_f32 v212, 0, v212
    v_cvt_pk_bf16_f32 v213, 0, v213
    v_cvt_pk_bf16_f32 v214, 0, v214
    v_cvt_pk_bf16_f32 v215, 0, v215
    v_cvt_pk_bf16_f32 v216, 0, v216
    v_cvt_pk_bf16_f32 v217, 0, v217
    v_cvt_pk_bf16_f32 v218, 0, v218
    v_cvt_pk_bf16_f32 v219, 0, v219
    v_cvt_pk_bf16_f32 v220, 0, v220
    v_cvt_pk_bf16_f32 v221, 0, v221
    v_cvt_pk_bf16_f32 v222, 0, v222
    v_cvt_pk_bf16_f32 v223, 0, v223
    v_pk_mul_f32 v[208:209], v[30:31], v[208:209] op_sel:[1,0]
    v_pk_mul_f32 v[210:211], v[30:31], v[210:211] op_sel:[1,0]
    v_pk_mul_f32 v[212:213], v[30:31], v[212:213] op_sel:[1,0]
    v_pk_mul_f32 v[214:215], v[30:31], v[214:215] op_sel:[1,0]
    v_pk_mul_f32 v[216:217], v[30:31], v[216:217] op_sel:[1,0]
    v_pk_mul_f32 v[218:219], v[30:31], v[218:219] op_sel:[1,0]
    v_pk_mul_f32 v[220:221], v[30:31], v[220:221] op_sel:[1,0]
    v_pk_mul_f32 v[222:223], v[30:31], v[222:223] op_sel:[1,0]
    v_cvt_pk_bf16_f32 v208, 0, v208
    v_cvt_pk_bf16_f32 v209, 0, v209
    v_cvt_pk_bf16_f32 v210, 0, v210
    v_cvt_pk_bf16_f32 v211, 0, v211
    v_cvt_pk_bf16_f32 v212, 0, v212
    v_cvt_pk_bf16_f32 v213, 0, v213
    v_cvt_pk_bf16_f32 v214, 0, v214
    v_cvt_pk_bf16_f32 v215, 0, v215
    v_cvt_pk_bf16_f32 v216, 0, v216
    v_cvt_pk_bf16_f32 v217, 0, v217
    v_cvt_pk_bf16_f32 v218, 0, v218
    v_cvt_pk_bf16_f32 v219, 0, v219
    v_cvt_pk_bf16_f32 v220, 0, v220
    v_cvt_pk_bf16_f32 v221, 0, v221
    v_cvt_pk_bf16_f32 v222, 0, v222
    v_cvt_pk_bf16_f32 v223, 0, v223
    v_pk_mul_f32 v[208:209], v[208:209], v[168:169]
    v_pk_mul_f32 v[210:211], v[210:211], v[170:171]
    v_pk_mul_f32 v[212:213], v[212:213], v[172:173]
    v_pk_mul_f32 v[214:215], v[214:215], v[174:175]
    v_pk_mul_f32 v[216:217], v[216:217], v[176:177]
    v_pk_mul_f32 v[218:219], v[218:219], v[178:179]
    v_pk_mul_f32 v[220:221], v[220:221], v[180:181]
    v_pk_mul_f32 v[222:223], v[222:223], v[182:183]
    v_cvt_pk_bf16_f32 v208, 0, v208
    v_cvt_pk_bf16_f32 v209, 0, v209
    v_cvt_pk_bf16_f32 v210, 0, v210
    v_cvt_pk_bf16_f32 v211, 0, v211
    v_cvt_pk_bf16_f32 v212, 0, v212
    v_cvt_pk_bf16_f32 v213, 0, v213
    v_cvt_pk_bf16_f32 v214, 0, v214
    v_cvt_pk_bf16_f32 v215, 0, v215
    v_cvt_pk_bf16_f32 v216, 0, v216
    v_cvt_pk_bf16_f32 v217, 0, v217
    v_cvt_pk_bf16_f32 v218, 0, v218
    v_cvt_pk_bf16_f32 v219, 0, v219
    v_cvt_pk_bf16_f32 v220, 0, v220
    v_cvt_pk_bf16_f32 v221, 0, v221
    v_cvt_pk_bf16_f32 v222, 0, v222
    v_cvt_pk_bf16_f32 v223, 0, v223
    v_pk_add_f32 v[208:209], v[208:209], v[88:89]
    v_pk_add_f32 v[210:211], v[210:211], v[90:91]
    v_pk_add_f32 v[212:213], v[212:213], v[92:93]
    v_pk_add_f32 v[214:215], v[214:215], v[94:95]
    v_pk_add_f32 v[216:217], v[216:217], v[96:97]
    v_pk_add_f32 v[218:219], v[218:219], v[98:99]
    v_pk_add_f32 v[220:221], v[220:221], v[100:101]
    v_pk_add_f32 v[222:223], v[222:223], v[102:103]
    v_cvt_pk_bf16_f32 v224, v208, v209
    v_cvt_pk_bf16_f32 v225, v210, v211
    v_cvt_pk_bf16_f32 v226, v212, v213
    v_cvt_pk_bf16_f32 v227, v214, v215
    v_cvt_pk_bf16_f32 v228, v216, v217
    v_cvt_pk_bf16_f32 v229, v218, v219
    v_cvt_pk_bf16_f32 v230, v220, v221
    v_cvt_pk_bf16_f32 v231, v222, v223
    s_cmp_eq_u64 s[84:85], 0
    s_cbranch_scc1 L_NOCAND
    v_mfma_f32_16x16x32_bf16 v[240:243], v[184:187], v[224:227], 0
    v_mfma_f32_16x16x32_bf16 v[240:243], v[188:191], v[228:231], v[240:243]
    v_mov_b32 v232, v224
    v_mov_b32 v233, v225
    v_mov_b32 v234, v226
    v_mov_b32 v235, v227
    v_mov_b32 v236, v228
    v_mov_b32 v237, v229
    v_mov_b32 v238, v230
    v_mov_b32 v239, v231
    s_lshl_b32 s96, s21, 14
    s_lshl_b32 s97, s12, 9
    s_add_u32 s98, s96, s97
    s_add_u32 s15, s98, 13631488
    v_lshrrev_b32 v7, 4, v1
    v_lshlrev_b32 v7, 4, v7
    v_add_u32 v8, 8192, v7
    v_permlane32_swap_b32 v232, v234
    v_permlane32_swap_b32 v233, v235
    v_permlane32_swap_b32 v236, v238
    v_permlane32_swap_b32 v237, v239
    v_permlane32_swap_b32 v12, v14
    v_permlane32_swap_b32 v13, v15
    v_permlane32_swap_b32 v16, v18
    v_permlane32_swap_b32 v17, v19
    v_cndmask_b32 v7, v7, v8, s[88:89]
    s_mov_b64 exec, s[84:85]
    buffer_store_dwordx4 v[232:235], v7, s[32:35], s15 offen sc1
    buffer_store_dwordx4 v[236:239], v7, s[32:35], s15 offen offset:64 sc1
    s_mov_b32 exec_hi, 0
    s_and_b32 exec_lo, s84, 0xffff
    buffer_store_dword v243, v7, s[32:35], s15 offen offset:256 sc1
    s_mov_b64 exec, s[84:85]
    buffer_store_dwordx4 v[12:15], v7, s[32:35], s15 offen offset:128 sc1
    buffer_store_dwordx4 v[16:19], v7, s[32:35], s15 offen offset:192 sc1
    s_mov_b64 exec, -1
    s_setprio 0
L_NOCAND:
    s_add_u32 s82, s81, 8192
    s_lshl2_add_u32 m0, s83, 67584
    s_nop 0
    buffer_load_dwordx4 v253, s[60:63], s82 offen nt lds
    s_add_u32 s82, s81, 12288
    s_lshl2_add_u32 m0, s83, 68608
    s_nop 0
    buffer_load_dwordx4 v253, s[60:63], s82 offen nt lds
    v_lshlrev_b32 v208, 16, v224
    v_and_b32 v209, s6, v224
    v_lshlrev_b32 v210, 16, v225
    v_and_b32 v211, s6, v225
    v_lshlrev_b32 v212, 16, v226
    v_and_b32 v213, s6, v226
    v_lshlrev_b32 v214, 16, v227
    v_and_b32 v215, s6, v227
    v_lshlrev_b32 v216, 16, v228
    v_and_b32 v217, s6, v228
    v_lshlrev_b32 v218, 16, v229
    v_and_b32 v219, s6, v229
    v_lshlrev_b32 v220, 16, v230
    v_and_b32 v221, s6, v230
    v_lshlrev_b32 v222, 16, v231
    v_and_b32 v223, s6, v231
    v_pk_mul_f32 v[208:209], v[208:209], v[104:105]
    v_pk_mul_f32 v[210:211], v[210:211], v[106:107]
    v_pk_mul_f32 v[212:213], v[212:213], v[108:109]
    v_pk_mul_f32 v[214:215], v[214:215], v[110:111]
    v_pk_mul_f32 v[216:217], v[216:217], v[112:113]
    v_pk_mul_f32 v[218:219], v[218:219], v[114:115]
    v_pk_mul_f32 v[220:221], v[220:221], v[116:117]
    v_pk_mul_f32 v[222:223], v[222:223], v[118:119]
    v_cvt_pk_bf16_f32 v208, 0, v208
    v_cvt_pk_bf16_f32 v209, 0, v209
    v_cvt_pk_bf16_f32 v210, 0, v210
    v_cvt_pk_bf16_f32 v211, 0, v211
    v_cvt_pk_bf16_f32 v212, 0, v212
    v_cvt_pk_bf16_f32 v213, 0, v213
    v_cvt_pk_bf16_f32 v214, 0, v214
    v_cvt_pk_bf16_f32 v215, 0, v215
    v_cvt_pk_bf16_f32 v216, 0, v216
    v_cvt_pk_bf16_f32 v217, 0, v217
    v_cvt_pk_bf16_f32 v218, 0, v218
    v_cvt_pk_bf16_f32 v219, 0, v219
    v_cvt_pk_bf16_f32 v220, 0, v220
    v_cvt_pk_bf16_f32 v221, 0, v221
    v_cvt_pk_bf16_f32 v222, 0, v222
    v_cvt_pk_bf16_f32 v223, 0, v223
    s_branch SCHK_43
SPOLL_42:
    s_load_dwordx8 s[24:31], s[32:33], s92 offset:2560 glc
SCHK_43:
    s_add_u32 s5, s5, 1
    s_cmp_ge_u32 s5, 200000
    s_waitcnt lgkmcnt(0)
    s_cbranch_scc1 SDONE_44
    s_cmp_lg_u32 s25, s4
    s_cbranch_scc1 SPOLL_42
    s_cmp_lg_u32 s27, s4
    s_cbranch_scc1 SPOLL_42
    s_cmp_lg_u32 s29, s4
    s_cbranch_scc1 SPOLL_42
    s_cmp_lg_u32 s31, s4
    s_cbranch_scc1 SPOLL_42
SDONE_44:
    s_min_u32 s25, s24, s28
    s_min_u32 s27, s26, s28
    s_min_u32 s29, s24, s30
    s_max_u32 s24, s24, s28
    s_max_u32 s26, s26, s30
    s_max_u32 s27, s27, s29
    s_max_u32 s25, s25, s26
    v_mov_b32 v244, s24
    v_mov_b32 v246, s27
    v_mov_b32 v245, s25
    ds_write_b128 v4, v[244:247]
    s_waitcnt vmcnt(4)
    s_waitcnt lgkmcnt(0)
    s_barrier
    ds_read_b128 v[244:247], v5
    v_and_b32 v8, 8, v1
    v_cmp_eq_u32 s[22:23], 0, v8
    v_cmp_gt_u32 s[24:25], 16, v1
    v_cmp_gt_u32 s[26:27], 32, v1
    s_waitcnt lgkmcnt(0)
    v_min_u32_dpp v192, v244, v244 quad_perm:[1,0,3,2] row_mask:0xf bank_mask:0xf
    v_min_u32_dpp v193, v245, v244 quad_perm:[1,0,3,2] row_mask:0xf bank_mask:0xf
    v_min_u32_dpp v194, v244, v245 quad_perm:[1,0,3,2] row_mask:0xf bank_mask:0xf
    v_max_u32_dpp v246, v246, v246 quad_perm:[1,0,3,2] row_mask:0xf bank_mask:0xf
    v_max_u32_dpp v245, v245, v245 quad_perm:[1,0,3,2] row_mask:0xf bank_mask:0xf
    v_max_u32_dpp v244, v244, v244 quad_perm:[1,0,3,2] row_mask:0xf bank_mask:0xf
    v_max3_u32 v246, v246, v193, v194
    v_max_u32 v245, v245, v192
    v_min_u32_dpp v192, v244, v244 quad_perm:[2,3,0,1] row_mask:0xf bank_mask:0xf
    s_nop 0
    v_min_u32_dpp v193, v245, v244 quad_perm:[2,3,0,1] row_mask:0xf bank_mask:0xf
    v_min_u32_dpp v194, v244, v245 quad_perm:[2,3,0,1] row_mask:0xf bank_mask:0xf
    v_max_u32_dpp v246, v246, v246 quad_perm:[2,3,0,1] row_mask:0xf bank_mask:0xf
    v_max_u32_dpp v245, v245, v245 quad_perm:[2,3,0,1] row_mask:0xf bank_mask:0xf
    v_max_u32_dpp v244, v244, v244 quad_perm:[2,3,0,1] row_mask:0xf bank_mask:0xf
    v_max3_u32 v246, v246, v193, v194
    v_max_u32 v245, v245, v192
    v_min_u32_dpp v192, v244, v244 row_half_mirror row_mask:0xf bank_mask:0xf
    s_nop 0
    v_min_u32_dpp v193, v245, v244 row_half_mirror row_mask:0xf bank_mask:0xf
    v_min_u32_dpp v194, v244, v245 row_half_mirror row_mask:0xf bank_mask:0xf
    v_max_u32_dpp v246, v246, v246 row_half_mirror row_mask:0xf bank_mask:0xf
    v_max_u32_dpp v245, v245, v245 row_half_mirror row_mask:0xf bank_mask:0xf
    v_max_u32_dpp v244, v244, v244 row_half_mirror row_mask:0xf bank_mask:0xf
    v_max3_u32 v246, v246, v193, v194
    v_max_u32 v245, v245, v192
    v_cndmask_b32 v192, v245, v244, s[22:23]
    v_cndmask_b32 v201, v246, v245, s[26:27]
    v_and_b32 v193, 31, v246
    v_and_b32 v192, 31, v192
    v_cndmask_b32 v201, v201, v244, s[24:25]
    v_lshl_add_u32 v4, v192, 13, v52
    v_lshl_add_u32 v5, v193, 13, v52
    v_and_b32 v194, 31, v201
    v_lshl_add_u32 v6, v194, 13, v53
    buffer_load_dwordx4 v[192:195], v4, s[32:35], 0 offen sc1
    buffer_load_dwordx4 v[196:199], v5, s[32:35], 0 offen sc1
    buffer_load_dword v200, v6, s[32:35], 0 offen sc1
    v_readfirstlane_b32 s91, v244
    v_readfirstlane_b32 s94, v245
    v_readfirstlane_b32 s95, v246
    ds_read_b64_tr_b16 v[56:57], v34
    ds_read_b64_tr_b16 v[58:59], v34 offset:512
    ds_read_b64_tr_b16 v[60:61], v34 offset:1024
    ds_read_b64_tr_b16 v[62:63], v34 offset:1536
    ds_read_b64_tr_b16 v[64:65], v34 offset:2048
    ds_read_b64_tr_b16 v[66:67], v34 offset:2560
    ds_read_b64_tr_b16 v[68:69], v34 offset:3072
    ds_read_b64_tr_b16 v[70:71], v34 offset:3584
    ds_read_b64_tr_b16 v[72:73], v34 offset:4096
    ds_read_b64_tr_b16 v[74:75], v34 offset:4608
    ds_read_b64_tr_b16 v[76:77], v34 offset:5120
    ds_read_b64_tr_b16 v[78:79], v34 offset:5632
    ds_read_b64_tr_b16 v[80:81], v34 offset:6144
    ds_read_b64_tr_b16 v[82:83], v34 offset:6656
    ds_read_b64_tr_b16 v[84:85], v34 offset:7168
    ds_read_b64_tr_b16 v[86:87], v34 offset:7680
    s_lshl_b32 s96, s3, 11
    s_add_u32 s13, s96, 98304
    v_lshrrev_b32 v44, 4, v1
    v_lshlrev_b32 v44, 4, v44
    v_and_b32 v45, 7, v1
    v_lshlrev_b32 v45, 4, v45
    v_xor_b32 v44, v44, v45
    v_and_b32 v46, 15, v1
    v_lshl_add_u32 v46, v46, 7, s13
    v_add_u32 v44, v44, v46
    v_xor_b32 v46, 64, v44
    v_lshrrev_b32 v47, 3, v1
    v_lshlrev_b32 v47, 4, v47
    v_xor_b32 v45, v47, v45
    v_lshrrev_b32 v47, 3, v1
    v_lshl_add_u32 v47, v47, 7, s13
    v_add_u32 v45, v45, v47
    s_lshl_b32 s96, s21, 7
    s_sub_u32 s97, 2047, s96
    s_lshl_b32 s98, s3, 4
    s_sub_u32 s13, s97, s98
    v_lshrrev_b32 v43, 3, v1
    v_sub_u32 v42, s13, v43
    v_subrev_u32 v43, 8, v42
    v_lshrrev_b32 v33, 3, v1
    v_lshlrev_b32 v33, 11, v33
    v_and_b32 v9, 7, v1
    v_lshl_add_u32 v33, v9, 4, v33
    v_pk_add_f32 v[208:209], v[208:209], v[152:153]
    v_pk_add_f32 v[210:211], v[210:211], v[154:155]
    v_pk_add_f32 v[212:213], v[212:213], v[156:157]
    v_pk_add_f32 v[214:215], v[214:215], v[158:159]
    v_pk_add_f32 v[216:217], v[216:217], v[160:161]
    v_pk_add_f32 v[218:219], v[218:219], v[162:163]
    v_pk_add_f32 v[220:221], v[220:221], v[164:165]
    v_pk_add_f32 v[222:223], v[222:223], v[166:167]
    v_cvt_pk_bf16_f32 v232, v208, v209
    v_cvt_pk_bf16_f32 v233, v210, v211
    v_cvt_pk_bf16_f32 v234, v212, v213
    v_cvt_pk_bf16_f32 v235, v214, v215
    v_cvt_pk_bf16_f32 v236, v216, v217
    v_cvt_pk_bf16_f32 v237, v218, v219
    v_cvt_pk_bf16_f32 v238, v220, v221
    v_cvt_pk_bf16_f32 v239, v222, v223
    v_permlane32_swap_b32 v232, v234
    v_permlane32_swap_b32 v233, v235
    v_permlane32_swap_b32 v236, v238
    v_permlane32_swap_b32 v237, v239
    ds_write_b128 v44, v[232:235]
    ds_write_b128 v46, v[236:239]
    ds_read_b128 v[232:235], v45
    ds_read_b128 v[236:239], v45 offset:1024
    s_waitcnt lgkmcnt(0)
    v_bfe_u32 v7, v201, 1, 4
    v_bfe_u32 v201, v201, 5, 7
    v_lshl_or_b32 v201, v7, 7, v201
    v_xor_b32 v201, 0x7ff, v201
    s_waitcnt vmcnt(0)
    v_max3_u32 v7, v192, v196, v200
    v_cmp_eq_u32 vcc, -1, v7
    s_cbranch_vccz POK_46
PRE_47:
    buffer_load_dwordx4 v[192:195], v4, s[32:35], 0 offen sc1
    buffer_load_dwordx4 v[196:199], v5, s[32:35], 0 offen sc1
    buffer_load_dword v200, v6, s[32:35], 0 offen sc1
    s_waitcnt vmcnt(0)
    v_max3_u32 v7, v192, v196, v200
    v_cmp_eq_u32 vcc, -1, v7
    s_cbranch_vccz POK_46
    s_add_u32 s5, s5, 1
    s_cmp_lt_u32 s5, 200000
    s_cbranch_scc1 PRE_47
POK_46:
    v_add_f32_dpp v200, v200, v200 quad_perm:[1,0,3,2] row_mask:0xf bank_mask:0xf
    s_nop 1
    v_add_f32_dpp v200, v200, v200 quad_perm:[2,3,0,1] row_mask:0xf bank_mask:0xf
    s_nop 1
    v_add_f32_dpp v200, v200, v200 row_half_mirror row_mask:0xf bank_mask:0xf
    s_nop 1
    v_add_f32_dpp v200, v200, v200 row_mirror row_mask:0xf bank_mask:0xf
    v_cvt_pk_bf16_f32 v200, 0, v200
    v_ashrrev_i32 v7, 31, v200
    v_or_b32 v7, 0x80000000, v7
    v_xor_b32 v200, v200, v7
    v_lshrrev_b32 v200, 16, v200
    v_lshl_or_b32 v200, v200, 11, v201
    s_nop 0
    v_readlane_b32 s24, v200, 0
    v_readlane_b32 s25, v200, 16
    v_readlane_b32 s26, v200, 32
    s_not_b64 s[28:29], s[22:23]
    s_cmp_lt_u32 s24, s25
    s_cselect_b64 s[28:29], s[22:23], s[28:29]
    s_cselect_b32 s27, s24, s25
    s_cmp_gt_u32 s26, s27
    s_cselect_b64 vcc, s[28:29], 0
    v_cndmask_b32 v192, v192, v196, vcc
    v_cndmask_b32 v193, v193, v197, vcc
    v_cndmask_b32 v194, v194, v198, vcc
    v_cndmask_b32 v195, v195, v199, vcc
    s_bitcmp1_b32 vcc_lo, 0
    s_cselect_b32 s24, s26, s24
    s_cselect_b32 s19, s17, s19
    s_cselect_b32 s17, s95, s91
    s_bitcmp1_b32 vcc_lo, 8
    s_cselect_b32 s25, s26, s25
    s_cselect_b32 s19, s18, s19
    s_cselect_b32 s18, s95, s94
    s_waitcnt lgkmcnt(0)
    v_mfma_f32_16x16x32_bf16 v[136:139], v[192:195], v[56:59], 0
    v_mfma_f32_16x16x32_bf16 v[140:143], v[192:195], v[60:63], 0
    v_mfma_f32_16x16x32_bf16 v[144:147], v[192:195], v[64:67], 0
    v_mfma_f32_16x16x32_bf16 v[148:151], v[192:195], v[68:71], 0
    v_mfma_f32_16x16x32_bf16 v[168:171], v[192:195], v[72:75], 0
    v_mfma_f32_16x16x32_bf16 v[172:175], v[192:195], v[76:79], 0
    v_mfma_f32_16x16x32_bf16 v[176:179], v[192:195], v[80:83], 0
    v_mfma_f32_16x16x32_bf16 v[180:183], v[192:195], v[84:87], 0
    s_nop 1
    v_add_f32 v196, v136, v141
    s_nop 0
    v_add_f32 v197, v146, v151
    s_nop 0
    v_add_f32 v198, v168, v173
    s_nop 0
    v_add_f32 v199, v178, v183
    v_add_f32 v196, v196, v197
    v_add_f32 v198, v198, v199
    v_mov_b32 v197, s4
    s_nop 0
    v_permlane16_swap_b32 v198, v199
    s_cmp_ge_u32 s9, 28
    s_cbranch_scc1 L_NOHP
    v_add_f32 v196, v196, v199
    v_add_f32 v198, v196, 0
    v_mov_b32 v199, s4
    s_nop 0
    v_permlane32_swap_b32 v196, v198
    s_mov_b64 exec, 0xffff
    buffer_store_dwordx4 v[196:199], v2, s[32:35], s73 offen sc1
    s_mov_b64 exec, -1
L_NOHP:
    s_and_b32 s68, s24, 2047
    s_and_b32 s69, s25, 2047
    s_waitcnt lgkmcnt(0)
    s_cmp_lg_u32 s93, 7
    s_cbranch_scc1 L_NONON
    v_mov_b32 v6, s4
    v_mov_b32 v7, 0
    s_mov_b64 exec, 1
    buffer_store_dword v6, v7, s[32:35], 0 offen sc1
    s_mov_b64 exec, -1
L_NONON:
    s_cmp_ge_u32 s9, 28
    s_cbranch_scc1 L_FIN3
    v_bfe_u32 v192, v1, 2, 1
    v_lshlrev_b32 v192, 7, v192
    v_lshrrev_b32 v9, 5, v1
    v_lshl_add_u32 v192, v9, 4, v192
    v_add_u32 v192, 156672, v192
    v_lshrrev_b32 v193, 4, v1
    v_mul_u32_u24 v193, 7168, v193
    v_and_b32 v9, 15, v1
    v_lshl_add_u32 v193, v9, 3, v193
    s_lshl3_add_u32 s96, s75, s3
    s_mul_i32 s97, s96, 28672
    s_lshl_b32 s98, s74, 7
    s_add_u32 s99, s97, s98
    s_add_u32 s80, s99, 22020096
    v_and_b32 v194, 1, v1
    v_lshlrev_b32 v194, 13, v194
    v_bfe_u32 v9, v1, 1, 1
    v_lshl_add_u32 v194, v9, 18, v194
    s_lshr_b32 s96, s9, 2
    s_and_b32 s97, s75, 1
    s_lshr_b32 s98, s3, 1
    s_lshl2_add_u32 s99, s97, s98
    s_and_b32 s97, s3, 1
    s_lshr_b32 s98, s75, 1
    s_lshl2_add_u32 s97, s97, s98
    s_lshl3_add_u32 s98, s99, s97
    s_lshl_b32 s99, s98, 12
    s_lshl_b32 s97, s8, 6
    s_add_u32 s98, s99, s97
    s_lshl2_add_u32 s99, s96, s98
    s_add_u32 s97, s99, 1048576
    s_add_u32 s81, s97, 3072
    s_cmp_lt_u32 s3, 4
    s_cbranch_scc1 L_HW
    s_barrier
    ds_read_b64_tr_b16 v[120:121], v35
    ds_read_b64_tr_b16 v[122:123], v35 offset:1024
    ds_read_b64_tr_b16 v[124:125], v35 offset:8192
    ds_read_b64_tr_b16 v[126:127], v35 offset:9216
    ds_read_b64_tr_b16 v[128:129], v35 offset:16384
    ds_read_b64_tr_b16 v[130:131], v35 offset:17408
    ds_read_b64_tr_b16 v[132:133], v35 offset:24576
    ds_read_b64_tr_b16 v[134:135], v35 offset:25600
    s_cmp_lg_u32 s3, 7
    s_cbranch_scc1 L_NOH
    s_bitcmp1_b32 s9, 3
    s_cselect_b32 s15, s25, s24
    s_cselect_b32 s17, s18, s17
    s_andn2_b32 s18, 2047, s15
    s_lshr_b32 s96, s8, 1
    s_lshl2_add_u32 s19, s12, s96
    s_lshr_b32 s96, s19, 1
    s_lshr_b32 s97, s9, 3
    s_lshl_b32 s98, s97, 1
    s_lshl2_add_u32 s99, s96, s98
    s_and_b32 s97, s19, 1
    s_add_u32 s96, s99, s97
    s_mul_i32 s98, s96, 7168
    s_add_u32 s20, s98, 22020096
    s_lshl_b32 s96, s18, 11
    s_lshl_b32 s97, s19, 5
    s_add_u32 s82, s96, s97
    v_and_b32 v10, 7, v1
    v_lshlrev_b32 v10, 2, v10
    s_lshr_b32 s96, s8, 1
    s_lshl_b32 s97, s96, 6
    s_add_u32 s13, s97, 157184
    v_and_b32 v5, 7, v1
    v_lshl_add_u32 v5, v5, 3, s13
    ds_read_b64 v[206:207], v5
    s_and_b32 s96, s17, 31
    s_lshl_b32 s97, s96, 13
    s_lshl_b32 s98, s12, 9
    s_add_u32 s99, s97, s98
    s_lshr_b32 s96, s8, 1
    s_lshl_b32 s97, s96, 5
    s_add_u32 s98, s99, s97
    s_add_u32 s91, s98, 13631488
    s_lshr_b32 s13, s15, 11
    s_lshl_b32 s13, s13, 16
    s_ashr_i32 s15, s13, 31
    s_andn2_b32 s15, 0x7fff0000, s15
    s_or_b32 s15, s15, 0x80000000
    s_xor_b32 s13, s13, s15
    v_mov_b32 v204, s13
    v_mul_f32 v204, s7, v204
    v_exp_f32 v204, -v204
L_PAD10:
    s_cbranch_execz L_RET10
    s_nop 0
    v_add_f32 v204, 1.0, v204
    v_rcp_f32 v204, v204
    s_nop 0
    v_cvt_pk_bf16_f32 v204, 0, v204
    v_mov_b32 v5, s4
    v_not_b32 v6, v5
POLL_48:
    buffer_load_dword v244, v10, s[32:35], s91 offen sc1
    buffer_load_dword v245, v10, s[32:35], s91 offen offset:128 sc1
    s_waitcnt vmcnt(0)
    v_max_u32 v246, v244, v245
    v_cmp_ne_u32 vcc, -1, v246
    s_nop 1
    v_cndmask_b32 v246, v6, v5, vcc
    v_cmp_ne_u32 vcc, s4, v246
    s_cbranch_vccz PDONE_49
    s_add_u32 s5, s5, 1
    s_cmp_lt_u32 s5, 200000
    s_cbranch_scc1 POLL_48
PDONE_49:
    v_lshlrev_b32 v246, 16, v245
    v_and_b32 v247, s6, v245
    v_and_b32 v245, s6, v244
    v_lshlrev_b32 v244, 16, v244
    s_branch L_NOH
L_HW:
    s_lshl_b32 s96, s3, 8
    s_add_u32 s13, s96, s72
    v_lshrrev_b32 v4, 4, v1
    v_lshlrev_b32 v4, 11, v4
    v_and_b32 v9, 15, v1
    v_lshl_add_u32 v4, v9, 4, v4
    s_lshl_b32 s96, s3, 5
    s_add_u32 s15, s96, 156672
    v_lshrrev_b32 v5, 5, v1
    v_lshl_add_u32 v5, v5, 7, s15
    v_bfe_u32 v9, v1, 2, 1
    v_lshl_add_u32 v5, v9, 4, v5
    v_bfe_u32 v9, v1, 1, 1
    v_lshl_add_u32 v5, v9, 3, v5
    v_bfe_u32 v9, v1, 3, 1
    v_lshl_add_u32 v5, v9, 2, v5
    v_and_b32 v9, 1, v1
    v_lshl_add_u32 v5, v9, 1, v5
    s_load_dword s24, s[32:33], s13 offset:1276 glc
    s_load_dword s25, s[32:33], s13 offset:3324 glc
    s_load_dword s26, s[32:33], s13 offset:5372 glc
    s_load_dword s27, s[32:33], s13 offset:7420 glc
    s_barrier
    ds_read_b64_tr_b16 v[120:121], v35
    ds_read_b64_tr_b16 v[122:123], v35 offset:1024
    ds_read_b64_tr_b16 v[124:125], v35 offset:8192
    ds_read_b64_tr_b16 v[126:127], v35 offset:9216
    ds_read_b64_tr_b16 v[128:129], v35 offset:16384
    ds_read_b64_tr_b16 v[130:131], v35 offset:17408
    ds_read_b64_tr_b16 v[132:133], v35 offset:24576
    ds_read_b64_tr_b16 v[134:135], v35 offset:25600
    s_branch SCHK_51
SPOLL_50:
    s_load_dword s24, s[32:33], s13 offset:1276 glc
    s_load_dword s25, s[32:33], s13 offset:3324 glc
    s_load_dword s26, s[32:33], s13 offset:5372 glc
    s_load_dword s27, s[32:33], s13 offset:7420 glc
SCHK_51:
    s_add_u32 s5, s5, 1
    s_cmp_ge_u32 s5, 200000
    s_waitcnt lgkmcnt(0)
    s_cbranch_scc1 SDONE_52
    s_cmp_lg_u32 s24, s4
    s_cbranch_scc1 SPOLL_50
    s_cmp_lg_u32 s25, s4
    s_cbranch_scc1 SPOLL_50
    s_cmp_lg_u32 s26, s4
    s_cbranch_scc1 SPOLL_50
    s_cmp_lg_u32 s27, s4
    s_cbranch_scc1 SPOLL_50
SDONE_52:
POLL_53:
    buffer_load_dwordx4 v[88:91], v4, s[32:35], s13 offen sc1
    buffer_load_dwordx4 v[92:95], v4, s[32:35], s13 offen offset:1024 sc1
    s_waitcnt vmcnt(0)
    v_bitop3_b32 v6, v89, v91, s4 bitop3:0x7e
    v_bitop3_b32 v6, v6, v93, s4 bitop3:0xf6
    v_bitop3_b32 v6, v6, v95, s4 bitop3:0xf6
    v_cmp_ne_u32 vcc, 0, v6
    s_cbranch_vccz PDONE_54
    s_add_u32 s5, s5, 1
    s_cmp_lt_u32 s5, 200000
    s_cbranch_scc1 POLL_53
PDONE_54:
    v_permlane32_swap_b32 v88, v90
    v_permlane32_swap_b32 v92, v94
    v_add_f32 v88, v88, v90
    v_add_f32 v92, v92, v94
    v_mov_b32 v90, v88
    v_mov_b32 v94, v92
    s_nop 0
    v_permlane16_swap_b32 v88, v90
    v_permlane16_swap_b32 v92, v94
    v_add_f32 v88, v88, v90
    v_add_f32 v92, v92, v94
    v_cvt_pk_bf16_f32 v88, 0, v88
    v_cvt_pk_bf16_f32 v92, 0, v92
    v_mul_f32 v6, s7, v88
    v_exp_f32 v6, -v6
    s_nop 0
    v_add_f32 v6, 1.0, v6
    v_rcp_f32 v6, v6
    s_nop 0
    v_mul_f32 v88, v88, v6
    v_cvt_pk_bf16_f32 v88, 0, v88
    v_mul_f32 v88, v88, v92
    v_cvt_pk_bf16_f32 v88, v88, v88
    ds_write_b16 v5, v88
L_NOH:
    s_waitcnt lgkmcnt(0)
    s_barrier
    ds_read_b128 v[88:91], v192
    ds_read_b128 v[92:95], v192 offset:32
    ds_read_b128 v[96:99], v192 offset:64
    ds_read_b128 v[100:103], v192 offset:96
    s_waitcnt lgkmcnt(3)
    v_mfma_f32_32x32x16_bf16 v[208:223], v[88:91], v[120:123], 0
    s_waitcnt lgkmcnt(2)
    v_mfma_f32_32x32x16_bf16 v[208:223], v[92:95], v[124:127], v[208:223]
    s_waitcnt lgkmcnt(1)
    v_mfma_f32_32x32x16_bf16 v[208:223], v[96:99], v[128:131], v[208:223]
    s_waitcnt lgkmcnt(0)
    v_mfma_f32_32x32x16_bf16 v[208:223], v[100:103], v[132:135], v[208:223]
    s_nop 11
    v_mov_b32 v209, s4
    buffer_store_dwordx2 v[208:209], v193, s[32:35], s80 offen sc1
    s_mov_b64 exec, 15
    buffer_store_dword v209, v194, s[32:35], s81 offen sc1
    s_mov_b64 exec, -1
    s_barrier
    s_branch L_FIN2
L_FIN3:
    s_waitcnt lgkmcnt(0)
L_FIN2:
    v_cmp_ne_u32 vcc, s68, v42
    v_cmp_ne_u32 s[22:23], s69, v42
    s_nop 0
    s_and_b64 exec, vcc, s[22:23]
    buffer_store_dwordx4 v[232:235], v33, s[64:67], s70 offen sc1
    s_mov_b64 exec, -1
    v_cmp_ne_u32 vcc, s68, v43
    v_cmp_ne_u32 s[22:23], s69, v43
    s_nop 0
    s_and_b64 exec, vcc, s[22:23]
    buffer_store_dwordx4 v[236:239], v33, s[64:67], s71 offen sc1
    s_mov_b64 exec, -1
    s_cmp_ge_u32 s9, 16
    s_cbranch_scc1 L_FIN
SPOLL_55:
    s_load_dwordx8 s[24:31], s[32:33], s92 offset:3072 glc
SCHK_56:
    s_add_u32 s5, s5, 1
    s_cmp_ge_u32 s5, 200000
    s_waitcnt lgkmcnt(0)
    s_cbranch_scc1 SDONE_57
    s_cmp_lg_u32 s24, s4
    s_cbranch_scc1 SPOLL_55
    s_cmp_lg_u32 s25, s4
    s_cbranch_scc1 SPOLL_55
    s_cmp_lg_u32 s26, s4
    s_cbranch_scc1 SPOLL_55
    s_cmp_lg_u32 s27, s4
    s_cbranch_scc1 SPOLL_55
    s_cmp_lg_u32 s28, s4
    s_cbranch_scc1 SPOLL_55
    s_cmp_lg_u32 s29, s4
    s_cbranch_scc1 SPOLL_55
    s_cmp_lg_u32 s30, s4
    s_cbranch_scc1 SPOLL_55
SDONE_57:
    s_barrier
    s_cmp_lg_u32 s3, 7
    s_cbranch_scc1 L_FIN
    s_add_u32 s13, s20, 4096
POLL_58:
    buffer_load_dwordx4 v[88:91], v2, s[32:35], s20 offen sc1
    buffer_load_dwordx4 v[92:95], v2, s[32:35], s20 offen offset:1024 sc1
    buffer_load_dwordx4 v[96:99], v2, s[32:35], s20 offen offset:2048 sc1
    buffer_load_dwordx4 v[100:103], v2, s[32:35], s20 offen offset:3072 sc1
    buffer_load_dwordx4 v[104:107], v2, s[32:35], s13 offen sc1
    buffer_load_dwordx4 v[108:111], v2, s[32:35], s13 offen offset:1024 sc1
    buffer_load_dwordx4 v[112:115], v2, s[32:35], s13 offen offset:2048 sc1
    s_waitcnt vmcnt(0)
    v_bitop3_b32 v4, v89, v91, s4 bitop3:0x7e
    v_bitop3_b32 v4, v4, v93, s4 bitop3:0xf6
    v_bitop3_b32 v4, v4, v95, s4 bitop3:0xf6
    v_bitop3_b32 v4, v4, v97, s4 bitop3:0xf6
    v_bitop3_b32 v4, v4, v99, s4 bitop3:0xf6
    v_bitop3_b32 v4, v4, v101, s4 bitop3:0xf6
    v_bitop3_b32 v4, v4, v103, s4 bitop3:0xf6
    v_bitop3_b32 v4, v4, v105, s4 bitop3:0xf6
    v_bitop3_b32 v4, v4, v107, s4 bitop3:0xf6
    v_bitop3_b32 v4, v4, v109, s4 bitop3:0xf6
    v_bitop3_b32 v4, v4, v111, s4 bitop3:0xf6
    v_bitop3_b32 v4, v4, v113, s4 bitop3:0xf6
    v_bitop3_b32 v4, v4, v115, s4 bitop3:0xf6
    v_cmp_ne_u32 vcc, 0, v4
    s_cbranch_vccz PDONE_59
    s_add_u32 s5, s5, 1
    s_cmp_lt_u32 s5, 200000
    s_cbranch_scc1 POLL_58
PDONE_59:
    v_add_f32 v88, v88, v92
    v_add_f32 v90, v90, v94
    v_add_f32 v96, v96, v100
    v_add_f32 v98, v98, v102
    v_add_f32 v104, v104, v108
    v_add_f32 v106, v106, v110
    v_add_f32 v88, v88, v96
    v_add_f32 v90, v90, v98
    v_add_f32 v104, v104, v112
    v_add_f32 v106, v106, v114
    v_add_f32 v88, v88, v104
    v_add_f32 v89, v90, v106
    s_nop 1
    v_permlane32_swap_b32 v88, v89
    v_add_f32 v88, v88, v89
    s_nop 1
    v_add_f32_dpp v88, v88, v88 row_ror:8 row_mask:0xf bank_mask:0xf
    v_mov_b32 v89, v88
    s_nop 1
    v_permlane16_swap_b32 v88, v89
    v_add_f32 v89, v88, v89
    v_cvt_pk_bf16_f32 v88, 0, v89
    v_cvt_pk_bf16_f32 v89, 0, v89
    s_nop 1
    v_permlane32_swap_b32 v88, v89
    v_pk_mul_f32 v[88:89], v[88:89], v[204:205] op_sel_hi:[1,0]
    v_cvt_pk_bf16_f32 v88, 0, v88
    v_cvt_pk_bf16_f32 v89, 0, v89
    v_pk_add_f32 v[88:89], v[88:89], v[244:245]
    v_cvt_pk_bf16_f32 v88, 0, v88
    v_cvt_pk_bf16_f32 v89, 0, v89
    v_pk_mul_f32 v[88:89], v[88:89], v[206:207]
    v_cvt_pk_bf16_f32 v88, 0, v88
    v_cvt_pk_bf16_f32 v89, 0, v89
    v_pk_add_f32 v[88:89], v[88:89], v[246:247]
    v_cvt_pk_bf16_f32 v88, v88, v89
    s_mov_b64 exec, 0xff
    buffer_store_dword v88, v10, s[64:67], s82 offen
    s_mov_b64 exec, -1
L_FIN:
L_END:
    s_endpgm
.p2align 10
.fill 768, 4, 0xbf800000
.section .rodata,"a"
.p2align 6
.amdhsa_kernel adaLN_cond__linear_kernel_hedgehog__moe_arch_mod__prompt_kernel
  .amdhsa_next_free_vgpr 256
  .amdhsa_next_free_sgpr 102
  .amdhsa_accum_offset 256
  .amdhsa_group_segment_fixed_size 0
  .amdhsa_kernarg_size 112
  .amdhsa_user_sgpr_count 2
  .amdhsa_user_sgpr_kernarg_segment_ptr 1
  .amdhsa_system_sgpr_workgroup_id_x 1
  .amdhsa_float_denorm_mode_32 3
  .amdhsa_float_denorm_mode_16_64 3
.end_amdhsa_kernel
```

```asm
; @launch grid=(256,1,1) block=(512,1,1) lds=163840
.amdgcn_target "amdgcn-amd-amdhsa--gfx950"
.text
.globl adaLN_cond__linear_kernel_hedgehog__moe_arch_mod__prompt_kernel
.p2align 12
.type adaLN_cond__linear_kernel_hedgehog__moe_arch_mod__prompt_kernel,@function
adaLN_cond__linear_kernel_hedgehog__moe_arch_mod__prompt_kernel:
    s_load_dwordx16 s[68:83], s[0:1], 0
    s_load_dwordx8 s[84:91], s[0:1], 64
    s_load_dwordx2 s[32:33], s[0:1], 104
    s_cmp_ge_u32 s2, 256
    s_cbranch_scc1 L_END
    v_lshrrev_b32 v4, 6, v0
    v_and_b32 v1, 63, v0
    s_nop 0
    v_readfirstlane_b32 s3, v4
    v_lshlrev_b32 v2, 4, v1
    s_mov_b32 s38, 4194304
    s_mov_b32 s39, 0x20000
    s_mov_b32 s50, 12582912
    s_mov_b32 s51, 0x20000
    s_mov_b32 s34, 268435456
    s_mov_b32 s35, 0x20000
    s_mov_b32 s42, 6291456
    s_mov_b32 s43, 0x20000
    s_mov_b32 s46, 2097152
    s_mov_b32 s47, 0x20000
    s_mov_b32 s54, 7340032
    s_mov_b32 s55, 0x20000
    s_mov_b32 s58, 7340032
    s_mov_b32 s59, 0x20000
    s_mov_b32 s62, 7340032
    s_mov_b32 s63, 0x20000
    s_mov_b32 s66, 4194304
    s_mov_b32 s67, 0x20000
    s_mov_b32 s5, 0
    s_mov_b32 s6, 0xffff0000
    s_mov_b32 s7, 0x3fb8aa3b
    s_and_b32 s8, s2, 7
    s_lshr_b32 s9, s2, 3
    s_lshl3_add_u32 s93, s2, s3
    s_and_b32 s96, s8, 4
    s_lshr_b32 s97, s9, 2
    s_lshl1_add_u32 s10, s96, s97
    s_and_b32 s96, s8, 3
    s_and_b32 s97, s9, 3
    s_xor_b32 s98, s97, 2
    s_lshl2_add_u32 s11, s96, s98
    s_and_b32 s96, s8, 1
    s_and_b32 s97, s9, 7
    s_lshl3_add_u32 s12, s96, s97
    s_lshr_b32 s96, s8, 1
    s_lshr_b32 s97, s9, 3
    s_lshl2_add_u32 s21, s96, s97
    s_lshl_b32 s96, s2, 6
    s_add_u32 s97, s96, s3
    s_lshl_b32 s98, s97, 6
    s_add_u32 s92, s98, 1048576
    s_lshr_b32 s96, s8, 1
    s_lshl_b32 s97, s96, 8
    s_lshl3_add_u32 s98, s9, s97
    s_add_u32 s99, s98, s3
    s_lshl_b32 s96, s99, 12
    s_and_b32 s97, s8, 1
    s_lshl_b32 s98, s97, 10
    s_add_u32 s16, s96, s98
    v_and_b32 v8, 31, v1
    v_lshlrev_b32 v8, 4, v8
    v_lshrrev_b32 v9, 5, v1
    v_lshl_add_u32 v8, v9, 11, v8
    s_lshl3_add_u32 s96, s8, s3
    s_lshl_b32 s15, s96, 5
    s_mul_i32 s96, s15, 6144
    s_xor_b32 s97, s9, 1
    s_lshl_b32 s98, s97, 7
    s_add_u32 s13, s96, s98
    s_add_u32 s14, s13, 12288
    s_lshl3_add_u32 s96, s21, s3
    s_lshl_b32 s97, s96, 15
    s_lshl_b32 s98, s12, 7
    s_add_u32 s18, s97, s98
    s_lshr_b32 s96, s8, 1
    s_lshl4_add_u32 s97, s96, s12
    s_lshl4_add_u32 s98, s97, s3
    s_lshl_b32 s99, s98, 9
    s_add_u32 s17, s99, 524288
    v_lshrrev_b32 v248, 3, v1
    v_mul_u32_u24 v248, 24576, v248
    v_and_b32 v9, 7, v1
    v_lshl_add_u32 v248, v9, 4, v248
    v_lshrrev_b32 v249, 3, v1
    v_lshl_add_u32 v249, v249, 2, s15
    v_and_b32 v10, 7, v1
    v_lshlrev_b32 v10, 4, v10
    v_lshrrev_b32 v11, 3, v1
    v_lshlrev_b32 v11, 4, v11
    v_xor_b32 v10, v10, v11
    v_lshrrev_b32 v11, 3, v1
    v_lshlrev_b32 v11, 11, v11
    v_add_u32 v10, v10, v11
    s_waitcnt lgkmcnt(0)
    global_load_dword v169, v249, s[86:87]
    s_mov_b64 s[48:49], s[88:89]
    buffer_load_dwordx4 v[160:163], v248, s[48:51], s13 offen nt
    buffer_load_dwordx4 v[164:167], v248, s[48:51], s14 offen nt
    s_load_dword s4, s[32:33], 0
    s_mov_b64 s[36:37], s[68:69]
    s_load_dword s24, s[32:33], s92 offset:0 glc
    s_load_dword s25, s[32:33], s17 offset:508 glc
    s_load_dword s26, s[32:33], s17 offset:4604 glc
    s_barrier
    buffer_load_dwordx4 v[152:155], v8, s[36:39], s16 offen nt
    buffer_load_dwordx4 v[156:159], v8, s[36:39], s16 offen offset:512 nt
    s_mov_b64 s[40:41], s[70:71]
    s_mov_b64 s[44:45], s[74:75]
    s_mov_b64 s[52:53], s[80:81]
    s_mov_b64 s[56:57], s[82:83]
    s_mov_b64 s[60:61], s[84:85]
    s_mov_b64 s[64:65], s[90:91]
    s_getpc_b64 s[22:23]
    s_and_b32 s22, s22, 0xfffffc00
    s_lshl3_add_u32 s96, s9, s3
    s_lshl_b32 s19, s96, 7
    v_lshrrev_b32 v4, 5, v1
    v_lshl_add_u32 v4, v4, 15, s19
    v_min_u32 v4, 41984, v4
    global_load_dword v11, v4, s[22:23]
    s_lshr_b32 s76, s3, 2
    s_and_b32 s77, s3, 3
    s_lshl_b32 s83, s3, 10
    s_mul_i32 s96, s8, 7
    s_lshr_b32 s97, s9, 2
    s_add_u32 s74, s96, s97
    s_and_b32 s75, s9, 3
    v_bfe_u32 v6, v1, 4, 1
    v_lshlrev_b32 v6, 6, v6
    v_and_b32 v3, 7, v1
    v_lshlrev_b32 v3, 4, v3
    v_xor_b32 v3, v3, v6
    v_lshrrev_b32 v6, 3, v1
    v_mul_u32_u24 v6, 6144, v6
    v_add_u32 v3, v3, v6
    s_and_b32 s84, s9, 12
    s_mul_i32 s96, s3, 49152
    s_lshl_b32 s97, s11, 7
    s_add_u32 s85, s96, s97
    v_lshlrev_b32 v250, 3, v1
    v_add_u32 v251, 147456, v2
    s_lshr_b32 s96, s3, 2
    s_lshl_b32 s97, s96, 10
    s_add_u32 s13, s97, 147456
    s_and_b32 s14, s3, 3
    v_and_b32 v252, 3, v1
    v_xor_b32 v252, s14, v252
    v_lshl_add_u32 v252, v252, 2, s13
    v_lshrrev_b32 v6, 4, v1
    v_lshlrev_b32 v6, 5, v6
    v_and_b32 v9, 7, v1
    v_lshl_add_u32 v6, v9, 7, v6
    v_bfe_u32 v9, v1, 3, 1
    v_lshl_add_u32 v6, v9, 4, v6
    v_add_u32 v252, v252, v6
    s_lshl_b32 s96, s3, 11
    s_add_u32 m0, s96, 131072
    s_nop 0
    buffer_load_dwordx4 v10, s[36:39], s18 offen lds
    s_add_u32 s18, s18, 16384
    s_lshl_b32 s96, s3, 11
    s_add_u32 m0, s96, 132096
    s_nop 0
    buffer_load_dwordx4 v10, s[36:39], s18 offen lds
    s_lshr_b32 s96, s3, 1
    s_xor_b32 s97, s9, 1
    s_and_b32 s98, s97, 15
    s_lshl4_add_u32 s99, s96, s98
    s_lshr_b32 s97, s9, 4
    s_lshl1_add_u32 s96, s99, s97
    s_lshl3_add_u32 s98, s96, s8
    s_lshl_b32 s99, s98, 9
    s_add_u32 s13, s99, 524288
    s_and_b32 s96, s9, 24
    s_add_u32 s97, s96, s3
    s_and_b32 s98, s8, 6
    s_lshl3_add_u32 s99, s97, s98
    s_lshl_b32 s96, s99, 12
    s_and_b32 s97, s9, 7
    s_lshl_b32 s98, s97, 9
    s_add_u32 s99, s96, s98
    s_and_b32 s97, s8, 1
    s_lshl_b32 s96, s97, 8
    s_add_u32 s98, s99, s96
    s_add_u32 s20, s98, 2097152
    s_waitcnt vmcnt(7)
    v_lshlrev_b32 v168, 16, v169
    v_and_b32 v169, s6, v169
    v_mul_f32 v4, s7, v168
    v_exp_f32 v4, -v4
    s_nop 0
    v_add_f32 v4, 1.0, v4
    v_rcp_f32 v4, v4
    s_nop 0
    v_mul_f32 v168, v168, v4
    v_cvt_pk_bf16_f32 v168, 0, v168
    v_mul_f32 v5, s7, v169
    v_exp_f32 v5, -v5
    s_nop 0
    v_add_f32 v5, 1.0, v5
    v_rcp_f32 v5, v5
    s_nop 0
    v_mul_f32 v169, v169, v5
    v_cvt_pk_bf16_f32 v169, 0, v169
    s_waitcnt vmcnt(5)
    s_lshr_b32 s96, s9, 4
    s_lshl_b32 s94, s96, 1
    s_add_u32 s96, s94, s84
    s_and_b32 s97, s96, 15
    s_mul_i32 s98, s97, 393216
    s_add_u32 s91, s98, s85
    s_lshl_b32 s96, s94, 13
    s_add_u32 s94, s96, s83
    s_add_u32 s82, s91, 2048
    s_mov_b32 m0, s94
    s_nop 0
    buffer_load_dwordx4 v3, s[40:43], s82 offen lds
    s_add_u32 s82, s91, 4096
    s_add_u32 m0, s94, 49152
    s_nop 0
    buffer_load_dwordx4 v3, s[40:43], s82 offen lds
    v_lshlrev_b32 v4, 16, v160
    v_and_b32 v5, s6, v160
    v_pk_mul_f32 v[176:177], v[168:169], v[4:5] op_sel:[0,0] op_sel_hi:[0,1]
    v_lshlrev_b32 v6, 16, v161
    v_and_b32 v7, s6, v161
    v_pk_mul_f32 v[178:179], v[168:169], v[6:7] op_sel:[0,0] op_sel_hi:[0,1]
    v_lshlrev_b32 v4, 16, v162
    v_and_b32 v5, s6, v162
    v_pk_mul_f32 v[180:181], v[168:169], v[4:5] op_sel:[0,0] op_sel_hi:[0,1]
    v_lshlrev_b32 v6, 16, v163
    v_and_b32 v7, s6, v163
    v_pk_mul_f32 v[182:183], v[168:169], v[6:7] op_sel:[0,0] op_sel_hi:[0,1]
    v_lshlrev_b32 v4, 16, v164
    v_and_b32 v5, s6, v164
    v_pk_fma_f32 v[176:177], v[168:169], v[4:5], v[176:177] op_sel:[1,0,0] op_sel_hi:[1,1,1]
    v_lshlrev_b32 v6, 16, v165
    v_and_b32 v7, s6, v165
    v_pk_fma_f32 v[178:179], v[168:169], v[6:7], v[178:179] op_sel:[1,0,0] op_sel_hi:[1,1,1]
    v_lshlrev_b32 v4, 16, v166
    v_and_b32 v5, s6, v166
    v_pk_fma_f32 v[180:181], v[168:169], v[4:5], v[180:181] op_sel:[1,0,0] op_sel_hi:[1,1,1]
    v_lshlrev_b32 v6, 16, v167
    v_and_b32 v7, s6, v167
    v_pk_fma_f32 v[182:183], v[168:169], v[6:7], v[182:183] op_sel:[1,0,0] op_sel_hi:[1,1,1]
    v_permlane32_swap_b32 v176, v180
    v_permlane32_swap_b32 v177, v181
    v_permlane32_swap_b32 v178, v182
    v_permlane32_swap_b32 v179, v183
    v_add_f32 v176, v176, v180
    v_add_f32 v177, v177, v181
    v_add_f32 v178, v178, v182
    v_add_f32 v179, v179, v183
    s_nop 0
    v_permlane16_swap_b32 v176, v178
    v_permlane16_swap_b32 v177, v179
    v_add_f32 v176, v176, v178
    v_add_f32 v177, v177, v179
    s_nop 0
    v_add_f32_dpp v176, v176, v176 row_ror:8 row_mask:0xf bank_mask:0xf
    v_add_f32_dpp v177, v177, v177 row_ror:8 row_mask:0xf bank_mask:0xf
    s_nop 1
    v_mov_b32_dpp v176, v177 quad_perm:[0,1,2,3] row_mask:0xf bank_mask:0xc
    s_waitcnt lgkmcnt(0)
    s_mul_i32 s4, s4, 0x9e3779b1
    s_add_u32 s4, s4, 0x7f4a7c15
    ds_write_b32 v252, v176
    s_waitcnt lgkmcnt(0)
    s_barrier
    ds_read_b128 v[176:179], v251
    ds_read_b128 v[180:183], v251 offset:1024
    s_waitcnt lgkmcnt(0)
    v_pk_add_f32 v[176:177], v[176:177], v[178:179]
    v_pk_add_f32 v[180:181], v[180:181], v[182:183]
    v_pk_add_f32 v[176:177], v[176:177], v[180:181]
    v_add_f32 v176, v176, v177
    v_mov_b32 v177, s4
    s_bitcmp1_b32 s3, 0
    s_cselect_b32 exec_lo, 0, -1
    s_cselect_b32 exec_hi, -1, 0
    buffer_store_dwordx2 v[176:177], v250, s[32:35], s13 offen sc1
    s_mov_b64 exec, -1
    s_waitcnt vmcnt(6)
    v_mov_b32 v8, 0x3f803f80
    v_dot2_f32_bf16 v4, v152, v8, 0
    v_dot2_f32_bf16 v5, v152, v152, 0
    v_dot2_f32_bf16 v6, v153, v8, 0
    v_dot2_f32_bf16 v7, v153, v153, 0
    v_dot2_f32_bf16 v4, v154, v8, v4
    v_dot2_f32_bf16 v5, v154, v154, v5
    v_dot2_f32_bf16 v6, v155, v8, v6
    v_dot2_f32_bf16 v7, v155, v155, v7
    v_dot2_f32_bf16 v4, v156, v8, v4
    v_dot2_f32_bf16 v5, v156, v156, v5
    v_dot2_f32_bf16 v6, v157, v8, v6
    v_dot2_f32_bf16 v7, v157, v157, v7
    v_dot2_f32_bf16 v4, v158, v8, v4
    v_dot2_f32_bf16 v5, v158, v158, v5
    v_dot2_f32_bf16 v6, v159, v8, v6
    v_dot2_f32_bf16 v7, v159, v159, v7
    s_lshl_b32 s96, s3, 5
    s_add_u32 s13, s96, 153600
    v_lshrrev_b32 v8, 5, v1
    v_lshl_add_u32 v8, v8, 4, s13
    v_bfe_u32 v9, v1, 4, 1
    v_lshl_add_u32 v8, v9, 3, v8
    v_pk_add_f32 v[172:173], v[4:5], v[6:7]
    v_and_b32 v5, 15, v1
    v_lshlrev_b32 v5, 4, v5
    v_add_u32 v5, 153600, v5
    v_and_b32 v4, 15, v1
    v_lshlrev_b32 v4, 4, v4
    v_bfe_u32 v9, v1, 4, 1
    v_lshl_add_u32 v4, v9, 12, v4
    v_add_f32_dpp v172, v172, v172 quad_perm:[1,0,3,2] row_mask:0xf bank_mask:0xf
    v_add_f32_dpp v173, v173, v173 quad_perm:[1,0,3,2] row_mask:0xf bank_mask:0xf
    s_nop 0
    v_add_f32_dpp v172, v172, v172 quad_perm:[2,3,0,1] row_mask:0xf bank_mask:0xf
    v_add_f32_dpp v173, v173, v173 quad_perm:[2,3,0,1] row_mask:0xf bank_mask:0xf
    s_nop 0
    v_add_f32_dpp v172, v172, v172 row_half_mirror row_mask:0xf bank_mask:0xf
    v_add_f32_dpp v173, v173, v173 row_half_mirror row_mask:0xf bank_mask:0xf
    s_nop 0
    v_add_f32_dpp v172, v172, v172 row_mirror row_mask:0xf bank_mask:0xf
    v_add_f32_dpp v173, v173, v173 row_mirror row_mask:0xf bank_mask:0xf
    s_nop 1
    v_permlane16_swap_b32 v172, v173
    v_add_f32 v172, v172, v173
    v_mov_b32 v173, s4
    ds_write_b64 v8, v[172:173]
    s_waitcnt lgkmcnt(0)
    s_barrier
    ds_read_b128 v[172:175], v5
    s_waitcnt lgkmcnt(0)
    s_mov_b32 exec_hi, 0
    buffer_store_dwordx4 v[172:175], v4, s[32:35], s20 offen sc1
    s_mov_b32 exec_hi, -1
    s_mov_b32 s82, s91
    s_add_u32 m0, s94, 98304
    s_nop 0
    buffer_load_dwordx4 v3, s[40:43], s82 offen lds
    s_lshr_b32 s96, s9, 4
    s_lshl_b32 s97, s96, 1
    s_xor_b32 s94, s97, 1
    s_add_u32 s96, s94, s84
    s_and_b32 s97, s96, 15
    s_mul_i32 s98, s97, 393216
    s_add_u32 s91, s98, s85
    s_lshl_b32 s96, s94, 13
    s_add_u32 s94, s96, s83
    s_add_u32 s82, s91, 2048
    s_mov_b32 m0, s94
    s_nop 0
    buffer_load_dwordx4 v3, s[40:43], s82 offen lds
    s_load_dword s24, s[32:33], s17 offset:508 glc
    s_load_dword s25, s[32:33], s17 offset:4604 glc
    v_and_b32 v4, 31, v1
    v_lshlrev_b32 v4, 4, v4
    v_lshrrev_b32 v9, 5, v1
    v_lshl_add_u32 v4, v9, 12, v4
    s_and_b32 s14, s3, 3
    s_lshr_b32 s96, s3, 2
    s_lshl_b32 s97, s96, 10
    s_add_u32 s15, s97, 155648
    v_bfe_u32 v5, v1, 4, 1
    v_bfe_u32 v9, v1, 2, 1
    v_lshl_add_u32 v5, v9, 1, v5
    v_xor_b32 v5, s14, v5
    v_lshl_add_u32 v5, v5, 2, s15
    v_and_b32 v6, 1, v1
    v_lshlrev_b32 v6, 5, v6
    v_bfe_u32 v9, v1, 3, 2
    v_lshl_add_u32 v6, v9, 6, v6
    v_bfe_u32 v9, v1, 2, 1
    v_lshl_add_u32 v6, v9, 8, v6
    v_bfe_u32 v9, v1, 1, 1
    v_lshl_add_u32 v6, v9, 9, v6
    v_lshrrev_b32 v9, 5, v1
    v_lshl_add_u32 v6, v9, 11, v6
    v_add_u32 v5, v5, v6
    s_lshl3_add_u32 s96, s2, s3
    s_lshl_b32 s97, s96, 9
    s_add_u32 s14, s97, 2097152
    v_and_b32 v8, 31, v1
    v_lshlrev_b32 v8, 4, v8
    s_branch SCHK_2
SPOLL_1:
    s_load_dword s24, s[32:33], s17 offset:508 glc
    s_load_dword s25, s[32:33], s17 offset:4604 glc
SCHK_2:
    s_add_u32 s5, s5, 1
    s_cmp_ge_u32 s5, 200000
    s_waitcnt lgkmcnt(0)
    s_cbranch_scc1 SDONE_3
    s_cmp_lg_u32 s24, s4
    s_cbranch_scc1 SPOLL_1
    s_cmp_lg_u32 s25, s4
    s_cbranch_scc1 SPOLL_1
SDONE_3:
    buffer_load_dwordx4 v[176:179], v4, s[32:35], s17 offen sc1
    s_load_dword s24, s[32:33], s14 offset:252 glc
    s_load_dword s25, s[32:33], s14 offset:508 glc
    s_lshl_b32 s96, s3, 11
    s_add_u32 s15, s96, 131072
    v_lshrrev_b32 v216, 4, v1
    v_lshlrev_b32 v216, 4, v216
    v_and_b32 v217, 7, v1
    v_lshlrev_b32 v217, 4, v217
    v_xor_b32 v216, v216, v217
    v_and_b32 v217, 15, v1
    v_lshl_add_u32 v217, v217, 7, s15
    v_add_u32 v216, v216, v217
    v_xor_b32 v217, 64, v216
    s_waitcnt vmcnt(7)
    ds_read_b128 v[12:15], v216
    ds_read_b128 v[16:19], v217
    s_branch SCHK_6
SPOLL_5:
    s_load_dword s24, s[32:33], s14 offset:252 glc
    s_load_dword s25, s[32:33], s14 offset:508 glc
SCHK_6:
    s_add_u32 s5, s5, 1
    s_cmp_ge_u32 s5, 200000
    s_waitcnt lgkmcnt(0)
    s_cbranch_scc1 SDONE_7
    s_cmp_lg_u32 s24, s4
    s_cbranch_scc1 SPOLL_5
    s_cmp_lg_u32 s25, s4
    s_cbranch_scc1 SPOLL_5
SDONE_7:
    buffer_load_dwordx4 v[172:175], v8, s[32:35], s14 offen sc1
    s_add_u32 s82, s91, 4096
    s_add_u32 m0, s94, 49152
    s_nop 0
    buffer_load_dwordx4 v3, s[40:43], s82 offen lds
    s_mov_b32 s82, s91
    s_add_u32 m0, s94, 98304
    s_nop 0
    buffer_load_dwordx4 v3, s[40:43], s82 offen lds
    v_permlane32_swap_b32 v12, v14
    v_permlane32_swap_b32 v13, v15
    v_permlane32_swap_b32 v16, v18
    v_permlane32_swap_b32 v17, v19
    v_lshlrev_b32 v184, 16, v12
    v_and_b32 v185, s6, v12
    v_lshlrev_b32 v186, 16, v13
    v_and_b32 v187, s6, v13
    v_lshlrev_b32 v188, 16, v14
    v_and_b32 v189, s6, v14
    v_lshlrev_b32 v190, 16, v15
    v_and_b32 v191, s6, v15
    v_lshlrev_b32 v192, 16, v16
    v_and_b32 v193, s6, v16
    v_lshlrev_b32 v194, 16, v17
    v_and_b32 v195, s6, v17
    v_lshlrev_b32 v196, 16, v18
    v_and_b32 v197, s6, v18
    v_lshlrev_b32 v198, 16, v19
    v_and_b32 v199, s6, v19
    s_waitcnt vmcnt(3)
    v_bitop3_b32 v7, v177, v179, s4 bitop3:0x7e
    v_cmp_ne_u32 vcc, 0, v7
    s_cbranch_vccz TOK_8
POLL_9:
    buffer_load_dwordx4 v[176:179], v4, s[32:35], s17 offen sc1
    s_waitcnt vmcnt(0)
    v_bitop3_b32 v7, v177, v179, s4 bitop3:0x7e
    v_cmp_ne_u32 vcc, 0, v7
    s_cbranch_vccz PDONE_10
    s_add_u32 s5, s5, 1
    s_cmp_lt_u32 s5, 200000
    s_cbranch_scc1 POLL_9
PDONE_10:
TOK_8:
    ds_write2_b32 v5, v176, v178 offset0:0 offset1:4
    s_waitcnt lgkmcnt(0)
    s_barrier
    ds_read_b128 v[208:211], v251 offset:10240
    ds_read_b128 v[212:215], v251 offset:11264
    ds_read_b128 v[200:203], v251 offset:8192
    ds_read_b128 v[204:207], v251 offset:9216
    s_lshl_b32 s96, s11, 12
    s_lshl_b32 s97, s3, 9
    s_add_u32 s13, s96, s97
    v_add_u32 v4, s13, v2
    s_lshl_b32 s96, s3, 9
    s_add_u32 m0, s96, 159744
    s_mov_b32 exec_hi, 0
    global_load_lds_dwordx4 v4, s[72:73]
    s_mov_b32 exec_hi, -1
    s_lshl4_add_u32 s96, s21, s12
    s_lshr_b32 s97, s3, 1
    s_lshl2_add_u32 s98, s96, s97
    s_lshl_b32 s99, s98, 12
    s_and_b32 s96, s3, 1
    s_lshl_b32 s97, s96, 8
    s_add_u32 s98, s99, s97
    s_add_u32 s13, s98, 4194304
    v_and_b32 v4, 15, v1
    v_lshlrev_b32 v4, 4, v4
    v_bfe_u32 v9, v1, 4, 1
    v_lshl_add_u32 v4, v9, 10, v4
    v_lshrrev_b32 v9, 5, v1
    v_lshl_add_u32 v4, v9, 9, v4
    s_waitcnt lgkmcnt(2)
    v_pk_add_f32 v[208:209], v[208:209], v[210:211]
    v_pk_add_f32 v[212:213], v[212:213], v[214:215]
    v_pk_add_f32 v[208:209], v[208:209], v[212:213]
    v_add_f32 v208, v208, v209
    v_cvt_pk_bf16_f32 v208, 0, v208
    s_waitcnt lgkmcnt(0)
    v_pk_add_f32 v[200:201], v[200:201], v[202:203]
    v_pk_add_f32 v[204:205], v[204:205], v[206:207]
    v_pk_add_f32 v[200:201], v[200:201], v[204:205]
    v_add_f32 v200, v200, v201
    v_add_f32 v208, 1.0, v208
    v_cvt_pk_bf16_f32 v208, 0, v208
    v_cvt_pk_bf16_f32 v200, 0, v200
    s_waitcnt vmcnt(3)
    v_bitop3_b32 v7, v173, v175, s4 bitop3:0x7e
    v_cmp_ne_u32 vcc, 0, v7
    s_cbranch_vccz L_STOK
POLL_11:
    buffer_load_dwordx4 v[172:175], v8, s[32:35], s14 offen sc1
    s_waitcnt vmcnt(0)
    v_bitop3_b32 v7, v173, v175, s4 bitop3:0x7e
    v_cmp_ne_u32 vcc, 0, v7
    s_cbranch_vccz PDONE_12
    s_add_u32 s5, s5, 1
    s_cmp_lt_u32 s5, 200000
    s_cbranch_scc1 POLL_11
PDONE_12:
L_STOK:
    v_permlane16_swap_b32 v172, v174
    v_add_f32 v175, v172, v174
    v_mul_f32 v174, 0x3a800000, v175
    v_mul_f32 v175, 0x3a800000, v175
    s_nop 1
    v_permlane16_swap_b32 v174, v175
    v_fma_f32 v172, -v174, v174, v175
    v_cvt_pk_bf16_f32 v173, 0, v174
    v_max_f32 v172, 0, v172
    v_cvt_pk_bf16_f32 v172, 0, v172
    v_pk_add_f32 v[184:185], v[172:173], v[184:185] op_sel:[1,0] neg_lo:[1,0] neg_hi:[1,0]
    v_pk_add_f32 v[186:187], v[172:173], v[186:187] op_sel:[1,0] neg_lo:[1,0] neg_hi:[1,0]
    v_pk_add_f32 v[188:189], v[172:173], v[188:189] op_sel:[1,0] neg_lo:[1,0] neg_hi:[1,0]
    v_pk_add_f32 v[190:191], v[172:173], v[190:191] op_sel:[1,0] neg_lo:[1,0] neg_hi:[1,0]
    v_add_f32 v172, 0x3727c5ac, v172
    v_cvt_pk_bf16_f32 v172, 0, v172
    v_sqrt_f32 v172, v172
    s_nop 0
    v_pk_add_f32 v[192:193], v[172:173], v[192:193] op_sel:[1,0] neg_lo:[1,0] neg_hi:[1,0]
    v_pk_add_f32 v[194:195], v[172:173], v[194:195] op_sel:[1,0] neg_lo:[1,0] neg_hi:[1,0]
    v_pk_add_f32 v[196:197], v[172:173], v[196:197] op_sel:[1,0] neg_lo:[1,0] neg_hi:[1,0]
    v_pk_add_f32 v[198:199], v[172:173], v[198:199] op_sel:[1,0] neg_lo:[1,0] neg_hi:[1,0]
    v_cvt_pk_bf16_f32 v172, 0, v172
    v_rcp_f32 v172, v172
    v_cvt_pk_bf16_f32 v184, 0, v184
    v_cvt_pk_bf16_f32 v185, 0, v185
    v_cvt_pk_bf16_f32 v186, 0, v186
    v_cvt_pk_bf16_f32 v187, 0, v187
    v_cvt_pk_bf16_f32 v188, 0, v188
    v_cvt_pk_bf16_f32 v189, 0, v189
    v_cvt_pk_bf16_f32 v190, 0, v190
    v_cvt_pk_bf16_f32 v191, 0, v191
    v_cvt_pk_bf16_f32 v192, 0, v192
    v_cvt_pk_bf16_f32 v193, 0, v193
    v_cvt_pk_bf16_f32 v194, 0, v194
    v_cvt_pk_bf16_f32 v195, 0, v195
    v_cvt_pk_bf16_f32 v196, 0, v196
    v_cvt_pk_bf16_f32 v197, 0, v197
    v_cvt_pk_bf16_f32 v198, 0, v198
    v_cvt_pk_bf16_f32 v199, 0, v199
    v_pk_mul_f32 v[184:185], v[184:185], v[172:173] op_sel_hi:[1,0]
    v_pk_mul_f32 v[186:187], v[186:187], v[172:173] op_sel_hi:[1,0]
    v_pk_mul_f32 v[188:189], v[188:189], v[172:173] op_sel_hi:[1,0]
    v_pk_mul_f32 v[190:191], v[190:191], v[172:173] op_sel_hi:[1,0]
    v_pk_mul_f32 v[192:193], v[192:193], v[172:173] op_sel_hi:[1,0]
    v_pk_mul_f32 v[194:195], v[194:195], v[172:173] op_sel_hi:[1,0]
    v_pk_mul_f32 v[196:197], v[196:197], v[172:173] op_sel_hi:[1,0]
    v_pk_mul_f32 v[198:199], v[198:199], v[172:173] op_sel_hi:[1,0]
    v_cvt_pk_bf16_f32 v184, 0, v184
    v_cvt_pk_bf16_f32 v185, 0, v185
    v_cvt_pk_bf16_f32 v186, 0, v186
    v_cvt_pk_bf16_f32 v187, 0, v187
    v_cvt_pk_bf16_f32 v188, 0, v188
    v_cvt_pk_bf16_f32 v189, 0, v189
    v_cvt_pk_bf16_f32 v190, 0, v190
    v_cvt_pk_bf16_f32 v191, 0, v191
    v_cvt_pk_bf16_f32 v192, 0, v192
    v_cvt_pk_bf16_f32 v193, 0, v193
    v_cvt_pk_bf16_f32 v194, 0, v194
    v_cvt_pk_bf16_f32 v195, 0, v195
    v_cvt_pk_bf16_f32 v196, 0, v196
    v_cvt_pk_bf16_f32 v197, 0, v197
    v_cvt_pk_bf16_f32 v198, 0, v198
    v_cvt_pk_bf16_f32 v199, 0, v199
    v_mul_f32_dpp v184, v208, v184 row_newbcast:0 row_mask:0xf bank_mask:0xf
    v_mul_f32_dpp v185, v208, v185 row_newbcast:1 row_mask:0xf bank_mask:0xf
    v_mul_f32_dpp v186, v208, v186 row_newbcast:2 row_mask:0xf bank_mask:0xf
    v_mul_f32_dpp v187, v208, v187 row_newbcast:3 row_mask:0xf bank_mask:0xf
    v_mul_f32_dpp v188, v208, v188 row_newbcast:4 row_mask:0xf bank_mask:0xf
    v_mul_f32_dpp v189, v208, v189 row_newbcast:5 row_mask:0xf bank_mask:0xf
    v_mul_f32_dpp v190, v208, v190 row_newbcast:6 row_mask:0xf bank_mask:0xf
    v_mul_f32_dpp v191, v208, v191 row_newbcast:7 row_mask:0xf bank_mask:0xf
    v_cvt_pk_bf16_f32 v184, 0, v184
    v_cvt_pk_bf16_f32 v185, 0, v185
    v_cvt_pk_bf16_f32 v186, 0, v186
    v_cvt_pk_bf16_f32 v187, 0, v187
    v_cvt_pk_bf16_f32 v188, 0, v188
    v_cvt_pk_bf16_f32 v189, 0, v189
    v_cvt_pk_bf16_f32 v190, 0, v190
    v_cvt_pk_bf16_f32 v191, 0, v191
    v_add_f32_dpp v184, v200, v184 row_newbcast:0 row_mask:0xf bank_mask:0xf
    v_add_f32_dpp v185, v200, v185 row_newbcast:1 row_mask:0xf bank_mask:0xf
    v_add_f32_dpp v186, v200, v186 row_newbcast:2 row_mask:0xf bank_mask:0xf
    v_add_f32_dpp v187, v200, v187 row_newbcast:3 row_mask:0xf bank_mask:0xf
    v_add_f32_dpp v188, v200, v188 row_newbcast:4 row_mask:0xf bank_mask:0xf
    v_add_f32_dpp v189, v200, v189 row_newbcast:5 row_mask:0xf bank_mask:0xf
    v_add_f32_dpp v190, v200, v190 row_newbcast:6 row_mask:0xf bank_mask:0xf
    v_add_f32_dpp v191, v200, v191 row_newbcast:7 row_mask:0xf bank_mask:0xf
    v_cvt_pk_bf16_f32 v216, v184, v185
    v_cvt_pk_bf16_f32 v217, v186, v187
    v_cvt_pk_bf16_f32 v218, v188, v189
    v_cvt_pk_bf16_f32 v219, v190, v191
    buffer_store_dwordx4 v[216:219], v4, s[32:35], s13 offen sc1
    v_mul_f32_dpp v192, v208, v192 row_newbcast:8 row_mask:0xf bank_mask:0xf
    v_mul_f32_dpp v193, v208, v193 row_newbcast:9 row_mask:0xf bank_mask:0xf
    v_mul_f32_dpp v194, v208, v194 row_newbcast:10 row_mask:0xf bank_mask:0xf
    v_mul_f32_dpp v195, v208, v195 row_newbcast:11 row_mask:0xf bank_mask:0xf
    v_mul_f32_dpp v196, v208, v196 row_newbcast:12 row_mask:0xf bank_mask:0xf
    v_mul_f32_dpp v197, v208, v197 row_newbcast:13 row_mask:0xf bank_mask:0xf
    v_mul_f32_dpp v198, v208, v198 row_newbcast:14 row_mask:0xf bank_mask:0xf
    v_mul_f32_dpp v199, v208, v199 row_newbcast:15 row_mask:0xf bank_mask:0xf
    v_cvt_pk_bf16_f32 v192, 0, v192
    v_cvt_pk_bf16_f32 v193, 0, v193
    v_cvt_pk_bf16_f32 v194, 0, v194
    v_cvt_pk_bf16_f32 v195, 0, v195
    v_cvt_pk_bf16_f32 v196, 0, v196
    v_cvt_pk_bf16_f32 v197, 0, v197
    v_cvt_pk_bf16_f32 v198, 0, v198
    v_cvt_pk_bf16_f32 v199, 0, v199
    v_add_f32_dpp v192, v200, v192 row_newbcast:8 row_mask:0xf bank_mask:0xf
    v_add_f32_dpp v193, v200, v193 row_newbcast:9 row_mask:0xf bank_mask:0xf
    v_add_f32_dpp v194, v200, v194 row_newbcast:10 row_mask:0xf bank_mask:0xf
    v_add_f32_dpp v195, v200, v195 row_newbcast:11 row_mask:0xf bank_mask:0xf
    v_add_f32_dpp v196, v200, v196 row_newbcast:12 row_mask:0xf bank_mask:0xf
    v_add_f32_dpp v197, v200, v197 row_newbcast:13 row_mask:0xf bank_mask:0xf
    v_add_f32_dpp v198, v200, v198 row_newbcast:14 row_mask:0xf bank_mask:0xf
    v_add_f32_dpp v199, v200, v199 row_newbcast:15 row_mask:0xf bank_mask:0xf
    v_cvt_pk_bf16_f32 v220, v192, v193
    v_cvt_pk_bf16_f32 v221, v194, v195
    v_cvt_pk_bf16_f32 v222, v196, v197
    v_cvt_pk_bf16_f32 v223, v198, v199
    buffer_store_dwordx4 v[220:223], v4, s[32:35], s13 offen offset:2048 sc1
    v_bfe_u32 v20, v1, 2, 2
    v_lshlrev_b32 v20, 7, v20
    v_bfe_u32 v9, v1, 3, 1
    v_lshl_add_u32 v20, v9, 6, v20
    v_bfe_u32 v9, v1, 4, 1
    v_lshl_add_u32 v20, v9, 5, v20
    v_and_b32 v9, 3, v1
    v_lshl_add_u32 v20, v9, 3, v20
    v_lshrrev_b32 v9, 5, v1
    v_lshl_add_u32 v20, v9, 9, v20
    v_xor_b32 v21, 64, v20
    v_add_u32 v22, 49152, v20
    v_add_u32 v23, 49152, v21
    v_add_u32 v24, 98304, v20
    v_add_u32 v25, 98304, v21
    v_and_b32 v5, 3, v1
    v_lshlrev_b32 v5, 15, v5
    v_bfe_u32 v9, v1, 2, 2
    v_lshl_add_u32 v5, v9, 12, v5
    s_and_b32 s96, s12, 1
    s_lshr_b32 s97, s21, 3
    s_and_b32 s98, s21, 7
    s_lshl_b32 s99, s98, 5
    s_lshl2_add_u32 s98, s97, s99
    s_lshl_b32 s97, s98, 12
    s_lshr_b32 s99, s12, 1
    s_lshl_b32 s98, s99, 6
    s_add_u32 s99, s97, s98
    s_lshl2_add_u32 s97, s96, s99
    s_add_u32 s13, s97, 1048576
    s_lshl_b32 s96, s10, 18
    s_lshl_b32 s97, s77, 12
    s_add_u32 s98, s96, s97
    s_add_u32 s88, s98, 4194304
    s_cmp_ge_u32 s9, 28
    s_cselect_b32 s54, 0, s54
    s_cselect_b32 s58, 0, s58
    s_cselect_b32 s62, 0, s62
    s_waitcnt vmcnt(0)
    s_barrier
    s_cmp_lg_u32 s3, 0
    s_cbranch_scc1 L_PB
    v_mov_b32 v6, s4
    s_mov_b32 exec_hi, 0
    s_mov_b32 exec_lo, 65535
    buffer_store_dword v6, v5, s[32:35], s13 offen sc1
    s_mov_b64 exec, -1
L_PB:
    s_lshr_b32 s96, s9, 4
    s_lshl_b32 s97, s96, 1
    s_xor_b32 s94, s97, 2
    s_add_u32 s96, s94, s84
    s_and_b32 s97, s96, 15
    s_mul_i32 s98, s97, 393216
    s_add_u32 s91, s98, s85
    s_lshl_b32 s96, s94, 13
    s_add_u32 s94, s96, s83
    s_add_u32 s82, s91, 2048
    s_mov_b32 m0, s94
    s_nop 0
    buffer_load_dwordx4 v3, s[40:43], s82 offen lds
    s_add_u32 s82, s91, 4096
    s_add_u32 m0, s94, 49152
    s_nop 0
    buffer_load_dwordx4 v3, s[40:43], s82 offen lds
    s_mov_b32 s82, s91
    s_add_u32 m0, s94, 98304
    s_nop 0
    buffer_load_dwordx4 v3, s[40:43], s82 offen lds
    s_lshr_b32 s96, s9, 4
    s_lshl_b32 s97, s96, 1
    s_xor_b32 s94, s97, 3
    s_add_u32 s96, s94, s84
    s_and_b32 s97, s96, 15
    s_mul_i32 s98, s97, 393216
    s_add_u32 s91, s98, s85
    s_lshl_b32 s96, s94, 13
    s_add_u32 s94, s96, s83
    s_add_u32 s82, s91, 2048
    s_mov_b32 m0, s94
    s_nop 0
    buffer_load_dwordx4 v3, s[40:43], s82 offen lds
    s_add_u32 s82, s91, 4096
    s_add_u32 m0, s94, 49152
    s_nop 0
    buffer_load_dwordx4 v3, s[40:43], s82 offen lds
    s_mov_b32 s82, s91
    s_add_u32 m0, s94, 98304
    s_nop 0
    buffer_load_dwordx4 v3, s[40:43], s82 offen lds
    s_lshl_b32 s96, s2, 12
    s_add_u32 s19, s96, 1048576
    s_and_b32 s96, s3, 3
    s_lshl_b32 s97, s96, 7
    s_add_u32 s20, s97, s19
    s_lshl_b32 s96, s84, 5
    s_add_u32 s19, s96, s19
    s_cmp_ge_u32 s3, 4
    s_cselect_b32 s19, s20, s19
    s_load_dwordx2 s[24:25], s[32:33], s19 offset:0 glc
    s_load_dwordx2 s[26:27], s[32:33], s19 offset:64 glc
    s_lshl_b32 s96, s3, 14
    s_lshl_b32 s97, s12, 7
    s_add_u32 s90, s96, s97
    s_and_b32 s96, s9, 1
    s_lshr_b32 s97, s9, 3
    s_lshl_b32 s98, s97, 1
    s_lshl3_add_u32 s99, s96, s98
    s_lshl_b32 s95, s99, 17
    s_lshl3_add_u32 s96, s75, s3
    s_mul_i32 s97, s96, 229376
    s_lshl_b32 s98, s74, 7
    s_add_u32 s80, s97, s98
    s_lshl3_add_u32 s96, s74, s3
    s_lshl_b32 s97, s96, 14
    s_lshl_b32 s98, s75, 9
    s_add_u32 s81, s97, s98
    s_and_b32 s96, s8, 3
    s_lshl3_add_u32 s97, s96, s3
    s_mul_i32 s98, s97, 393216
    s_lshr_b32 s99, s8, 2
    s_lshl1_add_u32 s96, s9, s99
    s_lshl_b32 s97, s96, 7
    s_add_u32 s99, s98, s97
    s_add_u32 s89, s99, 4096
    s_and_b32 s96, s3, 1
    s_lshl_b32 s14, s96, 6
    v_bfe_u32 v6, v1, 4, 1
    v_lshl_add_u32 v6, v6, 5, s14
    v_and_b32 v26, 7, v1
    v_lshlrev_b32 v26, 4, v26
    v_xor_b32 v26, v26, v6
    v_lshrrev_b32 v6, 3, v1
    v_lshlrev_b32 v6, 11, v6
    v_add_u32 v26, v26, v6
    s_and_b32 s96, s3, 2
    s_lshl_b32 s14, s96, 5
    v_bfe_u32 v6, v1, 4, 1
    v_lshl_add_u32 v6, v6, 5, s14
    v_and_b32 v27, 7, v1
    v_lshlrev_b32 v27, 4, v27
    v_xor_b32 v27, v27, v6
    v_lshrrev_b32 v6, 3, v1
    v_mul_u32_u24 v6, 7168, v6
    v_add_u32 v27, v27, v6
    s_and_b32 s96, s3, 1
    s_lshl_b32 s14, s96, 7
    v_lshrrev_b32 v6, 5, v1
    v_lshl_add_u32 v6, v6, 6, s14
    v_and_b32 v253, 31, v1
    v_lshlrev_b32 v253, 4, v253
    v_lshrrev_b32 v9, 5, v1
    v_lshl_add_u32 v253, v9, 11, v253
    v_xor_b32 v253, v253, v6
    s_lshl_b32 s16, s84, 14
    v_add_u32 v249, s88, v2
    s_lshl_b32 s96, s77, 11
    s_add_u32 s14, s96, 151552
    v_add_u32 v0, s14, v2
    s_mov_b64 exec, 0
    s_cmp_eq_u32 s3, 4
    s_cbranch_scc1 L_PAD2
    s_cmp_eq_u32 s3, 5
    s_cbranch_scc1 L_PAD3
    s_cmp_eq_u32 s3, 6
    s_cbranch_scc1 L_PAD4
    s_cmp_eq_u32 s3, 7
    s_cbranch_scc1 L_PAD5
    s_branch L_TEND
L_RET2:
    s_branch L_PAD6
L_RET6:
    s_branch L_PAD10
L_RET10:
    s_branch L_TEND
L_RET3:
    s_branch L_PAD7
L_RET7:
    s_branch L_TEND
L_RET4:
    s_branch L_PAD8
L_RET8:
    s_branch L_TEND
L_RET5:
    s_branch L_PAD9
L_RET9:
    s_branch L_TEND
    s_nop 0
    s_nop 0
    s_nop 0
    s_nop 0
    s_nop 0
    s_nop 0
    s_nop 0
    s_nop 0
    s_nop 0
    s_nop 0
    s_nop 0
    s_nop 0
    s_nop 0
    s_nop 0
    s_nop 0
    s_nop 0
    s_nop 0
    s_nop 0
    s_nop 0
    s_nop 0
    s_nop 0
    s_nop 0
    s_nop 0
    s_nop 0
    s_nop 0
    s_nop 0
    s_nop 0
    s_nop 0
L_TEND:
    s_mov_b64 exec, -1
    s_cmp_ge_u32 s3, 4
    s_cbranch_scc1 L_HELP
    s_branch SCHK_14
SPOLL_13:
    s_load_dwordx2 s[24:25], s[32:33], s19 offset:0 glc
    s_load_dwordx2 s[26:27], s[32:33], s19 offset:64 glc
SCHK_14:
    s_add_u32 s5, s5, 1
    s_cmp_ge_u32 s5, 200000
    s_waitcnt lgkmcnt(0)
    s_cbranch_scc1 SDONE_15
    s_cmp_lg_u32 s24, s4
    s_cbranch_scc1 SPOLL_13
    s_cmp_lg_u32 s25, s4
    s_cbranch_scc1 SPOLL_13
    s_cmp_lg_u32 s26, s4
    s_cbranch_scc1 SPOLL_13
    s_cmp_lg_u32 s27, s4
    s_cbranch_scc1 SPOLL_13
SDONE_15:
    s_setprio 2
    buffer_load_dwordx4 v[152:155], v249, s[32:35], s16 offen sc1
    buffer_load_dwordx4 v[156:159], v249, s[32:35], s16 offen offset:1024 sc1
    buffer_load_dwordx4 v[160:163], v249, s[32:35], s16 offen offset:2048 sc1
    buffer_load_dwordx4 v[164:167], v249, s[32:35], s16 offen offset:3072 sc1
    s_add_u32 s16, s16, 16384
    s_and_b32 s16, s16, 0x3ffff
    buffer_load_dwordx4 v[168:171], v249, s[32:35], s16 offen sc1
    buffer_load_dwordx4 v[172:175], v249, s[32:35], s16 offen offset:1024 sc1
    buffer_load_dwordx4 v[176:179], v249, s[32:35], s16 offen offset:2048 sc1
    buffer_load_dwordx4 v[180:183], v249, s[32:35], s16 offen offset:3072 sc1
    s_waitcnt vmcnt(8)
    s_barrier
    ds_read_b64_tr_b16 v[28:29], v20
    ds_read_b64_tr_b16 v[30:31], v20 offset:2048
    ds_read_b64_tr_b16 v[32:33], v21
    ds_read_b64_tr_b16 v[34:35], v21 offset:2048
    ds_read_b64_tr_b16 v[36:37], v24
    ds_read_b64_tr_b16 v[38:39], v24 offset:2048
    ds_read_b64_tr_b16 v[40:41], v25
    ds_read_b64_tr_b16 v[42:43], v25 offset:2048
    ds_read_b64_tr_b16 v[44:45], v22
    ds_read_b64_tr_b16 v[46:47], v22 offset:2048
    ds_read_b64_tr_b16 v[48:49], v23
    ds_read_b64_tr_b16 v[50:51], v23 offset:2048
    s_waitcnt vmcnt(7)
    s_waitcnt lgkmcnt(10)
    v_mfma_f32_32x32x16_bf16 v[56:71], v[28:31], v[152:155], 0
    s_add_u32 s16, s16, 16384
    ds_read_b64_tr_b16 v[52:53], v20 offset:1024
    ds_read_b64_tr_b16 v[54:55], v20 offset:3072
    s_waitcnt lgkmcnt(10)
    v_mfma_f32_32x32x16_bf16 v[72:87], v[32:35], v[152:155], 0
    s_and_b32 s16, s16, 0x3ffff
    ds_read_b64_tr_b16 v[28:29], v21 offset:1024
    ds_read_b64_tr_b16 v[30:31], v21 offset:3072
    s_waitcnt lgkmcnt(10)
    v_mfma_f32_32x32x16_bf16 v[120:135], v[36:39], v[152:155], 0
    ds_read_b64_tr_b16 v[32:33], v24 offset:1024
    ds_read_b64_tr_b16 v[34:35], v24 offset:3072
    s_waitcnt lgkmcnt(10)
    v_mfma_f32_32x32x16_bf16 v[136:151], v[40:43], v[152:155], 0
    buffer_load_dwordx4 v[184:187], v249, s[32:35], s16 offen sc1
    ds_read_b64_tr_b16 v[36:37], v25 offset:1024
    ds_read_b64_tr_b16 v[38:39], v25 offset:3072
    s_waitcnt lgkmcnt(10)
    v_mfma_f32_32x32x16_bf16 v[88:103], v[44:47], v[152:155], 0
    ds_read_b64_tr_b16 v[40:41], v22 offset:1024
    ds_read_b64_tr_b16 v[42:43], v22 offset:3072
    s_waitcnt lgkmcnt(10)
    v_mfma_f32_32x32x16_bf16 v[104:119], v[48:51], v[152:155], 0
    ds_read_b64_tr_b16 v[44:45], v23 offset:1024
    ds_read_b64_tr_b16 v[46:47], v23 offset:3072
    s_waitcnt vmcnt(7)
    s_waitcnt lgkmcnt(10)
    v_mfma_f32_32x32x16_bf16 v[56:71], v[52:55], v[156:159], v[56:71]
    ds_read_b64_tr_b16 v[48:49], v20 offset:4096
    ds_read_b64_tr_b16 v[50:51], v20 offset:6144
    s_waitcnt lgkmcnt(10)
    v_mfma_f32_32x32x16_bf16 v[72:87], v[28:31], v[156:159], v[72:87]
    buffer_load_dwordx4 v[188:191], v249, s[32:35], s16 offen offset:1024 sc1
    ds_read_b64_tr_b16 v[52:53], v21 offset:4096
    ds_read_b64_tr_b16 v[54:55], v21 offset:6144
    s_waitcnt lgkmcnt(10)
    v_mfma_f32_32x32x16_bf16 v[120:135], v[32:35], v[156:159], v[120:135]
    ds_read_b64_tr_b16 v[28:29], v24 offset:4096
    ds_read_b64_tr_b16 v[30:31], v24 offset:6144
    s_waitcnt lgkmcnt(10)
    v_mfma_f32_32x32x16_bf16 v[136:151], v[36:39], v[156:159], v[136:151]
    ds_read_b64_tr_b16 v[32:33], v25 offset:4096
    ds_read_b64_tr_b16 v[34:35], v25 offset:6144
    s_waitcnt lgkmcnt(10)
    v_mfma_f32_32x32x16_bf16 v[88:103], v[40:43], v[156:159], v[88:103]
    ds_read_b64_tr_b16 v[36:37], v22 offset:4096
    ds_read_b64_tr_b16 v[38:39], v22 offset:6144
    s_waitcnt lgkmcnt(10)
    v_mfma_f32_32x32x16_bf16 v[104:119], v[44:47], v[156:159], v[104:119]
    buffer_load_dwordx4 v[192:195], v249, s[32:35], s16 offen offset:2048 sc1
    ds_read_b64_tr_b16 v[40:41], v23 offset:4096
    ds_read_b64_tr_b16 v[42:43], v23 offset:6144
    s_waitcnt vmcnt(8)
    s_waitcnt lgkmcnt(10)
    v_mfma_f32_32x32x16_bf16 v[56:71], v[48:51], v[160:163], v[56:71]
    ds_read_b64_tr_b16 v[44:45], v20 offset:5120
    ds_read_b64_tr_b16 v[46:47], v20 offset:7168
    s_waitcnt lgkmcnt(10)
    v_mfma_f32_32x32x16_bf16 v[72:87], v[52:55], v[160:163], v[72:87]
    ds_read_b64_tr_b16 v[48:49], v21 offset:5120
    ds_read_b64_tr_b16 v[50:51], v21 offset:7168
    s_waitcnt lgkmcnt(10)
    v_mfma_f32_32x32x16_bf16 v[120:135], v[28:31], v[160:163], v[120:135]
    ds_read_b64_tr_b16 v[52:53], v24 offset:5120
    ds_read_b64_tr_b16 v[54:55], v24 offset:7168
    s_waitcnt lgkmcnt(10)
    v_mfma_f32_32x32x16_bf16 v[136:151], v[32:35], v[160:163], v[136:151]
    buffer_load_dwordx4 v[196:199], v249, s[32:35], s16 offen offset:3072 sc1
    ds_read_b64_tr_b16 v[28:29], v25 offset:5120
    ds_read_b64_tr_b16 v[30:31], v25 offset:7168
    s_waitcnt lgkmcnt(10)
    v_mfma_f32_32x32x16_bf16 v[88:103], v[36:39], v[160:163], v[88:103]
    s_add_u32 s16, s16, 16384
    ds_read_b64_tr_b16 v[32:33], v22 offset:5120
    ds_read_b64_tr_b16 v[34:35], v22 offset:7168
    s_waitcnt lgkmcnt(10)
    v_mfma_f32_32x32x16_bf16 v[104:119], v[40:43], v[160:163], v[104:119]
    s_and_b32 s16, s16, 0x3ffff
    ds_read_b64_tr_b16 v[36:37], v23 offset:5120
    ds_read_b64_tr_b16 v[38:39], v23 offset:7168
    s_waitcnt vmcnt(8)
    s_waitcnt lgkmcnt(10)
    v_mfma_f32_32x32x16_bf16 v[56:71], v[44:47], v[164:167], v[56:71]
    ds_read_b64_tr_b16 v[40:41], v20 offset:8192
    ds_read_b64_tr_b16 v[42:43], v20 offset:10240
    s_waitcnt lgkmcnt(10)
    v_mfma_f32_32x32x16_bf16 v[72:87], v[48:51], v[164:167], v[72:87]
    buffer_load_dwordx4 v[200:203], v249, s[32:35], s16 offen sc1
    ds_read_b64_tr_b16 v[44:45], v21 offset:8192
    ds_read_b64_tr_b16 v[46:47], v21 offset:10240
    s_waitcnt lgkmcnt(10)
    v_mfma_f32_32x32x16_bf16 v[120:135], v[52:55], v[164:167], v[120:135]
    ds_read_b64_tr_b16 v[48:49], v24 offset:8192
    ds_read_b64_tr_b16 v[50:51], v24 offset:10240
    s_waitcnt lgkmcnt(10)
    v_mfma_f32_32x32x16_bf16 v[136:151], v[28:31], v[164:167], v[136:151]
    ds_read_b64_tr_b16 v[52:53], v25 offset:8192
    ds_read_b64_tr_b16 v[54:55], v25 offset:10240
    s_waitcnt lgkmcnt(10)
    v_mfma_f32_32x32x16_bf16 v[88:103], v[32:35], v[164:167], v[88:103]
    ds_read_b64_tr_b16 v[28:29], v22 offset:8192
    ds_read_b64_tr_b16 v[30:31], v22 offset:10240
    s_waitcnt lgkmcnt(10)
    v_mfma_f32_32x32x16_bf16 v[104:119], v[36:39], v[164:167], v[104:119]
    buffer_load_dwordx4 v[204:207], v249, s[32:35], s16 offen offset:1024 sc1
    ds_read_b64_tr_b16 v[32:33], v23 offset:8192
    ds_read_b64_tr_b16 v[34:35], v23 offset:10240
    s_barrier
    s_waitcnt vmcnt(9)
    s_waitcnt lgkmcnt(10)
    v_mfma_f32_32x32x16_bf16 v[56:71], v[40:43], v[168:171], v[56:71]
    ds_read_b64_tr_b16 v[36:37], v20 offset:9216
    ds_read_b64_tr_b16 v[38:39], v20 offset:11264
    s_waitcnt lgkmcnt(10)
    v_mfma_f32_32x32x16_bf16 v[72:87], v[44:47], v[168:171], v[72:87]
    ds_read_b64_tr_b16 v[40:41], v21 offset:9216
    ds_read_b64_tr_b16 v[42:43], v21 offset:11264
    s_waitcnt lgkmcnt(10)
    v_mfma_f32_32x32x16_bf16 v[120:135], v[48:51], v[168:171], v[120:135]
    ds_read_b64_tr_b16 v[44:45], v24 offset:9216
    ds_read_b64_tr_b16 v[46:47], v24 offset:11264
    s_waitcnt lgkmcnt(10)
    v_mfma_f32_32x32x16_bf16 v[136:151], v[52:55], v[168:171], v[136:151]
    ds_read_b64_tr_b16 v[48:49], v25 offset:9216
    ds_read_b64_tr_b16 v[50:51], v25 offset:11264
    s_waitcnt lgkmcnt(10)
    v_mfma_f32_32x32x16_bf16 v[88:103], v[28:31], v[168:171], v[88:103]
    ds_read_b64_tr_b16 v[52:53], v22 offset:9216
    ds_read_b64_tr_b16 v[54:55], v22 offset:11264
    s_waitcnt lgkmcnt(10)
    v_mfma_f32_32x32x16_bf16 v[104:119], v[32:35], v[168:171], v[104:119]
    ds_read_b64_tr_b16 v[28:29], v23 offset:9216
    ds_read_b64_tr_b16 v[30:31], v23 offset:11264
    s_waitcnt vmcnt(8)
    s_waitcnt lgkmcnt(10)
    v_mfma_f32_32x32x16_bf16 v[56:71], v[36:39], v[172:175], v[56:71]
    ds_read_b64_tr_b16 v[32:33], v20 offset:12288
    ds_read_b64_tr_b16 v[34:35], v20 offset:14336
    s_waitcnt lgkmcnt(10)
    v_mfma_f32_32x32x16_bf16 v[72:87], v[40:43], v[172:175], v[72:87]
    ds_read_b64_tr_b16 v[36:37], v21 offset:12288
    ds_read_b64_tr_b16 v[38:39], v21 offset:14336
    s_waitcnt lgkmcnt(10)
    v_mfma_f32_32x32x16_bf16 v[120:135], v[44:47], v[172:175], v[120:135]
    buffer_load_dwordx4 v[208:211], v249, s[32:35], s16 offen offset:2048 sc1
    ds_read_b64_tr_b16 v[40:41], v24 offset:12288
    ds_read_b64_tr_b16 v[42:43], v24 offset:14336
    s_waitcnt lgkmcnt(10)
    v_mfma_f32_32x32x16_bf16 v[136:151], v[48:51], v[172:175], v[136:151]
    ds_read_b64_tr_b16 v[44:45], v25 offset:12288
    ds_read_b64_tr_b16 v[46:47], v25 offset:14336
    s_waitcnt lgkmcnt(10)
    v_mfma_f32_32x32x16_bf16 v[88:103], v[52:55], v[172:175], v[88:103]
    ds_read_b64_tr_b16 v[48:49], v22 offset:12288
    ds_read_b64_tr_b16 v[50:51], v22 offset:14336
    s_waitcnt lgkmcnt(10)
    v_mfma_f32_32x32x16_bf16 v[104:119], v[28:31], v[172:175], v[104:119]
    buffer_load_dwordx4 v[212:215], v249, s[32:35], s16 offen offset:3072 sc1
    ds_read_b64_tr_b16 v[52:53], v23 offset:12288
    ds_read_b64_tr_b16 v[54:55], v23 offset:14336
    s_waitcnt vmcnt(9)
    s_waitcnt lgkmcnt(10)
    v_mfma_f32_32x32x16_bf16 v[56:71], v[32:35], v[176:179], v[56:71]
    s_add_u32 s16, s16, 16384
    ds_read_b64_tr_b16 v[28:29], v20 offset:13312
    ds_read_b64_tr_b16 v[30:31], v20 offset:15360
    s_waitcnt lgkmcnt(10)
    v_mfma_f32_32x32x16_bf16 v[72:87], v[36:39], v[176:179], v[72:87]
    s_and_b32 s16, s16, 0x3ffff
    ds_read_b64_tr_b16 v[32:33], v21 offset:13312
    ds_read_b64_tr_b16 v[34:35], v21 offset:15360
    s_waitcnt lgkmcnt(10)
    v_mfma_f32_32x32x16_bf16 v[120:135], v[40:43], v[176:179], v[120:135]
    buffer_load_dwordx4 v[216:219], v249, s[32:35], s16 offen sc1
    ds_read_b64_tr_b16 v[36:37], v24 offset:13312
    ds_read_b64_tr_b16 v[38:39], v24 offset:15360
    s_waitcnt lgkmcnt(10)
    v_mfma_f32_32x32x16_bf16 v[136:151], v[44:47], v[176:179], v[136:151]
    ds_read_b64_tr_b16 v[40:41], v25 offset:13312
    ds_read_b64_tr_b16 v[42:43], v25 offset:15360
    s_waitcnt lgkmcnt(10)
    v_mfma_f32_32x32x16_bf16 v[88:103], v[48:51], v[176:179], v[88:103]
    ds_read_b64_tr_b16 v[44:45], v22 offset:13312
    ds_read_b64_tr_b16 v[46:47], v22 offset:15360
    s_waitcnt lgkmcnt(10)
    v_mfma_f32_32x32x16_bf16 v[104:119], v[52:55], v[176:179], v[104:119]
    buffer_load_dwordx4 v[220:223], v249, s[32:35], s16 offen offset:1024 sc1
    ds_read_b64_tr_b16 v[48:49], v23 offset:13312
    ds_read_b64_tr_b16 v[50:51], v23 offset:15360
    s_waitcnt vmcnt(10)
    s_waitcnt lgkmcnt(10)
    v_mfma_f32_32x32x16_bf16 v[56:71], v[28:31], v[180:183], v[56:71]
    ds_read_b64_tr_b16 v[52:53], v20 offset:16384
    ds_read_b64_tr_b16 v[54:55], v20 offset:18432
    s_waitcnt lgkmcnt(10)
    v_mfma_f32_32x32x16_bf16 v[72:87], v[32:35], v[180:183], v[72:87]
    ds_read_b64_tr_b16 v[28:29], v21 offset:16384
    ds_read_b64_tr_b16 v[30:31], v21 offset:18432
    s_waitcnt lgkmcnt(10)
    v_mfma_f32_32x32x16_bf16 v[120:135], v[36:39], v[180:183], v[120:135]
    buffer_load_dwordx4 v[224:227], v249, s[32:35], s16 offen offset:2048 sc1
    ds_read_b64_tr_b16 v[32:33], v24 offset:16384
    ds_read_b64_tr_b16 v[34:35], v24 offset:18432
    s_waitcnt lgkmcnt(10)
    v_mfma_f32_32x32x16_bf16 v[136:151], v[40:43], v[180:183], v[136:151]
    ds_read_b64_tr_b16 v[36:37], v25 offset:16384
    ds_read_b64_tr_b16 v[38:39], v25 offset:18432
    s_waitcnt lgkmcnt(10)
    v_mfma_f32_32x32x16_bf16 v[88:103], v[44:47], v[180:183], v[88:103]
    ds_read_b64_tr_b16 v[40:41], v22 offset:16384
    ds_read_b64_tr_b16 v[42:43], v22 offset:18432
    s_waitcnt lgkmcnt(10)
    v_mfma_f32_32x32x16_bf16 v[104:119], v[48:51], v[180:183], v[104:119]
    buffer_load_dwordx4 v[228:231], v249, s[32:35], s16 offen offset:3072 sc1
    ds_read_b64_tr_b16 v[44:45], v23 offset:16384
    ds_read_b64_tr_b16 v[46:47], v23 offset:18432
    s_barrier
    s_waitcnt vmcnt(11)
    s_waitcnt lgkmcnt(10)
    v_mfma_f32_32x32x16_bf16 v[56:71], v[52:55], v[184:187], v[56:71]
    s_add_u32 s16, s16, 16384
    ds_read_b64_tr_b16 v[48:49], v20 offset:17408
    ds_read_b64_tr_b16 v[50:51], v20 offset:19456
    s_waitcnt lgkmcnt(10)
    v_mfma_f32_32x32x16_bf16 v[72:87], v[28:31], v[184:187], v[72:87]
    s_and_b32 s16, s16, 0x3ffff
    ds_read_b64_tr_b16 v[52:53], v21 offset:17408
    ds_read_b64_tr_b16 v[54:55], v21 offset:19456
    s_waitcnt lgkmcnt(10)
    v_mfma_f32_32x32x16_bf16 v[120:135], v[32:35], v[184:187], v[120:135]
    ds_read_b64_tr_b16 v[28:29], v24 offset:17408
    ds_read_b64_tr_b16 v[30:31], v24 offset:19456
    s_waitcnt lgkmcnt(10)
    v_mfma_f32_32x32x16_bf16 v[136:151], v[36:39], v[184:187], v[136:151]
    ds_read_b64_tr_b16 v[32:33], v25 offset:17408
    ds_read_b64_tr_b16 v[34:35], v25 offset:19456
    s_waitcnt lgkmcnt(10)
    v_mfma_f32_32x32x16_bf16 v[88:103], v[40:43], v[184:187], v[88:103]
    ds_read_b64_tr_b16 v[36:37], v22 offset:17408
    ds_read_b64_tr_b16 v[38:39], v22 offset:19456
    s_waitcnt lgkmcnt(10)
    v_mfma_f32_32x32x16_bf16 v[104:119], v[44:47], v[184:187], v[104:119]
    ds_read_b64_tr_b16 v[40:41], v23 offset:17408
    ds_read_b64_tr_b16 v[42:43], v23 offset:19456
    s_waitcnt vmcnt(10)
    s_waitcnt lgkmcnt(10)
    v_mfma_f32_32x32x16_bf16 v[56:71], v[48:51], v[188:191], v[56:71]
    ds_read_b64_tr_b16 v[44:45], v20 offset:20480
    ds_read_b64_tr_b16 v[46:47], v20 offset:22528
    s_waitcnt lgkmcnt(10)
    v_mfma_f32_32x32x16_bf16 v[72:87], v[52:55], v[188:191], v[72:87]
    ds_read_b64_tr_b16 v[48:49], v21 offset:20480
    ds_read_b64_tr_b16 v[50:51], v21 offset:22528
    s_waitcnt lgkmcnt(10)
    v_mfma_f32_32x32x16_bf16 v[120:135], v[28:31], v[188:191], v[120:135]
    buffer_load_dwordx4 v[232:235], v249, s[32:35], s16 offen sc1
    ds_read_b64_tr_b16 v[52:53], v24 offset:20480
    ds_read_b64_tr_b16 v[54:55], v24 offset:22528
    s_waitcnt lgkmcnt(10)
    v_mfma_f32_32x32x16_bf16 v[136:151], v[32:35], v[188:191], v[136:151]
    ds_read_b64_tr_b16 v[28:29], v25 offset:20480
    ds_read_b64_tr_b16 v[30:31], v25 offset:22528
    s_waitcnt lgkmcnt(10)
    v_mfma_f32_32x32x16_bf16 v[88:103], v[36:39], v[188:191], v[88:103]
    ds_read_b64_tr_b16 v[32:33], v22 offset:20480
    ds_read_b64_tr_b16 v[34:35], v22 offset:22528
    s_waitcnt lgkmcnt(10)
    v_mfma_f32_32x32x16_bf16 v[104:119], v[40:43], v[188:191], v[104:119]
    buffer_load_dwordx4 v[236:239], v249, s[32:35], s16 offen offset:1024 sc1
    ds_read_b64_tr_b16 v[36:37], v23 offset:20480
    ds_read_b64_tr_b16 v[38:39], v23 offset:22528
    s_waitcnt vmcnt(11)
    s_waitcnt lgkmcnt(10)
    v_mfma_f32_32x32x16_bf16 v[56:71], v[44:47], v[192:195], v[56:71]
    ds_read_b64_tr_b16 v[40:41], v20 offset:21504
    ds_read_b64_tr_b16 v[42:43], v20 offset:23552
    s_waitcnt lgkmcnt(10)
    v_mfma_f32_32x32x16_bf16 v[72:87], v[48:51], v[192:195], v[72:87]
    ds_read_b64_tr_b16 v[44:45], v21 offset:21504
    ds_read_b64_tr_b16 v[46:47], v21 offset:23552
    s_waitcnt lgkmcnt(10)
    v_mfma_f32_32x32x16_bf16 v[120:135], v[52:55], v[192:195], v[120:135]
    buffer_load_dwordx4 v[240:243], v249, s[32:35], s16 offen offset:2048 sc1
    ds_read_b64_tr_b16 v[48:49], v24 offset:21504
    ds_read_b64_tr_b16 v[50:51], v24 offset:23552
    s_waitcnt lgkmcnt(10)
    v_mfma_f32_32x32x16_bf16 v[136:151], v[28:31], v[192:195], v[136:151]
    ds_read_b64_tr_b16 v[52:53], v25 offset:21504
    ds_read_b64_tr_b16 v[54:55], v25 offset:23552
    s_waitcnt lgkmcnt(10)
    v_mfma_f32_32x32x16_bf16 v[88:103], v[32:35], v[192:195], v[88:103]
    ds_read_b64_tr_b16 v[28:29], v22 offset:21504
    ds_read_b64_tr_b16 v[30:31], v22 offset:23552
    s_waitcnt lgkmcnt(10)
    v_mfma_f32_32x32x16_bf16 v[104:119], v[36:39], v[192:195], v[104:119]
    buffer_load_dwordx4 v[244:247], v249, s[32:35], s16 offen offset:3072 sc1
    ds_read_b64_tr_b16 v[32:33], v23 offset:21504
    ds_read_b64_tr_b16 v[34:35], v23 offset:23552
    s_waitcnt vmcnt(12)
    s_waitcnt lgkmcnt(10)
    v_mfma_f32_32x32x16_bf16 v[56:71], v[40:43], v[196:199], v[56:71]
    s_add_u32 s16, s16, 16384
    ds_read_b64_tr_b16 v[36:37], v20 offset:24576
    ds_read_b64_tr_b16 v[38:39], v20 offset:26624
    s_waitcnt lgkmcnt(10)
    v_mfma_f32_32x32x16_bf16 v[72:87], v[44:47], v[196:199], v[72:87]
    s_and_b32 s16, s16, 0x3ffff
    ds_read_b64_tr_b16 v[40:41], v21 offset:24576
    ds_read_b64_tr_b16 v[42:43], v21 offset:26624
    s_waitcnt lgkmcnt(10)
    v_mfma_f32_32x32x16_bf16 v[120:135], v[48:51], v[196:199], v[120:135]
    buffer_load_dwordx4 v[152:155], v249, s[32:35], s16 offen sc1
    ds_read_b64_tr_b16 v[44:45], v24 offset:24576
    ds_read_b64_tr_b16 v[46:47], v24 offset:26624
    s_waitcnt lgkmcnt(10)
    v_mfma_f32_32x32x16_bf16 v[136:151], v[52:55], v[196:199], v[136:151]
    ds_read_b64_tr_b16 v[48:49], v25 offset:24576
    ds_read_b64_tr_b16 v[50:51], v25 offset:26624
    s_waitcnt lgkmcnt(10)
    v_mfma_f32_32x32x16_bf16 v[88:103], v[28:31], v[196:199], v[88:103]
    ds_read_b64_tr_b16 v[52:53], v22 offset:24576
    ds_read_b64_tr_b16 v[54:55], v22 offset:26624
    s_waitcnt lgkmcnt(10)
    v_mfma_f32_32x32x16_bf16 v[104:119], v[32:35], v[196:199], v[104:119]
    buffer_load_dwordx4 v[156:159], v249, s[32:35], s16 offen offset:1024 sc1
    ds_read_b64_tr_b16 v[28:29], v23 offset:24576
    ds_read_b64_tr_b16 v[30:31], v23 offset:26624
    s_barrier
    s_waitcnt vmcnt(13)
    s_waitcnt lgkmcnt(10)
    v_mfma_f32_32x32x16_bf16 v[56:71], v[36:39], v[200:203], v[56:71]
    ds_read_b64_tr_b16 v[32:33], v20 offset:25600
    ds_read_b64_tr_b16 v[34:35], v20 offset:27648
    s_waitcnt lgkmcnt(10)
L_PAD2:
    s_cbranch_execz L_RET2
    v_mfma_f32_32x32x16_bf16 v[72:87], v[40:43], v[200:203], v[72:87]
    ds_read_b64_tr_b16 v[36:37], v21 offset:25600
    ds_read_b64_tr_b16 v[38:39], v21 offset:27648
    s_waitcnt lgkmcnt(10)
    v_mfma_f32_32x32x16_bf16 v[120:135], v[44:47], v[200:203], v[120:135]
    ds_read_b64_tr_b16 v[40:41], v24 offset:25600
    ds_read_b64_tr_b16 v[42:43], v24 offset:27648
    s_waitcnt lgkmcnt(10)
    v_mfma_f32_32x32x16_bf16 v[136:151], v[48:51], v[200:203], v[136:151]
    ds_read_b64_tr_b16 v[44:45], v25 offset:25600
    ds_read_b64_tr_b16 v[46:47], v25 offset:27648
    s_waitcnt lgkmcnt(10)
    v_mfma_f32_32x32x16_bf16 v[88:103], v[52:55], v[200:203], v[88:103]
    ds_read_b64_tr_b16 v[48:49], v22 offset:25600
    ds_read_b64_tr_b16 v[50:51], v22 offset:27648
    s_waitcnt lgkmcnt(10)
    v_mfma_f32_32x32x16_bf16 v[104:119], v[28:31], v[200:203], v[104:119]
    ds_read_b64_tr_b16 v[52:53], v23 offset:25600
    ds_read_b64_tr_b16 v[54:55], v23 offset:27648
    s_waitcnt vmcnt(12)
    s_waitcnt lgkmcnt(10)
    v_mfma_f32_32x32x16_bf16 v[56:71], v[32:35], v[204:207], v[56:71]
    ds_read_b64_tr_b16 v[28:29], v20 offset:28672
    ds_read_b64_tr_b16 v[30:31], v20 offset:30720
    s_waitcnt lgkmcnt(10)
    v_mfma_f32_32x32x16_bf16 v[72:87], v[36:39], v[204:207], v[72:87]
    ds_read_b64_tr_b16 v[32:33], v21 offset:28672
    ds_read_b64_tr_b16 v[34:35], v21 offset:30720
    s_waitcnt lgkmcnt(10)
    v_mfma_f32_32x32x16_bf16 v[120:135], v[40:43], v[204:207], v[120:135]
    buffer_load_dwordx4 v[160:163], v249, s[32:35], s16 offen offset:2048 sc1
    ds_read_b64_tr_b16 v[36:37], v24 offset:28672
    ds_read_b64_tr_b16 v[38:39], v24 offset:30720
    s_waitcnt lgkmcnt(10)
    v_mfma_f32_32x32x16_bf16 v[136:151], v[44:47], v[204:207], v[136:151]
    ds_read_b64_tr_b16 v[40:41], v25 offset:28672
    ds_read_b64_tr_b16 v[42:43], v25 offset:30720
    s_waitcnt lgkmcnt(10)
    v_mfma_f32_32x32x16_bf16 v[88:103], v[48:51], v[204:207], v[88:103]
    ds_read_b64_tr_b16 v[44:45], v22 offset:28672
    ds_read_b64_tr_b16 v[46:47], v22 offset:30720
    s_waitcnt lgkmcnt(10)
    v_mfma_f32_32x32x16_bf16 v[104:119], v[52:55], v[204:207], v[104:119]
    buffer_load_dwordx4 v[164:167], v249, s[32:35], s16 offen offset:3072 sc1
    ds_read_b64_tr_b16 v[48:49], v23 offset:28672
    ds_read_b64_tr_b16 v[50:51], v23 offset:30720
    s_waitcnt vmcnt(13)
    s_waitcnt lgkmcnt(10)
    v_mfma_f32_32x32x16_bf16 v[56:71], v[28:31], v[208:211], v[56:71]
    s_add_u32 s16, s16, 16384
    ds_read_b64_tr_b16 v[52:53], v20 offset:29696
    ds_read_b64_tr_b16 v[54:55], v20 offset:31744
    s_waitcnt lgkmcnt(10)
    v_mfma_f32_32x32x16_bf16 v[72:87], v[32:35], v[208:211], v[72:87]
    s_and_b32 s16, s16, 0x3ffff
    ds_read_b64_tr_b16 v[28:29], v21 offset:29696
    ds_read_b64_tr_b16 v[30:31], v21 offset:31744
    s_waitcnt lgkmcnt(10)
    v_mfma_f32_32x32x16_bf16 v[120:135], v[36:39], v[208:211], v[120:135]
    buffer_load_dwordx4 v[168:171], v249, s[32:35], s16 offen sc1
    ds_read_b64_tr_b16 v[32:33], v24 offset:29696
    ds_read_b64_tr_b16 v[34:35], v24 offset:31744
    s_waitcnt lgkmcnt(10)
    v_mfma_f32_32x32x16_bf16 v[136:151], v[40:43], v[208:211], v[136:151]
    ds_read_b64_tr_b16 v[36:37], v25 offset:29696
    ds_read_b64_tr_b16 v[38:39], v25 offset:31744
    s_waitcnt lgkmcnt(10)
    v_mfma_f32_32x32x16_bf16 v[88:103], v[44:47], v[208:211], v[88:103]
    ds_read_b64_tr_b16 v[40:41], v22 offset:29696
    ds_read_b64_tr_b16 v[42:43], v22 offset:31744
    s_waitcnt lgkmcnt(10)
    v_mfma_f32_32x32x16_bf16 v[104:119], v[48:51], v[208:211], v[104:119]
    buffer_load_dwordx4 v[172:175], v249, s[32:35], s16 offen offset:1024 sc1
    ds_read_b64_tr_b16 v[44:45], v23 offset:29696
    ds_read_b64_tr_b16 v[46:47], v23 offset:31744
    s_waitcnt vmcnt(14)
    s_waitcnt lgkmcnt(10)
    v_mfma_f32_32x32x16_bf16 v[56:71], v[52:55], v[212:215], v[56:71]
    ds_read_b64_tr_b16 v[48:49], v20 offset:32768
    ds_read_b64_tr_b16 v[50:51], v20 offset:34816
    s_waitcnt lgkmcnt(10)
    v_mfma_f32_32x32x16_bf16 v[72:87], v[28:31], v[212:215], v[72:87]
    ds_read_b64_tr_b16 v[52:53], v21 offset:32768
    ds_read_b64_tr_b16 v[54:55], v21 offset:34816
    s_waitcnt lgkmcnt(10)
    v_mfma_f32_32x32x16_bf16 v[120:135], v[32:35], v[212:215], v[120:135]
    buffer_load_dwordx4 v[176:179], v249, s[32:35], s16 offen offset:2048 sc1
    ds_read_b64_tr_b16 v[28:29], v24 offset:32768
    ds_read_b64_tr_b16 v[30:31], v24 offset:34816
    s_waitcnt lgkmcnt(10)
    v_mfma_f32_32x32x16_bf16 v[136:151], v[36:39], v[212:215], v[136:151]
    ds_read_b64_tr_b16 v[32:33], v25 offset:32768
    ds_read_b64_tr_b16 v[34:35], v25 offset:34816
    s_waitcnt lgkmcnt(10)
    v_mfma_f32_32x32x16_bf16 v[88:103], v[40:43], v[212:215], v[88:103]
    ds_read_b64_tr_b16 v[36:37], v22 offset:32768
    ds_read_b64_tr_b16 v[38:39], v22 offset:34816
    s_waitcnt lgkmcnt(10)
    v_mfma_f32_32x32x16_bf16 v[104:119], v[44:47], v[212:215], v[104:119]
    buffer_load_dwordx4 v[180:183], v249, s[32:35], s16 offen offset:3072 sc1
    ds_read_b64_tr_b16 v[40:41], v23 offset:32768
    ds_read_b64_tr_b16 v[42:43], v23 offset:34816
    s_barrier
    s_waitcnt vmcnt(15)
    s_waitcnt lgkmcnt(10)
    v_mfma_f32_32x32x16_bf16 v[56:71], v[48:51], v[216:219], v[56:71]
    s_add_u32 s16, s16, 16384
    ds_read_b64_tr_b16 v[44:45], v20 offset:33792
    ds_read_b64_tr_b16 v[46:47], v20 offset:35840
    s_waitcnt lgkmcnt(10)
    v_mfma_f32_32x32x16_bf16 v[72:87], v[52:55], v[216:219], v[72:87]
    s_and_b32 s16, s16, 0x3ffff
    ds_read_b64_tr_b16 v[48:49], v21 offset:33792
    ds_read_b64_tr_b16 v[50:51], v21 offset:35840
    s_waitcnt lgkmcnt(10)
    v_mfma_f32_32x32x16_bf16 v[120:135], v[28:31], v[216:219], v[120:135]
    ds_read_b64_tr_b16 v[52:53], v24 offset:33792
    ds_read_b64_tr_b16 v[54:55], v24 offset:35840
    s_waitcnt lgkmcnt(10)
    v_mfma_f32_32x32x16_bf16 v[136:151], v[32:35], v[216:219], v[136:151]
    ds_read_b64_tr_b16 v[28:29], v25 offset:33792
    ds_read_b64_tr_b16 v[30:31], v25 offset:35840
    s_waitcnt lgkmcnt(10)
    v_mfma_f32_32x32x16_bf16 v[88:103], v[36:39], v[216:219], v[88:103]
    ds_read_b64_tr_b16 v[32:33], v22 offset:33792
    ds_read_b64_tr_b16 v[34:35], v22 offset:35840
    s_waitcnt lgkmcnt(10)
    v_mfma_f32_32x32x16_bf16 v[104:119], v[40:43], v[216:219], v[104:119]
    ds_read_b64_tr_b16 v[36:37], v23 offset:33792
    ds_read_b64_tr_b16 v[38:39], v23 offset:35840
    s_waitcnt vmcnt(14)
    s_waitcnt lgkmcnt(10)
    v_mfma_f32_32x32x16_bf16 v[56:71], v[44:47], v[220:223], v[56:71]
    ds_read_b64_tr_b16 v[40:41], v20 offset:36864
    ds_read_b64_tr_b16 v[42:43], v20 offset:38912
    s_waitcnt lgkmcnt(10)
    v_mfma_f32_32x32x16_bf16 v[72:87], v[48:51], v[220:223], v[72:87]
    ds_read_b64_tr_b16 v[44:45], v21 offset:36864
    ds_read_b64_tr_b16 v[46:47], v21 offset:38912
    s_waitcnt lgkmcnt(10)
    v_mfma_f32_32x32x16_bf16 v[120:135], v[52:55], v[220:223], v[120:135]
    buffer_load_dwordx4 v[184:187], v249, s[32:35], s16 offen sc1
    ds_read_b64_tr_b16 v[48:49], v24 offset:36864
    ds_read_b64_tr_b16 v[50:51], v24 offset:38912
    s_waitcnt lgkmcnt(10)
    v_mfma_f32_32x32x16_bf16 v[136:151], v[28:31], v[220:223], v[136:151]
    ds_read_b64_tr_b16 v[52:53], v25 offset:36864
    ds_read_b64_tr_b16 v[54:55], v25 offset:38912
    s_waitcnt lgkmcnt(10)
    v_mfma_f32_32x32x16_bf16 v[88:103], v[32:35], v[220:223], v[88:103]
    ds_read_b64_tr_b16 v[28:29], v22 offset:36864
    ds_read_b64_tr_b16 v[30:31], v22 offset:38912
    s_waitcnt lgkmcnt(10)
    v_mfma_f32_32x32x16_bf16 v[104:119], v[36:39], v[220:223], v[104:119]
    buffer_load_dwordx4 v[188:191], v249, s[32:35], s16 offen offset:1024 sc1
    ds_read_b64_tr_b16 v[32:33], v23 offset:36864
    ds_read_b64_tr_b16 v[34:35], v23 offset:38912
    s_waitcnt vmcnt(15)
    s_waitcnt lgkmcnt(10)
    v_mfma_f32_32x32x16_bf16 v[56:71], v[40:43], v[224:227], v[56:71]
    ds_read_b64_tr_b16 v[36:37], v20 offset:37888
    ds_read_b64_tr_b16 v[38:39], v20 offset:39936
    s_waitcnt lgkmcnt(10)
    v_mfma_f32_32x32x16_bf16 v[72:87], v[44:47], v[224:227], v[72:87]
    ds_read_b64_tr_b16 v[40:41], v21 offset:37888
    ds_read_b64_tr_b16 v[42:43], v21 offset:39936
    s_waitcnt lgkmcnt(10)
    v_mfma_f32_32x32x16_bf16 v[120:135], v[48:51], v[224:227], v[120:135]
    buffer_load_dwordx4 v[192:195], v249, s[32:35], s16 offen offset:2048 sc1
    ds_read_b64_tr_b16 v[44:45], v24 offset:37888
    ds_read_b64_tr_b16 v[46:47], v24 offset:39936
    s_waitcnt lgkmcnt(10)
    v_mfma_f32_32x32x16_bf16 v[136:151], v[52:55], v[224:227], v[136:151]
    ds_read_b64_tr_b16 v[48:49], v25 offset:37888
    ds_read_b64_tr_b16 v[50:51], v25 offset:39936
    s_waitcnt lgkmcnt(10)
    v_mfma_f32_32x32x16_bf16 v[88:103], v[28:31], v[224:227], v[88:103]
    ds_read_b64_tr_b16 v[52:53], v22 offset:37888
    ds_read_b64_tr_b16 v[54:55], v22 offset:39936
    s_waitcnt lgkmcnt(10)
    v_mfma_f32_32x32x16_bf16 v[104:119], v[32:35], v[224:227], v[104:119]
    buffer_load_dwordx4 v[196:199], v249, s[32:35], s16 offen offset:3072 sc1
    ds_read_b64_tr_b16 v[28:29], v23 offset:37888
    ds_read_b64_tr_b16 v[30:31], v23 offset:39936
    s_waitcnt vmcnt(16)
    s_waitcnt lgkmcnt(10)
    v_mfma_f32_32x32x16_bf16 v[56:71], v[36:39], v[228:231], v[56:71]
    s_add_u32 s16, s16, 16384
    ds_read_b64_tr_b16 v[32:33], v20 offset:40960
    ds_read_b64_tr_b16 v[34:35], v20 offset:43008
    s_waitcnt lgkmcnt(10)
    v_mfma_f32_32x32x16_bf16 v[72:87], v[40:43], v[228:231], v[72:87]
    s_and_b32 s16, s16, 0x3ffff
    ds_read_b64_tr_b16 v[36:37], v21 offset:40960
    ds_read_b64_tr_b16 v[38:39], v21 offset:43008
    s_waitcnt lgkmcnt(10)
    v_mfma_f32_32x32x16_bf16 v[120:135], v[44:47], v[228:231], v[120:135]
    buffer_load_dwordx4 v[200:203], v249, s[32:35], s16 offen sc1
    ds_read_b64_tr_b16 v[40:41], v24 offset:40960
    ds_read_b64_tr_b16 v[42:43], v24 offset:43008
    s_waitcnt lgkmcnt(10)
    v_mfma_f32_32x32x16_bf16 v[136:151], v[48:51], v[228:231], v[136:151]
    ds_read_b64_tr_b16 v[44:45], v25 offset:40960
    ds_read_b64_tr_b16 v[46:47], v25 offset:43008
    s_waitcnt lgkmcnt(10)
    v_mfma_f32_32x32x16_bf16 v[88:103], v[52:55], v[228:231], v[88:103]
    ds_read_b64_tr_b16 v[48:49], v22 offset:40960
    ds_read_b64_tr_b16 v[50:51], v22 offset:43008
    s_waitcnt lgkmcnt(10)
    v_mfma_f32_32x32x16_bf16 v[104:119], v[28:31], v[228:231], v[104:119]
    buffer_load_dwordx4 v[204:207], v249, s[32:35], s16 offen offset:1024 sc1
    ds_read_b64_tr_b16 v[52:53], v23 offset:40960
    ds_read_b64_tr_b16 v[54:55], v23 offset:43008
    s_barrier
    s_waitcnt vmcnt(17)
    s_waitcnt lgkmcnt(10)
    v_mfma_f32_32x32x16_bf16 v[56:71], v[32:35], v[232:235], v[56:71]
    ds_read_b64_tr_b16 v[28:29], v20 offset:41984
    ds_read_b64_tr_b16 v[30:31], v20 offset:44032
    s_waitcnt lgkmcnt(10)
    v_mfma_f32_32x32x16_bf16 v[72:87], v[36:39], v[232:235], v[72:87]
    ds_read_b64_tr_b16 v[32:33], v21 offset:41984
    ds_read_b64_tr_b16 v[34:35], v21 offset:44032
    s_waitcnt lgkmcnt(10)
    v_mfma_f32_32x32x16_bf16 v[120:135], v[40:43], v[232:235], v[120:135]
    ds_read_b64_tr_b16 v[36:37], v24 offset:41984
    ds_read_b64_tr_b16 v[38:39], v24 offset:44032
    s_waitcnt lgkmcnt(10)
    v_mfma_f32_32x32x16_bf16 v[136:151], v[44:47], v[232:235], v[136:151]
    ds_read_b64_tr_b16 v[40:41], v25 offset:41984
    ds_read_b64_tr_b16 v[42:43], v25 offset:44032
    s_waitcnt lgkmcnt(10)
    v_mfma_f32_32x32x16_bf16 v[88:103], v[48:51], v[232:235], v[88:103]
    ds_read_b64_tr_b16 v[44:45], v22 offset:41984
    ds_read_b64_tr_b16 v[46:47], v22 offset:44032
    s_waitcnt lgkmcnt(10)
    v_mfma_f32_32x32x16_bf16 v[104:119], v[52:55], v[232:235], v[104:119]
    ds_read_b64_tr_b16 v[48:49], v23 offset:41984
    ds_read_b64_tr_b16 v[50:51], v23 offset:44032
    s_waitcnt vmcnt(16)
    s_waitcnt lgkmcnt(10)
    v_mfma_f32_32x32x16_bf16 v[56:71], v[28:31], v[236:239], v[56:71]
    ds_read_b64_tr_b16 v[52:53], v20 offset:45056
    ds_read_b64_tr_b16 v[54:55], v20 offset:47104
    s_waitcnt lgkmcnt(10)
    v_mfma_f32_32x32x16_bf16 v[72:87], v[32:35], v[236:239], v[72:87]
    ds_read_b64_tr_b16 v[28:29], v21 offset:45056
    ds_read_b64_tr_b16 v[30:31], v21 offset:47104
    s_waitcnt lgkmcnt(10)
    v_mfma_f32_32x32x16_bf16 v[120:135], v[36:39], v[236:239], v[120:135]
    buffer_load_dwordx4 v[208:211], v249, s[32:35], s16 offen offset:2048 sc1
    ds_read_b64_tr_b16 v[32:33], v24 offset:45056
    ds_read_b64_tr_b16 v[34:35], v24 offset:47104
    s_waitcnt lgkmcnt(10)
    v_mfma_f32_32x32x16_bf16 v[136:151], v[40:43], v[236:239], v[136:151]
    ds_read_b64_tr_b16 v[36:37], v25 offset:45056
    ds_read_b64_tr_b16 v[38:39], v25 offset:47104
    s_waitcnt lgkmcnt(10)
    v_mfma_f32_32x32x16_bf16 v[88:103], v[44:47], v[236:239], v[88:103]
    ds_read_b64_tr_b16 v[40:41], v22 offset:45056
    ds_read_b64_tr_b16 v[42:43], v22 offset:47104
    s_waitcnt lgkmcnt(10)
    v_mfma_f32_32x32x16_bf16 v[104:119], v[48:51], v[236:239], v[104:119]
    buffer_load_dwordx4 v[212:215], v249, s[32:35], s16 offen offset:3072 sc1
    ds_read_b64_tr_b16 v[44:45], v23 offset:45056
    ds_read_b64_tr_b16 v[46:47], v23 offset:47104
    s_waitcnt vmcnt(17)
    s_waitcnt lgkmcnt(10)
    v_mfma_f32_32x32x16_bf16 v[56:71], v[52:55], v[240:243], v[56:71]
    s_add_u32 s16, s16, 16384
    ds_read_b64_tr_b16 v[48:49], v20 offset:46080
    ds_read_b64_tr_b16 v[50:51], v20 offset:48128
    s_waitcnt lgkmcnt(10)
    v_mfma_f32_32x32x16_bf16 v[72:87], v[28:31], v[240:243], v[72:87]
    s_and_b32 s16, s16, 0x3ffff
    ds_read_b64_tr_b16 v[52:53], v21 offset:46080
    ds_read_b64_tr_b16 v[54:55], v21 offset:48128
    s_waitcnt lgkmcnt(10)
    v_mfma_f32_32x32x16_bf16 v[120:135], v[32:35], v[240:243], v[120:135]
    buffer_load_dwordx4 v[216:219], v249, s[32:35], s16 offen sc1
    ds_read_b64_tr_b16 v[28:29], v24 offset:46080
    ds_read_b64_tr_b16 v[30:31], v24 offset:48128
    s_waitcnt lgkmcnt(10)
    v_mfma_f32_32x32x16_bf16 v[136:151], v[36:39], v[240:243], v[136:151]
    ds_read_b64_tr_b16 v[32:33], v25 offset:46080
    ds_read_b64_tr_b16 v[34:35], v25 offset:48128
    s_waitcnt lgkmcnt(10)
    v_mfma_f32_32x32x16_bf16 v[88:103], v[40:43], v[240:243], v[88:103]
    ds_read_b64_tr_b16 v[36:37], v22 offset:46080
    ds_read_b64_tr_b16 v[38:39], v22 offset:48128
    s_waitcnt lgkmcnt(10)
    v_mfma_f32_32x32x16_bf16 v[104:119], v[44:47], v[240:243], v[104:119]
    buffer_load_dwordx4 v[220:223], v249, s[32:35], s16 offen offset:1024 sc1
    ds_read_b64_tr_b16 v[40:41], v23 offset:46080
    ds_read_b64_tr_b16 v[42:43], v23 offset:48128
    s_waitcnt vmcnt(18)
    s_waitcnt lgkmcnt(10)
    v_mfma_f32_32x32x16_bf16 v[56:71], v[48:51], v[244:247], v[56:71]
    ds_read_b64_tr_b16 v[44:45], v20
    ds_read_b64_tr_b16 v[46:47], v20 offset:2048
    s_waitcnt lgkmcnt(10)
    v_mfma_f32_32x32x16_bf16 v[72:87], v[52:55], v[244:247], v[72:87]
    ds_read_b64_tr_b16 v[48:49], v21
    ds_read_b64_tr_b16 v[50:51], v21 offset:2048
    s_waitcnt lgkmcnt(10)
    v_mfma_f32_32x32x16_bf16 v[120:135], v[28:31], v[244:247], v[120:135]
    buffer_load_dwordx4 v[224:227], v249, s[32:35], s16 offen offset:2048 sc1
    ds_read_b64_tr_b16 v[52:53], v24
    ds_read_b64_tr_b16 v[54:55], v24 offset:2048
    s_waitcnt lgkmcnt(10)
    v_mfma_f32_32x32x16_bf16 v[136:151], v[32:35], v[244:247], v[136:151]
    ds_read_b64_tr_b16 v[28:29], v25
    ds_read_b64_tr_b16 v[30:31], v25 offset:2048
    s_waitcnt lgkmcnt(10)
    v_mfma_f32_32x32x16_bf16 v[88:103], v[36:39], v[244:247], v[88:103]
    ds_read_b64_tr_b16 v[32:33], v22
    ds_read_b64_tr_b16 v[34:35], v22 offset:2048
    s_waitcnt lgkmcnt(10)
    v_mfma_f32_32x32x16_bf16 v[104:119], v[40:43], v[244:247], v[104:119]
    buffer_load_dwordx4 v[228:231], v249, s[32:35], s16 offen offset:3072 sc1
    ds_read_b64_tr_b16 v[36:37], v23
    ds_read_b64_tr_b16 v[38:39], v23 offset:2048
    s_barrier
    s_waitcnt vmcnt(19)
    s_waitcnt lgkmcnt(10)
    v_mfma_f32_32x32x16_bf16 v[56:71], v[44:47], v[152:155], v[56:71]
    s_add_u32 s16, s16, 16384
    ds_read_b64_tr_b16 v[40:41], v20 offset:1024
    ds_read_b64_tr_b16 v[42:43], v20 offset:3072
    s_waitcnt lgkmcnt(10)
    v_mfma_f32_32x32x16_bf16 v[72:87], v[48:51], v[152:155], v[72:87]
    s_and_b32 s16, s16, 0x3ffff
    ds_read_b64_tr_b16 v[44:45], v21 offset:1024
    ds_read_b64_tr_b16 v[46:47], v21 offset:3072
    s_waitcnt lgkmcnt(10)
    v_mfma_f32_32x32x16_bf16 v[120:135], v[52:55], v[152:155], v[120:135]
    ds_read_b64_tr_b16 v[48:49], v24 offset:1024
    ds_read_b64_tr_b16 v[50:51], v24 offset:3072
    s_waitcnt lgkmcnt(10)
    v_mfma_f32_32x32x16_bf16 v[136:151], v[28:31], v[152:155], v[136:151]
    ds_read_b64_tr_b16 v[52:53], v25 offset:1024
    ds_read_b64_tr_b16 v[54:55], v25 offset:3072
    s_waitcnt lgkmcnt(10)
    v_mfma_f32_32x32x16_bf16 v[88:103], v[32:35], v[152:155], v[88:103]
    ds_read_b64_tr_b16 v[28:29], v22 offset:1024
    ds_read_b64_tr_b16 v[30:31], v22 offset:3072
    s_waitcnt lgkmcnt(10)
    v_mfma_f32_32x32x16_bf16 v[104:119], v[36:39], v[152:155], v[104:119]
    ds_read_b64_tr_b16 v[32:33], v23 offset:1024
    ds_read_b64_tr_b16 v[34:35], v23 offset:3072
    s_waitcnt vmcnt(18)
    s_waitcnt lgkmcnt(10)
    v_mfma_f32_32x32x16_bf16 v[56:71], v[40:43], v[156:159], v[56:71]
    ds_read_b64_tr_b16 v[36:37], v20 offset:4096
    ds_read_b64_tr_b16 v[38:39], v20 offset:6144
    s_waitcnt lgkmcnt(10)
    v_mfma_f32_32x32x16_bf16 v[72:87], v[44:47], v[156:159], v[72:87]
    ds_read_b64_tr_b16 v[40:41], v21 offset:4096
    ds_read_b64_tr_b16 v[42:43], v21 offset:6144
    s_waitcnt lgkmcnt(10)
    v_mfma_f32_32x32x16_bf16 v[120:135], v[48:51], v[156:159], v[120:135]
    ds_read_b64_tr_b16 v[44:45], v24 offset:4096
    ds_read_b64_tr_b16 v[46:47], v24 offset:6144
    s_waitcnt lgkmcnt(10)
    v_mfma_f32_32x32x16_bf16 v[136:151], v[52:55], v[156:159], v[136:151]
    buffer_load_dwordx4 v[232:235], v249, s[32:35], s16 offen sc1
    ds_read_b64_tr_b16 v[48:49], v25 offset:4096
    ds_read_b64_tr_b16 v[50:51], v25 offset:6144
    s_waitcnt lgkmcnt(10)
    v_mfma_f32_32x32x16_bf16 v[88:103], v[28:31], v[156:159], v[88:103]
    ds_read_b64_tr_b16 v[52:53], v22 offset:4096
    ds_read_b64_tr_b16 v[54:55], v22 offset:6144
    s_waitcnt lgkmcnt(10)
    v_mfma_f32_32x32x16_bf16 v[104:119], v[32:35], v[156:159], v[104:119]
    ds_read_b64_tr_b16 v[28:29], v23 offset:4096
    ds_read_b64_tr_b16 v[30:31], v23 offset:6144
    s_waitcnt vmcnt(18)
    s_waitcnt lgkmcnt(10)
    v_mfma_f32_32x32x16_bf16 v[56:71], v[36:39], v[160:163], v[56:71]
    ds_read_b64_tr_b16 v[32:33], v20 offset:5120
    ds_read_b64_tr_b16 v[34:35], v20 offset:7168
    s_waitcnt lgkmcnt(10)
    v_mfma_f32_32x32x16_bf16 v[72:87], v[40:43], v[160:163], v[72:87]
    buffer_load_dwordx4 v[236:239], v249, s[32:35], s16 offen offset:1024 sc1
    ds_read_b64_tr_b16 v[36:37], v21 offset:5120
    ds_read_b64_tr_b16 v[38:39], v21 offset:7168
    s_waitcnt lgkmcnt(10)
    v_mfma_f32_32x32x16_bf16 v[120:135], v[44:47], v[160:163], v[120:135]
    ds_read_b64_tr_b16 v[40:41], v24 offset:5120
    ds_read_b64_tr_b16 v[42:43], v24 offset:7168
    s_waitcnt lgkmcnt(10)
    v_mfma_f32_32x32x16_bf16 v[136:151], v[48:51], v[160:163], v[136:151]
    ds_read_b64_tr_b16 v[44:45], v25 offset:5120
    ds_read_b64_tr_b16 v[46:47], v25 offset:7168
    s_waitcnt lgkmcnt(10)
    v_mfma_f32_32x32x16_bf16 v[88:103], v[52:55], v[160:163], v[88:103]
    buffer_load_dwordx4 v[240:243], v249, s[32:35], s16 offen offset:2048 sc1
    ds_read_b64_tr_b16 v[48:49], v22 offset:5120
    ds_read_b64_tr_b16 v[50:51], v22 offset:7168
    s_waitcnt lgkmcnt(10)
    v_mfma_f32_32x32x16_bf16 v[104:119], v[28:31], v[160:163], v[104:119]
    ds_read_b64_tr_b16 v[52:53], v23 offset:5120
    ds_read_b64_tr_b16 v[54:55], v23 offset:7168
    s_waitcnt vmcnt(19)
    s_waitcnt lgkmcnt(10)
    v_mfma_f32_32x32x16_bf16 v[56:71], v[32:35], v[164:167], v[56:71]
    ds_read_b64_tr_b16 v[28:29], v20 offset:8192
    ds_read_b64_tr_b16 v[30:31], v20 offset:10240
    s_waitcnt lgkmcnt(10)
    v_mfma_f32_32x32x16_bf16 v[72:87], v[36:39], v[164:167], v[72:87]
    ds_read_b64_tr_b16 v[32:33], v21 offset:8192
    ds_read_b64_tr_b16 v[34:35], v21 offset:10240
    s_waitcnt lgkmcnt(10)
    v_mfma_f32_32x32x16_bf16 v[120:135], v[40:43], v[164:167], v[120:135]
    buffer_load_dwordx4 v[244:247], v249, s[32:35], s16 offen offset:3072 sc1
    ds_read_b64_tr_b16 v[36:37], v24 offset:8192
    ds_read_b64_tr_b16 v[38:39], v24 offset:10240
    s_waitcnt lgkmcnt(10)
    v_mfma_f32_32x32x16_bf16 v[136:151], v[44:47], v[164:167], v[136:151]
    s_add_u32 s16, s16, 16384
    ds_read_b64_tr_b16 v[40:41], v25 offset:8192
    ds_read_b64_tr_b16 v[42:43], v25 offset:10240
    s_waitcnt lgkmcnt(10)
    v_mfma_f32_32x32x16_bf16 v[88:103], v[48:51], v[164:167], v[88:103]
    s_and_b32 s16, s16, 0x3ffff
    ds_read_b64_tr_b16 v[44:45], v22 offset:8192
    ds_read_b64_tr_b16 v[46:47], v22 offset:10240
    s_waitcnt lgkmcnt(10)
    v_mfma_f32_32x32x16_bf16 v[104:119], v[52:55], v[164:167], v[104:119]
    buffer_load_dwordx4 v[152:155], v249, s[32:35], s16 offen sc1
    ds_read_b64_tr_b16 v[48:49], v23 offset:8192
    ds_read_b64_tr_b16 v[50:51], v23 offset:10240
    s_barrier
    s_waitcnt vmcnt(20)
    s_waitcnt lgkmcnt(10)
    v_mfma_f32_32x32x16_bf16 v[56:71], v[28:31], v[168:171], v[56:71]
    ds_read_b64_tr_b16 v[52:53], v20 offset:9216
    ds_read_b64_tr_b16 v[54:55], v20 offset:11264
    s_waitcnt lgkmcnt(10)
    v_mfma_f32_32x32x16_bf16 v[72:87], v[32:35], v[168:171], v[72:87]
    ds_read_b64_tr_b16 v[28:29], v21 offset:9216
    ds_read_b64_tr_b16 v[30:31], v21 offset:11264
    s_waitcnt lgkmcnt(10)
    v_mfma_f32_32x32x16_bf16 v[120:135], v[36:39], v[168:171], v[120:135]
    ds_read_b64_tr_b16 v[32:33], v24 offset:9216
    ds_read_b64_tr_b16 v[34:35], v24 offset:11264
    s_waitcnt lgkmcnt(10)
    v_mfma_f32_32x32x16_bf16 v[136:151], v[40:43], v[168:171], v[136:151]
    ds_read_b64_tr_b16 v[36:37], v25 offset:9216
    ds_read_b64_tr_b16 v[38:39], v25 offset:11264
    s_waitcnt lgkmcnt(10)
    v_mfma_f32_32x32x16_bf16 v[88:103], v[44:47], v[168:171], v[88:103]
    ds_read_b64_tr_b16 v[40:41], v22 offset:9216
    ds_read_b64_tr_b16 v[42:43], v22 offset:11264
    s_waitcnt lgkmcnt(10)
    v_mfma_f32_32x32x16_bf16 v[104:119], v[48:51], v[168:171], v[104:119]
    ds_read_b64_tr_b16 v[44:45], v23 offset:9216
    ds_read_b64_tr_b16 v[46:47], v23 offset:11264
    s_waitcnt vmcnt(19)
    s_waitcnt lgkmcnt(10)
    v_mfma_f32_32x32x16_bf16 v[56:71], v[52:55], v[172:175], v[56:71]
    ds_read_b64_tr_b16 v[48:49], v20 offset:12288
    ds_read_b64_tr_b16 v[50:51], v20 offset:14336
    s_waitcnt lgkmcnt(10)
    v_mfma_f32_32x32x16_bf16 v[72:87], v[28:31], v[172:175], v[72:87]
    ds_read_b64_tr_b16 v[52:53], v21 offset:12288
    ds_read_b64_tr_b16 v[54:55], v21 offset:14336
    s_waitcnt lgkmcnt(10)
    v_mfma_f32_32x32x16_bf16 v[120:135], v[32:35], v[172:175], v[120:135]
    ds_read_b64_tr_b16 v[28:29], v24 offset:12288
    ds_read_b64_tr_b16 v[30:31], v24 offset:14336
    s_waitcnt lgkmcnt(10)
    v_mfma_f32_32x32x16_bf16 v[136:151], v[36:39], v[172:175], v[136:151]
    buffer_load_dwordx4 v[156:159], v249, s[32:35], s16 offen offset:1024 sc1
    ds_read_b64_tr_b16 v[32:33], v25 offset:12288
    ds_read_b64_tr_b16 v[34:35], v25 offset:14336
    s_waitcnt lgkmcnt(10)
    v_mfma_f32_32x32x16_bf16 v[88:103], v[40:43], v[172:175], v[88:103]
    ds_read_b64_tr_b16 v[36:37], v22 offset:12288
    ds_read_b64_tr_b16 v[38:39], v22 offset:14336
    s_waitcnt lgkmcnt(10)
    v_mfma_f32_32x32x16_bf16 v[104:119], v[44:47], v[172:175], v[104:119]
    ds_read_b64_tr_b16 v[40:41], v23 offset:12288
    ds_read_b64_tr_b16 v[42:43], v23 offset:14336
    s_waitcnt vmcnt(19)
    s_waitcnt lgkmcnt(10)
    v_mfma_f32_32x32x16_bf16 v[56:71], v[48:51], v[176:179], v[56:71]
    ds_read_b64_tr_b16 v[44:45], v20 offset:13312
    ds_read_b64_tr_b16 v[46:47], v20 offset:15360
    s_waitcnt lgkmcnt(10)
    v_mfma_f32_32x32x16_bf16 v[72:87], v[52:55], v[176:179], v[72:87]
    buffer_load_dwordx4 v[160:163], v249, s[32:35], s16 offen offset:2048 sc1
    ds_read_b64_tr_b16 v[48:49], v21 offset:13312
    ds_read_b64_tr_b16 v[50:51], v21 offset:15360
    s_waitcnt lgkmcnt(10)
    v_mfma_f32_32x32x16_bf16 v[120:135], v[28:31], v[176:179], v[120:135]
    ds_read_b64_tr_b16 v[52:53], v24 offset:13312
    ds_read_b64_tr_b16 v[54:55], v24 offset:15360
    s_waitcnt lgkmcnt(10)
    v_mfma_f32_32x32x16_bf16 v[136:151], v[32:35], v[176:179], v[136:151]
    ds_read_b64_tr_b16 v[28:29], v25 offset:13312
    ds_read_b64_tr_b16 v[30:31], v25 offset:15360
    s_waitcnt lgkmcnt(10)
    v_mfma_f32_32x32x16_bf16 v[88:103], v[36:39], v[176:179], v[88:103]
    buffer_load_dwordx4 v[164:167], v249, s[32:35], s16 offen offset:3072 sc1
    ds_read_b64_tr_b16 v[32:33], v22 offset:13312
    ds_read_b64_tr_b16 v[34:35], v22 offset:15360
    s_waitcnt lgkmcnt(10)
    v_mfma_f32_32x32x16_bf16 v[104:119], v[40:43], v[176:179], v[104:119]
    s_add_u32 s16, s16, 16384
    ds_read_b64_tr_b16 v[36:37], v23 offset:13312
    ds_read_b64_tr_b16 v[38:39], v23 offset:15360
    s_waitcnt vmcnt(20)
    s_waitcnt lgkmcnt(10)
    v_mfma_f32_32x32x16_bf16 v[56:71], v[44:47], v[180:183], v[56:71]
    s_and_b32 s16, s16, 0x3ffff
    ds_read_b64_tr_b16 v[40:41], v20 offset:16384
    ds_read_b64_tr_b16 v[42:43], v20 offset:18432
    s_waitcnt lgkmcnt(10)
    v_mfma_f32_32x32x16_bf16 v[72:87], v[48:51], v[180:183], v[72:87]
    ds_read_b64_tr_b16 v[44:45], v21 offset:16384
    ds_read_b64_tr_b16 v[46:47], v21 offset:18432
    s_waitcnt lgkmcnt(10)
    v_mfma_f32_32x32x16_bf16 v[120:135], v[52:55], v[180:183], v[120:135]
    buffer_load_dwordx4 v[168:171], v249, s[32:35], s16 offen sc1
    ds_read_b64_tr_b16 v[48:49], v24 offset:16384
    ds_read_b64_tr_b16 v[50:51], v24 offset:18432
    s_waitcnt lgkmcnt(10)
    v_mfma_f32_32x32x16_bf16 v[136:151], v[28:31], v[180:183], v[136:151]
    ds_read_b64_tr_b16 v[52:53], v25 offset:16384
    ds_read_b64_tr_b16 v[54:55], v25 offset:18432
    s_waitcnt lgkmcnt(10)
    v_mfma_f32_32x32x16_bf16 v[88:103], v[32:35], v[180:183], v[88:103]
    ds_read_b64_tr_b16 v[28:29], v22 offset:16384
    ds_read_b64_tr_b16 v[30:31], v22 offset:18432
    s_waitcnt lgkmcnt(10)
    v_mfma_f32_32x32x16_bf16 v[104:119], v[36:39], v[180:183], v[104:119]
    buffer_load_dwordx4 v[172:175], v249, s[32:35], s16 offen offset:1024 sc1
    ds_read_b64_tr_b16 v[32:33], v23 offset:16384
    ds_read_b64_tr_b16 v[34:35], v23 offset:18432
    s_barrier
    s_waitcnt vmcnt(21)
    s_waitcnt lgkmcnt(10)
    v_mfma_f32_32x32x16_bf16 v[56:71], v[40:43], v[184:187], v[56:71]
    ds_read_b64_tr_b16 v[36:37], v20 offset:17408
    ds_read_b64_tr_b16 v[38:39], v20 offset:19456
    s_waitcnt lgkmcnt(10)
    v_mfma_f32_32x32x16_bf16 v[72:87], v[44:47], v[184:187], v[72:87]
    ds_read_b64_tr_b16 v[40:41], v21 offset:17408
    ds_read_b64_tr_b16 v[42:43], v21 offset:19456
    s_waitcnt lgkmcnt(10)
    v_mfma_f32_32x32x16_bf16 v[120:135], v[48:51], v[184:187], v[120:135]
    ds_read_b64_tr_b16 v[44:45], v24 offset:17408
    ds_read_b64_tr_b16 v[46:47], v24 offset:19456
    s_waitcnt lgkmcnt(10)
    v_mfma_f32_32x32x16_bf16 v[136:151], v[52:55], v[184:187], v[136:151]
    ds_read_b64_tr_b16 v[48:49], v25 offset:17408
    ds_read_b64_tr_b16 v[50:51], v25 offset:19456
    s_waitcnt lgkmcnt(10)
    v_mfma_f32_32x32x16_bf16 v[88:103], v[28:31], v[184:187], v[88:103]
    ds_read_b64_tr_b16 v[52:53], v22 offset:17408
    ds_read_b64_tr_b16 v[54:55], v22 offset:19456
    s_waitcnt lgkmcnt(10)
    v_mfma_f32_32x32x16_bf16 v[104:119], v[32:35], v[184:187], v[104:119]
    ds_read_b64_tr_b16 v[28:29], v23 offset:17408
    ds_read_b64_tr_b16 v[30:31], v23 offset:19456
    s_waitcnt vmcnt(20)
    s_waitcnt lgkmcnt(10)
    v_mfma_f32_32x32x16_bf16 v[56:71], v[36:39], v[188:191], v[56:71]
    ds_read_b64_tr_b16 v[32:33], v20 offset:20480
    ds_read_b64_tr_b16 v[34:35], v20 offset:22528
    s_waitcnt lgkmcnt(10)
    v_mfma_f32_32x32x16_bf16 v[72:87], v[40:43], v[188:191], v[72:87]
    ds_read_b64_tr_b16 v[36:37], v21 offset:20480
    ds_read_b64_tr_b16 v[38:39], v21 offset:22528
    s_waitcnt lgkmcnt(10)
    v_mfma_f32_32x32x16_bf16 v[120:135], v[44:47], v[188:191], v[120:135]
    ds_read_b64_tr_b16 v[40:41], v24 offset:20480
    ds_read_b64_tr_b16 v[42:43], v24 offset:22528
    s_waitcnt lgkmcnt(10)
    v_mfma_f32_32x32x16_bf16 v[136:151], v[48:51], v[188:191], v[136:151]
    buffer_load_dwordx4 v[176:179], v249, s[32:35], s16 offen offset:2048 sc1
    ds_read_b64_tr_b16 v[44:45], v25 offset:20480
    ds_read_b64_tr_b16 v[46:47], v25 offset:22528
    s_waitcnt lgkmcnt(10)
    v_mfma_f32_32x32x16_bf16 v[88:103], v[52:55], v[188:191], v[88:103]
    ds_read_b64_tr_b16 v[48:49], v22 offset:20480
    ds_read_b64_tr_b16 v[50:51], v22 offset:22528
    s_waitcnt lgkmcnt(10)
    v_mfma_f32_32x32x16_bf16 v[104:119], v[28:31], v[188:191], v[104:119]
L_PAD3:
    s_cbranch_execz L_RET3
    ds_read_b64_tr_b16 v[52:53], v23 offset:20480
    ds_read_b64_tr_b16 v[54:55], v23 offset:22528
    s_waitcnt vmcnt(20)
    s_waitcnt lgkmcnt(10)
    v_mfma_f32_32x32x16_bf16 v[56:71], v[32:35], v[192:195], v[56:71]
    ds_read_b64_tr_b16 v[28:29], v20 offset:21504
    ds_read_b64_tr_b16 v[30:31], v20 offset:23552
    s_waitcnt lgkmcnt(10)
    v_mfma_f32_32x32x16_bf16 v[72:87], v[36:39], v[192:195], v[72:87]
    buffer_load_dwordx4 v[180:183], v249, s[32:35], s16 offen offset:3072 sc1
    ds_read_b64_tr_b16 v[32:33], v21 offset:21504
    ds_read_b64_tr_b16 v[34:35], v21 offset:23552
    s_waitcnt lgkmcnt(10)
    v_mfma_f32_32x32x16_bf16 v[120:135], v[40:43], v[192:195], v[120:135]
    s_add_u32 s16, s16, 16384
    ds_read_b64_tr_b16 v[36:37], v24 offset:21504
    ds_read_b64_tr_b16 v[38:39], v24 offset:23552
    s_waitcnt lgkmcnt(10)
    v_mfma_f32_32x32x16_bf16 v[136:151], v[44:47], v[192:195], v[136:151]
    s_and_b32 s16, s16, 0x3ffff
    ds_read_b64_tr_b16 v[40:41], v25 offset:21504
    ds_read_b64_tr_b16 v[42:43], v25 offset:23552
    s_waitcnt lgkmcnt(10)
    v_mfma_f32_32x32x16_bf16 v[88:103], v[48:51], v[192:195], v[88:103]
    buffer_load_dwordx4 v[184:187], v249, s[32:35], s16 offen sc1
    ds_read_b64_tr_b16 v[44:45], v22 offset:21504
    ds_read_b64_tr_b16 v[46:47], v22 offset:23552
    s_waitcnt lgkmcnt(10)
    v_mfma_f32_32x32x16_bf16 v[104:119], v[52:55], v[192:195], v[104:119]
    ds_read_b64_tr_b16 v[48:49], v23 offset:21504
    ds_read_b64_tr_b16 v[50:51], v23 offset:23552
    s_waitcnt vmcnt(21)
    s_waitcnt lgkmcnt(10)
    v_mfma_f32_32x32x16_bf16 v[56:71], v[28:31], v[196:199], v[56:71]
    ds_read_b64_tr_b16 v[52:53], v20 offset:24576
    ds_read_b64_tr_b16 v[54:55], v20 offset:26624
    s_waitcnt lgkmcnt(10)
    v_mfma_f32_32x32x16_bf16 v[72:87], v[32:35], v[196:199], v[72:87]
    ds_read_b64_tr_b16 v[28:29], v21 offset:24576
    ds_read_b64_tr_b16 v[30:31], v21 offset:26624
    s_waitcnt lgkmcnt(10)
    v_mfma_f32_32x32x16_bf16 v[120:135], v[36:39], v[196:199], v[120:135]
    buffer_load_dwordx4 v[188:191], v249, s[32:35], s16 offen offset:1024 sc1
    ds_read_b64_tr_b16 v[32:33], v20 offset:25600
    ds_read_b64_tr_b16 v[34:35], v20 offset:27648
    s_waitcnt lgkmcnt(10)
    v_mfma_f32_32x32x16_bf16 v[136:151], v[40:43], v[196:199], v[136:151]
    ds_read_b64_tr_b16 v[36:37], v21 offset:25600
    ds_read_b64_tr_b16 v[38:39], v21 offset:27648
    s_waitcnt lgkmcnt(10)
    v_mfma_f32_32x32x16_bf16 v[88:103], v[44:47], v[196:199], v[88:103]
    ds_read_b64_tr_b16 v[40:41], v20 offset:28672
    ds_read_b64_tr_b16 v[42:43], v20 offset:30720
    s_waitcnt lgkmcnt(10)
    v_mfma_f32_32x32x16_bf16 v[104:119], v[48:51], v[196:199], v[104:119]
    buffer_load_dwordx4 v[192:195], v249, s[32:35], s16 offen offset:2048 sc1
    ds_read_b64_tr_b16 v[44:45], v21 offset:28672
    ds_read_b64_tr_b16 v[46:47], v21 offset:30720
    s_barrier
    s_waitcnt vmcnt(22)
    s_waitcnt lgkmcnt(10)
    v_mfma_f32_32x32x16_bf16 v[56:71], v[52:55], v[200:203], v[56:71]
    ds_read_b64_tr_b16 v[48:49], v20 offset:29696
    ds_read_b64_tr_b16 v[50:51], v20 offset:31744
    s_waitcnt lgkmcnt(10)
    v_mfma_f32_32x32x16_bf16 v[72:87], v[28:31], v[200:203], v[72:87]
    ds_read_b64_tr_b16 v[52:53], v21 offset:29696
    ds_read_b64_tr_b16 v[54:55], v21 offset:31744
    s_waitcnt vmcnt(21)
    s_waitcnt lgkmcnt(10)
    v_mfma_f32_32x32x16_bf16 v[56:71], v[32:35], v[204:207], v[56:71]
    ds_read_b64_tr_b16 v[28:29], v24 offset:24576
    ds_read_b64_tr_b16 v[30:31], v24 offset:26624
    s_waitcnt lgkmcnt(10)
    v_mfma_f32_32x32x16_bf16 v[72:87], v[36:39], v[204:207], v[72:87]
    ds_read_b64_tr_b16 v[32:33], v25 offset:24576
    ds_read_b64_tr_b16 v[34:35], v25 offset:26624
    s_waitcnt vmcnt(20)
    s_waitcnt lgkmcnt(10)
    v_mfma_f32_32x32x16_bf16 v[56:71], v[40:43], v[208:211], v[56:71]
    ds_read_b64_tr_b16 v[36:37], v22 offset:24576
    ds_read_b64_tr_b16 v[38:39], v22 offset:26624
    s_waitcnt lgkmcnt(10)
    v_mfma_f32_32x32x16_bf16 v[72:87], v[44:47], v[208:211], v[72:87]
    ds_read_b64_tr_b16 v[40:41], v23 offset:24576
    ds_read_b64_tr_b16 v[42:43], v23 offset:26624
    s_waitcnt vmcnt(19)
    s_waitcnt lgkmcnt(10)
    v_mfma_f32_32x32x16_bf16 v[56:71], v[48:51], v[212:215], v[56:71]
    ds_read_b64_tr_b16 v[44:45], v24 offset:25600
    ds_read_b64_tr_b16 v[46:47], v24 offset:27648
    s_waitcnt lgkmcnt(10)
    v_mfma_f32_32x32x16_bf16 v[72:87], v[52:55], v[212:215], v[72:87]
    ds_read_b64_tr_b16 v[48:49], v25 offset:25600
    ds_read_b64_tr_b16 v[50:51], v25 offset:27648
    s_barrier
    s_waitcnt lgkmcnt(10)
    v_mfma_f32_32x32x16_bf16 v[120:135], v[28:31], v[200:203], v[120:135]
    ds_read_b64_tr_b16 v[52:53], v22 offset:25600
    ds_read_b64_tr_b16 v[54:55], v22 offset:27648
    s_waitcnt lgkmcnt(10)
    v_mfma_f32_32x32x16_bf16 v[136:151], v[32:35], v[200:203], v[136:151]
    buffer_load_dwordx4 v[196:199], v249, s[32:35], s16 offen offset:3072 sc1
    ds_read_b64_tr_b16 v[28:29], v23 offset:25600
    ds_read_b64_tr_b16 v[30:31], v23 offset:27648
    s_waitcnt lgkmcnt(10)
    v_mfma_f32_32x32x16_bf16 v[88:103], v[36:39], v[200:203], v[88:103]
    s_add_u32 s16, s16, 16384
    ds_read_b64_tr_b16 v[32:33], v24 offset:28672
    ds_read_b64_tr_b16 v[34:35], v24 offset:30720
    s_waitcnt lgkmcnt(10)
    v_mfma_f32_32x32x16_bf16 v[104:119], v[40:43], v[200:203], v[104:119]
    s_and_b32 s16, s16, 0x3ffff
    ds_read_b64_tr_b16 v[36:37], v25 offset:28672
    ds_read_b64_tr_b16 v[38:39], v25 offset:30720
    s_waitcnt lgkmcnt(10)
    v_mfma_f32_32x32x16_bf16 v[120:135], v[44:47], v[204:207], v[120:135]
    ds_read_b64_tr_b16 v[40:41], v22 offset:28672
    ds_read_b64_tr_b16 v[42:43], v22 offset:30720
    s_waitcnt lgkmcnt(10)
    v_mfma_f32_32x32x16_bf16 v[136:151], v[48:51], v[204:207], v[136:151]
    buffer_load_dwordx4 v[200:203], v249, s[32:35], s16 offen sc1
    ds_read_b64_tr_b16 v[44:45], v23 offset:28672
    ds_read_b64_tr_b16 v[46:47], v23 offset:30720
    s_waitcnt lgkmcnt(10)
    v_mfma_f32_32x32x16_bf16 v[88:103], v[52:55], v[204:207], v[88:103]
    ds_read_b64_tr_b16 v[48:49], v24 offset:29696
    ds_read_b64_tr_b16 v[50:51], v24 offset:31744
    s_waitcnt lgkmcnt(10)
    v_mfma_f32_32x32x16_bf16 v[104:119], v[28:31], v[204:207], v[104:119]
    ds_read_b64_tr_b16 v[52:53], v25 offset:29696
    ds_read_b64_tr_b16 v[54:55], v25 offset:31744
    s_waitcnt lgkmcnt(10)
    v_mfma_f32_32x32x16_bf16 v[120:135], v[32:35], v[208:211], v[120:135]
    buffer_load_dwordx4 v[204:207], v249, s[32:35], s16 offen offset:1024 sc1
    ds_read_b64_tr_b16 v[28:29], v22 offset:29696
    ds_read_b64_tr_b16 v[30:31], v22 offset:31744
    s_waitcnt lgkmcnt(10)
    v_mfma_f32_32x32x16_bf16 v[136:151], v[36:39], v[208:211], v[136:151]
    ds_read_b64_tr_b16 v[32:33], v23 offset:29696
    ds_read_b64_tr_b16 v[34:35], v23 offset:31744
    s_waitcnt lgkmcnt(10)
    v_mfma_f32_32x32x16_bf16 v[88:103], v[40:43], v[208:211], v[88:103]
    ds_read_b64_tr_b16 v[36:37], v20 offset:32768
    ds_read_b64_tr_b16 v[38:39], v20 offset:34816
    s_waitcnt lgkmcnt(10)
    v_mfma_f32_32x32x16_bf16 v[104:119], v[44:47], v[208:211], v[104:119]
    ds_read_b64_tr_b16 v[40:41], v20 offset:33792
    ds_read_b64_tr_b16 v[42:43], v20 offset:35840
    s_waitcnt lgkmcnt(10)
    v_mfma_f32_32x32x16_bf16 v[120:135], v[48:51], v[212:215], v[120:135]
    buffer_load_dwordx4 v[208:211], v249, s[32:35], s16 offen offset:2048 sc1
    ds_read_b64_tr_b16 v[44:45], v20 offset:36864
    ds_read_b64_tr_b16 v[46:47], v20 offset:38912
    s_waitcnt lgkmcnt(10)
    v_mfma_f32_32x32x16_bf16 v[136:151], v[52:55], v[212:215], v[136:151]
    ds_read_b64_tr_b16 v[48:49], v20 offset:37888
    ds_read_b64_tr_b16 v[50:51], v20 offset:39936
    s_waitcnt lgkmcnt(10)
    v_mfma_f32_32x32x16_bf16 v[88:103], v[28:31], v[212:215], v[88:103]
    ds_read_b64_tr_b16 v[52:53], v20 offset:40960
    ds_read_b64_tr_b16 v[54:55], v20 offset:43008
    s_waitcnt lgkmcnt(10)
    v_mfma_f32_32x32x16_bf16 v[104:119], v[32:35], v[212:215], v[104:119]
    buffer_load_dwordx4 v[212:215], v249, s[32:35], s16 offen offset:3072 sc1
    ds_read_b64_tr_b16 v[28:29], v20 offset:41984
    ds_read_b64_tr_b16 v[30:31], v20 offset:44032
    s_barrier
    s_waitcnt vmcnt(23)
    s_waitcnt lgkmcnt(10)
    v_mfma_f32_32x32x16_bf16 v[56:71], v[36:39], v[216:219], v[56:71]
    s_add_u32 s16, s16, 16384
    ds_read_b64_tr_b16 v[32:33], v20 offset:45056
    ds_read_b64_tr_b16 v[34:35], v20 offset:47104
    s_waitcnt vmcnt(22)
    s_waitcnt lgkmcnt(10)
    v_mfma_f32_32x32x16_bf16 v[56:71], v[40:43], v[220:223], v[56:71]
    s_and_b32 s16, s16, 0x3ffff
    ds_read_b64_tr_b16 v[36:37], v20 offset:46080
    ds_read_b64_tr_b16 v[38:39], v20 offset:48128
    s_waitcnt vmcnt(21)
    s_waitcnt lgkmcnt(10)
    v_mfma_f32_32x32x16_bf16 v[56:71], v[44:47], v[224:227], v[56:71]
    ds_read_b64_tr_b16 v[40:41], v20
    ds_read_b64_tr_b16 v[42:43], v20 offset:2048
    s_waitcnt vmcnt(20)
    s_waitcnt lgkmcnt(10)
    v_mfma_f32_32x32x16_bf16 v[56:71], v[48:51], v[228:231], v[56:71]
    ds_read_b64_tr_b16 v[44:45], v20 offset:1024
    ds_read_b64_tr_b16 v[46:47], v20 offset:3072
    s_waitcnt vmcnt(19)
    s_waitcnt lgkmcnt(10)
    v_mfma_f32_32x32x16_bf16 v[56:71], v[52:55], v[232:235], v[56:71]
    ds_read_b64_tr_b16 v[48:49], v20 offset:4096
    ds_read_b64_tr_b16 v[50:51], v20 offset:6144
    s_waitcnt vmcnt(18)
    s_waitcnt lgkmcnt(10)
    v_mfma_f32_32x32x16_bf16 v[56:71], v[28:31], v[236:239], v[56:71]
    ds_read_b64_tr_b16 v[52:53], v20 offset:5120
    ds_read_b64_tr_b16 v[54:55], v20 offset:7168
    s_waitcnt vmcnt(17)
    s_waitcnt lgkmcnt(10)
    v_mfma_f32_32x32x16_bf16 v[56:71], v[32:35], v[240:243], v[56:71]
    ds_read_b64_tr_b16 v[28:29], v20 offset:8192
    ds_read_b64_tr_b16 v[30:31], v20 offset:10240
    s_waitcnt vmcnt(16)
    s_waitcnt lgkmcnt(10)
    v_mfma_f32_32x32x16_bf16 v[56:71], v[36:39], v[244:247], v[56:71]
    ds_read_b64_tr_b16 v[32:33], v20 offset:9216
    ds_read_b64_tr_b16 v[34:35], v20 offset:11264
    s_waitcnt vmcnt(15)
    s_waitcnt lgkmcnt(10)
    v_mfma_f32_32x32x16_bf16 v[56:71], v[40:43], v[152:155], v[56:71]
    ds_read_b64_tr_b16 v[36:37], v20 offset:12288
    ds_read_b64_tr_b16 v[38:39], v20 offset:14336
    s_waitcnt vmcnt(14)
    s_waitcnt lgkmcnt(10)
    v_mfma_f32_32x32x16_bf16 v[56:71], v[44:47], v[156:159], v[56:71]
    ds_read_b64_tr_b16 v[40:41], v20 offset:13312
    ds_read_b64_tr_b16 v[42:43], v20 offset:15360
    s_waitcnt vmcnt(13)
    s_waitcnt lgkmcnt(10)
    v_mfma_f32_32x32x16_bf16 v[56:71], v[48:51], v[160:163], v[56:71]
    ds_read_b64_tr_b16 v[44:45], v20 offset:16384
    ds_read_b64_tr_b16 v[46:47], v20 offset:18432
    s_waitcnt vmcnt(12)
    s_waitcnt lgkmcnt(10)
    v_mfma_f32_32x32x16_bf16 v[56:71], v[52:55], v[164:167], v[56:71]
    ds_read_b64_tr_b16 v[48:49], v20 offset:17408
    ds_read_b64_tr_b16 v[50:51], v20 offset:19456
    s_waitcnt vmcnt(11)
    s_waitcnt lgkmcnt(10)
    v_mfma_f32_32x32x16_bf16 v[56:71], v[28:31], v[168:171], v[56:71]
    ds_read_b64_tr_b16 v[52:53], v20 offset:20480
    ds_read_b64_tr_b16 v[54:55], v20 offset:22528
    s_waitcnt vmcnt(10)
    s_waitcnt lgkmcnt(10)
    v_mfma_f32_32x32x16_bf16 v[56:71], v[32:35], v[172:175], v[56:71]
    ds_read_b64_tr_b16 v[28:29], v20 offset:21504
    ds_read_b64_tr_b16 v[30:31], v20 offset:23552
    s_barrier
    s_waitcnt vmcnt(9)
    s_waitcnt lgkmcnt(10)
    v_mfma_f32_32x32x16_bf16 v[56:71], v[36:39], v[176:179], v[56:71]
    ds_read_b64_tr_b16 v[32:33], v20 offset:24576
    ds_read_b64_tr_b16 v[34:35], v20 offset:26624
    s_waitcnt vmcnt(8)
    s_waitcnt lgkmcnt(10)
    v_mfma_f32_32x32x16_bf16 v[56:71], v[40:43], v[180:183], v[56:71]
    ds_read_b64_tr_b16 v[36:37], v20 offset:25600
    ds_read_b64_tr_b16 v[38:39], v20 offset:27648
    s_waitcnt vmcnt(7)
    s_waitcnt lgkmcnt(10)
    v_mfma_f32_32x32x16_bf16 v[56:71], v[44:47], v[184:187], v[56:71]
    ds_read_b64_tr_b16 v[40:41], v20 offset:28672
    ds_read_b64_tr_b16 v[42:43], v20 offset:30720
    s_waitcnt vmcnt(6)
    s_waitcnt lgkmcnt(10)
    v_mfma_f32_32x32x16_bf16 v[56:71], v[48:51], v[188:191], v[56:71]
    ds_read_b64_tr_b16 v[44:45], v20 offset:29696
    ds_read_b64_tr_b16 v[46:47], v20 offset:31744
    s_waitcnt vmcnt(5)
    s_waitcnt lgkmcnt(10)
    v_mfma_f32_32x32x16_bf16 v[56:71], v[52:55], v[192:195], v[56:71]
    ds_read_b64_tr_b16 v[48:49], v21 offset:32768
    ds_read_b64_tr_b16 v[50:51], v21 offset:34816
    s_waitcnt vmcnt(4)
    s_waitcnt lgkmcnt(10)
    v_mfma_f32_32x32x16_bf16 v[56:71], v[28:31], v[196:199], v[56:71]
    ds_read_b64_tr_b16 v[52:53], v21 offset:33792
    ds_read_b64_tr_b16 v[54:55], v21 offset:35840
    s_waitcnt vmcnt(3)
    s_waitcnt lgkmcnt(10)
    v_mfma_f32_32x32x16_bf16 v[56:71], v[32:35], v[200:203], v[56:71]
    ds_read_b64_tr_b16 v[28:29], v21 offset:36864
    ds_read_b64_tr_b16 v[30:31], v21 offset:38912
    s_waitcnt vmcnt(2)
    s_waitcnt lgkmcnt(10)
    v_mfma_f32_32x32x16_bf16 v[56:71], v[36:39], v[204:207], v[56:71]
    ds_read_b64_tr_b16 v[32:33], v21 offset:37888
    ds_read_b64_tr_b16 v[34:35], v21 offset:39936
    s_waitcnt vmcnt(1)
    s_waitcnt lgkmcnt(10)
    v_mfma_f32_32x32x16_bf16 v[56:71], v[40:43], v[208:211], v[56:71]
    ds_read_b64_tr_b16 v[36:37], v21 offset:40960
    ds_read_b64_tr_b16 v[38:39], v21 offset:43008
    s_waitcnt vmcnt(0)
    s_waitcnt lgkmcnt(10)
    v_mfma_f32_32x32x16_bf16 v[56:71], v[44:47], v[212:215], v[56:71]
    ds_read_b64_tr_b16 v[40:41], v21 offset:41984
    ds_read_b64_tr_b16 v[42:43], v21 offset:44032
    s_waitcnt lgkmcnt(10)
    v_mfma_f32_32x32x16_bf16 v[72:87], v[48:51], v[216:219], v[72:87]
    ds_read_b64_tr_b16 v[44:45], v21 offset:45056
    ds_read_b64_tr_b16 v[46:47], v21 offset:47104
    s_waitcnt lgkmcnt(10)
    v_mfma_f32_32x32x16_bf16 v[72:87], v[52:55], v[220:223], v[72:87]
    s_nop 3
    v_cvt_pk_bf16_f32 v56, v56, v57
    v_cvt_pk_bf16_f32 v57, v58, v59
    ds_read_b64_tr_b16 v[48:49], v21 offset:46080
    ds_read_b64_tr_b16 v[50:51], v21 offset:48128
    s_waitcnt lgkmcnt(10)
    v_mfma_f32_32x32x16_bf16 v[72:87], v[28:31], v[224:227], v[72:87]
    v_cvt_pk_bf16_f32 v58, v60, v61
    v_cvt_pk_bf16_f32 v59, v62, v63
    ds_read_b64_tr_b16 v[52:53], v21
    ds_read_b64_tr_b16 v[54:55], v21 offset:2048
    s_waitcnt lgkmcnt(10)
    v_mfma_f32_32x32x16_bf16 v[72:87], v[32:35], v[228:231], v[72:87]
    ds_write_b128 v0, v[56:59]
    v_cvt_pk_bf16_f32 v60, v64, v65
    ds_read_b64_tr_b16 v[28:29], v21 offset:1024
    ds_read_b64_tr_b16 v[30:31], v21 offset:3072
    s_waitcnt lgkmcnt(11)
    v_mfma_f32_32x32x16_bf16 v[72:87], v[36:39], v[232:235], v[72:87]
    v_cvt_pk_bf16_f32 v61, v66, v67
    v_cvt_pk_bf16_f32 v62, v68, v69
    ds_read_b64_tr_b16 v[32:33], v21 offset:4096
    ds_read_b64_tr_b16 v[34:35], v21 offset:6144
    s_waitcnt lgkmcnt(11)
    v_mfma_f32_32x32x16_bf16 v[72:87], v[40:43], v[236:239], v[72:87]
    v_cvt_pk_bf16_f32 v63, v70, v71
    ds_write_b128 v0, v[60:63] offset:1024
    ds_read_b64_tr_b16 v[36:37], v21 offset:5120
    ds_read_b64_tr_b16 v[38:39], v21 offset:7168
    s_waitcnt lgkmcnt(12)
    v_mfma_f32_32x32x16_bf16 v[72:87], v[44:47], v[240:243], v[72:87]
    v_subrev_u32 v0, 118784, v0
    ds_read_b64_tr_b16 v[40:41], v21 offset:8192
    ds_read_b64_tr_b16 v[42:43], v21 offset:10240
    s_waitcnt lgkmcnt(12)
    v_mfma_f32_32x32x16_bf16 v[72:87], v[48:51], v[244:247], v[72:87]
    ds_read_b64_tr_b16 v[44:45], v21 offset:9216
    ds_read_b64_tr_b16 v[46:47], v21 offset:11264
    s_waitcnt lgkmcnt(6)
    s_barrier
    v_mfma_f32_32x32x16_bf16 v[72:87], v[52:55], v[152:155], v[72:87]
    ds_read_b64_tr_b16 v[48:49], v21 offset:12288
    ds_read_b64_tr_b16 v[50:51], v21 offset:14336
    v_mfma_f32_32x32x16_bf16 v[72:87], v[28:31], v[156:159], v[72:87]
    ds_read_b64_tr_b16 v[52:53], v21 offset:13312
    ds_read_b64_tr_b16 v[54:55], v21 offset:15360
    v_mfma_f32_32x32x16_bf16 v[72:87], v[32:35], v[160:163], v[72:87]
    ds_read_b64_tr_b16 v[28:29], v21 offset:16384
    ds_read_b64_tr_b16 v[30:31], v21 offset:18432
    s_waitcnt lgkmcnt(10)
    v_mfma_f32_32x32x16_bf16 v[72:87], v[36:39], v[164:167], v[72:87]
    ds_read_b64_tr_b16 v[32:33], v21 offset:17408
    ds_read_b64_tr_b16 v[34:35], v21 offset:19456
    s_waitcnt lgkmcnt(10)
    v_mfma_f32_32x32x16_bf16 v[72:87], v[40:43], v[168:171], v[72:87]
    ds_read_b64_tr_b16 v[36:37], v21 offset:20480
    ds_read_b64_tr_b16 v[38:39], v21 offset:22528
    s_waitcnt lgkmcnt(10)
    v_mfma_f32_32x32x16_bf16 v[72:87], v[44:47], v[172:175], v[72:87]
    ds_read_b64_tr_b16 v[40:41], v21 offset:21504
    ds_read_b64_tr_b16 v[42:43], v21 offset:23552
    s_waitcnt lgkmcnt(10)
    v_mfma_f32_32x32x16_bf16 v[72:87], v[48:51], v[176:179], v[72:87]
    ds_read_b64_tr_b16 v[44:45], v21 offset:24576
    ds_read_b64_tr_b16 v[46:47], v21 offset:26624
    s_waitcnt lgkmcnt(10)
    v_mfma_f32_32x32x16_bf16 v[72:87], v[52:55], v[180:183], v[72:87]
    ds_read_b64_tr_b16 v[48:49], v21 offset:25600
    ds_read_b64_tr_b16 v[50:51], v21 offset:27648
    s_waitcnt lgkmcnt(10)
    v_mfma_f32_32x32x16_bf16 v[72:87], v[28:31], v[184:187], v[72:87]
    ds_read_b64_tr_b16 v[52:53], v21 offset:28672
    ds_read_b64_tr_b16 v[54:55], v21 offset:30720
    s_waitcnt lgkmcnt(10)
    v_mfma_f32_32x32x16_bf16 v[72:87], v[32:35], v[188:191], v[72:87]
    ds_read_b64_tr_b16 v[28:29], v21 offset:29696
    ds_read_b64_tr_b16 v[30:31], v21 offset:31744
    s_waitcnt lgkmcnt(10)
    v_mfma_f32_32x32x16_bf16 v[72:87], v[36:39], v[192:195], v[72:87]
    ds_read_b64_tr_b16 v[32:33], v22 offset:32768
    ds_read_b64_tr_b16 v[34:35], v22 offset:34816
    s_waitcnt lgkmcnt(10)
    v_mfma_f32_32x32x16_bf16 v[72:87], v[40:43], v[196:199], v[72:87]
    ds_read_b64_tr_b16 v[36:37], v23 offset:32768
    ds_read_b64_tr_b16 v[38:39], v23 offset:34816
    s_waitcnt lgkmcnt(10)
    v_mfma_f32_32x32x16_bf16 v[72:87], v[44:47], v[200:203], v[72:87]
    ds_read_b64_tr_b16 v[40:41], v22 offset:33792
    ds_read_b64_tr_b16 v[42:43], v22 offset:35840
    s_waitcnt lgkmcnt(10)
    v_mfma_f32_32x32x16_bf16 v[72:87], v[48:51], v[204:207], v[72:87]
    ds_read_b64_tr_b16 v[44:45], v23 offset:33792
    ds_read_b64_tr_b16 v[46:47], v23 offset:35840
    s_waitcnt lgkmcnt(10)
    v_mfma_f32_32x32x16_bf16 v[72:87], v[52:55], v[208:211], v[72:87]
    ds_read_b64_tr_b16 v[48:49], v22 offset:36864
    ds_read_b64_tr_b16 v[50:51], v22 offset:38912
    s_waitcnt lgkmcnt(10)
    v_mfma_f32_32x32x16_bf16 v[72:87], v[28:31], v[212:215], v[72:87]
    ds_read_b64_tr_b16 v[52:53], v23 offset:36864
    ds_read_b64_tr_b16 v[54:55], v23 offset:38912
    s_waitcnt lgkmcnt(10)
    v_mfma_f32_32x32x16_bf16 v[88:103], v[32:35], v[216:219], v[88:103]
    ds_read_b64_tr_b16 v[28:29], v22 offset:37888
    ds_read_b64_tr_b16 v[30:31], v22 offset:39936
    s_waitcnt lgkmcnt(10)
    v_mfma_f32_32x32x16_bf16 v[104:119], v[36:39], v[216:219], v[104:119]
    s_nop 3
    v_cvt_pk_bf16_f32 v72, v72, v73
    v_cvt_pk_bf16_f32 v73, v74, v75
    ds_read_b64_tr_b16 v[32:33], v23 offset:37888
    ds_read_b64_tr_b16 v[34:35], v23 offset:39936
    s_waitcnt lgkmcnt(10)
    v_mfma_f32_32x32x16_bf16 v[88:103], v[40:43], v[220:223], v[88:103]
    v_cvt_pk_bf16_f32 v74, v76, v77
    v_cvt_pk_bf16_f32 v75, v78, v79
    ds_read_b64_tr_b16 v[36:37], v22 offset:40960
    ds_read_b64_tr_b16 v[38:39], v22 offset:43008
    s_waitcnt lgkmcnt(10)
    v_mfma_f32_32x32x16_bf16 v[104:119], v[44:47], v[220:223], v[104:119]
    ds_write_b128 v0, v[72:75]
    v_cvt_pk_bf16_f32 v76, v80, v81
    ds_read_b64_tr_b16 v[40:41], v23 offset:40960
    ds_read_b64_tr_b16 v[42:43], v23 offset:43008
    s_waitcnt lgkmcnt(11)
    v_mfma_f32_32x32x16_bf16 v[88:103], v[48:51], v[224:227], v[88:103]
    v_cvt_pk_bf16_f32 v77, v82, v83
    v_cvt_pk_bf16_f32 v78, v84, v85
    ds_read_b64_tr_b16 v[44:45], v22 offset:41984
    ds_read_b64_tr_b16 v[46:47], v22 offset:44032
    s_waitcnt lgkmcnt(11)
    v_mfma_f32_32x32x16_bf16 v[104:119], v[52:55], v[224:227], v[104:119]
    v_cvt_pk_bf16_f32 v79, v86, v87
    ds_write_b128 v0, v[76:79] offset:1024
    ds_read_b64_tr_b16 v[48:49], v23 offset:41984
    ds_read_b64_tr_b16 v[50:51], v23 offset:44032
    s_waitcnt lgkmcnt(12)
    v_mfma_f32_32x32x16_bf16 v[88:103], v[28:31], v[228:231], v[88:103]
    ds_read_b64_tr_b16 v[52:53], v22 offset:45056
    ds_read_b64_tr_b16 v[54:55], v22 offset:47104
    s_waitcnt lgkmcnt(12)
    v_mfma_f32_32x32x16_bf16 v[104:119], v[32:35], v[228:231], v[104:119]
    ds_read_b64_tr_b16 v[28:29], v23 offset:45056
    ds_read_b64_tr_b16 v[30:31], v23 offset:47104
    s_waitcnt lgkmcnt(6)
    s_barrier
    v_mfma_f32_32x32x16_bf16 v[88:103], v[36:39], v[232:235], v[88:103]
    s_lshl_b32 s96, s77, 11
    s_add_u32 s14, s96, 32768
    v_and_b32 v0, 7, v1
    ds_read_b64_tr_b16 v[32:33], v22 offset:46080
    ds_read_b64_tr_b16 v[34:35], v22 offset:48128
    v_mfma_f32_32x32x16_bf16 v[104:119], v[40:43], v[232:235], v[104:119]
    v_lshl_add_u32 v0, v0, 4, s14
    ds_read_b64_tr_b16 v[36:37], v23 offset:46080
    ds_read_b64_tr_b16 v[38:39], v23 offset:48128
    v_mfma_f32_32x32x16_bf16 v[88:103], v[44:47], v[236:239], v[88:103]
    v_bfe_u32 v4, v1, 3, 2
    ds_read_b64_tr_b16 v[40:41], v22
    ds_read_b64_tr_b16 v[42:43], v22 offset:2048
    s_waitcnt lgkmcnt(10)
    v_mfma_f32_32x32x16_bf16 v[104:119], v[48:51], v[236:239], v[104:119]
    v_lshl_add_u32 v0, v4, 8, v0
    v_lshrrev_b32 v4, 5, v1
    ds_read_b64_tr_b16 v[44:45], v23
    ds_read_b64_tr_b16 v[46:47], v23 offset:2048
    s_waitcnt lgkmcnt(10)
    v_mfma_f32_32x32x16_bf16 v[88:103], v[52:55], v[240:243], v[88:103]
    v_lshl_add_u32 v0, v4, 7, v0
    ds_read_b64_tr_b16 v[48:49], v22 offset:1024
    ds_read_b64_tr_b16 v[50:51], v22 offset:3072
    s_waitcnt lgkmcnt(10)
    v_mfma_f32_32x32x16_bf16 v[104:119], v[28:31], v[240:243], v[104:119]
    ds_read_b64_tr_b16 v[52:53], v23 offset:1024
    ds_read_b64_tr_b16 v[54:55], v23 offset:3072
    s_waitcnt lgkmcnt(10)
    v_mfma_f32_32x32x16_bf16 v[88:103], v[32:35], v[244:247], v[88:103]
    ds_read_b64_tr_b16 v[28:29], v22 offset:4096
    ds_read_b64_tr_b16 v[30:31], v22 offset:6144
    s_waitcnt lgkmcnt(10)
    v_mfma_f32_32x32x16_bf16 v[104:119], v[36:39], v[244:247], v[104:119]
    ds_read_b64_tr_b16 v[32:33], v23 offset:4096
    ds_read_b64_tr_b16 v[34:35], v23 offset:6144
    s_waitcnt lgkmcnt(10)
    v_mfma_f32_32x32x16_bf16 v[88:103], v[40:43], v[152:155], v[88:103]
    ds_read_b64_tr_b16 v[36:37], v22 offset:5120
    ds_read_b64_tr_b16 v[38:39], v22 offset:7168
    s_waitcnt lgkmcnt(10)
    v_mfma_f32_32x32x16_bf16 v[104:119], v[44:47], v[152:155], v[104:119]
    ds_read_b64_tr_b16 v[40:41], v23 offset:5120
    ds_read_b64_tr_b16 v[42:43], v23 offset:7168
    s_waitcnt lgkmcnt(10)
    v_mfma_f32_32x32x16_bf16 v[88:103], v[48:51], v[156:159], v[88:103]
    ds_read_b64_tr_b16 v[44:45], v22 offset:8192
    ds_read_b64_tr_b16 v[46:47], v22 offset:10240
    s_waitcnt lgkmcnt(10)
    v_mfma_f32_32x32x16_bf16 v[104:119], v[52:55], v[156:159], v[104:119]
    ds_read_b64_tr_b16 v[48:49], v23 offset:8192
    ds_read_b64_tr_b16 v[50:51], v23 offset:10240
    s_waitcnt lgkmcnt(10)
    v_mfma_f32_32x32x16_bf16 v[88:103], v[28:31], v[160:163], v[88:103]
    ds_read_b64_tr_b16 v[52:53], v22 offset:9216
    ds_read_b64_tr_b16 v[54:55], v22 offset:11264
    s_waitcnt lgkmcnt(10)
    v_mfma_f32_32x32x16_bf16 v[104:119], v[32:35], v[160:163], v[104:119]
    ds_read_b64_tr_b16 v[28:29], v23 offset:9216
    ds_read_b64_tr_b16 v[30:31], v23 offset:11264
    s_waitcnt lgkmcnt(10)
    v_mfma_f32_32x32x16_bf16 v[88:103], v[36:39], v[164:167], v[88:103]
    ds_read_b64_tr_b16 v[32:33], v22 offset:12288
    ds_read_b64_tr_b16 v[34:35], v22 offset:14336
    s_waitcnt lgkmcnt(10)
    v_mfma_f32_32x32x16_bf16 v[104:119], v[40:43], v[164:167], v[104:119]
    ds_read_b64_tr_b16 v[36:37], v23 offset:12288
    ds_read_b64_tr_b16 v[38:39], v23 offset:14336
    s_waitcnt lgkmcnt(10)
    v_mfma_f32_32x32x16_bf16 v[88:103], v[44:47], v[168:171], v[88:103]
    ds_read_b64_tr_b16 v[40:41], v22 offset:13312
    ds_read_b64_tr_b16 v[42:43], v22 offset:15360
    s_waitcnt lgkmcnt(10)
    v_mfma_f32_32x32x16_bf16 v[104:119], v[48:51], v[168:171], v[104:119]
    ds_read_b64_tr_b16 v[44:45], v23 offset:13312
    ds_read_b64_tr_b16 v[46:47], v23 offset:15360
    s_waitcnt lgkmcnt(10)
    v_mfma_f32_32x32x16_bf16 v[88:103], v[52:55], v[172:175], v[88:103]
    ds_read_b64_tr_b16 v[48:49], v22 offset:16384
    ds_read_b64_tr_b16 v[50:51], v22 offset:18432
    s_waitcnt lgkmcnt(10)
    v_mfma_f32_32x32x16_bf16 v[104:119], v[28:31], v[172:175], v[104:119]
    ds_read_b64_tr_b16 v[52:53], v23 offset:16384
    ds_read_b64_tr_b16 v[54:55], v23 offset:18432
    s_waitcnt lgkmcnt(10)
    v_mfma_f32_32x32x16_bf16 v[88:103], v[32:35], v[176:179], v[88:103]
    ds_read_b64_tr_b16 v[28:29], v22 offset:17408
    ds_read_b64_tr_b16 v[30:31], v22 offset:19456
    s_waitcnt lgkmcnt(10)
    v_mfma_f32_32x32x16_bf16 v[104:119], v[36:39], v[176:179], v[104:119]
    ds_read_b64_tr_b16 v[32:33], v23 offset:17408
    ds_read_b64_tr_b16 v[34:35], v23 offset:19456
    s_waitcnt lgkmcnt(10)
    v_mfma_f32_32x32x16_bf16 v[88:103], v[40:43], v[180:183], v[88:103]
    ds_read_b64_tr_b16 v[36:37], v22 offset:20480
    ds_read_b64_tr_b16 v[38:39], v22 offset:22528
    s_waitcnt lgkmcnt(10)
    v_mfma_f32_32x32x16_bf16 v[104:119], v[44:47], v[180:183], v[104:119]
    ds_read_b64_tr_b16 v[40:41], v23 offset:20480
    ds_read_b64_tr_b16 v[42:43], v23 offset:22528
    s_waitcnt lgkmcnt(10)
    v_mfma_f32_32x32x16_bf16 v[88:103], v[48:51], v[184:187], v[88:103]
    ds_read_b64_tr_b16 v[44:45], v22 offset:21504
    ds_read_b64_tr_b16 v[46:47], v22 offset:23552
    s_waitcnt lgkmcnt(10)
    v_mfma_f32_32x32x16_bf16 v[104:119], v[52:55], v[184:187], v[104:119]
    ds_read_b64_tr_b16 v[48:49], v23 offset:21504
    ds_read_b64_tr_b16 v[50:51], v23 offset:23552
    s_waitcnt lgkmcnt(10)
    v_mfma_f32_32x32x16_bf16 v[88:103], v[28:31], v[188:191], v[88:103]
    ds_read_b64_tr_b16 v[52:53], v22 offset:24576
    ds_read_b64_tr_b16 v[54:55], v22 offset:26624
    s_waitcnt lgkmcnt(10)
    v_mfma_f32_32x32x16_bf16 v[104:119], v[32:35], v[188:191], v[104:119]
    ds_read_b64_tr_b16 v[28:29], v23 offset:24576
    ds_read_b64_tr_b16 v[30:31], v23 offset:26624
    s_waitcnt lgkmcnt(10)
    v_mfma_f32_32x32x16_bf16 v[88:103], v[36:39], v[192:195], v[88:103]
    ds_read_b64_tr_b16 v[32:33], v22 offset:25600
    ds_read_b64_tr_b16 v[34:35], v22 offset:27648
    s_waitcnt lgkmcnt(10)
    v_mfma_f32_32x32x16_bf16 v[104:119], v[40:43], v[192:195], v[104:119]
    ds_read_b64_tr_b16 v[36:37], v23 offset:25600
    ds_read_b64_tr_b16 v[38:39], v23 offset:27648
    s_waitcnt lgkmcnt(10)
    v_mfma_f32_32x32x16_bf16 v[88:103], v[44:47], v[196:199], v[88:103]
    ds_read_b64_tr_b16 v[40:41], v22 offset:28672
    ds_read_b64_tr_b16 v[42:43], v22 offset:30720
    s_waitcnt lgkmcnt(10)
    v_mfma_f32_32x32x16_bf16 v[104:119], v[48:51], v[196:199], v[104:119]
    ds_read_b64_tr_b16 v[44:45], v23 offset:28672
    ds_read_b64_tr_b16 v[46:47], v23 offset:30720
    s_waitcnt lgkmcnt(10)
    v_mfma_f32_32x32x16_bf16 v[88:103], v[52:55], v[200:203], v[88:103]
    ds_read_b64_tr_b16 v[48:49], v22 offset:29696
    ds_read_b64_tr_b16 v[50:51], v22 offset:31744
    s_waitcnt lgkmcnt(10)
    v_mfma_f32_32x32x16_bf16 v[104:119], v[28:31], v[200:203], v[104:119]
    ds_read_b64_tr_b16 v[52:53], v23 offset:29696
    ds_read_b64_tr_b16 v[54:55], v23 offset:31744
    s_waitcnt lgkmcnt(10)
    v_mfma_f32_32x32x16_bf16 v[88:103], v[32:35], v[204:207], v[88:103]
    ds_read_b64_tr_b16 v[28:29], v24 offset:32768
    ds_read_b64_tr_b16 v[30:31], v24 offset:34816
    s_waitcnt lgkmcnt(10)
    v_mfma_f32_32x32x16_bf16 v[104:119], v[36:39], v[204:207], v[104:119]
    ds_read_b64_tr_b16 v[32:33], v25 offset:32768
    ds_read_b64_tr_b16 v[34:35], v25 offset:34816
    s_waitcnt lgkmcnt(10)
    v_mfma_f32_32x32x16_bf16 v[88:103], v[40:43], v[208:211], v[88:103]
L_PAD4:
    s_cbranch_execz L_RET4
    ds_read_b64_tr_b16 v[36:37], v24 offset:33792
    ds_read_b64_tr_b16 v[38:39], v24 offset:35840
    s_waitcnt lgkmcnt(10)
    v_mfma_f32_32x32x16_bf16 v[104:119], v[44:47], v[208:211], v[104:119]
    ds_read_b64_tr_b16 v[40:41], v25 offset:33792
    ds_read_b64_tr_b16 v[42:43], v25 offset:35840
    s_waitcnt lgkmcnt(10)
    v_mfma_f32_32x32x16_bf16 v[88:103], v[48:51], v[212:215], v[88:103]
    ds_read_b64_tr_b16 v[44:45], v24 offset:36864
    ds_read_b64_tr_b16 v[46:47], v24 offset:38912
    s_waitcnt lgkmcnt(10)
    v_mfma_f32_32x32x16_bf16 v[104:119], v[52:55], v[212:215], v[104:119]
    ds_read_b64_tr_b16 v[48:49], v25 offset:36864
    ds_read_b64_tr_b16 v[50:51], v25 offset:38912
    s_barrier
    s_waitcnt lgkmcnt(10)
    v_mfma_f32_32x32x16_bf16 v[120:135], v[28:31], v[216:219], v[120:135]
    ds_read_b64_tr_b16 v[52:53], v24 offset:37888
    ds_read_b64_tr_b16 v[54:55], v24 offset:39936
    s_waitcnt lgkmcnt(10)
    v_mfma_f32_32x32x16_bf16 v[136:151], v[32:35], v[216:219], v[136:151]
    ds_read_b64_tr_b16 v[28:29], v25 offset:37888
    ds_read_b64_tr_b16 v[30:31], v25 offset:39936
    s_waitcnt lgkmcnt(10)
    v_mfma_f32_32x32x16_bf16 v[120:135], v[36:39], v[220:223], v[120:135]
    v_cvt_pk_bf16_f32 v88, v88, v89
    ds_read_b64_tr_b16 v[32:33], v24 offset:40960
    ds_read_b64_tr_b16 v[34:35], v24 offset:43008
    s_waitcnt lgkmcnt(10)
    v_mfma_f32_32x32x16_bf16 v[136:151], v[40:43], v[220:223], v[136:151]
    v_cvt_pk_bf16_f32 v89, v90, v91
    ds_read_b64_tr_b16 v[36:37], v25 offset:40960
    ds_read_b64_tr_b16 v[38:39], v25 offset:43008
    s_waitcnt lgkmcnt(10)
    v_mfma_f32_32x32x16_bf16 v[120:135], v[44:47], v[224:227], v[120:135]
    v_cvt_pk_bf16_f32 v90, v92, v93
    ds_read_b64_tr_b16 v[40:41], v24 offset:41984
    ds_read_b64_tr_b16 v[42:43], v24 offset:44032
    s_waitcnt lgkmcnt(10)
    v_mfma_f32_32x32x16_bf16 v[136:151], v[48:51], v[224:227], v[136:151]
    v_cvt_pk_bf16_f32 v91, v94, v95
    ds_read_b64_tr_b16 v[44:45], v25 offset:41984
    ds_read_b64_tr_b16 v[46:47], v25 offset:44032
    s_waitcnt lgkmcnt(10)
    v_mfma_f32_32x32x16_bf16 v[120:135], v[52:55], v[228:231], v[120:135]
    ds_write_b128 v0, v[88:91]
    ds_read_b64_tr_b16 v[48:49], v24 offset:45056
    ds_read_b64_tr_b16 v[50:51], v24 offset:47104
    s_waitcnt lgkmcnt(11)
    v_mfma_f32_32x32x16_bf16 v[136:151], v[28:31], v[228:231], v[136:151]
    v_cvt_pk_bf16_f32 v92, v96, v97
    ds_read_b64_tr_b16 v[52:53], v25 offset:45056
    ds_read_b64_tr_b16 v[54:55], v25 offset:47104
    s_waitcnt lgkmcnt(11)
    v_mfma_f32_32x32x16_bf16 v[120:135], v[32:35], v[232:235], v[120:135]
    v_cvt_pk_bf16_f32 v93, v98, v99
    ds_read_b64_tr_b16 v[28:29], v24 offset:46080
    ds_read_b64_tr_b16 v[30:31], v24 offset:48128
    s_waitcnt lgkmcnt(11)
    v_mfma_f32_32x32x16_bf16 v[136:151], v[36:39], v[232:235], v[136:151]
    v_cvt_pk_bf16_f32 v94, v100, v101
    ds_read_b64_tr_b16 v[32:33], v25 offset:46080
    ds_read_b64_tr_b16 v[34:35], v25 offset:48128
    s_waitcnt lgkmcnt(11)
    v_mfma_f32_32x32x16_bf16 v[120:135], v[40:43], v[236:239], v[120:135]
    v_cvt_pk_bf16_f32 v95, v102, v103
    ds_read_b64_tr_b16 v[36:37], v24
    ds_read_b64_tr_b16 v[38:39], v24 offset:2048
    s_waitcnt lgkmcnt(11)
    v_mfma_f32_32x32x16_bf16 v[136:151], v[44:47], v[236:239], v[136:151]
    ds_write_b128 v0, v[92:95] offset:1024
    ds_read_b64_tr_b16 v[40:41], v25
    ds_read_b64_tr_b16 v[42:43], v25 offset:2048
    s_waitcnt lgkmcnt(11)
    v_mfma_f32_32x32x16_bf16 v[120:135], v[48:51], v[240:243], v[120:135]
    v_cvt_pk_bf16_f32 v104, v104, v105
    ds_read_b64_tr_b16 v[44:45], v24 offset:1024
    ds_read_b64_tr_b16 v[46:47], v24 offset:3072
    s_waitcnt lgkmcnt(11)
    v_mfma_f32_32x32x16_bf16 v[136:151], v[52:55], v[240:243], v[136:151]
    v_cvt_pk_bf16_f32 v105, v106, v107
    ds_read_b64_tr_b16 v[48:49], v25 offset:1024
    ds_read_b64_tr_b16 v[50:51], v25 offset:3072
    s_waitcnt lgkmcnt(11)
    v_mfma_f32_32x32x16_bf16 v[120:135], v[28:31], v[244:247], v[120:135]
    v_cvt_pk_bf16_f32 v106, v108, v109
    ds_read_b64_tr_b16 v[52:53], v24 offset:4096
    ds_read_b64_tr_b16 v[54:55], v24 offset:6144
    s_waitcnt lgkmcnt(11)
    v_mfma_f32_32x32x16_bf16 v[136:151], v[32:35], v[244:247], v[136:151]
    v_cvt_pk_bf16_f32 v107, v110, v111
    ds_read_b64_tr_b16 v[28:29], v25 offset:4096
    ds_read_b64_tr_b16 v[30:31], v25 offset:6144
    s_waitcnt lgkmcnt(11)
    v_mfma_f32_32x32x16_bf16 v[120:135], v[36:39], v[152:155], v[120:135]
    ds_write_b128 v0, v[104:107] offset:8192
    ds_read_b64_tr_b16 v[32:33], v24 offset:5120
    ds_read_b64_tr_b16 v[34:35], v24 offset:7168
    s_waitcnt lgkmcnt(11)
    v_mfma_f32_32x32x16_bf16 v[136:151], v[40:43], v[152:155], v[136:151]
    v_cvt_pk_bf16_f32 v108, v112, v113
    ds_read_b64_tr_b16 v[36:37], v25 offset:5120
    ds_read_b64_tr_b16 v[38:39], v25 offset:7168
    s_waitcnt lgkmcnt(11)
    v_mfma_f32_32x32x16_bf16 v[120:135], v[44:47], v[156:159], v[120:135]
    v_cvt_pk_bf16_f32 v109, v114, v115
    ds_read_b64_tr_b16 v[40:41], v24 offset:8192
    ds_read_b64_tr_b16 v[42:43], v24 offset:10240
    s_waitcnt lgkmcnt(11)
    v_mfma_f32_32x32x16_bf16 v[136:151], v[48:51], v[156:159], v[136:151]
    v_cvt_pk_bf16_f32 v110, v116, v117
    ds_read_b64_tr_b16 v[44:45], v25 offset:8192
    ds_read_b64_tr_b16 v[46:47], v25 offset:10240
    s_waitcnt lgkmcnt(11)
    v_mfma_f32_32x32x16_bf16 v[120:135], v[52:55], v[160:163], v[120:135]
    v_cvt_pk_bf16_f32 v111, v118, v119
    ds_read_b64_tr_b16 v[48:49], v24 offset:9216
    ds_read_b64_tr_b16 v[50:51], v24 offset:11264
    s_waitcnt lgkmcnt(11)
    v_mfma_f32_32x32x16_bf16 v[136:151], v[28:31], v[160:163], v[136:151]
    ds_write_b128 v0, v[108:111] offset:9216
    ds_read_b64_tr_b16 v[52:53], v25 offset:9216
    ds_read_b64_tr_b16 v[54:55], v25 offset:11264
    s_waitcnt lgkmcnt(11)
    v_mfma_f32_32x32x16_bf16 v[120:135], v[32:35], v[164:167], v[120:135]
    v_and_b32 v85, 1, v1
    ds_read_b64_tr_b16 v[28:29], v24 offset:12288
    ds_read_b64_tr_b16 v[30:31], v24 offset:14336
    s_waitcnt lgkmcnt(11)
    v_mfma_f32_32x32x16_bf16 v[136:151], v[36:39], v[164:167], v[136:151]
    v_lshlrev_b32 v85, 3, v85
    ds_read_b64_tr_b16 v[32:33], v25 offset:12288
    ds_read_b64_tr_b16 v[34:35], v25 offset:14336
    s_waitcnt lgkmcnt(11)
    v_mfma_f32_32x32x16_bf16 v[120:135], v[40:43], v[168:171], v[120:135]
    v_bfe_u32 v84, v1, 2, 2
    ds_read_b64_tr_b16 v[36:37], v24 offset:13312
    ds_read_b64_tr_b16 v[38:39], v24 offset:15360
    s_waitcnt lgkmcnt(11)
    v_mfma_f32_32x32x16_bf16 v[136:151], v[44:47], v[168:171], v[136:151]
    v_lshl_add_u32 v85, v84, 4, v85
    ds_read_b64_tr_b16 v[40:41], v25 offset:13312
    ds_read_b64_tr_b16 v[42:43], v25 offset:15360
    s_waitcnt lgkmcnt(11)
    v_mfma_f32_32x32x16_bf16 v[120:135], v[48:51], v[172:175], v[120:135]
    v_bfe_u32 v84, v1, 4, 1
    ds_read_b64_tr_b16 v[44:45], v24 offset:16384
    ds_read_b64_tr_b16 v[46:47], v24 offset:18432
    s_waitcnt lgkmcnt(10)
    v_mfma_f32_32x32x16_bf16 v[136:151], v[52:55], v[172:175], v[136:151]
    v_lshl_add_u32 v85, v84, 6, v85
    ds_read_b64_tr_b16 v[48:49], v25 offset:16384
    ds_read_b64_tr_b16 v[50:51], v25 offset:18432
    s_waitcnt lgkmcnt(10)
    v_mfma_f32_32x32x16_bf16 v[120:135], v[28:31], v[176:179], v[120:135]
    v_bfe_u32 v84, v1, 1, 1
    ds_read_b64_tr_b16 v[52:53], v24 offset:17408
    ds_read_b64_tr_b16 v[54:55], v24 offset:19456
    s_waitcnt lgkmcnt(10)
    v_mfma_f32_32x32x16_bf16 v[136:151], v[32:35], v[176:179], v[136:151]
    v_lshl_add_u32 v85, v84, 7, v85
    ds_read_b64_tr_b16 v[28:29], v25 offset:17408
    ds_read_b64_tr_b16 v[30:31], v25 offset:19456
    s_waitcnt lgkmcnt(10)
    v_mfma_f32_32x32x16_bf16 v[120:135], v[36:39], v[180:183], v[120:135]
    v_lshrrev_b32 v84, 5, v1
    ds_read_b64_tr_b16 v[32:33], v24 offset:20480
    ds_read_b64_tr_b16 v[34:35], v24 offset:22528
    s_waitcnt lgkmcnt(10)
    v_mfma_f32_32x32x16_bf16 v[136:151], v[40:43], v[180:183], v[136:151]
    v_lshl_add_u32 v85, v84, 8, v85
    ds_read_b64_tr_b16 v[36:37], v25 offset:20480
    ds_read_b64_tr_b16 v[38:39], v25 offset:22528
    s_waitcnt lgkmcnt(10)
    v_mfma_f32_32x32x16_bf16 v[120:135], v[44:47], v[184:187], v[120:135]
    s_lshl_b32 s13, s3, 12
    v_add_u32 v84, s13, v85
    ds_read_b64_tr_b16 v[40:41], v24 offset:21504
    ds_read_b64_tr_b16 v[42:43], v24 offset:23552
    s_waitcnt lgkmcnt(10)
    v_mfma_f32_32x32x16_bf16 v[136:151], v[48:51], v[184:187], v[136:151]
    s_lshl_b32 s96, s76, 13
    s_add_u32 s13, s96, 32768
    v_add_u32 v85, s13, v85
    ds_read_b64_tr_b16 v[44:45], v25 offset:21504
    ds_read_b64_tr_b16 v[46:47], v25 offset:23552
    s_waitcnt lgkmcnt(10)
    v_mfma_f32_32x32x16_bf16 v[120:135], v[52:55], v[188:191], v[120:135]
    v_mov_b32 v80, 0x3f803f80
    ds_read_b64_tr_b16 v[48:49], v24 offset:24576
    ds_read_b64_tr_b16 v[50:51], v24 offset:26624
    s_waitcnt lgkmcnt(10)
    v_mfma_f32_32x32x16_bf16 v[136:151], v[28:31], v[188:191], v[136:151]
    v_mov_b32 v81, 0x3f803f80
    ds_read_b64_tr_b16 v[52:53], v25 offset:24576
    ds_read_b64_tr_b16 v[54:55], v25 offset:26624
    s_waitcnt lgkmcnt(10)
    v_mfma_f32_32x32x16_bf16 v[120:135], v[32:35], v[192:195], v[120:135]
    v_mov_b32 v82, 0x3f803f80
    ds_read_b64_tr_b16 v[28:29], v24 offset:25600
    ds_read_b64_tr_b16 v[30:31], v24 offset:27648
    s_waitcnt lgkmcnt(10)
    v_mfma_f32_32x32x16_bf16 v[136:151], v[36:39], v[192:195], v[136:151]
    v_mov_b32 v83, 0x3f803f80
    ds_read_b64_tr_b16 v[32:33], v25 offset:25600
    ds_read_b64_tr_b16 v[34:35], v25 offset:27648
    s_waitcnt lgkmcnt(10)
    v_mfma_f32_32x32x16_bf16 v[120:135], v[40:43], v[196:199], v[120:135]
    s_lshl3_add_u32 s96, s11, s3
    s_lshl_b32 s97, s96, 5
    s_add_u32 s98, s97, s10
    s_lshl_b32 s99, s98, 10
    s_add_u32 s13, s99, 25165824
    s_add_u32 s15, s13, 16384
    s_lshl3_add_u32 s96, s11, s3
    s_lshl_b32 s97, s96, 10
    s_add_u32 s16, s97, 21495808
    s_lshl_b32 s96, s10, 6
    s_add_u32 s14, s96, s16
    ds_read_b64_tr_b16 v[36:37], v24 offset:28672
    ds_read_b64_tr_b16 v[38:39], v24 offset:30720
    s_waitcnt lgkmcnt(10)
    v_mfma_f32_32x32x16_bf16 v[136:151], v[44:47], v[196:199], v[136:151]
    ds_read_b64_tr_b16 v[40:41], v25 offset:28672
    ds_read_b64_tr_b16 v[42:43], v25 offset:30720
    s_waitcnt lgkmcnt(10)
    v_mfma_f32_32x32x16_bf16 v[120:135], v[48:51], v[200:203], v[120:135]
    ds_read_b64_tr_b16 v[44:45], v25 offset:29696
    ds_read_b64_tr_b16 v[46:47], v25 offset:31744
    s_waitcnt lgkmcnt(10)
    v_mfma_f32_32x32x16_bf16 v[136:151], v[52:55], v[200:203], v[136:151]
    ds_read_b64_tr_b16 v[48:49], v24 offset:29696
    ds_read_b64_tr_b16 v[50:51], v24 offset:31744
    s_waitcnt lgkmcnt(10)
    v_mfma_f32_32x32x16_bf16 v[120:135], v[28:31], v[204:207], v[120:135]
    s_waitcnt lgkmcnt(8)
    v_mfma_f32_32x32x16_bf16 v[136:151], v[32:35], v[204:207], v[136:151]
    s_waitcnt lgkmcnt(6)
    v_mfma_f32_32x32x16_bf16 v[120:135], v[36:39], v[208:211], v[120:135]
    s_waitcnt lgkmcnt(4)
    v_mfma_f32_32x32x16_bf16 v[136:151], v[40:43], v[208:211], v[136:151]
    s_waitcnt lgkmcnt(2)
    v_mfma_f32_32x32x16_bf16 v[136:151], v[44:47], v[212:215], v[136:151]
    s_waitcnt lgkmcnt(0)
    v_mfma_f32_32x32x16_bf16 v[120:135], v[48:51], v[212:215], v[120:135]
    s_lshl_b32 s96, s77, 11
    s_add_u32 s17, s96, 151552
    v_add_u32 v0, s17, v2
    v_bfe_u32 v4, v1, 2, 2
    v_lshlrev_b32 v4, 6, v4
    v_bfe_u32 v9, v1, 4, 1
    v_lshl_add_u32 v4, v9, 5, v4
    v_and_b32 v9, 3, v1
    v_lshl_add_u32 v4, v9, 3, v4
    v_lshrrev_b32 v9, 5, v1
    v_lshl_add_u32 v4, v9, 8, v4
    v_add_u32 v4, 159744, v4
    ds_read_b64_tr_b16 v[176:177], v4
    ds_read_b64_tr_b16 v[178:179], v4 offset:512
    ds_read_b64_tr_b16 v[180:181], v4 offset:1024
    ds_read_b64_tr_b16 v[182:183], v4 offset:1536
    v_cvt_pk_bf16_f32 v152, v136, v137
    v_cvt_pk_bf16_f32 v153, v138, v139
    v_cvt_pk_bf16_f32 v154, v140, v141
    v_cvt_pk_bf16_f32 v155, v142, v143
    v_cvt_pk_bf16_f32 v156, v144, v145
    v_cvt_pk_bf16_f32 v157, v146, v147
    v_cvt_pk_bf16_f32 v158, v148, v149
    v_cvt_pk_bf16_f32 v159, v150, v151
    ds_write_b128 v0, v[152:155]
    ds_write_b128 v0, v[156:159] offset:1024
    v_cvt_pk_bf16_f32 v168, v120, v121
    v_cvt_pk_bf16_f32 v169, v122, v123
    v_cvt_pk_bf16_f32 v170, v124, v125
    v_cvt_pk_bf16_f32 v171, v126, v127
    v_cvt_pk_bf16_f32 v172, v128, v129
    v_cvt_pk_bf16_f32 v173, v130, v131
    v_cvt_pk_bf16_f32 v174, v132, v133
    v_cvt_pk_bf16_f32 v175, v134, v135
    s_setprio 0
    s_branch L_JOIN
L_HELP:
    s_waitcnt vmcnt(0)
    s_barrier
    s_add_u32 s96, s84, 4
    s_and_b32 s97, s96, 15
    s_mul_i32 s98, s97, 393216
    s_add_u32 s99, s98, s85
    s_add_u32 s82, s99, 4294772736
    s_add_u32 m0, s83, 28672
    s_nop 0
    buffer_load_dwordx4 v3, s[40:43], s82 offen lds
    s_add_u32 s96, s84, 4
    s_and_b32 s97, s96, 15
    s_mul_i32 s98, s97, 393216
    s_add_u32 s99, s98, s85
    s_add_u32 s82, s99, 2048
    s_add_u32 m0, s83, 32768
    s_nop 0
    buffer_load_dwordx4 v3, s[40:43], s82 offen lds
    s_add_u32 s96, s84, 4
    s_and_b32 s97, s96, 15
    s_mul_i32 s98, s97, 393216
    s_add_u32 s99, s98, s85
    s_add_u32 s82, s99, 4294774784
    s_add_u32 m0, s83, 77824
    s_nop 0
    buffer_load_dwordx4 v3, s[40:43], s82 offen lds
    s_add_u32 s96, s84, 4
    s_and_b32 s97, s96, 15
    s_mul_i32 s98, s97, 393216
    s_add_u32 s99, s98, s85
    s_add_u32 s82, s99, 4096
    s_add_u32 m0, s83, 81920
    s_nop 0
    buffer_load_dwordx4 v3, s[40:43], s82 offen lds
    s_add_u32 s96, s84, 4
    s_and_b32 s97, s96, 15
    s_mul_i32 s98, s97, 393216
    s_add_u32 s99, s98, s85
    s_add_u32 s82, s99, 4294770688
    s_add_u32 m0, s83, 126976
    s_nop 0
    buffer_load_dwordx4 v3, s[40:43], s82 offen lds
    s_add_u32 s96, s84, 4
    s_and_b32 s97, s96, 15
    s_mul_i32 s98, s97, 393216
    s_add_u32 s82, s98, s85
    s_add_u32 m0, s83, 131072
    s_nop 0
    buffer_load_dwordx4 v3, s[40:43], s82 offen lds
    s_add_u32 s96, s84, 5
    s_and_b32 s97, s96, 15
    s_mul_i32 s98, s97, 393216
    s_add_u32 s99, s98, s85
    s_add_u32 s82, s99, 4294772736
    s_add_u32 m0, s83, 36864
    s_nop 0
    buffer_load_dwordx4 v3, s[40:43], s82 offen lds
    s_add_u32 s96, s84, 5
    s_and_b32 s97, s96, 15
    s_mul_i32 s98, s97, 393216
    s_add_u32 s99, s98, s85
    s_add_u32 s82, s99, 2048
    s_add_u32 m0, s83, 40960
    s_nop 0
    buffer_load_dwordx4 v3, s[40:43], s82 offen lds
    s_add_u32 s96, s84, 5
    s_and_b32 s97, s96, 15
    s_mul_i32 s98, s97, 393216
    s_add_u32 s99, s98, s85
    s_add_u32 s82, s99, 4294774784
    s_add_u32 m0, s83, 86016
    s_nop 0
    buffer_load_dwordx4 v3, s[40:43], s82 offen lds
    s_add_u32 s96, s84, 5
    s_and_b32 s97, s96, 15
    s_mul_i32 s98, s97, 393216
    s_add_u32 s99, s98, s85
    s_add_u32 s82, s99, 4096
    s_add_u32 m0, s83, 90112
    s_nop 0
    buffer_load_dwordx4 v3, s[40:43], s82 offen lds
    s_add_u32 s96, s84, 5
    s_and_b32 s97, s96, 15
    s_mul_i32 s98, s97, 393216
    s_add_u32 s99, s98, s85
    s_add_u32 s82, s99, 4294770688
    s_add_u32 m0, s83, 135168
    s_nop 0
    buffer_load_dwordx4 v3, s[40:43], s82 offen lds
    s_add_u32 s96, s84, 5
    s_and_b32 s97, s96, 15
    s_mul_i32 s98, s97, 393216
    s_add_u32 s82, s98, s85
    s_add_u32 m0, s83, 139264
    s_nop 0
    buffer_load_dwordx4 v3, s[40:43], s82 offen lds
    s_waitcnt lgkmcnt(0)
SPOLL_16:
    s_load_dwordx2 s[24:25], s[32:33], s19 offset:0 glc
    s_load_dwordx2 s[26:27], s[32:33], s19 offset:64 glc
SCHK_17:
    s_add_u32 s5, s5, 1
    s_cmp_ge_u32 s5, 200000
    s_waitcnt lgkmcnt(0)
    s_cbranch_scc1 SDONE_18
    s_cmp_lg_u32 s24, s4
    s_cbranch_scc1 SPOLL_16
    s_cmp_lg_u32 s25, s4
    s_cbranch_scc1 SPOLL_16
    s_cmp_lg_u32 s26, s4
    s_cbranch_scc1 SPOLL_16
    s_cmp_lg_u32 s27, s4
    s_cbranch_scc1 SPOLL_16
SDONE_18:
    v_bfe_u32 v4, v1, 2, 2
    v_lshlrev_b32 v4, 6, v4
    v_bfe_u32 v9, v1, 4, 1
    v_lshl_add_u32 v4, v9, 5, v4
    v_and_b32 v9, 3, v1
    v_lshl_add_u32 v4, v9, 3, v4
    v_lshrrev_b32 v9, 5, v1
    v_lshl_add_u32 v4, v9, 8, v4
    v_add_u32 v4, 159744, v4
    ds_read_b64_tr_b16 v[168:169], v4
    ds_read_b64_tr_b16 v[170:171], v4 offset:512
    ds_read_b64_tr_b16 v[172:173], v4 offset:1024
    ds_read_b64_tr_b16 v[174:175], v4 offset:1536
    ds_read_b64_tr_b16 v[176:177], v4 offset:2048
    ds_read_b64_tr_b16 v[178:179], v4 offset:2560
    ds_read_b64_tr_b16 v[180:181], v4 offset:3072
    ds_read_b64_tr_b16 v[182:183], v4 offset:3584
    s_lshl_b32 s14, s77, 10
    v_and_b32 v232, 7, v1
    v_lshl_add_u32 v232, v232, 4, s14
    v_bfe_u32 v9, v1, 3, 2
    v_lshl_add_u32 v232, v9, 8, v232
    v_lshrrev_b32 v9, 5, v1
    v_lshl_add_u32 v232, v9, 7, v232
    s_and_b32 s96, s9, 1
    s_lshl1_add_u32 s18, s96, 1
    s_and_b32 s96, s8, 3
    s_lshl2_add_u32 s97, s96, s3
    s_sub_u32 s98, s97, 4
    s_lshl_b32 s82, s98, 7
    v_lshrrev_b32 v8, 3, v1
    v_lshl_add_u32 v8, v8, 4, s82
    global_load_dwordx4 v[40:43], v8, s[86:87]
    v_lshrrev_b32 v248, 3, v1
    v_mul_u32_u24 v248, 98304, v248
    v_and_b32 v9, 7, v1
    v_lshl_add_u32 v248, v9, 4, v248
    s_and_b32 s96, s8, 3
    s_lshl2_add_u32 s97, s96, s3
    s_sub_u32 s98, s97, 4
    s_mul_i32 s99, s98, 786432
    s_lshr_b32 s96, s8, 2
    s_lshl1_add_u32 s97, s9, s96
    s_lshl_b32 s98, s97, 7
    s_add_u32 s96, s99, s98
    s_add_u32 s19, s96, 4096
    s_barrier
    s_add_u32 s96, s84, 6
    s_and_b32 s97, s96, 15
    s_mul_i32 s98, s97, 393216
    s_add_u32 s99, s98, s85
    s_add_u32 s82, s99, 4294772736
    s_add_u32 m0, s83, 4294963200
    s_nop 0
    buffer_load_dwordx4 v3, s[40:43], s82 offen lds
    s_add_u32 s96, s84, 6
    s_and_b32 s97, s96, 15
    s_mul_i32 s98, s97, 393216
    s_add_u32 s99, s98, s85
    s_add_u32 s82, s99, 2048
    s_mov_b32 m0, s83
    s_nop 0
    buffer_load_dwordx4 v3, s[40:43], s82 offen lds
    s_add_u32 s96, s84, 6
    s_and_b32 s97, s96, 15
    s_mul_i32 s98, s97, 393216
    s_add_u32 s99, s98, s85
    s_add_u32 s82, s99, 4294770688
    s_add_u32 m0, s83, 94208
    s_nop 0
    buffer_load_dwordx4 v3, s[40:43], s82 offen lds
    s_add_u32 s96, s84, 6
    s_and_b32 s97, s96, 15
    s_mul_i32 s98, s97, 393216
    s_add_u32 s82, s98, s85
    s_add_u32 m0, s83, 98304
    s_nop 0
    buffer_load_dwordx4 v3, s[40:43], s82 offen lds
    s_add_u32 s96, s84, 6
    s_and_b32 s97, s96, 15
    s_mul_i32 s98, s97, 393216
    s_add_u32 s99, s98, s85
    s_add_u32 s82, s99, 4294774784
    s_add_u32 m0, s83, 45056
    s_nop 0
    buffer_load_dwordx4 v3, s[40:43], s82 offen lds
    s_add_u32 s96, s84, 6
    s_and_b32 s97, s96, 15
    s_mul_i32 s98, s97, 393216
    s_add_u32 s99, s98, s85
    s_add_u32 s82, s99, 4096
    s_add_u32 m0, s83, 49152
    s_nop 0
    buffer_load_dwordx4 v3, s[40:43], s82 offen lds
    s_waitcnt lgkmcnt(0)
    s_load_dword s24, s[32:33], s92 offset:512 glc
    s_load_dword s25, s[32:33], s92 offset:256 glc
    s_load_dword s26, s[32:33], s92 offset:3584 glc
    s_load_dword s27, s[32:33], s92 offset:3328 glc
    s_barrier
    s_add_u32 s96, s84, 7
    s_and_b32 s97, s96, 15
    s_mul_i32 s98, s97, 393216
    s_add_u32 s99, s98, s85
    s_add_u32 s82, s99, 4294772736
    s_add_u32 m0, s83, 4096
    s_nop 0
    buffer_load_dwordx4 v3, s[40:43], s82 offen lds
    s_add_u32 s96, s84, 7
    s_and_b32 s97, s96, 15
    s_mul_i32 s98, s97, 393216
    s_add_u32 s99, s98, s85
    s_add_u32 s82, s99, 2048
    s_add_u32 m0, s83, 8192
    s_nop 0
    buffer_load_dwordx4 v3, s[40:43], s82 offen lds
    s_add_u32 s96, s84, 7
    s_and_b32 s97, s96, 15
    s_mul_i32 s98, s97, 393216
    s_add_u32 s99, s98, s85
    s_add_u32 s82, s99, 4294770688
    s_add_u32 m0, s83, 102400
    s_nop 0
    buffer_load_dwordx4 v3, s[40:43], s82 offen lds
    s_add_u32 s96, s84, 7
    s_and_b32 s97, s96, 15
    s_mul_i32 s98, s97, 393216
    s_add_u32 s82, s98, s85
    s_add_u32 m0, s83, 106496
    s_nop 0
    buffer_load_dwordx4 v3, s[40:43], s82 offen lds
    s_add_u32 s96, s84, 7
    s_and_b32 s97, s96, 15
    s_mul_i32 s98, s97, 393216
    s_add_u32 s99, s98, s85
    s_add_u32 s82, s99, 4294774784
    s_add_u32 m0, s83, 53248
    s_nop 0
    buffer_load_dwordx4 v3, s[40:43], s82 offen lds
    s_add_u32 s96, s84, 7
    s_and_b32 s97, s96, 15
    s_mul_i32 s98, s97, 393216
    s_add_u32 s99, s98, s85
    s_add_u32 s82, s99, 4096
    s_add_u32 m0, s83, 57344
    s_nop 0
    buffer_load_dwordx4 v3, s[40:43], s82 offen lds
    s_waitcnt vmcnt(23)
    s_waitcnt vmcnt(19)
    s_barrier
    s_add_u32 s96, s84, 8
    s_and_b32 s97, s96, 15
    s_mul_i32 s98, s97, 393216
    s_add_u32 s99, s98, s85
    s_add_u32 s82, s99, 4294772736
    s_add_u32 m0, s83, 12288
    s_nop 0
    buffer_load_dwordx4 v3, s[40:43], s82 offen lds
    s_add_u32 s96, s84, 8
    s_and_b32 s97, s96, 15
    s_mul_i32 s98, s97, 393216
    s_add_u32 s99, s98, s85
    s_add_u32 s82, s99, 2048
    s_add_u32 m0, s83, 16384
    s_nop 0
    buffer_load_dwordx4 v3, s[40:43], s82 offen lds
    s_add_u32 s96, s84, 8
    s_and_b32 s97, s96, 15
    s_mul_i32 s98, s97, 393216
    s_add_u32 s99, s98, s85
    s_add_u32 s82, s99, 4294770688
    s_add_u32 m0, s83, 110592
    s_nop 0
    buffer_load_dwordx4 v3, s[40:43], s82 offen lds
    s_add_u32 s96, s84, 8
    s_and_b32 s97, s96, 15
    s_mul_i32 s98, s97, 393216
    s_add_u32 s82, s98, s85
    s_add_u32 m0, s83, 114688
    s_nop 0
    buffer_load_dwordx4 v3, s[40:43], s82 offen lds
    s_add_u32 s96, s84, 8
    s_and_b32 s97, s96, 15
    s_mul_i32 s98, s97, 393216
    s_add_u32 s99, s98, s85
    s_add_u32 s82, s99, 4294774784
    s_add_u32 m0, s83, 61440
    s_nop 0
    buffer_load_dwordx4 v3, s[40:43], s82 offen lds
    s_add_u32 s96, s84, 8
    s_and_b32 s97, s96, 15
    s_mul_i32 s98, s97, 393216
    s_add_u32 s99, s98, s85
    s_add_u32 s82, s99, 4096
    s_add_u32 m0, s83, 65536
    s_nop 0
    buffer_load_dwordx4 v3, s[40:43], s82 offen lds
    s_waitcnt vmcnt(18)
    v_lshlrev_b32 v36, 16, v40
    v_and_b32 v37, s6, v40
    v_lshlrev_b32 v38, 16, v41
    v_and_b32 v39, s6, v41
    v_lshlrev_b32 v40, 16, v42
    v_and_b32 v41, s6, v42
    v_lshlrev_b32 v42, 16, v43
    v_and_b32 v43, s6, v43
    v_mul_f32 v8, s7, v36
    v_exp_f32 v8, -v8
    s_nop 0
    v_add_f32 v8, 1.0, v8
    v_rcp_f32 v8, v8
    s_nop 0
    v_mul_f32 v36, v36, v8
    v_cvt_pk_bf16_f32 v36, 0, v36
    v_mul_f32 v9, s7, v37
    v_exp_f32 v9, -v9
    s_nop 0
    v_add_f32 v9, 1.0, v9
    v_rcp_f32 v9, v9
    s_nop 0
    v_mul_f32 v37, v37, v9
    v_cvt_pk_bf16_f32 v37, 0, v37
    v_mul_f32 v8, s7, v38
    v_exp_f32 v8, -v8
    s_nop 0
    v_add_f32 v8, 1.0, v8
    v_rcp_f32 v8, v8
    s_nop 0
    v_mul_f32 v38, v38, v8
    v_cvt_pk_bf16_f32 v38, 0, v38
    v_mul_f32 v9, s7, v39
    v_exp_f32 v9, -v9
    s_nop 0
    v_add_f32 v9, 1.0, v9
    v_rcp_f32 v9, v9
    s_nop 0
    v_mul_f32 v39, v39, v9
    v_cvt_pk_bf16_f32 v39, 0, v39
    v_mul_f32 v8, s7, v40
    v_exp_f32 v8, -v8
    s_nop 0
    v_add_f32 v8, 1.0, v8
    v_rcp_f32 v8, v8
    s_nop 0
    v_mul_f32 v40, v40, v8
    v_cvt_pk_bf16_f32 v40, 0, v40
    v_mul_f32 v9, s7, v41
    v_exp_f32 v9, -v9
    s_nop 0
    v_add_f32 v9, 1.0, v9
    v_rcp_f32 v9, v9
    s_nop 0
    v_mul_f32 v41, v41, v9
    v_cvt_pk_bf16_f32 v41, 0, v41
    v_mul_f32 v8, s7, v42
    v_exp_f32 v8, -v8
    s_nop 0
    v_add_f32 v8, 1.0, v8
    v_rcp_f32 v8, v8
    s_nop 0
    v_mul_f32 v42, v42, v8
    v_cvt_pk_bf16_f32 v42, 0, v42
    v_mul_f32 v9, s7, v43
    v_exp_f32 v9, -v9
L_PAD5:
    s_cbranch_execz L_RET5
    s_nop 0
    v_add_f32 v9, 1.0, v9
    v_rcp_f32 v9, v9
    s_nop 0
    v_mul_f32 v43, v43, v9
    v_cvt_pk_bf16_f32 v43, 0, v43
    s_waitcnt lgkmcnt(0)
    s_load_dword s24, s[32:33], s92 offset:1024 glc
    s_load_dword s25, s[32:33], s92 offset:768 glc
    s_load_dword s26, s[32:33], s92 offset:1536 glc
    s_load_dword s27, s[32:33], s92 offset:1280 glc
    s_barrier
    s_add_u32 s96, s84, 9
    s_and_b32 s97, s96, 15
    s_mul_i32 s98, s97, 393216
    s_add_u32 s99, s98, s85
    s_add_u32 s82, s99, 4294772736
    s_add_u32 m0, s83, 20480
    s_nop 0
    buffer_load_dwordx4 v3, s[40:43], s82 offen lds
    s_add_u32 s96, s84, 9
    s_and_b32 s97, s96, 15
    s_mul_i32 s98, s97, 393216
    s_add_u32 s99, s98, s85
    s_add_u32 s82, s99, 2048
    s_add_u32 m0, s83, 24576
    s_nop 0
    buffer_load_dwordx4 v3, s[40:43], s82 offen lds
    s_add_u32 s96, s84, 9
    s_and_b32 s97, s96, 15
    s_mul_i32 s98, s97, 393216
    s_add_u32 s99, s98, s85
    s_add_u32 s82, s99, 4294770688
    s_add_u32 m0, s83, 118784
    s_nop 0
    buffer_load_dwordx4 v3, s[40:43], s82 offen lds
    s_add_u32 s96, s84, 9
    s_and_b32 s97, s96, 15
    s_mul_i32 s98, s97, 393216
    s_add_u32 s82, s98, s85
    s_add_u32 m0, s83, 122880
    s_nop 0
    buffer_load_dwordx4 v3, s[40:43], s82 offen lds
    s_add_u32 s96, s84, 9
    s_and_b32 s97, s96, 15
    s_mul_i32 s98, s97, 393216
    s_add_u32 s99, s98, s85
    s_add_u32 s82, s99, 4294774784
    s_add_u32 m0, s83, 69632
    s_nop 0
    buffer_load_dwordx4 v3, s[40:43], s82 offen lds
    s_add_u32 s96, s84, 9
    s_and_b32 s97, s96, 15
    s_mul_i32 s98, s97, 393216
    s_add_u32 s99, s98, s85
    s_add_u32 s82, s99, 4096
    s_add_u32 m0, s83, 73728
    s_nop 0
    buffer_load_dwordx4 v3, s[40:43], s82 offen lds
    s_waitcnt vmcnt(22)
    s_waitcnt vmcnt(20)
    s_waitcnt vmcnt(18)
    s_barrier
    s_add_u32 s96, s84, 10
    s_and_b32 s97, s96, 15
    s_mul_i32 s98, s97, 393216
    s_add_u32 s99, s98, s85
    s_add_u32 s82, s99, 4294772736
    s_add_u32 m0, s83, 28672
    s_nop 0
    buffer_load_dwordx4 v3, s[40:43], s82 offen lds
    s_add_u32 s96, s84, 10
    s_and_b32 s97, s96, 15
    s_mul_i32 s98, s97, 393216
    s_add_u32 s99, s98, s85
    s_add_u32 s82, s99, 2048
    s_add_u32 m0, s83, 32768
    s_nop 0
    buffer_load_dwordx4 v3, s[40:43], s82 offen lds
    s_add_u32 s96, s84, 10
    s_and_b32 s97, s96, 15
    s_mul_i32 s98, s97, 393216
    s_add_u32 s99, s98, s85
    s_add_u32 s82, s99, 4294774784
    s_add_u32 m0, s83, 77824
    s_nop 0
    buffer_load_dwordx4 v3, s[40:43], s82 offen lds
    s_add_u32 s96, s84, 10
    s_and_b32 s97, s96, 15
    s_mul_i32 s98, s97, 393216
    s_add_u32 s99, s98, s85
    s_add_u32 s82, s99, 4096
    s_add_u32 m0, s83, 81920
    s_nop 0
    buffer_load_dwordx4 v3, s[40:43], s82 offen lds
    s_waitcnt lgkmcnt(0)
    s_load_dword s24, s[32:33], s92 offset:2560 glc
    s_load_dword s25, s[32:33], s92 offset:2304 glc
    s_load_dword s26, s[32:33], s92 offset:3072 glc
    s_load_dword s27, s[32:33], s92 offset:2816 glc
    s_waitcnt vmcnt(20)
    s_waitcnt vmcnt(18)
    s_waitcnt vmcnt(16)
    s_barrier
    s_add_u32 s96, s84, 11
    s_and_b32 s97, s96, 15
    s_mul_i32 s98, s97, 393216
    s_add_u32 s99, s98, s85
    s_add_u32 s82, s99, 4294772736
    s_add_u32 m0, s83, 36864
    s_nop 0
    buffer_load_dwordx4 v3, s[40:43], s82 offen lds
    s_add_u32 s96, s84, 11
    s_and_b32 s97, s96, 15
    s_mul_i32 s98, s97, 393216
    s_add_u32 s99, s98, s85
    s_add_u32 s82, s99, 2048
    s_add_u32 m0, s83, 40960
    s_nop 0
    buffer_load_dwordx4 v3, s[40:43], s82 offen lds
    s_add_u32 s96, s84, 11
    s_and_b32 s97, s96, 15
    s_mul_i32 s98, s97, 393216
    s_add_u32 s99, s98, s85
    s_add_u32 s82, s99, 4294774784
    s_add_u32 m0, s83, 86016
    s_nop 0
    buffer_load_dwordx4 v3, s[40:43], s82 offen lds
    s_add_u32 s96, s84, 11
    s_and_b32 s97, s96, 15
    s_mul_i32 s98, s97, 393216
    s_add_u32 s99, s98, s85
    s_add_u32 s82, s99, 4096
    s_add_u32 m0, s83, 90112
    s_nop 0
    buffer_load_dwordx4 v3, s[40:43], s82 offen lds
    s_waitcnt vmcnt(18)
    s_waitcnt vmcnt(16)
    s_waitcnt vmcnt(14)
    s_barrier
    s_add_u32 s96, s84, 12
    s_and_b32 s97, s96, 15
    s_mul_i32 s98, s97, 393216
    s_add_u32 s99, s98, s85
    s_add_u32 s82, s99, 4294772736
    s_add_u32 m0, s83, 4294963200
    s_nop 0
    buffer_load_dwordx4 v3, s[40:43], s82 offen lds
    s_add_u32 s96, s84, 12
    s_and_b32 s97, s96, 15
    s_mul_i32 s98, s97, 393216
    s_add_u32 s99, s98, s85
    s_add_u32 s82, s99, 2048
    s_mov_b32 m0, s83
    s_nop 0
    buffer_load_dwordx4 v3, s[40:43], s82 offen lds
    s_add_u32 s96, s84, 12
    s_and_b32 s97, s96, 15
    s_mul_i32 s98, s97, 393216
    s_add_u32 s99, s98, s85
    s_add_u32 s82, s99, 4294774784
    s_add_u32 m0, s83, 45056
    s_nop 0
    buffer_load_dwordx4 v3, s[40:43], s82 offen lds
    s_add_u32 s96, s84, 12
    s_and_b32 s97, s96, 15
    s_mul_i32 s98, s97, 393216
    s_add_u32 s99, s98, s85
    s_add_u32 s82, s99, 4096
    s_add_u32 m0, s83, 49152
    s_nop 0
    buffer_load_dwordx4 v3, s[40:43], s82 offen lds
    s_waitcnt vmcnt(16)
    s_barrier
    s_add_u32 s96, s84, 13
    s_and_b32 s97, s96, 15
    s_mul_i32 s98, s97, 393216
    s_add_u32 s99, s98, s85
    s_add_u32 s82, s99, 4294772736
    s_add_u32 m0, s83, 4096
    s_nop 0
    buffer_load_dwordx4 v3, s[40:43], s82 offen lds
    s_add_u32 s96, s84, 13
    s_and_b32 s97, s96, 15
    s_mul_i32 s98, s97, 393216
    s_add_u32 s99, s98, s85
    s_add_u32 s82, s99, 2048
    s_add_u32 m0, s83, 8192
    s_nop 0
    buffer_load_dwordx4 v3, s[40:43], s82 offen lds
    s_add_u32 s96, s84, 13
    s_and_b32 s97, s96, 15
    s_mul_i32 s98, s97, 393216
    s_add_u32 s99, s98, s85
    s_add_u32 s82, s99, 4294774784
    s_add_u32 m0, s83, 53248
    s_nop 0
    buffer_load_dwordx4 v3, s[40:43], s82 offen lds
    s_add_u32 s96, s84, 13
    s_and_b32 s97, s96, 15
    s_mul_i32 s98, s97, 393216
    s_add_u32 s99, s98, s85
    s_add_u32 s82, s99, 4096
    s_add_u32 m0, s83, 57344
    s_nop 0
    buffer_load_dwordx4 v3, s[40:43], s82 offen lds
    s_lshl_b32 s96, s74, 13
    s_sub_u32 s97, s3, 4
    s_lshl_b32 s98, s97, 8
    s_add_u32 s99, s96, s98
    s_add_u32 s13, s99, 20971520
    s_waitcnt lgkmcnt(0)
    s_load_dword s24, s[32:33], s13 offset:1276 glc
    s_load_dword s25, s[32:33], s13 offset:3324 glc
    s_load_dword s26, s[32:33], s13 offset:5372 glc
    s_load_dword s27, s[32:33], s13 offset:7420 glc
    s_waitcnt vmcnt(18)
    s_waitcnt vmcnt(16)
    s_barrier
    s_add_u32 s96, s84, 14
    s_and_b32 s97, s96, 15
    s_mul_i32 s98, s97, 393216
    s_add_u32 s99, s98, s85
    s_add_u32 s82, s99, 4294772736
    s_add_u32 m0, s83, 12288
    s_nop 0
    buffer_load_dwordx4 v3, s[40:43], s82 offen lds
    s_add_u32 s96, s84, 14
    s_and_b32 s97, s96, 15
    s_mul_i32 s98, s97, 393216
    s_add_u32 s99, s98, s85
    s_add_u32 s82, s99, 2048
    s_add_u32 m0, s83, 16384
    s_nop 0
    buffer_load_dwordx4 v3, s[40:43], s82 offen lds
    s_add_u32 s96, s84, 10
    s_and_b32 s97, s96, 15
    s_mul_i32 s98, s97, 393216
    s_add_u32 s99, s98, s85
    s_add_u32 s82, s99, 4294770688
    s_add_u32 m0, s83, 126976
    s_nop 0
    buffer_load_dwordx4 v3, s[40:43], s82 offen lds
    s_add_u32 s96, s84, 10
    s_and_b32 s97, s96, 15
    s_mul_i32 s98, s97, 393216
    s_add_u32 s82, s98, s85
    s_add_u32 m0, s83, 131072
    s_nop 0
    buffer_load_dwordx4 v3, s[40:43], s82 offen lds
    s_waitcnt vmcnt(18)
    s_waitcnt vmcnt(14)
    s_barrier
    s_add_u32 s96, s84, 15
    s_and_b32 s97, s96, 15
    s_mul_i32 s98, s97, 393216
    s_add_u32 s99, s98, s85
    s_add_u32 s82, s99, 4294772736
    s_add_u32 m0, s83, 20480
    s_nop 0
    buffer_load_dwordx4 v3, s[40:43], s82 offen lds
    s_add_u32 s96, s84, 15
    s_and_b32 s97, s96, 15
    s_mul_i32 s98, s97, 393216
    s_add_u32 s99, s98, s85
    s_add_u32 s82, s99, 2048
    s_add_u32 m0, s83, 24576
    s_nop 0
    buffer_load_dwordx4 v3, s[40:43], s82 offen lds
    s_add_u32 s96, s84, 11
    s_and_b32 s97, s96, 15
    s_mul_i32 s98, s97, 393216
    s_add_u32 s99, s98, s85
    s_add_u32 s82, s99, 4294770688
    s_add_u32 m0, s83, 135168
    s_nop 0
    buffer_load_dwordx4 v3, s[40:43], s82 offen lds
    s_add_u32 s96, s84, 11
    s_and_b32 s97, s96, 15
    s_mul_i32 s98, s97, 393216
    s_add_u32 s82, s98, s85
    s_add_u32 m0, s83, 139264
    s_nop 0
    buffer_load_dwordx4 v3, s[40:43], s82 offen lds
    s_waitcnt vmcnt(14)
    s_waitcnt vmcnt(10)
    s_waitcnt vmcnt(6)
    s_barrier
    s_add_u32 s96, s84, 14
    s_and_b32 s97, s96, 15
    s_mul_i32 s98, s97, 393216
    s_add_u32 s99, s98, s85
    s_add_u32 s82, s99, 4294774784
    s_add_u32 m0, s83, 61440
    s_nop 0
    buffer_load_dwordx4 v3, s[40:43], s82 offen lds
    s_add_u32 s96, s84, 14
    s_and_b32 s97, s96, 15
    s_mul_i32 s98, s97, 393216
    s_add_u32 s99, s98, s85
    s_add_u32 s82, s99, 4096
    s_add_u32 m0, s83, 65536
    s_nop 0
    buffer_load_dwordx4 v3, s[40:43], s82 offen lds
    s_add_u32 s96, s84, 15
    s_and_b32 s97, s96, 15
    s_mul_i32 s98, s97, 393216
    s_add_u32 s99, s98, s85
    s_add_u32 s82, s99, 4294774784
    s_add_u32 m0, s83, 69632
    s_nop 0
    buffer_load_dwordx4 v3, s[40:43], s82 offen lds
    s_add_u32 s96, s84, 15
    s_and_b32 s97, s96, 15
    s_mul_i32 s98, s97, 393216
    s_add_u32 s99, s98, s85
    s_add_u32 s82, s99, 4096
    s_add_u32 m0, s83, 73728
    s_nop 0
    buffer_load_dwordx4 v3, s[40:43], s82 offen lds
    s_add_u32 s96, s84, 12
    s_and_b32 s97, s96, 15
    s_mul_i32 s98, s97, 393216
    s_add_u32 s99, s98, s85
    s_add_u32 s82, s99, 4294770688
    s_add_u32 m0, s83, 94208
    s_nop 0
    buffer_load_dwordx4 v3, s[40:43], s82 offen lds
    s_add_u32 s96, s84, 12
    s_and_b32 s97, s96, 15
    s_mul_i32 s98, s97, 393216
    s_add_u32 s82, s98, s85
    s_add_u32 m0, s83, 98304
    s_nop 0
    buffer_load_dwordx4 v3, s[40:43], s82 offen lds
    s_mov_b32 s82, s19
    buffer_load_dwordx4 v[88:91], v248, s[48:51], s82 offen nt
    s_add_u32 s82, s19, 12288
    buffer_load_dwordx4 v[92:95], v248, s[48:51], s82 offen nt
    s_add_u32 s82, s19, 24576
    buffer_load_dwordx4 v[96:99], v248, s[48:51], s82 offen nt
    s_add_u32 s82, s19, 36864
    buffer_load_dwordx4 v[100:103], v248, s[48:51], s82 offen nt
    s_waitcnt vmcnt(12)
    s_barrier
    s_add_u32 s96, s84, 13
    s_and_b32 s97, s96, 15
    s_mul_i32 s98, s97, 393216
    s_add_u32 s99, s98, s85
    s_add_u32 s82, s99, 4294770688
    s_add_u32 m0, s83, 102400
    s_nop 0
    buffer_load_dwordx4 v3, s[40:43], s82 offen lds
    s_add_u32 s96, s84, 13
    s_and_b32 s97, s96, 15
    s_mul_i32 s98, s97, 393216
    s_add_u32 s82, s98, s85
    s_add_u32 m0, s83, 106496
    s_nop 0
    buffer_load_dwordx4 v3, s[40:43], s82 offen lds
    s_add_u32 s96, s84, 14
    s_and_b32 s97, s96, 15
    s_mul_i32 s98, s97, 393216
    s_add_u32 s99, s98, s85
    s_add_u32 s82, s99, 4294770688
    s_add_u32 m0, s83, 110592
    s_nop 0
    buffer_load_dwordx4 v3, s[40:43], s82 offen lds
    s_add_u32 s96, s84, 14
    s_and_b32 s97, s96, 15
    s_mul_i32 s98, s97, 393216
    s_add_u32 s82, s98, s85
    s_add_u32 m0, s83, 114688
    s_nop 0
    buffer_load_dwordx4 v3, s[40:43], s82 offen lds
    s_add_u32 s96, s84, 15
    s_and_b32 s97, s96, 15
    s_mul_i32 s98, s97, 393216
    s_add_u32 s99, s98, s85
    s_add_u32 s82, s99, 4294770688
    s_add_u32 m0, s83, 118784
    s_nop 0
    buffer_load_dwordx4 v3, s[40:43], s82 offen lds
    s_add_u32 s96, s84, 15
    s_and_b32 s97, s96, 15
    s_mul_i32 s98, s97, 393216
    s_add_u32 s82, s98, s85
    s_add_u32 m0, s83, 122880
    s_nop 0
    buffer_load_dwordx4 v3, s[40:43], s82 offen lds
    v_and_b32 v85, 1, v1
    v_lshlrev_b32 v85, 3, v85
    v_bfe_u32 v84, v1, 2, 2
    v_lshl_add_u32 v85, v84, 4, v85
    v_bfe_u32 v84, v1, 4, 1
    v_lshl_add_u32 v85, v84, 6, v85
    v_bfe_u32 v84, v1, 1, 1
    v_lshl_add_u32 v85, v84, 7, v85
    v_lshrrev_b32 v84, 5, v1
    v_lshl_add_u32 v85, v84, 8, v85
    s_lshl_b32 s13, s3, 12
    v_add_u32 v84, s13, v85
    s_lshl_b32 s96, s76, 13
    s_add_u32 s13, s96, 32768
    v_add_u32 v85, s13, v85
    v_mov_b32 v80, 0x3f803f80
    v_mov_b32 v81, 0x3f803f80
    v_mov_b32 v82, 0x3f803f80
    v_mov_b32 v83, 0x3f803f80
    s_lshl3_add_u32 s96, s11, s3
    s_lshl_b32 s97, s96, 5
    s_add_u32 s98, s97, s10
    s_lshl_b32 s99, s98, 10
    s_add_u32 s13, s99, 25165824
    s_add_u32 s15, s13, 16384
    s_lshl3_add_u32 s96, s11, s3
    s_lshl_b32 s97, s96, 10
    s_add_u32 s16, s97, 21495808
    s_lshl_b32 s96, s10, 6
    s_add_u32 s14, s96, s16
    s_waitcnt lgkmcnt(0)
    s_barrier
    s_setprio 3
    ds_read_b128 v[152:155], v0
    ds_read_b128 v[156:159], v0 offset:1024
    v_subrev_u32 v0, 118784, v0
    s_waitcnt lgkmcnt(1)
    v_mfma_f32_32x32x16_bf16 v[184:199], v[168:171], v[152:155], 0
    s_waitcnt lgkmcnt(0)
    v_mfma_f32_32x32x16_bf16 v[184:199], v[172:175], v[156:159], v[184:199]
    s_setprio 0
    s_nop 10
    v_cvt_pk_bf16_f32 v184, 0, v184
    v_cvt_pk_bf16_f32 v185, 0, v185
    v_cvt_pk_bf16_f32 v186, 0, v186
    s_add_u32 s82, s19, 49152
    buffer_load_dwordx4 v[104:107], v248, s[48:51], s82 offen nt
    v_cvt_pk_bf16_f32 v187, 0, v187
    v_cvt_pk_bf16_f32 v188, 0, v188
    v_cvt_pk_bf16_f32 v189, 0, v189
    v_cvt_pk_bf16_f32 v190, 0, v190
    v_cvt_pk_bf16_f32 v191, 0, v191
    v_cvt_pk_bf16_f32 v192, 0, v192
    v_cvt_pk_bf16_f32 v193, 0, v193
    v_cvt_pk_bf16_f32 v194, 0, v194
    v_cvt_pk_bf16_f32 v195, 0, v195
    v_cvt_pk_bf16_f32 v196, 0, v196
    s_add_u32 s82, s19, 61440
    buffer_load_dwordx4 v[108:111], v248, s[48:51], s82 offen nt
    v_cvt_pk_bf16_f32 v197, 0, v197
    v_cvt_pk_bf16_f32 v198, 0, v198
    v_cvt_pk_bf16_f32 v199, 0, v199
    v_max3_f32 v4, v184, v185, v186
    v_min3_f32 v5, v184, v185, v186
    v_max3_f32 v4, v4, v187, v188
    v_min3_f32 v5, v5, v187, v188
    v_max3_f32 v4, v4, v189, v190
    v_min3_f32 v5, v5, v189, v190
    v_max3_f32 v4, v4, v191, v192
    s_add_u32 s82, s19, 73728
    buffer_load_dwordx4 v[112:115], v248, s[48:51], s82 offen nt
    v_min3_f32 v5, v5, v191, v192
    v_max3_f32 v4, v4, v193, v194
    v_min3_f32 v5, v5, v193, v194
    v_max3_f32 v4, v4, v195, v196
    v_min3_f32 v5, v5, v195, v196
    v_max3_f32 v4, v4, v197, v198
    v_min3_f32 v5, v5, v197, v198
    v_max_f32 v6, v4, v199
    v_min_f32 v7, v5, v199
    v_max_f32 v4, v4, v199
    s_add_u32 s82, s19, 86016
    buffer_load_dwordx4 v[116:119], v248, s[48:51], s82 offen nt
    v_min_f32 v5, v5, v199
    v_permlane32_swap_b32 v4, v6
    s_nop 0
    v_permlane32_swap_b32 v5, v7
    v_max_f32 v4, v4, v6
    v_min_f32 v5, v5, v7
    v_mul_f32_e64 v4, v4, s7
    v_mul_f32_e64 v5, v5, s7
    v_fma_f32 v216, v184, s7, -v4
    v_fma_f32 v217, v185, s7, -v4
    v_fma_f32 v184, -v184, s7, v5
    v_fma_f32 v185, -v185, s7, v5
    v_fma_f32 v218, v186, s7, -v4
    v_fma_f32 v219, v187, s7, -v4
    v_fma_f32 v186, -v186, s7, v5
    v_fma_f32 v187, -v187, s7, v5
    s_waitcnt vmcnt(18)
    s_waitcnt vmcnt(16)
    s_barrier
    s_setprio 3
    ds_read_b128 v[152:155], v0
    ds_read_b128 v[156:159], v0 offset:1024
    s_waitcnt lgkmcnt(1)
    v_mfma_f32_32x32x16_bf16 v[200:215], v[176:179], v[152:155], 0
    s_waitcnt lgkmcnt(0)
    v_mfma_f32_32x32x16_bf16 v[200:215], v[180:183], v[156:159], v[200:215]
    s_setprio 0
    v_fma_f32 v220, v188, s7, -v4
    v_fma_f32 v221, v189, s7, -v4
    v_fma_f32 v188, -v188, s7, v5
    v_fma_f32 v189, -v189, s7, v5
    v_fma_f32 v222, v190, s7, -v4
    s_mov_b32 s82, s80
    buffer_load_dwordx4 v[56:59], v27, s[52:55], s82 offen nt
    v_fma_f32 v223, v191, s7, -v4
    v_fma_f32 v190, -v190, s7, v5
    v_fma_f32 v191, -v191, s7, v5
    v_fma_f32 v224, v192, s7, -v4
    v_fma_f32 v225, v193, s7, -v4
    s_setprio 3
    v_fma_f32 v192, -v192, s7, v5
    v_fma_f32 v193, -v193, s7, v5
    v_fma_f32 v226, v194, s7, -v4
    v_fma_f32 v227, v195, s7, -v4
    v_fma_f32 v194, -v194, s7, v5
    v_fma_f32 v195, -v195, s7, v5
    v_fma_f32 v228, v196, s7, -v4
    v_fma_f32 v229, v197, s7, -v4
    v_fma_f32 v196, -v196, s7, v5
    v_fma_f32 v197, -v197, s7, v5
    v_fma_f32 v230, v198, s7, -v4
    v_fma_f32 v231, v199, s7, -v4
    v_fma_f32 v198, -v198, s7, v5
    v_fma_f32 v199, -v199, s7, v5
    v_exp_f32 v216, v216
    s_add_u32 s82, s80, 4294049792
    buffer_load_dwordx4 v[60:63], v27, s[52:55], s82 offen nt
    v_exp_f32 v184, v184
    v_exp_f32 v217, v217
    v_exp_f32 v185, v185
    v_exp_f32 v218, v218
    v_exp_f32 v186, v186
    v_exp_f32 v219, v219
    v_exp_f32 v187, v187
    v_exp_f32 v220, v220
    v_exp_f32 v188, v188
    v_exp_f32 v221, v221
    v_exp_f32 v189, v189
    v_exp_f32 v222, v222
    v_exp_f32 v190, v190
    v_exp_f32 v223, v223
    v_exp_f32 v191, v191
    v_exp_f32 v224, v224
    v_exp_f32 v192, v192
    v_exp_f32 v225, v225
    v_exp_f32 v193, v193
    v_exp_f32 v226, v226
    s_add_u32 s82, s80, 57344
    buffer_load_dwordx4 v[64:67], v27, s[52:55], s82 offen nt
    v_exp_f32 v194, v194
    v_exp_f32 v227, v227
    v_exp_f32 v195, v195
    v_exp_f32 v228, v228
    v_exp_f32 v196, v196
    v_exp_f32 v229, v229
    v_exp_f32 v197, v197
    v_exp_f32 v230, v230
    v_exp_f32 v198, v198
    v_exp_f32 v231, v231
    v_exp_f32 v199, v199
    v_add_f32 v8, v216, v218
    v_add_f32 v9, v217, v219
    v_add_f32 v10, v184, v186
    v_add_f32 v11, v185, v187
    v_add_f32 v8, v8, v220
    v_add_f32 v9, v9, v221
    v_add_f32 v10, v10, v188
    v_add_f32 v11, v11, v189
    v_add_f32 v8, v8, v222
    s_add_u32 s82, s80, 4294107136
    buffer_load_dwordx4 v[68:71], v27, s[52:55], s82 offen nt
    v_add_f32 v9, v9, v223
    v_add_f32 v10, v10, v190
    v_add_f32 v11, v11, v191
    v_add_f32 v8, v8, v224
    v_add_f32 v9, v9, v225
    v_add_f32 v10, v10, v192
    v_add_f32 v11, v11, v193
    v_add_f32 v8, v8, v226
    v_add_f32 v9, v9, v227
    v_add_f32 v10, v10, v194
    v_add_f32 v11, v11, v195
    v_add_f32 v8, v8, v228
    v_add_f32 v9, v9, v229
    v_add_f32 v10, v10, v196
    v_add_f32 v11, v11, v197
    v_add_f32 v8, v8, v230
    v_add_f32 v9, v9, v231
    v_add_f32 v10, v10, v198
    v_add_f32 v11, v11, v199
    v_add_f32 v6, v8, v9
    v_add_f32 v7, v10, v11
    v_add_f32 v4, v8, v9
    s_setprio 0
    v_add_f32 v5, v10, v11
    v_permlane32_swap_b32 v4, v6
    s_nop 0
    v_permlane32_swap_b32 v5, v7
    v_add_f32 v4, v4, v6
    v_add_f32 v5, v5, v7
    v_rcp_f32 v4, v4
    v_rcp_f32 v5, v5
    v_mul_f32 v216, v216, v4
    v_mul_f32 v217, v217, v4
    v_mul_f32 v184, v184, v5
    v_mul_f32 v185, v185, v5
    v_mul_f32 v218, v218, v4
    v_mul_f32 v219, v219, v4
    v_mul_f32 v186, v186, v5
    v_mul_f32 v187, v187, v5
    v_mul_f32 v220, v220, v4
    v_mul_f32 v221, v221, v4
    v_mul_f32 v188, v188, v5
    v_mul_f32 v189, v189, v5
    v_mul_f32 v222, v222, v4
    v_mul_f32 v223, v223, v4
    v_mul_f32 v190, v190, v5
    v_mul_f32 v191, v191, v5
    v_mul_f32 v224, v224, v4
    v_mul_f32 v225, v225, v4
    v_mul_f32 v192, v192, v5
    v_mul_f32 v193, v193, v5
    v_mul_f32 v226, v226, v4
    v_mul_f32 v227, v227, v4
    v_mul_f32 v194, v194, v5
    v_mul_f32 v195, v195, v5
    v_mul_f32 v228, v228, v4
    v_mul_f32 v229, v229, v4
    v_mul_f32 v196, v196, v5
    v_mul_f32 v197, v197, v5
    v_mul_f32 v230, v230, v4
    v_mul_f32 v231, v231, v4
    v_mul_f32 v198, v198, v5
    v_mul_f32 v199, v199, v5
    v_cvt_pk_bf16_f32 v216, v216, v217
    v_cvt_pk_bf16_f32 v217, v218, v219
    v_cvt_pk_bf16_f32 v218, v220, v221
    v_cvt_pk_bf16_f32 v219, v222, v223
    v_cvt_pk_bf16_f32 v220, v224, v225
    v_cvt_pk_bf16_f32 v221, v226, v227
    v_cvt_pk_bf16_f32 v222, v228, v229
    v_cvt_pk_bf16_f32 v223, v230, v231
    ds_write_b128 v232, v[216:219]
    v_cvt_pk_bf16_f32 v224, v184, v185
    v_cvt_pk_bf16_f32 v225, v186, v187
    v_cvt_pk_bf16_f32 v226, v188, v189
    v_cvt_pk_bf16_f32 v227, v190, v191
    ds_write_b128 v232, v[220:223] offset:4096
    s_waitcnt vmcnt(18)
    s_waitcnt vmcnt(12)
    s_waitcnt vmcnt(10)
    s_waitcnt vmcnt(8)
    s_barrier
    ds_write_b128 v232, v[224:227] offset:8192
    v_cvt_pk_bf16_f32 v228, v192, v193
    v_cvt_pk_bf16_f32 v229, v194, v195
    v_cvt_pk_bf16_f32 v230, v196, v197
    v_cvt_pk_bf16_f32 v231, v198, v199
    s_xor_b32 s96, s95, 786432
    s_add_u32 s97, s96, s90
    s_sub_u32 s82, s97, 65536
    s_add_u32 m0, s83, 45056
    s_nop 0
    buffer_load_dwordx4 v26, s[44:47], s82 offen lds
    ds_write_b128 v232, v[228:231] offset:12288
    v_cvt_pk_bf16_f32 v200, 0, v200
    v_cvt_pk_bf16_f32 v201, 0, v201
    v_cvt_pk_bf16_f32 v202, 0, v202
    v_cvt_pk_bf16_f32 v203, 0, v203
    v_cvt_pk_bf16_f32 v204, 0, v204
    v_cvt_pk_bf16_f32 v205, 0, v205
    v_cvt_pk_bf16_f32 v206, 0, v206
    v_cvt_pk_bf16_f32 v207, 0, v207
    v_cvt_pk_bf16_f32 v208, 0, v208
    v_cvt_pk_bf16_f32 v209, 0, v209
    v_cvt_pk_bf16_f32 v210, 0, v210
    v_cvt_pk_bf16_f32 v211, 0, v211
    s_xor_b32 s96, s95, 786432
    s_add_u32 s82, s96, s90
    s_add_u32 m0, s83, 49152
    s_nop 0
    buffer_load_dwordx4 v26, s[44:47], s82 offen lds
    v_cvt_pk_bf16_f32 v212, 0, v212
    v_cvt_pk_bf16_f32 v213, 0, v213
    v_cvt_pk_bf16_f32 v214, 0, v214
    v_cvt_pk_bf16_f32 v215, 0, v215
    v_max3_f32 v4, v200, v201, v202
    v_min3_f32 v5, v200, v201, v202
    v_max3_f32 v4, v4, v203, v204
    v_min3_f32 v5, v5, v203, v204
L_PAD6:
    s_cbranch_execz L_RET6
    v_max3_f32 v4, v4, v205, v206
    v_min3_f32 v5, v5, v205, v206
    v_max3_f32 v4, v4, v207, v208
    v_min3_f32 v5, v5, v207, v208
    v_max3_f32 v4, v4, v209, v210
    v_min3_f32 v5, v5, v209, v210
    s_xor_b32 s96, s95, 917504
    s_add_u32 s97, s96, s90
    s_sub_u32 s82, s97, 65536
    s_add_u32 m0, s83, 53248
    s_nop 0
    buffer_load_dwordx4 v26, s[44:47], s82 offen lds
    v_max3_f32 v4, v4, v211, v212
    v_min3_f32 v5, v5, v211, v212
    v_max3_f32 v4, v4, v213, v214
    v_min3_f32 v5, v5, v213, v214
    v_max_f32 v6, v4, v215
    v_min_f32 v7, v5, v215
    v_max_f32 v4, v4, v215
    s_waitcnt lgkmcnt(0)
    v_min_f32 v5, v5, v215
    v_permlane32_swap_b32 v4, v6
    s_nop 0
    v_permlane32_swap_b32 v5, v7
    v_max_f32 v4, v4, v6
    v_min_f32 v5, v5, v7
    v_mul_f32_e64 v4, v4, s7
    s_xor_b32 s96, s95, 917504
    s_add_u32 s82, s96, s90
    s_add_u32 m0, s83, 57344
    s_nop 0
    buffer_load_dwordx4 v26, s[44:47], s82 offen lds
    v_mul_f32_e64 v5, v5, s7
    v_fma_f32 v216, v200, s7, -v4
    v_fma_f32 v217, v201, s7, -v4
    v_fma_f32 v200, -v200, s7, v5
    v_fma_f32 v201, -v201, s7, v5
    v_fma_f32 v218, v202, s7, -v4
    v_fma_f32 v219, v203, s7, -v4
    v_fma_f32 v202, -v202, s7, v5
    v_fma_f32 v203, -v203, s7, v5
    v_fma_f32 v220, v204, s7, -v4
    v_fma_f32 v221, v205, s7, -v4
    v_fma_f32 v204, -v204, s7, v5
    v_fma_f32 v205, -v205, s7, v5
    v_fma_f32 v222, v206, s7, -v4
    s_xor_b32 s96, s95, 1048576
    s_add_u32 s97, s96, s90
    s_sub_u32 s82, s97, 65536
    s_add_u32 m0, s83, 61440
    s_nop 0
    buffer_load_dwordx4 v26, s[44:47], s82 offen lds
    v_fma_f32 v223, v207, s7, -v4
    v_fma_f32 v206, -v206, s7, v5
    v_fma_f32 v207, -v207, s7, v5
    v_fma_f32 v224, v208, s7, -v4
    v_fma_f32 v225, v209, s7, -v4
    v_fma_f32 v208, -v208, s7, v5
    v_fma_f32 v209, -v209, s7, v5
    v_fma_f32 v226, v210, s7, -v4
    v_fma_f32 v227, v211, s7, -v4
    v_fma_f32 v210, -v210, s7, v5
    v_fma_f32 v211, -v211, s7, v5
    v_fma_f32 v228, v212, s7, -v4
    v_fma_f32 v229, v213, s7, -v4
    v_fma_f32 v212, -v212, s7, v5
    s_xor_b32 s96, s95, 1048576
    s_add_u32 s82, s96, s90
    s_add_u32 m0, s83, 65536
    s_nop 0
    buffer_load_dwordx4 v26, s[44:47], s82 offen lds
    v_fma_f32 v213, -v213, s7, v5
    v_fma_f32 v230, v214, s7, -v4
    v_fma_f32 v231, v215, s7, -v4
    v_fma_f32 v214, -v214, s7, v5
    v_fma_f32 v215, -v215, s7, v5
    v_exp_f32 v216, v216
    v_exp_f32 v200, v200
    v_exp_f32 v217, v217
    v_exp_f32 v201, v201
    v_exp_f32 v218, v218
    v_exp_f32 v202, v202
    v_exp_f32 v219, v219
    v_exp_f32 v203, v203
    v_exp_f32 v220, v220
    s_xor_b32 s96, s95, 1179648
    s_add_u32 s97, s96, s90
    s_sub_u32 s82, s97, 65536
    s_add_u32 m0, s83, 69632
    s_nop 0
    buffer_load_dwordx4 v26, s[44:47], s82 offen lds
    v_exp_f32 v204, v204
    v_exp_f32 v221, v221
    v_exp_f32 v205, v205
    v_exp_f32 v222, v222
    v_exp_f32 v206, v206
    v_exp_f32 v223, v223
    v_exp_f32 v207, v207
    v_exp_f32 v224, v224
    v_exp_f32 v208, v208
    v_exp_f32 v225, v225
    v_exp_f32 v209, v209
    v_exp_f32 v226, v226
    v_exp_f32 v210, v210
    v_exp_f32 v227, v227
    s_xor_b32 s96, s95, 1179648
    s_add_u32 s82, s96, s90
    s_add_u32 m0, s83, 73728
    s_nop 0
    buffer_load_dwordx4 v26, s[44:47], s82 offen lds
    v_exp_f32 v211, v211
    v_exp_f32 v228, v228
    v_exp_f32 v212, v212
    v_exp_f32 v229, v229
    v_exp_f32 v213, v213
    v_exp_f32 v230, v230
    v_exp_f32 v214, v214
    v_exp_f32 v231, v231
    v_exp_f32 v215, v215
    v_add_f32 v8, v216, v218
    v_add_f32 v9, v217, v219
    v_add_f32 v10, v200, v202
    v_add_f32 v11, v201, v203
    v_add_f32 v8, v8, v220
    v_add_f32 v9, v9, v221
    v_add_f32 v10, v10, v204
    v_add_f32 v11, v11, v205
    v_add_f32 v8, v8, v222
    v_add_f32 v9, v9, v223
    v_add_f32 v10, v10, v206
    v_add_f32 v11, v11, v207
    v_add_f32 v8, v8, v224
    v_add_f32 v9, v9, v225
    v_add_f32 v10, v10, v208
    v_add_f32 v11, v11, v209
    v_add_f32 v8, v8, v226
    v_add_f32 v9, v9, v227
    v_add_f32 v10, v10, v210
    v_add_f32 v11, v11, v211
    v_add_f32 v8, v8, v228
    v_add_f32 v9, v9, v229
    v_add_f32 v10, v10, v212
    v_add_f32 v11, v11, v213
    v_add_f32 v8, v8, v230
    v_add_f32 v9, v9, v231
    v_add_f32 v10, v10, v214
    v_add_f32 v11, v11, v215
    v_add_f32 v6, v8, v9
    v_add_f32 v7, v10, v11
    v_add_f32 v4, v8, v9
    v_add_f32 v5, v10, v11
    s_nop 0
    v_permlane32_swap_b32 v4, v6
    v_permlane32_swap_b32 v5, v7
    v_add_f32 v4, v4, v6
    v_add_f32 v5, v5, v7
    v_rcp_f32 v4, v4
    v_rcp_f32 v5, v5
    v_mul_f32 v216, v216, v4
    v_mul_f32 v217, v217, v4
    v_mul_f32 v200, v200, v5
    v_mul_f32 v201, v201, v5
    v_mul_f32 v218, v218, v4
    v_mul_f32 v219, v219, v4
    v_mul_f32 v202, v202, v5
    v_mul_f32 v203, v203, v5
    v_mul_f32 v220, v220, v4
    v_mul_f32 v221, v221, v4
    v_mul_f32 v204, v204, v5
    v_mul_f32 v205, v205, v5
    v_mul_f32 v222, v222, v4
    v_mul_f32 v223, v223, v4
    v_mul_f32 v206, v206, v5
    v_mul_f32 v207, v207, v5
    v_mul_f32 v224, v224, v4
    v_mul_f32 v225, v225, v4
    v_mul_f32 v208, v208, v5
    v_mul_f32 v209, v209, v5
    v_mul_f32 v226, v226, v4
    v_mul_f32 v227, v227, v4
    v_mul_f32 v210, v210, v5
    v_mul_f32 v211, v211, v5
    v_mul_f32 v228, v228, v4
    v_mul_f32 v229, v229, v4
    v_mul_f32 v212, v212, v5
    v_mul_f32 v213, v213, v5
    v_mul_f32 v230, v230, v4
    v_mul_f32 v231, v231, v4
    v_mul_f32 v214, v214, v5
    v_mul_f32 v215, v215, v5
    v_cvt_pk_bf16_f32 v216, v216, v217
    v_cvt_pk_bf16_f32 v217, v218, v219
    v_cvt_pk_bf16_f32 v218, v220, v221
    v_cvt_pk_bf16_f32 v219, v222, v223
    v_cvt_pk_bf16_f32 v220, v224, v225
    v_cvt_pk_bf16_f32 v221, v226, v227
    v_cvt_pk_bf16_f32 v222, v228, v229
    v_cvt_pk_bf16_f32 v223, v230, v231
    ds_write_b128 v232, v[216:219] offset:16384
    v_cvt_pk_bf16_f32 v224, v200, v201
    v_cvt_pk_bf16_f32 v225, v202, v203
    v_cvt_pk_bf16_f32 v226, v204, v205
    v_cvt_pk_bf16_f32 v227, v206, v207
    ds_write_b128 v232, v[220:223] offset:20480
    ds_write_b128 v232, v[224:227] offset:24576
    v_cvt_pk_bf16_f32 v228, v208, v209
    v_cvt_pk_bf16_f32 v229, v210, v211
    v_cvt_pk_bf16_f32 v230, v212, v213
    v_cvt_pk_bf16_f32 v231, v214, v215
    ds_write_b128 v232, v[228:231] offset:28672
    s_lshl_b32 s96, s77, 11
    s_add_u32 s17, s96, 151552
    v_add_u32 v0, s17, v2
    s_setprio 0
L_JOIN:
    s_waitcnt lgkmcnt(0)
    s_barrier
    ds_read_b64_tr_b16 v[184:185], v84
    ds_read_b64_tr_b16 v[186:187], v84 offset:512
    ds_read_b64_tr_b16 v[200:201], v85
    ds_read_b64_tr_b16 v[202:203], v85 offset:512
    ds_read_b64_tr_b16 v[204:205], v85 offset:1024
    ds_read_b64_tr_b16 v[206:207], v85 offset:1536
    ds_read_b64_tr_b16 v[188:189], v84 offset:1024
    ds_read_b64_tr_b16 v[190:191], v84 offset:1536
    ds_read_b64_tr_b16 v[208:209], v85 offset:2048
    ds_read_b64_tr_b16 v[210:211], v85 offset:2560
    ds_read_b64_tr_b16 v[212:213], v85 offset:3072
    ds_read_b64_tr_b16 v[214:215], v85 offset:3584
    ds_read_b64_tr_b16 v[192:193], v84 offset:2048
    ds_read_b64_tr_b16 v[194:195], v84 offset:2560
    ds_read_b64_tr_b16 v[216:217], v85 offset:4096
    ds_read_b64_tr_b16 v[218:219], v85 offset:4608
    ds_read_b64_tr_b16 v[220:221], v85 offset:5120
    ds_read_b64_tr_b16 v[222:223], v85 offset:5632
    s_waitcnt lgkmcnt(12)
    v_mfma_f32_16x16x32_bf16 v[232:235], v[184:187], v[200:203], 0
    v_mfma_f32_16x16x32_bf16 v[236:239], v[184:187], v[204:207], 0
    v_mfma_f32_16x16x32_bf16 v[240:243], v[184:187], v[80:83], 0
    ds_read_b64_tr_b16 v[196:197], v84 offset:3072
    ds_read_b64_tr_b16 v[198:199], v84 offset:3584
    ds_read_b64_tr_b16 v[224:225], v85 offset:6144
    ds_read_b64_tr_b16 v[226:227], v85 offset:6656
    ds_read_b64_tr_b16 v[228:229], v85 offset:7168
    ds_read_b64_tr_b16 v[230:231], v85 offset:7680
    s_waitcnt lgkmcnt(12)
    v_mfma_f32_16x16x32_bf16 v[232:235], v[188:191], v[208:211], v[232:235]
    v_mfma_f32_16x16x32_bf16 v[236:239], v[188:191], v[212:215], v[236:239]
    v_mfma_f32_16x16x32_bf16 v[240:243], v[188:191], v[80:83], v[240:243]
    s_waitcnt lgkmcnt(6)
    v_mfma_f32_16x16x32_bf16 v[232:235], v[192:195], v[216:219], v[232:235]
    v_mfma_f32_16x16x32_bf16 v[236:239], v[192:195], v[220:223], v[236:239]
    v_mfma_f32_16x16x32_bf16 v[240:243], v[192:195], v[80:83], v[240:243]
    s_waitcnt lgkmcnt(0)
    v_mfma_f32_16x16x32_bf16 v[232:235], v[196:199], v[224:227], v[232:235]
    v_mfma_f32_16x16x32_bf16 v[236:239], v[196:199], v[228:231], v[236:239]
    v_mfma_f32_16x16x32_bf16 v[240:243], v[196:199], v[80:83], v[240:243]
    s_cmp_lt_u32 s3, 4
    s_cbranch_scc1 L_NOQX
    ds_read_b128 v[168:171], v0
    ds_read_b128 v[172:175], v0 offset:1024
L_NOQX:
    s_nop 3
    buffer_store_dwordx4 v[232:235], v2, s[32:35], s13 offen sc1
    buffer_store_dwordx4 v[236:239], v2, s[32:35], s15 offen sc1
    s_mov_b32 exec_lo, 0x00010001
    s_mov_b32 exec_hi, 0x00010001
    buffer_store_dwordx4 v[240:243], v1, s[32:35], s14 offen sc1
    s_mov_b64 exec, -1
    s_waitcnt lgkmcnt(0)
    v_mfma_f32_32x32x16_bf16 v[120:135], v[176:179], v[168:171], 0
    v_mfma_f32_32x32x16_bf16 v[120:135], v[180:183], v[172:175], v[120:135]
    v_and_b32 v46, 7, v1
    v_lshlrev_b32 v46, 17, v46
    v_bfe_u32 v9, v1, 3, 1
    v_lshl_add_u32 v46, v9, 14, v46
    s_and_b32 s96, s10, 1
    s_and_b32 s97, s2, 27
    s_lshl_b32 s98, s97, 12
    s_lshr_b32 s99, s10, 1
    s_lshl_b32 s97, s99, 6
    s_add_u32 s99, s98, s97
    s_lshl2_add_u32 s98, s96, s99
    s_add_u32 s97, s98, 1048576
    s_add_u32 s17, s97, 512
    v_lshrrev_b32 v47, 3, v1
    v_lshlrev_b32 v47, 10, v47
    v_and_b32 v9, 7, v1
    v_lshl_add_u32 v47, v9, 4, v47
    v_and_b32 v48, 7, v1
    v_lshlrev_b32 v48, 4, v48
    v_lshrrev_b32 v9, 5, v1
    v_lshl_add_u32 v48, v9, 3, v48
    v_cvt_pk_bf16_f32 v120, 0, v120
    v_cvt_pk_bf16_f32 v121, 0, v121
    v_cvt_pk_bf16_f32 v122, 0, v122
    v_cvt_pk_bf16_f32 v123, 0, v123
    v_cvt_pk_bf16_f32 v124, 0, v124
    v_cvt_pk_bf16_f32 v125, 0, v125
    v_cvt_pk_bf16_f32 v126, 0, v126
    v_cvt_pk_bf16_f32 v127, 0, v127
    v_cvt_pk_bf16_f32 v128, 0, v128
    v_cvt_pk_bf16_f32 v129, 0, v129
    v_cvt_pk_bf16_f32 v130, 0, v130
    v_cvt_pk_bf16_f32 v131, 0, v131
    v_cvt_pk_bf16_f32 v132, 0, v132
    v_cvt_pk_bf16_f32 v133, 0, v133
    v_cvt_pk_bf16_f32 v134, 0, v134
    v_cvt_pk_bf16_f32 v135, 0, v135
    v_max3_f32 v4, v120, v121, v122
    v_min3_f32 v5, v120, v121, v122
    v_max3_f32 v4, v4, v123, v124
    v_min3_f32 v5, v5, v123, v124
    v_max3_f32 v4, v4, v125, v126
    v_min3_f32 v5, v5, v125, v126
    v_max3_f32 v4, v4, v127, v128
    v_min3_f32 v5, v5, v127, v128
    v_max3_f32 v4, v4, v129, v130
    v_min3_f32 v5, v5, v129, v130
    v_max3_f32 v4, v4, v131, v132
    v_min3_f32 v5, v5, v131, v132
    v_max3_f32 v4, v4, v133, v134
    v_min3_f32 v5, v5, v133, v134
    v_max_f32 v6, v4, v135
    v_min_f32 v7, v5, v135
    v_max_f32 v4, v4, v135
    v_min_f32 v5, v5, v135
    s_nop 0
    v_permlane32_swap_b32 v4, v6
    v_permlane32_swap_b32 v5, v7
    v_max_f32 v4, v4, v6
    v_min_f32 v5, v5, v7
    v_pk_mul_f32 v[4:5], v[4:5], s[6:7] op_sel:[0,1]
    v_mov_b32 v6, v5
    v_pk_fma_f32 v[136:137], v[120:121], s[6:7], v[4:5] op_sel:[0,1,0] op_sel_hi:[1,1,0] neg_lo:[0,0,1] neg_hi:[0,0,1]
    v_pk_fma_f32 v[120:121], v[120:121], s[6:7], v[6:7] op_sel:[0,1,0] op_sel_hi:[1,1,0] neg_lo:[1,0,0] neg_hi:[1,0,0]
    v_pk_fma_f32 v[138:139], v[122:123], s[6:7], v[4:5] op_sel:[0,1,0] op_sel_hi:[1,1,0] neg_lo:[0,0,1] neg_hi:[0,0,1]
    v_pk_fma_f32 v[122:123], v[122:123], s[6:7], v[6:7] op_sel:[0,1,0] op_sel_hi:[1,1,0] neg_lo:[1,0,0] neg_hi:[1,0,0]
    v_pk_fma_f32 v[140:141], v[124:125], s[6:7], v[4:5] op_sel:[0,1,0] op_sel_hi:[1,1,0] neg_lo:[0,0,1] neg_hi:[0,0,1]
    v_pk_fma_f32 v[124:125], v[124:125], s[6:7], v[6:7] op_sel:[0,1,0] op_sel_hi:[1,1,0] neg_lo:[1,0,0] neg_hi:[1,0,0]
    v_pk_fma_f32 v[142:143], v[126:127], s[6:7], v[4:5] op_sel:[0,1,0] op_sel_hi:[1,1,0] neg_lo:[0,0,1] neg_hi:[0,0,1]
    v_pk_fma_f32 v[126:127], v[126:127], s[6:7], v[6:7] op_sel:[0,1,0] op_sel_hi:[1,1,0] neg_lo:[1,0,0] neg_hi:[1,0,0]
    v_pk_fma_f32 v[144:145], v[128:129], s[6:7], v[4:5] op_sel:[0,1,0] op_sel_hi:[1,1,0] neg_lo:[0,0,1] neg_hi:[0,0,1]
    v_pk_fma_f32 v[128:129], v[128:129], s[6:7], v[6:7] op_sel:[0,1,0] op_sel_hi:[1,1,0] neg_lo:[1,0,0] neg_hi:[1,0,0]
    v_pk_fma_f32 v[146:147], v[130:131], s[6:7], v[4:5] op_sel:[0,1,0] op_sel_hi:[1,1,0] neg_lo:[0,0,1] neg_hi:[0,0,1]
    v_pk_fma_f32 v[130:131], v[130:131], s[6:7], v[6:7] op_sel:[0,1,0] op_sel_hi:[1,1,0] neg_lo:[1,0,0] neg_hi:[1,0,0]
    v_pk_fma_f32 v[148:149], v[132:133], s[6:7], v[4:5] op_sel:[0,1,0] op_sel_hi:[1,1,0] neg_lo:[0,0,1] neg_hi:[0,0,1]
    v_pk_fma_f32 v[132:133], v[132:133], s[6:7], v[6:7] op_sel:[0,1,0] op_sel_hi:[1,1,0] neg_lo:[1,0,0] neg_hi:[1,0,0]
    v_pk_fma_f32 v[150:151], v[134:135], s[6:7], v[4:5] op_sel:[0,1,0] op_sel_hi:[1,1,0] neg_lo:[0,0,1] neg_hi:[0,0,1]
    v_pk_fma_f32 v[134:135], v[134:135], s[6:7], v[6:7] op_sel:[0,1,0] op_sel_hi:[1,1,0] neg_lo:[1,0,0] neg_hi:[1,0,0]
    v_exp_f32 v136, v136
    v_exp_f32 v120, v120
    v_exp_f32 v137, v137
    v_exp_f32 v121, v121
    v_exp_f32 v138, v138
    v_exp_f32 v122, v122
    v_exp_f32 v139, v139
    v_exp_f32 v123, v123
    v_exp_f32 v140, v140
    v_exp_f32 v124, v124
    v_exp_f32 v141, v141
    v_exp_f32 v125, v125
    v_exp_f32 v142, v142
    v_exp_f32 v126, v126
    v_exp_f32 v143, v143
    v_exp_f32 v127, v127
    s_waitcnt vmcnt(0)
    s_barrier
    s_cmp_lg_u32 s3, 0
    s_cbranch_scc1 L_PC
    v_mov_b32 v85, s4
    s_mov_b32 exec_hi, 0
    s_mov_b32 exec_lo, 65535
    buffer_store_dword v85, v46, s[32:35], s17 offen sc1
    s_mov_b64 exec, -1
L_PC:
    s_xor_b32 s96, s95, 1310720
    s_add_u32 s82, s96, s90
    s_add_u32 m0, s83, 81920
    s_nop 0
    buffer_load_dwordx4 v26, s[44:47], s82 offen lds
    v_exp_f32 v144, v144
    v_exp_f32 v128, v128
    v_exp_f32 v145, v145
    v_exp_f32 v129, v129
    s_xor_b32 s96, s95, 1441792
    s_add_u32 s82, s96, s90
    s_add_u32 m0, s83, 90112
    s_nop 0
    buffer_load_dwordx4 v26, s[44:47], s82 offen lds
    v_exp_f32 v146, v146
    v_exp_f32 v130, v130
    v_exp_f32 v147, v147
    v_exp_f32 v131, v131
    s_xor_b32 s96, s95, 1572864
    s_add_u32 s82, s96, s90
    s_add_u32 m0, s83, 98304
    s_nop 0
    buffer_load_dwordx4 v26, s[44:47], s82 offen lds
    v_exp_f32 v148, v148
    v_exp_f32 v132, v132
    v_exp_f32 v149, v149
    v_exp_f32 v133, v133
    s_xor_b32 s96, s95, 1703936
    s_add_u32 s82, s96, s90
    s_add_u32 m0, s83, 106496
    s_nop 0
    buffer_load_dwordx4 v26, s[44:47], s82 offen lds
    v_exp_f32 v150, v150
    v_exp_f32 v134, v134
    v_exp_f32 v151, v151
    v_exp_f32 v135, v135
    s_lshl4_add_u32 s96, s11, s10
    s_lshl_b32 s97, s96, 14
    s_lshl_b32 s98, s3, 7
    s_add_u32 s99, s97, s98
    s_add_u32 s13, s99, 25165824
    s_add_u32 s14, s13, 8192
    s_lshl4_add_u32 s96, s11, s10
    s_lshl_b32 s97, s96, 10
    s_lshl_b32 s98, s3, 7
    s_add_u32 s99, s97, s98
    s_add_u32 s15, s99, 29360128
    s_add_u32 s17, s17, 3072
    s_load_dwordx2 s[24:25], s[32:33], s92 offset:512 glc
    s_xor_b32 s96, s95, 1835008
    s_add_u32 s82, s96, s90
    s_add_u32 m0, s83, 114688
    s_nop 0
    buffer_load_dwordx4 v26, s[44:47], s82 offen lds
    v_pk_add_f32 v[8:9], v[136:137], v[138:139]
    v_pk_add_f32 v[10:11], v[120:121], v[122:123]
    v_pk_add_f32 v[8:9], v[8:9], v[140:141]
    v_pk_add_f32 v[10:11], v[10:11], v[124:125]
    v_pk_add_f32 v[8:9], v[8:9], v[142:143]
    v_pk_add_f32 v[10:11], v[10:11], v[126:127]
    v_pk_add_f32 v[8:9], v[8:9], v[144:145]
    v_pk_add_f32 v[10:11], v[10:11], v[128:129]
    v_pk_add_f32 v[8:9], v[8:9], v[146:147]
    v_pk_add_f32 v[10:11], v[10:11], v[130:131]
    v_pk_add_f32 v[8:9], v[8:9], v[148:149]
    v_pk_add_f32 v[10:11], v[10:11], v[132:133]
    v_pk_add_f32 v[8:9], v[8:9], v[150:151]
    v_pk_add_f32 v[10:11], v[10:11], v[134:135]
    s_xor_b32 s96, s95, 1966080
    s_add_u32 s82, s96, s90
    s_add_u32 m0, s83, 122880
    s_nop 0
    buffer_load_dwordx4 v26, s[44:47], s82 offen lds
    v_add_f32 v6, v8, v9
    v_add_f32 v7, v10, v11
    v_add_f32 v4, v8, v9
    v_add_f32 v5, v10, v11
    s_nop 0
    v_permlane32_swap_b32 v4, v6
    v_permlane32_swap_b32 v5, v7
    v_pk_add_f32 v[4:5], v[4:5], v[6:7]
    v_rcp_f32 v4, v4
    v_rcp_f32 v5, v5
    s_nop 0
    v_pk_mul_f32 v[136:137], v[136:137], v[4:5] op_sel_hi:[1,0]
    v_pk_mul_f32 v[120:121], v[4:5], v[120:121] op_sel:[1,0]
    v_pk_mul_f32 v[138:139], v[138:139], v[4:5] op_sel_hi:[1,0]
    v_pk_mul_f32 v[122:123], v[4:5], v[122:123] op_sel:[1,0]
    v_pk_mul_f32 v[140:141], v[140:141], v[4:5] op_sel_hi:[1,0]
    s_add_u32 s82, s95, s90
    s_mov_b32 m0, s83
    s_nop 0
    buffer_load_dwordx4 v26, s[44:47], s82 offen lds
    v_pk_mul_f32 v[124:125], v[4:5], v[124:125] op_sel:[1,0]
    v_pk_mul_f32 v[142:143], v[142:143], v[4:5] op_sel_hi:[1,0]
    v_pk_mul_f32 v[126:127], v[4:5], v[126:127] op_sel:[1,0]
    v_pk_mul_f32 v[144:145], v[144:145], v[4:5] op_sel_hi:[1,0]
    v_pk_mul_f32 v[128:129], v[4:5], v[128:129] op_sel:[1,0]
    v_pk_mul_f32 v[146:147], v[146:147], v[4:5] op_sel_hi:[1,0]
    v_pk_mul_f32 v[130:131], v[4:5], v[130:131] op_sel:[1,0]
    v_pk_mul_f32 v[148:149], v[148:149], v[4:5] op_sel_hi:[1,0]
    v_pk_mul_f32 v[132:133], v[4:5], v[132:133] op_sel:[1,0]
    v_pk_mul_f32 v[150:151], v[150:151], v[4:5] op_sel_hi:[1,0]
    v_pk_mul_f32 v[134:135], v[4:5], v[134:135] op_sel:[1,0]
    v_cvt_pk_bf16_f32 v152, v136, v137
    v_cvt_pk_bf16_f32 v153, v138, v139
    v_cvt_pk_bf16_f32 v154, v140, v141
    s_xor_b32 s96, s95, 131072
    s_add_u32 s82, s96, s90
    s_add_u32 m0, s83, 8192
    s_nop 0
    buffer_load_dwordx4 v26, s[44:47], s82 offen lds
    v_cvt_pk_bf16_f32 v155, v142, v143
    v_cvt_pk_bf16_f32 v156, v144, v145
    v_cvt_pk_bf16_f32 v157, v146, v147
    v_cvt_pk_bf16_f32 v158, v148, v149
    v_cvt_pk_bf16_f32 v159, v150, v151
    v_cvt_pk_bf16_f32 v160, v120, v121
    v_cvt_pk_bf16_f32 v161, v122, v123
    v_cvt_pk_bf16_f32 v162, v124, v125
    v_cvt_pk_bf16_f32 v163, v126, v127
    v_cvt_pk_bf16_f32 v164, v128, v129
    v_cvt_pk_bf16_f32 v165, v130, v131
    v_cvt_pk_bf16_f32 v166, v132, v133
    v_cvt_pk_bf16_f32 v167, v134, v135
    s_branch SCHK_20
SPOLL_19:
    s_load_dwordx2 s[24:25], s[32:33], s92 offset:512 glc
SCHK_20:
    s_add_u32 s5, s5, 1
    s_cmp_ge_u32 s5, 200000
    s_waitcnt lgkmcnt(0)
    s_cbranch_scc1 SDONE_21
    s_cmp_lg_u32 s24, s4
    s_cbranch_scc1 SPOLL_19
    s_cmp_lg_u32 s25, s4
    s_cbranch_scc1 SPOLL_19
SDONE_21:
    s_barrier
    buffer_load_dwordx4 v[184:187], v47, s[32:35], s13 offen sc1
    buffer_load_dwordx4 v[188:191], v47, s[32:35], s14 offen sc1
    buffer_load_dwordx4 v[192:195], v2, s[32:35], s16 offen sc1
    s_lshl_b32 s19, s12, 7
    v_and_b32 v32, 3, v1
    v_lshl_add_u32 v32, v32, 1, s19
    v_lshrrev_b32 v28, 5, v1
    v_lshl_add_u32 v32, v28, 3, v32
    v_bfe_u32 v28, v1, 4, 1
    v_lshl_add_u32 v32, v28, 4, v32
    v_bfe_u32 v28, v1, 2, 2
    v_lshl_add_u32 v32, v28, 5, v32
    global_load_ushort v32, v32, s[78:79]
    s_lshl_b32 s96, s3, 5
    s_add_u32 s14, s96, 155648
    v_and_b32 v6, 3, v1
    v_lshl_add_u32 v6, v6, 3, s14
    v_lshrrev_b32 v9, 5, v1
    v_lshl_add_u32 v6, v9, 2, v6
    s_lshl_b32 s96, s3, 10
    s_add_u32 s14, s96, 147456
    v_and_b32 v5, 15, v1
    v_lshl_add_u32 v5, v5, 4, s14
    v_lshrrev_b32 v9, 5, v1
    v_lshl_add_u32 v5, v9, 9, v5
    v_bfe_u32 v9, v1, 4, 1
    v_lshl_add_u32 v5, v9, 3, v5
    s_lshl_b32 s96, s76, 7
    s_add_u32 s14, s96, 155648
    v_lshrrev_b32 v7, 5, v1
    v_lshl_add_u32 v7, v7, 4, s14
    s_lshl_b32 s96, s76, 12
    s_add_u32 s14, s96, 147456
    v_add_u32 v84, s14, v2
    s_cmp_lt_u32 s3, 4
    s_cbranch_scc1 L_HG1
    v_lshlrev_b32 v8, 16, v88
    v_and_b32 v9, s6, v88
    v_pk_mul_f32 v[196:197], v[36:37], v[8:9] op_sel:[0,0] op_sel_hi:[0,1]
    v_lshlrev_b32 v10, 16, v89
    v_and_b32 v11, s6, v89
    v_pk_mul_f32 v[198:199], v[36:37], v[10:11] op_sel:[0,0] op_sel_hi:[0,1]
    v_lshlrev_b32 v8, 16, v90
    v_and_b32 v9, s6, v90
    v_pk_mul_f32 v[200:201], v[36:37], v[8:9] op_sel:[0,0] op_sel_hi:[0,1]
    v_lshlrev_b32 v10, 16, v91
    v_and_b32 v11, s6, v91
    v_pk_mul_f32 v[202:203], v[36:37], v[10:11] op_sel:[0,0] op_sel_hi:[0,1]
    v_lshlrev_b32 v8, 16, v92
    v_and_b32 v9, s6, v92
    v_pk_fma_f32 v[196:197], v[36:37], v[8:9], v[196:197] op_sel:[1,0,0] op_sel_hi:[1,1,1]
    v_lshlrev_b32 v10, 16, v93
    v_and_b32 v11, s6, v93
    v_pk_fma_f32 v[198:199], v[36:37], v[10:11], v[198:199] op_sel:[1,0,0] op_sel_hi:[1,1,1]
    v_lshlrev_b32 v8, 16, v94
    v_and_b32 v9, s6, v94
    v_pk_fma_f32 v[200:201], v[36:37], v[8:9], v[200:201] op_sel:[1,0,0] op_sel_hi:[1,1,1]
    v_lshlrev_b32 v10, 16, v95
    v_and_b32 v11, s6, v95
    v_pk_fma_f32 v[202:203], v[36:37], v[10:11], v[202:203] op_sel:[1,0,0] op_sel_hi:[1,1,1]
    v_lshlrev_b32 v8, 16, v96
    v_and_b32 v9, s6, v96
    v_pk_fma_f32 v[196:197], v[38:39], v[8:9], v[196:197] op_sel:[0,0,0] op_sel_hi:[0,1,1]
    v_lshlrev_b32 v10, 16, v97
    v_and_b32 v11, s6, v97
    v_pk_fma_f32 v[198:199], v[38:39], v[10:11], v[198:199] op_sel:[0,0,0] op_sel_hi:[0,1,1]
    v_lshlrev_b32 v8, 16, v98
    v_and_b32 v9, s6, v98
    v_pk_fma_f32 v[200:201], v[38:39], v[8:9], v[200:201] op_sel:[0,0,0] op_sel_hi:[0,1,1]
    v_lshlrev_b32 v10, 16, v99
    v_and_b32 v11, s6, v99
    v_pk_fma_f32 v[202:203], v[38:39], v[10:11], v[202:203] op_sel:[0,0,0] op_sel_hi:[0,1,1]
    v_lshlrev_b32 v8, 16, v100
    v_and_b32 v9, s6, v100
    v_pk_fma_f32 v[196:197], v[38:39], v[8:9], v[196:197] op_sel:[1,0,0] op_sel_hi:[1,1,1]
    v_lshlrev_b32 v10, 16, v101
    v_and_b32 v11, s6, v101
    v_pk_fma_f32 v[198:199], v[38:39], v[10:11], v[198:199] op_sel:[1,0,0] op_sel_hi:[1,1,1]
    v_lshlrev_b32 v8, 16, v102
    v_and_b32 v9, s6, v102
    v_pk_fma_f32 v[200:201], v[38:39], v[8:9], v[200:201] op_sel:[1,0,0] op_sel_hi:[1,1,1]
    v_lshlrev_b32 v10, 16, v103
    v_and_b32 v11, s6, v103
    v_pk_fma_f32 v[202:203], v[38:39], v[10:11], v[202:203] op_sel:[1,0,0] op_sel_hi:[1,1,1]
    v_lshlrev_b32 v8, 16, v104
    v_and_b32 v9, s6, v104
    v_pk_fma_f32 v[196:197], v[40:41], v[8:9], v[196:197] op_sel:[0,0,0] op_sel_hi:[0,1,1]
    v_lshlrev_b32 v10, 16, v105
    v_and_b32 v11, s6, v105
    v_pk_fma_f32 v[198:199], v[40:41], v[10:11], v[198:199] op_sel:[0,0,0] op_sel_hi:[0,1,1]
    v_lshlrev_b32 v8, 16, v106
    v_and_b32 v9, s6, v106
    v_pk_fma_f32 v[200:201], v[40:41], v[8:9], v[200:201] op_sel:[0,0,0] op_sel_hi:[0,1,1]
    v_lshlrev_b32 v10, 16, v107
    v_and_b32 v11, s6, v107
    v_pk_fma_f32 v[202:203], v[40:41], v[10:11], v[202:203] op_sel:[0,0,0] op_sel_hi:[0,1,1]
    v_lshlrev_b32 v8, 16, v108
    v_and_b32 v9, s6, v108
    v_pk_fma_f32 v[196:197], v[40:41], v[8:9], v[196:197] op_sel:[1,0,0] op_sel_hi:[1,1,1]
    v_lshlrev_b32 v10, 16, v109
    v_and_b32 v11, s6, v109
    v_pk_fma_f32 v[198:199], v[40:41], v[10:11], v[198:199] op_sel:[1,0,0] op_sel_hi:[1,1,1]
    v_lshlrev_b32 v8, 16, v110
    v_and_b32 v9, s6, v110
    v_pk_fma_f32 v[200:201], v[40:41], v[8:9], v[200:201] op_sel:[1,0,0] op_sel_hi:[1,1,1]
    v_lshlrev_b32 v10, 16, v111
    v_and_b32 v11, s6, v111
    v_pk_fma_f32 v[202:203], v[40:41], v[10:11], v[202:203] op_sel:[1,0,0] op_sel_hi:[1,1,1]
    v_lshlrev_b32 v8, 16, v112
    v_and_b32 v9, s6, v112
    v_pk_fma_f32 v[196:197], v[42:43], v[8:9], v[196:197] op_sel:[0,0,0] op_sel_hi:[0,1,1]
    v_lshlrev_b32 v10, 16, v113
    v_and_b32 v11, s6, v113
    v_pk_fma_f32 v[198:199], v[42:43], v[10:11], v[198:199] op_sel:[0,0,0] op_sel_hi:[0,1,1]
    v_lshlrev_b32 v8, 16, v114
    v_and_b32 v9, s6, v114
    v_pk_fma_f32 v[200:201], v[42:43], v[8:9], v[200:201] op_sel:[0,0,0] op_sel_hi:[0,1,1]
    v_lshlrev_b32 v10, 16, v115
    v_and_b32 v11, s6, v115
    v_pk_fma_f32 v[202:203], v[42:43], v[10:11], v[202:203] op_sel:[0,0,0] op_sel_hi:[0,1,1]
    v_lshlrev_b32 v8, 16, v116
    v_and_b32 v9, s6, v116
    v_pk_fma_f32 v[196:197], v[42:43], v[8:9], v[196:197] op_sel:[1,0,0] op_sel_hi:[1,1,1]
    v_lshlrev_b32 v10, 16, v117
    v_and_b32 v11, s6, v117
    v_pk_fma_f32 v[198:199], v[42:43], v[10:11], v[198:199] op_sel:[1,0,0] op_sel_hi:[1,1,1]
    v_lshlrev_b32 v8, 16, v118
    v_and_b32 v9, s6, v118
    v_pk_fma_f32 v[200:201], v[42:43], v[8:9], v[200:201] op_sel:[1,0,0] op_sel_hi:[1,1,1]
    v_lshlrev_b32 v10, 16, v119
    v_and_b32 v11, s6, v119
    v_pk_fma_f32 v[202:203], v[42:43], v[10:11], v[202:203] op_sel:[1,0,0] op_sel_hi:[1,1,1]
    v_permlane32_swap_b32 v196, v200
    v_permlane32_swap_b32 v197, v201
    v_permlane32_swap_b32 v198, v202
    v_permlane32_swap_b32 v199, v203
    v_add_f32 v196, v196, v200
    v_add_f32 v197, v197, v201
    v_add_f32 v198, v198, v202
    v_add_f32 v199, v199, v203
    s_nop 0
    v_permlane16_swap_b32 v196, v198
    v_permlane16_swap_b32 v197, v199
    v_add_f32 v196, v196, v198
    v_add_f32 v197, v197, v199
    s_nop 0
    v_add_f32_dpp v196, v196, v196 row_ror:8 row_mask:0xf bank_mask:0xf
    v_add_f32_dpp v197, v197, v197 row_ror:8 row_mask:0xf bank_mask:0xf
    s_nop 1
    v_mov_b32_dpp v196, v197 quad_perm:[0,1,2,3] row_mask:0xf bank_mask:0xc
    ds_write_b32 v252, v196 offset:9984
L_HG1:
    s_waitcnt vmcnt(2)
    v_pk_add_f32 v[184:185], v[184:185], v[188:189]
    v_pk_add_f32 v[186:187], v[186:187], v[190:191]
    s_nop 1
    v_permlane32_swap_b32 v184, v186
    v_permlane32_swap_b32 v185, v187
    v_pk_add_f32 v[184:185], v[184:185], v[186:187]
    s_nop 1
    v_add_f32_dpp v184, v184, v184 row_ror:8 row_mask:0xf bank_mask:0xf
    v_add_f32_dpp v185, v185, v185 row_ror:8 row_mask:0xf bank_mask:0xf
    v_mov_b32 v186, v184
    v_mov_b32 v187, v185
    s_nop 0
    v_permlane16_swap_b32 v184, v186
    v_permlane16_swap_b32 v185, v187
    v_pk_add_f32 v[184:185], v[184:185], v[186:187]
    v_cvt_pk_bf16_f32 v184, v184, v185
    v_mov_b32 v185, s4
    s_mov_b32 exec_lo, 0xff
    s_mov_b32 exec_hi, 0xff
    buffer_store_dwordx2 v[184:185], v48, s[32:35], s15 offen sc1
    s_mov_b64 exec, -1
    s_waitcnt lgkmcnt(0)
    s_barrier
    s_cmp_lg_u32 s3, 0
    s_cbranch_scc1 L_PC2
    v_mov_b32 v85, s4
    s_mov_b32 exec_hi, 0
    s_mov_b32 exec_lo, 65535
    buffer_store_dword v85, v46, s[32:35], s17 offen sc1
    s_mov_b64 exec, -1
L_PC2:
L_PAD7:
    s_cbranch_execz L_RET7
    s_cmp_lg_u32 s3, 3
    s_cbranch_scc1 L_M2F
    ds_read_b128 v[196:199], v251 offset:11008
    s_lshr_b32 s96, s8, 2
    s_lshl1_add_u32 s97, s9, s96
    s_and_b32 s98, s8, 3
    s_lshl2_add_u32 s99, s97, s98
    s_lshl_b32 s96, s99, 9
    s_add_u32 s18, s96, 131072
    s_waitcnt lgkmcnt(0)
    v_add_f32 v196, v196, v197
    v_add_f32 v198, v198, v199
    v_mov_b32 v197, s4
    v_add_f32 v196, v196, v198
    buffer_store_dwordx2 v[196:197], v250, s[32:35], s18 offen sc1
L_M2F:
    s_waitcnt vmcnt(2)
    s_xor_b32 s96, s95, 262144
    s_add_u32 s82, s96, s90
    s_add_u32 m0, s83, 16384
    s_nop 0
    buffer_load_dwordx4 v26, s[44:47], s82 offen lds
    v_permlane32_swap_b32 v192, v194
    v_permlane32_swap_b32 v193, v195
    v_pk_add_f32 v[192:193], v[192:193], v[194:195]
    s_nop 1
    v_add_f32_dpp v192, v192, v192 row_ror:4 row_mask:0xf bank_mask:0xf
    s_xor_b32 s96, s95, 393216
    s_add_u32 s82, s96, s90
    s_add_u32 m0, s83, 24576
    s_nop 0
    buffer_load_dwordx4 v26, s[44:47], s82 offen lds
    v_add_f32_dpp v193, v193, v193 row_ror:4 row_mask:0xf bank_mask:0xf
    v_add_f32_dpp v192, v192, v192 row_ror:8 row_mask:0xf bank_mask:0xf
    s_nop 0
    v_add_f32_dpp v193, v193, v193 row_ror:8 row_mask:0xf bank_mask:0xf
    s_xor_b32 s96, s95, 524288
    s_add_u32 s82, s96, s90
    s_add_u32 m0, s83, 32768
    s_nop 0
    buffer_load_dwordx4 v26, s[44:47], s82 offen lds
    v_mov_b32 v194, v192
    v_mov_b32 v195, v193
    s_nop 0
    v_permlane16_swap_b32 v192, v194
    s_xor_b32 s96, s95, 655360
    s_add_u32 s82, s96, s90
    s_add_u32 m0, s83, 40960
    s_nop 0
    buffer_load_dwordx4 v26, s[44:47], s82 offen lds
    v_permlane16_swap_b32 v193, v195
    v_pk_add_f32 v[192:193], v[192:193], v[194:195]
    v_cvt_pk_bf16_f32 v192, v192, v193
    ds_write_b32 v6, v192
    s_waitcnt lgkmcnt(0)
    s_barrier
    ds_read_b128 v[196:199], v7
    ds_read_b128 v[200:203], v7 offset:32
    ds_read_b128 v[204:207], v7 offset:64
    ds_read_b128 v[208:211], v7 offset:96
    s_lshr_b32 s96, s8, 2
    s_lshl1_add_u32 s97, s9, s96
    s_and_b32 s98, s8, 3
    s_lshl2_add_u32 s99, s97, s98
    s_lshl_b32 s96, s99, 9
    s_add_u32 s18, s96, 131072
    s_waitcnt lgkmcnt(0)
    s_lshl3_add_u32 s96, s11, s3
    s_lshl_b32 s97, s96, 11
    s_add_u32 s13, s97, 29360128
    s_load_dwordx2 s[24:25], s[32:33], s92 offset:3584 glc
    v_mfma_f32_32x32x16_bf16 v[136:151], v[196:199], v[152:155], 0
    v_mfma_f32_32x32x16_bf16 v[136:151], v[200:203], v[156:159], v[136:151]
    v_mfma_f32_32x32x16_bf16 v[136:151], v[204:207], v[160:163], v[136:151]
    v_mfma_f32_32x32x16_bf16 v[136:151], v[208:211], v[164:167], v[136:151]
    s_lshr_b32 s96, s3, 2
    s_lshl_b32 s97, s96, 15
    s_and_b32 s98, s3, 3
    s_lshl_b32 s99, s98, 5
    s_add_u32 s19, s97, s99
    v_lshrrev_b32 v34, 4, v1
    v_lshlrev_b32 v34, 13, v34
    v_bfe_u32 v9, v1, 2, 2
    v_lshl_add_u32 v34, v9, 7, v34
    v_bfe_u32 v9, v1, 3, 2
    v_lshl_add_u32 v34, v9, 5, v34
    v_and_b32 v9, 3, v1
    v_lshl_add_u32 v34, v9, 3, v34
    v_xor_b32 v34, s19, v34
    s_lshl_b32 s96, s75, 11
    s_add_u32 s19, s96, 13631488
    v_and_b32 v52, 7, v1
    v_lshl_add_u32 v52, v52, 4, s19
    v_lshrrev_b32 v9, 4, v1
    v_lshl_add_u32 v52, v9, 9, v52
    v_and_b32 v53, 15, v1
    v_lshlrev_b32 v53, 9, v53
    v_add_u32 v53, 13631744, v53
    s_lshl_b32 s96, s74, 13
    s_add_u32 s72, s96, 20971520
    s_lshl3_add_u32 s96, s75, s3
    s_lshl_b32 s97, s96, 8
    s_add_u32 s73, s97, s72
    s_lshl3_add_u32 s96, s21, s3
    s_lshl4_add_u32 s97, s96, s12
    s_lshl_b32 s98, s97, 8
    s_add_u32 s86, s98, 12582912
    s_and_b32 s96, s12, 1
    s_lshr_b32 s97, s21, 2
    s_and_b32 s98, s21, 3
    s_lshl_b32 s99, s98, 6
    s_lshl1_add_u32 s98, s97, s99
    s_lshl_b32 s97, s98, 12
    s_lshr_b32 s99, s12, 1
    s_lshl_b32 s98, s99, 6
    s_add_u32 s99, s97, s98
    s_lshl2_add_u32 s97, s96, s99
    s_add_u32 s98, s97, 1048576
    s_add_u32 s87, s98, 1536
    s_lshl3_add_u32 s96, s21, s3
    s_lshl_b32 s97, s96, 15
    s_lshl_b32 s98, s12, 7
    s_add_u32 s70, s97, s98
    s_add_u32 s71, s70, 16384
    v_cvt_pk_bf16_f32 v136, 0, v136
    v_add_f32 v136, 0x358637bd, v136
    v_cvt_pk_bf16_f32 v136, 0, v136
    v_rcp_f32 v136, v136
    s_branch SCHK_23
SPOLL_22:
    s_load_dwordx2 s[24:25], s[32:33], s92 offset:3584 glc
SCHK_23:
    s_add_u32 s5, s5, 1
    s_cmp_ge_u32 s5, 200000
    s_waitcnt lgkmcnt(0)
    s_cbranch_scc1 SDONE_24
    s_cmp_lg_u32 s24, s4
    s_cbranch_scc1 SPOLL_22
    s_cmp_lg_u32 s25, s4
    s_cbranch_scc1 SPOLL_22
SDONE_24:
    buffer_load_dwordx4 v[228:231], v2, s[32:35], s13 offen sc1
    buffer_load_dwordx4 v[232:235], v2, s[32:35], s13 offen offset:1024 sc1
    s_lshl_b32 s19, s3, 6
    v_bfe_u32 v35, v1, 2, 1
    v_lshlrev_b32 v35, 9, v35
    v_bfe_u32 v9, v1, 3, 1
    v_lshl_add_u32 v35, v9, 12, v35
    v_lshrrev_b32 v9, 5, v1
    v_lshl_add_u32 v35, v9, 11, v35
    v_bfe_u32 v9, v1, 2, 2
    v_lshl_add_u32 v35, v9, 6, v35
    v_bfe_u32 v9, v1, 4, 1
    v_lshl_add_u32 v35, v9, 5, v35
    v_and_b32 v9, 3, v1
    v_lshl_add_u32 v35, v9, 3, v35
    v_xor_b32 v35, s19, v35
    v_add_u32 v35, 65536, v35
    s_waitcnt vmcnt(0)
    v_bitop3_b32 v4, v229, v231, s4 bitop3:0x7e
    v_bitop3_b32 v4, v4, v233, s4 bitop3:0xf6
    v_bitop3_b32 v4, v4, v235, s4 bitop3:0xf6
    v_cmp_ne_u32 vcc, 0, v4
    s_cbranch_vccz TOK_26
POLL_27:
    buffer_load_dwordx4 v[228:231], v2, s[32:35], s13 offen sc1
    buffer_load_dwordx4 v[232:235], v2, s[32:35], s13 offen offset:1024 sc1
    s_waitcnt vmcnt(0)
    v_bitop3_b32 v4, v229, v231, s4 bitop3:0x7e
    v_bitop3_b32 v4, v4, v233, s4 bitop3:0xf6
    v_bitop3_b32 v4, v4, v235, s4 bitop3:0xf6
    v_cmp_ne_u32 vcc, 0, v4
    s_cbranch_vccz PDONE_28
    s_add_u32 s5, s5, 1
    s_cmp_lt_u32 s5, 200000
    s_cbranch_scc1 POLL_27
PDONE_28:
TOK_26:
    ds_write2_b32 v5, v228, v230 offset0:0 offset1:1
    ds_write2_b32 v5, v232, v234 offset0:64 offset1:65
    s_waitcnt lgkmcnt(0)
    s_barrier
    ds_read_b128 v[212:215], v84
    ds_read_b128 v[216:219], v84 offset:1024
    ds_read_b128 v[220:223], v84 offset:2048
    ds_read_b128 v[224:227], v84 offset:3072
    s_lshl_b32 s96, s77, 1
    s_lshl3_add_u32 s97, s10, s96
    s_lshl_b32 s98, s97, 5
    s_lshl1_add_u32 s99, s11, s98
    s_add_u32 s96, s99, s76
    s_lshl_b32 s97, s96, 10
    s_add_u32 s13, s97, 8388608
    v_and_b32 v47, 15, v1
    v_lshlrev_b32 v47, 4, v47
    v_bfe_u32 v9, v1, 4, 1
    v_lshl_add_u32 v47, v9, 15, v47
    v_lshrrev_b32 v9, 5, v1
    v_lshl_add_u32 v47, v9, 8, v47
    s_waitcnt lgkmcnt(3)
    v_mfma_f32_32x32x16_bf16 v[120:135], v[212:215], v[152:155], 0
    s_waitcnt lgkmcnt(2)
    v_mfma_f32_32x32x16_bf16 v[120:135], v[216:219], v[156:159], v[120:135]
    s_waitcnt lgkmcnt(1)
    v_mfma_f32_32x32x16_bf16 v[120:135], v[220:223], v[160:163], v[120:135]
    s_waitcnt lgkmcnt(0)
    v_mfma_f32_32x32x16_bf16 v[120:135], v[224:227], v[164:167], v[120:135]
    s_lshr_b32 s96, s3, 1
    s_lshl4_add_u32 s97, s96, s12
    s_lshl_b32 s98, s97, 11
    s_and_b32 s99, s3, 1
    s_lshl_b32 s96, s99, 10
    s_add_u32 s97, s98, s96
    s_add_u32 s18, s97, 131072
    buffer_load_dwordx4 v[28:31], v2, s[32:35], s18 offen sc1
    s_nop 3
    v_cvt_pk_bf16_f32 v120, 0, v120
    v_cvt_pk_bf16_f32 v121, 0, v121
    v_cvt_pk_bf16_f32 v122, 0, v122
    v_cvt_pk_bf16_f32 v123, 0, v123
    v_cvt_pk_bf16_f32 v124, 0, v124
    v_cvt_pk_bf16_f32 v125, 0, v125
    v_cvt_pk_bf16_f32 v126, 0, v126
    v_cvt_pk_bf16_f32 v127, 0, v127
    v_pk_mul_f32 v[120:121], v[120:121], v[136:137] op_sel_hi:[1,0]
    v_pk_mul_f32 v[122:123], v[122:123], v[136:137] op_sel_hi:[1,0]
    v_pk_mul_f32 v[124:125], v[124:125], v[136:137] op_sel_hi:[1,0]
    v_pk_mul_f32 v[126:127], v[126:127], v[136:137] op_sel_hi:[1,0]
    v_cvt_pk_bf16_f32 v168, v120, v121
    v_cvt_pk_bf16_f32 v169, v122, v123
    v_cvt_pk_bf16_f32 v170, v124, v125
    v_cvt_pk_bf16_f32 v171, v126, v127
    buffer_store_dwordx4 v[168:171], v47, s[32:35], s13 offen sc1
    v_cvt_pk_bf16_f32 v128, 0, v128
    v_cvt_pk_bf16_f32 v129, 0, v129
    v_cvt_pk_bf16_f32 v130, 0, v130
    v_cvt_pk_bf16_f32 v131, 0, v131
    v_cvt_pk_bf16_f32 v132, 0, v132
    v_cvt_pk_bf16_f32 v133, 0, v133
    v_cvt_pk_bf16_f32 v134, 0, v134
    v_cvt_pk_bf16_f32 v135, 0, v135
    v_pk_mul_f32 v[128:129], v[128:129], v[136:137] op_sel_hi:[1,0]
    v_pk_mul_f32 v[130:131], v[130:131], v[136:137] op_sel_hi:[1,0]
    v_pk_mul_f32 v[132:133], v[132:133], v[136:137] op_sel_hi:[1,0]
    v_pk_mul_f32 v[134:135], v[134:135], v[136:137] op_sel_hi:[1,0]
    v_cvt_pk_bf16_f32 v172, v128, v129
    v_cvt_pk_bf16_f32 v173, v130, v131
    v_cvt_pk_bf16_f32 v174, v132, v133
    v_cvt_pk_bf16_f32 v175, v134, v135
    buffer_store_dwordx4 v[172:175], v47, s[32:35], s13 offen offset:512 sc1
    v_bfe_u32 v36, v1, 2, 2
    v_lshlrev_b32 v36, 7, v36
    v_lshrrev_b32 v9, 4, v1
    v_lshl_add_u32 v36, v9, 10, v36
    v_and_b32 v9, 1, v1
    v_lshl_add_u32 v36, v9, 4, v36
    v_bfe_u32 v9, v1, 1, 1
    v_lshl_add_u32 v36, v9, 3, v36
    v_bfe_u32 v9, v1, 3, 2
    v_lshl_add_u32 v36, v9, 5, v36
    s_and_b32 s96, s9, 1
    s_lshl_b32 s97, s96, 2
    s_xor_b32 s98, s3, s97
    s_lshl_b32 s17, s98, 12
    s_lshl_b32 s96, s17, 2
    s_lshr_b32 s97, s95, 4
    s_xor_b32 s14, s96, s97
    v_add_u32 v36, s14, v36
    v_xor_b32 v37, 32, v36
    v_xor_b32 v38, 64, v36
    v_xor_b32 v39, 96, v36
    v_and_b32 v5, 7, v1
    v_lshlrev_b32 v5, 15, v5
    v_bfe_u32 v9, v1, 3, 1
    v_lshl_add_u32 v5, v9, 12, v5
    s_and_b32 s96, s11, 1
    s_lshr_b32 s97, s10, 2
    s_and_b32 s98, s10, 3
    s_lshl_b32 s99, s98, 6
    s_lshl1_add_u32 s98, s97, s99
    s_lshl_b32 s97, s98, 12
    s_lshr_b32 s99, s11, 1
    s_lshl_b32 s98, s99, 6
    s_add_u32 s99, s97, s98
    s_lshl2_add_u32 s97, s96, s99
    s_add_u32 s98, s97, 1048576
    s_add_u32 s15, s98, 1024
    v_lshlrev_b32 v152, 16, v12
    v_and_b32 v153, s6, v12
    v_lshlrev_b32 v154, 16, v13
    v_and_b32 v155, s6, v13
    v_lshlrev_b32 v156, 16, v14
    v_and_b32 v157, s6, v14
    v_lshlrev_b32 v158, 16, v15
    v_and_b32 v159, s6, v15
    v_lshlrev_b32 v160, 16, v16
    v_and_b32 v161, s6, v16
    v_lshlrev_b32 v162, 16, v17
    v_and_b32 v163, s6, v17
    v_lshlrev_b32 v164, 16, v18
    v_and_b32 v165, s6, v18
    v_lshlrev_b32 v166, 16, v19
    v_and_b32 v167, s6, v19
    s_lshl3_add_u32 s96, s21, s3
    s_lshl_b32 s97, s96, 15
    s_add_u32 s19, s97, 8388608
    s_and_b32 s96, s3, 1
    s_lshl_b32 s14, s96, 1
    s_lshr_b32 s96, s3, 1
    s_lshl_b32 s97, s96, 10
    s_add_u32 s16, s97, 159744
    v_bfe_u32 v4, v1, 4, 1
    v_bfe_u32 v9, v1, 2, 1
    v_lshl_add_u32 v4, v9, 1, v4
    v_lshrrev_b32 v7, 5, v1
    v_lshl_add_u32 v7, v7, 0, s14
    v_xor_b32 v4, v4, v7
    v_lshl_add_u32 v4, v4, 2, s16
    v_and_b32 v7, 1, v1
    v_lshlrev_b32 v7, 5, v7
    v_bfe_u32 v9, v1, 3, 2
    v_lshl_add_u32 v7, v9, 6, v7
    v_bfe_u32 v9, v1, 2, 1
    v_lshl_add_u32 v7, v9, 8, v7
    v_bfe_u32 v9, v1, 1, 1
    v_lshl_add_u32 v7, v9, 9, v7
    v_add_u32 v4, v4, v7
    s_waitcnt vmcnt(2)
    v_bitop3_b32 v6, v29, v31, s4 bitop3:0x7e
    v_cmp_ne_u32 vcc, 0, v6
    s_cbranch_vccz L_MGOK
POLL_29:
    buffer_load_dwordx4 v[28:31], v2, s[32:35], s18 offen sc1
    s_waitcnt vmcnt(0)
    v_bitop3_b32 v6, v29, v31, s4 bitop3:0x7e
    v_cmp_ne_u32 vcc, 0, v6
    s_cbranch_vccz PDONE_30
    s_add_u32 s5, s5, 1
    s_cmp_lt_u32 s5, 200000
    s_cbranch_scc1 POLL_29
PDONE_30:
L_MGOK:
    ds_write2_b32 v4, v28, v30 offset0:0 offset1:4
    s_waitcnt vmcnt(0)
    s_waitcnt lgkmcnt(0)
    s_barrier
    s_cmp_lg_u32 s3, 0
    s_cbranch_scc1 L_PD
    v_mov_b32 v6, s4
    s_mov_b32 exec_hi, 0
    s_mov_b32 exec_lo, 65535
    buffer_store_dword v6, v5, s[32:35], s15 offen sc1
    s_mov_b64 exec, -1
L_PD:
    v_mov_b32 v236, -1
    v_mov_b32 v237, -1
    v_mov_b32 v238, -1
    v_mov_b32 v239, -1
    s_mov_b64 exec, 0xffff
    buffer_store_dwordx4 v[236:239], v2, s[32:35], s86 offen sc1
    s_mov_b64 exec, -1
    s_cmp_lg_u32 s3, 5
    s_cbranch_scc1 L_NOPO
    s_lshl_b32 s96, s21, 14
    s_lshl_b32 s97, s12, 9
    s_add_u32 s98, s96, s97
    s_add_u32 s16, s98, 13631488
    v_and_b32 v240, 31, v1
    v_lshlrev_b32 v240, 4, v240
    v_lshrrev_b32 v241, 5, v1
    v_lshl_add_u32 v240, v241, 13, v240
    buffer_store_dwordx4 v[236:239], v240, s[32:35], s16 offen sc1
L_NOPO:
    s_lshl_b32 s96, s2, 12
    s_lshr_b32 s97, s17, 6
    s_add_u32 s98, s96, s97
    s_add_u32 s99, s98, 1048576
    s_add_u32 s18, s99, 1024
    ds_read_b128 v[192:195], v251 offset:12288
    ds_read_b128 v[196:199], v251 offset:13312
    ds_read_b128 v[200:203], v251 offset:14336
    ds_read_b128 v[204:207], v251 offset:15360
    v_and_b32 v8, 3, v1
    v_lshlrev_b32 v8, 2, v8
    v_lshrrev_b32 v9, 5, v1
    v_lshl_add_u32 v8, v9, 4, v8
    v_bfe_u32 v9, v1, 4, 1
    v_lshl_add_u32 v8, v9, 5, v8
    v_bfe_u32 v9, v1, 2, 2
    v_lshl_add_u32 v8, v9, 6, v8
    v_add_u32 v8, 157184, v8
    s_lshl4_add_u32 s96, s21, s12
    s_lshl_b32 s97, s96, 6
    s_add_u32 s13, s97, 14155776
    v_lshlrev_b32 v10, 1, v1
    v_add_u32 v10, 157440, v10
    v_and_b32 v11, 3, v1
    v_lshlrev_b32 v11, 7, v11
    v_lshrrev_b32 v9, 4, v1
    v_lshl_add_u32 v11, v9, 5, v11
    v_add_u32 v11, 157440, v11
    s_waitcnt lgkmcnt(0)
    s_load_dwordx2 s[24:25], s[32:33], s18 offset:0 glc
    v_pk_add_f32 v[192:193], v[192:193], v[194:195]
    v_add_f32 v28, v192, v193
    v_pk_add_f32 v[196:197], v[196:197], v[198:199]
    v_add_f32 v29, v196, v197
    v_pk_add_f32 v[200:201], v[200:201], v[202:203]
    v_add_f32 v30, v200, v201
    v_pk_add_f32 v[204:205], v[204:205], v[206:207]
    v_add_f32 v31, v204, v205
    v_cvt_pk_bf16_f32 v28, 0, v28
    v_cvt_pk_bf16_f32 v29, 0, v29
    v_cvt_pk_bf16_f32 v30, 0, v30
    v_cvt_pk_bf16_f32 v31, 0, v31
    v_add_f32 v30, 1.0, v30
    v_lshlrev_b32 v32, 16, v32
    v_cvt_pk_bf16_f32 v30, 0, v30
    ds_write_b32 v8, v31
    v_mul_f32 v192, v30, v32
    v_cvt_pk_bf16_f32 v193, 0, v192
    v_sub_f32 v194, v192, v193
    v_add_f32_dpp v192, v192, v192 quad_perm:[1,0,3,2] row_mask:0xf bank_mask:0xf
    s_nop 1
    v_add_f32_dpp v192, v192, v192 quad_perm:[2,3,0,1] row_mask:0xf bank_mask:0xf
    s_nop 1
    v_add_f32_dpp v192, v192, v192 row_half_mirror row_mask:0xf bank_mask:0xf
    s_nop 1
    v_add_f32_dpp v192, v192, v192 row_ror:8 row_mask:0xf bank_mask:0xf
    v_mov_b32 v199, v192
    s_nop 1
    v_permlane16_swap_b32 v192, v199
    v_add_f32 v192, v192, v199
    v_mov_b32 v199, v192
    s_nop 1
    v_permlane32_swap_b32 v192, v199
    v_add_f32 v192, v192, v199
    v_mov_b32_dpp v196, v193 row_shl:1 row_mask:0xf bank_mask:0xf
    v_mov_b32_dpp v197, v194 row_shl:1 row_mask:0xf bank_mask:0xf
    v_mov_b32_dpp v198, v32 row_shl:1 row_mask:0xf bank_mask:0xf
    v_cvt_pk_bf16_f32 v196, v193, v196
    v_cvt_pk_bf16_f32 v197, v194, v197
    v_cvt_pk_bf16_f32 v198, v32, v198
    v_mov_b32 v193, s4
    v_mov_b32 v194, 0
    s_cmp_lg_u32 s3, 2
    s_cbranch_scc1 L_NOUP
    s_mov_b64 exec, 1
    buffer_store_dwordx2 v[192:193], v194, s[32:35], s13 offen sc1
    s_mov_b64 exec, -1
L_NOUP:
    v_mov_b32 v199, 0x3f803f80
    s_mov_b32 exec_lo, 0x55555555
    s_mov_b32 exec_hi, 0x55555555
    ds_write_b32 v10, v199 offset:0
    ds_write_b32 v10, v196 offset:128
    ds_write_b32 v10, v197 offset:256
    ds_write_b32 v10, v198 offset:384
    s_mov_b64 exec, -1
    ds_read_b128 v[184:187], v11
    ds_read_b128 v[188:191], v11 offset:16
    v_mov_b32 v42, v29
    v_mov_b32 v43, v31
    v_mov_b32 v33, v30
    v_mov_b32_dpp v136, v28 row_newbcast:0 row_mask:0xf bank_mask:0xf
    v_mov_b32_dpp v137, v28 row_newbcast:1 row_mask:0xf bank_mask:0xf
    v_mov_b32_dpp v138, v28 row_newbcast:2 row_mask:0xf bank_mask:0xf
    v_mov_b32_dpp v139, v28 row_newbcast:3 row_mask:0xf bank_mask:0xf
    v_mov_b32_dpp v140, v28 row_newbcast:4 row_mask:0xf bank_mask:0xf
    v_mov_b32_dpp v141, v28 row_newbcast:5 row_mask:0xf bank_mask:0xf
    v_mov_b32_dpp v142, v28 row_newbcast:6 row_mask:0xf bank_mask:0xf
    v_mov_b32_dpp v143, v28 row_newbcast:7 row_mask:0xf bank_mask:0xf
    v_mov_b32_dpp v144, v28 row_newbcast:8 row_mask:0xf bank_mask:0xf
    v_mov_b32_dpp v145, v28 row_newbcast:9 row_mask:0xf bank_mask:0xf
    v_mov_b32_dpp v146, v28 row_newbcast:10 row_mask:0xf bank_mask:0xf
    v_mov_b32_dpp v147, v28 row_newbcast:11 row_mask:0xf bank_mask:0xf
    v_mov_b32_dpp v148, v28 row_newbcast:12 row_mask:0xf bank_mask:0xf
    v_mov_b32_dpp v149, v28 row_newbcast:13 row_mask:0xf bank_mask:0xf
    v_mov_b32_dpp v150, v28 row_newbcast:14 row_mask:0xf bank_mask:0xf
    v_mov_b32_dpp v151, v28 row_newbcast:15 row_mask:0xf bank_mask:0xf
    v_mov_b32 v29, v5
    s_branch SCHK_32
SPOLL_31:
    s_load_dwordx2 s[24:25], s[32:33], s18 offset:0 glc
SCHK_32:
    s_add_u32 s5, s5, 1
    s_cmp_ge_u32 s5, 200000
    s_waitcnt lgkmcnt(0)
    s_cbranch_scc1 SDONE_33
    s_cmp_lg_u32 s24, s4
    s_cbranch_scc1 SPOLL_31
    s_cmp_lg_u32 s25, s4
    s_cbranch_scc1 SPOLL_31
SDONE_33:
    s_add_u32 s20, s17, s19
    buffer_load_dwordx4 v[224:227], v2, s[32:35], s20 offen sc1
    ds_read_b64_tr_b16 v[192:193], v36
    ds_read_b64_tr_b16 v[194:195], v36 offset:512
    ds_read_b64_tr_b16 v[196:197], v37
    ds_read_b64_tr_b16 v[198:199], v37 offset:512
    ds_read_b64_tr_b16 v[200:201], v38
    ds_read_b64_tr_b16 v[202:203], v38 offset:512
    ds_read_b64_tr_b16 v[204:205], v39
    ds_read_b64_tr_b16 v[206:207], v39 offset:512
    ds_read_b64_tr_b16 v[208:209], v36 offset:4096
    ds_read_b64_tr_b16 v[210:211], v36 offset:4608
    ds_read_b64_tr_b16 v[212:213], v37 offset:4096
    ds_read_b64_tr_b16 v[214:215], v37 offset:4608
    ds_read_b64_tr_b16 v[216:217], v38 offset:4096
    ds_read_b64_tr_b16 v[218:219], v38 offset:4608
    buffer_load_dwordx4 v[228:231], v2, s[32:35], s20 offen offset:1024 sc1
    buffer_load_dwordx4 v[232:235], v2, s[32:35], s20 offen offset:2048 sc1
    buffer_load_dwordx4 v[236:239], v2, s[32:35], s20 offen offset:3072 sc1
    s_barrier
    s_xor_b32 s96, s17, 4096
    s_add_u32 s20, s96, s19
    buffer_load_dwordx4 v[240:243], v2, s[32:35], s20 offen sc1
    buffer_load_dwordx4 v[244:247], v2, s[32:35], s20 offen offset:1024 sc1
    buffer_load_dwordx4 v[44:47], v2, s[32:35], s20 offen offset:2048 sc1
    buffer_load_dwordx4 v[48:51], v2, s[32:35], s20 offen offset:3072 sc1
    s_lshl_b32 s96, s21, 10
    s_add_u32 s13, s96, 14155776
    v_and_b32 v10, 15, v1
    v_lshlrev_b32 v10, 6, v10
    s_cmp_lt_u32 s3, 4
    s_cbranch_scc1 L_G2P0
    s_setprio 1
L_G2P0:
    s_waitcnt vmcnt(7)
    s_waitcnt lgkmcnt(6)
    v_mfma_f32_16x16x32_bf16 v[120:123], v[192:195], v[224:227], 0
    ds_read_b64_tr_b16 v[220:221], v39 offset:4096
    ds_read_b64_tr_b16 v[222:223], v39 offset:4608
    v_mfma_f32_16x16x32_bf16 v[124:127], v[196:199], v[224:227], 0
    ds_read_b64_tr_b16 v[192:193], v36 offset:8192
    ds_read_b64_tr_b16 v[194:195], v36 offset:8704
    v_mfma_f32_16x16x32_bf16 v[128:131], v[200:203], v[224:227], 0
    ds_read_b64_tr_b16 v[196:197], v37 offset:8192
    ds_read_b64_tr_b16 v[198:199], v37 offset:8704
    v_mfma_f32_16x16x32_bf16 v[132:135], v[204:207], v[224:227], 0
    ds_read_b64_tr_b16 v[200:201], v38 offset:8192
    ds_read_b64_tr_b16 v[202:203], v38 offset:8704
    s_xor_b32 s96, s17, 8192
    s_add_u32 s20, s96, s19
    buffer_load_dwordx4 v[224:227], v2, s[32:35], s20 offen sc1
    s_waitcnt vmcnt(7)
    s_waitcnt lgkmcnt(6)
    v_mfma_f32_16x16x32_bf16 v[120:123], v[208:211], v[228:231], v[120:123]
    ds_read_b64_tr_b16 v[204:205], v39 offset:8192
    ds_read_b64_tr_b16 v[206:207], v39 offset:8704
    v_mfma_f32_16x16x32_bf16 v[124:127], v[212:215], v[228:231], v[124:127]
    ds_read_b64_tr_b16 v[208:209], v36 offset:12288
    ds_read_b64_tr_b16 v[210:211], v36 offset:12800
    v_xor_b32 v36, 16384, v36
    v_mfma_f32_16x16x32_bf16 v[128:131], v[216:219], v[228:231], v[128:131]
    ds_read_b64_tr_b16 v[212:213], v37 offset:12288
    ds_read_b64_tr_b16 v[214:215], v37 offset:12800
    v_xor_b32 v37, 16384, v37
    v_mfma_f32_16x16x32_bf16 v[132:135], v[220:223], v[228:231], v[132:135]
    ds_read_b64_tr_b16 v[216:217], v38 offset:12288
    ds_read_b64_tr_b16 v[218:219], v38 offset:12800
    v_xor_b32 v38, 16384, v38
    buffer_load_dwordx4 v[228:231], v2, s[32:35], s20 offen offset:1024 sc1
    s_waitcnt vmcnt(7)
    s_waitcnt lgkmcnt(6)
    v_mfma_f32_16x16x32_bf16 v[120:123], v[192:195], v[232:235], v[120:123]
    ds_read_b64_tr_b16 v[220:221], v39 offset:12288
    ds_read_b64_tr_b16 v[222:223], v39 offset:12800
    v_xor_b32 v39, 16384, v39
    v_mfma_f32_16x16x32_bf16 v[124:127], v[196:199], v[232:235], v[124:127]
    ds_read_b64_tr_b16 v[192:193], v36
    ds_read_b64_tr_b16 v[194:195], v36 offset:512
    v_mfma_f32_16x16x32_bf16 v[128:131], v[200:203], v[232:235], v[128:131]
    ds_read_b64_tr_b16 v[196:197], v37
    ds_read_b64_tr_b16 v[198:199], v37 offset:512
    v_mfma_f32_16x16x32_bf16 v[132:135], v[204:207], v[232:235], v[132:135]
    ds_read_b64_tr_b16 v[200:201], v38
    ds_read_b64_tr_b16 v[202:203], v38 offset:512
    buffer_load_dwordx4 v[232:235], v2, s[32:35], s20 offen offset:2048 sc1
    s_waitcnt vmcnt(7)
    s_waitcnt lgkmcnt(6)
    v_mfma_f32_16x16x32_bf16 v[120:123], v[208:211], v[236:239], v[120:123]
    ds_read_b64_tr_b16 v[204:205], v39
    ds_read_b64_tr_b16 v[206:207], v39 offset:512
    v_mfma_f32_16x16x32_bf16 v[124:127], v[212:215], v[236:239], v[124:127]
    ds_read_b64_tr_b16 v[208:209], v36 offset:4096
    ds_read_b64_tr_b16 v[210:211], v36 offset:4608
    v_mfma_f32_16x16x32_bf16 v[128:131], v[216:219], v[236:239], v[128:131]
    ds_read_b64_tr_b16 v[212:213], v37 offset:4096
    ds_read_b64_tr_b16 v[214:215], v37 offset:4608
    v_mfma_f32_16x16x32_bf16 v[132:135], v[220:223], v[236:239], v[132:135]
    ds_read_b64_tr_b16 v[216:217], v38 offset:4096
    ds_read_b64_tr_b16 v[218:219], v38 offset:4608
    buffer_load_dwordx4 v[236:239], v2, s[32:35], s20 offen offset:3072 sc1
    s_waitcnt vmcnt(7)
    s_waitcnt lgkmcnt(6)
    v_mfma_f32_16x16x32_bf16 v[120:123], v[192:195], v[240:243], v[120:123]
    ds_read_b64_tr_b16 v[220:221], v39 offset:4096
    ds_read_b64_tr_b16 v[222:223], v39 offset:4608
    v_mfma_f32_16x16x32_bf16 v[124:127], v[196:199], v[240:243], v[124:127]
    ds_read_b64_tr_b16 v[192:193], v36 offset:8192
    ds_read_b64_tr_b16 v[194:195], v36 offset:8704
    v_mfma_f32_16x16x32_bf16 v[128:131], v[200:203], v[240:243], v[128:131]
    ds_read_b64_tr_b16 v[196:197], v37 offset:8192
    ds_read_b64_tr_b16 v[198:199], v37 offset:8704
    v_mfma_f32_16x16x32_bf16 v[132:135], v[204:207], v[240:243], v[132:135]
    ds_read_b64_tr_b16 v[200:201], v38 offset:8192
    ds_read_b64_tr_b16 v[202:203], v38 offset:8704
    s_xor_b32 s96, s17, 12288
    s_add_u32 s20, s96, s19
    buffer_load_dwordx4 v[240:243], v2, s[32:35], s20 offen sc1
    s_waitcnt vmcnt(7)
    s_waitcnt lgkmcnt(6)
    v_mfma_f32_16x16x32_bf16 v[120:123], v[208:211], v[244:247], v[120:123]
    ds_read_b64_tr_b16 v[204:205], v39 offset:8192
    ds_read_b64_tr_b16 v[206:207], v39 offset:8704
    v_mfma_f32_16x16x32_bf16 v[124:127], v[212:215], v[244:247], v[124:127]
    ds_read_b64_tr_b16 v[208:209], v36 offset:12288
    ds_read_b64_tr_b16 v[210:211], v36 offset:12800
    v_xor_b32 v36, 49152, v36
    v_mfma_f32_16x16x32_bf16 v[128:131], v[216:219], v[244:247], v[128:131]
    ds_read_b64_tr_b16 v[212:213], v37 offset:12288
    ds_read_b64_tr_b16 v[214:215], v37 offset:12800
    v_xor_b32 v37, 49152, v37
    v_mfma_f32_16x16x32_bf16 v[132:135], v[220:223], v[244:247], v[132:135]
    ds_read_b64_tr_b16 v[216:217], v38 offset:12288
    ds_read_b64_tr_b16 v[218:219], v38 offset:12800
    v_xor_b32 v38, 49152, v38
    buffer_load_dwordx4 v[244:247], v2, s[32:35], s20 offen offset:1024 sc1
    s_waitcnt vmcnt(7)
    s_waitcnt lgkmcnt(6)
    v_mfma_f32_16x16x32_bf16 v[120:123], v[192:195], v[44:47], v[120:123]
    ds_read_b64_tr_b16 v[220:221], v39 offset:12288
    ds_read_b64_tr_b16 v[222:223], v39 offset:12800
    v_xor_b32 v39, 49152, v39
    v_mfma_f32_16x16x32_bf16 v[124:127], v[196:199], v[44:47], v[124:127]
    ds_read_b64_tr_b16 v[192:193], v36
    ds_read_b64_tr_b16 v[194:195], v36 offset:512
    v_mfma_f32_16x16x32_bf16 v[128:131], v[200:203], v[44:47], v[128:131]
    ds_read_b64_tr_b16 v[196:197], v37
    ds_read_b64_tr_b16 v[198:199], v37 offset:512
    v_mfma_f32_16x16x32_bf16 v[132:135], v[204:207], v[44:47], v[132:135]
    ds_read_b64_tr_b16 v[200:201], v38
    ds_read_b64_tr_b16 v[202:203], v38 offset:512
    buffer_load_dwordx4 v[44:47], v2, s[32:35], s20 offen offset:2048 sc1
    s_waitcnt vmcnt(7)
    s_waitcnt lgkmcnt(6)
    v_mfma_f32_16x16x32_bf16 v[120:123], v[208:211], v[48:51], v[120:123]
    ds_read_b64_tr_b16 v[204:205], v39
    ds_read_b64_tr_b16 v[206:207], v39 offset:512
    v_mfma_f32_16x16x32_bf16 v[124:127], v[212:215], v[48:51], v[124:127]
    ds_read_b64_tr_b16 v[208:209], v36 offset:4096
    ds_read_b64_tr_b16 v[210:211], v36 offset:4608
    v_mfma_f32_16x16x32_bf16 v[128:131], v[216:219], v[48:51], v[128:131]
    ds_read_b64_tr_b16 v[212:213], v37 offset:4096
    ds_read_b64_tr_b16 v[214:215], v37 offset:4608
    v_mfma_f32_16x16x32_bf16 v[132:135], v[220:223], v[48:51], v[132:135]
    ds_read_b64_tr_b16 v[216:217], v38 offset:4096
    ds_read_b64_tr_b16 v[218:219], v38 offset:4608
    buffer_load_dwordx4 v[48:51], v2, s[32:35], s20 offen offset:3072 sc1
    s_waitcnt vmcnt(7)
    s_waitcnt lgkmcnt(6)
    v_mfma_f32_16x16x32_bf16 v[120:123], v[192:195], v[224:227], v[120:123]
    ds_read_b64_tr_b16 v[220:221], v39 offset:4096
    ds_read_b64_tr_b16 v[222:223], v39 offset:4608
    v_mfma_f32_16x16x32_bf16 v[124:127], v[196:199], v[224:227], v[124:127]
    ds_read_b64_tr_b16 v[192:193], v36 offset:8192
    ds_read_b64_tr_b16 v[194:195], v36 offset:8704
    v_mfma_f32_16x16x32_bf16 v[128:131], v[200:203], v[224:227], v[128:131]
L_PAD8:
    s_cbranch_execz L_RET8
    ds_read_b64_tr_b16 v[196:197], v37 offset:8192
    ds_read_b64_tr_b16 v[198:199], v37 offset:8704
    v_mfma_f32_16x16x32_bf16 v[132:135], v[204:207], v[224:227], v[132:135]
    ds_read_b64_tr_b16 v[200:201], v38 offset:8192
    ds_read_b64_tr_b16 v[202:203], v38 offset:8704
    s_xor_b32 s96, s17, 16384
    s_add_u32 s20, s96, s19
    buffer_load_dwordx4 v[224:227], v2, s[32:35], s20 offen sc1
    s_waitcnt vmcnt(7)
    s_waitcnt lgkmcnt(6)
    v_mfma_f32_16x16x32_bf16 v[120:123], v[208:211], v[228:231], v[120:123]
    ds_read_b64_tr_b16 v[204:205], v39 offset:8192
    ds_read_b64_tr_b16 v[206:207], v39 offset:8704
    v_mfma_f32_16x16x32_bf16 v[124:127], v[212:215], v[228:231], v[124:127]
    ds_read_b64_tr_b16 v[208:209], v36 offset:12288
    ds_read_b64_tr_b16 v[210:211], v36 offset:12800
    v_xor_b32 v36, 16384, v36
    v_mfma_f32_16x16x32_bf16 v[128:131], v[216:219], v[228:231], v[128:131]
    ds_read_b64_tr_b16 v[212:213], v37 offset:12288
    ds_read_b64_tr_b16 v[214:215], v37 offset:12800
    v_xor_b32 v37, 16384, v37
    v_mfma_f32_16x16x32_bf16 v[132:135], v[220:223], v[228:231], v[132:135]
    ds_read_b64_tr_b16 v[216:217], v38 offset:12288
    ds_read_b64_tr_b16 v[218:219], v38 offset:12800
    v_xor_b32 v38, 16384, v38
    buffer_load_dwordx4 v[228:231], v2, s[32:35], s20 offen offset:1024 sc1
    s_waitcnt vmcnt(7)
    s_waitcnt lgkmcnt(6)
    v_mfma_f32_16x16x32_bf16 v[120:123], v[192:195], v[232:235], v[120:123]
    ds_read_b64_tr_b16 v[220:221], v39 offset:12288
    ds_read_b64_tr_b16 v[222:223], v39 offset:12800
    v_xor_b32 v39, 16384, v39
    v_mfma_f32_16x16x32_bf16 v[124:127], v[196:199], v[232:235], v[124:127]
    ds_read_b64_tr_b16 v[192:193], v36
    ds_read_b64_tr_b16 v[194:195], v36 offset:512
    v_mfma_f32_16x16x32_bf16 v[128:131], v[200:203], v[232:235], v[128:131]
    ds_read_b64_tr_b16 v[196:197], v37
    ds_read_b64_tr_b16 v[198:199], v37 offset:512
    v_mfma_f32_16x16x32_bf16 v[132:135], v[204:207], v[232:235], v[132:135]
    ds_read_b64_tr_b16 v[200:201], v38
    ds_read_b64_tr_b16 v[202:203], v38 offset:512
    buffer_load_dwordx4 v[232:235], v2, s[32:35], s20 offen offset:2048 sc1
    s_waitcnt vmcnt(7)
    s_waitcnt lgkmcnt(6)
    v_mfma_f32_16x16x32_bf16 v[120:123], v[208:211], v[236:239], v[120:123]
    ds_read_b64_tr_b16 v[204:205], v39
    ds_read_b64_tr_b16 v[206:207], v39 offset:512
    v_mfma_f32_16x16x32_bf16 v[124:127], v[212:215], v[236:239], v[124:127]
    ds_read_b64_tr_b16 v[208:209], v36 offset:4096
    ds_read_b64_tr_b16 v[210:211], v36 offset:4608
    v_mfma_f32_16x16x32_bf16 v[128:131], v[216:219], v[236:239], v[128:131]
    ds_read_b64_tr_b16 v[212:213], v37 offset:4096
    ds_read_b64_tr_b16 v[214:215], v37 offset:4608
    v_mfma_f32_16x16x32_bf16 v[132:135], v[220:223], v[236:239], v[132:135]
    ds_read_b64_tr_b16 v[216:217], v38 offset:4096
    ds_read_b64_tr_b16 v[218:219], v38 offset:4608
    buffer_load_dwordx4 v[236:239], v2, s[32:35], s20 offen offset:3072 sc1
    s_waitcnt vmcnt(7)
    s_waitcnt lgkmcnt(6)
    v_mfma_f32_16x16x32_bf16 v[120:123], v[192:195], v[240:243], v[120:123]
    ds_read_b64_tr_b16 v[220:221], v39 offset:4096
    ds_read_b64_tr_b16 v[222:223], v39 offset:4608
    v_mfma_f32_16x16x32_bf16 v[124:127], v[196:199], v[240:243], v[124:127]
    ds_read_b64_tr_b16 v[192:193], v36 offset:8192
    ds_read_b64_tr_b16 v[194:195], v36 offset:8704
    v_mfma_f32_16x16x32_bf16 v[128:131], v[200:203], v[240:243], v[128:131]
    ds_read_b64_tr_b16 v[196:197], v37 offset:8192
    ds_read_b64_tr_b16 v[198:199], v37 offset:8704
    v_mfma_f32_16x16x32_bf16 v[132:135], v[204:207], v[240:243], v[132:135]
    ds_read_b64_tr_b16 v[200:201], v38 offset:8192
    ds_read_b64_tr_b16 v[202:203], v38 offset:8704
    s_xor_b32 s96, s17, 20480
    s_add_u32 s20, s96, s19
    buffer_load_dwordx4 v[240:243], v2, s[32:35], s20 offen sc1
    s_waitcnt vmcnt(7)
    s_waitcnt lgkmcnt(6)
    v_mfma_f32_16x16x32_bf16 v[120:123], v[208:211], v[244:247], v[120:123]
    ds_read_b64_tr_b16 v[204:205], v39 offset:8192
    ds_read_b64_tr_b16 v[206:207], v39 offset:8704
    v_mfma_f32_16x16x32_bf16 v[124:127], v[212:215], v[244:247], v[124:127]
    ds_read_b64_tr_b16 v[208:209], v36 offset:12288
    ds_read_b64_tr_b16 v[210:211], v36 offset:12800
    v_xor_b32 v36, 114688, v36
    v_mfma_f32_16x16x32_bf16 v[128:131], v[216:219], v[244:247], v[128:131]
    ds_read_b64_tr_b16 v[212:213], v37 offset:12288
    ds_read_b64_tr_b16 v[214:215], v37 offset:12800
    v_xor_b32 v37, 114688, v37
    v_mfma_f32_16x16x32_bf16 v[132:135], v[220:223], v[244:247], v[132:135]
    ds_read_b64_tr_b16 v[216:217], v38 offset:12288
    ds_read_b64_tr_b16 v[218:219], v38 offset:12800
    v_xor_b32 v38, 114688, v38
    buffer_load_dwordx4 v[244:247], v2, s[32:35], s20 offen offset:1024 sc1
    s_waitcnt vmcnt(7)
    s_waitcnt lgkmcnt(6)
    v_mfma_f32_16x16x32_bf16 v[120:123], v[192:195], v[44:47], v[120:123]
    ds_read_b64_tr_b16 v[220:221], v39 offset:12288
    ds_read_b64_tr_b16 v[222:223], v39 offset:12800
    v_xor_b32 v39, 114688, v39
    v_mfma_f32_16x16x32_bf16 v[124:127], v[196:199], v[44:47], v[124:127]
    ds_read_b64_tr_b16 v[192:193], v36
    ds_read_b64_tr_b16 v[194:195], v36 offset:512
    v_mfma_f32_16x16x32_bf16 v[128:131], v[200:203], v[44:47], v[128:131]
    ds_read_b64_tr_b16 v[196:197], v37
    ds_read_b64_tr_b16 v[198:199], v37 offset:512
    v_mfma_f32_16x16x32_bf16 v[132:135], v[204:207], v[44:47], v[132:135]
    ds_read_b64_tr_b16 v[200:201], v38
    ds_read_b64_tr_b16 v[202:203], v38 offset:512
    buffer_load_dwordx4 v[44:47], v2, s[32:35], s20 offen offset:2048 sc1
    s_waitcnt vmcnt(7)
    s_waitcnt lgkmcnt(6)
    v_mfma_f32_16x16x32_bf16 v[120:123], v[208:211], v[48:51], v[120:123]
    ds_read_b64_tr_b16 v[204:205], v39
    ds_read_b64_tr_b16 v[206:207], v39 offset:512
    v_mfma_f32_16x16x32_bf16 v[124:127], v[212:215], v[48:51], v[124:127]
    ds_read_b64_tr_b16 v[208:209], v36 offset:4096
    ds_read_b64_tr_b16 v[210:211], v36 offset:4608
    v_mfma_f32_16x16x32_bf16 v[128:131], v[216:219], v[48:51], v[128:131]
    ds_read_b64_tr_b16 v[212:213], v37 offset:4096
    ds_read_b64_tr_b16 v[214:215], v37 offset:4608
    v_mfma_f32_16x16x32_bf16 v[132:135], v[220:223], v[48:51], v[132:135]
    ds_read_b64_tr_b16 v[216:217], v38 offset:4096
    ds_read_b64_tr_b16 v[218:219], v38 offset:4608
    buffer_load_dwordx4 v[48:51], v2, s[32:35], s20 offen offset:3072 sc1
    s_waitcnt vmcnt(7)
    s_waitcnt lgkmcnt(6)
    v_mfma_f32_16x16x32_bf16 v[120:123], v[192:195], v[224:227], v[120:123]
    ds_read_b64_tr_b16 v[220:221], v39 offset:4096
    ds_read_b64_tr_b16 v[222:223], v39 offset:4608
    v_mfma_f32_16x16x32_bf16 v[124:127], v[196:199], v[224:227], v[124:127]
    ds_read_b64_tr_b16 v[192:193], v36 offset:8192
    ds_read_b64_tr_b16 v[194:195], v36 offset:8704
    v_mfma_f32_16x16x32_bf16 v[128:131], v[200:203], v[224:227], v[128:131]
    ds_read_b64_tr_b16 v[196:197], v37 offset:8192
    ds_read_b64_tr_b16 v[198:199], v37 offset:8704
    v_mfma_f32_16x16x32_bf16 v[132:135], v[204:207], v[224:227], v[132:135]
    ds_read_b64_tr_b16 v[200:201], v38 offset:8192
    ds_read_b64_tr_b16 v[202:203], v38 offset:8704
    s_xor_b32 s96, s17, 24576
    s_add_u32 s20, s96, s19
    buffer_load_dwordx4 v[224:227], v2, s[32:35], s20 offen sc1
    s_waitcnt vmcnt(7)
    s_waitcnt lgkmcnt(6)
    v_mfma_f32_16x16x32_bf16 v[120:123], v[208:211], v[228:231], v[120:123]
    ds_read_b64_tr_b16 v[204:205], v39 offset:8192
    ds_read_b64_tr_b16 v[206:207], v39 offset:8704
    v_mfma_f32_16x16x32_bf16 v[124:127], v[212:215], v[228:231], v[124:127]
    ds_read_b64_tr_b16 v[208:209], v36 offset:12288
    ds_read_b64_tr_b16 v[210:211], v36 offset:12800
    v_xor_b32 v36, 16384, v36
    v_mfma_f32_16x16x32_bf16 v[128:131], v[216:219], v[228:231], v[128:131]
    ds_read_b64_tr_b16 v[212:213], v37 offset:12288
    ds_read_b64_tr_b16 v[214:215], v37 offset:12800
    v_xor_b32 v37, 16384, v37
    v_mfma_f32_16x16x32_bf16 v[132:135], v[220:223], v[228:231], v[132:135]
    ds_read_b64_tr_b16 v[216:217], v38 offset:12288
    ds_read_b64_tr_b16 v[218:219], v38 offset:12800
    v_xor_b32 v38, 16384, v38
    buffer_load_dwordx4 v[228:231], v2, s[32:35], s20 offen offset:1024 sc1
    s_waitcnt vmcnt(7)
    s_waitcnt lgkmcnt(6)
    v_mfma_f32_16x16x32_bf16 v[120:123], v[192:195], v[232:235], v[120:123]
    ds_read_b64_tr_b16 v[220:221], v39 offset:12288
    ds_read_b64_tr_b16 v[222:223], v39 offset:12800
    v_xor_b32 v39, 16384, v39
    v_mfma_f32_16x16x32_bf16 v[124:127], v[196:199], v[232:235], v[124:127]
    ds_read_b64_tr_b16 v[192:193], v36
    ds_read_b64_tr_b16 v[194:195], v36 offset:512
    v_mfma_f32_16x16x32_bf16 v[128:131], v[200:203], v[232:235], v[128:131]
    ds_read_b64_tr_b16 v[196:197], v37
    ds_read_b64_tr_b16 v[198:199], v37 offset:512
    v_mfma_f32_16x16x32_bf16 v[132:135], v[204:207], v[232:235], v[132:135]
    ds_read_b64_tr_b16 v[200:201], v38
    ds_read_b64_tr_b16 v[202:203], v38 offset:512
    buffer_load_dwordx4 v[232:235], v2, s[32:35], s20 offen offset:2048 sc1
    s_waitcnt vmcnt(7)
    s_waitcnt lgkmcnt(6)
    v_mfma_f32_16x16x32_bf16 v[120:123], v[208:211], v[236:239], v[120:123]
    ds_read_b64_tr_b16 v[204:205], v39
    ds_read_b64_tr_b16 v[206:207], v39 offset:512
    v_mfma_f32_16x16x32_bf16 v[124:127], v[212:215], v[236:239], v[124:127]
    ds_read_b64_tr_b16 v[208:209], v36 offset:4096
    ds_read_b64_tr_b16 v[210:211], v36 offset:4608
    v_mfma_f32_16x16x32_bf16 v[128:131], v[216:219], v[236:239], v[128:131]
    ds_read_b64_tr_b16 v[212:213], v37 offset:4096
    ds_read_b64_tr_b16 v[214:215], v37 offset:4608
    v_mfma_f32_16x16x32_bf16 v[132:135], v[220:223], v[236:239], v[132:135]
    ds_read_b64_tr_b16 v[216:217], v38 offset:4096
    ds_read_b64_tr_b16 v[218:219], v38 offset:4608
    buffer_load_dwordx4 v[236:239], v2, s[32:35], s20 offen offset:3072 sc1
    s_waitcnt vmcnt(7)
    s_waitcnt lgkmcnt(6)
    v_mfma_f32_16x16x32_bf16 v[120:123], v[192:195], v[240:243], v[120:123]
    ds_read_b64_tr_b16 v[220:221], v39 offset:4096
    ds_read_b64_tr_b16 v[222:223], v39 offset:4608
    v_mfma_f32_16x16x32_bf16 v[124:127], v[196:199], v[240:243], v[124:127]
    ds_read_b64_tr_b16 v[192:193], v36 offset:8192
    ds_read_b64_tr_b16 v[194:195], v36 offset:8704
    v_mfma_f32_16x16x32_bf16 v[128:131], v[200:203], v[240:243], v[128:131]
    ds_read_b64_tr_b16 v[196:197], v37 offset:8192
    ds_read_b64_tr_b16 v[198:199], v37 offset:8704
    v_mfma_f32_16x16x32_bf16 v[132:135], v[204:207], v[240:243], v[132:135]
    ds_read_b64_tr_b16 v[200:201], v38 offset:8192
    ds_read_b64_tr_b16 v[202:203], v38 offset:8704
    s_xor_b32 s96, s17, 28672
    s_add_u32 s20, s96, s19
    buffer_load_dwordx4 v[240:243], v2, s[32:35], s20 offen sc1
    s_waitcnt vmcnt(7)
    s_waitcnt lgkmcnt(6)
    v_mfma_f32_16x16x32_bf16 v[120:123], v[208:211], v[244:247], v[120:123]
    ds_read_b64_tr_b16 v[204:205], v39 offset:8192
    ds_read_b64_tr_b16 v[206:207], v39 offset:8704
    v_mfma_f32_16x16x32_bf16 v[124:127], v[212:215], v[244:247], v[124:127]
    ds_read_b64_tr_b16 v[208:209], v36 offset:12288
    ds_read_b64_tr_b16 v[210:211], v36 offset:12800
    v_xor_b32 v36, 49152, v36
    v_mfma_f32_16x16x32_bf16 v[128:131], v[216:219], v[244:247], v[128:131]
    ds_read_b64_tr_b16 v[212:213], v37 offset:12288
    ds_read_b64_tr_b16 v[214:215], v37 offset:12800
    v_xor_b32 v37, 49152, v37
    v_mfma_f32_16x16x32_bf16 v[132:135], v[220:223], v[244:247], v[132:135]
    ds_read_b64_tr_b16 v[216:217], v38 offset:12288
    ds_read_b64_tr_b16 v[218:219], v38 offset:12800
    v_xor_b32 v38, 49152, v38
    buffer_load_dwordx4 v[244:247], v2, s[32:35], s20 offen offset:1024 sc1
    s_cmp_lt_u32 s3, 4
    s_cbranch_scc1 L_G2P22
    s_setprio 0
L_G2P22:
    s_waitcnt vmcnt(7)
    s_waitcnt lgkmcnt(6)
    v_mfma_f32_16x16x32_bf16 v[120:123], v[192:195], v[44:47], v[120:123]
    ds_read_b64_tr_b16 v[220:221], v39 offset:12288
    ds_read_b64_tr_b16 v[222:223], v39 offset:12800
    v_xor_b32 v39, 49152, v39
    v_mfma_f32_16x16x32_bf16 v[124:127], v[196:199], v[44:47], v[124:127]
    ds_read_b64_tr_b16 v[192:193], v36
    ds_read_b64_tr_b16 v[194:195], v36 offset:512
    v_mfma_f32_16x16x32_bf16 v[128:131], v[200:203], v[44:47], v[128:131]
    ds_read_b64_tr_b16 v[196:197], v37
    ds_read_b64_tr_b16 v[198:199], v37 offset:512
    v_mfma_f32_16x16x32_bf16 v[132:135], v[204:207], v[44:47], v[132:135]
    ds_read_b64_tr_b16 v[200:201], v38
    ds_read_b64_tr_b16 v[202:203], v38 offset:512
    buffer_load_dwordx4 v[44:47], v2, s[32:35], s20 offen offset:2048 sc1
    s_waitcnt vmcnt(7)
    s_waitcnt lgkmcnt(6)
    v_mfma_f32_16x16x32_bf16 v[120:123], v[208:211], v[48:51], v[120:123]
    ds_read_b64_tr_b16 v[204:205], v39
    ds_read_b64_tr_b16 v[206:207], v39 offset:512
    v_mfma_f32_16x16x32_bf16 v[124:127], v[212:215], v[48:51], v[124:127]
    ds_read_b64_tr_b16 v[208:209], v36 offset:4096
    ds_read_b64_tr_b16 v[210:211], v36 offset:4608
    v_mfma_f32_16x16x32_bf16 v[128:131], v[216:219], v[48:51], v[128:131]
    ds_read_b64_tr_b16 v[212:213], v37 offset:4096
    ds_read_b64_tr_b16 v[214:215], v37 offset:4608
    v_mfma_f32_16x16x32_bf16 v[132:135], v[220:223], v[48:51], v[132:135]
    ds_read_b64_tr_b16 v[216:217], v38 offset:4096
    ds_read_b64_tr_b16 v[218:219], v38 offset:4608
    buffer_load_dwordx4 v[48:51], v2, s[32:35], s20 offen offset:3072 sc1
    buffer_load_dwordx2 v[40:41], v10, s[32:35], s13 offen sc1
    s_waitcnt vmcnt(8)
    s_waitcnt lgkmcnt(6)
    v_mfma_f32_16x16x32_bf16 v[120:123], v[192:195], v[224:227], v[120:123]
    ds_read_b64_tr_b16 v[220:221], v39 offset:4096
    ds_read_b64_tr_b16 v[222:223], v39 offset:4608
    v_mfma_f32_16x16x32_bf16 v[124:127], v[196:199], v[224:227], v[124:127]
    ds_read_b64_tr_b16 v[192:193], v36 offset:8192
    ds_read_b64_tr_b16 v[194:195], v36 offset:8704
    v_mfma_f32_16x16x32_bf16 v[128:131], v[200:203], v[224:227], v[128:131]
    ds_read_b64_tr_b16 v[196:197], v37 offset:8192
    ds_read_b64_tr_b16 v[198:199], v37 offset:8704
    v_mfma_f32_16x16x32_bf16 v[132:135], v[204:207], v[224:227], v[132:135]
    ds_read_b64_tr_b16 v[200:201], v38 offset:8192
    ds_read_b64_tr_b16 v[202:203], v38 offset:8704
    s_waitcnt vmcnt(7)
    s_waitcnt lgkmcnt(6)
    v_mfma_f32_16x16x32_bf16 v[120:123], v[208:211], v[228:231], v[120:123]
    ds_read_b64_tr_b16 v[204:205], v39 offset:8192
    ds_read_b64_tr_b16 v[206:207], v39 offset:8704
    v_mfma_f32_16x16x32_bf16 v[124:127], v[212:215], v[228:231], v[124:127]
    ds_read_b64_tr_b16 v[208:209], v36 offset:12288
    ds_read_b64_tr_b16 v[210:211], v36 offset:12800
    v_xor_b32 v36, 16384, v36
    v_mfma_f32_16x16x32_bf16 v[128:131], v[216:219], v[228:231], v[128:131]
    ds_read_b64_tr_b16 v[212:213], v37 offset:12288
    ds_read_b64_tr_b16 v[214:215], v37 offset:12800
    v_xor_b32 v37, 16384, v37
    v_mfma_f32_16x16x32_bf16 v[132:135], v[220:223], v[228:231], v[132:135]
    ds_read_b64_tr_b16 v[216:217], v38 offset:12288
    ds_read_b64_tr_b16 v[218:219], v38 offset:12800
    v_xor_b32 v38, 16384, v38
    s_waitcnt vmcnt(6)
    s_waitcnt lgkmcnt(6)
    v_mfma_f32_16x16x32_bf16 v[120:123], v[192:195], v[232:235], v[120:123]
    ds_read_b64_tr_b16 v[220:221], v39 offset:12288
    ds_read_b64_tr_b16 v[222:223], v39 offset:12800
    v_xor_b32 v39, 16384, v39
    v_mfma_f32_16x16x32_bf16 v[124:127], v[196:199], v[232:235], v[124:127]
    ds_read_b64_tr_b16 v[192:193], v36
    ds_read_b64_tr_b16 v[194:195], v36 offset:512
    v_mfma_f32_16x16x32_bf16 v[128:131], v[200:203], v[232:235], v[128:131]
    ds_read_b64_tr_b16 v[196:197], v37
    ds_read_b64_tr_b16 v[198:199], v37 offset:512
    v_mfma_f32_16x16x32_bf16 v[132:135], v[204:207], v[232:235], v[132:135]
    ds_read_b64_tr_b16 v[200:201], v38
    ds_read_b64_tr_b16 v[202:203], v38 offset:512
    s_waitcnt vmcnt(5)
    s_waitcnt lgkmcnt(6)
    v_mfma_f32_16x16x32_bf16 v[120:123], v[208:211], v[236:239], v[120:123]
    ds_read_b64_tr_b16 v[204:205], v39
    ds_read_b64_tr_b16 v[206:207], v39 offset:512
    v_mfma_f32_16x16x32_bf16 v[124:127], v[212:215], v[236:239], v[124:127]
    ds_read_b64_tr_b16 v[208:209], v36 offset:4096
    ds_read_b64_tr_b16 v[210:211], v36 offset:4608
    v_mfma_f32_16x16x32_bf16 v[128:131], v[216:219], v[236:239], v[128:131]
    ds_read_b64_tr_b16 v[212:213], v37 offset:4096
    ds_read_b64_tr_b16 v[214:215], v37 offset:4608
    v_mfma_f32_16x16x32_bf16 v[132:135], v[220:223], v[236:239], v[132:135]
    ds_read_b64_tr_b16 v[216:217], v38 offset:4096
    ds_read_b64_tr_b16 v[218:219], v38 offset:4608
    s_add_u32 s82, s80, 114688
    buffer_load_dwordx4 v[72:75], v27, s[52:55], s82 offen nt
    s_add_u32 s82, s80, 172032
    buffer_load_dwordx4 v[76:79], v27, s[52:55], s82 offen nt
    s_mov_b32 s82, s80
    buffer_load_dwordx4 v[80:83], v27, s[56:59], s82 offen nt
    s_waitcnt vmcnt(7)
    s_waitcnt lgkmcnt(6)
    v_mfma_f32_16x16x32_bf16 v[120:123], v[192:195], v[240:243], v[120:123]
    ds_read_b64_tr_b16 v[220:221], v39 offset:4096
    ds_read_b64_tr_b16 v[222:223], v39 offset:4608
    v_mfma_f32_16x16x32_bf16 v[124:127], v[196:199], v[240:243], v[124:127]
    ds_read_b64_tr_b16 v[192:193], v36 offset:8192
    ds_read_b64_tr_b16 v[194:195], v36 offset:8704
    v_mfma_f32_16x16x32_bf16 v[128:131], v[200:203], v[240:243], v[128:131]
    ds_read_b64_tr_b16 v[196:197], v37 offset:8192
    ds_read_b64_tr_b16 v[198:199], v37 offset:8704
    v_mfma_f32_16x16x32_bf16 v[132:135], v[204:207], v[240:243], v[132:135]
    ds_read_b64_tr_b16 v[200:201], v38 offset:8192
    ds_read_b64_tr_b16 v[202:203], v38 offset:8704
    s_waitcnt vmcnt(6)
    s_waitcnt lgkmcnt(6)
    v_mfma_f32_16x16x32_bf16 v[120:123], v[208:211], v[244:247], v[120:123]
    ds_read_b64_tr_b16 v[204:205], v39 offset:8192
    ds_read_b64_tr_b16 v[206:207], v39 offset:8704
    v_mfma_f32_16x16x32_bf16 v[124:127], v[212:215], v[244:247], v[124:127]
    ds_read_b64_tr_b16 v[208:209], v36 offset:12288
    ds_read_b64_tr_b16 v[210:211], v36 offset:12800
    v_mfma_f32_16x16x32_bf16 v[128:131], v[216:219], v[244:247], v[128:131]
    ds_read_b64_tr_b16 v[212:213], v37 offset:12288
    ds_read_b64_tr_b16 v[214:215], v37 offset:12800
    v_mfma_f32_16x16x32_bf16 v[132:135], v[220:223], v[244:247], v[132:135]
    ds_read_b64_tr_b16 v[216:217], v38 offset:12288
    ds_read_b64_tr_b16 v[218:219], v38 offset:12800
    s_waitcnt vmcnt(5)
    s_waitcnt lgkmcnt(6)
    v_mfma_f32_16x16x32_bf16 v[120:123], v[192:195], v[44:47], v[120:123]
    ds_read_b64_tr_b16 v[220:221], v39 offset:12288
    ds_read_b64_tr_b16 v[222:223], v39 offset:12800
    v_mfma_f32_16x16x32_bf16 v[124:127], v[196:199], v[44:47], v[124:127]
    v_mfma_f32_16x16x32_bf16 v[128:131], v[200:203], v[44:47], v[128:131]
    v_mfma_f32_16x16x32_bf16 v[132:135], v[204:207], v[44:47], v[132:135]
    s_waitcnt vmcnt(4)
    s_waitcnt lgkmcnt(0)
    v_mfma_f32_16x16x32_bf16 v[120:123], v[208:211], v[48:51], v[120:123]
    v_mfma_f32_16x16x32_bf16 v[124:127], v[212:215], v[48:51], v[124:127]
    v_mfma_f32_16x16x32_bf16 v[128:131], v[216:219], v[48:51], v[128:131]
    v_mfma_f32_16x16x32_bf16 v[132:135], v[220:223], v[48:51], v[132:135]
    s_nop 4
    v_cvt_pk_bf16_f32 v120, 0, v120
    v_cvt_pk_bf16_f32 v121, 0, v121
    v_cvt_pk_bf16_f32 v122, 0, v122
    v_cvt_pk_bf16_f32 v123, 0, v123
    v_cvt_pk_bf16_f32 v124, 0, v124
    v_cvt_pk_bf16_f32 v125, 0, v125
    v_cvt_pk_bf16_f32 v126, 0, v126
    v_cvt_pk_bf16_f32 v127, 0, v127
    v_pk_mul_f32 v[120:121], v[120:121], v[136:137]
    v_pk_mul_f32 v[122:123], v[122:123], v[138:139]
    v_pk_mul_f32 v[124:125], v[124:125], v[140:141]
    v_pk_mul_f32 v[126:127], v[126:127], v[142:143]
    v_cvt_pk_bf16_f32 v120, 0, v120
    v_cvt_pk_bf16_f32 v121, 0, v121
    v_cvt_pk_bf16_f32 v122, 0, v122
    v_cvt_pk_bf16_f32 v123, 0, v123
    v_cvt_pk_bf16_f32 v124, 0, v124
    v_cvt_pk_bf16_f32 v125, 0, v125
    v_cvt_pk_bf16_f32 v126, 0, v126
    v_cvt_pk_bf16_f32 v127, 0, v127
    v_pk_add_f32 v[120:121], v[120:121], v[152:153]
    v_pk_add_f32 v[122:123], v[122:123], v[154:155]
    v_pk_add_f32 v[124:125], v[124:125], v[156:157]
    v_pk_add_f32 v[126:127], v[126:127], v[158:159]
    v_cvt_pk_bf16_f32 v12, v120, v121
    v_cvt_pk_bf16_f32 v13, v122, v123
    v_cvt_pk_bf16_f32 v14, v124, v125
    v_cvt_pk_bf16_f32 v15, v126, v127
    v_dot2_f32_bf16 v4, v12, v12, 0
    v_dot2_f32_bf16 v5, v13, v13, 0
    v_dot2_f32_bf16 v4, v14, v14, v4
    v_dot2_f32_bf16 v5, v15, v15, v5
    v_mfma_f32_16x16x32_bf16 v[240:243], v[184:187], v[12:15], 0
    v_cvt_pk_bf16_f32 v128, 0, v128
    v_cvt_pk_bf16_f32 v129, 0, v129
    v_cvt_pk_bf16_f32 v130, 0, v130
    v_cvt_pk_bf16_f32 v131, 0, v131
    v_cvt_pk_bf16_f32 v132, 0, v132
    v_cvt_pk_bf16_f32 v133, 0, v133
    v_cvt_pk_bf16_f32 v134, 0, v134
    v_cvt_pk_bf16_f32 v135, 0, v135
    v_pk_mul_f32 v[128:129], v[128:129], v[144:145]
    v_pk_mul_f32 v[130:131], v[130:131], v[146:147]
    v_pk_mul_f32 v[132:133], v[132:133], v[148:149]
    v_pk_mul_f32 v[134:135], v[134:135], v[150:151]
    v_cvt_pk_bf16_f32 v128, 0, v128
    v_cvt_pk_bf16_f32 v129, 0, v129
    v_cvt_pk_bf16_f32 v130, 0, v130
    v_cvt_pk_bf16_f32 v131, 0, v131
    v_cvt_pk_bf16_f32 v132, 0, v132
    v_cvt_pk_bf16_f32 v133, 0, v133
    v_cvt_pk_bf16_f32 v134, 0, v134
    v_cvt_pk_bf16_f32 v135, 0, v135
    v_pk_add_f32 v[128:129], v[128:129], v[160:161]
    v_pk_add_f32 v[130:131], v[130:131], v[162:163]
    v_pk_add_f32 v[132:133], v[132:133], v[164:165]
    v_pk_add_f32 v[134:135], v[134:135], v[166:167]
    v_cvt_pk_bf16_f32 v16, v128, v129
    v_cvt_pk_bf16_f32 v17, v130, v131
    v_cvt_pk_bf16_f32 v18, v132, v133
    v_cvt_pk_bf16_f32 v19, v134, v135
    v_dot2_f32_bf16 v4, v16, v16, v4
    v_dot2_f32_bf16 v5, v17, v17, v5
    v_dot2_f32_bf16 v4, v18, v18, v4
    v_dot2_f32_bf16 v5, v19, v19, v5
    v_mfma_f32_16x16x32_bf16 v[240:243], v[188:191], v[16:19], v[240:243]
    s_nop 1
    v_add_f32 v4, v4, v5
    v_mov_b32 v5, v4
    s_nop 1
    v_permlane32_swap_b32 v4, v5
    v_add_f32 v4, v4, v5
    v_mov_b32 v5, v4
    s_nop 1
    v_permlane16_swap_b32 v4, v5
    v_add_f32 v243, v4, v5
    s_mov_b64 exec, 0xffff
    buffer_store_dwordx4 v[240:243], v2, s[32:35], s86 offen sc1
    s_mov_b64 exec, -1
    s_barrier
    s_cmp_lg_u32 s3, 0
    s_cbranch_scc1 L_PE
    v_mov_b32 v6, s4
    s_mov_b32 exec_hi, 0
    s_mov_b32 exec_lo, 65535
    buffer_store_dword v6, v29, s[32:35], s87 offen sc1
    s_mov_b64 exec, -1
L_PE:
    s_add_u32 s82, s80, 57344
    s_lshl2_add_u32 m0, s83, 33792
    s_nop 0
    buffer_load_dwordx4 v27, s[56:59], s82 offen nt lds
    s_add_u32 s82, s80, 114688
    s_lshl2_add_u32 m0, s83, 34816
    s_nop 0
    buffer_load_dwordx4 v27, s[56:59], s82 offen nt lds
    s_lshl_b32 s15, s3, 12
    v_add_u32 v4, s15, v2
    v_add_u32 v7, 65536, v4
    s_waitcnt vmcnt(6)
    v_cmp_ne_u32 vcc, s4, v41
    s_cbranch_vccz L_UPOK
POLL_34:
    buffer_load_dwordx2 v[40:41], v10, s[32:35], s13 offen sc1
    s_waitcnt vmcnt(0)
    v_cmp_ne_u32 vcc, s4, v41
    s_cbranch_vccz PDONE_35
    s_add_u32 s5, s5, 1
    s_cmp_lt_u32 s5, 200000
    s_cbranch_scc1 POLL_34
PDONE_35:
L_UPOK:
    s_lshl3_add_u32 s96, s21, s3
    s_lshl_b32 s97, s96, 12
    s_add_u32 s14, s97, 12582912
    s_load_dwordx2 s[24:25], s[32:33], s92 offset:1536 glc
    v_add_f32_dpp v40, v40, v40 quad_perm:[1,0,3,2] row_mask:0xf bank_mask:0xf
    s_nop 1
    v_add_f32_dpp v40, v40, v40 quad_perm:[2,3,0,1] row_mask:0xf bank_mask:0xf
    s_nop 1
    v_add_f32_dpp v40, v40, v40 row_half_mirror row_mask:0xf bank_mask:0xf
    s_nop 1
    v_add_f32_dpp v40, v40, v40 row_mirror row_mask:0xf bank_mask:0xf
    v_lshlrev_b32 v152, 16, v12
    v_and_b32 v153, s6, v12
    v_lshlrev_b32 v154, 16, v13
    v_and_b32 v155, s6, v13
    v_lshlrev_b32 v156, 16, v14
    v_and_b32 v157, s6, v14
    v_lshlrev_b32 v158, 16, v15
    v_and_b32 v159, s6, v15
    v_lshlrev_b32 v160, 16, v16
    v_and_b32 v161, s6, v16
    v_lshlrev_b32 v162, 16, v17
    v_and_b32 v163, s6, v17
    v_lshlrev_b32 v164, 16, v18
    v_and_b32 v165, s6, v18
    v_lshlrev_b32 v166, 16, v19
    v_and_b32 v167, s6, v19
    s_lshl_b32 s96, s3, 9
    s_lshl1_add_u32 s15, s21, s96
    v_and_b32 v29, 15, v1
    v_lshl_add_u32 v29, v29, 5, s15
    v_xor_b32 v5, 0x4000, v4
    v_xor_b32 v8, 0x4000, v7
    s_waitcnt vmcnt(3)
    ds_write_b128 v4, v[72:75] offset:2048
    ds_write_b128 v4, v[76:79] offset:3072
    ds_write_b128 v4, v[80:83] offset:32768
    s_cmp_lt_u32 s3, 4
    s_cbranch_scc1 L_FW1
    ds_write_b128 v4, v[56:59] offset:0
    ds_write_b128 v5, v[60:63] offset:0
    ds_write_b128 v4, v[64:67] offset:1024
    ds_write_b128 v5, v[68:71] offset:1024
L_FW1:
    s_branch SCHK_37
SPOLL_36:
    s_load_dwordx2 s[24:25], s[32:33], s92 offset:1536 glc
SCHK_37:
    s_add_u32 s5, s5, 1
    s_cmp_ge_u32 s5, 200000
    s_waitcnt lgkmcnt(0)
    s_cbranch_scc1 SDONE_38
    s_cmp_lg_u32 s24, s4
    s_cbranch_scc1 SPOLL_36
    s_cmp_lg_u32 s25, s4
    s_cbranch_scc1 SPOLL_36
SDONE_38:
    s_barrier
    buffer_load_dwordx4 v[192:195], v2, s[32:35], s14 offen sc1
    buffer_load_dwordx4 v[196:199], v2, s[32:35], s14 offen offset:1024 sc1
    buffer_load_dwordx4 v[200:203], v2, s[32:35], s14 offen offset:2048 sc1
    buffer_load_dwordx4 v[204:207], v2, s[32:35], s14 offen offset:3072 sc1
    s_barrier
    s_add_u32 s82, s80, 172032
    s_lshl2_add_u32 m0, s83, 35840
    s_nop 0
    buffer_load_dwordx4 v27, s[56:59], s82 offen nt lds
    s_mov_b32 s82, s81
    s_lshl2_add_u32 m0, s83, 65536
    s_nop 0
    buffer_load_dwordx4 v253, s[60:63], s82 offen nt lds
    s_add_u32 s82, s81, 4096
    s_lshl2_add_u32 m0, s83, 66560
    s_nop 0
    buffer_load_dwordx4 v253, s[60:63], s82 offen nt lds
    v_mov_b32_dpp v168, v33 row_newbcast:0 row_mask:0xf bank_mask:0xf
    v_mov_b32_dpp v169, v33 row_newbcast:1 row_mask:0xf bank_mask:0xf
    v_mov_b32_dpp v170, v33 row_newbcast:2 row_mask:0xf bank_mask:0xf
    v_mov_b32_dpp v171, v33 row_newbcast:3 row_mask:0xf bank_mask:0xf
    v_mov_b32_dpp v172, v33 row_newbcast:4 row_mask:0xf bank_mask:0xf
    v_mov_b32_dpp v173, v33 row_newbcast:5 row_mask:0xf bank_mask:0xf
    v_mov_b32_dpp v174, v33 row_newbcast:6 row_mask:0xf bank_mask:0xf
    v_mov_b32_dpp v175, v33 row_newbcast:7 row_mask:0xf bank_mask:0xf
    v_mov_b32_dpp v176, v33 row_newbcast:8 row_mask:0xf bank_mask:0xf
    v_mov_b32_dpp v177, v33 row_newbcast:9 row_mask:0xf bank_mask:0xf
    v_mov_b32_dpp v178, v33 row_newbcast:10 row_mask:0xf bank_mask:0xf
    v_mov_b32_dpp v179, v33 row_newbcast:11 row_mask:0xf bank_mask:0xf
    v_mov_b32_dpp v180, v33 row_newbcast:12 row_mask:0xf bank_mask:0xf
    v_mov_b32_dpp v181, v33 row_newbcast:13 row_mask:0xf bank_mask:0xf
    v_mov_b32_dpp v182, v33 row_newbcast:14 row_mask:0xf bank_mask:0xf
    v_mov_b32_dpp v183, v33 row_newbcast:15 row_mask:0xf bank_mask:0xf
    v_mov_b32_dpp v88, v42 row_newbcast:0 row_mask:0xf bank_mask:0xf
    v_mov_b32_dpp v89, v42 row_newbcast:1 row_mask:0xf bank_mask:0xf
    v_mov_b32_dpp v90, v42 row_newbcast:2 row_mask:0xf bank_mask:0xf
    v_mov_b32_dpp v91, v42 row_newbcast:3 row_mask:0xf bank_mask:0xf
    v_mov_b32_dpp v92, v42 row_newbcast:4 row_mask:0xf bank_mask:0xf
    v_mov_b32_dpp v93, v42 row_newbcast:5 row_mask:0xf bank_mask:0xf
    v_mov_b32_dpp v94, v42 row_newbcast:6 row_mask:0xf bank_mask:0xf
    v_mov_b32_dpp v95, v42 row_newbcast:7 row_mask:0xf bank_mask:0xf
    v_mov_b32_dpp v96, v42 row_newbcast:8 row_mask:0xf bank_mask:0xf
    v_mov_b32_dpp v97, v42 row_newbcast:9 row_mask:0xf bank_mask:0xf
    v_mov_b32_dpp v98, v42 row_newbcast:10 row_mask:0xf bank_mask:0xf
L_PAD9:
    s_cbranch_execz L_RET9
    v_mov_b32_dpp v99, v42 row_newbcast:11 row_mask:0xf bank_mask:0xf
    v_mov_b32_dpp v100, v42 row_newbcast:12 row_mask:0xf bank_mask:0xf
    v_mov_b32_dpp v101, v42 row_newbcast:13 row_mask:0xf bank_mask:0xf
    v_mov_b32_dpp v102, v42 row_newbcast:14 row_mask:0xf bank_mask:0xf
    v_mov_b32_dpp v103, v42 row_newbcast:15 row_mask:0xf bank_mask:0xf
    v_mov_b32_dpp v104, v43 row_newbcast:0 row_mask:0xf bank_mask:0xf
    v_mov_b32_dpp v105, v43 row_newbcast:1 row_mask:0xf bank_mask:0xf
    v_mov_b32_dpp v106, v43 row_newbcast:2 row_mask:0xf bank_mask:0xf
    v_mov_b32_dpp v107, v43 row_newbcast:3 row_mask:0xf bank_mask:0xf
    v_mov_b32_dpp v108, v43 row_newbcast:4 row_mask:0xf bank_mask:0xf
    v_mov_b32_dpp v109, v43 row_newbcast:5 row_mask:0xf bank_mask:0xf
    v_mov_b32_dpp v110, v43 row_newbcast:6 row_mask:0xf bank_mask:0xf
    v_mov_b32_dpp v111, v43 row_newbcast:7 row_mask:0xf bank_mask:0xf
    v_mov_b32_dpp v112, v43 row_newbcast:8 row_mask:0xf bank_mask:0xf
    v_mov_b32_dpp v113, v43 row_newbcast:9 row_mask:0xf bank_mask:0xf
    v_mov_b32_dpp v114, v43 row_newbcast:10 row_mask:0xf bank_mask:0xf
    v_mov_b32_dpp v115, v43 row_newbcast:11 row_mask:0xf bank_mask:0xf
    v_mov_b32_dpp v116, v43 row_newbcast:12 row_mask:0xf bank_mask:0xf
    v_mov_b32_dpp v117, v43 row_newbcast:13 row_mask:0xf bank_mask:0xf
    v_mov_b32_dpp v118, v43 row_newbcast:14 row_mask:0xf bank_mask:0xf
    v_mov_b32_dpp v119, v43 row_newbcast:15 row_mask:0xf bank_mask:0xf
    s_lshl3_add_u32 s15, s3, 156160
    v_mov_b32 v4, s15
    v_and_b32 v5, 7, v1
    v_lshlrev_b32 v5, 3, v5
    v_add_u32 v5, 156160, v5
    v_and_b32 v6, 3, v1
    v_lshlrev_b32 v6, 18, v6
    v_bfe_u32 v9, v1, 2, 2
    v_lshl_add_u32 v6, v9, 13, v6
    s_and_b32 s96, s21, 1
    s_and_b32 s97, s12, 7
    s_lshr_b32 s98, s12, 3
    s_lshl3_add_u32 s99, s97, s98
    s_lshl_b32 s97, s99, 12
    s_lshr_b32 s98, s21, 1
    s_lshl_b32 s99, s98, 6
    s_add_u32 s98, s97, s99
    s_lshl4_add_u32 s97, s96, s98
    s_add_u32 s99, s97, 1048576
    s_add_u32 s16, s99, 2560
    s_waitcnt vmcnt(3)
    v_pk_add_f32 v[192:193], v[192:193], v[196:197]
    v_pk_add_f32 v[200:201], v[200:201], v[204:205]
    v_pk_add_f32 v[194:195], v[194:195], v[198:199]
    v_pk_add_f32 v[202:203], v[202:203], v[206:207]
    v_pk_add_f32 v[192:193], v[192:193], v[200:201]
    v_pk_add_f32 v[194:195], v[194:195], v[202:203]
    v_add_f32 v193, v193, v194
    v_add_f32 v197, v192, v195
    v_cmp_u_f32 vcc, v193, v197
    s_cbranch_vccz POK_40
PRE_41:
    buffer_load_dwordx4 v[192:195], v2, s[32:35], s14 offen sc1
    buffer_load_dwordx4 v[196:199], v2, s[32:35], s14 offen offset:1024 sc1
    buffer_load_dwordx4 v[200:203], v2, s[32:35], s14 offen offset:2048 sc1
    buffer_load_dwordx4 v[204:207], v2, s[32:35], s14 offen offset:3072 sc1
    s_waitcnt vmcnt(0)
    v_pk_add_f32 v[192:193], v[192:193], v[196:197]
    v_pk_add_f32 v[200:201], v[200:201], v[204:205]
    v_pk_add_f32 v[194:195], v[194:195], v[198:199]
    v_pk_add_f32 v[202:203], v[202:203], v[206:207]
    v_pk_add_f32 v[192:193], v[192:193], v[200:201]
    v_pk_add_f32 v[194:195], v[194:195], v[202:203]
    v_add_f32 v193, v193, v194
    v_add_f32 v197, v192, v195
    v_cmp_u_f32 vcc, v193, v197
    s_cbranch_vccz POK_40
    s_add_u32 s5, s5, 1
    s_cmp_lt_u32 s5, 200000
    s_cbranch_scc1 PRE_41
POK_40:
    v_mov_b32 v196, v195
    s_nop 1
    v_permlane32_swap_b32 v195, v196
    v_permlane32_swap_b32 v192, v193
    v_add_f32 v195, v195, v196
    v_add_f32 v192, v192, v193
    s_nop 1
    v_permlane16_swap_b32 v192, v195
    v_add_f32 v193, v192, v195
    v_add_f32 v195, v192, v195
    s_nop 1
    v_permlane16_swap_b32 v193, v195
    v_mov_b32 v192, v193
    v_mul_f32 v195, 0x3a800000, v195
    s_nop 0
    v_permlane32_swap_b32 v192, v193
    v_mul_f32 v192, 0x3a800000, v192
    v_fma_f32 v31, -v192, v192, v195
    v_cvt_pk_bf16_f32 v30, 0, v192
    v_max_f32 v31, 0, v31
    v_cvt_pk_bf16_f32 v31, 0, v31
    v_fma_f32 v193, -v30, v40, v193
    v_add_f32 v31, 0x3727c5ac, v31
    v_cvt_pk_bf16_f32 v31, 0, v31
    v_sqrt_f32 v31, v31
    s_nop 0
    v_cvt_pk_bf16_f32 v31, 0, v31
    v_rcp_f32 v31, v31
    s_nop 0
    v_mul_f32 v32, v193, v31
    v_ashrrev_i32 v196, 31, v32
    v_or_b32 v196, 0x80000000, v196
    v_xor_b32 v32, v32, v196
    s_mov_b32 s15, 0xfffff000
    v_and_or_b32 v32, v32, s15, v29
    s_nop 1
    v_max_u32_dpp v244, v32, v32 quad_perm:[1,0,3,2] row_mask:0xf bank_mask:0xf
    v_min_u32_dpp v245, v32, v32 quad_perm:[1,0,3,2] row_mask:0xf bank_mask:0xf
    s_nop 0
    v_min_u32_dpp v196, v244, v244 quad_perm:[2,3,0,1] row_mask:0xf bank_mask:0xf
    v_max_u32_dpp v245, v245, v245 quad_perm:[2,3,0,1] row_mask:0xf bank_mask:0xf
    v_max_u32_dpp v244, v244, v244 quad_perm:[2,3,0,1] row_mask:0xf bank_mask:0xf
    v_max_u32 v245, v245, v196
    s_nop 0
    v_min_u32_dpp v196, v244, v244 row_half_mirror row_mask:0xf bank_mask:0xf
    v_max_u32_dpp v245, v245, v245 row_half_mirror row_mask:0xf bank_mask:0xf
    v_max_u32_dpp v244, v244, v244 row_half_mirror row_mask:0xf bank_mask:0xf
    v_max_u32 v245, v245, v196
    s_nop 0
    v_min_u32_dpp v196, v244, v244 row_mirror row_mask:0xf bank_mask:0xf
    v_max_u32_dpp v245, v245, v245 row_mirror row_mask:0xf bank_mask:0xf
    v_max_u32_dpp v244, v244, v244 row_mirror row_mask:0xf bank_mask:0xf
    v_max_u32 v245, v245, v196
    ds_write_b64 v4, v[244:245]
    s_waitcnt lgkmcnt(0)
    s_barrier
    ds_read_b64 v[244:245], v5
    v_pk_add_f32 v[208:209], v[152:153], v[30:31] op_sel_hi:[1,0] neg_lo:[0,1] neg_hi:[0,1]
    v_pk_add_f32 v[210:211], v[154:155], v[30:31] op_sel_hi:[1,0] neg_lo:[0,1] neg_hi:[0,1]
    v_pk_add_f32 v[212:213], v[156:157], v[30:31] op_sel_hi:[1,0] neg_lo:[0,1] neg_hi:[0,1]
    v_pk_add_f32 v[214:215], v[158:159], v[30:31] op_sel_hi:[1,0] neg_lo:[0,1] neg_hi:[0,1]
    v_pk_add_f32 v[216:217], v[160:161], v[30:31] op_sel_hi:[1,0] neg_lo:[0,1] neg_hi:[0,1]
    v_pk_add_f32 v[218:219], v[162:163], v[30:31] op_sel_hi:[1,0] neg_lo:[0,1] neg_hi:[0,1]
    v_pk_add_f32 v[220:221], v[164:165], v[30:31] op_sel_hi:[1,0] neg_lo:[0,1] neg_hi:[0,1]
    v_pk_add_f32 v[222:223], v[166:167], v[30:31] op_sel_hi:[1,0] neg_lo:[0,1] neg_hi:[0,1]
    s_waitcnt lgkmcnt(0)
    v_min_u32_dpp v196, v244, v244 quad_perm:[1,0,3,2] row_mask:0xf bank_mask:0xf
    v_max_u32_dpp v245, v245, v245 quad_perm:[1,0,3,2] row_mask:0xf bank_mask:0xf
    v_max_u32_dpp v244, v244, v244 quad_perm:[1,0,3,2] row_mask:0xf bank_mask:0xf
    v_max_u32 v245, v245, v196
    s_nop 0
    v_min_u32_dpp v196, v244, v244 quad_perm:[2,3,0,1] row_mask:0xf bank_mask:0xf
    v_max_u32_dpp v245, v245, v245 quad_perm:[2,3,0,1] row_mask:0xf bank_mask:0xf
    v_max_u32_dpp v244, v244, v244 quad_perm:[2,3,0,1] row_mask:0xf bank_mask:0xf
    v_max_u32 v245, v245, v196
    s_nop 0
    v_min_u32_dpp v196, v244, v244 row_half_mirror row_mask:0xf bank_mask:0xf
    v_max_u32_dpp v245, v245, v245 row_half_mirror row_mask:0xf bank_mask:0xf
    v_max_u32_dpp v244, v244, v244 row_half_mirror row_mask:0xf bank_mask:0xf
    v_max_u32 v245, v245, v196
    v_cmp_eq_u32 s[88:89], v32, v245
    v_cmp_eq_u32 vcc, v32, v244
    v_or_b32 v246, 1, v245
    v_mov_b32 v245, s4
    v_mov_b32 v247, s4
    s_or_b64 s[84:85], vcc, s[88:89]
    s_cmp_lg_u32 s3, 0
    s_cbranch_scc1 L_NOF
    s_mov_b64 exec, 0xffff
    buffer_store_dwordx4 v[244:247], v6, s[32:35], s16 offen sc1
    s_mov_b64 exec, -1
L_NOF:
    s_cmp_eq_u64 s[84:85], 0
    s_cbranch_scc1 L_NOPR
    s_setprio 1
L_NOPR:
    s_lshl4_add_u32 s13, s3, 156288
    v_mov_b32 v4, s13
    v_and_b32 v5, 7, v1
    v_lshlrev_b32 v5, 4, v5
    v_add_u32 v5, 156288, v5
    s_load_dwordx8 s[24:31], s[32:33], s92 offset:2560 glc
    v_cvt_pk_bf16_f32 v208, 0, v208
    v_cvt_pk_bf16_f32 v209, 0, v209
    v_cvt_pk_bf16_f32 v210, 0, v210
    v_cvt_pk_bf16_f32 v211, 0, v211
    v_cvt_pk_bf16_f32 v212, 0, v212
    v_cvt_pk_bf16_f32 v213, 0, v213
    v_cvt_pk_bf16_f32 v214, 0, v214
    v_cvt_pk_bf16_f32 v215, 0, v215
    v_cvt_pk_bf16_f32 v216, 0, v216
    v_cvt_pk_bf16_f32 v217, 0, v217
    v_cvt_pk_bf16_f32 v218, 0, v218
    v_cvt_pk_bf16_f32 v219, 0, v219
    v_cvt_pk_bf16_f32 v220, 0, v220
    v_cvt_pk_bf16_f32 v221, 0, v221
    v_cvt_pk_bf16_f32 v222, 0, v222
    v_cvt_pk_bf16_f32 v223, 0, v223
    v_pk_mul_f32 v[208:209], v[30:31], v[208:209] op_sel:[1,0]
    v_pk_mul_f32 v[210:211], v[30:31], v[210:211] op_sel:[1,0]
    v_pk_mul_f32 v[212:213], v[30:31], v[212:213] op_sel:[1,0]
    v_pk_mul_f32 v[214:215], v[30:31], v[214:215] op_sel:[1,0]
    v_pk_mul_f32 v[216:217], v[30:31], v[216:217] op_sel:[1,0]
    v_pk_mul_f32 v[218:219], v[30:31], v[218:219] op_sel:[1,0]
    v_pk_mul_f32 v[220:221], v[30:31], v[220:221] op_sel:[1,0]
    v_pk_mul_f32 v[222:223], v[30:31], v[222:223] op_sel:[1,0]
    v_cvt_pk_bf16_f32 v208, 0, v208
    v_cvt_pk_bf16_f32 v209, 0, v209
    v_cvt_pk_bf16_f32 v210, 0, v210
    v_cvt_pk_bf16_f32 v211, 0, v211
    v_cvt_pk_bf16_f32 v212, 0, v212
    v_cvt_pk_bf16_f32 v213, 0, v213
    v_cvt_pk_bf16_f32 v214, 0, v214
    v_cvt_pk_bf16_f32 v215, 0, v215
    v_cvt_pk_bf16_f32 v216, 0, v216
    v_cvt_pk_bf16_f32 v217, 0, v217
    v_cvt_pk_bf16_f32 v218, 0, v218
    v_cvt_pk_bf16_f32 v219, 0, v219
    v_cvt_pk_bf16_f32 v220, 0, v220
    v_cvt_pk_bf16_f32 v221, 0, v221
    v_cvt_pk_bf16_f32 v222, 0, v222
    v_cvt_pk_bf16_f32 v223, 0, v223
    v_pk_mul_f32 v[208:209], v[208:209], v[168:169]
    v_pk_mul_f32 v[210:211], v[210:211], v[170:171]
    v_pk_mul_f32 v[212:213], v[212:213], v[172:173]
    v_pk_mul_f32 v[214:215], v[214:215], v[174:175]
    v_pk_mul_f32 v[216:217], v[216:217], v[176:177]
    v_pk_mul_f32 v[218:219], v[218:219], v[178:179]
    v_pk_mul_f32 v[220:221], v[220:221], v[180:181]
    v_pk_mul_f32 v[222:223], v[222:223], v[182:183]
    v_cvt_pk_bf16_f32 v208, 0, v208
    v_cvt_pk_bf16_f32 v209, 0, v209
    v_cvt_pk_bf16_f32 v210, 0, v210
    v_cvt_pk_bf16_f32 v211, 0, v211
    v_cvt_pk_bf16_f32 v212, 0, v212
    v_cvt_pk_bf16_f32 v213, 0, v213
    v_cvt_pk_bf16_f32 v214, 0, v214
    v_cvt_pk_bf16_f32 v215, 0, v215
    v_cvt_pk_bf16_f32 v216, 0, v216
    v_cvt_pk_bf16_f32 v217, 0, v217
    v_cvt_pk_bf16_f32 v218, 0, v218
    v_cvt_pk_bf16_f32 v219, 0, v219
    v_cvt_pk_bf16_f32 v220, 0, v220
    v_cvt_pk_bf16_f32 v221, 0, v221
    v_cvt_pk_bf16_f32 v222, 0, v222
    v_cvt_pk_bf16_f32 v223, 0, v223
    v_pk_add_f32 v[208:209], v[208:209], v[88:89]
    v_pk_add_f32 v[210:211], v[210:211], v[90:91]
    v_pk_add_f32 v[212:213], v[212:213], v[92:93]
    v_pk_add_f32 v[214:215], v[214:215], v[94:95]
    v_pk_add_f32 v[216:217], v[216:217], v[96:97]
    v_pk_add_f32 v[218:219], v[218:219], v[98:99]
    v_pk_add_f32 v[220:221], v[220:221], v[100:101]
    v_pk_add_f32 v[222:223], v[222:223], v[102:103]
    v_cvt_pk_bf16_f32 v224, v208, v209
    v_cvt_pk_bf16_f32 v225, v210, v211
    v_cvt_pk_bf16_f32 v226, v212, v213
    v_cvt_pk_bf16_f32 v227, v214, v215
    v_cvt_pk_bf16_f32 v228, v216, v217
    v_cvt_pk_bf16_f32 v229, v218, v219
    v_cvt_pk_bf16_f32 v230, v220, v221
    v_cvt_pk_bf16_f32 v231, v222, v223
    s_cmp_eq_u64 s[84:85], 0
    s_cbranch_scc1 L_NOCAND
    v_mfma_f32_16x16x32_bf16 v[240:243], v[184:187], v[224:227], 0
    v_mfma_f32_16x16x32_bf16 v[240:243], v[188:191], v[228:231], v[240:243]
    v_mov_b32 v232, v224
    v_mov_b32 v233, v225
    v_mov_b32 v234, v226
    v_mov_b32 v235, v227
    v_mov_b32 v236, v228
    v_mov_b32 v237, v229
    v_mov_b32 v238, v230
    v_mov_b32 v239, v231
    s_lshl_b32 s96, s21, 14
    s_lshl_b32 s97, s12, 9
    s_add_u32 s98, s96, s97
    s_add_u32 s15, s98, 13631488
    v_lshrrev_b32 v7, 4, v1
    v_lshlrev_b32 v7, 4, v7
    v_add_u32 v8, 8192, v7
    v_permlane32_swap_b32 v232, v234
    v_permlane32_swap_b32 v233, v235
    v_permlane32_swap_b32 v236, v238
    v_permlane32_swap_b32 v237, v239
    v_permlane32_swap_b32 v12, v14
    v_permlane32_swap_b32 v13, v15
    v_permlane32_swap_b32 v16, v18
    v_permlane32_swap_b32 v17, v19
    v_cndmask_b32 v7, v7, v8, s[88:89]
    s_mov_b64 exec, s[84:85]
    buffer_store_dwordx4 v[232:235], v7, s[32:35], s15 offen sc1
    buffer_store_dwordx4 v[236:239], v7, s[32:35], s15 offen offset:64 sc1
    s_mov_b32 exec_hi, 0
    s_and_b32 exec_lo, s84, 0xffff
    buffer_store_dword v243, v7, s[32:35], s15 offen offset:256 sc1
    s_mov_b64 exec, s[84:85]
    buffer_store_dwordx4 v[12:15], v7, s[32:35], s15 offen offset:128 sc1
    buffer_store_dwordx4 v[16:19], v7, s[32:35], s15 offen offset:192 sc1
    s_mov_b64 exec, -1
    s_setprio 0
L_NOCAND:
    s_add_u32 s82, s81, 8192
    s_lshl2_add_u32 m0, s83, 67584
    s_nop 0
    buffer_load_dwordx4 v253, s[60:63], s82 offen nt lds
    s_add_u32 s82, s81, 12288
    s_lshl2_add_u32 m0, s83, 68608
    s_nop 0
    buffer_load_dwordx4 v253, s[60:63], s82 offen nt lds
    v_lshlrev_b32 v208, 16, v224
    v_and_b32 v209, s6, v224
    v_lshlrev_b32 v210, 16, v225
    v_and_b32 v211, s6, v225
    v_lshlrev_b32 v212, 16, v226
    v_and_b32 v213, s6, v226
    v_lshlrev_b32 v214, 16, v227
    v_and_b32 v215, s6, v227
    v_lshlrev_b32 v216, 16, v228
    v_and_b32 v217, s6, v228
    v_lshlrev_b32 v218, 16, v229
    v_and_b32 v219, s6, v229
    v_lshlrev_b32 v220, 16, v230
    v_and_b32 v221, s6, v230
    v_lshlrev_b32 v222, 16, v231
    v_and_b32 v223, s6, v231
    v_pk_mul_f32 v[208:209], v[208:209], v[104:105]
    v_pk_mul_f32 v[210:211], v[210:211], v[106:107]
    v_pk_mul_f32 v[212:213], v[212:213], v[108:109]
    v_pk_mul_f32 v[214:215], v[214:215], v[110:111]
    v_pk_mul_f32 v[216:217], v[216:217], v[112:113]
    v_pk_mul_f32 v[218:219], v[218:219], v[114:115]
    v_pk_mul_f32 v[220:221], v[220:221], v[116:117]
    v_pk_mul_f32 v[222:223], v[222:223], v[118:119]
    v_cvt_pk_bf16_f32 v208, 0, v208
    v_cvt_pk_bf16_f32 v209, 0, v209
    v_cvt_pk_bf16_f32 v210, 0, v210
    v_cvt_pk_bf16_f32 v211, 0, v211
    v_cvt_pk_bf16_f32 v212, 0, v212
    v_cvt_pk_bf16_f32 v213, 0, v213
    v_cvt_pk_bf16_f32 v214, 0, v214
    v_cvt_pk_bf16_f32 v215, 0, v215
    v_cvt_pk_bf16_f32 v216, 0, v216
    v_cvt_pk_bf16_f32 v217, 0, v217
    v_cvt_pk_bf16_f32 v218, 0, v218
    v_cvt_pk_bf16_f32 v219, 0, v219
    v_cvt_pk_bf16_f32 v220, 0, v220
    v_cvt_pk_bf16_f32 v221, 0, v221
    v_cvt_pk_bf16_f32 v222, 0, v222
    v_cvt_pk_bf16_f32 v223, 0, v223
    s_branch SCHK_43
SPOLL_42:
    s_load_dwordx8 s[24:31], s[32:33], s92 offset:2560 glc
SCHK_43:
    s_add_u32 s5, s5, 1
    s_cmp_ge_u32 s5, 200000
    s_waitcnt lgkmcnt(0)
    s_cbranch_scc1 SDONE_44
    s_cmp_lg_u32 s25, s4
    s_cbranch_scc1 SPOLL_42
    s_cmp_lg_u32 s27, s4
    s_cbranch_scc1 SPOLL_42
    s_cmp_lg_u32 s29, s4
    s_cbranch_scc1 SPOLL_42
    s_cmp_lg_u32 s31, s4
    s_cbranch_scc1 SPOLL_42
SDONE_44:
    s_min_u32 s25, s24, s28
    s_min_u32 s27, s26, s28
    s_min_u32 s29, s24, s30
    s_max_u32 s24, s24, s28
    s_max_u32 s26, s26, s30
    s_max_u32 s27, s27, s29
    s_max_u32 s25, s25, s26
    v_mov_b32 v244, s24
    v_mov_b32 v246, s27
    v_mov_b32 v245, s25
    ds_write_b128 v4, v[244:247]
    s_waitcnt vmcnt(4)
    s_waitcnt lgkmcnt(0)
    s_barrier
    ds_read_b128 v[244:247], v5
    v_and_b32 v8, 8, v1
    v_cmp_eq_u32 s[22:23], 0, v8
    v_cmp_gt_u32 s[24:25], 16, v1
    v_cmp_gt_u32 s[26:27], 32, v1
    s_waitcnt lgkmcnt(0)
    v_min_u32_dpp v192, v244, v244 quad_perm:[1,0,3,2] row_mask:0xf bank_mask:0xf
    v_min_u32_dpp v193, v245, v244 quad_perm:[1,0,3,2] row_mask:0xf bank_mask:0xf
    v_min_u32_dpp v194, v244, v245 quad_perm:[1,0,3,2] row_mask:0xf bank_mask:0xf
    v_max_u32_dpp v246, v246, v246 quad_perm:[1,0,3,2] row_mask:0xf bank_mask:0xf
    v_max_u32_dpp v245, v245, v245 quad_perm:[1,0,3,2] row_mask:0xf bank_mask:0xf
    v_max_u32_dpp v244, v244, v244 quad_perm:[1,0,3,2] row_mask:0xf bank_mask:0xf
    v_max3_u32 v246, v246, v193, v194
    v_max_u32 v245, v245, v192
    v_min_u32_dpp v192, v244, v244 quad_perm:[2,3,0,1] row_mask:0xf bank_mask:0xf
    s_nop 0
    v_min_u32_dpp v193, v245, v244 quad_perm:[2,3,0,1] row_mask:0xf bank_mask:0xf
    v_min_u32_dpp v194, v244, v245 quad_perm:[2,3,0,1] row_mask:0xf bank_mask:0xf
    v_max_u32_dpp v246, v246, v246 quad_perm:[2,3,0,1] row_mask:0xf bank_mask:0xf
    v_max_u32_dpp v245, v245, v245 quad_perm:[2,3,0,1] row_mask:0xf bank_mask:0xf
    v_max_u32_dpp v244, v244, v244 quad_perm:[2,3,0,1] row_mask:0xf bank_mask:0xf
    v_max3_u32 v246, v246, v193, v194
    v_max_u32 v245, v245, v192
    v_min_u32_dpp v192, v244, v244 row_half_mirror row_mask:0xf bank_mask:0xf
    s_nop 0
    v_min_u32_dpp v193, v245, v244 row_half_mirror row_mask:0xf bank_mask:0xf
    v_min_u32_dpp v194, v244, v245 row_half_mirror row_mask:0xf bank_mask:0xf
    v_max_u32_dpp v246, v246, v246 row_half_mirror row_mask:0xf bank_mask:0xf
    v_max_u32_dpp v245, v245, v245 row_half_mirror row_mask:0xf bank_mask:0xf
    v_max_u32_dpp v244, v244, v244 row_half_mirror row_mask:0xf bank_mask:0xf
    v_max3_u32 v246, v246, v193, v194
    v_max_u32 v245, v245, v192
    v_cndmask_b32 v192, v245, v244, s[22:23]
    v_cndmask_b32 v201, v246, v245, s[26:27]
    v_and_b32 v193, 31, v246
    v_and_b32 v192, 31, v192
    v_cndmask_b32 v201, v201, v244, s[24:25]
    v_lshl_add_u32 v4, v192, 13, v52
    v_lshl_add_u32 v5, v193, 13, v52
    v_and_b32 v194, 31, v201
    v_lshl_add_u32 v6, v194, 13, v53
    buffer_load_dwordx4 v[192:195], v4, s[32:35], 0 offen sc1
    buffer_load_dwordx4 v[196:199], v5, s[32:35], 0 offen sc1
    buffer_load_dword v200, v6, s[32:35], 0 offen sc1
    v_readfirstlane_b32 s91, v244
    v_readfirstlane_b32 s94, v245
    v_readfirstlane_b32 s95, v246
    ds_read_b64_tr_b16 v[56:57], v34
    ds_read_b64_tr_b16 v[58:59], v34 offset:512
    ds_read_b64_tr_b16 v[60:61], v34 offset:1024
    ds_read_b64_tr_b16 v[62:63], v34 offset:1536
    ds_read_b64_tr_b16 v[64:65], v34 offset:2048
    ds_read_b64_tr_b16 v[66:67], v34 offset:2560
    ds_read_b64_tr_b16 v[68:69], v34 offset:3072
    ds_read_b64_tr_b16 v[70:71], v34 offset:3584
    ds_read_b64_tr_b16 v[72:73], v34 offset:4096
    ds_read_b64_tr_b16 v[74:75], v34 offset:4608
    ds_read_b64_tr_b16 v[76:77], v34 offset:5120
    ds_read_b64_tr_b16 v[78:79], v34 offset:5632
    ds_read_b64_tr_b16 v[80:81], v34 offset:6144
    ds_read_b64_tr_b16 v[82:83], v34 offset:6656
    ds_read_b64_tr_b16 v[84:85], v34 offset:7168
    ds_read_b64_tr_b16 v[86:87], v34 offset:7680
    s_lshl_b32 s96, s3, 11
    s_add_u32 s13, s96, 98304
    v_lshrrev_b32 v44, 4, v1
    v_lshlrev_b32 v44, 4, v44
    v_and_b32 v45, 7, v1
    v_lshlrev_b32 v45, 4, v45
    v_xor_b32 v44, v44, v45
    v_and_b32 v46, 15, v1
    v_lshl_add_u32 v46, v46, 7, s13
    v_add_u32 v44, v44, v46
    v_xor_b32 v46, 64, v44
    v_lshrrev_b32 v47, 3, v1
    v_lshlrev_b32 v47, 4, v47
    v_xor_b32 v45, v47, v45
    v_lshrrev_b32 v47, 3, v1
    v_lshl_add_u32 v47, v47, 7, s13
    v_add_u32 v45, v45, v47
    s_lshl_b32 s96, s21, 7
    s_sub_u32 s97, 2047, s96
    s_lshl_b32 s98, s3, 4
    s_sub_u32 s13, s97, s98
    v_lshrrev_b32 v43, 3, v1
    v_sub_u32 v42, s13, v43
    v_subrev_u32 v43, 8, v42
    v_lshrrev_b32 v33, 3, v1
    v_lshlrev_b32 v33, 11, v33
    v_and_b32 v9, 7, v1
    v_lshl_add_u32 v33, v9, 4, v33
    v_pk_add_f32 v[208:209], v[208:209], v[152:153]
    v_pk_add_f32 v[210:211], v[210:211], v[154:155]
    v_pk_add_f32 v[212:213], v[212:213], v[156:157]
    v_pk_add_f32 v[214:215], v[214:215], v[158:159]
    v_pk_add_f32 v[216:217], v[216:217], v[160:161]
    v_pk_add_f32 v[218:219], v[218:219], v[162:163]
    v_pk_add_f32 v[220:221], v[220:221], v[164:165]
    v_pk_add_f32 v[222:223], v[222:223], v[166:167]
    v_cvt_pk_bf16_f32 v232, v208, v209
    v_cvt_pk_bf16_f32 v233, v210, v211
    v_cvt_pk_bf16_f32 v234, v212, v213
    v_cvt_pk_bf16_f32 v235, v214, v215
    v_cvt_pk_bf16_f32 v236, v216, v217
    v_cvt_pk_bf16_f32 v237, v218, v219
    v_cvt_pk_bf16_f32 v238, v220, v221
    v_cvt_pk_bf16_f32 v239, v222, v223
    v_permlane32_swap_b32 v232, v234
    v_permlane32_swap_b32 v233, v235
    v_permlane32_swap_b32 v236, v238
    v_permlane32_swap_b32 v237, v239
    ds_write_b128 v44, v[232:235]
    ds_write_b128 v46, v[236:239]
    ds_read_b128 v[232:235], v45
    ds_read_b128 v[236:239], v45 offset:1024
    s_waitcnt lgkmcnt(0)
    v_bfe_u32 v7, v201, 1, 4
    v_bfe_u32 v201, v201, 5, 7
    v_lshl_or_b32 v201, v7, 7, v201
    v_xor_b32 v201, 0x7ff, v201
    s_waitcnt vmcnt(0)
    v_max3_u32 v7, v192, v196, v200
    v_cmp_eq_u32 vcc, -1, v7
    s_cbranch_vccz POK_46
PRE_47:
    buffer_load_dwordx4 v[192:195], v4, s[32:35], 0 offen sc1
    buffer_load_dwordx4 v[196:199], v5, s[32:35], 0 offen sc1
    buffer_load_dword v200, v6, s[32:35], 0 offen sc1
    s_waitcnt vmcnt(0)
    v_max3_u32 v7, v192, v196, v200
    v_cmp_eq_u32 vcc, -1, v7
    s_cbranch_vccz POK_46
    s_add_u32 s5, s5, 1
    s_cmp_lt_u32 s5, 200000
    s_cbranch_scc1 PRE_47
POK_46:
    v_add_f32_dpp v200, v200, v200 quad_perm:[1,0,3,2] row_mask:0xf bank_mask:0xf
    s_nop 1
    v_add_f32_dpp v200, v200, v200 quad_perm:[2,3,0,1] row_mask:0xf bank_mask:0xf
    s_nop 1
    v_add_f32_dpp v200, v200, v200 row_half_mirror row_mask:0xf bank_mask:0xf
    s_nop 1
    v_add_f32_dpp v200, v200, v200 row_mirror row_mask:0xf bank_mask:0xf
    v_cvt_pk_bf16_f32 v200, 0, v200
    v_ashrrev_i32 v7, 31, v200
    v_or_b32 v7, 0x80000000, v7
    v_xor_b32 v200, v200, v7
    v_lshrrev_b32 v200, 16, v200
    v_lshl_or_b32 v200, v200, 11, v201
    s_nop 0
    v_readlane_b32 s24, v200, 0
    v_readlane_b32 s25, v200, 16
    v_readlane_b32 s26, v200, 32
    s_not_b64 s[28:29], s[22:23]
    s_cmp_lt_u32 s24, s25
    s_cselect_b64 s[28:29], s[22:23], s[28:29]
    s_cselect_b32 s27, s24, s25
    s_cmp_gt_u32 s26, s27
    s_cselect_b64 vcc, s[28:29], 0
    v_cndmask_b32 v192, v192, v196, vcc
    v_cndmask_b32 v193, v193, v197, vcc
    v_cndmask_b32 v194, v194, v198, vcc
    v_cndmask_b32 v195, v195, v199, vcc
    s_bitcmp1_b32 vcc_lo, 0
    s_cselect_b32 s24, s26, s24
    s_cselect_b32 s19, s17, s19
    s_cselect_b32 s17, s95, s91
    s_bitcmp1_b32 vcc_lo, 8
    s_cselect_b32 s25, s26, s25
    s_cselect_b32 s19, s18, s19
    s_cselect_b32 s18, s95, s94
    s_waitcnt lgkmcnt(0)
    v_mfma_f32_16x16x32_bf16 v[136:139], v[192:195], v[56:59], 0
    v_mfma_f32_16x16x32_bf16 v[140:143], v[192:195], v[60:63], 0
    v_mfma_f32_16x16x32_bf16 v[144:147], v[192:195], v[64:67], 0
    v_mfma_f32_16x16x32_bf16 v[148:151], v[192:195], v[68:71], 0
    v_mfma_f32_16x16x32_bf16 v[168:171], v[192:195], v[72:75], 0
    v_mfma_f32_16x16x32_bf16 v[172:175], v[192:195], v[76:79], 0
    v_mfma_f32_16x16x32_bf16 v[176:179], v[192:195], v[80:83], 0
    v_mfma_f32_16x16x32_bf16 v[180:183], v[192:195], v[84:87], 0
    s_nop 1
    v_add_f32 v196, v136, v141
    s_nop 0
    v_add_f32 v197, v146, v151
    s_nop 0
    v_add_f32 v198, v168, v173
    s_nop 0
    v_add_f32 v199, v178, v183
    v_add_f32 v196, v196, v197
    v_add_f32 v198, v198, v199
    v_mov_b32 v197, s4
    s_nop 0
    v_permlane16_swap_b32 v198, v199
    s_cmp_ge_u32 s9, 28
    s_cbranch_scc1 L_NOHP
    v_add_f32 v196, v196, v199
    v_add_f32 v198, v196, 0
    v_mov_b32 v199, s4
    s_nop 0
    v_permlane32_swap_b32 v196, v198
    s_mov_b64 exec, 0xffff
    buffer_store_dwordx4 v[196:199], v2, s[32:35], s73 offen sc1
    s_mov_b64 exec, -1
L_NOHP:
    s_and_b32 s68, s24, 2047
    s_and_b32 s69, s25, 2047
    s_waitcnt lgkmcnt(0)
    s_cmp_lg_u32 s93, 7
    s_cbranch_scc1 L_NONON
    v_mov_b32 v6, s4
    v_mov_b32 v7, 0
    s_mov_b64 exec, 1
    buffer_store_dword v6, v7, s[32:35], 0 offen sc1
    s_mov_b64 exec, -1
L_NONON:
    s_cmp_ge_u32 s9, 28
    s_cbranch_scc1 L_FIN3
    v_bfe_u32 v192, v1, 2, 1
    v_lshlrev_b32 v192, 7, v192
    v_lshrrev_b32 v9, 5, v1
    v_lshl_add_u32 v192, v9, 4, v192
    v_add_u32 v192, 156672, v192
    v_lshrrev_b32 v193, 4, v1
    v_mul_u32_u24 v193, 7168, v193
    v_and_b32 v9, 15, v1
    v_lshl_add_u32 v193, v9, 3, v193
    s_lshl3_add_u32 s96, s75, s3
    s_mul_i32 s97, s96, 28672
    s_lshl_b32 s98, s74, 7
    s_add_u32 s99, s97, s98
    s_add_u32 s80, s99, 22020096
    v_and_b32 v194, 1, v1
    v_lshlrev_b32 v194, 13, v194
    v_bfe_u32 v9, v1, 1, 1
    v_lshl_add_u32 v194, v9, 18, v194
    s_lshr_b32 s96, s9, 2
    s_and_b32 s97, s75, 1
    s_lshr_b32 s98, s3, 1
    s_lshl2_add_u32 s99, s97, s98
    s_and_b32 s97, s3, 1
    s_lshr_b32 s98, s75, 1
    s_lshl2_add_u32 s97, s97, s98
    s_lshl3_add_u32 s98, s99, s97
    s_lshl_b32 s99, s98, 12
    s_lshl_b32 s97, s8, 6
    s_add_u32 s98, s99, s97
    s_lshl2_add_u32 s99, s96, s98
    s_add_u32 s97, s99, 1048576
    s_add_u32 s81, s97, 3072
    s_cmp_lt_u32 s3, 4
    s_cbranch_scc1 L_HW
    s_barrier
    ds_read_b64_tr_b16 v[120:121], v35
    ds_read_b64_tr_b16 v[122:123], v35 offset:1024
    ds_read_b64_tr_b16 v[124:125], v35 offset:8192
    ds_read_b64_tr_b16 v[126:127], v35 offset:9216
    ds_read_b64_tr_b16 v[128:129], v35 offset:16384
    ds_read_b64_tr_b16 v[130:131], v35 offset:17408
    ds_read_b64_tr_b16 v[132:133], v35 offset:24576
    ds_read_b64_tr_b16 v[134:135], v35 offset:25600
    s_cmp_lg_u32 s3, 7
    s_cbranch_scc1 L_NOH
    s_bitcmp1_b32 s9, 3
    s_cselect_b32 s15, s25, s24
    s_cselect_b32 s17, s18, s17
    s_andn2_b32 s18, 2047, s15
    s_lshr_b32 s96, s8, 1
    s_lshl2_add_u32 s19, s12, s96
    s_lshr_b32 s96, s19, 1
    s_lshr_b32 s97, s9, 3
    s_lshl_b32 s98, s97, 1
    s_lshl2_add_u32 s99, s96, s98
    s_and_b32 s97, s19, 1
    s_add_u32 s96, s99, s97
    s_mul_i32 s98, s96, 7168
    s_add_u32 s20, s98, 22020096
    s_lshl_b32 s96, s18, 11
    s_lshl_b32 s97, s19, 5
    s_add_u32 s82, s96, s97
    v_and_b32 v10, 7, v1
    v_lshlrev_b32 v10, 2, v10
    s_lshr_b32 s96, s8, 1
    s_lshl_b32 s97, s96, 6
    s_add_u32 s13, s97, 157184
    v_and_b32 v5, 7, v1
    v_lshl_add_u32 v5, v5, 3, s13
    ds_read_b64 v[206:207], v5
    s_and_b32 s96, s17, 31
    s_lshl_b32 s97, s96, 13
    s_lshl_b32 s98, s12, 9
    s_add_u32 s99, s97, s98
    s_lshr_b32 s96, s8, 1
    s_lshl_b32 s97, s96, 5
    s_add_u32 s98, s99, s97
    s_add_u32 s91, s98, 13631488
    s_lshr_b32 s13, s15, 11
    s_lshl_b32 s13, s13, 16
    s_ashr_i32 s15, s13, 31
    s_andn2_b32 s15, 0x7fff0000, s15
    s_or_b32 s15, s15, 0x80000000
    s_xor_b32 s13, s13, s15
    v_mov_b32 v204, s13
    v_mul_f32 v204, s7, v204
    v_exp_f32 v204, -v204
    s_nop 0
    v_add_f32 v204, 1.0, v204
    v_rcp_f32 v204, v204
L_PAD10:
    s_cbranch_execz L_RET10
    s_nop 0
    v_cvt_pk_bf16_f32 v204, 0, v204
    v_mov_b32 v5, s4
    v_not_b32 v6, v5
POLL_48:
    buffer_load_dword v244, v10, s[32:35], s91 offen sc1
    buffer_load_dword v245, v10, s[32:35], s91 offen offset:128 sc1
    s_waitcnt vmcnt(0)
    v_max_u32 v246, v244, v245
    v_cmp_ne_u32 vcc, -1, v246
    s_nop 1
    v_cndmask_b32 v246, v6, v5, vcc
    v_cmp_ne_u32 vcc, s4, v246
    s_cbranch_vccz PDONE_49
    s_add_u32 s5, s5, 1
    s_cmp_lt_u32 s5, 200000
    s_cbranch_scc1 POLL_48
PDONE_49:
    v_lshlrev_b32 v246, 16, v245
    v_and_b32 v247, s6, v245
    v_and_b32 v245, s6, v244
    v_lshlrev_b32 v244, 16, v244
    s_branch L_NOH
L_HW:
    s_lshl_b32 s96, s3, 8
    s_add_u32 s13, s96, s72
    v_lshrrev_b32 v4, 4, v1
    v_lshlrev_b32 v4, 11, v4
    v_and_b32 v9, 15, v1
    v_lshl_add_u32 v4, v9, 4, v4
    s_lshl_b32 s96, s3, 5
    s_add_u32 s15, s96, 156672
    v_lshrrev_b32 v5, 5, v1
    v_lshl_add_u32 v5, v5, 7, s15
    v_bfe_u32 v9, v1, 2, 1
    v_lshl_add_u32 v5, v9, 4, v5
    v_bfe_u32 v9, v1, 1, 1
    v_lshl_add_u32 v5, v9, 3, v5
    v_bfe_u32 v9, v1, 3, 1
    v_lshl_add_u32 v5, v9, 2, v5
    v_and_b32 v9, 1, v1
    v_lshl_add_u32 v5, v9, 1, v5
    s_load_dword s24, s[32:33], s13 offset:1276 glc
    s_load_dword s25, s[32:33], s13 offset:3324 glc
    s_load_dword s26, s[32:33], s13 offset:5372 glc
    s_load_dword s27, s[32:33], s13 offset:7420 glc
    s_barrier
    ds_read_b64_tr_b16 v[120:121], v35
    ds_read_b64_tr_b16 v[122:123], v35 offset:1024
    ds_read_b64_tr_b16 v[124:125], v35 offset:8192
    ds_read_b64_tr_b16 v[126:127], v35 offset:9216
    ds_read_b64_tr_b16 v[128:129], v35 offset:16384
    ds_read_b64_tr_b16 v[130:131], v35 offset:17408
    ds_read_b64_tr_b16 v[132:133], v35 offset:24576
    ds_read_b64_tr_b16 v[134:135], v35 offset:25600
    s_branch SCHK_51
SPOLL_50:
    s_load_dword s24, s[32:33], s13 offset:1276 glc
    s_load_dword s25, s[32:33], s13 offset:3324 glc
    s_load_dword s26, s[32:33], s13 offset:5372 glc
    s_load_dword s27, s[32:33], s13 offset:7420 glc
SCHK_51:
    s_add_u32 s5, s5, 1
    s_cmp_ge_u32 s5, 200000
    s_waitcnt lgkmcnt(0)
    s_cbranch_scc1 SDONE_52
    s_cmp_lg_u32 s24, s4
    s_cbranch_scc1 SPOLL_50
    s_cmp_lg_u32 s25, s4
    s_cbranch_scc1 SPOLL_50
    s_cmp_lg_u32 s26, s4
    s_cbranch_scc1 SPOLL_50
    s_cmp_lg_u32 s27, s4
    s_cbranch_scc1 SPOLL_50
SDONE_52:
POLL_53:
    buffer_load_dwordx4 v[88:91], v4, s[32:35], s13 offen sc1
    buffer_load_dwordx4 v[92:95], v4, s[32:35], s13 offen offset:1024 sc1
    s_waitcnt vmcnt(0)
    v_bitop3_b32 v6, v89, v91, s4 bitop3:0x7e
    v_bitop3_b32 v6, v6, v93, s4 bitop3:0xf6
    v_bitop3_b32 v6, v6, v95, s4 bitop3:0xf6
    v_cmp_ne_u32 vcc, 0, v6
    s_cbranch_vccz PDONE_54
    s_add_u32 s5, s5, 1
    s_cmp_lt_u32 s5, 200000
    s_cbranch_scc1 POLL_53
PDONE_54:
    v_permlane32_swap_b32 v88, v90
    v_permlane32_swap_b32 v92, v94
    v_add_f32 v88, v88, v90
    v_add_f32 v92, v92, v94
    v_mov_b32 v90, v88
    v_mov_b32 v94, v92
    s_nop 0
    v_permlane16_swap_b32 v88, v90
    v_permlane16_swap_b32 v92, v94
    v_add_f32 v88, v88, v90
    v_add_f32 v92, v92, v94
    v_cvt_pk_bf16_f32 v88, 0, v88
    v_cvt_pk_bf16_f32 v92, 0, v92
    v_mul_f32 v6, s7, v88
    v_exp_f32 v6, -v6
    s_nop 0
    v_add_f32 v6, 1.0, v6
    v_rcp_f32 v6, v6
    s_nop 0
    v_mul_f32 v88, v88, v6
    v_cvt_pk_bf16_f32 v88, 0, v88
    v_mul_f32 v88, v88, v92
    v_cvt_pk_bf16_f32 v88, v88, v88
    ds_write_b16 v5, v88
L_NOH:
    s_waitcnt lgkmcnt(0)
    s_barrier
    ds_read_b128 v[88:91], v192
    ds_read_b128 v[92:95], v192 offset:32
    ds_read_b128 v[96:99], v192 offset:64
    ds_read_b128 v[100:103], v192 offset:96
    s_waitcnt lgkmcnt(3)
    v_mfma_f32_32x32x16_bf16 v[208:223], v[88:91], v[120:123], 0
    s_waitcnt lgkmcnt(2)
    v_mfma_f32_32x32x16_bf16 v[208:223], v[92:95], v[124:127], v[208:223]
    s_waitcnt lgkmcnt(1)
    v_mfma_f32_32x32x16_bf16 v[208:223], v[96:99], v[128:131], v[208:223]
    s_waitcnt lgkmcnt(0)
    v_mfma_f32_32x32x16_bf16 v[208:223], v[100:103], v[132:135], v[208:223]
    s_nop 11
    v_mov_b32 v209, s4
    buffer_store_dwordx2 v[208:209], v193, s[32:35], s80 offen sc1
    s_mov_b64 exec, 15
    buffer_store_dword v209, v194, s[32:35], s81 offen sc1
    s_mov_b64 exec, -1
    s_barrier
    s_branch L_FIN2
L_FIN3:
    s_waitcnt lgkmcnt(0)
L_FIN2:
    v_cmp_ne_u32 vcc, s68, v42
    v_cmp_ne_u32 s[22:23], s69, v42
    s_nop 0
    s_and_b64 exec, vcc, s[22:23]
    buffer_store_dwordx4 v[232:235], v33, s[64:67], s70 offen sc1
    s_mov_b64 exec, -1
    v_cmp_ne_u32 vcc, s68, v43
    v_cmp_ne_u32 s[22:23], s69, v43
    s_nop 0
    s_and_b64 exec, vcc, s[22:23]
    buffer_store_dwordx4 v[236:239], v33, s[64:67], s71 offen sc1
    s_mov_b64 exec, -1
    s_cmp_ge_u32 s9, 16
    s_cbranch_scc1 L_FIN
SPOLL_55:
    s_load_dwordx8 s[24:31], s[32:33], s92 offset:3072 glc
SCHK_56:
    s_add_u32 s5, s5, 1
    s_cmp_ge_u32 s5, 200000
    s_waitcnt lgkmcnt(0)
    s_cbranch_scc1 SDONE_57
    s_cmp_lg_u32 s24, s4
    s_cbranch_scc1 SPOLL_55
    s_cmp_lg_u32 s25, s4
    s_cbranch_scc1 SPOLL_55
    s_cmp_lg_u32 s26, s4
    s_cbranch_scc1 SPOLL_55
    s_cmp_lg_u32 s27, s4
    s_cbranch_scc1 SPOLL_55
    s_cmp_lg_u32 s28, s4
    s_cbranch_scc1 SPOLL_55
    s_cmp_lg_u32 s29, s4
    s_cbranch_scc1 SPOLL_55
    s_cmp_lg_u32 s30, s4
    s_cbranch_scc1 SPOLL_55
SDONE_57:
    s_barrier
    s_cmp_lg_u32 s3, 7
    s_cbranch_scc1 L_FIN
    s_add_u32 s13, s20, 4096
POLL_58:
    buffer_load_dwordx4 v[88:91], v2, s[32:35], s20 offen sc1
    buffer_load_dwordx4 v[92:95], v2, s[32:35], s20 offen offset:1024 sc1
    buffer_load_dwordx4 v[96:99], v2, s[32:35], s20 offen offset:2048 sc1
    buffer_load_dwordx4 v[100:103], v2, s[32:35], s20 offen offset:3072 sc1
    buffer_load_dwordx4 v[104:107], v2, s[32:35], s13 offen sc1
    buffer_load_dwordx4 v[108:111], v2, s[32:35], s13 offen offset:1024 sc1
    buffer_load_dwordx4 v[112:115], v2, s[32:35], s13 offen offset:2048 sc1
    s_waitcnt vmcnt(0)
    v_bitop3_b32 v4, v89, v91, s4 bitop3:0x7e
    v_bitop3_b32 v4, v4, v93, s4 bitop3:0xf6
    v_bitop3_b32 v4, v4, v95, s4 bitop3:0xf6
    v_bitop3_b32 v4, v4, v97, s4 bitop3:0xf6
    v_bitop3_b32 v4, v4, v99, s4 bitop3:0xf6
    v_bitop3_b32 v4, v4, v101, s4 bitop3:0xf6
    v_bitop3_b32 v4, v4, v103, s4 bitop3:0xf6
    v_bitop3_b32 v4, v4, v105, s4 bitop3:0xf6
    v_bitop3_b32 v4, v4, v107, s4 bitop3:0xf6
    v_bitop3_b32 v4, v4, v109, s4 bitop3:0xf6
    v_bitop3_b32 v4, v4, v111, s4 bitop3:0xf6
    v_bitop3_b32 v4, v4, v113, s4 bitop3:0xf6
    v_bitop3_b32 v4, v4, v115, s4 bitop3:0xf6
    v_cmp_ne_u32 vcc, 0, v4
    s_cbranch_vccz PDONE_59
    s_add_u32 s5, s5, 1
    s_cmp_lt_u32 s5, 200000
    s_cbranch_scc1 POLL_58
PDONE_59:
    v_add_f32 v88, v88, v92
    v_add_f32 v90, v90, v94
    v_add_f32 v96, v96, v100
    v_add_f32 v98, v98, v102
    v_add_f32 v104, v104, v108
    v_add_f32 v106, v106, v110
    v_add_f32 v88, v88, v96
    v_add_f32 v90, v90, v98
    v_add_f32 v104, v104, v112
    v_add_f32 v106, v106, v114
    v_add_f32 v88, v88, v104
    v_add_f32 v89, v90, v106
    s_nop 1
    v_permlane32_swap_b32 v88, v89
    v_add_f32 v88, v88, v89
    s_nop 1
    v_add_f32_dpp v88, v88, v88 row_ror:8 row_mask:0xf bank_mask:0xf
    v_mov_b32 v89, v88
    s_nop 1
    v_permlane16_swap_b32 v88, v89
    v_add_f32 v89, v88, v89
    v_cvt_pk_bf16_f32 v88, 0, v89
    v_cvt_pk_bf16_f32 v89, 0, v89
    s_nop 1
    v_permlane32_swap_b32 v88, v89
    v_pk_mul_f32 v[88:89], v[88:89], v[204:205] op_sel_hi:[1,0]
    v_cvt_pk_bf16_f32 v88, 0, v88
    v_cvt_pk_bf16_f32 v89, 0, v89
    v_pk_add_f32 v[88:89], v[88:89], v[244:245]
    v_cvt_pk_bf16_f32 v88, 0, v88
    v_cvt_pk_bf16_f32 v89, 0, v89
    v_pk_mul_f32 v[88:89], v[88:89], v[206:207]
    v_cvt_pk_bf16_f32 v88, 0, v88
    v_cvt_pk_bf16_f32 v89, 0, v89
    v_pk_add_f32 v[88:89], v[88:89], v[246:247]
    v_cvt_pk_bf16_f32 v88, v88, v89
    s_mov_b64 exec, 0xff
    buffer_store_dword v88, v10, s[64:67], s82 offen
    s_mov_b64 exec, -1
L_FIN:
L_END:
    s_endpgm
.p2align 10
.fill 768, 4, 0xbf800000
.section .rodata,"a"
.p2align 6
.amdhsa_kernel adaLN_cond__linear_kernel_hedgehog__moe_arch_mod__prompt_kernel
  .amdhsa_next_free_vgpr 256
  .amdhsa_next_free_sgpr 102
  .amdhsa_accum_offset 256
  .amdhsa_group_segment_fixed_size 0
  .amdhsa_kernarg_size 112
  .amdhsa_user_sgpr_count 2
  .amdhsa_user_sgpr_kernarg_segment_ptr 1
  .amdhsa_system_sgpr_workgroup_id_x 1
  .amdhsa_float_denorm_mode_32 3
  .amdhsa_float_denorm_mode_16_64 3
.end_amdhsa_kernel
```

```asm
; @launch grid=(256,1,1) block=(512,1,1) lds=163840
.amdgcn_target "amdgcn-amd-amdhsa--gfx950"
.text
.globl adaLN_cond__linear_kernel_hedgehog__moe_arch_mod__prompt_kernel
.p2align 12
.type adaLN_cond__linear_kernel_hedgehog__moe_arch_mod__prompt_kernel,@function
adaLN_cond__linear_kernel_hedgehog__moe_arch_mod__prompt_kernel:
    s_load_dwordx16 s[68:83], s[0:1], 0
    s_load_dwordx8 s[84:91], s[0:1], 64
    s_load_dwordx2 s[32:33], s[0:1], 104
    s_cmp_ge_u32 s2, 256
    s_cbranch_scc1 L_END
    v_lshrrev_b32 v4, 6, v0
    v_and_b32 v1, 63, v0
    s_nop 0
    v_readfirstlane_b32 s3, v4
    v_lshlrev_b32 v2, 4, v1
    s_mov_b32 s38, 4194304
    s_mov_b32 s39, 0x20000
    s_mov_b32 s50, 12582912
    s_mov_b32 s51, 0x20000
    s_mov_b32 s34, 268435456
    s_mov_b32 s35, 0x20000
    s_mov_b32 s42, 6291456
    s_mov_b32 s43, 0x20000
    s_mov_b32 s46, 2097152
    s_mov_b32 s47, 0x20000
    s_mov_b32 s54, 7340032
    s_mov_b32 s55, 0x20000
    s_mov_b32 s58, 7340032
    s_mov_b32 s59, 0x20000
    s_mov_b32 s62, 7340032
    s_mov_b32 s63, 0x20000
    s_mov_b32 s66, 4194304
    s_mov_b32 s67, 0x20000
    s_mov_b32 s5, 0
    s_mov_b32 s6, 0xffff0000
    s_mov_b32 s7, 0x3fb8aa3b
    s_and_b32 s8, s2, 7
    s_lshr_b32 s9, s2, 3
    s_lshl3_add_u32 s93, s2, s3
    s_and_b32 s96, s8, 4
    s_lshr_b32 s97, s9, 2
    s_lshl1_add_u32 s10, s96, s97
    s_and_b32 s96, s8, 3
    s_and_b32 s97, s9, 3
    s_xor_b32 s98, s97, 2
    s_lshl2_add_u32 s11, s96, s98
    s_and_b32 s96, s8, 1
    s_and_b32 s97, s9, 7
    s_lshl3_add_u32 s12, s96, s97
    s_lshr_b32 s96, s8, 1
    s_lshr_b32 s97, s9, 3
    s_lshl2_add_u32 s21, s96, s97
    s_lshl_b32 s96, s2, 6
    s_add_u32 s97, s96, s3
    s_lshl_b32 s98, s97, 6
    s_add_u32 s92, s98, 1048576
    s_lshr_b32 s96, s8, 1
    s_lshl_b32 s97, s96, 8
    s_lshl3_add_u32 s98, s9, s97
    s_add_u32 s99, s98, s3
    s_lshl_b32 s96, s99, 12
    s_and_b32 s97, s8, 1
    s_lshl_b32 s98, s97, 10
    s_add_u32 s16, s96, s98
    v_and_b32 v8, 31, v1
    v_lshlrev_b32 v8, 4, v8
    v_lshrrev_b32 v9, 5, v1
    v_lshl_add_u32 v8, v9, 11, v8
    s_lshl3_add_u32 s96, s8, s3
    s_lshl_b32 s15, s96, 5
    s_mul_i32 s96, s15, 6144
    s_xor_b32 s97, s9, 1
    s_lshl_b32 s98, s97, 7
    s_add_u32 s13, s96, s98
    s_add_u32 s14, s13, 12288
    s_lshl3_add_u32 s96, s21, s3
    s_lshl_b32 s97, s96, 15
    s_lshl_b32 s98, s12, 7
    s_add_u32 s18, s97, s98
    s_lshr_b32 s96, s8, 1
    s_lshl4_add_u32 s97, s96, s12
    s_lshl4_add_u32 s98, s97, s3
    s_lshl_b32 s99, s98, 9
    s_add_u32 s17, s99, 524288
    v_lshrrev_b32 v248, 3, v1
    v_mul_u32_u24 v248, 24576, v248
    v_and_b32 v9, 7, v1
    v_lshl_add_u32 v248, v9, 4, v248
    v_lshrrev_b32 v249, 3, v1
    v_lshl_add_u32 v249, v249, 2, s15
    v_and_b32 v10, 7, v1
    v_lshlrev_b32 v10, 4, v10
    v_lshrrev_b32 v11, 3, v1
    v_lshlrev_b32 v11, 4, v11
    v_xor_b32 v10, v10, v11
    v_lshrrev_b32 v11, 3, v1
    v_lshlrev_b32 v11, 11, v11
    v_add_u32 v10, v10, v11
    s_waitcnt lgkmcnt(0)
    global_load_dword v169, v249, s[86:87]
    s_mov_b64 s[48:49], s[88:89]
    buffer_load_dwordx4 v[160:163], v248, s[48:51], s13 offen nt
    buffer_load_dwordx4 v[164:167], v248, s[48:51], s14 offen nt
    s_load_dword s4, s[32:33], 0
    s_mov_b64 s[36:37], s[68:69]
    s_load_dword s24, s[32:33], s92 offset:0 glc
    s_load_dword s25, s[32:33], s17 offset:508 glc
    s_load_dword s26, s[32:33], s17 offset:4604 glc
    s_barrier
    buffer_load_dwordx4 v[152:155], v8, s[36:39], s16 offen nt
    buffer_load_dwordx4 v[156:159], v8, s[36:39], s16 offen offset:512 nt
    s_mov_b64 s[40:41], s[70:71]
    s_mov_b64 s[44:45], s[74:75]
    s_mov_b64 s[52:53], s[80:81]
    s_mov_b64 s[56:57], s[82:83]
    s_mov_b64 s[60:61], s[84:85]
    s_mov_b64 s[64:65], s[90:91]
    s_getpc_b64 s[22:23]
    s_and_b32 s22, s22, 0xfffffc00
    s_lshl3_add_u32 s96, s9, s3
    s_lshl_b32 s19, s96, 7
    v_lshrrev_b32 v4, 5, v1
    v_lshl_add_u32 v4, v4, 15, s19
    v_min_u32 v4, 41984, v4
    global_load_dword v11, v4, s[22:23]
    s_lshr_b32 s76, s3, 2
    s_and_b32 s77, s3, 3
    s_lshl_b32 s83, s3, 10
    s_mul_i32 s96, s8, 7
    s_lshr_b32 s97, s9, 2
    s_add_u32 s74, s96, s97
    s_and_b32 s75, s9, 3
    v_bfe_u32 v6, v1, 4, 1
    v_lshlrev_b32 v6, 6, v6
    v_and_b32 v3, 7, v1
    v_lshlrev_b32 v3, 4, v3
    v_xor_b32 v3, v3, v6
    v_lshrrev_b32 v6, 3, v1
    v_mul_u32_u24 v6, 6144, v6
    v_add_u32 v3, v3, v6
    s_and_b32 s84, s9, 12
    s_mul_i32 s96, s3, 49152
    s_lshl_b32 s97, s11, 7
    s_add_u32 s85, s96, s97
    v_lshlrev_b32 v250, 3, v1
    v_add_u32 v251, 147456, v2
    s_lshr_b32 s96, s3, 2
    s_lshl_b32 s97, s96, 10
    s_add_u32 s13, s97, 147456
    s_and_b32 s14, s3, 3
    v_and_b32 v252, 3, v1
    v_xor_b32 v252, s14, v252
    v_lshl_add_u32 v252, v252, 2, s13
    v_lshrrev_b32 v6, 4, v1
    v_lshlrev_b32 v6, 5, v6
    v_and_b32 v9, 7, v1
    v_lshl_add_u32 v6, v9, 7, v6
    v_bfe_u32 v9, v1, 3, 1
    v_lshl_add_u32 v6, v9, 4, v6
    v_add_u32 v252, v252, v6
    s_lshl_b32 s96, s3, 11
    s_add_u32 m0, s96, 131072
    s_nop 0
    buffer_load_dwordx4 v10, s[36:39], s18 offen lds
    s_add_u32 s18, s18, 16384
    s_lshl_b32 s96, s3, 11
    s_add_u32 m0, s96, 132096
    s_nop 0
    buffer_load_dwordx4 v10, s[36:39], s18 offen lds
    s_lshr_b32 s96, s3, 1
    s_xor_b32 s97, s9, 1
    s_and_b32 s98, s97, 15
    s_lshl4_add_u32 s99, s96, s98
    s_lshr_b32 s97, s9, 4
    s_lshl1_add_u32 s96, s99, s97
    s_lshl3_add_u32 s98, s96, s8
    s_lshl_b32 s99, s98, 9
    s_add_u32 s13, s99, 524288
    s_and_b32 s96, s9, 24
    s_add_u32 s97, s96, s3
    s_and_b32 s98, s8, 6
    s_lshl3_add_u32 s99, s97, s98
    s_lshl_b32 s96, s99, 12
    s_and_b32 s97, s9, 7
    s_lshl_b32 s98, s97, 9
    s_add_u32 s99, s96, s98
    s_and_b32 s97, s8, 1
    s_lshl_b32 s96, s97, 8
    s_add_u32 s98, s99, s96
    s_add_u32 s20, s98, 2097152
    s_waitcnt vmcnt(7)
    v_lshlrev_b32 v168, 16, v169
    v_and_b32 v169, s6, v169
    v_mul_f32 v4, s7, v168
    v_exp_f32 v4, -v4
    s_nop 0
    v_add_f32 v4, 1.0, v4
    v_rcp_f32 v4, v4
    s_nop 0
    v_mul_f32 v168, v168, v4
    v_cvt_pk_bf16_f32 v168, 0, v168
    v_mul_f32 v5, s7, v169
    v_exp_f32 v5, -v5
    s_nop 0
    v_add_f32 v5, 1.0, v5
    v_rcp_f32 v5, v5
    s_nop 0
    v_mul_f32 v169, v169, v5
    v_cvt_pk_bf16_f32 v169, 0, v169
    s_waitcnt vmcnt(5)
    s_lshr_b32 s96, s9, 4
    s_lshl_b32 s94, s96, 1
    s_add_u32 s96, s94, s84
    s_and_b32 s97, s96, 15
    s_mul_i32 s98, s97, 393216
    s_add_u32 s91, s98, s85
    s_lshl_b32 s96, s94, 13
    s_add_u32 s94, s96, s83
    s_add_u32 s82, s91, 2048
    s_mov_b32 m0, s94
    s_nop 0
    buffer_load_dwordx4 v3, s[40:43], s82 offen lds
    s_add_u32 s82, s91, 4096
    s_add_u32 m0, s94, 49152
    s_nop 0
    buffer_load_dwordx4 v3, s[40:43], s82 offen lds
    v_lshlrev_b32 v4, 16, v160
    v_and_b32 v5, s6, v160
    v_pk_mul_f32 v[176:177], v[168:169], v[4:5] op_sel:[0,0] op_sel_hi:[0,1]
    v_lshlrev_b32 v6, 16, v161
    v_and_b32 v7, s6, v161
    v_pk_mul_f32 v[178:179], v[168:169], v[6:7] op_sel:[0,0] op_sel_hi:[0,1]
    v_lshlrev_b32 v4, 16, v162
    v_and_b32 v5, s6, v162
    v_pk_mul_f32 v[180:181], v[168:169], v[4:5] op_sel:[0,0] op_sel_hi:[0,1]
    v_lshlrev_b32 v6, 16, v163
    v_and_b32 v7, s6, v163
    v_pk_mul_f32 v[182:183], v[168:169], v[6:7] op_sel:[0,0] op_sel_hi:[0,1]
    v_lshlrev_b32 v4, 16, v164
    v_and_b32 v5, s6, v164
    v_pk_fma_f32 v[176:177], v[168:169], v[4:5], v[176:177] op_sel:[1,0,0] op_sel_hi:[1,1,1]
    v_lshlrev_b32 v6, 16, v165
    v_and_b32 v7, s6, v165
    v_pk_fma_f32 v[178:179], v[168:169], v[6:7], v[178:179] op_sel:[1,0,0] op_sel_hi:[1,1,1]
    v_lshlrev_b32 v4, 16, v166
    v_and_b32 v5, s6, v166
    v_pk_fma_f32 v[180:181], v[168:169], v[4:5], v[180:181] op_sel:[1,0,0] op_sel_hi:[1,1,1]
    v_lshlrev_b32 v6, 16, v167
    v_and_b32 v7, s6, v167
    v_pk_fma_f32 v[182:183], v[168:169], v[6:7], v[182:183] op_sel:[1,0,0] op_sel_hi:[1,1,1]
    v_permlane32_swap_b32 v176, v180
    v_permlane32_swap_b32 v177, v181
    v_permlane32_swap_b32 v178, v182
    v_permlane32_swap_b32 v179, v183
    v_add_f32 v176, v176, v180
    v_add_f32 v177, v177, v181
    v_add_f32 v178, v178, v182
    v_add_f32 v179, v179, v183
    s_nop 0
    v_permlane16_swap_b32 v176, v178
    v_permlane16_swap_b32 v177, v179
    v_add_f32 v176, v176, v178
    v_add_f32 v177, v177, v179
    s_nop 0
    v_add_f32_dpp v176, v176, v176 row_ror:8 row_mask:0xf bank_mask:0xf
    v_add_f32_dpp v177, v177, v177 row_ror:8 row_mask:0xf bank_mask:0xf
    s_nop 1
    v_mov_b32_dpp v176, v177 quad_perm:[0,1,2,3] row_mask:0xf bank_mask:0xc
    s_waitcnt lgkmcnt(0)
    s_mul_i32 s4, s4, 0x9e3779b1
    s_add_u32 s4, s4, 0x7f4a7c15
    ds_write_b32 v252, v176
    s_waitcnt lgkmcnt(0)
    s_barrier
    ds_read_b128 v[176:179], v251
    ds_read_b128 v[180:183], v251 offset:1024
    s_waitcnt lgkmcnt(0)
    v_pk_add_f32 v[176:177], v[176:177], v[178:179]
    v_pk_add_f32 v[180:181], v[180:181], v[182:183]
    v_pk_add_f32 v[176:177], v[176:177], v[180:181]
    v_add_f32 v176, v176, v177
    v_mov_b32 v177, s4
    s_bitcmp1_b32 s3, 0
    s_cselect_b32 exec_lo, 0, -1
    s_cselect_b32 exec_hi, -1, 0
    buffer_store_dwordx2 v[176:177], v250, s[32:35], s13 offen sc1
    s_mov_b64 exec, -1
    s_waitcnt vmcnt(6)
    v_mov_b32 v8, 0x3f803f80
    v_dot2_f32_bf16 v4, v152, v8, 0
    v_dot2_f32_bf16 v5, v152, v152, 0
    v_dot2_f32_bf16 v6, v153, v8, 0
    v_dot2_f32_bf16 v7, v153, v153, 0
    v_dot2_f32_bf16 v4, v154, v8, v4
    v_dot2_f32_bf16 v5, v154, v154, v5
    v_dot2_f32_bf16 v6, v155, v8, v6
    v_dot2_f32_bf16 v7, v155, v155, v7
    v_dot2_f32_bf16 v4, v156, v8, v4
    v_dot2_f32_bf16 v5, v156, v156, v5
    v_dot2_f32_bf16 v6, v157, v8, v6
    v_dot2_f32_bf16 v7, v157, v157, v7
    v_dot2_f32_bf16 v4, v158, v8, v4
    v_dot2_f32_bf16 v5, v158, v158, v5
    v_dot2_f32_bf16 v6, v159, v8, v6
    v_dot2_f32_bf16 v7, v159, v159, v7
    s_lshl_b32 s96, s3, 5
    s_add_u32 s13, s96, 153600
    v_lshrrev_b32 v8, 5, v1
    v_lshl_add_u32 v8, v8, 4, s13
    v_bfe_u32 v9, v1, 4, 1
    v_lshl_add_u32 v8, v9, 3, v8
    v_pk_add_f32 v[172:173], v[4:5], v[6:7]
    v_and_b32 v5, 15, v1
    v_lshlrev_b32 v5, 4, v5
    v_add_u32 v5, 153600, v5
    v_and_b32 v4, 15, v1
    v_lshlrev_b32 v4, 4, v4
    v_bfe_u32 v9, v1, 4, 1
    v_lshl_add_u32 v4, v9, 12, v4
    v_add_f32_dpp v172, v172, v172 quad_perm:[1,0,3,2] row_mask:0xf bank_mask:0xf
    v_add_f32_dpp v173, v173, v173 quad_perm:[1,0,3,2] row_mask:0xf bank_mask:0xf
    s_nop 0
    v_add_f32_dpp v172, v172, v172 quad_perm:[2,3,0,1] row_mask:0xf bank_mask:0xf
    v_add_f32_dpp v173, v173, v173 quad_perm:[2,3,0,1] row_mask:0xf bank_mask:0xf
    s_nop 0
    v_add_f32_dpp v172, v172, v172 row_half_mirror row_mask:0xf bank_mask:0xf
    v_add_f32_dpp v173, v173, v173 row_half_mirror row_mask:0xf bank_mask:0xf
    s_nop 0
    v_add_f32_dpp v172, v172, v172 row_mirror row_mask:0xf bank_mask:0xf
    v_add_f32_dpp v173, v173, v173 row_mirror row_mask:0xf bank_mask:0xf
    s_nop 1
    v_permlane16_swap_b32 v172, v173
    v_add_f32 v172, v172, v173
    v_mov_b32 v173, s4
    ds_write_b64 v8, v[172:173]
    s_waitcnt lgkmcnt(0)
    s_barrier
    ds_read_b128 v[172:175], v5
    s_waitcnt lgkmcnt(0)
    s_mov_b32 exec_hi, 0
    buffer_store_dwordx4 v[172:175], v4, s[32:35], s20 offen sc1
    s_mov_b32 exec_hi, -1
    s_mov_b32 s82, s91
    s_add_u32 m0, s94, 98304
    s_nop 0
    buffer_load_dwordx4 v3, s[40:43], s82 offen lds
    s_lshr_b32 s96, s9, 4
    s_lshl_b32 s97, s96, 1
    s_xor_b32 s94, s97, 1
    s_add_u32 s96, s94, s84
    s_and_b32 s97, s96, 15
    s_mul_i32 s98, s97, 393216
    s_add_u32 s91, s98, s85
    s_lshl_b32 s96, s94, 13
    s_add_u32 s94, s96, s83
    s_add_u32 s82, s91, 2048
    s_mov_b32 m0, s94
    s_nop 0
    buffer_load_dwordx4 v3, s[40:43], s82 offen lds
    s_load_dword s24, s[32:33], s17 offset:508 glc
    s_load_dword s25, s[32:33], s17 offset:4604 glc
    v_and_b32 v4, 31, v1
    v_lshlrev_b32 v4, 4, v4
    v_lshrrev_b32 v9, 5, v1
    v_lshl_add_u32 v4, v9, 12, v4
    s_and_b32 s14, s3, 3
    s_lshr_b32 s96, s3, 2
    s_lshl_b32 s97, s96, 10
    s_add_u32 s15, s97, 155648
    v_bfe_u32 v5, v1, 4, 1
    v_bfe_u32 v9, v1, 2, 1
    v_lshl_add_u32 v5, v9, 1, v5
    v_xor_b32 v5, s14, v5
    v_lshl_add_u32 v5, v5, 2, s15
    v_and_b32 v6, 1, v1
    v_lshlrev_b32 v6, 5, v6
    v_bfe_u32 v9, v1, 3, 2
    v_lshl_add_u32 v6, v9, 6, v6
    v_bfe_u32 v9, v1, 2, 1
    v_lshl_add_u32 v6, v9, 8, v6
    v_bfe_u32 v9, v1, 1, 1
    v_lshl_add_u32 v6, v9, 9, v6
    v_lshrrev_b32 v9, 5, v1
    v_lshl_add_u32 v6, v9, 11, v6
    v_add_u32 v5, v5, v6
    s_lshl3_add_u32 s96, s2, s3
    s_lshl_b32 s97, s96, 9
    s_add_u32 s14, s97, 2097152
    v_and_b32 v8, 31, v1
    v_lshlrev_b32 v8, 4, v8
    s_branch SCHK_2
SPOLL_1:
    s_load_dword s24, s[32:33], s17 offset:508 glc
    s_load_dword s25, s[32:33], s17 offset:4604 glc
SCHK_2:
    s_add_u32 s5, s5, 1
    s_cmp_ge_u32 s5, 200000
    s_waitcnt lgkmcnt(0)
    s_cbranch_scc1 SDONE_3
    s_cmp_lg_u32 s24, s4
    s_cbranch_scc1 SPOLL_1
    s_cmp_lg_u32 s25, s4
    s_cbranch_scc1 SPOLL_1
SDONE_3:
    buffer_load_dwordx4 v[176:179], v4, s[32:35], s17 offen sc1
    s_load_dword s24, s[32:33], s14 offset:252 glc
    s_load_dword s25, s[32:33], s14 offset:508 glc
    s_lshl_b32 s96, s3, 11
    s_add_u32 s15, s96, 131072
    v_lshrrev_b32 v216, 4, v1
    v_lshlrev_b32 v216, 4, v216
    v_and_b32 v217, 7, v1
    v_lshlrev_b32 v217, 4, v217
    v_xor_b32 v216, v216, v217
    v_and_b32 v217, 15, v1
    v_lshl_add_u32 v217, v217, 7, s15
    v_add_u32 v216, v216, v217
    v_xor_b32 v217, 64, v216
    s_waitcnt vmcnt(7)
    ds_read_b128 v[12:15], v216
    ds_read_b128 v[16:19], v217
    s_branch SCHK_6
SPOLL_5:
    s_load_dword s24, s[32:33], s14 offset:252 glc
    s_load_dword s25, s[32:33], s14 offset:508 glc
SCHK_6:
    s_add_u32 s5, s5, 1
    s_cmp_ge_u32 s5, 200000
    s_waitcnt lgkmcnt(0)
    s_cbranch_scc1 SDONE_7
    s_cmp_lg_u32 s24, s4
    s_cbranch_scc1 SPOLL_5
    s_cmp_lg_u32 s25, s4
    s_cbranch_scc1 SPOLL_5
SDONE_7:
    buffer_load_dwordx4 v[172:175], v8, s[32:35], s14 offen sc1
    s_add_u32 s82, s91, 4096
    s_add_u32 m0, s94, 49152
    s_nop 0
    buffer_load_dwordx4 v3, s[40:43], s82 offen lds
    s_mov_b32 s82, s91
    s_add_u32 m0, s94, 98304
    s_nop 0
    buffer_load_dwordx4 v3, s[40:43], s82 offen lds
    v_permlane32_swap_b32 v12, v14
    v_permlane32_swap_b32 v13, v15
    v_permlane32_swap_b32 v16, v18
    v_permlane32_swap_b32 v17, v19
    v_lshlrev_b32 v184, 16, v12
    v_and_b32 v185, s6, v12
    v_lshlrev_b32 v186, 16, v13
    v_and_b32 v187, s6, v13
    v_lshlrev_b32 v188, 16, v14
    v_and_b32 v189, s6, v14
    v_lshlrev_b32 v190, 16, v15
    v_and_b32 v191, s6, v15
    v_lshlrev_b32 v192, 16, v16
    v_and_b32 v193, s6, v16
    v_lshlrev_b32 v194, 16, v17
    v_and_b32 v195, s6, v17
    v_lshlrev_b32 v196, 16, v18
    v_and_b32 v197, s6, v18
    v_lshlrev_b32 v198, 16, v19
    v_and_b32 v199, s6, v19
    s_waitcnt vmcnt(3)
    v_bitop3_b32 v7, v177, v179, s4 bitop3:0x7e
    v_cmp_ne_u32 vcc, 0, v7
    s_cbranch_vccz TOK_8
POLL_9:
    buffer_load_dwordx4 v[176:179], v4, s[32:35], s17 offen sc1
    s_waitcnt vmcnt(0)
    v_bitop3_b32 v7, v177, v179, s4 bitop3:0x7e
    v_cmp_ne_u32 vcc, 0, v7
    s_cbranch_vccz PDONE_10
    s_add_u32 s5, s5, 1
    s_cmp_lt_u32 s5, 200000
    s_cbranch_scc1 POLL_9
PDONE_10:
TOK_8:
    ds_write2_b32 v5, v176, v178 offset0:0 offset1:4
    s_waitcnt lgkmcnt(0)
    s_barrier
    ds_read_b128 v[208:211], v251 offset:10240
    ds_read_b128 v[212:215], v251 offset:11264
    ds_read_b128 v[200:203], v251 offset:8192
    ds_read_b128 v[204:207], v251 offset:9216
    s_lshl_b32 s96, s11, 12
    s_lshl_b32 s97, s3, 9
    s_add_u32 s13, s96, s97
    v_add_u32 v4, s13, v2
    s_lshl_b32 s96, s3, 9
    s_add_u32 m0, s96, 159744
    s_mov_b32 exec_hi, 0
    global_load_lds_dwordx4 v4, s[72:73]
    s_mov_b32 exec_hi, -1
    s_lshl4_add_u32 s96, s21, s12
    s_lshr_b32 s97, s3, 1
    s_lshl2_add_u32 s98, s96, s97
    s_lshl_b32 s99, s98, 12
    s_and_b32 s96, s3, 1
    s_lshl_b32 s97, s96, 8
    s_add_u32 s98, s99, s97
    s_add_u32 s13, s98, 4194304
    v_and_b32 v4, 15, v1
    v_lshlrev_b32 v4, 4, v4
    v_bfe_u32 v9, v1, 4, 1
    v_lshl_add_u32 v4, v9, 10, v4
    v_lshrrev_b32 v9, 5, v1
    v_lshl_add_u32 v4, v9, 9, v4
    s_waitcnt lgkmcnt(2)
    v_pk_add_f32 v[208:209], v[208:209], v[210:211]
    v_pk_add_f32 v[212:213], v[212:213], v[214:215]
    v_pk_add_f32 v[208:209], v[208:209], v[212:213]
    v_add_f32 v208, v208, v209
    v_cvt_pk_bf16_f32 v208, 0, v208
    s_waitcnt lgkmcnt(0)
    v_pk_add_f32 v[200:201], v[200:201], v[202:203]
    v_pk_add_f32 v[204:205], v[204:205], v[206:207]
    v_pk_add_f32 v[200:201], v[200:201], v[204:205]
    v_add_f32 v200, v200, v201
    v_add_f32 v208, 1.0, v208
    v_cvt_pk_bf16_f32 v208, 0, v208
    v_cvt_pk_bf16_f32 v200, 0, v200
    s_waitcnt vmcnt(3)
    v_bitop3_b32 v7, v173, v175, s4 bitop3:0x7e
    v_cmp_ne_u32 vcc, 0, v7
    s_cbranch_vccz L_STOK
POLL_11:
    buffer_load_dwordx4 v[172:175], v8, s[32:35], s14 offen sc1
    s_waitcnt vmcnt(0)
    v_bitop3_b32 v7, v173, v175, s4 bitop3:0x7e
    v_cmp_ne_u32 vcc, 0, v7
    s_cbranch_vccz PDONE_12
    s_add_u32 s5, s5, 1
    s_cmp_lt_u32 s5, 200000
    s_cbranch_scc1 POLL_11
PDONE_12:
L_STOK:
    v_permlane16_swap_b32 v172, v174
    v_add_f32 v175, v172, v174
    v_mul_f32 v174, 0x3a800000, v175
    v_mul_f32 v175, 0x3a800000, v175
    s_nop 1
    v_permlane16_swap_b32 v174, v175
    v_fma_f32 v172, -v174, v174, v175
    v_cvt_pk_bf16_f32 v173, 0, v174
    v_max_f32 v172, 0, v172
    v_cvt_pk_bf16_f32 v172, 0, v172
    v_pk_add_f32 v[184:185], v[172:173], v[184:185] op_sel:[1,0] neg_lo:[1,0] neg_hi:[1,0]
    v_pk_add_f32 v[186:187], v[172:173], v[186:187] op_sel:[1,0] neg_lo:[1,0] neg_hi:[1,0]
    v_pk_add_f32 v[188:189], v[172:173], v[188:189] op_sel:[1,0] neg_lo:[1,0] neg_hi:[1,0]
    v_pk_add_f32 v[190:191], v[172:173], v[190:191] op_sel:[1,0] neg_lo:[1,0] neg_hi:[1,0]
    v_add_f32 v172, 0x3727c5ac, v172
    v_cvt_pk_bf16_f32 v172, 0, v172
    v_sqrt_f32 v172, v172
    s_nop 0
    v_pk_add_f32 v[192:193], v[172:173], v[192:193] op_sel:[1,0] neg_lo:[1,0] neg_hi:[1,0]
    v_pk_add_f32 v[194:195], v[172:173], v[194:195] op_sel:[1,0] neg_lo:[1,0] neg_hi:[1,0]
    v_pk_add_f32 v[196:197], v[172:173], v[196:197] op_sel:[1,0] neg_lo:[1,0] neg_hi:[1,0]
    v_pk_add_f32 v[198:199], v[172:173], v[198:199] op_sel:[1,0] neg_lo:[1,0] neg_hi:[1,0]
    v_cvt_pk_bf16_f32 v172, 0, v172
    v_rcp_f32 v172, v172
    v_cvt_pk_bf16_f32 v184, 0, v184
    v_cvt_pk_bf16_f32 v185, 0, v185
    v_cvt_pk_bf16_f32 v186, 0, v186
    v_cvt_pk_bf16_f32 v187, 0, v187
    v_cvt_pk_bf16_f32 v188, 0, v188
    v_cvt_pk_bf16_f32 v189, 0, v189
    v_cvt_pk_bf16_f32 v190, 0, v190
    v_cvt_pk_bf16_f32 v191, 0, v191
    v_cvt_pk_bf16_f32 v192, 0, v192
    v_cvt_pk_bf16_f32 v193, 0, v193
    v_cvt_pk_bf16_f32 v194, 0, v194
    v_cvt_pk_bf16_f32 v195, 0, v195
    v_cvt_pk_bf16_f32 v196, 0, v196
    v_cvt_pk_bf16_f32 v197, 0, v197
    v_cvt_pk_bf16_f32 v198, 0, v198
    v_cvt_pk_bf16_f32 v199, 0, v199
    v_pk_mul_f32 v[184:185], v[184:185], v[172:173] op_sel_hi:[1,0]
    v_pk_mul_f32 v[186:187], v[186:187], v[172:173] op_sel_hi:[1,0]
    v_pk_mul_f32 v[188:189], v[188:189], v[172:173] op_sel_hi:[1,0]
    v_pk_mul_f32 v[190:191], v[190:191], v[172:173] op_sel_hi:[1,0]
    v_pk_mul_f32 v[192:193], v[192:193], v[172:173] op_sel_hi:[1,0]
    v_pk_mul_f32 v[194:195], v[194:195], v[172:173] op_sel_hi:[1,0]
    v_pk_mul_f32 v[196:197], v[196:197], v[172:173] op_sel_hi:[1,0]
    v_pk_mul_f32 v[198:199], v[198:199], v[172:173] op_sel_hi:[1,0]
    v_cvt_pk_bf16_f32 v184, 0, v184
    v_cvt_pk_bf16_f32 v185, 0, v185
    v_cvt_pk_bf16_f32 v186, 0, v186
    v_cvt_pk_bf16_f32 v187, 0, v187
    v_cvt_pk_bf16_f32 v188, 0, v188
    v_cvt_pk_bf16_f32 v189, 0, v189
    v_cvt_pk_bf16_f32 v190, 0, v190
    v_cvt_pk_bf16_f32 v191, 0, v191
    v_cvt_pk_bf16_f32 v192, 0, v192
    v_cvt_pk_bf16_f32 v193, 0, v193
    v_cvt_pk_bf16_f32 v194, 0, v194
    v_cvt_pk_bf16_f32 v195, 0, v195
    v_cvt_pk_bf16_f32 v196, 0, v196
    v_cvt_pk_bf16_f32 v197, 0, v197
    v_cvt_pk_bf16_f32 v198, 0, v198
    v_cvt_pk_bf16_f32 v199, 0, v199
    v_mul_f32_dpp v184, v208, v184 row_newbcast:0 row_mask:0xf bank_mask:0xf
    v_mul_f32_dpp v185, v208, v185 row_newbcast:1 row_mask:0xf bank_mask:0xf
    v_mul_f32_dpp v186, v208, v186 row_newbcast:2 row_mask:0xf bank_mask:0xf
    v_mul_f32_dpp v187, v208, v187 row_newbcast:3 row_mask:0xf bank_mask:0xf
    v_mul_f32_dpp v188, v208, v188 row_newbcast:4 row_mask:0xf bank_mask:0xf
    v_mul_f32_dpp v189, v208, v189 row_newbcast:5 row_mask:0xf bank_mask:0xf
    v_mul_f32_dpp v190, v208, v190 row_newbcast:6 row_mask:0xf bank_mask:0xf
    v_mul_f32_dpp v191, v208, v191 row_newbcast:7 row_mask:0xf bank_mask:0xf
    v_cvt_pk_bf16_f32 v184, 0, v184
    v_cvt_pk_bf16_f32 v185, 0, v185
    v_cvt_pk_bf16_f32 v186, 0, v186
    v_cvt_pk_bf16_f32 v187, 0, v187
    v_cvt_pk_bf16_f32 v188, 0, v188
    v_cvt_pk_bf16_f32 v189, 0, v189
    v_cvt_pk_bf16_f32 v190, 0, v190
    v_cvt_pk_bf16_f32 v191, 0, v191
    v_add_f32_dpp v184, v200, v184 row_newbcast:0 row_mask:0xf bank_mask:0xf
    v_add_f32_dpp v185, v200, v185 row_newbcast:1 row_mask:0xf bank_mask:0xf
    v_add_f32_dpp v186, v200, v186 row_newbcast:2 row_mask:0xf bank_mask:0xf
    v_add_f32_dpp v187, v200, v187 row_newbcast:3 row_mask:0xf bank_mask:0xf
    v_add_f32_dpp v188, v200, v188 row_newbcast:4 row_mask:0xf bank_mask:0xf
    v_add_f32_dpp v189, v200, v189 row_newbcast:5 row_mask:0xf bank_mask:0xf
    v_add_f32_dpp v190, v200, v190 row_newbcast:6 row_mask:0xf bank_mask:0xf
    v_add_f32_dpp v191, v200, v191 row_newbcast:7 row_mask:0xf bank_mask:0xf
    v_cvt_pk_bf16_f32 v216, v184, v185
    v_cvt_pk_bf16_f32 v217, v186, v187
    v_cvt_pk_bf16_f32 v218, v188, v189
    v_cvt_pk_bf16_f32 v219, v190, v191
    buffer_store_dwordx4 v[216:219], v4, s[32:35], s13 offen sc1
    v_mul_f32_dpp v192, v208, v192 row_newbcast:8 row_mask:0xf bank_mask:0xf
    v_mul_f32_dpp v193, v208, v193 row_newbcast:9 row_mask:0xf bank_mask:0xf
    v_mul_f32_dpp v194, v208, v194 row_newbcast:10 row_mask:0xf bank_mask:0xf
    v_mul_f32_dpp v195, v208, v195 row_newbcast:11 row_mask:0xf bank_mask:0xf
    v_mul_f32_dpp v196, v208, v196 row_newbcast:12 row_mask:0xf bank_mask:0xf
    v_mul_f32_dpp v197, v208, v197 row_newbcast:13 row_mask:0xf bank_mask:0xf
    v_mul_f32_dpp v198, v208, v198 row_newbcast:14 row_mask:0xf bank_mask:0xf
    v_mul_f32_dpp v199, v208, v199 row_newbcast:15 row_mask:0xf bank_mask:0xf
    v_cvt_pk_bf16_f32 v192, 0, v192
    v_cvt_pk_bf16_f32 v193, 0, v193
    v_cvt_pk_bf16_f32 v194, 0, v194
    v_cvt_pk_bf16_f32 v195, 0, v195
    v_cvt_pk_bf16_f32 v196, 0, v196
    v_cvt_pk_bf16_f32 v197, 0, v197
    v_cvt_pk_bf16_f32 v198, 0, v198
    v_cvt_pk_bf16_f32 v199, 0, v199
    v_add_f32_dpp v192, v200, v192 row_newbcast:8 row_mask:0xf bank_mask:0xf
    v_add_f32_dpp v193, v200, v193 row_newbcast:9 row_mask:0xf bank_mask:0xf
    v_add_f32_dpp v194, v200, v194 row_newbcast:10 row_mask:0xf bank_mask:0xf
    v_add_f32_dpp v195, v200, v195 row_newbcast:11 row_mask:0xf bank_mask:0xf
    v_add_f32_dpp v196, v200, v196 row_newbcast:12 row_mask:0xf bank_mask:0xf
    v_add_f32_dpp v197, v200, v197 row_newbcast:13 row_mask:0xf bank_mask:0xf
    v_add_f32_dpp v198, v200, v198 row_newbcast:14 row_mask:0xf bank_mask:0xf
    v_add_f32_dpp v199, v200, v199 row_newbcast:15 row_mask:0xf bank_mask:0xf
    v_cvt_pk_bf16_f32 v220, v192, v193
    v_cvt_pk_bf16_f32 v221, v194, v195
    v_cvt_pk_bf16_f32 v222, v196, v197
    v_cvt_pk_bf16_f32 v223, v198, v199
    buffer_store_dwordx4 v[220:223], v4, s[32:35], s13 offen offset:2048 sc1
    v_bfe_u32 v20, v1, 2, 2
    v_lshlrev_b32 v20, 7, v20
    v_bfe_u32 v9, v1, 3, 1
    v_lshl_add_u32 v20, v9, 6, v20
    v_bfe_u32 v9, v1, 4, 1
    v_lshl_add_u32 v20, v9, 5, v20
    v_and_b32 v9, 3, v1
    v_lshl_add_u32 v20, v9, 3, v20
    v_lshrrev_b32 v9, 5, v1
    v_lshl_add_u32 v20, v9, 9, v20
    v_xor_b32 v21, 64, v20
    v_add_u32 v22, 49152, v20
    v_add_u32 v23, 49152, v21
    v_add_u32 v24, 98304, v20
    v_add_u32 v25, 98304, v21
    v_and_b32 v5, 3, v1
    v_lshlrev_b32 v5, 15, v5
    v_bfe_u32 v9, v1, 2, 2
    v_lshl_add_u32 v5, v9, 12, v5
    s_and_b32 s96, s12, 1
    s_lshr_b32 s97, s21, 3
    s_and_b32 s98, s21, 7
    s_lshl_b32 s99, s98, 5
    s_lshl2_add_u32 s98, s97, s99
    s_lshl_b32 s97, s98, 12
    s_lshr_b32 s99, s12, 1
    s_lshl_b32 s98, s99, 6
    s_add_u32 s99, s97, s98
    s_lshl2_add_u32 s97, s96, s99
    s_add_u32 s13, s97, 1048576
    s_lshl_b32 s96, s10, 18
    s_lshl_b32 s97, s77, 12
    s_add_u32 s98, s96, s97
    s_add_u32 s88, s98, 4194304
    s_cmp_ge_u32 s9, 28
    s_cselect_b32 s54, 0, s54
    s_cselect_b32 s58, 0, s58
    s_cselect_b32 s62, 0, s62
    s_waitcnt vmcnt(0)
    s_barrier
    s_cmp_lg_u32 s3, 0
    s_cbranch_scc1 L_PB
    v_mov_b32 v6, s4
    s_mov_b32 exec_hi, 0
    s_mov_b32 exec_lo, 65535
    buffer_store_dword v6, v5, s[32:35], s13 offen sc1
    s_mov_b64 exec, -1
L_PB:
    s_lshr_b32 s96, s9, 4
    s_lshl_b32 s97, s96, 1
    s_xor_b32 s94, s97, 2
    s_add_u32 s96, s94, s84
    s_and_b32 s97, s96, 15
    s_mul_i32 s98, s97, 393216
    s_add_u32 s91, s98, s85
    s_lshl_b32 s96, s94, 13
    s_add_u32 s94, s96, s83
    s_add_u32 s82, s91, 2048
    s_mov_b32 m0, s94
    s_nop 0
    buffer_load_dwordx4 v3, s[40:43], s82 offen lds
    s_add_u32 s82, s91, 4096
    s_add_u32 m0, s94, 49152
    s_nop 0
    buffer_load_dwordx4 v3, s[40:43], s82 offen lds
    s_mov_b32 s82, s91
    s_add_u32 m0, s94, 98304
    s_nop 0
    buffer_load_dwordx4 v3, s[40:43], s82 offen lds
    s_lshr_b32 s96, s9, 4
    s_lshl_b32 s97, s96, 1
    s_xor_b32 s94, s97, 3
    s_add_u32 s96, s94, s84
    s_and_b32 s97, s96, 15
    s_mul_i32 s98, s97, 393216
    s_add_u32 s91, s98, s85
    s_lshl_b32 s96, s94, 13
    s_add_u32 s94, s96, s83
    s_add_u32 s82, s91, 2048
    s_mov_b32 m0, s94
    s_nop 0
    buffer_load_dwordx4 v3, s[40:43], s82 offen lds
    s_add_u32 s82, s91, 4096
    s_add_u32 m0, s94, 49152
    s_nop 0
    buffer_load_dwordx4 v3, s[40:43], s82 offen lds
    s_mov_b32 s82, s91
    s_add_u32 m0, s94, 98304
    s_nop 0
    buffer_load_dwordx4 v3, s[40:43], s82 offen lds
    s_lshl_b32 s96, s2, 12
    s_add_u32 s19, s96, 1048576
    s_and_b32 s96, s3, 3
    s_lshl_b32 s97, s96, 7
    s_add_u32 s20, s97, s19
    s_lshl_b32 s96, s84, 5
    s_add_u32 s19, s96, s19
    s_cmp_ge_u32 s3, 4
    s_cselect_b32 s19, s20, s19
    s_load_dwordx2 s[24:25], s[32:33], s19 offset:0 glc
    s_load_dwordx2 s[26:27], s[32:33], s19 offset:64 glc
    s_lshl_b32 s96, s3, 14
    s_lshl_b32 s97, s12, 7
    s_add_u32 s90, s96, s97
    s_and_b32 s96, s9, 1
    s_lshr_b32 s97, s9, 3
    s_lshl_b32 s98, s97, 1
    s_lshl3_add_u32 s99, s96, s98
    s_lshl_b32 s95, s99, 17
    s_lshl3_add_u32 s96, s75, s3
    s_mul_i32 s97, s96, 229376
    s_lshl_b32 s98, s74, 7
    s_add_u32 s80, s97, s98
    s_lshl3_add_u32 s96, s74, s3
    s_lshl_b32 s97, s96, 14
    s_lshl_b32 s98, s75, 9
    s_add_u32 s81, s97, s98
    s_and_b32 s96, s8, 3
    s_lshl3_add_u32 s97, s96, s3
    s_mul_i32 s98, s97, 393216
    s_lshr_b32 s99, s8, 2
    s_lshl1_add_u32 s96, s9, s99
    s_lshl_b32 s97, s96, 7
    s_add_u32 s99, s98, s97
    s_add_u32 s89, s99, 4096
    s_and_b32 s96, s3, 1
    s_lshl_b32 s14, s96, 6
    v_bfe_u32 v6, v1, 4, 1
    v_lshl_add_u32 v6, v6, 5, s14
    v_and_b32 v26, 7, v1
    v_lshlrev_b32 v26, 4, v26
    v_xor_b32 v26, v26, v6
    v_lshrrev_b32 v6, 3, v1
    v_lshlrev_b32 v6, 11, v6
    v_add_u32 v26, v26, v6
    s_and_b32 s96, s3, 2
    s_lshl_b32 s14, s96, 5
    v_bfe_u32 v6, v1, 4, 1
    v_lshl_add_u32 v6, v6, 5, s14
    v_and_b32 v27, 7, v1
    v_lshlrev_b32 v27, 4, v27
    v_xor_b32 v27, v27, v6
    v_lshrrev_b32 v6, 3, v1
    v_mul_u32_u24 v6, 7168, v6
    v_add_u32 v27, v27, v6
    s_and_b32 s96, s3, 1
    s_lshl_b32 s14, s96, 7
    v_lshrrev_b32 v6, 5, v1
    v_lshl_add_u32 v6, v6, 6, s14
    v_and_b32 v253, 31, v1
    v_lshlrev_b32 v253, 4, v253
    v_lshrrev_b32 v9, 5, v1
    v_lshl_add_u32 v253, v9, 11, v253
    v_xor_b32 v253, v253, v6
    s_lshl_b32 s16, s84, 14
    v_add_u32 v249, s88, v2
    s_lshl_b32 s96, s77, 11
    s_add_u32 s14, s96, 151552
    v_add_u32 v0, s14, v2
    s_mov_b64 exec, 0
    s_cmp_eq_u32 s3, 4
    s_cbranch_scc1 L_PAD2
    s_cmp_eq_u32 s3, 5
    s_cbranch_scc1 L_PAD3
    s_cmp_eq_u32 s3, 6
    s_cbranch_scc1 L_PAD4
    s_cmp_eq_u32 s3, 7
    s_cbranch_scc1 L_PAD5
    s_branch L_TEND
L_RET2:
    s_branch L_PAD6
L_RET6:
    s_branch L_PAD10
L_RET10:
    s_branch L_TEND
L_RET3:
    s_branch L_PAD7
L_RET7:
    s_branch L_TEND
L_RET4:
    s_branch L_PAD8
L_RET8:
    s_branch L_TEND
L_RET5:
    s_branch L_PAD9
L_RET9:
    s_branch L_TEND
    s_nop 0
    s_nop 0
    s_nop 0
    s_nop 0
    s_nop 0
    s_nop 0
    s_nop 0
    s_nop 0
    s_nop 0
    s_nop 0
    s_nop 0
    s_nop 0
    s_nop 0
    s_nop 0
    s_nop 0
    s_nop 0
    s_nop 0
    s_nop 0
    s_nop 0
    s_nop 0
    s_nop 0
    s_nop 0
    s_nop 0
    s_nop 0
    s_nop 0
    s_nop 0
    s_nop 0
    s_nop 0
L_TEND:
    s_mov_b64 exec, -1
    s_cmp_ge_u32 s3, 4
    s_cbranch_scc1 L_HELP
    s_branch SCHK_14
SPOLL_13:
    s_load_dwordx2 s[24:25], s[32:33], s19 offset:0 glc
    s_load_dwordx2 s[26:27], s[32:33], s19 offset:64 glc
SCHK_14:
    s_add_u32 s5, s5, 1
    s_cmp_ge_u32 s5, 200000
    s_waitcnt lgkmcnt(0)
    s_cbranch_scc1 SDONE_15
    s_cmp_lg_u32 s24, s4
    s_cbranch_scc1 SPOLL_13
    s_cmp_lg_u32 s25, s4
    s_cbranch_scc1 SPOLL_13
    s_cmp_lg_u32 s26, s4
    s_cbranch_scc1 SPOLL_13
    s_cmp_lg_u32 s27, s4
    s_cbranch_scc1 SPOLL_13
SDONE_15:
    s_setprio 2
    buffer_load_dwordx4 v[152:155], v249, s[32:35], s16 offen sc1
    buffer_load_dwordx4 v[156:159], v249, s[32:35], s16 offen offset:1024 sc1
    buffer_load_dwordx4 v[160:163], v249, s[32:35], s16 offen offset:2048 sc1
    buffer_load_dwordx4 v[164:167], v249, s[32:35], s16 offen offset:3072 sc1
    s_add_u32 s16, s16, 16384
    s_and_b32 s16, s16, 0x3ffff
    buffer_load_dwordx4 v[168:171], v249, s[32:35], s16 offen sc1
    buffer_load_dwordx4 v[172:175], v249, s[32:35], s16 offen offset:1024 sc1
    buffer_load_dwordx4 v[176:179], v249, s[32:35], s16 offen offset:2048 sc1
    buffer_load_dwordx4 v[180:183], v249, s[32:35], s16 offen offset:3072 sc1
    s_waitcnt vmcnt(8)
    s_barrier
    ds_read_b64_tr_b16 v[28:29], v20
    ds_read_b64_tr_b16 v[30:31], v20 offset:2048
    ds_read_b64_tr_b16 v[32:33], v21
    ds_read_b64_tr_b16 v[34:35], v21 offset:2048
    ds_read_b64_tr_b16 v[36:37], v24
    ds_read_b64_tr_b16 v[38:39], v24 offset:2048
    ds_read_b64_tr_b16 v[40:41], v25
    ds_read_b64_tr_b16 v[42:43], v25 offset:2048
    ds_read_b64_tr_b16 v[44:45], v22
    ds_read_b64_tr_b16 v[46:47], v22 offset:2048
    ds_read_b64_tr_b16 v[48:49], v23
    ds_read_b64_tr_b16 v[50:51], v23 offset:2048
    s_waitcnt vmcnt(7)
    s_waitcnt lgkmcnt(10)
    v_mfma_f32_32x32x16_bf16 v[56:71], v[28:31], v[152:155], 0
    s_add_u32 s16, s16, 16384
    ds_read_b64_tr_b16 v[52:53], v20 offset:1024
    ds_read_b64_tr_b16 v[54:55], v20 offset:3072
    s_waitcnt lgkmcnt(10)
    v_mfma_f32_32x32x16_bf16 v[72:87], v[32:35], v[152:155], 0
    s_and_b32 s16, s16, 0x3ffff
    ds_read_b64_tr_b16 v[28:29], v21 offset:1024
    ds_read_b64_tr_b16 v[30:31], v21 offset:3072
    s_waitcnt lgkmcnt(10)
    v_mfma_f32_32x32x16_bf16 v[120:135], v[36:39], v[152:155], 0
    ds_read_b64_tr_b16 v[32:33], v24 offset:1024
    ds_read_b64_tr_b16 v[34:35], v24 offset:3072
    s_waitcnt lgkmcnt(10)
    v_mfma_f32_32x32x16_bf16 v[136:151], v[40:43], v[152:155], 0
    buffer_load_dwordx4 v[184:187], v249, s[32:35], s16 offen sc1
    ds_read_b64_tr_b16 v[36:37], v25 offset:1024
    ds_read_b64_tr_b16 v[38:39], v25 offset:3072
    s_waitcnt lgkmcnt(10)
    v_mfma_f32_32x32x16_bf16 v[88:103], v[44:47], v[152:155], 0
    ds_read_b64_tr_b16 v[40:41], v22 offset:1024
    ds_read_b64_tr_b16 v[42:43], v22 offset:3072
    s_waitcnt lgkmcnt(10)
    v_mfma_f32_32x32x16_bf16 v[104:119], v[48:51], v[152:155], 0
    ds_read_b64_tr_b16 v[44:45], v23 offset:1024
    ds_read_b64_tr_b16 v[46:47], v23 offset:3072
    s_waitcnt vmcnt(7)
    s_waitcnt lgkmcnt(10)
    v_mfma_f32_32x32x16_bf16 v[56:71], v[52:55], v[156:159], v[56:71]
    ds_read_b64_tr_b16 v[48:49], v20 offset:4096
    ds_read_b64_tr_b16 v[50:51], v20 offset:6144
    s_waitcnt lgkmcnt(10)
    v_mfma_f32_32x32x16_bf16 v[72:87], v[28:31], v[156:159], v[72:87]
    buffer_load_dwordx4 v[188:191], v249, s[32:35], s16 offen offset:1024 sc1
    ds_read_b64_tr_b16 v[52:53], v21 offset:4096
    ds_read_b64_tr_b16 v[54:55], v21 offset:6144
    s_waitcnt lgkmcnt(10)
    v_mfma_f32_32x32x16_bf16 v[120:135], v[32:35], v[156:159], v[120:135]
    ds_read_b64_tr_b16 v[28:29], v24 offset:4096
    ds_read_b64_tr_b16 v[30:31], v24 offset:6144
    s_waitcnt lgkmcnt(10)
    v_mfma_f32_32x32x16_bf16 v[136:151], v[36:39], v[156:159], v[136:151]
    ds_read_b64_tr_b16 v[32:33], v25 offset:4096
    ds_read_b64_tr_b16 v[34:35], v25 offset:6144
    s_waitcnt lgkmcnt(10)
    v_mfma_f32_32x32x16_bf16 v[88:103], v[40:43], v[156:159], v[88:103]
    ds_read_b64_tr_b16 v[36:37], v22 offset:4096
    ds_read_b64_tr_b16 v[38:39], v22 offset:6144
    s_waitcnt lgkmcnt(10)
    v_mfma_f32_32x32x16_bf16 v[104:119], v[44:47], v[156:159], v[104:119]
    buffer_load_dwordx4 v[192:195], v249, s[32:35], s16 offen offset:2048 sc1
    ds_read_b64_tr_b16 v[40:41], v23 offset:4096
    ds_read_b64_tr_b16 v[42:43], v23 offset:6144
    s_waitcnt vmcnt(8)
    s_waitcnt lgkmcnt(10)
    v_mfma_f32_32x32x16_bf16 v[56:71], v[48:51], v[160:163], v[56:71]
    ds_read_b64_tr_b16 v[44:45], v20 offset:5120
    ds_read_b64_tr_b16 v[46:47], v20 offset:7168
    s_waitcnt lgkmcnt(10)
    v_mfma_f32_32x32x16_bf16 v[72:87], v[52:55], v[160:163], v[72:87]
    ds_read_b64_tr_b16 v[48:49], v21 offset:5120
    ds_read_b64_tr_b16 v[50:51], v21 offset:7168
    s_waitcnt lgkmcnt(10)
    v_mfma_f32_32x32x16_bf16 v[120:135], v[28:31], v[160:163], v[120:135]
    ds_read_b64_tr_b16 v[52:53], v24 offset:5120
    ds_read_b64_tr_b16 v[54:55], v24 offset:7168
    s_waitcnt lgkmcnt(10)
    v_mfma_f32_32x32x16_bf16 v[136:151], v[32:35], v[160:163], v[136:151]
    buffer_load_dwordx4 v[196:199], v249, s[32:35], s16 offen offset:3072 sc1
    ds_read_b64_tr_b16 v[28:29], v25 offset:5120
    ds_read_b64_tr_b16 v[30:31], v25 offset:7168
    s_waitcnt lgkmcnt(10)
    v_mfma_f32_32x32x16_bf16 v[88:103], v[36:39], v[160:163], v[88:103]
    s_add_u32 s16, s16, 16384
    ds_read_b64_tr_b16 v[32:33], v22 offset:5120
    ds_read_b64_tr_b16 v[34:35], v22 offset:7168
    s_waitcnt lgkmcnt(10)
    v_mfma_f32_32x32x16_bf16 v[104:119], v[40:43], v[160:163], v[104:119]
    s_and_b32 s16, s16, 0x3ffff
    ds_read_b64_tr_b16 v[36:37], v23 offset:5120
    ds_read_b64_tr_b16 v[38:39], v23 offset:7168
    s_waitcnt vmcnt(8)
    s_waitcnt lgkmcnt(10)
    v_mfma_f32_32x32x16_bf16 v[56:71], v[44:47], v[164:167], v[56:71]
    ds_read_b64_tr_b16 v[40:41], v20 offset:8192
    ds_read_b64_tr_b16 v[42:43], v20 offset:10240
    s_waitcnt lgkmcnt(10)
    v_mfma_f32_32x32x16_bf16 v[72:87], v[48:51], v[164:167], v[72:87]
    buffer_load_dwordx4 v[200:203], v249, s[32:35], s16 offen sc1
    ds_read_b64_tr_b16 v[44:45], v21 offset:8192
    ds_read_b64_tr_b16 v[46:47], v21 offset:10240
    s_waitcnt lgkmcnt(10)
    v_mfma_f32_32x32x16_bf16 v[120:135], v[52:55], v[164:167], v[120:135]
    ds_read_b64_tr_b16 v[48:49], v24 offset:8192
    ds_read_b64_tr_b16 v[50:51], v24 offset:10240
    s_waitcnt lgkmcnt(10)
    v_mfma_f32_32x32x16_bf16 v[136:151], v[28:31], v[164:167], v[136:151]
    ds_read_b64_tr_b16 v[52:53], v25 offset:8192
    ds_read_b64_tr_b16 v[54:55], v25 offset:10240
    s_waitcnt lgkmcnt(10)
    v_mfma_f32_32x32x16_bf16 v[88:103], v[32:35], v[164:167], v[88:103]
    ds_read_b64_tr_b16 v[28:29], v22 offset:8192
    ds_read_b64_tr_b16 v[30:31], v22 offset:10240
    s_waitcnt lgkmcnt(10)
    v_mfma_f32_32x32x16_bf16 v[104:119], v[36:39], v[164:167], v[104:119]
    buffer_load_dwordx4 v[204:207], v249, s[32:35], s16 offen offset:1024 sc1
    ds_read_b64_tr_b16 v[32:33], v23 offset:8192
    ds_read_b64_tr_b16 v[34:35], v23 offset:10240
    s_barrier
    s_waitcnt vmcnt(9)
    s_waitcnt lgkmcnt(10)
    v_mfma_f32_32x32x16_bf16 v[56:71], v[40:43], v[168:171], v[56:71]
    ds_read_b64_tr_b16 v[36:37], v20 offset:9216
    ds_read_b64_tr_b16 v[38:39], v20 offset:11264
    s_waitcnt lgkmcnt(10)
    v_mfma_f32_32x32x16_bf16 v[72:87], v[44:47], v[168:171], v[72:87]
    ds_read_b64_tr_b16 v[40:41], v21 offset:9216
    ds_read_b64_tr_b16 v[42:43], v21 offset:11264
    s_waitcnt lgkmcnt(10)
    v_mfma_f32_32x32x16_bf16 v[120:135], v[48:51], v[168:171], v[120:135]
    ds_read_b64_tr_b16 v[44:45], v24 offset:9216
    ds_read_b64_tr_b16 v[46:47], v24 offset:11264
    s_waitcnt lgkmcnt(10)
    v_mfma_f32_32x32x16_bf16 v[136:151], v[52:55], v[168:171], v[136:151]
    ds_read_b64_tr_b16 v[48:49], v25 offset:9216
    ds_read_b64_tr_b16 v[50:51], v25 offset:11264
    s_waitcnt lgkmcnt(10)
    v_mfma_f32_32x32x16_bf16 v[88:103], v[28:31], v[168:171], v[88:103]
    ds_read_b64_tr_b16 v[52:53], v22 offset:9216
    ds_read_b64_tr_b16 v[54:55], v22 offset:11264
    s_waitcnt lgkmcnt(10)
    v_mfma_f32_32x32x16_bf16 v[104:119], v[32:35], v[168:171], v[104:119]
    ds_read_b64_tr_b16 v[28:29], v23 offset:9216
    ds_read_b64_tr_b16 v[30:31], v23 offset:11264
    s_waitcnt vmcnt(8)
    s_waitcnt lgkmcnt(10)
    v_mfma_f32_32x32x16_bf16 v[56:71], v[36:39], v[172:175], v[56:71]
    ds_read_b64_tr_b16 v[32:33], v20 offset:12288
    ds_read_b64_tr_b16 v[34:35], v20 offset:14336
    s_waitcnt lgkmcnt(10)
    v_mfma_f32_32x32x16_bf16 v[72:87], v[40:43], v[172:175], v[72:87]
    ds_read_b64_tr_b16 v[36:37], v21 offset:12288
    ds_read_b64_tr_b16 v[38:39], v21 offset:14336
    s_waitcnt lgkmcnt(10)
    v_mfma_f32_32x32x16_bf16 v[120:135], v[44:47], v[172:175], v[120:135]
    buffer_load_dwordx4 v[208:211], v249, s[32:35], s16 offen offset:2048 sc1
    ds_read_b64_tr_b16 v[40:41], v24 offset:12288
    ds_read_b64_tr_b16 v[42:43], v24 offset:14336
    s_waitcnt lgkmcnt(10)
    v_mfma_f32_32x32x16_bf16 v[136:151], v[48:51], v[172:175], v[136:151]
    ds_read_b64_tr_b16 v[44:45], v25 offset:12288
    ds_read_b64_tr_b16 v[46:47], v25 offset:14336
    s_waitcnt lgkmcnt(10)
    v_mfma_f32_32x32x16_bf16 v[88:103], v[52:55], v[172:175], v[88:103]
    ds_read_b64_tr_b16 v[48:49], v22 offset:12288
    ds_read_b64_tr_b16 v[50:51], v22 offset:14336
    s_waitcnt lgkmcnt(10)
    v_mfma_f32_32x32x16_bf16 v[104:119], v[28:31], v[172:175], v[104:119]
    buffer_load_dwordx4 v[212:215], v249, s[32:35], s16 offen offset:3072 sc1
    ds_read_b64_tr_b16 v[52:53], v23 offset:12288
    ds_read_b64_tr_b16 v[54:55], v23 offset:14336
    s_waitcnt vmcnt(9)
    s_waitcnt lgkmcnt(10)
    v_mfma_f32_32x32x16_bf16 v[56:71], v[32:35], v[176:179], v[56:71]
    s_add_u32 s16, s16, 16384
    ds_read_b64_tr_b16 v[28:29], v20 offset:13312
    ds_read_b64_tr_b16 v[30:31], v20 offset:15360
    s_waitcnt lgkmcnt(10)
    v_mfma_f32_32x32x16_bf16 v[72:87], v[36:39], v[176:179], v[72:87]
    s_and_b32 s16, s16, 0x3ffff
    ds_read_b64_tr_b16 v[32:33], v21 offset:13312
    ds_read_b64_tr_b16 v[34:35], v21 offset:15360
    s_waitcnt lgkmcnt(10)
    v_mfma_f32_32x32x16_bf16 v[120:135], v[40:43], v[176:179], v[120:135]
    buffer_load_dwordx4 v[216:219], v249, s[32:35], s16 offen sc1
    ds_read_b64_tr_b16 v[36:37], v24 offset:13312
    ds_read_b64_tr_b16 v[38:39], v24 offset:15360
    s_waitcnt lgkmcnt(10)
    v_mfma_f32_32x32x16_bf16 v[136:151], v[44:47], v[176:179], v[136:151]
    ds_read_b64_tr_b16 v[40:41], v25 offset:13312
    ds_read_b64_tr_b16 v[42:43], v25 offset:15360
    s_waitcnt lgkmcnt(10)
    v_mfma_f32_32x32x16_bf16 v[88:103], v[48:51], v[176:179], v[88:103]
    ds_read_b64_tr_b16 v[44:45], v22 offset:13312
    ds_read_b64_tr_b16 v[46:47], v22 offset:15360
    s_waitcnt lgkmcnt(10)
    v_mfma_f32_32x32x16_bf16 v[104:119], v[52:55], v[176:179], v[104:119]
    buffer_load_dwordx4 v[220:223], v249, s[32:35], s16 offen offset:1024 sc1
    ds_read_b64_tr_b16 v[48:49], v23 offset:13312
    ds_read_b64_tr_b16 v[50:51], v23 offset:15360
    s_waitcnt vmcnt(10)
    s_waitcnt lgkmcnt(10)
    v_mfma_f32_32x32x16_bf16 v[56:71], v[28:31], v[180:183], v[56:71]
    ds_read_b64_tr_b16 v[52:53], v20 offset:16384
    ds_read_b64_tr_b16 v[54:55], v20 offset:18432
    s_waitcnt lgkmcnt(10)
    v_mfma_f32_32x32x16_bf16 v[72:87], v[32:35], v[180:183], v[72:87]
    ds_read_b64_tr_b16 v[28:29], v21 offset:16384
    ds_read_b64_tr_b16 v[30:31], v21 offset:18432
    s_waitcnt lgkmcnt(10)
    v_mfma_f32_32x32x16_bf16 v[120:135], v[36:39], v[180:183], v[120:135]
    buffer_load_dwordx4 v[224:227], v249, s[32:35], s16 offen offset:2048 sc1
    ds_read_b64_tr_b16 v[32:33], v24 offset:16384
    ds_read_b64_tr_b16 v[34:35], v24 offset:18432
    s_waitcnt lgkmcnt(10)
    v_mfma_f32_32x32x16_bf16 v[136:151], v[40:43], v[180:183], v[136:151]
    ds_read_b64_tr_b16 v[36:37], v25 offset:16384
    ds_read_b64_tr_b16 v[38:39], v25 offset:18432
    s_waitcnt lgkmcnt(10)
    v_mfma_f32_32x32x16_bf16 v[88:103], v[44:47], v[180:183], v[88:103]
    ds_read_b64_tr_b16 v[40:41], v22 offset:16384
    ds_read_b64_tr_b16 v[42:43], v22 offset:18432
    s_waitcnt lgkmcnt(10)
    v_mfma_f32_32x32x16_bf16 v[104:119], v[48:51], v[180:183], v[104:119]
    buffer_load_dwordx4 v[228:231], v249, s[32:35], s16 offen offset:3072 sc1
    ds_read_b64_tr_b16 v[44:45], v23 offset:16384
    ds_read_b64_tr_b16 v[46:47], v23 offset:18432
    s_barrier
    s_waitcnt vmcnt(11)
    s_waitcnt lgkmcnt(10)
    v_mfma_f32_32x32x16_bf16 v[56:71], v[52:55], v[184:187], v[56:71]
    s_add_u32 s16, s16, 16384
    ds_read_b64_tr_b16 v[48:49], v20 offset:17408
    ds_read_b64_tr_b16 v[50:51], v20 offset:19456
    s_waitcnt lgkmcnt(10)
    v_mfma_f32_32x32x16_bf16 v[72:87], v[28:31], v[184:187], v[72:87]
    s_and_b32 s16, s16, 0x3ffff
    ds_read_b64_tr_b16 v[52:53], v21 offset:17408
    ds_read_b64_tr_b16 v[54:55], v21 offset:19456
    s_waitcnt lgkmcnt(10)
    v_mfma_f32_32x32x16_bf16 v[120:135], v[32:35], v[184:187], v[120:135]
    ds_read_b64_tr_b16 v[28:29], v24 offset:17408
    ds_read_b64_tr_b16 v[30:31], v24 offset:19456
    s_waitcnt lgkmcnt(10)
    v_mfma_f32_32x32x16_bf16 v[136:151], v[36:39], v[184:187], v[136:151]
    ds_read_b64_tr_b16 v[32:33], v25 offset:17408
    ds_read_b64_tr_b16 v[34:35], v25 offset:19456
    s_waitcnt lgkmcnt(10)
    v_mfma_f32_32x32x16_bf16 v[88:103], v[40:43], v[184:187], v[88:103]
    ds_read_b64_tr_b16 v[36:37], v22 offset:17408
    ds_read_b64_tr_b16 v[38:39], v22 offset:19456
    s_waitcnt lgkmcnt(10)
    v_mfma_f32_32x32x16_bf16 v[104:119], v[44:47], v[184:187], v[104:119]
    ds_read_b64_tr_b16 v[40:41], v23 offset:17408
    ds_read_b64_tr_b16 v[42:43], v23 offset:19456
    s_waitcnt vmcnt(10)
    s_waitcnt lgkmcnt(10)
    v_mfma_f32_32x32x16_bf16 v[56:71], v[48:51], v[188:191], v[56:71]
    ds_read_b64_tr_b16 v[44:45], v20 offset:20480
    ds_read_b64_tr_b16 v[46:47], v20 offset:22528
    s_waitcnt lgkmcnt(10)
    v_mfma_f32_32x32x16_bf16 v[72:87], v[52:55], v[188:191], v[72:87]
    ds_read_b64_tr_b16 v[48:49], v21 offset:20480
    ds_read_b64_tr_b16 v[50:51], v21 offset:22528
    s_waitcnt lgkmcnt(10)
    v_mfma_f32_32x32x16_bf16 v[120:135], v[28:31], v[188:191], v[120:135]
    buffer_load_dwordx4 v[232:235], v249, s[32:35], s16 offen sc1
    ds_read_b64_tr_b16 v[52:53], v24 offset:20480
    ds_read_b64_tr_b16 v[54:55], v24 offset:22528
    s_waitcnt lgkmcnt(10)
    v_mfma_f32_32x32x16_bf16 v[136:151], v[32:35], v[188:191], v[136:151]
    ds_read_b64_tr_b16 v[28:29], v25 offset:20480
    ds_read_b64_tr_b16 v[30:31], v25 offset:22528
    s_waitcnt lgkmcnt(10)
    v_mfma_f32_32x32x16_bf16 v[88:103], v[36:39], v[188:191], v[88:103]
    ds_read_b64_tr_b16 v[32:33], v22 offset:20480
    ds_read_b64_tr_b16 v[34:35], v22 offset:22528
    s_waitcnt lgkmcnt(10)
    v_mfma_f32_32x32x16_bf16 v[104:119], v[40:43], v[188:191], v[104:119]
    buffer_load_dwordx4 v[236:239], v249, s[32:35], s16 offen offset:1024 sc1
    ds_read_b64_tr_b16 v[36:37], v23 offset:20480
    ds_read_b64_tr_b16 v[38:39], v23 offset:22528
    s_waitcnt vmcnt(11)
    s_waitcnt lgkmcnt(10)
    v_mfma_f32_32x32x16_bf16 v[56:71], v[44:47], v[192:195], v[56:71]
    ds_read_b64_tr_b16 v[40:41], v20 offset:21504
    ds_read_b64_tr_b16 v[42:43], v20 offset:23552
    s_waitcnt lgkmcnt(10)
    v_mfma_f32_32x32x16_bf16 v[72:87], v[48:51], v[192:195], v[72:87]
    ds_read_b64_tr_b16 v[44:45], v21 offset:21504
    ds_read_b64_tr_b16 v[46:47], v21 offset:23552
    s_waitcnt lgkmcnt(10)
    v_mfma_f32_32x32x16_bf16 v[120:135], v[52:55], v[192:195], v[120:135]
    buffer_load_dwordx4 v[240:243], v249, s[32:35], s16 offen offset:2048 sc1
    ds_read_b64_tr_b16 v[48:49], v24 offset:21504
    ds_read_b64_tr_b16 v[50:51], v24 offset:23552
    s_waitcnt lgkmcnt(10)
    v_mfma_f32_32x32x16_bf16 v[136:151], v[28:31], v[192:195], v[136:151]
    ds_read_b64_tr_b16 v[52:53], v25 offset:21504
    ds_read_b64_tr_b16 v[54:55], v25 offset:23552
    s_waitcnt lgkmcnt(10)
    v_mfma_f32_32x32x16_bf16 v[88:103], v[32:35], v[192:195], v[88:103]
    ds_read_b64_tr_b16 v[28:29], v22 offset:21504
    ds_read_b64_tr_b16 v[30:31], v22 offset:23552
    s_waitcnt lgkmcnt(10)
    v_mfma_f32_32x32x16_bf16 v[104:119], v[36:39], v[192:195], v[104:119]
    buffer_load_dwordx4 v[244:247], v249, s[32:35], s16 offen offset:3072 sc1
    ds_read_b64_tr_b16 v[32:33], v23 offset:21504
    ds_read_b64_tr_b16 v[34:35], v23 offset:23552
    s_waitcnt vmcnt(12)
    s_waitcnt lgkmcnt(10)
    v_mfma_f32_32x32x16_bf16 v[56:71], v[40:43], v[196:199], v[56:71]
    s_add_u32 s16, s16, 16384
    ds_read_b64_tr_b16 v[36:37], v20 offset:24576
    ds_read_b64_tr_b16 v[38:39], v20 offset:26624
    s_waitcnt lgkmcnt(10)
    v_mfma_f32_32x32x16_bf16 v[72:87], v[44:47], v[196:199], v[72:87]
    s_and_b32 s16, s16, 0x3ffff
    ds_read_b64_tr_b16 v[40:41], v21 offset:24576
    ds_read_b64_tr_b16 v[42:43], v21 offset:26624
    s_waitcnt lgkmcnt(10)
    v_mfma_f32_32x32x16_bf16 v[120:135], v[48:51], v[196:199], v[120:135]
    buffer_load_dwordx4 v[152:155], v249, s[32:35], s16 offen sc1
    ds_read_b64_tr_b16 v[44:45], v24 offset:24576
    ds_read_b64_tr_b16 v[46:47], v24 offset:26624
    s_waitcnt lgkmcnt(10)
    v_mfma_f32_32x32x16_bf16 v[136:151], v[52:55], v[196:199], v[136:151]
    ds_read_b64_tr_b16 v[48:49], v25 offset:24576
    ds_read_b64_tr_b16 v[50:51], v25 offset:26624
    s_waitcnt lgkmcnt(10)
    v_mfma_f32_32x32x16_bf16 v[88:103], v[28:31], v[196:199], v[88:103]
    ds_read_b64_tr_b16 v[52:53], v22 offset:24576
    ds_read_b64_tr_b16 v[54:55], v22 offset:26624
    s_waitcnt lgkmcnt(10)
    v_mfma_f32_32x32x16_bf16 v[104:119], v[32:35], v[196:199], v[104:119]
    buffer_load_dwordx4 v[156:159], v249, s[32:35], s16 offen offset:1024 sc1
    ds_read_b64_tr_b16 v[28:29], v23 offset:24576
    ds_read_b64_tr_b16 v[30:31], v23 offset:26624
    s_barrier
    s_waitcnt vmcnt(13)
    s_waitcnt lgkmcnt(10)
    v_mfma_f32_32x32x16_bf16 v[56:71], v[36:39], v[200:203], v[56:71]
    ds_read_b64_tr_b16 v[32:33], v20 offset:25600
    ds_read_b64_tr_b16 v[34:35], v20 offset:27648
    s_waitcnt lgkmcnt(10)
L_PAD2:
    s_cbranch_execz L_RET2
    v_mfma_f32_32x32x16_bf16 v[72:87], v[40:43], v[200:203], v[72:87]
    ds_read_b64_tr_b16 v[36:37], v21 offset:25600
    ds_read_b64_tr_b16 v[38:39], v21 offset:27648
    s_waitcnt lgkmcnt(10)
    v_mfma_f32_32x32x16_bf16 v[120:135], v[44:47], v[200:203], v[120:135]
    ds_read_b64_tr_b16 v[40:41], v24 offset:25600
    ds_read_b64_tr_b16 v[42:43], v24 offset:27648
    s_waitcnt lgkmcnt(10)
    v_mfma_f32_32x32x16_bf16 v[136:151], v[48:51], v[200:203], v[136:151]
    ds_read_b64_tr_b16 v[44:45], v25 offset:25600
    ds_read_b64_tr_b16 v[46:47], v25 offset:27648
    s_waitcnt lgkmcnt(10)
    v_mfma_f32_32x32x16_bf16 v[88:103], v[52:55], v[200:203], v[88:103]
    ds_read_b64_tr_b16 v[48:49], v22 offset:25600
    ds_read_b64_tr_b16 v[50:51], v22 offset:27648
    s_waitcnt lgkmcnt(10)
    v_mfma_f32_32x32x16_bf16 v[104:119], v[28:31], v[200:203], v[104:119]
    ds_read_b64_tr_b16 v[52:53], v23 offset:25600
    ds_read_b64_tr_b16 v[54:55], v23 offset:27648
    s_waitcnt vmcnt(12)
    s_waitcnt lgkmcnt(10)
    v_mfma_f32_32x32x16_bf16 v[56:71], v[32:35], v[204:207], v[56:71]
    ds_read_b64_tr_b16 v[28:29], v20 offset:28672
    ds_read_b64_tr_b16 v[30:31], v20 offset:30720
    s_waitcnt lgkmcnt(10)
    v_mfma_f32_32x32x16_bf16 v[72:87], v[36:39], v[204:207], v[72:87]
    ds_read_b64_tr_b16 v[32:33], v21 offset:28672
    ds_read_b64_tr_b16 v[34:35], v21 offset:30720
    s_waitcnt lgkmcnt(10)
    v_mfma_f32_32x32x16_bf16 v[120:135], v[40:43], v[204:207], v[120:135]
    buffer_load_dwordx4 v[160:163], v249, s[32:35], s16 offen offset:2048 sc1
    ds_read_b64_tr_b16 v[36:37], v24 offset:28672
    ds_read_b64_tr_b16 v[38:39], v24 offset:30720
    s_waitcnt lgkmcnt(10)
    v_mfma_f32_32x32x16_bf16 v[136:151], v[44:47], v[204:207], v[136:151]
    ds_read_b64_tr_b16 v[40:41], v25 offset:28672
    ds_read_b64_tr_b16 v[42:43], v25 offset:30720
    s_waitcnt lgkmcnt(10)
    v_mfma_f32_32x32x16_bf16 v[88:103], v[48:51], v[204:207], v[88:103]
    ds_read_b64_tr_b16 v[44:45], v22 offset:28672
    ds_read_b64_tr_b16 v[46:47], v22 offset:30720
    s_waitcnt lgkmcnt(10)
    v_mfma_f32_32x32x16_bf16 v[104:119], v[52:55], v[204:207], v[104:119]
    buffer_load_dwordx4 v[164:167], v249, s[32:35], s16 offen offset:3072 sc1
    ds_read_b64_tr_b16 v[48:49], v23 offset:28672
    ds_read_b64_tr_b16 v[50:51], v23 offset:30720
    s_waitcnt vmcnt(13)
    s_waitcnt lgkmcnt(10)
    v_mfma_f32_32x32x16_bf16 v[56:71], v[28:31], v[208:211], v[56:71]
    s_add_u32 s16, s16, 16384
    ds_read_b64_tr_b16 v[52:53], v20 offset:29696
    ds_read_b64_tr_b16 v[54:55], v20 offset:31744
    s_waitcnt lgkmcnt(10)
    v_mfma_f32_32x32x16_bf16 v[72:87], v[32:35], v[208:211], v[72:87]
    s_and_b32 s16, s16, 0x3ffff
    ds_read_b64_tr_b16 v[28:29], v21 offset:29696
    ds_read_b64_tr_b16 v[30:31], v21 offset:31744
    s_waitcnt lgkmcnt(10)
    v_mfma_f32_32x32x16_bf16 v[120:135], v[36:39], v[208:211], v[120:135]
    buffer_load_dwordx4 v[168:171], v249, s[32:35], s16 offen sc1
    ds_read_b64_tr_b16 v[32:33], v24 offset:29696
    ds_read_b64_tr_b16 v[34:35], v24 offset:31744
    s_waitcnt lgkmcnt(10)
    v_mfma_f32_32x32x16_bf16 v[136:151], v[40:43], v[208:211], v[136:151]
    ds_read_b64_tr_b16 v[36:37], v25 offset:29696
    ds_read_b64_tr_b16 v[38:39], v25 offset:31744
    s_waitcnt lgkmcnt(10)
    v_mfma_f32_32x32x16_bf16 v[88:103], v[44:47], v[208:211], v[88:103]
    ds_read_b64_tr_b16 v[40:41], v22 offset:29696
    ds_read_b64_tr_b16 v[42:43], v22 offset:31744
    s_waitcnt lgkmcnt(10)
    v_mfma_f32_32x32x16_bf16 v[104:119], v[48:51], v[208:211], v[104:119]
    buffer_load_dwordx4 v[172:175], v249, s[32:35], s16 offen offset:1024 sc1
    ds_read_b64_tr_b16 v[44:45], v23 offset:29696
    ds_read_b64_tr_b16 v[46:47], v23 offset:31744
    s_waitcnt vmcnt(14)
    s_waitcnt lgkmcnt(10)
    v_mfma_f32_32x32x16_bf16 v[56:71], v[52:55], v[212:215], v[56:71]
    ds_read_b64_tr_b16 v[48:49], v20 offset:32768
    ds_read_b64_tr_b16 v[50:51], v20 offset:34816
    s_waitcnt lgkmcnt(10)
    v_mfma_f32_32x32x16_bf16 v[72:87], v[28:31], v[212:215], v[72:87]
    ds_read_b64_tr_b16 v[52:53], v21 offset:32768
    ds_read_b64_tr_b16 v[54:55], v21 offset:34816
    s_waitcnt lgkmcnt(10)
    v_mfma_f32_32x32x16_bf16 v[120:135], v[32:35], v[212:215], v[120:135]
    buffer_load_dwordx4 v[176:179], v249, s[32:35], s16 offen offset:2048 sc1
    ds_read_b64_tr_b16 v[28:29], v24 offset:32768
    ds_read_b64_tr_b16 v[30:31], v24 offset:34816
    s_waitcnt lgkmcnt(10)
    v_mfma_f32_32x32x16_bf16 v[136:151], v[36:39], v[212:215], v[136:151]
    ds_read_b64_tr_b16 v[32:33], v25 offset:32768
    ds_read_b64_tr_b16 v[34:35], v25 offset:34816
    s_waitcnt lgkmcnt(10)
    v_mfma_f32_32x32x16_bf16 v[88:103], v[40:43], v[212:215], v[88:103]
    ds_read_b64_tr_b16 v[36:37], v22 offset:32768
    ds_read_b64_tr_b16 v[38:39], v22 offset:34816
    s_waitcnt lgkmcnt(10)
    v_mfma_f32_32x32x16_bf16 v[104:119], v[44:47], v[212:215], v[104:119]
    buffer_load_dwordx4 v[180:183], v249, s[32:35], s16 offen offset:3072 sc1
    ds_read_b64_tr_b16 v[40:41], v23 offset:32768
    ds_read_b64_tr_b16 v[42:43], v23 offset:34816
    s_barrier
    s_waitcnt vmcnt(15)
    s_waitcnt lgkmcnt(10)
    v_mfma_f32_32x32x16_bf16 v[56:71], v[48:51], v[216:219], v[56:71]
    s_add_u32 s16, s16, 16384
    ds_read_b64_tr_b16 v[44:45], v20 offset:33792
    ds_read_b64_tr_b16 v[46:47], v20 offset:35840
    s_waitcnt lgkmcnt(10)
    v_mfma_f32_32x32x16_bf16 v[72:87], v[52:55], v[216:219], v[72:87]
    s_and_b32 s16, s16, 0x3ffff
    ds_read_b64_tr_b16 v[48:49], v21 offset:33792
    ds_read_b64_tr_b16 v[50:51], v21 offset:35840
    s_waitcnt lgkmcnt(10)
    v_mfma_f32_32x32x16_bf16 v[120:135], v[28:31], v[216:219], v[120:135]
    ds_read_b64_tr_b16 v[52:53], v24 offset:33792
    ds_read_b64_tr_b16 v[54:55], v24 offset:35840
    s_waitcnt lgkmcnt(10)
    v_mfma_f32_32x32x16_bf16 v[136:151], v[32:35], v[216:219], v[136:151]
    ds_read_b64_tr_b16 v[28:29], v25 offset:33792
    ds_read_b64_tr_b16 v[30:31], v25 offset:35840
    s_waitcnt lgkmcnt(10)
    v_mfma_f32_32x32x16_bf16 v[88:103], v[36:39], v[216:219], v[88:103]
    ds_read_b64_tr_b16 v[32:33], v22 offset:33792
    ds_read_b64_tr_b16 v[34:35], v22 offset:35840
    s_waitcnt lgkmcnt(10)
    v_mfma_f32_32x32x16_bf16 v[104:119], v[40:43], v[216:219], v[104:119]
    ds_read_b64_tr_b16 v[36:37], v23 offset:33792
    ds_read_b64_tr_b16 v[38:39], v23 offset:35840
    s_waitcnt vmcnt(14)
    s_waitcnt lgkmcnt(10)
    v_mfma_f32_32x32x16_bf16 v[56:71], v[44:47], v[220:223], v[56:71]
    ds_read_b64_tr_b16 v[40:41], v20 offset:36864
    ds_read_b64_tr_b16 v[42:43], v20 offset:38912
    s_waitcnt lgkmcnt(10)
    v_mfma_f32_32x32x16_bf16 v[72:87], v[48:51], v[220:223], v[72:87]
    ds_read_b64_tr_b16 v[44:45], v21 offset:36864
    ds_read_b64_tr_b16 v[46:47], v21 offset:38912
    s_waitcnt lgkmcnt(10)
    v_mfma_f32_32x32x16_bf16 v[120:135], v[52:55], v[220:223], v[120:135]
    buffer_load_dwordx4 v[184:187], v249, s[32:35], s16 offen sc1
    ds_read_b64_tr_b16 v[48:49], v24 offset:36864
    ds_read_b64_tr_b16 v[50:51], v24 offset:38912
    s_waitcnt lgkmcnt(10)
    v_mfma_f32_32x32x16_bf16 v[136:151], v[28:31], v[220:223], v[136:151]
    ds_read_b64_tr_b16 v[52:53], v25 offset:36864
    ds_read_b64_tr_b16 v[54:55], v25 offset:38912
    s_waitcnt lgkmcnt(10)
    v_mfma_f32_32x32x16_bf16 v[88:103], v[32:35], v[220:223], v[88:103]
    ds_read_b64_tr_b16 v[28:29], v22 offset:36864
    ds_read_b64_tr_b16 v[30:31], v22 offset:38912
    s_waitcnt lgkmcnt(10)
    v_mfma_f32_32x32x16_bf16 v[104:119], v[36:39], v[220:223], v[104:119]
    buffer_load_dwordx4 v[188:191], v249, s[32:35], s16 offen offset:1024 sc1
    ds_read_b64_tr_b16 v[32:33], v23 offset:36864
    ds_read_b64_tr_b16 v[34:35], v23 offset:38912
    s_waitcnt vmcnt(15)
    s_waitcnt lgkmcnt(10)
    v_mfma_f32_32x32x16_bf16 v[56:71], v[40:43], v[224:227], v[56:71]
    ds_read_b64_tr_b16 v[36:37], v20 offset:37888
    ds_read_b64_tr_b16 v[38:39], v20 offset:39936
    s_waitcnt lgkmcnt(10)
    v_mfma_f32_32x32x16_bf16 v[72:87], v[44:47], v[224:227], v[72:87]
    ds_read_b64_tr_b16 v[40:41], v21 offset:37888
    ds_read_b64_tr_b16 v[42:43], v21 offset:39936
    s_waitcnt lgkmcnt(10)
    v_mfma_f32_32x32x16_bf16 v[120:135], v[48:51], v[224:227], v[120:135]
    buffer_load_dwordx4 v[192:195], v249, s[32:35], s16 offen offset:2048 sc1
    ds_read_b64_tr_b16 v[44:45], v24 offset:37888
    ds_read_b64_tr_b16 v[46:47], v24 offset:39936
    s_waitcnt lgkmcnt(10)
    v_mfma_f32_32x32x16_bf16 v[136:151], v[52:55], v[224:227], v[136:151]
    ds_read_b64_tr_b16 v[48:49], v25 offset:37888
    ds_read_b64_tr_b16 v[50:51], v25 offset:39936
    s_waitcnt lgkmcnt(10)
    v_mfma_f32_32x32x16_bf16 v[88:103], v[28:31], v[224:227], v[88:103]
    ds_read_b64_tr_b16 v[52:53], v22 offset:37888
    ds_read_b64_tr_b16 v[54:55], v22 offset:39936
    s_waitcnt lgkmcnt(10)
    v_mfma_f32_32x32x16_bf16 v[104:119], v[32:35], v[224:227], v[104:119]
    buffer_load_dwordx4 v[196:199], v249, s[32:35], s16 offen offset:3072 sc1
    ds_read_b64_tr_b16 v[28:29], v23 offset:37888
    ds_read_b64_tr_b16 v[30:31], v23 offset:39936
    s_waitcnt vmcnt(16)
    s_waitcnt lgkmcnt(10)
    v_mfma_f32_32x32x16_bf16 v[56:71], v[36:39], v[228:231], v[56:71]
    s_add_u32 s16, s16, 16384
    ds_read_b64_tr_b16 v[32:33], v20 offset:40960
    ds_read_b64_tr_b16 v[34:35], v20 offset:43008
    s_waitcnt lgkmcnt(10)
    v_mfma_f32_32x32x16_bf16 v[72:87], v[40:43], v[228:231], v[72:87]
    s_and_b32 s16, s16, 0x3ffff
    ds_read_b64_tr_b16 v[36:37], v21 offset:40960
    ds_read_b64_tr_b16 v[38:39], v21 offset:43008
    s_waitcnt lgkmcnt(10)
    v_mfma_f32_32x32x16_bf16 v[120:135], v[44:47], v[228:231], v[120:135]
    buffer_load_dwordx4 v[200:203], v249, s[32:35], s16 offen sc1
    ds_read_b64_tr_b16 v[40:41], v24 offset:40960
    ds_read_b64_tr_b16 v[42:43], v24 offset:43008
    s_waitcnt lgkmcnt(10)
    v_mfma_f32_32x32x16_bf16 v[136:151], v[48:51], v[228:231], v[136:151]
    ds_read_b64_tr_b16 v[44:45], v25 offset:40960
    ds_read_b64_tr_b16 v[46:47], v25 offset:43008
    s_waitcnt lgkmcnt(10)
    v_mfma_f32_32x32x16_bf16 v[88:103], v[52:55], v[228:231], v[88:103]
    ds_read_b64_tr_b16 v[48:49], v22 offset:40960
    ds_read_b64_tr_b16 v[50:51], v22 offset:43008
    s_waitcnt lgkmcnt(10)
    v_mfma_f32_32x32x16_bf16 v[104:119], v[28:31], v[228:231], v[104:119]
    buffer_load_dwordx4 v[204:207], v249, s[32:35], s16 offen offset:1024 sc1
    ds_read_b64_tr_b16 v[52:53], v23 offset:40960
    ds_read_b64_tr_b16 v[54:55], v23 offset:43008
    s_barrier
    s_waitcnt vmcnt(17)
    s_waitcnt lgkmcnt(10)
    v_mfma_f32_32x32x16_bf16 v[56:71], v[32:35], v[232:235], v[56:71]
    ds_read_b64_tr_b16 v[28:29], v20 offset:41984
    ds_read_b64_tr_b16 v[30:31], v20 offset:44032
    s_waitcnt lgkmcnt(10)
    v_mfma_f32_32x32x16_bf16 v[72:87], v[36:39], v[232:235], v[72:87]
    ds_read_b64_tr_b16 v[32:33], v21 offset:41984
    ds_read_b64_tr_b16 v[34:35], v21 offset:44032
    s_waitcnt lgkmcnt(10)
    v_mfma_f32_32x32x16_bf16 v[120:135], v[40:43], v[232:235], v[120:135]
    ds_read_b64_tr_b16 v[36:37], v24 offset:41984
    ds_read_b64_tr_b16 v[38:39], v24 offset:44032
    s_waitcnt lgkmcnt(10)
    v_mfma_f32_32x32x16_bf16 v[136:151], v[44:47], v[232:235], v[136:151]
    ds_read_b64_tr_b16 v[40:41], v25 offset:41984
    ds_read_b64_tr_b16 v[42:43], v25 offset:44032
    s_waitcnt lgkmcnt(10)
    v_mfma_f32_32x32x16_bf16 v[88:103], v[48:51], v[232:235], v[88:103]
    ds_read_b64_tr_b16 v[44:45], v22 offset:41984
    ds_read_b64_tr_b16 v[46:47], v22 offset:44032
    s_waitcnt lgkmcnt(10)
    v_mfma_f32_32x32x16_bf16 v[104:119], v[52:55], v[232:235], v[104:119]
    ds_read_b64_tr_b16 v[48:49], v23 offset:41984
    ds_read_b64_tr_b16 v[50:51], v23 offset:44032
    s_waitcnt vmcnt(16)
    s_waitcnt lgkmcnt(10)
    v_mfma_f32_32x32x16_bf16 v[56:71], v[28:31], v[236:239], v[56:71]
    ds_read_b64_tr_b16 v[52:53], v20 offset:45056
    ds_read_b64_tr_b16 v[54:55], v20 offset:47104
    s_waitcnt lgkmcnt(10)
    v_mfma_f32_32x32x16_bf16 v[72:87], v[32:35], v[236:239], v[72:87]
    ds_read_b64_tr_b16 v[28:29], v21 offset:45056
    ds_read_b64_tr_b16 v[30:31], v21 offset:47104
    s_waitcnt lgkmcnt(10)
    v_mfma_f32_32x32x16_bf16 v[120:135], v[36:39], v[236:239], v[120:135]
    buffer_load_dwordx4 v[208:211], v249, s[32:35], s16 offen offset:2048 sc1
    ds_read_b64_tr_b16 v[32:33], v24 offset:45056
    ds_read_b64_tr_b16 v[34:35], v24 offset:47104
    s_waitcnt lgkmcnt(10)
    v_mfma_f32_32x32x16_bf16 v[136:151], v[40:43], v[236:239], v[136:151]
    ds_read_b64_tr_b16 v[36:37], v25 offset:45056
    ds_read_b64_tr_b16 v[38:39], v25 offset:47104
    s_waitcnt lgkmcnt(10)
    v_mfma_f32_32x32x16_bf16 v[88:103], v[44:47], v[236:239], v[88:103]
    ds_read_b64_tr_b16 v[40:41], v22 offset:45056
    ds_read_b64_tr_b16 v[42:43], v22 offset:47104
    s_waitcnt lgkmcnt(10)
    v_mfma_f32_32x32x16_bf16 v[104:119], v[48:51], v[236:239], v[104:119]
    buffer_load_dwordx4 v[212:215], v249, s[32:35], s16 offen offset:3072 sc1
    ds_read_b64_tr_b16 v[44:45], v23 offset:45056
    ds_read_b64_tr_b16 v[46:47], v23 offset:47104
    s_waitcnt vmcnt(17)
    s_waitcnt lgkmcnt(10)
    v_mfma_f32_32x32x16_bf16 v[56:71], v[52:55], v[240:243], v[56:71]
    s_add_u32 s16, s16, 16384
    ds_read_b64_tr_b16 v[48:49], v20 offset:46080
    ds_read_b64_tr_b16 v[50:51], v20 offset:48128
    s_waitcnt lgkmcnt(10)
    v_mfma_f32_32x32x16_bf16 v[72:87], v[28:31], v[240:243], v[72:87]
    s_and_b32 s16, s16, 0x3ffff
    ds_read_b64_tr_b16 v[52:53], v21 offset:46080
    ds_read_b64_tr_b16 v[54:55], v21 offset:48128
    s_waitcnt lgkmcnt(10)
    v_mfma_f32_32x32x16_bf16 v[120:135], v[32:35], v[240:243], v[120:135]
    buffer_load_dwordx4 v[216:219], v249, s[32:35], s16 offen sc1
    ds_read_b64_tr_b16 v[28:29], v24 offset:46080
    ds_read_b64_tr_b16 v[30:31], v24 offset:48128
    s_waitcnt lgkmcnt(10)
    v_mfma_f32_32x32x16_bf16 v[136:151], v[36:39], v[240:243], v[136:151]
    ds_read_b64_tr_b16 v[32:33], v25 offset:46080
    ds_read_b64_tr_b16 v[34:35], v25 offset:48128
    s_waitcnt lgkmcnt(10)
    v_mfma_f32_32x32x16_bf16 v[88:103], v[40:43], v[240:243], v[88:103]
    ds_read_b64_tr_b16 v[36:37], v22 offset:46080
    ds_read_b64_tr_b16 v[38:39], v22 offset:48128
    s_waitcnt lgkmcnt(10)
    v_mfma_f32_32x32x16_bf16 v[104:119], v[44:47], v[240:243], v[104:119]
    buffer_load_dwordx4 v[220:223], v249, s[32:35], s16 offen offset:1024 sc1
    ds_read_b64_tr_b16 v[40:41], v23 offset:46080
    ds_read_b64_tr_b16 v[42:43], v23 offset:48128
    s_waitcnt vmcnt(18)
    s_waitcnt lgkmcnt(10)
    v_mfma_f32_32x32x16_bf16 v[56:71], v[48:51], v[244:247], v[56:71]
    ds_read_b64_tr_b16 v[44:45], v20
    ds_read_b64_tr_b16 v[46:47], v20 offset:2048
    s_waitcnt lgkmcnt(10)
    v_mfma_f32_32x32x16_bf16 v[72:87], v[52:55], v[244:247], v[72:87]
    ds_read_b64_tr_b16 v[48:49], v21
    ds_read_b64_tr_b16 v[50:51], v21 offset:2048
    s_waitcnt lgkmcnt(10)
    v_mfma_f32_32x32x16_bf16 v[120:135], v[28:31], v[244:247], v[120:135]
    buffer_load_dwordx4 v[224:227], v249, s[32:35], s16 offen offset:2048 sc1
    ds_read_b64_tr_b16 v[52:53], v24
    ds_read_b64_tr_b16 v[54:55], v24 offset:2048
    s_waitcnt lgkmcnt(10)
    v_mfma_f32_32x32x16_bf16 v[136:151], v[32:35], v[244:247], v[136:151]
    ds_read_b64_tr_b16 v[28:29], v25
    ds_read_b64_tr_b16 v[30:31], v25 offset:2048
    s_waitcnt lgkmcnt(10)
    v_mfma_f32_32x32x16_bf16 v[88:103], v[36:39], v[244:247], v[88:103]
    ds_read_b64_tr_b16 v[32:33], v22
    ds_read_b64_tr_b16 v[34:35], v22 offset:2048
    s_waitcnt lgkmcnt(10)
    v_mfma_f32_32x32x16_bf16 v[104:119], v[40:43], v[244:247], v[104:119]
    buffer_load_dwordx4 v[228:231], v249, s[32:35], s16 offen offset:3072 sc1
    ds_read_b64_tr_b16 v[36:37], v23
    ds_read_b64_tr_b16 v[38:39], v23 offset:2048
    s_barrier
    s_waitcnt vmcnt(19)
    s_waitcnt lgkmcnt(10)
    v_mfma_f32_32x32x16_bf16 v[56:71], v[44:47], v[152:155], v[56:71]
    s_add_u32 s16, s16, 16384
    ds_read_b64_tr_b16 v[40:41], v20 offset:1024
    ds_read_b64_tr_b16 v[42:43], v20 offset:3072
    s_waitcnt lgkmcnt(10)
    v_mfma_f32_32x32x16_bf16 v[72:87], v[48:51], v[152:155], v[72:87]
    s_and_b32 s16, s16, 0x3ffff
    ds_read_b64_tr_b16 v[44:45], v21 offset:1024
    ds_read_b64_tr_b16 v[46:47], v21 offset:3072
    s_waitcnt lgkmcnt(10)
    v_mfma_f32_32x32x16_bf16 v[120:135], v[52:55], v[152:155], v[120:135]
    ds_read_b64_tr_b16 v[48:49], v24 offset:1024
    ds_read_b64_tr_b16 v[50:51], v24 offset:3072
    s_waitcnt lgkmcnt(10)
    v_mfma_f32_32x32x16_bf16 v[136:151], v[28:31], v[152:155], v[136:151]
    ds_read_b64_tr_b16 v[52:53], v25 offset:1024
    ds_read_b64_tr_b16 v[54:55], v25 offset:3072
    s_waitcnt lgkmcnt(10)
    v_mfma_f32_32x32x16_bf16 v[88:103], v[32:35], v[152:155], v[88:103]
    ds_read_b64_tr_b16 v[28:29], v22 offset:1024
    ds_read_b64_tr_b16 v[30:31], v22 offset:3072
    s_waitcnt lgkmcnt(10)
    v_mfma_f32_32x32x16_bf16 v[104:119], v[36:39], v[152:155], v[104:119]
    ds_read_b64_tr_b16 v[32:33], v23 offset:1024
    ds_read_b64_tr_b16 v[34:35], v23 offset:3072
    s_waitcnt vmcnt(18)
    s_waitcnt lgkmcnt(10)
    v_mfma_f32_32x32x16_bf16 v[56:71], v[40:43], v[156:159], v[56:71]
    ds_read_b64_tr_b16 v[36:37], v20 offset:4096
    ds_read_b64_tr_b16 v[38:39], v20 offset:6144
    s_waitcnt lgkmcnt(10)
    v_mfma_f32_32x32x16_bf16 v[72:87], v[44:47], v[156:159], v[72:87]
    ds_read_b64_tr_b16 v[40:41], v21 offset:4096
    ds_read_b64_tr_b16 v[42:43], v21 offset:6144
    s_waitcnt lgkmcnt(10)
    v_mfma_f32_32x32x16_bf16 v[120:135], v[48:51], v[156:159], v[120:135]
    ds_read_b64_tr_b16 v[44:45], v24 offset:4096
    ds_read_b64_tr_b16 v[46:47], v24 offset:6144
    s_waitcnt lgkmcnt(10)
    v_mfma_f32_32x32x16_bf16 v[136:151], v[52:55], v[156:159], v[136:151]
    buffer_load_dwordx4 v[232:235], v249, s[32:35], s16 offen sc1
    ds_read_b64_tr_b16 v[48:49], v25 offset:4096
    ds_read_b64_tr_b16 v[50:51], v25 offset:6144
    s_waitcnt lgkmcnt(10)
    v_mfma_f32_32x32x16_bf16 v[88:103], v[28:31], v[156:159], v[88:103]
    ds_read_b64_tr_b16 v[52:53], v22 offset:4096
    ds_read_b64_tr_b16 v[54:55], v22 offset:6144
    s_waitcnt lgkmcnt(10)
    v_mfma_f32_32x32x16_bf16 v[104:119], v[32:35], v[156:159], v[104:119]
    ds_read_b64_tr_b16 v[28:29], v23 offset:4096
    ds_read_b64_tr_b16 v[30:31], v23 offset:6144
    s_waitcnt vmcnt(18)
    s_waitcnt lgkmcnt(10)
    v_mfma_f32_32x32x16_bf16 v[56:71], v[36:39], v[160:163], v[56:71]
    ds_read_b64_tr_b16 v[32:33], v20 offset:5120
    ds_read_b64_tr_b16 v[34:35], v20 offset:7168
    s_waitcnt lgkmcnt(10)
    v_mfma_f32_32x32x16_bf16 v[72:87], v[40:43], v[160:163], v[72:87]
    buffer_load_dwordx4 v[236:239], v249, s[32:35], s16 offen offset:1024 sc1
    ds_read_b64_tr_b16 v[36:37], v21 offset:5120
    ds_read_b64_tr_b16 v[38:39], v21 offset:7168
    s_waitcnt lgkmcnt(10)
    v_mfma_f32_32x32x16_bf16 v[120:135], v[44:47], v[160:163], v[120:135]
    ds_read_b64_tr_b16 v[40:41], v24 offset:5120
    ds_read_b64_tr_b16 v[42:43], v24 offset:7168
    s_waitcnt lgkmcnt(10)
    v_mfma_f32_32x32x16_bf16 v[136:151], v[48:51], v[160:163], v[136:151]
    ds_read_b64_tr_b16 v[44:45], v25 offset:5120
    ds_read_b64_tr_b16 v[46:47], v25 offset:7168
    s_waitcnt lgkmcnt(10)
    v_mfma_f32_32x32x16_bf16 v[88:103], v[52:55], v[160:163], v[88:103]
    buffer_load_dwordx4 v[240:243], v249, s[32:35], s16 offen offset:2048 sc1
    ds_read_b64_tr_b16 v[48:49], v22 offset:5120
    ds_read_b64_tr_b16 v[50:51], v22 offset:7168
    s_waitcnt lgkmcnt(10)
    v_mfma_f32_32x32x16_bf16 v[104:119], v[28:31], v[160:163], v[104:119]
    ds_read_b64_tr_b16 v[52:53], v23 offset:5120
    ds_read_b64_tr_b16 v[54:55], v23 offset:7168
    s_waitcnt vmcnt(19)
    s_waitcnt lgkmcnt(10)
    v_mfma_f32_32x32x16_bf16 v[56:71], v[32:35], v[164:167], v[56:71]
    ds_read_b64_tr_b16 v[28:29], v20 offset:8192
    ds_read_b64_tr_b16 v[30:31], v20 offset:10240
    s_waitcnt lgkmcnt(10)
    v_mfma_f32_32x32x16_bf16 v[72:87], v[36:39], v[164:167], v[72:87]
    ds_read_b64_tr_b16 v[32:33], v21 offset:8192
    ds_read_b64_tr_b16 v[34:35], v21 offset:10240
    s_waitcnt lgkmcnt(10)
    v_mfma_f32_32x32x16_bf16 v[120:135], v[40:43], v[164:167], v[120:135]
    buffer_load_dwordx4 v[244:247], v249, s[32:35], s16 offen offset:3072 sc1
    ds_read_b64_tr_b16 v[36:37], v24 offset:8192
    ds_read_b64_tr_b16 v[38:39], v24 offset:10240
    s_waitcnt lgkmcnt(10)
    v_mfma_f32_32x32x16_bf16 v[136:151], v[44:47], v[164:167], v[136:151]
    s_add_u32 s16, s16, 16384
    ds_read_b64_tr_b16 v[40:41], v25 offset:8192
    ds_read_b64_tr_b16 v[42:43], v25 offset:10240
    s_waitcnt lgkmcnt(10)
    v_mfma_f32_32x32x16_bf16 v[88:103], v[48:51], v[164:167], v[88:103]
    s_and_b32 s16, s16, 0x3ffff
    ds_read_b64_tr_b16 v[44:45], v22 offset:8192
    ds_read_b64_tr_b16 v[46:47], v22 offset:10240
    s_waitcnt lgkmcnt(10)
    v_mfma_f32_32x32x16_bf16 v[104:119], v[52:55], v[164:167], v[104:119]
    buffer_load_dwordx4 v[152:155], v249, s[32:35], s16 offen sc1
    ds_read_b64_tr_b16 v[48:49], v23 offset:8192
    ds_read_b64_tr_b16 v[50:51], v23 offset:10240
    s_barrier
    s_waitcnt vmcnt(20)
    s_waitcnt lgkmcnt(10)
    v_mfma_f32_32x32x16_bf16 v[56:71], v[28:31], v[168:171], v[56:71]
    ds_read_b64_tr_b16 v[52:53], v20 offset:9216
    ds_read_b64_tr_b16 v[54:55], v20 offset:11264
    s_waitcnt lgkmcnt(10)
    v_mfma_f32_32x32x16_bf16 v[72:87], v[32:35], v[168:171], v[72:87]
    ds_read_b64_tr_b16 v[28:29], v21 offset:9216
    ds_read_b64_tr_b16 v[30:31], v21 offset:11264
    s_waitcnt lgkmcnt(10)
    v_mfma_f32_32x32x16_bf16 v[120:135], v[36:39], v[168:171], v[120:135]
    ds_read_b64_tr_b16 v[32:33], v24 offset:9216
    ds_read_b64_tr_b16 v[34:35], v24 offset:11264
    s_waitcnt lgkmcnt(10)
    v_mfma_f32_32x32x16_bf16 v[136:151], v[40:43], v[168:171], v[136:151]
    ds_read_b64_tr_b16 v[36:37], v25 offset:9216
    ds_read_b64_tr_b16 v[38:39], v25 offset:11264
    s_waitcnt lgkmcnt(10)
    v_mfma_f32_32x32x16_bf16 v[88:103], v[44:47], v[168:171], v[88:103]
    ds_read_b64_tr_b16 v[40:41], v22 offset:9216
    ds_read_b64_tr_b16 v[42:43], v22 offset:11264
    s_waitcnt lgkmcnt(10)
    v_mfma_f32_32x32x16_bf16 v[104:119], v[48:51], v[168:171], v[104:119]
    ds_read_b64_tr_b16 v[44:45], v23 offset:9216
    ds_read_b64_tr_b16 v[46:47], v23 offset:11264
    s_waitcnt vmcnt(19)
    s_waitcnt lgkmcnt(10)
    v_mfma_f32_32x32x16_bf16 v[56:71], v[52:55], v[172:175], v[56:71]
    ds_read_b64_tr_b16 v[48:49], v20 offset:12288
    ds_read_b64_tr_b16 v[50:51], v20 offset:14336
    s_waitcnt lgkmcnt(10)
    v_mfma_f32_32x32x16_bf16 v[72:87], v[28:31], v[172:175], v[72:87]
    ds_read_b64_tr_b16 v[52:53], v21 offset:12288
    ds_read_b64_tr_b16 v[54:55], v21 offset:14336
    s_waitcnt lgkmcnt(10)
    v_mfma_f32_32x32x16_bf16 v[120:135], v[32:35], v[172:175], v[120:135]
    ds_read_b64_tr_b16 v[28:29], v24 offset:12288
    ds_read_b64_tr_b16 v[30:31], v24 offset:14336
    s_waitcnt lgkmcnt(10)
    v_mfma_f32_32x32x16_bf16 v[136:151], v[36:39], v[172:175], v[136:151]
    buffer_load_dwordx4 v[156:159], v249, s[32:35], s16 offen offset:1024 sc1
    ds_read_b64_tr_b16 v[32:33], v25 offset:12288
    ds_read_b64_tr_b16 v[34:35], v25 offset:14336
    s_waitcnt lgkmcnt(10)
    v_mfma_f32_32x32x16_bf16 v[88:103], v[40:43], v[172:175], v[88:103]
    ds_read_b64_tr_b16 v[36:37], v22 offset:12288
    ds_read_b64_tr_b16 v[38:39], v22 offset:14336
    s_waitcnt lgkmcnt(10)
    v_mfma_f32_32x32x16_bf16 v[104:119], v[44:47], v[172:175], v[104:119]
    ds_read_b64_tr_b16 v[40:41], v23 offset:12288
    ds_read_b64_tr_b16 v[42:43], v23 offset:14336
    s_waitcnt vmcnt(19)
    s_waitcnt lgkmcnt(10)
    v_mfma_f32_32x32x16_bf16 v[56:71], v[48:51], v[176:179], v[56:71]
    ds_read_b64_tr_b16 v[44:45], v20 offset:13312
    ds_read_b64_tr_b16 v[46:47], v20 offset:15360
    s_waitcnt lgkmcnt(10)
    v_mfma_f32_32x32x16_bf16 v[72:87], v[52:55], v[176:179], v[72:87]
    buffer_load_dwordx4 v[160:163], v249, s[32:35], s16 offen offset:2048 sc1
    ds_read_b64_tr_b16 v[48:49], v21 offset:13312
    ds_read_b64_tr_b16 v[50:51], v21 offset:15360
    s_waitcnt lgkmcnt(10)
    v_mfma_f32_32x32x16_bf16 v[120:135], v[28:31], v[176:179], v[120:135]
    ds_read_b64_tr_b16 v[52:53], v24 offset:13312
    ds_read_b64_tr_b16 v[54:55], v24 offset:15360
    s_waitcnt lgkmcnt(10)
    v_mfma_f32_32x32x16_bf16 v[136:151], v[32:35], v[176:179], v[136:151]
    ds_read_b64_tr_b16 v[28:29], v25 offset:13312
    ds_read_b64_tr_b16 v[30:31], v25 offset:15360
    s_waitcnt lgkmcnt(10)
    v_mfma_f32_32x32x16_bf16 v[88:103], v[36:39], v[176:179], v[88:103]
    buffer_load_dwordx4 v[164:167], v249, s[32:35], s16 offen offset:3072 sc1
    ds_read_b64_tr_b16 v[32:33], v22 offset:13312
    ds_read_b64_tr_b16 v[34:35], v22 offset:15360
    s_waitcnt lgkmcnt(10)
    v_mfma_f32_32x32x16_bf16 v[104:119], v[40:43], v[176:179], v[104:119]
    s_add_u32 s16, s16, 16384
    ds_read_b64_tr_b16 v[36:37], v23 offset:13312
    ds_read_b64_tr_b16 v[38:39], v23 offset:15360
    s_waitcnt vmcnt(20)
    s_waitcnt lgkmcnt(10)
    v_mfma_f32_32x32x16_bf16 v[56:71], v[44:47], v[180:183], v[56:71]
    s_and_b32 s16, s16, 0x3ffff
    ds_read_b64_tr_b16 v[40:41], v20 offset:16384
    ds_read_b64_tr_b16 v[42:43], v20 offset:18432
    s_waitcnt lgkmcnt(10)
    v_mfma_f32_32x32x16_bf16 v[72:87], v[48:51], v[180:183], v[72:87]
    ds_read_b64_tr_b16 v[44:45], v21 offset:16384
    ds_read_b64_tr_b16 v[46:47], v21 offset:18432
    s_waitcnt lgkmcnt(10)
    v_mfma_f32_32x32x16_bf16 v[120:135], v[52:55], v[180:183], v[120:135]
    buffer_load_dwordx4 v[168:171], v249, s[32:35], s16 offen sc1
    ds_read_b64_tr_b16 v[48:49], v24 offset:16384
    ds_read_b64_tr_b16 v[50:51], v24 offset:18432
    s_waitcnt lgkmcnt(10)
    v_mfma_f32_32x32x16_bf16 v[136:151], v[28:31], v[180:183], v[136:151]
    ds_read_b64_tr_b16 v[52:53], v25 offset:16384
    ds_read_b64_tr_b16 v[54:55], v25 offset:18432
    s_waitcnt lgkmcnt(10)
    v_mfma_f32_32x32x16_bf16 v[88:103], v[32:35], v[180:183], v[88:103]
    ds_read_b64_tr_b16 v[28:29], v22 offset:16384
    ds_read_b64_tr_b16 v[30:31], v22 offset:18432
    s_waitcnt lgkmcnt(10)
    v_mfma_f32_32x32x16_bf16 v[104:119], v[36:39], v[180:183], v[104:119]
    buffer_load_dwordx4 v[172:175], v249, s[32:35], s16 offen offset:1024 sc1
    ds_read_b64_tr_b16 v[32:33], v23 offset:16384
    ds_read_b64_tr_b16 v[34:35], v23 offset:18432
    s_barrier
    s_waitcnt vmcnt(21)
    s_waitcnt lgkmcnt(10)
    v_mfma_f32_32x32x16_bf16 v[56:71], v[40:43], v[184:187], v[56:71]
    ds_read_b64_tr_b16 v[36:37], v20 offset:17408
    ds_read_b64_tr_b16 v[38:39], v20 offset:19456
    s_waitcnt lgkmcnt(10)
    v_mfma_f32_32x32x16_bf16 v[72:87], v[44:47], v[184:187], v[72:87]
    ds_read_b64_tr_b16 v[40:41], v21 offset:17408
    ds_read_b64_tr_b16 v[42:43], v21 offset:19456
    s_waitcnt lgkmcnt(10)
    v_mfma_f32_32x32x16_bf16 v[120:135], v[48:51], v[184:187], v[120:135]
    ds_read_b64_tr_b16 v[44:45], v24 offset:17408
    ds_read_b64_tr_b16 v[46:47], v24 offset:19456
    s_waitcnt lgkmcnt(10)
    v_mfma_f32_32x32x16_bf16 v[136:151], v[52:55], v[184:187], v[136:151]
    ds_read_b64_tr_b16 v[48:49], v25 offset:17408
    ds_read_b64_tr_b16 v[50:51], v25 offset:19456
    s_waitcnt lgkmcnt(10)
    v_mfma_f32_32x32x16_bf16 v[88:103], v[28:31], v[184:187], v[88:103]
    ds_read_b64_tr_b16 v[52:53], v22 offset:17408
    ds_read_b64_tr_b16 v[54:55], v22 offset:19456
    s_waitcnt lgkmcnt(10)
    v_mfma_f32_32x32x16_bf16 v[104:119], v[32:35], v[184:187], v[104:119]
    ds_read_b64_tr_b16 v[28:29], v23 offset:17408
    ds_read_b64_tr_b16 v[30:31], v23 offset:19456
    s_waitcnt vmcnt(20)
    s_waitcnt lgkmcnt(10)
    v_mfma_f32_32x32x16_bf16 v[56:71], v[36:39], v[188:191], v[56:71]
    ds_read_b64_tr_b16 v[32:33], v20 offset:20480
    ds_read_b64_tr_b16 v[34:35], v20 offset:22528
    s_waitcnt lgkmcnt(10)
    v_mfma_f32_32x32x16_bf16 v[72:87], v[40:43], v[188:191], v[72:87]
    ds_read_b64_tr_b16 v[36:37], v21 offset:20480
    ds_read_b64_tr_b16 v[38:39], v21 offset:22528
    s_waitcnt lgkmcnt(10)
    v_mfma_f32_32x32x16_bf16 v[120:135], v[44:47], v[188:191], v[120:135]
    ds_read_b64_tr_b16 v[40:41], v24 offset:20480
    ds_read_b64_tr_b16 v[42:43], v24 offset:22528
    s_waitcnt lgkmcnt(10)
    v_mfma_f32_32x32x16_bf16 v[136:151], v[48:51], v[188:191], v[136:151]
    buffer_load_dwordx4 v[176:179], v249, s[32:35], s16 offen offset:2048 sc1
    ds_read_b64_tr_b16 v[44:45], v25 offset:20480
    ds_read_b64_tr_b16 v[46:47], v25 offset:22528
    s_waitcnt lgkmcnt(10)
    v_mfma_f32_32x32x16_bf16 v[88:103], v[52:55], v[188:191], v[88:103]
    ds_read_b64_tr_b16 v[48:49], v22 offset:20480
    ds_read_b64_tr_b16 v[50:51], v22 offset:22528
    s_waitcnt lgkmcnt(10)
    v_mfma_f32_32x32x16_bf16 v[104:119], v[28:31], v[188:191], v[104:119]
L_PAD3:
    s_cbranch_execz L_RET3
    ds_read_b64_tr_b16 v[52:53], v23 offset:20480
    ds_read_b64_tr_b16 v[54:55], v23 offset:22528
    s_waitcnt vmcnt(20)
    s_waitcnt lgkmcnt(10)
    v_mfma_f32_32x32x16_bf16 v[56:71], v[32:35], v[192:195], v[56:71]
    ds_read_b64_tr_b16 v[28:29], v20 offset:21504
    ds_read_b64_tr_b16 v[30:31], v20 offset:23552
    s_waitcnt lgkmcnt(10)
    v_mfma_f32_32x32x16_bf16 v[72:87], v[36:39], v[192:195], v[72:87]
    buffer_load_dwordx4 v[180:183], v249, s[32:35], s16 offen offset:3072 sc1
    ds_read_b64_tr_b16 v[32:33], v21 offset:21504
    ds_read_b64_tr_b16 v[34:35], v21 offset:23552
    s_waitcnt lgkmcnt(10)
    v_mfma_f32_32x32x16_bf16 v[120:135], v[40:43], v[192:195], v[120:135]
    s_add_u32 s16, s16, 16384
    ds_read_b64_tr_b16 v[36:37], v24 offset:21504
    ds_read_b64_tr_b16 v[38:39], v24 offset:23552
    s_waitcnt lgkmcnt(10)
    v_mfma_f32_32x32x16_bf16 v[136:151], v[44:47], v[192:195], v[136:151]
    s_and_b32 s16, s16, 0x3ffff
    ds_read_b64_tr_b16 v[40:41], v25 offset:21504
    ds_read_b64_tr_b16 v[42:43], v25 offset:23552
    s_waitcnt lgkmcnt(10)
    v_mfma_f32_32x32x16_bf16 v[88:103], v[48:51], v[192:195], v[88:103]
    buffer_load_dwordx4 v[184:187], v249, s[32:35], s16 offen sc1
    ds_read_b64_tr_b16 v[44:45], v22 offset:21504
    ds_read_b64_tr_b16 v[46:47], v22 offset:23552
    s_waitcnt lgkmcnt(10)
    v_mfma_f32_32x32x16_bf16 v[104:119], v[52:55], v[192:195], v[104:119]
    ds_read_b64_tr_b16 v[48:49], v23 offset:21504
    ds_read_b64_tr_b16 v[50:51], v23 offset:23552
    s_waitcnt vmcnt(21)
    s_waitcnt lgkmcnt(10)
    v_mfma_f32_32x32x16_bf16 v[56:71], v[28:31], v[196:199], v[56:71]
    ds_read_b64_tr_b16 v[52:53], v20 offset:24576
    ds_read_b64_tr_b16 v[54:55], v20 offset:26624
    s_waitcnt lgkmcnt(10)
    v_mfma_f32_32x32x16_bf16 v[72:87], v[32:35], v[196:199], v[72:87]
    ds_read_b64_tr_b16 v[28:29], v21 offset:24576
    ds_read_b64_tr_b16 v[30:31], v21 offset:26624
    s_waitcnt lgkmcnt(10)
    v_mfma_f32_32x32x16_bf16 v[120:135], v[36:39], v[196:199], v[120:135]
    buffer_load_dwordx4 v[188:191], v249, s[32:35], s16 offen offset:1024 sc1
    ds_read_b64_tr_b16 v[32:33], v20 offset:25600
    ds_read_b64_tr_b16 v[34:35], v20 offset:27648
    s_waitcnt lgkmcnt(10)
    v_mfma_f32_32x32x16_bf16 v[136:151], v[40:43], v[196:199], v[136:151]
    ds_read_b64_tr_b16 v[36:37], v21 offset:25600
    ds_read_b64_tr_b16 v[38:39], v21 offset:27648
    s_waitcnt lgkmcnt(10)
    v_mfma_f32_32x32x16_bf16 v[88:103], v[44:47], v[196:199], v[88:103]
    ds_read_b64_tr_b16 v[40:41], v20 offset:28672
    ds_read_b64_tr_b16 v[42:43], v20 offset:30720
    s_waitcnt lgkmcnt(10)
    v_mfma_f32_32x32x16_bf16 v[104:119], v[48:51], v[196:199], v[104:119]
    buffer_load_dwordx4 v[192:195], v249, s[32:35], s16 offen offset:2048 sc1
    ds_read_b64_tr_b16 v[44:45], v21 offset:28672
    ds_read_b64_tr_b16 v[46:47], v21 offset:30720
    s_barrier
    s_waitcnt vmcnt(22)
    s_waitcnt lgkmcnt(10)
    v_mfma_f32_32x32x16_bf16 v[56:71], v[52:55], v[200:203], v[56:71]
    ds_read_b64_tr_b16 v[48:49], v20 offset:29696
    ds_read_b64_tr_b16 v[50:51], v20 offset:31744
    s_waitcnt lgkmcnt(10)
    v_mfma_f32_32x32x16_bf16 v[72:87], v[28:31], v[200:203], v[72:87]
    ds_read_b64_tr_b16 v[52:53], v21 offset:29696
    ds_read_b64_tr_b16 v[54:55], v21 offset:31744
    s_waitcnt vmcnt(21)
    s_waitcnt lgkmcnt(10)
    v_mfma_f32_32x32x16_bf16 v[56:71], v[32:35], v[204:207], v[56:71]
    ds_read_b64_tr_b16 v[28:29], v24 offset:24576
    ds_read_b64_tr_b16 v[30:31], v24 offset:26624
    s_waitcnt lgkmcnt(10)
    v_mfma_f32_32x32x16_bf16 v[72:87], v[36:39], v[204:207], v[72:87]
    ds_read_b64_tr_b16 v[32:33], v25 offset:24576
    ds_read_b64_tr_b16 v[34:35], v25 offset:26624
    s_waitcnt vmcnt(20)
    s_waitcnt lgkmcnt(10)
    v_mfma_f32_32x32x16_bf16 v[56:71], v[40:43], v[208:211], v[56:71]
    ds_read_b64_tr_b16 v[36:37], v22 offset:24576
    ds_read_b64_tr_b16 v[38:39], v22 offset:26624
    s_waitcnt lgkmcnt(10)
    v_mfma_f32_32x32x16_bf16 v[72:87], v[44:47], v[208:211], v[72:87]
    ds_read_b64_tr_b16 v[40:41], v23 offset:24576
    ds_read_b64_tr_b16 v[42:43], v23 offset:26624
    s_waitcnt vmcnt(19)
    s_waitcnt lgkmcnt(10)
    v_mfma_f32_32x32x16_bf16 v[56:71], v[48:51], v[212:215], v[56:71]
    ds_read_b64_tr_b16 v[44:45], v24 offset:25600
    ds_read_b64_tr_b16 v[46:47], v24 offset:27648
    s_waitcnt lgkmcnt(10)
    v_mfma_f32_32x32x16_bf16 v[72:87], v[52:55], v[212:215], v[72:87]
    ds_read_b64_tr_b16 v[48:49], v25 offset:25600
    ds_read_b64_tr_b16 v[50:51], v25 offset:27648
    s_barrier
    s_waitcnt lgkmcnt(10)
    v_mfma_f32_32x32x16_bf16 v[120:135], v[28:31], v[200:203], v[120:135]
    ds_read_b64_tr_b16 v[52:53], v22 offset:25600
    ds_read_b64_tr_b16 v[54:55], v22 offset:27648
    s_waitcnt lgkmcnt(10)
    v_mfma_f32_32x32x16_bf16 v[136:151], v[32:35], v[200:203], v[136:151]
    buffer_load_dwordx4 v[196:199], v249, s[32:35], s16 offen offset:3072 sc1
    ds_read_b64_tr_b16 v[28:29], v23 offset:25600
    ds_read_b64_tr_b16 v[30:31], v23 offset:27648
    s_waitcnt lgkmcnt(10)
    v_mfma_f32_32x32x16_bf16 v[88:103], v[36:39], v[200:203], v[88:103]
    s_add_u32 s16, s16, 16384
    ds_read_b64_tr_b16 v[32:33], v24 offset:28672
    ds_read_b64_tr_b16 v[34:35], v24 offset:30720
    s_waitcnt lgkmcnt(10)
    v_mfma_f32_32x32x16_bf16 v[104:119], v[40:43], v[200:203], v[104:119]
    s_and_b32 s16, s16, 0x3ffff
    ds_read_b64_tr_b16 v[36:37], v25 offset:28672
    ds_read_b64_tr_b16 v[38:39], v25 offset:30720
    s_waitcnt lgkmcnt(10)
    v_mfma_f32_32x32x16_bf16 v[120:135], v[44:47], v[204:207], v[120:135]
    ds_read_b64_tr_b16 v[40:41], v22 offset:28672
    ds_read_b64_tr_b16 v[42:43], v22 offset:30720
    s_waitcnt lgkmcnt(10)
    v_mfma_f32_32x32x16_bf16 v[136:151], v[48:51], v[204:207], v[136:151]
    buffer_load_dwordx4 v[200:203], v249, s[32:35], s16 offen sc1
    ds_read_b64_tr_b16 v[44:45], v23 offset:28672
    ds_read_b64_tr_b16 v[46:47], v23 offset:30720
    s_waitcnt lgkmcnt(10)
    v_mfma_f32_32x32x16_bf16 v[88:103], v[52:55], v[204:207], v[88:103]
    ds_read_b64_tr_b16 v[48:49], v24 offset:29696
    ds_read_b64_tr_b16 v[50:51], v24 offset:31744
    s_waitcnt lgkmcnt(10)
    v_mfma_f32_32x32x16_bf16 v[104:119], v[28:31], v[204:207], v[104:119]
    ds_read_b64_tr_b16 v[52:53], v25 offset:29696
    ds_read_b64_tr_b16 v[54:55], v25 offset:31744
    s_waitcnt lgkmcnt(10)
    v_mfma_f32_32x32x16_bf16 v[120:135], v[32:35], v[208:211], v[120:135]
    buffer_load_dwordx4 v[204:207], v249, s[32:35], s16 offen offset:1024 sc1
    ds_read_b64_tr_b16 v[28:29], v22 offset:29696
    ds_read_b64_tr_b16 v[30:31], v22 offset:31744
    s_waitcnt lgkmcnt(10)
    v_mfma_f32_32x32x16_bf16 v[136:151], v[36:39], v[208:211], v[136:151]
    ds_read_b64_tr_b16 v[32:33], v23 offset:29696
    ds_read_b64_tr_b16 v[34:35], v23 offset:31744
    s_waitcnt lgkmcnt(10)
    v_mfma_f32_32x32x16_bf16 v[88:103], v[40:43], v[208:211], v[88:103]
    ds_read_b64_tr_b16 v[36:37], v20 offset:32768
    ds_read_b64_tr_b16 v[38:39], v20 offset:34816
    s_waitcnt lgkmcnt(10)
    v_mfma_f32_32x32x16_bf16 v[104:119], v[44:47], v[208:211], v[104:119]
    ds_read_b64_tr_b16 v[40:41], v20 offset:33792
    ds_read_b64_tr_b16 v[42:43], v20 offset:35840
    s_waitcnt lgkmcnt(10)
    v_mfma_f32_32x32x16_bf16 v[120:135], v[48:51], v[212:215], v[120:135]
    buffer_load_dwordx4 v[208:211], v249, s[32:35], s16 offen offset:2048 sc1
    ds_read_b64_tr_b16 v[44:45], v20 offset:36864
    ds_read_b64_tr_b16 v[46:47], v20 offset:38912
    s_waitcnt lgkmcnt(10)
    v_mfma_f32_32x32x16_bf16 v[136:151], v[52:55], v[212:215], v[136:151]
    ds_read_b64_tr_b16 v[48:49], v20 offset:37888
    ds_read_b64_tr_b16 v[50:51], v20 offset:39936
    s_waitcnt lgkmcnt(10)
    v_mfma_f32_32x32x16_bf16 v[88:103], v[28:31], v[212:215], v[88:103]
    ds_read_b64_tr_b16 v[52:53], v20 offset:40960
    ds_read_b64_tr_b16 v[54:55], v20 offset:43008
    s_waitcnt lgkmcnt(10)
    v_mfma_f32_32x32x16_bf16 v[104:119], v[32:35], v[212:215], v[104:119]
    buffer_load_dwordx4 v[212:215], v249, s[32:35], s16 offen offset:3072 sc1
    ds_read_b64_tr_b16 v[28:29], v20 offset:41984
    ds_read_b64_tr_b16 v[30:31], v20 offset:44032
    s_barrier
    s_waitcnt vmcnt(23)
    s_waitcnt lgkmcnt(10)
    v_mfma_f32_32x32x16_bf16 v[56:71], v[36:39], v[216:219], v[56:71]
    s_add_u32 s16, s16, 16384
    ds_read_b64_tr_b16 v[32:33], v20 offset:45056
    ds_read_b64_tr_b16 v[34:35], v20 offset:47104
    s_waitcnt vmcnt(22)
    s_waitcnt lgkmcnt(10)
    v_mfma_f32_32x32x16_bf16 v[56:71], v[40:43], v[220:223], v[56:71]
    s_and_b32 s16, s16, 0x3ffff
    ds_read_b64_tr_b16 v[36:37], v20 offset:46080
    ds_read_b64_tr_b16 v[38:39], v20 offset:48128
    s_waitcnt vmcnt(21)
    s_waitcnt lgkmcnt(10)
    v_mfma_f32_32x32x16_bf16 v[56:71], v[44:47], v[224:227], v[56:71]
    ds_read_b64_tr_b16 v[40:41], v20
    ds_read_b64_tr_b16 v[42:43], v20 offset:2048
    s_waitcnt vmcnt(20)
    s_waitcnt lgkmcnt(10)
    v_mfma_f32_32x32x16_bf16 v[56:71], v[48:51], v[228:231], v[56:71]
    ds_read_b64_tr_b16 v[44:45], v20 offset:1024
    ds_read_b64_tr_b16 v[46:47], v20 offset:3072
    s_waitcnt vmcnt(19)
    s_waitcnt lgkmcnt(10)
    v_mfma_f32_32x32x16_bf16 v[56:71], v[52:55], v[232:235], v[56:71]
    ds_read_b64_tr_b16 v[48:49], v20 offset:4096
    ds_read_b64_tr_b16 v[50:51], v20 offset:6144
    s_waitcnt vmcnt(18)
    s_waitcnt lgkmcnt(10)
    v_mfma_f32_32x32x16_bf16 v[56:71], v[28:31], v[236:239], v[56:71]
    ds_read_b64_tr_b16 v[52:53], v20 offset:5120
    ds_read_b64_tr_b16 v[54:55], v20 offset:7168
    s_waitcnt vmcnt(17)
    s_waitcnt lgkmcnt(10)
    v_mfma_f32_32x32x16_bf16 v[56:71], v[32:35], v[240:243], v[56:71]
    ds_read_b64_tr_b16 v[28:29], v20 offset:8192
    ds_read_b64_tr_b16 v[30:31], v20 offset:10240
    s_waitcnt vmcnt(16)
    s_waitcnt lgkmcnt(10)
    v_mfma_f32_32x32x16_bf16 v[56:71], v[36:39], v[244:247], v[56:71]
    ds_read_b64_tr_b16 v[32:33], v20 offset:9216
    ds_read_b64_tr_b16 v[34:35], v20 offset:11264
    s_waitcnt vmcnt(15)
    s_waitcnt lgkmcnt(10)
    v_mfma_f32_32x32x16_bf16 v[56:71], v[40:43], v[152:155], v[56:71]
    ds_read_b64_tr_b16 v[36:37], v20 offset:12288
    ds_read_b64_tr_b16 v[38:39], v20 offset:14336
    s_waitcnt vmcnt(14)
    s_waitcnt lgkmcnt(10)
    v_mfma_f32_32x32x16_bf16 v[56:71], v[44:47], v[156:159], v[56:71]
    ds_read_b64_tr_b16 v[40:41], v20 offset:13312
    ds_read_b64_tr_b16 v[42:43], v20 offset:15360
    s_waitcnt vmcnt(13)
    s_waitcnt lgkmcnt(10)
    v_mfma_f32_32x32x16_bf16 v[56:71], v[48:51], v[160:163], v[56:71]
    ds_read_b64_tr_b16 v[44:45], v20 offset:16384
    ds_read_b64_tr_b16 v[46:47], v20 offset:18432
    s_waitcnt vmcnt(12)
    s_waitcnt lgkmcnt(10)
    v_mfma_f32_32x32x16_bf16 v[56:71], v[52:55], v[164:167], v[56:71]
    ds_read_b64_tr_b16 v[48:49], v20 offset:17408
    ds_read_b64_tr_b16 v[50:51], v20 offset:19456
    s_waitcnt vmcnt(11)
    s_waitcnt lgkmcnt(10)
    v_mfma_f32_32x32x16_bf16 v[56:71], v[28:31], v[168:171], v[56:71]
    ds_read_b64_tr_b16 v[52:53], v20 offset:20480
    ds_read_b64_tr_b16 v[54:55], v20 offset:22528
    s_waitcnt vmcnt(10)
    s_waitcnt lgkmcnt(10)
    v_mfma_f32_32x32x16_bf16 v[56:71], v[32:35], v[172:175], v[56:71]
    ds_read_b64_tr_b16 v[28:29], v20 offset:21504
    ds_read_b64_tr_b16 v[30:31], v20 offset:23552
    s_barrier
    s_waitcnt vmcnt(9)
    s_waitcnt lgkmcnt(10)
    v_mfma_f32_32x32x16_bf16 v[56:71], v[36:39], v[176:179], v[56:71]
    ds_read_b64_tr_b16 v[32:33], v20 offset:24576
    ds_read_b64_tr_b16 v[34:35], v20 offset:26624
    s_waitcnt vmcnt(8)
    s_waitcnt lgkmcnt(10)
    v_mfma_f32_32x32x16_bf16 v[56:71], v[40:43], v[180:183], v[56:71]
    ds_read_b64_tr_b16 v[36:37], v20 offset:25600
    ds_read_b64_tr_b16 v[38:39], v20 offset:27648
    s_waitcnt vmcnt(7)
    s_waitcnt lgkmcnt(10)
    v_mfma_f32_32x32x16_bf16 v[56:71], v[44:47], v[184:187], v[56:71]
    ds_read_b64_tr_b16 v[40:41], v20 offset:28672
    ds_read_b64_tr_b16 v[42:43], v20 offset:30720
    s_waitcnt vmcnt(6)
    s_waitcnt lgkmcnt(10)
    v_mfma_f32_32x32x16_bf16 v[56:71], v[48:51], v[188:191], v[56:71]
    ds_read_b64_tr_b16 v[44:45], v20 offset:29696
    ds_read_b64_tr_b16 v[46:47], v20 offset:31744
    s_waitcnt vmcnt(5)
    s_waitcnt lgkmcnt(10)
    v_mfma_f32_32x32x16_bf16 v[56:71], v[52:55], v[192:195], v[56:71]
    ds_read_b64_tr_b16 v[48:49], v21 offset:32768
    ds_read_b64_tr_b16 v[50:51], v21 offset:34816
    s_waitcnt vmcnt(4)
    s_waitcnt lgkmcnt(10)
    v_mfma_f32_32x32x16_bf16 v[56:71], v[28:31], v[196:199], v[56:71]
    ds_read_b64_tr_b16 v[52:53], v21 offset:33792
    ds_read_b64_tr_b16 v[54:55], v21 offset:35840
    s_waitcnt vmcnt(3)
    s_waitcnt lgkmcnt(10)
    v_mfma_f32_32x32x16_bf16 v[56:71], v[32:35], v[200:203], v[56:71]
    ds_read_b64_tr_b16 v[28:29], v21 offset:36864
    ds_read_b64_tr_b16 v[30:31], v21 offset:38912
    s_waitcnt vmcnt(2)
    s_waitcnt lgkmcnt(10)
    v_mfma_f32_32x32x16_bf16 v[56:71], v[36:39], v[204:207], v[56:71]
    ds_read_b64_tr_b16 v[32:33], v21 offset:37888
    ds_read_b64_tr_b16 v[34:35], v21 offset:39936
    s_waitcnt vmcnt(1)
    s_waitcnt lgkmcnt(10)
    v_mfma_f32_32x32x16_bf16 v[56:71], v[40:43], v[208:211], v[56:71]
    ds_read_b64_tr_b16 v[36:37], v21 offset:40960
    ds_read_b64_tr_b16 v[38:39], v21 offset:43008
    s_waitcnt vmcnt(0)
    s_waitcnt lgkmcnt(10)
    v_mfma_f32_32x32x16_bf16 v[56:71], v[44:47], v[212:215], v[56:71]
    ds_read_b64_tr_b16 v[40:41], v21 offset:41984
    ds_read_b64_tr_b16 v[42:43], v21 offset:44032
    s_waitcnt lgkmcnt(10)
    v_mfma_f32_32x32x16_bf16 v[72:87], v[48:51], v[216:219], v[72:87]
    ds_read_b64_tr_b16 v[44:45], v21 offset:45056
    ds_read_b64_tr_b16 v[46:47], v21 offset:47104
    s_waitcnt lgkmcnt(10)
    v_mfma_f32_32x32x16_bf16 v[72:87], v[52:55], v[220:223], v[72:87]
    s_nop 3
    v_cvt_pk_bf16_f32 v56, v56, v57
    v_cvt_pk_bf16_f32 v57, v58, v59
    ds_read_b64_tr_b16 v[48:49], v21 offset:46080
    ds_read_b64_tr_b16 v[50:51], v21 offset:48128
    s_waitcnt lgkmcnt(10)
    v_mfma_f32_32x32x16_bf16 v[72:87], v[28:31], v[224:227], v[72:87]
    v_cvt_pk_bf16_f32 v58, v60, v61
    v_cvt_pk_bf16_f32 v59, v62, v63
    ds_read_b64_tr_b16 v[52:53], v21
    ds_read_b64_tr_b16 v[54:55], v21 offset:2048
    s_waitcnt lgkmcnt(10)
    v_mfma_f32_32x32x16_bf16 v[72:87], v[32:35], v[228:231], v[72:87]
    ds_write_b128 v0, v[56:59]
    v_cvt_pk_bf16_f32 v60, v64, v65
    ds_read_b64_tr_b16 v[28:29], v21 offset:1024
    ds_read_b64_tr_b16 v[30:31], v21 offset:3072
    s_waitcnt lgkmcnt(11)
    v_mfma_f32_32x32x16_bf16 v[72:87], v[36:39], v[232:235], v[72:87]
    v_cvt_pk_bf16_f32 v61, v66, v67
    v_cvt_pk_bf16_f32 v62, v68, v69
    ds_read_b64_tr_b16 v[32:33], v21 offset:4096
    ds_read_b64_tr_b16 v[34:35], v21 offset:6144
    s_waitcnt lgkmcnt(11)
    v_mfma_f32_32x32x16_bf16 v[72:87], v[40:43], v[236:239], v[72:87]
    v_cvt_pk_bf16_f32 v63, v70, v71
    ds_write_b128 v0, v[60:63] offset:1024
    ds_read_b64_tr_b16 v[36:37], v21 offset:5120
    ds_read_b64_tr_b16 v[38:39], v21 offset:7168
    s_waitcnt lgkmcnt(12)
    v_mfma_f32_32x32x16_bf16 v[72:87], v[44:47], v[240:243], v[72:87]
    v_subrev_u32 v0, 118784, v0
    ds_read_b64_tr_b16 v[40:41], v21 offset:8192
    ds_read_b64_tr_b16 v[42:43], v21 offset:10240
    s_waitcnt lgkmcnt(12)
    v_mfma_f32_32x32x16_bf16 v[72:87], v[48:51], v[244:247], v[72:87]
    ds_read_b64_tr_b16 v[44:45], v21 offset:9216
    ds_read_b64_tr_b16 v[46:47], v21 offset:11264
    s_waitcnt lgkmcnt(6)
    s_barrier
    v_mfma_f32_32x32x16_bf16 v[72:87], v[52:55], v[152:155], v[72:87]
    ds_read_b64_tr_b16 v[48:49], v21 offset:12288
    ds_read_b64_tr_b16 v[50:51], v21 offset:14336
    v_mfma_f32_32x32x16_bf16 v[72:87], v[28:31], v[156:159], v[72:87]
    ds_read_b64_tr_b16 v[52:53], v21 offset:13312
    ds_read_b64_tr_b16 v[54:55], v21 offset:15360
    v_mfma_f32_32x32x16_bf16 v[72:87], v[32:35], v[160:163], v[72:87]
    ds_read_b64_tr_b16 v[28:29], v21 offset:16384
    ds_read_b64_tr_b16 v[30:31], v21 offset:18432
    s_waitcnt lgkmcnt(10)
    v_mfma_f32_32x32x16_bf16 v[72:87], v[36:39], v[164:167], v[72:87]
    ds_read_b64_tr_b16 v[32:33], v21 offset:17408
    ds_read_b64_tr_b16 v[34:35], v21 offset:19456
    s_waitcnt lgkmcnt(10)
    v_mfma_f32_32x32x16_bf16 v[72:87], v[40:43], v[168:171], v[72:87]
    ds_read_b64_tr_b16 v[36:37], v21 offset:20480
    ds_read_b64_tr_b16 v[38:39], v21 offset:22528
    s_waitcnt lgkmcnt(10)
    v_mfma_f32_32x32x16_bf16 v[72:87], v[44:47], v[172:175], v[72:87]
    ds_read_b64_tr_b16 v[40:41], v21 offset:21504
    ds_read_b64_tr_b16 v[42:43], v21 offset:23552
    s_waitcnt lgkmcnt(10)
    v_mfma_f32_32x32x16_bf16 v[72:87], v[48:51], v[176:179], v[72:87]
    ds_read_b64_tr_b16 v[44:45], v21 offset:24576
    ds_read_b64_tr_b16 v[46:47], v21 offset:26624
    s_waitcnt lgkmcnt(10)
    v_mfma_f32_32x32x16_bf16 v[72:87], v[52:55], v[180:183], v[72:87]
    ds_read_b64_tr_b16 v[48:49], v21 offset:25600
    ds_read_b64_tr_b16 v[50:51], v21 offset:27648
    s_waitcnt lgkmcnt(10)
    v_mfma_f32_32x32x16_bf16 v[72:87], v[28:31], v[184:187], v[72:87]
    ds_read_b64_tr_b16 v[52:53], v21 offset:28672
    ds_read_b64_tr_b16 v[54:55], v21 offset:30720
    s_waitcnt lgkmcnt(10)
    v_mfma_f32_32x32x16_bf16 v[72:87], v[32:35], v[188:191], v[72:87]
    ds_read_b64_tr_b16 v[28:29], v21 offset:29696
    ds_read_b64_tr_b16 v[30:31], v21 offset:31744
    s_waitcnt lgkmcnt(10)
    v_mfma_f32_32x32x16_bf16 v[72:87], v[36:39], v[192:195], v[72:87]
    ds_read_b64_tr_b16 v[32:33], v22 offset:32768
    ds_read_b64_tr_b16 v[34:35], v22 offset:34816
    s_waitcnt lgkmcnt(10)
    v_mfma_f32_32x32x16_bf16 v[72:87], v[40:43], v[196:199], v[72:87]
    ds_read_b64_tr_b16 v[36:37], v23 offset:32768
    ds_read_b64_tr_b16 v[38:39], v23 offset:34816
    s_waitcnt lgkmcnt(10)
    v_mfma_f32_32x32x16_bf16 v[72:87], v[44:47], v[200:203], v[72:87]
    ds_read_b64_tr_b16 v[40:41], v22 offset:33792
    ds_read_b64_tr_b16 v[42:43], v22 offset:35840
    s_waitcnt lgkmcnt(10)
    v_mfma_f32_32x32x16_bf16 v[72:87], v[48:51], v[204:207], v[72:87]
    ds_read_b64_tr_b16 v[44:45], v23 offset:33792
    ds_read_b64_tr_b16 v[46:47], v23 offset:35840
    s_waitcnt lgkmcnt(10)
    v_mfma_f32_32x32x16_bf16 v[72:87], v[52:55], v[208:211], v[72:87]
    ds_read_b64_tr_b16 v[48:49], v22 offset:36864
    ds_read_b64_tr_b16 v[50:51], v22 offset:38912
    s_waitcnt lgkmcnt(10)
    v_mfma_f32_32x32x16_bf16 v[72:87], v[28:31], v[212:215], v[72:87]
    ds_read_b64_tr_b16 v[52:53], v23 offset:36864
    ds_read_b64_tr_b16 v[54:55], v23 offset:38912
    s_waitcnt lgkmcnt(10)
    v_mfma_f32_32x32x16_bf16 v[88:103], v[32:35], v[216:219], v[88:103]
    ds_read_b64_tr_b16 v[28:29], v22 offset:37888
    ds_read_b64_tr_b16 v[30:31], v22 offset:39936
    s_waitcnt lgkmcnt(10)
    v_mfma_f32_32x32x16_bf16 v[104:119], v[36:39], v[216:219], v[104:119]
    s_nop 3
    v_cvt_pk_bf16_f32 v72, v72, v73
    v_cvt_pk_bf16_f32 v73, v74, v75
    ds_read_b64_tr_b16 v[32:33], v23 offset:37888
    ds_read_b64_tr_b16 v[34:35], v23 offset:39936
    s_waitcnt lgkmcnt(10)
    v_mfma_f32_32x32x16_bf16 v[88:103], v[40:43], v[220:223], v[88:103]
    v_cvt_pk_bf16_f32 v74, v76, v77
    v_cvt_pk_bf16_f32 v75, v78, v79
    ds_read_b64_tr_b16 v[36:37], v22 offset:40960
    ds_read_b64_tr_b16 v[38:39], v22 offset:43008
    s_waitcnt lgkmcnt(10)
    v_mfma_f32_32x32x16_bf16 v[104:119], v[44:47], v[220:223], v[104:119]
    ds_write_b128 v0, v[72:75]
    v_cvt_pk_bf16_f32 v76, v80, v81
    ds_read_b64_tr_b16 v[40:41], v23 offset:40960
    ds_read_b64_tr_b16 v[42:43], v23 offset:43008
    s_waitcnt lgkmcnt(11)
    v_mfma_f32_32x32x16_bf16 v[88:103], v[48:51], v[224:227], v[88:103]
    v_cvt_pk_bf16_f32 v77, v82, v83
    v_cvt_pk_bf16_f32 v78, v84, v85
    ds_read_b64_tr_b16 v[44:45], v22 offset:41984
    ds_read_b64_tr_b16 v[46:47], v22 offset:44032
    s_waitcnt lgkmcnt(11)
    v_mfma_f32_32x32x16_bf16 v[104:119], v[52:55], v[224:227], v[104:119]
    v_cvt_pk_bf16_f32 v79, v86, v87
    ds_write_b128 v0, v[76:79] offset:1024
    ds_read_b64_tr_b16 v[48:49], v23 offset:41984
    ds_read_b64_tr_b16 v[50:51], v23 offset:44032
    s_waitcnt lgkmcnt(12)
    v_mfma_f32_32x32x16_bf16 v[88:103], v[28:31], v[228:231], v[88:103]
    ds_read_b64_tr_b16 v[52:53], v22 offset:45056
    ds_read_b64_tr_b16 v[54:55], v22 offset:47104
    s_waitcnt lgkmcnt(12)
    v_mfma_f32_32x32x16_bf16 v[104:119], v[32:35], v[228:231], v[104:119]
    ds_read_b64_tr_b16 v[28:29], v23 offset:45056
    ds_read_b64_tr_b16 v[30:31], v23 offset:47104
    s_waitcnt lgkmcnt(6)
    s_barrier
    v_mfma_f32_32x32x16_bf16 v[88:103], v[36:39], v[232:235], v[88:103]
    s_lshl_b32 s96, s77, 11
    s_add_u32 s14, s96, 32768
    v_and_b32 v0, 7, v1
    ds_read_b64_tr_b16 v[32:33], v22 offset:46080
    ds_read_b64_tr_b16 v[34:35], v22 offset:48128
    v_mfma_f32_32x32x16_bf16 v[104:119], v[40:43], v[232:235], v[104:119]
    v_lshl_add_u32 v0, v0, 4, s14
    ds_read_b64_tr_b16 v[36:37], v23 offset:46080
    ds_read_b64_tr_b16 v[38:39], v23 offset:48128
    v_mfma_f32_32x32x16_bf16 v[88:103], v[44:47], v[236:239], v[88:103]
    v_bfe_u32 v4, v1, 3, 2
    ds_read_b64_tr_b16 v[40:41], v22
    ds_read_b64_tr_b16 v[42:43], v22 offset:2048
    s_waitcnt lgkmcnt(10)
    v_mfma_f32_32x32x16_bf16 v[104:119], v[48:51], v[236:239], v[104:119]
    v_lshl_add_u32 v0, v4, 8, v0
    v_lshrrev_b32 v4, 5, v1
    ds_read_b64_tr_b16 v[44:45], v23
    ds_read_b64_tr_b16 v[46:47], v23 offset:2048
    s_waitcnt lgkmcnt(10)
    v_mfma_f32_32x32x16_bf16 v[88:103], v[52:55], v[240:243], v[88:103]
    v_lshl_add_u32 v0, v4, 7, v0
    ds_read_b64_tr_b16 v[48:49], v22 offset:1024
    ds_read_b64_tr_b16 v[50:51], v22 offset:3072
    s_waitcnt lgkmcnt(10)
    v_mfma_f32_32x32x16_bf16 v[104:119], v[28:31], v[240:243], v[104:119]
    ds_read_b64_tr_b16 v[52:53], v23 offset:1024
    ds_read_b64_tr_b16 v[54:55], v23 offset:3072
    s_waitcnt lgkmcnt(10)
    v_mfma_f32_32x32x16_bf16 v[88:103], v[32:35], v[244:247], v[88:103]
    ds_read_b64_tr_b16 v[28:29], v22 offset:4096
    ds_read_b64_tr_b16 v[30:31], v22 offset:6144
    s_waitcnt lgkmcnt(10)
    v_mfma_f32_32x32x16_bf16 v[104:119], v[36:39], v[244:247], v[104:119]
    ds_read_b64_tr_b16 v[32:33], v23 offset:4096
    ds_read_b64_tr_b16 v[34:35], v23 offset:6144
    s_waitcnt lgkmcnt(10)
    v_mfma_f32_32x32x16_bf16 v[88:103], v[40:43], v[152:155], v[88:103]
    ds_read_b64_tr_b16 v[36:37], v22 offset:5120
    ds_read_b64_tr_b16 v[38:39], v22 offset:7168
    s_waitcnt lgkmcnt(10)
    v_mfma_f32_32x32x16_bf16 v[104:119], v[44:47], v[152:155], v[104:119]
    ds_read_b64_tr_b16 v[40:41], v23 offset:5120
    ds_read_b64_tr_b16 v[42:43], v23 offset:7168
    s_waitcnt lgkmcnt(10)
    v_mfma_f32_32x32x16_bf16 v[88:103], v[48:51], v[156:159], v[88:103]
    ds_read_b64_tr_b16 v[44:45], v22 offset:8192
    ds_read_b64_tr_b16 v[46:47], v22 offset:10240
    s_waitcnt lgkmcnt(10)
    v_mfma_f32_32x32x16_bf16 v[104:119], v[52:55], v[156:159], v[104:119]
    ds_read_b64_tr_b16 v[48:49], v23 offset:8192
    ds_read_b64_tr_b16 v[50:51], v23 offset:10240
    s_waitcnt lgkmcnt(10)
    v_mfma_f32_32x32x16_bf16 v[88:103], v[28:31], v[160:163], v[88:103]
    ds_read_b64_tr_b16 v[52:53], v22 offset:9216
    ds_read_b64_tr_b16 v[54:55], v22 offset:11264
    s_waitcnt lgkmcnt(10)
    v_mfma_f32_32x32x16_bf16 v[104:119], v[32:35], v[160:163], v[104:119]
    ds_read_b64_tr_b16 v[28:29], v23 offset:9216
    ds_read_b64_tr_b16 v[30:31], v23 offset:11264
    s_waitcnt lgkmcnt(10)
    v_mfma_f32_32x32x16_bf16 v[88:103], v[36:39], v[164:167], v[88:103]
    ds_read_b64_tr_b16 v[32:33], v22 offset:12288
    ds_read_b64_tr_b16 v[34:35], v22 offset:14336
    s_waitcnt lgkmcnt(10)
    v_mfma_f32_32x32x16_bf16 v[104:119], v[40:43], v[164:167], v[104:119]
    ds_read_b64_tr_b16 v[36:37], v23 offset:12288
    ds_read_b64_tr_b16 v[38:39], v23 offset:14336
    s_waitcnt lgkmcnt(10)
    v_mfma_f32_32x32x16_bf16 v[88:103], v[44:47], v[168:171], v[88:103]
    ds_read_b64_tr_b16 v[40:41], v22 offset:13312
    ds_read_b64_tr_b16 v[42:43], v22 offset:15360
    s_waitcnt lgkmcnt(10)
    v_mfma_f32_32x32x16_bf16 v[104:119], v[48:51], v[168:171], v[104:119]
    ds_read_b64_tr_b16 v[44:45], v23 offset:13312
    ds_read_b64_tr_b16 v[46:47], v23 offset:15360
    s_waitcnt lgkmcnt(10)
    v_mfma_f32_32x32x16_bf16 v[88:103], v[52:55], v[172:175], v[88:103]
    ds_read_b64_tr_b16 v[48:49], v22 offset:16384
    ds_read_b64_tr_b16 v[50:51], v22 offset:18432
    s_waitcnt lgkmcnt(10)
    v_mfma_f32_32x32x16_bf16 v[104:119], v[28:31], v[172:175], v[104:119]
    ds_read_b64_tr_b16 v[52:53], v23 offset:16384
    ds_read_b64_tr_b16 v[54:55], v23 offset:18432
    s_waitcnt lgkmcnt(10)
    v_mfma_f32_32x32x16_bf16 v[88:103], v[32:35], v[176:179], v[88:103]
    ds_read_b64_tr_b16 v[28:29], v22 offset:17408
    ds_read_b64_tr_b16 v[30:31], v22 offset:19456
    s_waitcnt lgkmcnt(10)
    v_mfma_f32_32x32x16_bf16 v[104:119], v[36:39], v[176:179], v[104:119]
    ds_read_b64_tr_b16 v[32:33], v23 offset:17408
    ds_read_b64_tr_b16 v[34:35], v23 offset:19456
    s_waitcnt lgkmcnt(10)
    v_mfma_f32_32x32x16_bf16 v[88:103], v[40:43], v[180:183], v[88:103]
    ds_read_b64_tr_b16 v[36:37], v22 offset:20480
    ds_read_b64_tr_b16 v[38:39], v22 offset:22528
    s_waitcnt lgkmcnt(10)
    v_mfma_f32_32x32x16_bf16 v[104:119], v[44:47], v[180:183], v[104:119]
    ds_read_b64_tr_b16 v[40:41], v23 offset:20480
    ds_read_b64_tr_b16 v[42:43], v23 offset:22528
    s_waitcnt lgkmcnt(10)
    v_mfma_f32_32x32x16_bf16 v[88:103], v[48:51], v[184:187], v[88:103]
    ds_read_b64_tr_b16 v[44:45], v22 offset:21504
    ds_read_b64_tr_b16 v[46:47], v22 offset:23552
    s_waitcnt lgkmcnt(10)
    v_mfma_f32_32x32x16_bf16 v[104:119], v[52:55], v[184:187], v[104:119]
    ds_read_b64_tr_b16 v[48:49], v23 offset:21504
    ds_read_b64_tr_b16 v[50:51], v23 offset:23552
    s_waitcnt lgkmcnt(10)
    v_mfma_f32_32x32x16_bf16 v[88:103], v[28:31], v[188:191], v[88:103]
    ds_read_b64_tr_b16 v[52:53], v22 offset:24576
    ds_read_b64_tr_b16 v[54:55], v22 offset:26624
    s_waitcnt lgkmcnt(10)
    v_mfma_f32_32x32x16_bf16 v[104:119], v[32:35], v[188:191], v[104:119]
    ds_read_b64_tr_b16 v[28:29], v23 offset:24576
    ds_read_b64_tr_b16 v[30:31], v23 offset:26624
    s_waitcnt lgkmcnt(10)
    v_mfma_f32_32x32x16_bf16 v[88:103], v[36:39], v[192:195], v[88:103]
    ds_read_b64_tr_b16 v[32:33], v22 offset:25600
    ds_read_b64_tr_b16 v[34:35], v22 offset:27648
    s_waitcnt lgkmcnt(10)
    v_mfma_f32_32x32x16_bf16 v[104:119], v[40:43], v[192:195], v[104:119]
    ds_read_b64_tr_b16 v[36:37], v23 offset:25600
    ds_read_b64_tr_b16 v[38:39], v23 offset:27648
    s_waitcnt lgkmcnt(10)
    v_mfma_f32_32x32x16_bf16 v[88:103], v[44:47], v[196:199], v[88:103]
    ds_read_b64_tr_b16 v[40:41], v22 offset:28672
    ds_read_b64_tr_b16 v[42:43], v22 offset:30720
    s_waitcnt lgkmcnt(10)
    v_mfma_f32_32x32x16_bf16 v[104:119], v[48:51], v[196:199], v[104:119]
    ds_read_b64_tr_b16 v[44:45], v23 offset:28672
    ds_read_b64_tr_b16 v[46:47], v23 offset:30720
    s_waitcnt lgkmcnt(10)
    v_mfma_f32_32x32x16_bf16 v[88:103], v[52:55], v[200:203], v[88:103]
    ds_read_b64_tr_b16 v[48:49], v22 offset:29696
    ds_read_b64_tr_b16 v[50:51], v22 offset:31744
    s_waitcnt lgkmcnt(10)
    v_mfma_f32_32x32x16_bf16 v[104:119], v[28:31], v[200:203], v[104:119]
    ds_read_b64_tr_b16 v[52:53], v23 offset:29696
    ds_read_b64_tr_b16 v[54:55], v23 offset:31744
    s_waitcnt lgkmcnt(10)
    v_mfma_f32_32x32x16_bf16 v[88:103], v[32:35], v[204:207], v[88:103]
    ds_read_b64_tr_b16 v[28:29], v24 offset:32768
    ds_read_b64_tr_b16 v[30:31], v24 offset:34816
    s_waitcnt lgkmcnt(10)
    v_mfma_f32_32x32x16_bf16 v[104:119], v[36:39], v[204:207], v[104:119]
    ds_read_b64_tr_b16 v[32:33], v25 offset:32768
    ds_read_b64_tr_b16 v[34:35], v25 offset:34816
    s_waitcnt lgkmcnt(10)
    v_mfma_f32_32x32x16_bf16 v[88:103], v[40:43], v[208:211], v[88:103]
L_PAD4:
    s_cbranch_execz L_RET4
    ds_read_b64_tr_b16 v[36:37], v24 offset:33792
    ds_read_b64_tr_b16 v[38:39], v24 offset:35840
    s_waitcnt lgkmcnt(10)
    v_mfma_f32_32x32x16_bf16 v[104:119], v[44:47], v[208:211], v[104:119]
    ds_read_b64_tr_b16 v[40:41], v25 offset:33792
    ds_read_b64_tr_b16 v[42:43], v25 offset:35840
    s_waitcnt lgkmcnt(10)
    v_mfma_f32_32x32x16_bf16 v[88:103], v[48:51], v[212:215], v[88:103]
    ds_read_b64_tr_b16 v[44:45], v24 offset:36864
    ds_read_b64_tr_b16 v[46:47], v24 offset:38912
    s_waitcnt lgkmcnt(10)
    v_mfma_f32_32x32x16_bf16 v[104:119], v[52:55], v[212:215], v[104:119]
    ds_read_b64_tr_b16 v[48:49], v25 offset:36864
    ds_read_b64_tr_b16 v[50:51], v25 offset:38912
    s_barrier
    s_waitcnt lgkmcnt(10)
    v_mfma_f32_32x32x16_bf16 v[120:135], v[28:31], v[216:219], v[120:135]
    ds_read_b64_tr_b16 v[52:53], v24 offset:37888
    ds_read_b64_tr_b16 v[54:55], v24 offset:39936
    s_waitcnt lgkmcnt(10)
    v_mfma_f32_32x32x16_bf16 v[136:151], v[32:35], v[216:219], v[136:151]
    ds_read_b64_tr_b16 v[28:29], v25 offset:37888
    ds_read_b64_tr_b16 v[30:31], v25 offset:39936
    s_waitcnt lgkmcnt(10)
    v_mfma_f32_32x32x16_bf16 v[120:135], v[36:39], v[220:223], v[120:135]
    v_cvt_pk_bf16_f32 v88, v88, v89
    ds_read_b64_tr_b16 v[32:33], v24 offset:40960
    ds_read_b64_tr_b16 v[34:35], v24 offset:43008
    s_waitcnt lgkmcnt(10)
    v_mfma_f32_32x32x16_bf16 v[136:151], v[40:43], v[220:223], v[136:151]
    v_cvt_pk_bf16_f32 v89, v90, v91
    ds_read_b64_tr_b16 v[36:37], v25 offset:40960
    ds_read_b64_tr_b16 v[38:39], v25 offset:43008
    s_waitcnt lgkmcnt(10)
    v_mfma_f32_32x32x16_bf16 v[120:135], v[44:47], v[224:227], v[120:135]
    v_cvt_pk_bf16_f32 v90, v92, v93
    ds_read_b64_tr_b16 v[40:41], v24 offset:41984
    ds_read_b64_tr_b16 v[42:43], v24 offset:44032
    s_waitcnt lgkmcnt(10)
    v_mfma_f32_32x32x16_bf16 v[136:151], v[48:51], v[224:227], v[136:151]
    v_cvt_pk_bf16_f32 v91, v94, v95
    ds_read_b64_tr_b16 v[44:45], v25 offset:41984
    ds_read_b64_tr_b16 v[46:47], v25 offset:44032
    s_waitcnt lgkmcnt(10)
    v_mfma_f32_32x32x16_bf16 v[120:135], v[52:55], v[228:231], v[120:135]
    ds_write_b128 v0, v[88:91]
    ds_read_b64_tr_b16 v[48:49], v24 offset:45056
    ds_read_b64_tr_b16 v[50:51], v24 offset:47104
    s_waitcnt lgkmcnt(11)
    v_mfma_f32_32x32x16_bf16 v[136:151], v[28:31], v[228:231], v[136:151]
    v_cvt_pk_bf16_f32 v92, v96, v97
    ds_read_b64_tr_b16 v[52:53], v25 offset:45056
    ds_read_b64_tr_b16 v[54:55], v25 offset:47104
    s_waitcnt lgkmcnt(11)
    v_mfma_f32_32x32x16_bf16 v[120:135], v[32:35], v[232:235], v[120:135]
    v_cvt_pk_bf16_f32 v93, v98, v99
    ds_read_b64_tr_b16 v[28:29], v24 offset:46080
    ds_read_b64_tr_b16 v[30:31], v24 offset:48128
    s_waitcnt lgkmcnt(11)
    v_mfma_f32_32x32x16_bf16 v[136:151], v[36:39], v[232:235], v[136:151]
    v_cvt_pk_bf16_f32 v94, v100, v101
    ds_read_b64_tr_b16 v[32:33], v25 offset:46080
    ds_read_b64_tr_b16 v[34:35], v25 offset:48128
    s_waitcnt lgkmcnt(11)
    v_mfma_f32_32x32x16_bf16 v[120:135], v[40:43], v[236:239], v[120:135]
    v_cvt_pk_bf16_f32 v95, v102, v103
    ds_read_b64_tr_b16 v[36:37], v24
    ds_read_b64_tr_b16 v[38:39], v24 offset:2048
    s_waitcnt lgkmcnt(11)
    v_mfma_f32_32x32x16_bf16 v[136:151], v[44:47], v[236:239], v[136:151]
    ds_write_b128 v0, v[92:95] offset:1024
    ds_read_b64_tr_b16 v[40:41], v25
    ds_read_b64_tr_b16 v[42:43], v25 offset:2048
    s_waitcnt lgkmcnt(11)
    v_mfma_f32_32x32x16_bf16 v[120:135], v[48:51], v[240:243], v[120:135]
    v_cvt_pk_bf16_f32 v104, v104, v105
    ds_read_b64_tr_b16 v[44:45], v24 offset:1024
    ds_read_b64_tr_b16 v[46:47], v24 offset:3072
    s_waitcnt lgkmcnt(11)
    v_mfma_f32_32x32x16_bf16 v[136:151], v[52:55], v[240:243], v[136:151]
    v_cvt_pk_bf16_f32 v105, v106, v107
    ds_read_b64_tr_b16 v[48:49], v25 offset:1024
    ds_read_b64_tr_b16 v[50:51], v25 offset:3072
    s_waitcnt lgkmcnt(11)
    v_mfma_f32_32x32x16_bf16 v[120:135], v[28:31], v[244:247], v[120:135]
    v_cvt_pk_bf16_f32 v106, v108, v109
    ds_read_b64_tr_b16 v[52:53], v24 offset:4096
    ds_read_b64_tr_b16 v[54:55], v24 offset:6144
    s_waitcnt lgkmcnt(11)
    v_mfma_f32_32x32x16_bf16 v[136:151], v[32:35], v[244:247], v[136:151]
    v_cvt_pk_bf16_f32 v107, v110, v111
    ds_read_b64_tr_b16 v[28:29], v25 offset:4096
    ds_read_b64_tr_b16 v[30:31], v25 offset:6144
    s_waitcnt lgkmcnt(11)
    v_mfma_f32_32x32x16_bf16 v[120:135], v[36:39], v[152:155], v[120:135]
    ds_write_b128 v0, v[104:107] offset:8192
    ds_read_b64_tr_b16 v[32:33], v24 offset:5120
    ds_read_b64_tr_b16 v[34:35], v24 offset:7168
    s_waitcnt lgkmcnt(11)
    v_mfma_f32_32x32x16_bf16 v[136:151], v[40:43], v[152:155], v[136:151]
    v_cvt_pk_bf16_f32 v108, v112, v113
    ds_read_b64_tr_b16 v[36:37], v25 offset:5120
    ds_read_b64_tr_b16 v[38:39], v25 offset:7168
    s_waitcnt lgkmcnt(11)
    v_mfma_f32_32x32x16_bf16 v[120:135], v[44:47], v[156:159], v[120:135]
    v_cvt_pk_bf16_f32 v109, v114, v115
    ds_read_b64_tr_b16 v[40:41], v24 offset:8192
    ds_read_b64_tr_b16 v[42:43], v24 offset:10240
    s_waitcnt lgkmcnt(11)
    v_mfma_f32_32x32x16_bf16 v[136:151], v[48:51], v[156:159], v[136:151]
    v_cvt_pk_bf16_f32 v110, v116, v117
    ds_read_b64_tr_b16 v[44:45], v25 offset:8192
    ds_read_b64_tr_b16 v[46:47], v25 offset:10240
    s_waitcnt lgkmcnt(11)
    v_mfma_f32_32x32x16_bf16 v[120:135], v[52:55], v[160:163], v[120:135]
    v_cvt_pk_bf16_f32 v111, v118, v119
    ds_read_b64_tr_b16 v[48:49], v24 offset:9216
    ds_read_b64_tr_b16 v[50:51], v24 offset:11264
    s_waitcnt lgkmcnt(11)
    v_mfma_f32_32x32x16_bf16 v[136:151], v[28:31], v[160:163], v[136:151]
    ds_write_b128 v0, v[108:111] offset:9216
    ds_read_b64_tr_b16 v[52:53], v25 offset:9216
    ds_read_b64_tr_b16 v[54:55], v25 offset:11264
    s_waitcnt lgkmcnt(11)
    v_mfma_f32_32x32x16_bf16 v[120:135], v[32:35], v[164:167], v[120:135]
    v_and_b32 v85, 1, v1
    ds_read_b64_tr_b16 v[28:29], v24 offset:12288
    ds_read_b64_tr_b16 v[30:31], v24 offset:14336
    s_waitcnt lgkmcnt(11)
    v_mfma_f32_32x32x16_bf16 v[136:151], v[36:39], v[164:167], v[136:151]
    v_lshlrev_b32 v85, 3, v85
    ds_read_b64_tr_b16 v[32:33], v25 offset:12288
    ds_read_b64_tr_b16 v[34:35], v25 offset:14336
    s_waitcnt lgkmcnt(11)
    v_mfma_f32_32x32x16_bf16 v[120:135], v[40:43], v[168:171], v[120:135]
    v_bfe_u32 v84, v1, 2, 2
    ds_read_b64_tr_b16 v[36:37], v24 offset:13312
    ds_read_b64_tr_b16 v[38:39], v24 offset:15360
    s_waitcnt lgkmcnt(11)
    v_mfma_f32_32x32x16_bf16 v[136:151], v[44:47], v[168:171], v[136:151]
    v_lshl_add_u32 v85, v84, 4, v85
    ds_read_b64_tr_b16 v[40:41], v25 offset:13312
    ds_read_b64_tr_b16 v[42:43], v25 offset:15360
    s_waitcnt lgkmcnt(11)
    v_mfma_f32_32x32x16_bf16 v[120:135], v[48:51], v[172:175], v[120:135]
    v_bfe_u32 v84, v1, 4, 1
    ds_read_b64_tr_b16 v[44:45], v24 offset:16384
    ds_read_b64_tr_b16 v[46:47], v24 offset:18432
    s_waitcnt lgkmcnt(10)
    v_mfma_f32_32x32x16_bf16 v[136:151], v[52:55], v[172:175], v[136:151]
    v_lshl_add_u32 v85, v84, 6, v85
    ds_read_b64_tr_b16 v[48:49], v25 offset:16384
    ds_read_b64_tr_b16 v[50:51], v25 offset:18432
    s_waitcnt lgkmcnt(10)
    v_mfma_f32_32x32x16_bf16 v[120:135], v[28:31], v[176:179], v[120:135]
    v_bfe_u32 v84, v1, 1, 1
    ds_read_b64_tr_b16 v[52:53], v24 offset:17408
    ds_read_b64_tr_b16 v[54:55], v24 offset:19456
    s_waitcnt lgkmcnt(10)
    v_mfma_f32_32x32x16_bf16 v[136:151], v[32:35], v[176:179], v[136:151]
    v_lshl_add_u32 v85, v84, 7, v85
    ds_read_b64_tr_b16 v[28:29], v25 offset:17408
    ds_read_b64_tr_b16 v[30:31], v25 offset:19456
    s_waitcnt lgkmcnt(10)
    v_mfma_f32_32x32x16_bf16 v[120:135], v[36:39], v[180:183], v[120:135]
    v_lshrrev_b32 v84, 5, v1
    ds_read_b64_tr_b16 v[32:33], v24 offset:20480
    ds_read_b64_tr_b16 v[34:35], v24 offset:22528
    s_waitcnt lgkmcnt(10)
    v_mfma_f32_32x32x16_bf16 v[136:151], v[40:43], v[180:183], v[136:151]
    v_lshl_add_u32 v85, v84, 8, v85
    ds_read_b64_tr_b16 v[36:37], v25 offset:20480
    ds_read_b64_tr_b16 v[38:39], v25 offset:22528
    s_waitcnt lgkmcnt(10)
    v_mfma_f32_32x32x16_bf16 v[120:135], v[44:47], v[184:187], v[120:135]
    s_lshl_b32 s13, s3, 12
    v_add_u32 v84, s13, v85
    ds_read_b64_tr_b16 v[40:41], v24 offset:21504
    ds_read_b64_tr_b16 v[42:43], v24 offset:23552
    s_waitcnt lgkmcnt(10)
    v_mfma_f32_32x32x16_bf16 v[136:151], v[48:51], v[184:187], v[136:151]
    s_lshl_b32 s96, s76, 13
    s_add_u32 s13, s96, 32768
    v_add_u32 v85, s13, v85
    ds_read_b64_tr_b16 v[44:45], v25 offset:21504
    ds_read_b64_tr_b16 v[46:47], v25 offset:23552
    s_waitcnt lgkmcnt(10)
    v_mfma_f32_32x32x16_bf16 v[120:135], v[52:55], v[188:191], v[120:135]
    v_mov_b32 v80, 0x3f803f80
    ds_read_b64_tr_b16 v[48:49], v24 offset:24576
    ds_read_b64_tr_b16 v[50:51], v24 offset:26624
    s_waitcnt lgkmcnt(10)
    v_mfma_f32_32x32x16_bf16 v[136:151], v[28:31], v[188:191], v[136:151]
    v_mov_b32 v81, 0x3f803f80
    ds_read_b64_tr_b16 v[52:53], v25 offset:24576
    ds_read_b64_tr_b16 v[54:55], v25 offset:26624
    s_waitcnt lgkmcnt(10)
    v_mfma_f32_32x32x16_bf16 v[120:135], v[32:35], v[192:195], v[120:135]
    v_mov_b32 v82, 0x3f803f80
    ds_read_b64_tr_b16 v[28:29], v24 offset:25600
    ds_read_b64_tr_b16 v[30:31], v24 offset:27648
    s_waitcnt lgkmcnt(10)
    v_mfma_f32_32x32x16_bf16 v[136:151], v[36:39], v[192:195], v[136:151]
    v_mov_b32 v83, 0x3f803f80
    ds_read_b64_tr_b16 v[32:33], v25 offset:25600
    ds_read_b64_tr_b16 v[34:35], v25 offset:27648
    s_waitcnt lgkmcnt(10)
    v_mfma_f32_32x32x16_bf16 v[120:135], v[40:43], v[196:199], v[120:135]
    s_lshl3_add_u32 s96, s11, s3
    s_lshl_b32 s97, s96, 5
    s_add_u32 s98, s97, s10
    s_lshl_b32 s99, s98, 10
    s_add_u32 s13, s99, 25165824
    s_add_u32 s15, s13, 16384
    s_lshl3_add_u32 s96, s11, s3
    s_lshl_b32 s97, s96, 10
    s_add_u32 s16, s97, 21495808
    s_lshl_b32 s96, s10, 6
    s_add_u32 s14, s96, s16
    ds_read_b64_tr_b16 v[36:37], v24 offset:28672
    ds_read_b64_tr_b16 v[38:39], v24 offset:30720
    s_waitcnt lgkmcnt(10)
    v_mfma_f32_32x32x16_bf16 v[136:151], v[44:47], v[196:199], v[136:151]
    ds_read_b64_tr_b16 v[40:41], v25 offset:28672
    ds_read_b64_tr_b16 v[42:43], v25 offset:30720
    s_waitcnt lgkmcnt(10)
    v_mfma_f32_32x32x16_bf16 v[120:135], v[48:51], v[200:203], v[120:135]
    ds_read_b64_tr_b16 v[44:45], v25 offset:29696
    ds_read_b64_tr_b16 v[46:47], v25 offset:31744
    s_waitcnt lgkmcnt(10)
    v_mfma_f32_32x32x16_bf16 v[136:151], v[52:55], v[200:203], v[136:151]
    ds_read_b64_tr_b16 v[48:49], v24 offset:29696
    ds_read_b64_tr_b16 v[50:51], v24 offset:31744
    s_waitcnt lgkmcnt(10)
    v_mfma_f32_32x32x16_bf16 v[120:135], v[28:31], v[204:207], v[120:135]
    s_waitcnt lgkmcnt(8)
    v_mfma_f32_32x32x16_bf16 v[136:151], v[32:35], v[204:207], v[136:151]
    s_waitcnt lgkmcnt(6)
    v_mfma_f32_32x32x16_bf16 v[120:135], v[36:39], v[208:211], v[120:135]
    s_waitcnt lgkmcnt(4)
    v_mfma_f32_32x32x16_bf16 v[136:151], v[40:43], v[208:211], v[136:151]
    s_waitcnt lgkmcnt(2)
    v_mfma_f32_32x32x16_bf16 v[136:151], v[44:47], v[212:215], v[136:151]
    s_waitcnt lgkmcnt(0)
    v_mfma_f32_32x32x16_bf16 v[120:135], v[48:51], v[212:215], v[120:135]
    s_lshl_b32 s96, s77, 11
    s_add_u32 s17, s96, 151552
    v_add_u32 v0, s17, v2
    v_bfe_u32 v4, v1, 2, 2
    v_lshlrev_b32 v4, 6, v4
    v_bfe_u32 v9, v1, 4, 1
    v_lshl_add_u32 v4, v9, 5, v4
    v_and_b32 v9, 3, v1
    v_lshl_add_u32 v4, v9, 3, v4
    v_lshrrev_b32 v9, 5, v1
    v_lshl_add_u32 v4, v9, 8, v4
    v_add_u32 v4, 159744, v4
    ds_read_b64_tr_b16 v[176:177], v4
    ds_read_b64_tr_b16 v[178:179], v4 offset:512
    ds_read_b64_tr_b16 v[180:181], v4 offset:1024
    ds_read_b64_tr_b16 v[182:183], v4 offset:1536
    v_cvt_pk_bf16_f32 v152, v136, v137
    v_cvt_pk_bf16_f32 v153, v138, v139
    v_cvt_pk_bf16_f32 v154, v140, v141
    v_cvt_pk_bf16_f32 v155, v142, v143
    v_cvt_pk_bf16_f32 v156, v144, v145
    v_cvt_pk_bf16_f32 v157, v146, v147
    v_cvt_pk_bf16_f32 v158, v148, v149
    v_cvt_pk_bf16_f32 v159, v150, v151
    ds_write_b128 v0, v[152:155]
    ds_write_b128 v0, v[156:159] offset:1024
    v_cvt_pk_bf16_f32 v168, v120, v121
    v_cvt_pk_bf16_f32 v169, v122, v123
    v_cvt_pk_bf16_f32 v170, v124, v125
    v_cvt_pk_bf16_f32 v171, v126, v127
    v_cvt_pk_bf16_f32 v172, v128, v129
    v_cvt_pk_bf16_f32 v173, v130, v131
    v_cvt_pk_bf16_f32 v174, v132, v133
    v_cvt_pk_bf16_f32 v175, v134, v135
    s_setprio 0
    s_branch L_JOIN
L_HELP:
    s_waitcnt vmcnt(0)
    s_barrier
    s_waitcnt lgkmcnt(0)
    s_load_dwordx2 s[24:25], s[32:33], s19 offset:0 glc
    s_load_dwordx2 s[26:27], s[32:33], s19 offset:64 glc
    s_add_u32 s96, s84, 4
    s_and_b32 s97, s96, 15
    s_mul_i32 s98, s97, 393216
    s_add_u32 s99, s98, s85
    s_add_u32 s82, s99, 4294772736
    s_add_u32 m0, s83, 28672
    s_nop 0
    buffer_load_dwordx4 v3, s[40:43], s82 offen lds
    s_add_u32 s96, s84, 4
    s_and_b32 s97, s96, 15
    s_mul_i32 s98, s97, 393216
    s_add_u32 s99, s98, s85
    s_add_u32 s82, s99, 2048
    s_add_u32 m0, s83, 32768
    s_nop 0
    buffer_load_dwordx4 v3, s[40:43], s82 offen lds
    s_add_u32 s96, s84, 4
    s_and_b32 s97, s96, 15
    s_mul_i32 s98, s97, 393216
    s_add_u32 s99, s98, s85
    s_add_u32 s82, s99, 4294774784
    s_add_u32 m0, s83, 77824
    s_nop 0
    buffer_load_dwordx4 v3, s[40:43], s82 offen lds
    s_add_u32 s96, s84, 4
    s_and_b32 s97, s96, 15
    s_mul_i32 s98, s97, 393216
    s_add_u32 s99, s98, s85
    s_add_u32 s82, s99, 4096
    s_add_u32 m0, s83, 81920
    s_nop 0
    buffer_load_dwordx4 v3, s[40:43], s82 offen lds
    s_add_u32 s96, s84, 4
    s_and_b32 s97, s96, 15
    s_mul_i32 s98, s97, 393216
    s_add_u32 s99, s98, s85
    s_add_u32 s82, s99, 4294770688
    s_add_u32 m0, s83, 126976
    s_nop 0
    buffer_load_dwordx4 v3, s[40:43], s82 offen lds
    s_add_u32 s96, s84, 4
    s_and_b32 s97, s96, 15
    s_mul_i32 s98, s97, 393216
    s_add_u32 s82, s98, s85
    s_add_u32 m0, s83, 131072
    s_nop 0
    buffer_load_dwordx4 v3, s[40:43], s82 offen lds
    s_add_u32 s96, s84, 5
    s_and_b32 s97, s96, 15
    s_mul_i32 s98, s97, 393216
    s_add_u32 s99, s98, s85
    s_add_u32 s82, s99, 4294772736
    s_add_u32 m0, s83, 36864
    s_nop 0
    buffer_load_dwordx4 v3, s[40:43], s82 offen lds
    s_add_u32 s96, s84, 5
    s_and_b32 s97, s96, 15
    s_mul_i32 s98, s97, 393216
    s_add_u32 s99, s98, s85
    s_add_u32 s82, s99, 2048
    s_add_u32 m0, s83, 40960
    s_nop 0
    buffer_load_dwordx4 v3, s[40:43], s82 offen lds
    s_add_u32 s96, s84, 5
    s_and_b32 s97, s96, 15
    s_mul_i32 s98, s97, 393216
    s_add_u32 s99, s98, s85
    s_add_u32 s82, s99, 4294774784
    s_add_u32 m0, s83, 86016
    s_nop 0
    buffer_load_dwordx4 v3, s[40:43], s82 offen lds
    s_add_u32 s96, s84, 5
    s_and_b32 s97, s96, 15
    s_mul_i32 s98, s97, 393216
    s_add_u32 s99, s98, s85
    s_add_u32 s82, s99, 4096
    s_add_u32 m0, s83, 90112
    s_nop 0
    buffer_load_dwordx4 v3, s[40:43], s82 offen lds
    s_add_u32 s96, s84, 5
    s_and_b32 s97, s96, 15
    s_mul_i32 s98, s97, 393216
    s_add_u32 s99, s98, s85
    s_add_u32 s82, s99, 4294770688
    s_add_u32 m0, s83, 135168
    s_nop 0
    buffer_load_dwordx4 v3, s[40:43], s82 offen lds
    s_add_u32 s96, s84, 5
    s_and_b32 s97, s96, 15
    s_mul_i32 s98, s97, 393216
    s_add_u32 s82, s98, s85
    s_add_u32 m0, s83, 139264
    s_nop 0
    buffer_load_dwordx4 v3, s[40:43], s82 offen lds
    s_branch SCHK_17
SPOLL_16:
    s_load_dwordx2 s[24:25], s[32:33], s19 offset:0 glc
    s_load_dwordx2 s[26:27], s[32:33], s19 offset:64 glc
SCHK_17:
    s_add_u32 s5, s5, 1
    s_cmp_ge_u32 s5, 200000
    s_waitcnt lgkmcnt(0)
    s_cbranch_scc1 SDONE_18
    s_cmp_lg_u32 s24, s4
    s_cbranch_scc1 SPOLL_16
    s_cmp_lg_u32 s25, s4
    s_cbranch_scc1 SPOLL_16
    s_cmp_lg_u32 s26, s4
    s_cbranch_scc1 SPOLL_16
    s_cmp_lg_u32 s27, s4
    s_cbranch_scc1 SPOLL_16
SDONE_18:
    s_barrier
    s_add_u32 s96, s84, 6
    s_and_b32 s97, s96, 15
    s_mul_i32 s98, s97, 393216
    s_add_u32 s99, s98, s85
    s_add_u32 s82, s99, 4294772736
    s_add_u32 m0, s83, 4294963200
    s_nop 0
    buffer_load_dwordx4 v3, s[40:43], s82 offen lds
    s_add_u32 s96, s84, 6
    s_and_b32 s97, s96, 15
    s_mul_i32 s98, s97, 393216
    s_add_u32 s99, s98, s85
    s_add_u32 s82, s99, 2048
    s_mov_b32 m0, s83
    s_nop 0
    buffer_load_dwordx4 v3, s[40:43], s82 offen lds
    s_add_u32 s96, s84, 6
    s_and_b32 s97, s96, 15
    s_mul_i32 s98, s97, 393216
    s_add_u32 s99, s98, s85
    s_add_u32 s82, s99, 4294770688
    s_add_u32 m0, s83, 94208
    s_nop 0
    buffer_load_dwordx4 v3, s[40:43], s82 offen lds
    s_add_u32 s96, s84, 6
    s_and_b32 s97, s96, 15
    s_mul_i32 s98, s97, 393216
    s_add_u32 s82, s98, s85
    s_add_u32 m0, s83, 98304
    s_nop 0
    buffer_load_dwordx4 v3, s[40:43], s82 offen lds
    s_add_u32 s96, s84, 6
    s_and_b32 s97, s96, 15
    s_mul_i32 s98, s97, 393216
    s_add_u32 s99, s98, s85
    s_add_u32 s82, s99, 4294774784
    s_add_u32 m0, s83, 45056
    s_nop 0
    buffer_load_dwordx4 v3, s[40:43], s82 offen lds
    s_add_u32 s96, s84, 6
    s_and_b32 s97, s96, 15
    s_mul_i32 s98, s97, 393216
    s_add_u32 s99, s98, s85
    s_add_u32 s82, s99, 4096
    s_add_u32 m0, s83, 49152
    s_nop 0
    buffer_load_dwordx4 v3, s[40:43], s82 offen lds
    v_bfe_u32 v4, v1, 2, 2
    v_lshlrev_b32 v4, 6, v4
    v_bfe_u32 v9, v1, 4, 1
    v_lshl_add_u32 v4, v9, 5, v4
    v_and_b32 v9, 3, v1
    v_lshl_add_u32 v4, v9, 3, v4
    v_lshrrev_b32 v9, 5, v1
    v_lshl_add_u32 v4, v9, 8, v4
    v_add_u32 v4, 159744, v4
    ds_read_b64_tr_b16 v[168:169], v4
    ds_read_b64_tr_b16 v[170:171], v4 offset:512
    ds_read_b64_tr_b16 v[172:173], v4 offset:1024
    ds_read_b64_tr_b16 v[174:175], v4 offset:1536
    ds_read_b64_tr_b16 v[176:177], v4 offset:2048
    ds_read_b64_tr_b16 v[178:179], v4 offset:2560
    ds_read_b64_tr_b16 v[180:181], v4 offset:3072
    ds_read_b64_tr_b16 v[182:183], v4 offset:3584
    s_lshl_b32 s14, s77, 10
    v_and_b32 v232, 7, v1
    v_lshl_add_u32 v232, v232, 4, s14
    v_bfe_u32 v9, v1, 3, 2
    v_lshl_add_u32 v232, v9, 8, v232
    v_lshrrev_b32 v9, 5, v1
    v_lshl_add_u32 v232, v9, 7, v232
    s_and_b32 s96, s9, 1
    s_lshl1_add_u32 s18, s96, 1
    s_and_b32 s96, s8, 3
    s_lshl2_add_u32 s97, s96, s3
    s_sub_u32 s98, s97, 4
    s_lshl_b32 s82, s98, 7
    v_lshrrev_b32 v8, 3, v1
    v_lshl_add_u32 v8, v8, 4, s82
    global_load_dwordx4 v[40:43], v8, s[86:87]
    v_lshrrev_b32 v248, 3, v1
    v_mul_u32_u24 v248, 98304, v248
    v_and_b32 v9, 7, v1
    v_lshl_add_u32 v248, v9, 4, v248
    s_and_b32 s96, s8, 3
    s_lshl2_add_u32 s97, s96, s3
    s_sub_u32 s98, s97, 4
    s_mul_i32 s99, s98, 786432
    s_lshr_b32 s96, s8, 2
    s_lshl1_add_u32 s97, s9, s96
    s_lshl_b32 s98, s97, 7
    s_add_u32 s96, s99, s98
    s_add_u32 s19, s96, 4096
    s_waitcnt lgkmcnt(0)
    s_load_dword s24, s[32:33], s92 offset:512 glc
    s_load_dword s25, s[32:33], s92 offset:256 glc
    s_load_dword s26, s[32:33], s92 offset:3584 glc
    s_load_dword s27, s[32:33], s92 offset:3328 glc
    s_barrier
    s_add_u32 s96, s84, 7
    s_and_b32 s97, s96, 15
    s_mul_i32 s98, s97, 393216
    s_add_u32 s99, s98, s85
    s_add_u32 s82, s99, 4294772736
    s_add_u32 m0, s83, 4096
    s_nop 0
    buffer_load_dwordx4 v3, s[40:43], s82 offen lds
    s_add_u32 s96, s84, 7
    s_and_b32 s97, s96, 15
    s_mul_i32 s98, s97, 393216
    s_add_u32 s99, s98, s85
    s_add_u32 s82, s99, 2048
    s_add_u32 m0, s83, 8192
    s_nop 0
    buffer_load_dwordx4 v3, s[40:43], s82 offen lds
    s_add_u32 s96, s84, 7
    s_and_b32 s97, s96, 15
    s_mul_i32 s98, s97, 393216
    s_add_u32 s99, s98, s85
    s_add_u32 s82, s99, 4294770688
    s_add_u32 m0, s83, 102400
    s_nop 0
    buffer_load_dwordx4 v3, s[40:43], s82 offen lds
    s_add_u32 s96, s84, 7
    s_and_b32 s97, s96, 15
    s_mul_i32 s98, s97, 393216
    s_add_u32 s82, s98, s85
    s_add_u32 m0, s83, 106496
    s_nop 0
    buffer_load_dwordx4 v3, s[40:43], s82 offen lds
    s_add_u32 s96, s84, 7
    s_and_b32 s97, s96, 15
    s_mul_i32 s98, s97, 393216
    s_add_u32 s99, s98, s85
    s_add_u32 s82, s99, 4294774784
    s_add_u32 m0, s83, 53248
    s_nop 0
    buffer_load_dwordx4 v3, s[40:43], s82 offen lds
    s_add_u32 s96, s84, 7
    s_and_b32 s97, s96, 15
    s_mul_i32 s98, s97, 393216
    s_add_u32 s99, s98, s85
    s_add_u32 s82, s99, 4096
    s_add_u32 m0, s83, 57344
    s_nop 0
    buffer_load_dwordx4 v3, s[40:43], s82 offen lds
    s_waitcnt vmcnt(23)
    s_waitcnt vmcnt(19)
    s_barrier
    s_add_u32 s96, s84, 8
    s_and_b32 s97, s96, 15
    s_mul_i32 s98, s97, 393216
    s_add_u32 s99, s98, s85
    s_add_u32 s82, s99, 4294772736
    s_add_u32 m0, s83, 12288
    s_nop 0
    buffer_load_dwordx4 v3, s[40:43], s82 offen lds
    s_add_u32 s96, s84, 8
    s_and_b32 s97, s96, 15
    s_mul_i32 s98, s97, 393216
    s_add_u32 s99, s98, s85
    s_add_u32 s82, s99, 2048
    s_add_u32 m0, s83, 16384
    s_nop 0
    buffer_load_dwordx4 v3, s[40:43], s82 offen lds
    s_add_u32 s96, s84, 8
    s_and_b32 s97, s96, 15
    s_mul_i32 s98, s97, 393216
    s_add_u32 s99, s98, s85
    s_add_u32 s82, s99, 4294770688
    s_add_u32 m0, s83, 110592
    s_nop 0
    buffer_load_dwordx4 v3, s[40:43], s82 offen lds
    s_add_u32 s96, s84, 8
    s_and_b32 s97, s96, 15
    s_mul_i32 s98, s97, 393216
    s_add_u32 s82, s98, s85
    s_add_u32 m0, s83, 114688
    s_nop 0
    buffer_load_dwordx4 v3, s[40:43], s82 offen lds
    s_add_u32 s96, s84, 8
    s_and_b32 s97, s96, 15
    s_mul_i32 s98, s97, 393216
    s_add_u32 s99, s98, s85
    s_add_u32 s82, s99, 4294774784
    s_add_u32 m0, s83, 61440
    s_nop 0
    buffer_load_dwordx4 v3, s[40:43], s82 offen lds
    s_add_u32 s96, s84, 8
    s_and_b32 s97, s96, 15
    s_mul_i32 s98, s97, 393216
    s_add_u32 s99, s98, s85
    s_add_u32 s82, s99, 4096
    s_add_u32 m0, s83, 65536
    s_nop 0
    buffer_load_dwordx4 v3, s[40:43], s82 offen lds
    s_waitcnt vmcnt(12)
    v_lshlrev_b32 v36, 16, v40
    v_and_b32 v37, s6, v40
    v_lshlrev_b32 v38, 16, v41
    v_and_b32 v39, s6, v41
    v_lshlrev_b32 v40, 16, v42
    v_and_b32 v41, s6, v42
    v_lshlrev_b32 v42, 16, v43
    v_and_b32 v43, s6, v43
    v_mul_f32 v8, s7, v36
    v_exp_f32 v8, -v8
    s_nop 0
    v_add_f32 v8, 1.0, v8
    v_rcp_f32 v8, v8
    s_nop 0
    v_mul_f32 v36, v36, v8
    v_cvt_pk_bf16_f32 v36, 0, v36
    v_mul_f32 v9, s7, v37
    v_exp_f32 v9, -v9
    s_nop 0
    v_add_f32 v9, 1.0, v9
    v_rcp_f32 v9, v9
    s_nop 0
    v_mul_f32 v37, v37, v9
    v_cvt_pk_bf16_f32 v37, 0, v37
    v_mul_f32 v8, s7, v38
    v_exp_f32 v8, -v8
    s_nop 0
    v_add_f32 v8, 1.0, v8
    v_rcp_f32 v8, v8
    s_nop 0
    v_mul_f32 v38, v38, v8
    v_cvt_pk_bf16_f32 v38, 0, v38
    v_mul_f32 v9, s7, v39
    v_exp_f32 v9, -v9
    s_nop 0
    v_add_f32 v9, 1.0, v9
    v_rcp_f32 v9, v9
    s_nop 0
    v_mul_f32 v39, v39, v9
    v_cvt_pk_bf16_f32 v39, 0, v39
    v_mul_f32 v8, s7, v40
    v_exp_f32 v8, -v8
    s_nop 0
    v_add_f32 v8, 1.0, v8
    v_rcp_f32 v8, v8
    s_nop 0
    v_mul_f32 v40, v40, v8
    v_cvt_pk_bf16_f32 v40, 0, v40
    v_mul_f32 v9, s7, v41
    v_exp_f32 v9, -v9
    s_nop 0
    v_add_f32 v9, 1.0, v9
    v_rcp_f32 v9, v9
    s_nop 0
    v_mul_f32 v41, v41, v9
    v_cvt_pk_bf16_f32 v41, 0, v41
    v_mul_f32 v8, s7, v42
    v_exp_f32 v8, -v8
    s_nop 0
    v_add_f32 v8, 1.0, v8
    v_rcp_f32 v8, v8
    s_nop 0
    v_mul_f32 v42, v42, v8
L_PAD5:
    s_cbranch_execz L_RET5
    v_cvt_pk_bf16_f32 v42, 0, v42
    v_mul_f32 v9, s7, v43
    v_exp_f32 v9, -v9
    s_nop 0
    v_add_f32 v9, 1.0, v9
    v_rcp_f32 v9, v9
    s_nop 0
    v_mul_f32 v43, v43, v9
    v_cvt_pk_bf16_f32 v43, 0, v43
    s_waitcnt lgkmcnt(0)
    s_load_dword s24, s[32:33], s92 offset:1024 glc
    s_load_dword s25, s[32:33], s92 offset:768 glc
    s_load_dword s26, s[32:33], s92 offset:1536 glc
    s_load_dword s27, s[32:33], s92 offset:1280 glc
    s_barrier
    s_add_u32 s96, s84, 9
    s_and_b32 s97, s96, 15
    s_mul_i32 s98, s97, 393216
    s_add_u32 s99, s98, s85
    s_add_u32 s82, s99, 4294772736
    s_add_u32 m0, s83, 20480
    s_nop 0
    buffer_load_dwordx4 v3, s[40:43], s82 offen lds
    s_add_u32 s96, s84, 9
    s_and_b32 s97, s96, 15
    s_mul_i32 s98, s97, 393216
    s_add_u32 s99, s98, s85
    s_add_u32 s82, s99, 2048
    s_add_u32 m0, s83, 24576
    s_nop 0
    buffer_load_dwordx4 v3, s[40:43], s82 offen lds
    s_add_u32 s96, s84, 9
    s_and_b32 s97, s96, 15
    s_mul_i32 s98, s97, 393216
    s_add_u32 s99, s98, s85
    s_add_u32 s82, s99, 4294770688
    s_add_u32 m0, s83, 118784
    s_nop 0
    buffer_load_dwordx4 v3, s[40:43], s82 offen lds
    s_add_u32 s96, s84, 9
    s_and_b32 s97, s96, 15
    s_mul_i32 s98, s97, 393216
    s_add_u32 s82, s98, s85
    s_add_u32 m0, s83, 122880
    s_nop 0
    buffer_load_dwordx4 v3, s[40:43], s82 offen lds
    s_add_u32 s96, s84, 9
    s_and_b32 s97, s96, 15
    s_mul_i32 s98, s97, 393216
    s_add_u32 s99, s98, s85
    s_add_u32 s82, s99, 4294774784
    s_add_u32 m0, s83, 69632
    s_nop 0
    buffer_load_dwordx4 v3, s[40:43], s82 offen lds
    s_add_u32 s96, s84, 9
    s_and_b32 s97, s96, 15
    s_mul_i32 s98, s97, 393216
    s_add_u32 s99, s98, s85
    s_add_u32 s82, s99, 4096
    s_add_u32 m0, s83, 73728
    s_nop 0
    buffer_load_dwordx4 v3, s[40:43], s82 offen lds
    s_barrier
    s_add_u32 s96, s84, 10
    s_and_b32 s97, s96, 15
    s_mul_i32 s98, s97, 393216
    s_add_u32 s99, s98, s85
    s_add_u32 s82, s99, 4294772736
    s_add_u32 m0, s83, 28672
    s_nop 0
    buffer_load_dwordx4 v3, s[40:43], s82 offen lds
    s_add_u32 s96, s84, 10
    s_and_b32 s97, s96, 15
    s_mul_i32 s98, s97, 393216
    s_add_u32 s99, s98, s85
    s_add_u32 s82, s99, 2048
    s_add_u32 m0, s83, 32768
    s_nop 0
    buffer_load_dwordx4 v3, s[40:43], s82 offen lds
    s_add_u32 s96, s84, 10
    s_and_b32 s97, s96, 15
    s_mul_i32 s98, s97, 393216
    s_add_u32 s99, s98, s85
    s_add_u32 s82, s99, 4294774784
    s_add_u32 m0, s83, 77824
    s_nop 0
    buffer_load_dwordx4 v3, s[40:43], s82 offen lds
    s_add_u32 s96, s84, 10
    s_and_b32 s97, s96, 15
    s_mul_i32 s98, s97, 393216
    s_add_u32 s99, s98, s85
    s_add_u32 s82, s99, 4096
    s_add_u32 m0, s83, 81920
    s_nop 0
    buffer_load_dwordx4 v3, s[40:43], s82 offen lds
    s_add_u32 s96, s84, 10
    s_and_b32 s97, s96, 15
    s_mul_i32 s98, s97, 393216
    s_add_u32 s99, s98, s85
    s_add_u32 s82, s99, 4294770688
    s_add_u32 m0, s83, 126976
    s_nop 0
    buffer_load_dwordx4 v3, s[40:43], s82 offen lds
    s_add_u32 s96, s84, 10
    s_and_b32 s97, s96, 15
    s_mul_i32 s98, s97, 393216
    s_add_u32 s82, s98, s85
    s_add_u32 m0, s83, 131072
    s_nop 0
    buffer_load_dwordx4 v3, s[40:43], s82 offen lds
    s_waitcnt lgkmcnt(0)
    s_load_dword s24, s[32:33], s92 offset:2560 glc
    s_load_dword s25, s[32:33], s92 offset:2304 glc
    s_load_dword s26, s[32:33], s92 offset:3072 glc
    s_load_dword s27, s[32:33], s92 offset:2816 glc
    s_waitcnt vmcnt(22)
    s_waitcnt vmcnt(20)
    s_waitcnt vmcnt(18)
    s_barrier
    s_add_u32 s96, s84, 11
    s_and_b32 s97, s96, 15
    s_mul_i32 s98, s97, 393216
    s_add_u32 s99, s98, s85
    s_add_u32 s82, s99, 4294772736
    s_add_u32 m0, s83, 36864
    s_nop 0
    buffer_load_dwordx4 v3, s[40:43], s82 offen lds
    s_add_u32 s96, s84, 11
    s_and_b32 s97, s96, 15
    s_mul_i32 s98, s97, 393216
    s_add_u32 s99, s98, s85
    s_add_u32 s82, s99, 2048
    s_add_u32 m0, s83, 40960
    s_nop 0
    buffer_load_dwordx4 v3, s[40:43], s82 offen lds
    s_add_u32 s96, s84, 11
    s_and_b32 s97, s96, 15
    s_mul_i32 s98, s97, 393216
    s_add_u32 s99, s98, s85
    s_add_u32 s82, s99, 4294774784
    s_add_u32 m0, s83, 86016
    s_nop 0
    buffer_load_dwordx4 v3, s[40:43], s82 offen lds
    s_add_u32 s96, s84, 11
    s_and_b32 s97, s96, 15
    s_mul_i32 s98, s97, 393216
    s_add_u32 s99, s98, s85
    s_add_u32 s82, s99, 4096
    s_add_u32 m0, s83, 90112
    s_nop 0
    buffer_load_dwordx4 v3, s[40:43], s82 offen lds
    s_add_u32 s96, s84, 11
    s_and_b32 s97, s96, 15
    s_mul_i32 s98, s97, 393216
    s_add_u32 s99, s98, s85
    s_add_u32 s82, s99, 4294770688
    s_add_u32 m0, s83, 135168
    s_nop 0
    buffer_load_dwordx4 v3, s[40:43], s82 offen lds
    s_add_u32 s96, s84, 11
    s_and_b32 s97, s96, 15
    s_mul_i32 s98, s97, 393216
    s_add_u32 s82, s98, s85
    s_add_u32 m0, s83, 139264
    s_nop 0
    buffer_load_dwordx4 v3, s[40:43], s82 offen lds
    s_waitcnt vmcnt(22)
    s_waitcnt vmcnt(20)
    s_waitcnt vmcnt(18)
    s_barrier
    s_add_u32 s96, s84, 12
    s_and_b32 s97, s96, 15
    s_mul_i32 s98, s97, 393216
    s_add_u32 s99, s98, s85
    s_add_u32 s82, s99, 4294772736
    s_add_u32 m0, s83, 4294963200
    s_nop 0
    buffer_load_dwordx4 v3, s[40:43], s82 offen lds
    s_add_u32 s96, s84, 12
    s_and_b32 s97, s96, 15
    s_mul_i32 s98, s97, 393216
    s_add_u32 s99, s98, s85
    s_add_u32 s82, s99, 2048
    s_mov_b32 m0, s83
    s_nop 0
    buffer_load_dwordx4 v3, s[40:43], s82 offen lds
    s_add_u32 s96, s84, 12
    s_and_b32 s97, s96, 15
    s_mul_i32 s98, s97, 393216
    s_add_u32 s99, s98, s85
    s_add_u32 s82, s99, 4294774784
    s_add_u32 m0, s83, 45056
    s_nop 0
    buffer_load_dwordx4 v3, s[40:43], s82 offen lds
    s_add_u32 s96, s84, 12
    s_and_b32 s97, s96, 15
    s_mul_i32 s98, s97, 393216
    s_add_u32 s99, s98, s85
    s_add_u32 s82, s99, 4096
    s_add_u32 m0, s83, 49152
    s_nop 0
    buffer_load_dwordx4 v3, s[40:43], s82 offen lds
    s_waitcnt vmcnt(20)
    s_barrier
    s_add_u32 s96, s84, 13
    s_and_b32 s97, s96, 15
    s_mul_i32 s98, s97, 393216
    s_add_u32 s99, s98, s85
    s_add_u32 s82, s99, 4294772736
    s_add_u32 m0, s83, 4096
    s_nop 0
    buffer_load_dwordx4 v3, s[40:43], s82 offen lds
    s_add_u32 s96, s84, 13
    s_and_b32 s97, s96, 15
    s_mul_i32 s98, s97, 393216
    s_add_u32 s99, s98, s85
    s_add_u32 s82, s99, 2048
    s_add_u32 m0, s83, 8192
    s_nop 0
    buffer_load_dwordx4 v3, s[40:43], s82 offen lds
    s_add_u32 s96, s84, 13
    s_and_b32 s97, s96, 15
    s_mul_i32 s98, s97, 393216
    s_add_u32 s99, s98, s85
    s_add_u32 s82, s99, 4294774784
    s_add_u32 m0, s83, 53248
    s_nop 0
    buffer_load_dwordx4 v3, s[40:43], s82 offen lds
    s_add_u32 s96, s84, 13
    s_and_b32 s97, s96, 15
    s_mul_i32 s98, s97, 393216
    s_add_u32 s99, s98, s85
    s_add_u32 s82, s99, 4096
    s_add_u32 m0, s83, 57344
    s_nop 0
    buffer_load_dwordx4 v3, s[40:43], s82 offen lds
    s_add_u32 s96, s84, 12
    s_and_b32 s97, s96, 15
    s_mul_i32 s98, s97, 393216
    s_add_u32 s99, s98, s85
    s_add_u32 s82, s99, 4294770688
    s_add_u32 m0, s83, 94208
    s_nop 0
    buffer_load_dwordx4 v3, s[40:43], s82 offen lds
    s_add_u32 s96, s84, 12
    s_and_b32 s97, s96, 15
    s_mul_i32 s98, s97, 393216
    s_add_u32 s82, s98, s85
    s_add_u32 m0, s83, 98304
    s_nop 0
    buffer_load_dwordx4 v3, s[40:43], s82 offen lds
    s_lshl_b32 s96, s74, 13
    s_sub_u32 s97, s3, 4
    s_lshl_b32 s98, s97, 8
    s_add_u32 s99, s96, s98
    s_add_u32 s13, s99, 20971520
    s_waitcnt lgkmcnt(0)
    s_load_dword s24, s[32:33], s13 offset:1276 glc
    s_load_dword s25, s[32:33], s13 offset:3324 glc
    s_load_dword s26, s[32:33], s13 offset:5372 glc
    s_load_dword s27, s[32:33], s13 offset:7420 glc
    s_waitcnt vmcnt(24)
    s_waitcnt vmcnt(22)
    s_barrier
    s_add_u32 s96, s84, 14
    s_and_b32 s97, s96, 15
    s_mul_i32 s98, s97, 393216
    s_add_u32 s99, s98, s85
    s_add_u32 s82, s99, 4294772736
    s_add_u32 m0, s83, 12288
    s_nop 0
    buffer_load_dwordx4 v3, s[40:43], s82 offen lds
    s_add_u32 s96, s84, 14
    s_and_b32 s97, s96, 15
    s_mul_i32 s98, s97, 393216
    s_add_u32 s99, s98, s85
    s_add_u32 s82, s99, 2048
    s_add_u32 m0, s83, 16384
    s_nop 0
    buffer_load_dwordx4 v3, s[40:43], s82 offen lds
    s_add_u32 s96, s84, 14
    s_and_b32 s97, s96, 15
    s_mul_i32 s98, s97, 393216
    s_add_u32 s99, s98, s85
    s_add_u32 s82, s99, 4294774784
    s_add_u32 m0, s83, 61440
    s_nop 0
    buffer_load_dwordx4 v3, s[40:43], s82 offen lds
    s_add_u32 s96, s84, 14
    s_and_b32 s97, s96, 15
    s_mul_i32 s98, s97, 393216
    s_add_u32 s99, s98, s85
    s_add_u32 s82, s99, 4096
    s_add_u32 m0, s83, 65536
    s_nop 0
    buffer_load_dwordx4 v3, s[40:43], s82 offen lds
    s_waitcnt vmcnt(24)
    s_waitcnt vmcnt(18)
    s_barrier
    s_add_u32 s96, s84, 15
    s_and_b32 s97, s96, 15
    s_mul_i32 s98, s97, 393216
    s_add_u32 s99, s98, s85
    s_add_u32 s82, s99, 4294772736
    s_add_u32 m0, s83, 20480
    s_nop 0
    buffer_load_dwordx4 v3, s[40:43], s82 offen lds
    s_add_u32 s96, s84, 15
    s_and_b32 s97, s96, 15
    s_mul_i32 s98, s97, 393216
    s_add_u32 s99, s98, s85
    s_add_u32 s82, s99, 2048
    s_add_u32 m0, s83, 24576
    s_nop 0
    buffer_load_dwordx4 v3, s[40:43], s82 offen lds
    s_waitcnt vmcnt(14)
    s_waitcnt vmcnt(10)
    s_waitcnt vmcnt(4)
    s_barrier
    s_add_u32 s96, s84, 15
    s_and_b32 s97, s96, 15
    s_mul_i32 s98, s97, 393216
    s_add_u32 s99, s98, s85
    s_add_u32 s82, s99, 4294774784
    s_add_u32 m0, s83, 69632
    s_nop 0
    buffer_load_dwordx4 v3, s[40:43], s82 offen lds
    s_add_u32 s96, s84, 15
    s_and_b32 s97, s96, 15
    s_mul_i32 s98, s97, 393216
    s_add_u32 s99, s98, s85
    s_add_u32 s82, s99, 4096
    s_add_u32 m0, s83, 73728
    s_nop 0
    buffer_load_dwordx4 v3, s[40:43], s82 offen lds
    s_add_u32 s96, s84, 13
    s_and_b32 s97, s96, 15
    s_mul_i32 s98, s97, 393216
    s_add_u32 s99, s98, s85
    s_add_u32 s82, s99, 4294770688
    s_add_u32 m0, s83, 102400
    s_nop 0
    buffer_load_dwordx4 v3, s[40:43], s82 offen lds
    s_add_u32 s96, s84, 13
    s_and_b32 s97, s96, 15
    s_mul_i32 s98, s97, 393216
    s_add_u32 s82, s98, s85
    s_add_u32 m0, s83, 106496
    s_nop 0
    buffer_load_dwordx4 v3, s[40:43], s82 offen lds
    s_mov_b32 s82, s19
    buffer_load_dwordx4 v[88:91], v248, s[48:51], s82 offen nt
    s_add_u32 s82, s19, 12288
    buffer_load_dwordx4 v[92:95], v248, s[48:51], s82 offen nt
    s_add_u32 s82, s19, 24576
    buffer_load_dwordx4 v[96:99], v248, s[48:51], s82 offen nt
    s_add_u32 s82, s19, 36864
    buffer_load_dwordx4 v[100:103], v248, s[48:51], s82 offen nt
    s_waitcnt vmcnt(8)
    s_barrier
    s_add_u32 s96, s84, 14
    s_and_b32 s97, s96, 15
    s_mul_i32 s98, s97, 393216
    s_add_u32 s99, s98, s85
    s_add_u32 s82, s99, 4294770688
    s_add_u32 m0, s83, 110592
    s_nop 0
    buffer_load_dwordx4 v3, s[40:43], s82 offen lds
    s_add_u32 s96, s84, 14
    s_and_b32 s97, s96, 15
    s_mul_i32 s98, s97, 393216
    s_add_u32 s82, s98, s85
    s_add_u32 m0, s83, 114688
    s_nop 0
    buffer_load_dwordx4 v3, s[40:43], s82 offen lds
    s_add_u32 s96, s84, 15
    s_and_b32 s97, s96, 15
    s_mul_i32 s98, s97, 393216
    s_add_u32 s99, s98, s85
    s_add_u32 s82, s99, 4294770688
    s_add_u32 m0, s83, 118784
    s_nop 0
    buffer_load_dwordx4 v3, s[40:43], s82 offen lds
    s_add_u32 s96, s84, 15
    s_and_b32 s97, s96, 15
    s_mul_i32 s98, s97, 393216
    s_add_u32 s82, s98, s85
    s_add_u32 m0, s83, 122880
    s_nop 0
    buffer_load_dwordx4 v3, s[40:43], s82 offen lds
    v_and_b32 v85, 1, v1
    v_lshlrev_b32 v85, 3, v85
    v_bfe_u32 v84, v1, 2, 2
    v_lshl_add_u32 v85, v84, 4, v85
    v_bfe_u32 v84, v1, 4, 1
    v_lshl_add_u32 v85, v84, 6, v85
    v_bfe_u32 v84, v1, 1, 1
    v_lshl_add_u32 v85, v84, 7, v85
    v_lshrrev_b32 v84, 5, v1
    v_lshl_add_u32 v85, v84, 8, v85
    s_lshl_b32 s13, s3, 12
    v_add_u32 v84, s13, v85
    s_lshl_b32 s96, s76, 13
    s_add_u32 s13, s96, 32768
    v_add_u32 v85, s13, v85
    v_mov_b32 v80, 0x3f803f80
    v_mov_b32 v81, 0x3f803f80
    v_mov_b32 v82, 0x3f803f80
    v_mov_b32 v83, 0x3f803f80
    s_lshl3_add_u32 s96, s11, s3
    s_lshl_b32 s97, s96, 5
    s_add_u32 s98, s97, s10
    s_lshl_b32 s99, s98, 10
    s_add_u32 s13, s99, 25165824
    s_add_u32 s15, s13, 16384
    s_lshl3_add_u32 s96, s11, s3
    s_lshl_b32 s97, s96, 10
    s_add_u32 s16, s97, 21495808
    s_lshl_b32 s96, s10, 6
    s_add_u32 s14, s96, s16
    s_waitcnt lgkmcnt(0)
    s_barrier
    s_setprio 3
    ds_read_b128 v[152:155], v0
    ds_read_b128 v[156:159], v0 offset:1024
    v_subrev_u32 v0, 118784, v0
    s_waitcnt lgkmcnt(1)
    v_mfma_f32_32x32x16_bf16 v[184:199], v[168:171], v[152:155], 0
    s_waitcnt lgkmcnt(0)
    v_mfma_f32_32x32x16_bf16 v[184:199], v[172:175], v[156:159], v[184:199]
    s_setprio 0
    s_nop 10
    v_cvt_pk_bf16_f32 v184, 0, v184
    v_cvt_pk_bf16_f32 v185, 0, v185
    v_cvt_pk_bf16_f32 v186, 0, v186
    s_add_u32 s82, s19, 49152
    buffer_load_dwordx4 v[104:107], v248, s[48:51], s82 offen nt
    v_cvt_pk_bf16_f32 v187, 0, v187
    v_cvt_pk_bf16_f32 v188, 0, v188
    v_cvt_pk_bf16_f32 v189, 0, v189
    v_cvt_pk_bf16_f32 v190, 0, v190
    v_cvt_pk_bf16_f32 v191, 0, v191
    v_cvt_pk_bf16_f32 v192, 0, v192
    v_cvt_pk_bf16_f32 v193, 0, v193
    v_cvt_pk_bf16_f32 v194, 0, v194
    v_cvt_pk_bf16_f32 v195, 0, v195
    v_cvt_pk_bf16_f32 v196, 0, v196
    s_add_u32 s82, s19, 61440
    buffer_load_dwordx4 v[108:111], v248, s[48:51], s82 offen nt
    v_cvt_pk_bf16_f32 v197, 0, v197
    v_cvt_pk_bf16_f32 v198, 0, v198
    v_cvt_pk_bf16_f32 v199, 0, v199
    v_max3_f32 v4, v184, v185, v186
    v_min3_f32 v5, v184, v185, v186
    v_max3_f32 v4, v4, v187, v188
    v_min3_f32 v5, v5, v187, v188
    v_max3_f32 v4, v4, v189, v190
    v_min3_f32 v5, v5, v189, v190
    v_max3_f32 v4, v4, v191, v192
    s_add_u32 s82, s19, 73728
    buffer_load_dwordx4 v[112:115], v248, s[48:51], s82 offen nt
    v_min3_f32 v5, v5, v191, v192
    v_max3_f32 v4, v4, v193, v194
    v_min3_f32 v5, v5, v193, v194
    v_max3_f32 v4, v4, v195, v196
    v_min3_f32 v5, v5, v195, v196
    v_max3_f32 v4, v4, v197, v198
    v_min3_f32 v5, v5, v197, v198
    v_max_f32 v6, v4, v199
    v_min_f32 v7, v5, v199
    v_max_f32 v4, v4, v199
    s_add_u32 s82, s19, 86016
    buffer_load_dwordx4 v[116:119], v248, s[48:51], s82 offen nt
    v_min_f32 v5, v5, v199
    v_permlane32_swap_b32 v4, v6
    s_nop 0
    v_permlane32_swap_b32 v5, v7
    v_max_f32 v4, v4, v6
    v_min_f32 v5, v5, v7
    v_mul_f32_e64 v4, v4, s7
    v_mul_f32_e64 v5, v5, s7
    v_fma_f32 v216, v184, s7, -v4
    v_fma_f32 v217, v185, s7, -v4
    v_fma_f32 v184, -v184, s7, v5
    v_fma_f32 v185, -v185, s7, v5
    v_fma_f32 v218, v186, s7, -v4
    v_fma_f32 v219, v187, s7, -v4
    v_fma_f32 v186, -v186, s7, v5
    v_fma_f32 v187, -v187, s7, v5
    s_waitcnt vmcnt(14)
    s_barrier
    s_setprio 3
    ds_read_b128 v[152:155], v0
    ds_read_b128 v[156:159], v0 offset:1024
    s_waitcnt lgkmcnt(1)
    v_mfma_f32_32x32x16_bf16 v[200:215], v[176:179], v[152:155], 0
    s_waitcnt lgkmcnt(0)
    v_mfma_f32_32x32x16_bf16 v[200:215], v[180:183], v[156:159], v[200:215]
    s_setprio 0
    v_fma_f32 v220, v188, s7, -v4
    v_fma_f32 v221, v189, s7, -v4
    v_fma_f32 v188, -v188, s7, v5
    v_fma_f32 v189, -v189, s7, v5
    v_fma_f32 v222, v190, s7, -v4
    s_mov_b32 s82, s80
    buffer_load_dwordx4 v[56:59], v27, s[52:55], s82 offen nt
    v_fma_f32 v223, v191, s7, -v4
    v_fma_f32 v190, -v190, s7, v5
    v_fma_f32 v191, -v191, s7, v5
    v_fma_f32 v224, v192, s7, -v4
    v_fma_f32 v225, v193, s7, -v4
    s_setprio 3
    v_fma_f32 v192, -v192, s7, v5
    v_fma_f32 v193, -v193, s7, v5
    v_fma_f32 v226, v194, s7, -v4
    v_fma_f32 v227, v195, s7, -v4
    v_fma_f32 v194, -v194, s7, v5
    v_fma_f32 v195, -v195, s7, v5
    v_fma_f32 v228, v196, s7, -v4
    v_fma_f32 v229, v197, s7, -v4
    v_fma_f32 v196, -v196, s7, v5
    v_fma_f32 v197, -v197, s7, v5
    v_fma_f32 v230, v198, s7, -v4
    v_fma_f32 v231, v199, s7, -v4
    v_fma_f32 v198, -v198, s7, v5
    v_fma_f32 v199, -v199, s7, v5
    v_exp_f32 v216, v216
    s_add_u32 s82, s80, 4294049792
    buffer_load_dwordx4 v[60:63], v27, s[52:55], s82 offen nt
    v_exp_f32 v184, v184
    v_exp_f32 v217, v217
    v_exp_f32 v185, v185
    v_exp_f32 v218, v218
    v_exp_f32 v186, v186
    v_exp_f32 v219, v219
    v_exp_f32 v187, v187
    v_exp_f32 v220, v220
    v_exp_f32 v188, v188
    v_exp_f32 v221, v221
    v_exp_f32 v189, v189
    v_exp_f32 v222, v222
    v_exp_f32 v190, v190
    v_exp_f32 v223, v223
    v_exp_f32 v191, v191
    v_exp_f32 v224, v224
    v_exp_f32 v192, v192
    v_exp_f32 v225, v225
    v_exp_f32 v193, v193
    v_exp_f32 v226, v226
    s_add_u32 s82, s80, 57344
    buffer_load_dwordx4 v[64:67], v27, s[52:55], s82 offen nt
    v_exp_f32 v194, v194
    v_exp_f32 v227, v227
    v_exp_f32 v195, v195
    v_exp_f32 v228, v228
    v_exp_f32 v196, v196
    v_exp_f32 v229, v229
    v_exp_f32 v197, v197
    v_exp_f32 v230, v230
    v_exp_f32 v198, v198
    v_exp_f32 v231, v231
    v_exp_f32 v199, v199
    v_add_f32 v8, v216, v218
    v_add_f32 v9, v217, v219
    v_add_f32 v10, v184, v186
    v_add_f32 v11, v185, v187
    v_add_f32 v8, v8, v220
    v_add_f32 v9, v9, v221
    v_add_f32 v10, v10, v188
    v_add_f32 v11, v11, v189
    v_add_f32 v8, v8, v222
    s_add_u32 s82, s80, 4294107136
    buffer_load_dwordx4 v[68:71], v27, s[52:55], s82 offen nt
    v_add_f32 v9, v9, v223
    v_add_f32 v10, v10, v190
    v_add_f32 v11, v11, v191
    v_add_f32 v8, v8, v224
    v_add_f32 v9, v9, v225
    v_add_f32 v10, v10, v192
    v_add_f32 v11, v11, v193
    v_add_f32 v8, v8, v226
    v_add_f32 v9, v9, v227
    v_add_f32 v10, v10, v194
    v_add_f32 v11, v11, v195
    v_add_f32 v8, v8, v228
    v_add_f32 v9, v9, v229
    v_add_f32 v10, v10, v196
    v_add_f32 v11, v11, v197
    v_add_f32 v8, v8, v230
    v_add_f32 v9, v9, v231
    v_add_f32 v10, v10, v198
    v_add_f32 v11, v11, v199
    v_add_f32 v6, v8, v9
    v_add_f32 v7, v10, v11
    v_add_f32 v4, v8, v9
    s_setprio 0
    v_add_f32 v5, v10, v11
    v_permlane32_swap_b32 v4, v6
    s_nop 0
    v_permlane32_swap_b32 v5, v7
    v_add_f32 v4, v4, v6
    v_add_f32 v5, v5, v7
    v_rcp_f32 v4, v4
    v_rcp_f32 v5, v5
    v_mul_f32 v216, v216, v4
    v_mul_f32 v217, v217, v4
    v_mul_f32 v184, v184, v5
    v_mul_f32 v185, v185, v5
    v_mul_f32 v218, v218, v4
    v_mul_f32 v219, v219, v4
    v_mul_f32 v186, v186, v5
    v_mul_f32 v187, v187, v5
    v_mul_f32 v220, v220, v4
    v_mul_f32 v221, v221, v4
    v_mul_f32 v188, v188, v5
    v_mul_f32 v189, v189, v5
    v_mul_f32 v222, v222, v4
    v_mul_f32 v223, v223, v4
    v_mul_f32 v190, v190, v5
    v_mul_f32 v191, v191, v5
    v_mul_f32 v224, v224, v4
    v_mul_f32 v225, v225, v4
    v_mul_f32 v192, v192, v5
    v_mul_f32 v193, v193, v5
    v_mul_f32 v226, v226, v4
    v_mul_f32 v227, v227, v4
    v_mul_f32 v194, v194, v5
    v_mul_f32 v195, v195, v5
    v_mul_f32 v228, v228, v4
    v_mul_f32 v229, v229, v4
    v_mul_f32 v196, v196, v5
    v_mul_f32 v197, v197, v5
    v_mul_f32 v230, v230, v4
    v_mul_f32 v231, v231, v4
    v_mul_f32 v198, v198, v5
    v_mul_f32 v199, v199, v5
    v_cvt_pk_bf16_f32 v216, v216, v217
    v_cvt_pk_bf16_f32 v217, v218, v219
    v_cvt_pk_bf16_f32 v218, v220, v221
    v_cvt_pk_bf16_f32 v219, v222, v223
    v_cvt_pk_bf16_f32 v220, v224, v225
    v_cvt_pk_bf16_f32 v221, v226, v227
    v_cvt_pk_bf16_f32 v222, v228, v229
    v_cvt_pk_bf16_f32 v223, v230, v231
    ds_write_b128 v232, v[216:219]
    v_cvt_pk_bf16_f32 v224, v184, v185
    v_cvt_pk_bf16_f32 v225, v186, v187
    v_cvt_pk_bf16_f32 v226, v188, v189
    v_cvt_pk_bf16_f32 v227, v190, v191
    ds_write_b128 v232, v[220:223] offset:4096
    s_waitcnt vmcnt(16)
    s_waitcnt vmcnt(10)
    s_waitcnt vmcnt(8)
    s_barrier
    ds_write_b128 v232, v[224:227] offset:8192
    v_cvt_pk_bf16_f32 v228, v192, v193
    v_cvt_pk_bf16_f32 v229, v194, v195
    v_cvt_pk_bf16_f32 v230, v196, v197
    v_cvt_pk_bf16_f32 v231, v198, v199
    s_xor_b32 s96, s95, 786432
    s_add_u32 s97, s96, s90
    s_sub_u32 s82, s97, 65536
    s_add_u32 m0, s83, 45056
    s_nop 0
    buffer_load_dwordx4 v26, s[44:47], s82 offen lds
    ds_write_b128 v232, v[228:231] offset:12288
    v_cvt_pk_bf16_f32 v200, 0, v200
    v_cvt_pk_bf16_f32 v201, 0, v201
    v_cvt_pk_bf16_f32 v202, 0, v202
    v_cvt_pk_bf16_f32 v203, 0, v203
    v_cvt_pk_bf16_f32 v204, 0, v204
    v_cvt_pk_bf16_f32 v205, 0, v205
    v_cvt_pk_bf16_f32 v206, 0, v206
    v_cvt_pk_bf16_f32 v207, 0, v207
    v_cvt_pk_bf16_f32 v208, 0, v208
    v_cvt_pk_bf16_f32 v209, 0, v209
    v_cvt_pk_bf16_f32 v210, 0, v210
    v_cvt_pk_bf16_f32 v211, 0, v211
    s_xor_b32 s96, s95, 786432
    s_add_u32 s82, s96, s90
    s_add_u32 m0, s83, 49152
    s_nop 0
    buffer_load_dwordx4 v26, s[44:47], s82 offen lds
    v_cvt_pk_bf16_f32 v212, 0, v212
    v_cvt_pk_bf16_f32 v213, 0, v213
    v_cvt_pk_bf16_f32 v214, 0, v214
    v_cvt_pk_bf16_f32 v215, 0, v215
    v_max3_f32 v4, v200, v201, v202
    v_min3_f32 v5, v200, v201, v202
    v_max3_f32 v4, v4, v203, v204
    v_min3_f32 v5, v5, v203, v204
L_PAD6:
    s_cbranch_execz L_RET6
    v_max3_f32 v4, v4, v205, v206
    v_min3_f32 v5, v5, v205, v206
    v_max3_f32 v4, v4, v207, v208
    v_min3_f32 v5, v5, v207, v208
    v_max3_f32 v4, v4, v209, v210
    v_min3_f32 v5, v5, v209, v210
    s_xor_b32 s96, s95, 917504
    s_add_u32 s97, s96, s90
    s_sub_u32 s82, s97, 65536
    s_add_u32 m0, s83, 53248
    s_nop 0
    buffer_load_dwordx4 v26, s[44:47], s82 offen lds
    v_max3_f32 v4, v4, v211, v212
    v_min3_f32 v5, v5, v211, v212
    v_max3_f32 v4, v4, v213, v214
    v_min3_f32 v5, v5, v213, v214
    v_max_f32 v6, v4, v215
    v_min_f32 v7, v5, v215
    v_max_f32 v4, v4, v215
    s_waitcnt lgkmcnt(0)
    v_min_f32 v5, v5, v215
    v_permlane32_swap_b32 v4, v6
    s_nop 0
    v_permlane32_swap_b32 v5, v7
    v_max_f32 v4, v4, v6
    v_min_f32 v5, v5, v7
    v_mul_f32_e64 v4, v4, s7
    s_xor_b32 s96, s95, 917504
    s_add_u32 s82, s96, s90
    s_add_u32 m0, s83, 57344
    s_nop 0
    buffer_load_dwordx4 v26, s[44:47], s82 offen lds
    v_mul_f32_e64 v5, v5, s7
    v_fma_f32 v216, v200, s7, -v4
    v_fma_f32 v217, v201, s7, -v4
    v_fma_f32 v200, -v200, s7, v5
    v_fma_f32 v201, -v201, s7, v5
    v_fma_f32 v218, v202, s7, -v4
    v_fma_f32 v219, v203, s7, -v4
    v_fma_f32 v202, -v202, s7, v5
    v_fma_f32 v203, -v203, s7, v5
    v_fma_f32 v220, v204, s7, -v4
    v_fma_f32 v221, v205, s7, -v4
    v_fma_f32 v204, -v204, s7, v5
    v_fma_f32 v205, -v205, s7, v5
    v_fma_f32 v222, v206, s7, -v4
    s_xor_b32 s96, s95, 1048576
    s_add_u32 s97, s96, s90
    s_sub_u32 s82, s97, 65536
    s_add_u32 m0, s83, 61440
    s_nop 0
    buffer_load_dwordx4 v26, s[44:47], s82 offen lds
    v_fma_f32 v223, v207, s7, -v4
    v_fma_f32 v206, -v206, s7, v5
    v_fma_f32 v207, -v207, s7, v5
    v_fma_f32 v224, v208, s7, -v4
    v_fma_f32 v225, v209, s7, -v4
    v_fma_f32 v208, -v208, s7, v5
    v_fma_f32 v209, -v209, s7, v5
    v_fma_f32 v226, v210, s7, -v4
    v_fma_f32 v227, v211, s7, -v4
    v_fma_f32 v210, -v210, s7, v5
    v_fma_f32 v211, -v211, s7, v5
    v_fma_f32 v228, v212, s7, -v4
    v_fma_f32 v229, v213, s7, -v4
    v_fma_f32 v212, -v212, s7, v5
    s_xor_b32 s96, s95, 1048576
    s_add_u32 s82, s96, s90
    s_add_u32 m0, s83, 65536
    s_nop 0
    buffer_load_dwordx4 v26, s[44:47], s82 offen lds
    v_fma_f32 v213, -v213, s7, v5
    v_fma_f32 v230, v214, s7, -v4
    v_fma_f32 v231, v215, s7, -v4
    v_fma_f32 v214, -v214, s7, v5
    v_fma_f32 v215, -v215, s7, v5
    v_exp_f32 v216, v216
    v_exp_f32 v200, v200
    v_exp_f32 v217, v217
    v_exp_f32 v201, v201
    v_exp_f32 v218, v218
    v_exp_f32 v202, v202
    v_exp_f32 v219, v219
    v_exp_f32 v203, v203
    v_exp_f32 v220, v220
    s_xor_b32 s96, s95, 1179648
    s_add_u32 s97, s96, s90
    s_sub_u32 s82, s97, 65536
    s_add_u32 m0, s83, 69632
    s_nop 0
    buffer_load_dwordx4 v26, s[44:47], s82 offen lds
    v_exp_f32 v204, v204
    v_exp_f32 v221, v221
    v_exp_f32 v205, v205
    v_exp_f32 v222, v222
    v_exp_f32 v206, v206
    v_exp_f32 v223, v223
    v_exp_f32 v207, v207
    v_exp_f32 v224, v224
    v_exp_f32 v208, v208
    v_exp_f32 v225, v225
    v_exp_f32 v209, v209
    v_exp_f32 v226, v226
    v_exp_f32 v210, v210
    v_exp_f32 v227, v227
    s_xor_b32 s96, s95, 1179648
    s_add_u32 s82, s96, s90
    s_add_u32 m0, s83, 73728
    s_nop 0
    buffer_load_dwordx4 v26, s[44:47], s82 offen lds
    v_exp_f32 v211, v211
    v_exp_f32 v228, v228
    v_exp_f32 v212, v212
    v_exp_f32 v229, v229
    v_exp_f32 v213, v213
    v_exp_f32 v230, v230
    v_exp_f32 v214, v214
    v_exp_f32 v231, v231
    v_exp_f32 v215, v215
    v_add_f32 v8, v216, v218
    v_add_f32 v9, v217, v219
    v_add_f32 v10, v200, v202
    v_add_f32 v11, v201, v203
    v_add_f32 v8, v8, v220
    v_add_f32 v9, v9, v221
    v_add_f32 v10, v10, v204
    v_add_f32 v11, v11, v205
    v_add_f32 v8, v8, v222
    v_add_f32 v9, v9, v223
    v_add_f32 v10, v10, v206
    v_add_f32 v11, v11, v207
    v_add_f32 v8, v8, v224
    v_add_f32 v9, v9, v225
    v_add_f32 v10, v10, v208
    v_add_f32 v11, v11, v209
    v_add_f32 v8, v8, v226
    v_add_f32 v9, v9, v227
    v_add_f32 v10, v10, v210
    v_add_f32 v11, v11, v211
    v_add_f32 v8, v8, v228
    v_add_f32 v9, v9, v229
    v_add_f32 v10, v10, v212
    v_add_f32 v11, v11, v213
    v_add_f32 v8, v8, v230
    v_add_f32 v9, v9, v231
    v_add_f32 v10, v10, v214
    v_add_f32 v11, v11, v215
    v_add_f32 v6, v8, v9
    v_add_f32 v7, v10, v11
    v_add_f32 v4, v8, v9
    v_add_f32 v5, v10, v11
    s_nop 0
    v_permlane32_swap_b32 v4, v6
    v_permlane32_swap_b32 v5, v7
    v_add_f32 v4, v4, v6
    v_add_f32 v5, v5, v7
    v_rcp_f32 v4, v4
    v_rcp_f32 v5, v5
    v_mul_f32 v216, v216, v4
    v_mul_f32 v217, v217, v4
    v_mul_f32 v200, v200, v5
    v_mul_f32 v201, v201, v5
    v_mul_f32 v218, v218, v4
    v_mul_f32 v219, v219, v4
    v_mul_f32 v202, v202, v5
    v_mul_f32 v203, v203, v5
    v_mul_f32 v220, v220, v4
    v_mul_f32 v221, v221, v4
    v_mul_f32 v204, v204, v5
    v_mul_f32 v205, v205, v5
    v_mul_f32 v222, v222, v4
    v_mul_f32 v223, v223, v4
    v_mul_f32 v206, v206, v5
    v_mul_f32 v207, v207, v5
    v_mul_f32 v224, v224, v4
    v_mul_f32 v225, v225, v4
    v_mul_f32 v208, v208, v5
    v_mul_f32 v209, v209, v5
    v_mul_f32 v226, v226, v4
    v_mul_f32 v227, v227, v4
    v_mul_f32 v210, v210, v5
    v_mul_f32 v211, v211, v5
    v_mul_f32 v228, v228, v4
    v_mul_f32 v229, v229, v4
    v_mul_f32 v212, v212, v5
    v_mul_f32 v213, v213, v5
    v_mul_f32 v230, v230, v4
    v_mul_f32 v231, v231, v4
    v_mul_f32 v214, v214, v5
    v_mul_f32 v215, v215, v5
    v_cvt_pk_bf16_f32 v216, v216, v217
    v_cvt_pk_bf16_f32 v217, v218, v219
    v_cvt_pk_bf16_f32 v218, v220, v221
    v_cvt_pk_bf16_f32 v219, v222, v223
    v_cvt_pk_bf16_f32 v220, v224, v225
    v_cvt_pk_bf16_f32 v221, v226, v227
    v_cvt_pk_bf16_f32 v222, v228, v229
    v_cvt_pk_bf16_f32 v223, v230, v231
    ds_write_b128 v232, v[216:219] offset:16384
    v_cvt_pk_bf16_f32 v224, v200, v201
    v_cvt_pk_bf16_f32 v225, v202, v203
    v_cvt_pk_bf16_f32 v226, v204, v205
    v_cvt_pk_bf16_f32 v227, v206, v207
    ds_write_b128 v232, v[220:223] offset:20480
    ds_write_b128 v232, v[224:227] offset:24576
    v_cvt_pk_bf16_f32 v228, v208, v209
    v_cvt_pk_bf16_f32 v229, v210, v211
    v_cvt_pk_bf16_f32 v230, v212, v213
    v_cvt_pk_bf16_f32 v231, v214, v215
    ds_write_b128 v232, v[228:231] offset:28672
    s_lshl_b32 s96, s77, 11
    s_add_u32 s17, s96, 151552
    v_add_u32 v0, s17, v2
    s_setprio 0
L_JOIN:
    s_waitcnt lgkmcnt(0)
    s_barrier
    ds_read_b64_tr_b16 v[184:185], v84
    ds_read_b64_tr_b16 v[186:187], v84 offset:512
    ds_read_b64_tr_b16 v[200:201], v85
    ds_read_b64_tr_b16 v[202:203], v85 offset:512
    ds_read_b64_tr_b16 v[204:205], v85 offset:1024
    ds_read_b64_tr_b16 v[206:207], v85 offset:1536
    ds_read_b64_tr_b16 v[188:189], v84 offset:1024
    ds_read_b64_tr_b16 v[190:191], v84 offset:1536
    ds_read_b64_tr_b16 v[208:209], v85 offset:2048
    ds_read_b64_tr_b16 v[210:211], v85 offset:2560
    ds_read_b64_tr_b16 v[212:213], v85 offset:3072
    ds_read_b64_tr_b16 v[214:215], v85 offset:3584
    ds_read_b64_tr_b16 v[192:193], v84 offset:2048
    ds_read_b64_tr_b16 v[194:195], v84 offset:2560
    ds_read_b64_tr_b16 v[216:217], v85 offset:4096
    ds_read_b64_tr_b16 v[218:219], v85 offset:4608
    ds_read_b64_tr_b16 v[220:221], v85 offset:5120
    ds_read_b64_tr_b16 v[222:223], v85 offset:5632
    s_waitcnt lgkmcnt(12)
    v_mfma_f32_16x16x32_bf16 v[232:235], v[184:187], v[200:203], 0
    v_mfma_f32_16x16x32_bf16 v[236:239], v[184:187], v[204:207], 0
    v_mfma_f32_16x16x32_bf16 v[240:243], v[184:187], v[80:83], 0
    ds_read_b64_tr_b16 v[196:197], v84 offset:3072
    ds_read_b64_tr_b16 v[198:199], v84 offset:3584
    ds_read_b64_tr_b16 v[224:225], v85 offset:6144
    ds_read_b64_tr_b16 v[226:227], v85 offset:6656
    ds_read_b64_tr_b16 v[228:229], v85 offset:7168
    ds_read_b64_tr_b16 v[230:231], v85 offset:7680
    s_waitcnt lgkmcnt(12)
    v_mfma_f32_16x16x32_bf16 v[232:235], v[188:191], v[208:211], v[232:235]
    v_mfma_f32_16x16x32_bf16 v[236:239], v[188:191], v[212:215], v[236:239]
    v_mfma_f32_16x16x32_bf16 v[240:243], v[188:191], v[80:83], v[240:243]
    s_waitcnt lgkmcnt(6)
    v_mfma_f32_16x16x32_bf16 v[232:235], v[192:195], v[216:219], v[232:235]
    v_mfma_f32_16x16x32_bf16 v[236:239], v[192:195], v[220:223], v[236:239]
    v_mfma_f32_16x16x32_bf16 v[240:243], v[192:195], v[80:83], v[240:243]
    s_waitcnt lgkmcnt(0)
    v_mfma_f32_16x16x32_bf16 v[232:235], v[196:199], v[224:227], v[232:235]
    v_mfma_f32_16x16x32_bf16 v[236:239], v[196:199], v[228:231], v[236:239]
    v_mfma_f32_16x16x32_bf16 v[240:243], v[196:199], v[80:83], v[240:243]
    s_cmp_lt_u32 s3, 4
    s_cbranch_scc1 L_NOQX
    ds_read_b128 v[168:171], v0
    ds_read_b128 v[172:175], v0 offset:1024
L_NOQX:
    s_nop 3
    buffer_store_dwordx4 v[232:235], v2, s[32:35], s13 offen sc1
    buffer_store_dwordx4 v[236:239], v2, s[32:35], s15 offen sc1
    s_mov_b32 exec_lo, 0x00010001
    s_mov_b32 exec_hi, 0x00010001
    buffer_store_dwordx4 v[240:243], v1, s[32:35], s14 offen sc1
    s_mov_b64 exec, -1
    s_waitcnt lgkmcnt(0)
    v_mfma_f32_32x32x16_bf16 v[120:135], v[176:179], v[168:171], 0
    v_mfma_f32_32x32x16_bf16 v[120:135], v[180:183], v[172:175], v[120:135]
    v_and_b32 v46, 7, v1
    v_lshlrev_b32 v46, 17, v46
    v_bfe_u32 v9, v1, 3, 1
    v_lshl_add_u32 v46, v9, 14, v46
    s_and_b32 s96, s10, 1
    s_and_b32 s97, s2, 27
    s_lshl_b32 s98, s97, 12
    s_lshr_b32 s99, s10, 1
    s_lshl_b32 s97, s99, 6
    s_add_u32 s99, s98, s97
    s_lshl2_add_u32 s98, s96, s99
    s_add_u32 s97, s98, 1048576
    s_add_u32 s17, s97, 512
    v_lshrrev_b32 v47, 3, v1
    v_lshlrev_b32 v47, 10, v47
    v_and_b32 v9, 7, v1
    v_lshl_add_u32 v47, v9, 4, v47
    v_and_b32 v48, 7, v1
    v_lshlrev_b32 v48, 4, v48
    v_lshrrev_b32 v9, 5, v1
    v_lshl_add_u32 v48, v9, 3, v48
    v_cvt_pk_bf16_f32 v120, 0, v120
    v_cvt_pk_bf16_f32 v121, 0, v121
    v_cvt_pk_bf16_f32 v122, 0, v122
    v_cvt_pk_bf16_f32 v123, 0, v123
    v_cvt_pk_bf16_f32 v124, 0, v124
    v_cvt_pk_bf16_f32 v125, 0, v125
    v_cvt_pk_bf16_f32 v126, 0, v126
    v_cvt_pk_bf16_f32 v127, 0, v127
    v_cvt_pk_bf16_f32 v128, 0, v128
    v_cvt_pk_bf16_f32 v129, 0, v129
    v_cvt_pk_bf16_f32 v130, 0, v130
    v_cvt_pk_bf16_f32 v131, 0, v131
    v_cvt_pk_bf16_f32 v132, 0, v132
    v_cvt_pk_bf16_f32 v133, 0, v133
    v_cvt_pk_bf16_f32 v134, 0, v134
    v_cvt_pk_bf16_f32 v135, 0, v135
    v_max3_f32 v4, v120, v121, v122
    v_min3_f32 v5, v120, v121, v122
    v_max3_f32 v4, v4, v123, v124
    v_min3_f32 v5, v5, v123, v124
    v_max3_f32 v4, v4, v125, v126
    v_min3_f32 v5, v5, v125, v126
    v_max3_f32 v4, v4, v127, v128
    v_min3_f32 v5, v5, v127, v128
    v_max3_f32 v4, v4, v129, v130
    v_min3_f32 v5, v5, v129, v130
    v_max3_f32 v4, v4, v131, v132
    v_min3_f32 v5, v5, v131, v132
    v_max3_f32 v4, v4, v133, v134
    v_min3_f32 v5, v5, v133, v134
    v_max_f32 v6, v4, v135
    v_min_f32 v7, v5, v135
    v_max_f32 v4, v4, v135
    v_min_f32 v5, v5, v135
    s_nop 0
    v_permlane32_swap_b32 v4, v6
    v_permlane32_swap_b32 v5, v7
    v_max_f32 v4, v4, v6
    v_min_f32 v5, v5, v7
    v_pk_mul_f32 v[4:5], v[4:5], s[6:7] op_sel:[0,1]
    v_mov_b32 v6, v5
    v_pk_fma_f32 v[136:137], v[120:121], s[6:7], v[4:5] op_sel:[0,1,0] op_sel_hi:[1,1,0] neg_lo:[0,0,1] neg_hi:[0,0,1]
    v_pk_fma_f32 v[120:121], v[120:121], s[6:7], v[6:7] op_sel:[0,1,0] op_sel_hi:[1,1,0] neg_lo:[1,0,0] neg_hi:[1,0,0]
    v_pk_fma_f32 v[138:139], v[122:123], s[6:7], v[4:5] op_sel:[0,1,0] op_sel_hi:[1,1,0] neg_lo:[0,0,1] neg_hi:[0,0,1]
    v_pk_fma_f32 v[122:123], v[122:123], s[6:7], v[6:7] op_sel:[0,1,0] op_sel_hi:[1,1,0] neg_lo:[1,0,0] neg_hi:[1,0,0]
    v_pk_fma_f32 v[140:141], v[124:125], s[6:7], v[4:5] op_sel:[0,1,0] op_sel_hi:[1,1,0] neg_lo:[0,0,1] neg_hi:[0,0,1]
    v_pk_fma_f32 v[124:125], v[124:125], s[6:7], v[6:7] op_sel:[0,1,0] op_sel_hi:[1,1,0] neg_lo:[1,0,0] neg_hi:[1,0,0]
    v_pk_fma_f32 v[142:143], v[126:127], s[6:7], v[4:5] op_sel:[0,1,0] op_sel_hi:[1,1,0] neg_lo:[0,0,1] neg_hi:[0,0,1]
    v_pk_fma_f32 v[126:127], v[126:127], s[6:7], v[6:7] op_sel:[0,1,0] op_sel_hi:[1,1,0] neg_lo:[1,0,0] neg_hi:[1,0,0]
    v_pk_fma_f32 v[144:145], v[128:129], s[6:7], v[4:5] op_sel:[0,1,0] op_sel_hi:[1,1,0] neg_lo:[0,0,1] neg_hi:[0,0,1]
    v_pk_fma_f32 v[128:129], v[128:129], s[6:7], v[6:7] op_sel:[0,1,0] op_sel_hi:[1,1,0] neg_lo:[1,0,0] neg_hi:[1,0,0]
    v_pk_fma_f32 v[146:147], v[130:131], s[6:7], v[4:5] op_sel:[0,1,0] op_sel_hi:[1,1,0] neg_lo:[0,0,1] neg_hi:[0,0,1]
    v_pk_fma_f32 v[130:131], v[130:131], s[6:7], v[6:7] op_sel:[0,1,0] op_sel_hi:[1,1,0] neg_lo:[1,0,0] neg_hi:[1,0,0]
    v_pk_fma_f32 v[148:149], v[132:133], s[6:7], v[4:5] op_sel:[0,1,0] op_sel_hi:[1,1,0] neg_lo:[0,0,1] neg_hi:[0,0,1]
    v_pk_fma_f32 v[132:133], v[132:133], s[6:7], v[6:7] op_sel:[0,1,0] op_sel_hi:[1,1,0] neg_lo:[1,0,0] neg_hi:[1,0,0]
    v_pk_fma_f32 v[150:151], v[134:135], s[6:7], v[4:5] op_sel:[0,1,0] op_sel_hi:[1,1,0] neg_lo:[0,0,1] neg_hi:[0,0,1]
    v_pk_fma_f32 v[134:135], v[134:135], s[6:7], v[6:7] op_sel:[0,1,0] op_sel_hi:[1,1,0] neg_lo:[1,0,0] neg_hi:[1,0,0]
    v_exp_f32 v136, v136
    v_exp_f32 v120, v120
    v_exp_f32 v137, v137
    v_exp_f32 v121, v121
    v_exp_f32 v138, v138
    v_exp_f32 v122, v122
    v_exp_f32 v139, v139
    v_exp_f32 v123, v123
    v_exp_f32 v140, v140
    v_exp_f32 v124, v124
    v_exp_f32 v141, v141
    v_exp_f32 v125, v125
    v_exp_f32 v142, v142
    v_exp_f32 v126, v126
    v_exp_f32 v143, v143
    v_exp_f32 v127, v127
    s_waitcnt vmcnt(0)
    s_barrier
    s_cmp_lg_u32 s3, 0
    s_cbranch_scc1 L_PC
    v_mov_b32 v85, s4
    s_mov_b32 exec_hi, 0
    s_mov_b32 exec_lo, 65535
    buffer_store_dword v85, v46, s[32:35], s17 offen sc1
    s_mov_b64 exec, -1
L_PC:
    s_xor_b32 s96, s95, 1310720
    s_add_u32 s82, s96, s90
    s_add_u32 m0, s83, 81920
    s_nop 0
    buffer_load_dwordx4 v26, s[44:47], s82 offen lds
    v_exp_f32 v144, v144
    v_exp_f32 v128, v128
    v_exp_f32 v145, v145
    v_exp_f32 v129, v129
    s_xor_b32 s96, s95, 1441792
    s_add_u32 s82, s96, s90
    s_add_u32 m0, s83, 90112
    s_nop 0
    buffer_load_dwordx4 v26, s[44:47], s82 offen lds
    v_exp_f32 v146, v146
    v_exp_f32 v130, v130
    v_exp_f32 v147, v147
    v_exp_f32 v131, v131
    s_xor_b32 s96, s95, 1572864
    s_add_u32 s82, s96, s90
    s_add_u32 m0, s83, 98304
    s_nop 0
    buffer_load_dwordx4 v26, s[44:47], s82 offen lds
    v_exp_f32 v148, v148
    v_exp_f32 v132, v132
    v_exp_f32 v149, v149
    v_exp_f32 v133, v133
    s_xor_b32 s96, s95, 1703936
    s_add_u32 s82, s96, s90
    s_add_u32 m0, s83, 106496
    s_nop 0
    buffer_load_dwordx4 v26, s[44:47], s82 offen lds
    v_exp_f32 v150, v150
    v_exp_f32 v134, v134
    v_exp_f32 v151, v151
    v_exp_f32 v135, v135
    s_lshl4_add_u32 s96, s11, s10
    s_lshl_b32 s97, s96, 14
    s_lshl_b32 s98, s3, 7
    s_add_u32 s99, s97, s98
    s_add_u32 s13, s99, 25165824
    s_add_u32 s14, s13, 8192
    s_lshl4_add_u32 s96, s11, s10
    s_lshl_b32 s97, s96, 10
    s_lshl_b32 s98, s3, 7
    s_add_u32 s99, s97, s98
    s_add_u32 s15, s99, 29360128
    s_add_u32 s17, s17, 3072
    s_load_dwordx2 s[24:25], s[32:33], s92 offset:512 glc
    s_xor_b32 s96, s95, 1835008
    s_add_u32 s82, s96, s90
    s_add_u32 m0, s83, 114688
    s_nop 0
    buffer_load_dwordx4 v26, s[44:47], s82 offen lds
    v_pk_add_f32 v[8:9], v[136:137], v[138:139]
    v_pk_add_f32 v[10:11], v[120:121], v[122:123]
    v_pk_add_f32 v[8:9], v[8:9], v[140:141]
    v_pk_add_f32 v[10:11], v[10:11], v[124:125]
    v_pk_add_f32 v[8:9], v[8:9], v[142:143]
    v_pk_add_f32 v[10:11], v[10:11], v[126:127]
    v_pk_add_f32 v[8:9], v[8:9], v[144:145]
    v_pk_add_f32 v[10:11], v[10:11], v[128:129]
    v_pk_add_f32 v[8:9], v[8:9], v[146:147]
    v_pk_add_f32 v[10:11], v[10:11], v[130:131]
    v_pk_add_f32 v[8:9], v[8:9], v[148:149]
    v_pk_add_f32 v[10:11], v[10:11], v[132:133]
    v_pk_add_f32 v[8:9], v[8:9], v[150:151]
    v_pk_add_f32 v[10:11], v[10:11], v[134:135]
    s_xor_b32 s96, s95, 1966080
    s_add_u32 s82, s96, s90
    s_add_u32 m0, s83, 122880
    s_nop 0
    buffer_load_dwordx4 v26, s[44:47], s82 offen lds
    v_add_f32 v6, v8, v9
    v_add_f32 v7, v10, v11
    v_add_f32 v4, v8, v9
    v_add_f32 v5, v10, v11
    s_nop 0
    v_permlane32_swap_b32 v4, v6
    v_permlane32_swap_b32 v5, v7
    v_pk_add_f32 v[4:5], v[4:5], v[6:7]
    v_rcp_f32 v4, v4
    v_rcp_f32 v5, v5
    s_nop 0
    v_pk_mul_f32 v[136:137], v[136:137], v[4:5] op_sel_hi:[1,0]
    v_pk_mul_f32 v[120:121], v[4:5], v[120:121] op_sel:[1,0]
    v_pk_mul_f32 v[138:139], v[138:139], v[4:5] op_sel_hi:[1,0]
    v_pk_mul_f32 v[122:123], v[4:5], v[122:123] op_sel:[1,0]
    v_pk_mul_f32 v[140:141], v[140:141], v[4:5] op_sel_hi:[1,0]
    s_add_u32 s82, s95, s90
    s_mov_b32 m0, s83
    s_nop 0
    buffer_load_dwordx4 v26, s[44:47], s82 offen lds
    v_pk_mul_f32 v[124:125], v[4:5], v[124:125] op_sel:[1,0]
    v_pk_mul_f32 v[142:143], v[142:143], v[4:5] op_sel_hi:[1,0]
    v_pk_mul_f32 v[126:127], v[4:5], v[126:127] op_sel:[1,0]
    v_pk_mul_f32 v[144:145], v[144:145], v[4:5] op_sel_hi:[1,0]
    v_pk_mul_f32 v[128:129], v[4:5], v[128:129] op_sel:[1,0]
    v_pk_mul_f32 v[146:147], v[146:147], v[4:5] op_sel_hi:[1,0]
    v_pk_mul_f32 v[130:131], v[4:5], v[130:131] op_sel:[1,0]
    v_pk_mul_f32 v[148:149], v[148:149], v[4:5] op_sel_hi:[1,0]
    v_pk_mul_f32 v[132:133], v[4:5], v[132:133] op_sel:[1,0]
    v_pk_mul_f32 v[150:151], v[150:151], v[4:5] op_sel_hi:[1,0]
    v_pk_mul_f32 v[134:135], v[4:5], v[134:135] op_sel:[1,0]
    v_cvt_pk_bf16_f32 v152, v136, v137
    v_cvt_pk_bf16_f32 v153, v138, v139
    v_cvt_pk_bf16_f32 v154, v140, v141
    s_xor_b32 s96, s95, 131072
    s_add_u32 s82, s96, s90
    s_add_u32 m0, s83, 8192
    s_nop 0
    buffer_load_dwordx4 v26, s[44:47], s82 offen lds
    v_cvt_pk_bf16_f32 v155, v142, v143
    v_cvt_pk_bf16_f32 v156, v144, v145
    v_cvt_pk_bf16_f32 v157, v146, v147
    v_cvt_pk_bf16_f32 v158, v148, v149
    v_cvt_pk_bf16_f32 v159, v150, v151
    v_cvt_pk_bf16_f32 v160, v120, v121
    v_cvt_pk_bf16_f32 v161, v122, v123
    v_cvt_pk_bf16_f32 v162, v124, v125
    v_cvt_pk_bf16_f32 v163, v126, v127
    v_cvt_pk_bf16_f32 v164, v128, v129
    v_cvt_pk_bf16_f32 v165, v130, v131
    v_cvt_pk_bf16_f32 v166, v132, v133
    v_cvt_pk_bf16_f32 v167, v134, v135
    s_branch SCHK_20
SPOLL_19:
    s_load_dwordx2 s[24:25], s[32:33], s92 offset:512 glc
SCHK_20:
    s_add_u32 s5, s5, 1
    s_cmp_ge_u32 s5, 200000
    s_waitcnt lgkmcnt(0)
    s_cbranch_scc1 SDONE_21
    s_cmp_lg_u32 s24, s4
    s_cbranch_scc1 SPOLL_19
    s_cmp_lg_u32 s25, s4
    s_cbranch_scc1 SPOLL_19
SDONE_21:
    s_barrier
    buffer_load_dwordx4 v[184:187], v47, s[32:35], s13 offen sc1
    buffer_load_dwordx4 v[188:191], v47, s[32:35], s14 offen sc1
    buffer_load_dwordx4 v[192:195], v2, s[32:35], s16 offen sc1
    s_lshl_b32 s19, s12, 7
    v_and_b32 v32, 3, v1
    v_lshl_add_u32 v32, v32, 1, s19
    v_lshrrev_b32 v28, 5, v1
    v_lshl_add_u32 v32, v28, 3, v32
    v_bfe_u32 v28, v1, 4, 1
    v_lshl_add_u32 v32, v28, 4, v32
    v_bfe_u32 v28, v1, 2, 2
    v_lshl_add_u32 v32, v28, 5, v32
    global_load_ushort v32, v32, s[78:79]
    s_lshl_b32 s96, s3, 5
    s_add_u32 s14, s96, 155648
    v_and_b32 v6, 3, v1
    v_lshl_add_u32 v6, v6, 3, s14
    v_lshrrev_b32 v9, 5, v1
    v_lshl_add_u32 v6, v9, 2, v6
    s_lshl_b32 s96, s3, 10
    s_add_u32 s14, s96, 147456
    v_and_b32 v5, 15, v1
    v_lshl_add_u32 v5, v5, 4, s14
    v_lshrrev_b32 v9, 5, v1
    v_lshl_add_u32 v5, v9, 9, v5
    v_bfe_u32 v9, v1, 4, 1
    v_lshl_add_u32 v5, v9, 3, v5
    s_lshl_b32 s96, s76, 7
    s_add_u32 s14, s96, 155648
    v_lshrrev_b32 v7, 5, v1
    v_lshl_add_u32 v7, v7, 4, s14
    s_lshl_b32 s96, s76, 12
    s_add_u32 s14, s96, 147456
    v_add_u32 v84, s14, v2
    s_cmp_lt_u32 s3, 4
    s_cbranch_scc1 L_HG1
    v_lshlrev_b32 v8, 16, v88
    v_and_b32 v9, s6, v88
    v_pk_mul_f32 v[196:197], v[36:37], v[8:9] op_sel:[0,0] op_sel_hi:[0,1]
    v_lshlrev_b32 v10, 16, v89
    v_and_b32 v11, s6, v89
    v_pk_mul_f32 v[198:199], v[36:37], v[10:11] op_sel:[0,0] op_sel_hi:[0,1]
    v_lshlrev_b32 v8, 16, v90
    v_and_b32 v9, s6, v90
    v_pk_mul_f32 v[200:201], v[36:37], v[8:9] op_sel:[0,0] op_sel_hi:[0,1]
    v_lshlrev_b32 v10, 16, v91
    v_and_b32 v11, s6, v91
    v_pk_mul_f32 v[202:203], v[36:37], v[10:11] op_sel:[0,0] op_sel_hi:[0,1]
    v_lshlrev_b32 v8, 16, v92
    v_and_b32 v9, s6, v92
    v_pk_fma_f32 v[196:197], v[36:37], v[8:9], v[196:197] op_sel:[1,0,0] op_sel_hi:[1,1,1]
    v_lshlrev_b32 v10, 16, v93
    v_and_b32 v11, s6, v93
    v_pk_fma_f32 v[198:199], v[36:37], v[10:11], v[198:199] op_sel:[1,0,0] op_sel_hi:[1,1,1]
    v_lshlrev_b32 v8, 16, v94
    v_and_b32 v9, s6, v94
    v_pk_fma_f32 v[200:201], v[36:37], v[8:9], v[200:201] op_sel:[1,0,0] op_sel_hi:[1,1,1]
    v_lshlrev_b32 v10, 16, v95
    v_and_b32 v11, s6, v95
    v_pk_fma_f32 v[202:203], v[36:37], v[10:11], v[202:203] op_sel:[1,0,0] op_sel_hi:[1,1,1]
    v_lshlrev_b32 v8, 16, v96
    v_and_b32 v9, s6, v96
    v_pk_fma_f32 v[196:197], v[38:39], v[8:9], v[196:197] op_sel:[0,0,0] op_sel_hi:[0,1,1]
    v_lshlrev_b32 v10, 16, v97
    v_and_b32 v11, s6, v97
    v_pk_fma_f32 v[198:199], v[38:39], v[10:11], v[198:199] op_sel:[0,0,0] op_sel_hi:[0,1,1]
    v_lshlrev_b32 v8, 16, v98
    v_and_b32 v9, s6, v98
    v_pk_fma_f32 v[200:201], v[38:39], v[8:9], v[200:201] op_sel:[0,0,0] op_sel_hi:[0,1,1]
    v_lshlrev_b32 v10, 16, v99
    v_and_b32 v11, s6, v99
    v_pk_fma_f32 v[202:203], v[38:39], v[10:11], v[202:203] op_sel:[0,0,0] op_sel_hi:[0,1,1]
    v_lshlrev_b32 v8, 16, v100
    v_and_b32 v9, s6, v100
    v_pk_fma_f32 v[196:197], v[38:39], v[8:9], v[196:197] op_sel:[1,0,0] op_sel_hi:[1,1,1]
    v_lshlrev_b32 v10, 16, v101
    v_and_b32 v11, s6, v101
    v_pk_fma_f32 v[198:199], v[38:39], v[10:11], v[198:199] op_sel:[1,0,0] op_sel_hi:[1,1,1]
    v_lshlrev_b32 v8, 16, v102
    v_and_b32 v9, s6, v102
    v_pk_fma_f32 v[200:201], v[38:39], v[8:9], v[200:201] op_sel:[1,0,0] op_sel_hi:[1,1,1]
    v_lshlrev_b32 v10, 16, v103
    v_and_b32 v11, s6, v103
    v_pk_fma_f32 v[202:203], v[38:39], v[10:11], v[202:203] op_sel:[1,0,0] op_sel_hi:[1,1,1]
    v_lshlrev_b32 v8, 16, v104
    v_and_b32 v9, s6, v104
    v_pk_fma_f32 v[196:197], v[40:41], v[8:9], v[196:197] op_sel:[0,0,0] op_sel_hi:[0,1,1]
    v_lshlrev_b32 v10, 16, v105
    v_and_b32 v11, s6, v105
    v_pk_fma_f32 v[198:199], v[40:41], v[10:11], v[198:199] op_sel:[0,0,0] op_sel_hi:[0,1,1]
    v_lshlrev_b32 v8, 16, v106
    v_and_b32 v9, s6, v106
    v_pk_fma_f32 v[200:201], v[40:41], v[8:9], v[200:201] op_sel:[0,0,0] op_sel_hi:[0,1,1]
    v_lshlrev_b32 v10, 16, v107
    v_and_b32 v11, s6, v107
    v_pk_fma_f32 v[202:203], v[40:41], v[10:11], v[202:203] op_sel:[0,0,0] op_sel_hi:[0,1,1]
    v_lshlrev_b32 v8, 16, v108
    v_and_b32 v9, s6, v108
    v_pk_fma_f32 v[196:197], v[40:41], v[8:9], v[196:197] op_sel:[1,0,0] op_sel_hi:[1,1,1]
    v_lshlrev_b32 v10, 16, v109
    v_and_b32 v11, s6, v109
    v_pk_fma_f32 v[198:199], v[40:41], v[10:11], v[198:199] op_sel:[1,0,0] op_sel_hi:[1,1,1]
    v_lshlrev_b32 v8, 16, v110
    v_and_b32 v9, s6, v110
    v_pk_fma_f32 v[200:201], v[40:41], v[8:9], v[200:201] op_sel:[1,0,0] op_sel_hi:[1,1,1]
    v_lshlrev_b32 v10, 16, v111
    v_and_b32 v11, s6, v111
    v_pk_fma_f32 v[202:203], v[40:41], v[10:11], v[202:203] op_sel:[1,0,0] op_sel_hi:[1,1,1]
    v_lshlrev_b32 v8, 16, v112
    v_and_b32 v9, s6, v112
    v_pk_fma_f32 v[196:197], v[42:43], v[8:9], v[196:197] op_sel:[0,0,0] op_sel_hi:[0,1,1]
    v_lshlrev_b32 v10, 16, v113
    v_and_b32 v11, s6, v113
    v_pk_fma_f32 v[198:199], v[42:43], v[10:11], v[198:199] op_sel:[0,0,0] op_sel_hi:[0,1,1]
    v_lshlrev_b32 v8, 16, v114
    v_and_b32 v9, s6, v114
    v_pk_fma_f32 v[200:201], v[42:43], v[8:9], v[200:201] op_sel:[0,0,0] op_sel_hi:[0,1,1]
    v_lshlrev_b32 v10, 16, v115
    v_and_b32 v11, s6, v115
    v_pk_fma_f32 v[202:203], v[42:43], v[10:11], v[202:203] op_sel:[0,0,0] op_sel_hi:[0,1,1]
    v_lshlrev_b32 v8, 16, v116
    v_and_b32 v9, s6, v116
    v_pk_fma_f32 v[196:197], v[42:43], v[8:9], v[196:197] op_sel:[1,0,0] op_sel_hi:[1,1,1]
    v_lshlrev_b32 v10, 16, v117
    v_and_b32 v11, s6, v117
    v_pk_fma_f32 v[198:199], v[42:43], v[10:11], v[198:199] op_sel:[1,0,0] op_sel_hi:[1,1,1]
    v_lshlrev_b32 v8, 16, v118
    v_and_b32 v9, s6, v118
    v_pk_fma_f32 v[200:201], v[42:43], v[8:9], v[200:201] op_sel:[1,0,0] op_sel_hi:[1,1,1]
    v_lshlrev_b32 v10, 16, v119
    v_and_b32 v11, s6, v119
    v_pk_fma_f32 v[202:203], v[42:43], v[10:11], v[202:203] op_sel:[1,0,0] op_sel_hi:[1,1,1]
    v_permlane32_swap_b32 v196, v200
    v_permlane32_swap_b32 v197, v201
    v_permlane32_swap_b32 v198, v202
    v_permlane32_swap_b32 v199, v203
    v_add_f32 v196, v196, v200
    v_add_f32 v197, v197, v201
    v_add_f32 v198, v198, v202
    v_add_f32 v199, v199, v203
    s_nop 0
    v_permlane16_swap_b32 v196, v198
    v_permlane16_swap_b32 v197, v199
    v_add_f32 v196, v196, v198
    v_add_f32 v197, v197, v199
    s_nop 0
    v_add_f32_dpp v196, v196, v196 row_ror:8 row_mask:0xf bank_mask:0xf
    v_add_f32_dpp v197, v197, v197 row_ror:8 row_mask:0xf bank_mask:0xf
    s_nop 1
    v_mov_b32_dpp v196, v197 quad_perm:[0,1,2,3] row_mask:0xf bank_mask:0xc
    ds_write_b32 v252, v196 offset:9984
L_HG1:
    s_waitcnt vmcnt(2)
    v_pk_add_f32 v[184:185], v[184:185], v[188:189]
    v_pk_add_f32 v[186:187], v[186:187], v[190:191]
    s_nop 1
    v_permlane32_swap_b32 v184, v186
    v_permlane32_swap_b32 v185, v187
    v_pk_add_f32 v[184:185], v[184:185], v[186:187]
    s_nop 1
    v_add_f32_dpp v184, v184, v184 row_ror:8 row_mask:0xf bank_mask:0xf
    v_add_f32_dpp v185, v185, v185 row_ror:8 row_mask:0xf bank_mask:0xf
    v_mov_b32 v186, v184
    v_mov_b32 v187, v185
    s_nop 0
    v_permlane16_swap_b32 v184, v186
    v_permlane16_swap_b32 v185, v187
    v_pk_add_f32 v[184:185], v[184:185], v[186:187]
    v_cvt_pk_bf16_f32 v184, v184, v185
    v_mov_b32 v185, s4
    s_mov_b32 exec_lo, 0xff
    s_mov_b32 exec_hi, 0xff
    buffer_store_dwordx2 v[184:185], v48, s[32:35], s15 offen sc1
    s_mov_b64 exec, -1
    s_waitcnt lgkmcnt(0)
    s_barrier
    s_cmp_lg_u32 s3, 0
    s_cbranch_scc1 L_PC2
    v_mov_b32 v85, s4
    s_mov_b32 exec_hi, 0
    s_mov_b32 exec_lo, 65535
    buffer_store_dword v85, v46, s[32:35], s17 offen sc1
    s_mov_b64 exec, -1
L_PC2:
L_PAD7:
    s_cbranch_execz L_RET7
    s_cmp_lg_u32 s3, 3
    s_cbranch_scc1 L_M2F
    ds_read_b128 v[196:199], v251 offset:11008
    s_lshr_b32 s96, s8, 2
    s_lshl1_add_u32 s97, s9, s96
    s_and_b32 s98, s8, 3
    s_lshl2_add_u32 s99, s97, s98
    s_lshl_b32 s96, s99, 9
    s_add_u32 s18, s96, 131072
    s_waitcnt lgkmcnt(0)
    v_add_f32 v196, v196, v197
    v_add_f32 v198, v198, v199
    v_mov_b32 v197, s4
    v_add_f32 v196, v196, v198
    buffer_store_dwordx2 v[196:197], v250, s[32:35], s18 offen sc1
L_M2F:
    s_waitcnt vmcnt(2)
    s_xor_b32 s96, s95, 262144
    s_add_u32 s82, s96, s90
    s_add_u32 m0, s83, 16384
    s_nop 0
    buffer_load_dwordx4 v26, s[44:47], s82 offen lds
    v_permlane32_swap_b32 v192, v194
    v_permlane32_swap_b32 v193, v195
    v_pk_add_f32 v[192:193], v[192:193], v[194:195]
    s_nop 1
    v_add_f32_dpp v192, v192, v192 row_ror:4 row_mask:0xf bank_mask:0xf
    s_xor_b32 s96, s95, 393216
    s_add_u32 s82, s96, s90
    s_add_u32 m0, s83, 24576
    s_nop 0
    buffer_load_dwordx4 v26, s[44:47], s82 offen lds
    v_add_f32_dpp v193, v193, v193 row_ror:4 row_mask:0xf bank_mask:0xf
    v_add_f32_dpp v192, v192, v192 row_ror:8 row_mask:0xf bank_mask:0xf
    s_nop 0
    v_add_f32_dpp v193, v193, v193 row_ror:8 row_mask:0xf bank_mask:0xf
    s_xor_b32 s96, s95, 524288
    s_add_u32 s82, s96, s90
    s_add_u32 m0, s83, 32768
    s_nop 0
    buffer_load_dwordx4 v26, s[44:47], s82 offen lds
    v_mov_b32 v194, v192
    v_mov_b32 v195, v193
    s_nop 0
    v_permlane16_swap_b32 v192, v194
    s_xor_b32 s96, s95, 655360
    s_add_u32 s82, s96, s90
    s_add_u32 m0, s83, 40960
    s_nop 0
    buffer_load_dwordx4 v26, s[44:47], s82 offen lds
    v_permlane16_swap_b32 v193, v195
    v_pk_add_f32 v[192:193], v[192:193], v[194:195]
    v_cvt_pk_bf16_f32 v192, v192, v193
    ds_write_b32 v6, v192
    s_waitcnt lgkmcnt(0)
    s_barrier
    ds_read_b128 v[196:199], v7
    ds_read_b128 v[200:203], v7 offset:32
    ds_read_b128 v[204:207], v7 offset:64
    ds_read_b128 v[208:211], v7 offset:96
    s_lshr_b32 s96, s8, 2
    s_lshl1_add_u32 s97, s9, s96
    s_and_b32 s98, s8, 3
    s_lshl2_add_u32 s99, s97, s98
    s_lshl_b32 s96, s99, 9
    s_add_u32 s18, s96, 131072
    s_waitcnt lgkmcnt(0)
    s_lshl3_add_u32 s96, s11, s3
    s_lshl_b32 s97, s96, 11
    s_add_u32 s13, s97, 29360128
    s_load_dwordx2 s[24:25], s[32:33], s92 offset:3584 glc
    v_mfma_f32_32x32x16_bf16 v[136:151], v[196:199], v[152:155], 0
    v_mfma_f32_32x32x16_bf16 v[136:151], v[200:203], v[156:159], v[136:151]
    v_mfma_f32_32x32x16_bf16 v[136:151], v[204:207], v[160:163], v[136:151]
    v_mfma_f32_32x32x16_bf16 v[136:151], v[208:211], v[164:167], v[136:151]
    s_lshr_b32 s96, s3, 2
    s_lshl_b32 s97, s96, 15
    s_and_b32 s98, s3, 3
    s_lshl_b32 s99, s98, 5
    s_add_u32 s19, s97, s99
    v_lshrrev_b32 v34, 4, v1
    v_lshlrev_b32 v34, 13, v34
    v_bfe_u32 v9, v1, 2, 2
    v_lshl_add_u32 v34, v9, 7, v34
    v_bfe_u32 v9, v1, 3, 2
    v_lshl_add_u32 v34, v9, 5, v34
    v_and_b32 v9, 3, v1
    v_lshl_add_u32 v34, v9, 3, v34
    v_xor_b32 v34, s19, v34
    s_lshl_b32 s96, s75, 11
    s_add_u32 s19, s96, 13631488
    v_and_b32 v52, 7, v1
    v_lshl_add_u32 v52, v52, 4, s19
    v_lshrrev_b32 v9, 4, v1
    v_lshl_add_u32 v52, v9, 9, v52
    v_and_b32 v53, 15, v1
    v_lshlrev_b32 v53, 9, v53
    v_add_u32 v53, 13631744, v53
    s_lshl_b32 s96, s74, 13
    s_add_u32 s72, s96, 20971520
    s_lshl3_add_u32 s96, s75, s3
    s_lshl_b32 s97, s96, 8
    s_add_u32 s73, s97, s72
    s_lshl3_add_u32 s96, s21, s3
    s_lshl4_add_u32 s97, s96, s12
    s_lshl_b32 s98, s97, 8
    s_add_u32 s86, s98, 12582912
    s_and_b32 s96, s12, 1
    s_lshr_b32 s97, s21, 2
    s_and_b32 s98, s21, 3
    s_lshl_b32 s99, s98, 6
    s_lshl1_add_u32 s98, s97, s99
    s_lshl_b32 s97, s98, 12
    s_lshr_b32 s99, s12, 1
    s_lshl_b32 s98, s99, 6
    s_add_u32 s99, s97, s98
    s_lshl2_add_u32 s97, s96, s99
    s_add_u32 s98, s97, 1048576
    s_add_u32 s87, s98, 1536
    s_lshl3_add_u32 s96, s21, s3
    s_lshl_b32 s97, s96, 15
    s_lshl_b32 s98, s12, 7
    s_add_u32 s70, s97, s98
    s_add_u32 s71, s70, 16384
    v_cvt_pk_bf16_f32 v136, 0, v136
    v_add_f32 v136, 0x358637bd, v136
    v_cvt_pk_bf16_f32 v136, 0, v136
    v_rcp_f32 v136, v136
    s_branch SCHK_23
SPOLL_22:
    s_load_dwordx2 s[24:25], s[32:33], s92 offset:3584 glc
SCHK_23:
    s_add_u32 s5, s5, 1
    s_cmp_ge_u32 s5, 200000
    s_waitcnt lgkmcnt(0)
    s_cbranch_scc1 SDONE_24
    s_cmp_lg_u32 s24, s4
    s_cbranch_scc1 SPOLL_22
    s_cmp_lg_u32 s25, s4
    s_cbranch_scc1 SPOLL_22
SDONE_24:
    buffer_load_dwordx4 v[228:231], v2, s[32:35], s13 offen sc1
    buffer_load_dwordx4 v[232:235], v2, s[32:35], s13 offen offset:1024 sc1
    s_lshl_b32 s19, s3, 6
    v_bfe_u32 v35, v1, 2, 1
    v_lshlrev_b32 v35, 9, v35
    v_bfe_u32 v9, v1, 3, 1
    v_lshl_add_u32 v35, v9, 12, v35
    v_lshrrev_b32 v9, 5, v1
    v_lshl_add_u32 v35, v9, 11, v35
    v_bfe_u32 v9, v1, 2, 2
    v_lshl_add_u32 v35, v9, 6, v35
    v_bfe_u32 v9, v1, 4, 1
    v_lshl_add_u32 v35, v9, 5, v35
    v_and_b32 v9, 3, v1
    v_lshl_add_u32 v35, v9, 3, v35
    v_xor_b32 v35, s19, v35
    v_add_u32 v35, 65536, v35
    s_waitcnt vmcnt(0)
    v_bitop3_b32 v4, v229, v231, s4 bitop3:0x7e
    v_bitop3_b32 v4, v4, v233, s4 bitop3:0xf6
    v_bitop3_b32 v4, v4, v235, s4 bitop3:0xf6
    v_cmp_ne_u32 vcc, 0, v4
    s_cbranch_vccz TOK_26
POLL_27:
    buffer_load_dwordx4 v[228:231], v2, s[32:35], s13 offen sc1
    buffer_load_dwordx4 v[232:235], v2, s[32:35], s13 offen offset:1024 sc1
    s_waitcnt vmcnt(0)
    v_bitop3_b32 v4, v229, v231, s4 bitop3:0x7e
    v_bitop3_b32 v4, v4, v233, s4 bitop3:0xf6
    v_bitop3_b32 v4, v4, v235, s4 bitop3:0xf6
    v_cmp_ne_u32 vcc, 0, v4
    s_cbranch_vccz PDONE_28
    s_add_u32 s5, s5, 1
    s_cmp_lt_u32 s5, 200000
    s_cbranch_scc1 POLL_27
PDONE_28:
TOK_26:
    ds_write2_b32 v5, v228, v230 offset0:0 offset1:1
    ds_write2_b32 v5, v232, v234 offset0:64 offset1:65
    s_waitcnt lgkmcnt(0)
    s_barrier
    ds_read_b128 v[212:215], v84
    ds_read_b128 v[216:219], v84 offset:1024
    ds_read_b128 v[220:223], v84 offset:2048
    ds_read_b128 v[224:227], v84 offset:3072
    s_lshl_b32 s96, s77, 1
    s_lshl3_add_u32 s97, s10, s96
    s_lshl_b32 s98, s97, 5
    s_lshl1_add_u32 s99, s11, s98
    s_add_u32 s96, s99, s76
    s_lshl_b32 s97, s96, 10
    s_add_u32 s13, s97, 8388608
    v_and_b32 v47, 15, v1
    v_lshlrev_b32 v47, 4, v47
    v_bfe_u32 v9, v1, 4, 1
    v_lshl_add_u32 v47, v9, 15, v47
    v_lshrrev_b32 v9, 5, v1
    v_lshl_add_u32 v47, v9, 8, v47
    s_waitcnt lgkmcnt(3)
    v_mfma_f32_32x32x16_bf16 v[120:135], v[212:215], v[152:155], 0
    s_waitcnt lgkmcnt(2)
    v_mfma_f32_32x32x16_bf16 v[120:135], v[216:219], v[156:159], v[120:135]
    s_waitcnt lgkmcnt(1)
    v_mfma_f32_32x32x16_bf16 v[120:135], v[220:223], v[160:163], v[120:135]
    s_waitcnt lgkmcnt(0)
    v_mfma_f32_32x32x16_bf16 v[120:135], v[224:227], v[164:167], v[120:135]
    s_lshr_b32 s96, s3, 1
    s_lshl4_add_u32 s97, s96, s12
    s_lshl_b32 s98, s97, 11
    s_and_b32 s99, s3, 1
    s_lshl_b32 s96, s99, 10
    s_add_u32 s97, s98, s96
    s_add_u32 s18, s97, 131072
    buffer_load_dwordx4 v[28:31], v2, s[32:35], s18 offen sc1
    s_nop 3
    v_cvt_pk_bf16_f32 v120, 0, v120
    v_cvt_pk_bf16_f32 v121, 0, v121
    v_cvt_pk_bf16_f32 v122, 0, v122
    v_cvt_pk_bf16_f32 v123, 0, v123
    v_cvt_pk_bf16_f32 v124, 0, v124
    v_cvt_pk_bf16_f32 v125, 0, v125
    v_cvt_pk_bf16_f32 v126, 0, v126
    v_cvt_pk_bf16_f32 v127, 0, v127
    v_pk_mul_f32 v[120:121], v[120:121], v[136:137] op_sel_hi:[1,0]
    v_pk_mul_f32 v[122:123], v[122:123], v[136:137] op_sel_hi:[1,0]
    v_pk_mul_f32 v[124:125], v[124:125], v[136:137] op_sel_hi:[1,0]
    v_pk_mul_f32 v[126:127], v[126:127], v[136:137] op_sel_hi:[1,0]
    v_cvt_pk_bf16_f32 v168, v120, v121
    v_cvt_pk_bf16_f32 v169, v122, v123
    v_cvt_pk_bf16_f32 v170, v124, v125
    v_cvt_pk_bf16_f32 v171, v126, v127
    buffer_store_dwordx4 v[168:171], v47, s[32:35], s13 offen sc1
    v_cvt_pk_bf16_f32 v128, 0, v128
    v_cvt_pk_bf16_f32 v129, 0, v129
    v_cvt_pk_bf16_f32 v130, 0, v130
    v_cvt_pk_bf16_f32 v131, 0, v131
    v_cvt_pk_bf16_f32 v132, 0, v132
    v_cvt_pk_bf16_f32 v133, 0, v133
    v_cvt_pk_bf16_f32 v134, 0, v134
    v_cvt_pk_bf16_f32 v135, 0, v135
    v_pk_mul_f32 v[128:129], v[128:129], v[136:137] op_sel_hi:[1,0]
    v_pk_mul_f32 v[130:131], v[130:131], v[136:137] op_sel_hi:[1,0]
    v_pk_mul_f32 v[132:133], v[132:133], v[136:137] op_sel_hi:[1,0]
    v_pk_mul_f32 v[134:135], v[134:135], v[136:137] op_sel_hi:[1,0]
    v_cvt_pk_bf16_f32 v172, v128, v129
    v_cvt_pk_bf16_f32 v173, v130, v131
    v_cvt_pk_bf16_f32 v174, v132, v133
    v_cvt_pk_bf16_f32 v175, v134, v135
    buffer_store_dwordx4 v[172:175], v47, s[32:35], s13 offen offset:512 sc1
    v_bfe_u32 v36, v1, 2, 2
    v_lshlrev_b32 v36, 7, v36
    v_lshrrev_b32 v9, 4, v1
    v_lshl_add_u32 v36, v9, 10, v36
    v_and_b32 v9, 1, v1
    v_lshl_add_u32 v36, v9, 4, v36
    v_bfe_u32 v9, v1, 1, 1
    v_lshl_add_u32 v36, v9, 3, v36
    v_bfe_u32 v9, v1, 3, 2
    v_lshl_add_u32 v36, v9, 5, v36
    s_and_b32 s96, s9, 1
    s_lshl_b32 s97, s96, 2
    s_xor_b32 s98, s3, s97
    s_lshl_b32 s17, s98, 12
    s_lshl_b32 s96, s17, 2
    s_lshr_b32 s97, s95, 4
    s_xor_b32 s14, s96, s97
    v_add_u32 v36, s14, v36
    v_xor_b32 v37, 32, v36
    v_xor_b32 v38, 64, v36
    v_xor_b32 v39, 96, v36
    v_and_b32 v5, 7, v1
    v_lshlrev_b32 v5, 15, v5
    v_bfe_u32 v9, v1, 3, 1
    v_lshl_add_u32 v5, v9, 12, v5
    s_and_b32 s96, s11, 1
    s_lshr_b32 s97, s10, 2
    s_and_b32 s98, s10, 3
    s_lshl_b32 s99, s98, 6
    s_lshl1_add_u32 s98, s97, s99
    s_lshl_b32 s97, s98, 12
    s_lshr_b32 s99, s11, 1
    s_lshl_b32 s98, s99, 6
    s_add_u32 s99, s97, s98
    s_lshl2_add_u32 s97, s96, s99
    s_add_u32 s98, s97, 1048576
    s_add_u32 s15, s98, 1024
    v_lshlrev_b32 v152, 16, v12
    v_and_b32 v153, s6, v12
    v_lshlrev_b32 v154, 16, v13
    v_and_b32 v155, s6, v13
    v_lshlrev_b32 v156, 16, v14
    v_and_b32 v157, s6, v14
    v_lshlrev_b32 v158, 16, v15
    v_and_b32 v159, s6, v15
    v_lshlrev_b32 v160, 16, v16
    v_and_b32 v161, s6, v16
    v_lshlrev_b32 v162, 16, v17
    v_and_b32 v163, s6, v17
    v_lshlrev_b32 v164, 16, v18
    v_and_b32 v165, s6, v18
    v_lshlrev_b32 v166, 16, v19
    v_and_b32 v167, s6, v19
    s_lshl3_add_u32 s96, s21, s3
    s_lshl_b32 s97, s96, 15
    s_add_u32 s19, s97, 8388608
    s_and_b32 s96, s3, 1
    s_lshl_b32 s14, s96, 1
    s_lshr_b32 s96, s3, 1
    s_lshl_b32 s97, s96, 10
    s_add_u32 s16, s97, 159744
    v_bfe_u32 v4, v1, 4, 1
    v_bfe_u32 v9, v1, 2, 1
    v_lshl_add_u32 v4, v9, 1, v4
    v_lshrrev_b32 v7, 5, v1
    v_lshl_add_u32 v7, v7, 0, s14
    v_xor_b32 v4, v4, v7
    v_lshl_add_u32 v4, v4, 2, s16
    v_and_b32 v7, 1, v1
    v_lshlrev_b32 v7, 5, v7
    v_bfe_u32 v9, v1, 3, 2
    v_lshl_add_u32 v7, v9, 6, v7
    v_bfe_u32 v9, v1, 2, 1
    v_lshl_add_u32 v7, v9, 8, v7
    v_bfe_u32 v9, v1, 1, 1
    v_lshl_add_u32 v7, v9, 9, v7
    v_add_u32 v4, v4, v7
    s_waitcnt vmcnt(2)
    v_bitop3_b32 v6, v29, v31, s4 bitop3:0x7e
    v_cmp_ne_u32 vcc, 0, v6
    s_cbranch_vccz L_MGOK
POLL_29:
    buffer_load_dwordx4 v[28:31], v2, s[32:35], s18 offen sc1
    s_waitcnt vmcnt(0)
    v_bitop3_b32 v6, v29, v31, s4 bitop3:0x7e
    v_cmp_ne_u32 vcc, 0, v6
    s_cbranch_vccz PDONE_30
    s_add_u32 s5, s5, 1
    s_cmp_lt_u32 s5, 200000
    s_cbranch_scc1 POLL_29
PDONE_30:
L_MGOK:
    ds_write2_b32 v4, v28, v30 offset0:0 offset1:4
    s_waitcnt vmcnt(0)
    s_waitcnt lgkmcnt(0)
    s_barrier
    s_cmp_lg_u32 s3, 0
    s_cbranch_scc1 L_PD
    v_mov_b32 v6, s4
    s_mov_b32 exec_hi, 0
    s_mov_b32 exec_lo, 65535
    buffer_store_dword v6, v5, s[32:35], s15 offen sc1
    s_mov_b64 exec, -1
L_PD:
    v_mov_b32 v236, -1
    v_mov_b32 v237, -1
    v_mov_b32 v238, -1
    v_mov_b32 v239, -1
    s_mov_b64 exec, 0xffff
    buffer_store_dwordx4 v[236:239], v2, s[32:35], s86 offen sc1
    s_mov_b64 exec, -1
    s_cmp_lg_u32 s3, 5
    s_cbranch_scc1 L_NOPO
    s_lshl_b32 s96, s21, 14
    s_lshl_b32 s97, s12, 9
    s_add_u32 s98, s96, s97
    s_add_u32 s16, s98, 13631488
    v_and_b32 v240, 31, v1
    v_lshlrev_b32 v240, 4, v240
    v_lshrrev_b32 v241, 5, v1
    v_lshl_add_u32 v240, v241, 13, v240
    buffer_store_dwordx4 v[236:239], v240, s[32:35], s16 offen sc1
L_NOPO:
    s_lshl_b32 s96, s2, 12
    s_lshr_b32 s97, s17, 6
    s_add_u32 s98, s96, s97
    s_add_u32 s99, s98, 1048576
    s_add_u32 s18, s99, 1024
    ds_read_b128 v[192:195], v251 offset:12288
    ds_read_b128 v[196:199], v251 offset:13312
    ds_read_b128 v[200:203], v251 offset:14336
    ds_read_b128 v[204:207], v251 offset:15360
    v_and_b32 v8, 3, v1
    v_lshlrev_b32 v8, 2, v8
    v_lshrrev_b32 v9, 5, v1
    v_lshl_add_u32 v8, v9, 4, v8
    v_bfe_u32 v9, v1, 4, 1
    v_lshl_add_u32 v8, v9, 5, v8
    v_bfe_u32 v9, v1, 2, 2
    v_lshl_add_u32 v8, v9, 6, v8
    v_add_u32 v8, 157184, v8
    s_lshl4_add_u32 s96, s21, s12
    s_lshl_b32 s97, s96, 6
    s_add_u32 s13, s97, 14155776
    v_lshlrev_b32 v10, 1, v1
    v_add_u32 v10, 157440, v10
    v_and_b32 v11, 3, v1
    v_lshlrev_b32 v11, 7, v11
    v_lshrrev_b32 v9, 4, v1
    v_lshl_add_u32 v11, v9, 5, v11
    v_add_u32 v11, 157440, v11
    s_waitcnt lgkmcnt(0)
    s_load_dwordx2 s[24:25], s[32:33], s18 offset:0 glc
    v_pk_add_f32 v[192:193], v[192:193], v[194:195]
    v_add_f32 v28, v192, v193
    v_pk_add_f32 v[196:197], v[196:197], v[198:199]
    v_add_f32 v29, v196, v197
    v_pk_add_f32 v[200:201], v[200:201], v[202:203]
    v_add_f32 v30, v200, v201
    v_pk_add_f32 v[204:205], v[204:205], v[206:207]
    v_add_f32 v31, v204, v205
    v_cvt_pk_bf16_f32 v28, 0, v28
    v_cvt_pk_bf16_f32 v29, 0, v29
    v_cvt_pk_bf16_f32 v30, 0, v30
    v_cvt_pk_bf16_f32 v31, 0, v31
    v_add_f32 v30, 1.0, v30
    v_lshlrev_b32 v32, 16, v32
    v_cvt_pk_bf16_f32 v30, 0, v30
    ds_write_b32 v8, v31
    v_mul_f32 v192, v30, v32
    v_cvt_pk_bf16_f32 v193, 0, v192
    v_sub_f32 v194, v192, v193
    v_add_f32_dpp v192, v192, v192 quad_perm:[1,0,3,2] row_mask:0xf bank_mask:0xf
    s_nop 1
    v_add_f32_dpp v192, v192, v192 quad_perm:[2,3,0,1] row_mask:0xf bank_mask:0xf
    s_nop 1
    v_add_f32_dpp v192, v192, v192 row_half_mirror row_mask:0xf bank_mask:0xf
    s_nop 1
    v_add_f32_dpp v192, v192, v192 row_ror:8 row_mask:0xf bank_mask:0xf
    v_mov_b32 v199, v192
    s_nop 1
    v_permlane16_swap_b32 v192, v199
    v_add_f32 v192, v192, v199
    v_mov_b32 v199, v192
    s_nop 1
    v_permlane32_swap_b32 v192, v199
    v_add_f32 v192, v192, v199
    v_mov_b32_dpp v196, v193 row_shl:1 row_mask:0xf bank_mask:0xf
    v_mov_b32_dpp v197, v194 row_shl:1 row_mask:0xf bank_mask:0xf
    v_mov_b32_dpp v198, v32 row_shl:1 row_mask:0xf bank_mask:0xf
    v_cvt_pk_bf16_f32 v196, v193, v196
    v_cvt_pk_bf16_f32 v197, v194, v197
    v_cvt_pk_bf16_f32 v198, v32, v198
    v_mov_b32 v193, s4
    v_mov_b32 v194, 0
    s_cmp_lg_u32 s3, 2
    s_cbranch_scc1 L_NOUP
    s_mov_b64 exec, 1
    buffer_store_dwordx2 v[192:193], v194, s[32:35], s13 offen sc1
    s_mov_b64 exec, -1
L_NOUP:
    v_mov_b32 v199, 0x3f803f80
    s_mov_b32 exec_lo, 0x55555555
    s_mov_b32 exec_hi, 0x55555555
    ds_write_b32 v10, v199 offset:0
    ds_write_b32 v10, v196 offset:128
    ds_write_b32 v10, v197 offset:256
    ds_write_b32 v10, v198 offset:384
    s_mov_b64 exec, -1
    ds_read_b128 v[184:187], v11
    ds_read_b128 v[188:191], v11 offset:16
    v_mov_b32 v42, v29
    v_mov_b32 v43, v31
    v_mov_b32 v33, v30
    v_mov_b32_dpp v136, v28 row_newbcast:0 row_mask:0xf bank_mask:0xf
    v_mov_b32_dpp v137, v28 row_newbcast:1 row_mask:0xf bank_mask:0xf
    v_mov_b32_dpp v138, v28 row_newbcast:2 row_mask:0xf bank_mask:0xf
    v_mov_b32_dpp v139, v28 row_newbcast:3 row_mask:0xf bank_mask:0xf
    v_mov_b32_dpp v140, v28 row_newbcast:4 row_mask:0xf bank_mask:0xf
    v_mov_b32_dpp v141, v28 row_newbcast:5 row_mask:0xf bank_mask:0xf
    v_mov_b32_dpp v142, v28 row_newbcast:6 row_mask:0xf bank_mask:0xf
    v_mov_b32_dpp v143, v28 row_newbcast:7 row_mask:0xf bank_mask:0xf
    v_mov_b32_dpp v144, v28 row_newbcast:8 row_mask:0xf bank_mask:0xf
    v_mov_b32_dpp v145, v28 row_newbcast:9 row_mask:0xf bank_mask:0xf
    v_mov_b32_dpp v146, v28 row_newbcast:10 row_mask:0xf bank_mask:0xf
    v_mov_b32_dpp v147, v28 row_newbcast:11 row_mask:0xf bank_mask:0xf
    v_mov_b32_dpp v148, v28 row_newbcast:12 row_mask:0xf bank_mask:0xf
    v_mov_b32_dpp v149, v28 row_newbcast:13 row_mask:0xf bank_mask:0xf
    v_mov_b32_dpp v150, v28 row_newbcast:14 row_mask:0xf bank_mask:0xf
    v_mov_b32_dpp v151, v28 row_newbcast:15 row_mask:0xf bank_mask:0xf
    v_mov_b32 v29, v5
    s_branch SCHK_32
SPOLL_31:
    s_load_dwordx2 s[24:25], s[32:33], s18 offset:0 glc
SCHK_32:
    s_add_u32 s5, s5, 1
    s_cmp_ge_u32 s5, 200000
    s_waitcnt lgkmcnt(0)
    s_cbranch_scc1 SDONE_33
    s_cmp_lg_u32 s24, s4
    s_cbranch_scc1 SPOLL_31
    s_cmp_lg_u32 s25, s4
    s_cbranch_scc1 SPOLL_31
SDONE_33:
    s_add_u32 s20, s17, s19
    buffer_load_dwordx4 v[224:227], v2, s[32:35], s20 offen sc1
    ds_read_b64_tr_b16 v[192:193], v36
    ds_read_b64_tr_b16 v[194:195], v36 offset:512
    ds_read_b64_tr_b16 v[196:197], v37
    ds_read_b64_tr_b16 v[198:199], v37 offset:512
    ds_read_b64_tr_b16 v[200:201], v38
    ds_read_b64_tr_b16 v[202:203], v38 offset:512
    ds_read_b64_tr_b16 v[204:205], v39
    ds_read_b64_tr_b16 v[206:207], v39 offset:512
    ds_read_b64_tr_b16 v[208:209], v36 offset:4096
    ds_read_b64_tr_b16 v[210:211], v36 offset:4608
    ds_read_b64_tr_b16 v[212:213], v37 offset:4096
    ds_read_b64_tr_b16 v[214:215], v37 offset:4608
    ds_read_b64_tr_b16 v[216:217], v38 offset:4096
    ds_read_b64_tr_b16 v[218:219], v38 offset:4608
    buffer_load_dwordx4 v[228:231], v2, s[32:35], s20 offen offset:1024 sc1
    buffer_load_dwordx4 v[232:235], v2, s[32:35], s20 offen offset:2048 sc1
    buffer_load_dwordx4 v[236:239], v2, s[32:35], s20 offen offset:3072 sc1
    s_barrier
    s_xor_b32 s96, s17, 4096
    s_add_u32 s20, s96, s19
    buffer_load_dwordx4 v[240:243], v2, s[32:35], s20 offen sc1
    buffer_load_dwordx4 v[244:247], v2, s[32:35], s20 offen offset:1024 sc1
    buffer_load_dwordx4 v[44:47], v2, s[32:35], s20 offen offset:2048 sc1
    buffer_load_dwordx4 v[48:51], v2, s[32:35], s20 offen offset:3072 sc1
    s_lshl_b32 s96, s21, 10
    s_add_u32 s13, s96, 14155776
    v_and_b32 v10, 15, v1
    v_lshlrev_b32 v10, 6, v10
    s_cmp_lt_u32 s3, 4
    s_cbranch_scc1 L_G2P0
    s_setprio 1
L_G2P0:
    s_waitcnt vmcnt(7)
    s_waitcnt lgkmcnt(6)
    v_mfma_f32_16x16x32_bf16 v[120:123], v[192:195], v[224:227], 0
    ds_read_b64_tr_b16 v[220:221], v39 offset:4096
    ds_read_b64_tr_b16 v[222:223], v39 offset:4608
    v_mfma_f32_16x16x32_bf16 v[124:127], v[196:199], v[224:227], 0
    ds_read_b64_tr_b16 v[192:193], v36 offset:8192
    ds_read_b64_tr_b16 v[194:195], v36 offset:8704
    v_mfma_f32_16x16x32_bf16 v[128:131], v[200:203], v[224:227], 0
    ds_read_b64_tr_b16 v[196:197], v37 offset:8192
    ds_read_b64_tr_b16 v[198:199], v37 offset:8704
    v_mfma_f32_16x16x32_bf16 v[132:135], v[204:207], v[224:227], 0
    ds_read_b64_tr_b16 v[200:201], v38 offset:8192
    ds_read_b64_tr_b16 v[202:203], v38 offset:8704
    s_xor_b32 s96, s17, 8192
    s_add_u32 s20, s96, s19
    buffer_load_dwordx4 v[224:227], v2, s[32:35], s20 offen sc1
    s_waitcnt vmcnt(7)
    s_waitcnt lgkmcnt(6)
    v_mfma_f32_16x16x32_bf16 v[120:123], v[208:211], v[228:231], v[120:123]
    ds_read_b64_tr_b16 v[204:205], v39 offset:8192
    ds_read_b64_tr_b16 v[206:207], v39 offset:8704
    v_mfma_f32_16x16x32_bf16 v[124:127], v[212:215], v[228:231], v[124:127]
    ds_read_b64_tr_b16 v[208:209], v36 offset:12288
    ds_read_b64_tr_b16 v[210:211], v36 offset:12800
    v_xor_b32 v36, 16384, v36
    v_mfma_f32_16x16x32_bf16 v[128:131], v[216:219], v[228:231], v[128:131]
    ds_read_b64_tr_b16 v[212:213], v37 offset:12288
    ds_read_b64_tr_b16 v[214:215], v37 offset:12800
    v_xor_b32 v37, 16384, v37
    v_mfma_f32_16x16x32_bf16 v[132:135], v[220:223], v[228:231], v[132:135]
    ds_read_b64_tr_b16 v[216:217], v38 offset:12288
    ds_read_b64_tr_b16 v[218:219], v38 offset:12800
    v_xor_b32 v38, 16384, v38
    buffer_load_dwordx4 v[228:231], v2, s[32:35], s20 offen offset:1024 sc1
    s_waitcnt vmcnt(7)
    s_waitcnt lgkmcnt(6)
    v_mfma_f32_16x16x32_bf16 v[120:123], v[192:195], v[232:235], v[120:123]
    ds_read_b64_tr_b16 v[220:221], v39 offset:12288
    ds_read_b64_tr_b16 v[222:223], v39 offset:12800
    v_xor_b32 v39, 16384, v39
    v_mfma_f32_16x16x32_bf16 v[124:127], v[196:199], v[232:235], v[124:127]
    ds_read_b64_tr_b16 v[192:193], v36
    ds_read_b64_tr_b16 v[194:195], v36 offset:512
    v_mfma_f32_16x16x32_bf16 v[128:131], v[200:203], v[232:235], v[128:131]
    ds_read_b64_tr_b16 v[196:197], v37
    ds_read_b64_tr_b16 v[198:199], v37 offset:512
    v_mfma_f32_16x16x32_bf16 v[132:135], v[204:207], v[232:235], v[132:135]
    ds_read_b64_tr_b16 v[200:201], v38
    ds_read_b64_tr_b16 v[202:203], v38 offset:512
    buffer_load_dwordx4 v[232:235], v2, s[32:35], s20 offen offset:2048 sc1
    s_waitcnt vmcnt(7)
    s_waitcnt lgkmcnt(6)
    v_mfma_f32_16x16x32_bf16 v[120:123], v[208:211], v[236:239], v[120:123]
    ds_read_b64_tr_b16 v[204:205], v39
    ds_read_b64_tr_b16 v[206:207], v39 offset:512
    v_mfma_f32_16x16x32_bf16 v[124:127], v[212:215], v[236:239], v[124:127]
    ds_read_b64_tr_b16 v[208:209], v36 offset:4096
    ds_read_b64_tr_b16 v[210:211], v36 offset:4608
    v_mfma_f32_16x16x32_bf16 v[128:131], v[216:219], v[236:239], v[128:131]
    ds_read_b64_tr_b16 v[212:213], v37 offset:4096
    ds_read_b64_tr_b16 v[214:215], v37 offset:4608
    v_mfma_f32_16x16x32_bf16 v[132:135], v[220:223], v[236:239], v[132:135]
    ds_read_b64_tr_b16 v[216:217], v38 offset:4096
    ds_read_b64_tr_b16 v[218:219], v38 offset:4608
    buffer_load_dwordx4 v[236:239], v2, s[32:35], s20 offen offset:3072 sc1
    s_waitcnt vmcnt(7)
    s_waitcnt lgkmcnt(6)
    v_mfma_f32_16x16x32_bf16 v[120:123], v[192:195], v[240:243], v[120:123]
    ds_read_b64_tr_b16 v[220:221], v39 offset:4096
    ds_read_b64_tr_b16 v[222:223], v39 offset:4608
    v_mfma_f32_16x16x32_bf16 v[124:127], v[196:199], v[240:243], v[124:127]
    ds_read_b64_tr_b16 v[192:193], v36 offset:8192
    ds_read_b64_tr_b16 v[194:195], v36 offset:8704
    v_mfma_f32_16x16x32_bf16 v[128:131], v[200:203], v[240:243], v[128:131]
    ds_read_b64_tr_b16 v[196:197], v37 offset:8192
    ds_read_b64_tr_b16 v[198:199], v37 offset:8704
    v_mfma_f32_16x16x32_bf16 v[132:135], v[204:207], v[240:243], v[132:135]
    ds_read_b64_tr_b16 v[200:201], v38 offset:8192
    ds_read_b64_tr_b16 v[202:203], v38 offset:8704
    s_xor_b32 s96, s17, 12288
    s_add_u32 s20, s96, s19
    buffer_load_dwordx4 v[240:243], v2, s[32:35], s20 offen sc1
    s_waitcnt vmcnt(7)
    s_waitcnt lgkmcnt(6)
    v_mfma_f32_16x16x32_bf16 v[120:123], v[208:211], v[244:247], v[120:123]
    ds_read_b64_tr_b16 v[204:205], v39 offset:8192
    ds_read_b64_tr_b16 v[206:207], v39 offset:8704
    v_mfma_f32_16x16x32_bf16 v[124:127], v[212:215], v[244:247], v[124:127]
    ds_read_b64_tr_b16 v[208:209], v36 offset:12288
    ds_read_b64_tr_b16 v[210:211], v36 offset:12800
    v_xor_b32 v36, 49152, v36
    v_mfma_f32_16x16x32_bf16 v[128:131], v[216:219], v[244:247], v[128:131]
    ds_read_b64_tr_b16 v[212:213], v37 offset:12288
    ds_read_b64_tr_b16 v[214:215], v37 offset:12800
    v_xor_b32 v37, 49152, v37
    v_mfma_f32_16x16x32_bf16 v[132:135], v[220:223], v[244:247], v[132:135]
    ds_read_b64_tr_b16 v[216:217], v38 offset:12288
    ds_read_b64_tr_b16 v[218:219], v38 offset:12800
    v_xor_b32 v38, 49152, v38
    buffer_load_dwordx4 v[244:247], v2, s[32:35], s20 offen offset:1024 sc1
    s_waitcnt vmcnt(7)
    s_waitcnt lgkmcnt(6)
    v_mfma_f32_16x16x32_bf16 v[120:123], v[192:195], v[44:47], v[120:123]
    ds_read_b64_tr_b16 v[220:221], v39 offset:12288
    ds_read_b64_tr_b16 v[222:223], v39 offset:12800
    v_xor_b32 v39, 49152, v39
    v_mfma_f32_16x16x32_bf16 v[124:127], v[196:199], v[44:47], v[124:127]
    ds_read_b64_tr_b16 v[192:193], v36
    ds_read_b64_tr_b16 v[194:195], v36 offset:512
    v_mfma_f32_16x16x32_bf16 v[128:131], v[200:203], v[44:47], v[128:131]
    ds_read_b64_tr_b16 v[196:197], v37
    ds_read_b64_tr_b16 v[198:199], v37 offset:512
    v_mfma_f32_16x16x32_bf16 v[132:135], v[204:207], v[44:47], v[132:135]
    ds_read_b64_tr_b16 v[200:201], v38
    ds_read_b64_tr_b16 v[202:203], v38 offset:512
    buffer_load_dwordx4 v[44:47], v2, s[32:35], s20 offen offset:2048 sc1
    s_waitcnt vmcnt(7)
    s_waitcnt lgkmcnt(6)
    v_mfma_f32_16x16x32_bf16 v[120:123], v[208:211], v[48:51], v[120:123]
    ds_read_b64_tr_b16 v[204:205], v39
    ds_read_b64_tr_b16 v[206:207], v39 offset:512
    v_mfma_f32_16x16x32_bf16 v[124:127], v[212:215], v[48:51], v[124:127]
    ds_read_b64_tr_b16 v[208:209], v36 offset:4096
    ds_read_b64_tr_b16 v[210:211], v36 offset:4608
    v_mfma_f32_16x16x32_bf16 v[128:131], v[216:219], v[48:51], v[128:131]
    ds_read_b64_tr_b16 v[212:213], v37 offset:4096
    ds_read_b64_tr_b16 v[214:215], v37 offset:4608
    v_mfma_f32_16x16x32_bf16 v[132:135], v[220:223], v[48:51], v[132:135]
    ds_read_b64_tr_b16 v[216:217], v38 offset:4096
    ds_read_b64_tr_b16 v[218:219], v38 offset:4608
    buffer_load_dwordx4 v[48:51], v2, s[32:35], s20 offen offset:3072 sc1
    s_waitcnt vmcnt(7)
    s_waitcnt lgkmcnt(6)
    v_mfma_f32_16x16x32_bf16 v[120:123], v[192:195], v[224:227], v[120:123]
    ds_read_b64_tr_b16 v[220:221], v39 offset:4096
    ds_read_b64_tr_b16 v[222:223], v39 offset:4608
    v_mfma_f32_16x16x32_bf16 v[124:127], v[196:199], v[224:227], v[124:127]
    ds_read_b64_tr_b16 v[192:193], v36 offset:8192
    ds_read_b64_tr_b16 v[194:195], v36 offset:8704
    v_mfma_f32_16x16x32_bf16 v[128:131], v[200:203], v[224:227], v[128:131]
L_PAD8:
    s_cbranch_execz L_RET8
    ds_read_b64_tr_b16 v[196:197], v37 offset:8192
    ds_read_b64_tr_b16 v[198:199], v37 offset:8704
    v_mfma_f32_16x16x32_bf16 v[132:135], v[204:207], v[224:227], v[132:135]
    ds_read_b64_tr_b16 v[200:201], v38 offset:8192
    ds_read_b64_tr_b16 v[202:203], v38 offset:8704
    s_xor_b32 s96, s17, 16384
    s_add_u32 s20, s96, s19
    buffer_load_dwordx4 v[224:227], v2, s[32:35], s20 offen sc1
    s_waitcnt vmcnt(7)
    s_waitcnt lgkmcnt(6)
    v_mfma_f32_16x16x32_bf16 v[120:123], v[208:211], v[228:231], v[120:123]
    ds_read_b64_tr_b16 v[204:205], v39 offset:8192
    ds_read_b64_tr_b16 v[206:207], v39 offset:8704
    v_mfma_f32_16x16x32_bf16 v[124:127], v[212:215], v[228:231], v[124:127]
    ds_read_b64_tr_b16 v[208:209], v36 offset:12288
    ds_read_b64_tr_b16 v[210:211], v36 offset:12800
    v_xor_b32 v36, 16384, v36
    v_mfma_f32_16x16x32_bf16 v[128:131], v[216:219], v[228:231], v[128:131]
    ds_read_b64_tr_b16 v[212:213], v37 offset:12288
    ds_read_b64_tr_b16 v[214:215], v37 offset:12800
    v_xor_b32 v37, 16384, v37
    v_mfma_f32_16x16x32_bf16 v[132:135], v[220:223], v[228:231], v[132:135]
    ds_read_b64_tr_b16 v[216:217], v38 offset:12288
    ds_read_b64_tr_b16 v[218:219], v38 offset:12800
    v_xor_b32 v38, 16384, v38
    buffer_load_dwordx4 v[228:231], v2, s[32:35], s20 offen offset:1024 sc1
    s_waitcnt vmcnt(7)
    s_waitcnt lgkmcnt(6)
    v_mfma_f32_16x16x32_bf16 v[120:123], v[192:195], v[232:235], v[120:123]
    ds_read_b64_tr_b16 v[220:221], v39 offset:12288
    ds_read_b64_tr_b16 v[222:223], v39 offset:12800
    v_xor_b32 v39, 16384, v39
    v_mfma_f32_16x16x32_bf16 v[124:127], v[196:199], v[232:235], v[124:127]
    ds_read_b64_tr_b16 v[192:193], v36
    ds_read_b64_tr_b16 v[194:195], v36 offset:512
    v_mfma_f32_16x16x32_bf16 v[128:131], v[200:203], v[232:235], v[128:131]
    ds_read_b64_tr_b16 v[196:197], v37
    ds_read_b64_tr_b16 v[198:199], v37 offset:512
    v_mfma_f32_16x16x32_bf16 v[132:135], v[204:207], v[232:235], v[132:135]
    ds_read_b64_tr_b16 v[200:201], v38
    ds_read_b64_tr_b16 v[202:203], v38 offset:512
    buffer_load_dwordx4 v[232:235], v2, s[32:35], s20 offen offset:2048 sc1
    s_waitcnt vmcnt(7)
    s_waitcnt lgkmcnt(6)
    v_mfma_f32_16x16x32_bf16 v[120:123], v[208:211], v[236:239], v[120:123]
    ds_read_b64_tr_b16 v[204:205], v39
    ds_read_b64_tr_b16 v[206:207], v39 offset:512
    v_mfma_f32_16x16x32_bf16 v[124:127], v[212:215], v[236:239], v[124:127]
    ds_read_b64_tr_b16 v[208:209], v36 offset:4096
    ds_read_b64_tr_b16 v[210:211], v36 offset:4608
    v_mfma_f32_16x16x32_bf16 v[128:131], v[216:219], v[236:239], v[128:131]
    ds_read_b64_tr_b16 v[212:213], v37 offset:4096
    ds_read_b64_tr_b16 v[214:215], v37 offset:4608
    v_mfma_f32_16x16x32_bf16 v[132:135], v[220:223], v[236:239], v[132:135]
    ds_read_b64_tr_b16 v[216:217], v38 offset:4096
    ds_read_b64_tr_b16 v[218:219], v38 offset:4608
    buffer_load_dwordx4 v[236:239], v2, s[32:35], s20 offen offset:3072 sc1
    s_waitcnt vmcnt(7)
    s_waitcnt lgkmcnt(6)
    v_mfma_f32_16x16x32_bf16 v[120:123], v[192:195], v[240:243], v[120:123]
    ds_read_b64_tr_b16 v[220:221], v39 offset:4096
    ds_read_b64_tr_b16 v[222:223], v39 offset:4608
    v_mfma_f32_16x16x32_bf16 v[124:127], v[196:199], v[240:243], v[124:127]
    ds_read_b64_tr_b16 v[192:193], v36 offset:8192
    ds_read_b64_tr_b16 v[194:195], v36 offset:8704
    v_mfma_f32_16x16x32_bf16 v[128:131], v[200:203], v[240:243], v[128:131]
    ds_read_b64_tr_b16 v[196:197], v37 offset:8192
    ds_read_b64_tr_b16 v[198:199], v37 offset:8704
    v_mfma_f32_16x16x32_bf16 v[132:135], v[204:207], v[240:243], v[132:135]
    ds_read_b64_tr_b16 v[200:201], v38 offset:8192
    ds_read_b64_tr_b16 v[202:203], v38 offset:8704
    s_xor_b32 s96, s17, 20480
    s_add_u32 s20, s96, s19
    buffer_load_dwordx4 v[240:243], v2, s[32:35], s20 offen sc1
    s_waitcnt vmcnt(7)
    s_waitcnt lgkmcnt(6)
    v_mfma_f32_16x16x32_bf16 v[120:123], v[208:211], v[244:247], v[120:123]
    ds_read_b64_tr_b16 v[204:205], v39 offset:8192
    ds_read_b64_tr_b16 v[206:207], v39 offset:8704
    v_mfma_f32_16x16x32_bf16 v[124:127], v[212:215], v[244:247], v[124:127]
    ds_read_b64_tr_b16 v[208:209], v36 offset:12288
    ds_read_b64_tr_b16 v[210:211], v36 offset:12800
    v_xor_b32 v36, 114688, v36
    v_mfma_f32_16x16x32_bf16 v[128:131], v[216:219], v[244:247], v[128:131]
    ds_read_b64_tr_b16 v[212:213], v37 offset:12288
    ds_read_b64_tr_b16 v[214:215], v37 offset:12800
    v_xor_b32 v37, 114688, v37
    v_mfma_f32_16x16x32_bf16 v[132:135], v[220:223], v[244:247], v[132:135]
    ds_read_b64_tr_b16 v[216:217], v38 offset:12288
    ds_read_b64_tr_b16 v[218:219], v38 offset:12800
    v_xor_b32 v38, 114688, v38
    buffer_load_dwordx4 v[244:247], v2, s[32:35], s20 offen offset:1024 sc1
    s_waitcnt vmcnt(7)
    s_waitcnt lgkmcnt(6)
    v_mfma_f32_16x16x32_bf16 v[120:123], v[192:195], v[44:47], v[120:123]
    ds_read_b64_tr_b16 v[220:221], v39 offset:12288
    ds_read_b64_tr_b16 v[222:223], v39 offset:12800
    v_xor_b32 v39, 114688, v39
    v_mfma_f32_16x16x32_bf16 v[124:127], v[196:199], v[44:47], v[124:127]
    ds_read_b64_tr_b16 v[192:193], v36
    ds_read_b64_tr_b16 v[194:195], v36 offset:512
    v_mfma_f32_16x16x32_bf16 v[128:131], v[200:203], v[44:47], v[128:131]
    ds_read_b64_tr_b16 v[196:197], v37
    ds_read_b64_tr_b16 v[198:199], v37 offset:512
    v_mfma_f32_16x16x32_bf16 v[132:135], v[204:207], v[44:47], v[132:135]
    ds_read_b64_tr_b16 v[200:201], v38
    ds_read_b64_tr_b16 v[202:203], v38 offset:512
    buffer_load_dwordx4 v[44:47], v2, s[32:35], s20 offen offset:2048 sc1
    s_waitcnt vmcnt(7)
    s_waitcnt lgkmcnt(6)
    v_mfma_f32_16x16x32_bf16 v[120:123], v[208:211], v[48:51], v[120:123]
    ds_read_b64_tr_b16 v[204:205], v39
    ds_read_b64_tr_b16 v[206:207], v39 offset:512
    v_mfma_f32_16x16x32_bf16 v[124:127], v[212:215], v[48:51], v[124:127]
    ds_read_b64_tr_b16 v[208:209], v36 offset:4096
    ds_read_b64_tr_b16 v[210:211], v36 offset:4608
    v_mfma_f32_16x16x32_bf16 v[128:131], v[216:219], v[48:51], v[128:131]
    ds_read_b64_tr_b16 v[212:213], v37 offset:4096
    ds_read_b64_tr_b16 v[214:215], v37 offset:4608
    v_mfma_f32_16x16x32_bf16 v[132:135], v[220:223], v[48:51], v[132:135]
    ds_read_b64_tr_b16 v[216:217], v38 offset:4096
    ds_read_b64_tr_b16 v[218:219], v38 offset:4608
    buffer_load_dwordx4 v[48:51], v2, s[32:35], s20 offen offset:3072 sc1
    s_waitcnt vmcnt(7)
    s_waitcnt lgkmcnt(6)
    v_mfma_f32_16x16x32_bf16 v[120:123], v[192:195], v[224:227], v[120:123]
    ds_read_b64_tr_b16 v[220:221], v39 offset:4096
    ds_read_b64_tr_b16 v[222:223], v39 offset:4608
    v_mfma_f32_16x16x32_bf16 v[124:127], v[196:199], v[224:227], v[124:127]
    ds_read_b64_tr_b16 v[192:193], v36 offset:8192
    ds_read_b64_tr_b16 v[194:195], v36 offset:8704
    v_mfma_f32_16x16x32_bf16 v[128:131], v[200:203], v[224:227], v[128:131]
    ds_read_b64_tr_b16 v[196:197], v37 offset:8192
    ds_read_b64_tr_b16 v[198:199], v37 offset:8704
    v_mfma_f32_16x16x32_bf16 v[132:135], v[204:207], v[224:227], v[132:135]
    ds_read_b64_tr_b16 v[200:201], v38 offset:8192
    ds_read_b64_tr_b16 v[202:203], v38 offset:8704
    s_xor_b32 s96, s17, 24576
    s_add_u32 s20, s96, s19
    buffer_load_dwordx4 v[224:227], v2, s[32:35], s20 offen sc1
    s_waitcnt vmcnt(7)
    s_waitcnt lgkmcnt(6)
    v_mfma_f32_16x16x32_bf16 v[120:123], v[208:211], v[228:231], v[120:123]
    ds_read_b64_tr_b16 v[204:205], v39 offset:8192
    ds_read_b64_tr_b16 v[206:207], v39 offset:8704
    v_mfma_f32_16x16x32_bf16 v[124:127], v[212:215], v[228:231], v[124:127]
    ds_read_b64_tr_b16 v[208:209], v36 offset:12288
    ds_read_b64_tr_b16 v[210:211], v36 offset:12800
    v_xor_b32 v36, 16384, v36
    v_mfma_f32_16x16x32_bf16 v[128:131], v[216:219], v[228:231], v[128:131]
    ds_read_b64_tr_b16 v[212:213], v37 offset:12288
    ds_read_b64_tr_b16 v[214:215], v37 offset:12800
    v_xor_b32 v37, 16384, v37
    v_mfma_f32_16x16x32_bf16 v[132:135], v[220:223], v[228:231], v[132:135]
    ds_read_b64_tr_b16 v[216:217], v38 offset:12288
    ds_read_b64_tr_b16 v[218:219], v38 offset:12800
    v_xor_b32 v38, 16384, v38
    buffer_load_dwordx4 v[228:231], v2, s[32:35], s20 offen offset:1024 sc1
    s_waitcnt vmcnt(7)
    s_waitcnt lgkmcnt(6)
    v_mfma_f32_16x16x32_bf16 v[120:123], v[192:195], v[232:235], v[120:123]
    ds_read_b64_tr_b16 v[220:221], v39 offset:12288
    ds_read_b64_tr_b16 v[222:223], v39 offset:12800
    v_xor_b32 v39, 16384, v39
    v_mfma_f32_16x16x32_bf16 v[124:127], v[196:199], v[232:235], v[124:127]
    ds_read_b64_tr_b16 v[192:193], v36
    ds_read_b64_tr_b16 v[194:195], v36 offset:512
    v_mfma_f32_16x16x32_bf16 v[128:131], v[200:203], v[232:235], v[128:131]
    ds_read_b64_tr_b16 v[196:197], v37
    ds_read_b64_tr_b16 v[198:199], v37 offset:512
    v_mfma_f32_16x16x32_bf16 v[132:135], v[204:207], v[232:235], v[132:135]
    ds_read_b64_tr_b16 v[200:201], v38
    ds_read_b64_tr_b16 v[202:203], v38 offset:512
    buffer_load_dwordx4 v[232:235], v2, s[32:35], s20 offen offset:2048 sc1
    s_waitcnt vmcnt(7)
    s_waitcnt lgkmcnt(6)
    v_mfma_f32_16x16x32_bf16 v[120:123], v[208:211], v[236:239], v[120:123]
    ds_read_b64_tr_b16 v[204:205], v39
    ds_read_b64_tr_b16 v[206:207], v39 offset:512
    v_mfma_f32_16x16x32_bf16 v[124:127], v[212:215], v[236:239], v[124:127]
    ds_read_b64_tr_b16 v[208:209], v36 offset:4096
    ds_read_b64_tr_b16 v[210:211], v36 offset:4608
    v_mfma_f32_16x16x32_bf16 v[128:131], v[216:219], v[236:239], v[128:131]
    ds_read_b64_tr_b16 v[212:213], v37 offset:4096
    ds_read_b64_tr_b16 v[214:215], v37 offset:4608
    v_mfma_f32_16x16x32_bf16 v[132:135], v[220:223], v[236:239], v[132:135]
    ds_read_b64_tr_b16 v[216:217], v38 offset:4096
    ds_read_b64_tr_b16 v[218:219], v38 offset:4608
    buffer_load_dwordx4 v[236:239], v2, s[32:35], s20 offen offset:3072 sc1
    s_waitcnt vmcnt(7)
    s_waitcnt lgkmcnt(6)
    v_mfma_f32_16x16x32_bf16 v[120:123], v[192:195], v[240:243], v[120:123]
    ds_read_b64_tr_b16 v[220:221], v39 offset:4096
    ds_read_b64_tr_b16 v[222:223], v39 offset:4608
    v_mfma_f32_16x16x32_bf16 v[124:127], v[196:199], v[240:243], v[124:127]
    ds_read_b64_tr_b16 v[192:193], v36 offset:8192
    ds_read_b64_tr_b16 v[194:195], v36 offset:8704
    v_mfma_f32_16x16x32_bf16 v[128:131], v[200:203], v[240:243], v[128:131]
    ds_read_b64_tr_b16 v[196:197], v37 offset:8192
    ds_read_b64_tr_b16 v[198:199], v37 offset:8704
    v_mfma_f32_16x16x32_bf16 v[132:135], v[204:207], v[240:243], v[132:135]
    ds_read_b64_tr_b16 v[200:201], v38 offset:8192
    ds_read_b64_tr_b16 v[202:203], v38 offset:8704
    s_xor_b32 s96, s17, 28672
    s_add_u32 s20, s96, s19
    buffer_load_dwordx4 v[240:243], v2, s[32:35], s20 offen sc1
    s_waitcnt vmcnt(7)
    s_waitcnt lgkmcnt(6)
    v_mfma_f32_16x16x32_bf16 v[120:123], v[208:211], v[244:247], v[120:123]
    ds_read_b64_tr_b16 v[204:205], v39 offset:8192
    ds_read_b64_tr_b16 v[206:207], v39 offset:8704
    v_mfma_f32_16x16x32_bf16 v[124:127], v[212:215], v[244:247], v[124:127]
    ds_read_b64_tr_b16 v[208:209], v36 offset:12288
    ds_read_b64_tr_b16 v[210:211], v36 offset:12800
    v_xor_b32 v36, 49152, v36
    v_mfma_f32_16x16x32_bf16 v[128:131], v[216:219], v[244:247], v[128:131]
    ds_read_b64_tr_b16 v[212:213], v37 offset:12288
    ds_read_b64_tr_b16 v[214:215], v37 offset:12800
    v_xor_b32 v37, 49152, v37
    v_mfma_f32_16x16x32_bf16 v[132:135], v[220:223], v[244:247], v[132:135]
    ds_read_b64_tr_b16 v[216:217], v38 offset:12288
    ds_read_b64_tr_b16 v[218:219], v38 offset:12800
    v_xor_b32 v38, 49152, v38
    buffer_load_dwordx4 v[244:247], v2, s[32:35], s20 offen offset:1024 sc1
    s_cmp_lt_u32 s3, 4
    s_cbranch_scc1 L_G2P22
    s_setprio 0
L_G2P22:
    s_waitcnt vmcnt(7)
    s_waitcnt lgkmcnt(6)
    v_mfma_f32_16x16x32_bf16 v[120:123], v[192:195], v[44:47], v[120:123]
    ds_read_b64_tr_b16 v[220:221], v39 offset:12288
    ds_read_b64_tr_b16 v[222:223], v39 offset:12800
    v_xor_b32 v39, 49152, v39
    v_mfma_f32_16x16x32_bf16 v[124:127], v[196:199], v[44:47], v[124:127]
    ds_read_b64_tr_b16 v[192:193], v36
    ds_read_b64_tr_b16 v[194:195], v36 offset:512
    v_mfma_f32_16x16x32_bf16 v[128:131], v[200:203], v[44:47], v[128:131]
    ds_read_b64_tr_b16 v[196:197], v37
    ds_read_b64_tr_b16 v[198:199], v37 offset:512
    v_mfma_f32_16x16x32_bf16 v[132:135], v[204:207], v[44:47], v[132:135]
    ds_read_b64_tr_b16 v[200:201], v38
    ds_read_b64_tr_b16 v[202:203], v38 offset:512
    buffer_load_dwordx4 v[44:47], v2, s[32:35], s20 offen offset:2048 sc1
    s_waitcnt vmcnt(7)
    s_waitcnt lgkmcnt(6)
    v_mfma_f32_16x16x32_bf16 v[120:123], v[208:211], v[48:51], v[120:123]
    ds_read_b64_tr_b16 v[204:205], v39
    ds_read_b64_tr_b16 v[206:207], v39 offset:512
    v_mfma_f32_16x16x32_bf16 v[124:127], v[212:215], v[48:51], v[124:127]
    ds_read_b64_tr_b16 v[208:209], v36 offset:4096
    ds_read_b64_tr_b16 v[210:211], v36 offset:4608
    v_mfma_f32_16x16x32_bf16 v[128:131], v[216:219], v[48:51], v[128:131]
    ds_read_b64_tr_b16 v[212:213], v37 offset:4096
    ds_read_b64_tr_b16 v[214:215], v37 offset:4608
    v_mfma_f32_16x16x32_bf16 v[132:135], v[220:223], v[48:51], v[132:135]
    ds_read_b64_tr_b16 v[216:217], v38 offset:4096
    ds_read_b64_tr_b16 v[218:219], v38 offset:4608
    buffer_load_dwordx4 v[48:51], v2, s[32:35], s20 offen offset:3072 sc1
    buffer_load_dwordx2 v[40:41], v10, s[32:35], s13 offen sc1
    s_waitcnt vmcnt(8)
    s_waitcnt lgkmcnt(6)
    v_mfma_f32_16x16x32_bf16 v[120:123], v[192:195], v[224:227], v[120:123]
    ds_read_b64_tr_b16 v[220:221], v39 offset:4096
    ds_read_b64_tr_b16 v[222:223], v39 offset:4608
    v_mfma_f32_16x16x32_bf16 v[124:127], v[196:199], v[224:227], v[124:127]
    ds_read_b64_tr_b16 v[192:193], v36 offset:8192
    ds_read_b64_tr_b16 v[194:195], v36 offset:8704
    v_mfma_f32_16x16x32_bf16 v[128:131], v[200:203], v[224:227], v[128:131]
    ds_read_b64_tr_b16 v[196:197], v37 offset:8192
    ds_read_b64_tr_b16 v[198:199], v37 offset:8704
    v_mfma_f32_16x16x32_bf16 v[132:135], v[204:207], v[224:227], v[132:135]
    ds_read_b64_tr_b16 v[200:201], v38 offset:8192
    ds_read_b64_tr_b16 v[202:203], v38 offset:8704
    s_waitcnt vmcnt(7)
    s_waitcnt lgkmcnt(6)
    v_mfma_f32_16x16x32_bf16 v[120:123], v[208:211], v[228:231], v[120:123]
    ds_read_b64_tr_b16 v[204:205], v39 offset:8192
    ds_read_b64_tr_b16 v[206:207], v39 offset:8704
    v_mfma_f32_16x16x32_bf16 v[124:127], v[212:215], v[228:231], v[124:127]
    ds_read_b64_tr_b16 v[208:209], v36 offset:12288
    ds_read_b64_tr_b16 v[210:211], v36 offset:12800
    v_xor_b32 v36, 16384, v36
    v_mfma_f32_16x16x32_bf16 v[128:131], v[216:219], v[228:231], v[128:131]
    ds_read_b64_tr_b16 v[212:213], v37 offset:12288
    ds_read_b64_tr_b16 v[214:215], v37 offset:12800
    v_xor_b32 v37, 16384, v37
    v_mfma_f32_16x16x32_bf16 v[132:135], v[220:223], v[228:231], v[132:135]
    ds_read_b64_tr_b16 v[216:217], v38 offset:12288
    ds_read_b64_tr_b16 v[218:219], v38 offset:12800
    v_xor_b32 v38, 16384, v38
    s_waitcnt vmcnt(6)
    s_waitcnt lgkmcnt(6)
    v_mfma_f32_16x16x32_bf16 v[120:123], v[192:195], v[232:235], v[120:123]
    ds_read_b64_tr_b16 v[220:221], v39 offset:12288
    ds_read_b64_tr_b16 v[222:223], v39 offset:12800
    v_xor_b32 v39, 16384, v39
    v_mfma_f32_16x16x32_bf16 v[124:127], v[196:199], v[232:235], v[124:127]
    ds_read_b64_tr_b16 v[192:193], v36
    ds_read_b64_tr_b16 v[194:195], v36 offset:512
    v_mfma_f32_16x16x32_bf16 v[128:131], v[200:203], v[232:235], v[128:131]
    ds_read_b64_tr_b16 v[196:197], v37
    ds_read_b64_tr_b16 v[198:199], v37 offset:512
    v_mfma_f32_16x16x32_bf16 v[132:135], v[204:207], v[232:235], v[132:135]
    ds_read_b64_tr_b16 v[200:201], v38
    ds_read_b64_tr_b16 v[202:203], v38 offset:512
    s_waitcnt vmcnt(5)
    s_waitcnt lgkmcnt(6)
    v_mfma_f32_16x16x32_bf16 v[120:123], v[208:211], v[236:239], v[120:123]
    ds_read_b64_tr_b16 v[204:205], v39
    ds_read_b64_tr_b16 v[206:207], v39 offset:512
    v_mfma_f32_16x16x32_bf16 v[124:127], v[212:215], v[236:239], v[124:127]
    ds_read_b64_tr_b16 v[208:209], v36 offset:4096
    ds_read_b64_tr_b16 v[210:211], v36 offset:4608
    v_mfma_f32_16x16x32_bf16 v[128:131], v[216:219], v[236:239], v[128:131]
    ds_read_b64_tr_b16 v[212:213], v37 offset:4096
    ds_read_b64_tr_b16 v[214:215], v37 offset:4608
    v_mfma_f32_16x16x32_bf16 v[132:135], v[220:223], v[236:239], v[132:135]
    ds_read_b64_tr_b16 v[216:217], v38 offset:4096
    ds_read_b64_tr_b16 v[218:219], v38 offset:4608
    s_add_u32 s82, s80, 114688
    buffer_load_dwordx4 v[72:75], v27, s[52:55], s82 offen nt
    s_add_u32 s82, s80, 172032
    buffer_load_dwordx4 v[76:79], v27, s[52:55], s82 offen nt
    s_mov_b32 s82, s80
    buffer_load_dwordx4 v[80:83], v27, s[56:59], s82 offen nt
    s_waitcnt vmcnt(7)
    s_waitcnt lgkmcnt(6)
    v_mfma_f32_16x16x32_bf16 v[120:123], v[192:195], v[240:243], v[120:123]
    ds_read_b64_tr_b16 v[220:221], v39 offset:4096
    ds_read_b64_tr_b16 v[222:223], v39 offset:4608
    v_mfma_f32_16x16x32_bf16 v[124:127], v[196:199], v[240:243], v[124:127]
    ds_read_b64_tr_b16 v[192:193], v36 offset:8192
    ds_read_b64_tr_b16 v[194:195], v36 offset:8704
    v_mfma_f32_16x16x32_bf16 v[128:131], v[200:203], v[240:243], v[128:131]
    ds_read_b64_tr_b16 v[196:197], v37 offset:8192
    ds_read_b64_tr_b16 v[198:199], v37 offset:8704
    v_mfma_f32_16x16x32_bf16 v[132:135], v[204:207], v[240:243], v[132:135]
    ds_read_b64_tr_b16 v[200:201], v38 offset:8192
    ds_read_b64_tr_b16 v[202:203], v38 offset:8704
    s_waitcnt vmcnt(6)
    s_waitcnt lgkmcnt(6)
    v_mfma_f32_16x16x32_bf16 v[120:123], v[208:211], v[244:247], v[120:123]
    ds_read_b64_tr_b16 v[204:205], v39 offset:8192
    ds_read_b64_tr_b16 v[206:207], v39 offset:8704
    v_mfma_f32_16x16x32_bf16 v[124:127], v[212:215], v[244:247], v[124:127]
    ds_read_b64_tr_b16 v[208:209], v36 offset:12288
    ds_read_b64_tr_b16 v[210:211], v36 offset:12800
    v_mfma_f32_16x16x32_bf16 v[128:131], v[216:219], v[244:247], v[128:131]
    ds_read_b64_tr_b16 v[212:213], v37 offset:12288
    ds_read_b64_tr_b16 v[214:215], v37 offset:12800
    v_mfma_f32_16x16x32_bf16 v[132:135], v[220:223], v[244:247], v[132:135]
    ds_read_b64_tr_b16 v[216:217], v38 offset:12288
    ds_read_b64_tr_b16 v[218:219], v38 offset:12800
    s_waitcnt vmcnt(5)
    s_waitcnt lgkmcnt(6)
    v_mfma_f32_16x16x32_bf16 v[120:123], v[192:195], v[44:47], v[120:123]
    ds_read_b64_tr_b16 v[220:221], v39 offset:12288
    ds_read_b64_tr_b16 v[222:223], v39 offset:12800
    v_mfma_f32_16x16x32_bf16 v[124:127], v[196:199], v[44:47], v[124:127]
    v_mfma_f32_16x16x32_bf16 v[128:131], v[200:203], v[44:47], v[128:131]
    v_mfma_f32_16x16x32_bf16 v[132:135], v[204:207], v[44:47], v[132:135]
    s_waitcnt vmcnt(4)
    s_waitcnt lgkmcnt(0)
    v_mfma_f32_16x16x32_bf16 v[120:123], v[208:211], v[48:51], v[120:123]
    v_mfma_f32_16x16x32_bf16 v[124:127], v[212:215], v[48:51], v[124:127]
    v_mfma_f32_16x16x32_bf16 v[128:131], v[216:219], v[48:51], v[128:131]
    v_mfma_f32_16x16x32_bf16 v[132:135], v[220:223], v[48:51], v[132:135]
    s_nop 4
    v_cvt_pk_bf16_f32 v120, 0, v120
    v_cvt_pk_bf16_f32 v121, 0, v121
    v_cvt_pk_bf16_f32 v122, 0, v122
    v_cvt_pk_bf16_f32 v123, 0, v123
    v_cvt_pk_bf16_f32 v124, 0, v124
    v_cvt_pk_bf16_f32 v125, 0, v125
    v_cvt_pk_bf16_f32 v126, 0, v126
    v_cvt_pk_bf16_f32 v127, 0, v127
    v_pk_mul_f32 v[120:121], v[120:121], v[136:137]
    v_pk_mul_f32 v[122:123], v[122:123], v[138:139]
    v_pk_mul_f32 v[124:125], v[124:125], v[140:141]
    v_pk_mul_f32 v[126:127], v[126:127], v[142:143]
    v_cvt_pk_bf16_f32 v120, 0, v120
    v_cvt_pk_bf16_f32 v121, 0, v121
    v_cvt_pk_bf16_f32 v122, 0, v122
    v_cvt_pk_bf16_f32 v123, 0, v123
    v_cvt_pk_bf16_f32 v124, 0, v124
    v_cvt_pk_bf16_f32 v125, 0, v125
    v_cvt_pk_bf16_f32 v126, 0, v126
    v_cvt_pk_bf16_f32 v127, 0, v127
    v_pk_add_f32 v[120:121], v[120:121], v[152:153]
    v_pk_add_f32 v[122:123], v[122:123], v[154:155]
    v_pk_add_f32 v[124:125], v[124:125], v[156:157]
    v_pk_add_f32 v[126:127], v[126:127], v[158:159]
    v_cvt_pk_bf16_f32 v12, v120, v121
    v_cvt_pk_bf16_f32 v13, v122, v123
    v_cvt_pk_bf16_f32 v14, v124, v125
    v_cvt_pk_bf16_f32 v15, v126, v127
    v_dot2_f32_bf16 v4, v12, v12, 0
    v_dot2_f32_bf16 v5, v13, v13, 0
    v_dot2_f32_bf16 v4, v14, v14, v4
    v_dot2_f32_bf16 v5, v15, v15, v5
    v_mfma_f32_16x16x32_bf16 v[240:243], v[184:187], v[12:15], 0
    v_cvt_pk_bf16_f32 v128, 0, v128
    v_cvt_pk_bf16_f32 v129, 0, v129
    v_cvt_pk_bf16_f32 v130, 0, v130
    v_cvt_pk_bf16_f32 v131, 0, v131
    v_cvt_pk_bf16_f32 v132, 0, v132
    v_cvt_pk_bf16_f32 v133, 0, v133
    v_cvt_pk_bf16_f32 v134, 0, v134
    v_cvt_pk_bf16_f32 v135, 0, v135
    v_pk_mul_f32 v[128:129], v[128:129], v[144:145]
    v_pk_mul_f32 v[130:131], v[130:131], v[146:147]
    v_pk_mul_f32 v[132:133], v[132:133], v[148:149]
    v_pk_mul_f32 v[134:135], v[134:135], v[150:151]
    v_cvt_pk_bf16_f32 v128, 0, v128
    v_cvt_pk_bf16_f32 v129, 0, v129
    v_cvt_pk_bf16_f32 v130, 0, v130
    v_cvt_pk_bf16_f32 v131, 0, v131
    v_cvt_pk_bf16_f32 v132, 0, v132
    v_cvt_pk_bf16_f32 v133, 0, v133
    v_cvt_pk_bf16_f32 v134, 0, v134
    v_cvt_pk_bf16_f32 v135, 0, v135
    v_pk_add_f32 v[128:129], v[128:129], v[160:161]
    v_pk_add_f32 v[130:131], v[130:131], v[162:163]
    v_pk_add_f32 v[132:133], v[132:133], v[164:165]
    v_pk_add_f32 v[134:135], v[134:135], v[166:167]
    v_cvt_pk_bf16_f32 v16, v128, v129
    v_cvt_pk_bf16_f32 v17, v130, v131
    v_cvt_pk_bf16_f32 v18, v132, v133
    v_cvt_pk_bf16_f32 v19, v134, v135
    v_dot2_f32_bf16 v4, v16, v16, v4
    v_dot2_f32_bf16 v5, v17, v17, v5
    v_dot2_f32_bf16 v4, v18, v18, v4
    v_dot2_f32_bf16 v5, v19, v19, v5
    v_mfma_f32_16x16x32_bf16 v[240:243], v[188:191], v[16:19], v[240:243]
    s_nop 1
    v_add_f32 v4, v4, v5
    v_mov_b32 v5, v4
    s_nop 1
    v_permlane32_swap_b32 v4, v5
    v_add_f32 v4, v4, v5
    v_mov_b32 v5, v4
    s_nop 1
    v_permlane16_swap_b32 v4, v5
    v_add_f32 v243, v4, v5
    s_mov_b64 exec, 0xffff
    buffer_store_dwordx4 v[240:243], v2, s[32:35], s86 offen sc1
    s_mov_b64 exec, -1
    s_barrier
    s_cmp_lg_u32 s3, 0
    s_cbranch_scc1 L_PE
    v_mov_b32 v6, s4
    s_mov_b32 exec_hi, 0
    s_mov_b32 exec_lo, 65535
    buffer_store_dword v6, v29, s[32:35], s87 offen sc1
    s_mov_b64 exec, -1
L_PE:
    s_add_u32 s82, s80, 57344
    s_lshl2_add_u32 m0, s83, 33792
    s_nop 0
    buffer_load_dwordx4 v27, s[56:59], s82 offen nt lds
    s_add_u32 s82, s80, 114688
    s_lshl2_add_u32 m0, s83, 34816
    s_nop 0
    buffer_load_dwordx4 v27, s[56:59], s82 offen nt lds
    s_lshl_b32 s15, s3, 12
    v_add_u32 v4, s15, v2
    v_add_u32 v7, 65536, v4
    s_waitcnt vmcnt(6)
    v_cmp_ne_u32 vcc, s4, v41
    s_cbranch_vccz L_UPOK
POLL_34:
    buffer_load_dwordx2 v[40:41], v10, s[32:35], s13 offen sc1
    s_waitcnt vmcnt(0)
    v_cmp_ne_u32 vcc, s4, v41
    s_cbranch_vccz PDONE_35
    s_add_u32 s5, s5, 1
    s_cmp_lt_u32 s5, 200000
    s_cbranch_scc1 POLL_34
PDONE_35:
L_UPOK:
    s_lshl3_add_u32 s96, s21, s3
    s_lshl_b32 s97, s96, 12
    s_add_u32 s14, s97, 12582912
    s_load_dwordx2 s[24:25], s[32:33], s92 offset:1536 glc
    v_add_f32_dpp v40, v40, v40 quad_perm:[1,0,3,2] row_mask:0xf bank_mask:0xf
    s_nop 1
    v_add_f32_dpp v40, v40, v40 quad_perm:[2,3,0,1] row_mask:0xf bank_mask:0xf
    s_nop 1
    v_add_f32_dpp v40, v40, v40 row_half_mirror row_mask:0xf bank_mask:0xf
    s_nop 1
    v_add_f32_dpp v40, v40, v40 row_mirror row_mask:0xf bank_mask:0xf
    v_lshlrev_b32 v152, 16, v12
    v_and_b32 v153, s6, v12
    v_lshlrev_b32 v154, 16, v13
    v_and_b32 v155, s6, v13
    v_lshlrev_b32 v156, 16, v14
    v_and_b32 v157, s6, v14
    v_lshlrev_b32 v158, 16, v15
    v_and_b32 v159, s6, v15
    v_lshlrev_b32 v160, 16, v16
    v_and_b32 v161, s6, v16
    v_lshlrev_b32 v162, 16, v17
    v_and_b32 v163, s6, v17
    v_lshlrev_b32 v164, 16, v18
    v_and_b32 v165, s6, v18
    v_lshlrev_b32 v166, 16, v19
    v_and_b32 v167, s6, v19
    s_lshl_b32 s96, s3, 9
    s_lshl1_add_u32 s15, s21, s96
    v_and_b32 v29, 15, v1
    v_lshl_add_u32 v29, v29, 5, s15
    v_xor_b32 v5, 0x4000, v4
    v_xor_b32 v8, 0x4000, v7
    s_waitcnt vmcnt(3)
    ds_write_b128 v4, v[72:75] offset:2048
    ds_write_b128 v4, v[76:79] offset:3072
    ds_write_b128 v4, v[80:83] offset:32768
    s_cmp_lt_u32 s3, 4
    s_cbranch_scc1 L_FW1
    ds_write_b128 v4, v[56:59] offset:0
    ds_write_b128 v5, v[60:63] offset:0
    ds_write_b128 v4, v[64:67] offset:1024
    ds_write_b128 v5, v[68:71] offset:1024
L_FW1:
    s_branch SCHK_37
SPOLL_36:
    s_load_dwordx2 s[24:25], s[32:33], s92 offset:1536 glc
SCHK_37:
    s_add_u32 s5, s5, 1
    s_cmp_ge_u32 s5, 200000
    s_waitcnt lgkmcnt(0)
    s_cbranch_scc1 SDONE_38
    s_cmp_lg_u32 s24, s4
    s_cbranch_scc1 SPOLL_36
    s_cmp_lg_u32 s25, s4
    s_cbranch_scc1 SPOLL_36
SDONE_38:
    s_barrier
    buffer_load_dwordx4 v[192:195], v2, s[32:35], s14 offen sc1
    buffer_load_dwordx4 v[196:199], v2, s[32:35], s14 offen offset:1024 sc1
    buffer_load_dwordx4 v[200:203], v2, s[32:35], s14 offen offset:2048 sc1
    buffer_load_dwordx4 v[204:207], v2, s[32:35], s14 offen offset:3072 sc1
    s_barrier
    s_add_u32 s82, s80, 172032
    s_lshl2_add_u32 m0, s83, 35840
    s_nop 0
    buffer_load_dwordx4 v27, s[56:59], s82 offen nt lds
    s_mov_b32 s82, s81
    s_lshl2_add_u32 m0, s83, 65536
    s_nop 0
    buffer_load_dwordx4 v253, s[60:63], s82 offen nt lds
    s_add_u32 s82, s81, 4096
    s_lshl2_add_u32 m0, s83, 66560
    s_nop 0
    buffer_load_dwordx4 v253, s[60:63], s82 offen nt lds
    v_mov_b32_dpp v168, v33 row_newbcast:0 row_mask:0xf bank_mask:0xf
    v_mov_b32_dpp v169, v33 row_newbcast:1 row_mask:0xf bank_mask:0xf
    v_mov_b32_dpp v170, v33 row_newbcast:2 row_mask:0xf bank_mask:0xf
    v_mov_b32_dpp v171, v33 row_newbcast:3 row_mask:0xf bank_mask:0xf
    v_mov_b32_dpp v172, v33 row_newbcast:4 row_mask:0xf bank_mask:0xf
    v_mov_b32_dpp v173, v33 row_newbcast:5 row_mask:0xf bank_mask:0xf
    v_mov_b32_dpp v174, v33 row_newbcast:6 row_mask:0xf bank_mask:0xf
    v_mov_b32_dpp v175, v33 row_newbcast:7 row_mask:0xf bank_mask:0xf
    v_mov_b32_dpp v176, v33 row_newbcast:8 row_mask:0xf bank_mask:0xf
    v_mov_b32_dpp v177, v33 row_newbcast:9 row_mask:0xf bank_mask:0xf
    v_mov_b32_dpp v178, v33 row_newbcast:10 row_mask:0xf bank_mask:0xf
    v_mov_b32_dpp v179, v33 row_newbcast:11 row_mask:0xf bank_mask:0xf
    v_mov_b32_dpp v180, v33 row_newbcast:12 row_mask:0xf bank_mask:0xf
    v_mov_b32_dpp v181, v33 row_newbcast:13 row_mask:0xf bank_mask:0xf
    v_mov_b32_dpp v182, v33 row_newbcast:14 row_mask:0xf bank_mask:0xf
    v_mov_b32_dpp v183, v33 row_newbcast:15 row_mask:0xf bank_mask:0xf
    v_mov_b32_dpp v88, v42 row_newbcast:0 row_mask:0xf bank_mask:0xf
    v_mov_b32_dpp v89, v42 row_newbcast:1 row_mask:0xf bank_mask:0xf
    v_mov_b32_dpp v90, v42 row_newbcast:2 row_mask:0xf bank_mask:0xf
    v_mov_b32_dpp v91, v42 row_newbcast:3 row_mask:0xf bank_mask:0xf
    v_mov_b32_dpp v92, v42 row_newbcast:4 row_mask:0xf bank_mask:0xf
    v_mov_b32_dpp v93, v42 row_newbcast:5 row_mask:0xf bank_mask:0xf
    v_mov_b32_dpp v94, v42 row_newbcast:6 row_mask:0xf bank_mask:0xf
    v_mov_b32_dpp v95, v42 row_newbcast:7 row_mask:0xf bank_mask:0xf
    v_mov_b32_dpp v96, v42 row_newbcast:8 row_mask:0xf bank_mask:0xf
    v_mov_b32_dpp v97, v42 row_newbcast:9 row_mask:0xf bank_mask:0xf
    v_mov_b32_dpp v98, v42 row_newbcast:10 row_mask:0xf bank_mask:0xf
L_PAD9:
    s_cbranch_execz L_RET9
    v_mov_b32_dpp v99, v42 row_newbcast:11 row_mask:0xf bank_mask:0xf
    v_mov_b32_dpp v100, v42 row_newbcast:12 row_mask:0xf bank_mask:0xf
    v_mov_b32_dpp v101, v42 row_newbcast:13 row_mask:0xf bank_mask:0xf
    v_mov_b32_dpp v102, v42 row_newbcast:14 row_mask:0xf bank_mask:0xf
    v_mov_b32_dpp v103, v42 row_newbcast:15 row_mask:0xf bank_mask:0xf
    v_mov_b32_dpp v104, v43 row_newbcast:0 row_mask:0xf bank_mask:0xf
    v_mov_b32_dpp v105, v43 row_newbcast:1 row_mask:0xf bank_mask:0xf
    v_mov_b32_dpp v106, v43 row_newbcast:2 row_mask:0xf bank_mask:0xf
    v_mov_b32_dpp v107, v43 row_newbcast:3 row_mask:0xf bank_mask:0xf
    v_mov_b32_dpp v108, v43 row_newbcast:4 row_mask:0xf bank_mask:0xf
    v_mov_b32_dpp v109, v43 row_newbcast:5 row_mask:0xf bank_mask:0xf
    v_mov_b32_dpp v110, v43 row_newbcast:6 row_mask:0xf bank_mask:0xf
    v_mov_b32_dpp v111, v43 row_newbcast:7 row_mask:0xf bank_mask:0xf
    v_mov_b32_dpp v112, v43 row_newbcast:8 row_mask:0xf bank_mask:0xf
    v_mov_b32_dpp v113, v43 row_newbcast:9 row_mask:0xf bank_mask:0xf
    v_mov_b32_dpp v114, v43 row_newbcast:10 row_mask:0xf bank_mask:0xf
    v_mov_b32_dpp v115, v43 row_newbcast:11 row_mask:0xf bank_mask:0xf
    v_mov_b32_dpp v116, v43 row_newbcast:12 row_mask:0xf bank_mask:0xf
    v_mov_b32_dpp v117, v43 row_newbcast:13 row_mask:0xf bank_mask:0xf
    v_mov_b32_dpp v118, v43 row_newbcast:14 row_mask:0xf bank_mask:0xf
    v_mov_b32_dpp v119, v43 row_newbcast:15 row_mask:0xf bank_mask:0xf
    s_lshl3_add_u32 s15, s3, 156160
    v_mov_b32 v4, s15
    v_and_b32 v5, 7, v1
    v_lshlrev_b32 v5, 3, v5
    v_add_u32 v5, 156160, v5
    v_and_b32 v6, 3, v1
    v_lshlrev_b32 v6, 18, v6
    v_bfe_u32 v9, v1, 2, 2
    v_lshl_add_u32 v6, v9, 13, v6
    s_and_b32 s96, s21, 1
    s_and_b32 s97, s12, 7
    s_lshr_b32 s98, s12, 3
    s_lshl3_add_u32 s99, s97, s98
    s_lshl_b32 s97, s99, 12
    s_lshr_b32 s98, s21, 1
    s_lshl_b32 s99, s98, 6
    s_add_u32 s98, s97, s99
    s_lshl4_add_u32 s97, s96, s98
    s_add_u32 s99, s97, 1048576
    s_add_u32 s16, s99, 2560
    s_waitcnt vmcnt(3)
    v_pk_add_f32 v[192:193], v[192:193], v[196:197]
    v_pk_add_f32 v[200:201], v[200:201], v[204:205]
    v_pk_add_f32 v[194:195], v[194:195], v[198:199]
    v_pk_add_f32 v[202:203], v[202:203], v[206:207]
    v_pk_add_f32 v[192:193], v[192:193], v[200:201]
    v_pk_add_f32 v[194:195], v[194:195], v[202:203]
    v_add_f32 v193, v193, v194
    v_add_f32 v197, v192, v195
    v_cmp_u_f32 vcc, v193, v197
    s_cbranch_vccz POK_40
PRE_41:
    buffer_load_dwordx4 v[192:195], v2, s[32:35], s14 offen sc1
    buffer_load_dwordx4 v[196:199], v2, s[32:35], s14 offen offset:1024 sc1
    buffer_load_dwordx4 v[200:203], v2, s[32:35], s14 offen offset:2048 sc1
    buffer_load_dwordx4 v[204:207], v2, s[32:35], s14 offen offset:3072 sc1
    s_waitcnt vmcnt(0)
    v_pk_add_f32 v[192:193], v[192:193], v[196:197]
    v_pk_add_f32 v[200:201], v[200:201], v[204:205]
    v_pk_add_f32 v[194:195], v[194:195], v[198:199]
    v_pk_add_f32 v[202:203], v[202:203], v[206:207]
    v_pk_add_f32 v[192:193], v[192:193], v[200:201]
    v_pk_add_f32 v[194:195], v[194:195], v[202:203]
    v_add_f32 v193, v193, v194
    v_add_f32 v197, v192, v195
    v_cmp_u_f32 vcc, v193, v197
    s_cbranch_vccz POK_40
    s_add_u32 s5, s5, 1
    s_cmp_lt_u32 s5, 200000
    s_cbranch_scc1 PRE_41
POK_40:
    v_mov_b32 v196, v195
    s_nop 1
    v_permlane32_swap_b32 v195, v196
    v_permlane32_swap_b32 v192, v193
    v_add_f32 v195, v195, v196
    v_add_f32 v192, v192, v193
    s_nop 1
    v_permlane16_swap_b32 v192, v195
    v_add_f32 v193, v192, v195
    v_add_f32 v195, v192, v195
    s_nop 1
    v_permlane16_swap_b32 v193, v195
    v_mov_b32 v192, v193
    v_mul_f32 v195, 0x3a800000, v195
    s_nop 0
    v_permlane32_swap_b32 v192, v193
    v_mul_f32 v192, 0x3a800000, v192
    v_fma_f32 v31, -v192, v192, v195
    v_cvt_pk_bf16_f32 v30, 0, v192
    v_max_f32 v31, 0, v31
    v_cvt_pk_bf16_f32 v31, 0, v31
    v_fma_f32 v193, -v30, v40, v193
    v_add_f32 v31, 0x3727c5ac, v31
    v_cvt_pk_bf16_f32 v31, 0, v31
    v_sqrt_f32 v31, v31
    s_nop 0
    v_cvt_pk_bf16_f32 v31, 0, v31
    v_rcp_f32 v31, v31
    s_nop 0
    v_mul_f32 v32, v193, v31
    v_ashrrev_i32 v196, 31, v32
    v_or_b32 v196, 0x80000000, v196
    v_xor_b32 v32, v32, v196
    s_mov_b32 s15, 0xfffff000
    v_and_or_b32 v32, v32, s15, v29
    s_nop 1
    v_max_u32_dpp v244, v32, v32 quad_perm:[1,0,3,2] row_mask:0xf bank_mask:0xf
    v_min_u32_dpp v245, v32, v32 quad_perm:[1,0,3,2] row_mask:0xf bank_mask:0xf
    s_nop 0
    v_min_u32_dpp v196, v244, v244 quad_perm:[2,3,0,1] row_mask:0xf bank_mask:0xf
    v_max_u32_dpp v245, v245, v245 quad_perm:[2,3,0,1] row_mask:0xf bank_mask:0xf
    v_max_u32_dpp v244, v244, v244 quad_perm:[2,3,0,1] row_mask:0xf bank_mask:0xf
    v_max_u32 v245, v245, v196
    s_nop 0
    v_min_u32_dpp v196, v244, v244 row_half_mirror row_mask:0xf bank_mask:0xf
    v_max_u32_dpp v245, v245, v245 row_half_mirror row_mask:0xf bank_mask:0xf
    v_max_u32_dpp v244, v244, v244 row_half_mirror row_mask:0xf bank_mask:0xf
    v_max_u32 v245, v245, v196
    s_nop 0
    v_min_u32_dpp v196, v244, v244 row_mirror row_mask:0xf bank_mask:0xf
    v_max_u32_dpp v245, v245, v245 row_mirror row_mask:0xf bank_mask:0xf
    v_max_u32_dpp v244, v244, v244 row_mirror row_mask:0xf bank_mask:0xf
    v_max_u32 v245, v245, v196
    ds_write_b64 v4, v[244:245]
    s_waitcnt lgkmcnt(0)
    s_barrier
    ds_read_b64 v[244:245], v5
    v_pk_add_f32 v[208:209], v[152:153], v[30:31] op_sel_hi:[1,0] neg_lo:[0,1] neg_hi:[0,1]
    v_pk_add_f32 v[210:211], v[154:155], v[30:31] op_sel_hi:[1,0] neg_lo:[0,1] neg_hi:[0,1]
    v_pk_add_f32 v[212:213], v[156:157], v[30:31] op_sel_hi:[1,0] neg_lo:[0,1] neg_hi:[0,1]
    v_pk_add_f32 v[214:215], v[158:159], v[30:31] op_sel_hi:[1,0] neg_lo:[0,1] neg_hi:[0,1]
    v_pk_add_f32 v[216:217], v[160:161], v[30:31] op_sel_hi:[1,0] neg_lo:[0,1] neg_hi:[0,1]
    v_pk_add_f32 v[218:219], v[162:163], v[30:31] op_sel_hi:[1,0] neg_lo:[0,1] neg_hi:[0,1]
    v_pk_add_f32 v[220:221], v[164:165], v[30:31] op_sel_hi:[1,0] neg_lo:[0,1] neg_hi:[0,1]
    v_pk_add_f32 v[222:223], v[166:167], v[30:31] op_sel_hi:[1,0] neg_lo:[0,1] neg_hi:[0,1]
    s_waitcnt lgkmcnt(0)
    v_min_u32_dpp v196, v244, v244 quad_perm:[1,0,3,2] row_mask:0xf bank_mask:0xf
    v_max_u32_dpp v245, v245, v245 quad_perm:[1,0,3,2] row_mask:0xf bank_mask:0xf
    v_max_u32_dpp v244, v244, v244 quad_perm:[1,0,3,2] row_mask:0xf bank_mask:0xf
    v_max_u32 v245, v245, v196
    s_nop 0
    v_min_u32_dpp v196, v244, v244 quad_perm:[2,3,0,1] row_mask:0xf bank_mask:0xf
    v_max_u32_dpp v245, v245, v245 quad_perm:[2,3,0,1] row_mask:0xf bank_mask:0xf
    v_max_u32_dpp v244, v244, v244 quad_perm:[2,3,0,1] row_mask:0xf bank_mask:0xf
    v_max_u32 v245, v245, v196
    s_nop 0
    v_min_u32_dpp v196, v244, v244 row_half_mirror row_mask:0xf bank_mask:0xf
    v_max_u32_dpp v245, v245, v245 row_half_mirror row_mask:0xf bank_mask:0xf
    v_max_u32_dpp v244, v244, v244 row_half_mirror row_mask:0xf bank_mask:0xf
    v_max_u32 v245, v245, v196
    v_cmp_eq_u32 s[88:89], v32, v245
    v_cmp_eq_u32 vcc, v32, v244
    v_or_b32 v246, 1, v245
    v_mov_b32 v245, s4
    v_mov_b32 v247, s4
    s_or_b64 s[84:85], vcc, s[88:89]
    s_cmp_lg_u32 s3, 0
    s_cbranch_scc1 L_NOF
    s_mov_b64 exec, 0xffff
    buffer_store_dwordx4 v[244:247], v6, s[32:35], s16 offen sc1
    s_mov_b64 exec, -1
L_NOF:
    s_cmp_eq_u64 s[84:85], 0
    s_cbranch_scc1 L_NOPR
    s_setprio 1
L_NOPR:
    s_lshl4_add_u32 s13, s3, 156288
    v_mov_b32 v4, s13
    v_and_b32 v5, 7, v1
    v_lshlrev_b32 v5, 4, v5
    v_add_u32 v5, 156288, v5
    s_load_dwordx8 s[24:31], s[32:33], s92 offset:2560 glc
    v_cvt_pk_bf16_f32 v208, 0, v208
    v_cvt_pk_bf16_f32 v209, 0, v209
    v_cvt_pk_bf16_f32 v210, 0, v210
    v_cvt_pk_bf16_f32 v211, 0, v211
    v_cvt_pk_bf16_f32 v212, 0, v212
    v_cvt_pk_bf16_f32 v213, 0, v213
    v_cvt_pk_bf16_f32 v214, 0, v214
    v_cvt_pk_bf16_f32 v215, 0, v215
    v_cvt_pk_bf16_f32 v216, 0, v216
    v_cvt_pk_bf16_f32 v217, 0, v217
    v_cvt_pk_bf16_f32 v218, 0, v218
    v_cvt_pk_bf16_f32 v219, 0, v219
    v_cvt_pk_bf16_f32 v220, 0, v220
    v_cvt_pk_bf16_f32 v221, 0, v221
    v_cvt_pk_bf16_f32 v222, 0, v222
    v_cvt_pk_bf16_f32 v223, 0, v223
    v_pk_mul_f32 v[208:209], v[30:31], v[208:209] op_sel:[1,0]
    v_pk_mul_f32 v[210:211], v[30:31], v[210:211] op_sel:[1,0]
    v_pk_mul_f32 v[212:213], v[30:31], v[212:213] op_sel:[1,0]
    v_pk_mul_f32 v[214:215], v[30:31], v[214:215] op_sel:[1,0]
    v_pk_mul_f32 v[216:217], v[30:31], v[216:217] op_sel:[1,0]
    v_pk_mul_f32 v[218:219], v[30:31], v[218:219] op_sel:[1,0]
    v_pk_mul_f32 v[220:221], v[30:31], v[220:221] op_sel:[1,0]
    v_pk_mul_f32 v[222:223], v[30:31], v[222:223] op_sel:[1,0]
    v_cvt_pk_bf16_f32 v208, 0, v208
    v_cvt_pk_bf16_f32 v209, 0, v209
    v_cvt_pk_bf16_f32 v210, 0, v210
    v_cvt_pk_bf16_f32 v211, 0, v211
    v_cvt_pk_bf16_f32 v212, 0, v212
    v_cvt_pk_bf16_f32 v213, 0, v213
    v_cvt_pk_bf16_f32 v214, 0, v214
    v_cvt_pk_bf16_f32 v215, 0, v215
    v_cvt_pk_bf16_f32 v216, 0, v216
    v_cvt_pk_bf16_f32 v217, 0, v217
    v_cvt_pk_bf16_f32 v218, 0, v218
    v_cvt_pk_bf16_f32 v219, 0, v219
    v_cvt_pk_bf16_f32 v220, 0, v220
    v_cvt_pk_bf16_f32 v221, 0, v221
    v_cvt_pk_bf16_f32 v222, 0, v222
    v_cvt_pk_bf16_f32 v223, 0, v223
    v_pk_mul_f32 v[208:209], v[208:209], v[168:169]
    v_pk_mul_f32 v[210:211], v[210:211], v[170:171]
    v_pk_mul_f32 v[212:213], v[212:213], v[172:173]
    v_pk_mul_f32 v[214:215], v[214:215], v[174:175]
    v_pk_mul_f32 v[216:217], v[216:217], v[176:177]
    v_pk_mul_f32 v[218:219], v[218:219], v[178:179]
    v_pk_mul_f32 v[220:221], v[220:221], v[180:181]
    v_pk_mul_f32 v[222:223], v[222:223], v[182:183]
    v_cvt_pk_bf16_f32 v208, 0, v208
    v_cvt_pk_bf16_f32 v209, 0, v209
    v_cvt_pk_bf16_f32 v210, 0, v210
    v_cvt_pk_bf16_f32 v211, 0, v211
    v_cvt_pk_bf16_f32 v212, 0, v212
    v_cvt_pk_bf16_f32 v213, 0, v213
    v_cvt_pk_bf16_f32 v214, 0, v214
    v_cvt_pk_bf16_f32 v215, 0, v215
    v_cvt_pk_bf16_f32 v216, 0, v216
    v_cvt_pk_bf16_f32 v217, 0, v217
    v_cvt_pk_bf16_f32 v218, 0, v218
    v_cvt_pk_bf16_f32 v219, 0, v219
    v_cvt_pk_bf16_f32 v220, 0, v220
    v_cvt_pk_bf16_f32 v221, 0, v221
    v_cvt_pk_bf16_f32 v222, 0, v222
    v_cvt_pk_bf16_f32 v223, 0, v223
    v_pk_add_f32 v[208:209], v[208:209], v[88:89]
    v_pk_add_f32 v[210:211], v[210:211], v[90:91]
    v_pk_add_f32 v[212:213], v[212:213], v[92:93]
    v_pk_add_f32 v[214:215], v[214:215], v[94:95]
    v_pk_add_f32 v[216:217], v[216:217], v[96:97]
    v_pk_add_f32 v[218:219], v[218:219], v[98:99]
    v_pk_add_f32 v[220:221], v[220:221], v[100:101]
    v_pk_add_f32 v[222:223], v[222:223], v[102:103]
    v_cvt_pk_bf16_f32 v224, v208, v209
    v_cvt_pk_bf16_f32 v225, v210, v211
    v_cvt_pk_bf16_f32 v226, v212, v213
    v_cvt_pk_bf16_f32 v227, v214, v215
    v_cvt_pk_bf16_f32 v228, v216, v217
    v_cvt_pk_bf16_f32 v229, v218, v219
    v_cvt_pk_bf16_f32 v230, v220, v221
    v_cvt_pk_bf16_f32 v231, v222, v223
    s_cmp_eq_u64 s[84:85], 0
    s_cbranch_scc1 L_NOCAND
    v_mfma_f32_16x16x32_bf16 v[240:243], v[184:187], v[224:227], 0
    v_mfma_f32_16x16x32_bf16 v[240:243], v[188:191], v[228:231], v[240:243]
    v_mov_b32 v232, v224
    v_mov_b32 v233, v225
    v_mov_b32 v234, v226
    v_mov_b32 v235, v227
    v_mov_b32 v236, v228
    v_mov_b32 v237, v229
    v_mov_b32 v238, v230
    v_mov_b32 v239, v231
    s_lshl_b32 s96, s21, 14
    s_lshl_b32 s97, s12, 9
    s_add_u32 s98, s96, s97
    s_add_u32 s15, s98, 13631488
    v_lshrrev_b32 v7, 4, v1
    v_lshlrev_b32 v7, 4, v7
    v_add_u32 v8, 8192, v7
    v_permlane32_swap_b32 v232, v234
    v_permlane32_swap_b32 v233, v235
    v_permlane32_swap_b32 v236, v238
    v_permlane32_swap_b32 v237, v239
    v_permlane32_swap_b32 v12, v14
    v_permlane32_swap_b32 v13, v15
    v_permlane32_swap_b32 v16, v18
    v_permlane32_swap_b32 v17, v19
    v_cndmask_b32 v7, v7, v8, s[88:89]
    s_mov_b64 exec, s[84:85]
    buffer_store_dwordx4 v[232:235], v7, s[32:35], s15 offen sc1
    buffer_store_dwordx4 v[236:239], v7, s[32:35], s15 offen offset:64 sc1
    s_mov_b32 exec_hi, 0
    s_and_b32 exec_lo, s84, 0xffff
    buffer_store_dword v243, v7, s[32:35], s15 offen offset:256 sc1
    s_mov_b64 exec, s[84:85]
    buffer_store_dwordx4 v[12:15], v7, s[32:35], s15 offen offset:128 sc1
    buffer_store_dwordx4 v[16:19], v7, s[32:35], s15 offen offset:192 sc1
    s_mov_b64 exec, -1
    s_setprio 0
L_NOCAND:
    s_add_u32 s82, s81, 8192
    s_lshl2_add_u32 m0, s83, 67584
    s_nop 0
    buffer_load_dwordx4 v253, s[60:63], s82 offen nt lds
    s_add_u32 s82, s81, 12288
    s_lshl2_add_u32 m0, s83, 68608
    s_nop 0
    buffer_load_dwordx4 v253, s[60:63], s82 offen nt lds
    v_lshlrev_b32 v208, 16, v224
    v_and_b32 v209, s6, v224
    v_lshlrev_b32 v210, 16, v225
    v_and_b32 v211, s6, v225
    v_lshlrev_b32 v212, 16, v226
    v_and_b32 v213, s6, v226
    v_lshlrev_b32 v214, 16, v227
    v_and_b32 v215, s6, v227
    v_lshlrev_b32 v216, 16, v228
    v_and_b32 v217, s6, v228
    v_lshlrev_b32 v218, 16, v229
    v_and_b32 v219, s6, v229
    v_lshlrev_b32 v220, 16, v230
    v_and_b32 v221, s6, v230
    v_lshlrev_b32 v222, 16, v231
    v_and_b32 v223, s6, v231
    v_pk_mul_f32 v[208:209], v[208:209], v[104:105]
    v_pk_mul_f32 v[210:211], v[210:211], v[106:107]
    v_pk_mul_f32 v[212:213], v[212:213], v[108:109]
    v_pk_mul_f32 v[214:215], v[214:215], v[110:111]
    v_pk_mul_f32 v[216:217], v[216:217], v[112:113]
    v_pk_mul_f32 v[218:219], v[218:219], v[114:115]
    v_pk_mul_f32 v[220:221], v[220:221], v[116:117]
    v_pk_mul_f32 v[222:223], v[222:223], v[118:119]
    v_cvt_pk_bf16_f32 v208, 0, v208
    v_cvt_pk_bf16_f32 v209, 0, v209
    v_cvt_pk_bf16_f32 v210, 0, v210
    v_cvt_pk_bf16_f32 v211, 0, v211
    v_cvt_pk_bf16_f32 v212, 0, v212
    v_cvt_pk_bf16_f32 v213, 0, v213
    v_cvt_pk_bf16_f32 v214, 0, v214
    v_cvt_pk_bf16_f32 v215, 0, v215
    v_cvt_pk_bf16_f32 v216, 0, v216
    v_cvt_pk_bf16_f32 v217, 0, v217
    v_cvt_pk_bf16_f32 v218, 0, v218
    v_cvt_pk_bf16_f32 v219, 0, v219
    v_cvt_pk_bf16_f32 v220, 0, v220
    v_cvt_pk_bf16_f32 v221, 0, v221
    v_cvt_pk_bf16_f32 v222, 0, v222
    v_cvt_pk_bf16_f32 v223, 0, v223
    s_branch SCHK_43
SPOLL_42:
    s_load_dwordx8 s[24:31], s[32:33], s92 offset:2560 glc
SCHK_43:
    s_add_u32 s5, s5, 1
    s_cmp_ge_u32 s5, 200000
    s_waitcnt lgkmcnt(0)
    s_cbranch_scc1 SDONE_44
    s_cmp_lg_u32 s25, s4
    s_cbranch_scc1 SPOLL_42
    s_cmp_lg_u32 s27, s4
    s_cbranch_scc1 SPOLL_42
    s_cmp_lg_u32 s29, s4
    s_cbranch_scc1 SPOLL_42
    s_cmp_lg_u32 s31, s4
    s_cbranch_scc1 SPOLL_42
SDONE_44:
    s_min_u32 s25, s24, s28
    s_min_u32 s27, s26, s28
    s_min_u32 s29, s24, s30
    s_max_u32 s24, s24, s28
    s_max_u32 s26, s26, s30
    s_max_u32 s27, s27, s29
    s_max_u32 s25, s25, s26
    v_mov_b32 v244, s24
    v_mov_b32 v246, s27
    v_mov_b32 v245, s25
    ds_write_b128 v4, v[244:247]
    s_waitcnt vmcnt(4)
    s_waitcnt lgkmcnt(0)
    s_barrier
    ds_read_b128 v[244:247], v5
    v_and_b32 v8, 8, v1
    v_cmp_eq_u32 s[22:23], 0, v8
    v_cmp_gt_u32 s[24:25], 16, v1
    v_cmp_gt_u32 s[26:27], 32, v1
    s_waitcnt lgkmcnt(0)
    v_min_u32_dpp v192, v244, v244 quad_perm:[1,0,3,2] row_mask:0xf bank_mask:0xf
    v_min_u32_dpp v193, v245, v244 quad_perm:[1,0,3,2] row_mask:0xf bank_mask:0xf
    v_min_u32_dpp v194, v244, v245 quad_perm:[1,0,3,2] row_mask:0xf bank_mask:0xf
    v_max_u32_dpp v246, v246, v246 quad_perm:[1,0,3,2] row_mask:0xf bank_mask:0xf
    v_max_u32_dpp v245, v245, v245 quad_perm:[1,0,3,2] row_mask:0xf bank_mask:0xf
    v_max_u32_dpp v244, v244, v244 quad_perm:[1,0,3,2] row_mask:0xf bank_mask:0xf
    v_max3_u32 v246, v246, v193, v194
    v_max_u32 v245, v245, v192
    v_min_u32_dpp v192, v244, v244 quad_perm:[2,3,0,1] row_mask:0xf bank_mask:0xf
    s_nop 0
    v_min_u32_dpp v193, v245, v244 quad_perm:[2,3,0,1] row_mask:0xf bank_mask:0xf
    v_min_u32_dpp v194, v244, v245 quad_perm:[2,3,0,1] row_mask:0xf bank_mask:0xf
    v_max_u32_dpp v246, v246, v246 quad_perm:[2,3,0,1] row_mask:0xf bank_mask:0xf
    v_max_u32_dpp v245, v245, v245 quad_perm:[2,3,0,1] row_mask:0xf bank_mask:0xf
    v_max_u32_dpp v244, v244, v244 quad_perm:[2,3,0,1] row_mask:0xf bank_mask:0xf
    v_max3_u32 v246, v246, v193, v194
    v_max_u32 v245, v245, v192
    v_min_u32_dpp v192, v244, v244 row_half_mirror row_mask:0xf bank_mask:0xf
    s_nop 0
    v_min_u32_dpp v193, v245, v244 row_half_mirror row_mask:0xf bank_mask:0xf
    v_min_u32_dpp v194, v244, v245 row_half_mirror row_mask:0xf bank_mask:0xf
    v_max_u32_dpp v246, v246, v246 row_half_mirror row_mask:0xf bank_mask:0xf
    v_max_u32_dpp v245, v245, v245 row_half_mirror row_mask:0xf bank_mask:0xf
    v_max_u32_dpp v244, v244, v244 row_half_mirror row_mask:0xf bank_mask:0xf
    v_max3_u32 v246, v246, v193, v194
    v_max_u32 v245, v245, v192
    v_cndmask_b32 v192, v245, v244, s[22:23]
    v_cndmask_b32 v201, v246, v245, s[26:27]
    v_and_b32 v193, 31, v246
    v_and_b32 v192, 31, v192
    v_cndmask_b32 v201, v201, v244, s[24:25]
    v_lshl_add_u32 v4, v192, 13, v52
    v_lshl_add_u32 v5, v193, 13, v52
    v_and_b32 v194, 31, v201
    v_lshl_add_u32 v6, v194, 13, v53
    buffer_load_dwordx4 v[192:195], v4, s[32:35], 0 offen sc1
    buffer_load_dwordx4 v[196:199], v5, s[32:35], 0 offen sc1
    buffer_load_dword v200, v6, s[32:35], 0 offen sc1
    v_readfirstlane_b32 s91, v244
    v_readfirstlane_b32 s94, v245
    v_readfirstlane_b32 s95, v246
    ds_read_b64_tr_b16 v[56:57], v34
    ds_read_b64_tr_b16 v[58:59], v34 offset:512
    ds_read_b64_tr_b16 v[60:61], v34 offset:1024
    ds_read_b64_tr_b16 v[62:63], v34 offset:1536
    ds_read_b64_tr_b16 v[64:65], v34 offset:2048
    ds_read_b64_tr_b16 v[66:67], v34 offset:2560
    ds_read_b64_tr_b16 v[68:69], v34 offset:3072
    ds_read_b64_tr_b16 v[70:71], v34 offset:3584
    ds_read_b64_tr_b16 v[72:73], v34 offset:4096
    ds_read_b64_tr_b16 v[74:75], v34 offset:4608
    ds_read_b64_tr_b16 v[76:77], v34 offset:5120
    ds_read_b64_tr_b16 v[78:79], v34 offset:5632
    ds_read_b64_tr_b16 v[80:81], v34 offset:6144
    ds_read_b64_tr_b16 v[82:83], v34 offset:6656
    ds_read_b64_tr_b16 v[84:85], v34 offset:7168
    ds_read_b64_tr_b16 v[86:87], v34 offset:7680
    s_lshl_b32 s96, s3, 11
    s_add_u32 s13, s96, 98304
    v_lshrrev_b32 v44, 4, v1
    v_lshlrev_b32 v44, 4, v44
    v_and_b32 v45, 7, v1
    v_lshlrev_b32 v45, 4, v45
    v_xor_b32 v44, v44, v45
    v_and_b32 v46, 15, v1
    v_lshl_add_u32 v46, v46, 7, s13
    v_add_u32 v44, v44, v46
    v_xor_b32 v46, 64, v44
    v_lshrrev_b32 v47, 3, v1
    v_lshlrev_b32 v47, 4, v47
    v_xor_b32 v45, v47, v45
    v_lshrrev_b32 v47, 3, v1
    v_lshl_add_u32 v47, v47, 7, s13
    v_add_u32 v45, v45, v47
    s_lshl_b32 s96, s21, 7
    s_sub_u32 s97, 2047, s96
    s_lshl_b32 s98, s3, 4
    s_sub_u32 s13, s97, s98
    v_lshrrev_b32 v43, 3, v1
    v_sub_u32 v42, s13, v43
    v_subrev_u32 v43, 8, v42
    v_lshrrev_b32 v33, 3, v1
    v_lshlrev_b32 v33, 11, v33
    v_and_b32 v9, 7, v1
    v_lshl_add_u32 v33, v9, 4, v33
    v_pk_add_f32 v[208:209], v[208:209], v[152:153]
    v_pk_add_f32 v[210:211], v[210:211], v[154:155]
    v_pk_add_f32 v[212:213], v[212:213], v[156:157]
    v_pk_add_f32 v[214:215], v[214:215], v[158:159]
    v_pk_add_f32 v[216:217], v[216:217], v[160:161]
    v_pk_add_f32 v[218:219], v[218:219], v[162:163]
    v_pk_add_f32 v[220:221], v[220:221], v[164:165]
    v_pk_add_f32 v[222:223], v[222:223], v[166:167]
    v_cvt_pk_bf16_f32 v232, v208, v209
    v_cvt_pk_bf16_f32 v233, v210, v211
    v_cvt_pk_bf16_f32 v234, v212, v213
    v_cvt_pk_bf16_f32 v235, v214, v215
    v_cvt_pk_bf16_f32 v236, v216, v217
    v_cvt_pk_bf16_f32 v237, v218, v219
    v_cvt_pk_bf16_f32 v238, v220, v221
    v_cvt_pk_bf16_f32 v239, v222, v223
    v_permlane32_swap_b32 v232, v234
    v_permlane32_swap_b32 v233, v235
    v_permlane32_swap_b32 v236, v238
    v_permlane32_swap_b32 v237, v239
    ds_write_b128 v44, v[232:235]
    ds_write_b128 v46, v[236:239]
    ds_read_b128 v[232:235], v45
    ds_read_b128 v[236:239], v45 offset:1024
    s_waitcnt lgkmcnt(0)
    v_bfe_u32 v7, v201, 1, 4
    v_bfe_u32 v201, v201, 5, 7
    v_lshl_or_b32 v201, v7, 7, v201
    v_xor_b32 v201, 0x7ff, v201
    s_waitcnt vmcnt(0)
    v_max3_u32 v7, v192, v196, v200
    v_cmp_eq_u32 vcc, -1, v7
    s_cbranch_vccz POK_46
PRE_47:
    buffer_load_dwordx4 v[192:195], v4, s[32:35], 0 offen sc1
    buffer_load_dwordx4 v[196:199], v5, s[32:35], 0 offen sc1
    buffer_load_dword v200, v6, s[32:35], 0 offen sc1
    s_waitcnt vmcnt(0)
    v_max3_u32 v7, v192, v196, v200
    v_cmp_eq_u32 vcc, -1, v7
    s_cbranch_vccz POK_46
    s_add_u32 s5, s5, 1
    s_cmp_lt_u32 s5, 200000
    s_cbranch_scc1 PRE_47
POK_46:
    v_add_f32_dpp v200, v200, v200 quad_perm:[1,0,3,2] row_mask:0xf bank_mask:0xf
    s_nop 1
    v_add_f32_dpp v200, v200, v200 quad_perm:[2,3,0,1] row_mask:0xf bank_mask:0xf
    s_nop 1
    v_add_f32_dpp v200, v200, v200 row_half_mirror row_mask:0xf bank_mask:0xf
    s_nop 1
    v_add_f32_dpp v200, v200, v200 row_mirror row_mask:0xf bank_mask:0xf
    v_cvt_pk_bf16_f32 v200, 0, v200
    v_ashrrev_i32 v7, 31, v200
    v_or_b32 v7, 0x80000000, v7
    v_xor_b32 v200, v200, v7
    v_lshrrev_b32 v200, 16, v200
    v_lshl_or_b32 v200, v200, 11, v201
    s_nop 0
    v_readlane_b32 s24, v200, 0
    v_readlane_b32 s25, v200, 16
    v_readlane_b32 s26, v200, 32
    s_not_b64 s[28:29], s[22:23]
    s_cmp_lt_u32 s24, s25
    s_cselect_b64 s[28:29], s[22:23], s[28:29]
    s_cselect_b32 s27, s24, s25
    s_cmp_gt_u32 s26, s27
    s_cselect_b64 vcc, s[28:29], 0
    v_cndmask_b32 v192, v192, v196, vcc
    v_cndmask_b32 v193, v193, v197, vcc
    v_cndmask_b32 v194, v194, v198, vcc
    v_cndmask_b32 v195, v195, v199, vcc
    s_bitcmp1_b32 vcc_lo, 0
    s_cselect_b32 s24, s26, s24
    s_cselect_b32 s19, s17, s19
    s_cselect_b32 s17, s95, s91
    s_bitcmp1_b32 vcc_lo, 8
    s_cselect_b32 s25, s26, s25
    s_cselect_b32 s19, s18, s19
    s_cselect_b32 s18, s95, s94
    s_waitcnt lgkmcnt(0)
    v_mfma_f32_16x16x32_bf16 v[136:139], v[192:195], v[56:59], 0
    v_mfma_f32_16x16x32_bf16 v[140:143], v[192:195], v[60:63], 0
    v_mfma_f32_16x16x32_bf16 v[144:147], v[192:195], v[64:67], 0
    v_mfma_f32_16x16x32_bf16 v[148:151], v[192:195], v[68:71], 0
    v_mfma_f32_16x16x32_bf16 v[168:171], v[192:195], v[72:75], 0
    v_mfma_f32_16x16x32_bf16 v[172:175], v[192:195], v[76:79], 0
    v_mfma_f32_16x16x32_bf16 v[176:179], v[192:195], v[80:83], 0
    v_mfma_f32_16x16x32_bf16 v[180:183], v[192:195], v[84:87], 0
    s_nop 1
    v_add_f32 v196, v136, v141
    s_nop 0
    v_add_f32 v197, v146, v151
    s_nop 0
    v_add_f32 v198, v168, v173
    s_nop 0
    v_add_f32 v199, v178, v183
    v_add_f32 v196, v196, v197
    v_add_f32 v198, v198, v199
    v_mov_b32 v197, s4
    s_nop 0
    v_permlane16_swap_b32 v198, v199
    s_cmp_ge_u32 s9, 28
    s_cbranch_scc1 L_NOHP
    v_add_f32 v196, v196, v199
    v_add_f32 v198, v196, 0
    v_mov_b32 v199, s4
    s_nop 0
    v_permlane32_swap_b32 v196, v198
    s_mov_b64 exec, 0xffff
    buffer_store_dwordx4 v[196:199], v2, s[32:35], s73 offen sc1
    s_mov_b64 exec, -1
L_NOHP:
    s_and_b32 s68, s24, 2047
    s_and_b32 s69, s25, 2047
    s_waitcnt lgkmcnt(0)
    s_cmp_lg_u32 s93, 7
    s_cbranch_scc1 L_NONON
    v_mov_b32 v6, s4
    v_mov_b32 v7, 0
    s_mov_b64 exec, 1
    buffer_store_dword v6, v7, s[32:35], 0 offen sc1
    s_mov_b64 exec, -1
L_NONON:
    s_cmp_ge_u32 s9, 28
    s_cbranch_scc1 L_FIN3
    v_bfe_u32 v192, v1, 2, 1
    v_lshlrev_b32 v192, 7, v192
    v_lshrrev_b32 v9, 5, v1
    v_lshl_add_u32 v192, v9, 4, v192
    v_add_u32 v192, 156672, v192
    v_lshrrev_b32 v193, 4, v1
    v_mul_u32_u24 v193, 7168, v193
    v_and_b32 v9, 15, v1
    v_lshl_add_u32 v193, v9, 3, v193
    s_lshl3_add_u32 s96, s75, s3
    s_mul_i32 s97, s96, 28672
    s_lshl_b32 s98, s74, 7
    s_add_u32 s99, s97, s98
    s_add_u32 s80, s99, 22020096
    v_and_b32 v194, 1, v1
    v_lshlrev_b32 v194, 13, v194
    v_bfe_u32 v9, v1, 1, 1
    v_lshl_add_u32 v194, v9, 18, v194
    s_lshr_b32 s96, s9, 2
    s_and_b32 s97, s75, 1
    s_lshr_b32 s98, s3, 1
    s_lshl2_add_u32 s99, s97, s98
    s_and_b32 s97, s3, 1
    s_lshr_b32 s98, s75, 1
    s_lshl2_add_u32 s97, s97, s98
    s_lshl3_add_u32 s98, s99, s97
    s_lshl_b32 s99, s98, 12
    s_lshl_b32 s97, s8, 6
    s_add_u32 s98, s99, s97
    s_lshl2_add_u32 s99, s96, s98
    s_add_u32 s97, s99, 1048576
    s_add_u32 s81, s97, 3072
    s_cmp_lt_u32 s3, 4
    s_cbranch_scc1 L_HW
    s_barrier
    ds_read_b64_tr_b16 v[120:121], v35
    ds_read_b64_tr_b16 v[122:123], v35 offset:1024
    ds_read_b64_tr_b16 v[124:125], v35 offset:8192
    ds_read_b64_tr_b16 v[126:127], v35 offset:9216
    ds_read_b64_tr_b16 v[128:129], v35 offset:16384
    ds_read_b64_tr_b16 v[130:131], v35 offset:17408
    ds_read_b64_tr_b16 v[132:133], v35 offset:24576
    ds_read_b64_tr_b16 v[134:135], v35 offset:25600
    s_cmp_lg_u32 s3, 7
    s_cbranch_scc1 L_NOH
    s_bitcmp1_b32 s9, 3
    s_cselect_b32 s15, s25, s24
    s_cselect_b32 s17, s18, s17
    s_andn2_b32 s18, 2047, s15
    s_lshr_b32 s96, s8, 1
    s_lshl2_add_u32 s19, s12, s96
    s_lshr_b32 s96, s19, 1
    s_lshr_b32 s97, s9, 3
    s_lshl_b32 s98, s97, 1
    s_lshl2_add_u32 s99, s96, s98
    s_and_b32 s97, s19, 1
    s_add_u32 s96, s99, s97
    s_mul_i32 s98, s96, 7168
    s_add_u32 s20, s98, 22020096
    s_lshl_b32 s96, s18, 11
    s_lshl_b32 s97, s19, 5
    s_add_u32 s82, s96, s97
    v_and_b32 v10, 7, v1
    v_lshlrev_b32 v10, 2, v10
    s_lshr_b32 s96, s8, 1
    s_lshl_b32 s97, s96, 6
    s_add_u32 s13, s97, 157184
    v_and_b32 v5, 7, v1
    v_lshl_add_u32 v5, v5, 3, s13
    ds_read_b64 v[206:207], v5
    s_and_b32 s96, s17, 31
    s_lshl_b32 s97, s96, 13
    s_lshl_b32 s98, s12, 9
    s_add_u32 s99, s97, s98
    s_lshr_b32 s96, s8, 1
    s_lshl_b32 s97, s96, 5
    s_add_u32 s98, s99, s97
    s_add_u32 s91, s98, 13631488
    s_lshr_b32 s13, s15, 11
    s_lshl_b32 s13, s13, 16
    s_ashr_i32 s15, s13, 31
    s_andn2_b32 s15, 0x7fff0000, s15
    s_or_b32 s15, s15, 0x80000000
    s_xor_b32 s13, s13, s15
    v_mov_b32 v204, s13
    v_mul_f32 v204, s7, v204
    v_exp_f32 v204, -v204
    s_nop 0
    v_add_f32 v204, 1.0, v204
    v_rcp_f32 v204, v204
L_PAD10:
    s_cbranch_execz L_RET10
    s_nop 0
    v_cvt_pk_bf16_f32 v204, 0, v204
    v_mov_b32 v5, s4
    v_not_b32 v6, v5
POLL_48:
    buffer_load_dword v244, v10, s[32:35], s91 offen sc1
    buffer_load_dword v245, v10, s[32:35], s91 offen offset:128 sc1
    s_waitcnt vmcnt(0)
    v_max_u32 v246, v244, v245
    v_cmp_ne_u32 vcc, -1, v246
    s_nop 1
    v_cndmask_b32 v246, v6, v5, vcc
    v_cmp_ne_u32 vcc, s4, v246
    s_cbranch_vccz PDONE_49
    s_add_u32 s5, s5, 1
    s_cmp_lt_u32 s5, 200000
    s_cbranch_scc1 POLL_48
PDONE_49:
    v_lshlrev_b32 v246, 16, v245
    v_and_b32 v247, s6, v245
    v_and_b32 v245, s6, v244
    v_lshlrev_b32 v244, 16, v244
    s_branch L_NOH
L_HW:
    s_lshl_b32 s96, s3, 8
    s_add_u32 s13, s96, s72
    v_lshrrev_b32 v4, 4, v1
    v_lshlrev_b32 v4, 11, v4
    v_and_b32 v9, 15, v1
    v_lshl_add_u32 v4, v9, 4, v4
    s_lshl_b32 s96, s3, 5
    s_add_u32 s15, s96, 156672
    v_lshrrev_b32 v5, 5, v1
    v_lshl_add_u32 v5, v5, 7, s15
    v_bfe_u32 v9, v1, 2, 1
    v_lshl_add_u32 v5, v9, 4, v5
    v_bfe_u32 v9, v1, 1, 1
    v_lshl_add_u32 v5, v9, 3, v5
    v_bfe_u32 v9, v1, 3, 1
    v_lshl_add_u32 v5, v9, 2, v5
    v_and_b32 v9, 1, v1
    v_lshl_add_u32 v5, v9, 1, v5
    s_load_dword s24, s[32:33], s13 offset:1276 glc
    s_load_dword s25, s[32:33], s13 offset:3324 glc
    s_load_dword s26, s[32:33], s13 offset:5372 glc
    s_load_dword s27, s[32:33], s13 offset:7420 glc
    s_barrier
    ds_read_b64_tr_b16 v[120:121], v35
    ds_read_b64_tr_b16 v[122:123], v35 offset:1024
    ds_read_b64_tr_b16 v[124:125], v35 offset:8192
    ds_read_b64_tr_b16 v[126:127], v35 offset:9216
    ds_read_b64_tr_b16 v[128:129], v35 offset:16384
    ds_read_b64_tr_b16 v[130:131], v35 offset:17408
    ds_read_b64_tr_b16 v[132:133], v35 offset:24576
    ds_read_b64_tr_b16 v[134:135], v35 offset:25600
    s_branch SCHK_51
SPOLL_50:
    s_load_dword s24, s[32:33], s13 offset:1276 glc
    s_load_dword s25, s[32:33], s13 offset:3324 glc
    s_load_dword s26, s[32:33], s13 offset:5372 glc
    s_load_dword s27, s[32:33], s13 offset:7420 glc
SCHK_51:
    s_add_u32 s5, s5, 1
    s_cmp_ge_u32 s5, 200000
    s_waitcnt lgkmcnt(0)
    s_cbranch_scc1 SDONE_52
    s_cmp_lg_u32 s24, s4
    s_cbranch_scc1 SPOLL_50
    s_cmp_lg_u32 s25, s4
    s_cbranch_scc1 SPOLL_50
    s_cmp_lg_u32 s26, s4
    s_cbranch_scc1 SPOLL_50
    s_cmp_lg_u32 s27, s4
    s_cbranch_scc1 SPOLL_50
SDONE_52:
POLL_53:
    buffer_load_dwordx4 v[88:91], v4, s[32:35], s13 offen sc1
    buffer_load_dwordx4 v[92:95], v4, s[32:35], s13 offen offset:1024 sc1
    s_waitcnt vmcnt(0)
    v_bitop3_b32 v6, v89, v91, s4 bitop3:0x7e
    v_bitop3_b32 v6, v6, v93, s4 bitop3:0xf6
    v_bitop3_b32 v6, v6, v95, s4 bitop3:0xf6
    v_cmp_ne_u32 vcc, 0, v6
    s_cbranch_vccz PDONE_54
    s_add_u32 s5, s5, 1
    s_cmp_lt_u32 s5, 200000
    s_cbranch_scc1 POLL_53
PDONE_54:
    v_permlane32_swap_b32 v88, v90
    v_permlane32_swap_b32 v92, v94
    v_add_f32 v88, v88, v90
    v_add_f32 v92, v92, v94
    v_mov_b32 v90, v88
    v_mov_b32 v94, v92
    s_nop 0
    v_permlane16_swap_b32 v88, v90
    v_permlane16_swap_b32 v92, v94
    v_add_f32 v88, v88, v90
    v_add_f32 v92, v92, v94
    v_cvt_pk_bf16_f32 v88, 0, v88
    v_cvt_pk_bf16_f32 v92, 0, v92
    v_mul_f32 v6, s7, v88
    v_exp_f32 v6, -v6
    s_nop 0
    v_add_f32 v6, 1.0, v6
    v_rcp_f32 v6, v6
    s_nop 0
    v_mul_f32 v88, v88, v6
    v_cvt_pk_bf16_f32 v88, 0, v88
    v_mul_f32 v88, v88, v92
    v_cvt_pk_bf16_f32 v88, v88, v88
    ds_write_b16 v5, v88
L_NOH:
    s_waitcnt lgkmcnt(0)
    s_barrier
    ds_read_b128 v[88:91], v192
    ds_read_b128 v[92:95], v192 offset:32
    ds_read_b128 v[96:99], v192 offset:64
    ds_read_b128 v[100:103], v192 offset:96
    s_waitcnt lgkmcnt(3)
    v_mfma_f32_32x32x16_bf16 v[208:223], v[88:91], v[120:123], 0
    s_waitcnt lgkmcnt(2)
    v_mfma_f32_32x32x16_bf16 v[208:223], v[92:95], v[124:127], v[208:223]
    s_waitcnt lgkmcnt(1)
    v_mfma_f32_32x32x16_bf16 v[208:223], v[96:99], v[128:131], v[208:223]
    s_waitcnt lgkmcnt(0)
    v_mfma_f32_32x32x16_bf16 v[208:223], v[100:103], v[132:135], v[208:223]
    s_nop 11
    v_mov_b32 v209, s4
    buffer_store_dwordx2 v[208:209], v193, s[32:35], s80 offen sc1
    s_mov_b64 exec, 15
    buffer_store_dword v209, v194, s[32:35], s81 offen sc1
    s_mov_b64 exec, -1
    s_barrier
    s_branch L_FIN2
L_FIN3:
    s_waitcnt lgkmcnt(0)
L_FIN2:
    v_cmp_ne_u32 vcc, s68, v42
    v_cmp_ne_u32 s[22:23], s69, v42
    s_nop 0
    s_and_b64 exec, vcc, s[22:23]
    buffer_store_dwordx4 v[232:235], v33, s[64:67], s70 offen sc1
    s_mov_b64 exec, -1
    v_cmp_ne_u32 vcc, s68, v43
    v_cmp_ne_u32 s[22:23], s69, v43
    s_nop 0
    s_and_b64 exec, vcc, s[22:23]
    buffer_store_dwordx4 v[236:239], v33, s[64:67], s71 offen sc1
    s_mov_b64 exec, -1
    s_cmp_ge_u32 s9, 16
    s_cbranch_scc1 L_FIN
SPOLL_55:
    s_load_dwordx8 s[24:31], s[32:33], s92 offset:3072 glc
SCHK_56:
    s_add_u32 s5, s5, 1
    s_cmp_ge_u32 s5, 200000
    s_waitcnt lgkmcnt(0)
    s_cbranch_scc1 SDONE_57
    s_cmp_lg_u32 s24, s4
    s_cbranch_scc1 SPOLL_55
    s_cmp_lg_u32 s25, s4
    s_cbranch_scc1 SPOLL_55
    s_cmp_lg_u32 s26, s4
    s_cbranch_scc1 SPOLL_55
    s_cmp_lg_u32 s27, s4
    s_cbranch_scc1 SPOLL_55
    s_cmp_lg_u32 s28, s4
    s_cbranch_scc1 SPOLL_55
    s_cmp_lg_u32 s29, s4
    s_cbranch_scc1 SPOLL_55
    s_cmp_lg_u32 s30, s4
    s_cbranch_scc1 SPOLL_55
SDONE_57:
    s_barrier
    s_cmp_lg_u32 s3, 7
    s_cbranch_scc1 L_FIN
    s_add_u32 s13, s20, 4096
POLL_58:
    buffer_load_dwordx4 v[88:91], v2, s[32:35], s20 offen sc1
    buffer_load_dwordx4 v[92:95], v2, s[32:35], s20 offen offset:1024 sc1
    buffer_load_dwordx4 v[96:99], v2, s[32:35], s20 offen offset:2048 sc1
    buffer_load_dwordx4 v[100:103], v2, s[32:35], s20 offen offset:3072 sc1
    buffer_load_dwordx4 v[104:107], v2, s[32:35], s13 offen sc1
    buffer_load_dwordx4 v[108:111], v2, s[32:35], s13 offen offset:1024 sc1
    buffer_load_dwordx4 v[112:115], v2, s[32:35], s13 offen offset:2048 sc1
    s_waitcnt vmcnt(0)
    v_bitop3_b32 v4, v89, v91, s4 bitop3:0x7e
    v_bitop3_b32 v4, v4, v93, s4 bitop3:0xf6
    v_bitop3_b32 v4, v4, v95, s4 bitop3:0xf6
    v_bitop3_b32 v4, v4, v97, s4 bitop3:0xf6
    v_bitop3_b32 v4, v4, v99, s4 bitop3:0xf6
    v_bitop3_b32 v4, v4, v101, s4 bitop3:0xf6
    v_bitop3_b32 v4, v4, v103, s4 bitop3:0xf6
    v_bitop3_b32 v4, v4, v105, s4 bitop3:0xf6
    v_bitop3_b32 v4, v4, v107, s4 bitop3:0xf6
    v_bitop3_b32 v4, v4, v109, s4 bitop3:0xf6
    v_bitop3_b32 v4, v4, v111, s4 bitop3:0xf6
    v_bitop3_b32 v4, v4, v113, s4 bitop3:0xf6
    v_bitop3_b32 v4, v4, v115, s4 bitop3:0xf6
    v_cmp_ne_u32 vcc, 0, v4
    s_cbranch_vccz PDONE_59
    s_add_u32 s5, s5, 1
    s_cmp_lt_u32 s5, 200000
    s_cbranch_scc1 POLL_58
PDONE_59:
    v_add_f32 v88, v88, v92
    v_add_f32 v90, v90, v94
    v_add_f32 v96, v96, v100
    v_add_f32 v98, v98, v102
    v_add_f32 v104, v104, v108
    v_add_f32 v106, v106, v110
    v_add_f32 v88, v88, v96
    v_add_f32 v90, v90, v98
    v_add_f32 v104, v104, v112
    v_add_f32 v106, v106, v114
    v_add_f32 v88, v88, v104
    v_add_f32 v89, v90, v106
    s_nop 1
    v_permlane32_swap_b32 v88, v89
    v_add_f32 v88, v88, v89
    s_nop 1
    v_add_f32_dpp v88, v88, v88 row_ror:8 row_mask:0xf bank_mask:0xf
    v_mov_b32 v89, v88
    s_nop 1
    v_permlane16_swap_b32 v88, v89
    v_add_f32 v89, v88, v89
    v_cvt_pk_bf16_f32 v88, 0, v89
    v_cvt_pk_bf16_f32 v89, 0, v89
    s_nop 1
    v_permlane32_swap_b32 v88, v89
    v_pk_mul_f32 v[88:89], v[88:89], v[204:205] op_sel_hi:[1,0]
    v_cvt_pk_bf16_f32 v88, 0, v88
    v_cvt_pk_bf16_f32 v89, 0, v89
    v_pk_add_f32 v[88:89], v[88:89], v[244:245]
    v_cvt_pk_bf16_f32 v88, 0, v88
    v_cvt_pk_bf16_f32 v89, 0, v89
    v_pk_mul_f32 v[88:89], v[88:89], v[206:207]
    v_cvt_pk_bf16_f32 v88, 0, v88
    v_cvt_pk_bf16_f32 v89, 0, v89
    v_pk_add_f32 v[88:89], v[88:89], v[246:247]
    v_cvt_pk_bf16_f32 v88, v88, v89
    s_mov_b64 exec, 0xff
    buffer_store_dword v88, v10, s[64:67], s82 offen
    s_mov_b64 exec, -1
L_FIN:
L_END:
    s_endpgm
.p2align 10
.fill 768, 4, 0xbf800000
.section .rodata,"a"
.p2align 6
.amdhsa_kernel adaLN_cond__linear_kernel_hedgehog__moe_arch_mod__prompt_kernel
  .amdhsa_next_free_vgpr 256
  .amdhsa_next_free_sgpr 102
  .amdhsa_accum_offset 256
  .amdhsa_group_segment_fixed_size 0
  .amdhsa_kernarg_size 112
  .amdhsa_user_sgpr_count 2
  .amdhsa_user_sgpr_kernarg_segment_ptr 1
  .amdhsa_system_sgpr_workgroup_id_x 1
  .amdhsa_float_denorm_mode_32 3
  .amdhsa_float_denorm_mode_16_64 3
.end_amdhsa_kernel
```

```asm
; @launch grid=(256,1,1) block=(512,1,1) lds=163840
.amdgcn_target "amdgcn-amd-amdhsa--gfx950"
.text
.globl adaLN_cond__linear_kernel_hedgehog__moe_arch_mod__prompt_kernel
.p2align 12
.type adaLN_cond__linear_kernel_hedgehog__moe_arch_mod__prompt_kernel,@function
adaLN_cond__linear_kernel_hedgehog__moe_arch_mod__prompt_kernel:
    s_load_dwordx16 s[68:83], s[0:1], 0
    s_load_dwordx8 s[84:91], s[0:1], 64
    s_load_dwordx2 s[32:33], s[0:1], 104
    s_cmp_ge_u32 s2, 256
    s_cbranch_scc1 L_END
    v_lshrrev_b32 v4, 6, v0
    v_and_b32 v1, 63, v0
    s_nop 0
    v_readfirstlane_b32 s3, v4
    v_lshlrev_b32 v2, 4, v1
    s_mov_b32 s38, 4194304
    s_mov_b32 s39, 0x20000
    s_mov_b32 s50, 12582912
    s_mov_b32 s51, 0x20000
    s_mov_b32 s34, 268435456
    s_mov_b32 s35, 0x20000
    s_mov_b32 s42, 6291456
    s_mov_b32 s43, 0x20000
    s_mov_b32 s46, 2097152
    s_mov_b32 s47, 0x20000
    s_mov_b32 s54, 7340032
    s_mov_b32 s55, 0x20000
    s_mov_b32 s58, 7340032
    s_mov_b32 s59, 0x20000
    s_mov_b32 s62, 7340032
    s_mov_b32 s63, 0x20000
    s_mov_b32 s66, 4194304
    s_mov_b32 s67, 0x20000
    s_mov_b32 s5, 0
    s_mov_b32 s6, 0xffff0000
    s_mov_b32 s7, 0x3fb8aa3b
    s_and_b32 s8, s2, 7
    s_lshr_b32 s9, s2, 3
    s_lshl3_add_u32 s93, s2, s3
    s_and_b32 s96, s8, 4
    s_lshr_b32 s97, s9, 2
    s_lshl1_add_u32 s10, s96, s97
    s_and_b32 s96, s8, 3
    s_and_b32 s97, s9, 3
    s_xor_b32 s98, s97, 2
    s_lshl2_add_u32 s11, s96, s98
    s_and_b32 s96, s8, 1
    s_and_b32 s97, s9, 7
    s_lshl3_add_u32 s12, s96, s97
    s_lshr_b32 s96, s8, 1
    s_lshr_b32 s97, s9, 3
    s_lshl2_add_u32 s21, s96, s97
    s_lshl_b32 s96, s2, 6
    s_add_u32 s97, s96, s3
    s_lshl_b32 s98, s97, 6
    s_add_u32 s92, s98, 1048576
    s_lshr_b32 s96, s8, 1
    s_lshl_b32 s97, s96, 8
    s_lshl3_add_u32 s98, s9, s97
    s_add_u32 s99, s98, s3
    s_lshl_b32 s96, s99, 12
    s_and_b32 s97, s8, 1
    s_lshl_b32 s98, s97, 10
    s_add_u32 s16, s96, s98
    v_and_b32 v8, 31, v1
    v_lshlrev_b32 v8, 4, v8
    v_lshrrev_b32 v9, 5, v1
    v_lshl_add_u32 v8, v9, 11, v8
    s_lshl3_add_u32 s96, s8, s3
    s_lshl_b32 s15, s96, 5
    s_mul_i32 s96, s15, 6144
    s_xor_b32 s97, s9, 1
    s_lshl_b32 s98, s97, 7
    s_add_u32 s13, s96, s98
    s_add_u32 s14, s13, 12288
    s_lshl3_add_u32 s96, s21, s3
    s_lshl_b32 s97, s96, 15
    s_lshl_b32 s98, s12, 7
    s_add_u32 s18, s97, s98
    s_lshr_b32 s96, s8, 1
    s_lshl4_add_u32 s97, s96, s12
    s_lshl4_add_u32 s98, s97, s3
    s_lshl_b32 s99, s98, 9
    s_add_u32 s17, s99, 524288
    v_lshrrev_b32 v248, 3, v1
    v_mul_u32_u24 v248, 24576, v248
    v_and_b32 v9, 7, v1
    v_lshl_add_u32 v248, v9, 4, v248
    v_lshrrev_b32 v249, 3, v1
    v_lshl_add_u32 v249, v249, 2, s15
    v_and_b32 v10, 7, v1
    v_lshlrev_b32 v10, 4, v10
    v_lshrrev_b32 v11, 3, v1
    v_lshlrev_b32 v11, 4, v11
    v_xor_b32 v10, v10, v11
    v_lshrrev_b32 v11, 3, v1
    v_lshlrev_b32 v11, 11, v11
    v_add_u32 v10, v10, v11
    s_waitcnt lgkmcnt(0)
    global_load_dword v169, v249, s[86:87]
    s_mov_b64 s[48:49], s[88:89]
    buffer_load_dwordx4 v[160:163], v248, s[48:51], s13 offen nt
    buffer_load_dwordx4 v[164:167], v248, s[48:51], s14 offen nt
    s_load_dword s4, s[32:33], 0
    s_mov_b64 s[36:37], s[68:69]
    s_load_dword s24, s[32:33], s92 offset:0 glc
    s_load_dword s25, s[32:33], s17 offset:508 glc
    s_load_dword s26, s[32:33], s17 offset:4604 glc
    s_barrier
    buffer_load_dwordx4 v[152:155], v8, s[36:39], s16 offen nt
    buffer_load_dwordx4 v[156:159], v8, s[36:39], s16 offen offset:512 nt
    s_mov_b64 s[40:41], s[70:71]
    s_mov_b64 s[44:45], s[74:75]
    s_mov_b64 s[52:53], s[80:81]
    s_mov_b64 s[56:57], s[82:83]
    s_mov_b64 s[60:61], s[84:85]
    s_mov_b64 s[64:65], s[90:91]
    s_getpc_b64 s[22:23]
    s_and_b32 s22, s22, 0xfffffc00
    s_lshl3_add_u32 s96, s9, s3
    s_lshl_b32 s19, s96, 7
    v_lshrrev_b32 v4, 5, v1
    v_lshl_add_u32 v4, v4, 15, s19
    v_min_u32 v4, 40960, v4
    global_load_dword v11, v4, s[22:23]
    s_lshr_b32 s76, s3, 2
    s_and_b32 s77, s3, 3
    s_lshl_b32 s83, s3, 10
    s_mul_i32 s96, s8, 7
    s_lshr_b32 s97, s9, 2
    s_add_u32 s74, s96, s97
    s_and_b32 s75, s9, 3
    v_bfe_u32 v6, v1, 4, 1
    v_lshlrev_b32 v6, 6, v6
    v_and_b32 v3, 7, v1
    v_lshlrev_b32 v3, 4, v3
    v_xor_b32 v3, v3, v6
    v_lshrrev_b32 v6, 3, v1
    v_mul_u32_u24 v6, 6144, v6
    v_add_u32 v3, v3, v6
    s_and_b32 s84, s9, 12
    s_mul_i32 s96, s3, 49152
    s_lshl_b32 s97, s11, 7
    s_add_u32 s85, s96, s97
    v_lshlrev_b32 v250, 3, v1
    v_add_u32 v251, 147456, v2
    s_lshr_b32 s96, s3, 2
    s_lshl_b32 s97, s96, 10
    s_add_u32 s13, s97, 147456
    s_and_b32 s14, s3, 3
    v_and_b32 v252, 3, v1
    v_xor_b32 v252, s14, v252
    v_lshl_add_u32 v252, v252, 2, s13
    v_lshrrev_b32 v6, 4, v1
    v_lshlrev_b32 v6, 5, v6
    v_and_b32 v9, 7, v1
    v_lshl_add_u32 v6, v9, 7, v6
    v_bfe_u32 v9, v1, 3, 1
    v_lshl_add_u32 v6, v9, 4, v6
    v_add_u32 v252, v252, v6
    s_lshl_b32 s96, s3, 11
    s_add_u32 m0, s96, 131072
    s_nop 0
    buffer_load_dwordx4 v10, s[36:39], s18 offen lds
    s_add_u32 s18, s18, 16384
    s_lshl_b32 s96, s3, 11
    s_add_u32 m0, s96, 132096
    s_nop 0
    buffer_load_dwordx4 v10, s[36:39], s18 offen lds
    s_lshr_b32 s96, s3, 1
    s_xor_b32 s97, s9, 1
    s_and_b32 s98, s97, 15
    s_lshl4_add_u32 s99, s96, s98
    s_lshr_b32 s97, s9, 4
    s_lshl1_add_u32 s96, s99, s97
    s_lshl3_add_u32 s98, s96, s8
    s_lshl_b32 s99, s98, 9
    s_add_u32 s13, s99, 524288
    s_and_b32 s96, s9, 24
    s_add_u32 s97, s96, s3
    s_and_b32 s98, s8, 6
    s_lshl3_add_u32 s99, s97, s98
    s_lshl_b32 s96, s99, 12
    s_and_b32 s97, s9, 7
    s_lshl_b32 s98, s97, 9
    s_add_u32 s99, s96, s98
    s_and_b32 s97, s8, 1
    s_lshl_b32 s96, s97, 8
    s_add_u32 s98, s99, s96
    s_add_u32 s20, s98, 2097152
    s_waitcnt vmcnt(7)
    v_lshlrev_b32 v168, 16, v169
    v_and_b32 v169, s6, v169
    v_mul_f32 v4, s7, v168
    v_exp_f32 v4, -v4
    s_nop 0
    v_add_f32 v4, 1.0, v4
    v_rcp_f32 v4, v4
    s_nop 0
    v_mul_f32 v168, v168, v4
    v_cvt_pk_bf16_f32 v168, 0, v168
    v_mul_f32 v5, s7, v169
    v_exp_f32 v5, -v5
    s_nop 0
    v_add_f32 v5, 1.0, v5
    v_rcp_f32 v5, v5
    s_nop 0
    v_mul_f32 v169, v169, v5
    v_cvt_pk_bf16_f32 v169, 0, v169
    s_waitcnt vmcnt(5)
    s_lshr_b32 s96, s9, 4
    s_lshl_b32 s94, s96, 1
    s_add_u32 s96, s94, s84
    s_and_b32 s97, s96, 15
    s_mul_i32 s98, s97, 393216
    s_add_u32 s91, s98, s85
    s_lshl_b32 s96, s94, 13
    s_add_u32 s94, s96, s83
    s_add_u32 s82, s91, 2048
    s_mov_b32 m0, s94
    s_nop 0
    buffer_load_dwordx4 v3, s[40:43], s82 offen lds
    s_add_u32 s82, s91, 4096
    s_add_u32 m0, s94, 49152
    s_nop 0
    buffer_load_dwordx4 v3, s[40:43], s82 offen lds
    v_lshlrev_b32 v4, 16, v160
    v_and_b32 v5, s6, v160
    v_pk_mul_f32 v[176:177], v[168:169], v[4:5] op_sel:[0,0] op_sel_hi:[0,1]
    v_lshlrev_b32 v6, 16, v161
    v_and_b32 v7, s6, v161
    v_pk_mul_f32 v[178:179], v[168:169], v[6:7] op_sel:[0,0] op_sel_hi:[0,1]
    v_lshlrev_b32 v4, 16, v162
    v_and_b32 v5, s6, v162
    v_pk_mul_f32 v[180:181], v[168:169], v[4:5] op_sel:[0,0] op_sel_hi:[0,1]
    v_lshlrev_b32 v6, 16, v163
    v_and_b32 v7, s6, v163
    v_pk_mul_f32 v[182:183], v[168:169], v[6:7] op_sel:[0,0] op_sel_hi:[0,1]
    v_lshlrev_b32 v4, 16, v164
    v_and_b32 v5, s6, v164
    v_pk_fma_f32 v[176:177], v[168:169], v[4:5], v[176:177] op_sel:[1,0,0] op_sel_hi:[1,1,1]
    v_lshlrev_b32 v6, 16, v165
    v_and_b32 v7, s6, v165
    v_pk_fma_f32 v[178:179], v[168:169], v[6:7], v[178:179] op_sel:[1,0,0] op_sel_hi:[1,1,1]
    v_lshlrev_b32 v4, 16, v166
    v_and_b32 v5, s6, v166
    v_pk_fma_f32 v[180:181], v[168:169], v[4:5], v[180:181] op_sel:[1,0,0] op_sel_hi:[1,1,1]
    v_lshlrev_b32 v6, 16, v167
    v_and_b32 v7, s6, v167
    v_pk_fma_f32 v[182:183], v[168:169], v[6:7], v[182:183] op_sel:[1,0,0] op_sel_hi:[1,1,1]
    v_permlane32_swap_b32 v176, v180
    v_permlane32_swap_b32 v177, v181
    v_permlane32_swap_b32 v178, v182
    v_permlane32_swap_b32 v179, v183
    v_add_f32 v176, v176, v180
    v_add_f32 v177, v177, v181
    v_add_f32 v178, v178, v182
    v_add_f32 v179, v179, v183
    s_nop 0
    v_permlane16_swap_b32 v176, v178
    v_permlane16_swap_b32 v177, v179
    v_add_f32 v176, v176, v178
    v_add_f32 v177, v177, v179
    s_nop 0
    v_add_f32_dpp v176, v176, v176 row_ror:8 row_mask:0xf bank_mask:0xf
    v_add_f32_dpp v177, v177, v177 row_ror:8 row_mask:0xf bank_mask:0xf
    s_nop 1
    v_mov_b32_dpp v176, v177 quad_perm:[0,1,2,3] row_mask:0xf bank_mask:0xc
    s_waitcnt lgkmcnt(0)
    s_mul_i32 s4, s4, 0x9e3779b1
    s_add_u32 s4, s4, 0x7f4a7c15
    ds_write_b32 v252, v176
    s_waitcnt lgkmcnt(0)
    s_barrier
    ds_read_b128 v[176:179], v251
    ds_read_b128 v[180:183], v251 offset:1024
    s_waitcnt lgkmcnt(0)
    v_pk_add_f32 v[176:177], v[176:177], v[178:179]
    v_pk_add_f32 v[180:181], v[180:181], v[182:183]
    v_pk_add_f32 v[176:177], v[176:177], v[180:181]
    v_add_f32 v176, v176, v177
    v_mov_b32 v177, s4
    s_bitcmp1_b32 s3, 0
    s_cselect_b32 exec_lo, 0, -1
    s_cselect_b32 exec_hi, -1, 0
    buffer_store_dwordx2 v[176:177], v250, s[32:35], s13 offen sc1
    s_mov_b64 exec, -1
    s_waitcnt vmcnt(6)
    v_mov_b32 v8, 0x3f803f80
    v_dot2_f32_bf16 v4, v152, v8, 0
    v_dot2_f32_bf16 v5, v152, v152, 0
    v_dot2_f32_bf16 v6, v153, v8, 0
    v_dot2_f32_bf16 v7, v153, v153, 0
    v_dot2_f32_bf16 v4, v154, v8, v4
    v_dot2_f32_bf16 v5, v154, v154, v5
    v_dot2_f32_bf16 v6, v155, v8, v6
    v_dot2_f32_bf16 v7, v155, v155, v7
    v_dot2_f32_bf16 v4, v156, v8, v4
    v_dot2_f32_bf16 v5, v156, v156, v5
    v_dot2_f32_bf16 v6, v157, v8, v6
    v_dot2_f32_bf16 v7, v157, v157, v7
    v_dot2_f32_bf16 v4, v158, v8, v4
    v_dot2_f32_bf16 v5, v158, v158, v5
    v_dot2_f32_bf16 v6, v159, v8, v6
    v_dot2_f32_bf16 v7, v159, v159, v7
    s_lshl_b32 s96, s3, 5
    s_add_u32 s13, s96, 153600
    v_lshrrev_b32 v8, 5, v1
    v_lshl_add_u32 v8, v8, 4, s13
    v_bfe_u32 v9, v1, 4, 1
    v_lshl_add_u32 v8, v9, 3, v8
    v_pk_add_f32 v[172:173], v[4:5], v[6:7]
    v_and_b32 v5, 15, v1
    v_lshlrev_b32 v5, 4, v5
    v_add_u32 v5, 153600, v5
    v_and_b32 v4, 15, v1
    v_lshlrev_b32 v4, 4, v4
    v_bfe_u32 v9, v1, 4, 1
    v_lshl_add_u32 v4, v9, 12, v4
    v_add_f32_dpp v172, v172, v172 quad_perm:[1,0,3,2] row_mask:0xf bank_mask:0xf
    v_add_f32_dpp v173, v173, v173 quad_perm:[1,0,3,2] row_mask:0xf bank_mask:0xf
    s_nop 0
    v_add_f32_dpp v172, v172, v172 quad_perm:[2,3,0,1] row_mask:0xf bank_mask:0xf
    v_add_f32_dpp v173, v173, v173 quad_perm:[2,3,0,1] row_mask:0xf bank_mask:0xf
    s_nop 0
    v_add_f32_dpp v172, v172, v172 row_half_mirror row_mask:0xf bank_mask:0xf
    v_add_f32_dpp v173, v173, v173 row_half_mirror row_mask:0xf bank_mask:0xf
    s_nop 0
    v_add_f32_dpp v172, v172, v172 row_mirror row_mask:0xf bank_mask:0xf
    v_add_f32_dpp v173, v173, v173 row_mirror row_mask:0xf bank_mask:0xf
    s_nop 1
    v_permlane16_swap_b32 v172, v173
    v_add_f32 v172, v172, v173
    v_mov_b32 v173, s4
    ds_write_b64 v8, v[172:173]
    s_waitcnt lgkmcnt(0)
    s_barrier
    ds_read_b128 v[172:175], v5
    s_waitcnt lgkmcnt(0)
    s_mov_b32 exec_hi, 0
    buffer_store_dwordx4 v[172:175], v4, s[32:35], s20 offen sc1
    s_mov_b32 exec_hi, -1
    s_mov_b32 s82, s91
    s_add_u32 m0, s94, 98304
    s_nop 0
    buffer_load_dwordx4 v3, s[40:43], s82 offen lds
    s_lshr_b32 s96, s9, 4
    s_lshl_b32 s97, s96, 1
    s_xor_b32 s94, s97, 1
    s_add_u32 s96, s94, s84
    s_and_b32 s97, s96, 15
    s_mul_i32 s98, s97, 393216
    s_add_u32 s91, s98, s85
    s_lshl_b32 s96, s94, 13
    s_add_u32 s94, s96, s83
    s_add_u32 s82, s91, 2048
    s_mov_b32 m0, s94
    s_nop 0
    buffer_load_dwordx4 v3, s[40:43], s82 offen lds
    s_load_dword s24, s[32:33], s17 offset:508 glc
    s_load_dword s25, s[32:33], s17 offset:4604 glc
    v_and_b32 v4, 31, v1
    v_lshlrev_b32 v4, 4, v4
    v_lshrrev_b32 v9, 5, v1
    v_lshl_add_u32 v4, v9, 12, v4
    s_and_b32 s14, s3, 3
    s_lshr_b32 s96, s3, 2
    s_lshl_b32 s97, s96, 10
    s_add_u32 s15, s97, 155648
    v_bfe_u32 v5, v1, 4, 1
    v_bfe_u32 v9, v1, 2, 1
    v_lshl_add_u32 v5, v9, 1, v5
    v_xor_b32 v5, s14, v5
    v_lshl_add_u32 v5, v5, 2, s15
    v_and_b32 v6, 1, v1
    v_lshlrev_b32 v6, 5, v6
    v_bfe_u32 v9, v1, 3, 2
    v_lshl_add_u32 v6, v9, 6, v6
    v_bfe_u32 v9, v1, 2, 1
    v_lshl_add_u32 v6, v9, 8, v6
    v_bfe_u32 v9, v1, 1, 1
    v_lshl_add_u32 v6, v9, 9, v6
    v_lshrrev_b32 v9, 5, v1
    v_lshl_add_u32 v6, v9, 11, v6
    v_add_u32 v5, v5, v6
    s_lshl3_add_u32 s96, s2, s3
    s_lshl_b32 s97, s96, 9
    s_add_u32 s14, s97, 2097152
    v_and_b32 v8, 31, v1
    v_lshlrev_b32 v8, 4, v8
    s_branch SCHK_2
SPOLL_1:
    s_load_dword s24, s[32:33], s17 offset:508 glc
    s_load_dword s25, s[32:33], s17 offset:4604 glc
SCHK_2:
    s_add_u32 s5, s5, 1
    s_cmp_ge_u32 s5, 200000
    s_waitcnt lgkmcnt(0)
    s_cbranch_scc1 SDONE_3
    s_cmp_lg_u32 s24, s4
    s_cbranch_scc1 SPOLL_1
    s_cmp_lg_u32 s25, s4
    s_cbranch_scc1 SPOLL_1
SDONE_3:
    buffer_load_dwordx4 v[176:179], v4, s[32:35], s17 offen sc1
    s_load_dword s24, s[32:33], s14 offset:252 glc
    s_load_dword s25, s[32:33], s14 offset:508 glc
    s_lshl_b32 s96, s3, 11
    s_add_u32 s15, s96, 131072
    v_lshrrev_b32 v216, 4, v1
    v_lshlrev_b32 v216, 4, v216
    v_and_b32 v217, 7, v1
    v_lshlrev_b32 v217, 4, v217
    v_xor_b32 v216, v216, v217
    v_and_b32 v217, 15, v1
    v_lshl_add_u32 v217, v217, 7, s15
    v_add_u32 v216, v216, v217
    v_xor_b32 v217, 64, v216
    s_waitcnt vmcnt(7)
    ds_read_b128 v[12:15], v216
    ds_read_b128 v[16:19], v217
    s_branch SCHK_6
SPOLL_5:
    s_load_dword s24, s[32:33], s14 offset:252 glc
    s_load_dword s25, s[32:33], s14 offset:508 glc
SCHK_6:
    s_add_u32 s5, s5, 1
    s_cmp_ge_u32 s5, 200000
    s_waitcnt lgkmcnt(0)
    s_cbranch_scc1 SDONE_7
    s_cmp_lg_u32 s24, s4
    s_cbranch_scc1 SPOLL_5
    s_cmp_lg_u32 s25, s4
    s_cbranch_scc1 SPOLL_5
SDONE_7:
    buffer_load_dwordx4 v[172:175], v8, s[32:35], s14 offen sc1
    s_add_u32 s82, s91, 4096
    s_add_u32 m0, s94, 49152
    s_nop 0
    buffer_load_dwordx4 v3, s[40:43], s82 offen lds
    s_mov_b32 s82, s91
    s_add_u32 m0, s94, 98304
    s_nop 0
    buffer_load_dwordx4 v3, s[40:43], s82 offen lds
    v_permlane32_swap_b32 v12, v14
    v_permlane32_swap_b32 v13, v15
    v_permlane32_swap_b32 v16, v18
    v_permlane32_swap_b32 v17, v19
    v_lshlrev_b32 v184, 16, v12
    v_and_b32 v185, s6, v12
    v_lshlrev_b32 v186, 16, v13
    v_and_b32 v187, s6, v13
    v_lshlrev_b32 v188, 16, v14
    v_and_b32 v189, s6, v14
    v_lshlrev_b32 v190, 16, v15
    v_and_b32 v191, s6, v15
    v_lshlrev_b32 v192, 16, v16
    v_and_b32 v193, s6, v16
    v_lshlrev_b32 v194, 16, v17
    v_and_b32 v195, s6, v17
    v_lshlrev_b32 v196, 16, v18
    v_and_b32 v197, s6, v18
    v_lshlrev_b32 v198, 16, v19
    v_and_b32 v199, s6, v19
    s_waitcnt vmcnt(3)
    v_bitop3_b32 v7, v177, v179, s4 bitop3:0x7e
    v_cmp_ne_u32 vcc, 0, v7
    s_cbranch_vccz TOK_8
POLL_9:
    buffer_load_dwordx4 v[176:179], v4, s[32:35], s17 offen sc1
    s_waitcnt vmcnt(0)
    v_bitop3_b32 v7, v177, v179, s4 bitop3:0x7e
    v_cmp_ne_u32 vcc, 0, v7
    s_cbranch_vccz PDONE_10
    s_add_u32 s5, s5, 1
    s_cmp_lt_u32 s5, 200000
    s_cbranch_scc1 POLL_9
PDONE_10:
TOK_8:
    ds_write2_b32 v5, v176, v178 offset0:0 offset1:4
    s_waitcnt lgkmcnt(0)
    s_barrier
    ds_read_b128 v[208:211], v251 offset:10240
    ds_read_b128 v[212:215], v251 offset:11264
    ds_read_b128 v[200:203], v251 offset:8192
    ds_read_b128 v[204:207], v251 offset:9216
    s_lshl_b32 s96, s11, 12
    s_lshl_b32 s97, s3, 9
    s_add_u32 s13, s96, s97
    v_add_u32 v4, s13, v2
    s_lshl_b32 s96, s3, 9
    s_add_u32 m0, s96, 159744
    s_mov_b32 exec_hi, 0
    global_load_lds_dwordx4 v4, s[72:73]
    s_mov_b32 exec_hi, -1
    s_lshl4_add_u32 s96, s21, s12
    s_lshr_b32 s97, s3, 1
    s_lshl2_add_u32 s98, s96, s97
    s_lshl_b32 s99, s98, 12
    s_and_b32 s96, s3, 1
    s_lshl_b32 s97, s96, 8
    s_add_u32 s98, s99, s97
    s_add_u32 s13, s98, 4194304
    v_and_b32 v4, 15, v1
    v_lshlrev_b32 v4, 4, v4
    v_bfe_u32 v9, v1, 4, 1
    v_lshl_add_u32 v4, v9, 10, v4
    v_lshrrev_b32 v9, 5, v1
    v_lshl_add_u32 v4, v9, 9, v4
    s_waitcnt lgkmcnt(2)
    v_pk_add_f32 v[208:209], v[208:209], v[210:211]
    v_pk_add_f32 v[212:213], v[212:213], v[214:215]
    v_pk_add_f32 v[208:209], v[208:209], v[212:213]
    v_add_f32 v208, v208, v209
    v_cvt_pk_bf16_f32 v208, 0, v208
    s_waitcnt lgkmcnt(0)
    v_pk_add_f32 v[200:201], v[200:201], v[202:203]
    v_pk_add_f32 v[204:205], v[204:205], v[206:207]
    v_pk_add_f32 v[200:201], v[200:201], v[204:205]
    v_add_f32 v200, v200, v201
    v_add_f32 v208, 1.0, v208
    v_cvt_pk_bf16_f32 v208, 0, v208
    v_cvt_pk_bf16_f32 v200, 0, v200
    s_waitcnt vmcnt(3)
    v_bitop3_b32 v7, v173, v175, s4 bitop3:0x7e
    v_cmp_ne_u32 vcc, 0, v7
    s_cbranch_vccz L_STOK
POLL_11:
    buffer_load_dwordx4 v[172:175], v8, s[32:35], s14 offen sc1
    s_waitcnt vmcnt(0)
    v_bitop3_b32 v7, v173, v175, s4 bitop3:0x7e
    v_cmp_ne_u32 vcc, 0, v7
    s_cbranch_vccz PDONE_12
    s_add_u32 s5, s5, 1
    s_cmp_lt_u32 s5, 200000
    s_cbranch_scc1 POLL_11
PDONE_12:
L_STOK:
    v_permlane16_swap_b32 v172, v174
    v_add_f32 v175, v172, v174
    v_mul_f32 v174, 0x3a800000, v175
    v_mul_f32 v175, 0x3a800000, v175
    s_nop 1
    v_permlane16_swap_b32 v174, v175
    v_fma_f32 v172, -v174, v174, v175
    v_cvt_pk_bf16_f32 v173, 0, v174
    v_max_f32 v172, 0, v172
    v_cvt_pk_bf16_f32 v172, 0, v172
    v_pk_add_f32 v[184:185], v[172:173], v[184:185] op_sel:[1,0] neg_lo:[1,0] neg_hi:[1,0]
    v_pk_add_f32 v[186:187], v[172:173], v[186:187] op_sel:[1,0] neg_lo:[1,0] neg_hi:[1,0]
    v_pk_add_f32 v[188:189], v[172:173], v[188:189] op_sel:[1,0] neg_lo:[1,0] neg_hi:[1,0]
    v_pk_add_f32 v[190:191], v[172:173], v[190:191] op_sel:[1,0] neg_lo:[1,0] neg_hi:[1,0]
    v_add_f32 v172, 0x3727c5ac, v172
    v_cvt_pk_bf16_f32 v172, 0, v172
    v_sqrt_f32 v172, v172
    s_nop 0
    v_pk_add_f32 v[192:193], v[172:173], v[192:193] op_sel:[1,0] neg_lo:[1,0] neg_hi:[1,0]
    v_pk_add_f32 v[194:195], v[172:173], v[194:195] op_sel:[1,0] neg_lo:[1,0] neg_hi:[1,0]
    v_pk_add_f32 v[196:197], v[172:173], v[196:197] op_sel:[1,0] neg_lo:[1,0] neg_hi:[1,0]
    v_pk_add_f32 v[198:199], v[172:173], v[198:199] op_sel:[1,0] neg_lo:[1,0] neg_hi:[1,0]
    v_cvt_pk_bf16_f32 v172, 0, v172
    v_rcp_f32 v172, v172
    v_cvt_pk_bf16_f32 v184, 0, v184
    v_cvt_pk_bf16_f32 v185, 0, v185
    v_cvt_pk_bf16_f32 v186, 0, v186
    v_cvt_pk_bf16_f32 v187, 0, v187
    v_cvt_pk_bf16_f32 v188, 0, v188
    v_cvt_pk_bf16_f32 v189, 0, v189
    v_cvt_pk_bf16_f32 v190, 0, v190
    v_cvt_pk_bf16_f32 v191, 0, v191
    v_cvt_pk_bf16_f32 v192, 0, v192
    v_cvt_pk_bf16_f32 v193, 0, v193
    v_cvt_pk_bf16_f32 v194, 0, v194
    v_cvt_pk_bf16_f32 v195, 0, v195
    v_cvt_pk_bf16_f32 v196, 0, v196
    v_cvt_pk_bf16_f32 v197, 0, v197
    v_cvt_pk_bf16_f32 v198, 0, v198
    v_cvt_pk_bf16_f32 v199, 0, v199
    v_pk_mul_f32 v[184:185], v[184:185], v[172:173] op_sel_hi:[1,0]
    v_pk_mul_f32 v[186:187], v[186:187], v[172:173] op_sel_hi:[1,0]
    v_pk_mul_f32 v[188:189], v[188:189], v[172:173] op_sel_hi:[1,0]
    v_pk_mul_f32 v[190:191], v[190:191], v[172:173] op_sel_hi:[1,0]
    v_pk_mul_f32 v[192:193], v[192:193], v[172:173] op_sel_hi:[1,0]
    v_pk_mul_f32 v[194:195], v[194:195], v[172:173] op_sel_hi:[1,0]
    v_pk_mul_f32 v[196:197], v[196:197], v[172:173] op_sel_hi:[1,0]
    v_pk_mul_f32 v[198:199], v[198:199], v[172:173] op_sel_hi:[1,0]
    v_cvt_pk_bf16_f32 v184, 0, v184
    v_cvt_pk_bf16_f32 v185, 0, v185
    v_cvt_pk_bf16_f32 v186, 0, v186
    v_cvt_pk_bf16_f32 v187, 0, v187
    v_cvt_pk_bf16_f32 v188, 0, v188
    v_cvt_pk_bf16_f32 v189, 0, v189
    v_cvt_pk_bf16_f32 v190, 0, v190
    v_cvt_pk_bf16_f32 v191, 0, v191
    v_cvt_pk_bf16_f32 v192, 0, v192
    v_cvt_pk_bf16_f32 v193, 0, v193
    v_cvt_pk_bf16_f32 v194, 0, v194
    v_cvt_pk_bf16_f32 v195, 0, v195
    v_cvt_pk_bf16_f32 v196, 0, v196
    v_cvt_pk_bf16_f32 v197, 0, v197
    v_cvt_pk_bf16_f32 v198, 0, v198
    v_cvt_pk_bf16_f32 v199, 0, v199
    v_mul_f32_dpp v184, v208, v184 row_newbcast:0 row_mask:0xf bank_mask:0xf
    v_mul_f32_dpp v185, v208, v185 row_newbcast:1 row_mask:0xf bank_mask:0xf
    v_mul_f32_dpp v186, v208, v186 row_newbcast:2 row_mask:0xf bank_mask:0xf
    v_mul_f32_dpp v187, v208, v187 row_newbcast:3 row_mask:0xf bank_mask:0xf
    v_mul_f32_dpp v188, v208, v188 row_newbcast:4 row_mask:0xf bank_mask:0xf
    v_mul_f32_dpp v189, v208, v189 row_newbcast:5 row_mask:0xf bank_mask:0xf
    v_mul_f32_dpp v190, v208, v190 row_newbcast:6 row_mask:0xf bank_mask:0xf
    v_mul_f32_dpp v191, v208, v191 row_newbcast:7 row_mask:0xf bank_mask:0xf
    v_cvt_pk_bf16_f32 v184, 0, v184
    v_cvt_pk_bf16_f32 v185, 0, v185
    v_cvt_pk_bf16_f32 v186, 0, v186
    v_cvt_pk_bf16_f32 v187, 0, v187
    v_cvt_pk_bf16_f32 v188, 0, v188
    v_cvt_pk_bf16_f32 v189, 0, v189
    v_cvt_pk_bf16_f32 v190, 0, v190
    v_cvt_pk_bf16_f32 v191, 0, v191
    v_add_f32_dpp v184, v200, v184 row_newbcast:0 row_mask:0xf bank_mask:0xf
    v_add_f32_dpp v185, v200, v185 row_newbcast:1 row_mask:0xf bank_mask:0xf
    v_add_f32_dpp v186, v200, v186 row_newbcast:2 row_mask:0xf bank_mask:0xf
    v_add_f32_dpp v187, v200, v187 row_newbcast:3 row_mask:0xf bank_mask:0xf
    v_add_f32_dpp v188, v200, v188 row_newbcast:4 row_mask:0xf bank_mask:0xf
    v_add_f32_dpp v189, v200, v189 row_newbcast:5 row_mask:0xf bank_mask:0xf
    v_add_f32_dpp v190, v200, v190 row_newbcast:6 row_mask:0xf bank_mask:0xf
    v_add_f32_dpp v191, v200, v191 row_newbcast:7 row_mask:0xf bank_mask:0xf
    v_cvt_pk_bf16_f32 v216, v184, v185
    v_cvt_pk_bf16_f32 v217, v186, v187
    v_cvt_pk_bf16_f32 v218, v188, v189
    v_cvt_pk_bf16_f32 v219, v190, v191
    buffer_store_dwordx4 v[216:219], v4, s[32:35], s13 offen sc1
    v_mul_f32_dpp v192, v208, v192 row_newbcast:8 row_mask:0xf bank_mask:0xf
    v_mul_f32_dpp v193, v208, v193 row_newbcast:9 row_mask:0xf bank_mask:0xf
    v_mul_f32_dpp v194, v208, v194 row_newbcast:10 row_mask:0xf bank_mask:0xf
    v_mul_f32_dpp v195, v208, v195 row_newbcast:11 row_mask:0xf bank_mask:0xf
    v_mul_f32_dpp v196, v208, v196 row_newbcast:12 row_mask:0xf bank_mask:0xf
    v_mul_f32_dpp v197, v208, v197 row_newbcast:13 row_mask:0xf bank_mask:0xf
    v_mul_f32_dpp v198, v208, v198 row_newbcast:14 row_mask:0xf bank_mask:0xf
    v_mul_f32_dpp v199, v208, v199 row_newbcast:15 row_mask:0xf bank_mask:0xf
    v_cvt_pk_bf16_f32 v192, 0, v192
    v_cvt_pk_bf16_f32 v193, 0, v193
    v_cvt_pk_bf16_f32 v194, 0, v194
    v_cvt_pk_bf16_f32 v195, 0, v195
    v_cvt_pk_bf16_f32 v196, 0, v196
    v_cvt_pk_bf16_f32 v197, 0, v197
    v_cvt_pk_bf16_f32 v198, 0, v198
    v_cvt_pk_bf16_f32 v199, 0, v199
    v_add_f32_dpp v192, v200, v192 row_newbcast:8 row_mask:0xf bank_mask:0xf
    v_add_f32_dpp v193, v200, v193 row_newbcast:9 row_mask:0xf bank_mask:0xf
    v_add_f32_dpp v194, v200, v194 row_newbcast:10 row_mask:0xf bank_mask:0xf
    v_add_f32_dpp v195, v200, v195 row_newbcast:11 row_mask:0xf bank_mask:0xf
    v_add_f32_dpp v196, v200, v196 row_newbcast:12 row_mask:0xf bank_mask:0xf
    v_add_f32_dpp v197, v200, v197 row_newbcast:13 row_mask:0xf bank_mask:0xf
    v_add_f32_dpp v198, v200, v198 row_newbcast:14 row_mask:0xf bank_mask:0xf
    v_add_f32_dpp v199, v200, v199 row_newbcast:15 row_mask:0xf bank_mask:0xf
    v_cvt_pk_bf16_f32 v220, v192, v193
    v_cvt_pk_bf16_f32 v221, v194, v195
    v_cvt_pk_bf16_f32 v222, v196, v197
    v_cvt_pk_bf16_f32 v223, v198, v199
    buffer_store_dwordx4 v[220:223], v4, s[32:35], s13 offen offset:2048 sc1
    v_bfe_u32 v20, v1, 2, 2
    v_lshlrev_b32 v20, 7, v20
    v_bfe_u32 v9, v1, 3, 1
    v_lshl_add_u32 v20, v9, 6, v20
    v_bfe_u32 v9, v1, 4, 1
    v_lshl_add_u32 v20, v9, 5, v20
    v_and_b32 v9, 3, v1
    v_lshl_add_u32 v20, v9, 3, v20
    v_lshrrev_b32 v9, 5, v1
    v_lshl_add_u32 v20, v9, 9, v20
    v_xor_b32 v21, 64, v20
    v_add_u32 v22, 49152, v20
    v_add_u32 v23, 49152, v21
    v_add_u32 v24, 98304, v20
    v_add_u32 v25, 98304, v21
    v_and_b32 v5, 3, v1
    v_lshlrev_b32 v5, 15, v5
    v_bfe_u32 v9, v1, 2, 2
    v_lshl_add_u32 v5, v9, 12, v5
    s_and_b32 s96, s12, 1
    s_lshr_b32 s97, s21, 3
    s_and_b32 s98, s21, 7
    s_lshl_b32 s99, s98, 5
    s_lshl2_add_u32 s98, s97, s99
    s_lshl_b32 s97, s98, 12
    s_lshr_b32 s99, s12, 1
    s_lshl_b32 s98, s99, 6
    s_add_u32 s99, s97, s98
    s_lshl2_add_u32 s97, s96, s99
    s_add_u32 s13, s97, 1048576
    s_lshl_b32 s96, s10, 18
    s_lshl_b32 s97, s77, 12
    s_add_u32 s98, s96, s97
    s_add_u32 s88, s98, 4194304
    s_cmp_ge_u32 s9, 28
    s_cselect_b32 s54, 0, s54
    s_cselect_b32 s58, 0, s58
    s_cselect_b32 s62, 0, s62
    s_waitcnt vmcnt(0)
    s_barrier
    s_cmp_lg_u32 s3, 0
    s_cbranch_scc1 L_PB
    v_mov_b32 v6, s4
    s_mov_b32 exec_hi, 0
    s_mov_b32 exec_lo, 65535
    buffer_store_dword v6, v5, s[32:35], s13 offen sc1
    s_mov_b64 exec, -1
L_PB:
    s_lshr_b32 s96, s9, 4
    s_lshl_b32 s97, s96, 1
    s_xor_b32 s94, s97, 2
    s_add_u32 s96, s94, s84
    s_and_b32 s97, s96, 15
    s_mul_i32 s98, s97, 393216
    s_add_u32 s91, s98, s85
    s_lshl_b32 s96, s94, 13
    s_add_u32 s94, s96, s83
    s_add_u32 s82, s91, 2048
    s_mov_b32 m0, s94
    s_nop 0
    buffer_load_dwordx4 v3, s[40:43], s82 offen lds
    s_add_u32 s82, s91, 4096
    s_add_u32 m0, s94, 49152
    s_nop 0
    buffer_load_dwordx4 v3, s[40:43], s82 offen lds
    s_mov_b32 s82, s91
    s_add_u32 m0, s94, 98304
    s_nop 0
    buffer_load_dwordx4 v3, s[40:43], s82 offen lds
    s_lshr_b32 s96, s9, 4
    s_lshl_b32 s97, s96, 1
    s_xor_b32 s94, s97, 3
    s_add_u32 s96, s94, s84
    s_and_b32 s97, s96, 15
    s_mul_i32 s98, s97, 393216
    s_add_u32 s91, s98, s85
    s_lshl_b32 s96, s94, 13
    s_add_u32 s94, s96, s83
    s_add_u32 s82, s91, 2048
    s_mov_b32 m0, s94
    s_nop 0
    buffer_load_dwordx4 v3, s[40:43], s82 offen lds
    s_add_u32 s82, s91, 4096
    s_add_u32 m0, s94, 49152
    s_nop 0
    buffer_load_dwordx4 v3, s[40:43], s82 offen lds
    s_mov_b32 s82, s91
    s_add_u32 m0, s94, 98304
    s_nop 0
    buffer_load_dwordx4 v3, s[40:43], s82 offen lds
    s_lshl_b32 s96, s2, 12
    s_add_u32 s19, s96, 1048576
    s_and_b32 s96, s3, 3
    s_lshl_b32 s97, s96, 7
    s_add_u32 s20, s97, s19
    s_lshl_b32 s96, s84, 5
    s_add_u32 s19, s96, s19
    s_cmp_ge_u32 s3, 4
    s_cselect_b32 s19, s20, s19
    s_load_dwordx2 s[24:25], s[32:33], s19 offset:0 glc
    s_load_dwordx2 s[26:27], s[32:33], s19 offset:64 glc
    s_lshl_b32 s96, s3, 14
    s_lshl_b32 s97, s12, 7
    s_add_u32 s90, s96, s97
    s_and_b32 s96, s9, 1
    s_lshr_b32 s97, s9, 3
    s_lshl_b32 s98, s97, 1
    s_lshl3_add_u32 s99, s96, s98
    s_lshl_b32 s95, s99, 17
    s_lshl3_add_u32 s96, s75, s3
    s_mul_i32 s97, s96, 229376
    s_lshl_b32 s98, s74, 7
    s_add_u32 s80, s97, s98
    s_lshl3_add_u32 s96, s74, s3
    s_lshl_b32 s97, s96, 14
    s_lshl_b32 s98, s75, 9
    s_add_u32 s81, s97, s98
    s_and_b32 s96, s8, 3
    s_lshl3_add_u32 s97, s96, s3
    s_mul_i32 s98, s97, 393216
    s_lshr_b32 s99, s8, 2
    s_lshl1_add_u32 s96, s9, s99
    s_lshl_b32 s97, s96, 7
    s_add_u32 s99, s98, s97
    s_add_u32 s89, s99, 4096
    s_and_b32 s96, s3, 1
    s_lshl_b32 s14, s96, 6
    v_bfe_u32 v6, v1, 4, 1
    v_lshl_add_u32 v6, v6, 5, s14
    v_and_b32 v26, 7, v1
    v_lshlrev_b32 v26, 4, v26
    v_xor_b32 v26, v26, v6
    v_lshrrev_b32 v6, 3, v1
    v_lshlrev_b32 v6, 11, v6
    v_add_u32 v26, v26, v6
    s_and_b32 s96, s3, 2
    s_lshl_b32 s14, s96, 5
    v_bfe_u32 v6, v1, 4, 1
    v_lshl_add_u32 v6, v6, 5, s14
    v_and_b32 v27, 7, v1
    v_lshlrev_b32 v27, 4, v27
    v_xor_b32 v27, v27, v6
    v_lshrrev_b32 v6, 3, v1
    v_mul_u32_u24 v6, 7168, v6
    v_add_u32 v27, v27, v6
    s_and_b32 s96, s3, 1
    s_lshl_b32 s14, s96, 7
    v_lshrrev_b32 v6, 5, v1
    v_lshl_add_u32 v6, v6, 6, s14
    v_and_b32 v253, 31, v1
    v_lshlrev_b32 v253, 4, v253
    v_lshrrev_b32 v9, 5, v1
    v_lshl_add_u32 v253, v9, 11, v253
    v_xor_b32 v253, v253, v6
    s_lshl_b32 s16, s84, 14
    v_add_u32 v249, s88, v2
    s_lshl_b32 s96, s77, 11
    s_add_u32 s14, s96, 151552
    v_add_u32 v0, s14, v2
    s_mov_b64 exec, 0
    s_cmp_eq_u32 s3, 4
    s_cbranch_scc1 L_PAD2
    s_cmp_eq_u32 s3, 5
    s_cbranch_scc1 L_PAD3
    s_cmp_eq_u32 s3, 6
    s_cbranch_scc1 L_PAD4
    s_cmp_eq_u32 s3, 7
    s_cbranch_scc1 L_PAD5
    s_branch L_TEND
L_RET2:
    s_branch L_PAD6
L_RET6:
    s_branch L_PAD10
L_RET10:
    s_branch L_TEND
L_RET3:
    s_branch L_PAD7
L_RET7:
    s_branch L_TEND
L_RET4:
    s_branch L_PAD8
L_RET8:
    s_branch L_TEND
L_RET5:
    s_branch L_PAD9
L_RET9:
    s_branch L_TEND
    s_nop 0
    s_nop 0
    s_nop 0
    s_nop 0
    s_nop 0
    s_nop 0
    s_nop 0
    s_nop 0
    s_nop 0
    s_nop 0
    s_nop 0
    s_nop 0
    s_nop 0
    s_nop 0
    s_nop 0
    s_nop 0
    s_nop 0
    s_nop 0
    s_nop 0
    s_nop 0
    s_nop 0
    s_nop 0
    s_nop 0
    s_nop 0
    s_nop 0
    s_nop 0
    s_nop 0
    s_nop 0
L_TEND:
    s_mov_b64 exec, -1
    s_cmp_ge_u32 s3, 4
    s_cbranch_scc1 L_HELP
    s_branch SCHK_14
SPOLL_13:
    s_load_dwordx2 s[24:25], s[32:33], s19 offset:0 glc
    s_load_dwordx2 s[26:27], s[32:33], s19 offset:64 glc
SCHK_14:
    s_add_u32 s5, s5, 1
    s_cmp_ge_u32 s5, 200000
    s_waitcnt lgkmcnt(0)
    s_cbranch_scc1 SDONE_15
    s_cmp_lg_u32 s24, s4
    s_cbranch_scc1 SPOLL_13
    s_cmp_lg_u32 s25, s4
    s_cbranch_scc1 SPOLL_13
    s_cmp_lg_u32 s26, s4
    s_cbranch_scc1 SPOLL_13
    s_cmp_lg_u32 s27, s4
    s_cbranch_scc1 SPOLL_13
SDONE_15:
    s_setprio 2
    buffer_load_dwordx4 v[152:155], v249, s[32:35], s16 offen sc1
    buffer_load_dwordx4 v[156:159], v249, s[32:35], s16 offen offset:1024 sc1
    buffer_load_dwordx4 v[160:163], v249, s[32:35], s16 offen offset:2048 sc1
    buffer_load_dwordx4 v[164:167], v249, s[32:35], s16 offen offset:3072 sc1
    s_add_u32 s16, s16, 16384
    s_and_b32 s16, s16, 0x3ffff
    buffer_load_dwordx4 v[168:171], v249, s[32:35], s16 offen sc1
    buffer_load_dwordx4 v[172:175], v249, s[32:35], s16 offen offset:1024 sc1
    buffer_load_dwordx4 v[176:179], v249, s[32:35], s16 offen offset:2048 sc1
    buffer_load_dwordx4 v[180:183], v249, s[32:35], s16 offen offset:3072 sc1
    s_waitcnt vmcnt(8)
    s_barrier
    ds_read_b64_tr_b16 v[28:29], v20
    ds_read_b64_tr_b16 v[30:31], v20 offset:2048
    ds_read_b64_tr_b16 v[32:33], v21
    ds_read_b64_tr_b16 v[34:35], v21 offset:2048
    ds_read_b64_tr_b16 v[36:37], v24
    ds_read_b64_tr_b16 v[38:39], v24 offset:2048
    ds_read_b64_tr_b16 v[40:41], v25
    ds_read_b64_tr_b16 v[42:43], v25 offset:2048
    ds_read_b64_tr_b16 v[44:45], v22
    ds_read_b64_tr_b16 v[46:47], v22 offset:2048
    ds_read_b64_tr_b16 v[48:49], v23
    ds_read_b64_tr_b16 v[50:51], v23 offset:2048
    s_waitcnt vmcnt(7)
    s_waitcnt lgkmcnt(8)
    v_mfma_f32_32x32x16_bf16 v[56:71], v[28:31], v[152:155], 0
    s_add_u32 s16, s16, 16384
    ds_read_b64_tr_b16 v[52:53], v20 offset:1024
    ds_read_b64_tr_b16 v[54:55], v20 offset:3072
    v_mfma_f32_32x32x16_bf16 v[72:87], v[32:35], v[152:155], 0
    s_and_b32 s16, s16, 0x3ffff
    ds_read_b64_tr_b16 v[28:29], v21 offset:1024
    ds_read_b64_tr_b16 v[30:31], v21 offset:3072
    s_waitcnt lgkmcnt(8)
    v_mfma_f32_32x32x16_bf16 v[120:135], v[36:39], v[152:155], 0
    ds_read_b64_tr_b16 v[32:33], v24 offset:1024
    ds_read_b64_tr_b16 v[34:35], v24 offset:3072
    v_mfma_f32_32x32x16_bf16 v[136:151], v[40:43], v[152:155], 0
    buffer_load_dwordx4 v[184:187], v249, s[32:35], s16 offen sc1
    ds_read_b64_tr_b16 v[36:37], v25 offset:1024
    ds_read_b64_tr_b16 v[38:39], v25 offset:3072
    s_waitcnt lgkmcnt(8)
    v_mfma_f32_32x32x16_bf16 v[88:103], v[44:47], v[152:155], 0
    ds_read_b64_tr_b16 v[40:41], v22 offset:1024
    ds_read_b64_tr_b16 v[42:43], v22 offset:3072
    v_mfma_f32_32x32x16_bf16 v[104:119], v[48:51], v[152:155], 0
    ds_read_b64_tr_b16 v[44:45], v23 offset:1024
    ds_read_b64_tr_b16 v[46:47], v23 offset:3072
    s_waitcnt vmcnt(7)
    s_waitcnt lgkmcnt(8)
    v_mfma_f32_32x32x16_bf16 v[56:71], v[52:55], v[156:159], v[56:71]
    ds_read_b64_tr_b16 v[48:49], v20 offset:4096
    ds_read_b64_tr_b16 v[50:51], v20 offset:6144
    v_mfma_f32_32x32x16_bf16 v[72:87], v[28:31], v[156:159], v[72:87]
    buffer_load_dwordx4 v[188:191], v249, s[32:35], s16 offen offset:1024 sc1
    ds_read_b64_tr_b16 v[52:53], v21 offset:4096
    ds_read_b64_tr_b16 v[54:55], v21 offset:6144
    s_waitcnt lgkmcnt(8)
    v_mfma_f32_32x32x16_bf16 v[120:135], v[32:35], v[156:159], v[120:135]
    ds_read_b64_tr_b16 v[28:29], v24 offset:4096
    ds_read_b64_tr_b16 v[30:31], v24 offset:6144
    v_mfma_f32_32x32x16_bf16 v[136:151], v[36:39], v[156:159], v[136:151]
    ds_read_b64_tr_b16 v[32:33], v25 offset:4096
    ds_read_b64_tr_b16 v[34:35], v25 offset:6144
    s_waitcnt lgkmcnt(8)
    v_mfma_f32_32x32x16_bf16 v[88:103], v[40:43], v[156:159], v[88:103]
    ds_read_b64_tr_b16 v[36:37], v22 offset:4096
    ds_read_b64_tr_b16 v[38:39], v22 offset:6144
    v_mfma_f32_32x32x16_bf16 v[104:119], v[44:47], v[156:159], v[104:119]
    buffer_load_dwordx4 v[192:195], v249, s[32:35], s16 offen offset:2048 sc1
    ds_read_b64_tr_b16 v[40:41], v23 offset:4096
    ds_read_b64_tr_b16 v[42:43], v23 offset:6144
    s_waitcnt vmcnt(8)
    s_waitcnt lgkmcnt(8)
    v_mfma_f32_32x32x16_bf16 v[56:71], v[48:51], v[160:163], v[56:71]
    ds_read_b64_tr_b16 v[44:45], v20 offset:5120
    ds_read_b64_tr_b16 v[46:47], v20 offset:7168
    v_mfma_f32_32x32x16_bf16 v[72:87], v[52:55], v[160:163], v[72:87]
    ds_read_b64_tr_b16 v[48:49], v21 offset:5120
    ds_read_b64_tr_b16 v[50:51], v21 offset:7168
    s_waitcnt lgkmcnt(8)
    v_mfma_f32_32x32x16_bf16 v[120:135], v[28:31], v[160:163], v[120:135]
    ds_read_b64_tr_b16 v[52:53], v24 offset:5120
    ds_read_b64_tr_b16 v[54:55], v24 offset:7168
    v_mfma_f32_32x32x16_bf16 v[136:151], v[32:35], v[160:163], v[136:151]
    buffer_load_dwordx4 v[196:199], v249, s[32:35], s16 offen offset:3072 sc1
    ds_read_b64_tr_b16 v[28:29], v25 offset:5120
    ds_read_b64_tr_b16 v[30:31], v25 offset:7168
    s_waitcnt lgkmcnt(8)
    v_mfma_f32_32x32x16_bf16 v[88:103], v[36:39], v[160:163], v[88:103]
    s_add_u32 s16, s16, 16384
    ds_read_b64_tr_b16 v[32:33], v22 offset:5120
    ds_read_b64_tr_b16 v[34:35], v22 offset:7168
    v_mfma_f32_32x32x16_bf16 v[104:119], v[40:43], v[160:163], v[104:119]
    s_and_b32 s16, s16, 0x3ffff
    ds_read_b64_tr_b16 v[36:37], v23 offset:5120
    ds_read_b64_tr_b16 v[38:39], v23 offset:7168
    s_waitcnt vmcnt(8)
    s_waitcnt lgkmcnt(8)
    v_mfma_f32_32x32x16_bf16 v[56:71], v[44:47], v[164:167], v[56:71]
    ds_read_b64_tr_b16 v[40:41], v20 offset:8192
    ds_read_b64_tr_b16 v[42:43], v20 offset:10240
    v_mfma_f32_32x32x16_bf16 v[72:87], v[48:51], v[164:167], v[72:87]
    buffer_load_dwordx4 v[200:203], v249, s[32:35], s16 offen sc1
    ds_read_b64_tr_b16 v[44:45], v21 offset:8192
    ds_read_b64_tr_b16 v[46:47], v21 offset:10240
    s_waitcnt lgkmcnt(8)
    v_mfma_f32_32x32x16_bf16 v[120:135], v[52:55], v[164:167], v[120:135]
    ds_read_b64_tr_b16 v[48:49], v24 offset:8192
    ds_read_b64_tr_b16 v[50:51], v24 offset:10240
    v_mfma_f32_32x32x16_bf16 v[136:151], v[28:31], v[164:167], v[136:151]
    ds_read_b64_tr_b16 v[52:53], v25 offset:8192
    ds_read_b64_tr_b16 v[54:55], v25 offset:10240
    s_waitcnt lgkmcnt(8)
    v_mfma_f32_32x32x16_bf16 v[88:103], v[32:35], v[164:167], v[88:103]
    ds_read_b64_tr_b16 v[28:29], v22 offset:8192
    ds_read_b64_tr_b16 v[30:31], v22 offset:10240
    v_mfma_f32_32x32x16_bf16 v[104:119], v[36:39], v[164:167], v[104:119]
    buffer_load_dwordx4 v[204:207], v249, s[32:35], s16 offen offset:1024 sc1
    ds_read_b64_tr_b16 v[32:33], v23 offset:8192
    ds_read_b64_tr_b16 v[34:35], v23 offset:10240
    s_barrier
    s_waitcnt vmcnt(9)
    s_waitcnt lgkmcnt(8)
    v_mfma_f32_32x32x16_bf16 v[56:71], v[40:43], v[168:171], v[56:71]
    ds_read_b64_tr_b16 v[36:37], v20 offset:9216
    ds_read_b64_tr_b16 v[38:39], v20 offset:11264
    v_mfma_f32_32x32x16_bf16 v[72:87], v[44:47], v[168:171], v[72:87]
    ds_read_b64_tr_b16 v[40:41], v21 offset:9216
    ds_read_b64_tr_b16 v[42:43], v21 offset:11264
    s_waitcnt lgkmcnt(8)
    v_mfma_f32_32x32x16_bf16 v[120:135], v[48:51], v[168:171], v[120:135]
    ds_read_b64_tr_b16 v[44:45], v24 offset:9216
    ds_read_b64_tr_b16 v[46:47], v24 offset:11264
    v_mfma_f32_32x32x16_bf16 v[136:151], v[52:55], v[168:171], v[136:151]
    ds_read_b64_tr_b16 v[48:49], v25 offset:9216
    ds_read_b64_tr_b16 v[50:51], v25 offset:11264
    s_waitcnt lgkmcnt(8)
    v_mfma_f32_32x32x16_bf16 v[88:103], v[28:31], v[168:171], v[88:103]
    ds_read_b64_tr_b16 v[52:53], v22 offset:9216
    ds_read_b64_tr_b16 v[54:55], v22 offset:11264
    v_mfma_f32_32x32x16_bf16 v[104:119], v[32:35], v[168:171], v[104:119]
    ds_read_b64_tr_b16 v[28:29], v23 offset:9216
    ds_read_b64_tr_b16 v[30:31], v23 offset:11264
    s_waitcnt vmcnt(8)
    s_waitcnt lgkmcnt(8)
    v_mfma_f32_32x32x16_bf16 v[56:71], v[36:39], v[172:175], v[56:71]
    ds_read_b64_tr_b16 v[32:33], v20 offset:12288
    ds_read_b64_tr_b16 v[34:35], v20 offset:14336
    v_mfma_f32_32x32x16_bf16 v[72:87], v[40:43], v[172:175], v[72:87]
    ds_read_b64_tr_b16 v[36:37], v21 offset:12288
    ds_read_b64_tr_b16 v[38:39], v21 offset:14336
    s_waitcnt lgkmcnt(8)
    v_mfma_f32_32x32x16_bf16 v[120:135], v[44:47], v[172:175], v[120:135]
    buffer_load_dwordx4 v[208:211], v249, s[32:35], s16 offen offset:2048 sc1
    ds_read_b64_tr_b16 v[40:41], v24 offset:12288
    ds_read_b64_tr_b16 v[42:43], v24 offset:14336
    v_mfma_f32_32x32x16_bf16 v[136:151], v[48:51], v[172:175], v[136:151]
    ds_read_b64_tr_b16 v[44:45], v25 offset:12288
    ds_read_b64_tr_b16 v[46:47], v25 offset:14336
    s_waitcnt lgkmcnt(8)
    v_mfma_f32_32x32x16_bf16 v[88:103], v[52:55], v[172:175], v[88:103]
    ds_read_b64_tr_b16 v[48:49], v22 offset:12288
    ds_read_b64_tr_b16 v[50:51], v22 offset:14336
    v_mfma_f32_32x32x16_bf16 v[104:119], v[28:31], v[172:175], v[104:119]
    buffer_load_dwordx4 v[212:215], v249, s[32:35], s16 offen offset:3072 sc1
    ds_read_b64_tr_b16 v[52:53], v23 offset:12288
    ds_read_b64_tr_b16 v[54:55], v23 offset:14336
    s_waitcnt vmcnt(9)
    s_waitcnt lgkmcnt(8)
    v_mfma_f32_32x32x16_bf16 v[56:71], v[32:35], v[176:179], v[56:71]
    s_add_u32 s16, s16, 16384
    ds_read_b64_tr_b16 v[28:29], v20 offset:13312
    ds_read_b64_tr_b16 v[30:31], v20 offset:15360
    v_mfma_f32_32x32x16_bf16 v[72:87], v[36:39], v[176:179], v[72:87]
    s_and_b32 s16, s16, 0x3ffff
    ds_read_b64_tr_b16 v[32:33], v21 offset:13312
    ds_read_b64_tr_b16 v[34:35], v21 offset:15360
    s_waitcnt lgkmcnt(8)
    v_mfma_f32_32x32x16_bf16 v[120:135], v[40:43], v[176:179], v[120:135]
    buffer_load_dwordx4 v[216:219], v249, s[32:35], s16 offen sc1
    ds_read_b64_tr_b16 v[36:37], v24 offset:13312
    ds_read_b64_tr_b16 v[38:39], v24 offset:15360
    v_mfma_f32_32x32x16_bf16 v[136:151], v[44:47], v[176:179], v[136:151]
    ds_read_b64_tr_b16 v[40:41], v25 offset:13312
    ds_read_b64_tr_b16 v[42:43], v25 offset:15360
    s_waitcnt lgkmcnt(8)
    v_mfma_f32_32x32x16_bf16 v[88:103], v[48:51], v[176:179], v[88:103]
    ds_read_b64_tr_b16 v[44:45], v22 offset:13312
    ds_read_b64_tr_b16 v[46:47], v22 offset:15360
    v_mfma_f32_32x32x16_bf16 v[104:119], v[52:55], v[176:179], v[104:119]
    buffer_load_dwordx4 v[220:223], v249, s[32:35], s16 offen offset:1024 sc1
    ds_read_b64_tr_b16 v[48:49], v23 offset:13312
    ds_read_b64_tr_b16 v[50:51], v23 offset:15360
    s_waitcnt vmcnt(10)
    s_waitcnt lgkmcnt(8)
    v_mfma_f32_32x32x16_bf16 v[56:71], v[28:31], v[180:183], v[56:71]
    ds_read_b64_tr_b16 v[52:53], v20 offset:16384
    ds_read_b64_tr_b16 v[54:55], v20 offset:18432
    v_mfma_f32_32x32x16_bf16 v[72:87], v[32:35], v[180:183], v[72:87]
    ds_read_b64_tr_b16 v[28:29], v21 offset:16384
    ds_read_b64_tr_b16 v[30:31], v21 offset:18432
    s_waitcnt lgkmcnt(8)
    v_mfma_f32_32x32x16_bf16 v[120:135], v[36:39], v[180:183], v[120:135]
    buffer_load_dwordx4 v[224:227], v249, s[32:35], s16 offen offset:2048 sc1
    ds_read_b64_tr_b16 v[32:33], v24 offset:16384
    ds_read_b64_tr_b16 v[34:35], v24 offset:18432
    v_mfma_f32_32x32x16_bf16 v[136:151], v[40:43], v[180:183], v[136:151]
    ds_read_b64_tr_b16 v[36:37], v25 offset:16384
    ds_read_b64_tr_b16 v[38:39], v25 offset:18432
    s_waitcnt lgkmcnt(8)
    v_mfma_f32_32x32x16_bf16 v[88:103], v[44:47], v[180:183], v[88:103]
    ds_read_b64_tr_b16 v[40:41], v22 offset:16384
    ds_read_b64_tr_b16 v[42:43], v22 offset:18432
    v_mfma_f32_32x32x16_bf16 v[104:119], v[48:51], v[180:183], v[104:119]
    buffer_load_dwordx4 v[228:231], v249, s[32:35], s16 offen offset:3072 sc1
    ds_read_b64_tr_b16 v[44:45], v23 offset:16384
    ds_read_b64_tr_b16 v[46:47], v23 offset:18432
    s_barrier
    s_waitcnt vmcnt(11)
    s_waitcnt lgkmcnt(8)
    v_mfma_f32_32x32x16_bf16 v[56:71], v[52:55], v[184:187], v[56:71]
    s_add_u32 s16, s16, 16384
    ds_read_b64_tr_b16 v[48:49], v20 offset:17408
    ds_read_b64_tr_b16 v[50:51], v20 offset:19456
    v_mfma_f32_32x32x16_bf16 v[72:87], v[28:31], v[184:187], v[72:87]
    s_and_b32 s16, s16, 0x3ffff
    ds_read_b64_tr_b16 v[52:53], v21 offset:17408
    ds_read_b64_tr_b16 v[54:55], v21 offset:19456
    s_waitcnt lgkmcnt(8)
    v_mfma_f32_32x32x16_bf16 v[120:135], v[32:35], v[184:187], v[120:135]
    ds_read_b64_tr_b16 v[28:29], v24 offset:17408
    ds_read_b64_tr_b16 v[30:31], v24 offset:19456
    v_mfma_f32_32x32x16_bf16 v[136:151], v[36:39], v[184:187], v[136:151]
    ds_read_b64_tr_b16 v[32:33], v25 offset:17408
    ds_read_b64_tr_b16 v[34:35], v25 offset:19456
    s_waitcnt lgkmcnt(8)
    v_mfma_f32_32x32x16_bf16 v[88:103], v[40:43], v[184:187], v[88:103]
    ds_read_b64_tr_b16 v[36:37], v22 offset:17408
    ds_read_b64_tr_b16 v[38:39], v22 offset:19456
    v_mfma_f32_32x32x16_bf16 v[104:119], v[44:47], v[184:187], v[104:119]
    ds_read_b64_tr_b16 v[40:41], v23 offset:17408
    ds_read_b64_tr_b16 v[42:43], v23 offset:19456
    s_waitcnt vmcnt(10)
    s_waitcnt lgkmcnt(8)
    v_mfma_f32_32x32x16_bf16 v[56:71], v[48:51], v[188:191], v[56:71]
    ds_read_b64_tr_b16 v[44:45], v20 offset:20480
    ds_read_b64_tr_b16 v[46:47], v20 offset:22528
    v_mfma_f32_32x32x16_bf16 v[72:87], v[52:55], v[188:191], v[72:87]
    ds_read_b64_tr_b16 v[48:49], v21 offset:20480
    ds_read_b64_tr_b16 v[50:51], v21 offset:22528
    s_waitcnt lgkmcnt(8)
    v_mfma_f32_32x32x16_bf16 v[120:135], v[28:31], v[188:191], v[120:135]
    buffer_load_dwordx4 v[232:235], v249, s[32:35], s16 offen sc1
    ds_read_b64_tr_b16 v[52:53], v24 offset:20480
    ds_read_b64_tr_b16 v[54:55], v24 offset:22528
    v_mfma_f32_32x32x16_bf16 v[136:151], v[32:35], v[188:191], v[136:151]
    ds_read_b64_tr_b16 v[28:29], v25 offset:20480
    ds_read_b64_tr_b16 v[30:31], v25 offset:22528
    s_waitcnt lgkmcnt(8)
    v_mfma_f32_32x32x16_bf16 v[88:103], v[36:39], v[188:191], v[88:103]
    ds_read_b64_tr_b16 v[32:33], v22 offset:20480
    ds_read_b64_tr_b16 v[34:35], v22 offset:22528
    v_mfma_f32_32x32x16_bf16 v[104:119], v[40:43], v[188:191], v[104:119]
    buffer_load_dwordx4 v[236:239], v249, s[32:35], s16 offen offset:1024 sc1
    ds_read_b64_tr_b16 v[36:37], v23 offset:20480
    ds_read_b64_tr_b16 v[38:39], v23 offset:22528
    s_waitcnt vmcnt(11)
    s_waitcnt lgkmcnt(8)
    v_mfma_f32_32x32x16_bf16 v[56:71], v[44:47], v[192:195], v[56:71]
    ds_read_b64_tr_b16 v[40:41], v20 offset:21504
    ds_read_b64_tr_b16 v[42:43], v20 offset:23552
    v_mfma_f32_32x32x16_bf16 v[72:87], v[48:51], v[192:195], v[72:87]
    ds_read_b64_tr_b16 v[44:45], v21 offset:21504
    ds_read_b64_tr_b16 v[46:47], v21 offset:23552
    s_waitcnt lgkmcnt(8)
    v_mfma_f32_32x32x16_bf16 v[120:135], v[52:55], v[192:195], v[120:135]
    buffer_load_dwordx4 v[240:243], v249, s[32:35], s16 offen offset:2048 sc1
    ds_read_b64_tr_b16 v[48:49], v24 offset:21504
    ds_read_b64_tr_b16 v[50:51], v24 offset:23552
    v_mfma_f32_32x32x16_bf16 v[136:151], v[28:31], v[192:195], v[136:151]
    ds_read_b64_tr_b16 v[52:53], v25 offset:21504
    ds_read_b64_tr_b16 v[54:55], v25 offset:23552
    s_waitcnt lgkmcnt(8)
    v_mfma_f32_32x32x16_bf16 v[88:103], v[32:35], v[192:195], v[88:103]
    ds_read_b64_tr_b16 v[28:29], v22 offset:21504
    ds_read_b64_tr_b16 v[30:31], v22 offset:23552
    v_mfma_f32_32x32x16_bf16 v[104:119], v[36:39], v[192:195], v[104:119]
    buffer_load_dwordx4 v[244:247], v249, s[32:35], s16 offen offset:3072 sc1
    ds_read_b64_tr_b16 v[32:33], v23 offset:21504
    ds_read_b64_tr_b16 v[34:35], v23 offset:23552
    s_waitcnt vmcnt(12)
    s_waitcnt lgkmcnt(8)
    v_mfma_f32_32x32x16_bf16 v[56:71], v[40:43], v[196:199], v[56:71]
    s_add_u32 s16, s16, 16384
    ds_read_b64_tr_b16 v[36:37], v20 offset:24576
    ds_read_b64_tr_b16 v[38:39], v20 offset:26624
    v_mfma_f32_32x32x16_bf16 v[72:87], v[44:47], v[196:199], v[72:87]
    s_and_b32 s16, s16, 0x3ffff
    ds_read_b64_tr_b16 v[40:41], v21 offset:24576
    ds_read_b64_tr_b16 v[42:43], v21 offset:26624
    s_waitcnt lgkmcnt(8)
    v_mfma_f32_32x32x16_bf16 v[120:135], v[48:51], v[196:199], v[120:135]
    buffer_load_dwordx4 v[152:155], v249, s[32:35], s16 offen sc1
    ds_read_b64_tr_b16 v[44:45], v24 offset:24576
    ds_read_b64_tr_b16 v[46:47], v24 offset:26624
    v_mfma_f32_32x32x16_bf16 v[136:151], v[52:55], v[196:199], v[136:151]
    ds_read_b64_tr_b16 v[48:49], v25 offset:24576
    ds_read_b64_tr_b16 v[50:51], v25 offset:26624
    s_waitcnt lgkmcnt(8)
    v_mfma_f32_32x32x16_bf16 v[88:103], v[28:31], v[196:199], v[88:103]
    ds_read_b64_tr_b16 v[52:53], v22 offset:24576
    ds_read_b64_tr_b16 v[54:55], v22 offset:26624
    v_mfma_f32_32x32x16_bf16 v[104:119], v[32:35], v[196:199], v[104:119]
    buffer_load_dwordx4 v[156:159], v249, s[32:35], s16 offen offset:1024 sc1
    ds_read_b64_tr_b16 v[28:29], v23 offset:24576
    ds_read_b64_tr_b16 v[30:31], v23 offset:26624
    s_barrier
    s_waitcnt vmcnt(13)
    s_waitcnt lgkmcnt(8)
    v_mfma_f32_32x32x16_bf16 v[56:71], v[36:39], v[200:203], v[56:71]
    ds_read_b64_tr_b16 v[32:33], v20 offset:25600
    ds_read_b64_tr_b16 v[34:35], v20 offset:27648
    v_mfma_f32_32x32x16_bf16 v[72:87], v[40:43], v[200:203], v[72:87]
    ds_read_b64_tr_b16 v[36:37], v21 offset:25600
    ds_read_b64_tr_b16 v[38:39], v21 offset:27648
    s_waitcnt lgkmcnt(8)
    v_mfma_f32_32x32x16_bf16 v[120:135], v[44:47], v[200:203], v[120:135]
    ds_read_b64_tr_b16 v[40:41], v24 offset:25600
    ds_read_b64_tr_b16 v[42:43], v24 offset:27648
    v_mfma_f32_32x32x16_bf16 v[136:151], v[48:51], v[200:203], v[136:151]
    ds_read_b64_tr_b16 v[44:45], v25 offset:25600
    ds_read_b64_tr_b16 v[46:47], v25 offset:27648
    s_waitcnt lgkmcnt(8)
    v_mfma_f32_32x32x16_bf16 v[88:103], v[52:55], v[200:203], v[88:103]
    ds_read_b64_tr_b16 v[48:49], v22 offset:25600
    ds_read_b64_tr_b16 v[50:51], v22 offset:27648
    v_mfma_f32_32x32x16_bf16 v[104:119], v[28:31], v[200:203], v[104:119]
    ds_read_b64_tr_b16 v[52:53], v23 offset:25600
    ds_read_b64_tr_b16 v[54:55], v23 offset:27648
    s_waitcnt vmcnt(12)
    s_waitcnt lgkmcnt(8)
    v_mfma_f32_32x32x16_bf16 v[56:71], v[32:35], v[204:207], v[56:71]
    ds_read_b64_tr_b16 v[28:29], v20 offset:28672
L_PAD2:
    s_cbranch_execz L_RET2
    ds_read_b64_tr_b16 v[30:31], v20 offset:30720
    v_mfma_f32_32x32x16_bf16 v[72:87], v[36:39], v[204:207], v[72:87]
    ds_read_b64_tr_b16 v[32:33], v21 offset:28672
    ds_read_b64_tr_b16 v[34:35], v21 offset:30720
    s_waitcnt lgkmcnt(8)
    v_mfma_f32_32x32x16_bf16 v[120:135], v[40:43], v[204:207], v[120:135]
    buffer_load_dwordx4 v[160:163], v249, s[32:35], s16 offen offset:2048 sc1
    ds_read_b64_tr_b16 v[36:37], v24 offset:28672
    ds_read_b64_tr_b16 v[38:39], v24 offset:30720
    v_mfma_f32_32x32x16_bf16 v[136:151], v[44:47], v[204:207], v[136:151]
    ds_read_b64_tr_b16 v[40:41], v25 offset:28672
    ds_read_b64_tr_b16 v[42:43], v25 offset:30720
    s_waitcnt lgkmcnt(8)
    v_mfma_f32_32x32x16_bf16 v[88:103], v[48:51], v[204:207], v[88:103]
    ds_read_b64_tr_b16 v[44:45], v22 offset:28672
    ds_read_b64_tr_b16 v[46:47], v22 offset:30720
    v_mfma_f32_32x32x16_bf16 v[104:119], v[52:55], v[204:207], v[104:119]
    buffer_load_dwordx4 v[164:167], v249, s[32:35], s16 offen offset:3072 sc1
    ds_read_b64_tr_b16 v[48:49], v23 offset:28672
    ds_read_b64_tr_b16 v[50:51], v23 offset:30720
    s_waitcnt vmcnt(13)
    s_waitcnt lgkmcnt(8)
    v_mfma_f32_32x32x16_bf16 v[56:71], v[28:31], v[208:211], v[56:71]
    s_add_u32 s16, s16, 16384
    ds_read_b64_tr_b16 v[52:53], v20 offset:29696
    ds_read_b64_tr_b16 v[54:55], v20 offset:31744
    v_mfma_f32_32x32x16_bf16 v[72:87], v[32:35], v[208:211], v[72:87]
    s_and_b32 s16, s16, 0x3ffff
    ds_read_b64_tr_b16 v[28:29], v21 offset:29696
    ds_read_b64_tr_b16 v[30:31], v21 offset:31744
    s_waitcnt lgkmcnt(8)
    v_mfma_f32_32x32x16_bf16 v[120:135], v[36:39], v[208:211], v[120:135]
    buffer_load_dwordx4 v[168:171], v249, s[32:35], s16 offen sc1
    ds_read_b64_tr_b16 v[32:33], v24 offset:29696
    ds_read_b64_tr_b16 v[34:35], v24 offset:31744
    v_mfma_f32_32x32x16_bf16 v[136:151], v[40:43], v[208:211], v[136:151]
    ds_read_b64_tr_b16 v[36:37], v25 offset:29696
    ds_read_b64_tr_b16 v[38:39], v25 offset:31744
    s_waitcnt lgkmcnt(8)
    v_mfma_f32_32x32x16_bf16 v[88:103], v[44:47], v[208:211], v[88:103]
    ds_read_b64_tr_b16 v[40:41], v22 offset:29696
    ds_read_b64_tr_b16 v[42:43], v22 offset:31744
    v_mfma_f32_32x32x16_bf16 v[104:119], v[48:51], v[208:211], v[104:119]
    buffer_load_dwordx4 v[172:175], v249, s[32:35], s16 offen offset:1024 sc1
    ds_read_b64_tr_b16 v[44:45], v23 offset:29696
    ds_read_b64_tr_b16 v[46:47], v23 offset:31744
    s_waitcnt vmcnt(14)
    s_waitcnt lgkmcnt(8)
    v_mfma_f32_32x32x16_bf16 v[56:71], v[52:55], v[212:215], v[56:71]
    ds_read_b64_tr_b16 v[48:49], v20 offset:32768
    ds_read_b64_tr_b16 v[50:51], v20 offset:34816
    v_mfma_f32_32x32x16_bf16 v[72:87], v[28:31], v[212:215], v[72:87]
    ds_read_b64_tr_b16 v[52:53], v21 offset:32768
    ds_read_b64_tr_b16 v[54:55], v21 offset:34816
    s_waitcnt lgkmcnt(8)
    v_mfma_f32_32x32x16_bf16 v[120:135], v[32:35], v[212:215], v[120:135]
    buffer_load_dwordx4 v[176:179], v249, s[32:35], s16 offen offset:2048 sc1
    ds_read_b64_tr_b16 v[28:29], v24 offset:32768
    ds_read_b64_tr_b16 v[30:31], v24 offset:34816
    v_mfma_f32_32x32x16_bf16 v[136:151], v[36:39], v[212:215], v[136:151]
    ds_read_b64_tr_b16 v[32:33], v25 offset:32768
    ds_read_b64_tr_b16 v[34:35], v25 offset:34816
    s_waitcnt lgkmcnt(8)
    v_mfma_f32_32x32x16_bf16 v[88:103], v[40:43], v[212:215], v[88:103]
    ds_read_b64_tr_b16 v[36:37], v22 offset:32768
    ds_read_b64_tr_b16 v[38:39], v22 offset:34816
    v_mfma_f32_32x32x16_bf16 v[104:119], v[44:47], v[212:215], v[104:119]
    buffer_load_dwordx4 v[180:183], v249, s[32:35], s16 offen offset:3072 sc1
    ds_read_b64_tr_b16 v[40:41], v23 offset:32768
    ds_read_b64_tr_b16 v[42:43], v23 offset:34816
    s_barrier
    s_waitcnt vmcnt(15)
    s_waitcnt lgkmcnt(8)
    v_mfma_f32_32x32x16_bf16 v[56:71], v[48:51], v[216:219], v[56:71]
    s_add_u32 s16, s16, 16384
    ds_read_b64_tr_b16 v[44:45], v20 offset:33792
    ds_read_b64_tr_b16 v[46:47], v20 offset:35840
    v_mfma_f32_32x32x16_bf16 v[72:87], v[52:55], v[216:219], v[72:87]
    s_and_b32 s16, s16, 0x3ffff
    ds_read_b64_tr_b16 v[48:49], v21 offset:33792
    ds_read_b64_tr_b16 v[50:51], v21 offset:35840
    s_waitcnt lgkmcnt(8)
    v_mfma_f32_32x32x16_bf16 v[120:135], v[28:31], v[216:219], v[120:135]
    ds_read_b64_tr_b16 v[52:53], v24 offset:33792
    ds_read_b64_tr_b16 v[54:55], v24 offset:35840
    v_mfma_f32_32x32x16_bf16 v[136:151], v[32:35], v[216:219], v[136:151]
    ds_read_b64_tr_b16 v[28:29], v25 offset:33792
    ds_read_b64_tr_b16 v[30:31], v25 offset:35840
    s_waitcnt lgkmcnt(8)
    v_mfma_f32_32x32x16_bf16 v[88:103], v[36:39], v[216:219], v[88:103]
    ds_read_b64_tr_b16 v[32:33], v22 offset:33792
    ds_read_b64_tr_b16 v[34:35], v22 offset:35840
    v_mfma_f32_32x32x16_bf16 v[104:119], v[40:43], v[216:219], v[104:119]
    ds_read_b64_tr_b16 v[36:37], v23 offset:33792
    ds_read_b64_tr_b16 v[38:39], v23 offset:35840
    s_waitcnt vmcnt(14)
    s_waitcnt lgkmcnt(8)
    v_mfma_f32_32x32x16_bf16 v[56:71], v[44:47], v[220:223], v[56:71]
    ds_read_b64_tr_b16 v[40:41], v20 offset:36864
    ds_read_b64_tr_b16 v[42:43], v20 offset:38912
    v_mfma_f32_32x32x16_bf16 v[72:87], v[48:51], v[220:223], v[72:87]
    ds_read_b64_tr_b16 v[44:45], v21 offset:36864
    ds_read_b64_tr_b16 v[46:47], v21 offset:38912
    s_waitcnt lgkmcnt(8)
    v_mfma_f32_32x32x16_bf16 v[120:135], v[52:55], v[220:223], v[120:135]
    buffer_load_dwordx4 v[184:187], v249, s[32:35], s16 offen sc1
    ds_read_b64_tr_b16 v[48:49], v24 offset:36864
    ds_read_b64_tr_b16 v[50:51], v24 offset:38912
    v_mfma_f32_32x32x16_bf16 v[136:151], v[28:31], v[220:223], v[136:151]
    ds_read_b64_tr_b16 v[52:53], v25 offset:36864
    ds_read_b64_tr_b16 v[54:55], v25 offset:38912
    s_waitcnt lgkmcnt(8)
    v_mfma_f32_32x32x16_bf16 v[88:103], v[32:35], v[220:223], v[88:103]
    ds_read_b64_tr_b16 v[28:29], v22 offset:36864
    ds_read_b64_tr_b16 v[30:31], v22 offset:38912
    v_mfma_f32_32x32x16_bf16 v[104:119], v[36:39], v[220:223], v[104:119]
    buffer_load_dwordx4 v[188:191], v249, s[32:35], s16 offen offset:1024 sc1
    ds_read_b64_tr_b16 v[32:33], v23 offset:36864
    ds_read_b64_tr_b16 v[34:35], v23 offset:38912
    s_waitcnt vmcnt(15)
    s_waitcnt lgkmcnt(8)
    v_mfma_f32_32x32x16_bf16 v[56:71], v[40:43], v[224:227], v[56:71]
    ds_read_b64_tr_b16 v[36:37], v20 offset:37888
    ds_read_b64_tr_b16 v[38:39], v20 offset:39936
    v_mfma_f32_32x32x16_bf16 v[72:87], v[44:47], v[224:227], v[72:87]
    ds_read_b64_tr_b16 v[40:41], v21 offset:37888
    ds_read_b64_tr_b16 v[42:43], v21 offset:39936
    s_waitcnt lgkmcnt(8)
    v_mfma_f32_32x32x16_bf16 v[120:135], v[48:51], v[224:227], v[120:135]
    buffer_load_dwordx4 v[192:195], v249, s[32:35], s16 offen offset:2048 sc1
    ds_read_b64_tr_b16 v[44:45], v24 offset:37888
    ds_read_b64_tr_b16 v[46:47], v24 offset:39936
    v_mfma_f32_32x32x16_bf16 v[136:151], v[52:55], v[224:227], v[136:151]
    ds_read_b64_tr_b16 v[48:49], v25 offset:37888
    ds_read_b64_tr_b16 v[50:51], v25 offset:39936
    s_waitcnt lgkmcnt(8)
    v_mfma_f32_32x32x16_bf16 v[88:103], v[28:31], v[224:227], v[88:103]
    ds_read_b64_tr_b16 v[52:53], v22 offset:37888
    ds_read_b64_tr_b16 v[54:55], v22 offset:39936
    v_mfma_f32_32x32x16_bf16 v[104:119], v[32:35], v[224:227], v[104:119]
    buffer_load_dwordx4 v[196:199], v249, s[32:35], s16 offen offset:3072 sc1
    ds_read_b64_tr_b16 v[28:29], v23 offset:37888
    ds_read_b64_tr_b16 v[30:31], v23 offset:39936
    s_waitcnt vmcnt(16)
    s_waitcnt lgkmcnt(8)
    v_mfma_f32_32x32x16_bf16 v[56:71], v[36:39], v[228:231], v[56:71]
    s_add_u32 s16, s16, 16384
    ds_read_b64_tr_b16 v[32:33], v20 offset:40960
    ds_read_b64_tr_b16 v[34:35], v20 offset:43008
    v_mfma_f32_32x32x16_bf16 v[72:87], v[40:43], v[228:231], v[72:87]
    s_and_b32 s16, s16, 0x3ffff
    ds_read_b64_tr_b16 v[36:37], v21 offset:40960
    ds_read_b64_tr_b16 v[38:39], v21 offset:43008
    s_waitcnt lgkmcnt(8)
    v_mfma_f32_32x32x16_bf16 v[120:135], v[44:47], v[228:231], v[120:135]
    buffer_load_dwordx4 v[200:203], v249, s[32:35], s16 offen sc1
    ds_read_b64_tr_b16 v[40:41], v24 offset:40960
    ds_read_b64_tr_b16 v[42:43], v24 offset:43008
    v_mfma_f32_32x32x16_bf16 v[136:151], v[48:51], v[228:231], v[136:151]
    ds_read_b64_tr_b16 v[44:45], v25 offset:40960
    ds_read_b64_tr_b16 v[46:47], v25 offset:43008
    s_waitcnt lgkmcnt(8)
    v_mfma_f32_32x32x16_bf16 v[88:103], v[52:55], v[228:231], v[88:103]
    ds_read_b64_tr_b16 v[48:49], v22 offset:40960
    ds_read_b64_tr_b16 v[50:51], v22 offset:43008
    v_mfma_f32_32x32x16_bf16 v[104:119], v[28:31], v[228:231], v[104:119]
    buffer_load_dwordx4 v[204:207], v249, s[32:35], s16 offen offset:1024 sc1
    ds_read_b64_tr_b16 v[52:53], v23 offset:40960
    ds_read_b64_tr_b16 v[54:55], v23 offset:43008
    s_barrier
    s_waitcnt vmcnt(17)
    s_waitcnt lgkmcnt(8)
    v_mfma_f32_32x32x16_bf16 v[56:71], v[32:35], v[232:235], v[56:71]
    ds_read_b64_tr_b16 v[28:29], v20 offset:41984
    ds_read_b64_tr_b16 v[30:31], v20 offset:44032
    v_mfma_f32_32x32x16_bf16 v[72:87], v[36:39], v[232:235], v[72:87]
    ds_read_b64_tr_b16 v[32:33], v21 offset:41984
    ds_read_b64_tr_b16 v[34:35], v21 offset:44032
    s_waitcnt lgkmcnt(8)
    v_mfma_f32_32x32x16_bf16 v[120:135], v[40:43], v[232:235], v[120:135]
    ds_read_b64_tr_b16 v[36:37], v24 offset:41984
    ds_read_b64_tr_b16 v[38:39], v24 offset:44032
    v_mfma_f32_32x32x16_bf16 v[136:151], v[44:47], v[232:235], v[136:151]
    ds_read_b64_tr_b16 v[40:41], v25 offset:41984
    ds_read_b64_tr_b16 v[42:43], v25 offset:44032
    s_waitcnt lgkmcnt(8)
    v_mfma_f32_32x32x16_bf16 v[88:103], v[48:51], v[232:235], v[88:103]
    ds_read_b64_tr_b16 v[44:45], v22 offset:41984
    ds_read_b64_tr_b16 v[46:47], v22 offset:44032
    v_mfma_f32_32x32x16_bf16 v[104:119], v[52:55], v[232:235], v[104:119]
    ds_read_b64_tr_b16 v[48:49], v23 offset:41984
    ds_read_b64_tr_b16 v[50:51], v23 offset:44032
    s_waitcnt vmcnt(16)
    s_waitcnt lgkmcnt(8)
    v_mfma_f32_32x32x16_bf16 v[56:71], v[28:31], v[236:239], v[56:71]
    ds_read_b64_tr_b16 v[52:53], v20 offset:45056
    ds_read_b64_tr_b16 v[54:55], v20 offset:47104
    v_mfma_f32_32x32x16_bf16 v[72:87], v[32:35], v[236:239], v[72:87]
    ds_read_b64_tr_b16 v[28:29], v21 offset:45056
    ds_read_b64_tr_b16 v[30:31], v21 offset:47104
    s_waitcnt lgkmcnt(8)
    v_mfma_f32_32x32x16_bf16 v[120:135], v[36:39], v[236:239], v[120:135]
    buffer_load_dwordx4 v[208:211], v249, s[32:35], s16 offen offset:2048 sc1
    ds_read_b64_tr_b16 v[32:33], v24 offset:45056
    ds_read_b64_tr_b16 v[34:35], v24 offset:47104
    v_mfma_f32_32x32x16_bf16 v[136:151], v[40:43], v[236:239], v[136:151]
    ds_read_b64_tr_b16 v[36:37], v25 offset:45056
    ds_read_b64_tr_b16 v[38:39], v25 offset:47104
    s_waitcnt lgkmcnt(8)
    v_mfma_f32_32x32x16_bf16 v[88:103], v[44:47], v[236:239], v[88:103]
    ds_read_b64_tr_b16 v[40:41], v22 offset:45056
    ds_read_b64_tr_b16 v[42:43], v22 offset:47104
    v_mfma_f32_32x32x16_bf16 v[104:119], v[48:51], v[236:239], v[104:119]
    buffer_load_dwordx4 v[212:215], v249, s[32:35], s16 offen offset:3072 sc1
    ds_read_b64_tr_b16 v[44:45], v23 offset:45056
    ds_read_b64_tr_b16 v[46:47], v23 offset:47104
    s_waitcnt vmcnt(17)
    s_waitcnt lgkmcnt(8)
    v_mfma_f32_32x32x16_bf16 v[56:71], v[52:55], v[240:243], v[56:71]
    s_add_u32 s16, s16, 16384
    ds_read_b64_tr_b16 v[48:49], v20 offset:46080
    ds_read_b64_tr_b16 v[50:51], v20 offset:48128
    v_mfma_f32_32x32x16_bf16 v[72:87], v[28:31], v[240:243], v[72:87]
    s_and_b32 s16, s16, 0x3ffff
    ds_read_b64_tr_b16 v[52:53], v21 offset:46080
    ds_read_b64_tr_b16 v[54:55], v21 offset:48128
    s_waitcnt lgkmcnt(8)
    v_mfma_f32_32x32x16_bf16 v[120:135], v[32:35], v[240:243], v[120:135]
    buffer_load_dwordx4 v[216:219], v249, s[32:35], s16 offen sc1
    ds_read_b64_tr_b16 v[28:29], v24 offset:46080
    ds_read_b64_tr_b16 v[30:31], v24 offset:48128
    v_mfma_f32_32x32x16_bf16 v[136:151], v[36:39], v[240:243], v[136:151]
    ds_read_b64_tr_b16 v[32:33], v25 offset:46080
    ds_read_b64_tr_b16 v[34:35], v25 offset:48128
    s_waitcnt lgkmcnt(8)
    v_mfma_f32_32x32x16_bf16 v[88:103], v[40:43], v[240:243], v[88:103]
    ds_read_b64_tr_b16 v[36:37], v22 offset:46080
    ds_read_b64_tr_b16 v[38:39], v22 offset:48128
    v_mfma_f32_32x32x16_bf16 v[104:119], v[44:47], v[240:243], v[104:119]
    buffer_load_dwordx4 v[220:223], v249, s[32:35], s16 offen offset:1024 sc1
    ds_read_b64_tr_b16 v[40:41], v23 offset:46080
    ds_read_b64_tr_b16 v[42:43], v23 offset:48128
    s_waitcnt vmcnt(18)
    s_waitcnt lgkmcnt(8)
    v_mfma_f32_32x32x16_bf16 v[56:71], v[48:51], v[244:247], v[56:71]
    ds_read_b64_tr_b16 v[44:45], v20
    ds_read_b64_tr_b16 v[46:47], v20 offset:2048
    v_mfma_f32_32x32x16_bf16 v[72:87], v[52:55], v[244:247], v[72:87]
    ds_read_b64_tr_b16 v[48:49], v21
    ds_read_b64_tr_b16 v[50:51], v21 offset:2048
    s_waitcnt lgkmcnt(8)
    v_mfma_f32_32x32x16_bf16 v[120:135], v[28:31], v[244:247], v[120:135]
    buffer_load_dwordx4 v[224:227], v249, s[32:35], s16 offen offset:2048 sc1
    ds_read_b64_tr_b16 v[52:53], v24
    ds_read_b64_tr_b16 v[54:55], v24 offset:2048
    v_mfma_f32_32x32x16_bf16 v[136:151], v[32:35], v[244:247], v[136:151]
    ds_read_b64_tr_b16 v[28:29], v25
    ds_read_b64_tr_b16 v[30:31], v25 offset:2048
    s_waitcnt lgkmcnt(8)
    v_mfma_f32_32x32x16_bf16 v[88:103], v[36:39], v[244:247], v[88:103]
    ds_read_b64_tr_b16 v[32:33], v22
    ds_read_b64_tr_b16 v[34:35], v22 offset:2048
    v_mfma_f32_32x32x16_bf16 v[104:119], v[40:43], v[244:247], v[104:119]
    buffer_load_dwordx4 v[228:231], v249, s[32:35], s16 offen offset:3072 sc1
    ds_read_b64_tr_b16 v[36:37], v23
    ds_read_b64_tr_b16 v[38:39], v23 offset:2048
    s_barrier
    s_waitcnt vmcnt(19)
    s_waitcnt lgkmcnt(8)
    v_mfma_f32_32x32x16_bf16 v[56:71], v[44:47], v[152:155], v[56:71]
    s_add_u32 s16, s16, 16384
    ds_read_b64_tr_b16 v[40:41], v20 offset:1024
    ds_read_b64_tr_b16 v[42:43], v20 offset:3072
    v_mfma_f32_32x32x16_bf16 v[72:87], v[48:51], v[152:155], v[72:87]
    s_and_b32 s16, s16, 0x3ffff
    ds_read_b64_tr_b16 v[44:45], v21 offset:1024
    ds_read_b64_tr_b16 v[46:47], v21 offset:3072
    s_waitcnt lgkmcnt(8)
    v_mfma_f32_32x32x16_bf16 v[120:135], v[52:55], v[152:155], v[120:135]
    ds_read_b64_tr_b16 v[48:49], v24 offset:1024
    ds_read_b64_tr_b16 v[50:51], v24 offset:3072
    v_mfma_f32_32x32x16_bf16 v[136:151], v[28:31], v[152:155], v[136:151]
    ds_read_b64_tr_b16 v[52:53], v25 offset:1024
    ds_read_b64_tr_b16 v[54:55], v25 offset:3072
    s_waitcnt lgkmcnt(8)
    v_mfma_f32_32x32x16_bf16 v[88:103], v[32:35], v[152:155], v[88:103]
    ds_read_b64_tr_b16 v[28:29], v22 offset:1024
    ds_read_b64_tr_b16 v[30:31], v22 offset:3072
    v_mfma_f32_32x32x16_bf16 v[104:119], v[36:39], v[152:155], v[104:119]
    ds_read_b64_tr_b16 v[32:33], v23 offset:1024
    ds_read_b64_tr_b16 v[34:35], v23 offset:3072
    s_waitcnt vmcnt(18)
    s_waitcnt lgkmcnt(8)
    v_mfma_f32_32x32x16_bf16 v[56:71], v[40:43], v[156:159], v[56:71]
    ds_read_b64_tr_b16 v[36:37], v20 offset:4096
    ds_read_b64_tr_b16 v[38:39], v20 offset:6144
    v_mfma_f32_32x32x16_bf16 v[72:87], v[44:47], v[156:159], v[72:87]
    ds_read_b64_tr_b16 v[40:41], v21 offset:4096
    ds_read_b64_tr_b16 v[42:43], v21 offset:6144
    s_waitcnt lgkmcnt(8)
    v_mfma_f32_32x32x16_bf16 v[120:135], v[48:51], v[156:159], v[120:135]
    ds_read_b64_tr_b16 v[44:45], v24 offset:4096
    ds_read_b64_tr_b16 v[46:47], v24 offset:6144
    v_mfma_f32_32x32x16_bf16 v[136:151], v[52:55], v[156:159], v[136:151]
    buffer_load_dwordx4 v[232:235], v249, s[32:35], s16 offen sc1
    ds_read_b64_tr_b16 v[48:49], v25 offset:4096
    ds_read_b64_tr_b16 v[50:51], v25 offset:6144
    s_waitcnt lgkmcnt(8)
    v_mfma_f32_32x32x16_bf16 v[88:103], v[28:31], v[156:159], v[88:103]
    ds_read_b64_tr_b16 v[52:53], v22 offset:4096
    ds_read_b64_tr_b16 v[54:55], v22 offset:6144
    v_mfma_f32_32x32x16_bf16 v[104:119], v[32:35], v[156:159], v[104:119]
    ds_read_b64_tr_b16 v[28:29], v23 offset:4096
    ds_read_b64_tr_b16 v[30:31], v23 offset:6144
    s_waitcnt vmcnt(18)
    s_waitcnt lgkmcnt(8)
    v_mfma_f32_32x32x16_bf16 v[56:71], v[36:39], v[160:163], v[56:71]
    ds_read_b64_tr_b16 v[32:33], v20 offset:5120
    ds_read_b64_tr_b16 v[34:35], v20 offset:7168
    v_mfma_f32_32x32x16_bf16 v[72:87], v[40:43], v[160:163], v[72:87]
    buffer_load_dwordx4 v[236:239], v249, s[32:35], s16 offen offset:1024 sc1
    ds_read_b64_tr_b16 v[36:37], v21 offset:5120
    ds_read_b64_tr_b16 v[38:39], v21 offset:7168
    s_waitcnt lgkmcnt(8)
    v_mfma_f32_32x32x16_bf16 v[120:135], v[44:47], v[160:163], v[120:135]
    ds_read_b64_tr_b16 v[40:41], v24 offset:5120
    ds_read_b64_tr_b16 v[42:43], v24 offset:7168
    v_mfma_f32_32x32x16_bf16 v[136:151], v[48:51], v[160:163], v[136:151]
    ds_read_b64_tr_b16 v[44:45], v25 offset:5120
    ds_read_b64_tr_b16 v[46:47], v25 offset:7168
    s_waitcnt lgkmcnt(8)
    v_mfma_f32_32x32x16_bf16 v[88:103], v[52:55], v[160:163], v[88:103]
    buffer_load_dwordx4 v[240:243], v249, s[32:35], s16 offen offset:2048 sc1
    ds_read_b64_tr_b16 v[48:49], v22 offset:5120
    ds_read_b64_tr_b16 v[50:51], v22 offset:7168
    v_mfma_f32_32x32x16_bf16 v[104:119], v[28:31], v[160:163], v[104:119]
    ds_read_b64_tr_b16 v[52:53], v23 offset:5120
    ds_read_b64_tr_b16 v[54:55], v23 offset:7168
    s_waitcnt vmcnt(19)
    s_waitcnt lgkmcnt(8)
    v_mfma_f32_32x32x16_bf16 v[56:71], v[32:35], v[164:167], v[56:71]
    ds_read_b64_tr_b16 v[28:29], v20 offset:8192
    ds_read_b64_tr_b16 v[30:31], v20 offset:10240
    v_mfma_f32_32x32x16_bf16 v[72:87], v[36:39], v[164:167], v[72:87]
    ds_read_b64_tr_b16 v[32:33], v21 offset:8192
    ds_read_b64_tr_b16 v[34:35], v21 offset:10240
    s_waitcnt lgkmcnt(8)
    v_mfma_f32_32x32x16_bf16 v[120:135], v[40:43], v[164:167], v[120:135]
    buffer_load_dwordx4 v[244:247], v249, s[32:35], s16 offen offset:3072 sc1
    ds_read_b64_tr_b16 v[36:37], v24 offset:8192
    ds_read_b64_tr_b16 v[38:39], v24 offset:10240
    v_mfma_f32_32x32x16_bf16 v[136:151], v[44:47], v[164:167], v[136:151]
    s_add_u32 s16, s16, 16384
    ds_read_b64_tr_b16 v[40:41], v25 offset:8192
    ds_read_b64_tr_b16 v[42:43], v25 offset:10240
    s_waitcnt lgkmcnt(8)
    v_mfma_f32_32x32x16_bf16 v[88:103], v[48:51], v[164:167], v[88:103]
    s_and_b32 s16, s16, 0x3ffff
    ds_read_b64_tr_b16 v[44:45], v22 offset:8192
    ds_read_b64_tr_b16 v[46:47], v22 offset:10240
    v_mfma_f32_32x32x16_bf16 v[104:119], v[52:55], v[164:167], v[104:119]
    buffer_load_dwordx4 v[152:155], v249, s[32:35], s16 offen sc1
    ds_read_b64_tr_b16 v[48:49], v23 offset:8192
    ds_read_b64_tr_b16 v[50:51], v23 offset:10240
    s_barrier
    s_waitcnt vmcnt(20)
    s_waitcnt lgkmcnt(8)
    v_mfma_f32_32x32x16_bf16 v[56:71], v[28:31], v[168:171], v[56:71]
    ds_read_b64_tr_b16 v[52:53], v20 offset:9216
    ds_read_b64_tr_b16 v[54:55], v20 offset:11264
    v_mfma_f32_32x32x16_bf16 v[72:87], v[32:35], v[168:171], v[72:87]
    ds_read_b64_tr_b16 v[28:29], v21 offset:9216
    ds_read_b64_tr_b16 v[30:31], v21 offset:11264
    s_waitcnt lgkmcnt(8)
    v_mfma_f32_32x32x16_bf16 v[120:135], v[36:39], v[168:171], v[120:135]
    ds_read_b64_tr_b16 v[32:33], v24 offset:9216
    ds_read_b64_tr_b16 v[34:35], v24 offset:11264
    v_mfma_f32_32x32x16_bf16 v[136:151], v[40:43], v[168:171], v[136:151]
    ds_read_b64_tr_b16 v[36:37], v25 offset:9216
    ds_read_b64_tr_b16 v[38:39], v25 offset:11264
    s_waitcnt lgkmcnt(8)
    v_mfma_f32_32x32x16_bf16 v[88:103], v[44:47], v[168:171], v[88:103]
    ds_read_b64_tr_b16 v[40:41], v22 offset:9216
    ds_read_b64_tr_b16 v[42:43], v22 offset:11264
    v_mfma_f32_32x32x16_bf16 v[104:119], v[48:51], v[168:171], v[104:119]
    ds_read_b64_tr_b16 v[44:45], v23 offset:9216
    ds_read_b64_tr_b16 v[46:47], v23 offset:11264
    s_waitcnt vmcnt(19)
    s_waitcnt lgkmcnt(8)
    v_mfma_f32_32x32x16_bf16 v[56:71], v[52:55], v[172:175], v[56:71]
    ds_read_b64_tr_b16 v[48:49], v20 offset:12288
    ds_read_b64_tr_b16 v[50:51], v20 offset:14336
    v_mfma_f32_32x32x16_bf16 v[72:87], v[28:31], v[172:175], v[72:87]
    ds_read_b64_tr_b16 v[52:53], v21 offset:12288
    ds_read_b64_tr_b16 v[54:55], v21 offset:14336
    s_waitcnt lgkmcnt(8)
    v_mfma_f32_32x32x16_bf16 v[120:135], v[32:35], v[172:175], v[120:135]
    ds_read_b64_tr_b16 v[28:29], v24 offset:12288
    ds_read_b64_tr_b16 v[30:31], v24 offset:14336
    v_mfma_f32_32x32x16_bf16 v[136:151], v[36:39], v[172:175], v[136:151]
    buffer_load_dwordx4 v[156:159], v249, s[32:35], s16 offen offset:1024 sc1
    ds_read_b64_tr_b16 v[32:33], v25 offset:12288
    ds_read_b64_tr_b16 v[34:35], v25 offset:14336
    s_waitcnt lgkmcnt(8)
    v_mfma_f32_32x32x16_bf16 v[88:103], v[40:43], v[172:175], v[88:103]
    ds_read_b64_tr_b16 v[36:37], v22 offset:12288
    ds_read_b64_tr_b16 v[38:39], v22 offset:14336
    v_mfma_f32_32x32x16_bf16 v[104:119], v[44:47], v[172:175], v[104:119]
    ds_read_b64_tr_b16 v[40:41], v23 offset:12288
    ds_read_b64_tr_b16 v[42:43], v23 offset:14336
    s_waitcnt vmcnt(19)
    s_waitcnt lgkmcnt(8)
    v_mfma_f32_32x32x16_bf16 v[56:71], v[48:51], v[176:179], v[56:71]
    ds_read_b64_tr_b16 v[44:45], v20 offset:13312
    ds_read_b64_tr_b16 v[46:47], v20 offset:15360
    v_mfma_f32_32x32x16_bf16 v[72:87], v[52:55], v[176:179], v[72:87]
    buffer_load_dwordx4 v[160:163], v249, s[32:35], s16 offen offset:2048 sc1
    ds_read_b64_tr_b16 v[48:49], v21 offset:13312
    ds_read_b64_tr_b16 v[50:51], v21 offset:15360
    s_waitcnt lgkmcnt(8)
    v_mfma_f32_32x32x16_bf16 v[120:135], v[28:31], v[176:179], v[120:135]
    ds_read_b64_tr_b16 v[52:53], v24 offset:13312
    ds_read_b64_tr_b16 v[54:55], v24 offset:15360
    v_mfma_f32_32x32x16_bf16 v[136:151], v[32:35], v[176:179], v[136:151]
    ds_read_b64_tr_b16 v[28:29], v25 offset:13312
    ds_read_b64_tr_b16 v[30:31], v25 offset:15360
    s_waitcnt lgkmcnt(8)
    v_mfma_f32_32x32x16_bf16 v[88:103], v[36:39], v[176:179], v[88:103]
    buffer_load_dwordx4 v[164:167], v249, s[32:35], s16 offen offset:3072 sc1
    ds_read_b64_tr_b16 v[32:33], v22 offset:13312
    ds_read_b64_tr_b16 v[34:35], v22 offset:15360
    v_mfma_f32_32x32x16_bf16 v[104:119], v[40:43], v[176:179], v[104:119]
    s_add_u32 s16, s16, 16384
    ds_read_b64_tr_b16 v[36:37], v23 offset:13312
    ds_read_b64_tr_b16 v[38:39], v23 offset:15360
    s_waitcnt vmcnt(20)
    s_waitcnt lgkmcnt(8)
    v_mfma_f32_32x32x16_bf16 v[56:71], v[44:47], v[180:183], v[56:71]
    s_and_b32 s16, s16, 0x3ffff
    ds_read_b64_tr_b16 v[40:41], v20 offset:16384
    ds_read_b64_tr_b16 v[42:43], v20 offset:18432
    v_mfma_f32_32x32x16_bf16 v[72:87], v[48:51], v[180:183], v[72:87]
    ds_read_b64_tr_b16 v[44:45], v21 offset:16384
    ds_read_b64_tr_b16 v[46:47], v21 offset:18432
    s_waitcnt lgkmcnt(8)
    v_mfma_f32_32x32x16_bf16 v[120:135], v[52:55], v[180:183], v[120:135]
    buffer_load_dwordx4 v[168:171], v249, s[32:35], s16 offen sc1
    ds_read_b64_tr_b16 v[48:49], v24 offset:16384
    ds_read_b64_tr_b16 v[50:51], v24 offset:18432
    v_mfma_f32_32x32x16_bf16 v[136:151], v[28:31], v[180:183], v[136:151]
    ds_read_b64_tr_b16 v[52:53], v25 offset:16384
    ds_read_b64_tr_b16 v[54:55], v25 offset:18432
    s_waitcnt lgkmcnt(8)
    v_mfma_f32_32x32x16_bf16 v[88:103], v[32:35], v[180:183], v[88:103]
    ds_read_b64_tr_b16 v[28:29], v22 offset:16384
    ds_read_b64_tr_b16 v[30:31], v22 offset:18432
    v_mfma_f32_32x32x16_bf16 v[104:119], v[36:39], v[180:183], v[104:119]
    buffer_load_dwordx4 v[172:175], v249, s[32:35], s16 offen offset:1024 sc1
    ds_read_b64_tr_b16 v[32:33], v23 offset:16384
    ds_read_b64_tr_b16 v[34:35], v23 offset:18432
    s_barrier
    s_waitcnt vmcnt(21)
    s_waitcnt lgkmcnt(8)
    v_mfma_f32_32x32x16_bf16 v[56:71], v[40:43], v[184:187], v[56:71]
    ds_read_b64_tr_b16 v[36:37], v20 offset:17408
    ds_read_b64_tr_b16 v[38:39], v20 offset:19456
    v_mfma_f32_32x32x16_bf16 v[72:87], v[44:47], v[184:187], v[72:87]
    ds_read_b64_tr_b16 v[40:41], v21 offset:17408
    ds_read_b64_tr_b16 v[42:43], v21 offset:19456
    s_waitcnt lgkmcnt(8)
    v_mfma_f32_32x32x16_bf16 v[120:135], v[48:51], v[184:187], v[120:135]
    ds_read_b64_tr_b16 v[44:45], v24 offset:17408
    ds_read_b64_tr_b16 v[46:47], v24 offset:19456
    v_mfma_f32_32x32x16_bf16 v[136:151], v[52:55], v[184:187], v[136:151]
    ds_read_b64_tr_b16 v[48:49], v25 offset:17408
    ds_read_b64_tr_b16 v[50:51], v25 offset:19456
    s_waitcnt lgkmcnt(8)
    v_mfma_f32_32x32x16_bf16 v[88:103], v[28:31], v[184:187], v[88:103]
    ds_read_b64_tr_b16 v[52:53], v22 offset:17408
    ds_read_b64_tr_b16 v[54:55], v22 offset:19456
    v_mfma_f32_32x32x16_bf16 v[104:119], v[32:35], v[184:187], v[104:119]
    ds_read_b64_tr_b16 v[28:29], v23 offset:17408
    ds_read_b64_tr_b16 v[30:31], v23 offset:19456
    s_waitcnt vmcnt(20)
    s_waitcnt lgkmcnt(8)
    v_mfma_f32_32x32x16_bf16 v[56:71], v[36:39], v[188:191], v[56:71]
    ds_read_b64_tr_b16 v[32:33], v20 offset:20480
    ds_read_b64_tr_b16 v[34:35], v20 offset:22528
    v_mfma_f32_32x32x16_bf16 v[72:87], v[40:43], v[188:191], v[72:87]
    ds_read_b64_tr_b16 v[36:37], v21 offset:20480
    ds_read_b64_tr_b16 v[38:39], v21 offset:22528
    s_waitcnt lgkmcnt(8)
    v_mfma_f32_32x32x16_bf16 v[120:135], v[44:47], v[188:191], v[120:135]
    ds_read_b64_tr_b16 v[40:41], v24 offset:20480
    ds_read_b64_tr_b16 v[42:43], v24 offset:22528
    v_mfma_f32_32x32x16_bf16 v[136:151], v[48:51], v[188:191], v[136:151]
    buffer_load_dwordx4 v[176:179], v249, s[32:35], s16 offen offset:2048 sc1
    ds_read_b64_tr_b16 v[44:45], v25 offset:20480
    ds_read_b64_tr_b16 v[46:47], v25 offset:22528
    s_waitcnt lgkmcnt(8)
    v_mfma_f32_32x32x16_bf16 v[88:103], v[52:55], v[188:191], v[88:103]
    ds_read_b64_tr_b16 v[48:49], v22 offset:20480
    ds_read_b64_tr_b16 v[50:51], v22 offset:22528
    v_mfma_f32_32x32x16_bf16 v[104:119], v[28:31], v[188:191], v[104:119]
    ds_read_b64_tr_b16 v[52:53], v23 offset:20480
    ds_read_b64_tr_b16 v[54:55], v23 offset:22528
    s_waitcnt vmcnt(20)
    s_waitcnt lgkmcnt(8)
    v_mfma_f32_32x32x16_bf16 v[56:71], v[32:35], v[192:195], v[56:71]
    ds_read_b64_tr_b16 v[28:29], v20 offset:21504
    ds_read_b64_tr_b16 v[30:31], v20 offset:23552
    v_mfma_f32_32x32x16_bf16 v[72:87], v[36:39], v[192:195], v[72:87]
    buffer_load_dwordx4 v[180:183], v249, s[32:35], s16 offen offset:3072 sc1
    ds_read_b64_tr_b16 v[32:33], v21 offset:21504
    ds_read_b64_tr_b16 v[34:35], v21 offset:23552
    s_waitcnt lgkmcnt(8)
    v_mfma_f32_32x32x16_bf16 v[120:135], v[40:43], v[192:195], v[120:135]
    s_add_u32 s16, s16, 16384
    ds_read_b64_tr_b16 v[36:37], v24 offset:21504
    ds_read_b64_tr_b16 v[38:39], v24 offset:23552
    v_mfma_f32_32x32x16_bf16 v[136:151], v[44:47], v[192:195], v[136:151]
    s_and_b32 s16, s16, 0x3ffff
    ds_read_b64_tr_b16 v[40:41], v25 offset:21504
    ds_read_b64_tr_b16 v[42:43], v25 offset:23552
    s_waitcnt lgkmcnt(8)
    v_mfma_f32_32x32x16_bf16 v[88:103], v[48:51], v[192:195], v[88:103]
    buffer_load_dwordx4 v[184:187], v249, s[32:35], s16 offen sc1
    ds_read_b64_tr_b16 v[44:45], v22 offset:21504
    ds_read_b64_tr_b16 v[46:47], v22 offset:23552
    v_mfma_f32_32x32x16_bf16 v[104:119], v[52:55], v[192:195], v[104:119]
    ds_read_b64_tr_b16 v[48:49], v23 offset:21504
    ds_read_b64_tr_b16 v[50:51], v23 offset:23552
    s_waitcnt vmcnt(21)
    s_waitcnt lgkmcnt(8)
    v_mfma_f32_32x32x16_bf16 v[56:71], v[28:31], v[196:199], v[56:71]
    ds_read_b64_tr_b16 v[52:53], v20 offset:24576
    ds_read_b64_tr_b16 v[54:55], v20 offset:26624
    v_mfma_f32_32x32x16_bf16 v[72:87], v[32:35], v[196:199], v[72:87]
    ds_read_b64_tr_b16 v[28:29], v21 offset:24576
    ds_read_b64_tr_b16 v[30:31], v21 offset:26624
    s_waitcnt lgkmcnt(8)
    v_mfma_f32_32x32x16_bf16 v[120:135], v[36:39], v[196:199], v[120:135]
    buffer_load_dwordx4 v[188:191], v249, s[32:35], s16 offen offset:1024 sc1
    ds_read_b64_tr_b16 v[32:33], v20 offset:25600
    ds_read_b64_tr_b16 v[34:35], v20 offset:27648
    v_mfma_f32_32x32x16_bf16 v[136:151], v[40:43], v[196:199], v[136:151]
    ds_read_b64_tr_b16 v[36:37], v21 offset:25600
    ds_read_b64_tr_b16 v[38:39], v21 offset:27648
    s_waitcnt lgkmcnt(8)
    v_mfma_f32_32x32x16_bf16 v[88:103], v[44:47], v[196:199], v[88:103]
    ds_read_b64_tr_b16 v[40:41], v20 offset:28672
    ds_read_b64_tr_b16 v[42:43], v20 offset:30720
    v_mfma_f32_32x32x16_bf16 v[104:119], v[48:51], v[196:199], v[104:119]
    buffer_load_dwordx4 v[192:195], v249, s[32:35], s16 offen offset:2048 sc1
    ds_read_b64_tr_b16 v[44:45], v21 offset:28672
    ds_read_b64_tr_b16 v[46:47], v21 offset:30720
    s_barrier
    s_waitcnt vmcnt(22)
    s_waitcnt lgkmcnt(8)
    v_mfma_f32_32x32x16_bf16 v[56:71], v[52:55], v[200:203], v[56:71]
L_PAD3:
    s_cbranch_execz L_RET3
    ds_read_b64_tr_b16 v[48:49], v20 offset:29696
    ds_read_b64_tr_b16 v[50:51], v20 offset:31744
    v_mfma_f32_32x32x16_bf16 v[72:87], v[28:31], v[200:203], v[72:87]
    ds_read_b64_tr_b16 v[52:53], v21 offset:29696
    ds_read_b64_tr_b16 v[54:55], v21 offset:31744
    s_waitcnt vmcnt(21)
    s_waitcnt lgkmcnt(8)
    v_mfma_f32_32x32x16_bf16 v[56:71], v[32:35], v[204:207], v[56:71]
    ds_read_b64_tr_b16 v[28:29], v24 offset:24576
    ds_read_b64_tr_b16 v[30:31], v24 offset:26624
    v_mfma_f32_32x32x16_bf16 v[72:87], v[36:39], v[204:207], v[72:87]
    ds_read_b64_tr_b16 v[32:33], v25 offset:24576
    ds_read_b64_tr_b16 v[34:35], v25 offset:26624
    s_waitcnt vmcnt(20)
    s_waitcnt lgkmcnt(8)
    v_mfma_f32_32x32x16_bf16 v[56:71], v[40:43], v[208:211], v[56:71]
    ds_read_b64_tr_b16 v[36:37], v22 offset:24576
    ds_read_b64_tr_b16 v[38:39], v22 offset:26624
    v_mfma_f32_32x32x16_bf16 v[72:87], v[44:47], v[208:211], v[72:87]
    ds_read_b64_tr_b16 v[40:41], v23 offset:24576
    ds_read_b64_tr_b16 v[42:43], v23 offset:26624
    s_waitcnt vmcnt(19)
    s_waitcnt lgkmcnt(8)
    v_mfma_f32_32x32x16_bf16 v[56:71], v[48:51], v[212:215], v[56:71]
    ds_read_b64_tr_b16 v[44:45], v24 offset:25600
    ds_read_b64_tr_b16 v[46:47], v24 offset:27648
    v_mfma_f32_32x32x16_bf16 v[72:87], v[52:55], v[212:215], v[72:87]
    ds_read_b64_tr_b16 v[48:49], v25 offset:25600
    ds_read_b64_tr_b16 v[50:51], v25 offset:27648
    s_barrier
    s_waitcnt lgkmcnt(8)
    v_mfma_f32_32x32x16_bf16 v[120:135], v[28:31], v[200:203], v[120:135]
    ds_read_b64_tr_b16 v[52:53], v22 offset:25600
    ds_read_b64_tr_b16 v[54:55], v22 offset:27648
    v_mfma_f32_32x32x16_bf16 v[136:151], v[32:35], v[200:203], v[136:151]
    buffer_load_dwordx4 v[196:199], v249, s[32:35], s16 offen offset:3072 sc1
    ds_read_b64_tr_b16 v[28:29], v23 offset:25600
    ds_read_b64_tr_b16 v[30:31], v23 offset:27648
    s_waitcnt lgkmcnt(8)
    v_mfma_f32_32x32x16_bf16 v[88:103], v[36:39], v[200:203], v[88:103]
    s_add_u32 s16, s16, 16384
    ds_read_b64_tr_b16 v[32:33], v24 offset:28672
    ds_read_b64_tr_b16 v[34:35], v24 offset:30720
    v_mfma_f32_32x32x16_bf16 v[104:119], v[40:43], v[200:203], v[104:119]
    s_and_b32 s16, s16, 0x3ffff
    ds_read_b64_tr_b16 v[36:37], v25 offset:28672
    ds_read_b64_tr_b16 v[38:39], v25 offset:30720
    s_waitcnt lgkmcnt(8)
    v_mfma_f32_32x32x16_bf16 v[120:135], v[44:47], v[204:207], v[120:135]
    ds_read_b64_tr_b16 v[40:41], v22 offset:28672
    ds_read_b64_tr_b16 v[42:43], v22 offset:30720
    v_mfma_f32_32x32x16_bf16 v[136:151], v[48:51], v[204:207], v[136:151]
    buffer_load_dwordx4 v[200:203], v249, s[32:35], s16 offen sc1
    ds_read_b64_tr_b16 v[44:45], v23 offset:28672
    ds_read_b64_tr_b16 v[46:47], v23 offset:30720
    s_waitcnt lgkmcnt(8)
    v_mfma_f32_32x32x16_bf16 v[88:103], v[52:55], v[204:207], v[88:103]
    ds_read_b64_tr_b16 v[48:49], v24 offset:29696
    ds_read_b64_tr_b16 v[50:51], v24 offset:31744
    v_mfma_f32_32x32x16_bf16 v[104:119], v[28:31], v[204:207], v[104:119]
    ds_read_b64_tr_b16 v[52:53], v25 offset:29696
    ds_read_b64_tr_b16 v[54:55], v25 offset:31744
    s_waitcnt lgkmcnt(8)
    v_mfma_f32_32x32x16_bf16 v[120:135], v[32:35], v[208:211], v[120:135]
    buffer_load_dwordx4 v[204:207], v249, s[32:35], s16 offen offset:1024 sc1
    ds_read_b64_tr_b16 v[28:29], v22 offset:29696
    ds_read_b64_tr_b16 v[30:31], v22 offset:31744
    v_mfma_f32_32x32x16_bf16 v[136:151], v[36:39], v[208:211], v[136:151]
    ds_read_b64_tr_b16 v[32:33], v23 offset:29696
    ds_read_b64_tr_b16 v[34:35], v23 offset:31744
    s_waitcnt lgkmcnt(8)
    v_mfma_f32_32x32x16_bf16 v[88:103], v[40:43], v[208:211], v[88:103]
    ds_read_b64_tr_b16 v[36:37], v20 offset:32768
    ds_read_b64_tr_b16 v[38:39], v20 offset:34816
    v_mfma_f32_32x32x16_bf16 v[104:119], v[44:47], v[208:211], v[104:119]
    ds_read_b64_tr_b16 v[40:41], v20 offset:33792
    ds_read_b64_tr_b16 v[42:43], v20 offset:35840
    s_waitcnt lgkmcnt(8)
    v_mfma_f32_32x32x16_bf16 v[120:135], v[48:51], v[212:215], v[120:135]
    buffer_load_dwordx4 v[208:211], v249, s[32:35], s16 offen offset:2048 sc1
    ds_read_b64_tr_b16 v[44:45], v20 offset:36864
    ds_read_b64_tr_b16 v[46:47], v20 offset:38912
    v_mfma_f32_32x32x16_bf16 v[136:151], v[52:55], v[212:215], v[136:151]
    ds_read_b64_tr_b16 v[48:49], v20 offset:37888
    ds_read_b64_tr_b16 v[50:51], v20 offset:39936
    s_waitcnt lgkmcnt(8)
    v_mfma_f32_32x32x16_bf16 v[88:103], v[28:31], v[212:215], v[88:103]
    ds_read_b64_tr_b16 v[52:53], v20 offset:40960
    ds_read_b64_tr_b16 v[54:55], v20 offset:43008
    v_mfma_f32_32x32x16_bf16 v[104:119], v[32:35], v[212:215], v[104:119]
    buffer_load_dwordx4 v[212:215], v249, s[32:35], s16 offen offset:3072 sc1
    ds_read_b64_tr_b16 v[28:29], v20 offset:41984
    ds_read_b64_tr_b16 v[30:31], v20 offset:44032
    s_barrier
    s_waitcnt vmcnt(23)
    s_waitcnt lgkmcnt(8)
    v_mfma_f32_32x32x16_bf16 v[56:71], v[36:39], v[216:219], v[56:71]
    s_add_u32 s16, s16, 16384
    ds_read_b64_tr_b16 v[32:33], v20 offset:45056
    ds_read_b64_tr_b16 v[34:35], v20 offset:47104
    s_waitcnt vmcnt(22)
    v_mfma_f32_32x32x16_bf16 v[56:71], v[40:43], v[220:223], v[56:71]
    s_and_b32 s16, s16, 0x3ffff
    ds_read_b64_tr_b16 v[36:37], v20 offset:46080
    ds_read_b64_tr_b16 v[38:39], v20 offset:48128
    s_waitcnt vmcnt(21)
    s_waitcnt lgkmcnt(8)
    v_mfma_f32_32x32x16_bf16 v[56:71], v[44:47], v[224:227], v[56:71]
    ds_read_b64_tr_b16 v[40:41], v20
    ds_read_b64_tr_b16 v[42:43], v20 offset:2048
    s_waitcnt vmcnt(20)
    v_mfma_f32_32x32x16_bf16 v[56:71], v[48:51], v[228:231], v[56:71]
    ds_read_b64_tr_b16 v[44:45], v20 offset:1024
    ds_read_b64_tr_b16 v[46:47], v20 offset:3072
    s_waitcnt vmcnt(19)
    s_waitcnt lgkmcnt(8)
    v_mfma_f32_32x32x16_bf16 v[56:71], v[52:55], v[232:235], v[56:71]
    ds_read_b64_tr_b16 v[48:49], v20 offset:4096
    ds_read_b64_tr_b16 v[50:51], v20 offset:6144
    s_waitcnt vmcnt(18)
    v_mfma_f32_32x32x16_bf16 v[56:71], v[28:31], v[236:239], v[56:71]
    ds_read_b64_tr_b16 v[52:53], v20 offset:5120
    ds_read_b64_tr_b16 v[54:55], v20 offset:7168
    s_waitcnt vmcnt(17)
    s_waitcnt lgkmcnt(8)
    v_mfma_f32_32x32x16_bf16 v[56:71], v[32:35], v[240:243], v[56:71]
    ds_read_b64_tr_b16 v[28:29], v20 offset:8192
    ds_read_b64_tr_b16 v[30:31], v20 offset:10240
    s_waitcnt vmcnt(16)
    v_mfma_f32_32x32x16_bf16 v[56:71], v[36:39], v[244:247], v[56:71]
    ds_read_b64_tr_b16 v[32:33], v20 offset:9216
    ds_read_b64_tr_b16 v[34:35], v20 offset:11264
    s_waitcnt vmcnt(15)
    s_waitcnt lgkmcnt(8)
    v_mfma_f32_32x32x16_bf16 v[56:71], v[40:43], v[152:155], v[56:71]
    ds_read_b64_tr_b16 v[36:37], v20 offset:12288
    ds_read_b64_tr_b16 v[38:39], v20 offset:14336
    s_waitcnt vmcnt(14)
    v_mfma_f32_32x32x16_bf16 v[56:71], v[44:47], v[156:159], v[56:71]
    ds_read_b64_tr_b16 v[40:41], v20 offset:13312
    ds_read_b64_tr_b16 v[42:43], v20 offset:15360
    s_waitcnt vmcnt(13)
    s_waitcnt lgkmcnt(8)
    v_mfma_f32_32x32x16_bf16 v[56:71], v[48:51], v[160:163], v[56:71]
    ds_read_b64_tr_b16 v[44:45], v20 offset:16384
    ds_read_b64_tr_b16 v[46:47], v20 offset:18432
    s_waitcnt vmcnt(12)
    v_mfma_f32_32x32x16_bf16 v[56:71], v[52:55], v[164:167], v[56:71]
    ds_read_b64_tr_b16 v[48:49], v20 offset:17408
    ds_read_b64_tr_b16 v[50:51], v20 offset:19456
    s_waitcnt vmcnt(11)
    s_waitcnt lgkmcnt(8)
    v_mfma_f32_32x32x16_bf16 v[56:71], v[28:31], v[168:171], v[56:71]
    ds_read_b64_tr_b16 v[52:53], v20 offset:20480
    ds_read_b64_tr_b16 v[54:55], v20 offset:22528
    s_waitcnt vmcnt(10)
    v_mfma_f32_32x32x16_bf16 v[56:71], v[32:35], v[172:175], v[56:71]
    ds_read_b64_tr_b16 v[28:29], v20 offset:21504
    ds_read_b64_tr_b16 v[30:31], v20 offset:23552
    s_barrier
    s_waitcnt vmcnt(9)
    s_waitcnt lgkmcnt(8)
    v_mfma_f32_32x32x16_bf16 v[56:71], v[36:39], v[176:179], v[56:71]
    ds_read_b64_tr_b16 v[32:33], v20 offset:24576
    ds_read_b64_tr_b16 v[34:35], v20 offset:26624
    s_waitcnt vmcnt(8)
    v_mfma_f32_32x32x16_bf16 v[56:71], v[40:43], v[180:183], v[56:71]
    ds_read_b64_tr_b16 v[36:37], v20 offset:25600
    ds_read_b64_tr_b16 v[38:39], v20 offset:27648
    s_waitcnt vmcnt(7)
    s_waitcnt lgkmcnt(8)
    v_mfma_f32_32x32x16_bf16 v[56:71], v[44:47], v[184:187], v[56:71]
    ds_read_b64_tr_b16 v[40:41], v20 offset:28672
    ds_read_b64_tr_b16 v[42:43], v20 offset:30720
    s_waitcnt vmcnt(6)
    v_mfma_f32_32x32x16_bf16 v[56:71], v[48:51], v[188:191], v[56:71]
    ds_read_b64_tr_b16 v[44:45], v20 offset:29696
    ds_read_b64_tr_b16 v[46:47], v20 offset:31744
    s_waitcnt vmcnt(5)
    s_waitcnt lgkmcnt(8)
    v_mfma_f32_32x32x16_bf16 v[56:71], v[52:55], v[192:195], v[56:71]
    ds_read_b64_tr_b16 v[48:49], v21 offset:32768
    ds_read_b64_tr_b16 v[50:51], v21 offset:34816
    s_waitcnt vmcnt(4)
    v_mfma_f32_32x32x16_bf16 v[56:71], v[28:31], v[196:199], v[56:71]
    ds_read_b64_tr_b16 v[52:53], v21 offset:33792
    ds_read_b64_tr_b16 v[54:55], v21 offset:35840
    s_waitcnt vmcnt(3)
    s_waitcnt lgkmcnt(8)
    v_mfma_f32_32x32x16_bf16 v[56:71], v[32:35], v[200:203], v[56:71]
    ds_read_b64_tr_b16 v[28:29], v21 offset:36864
    ds_read_b64_tr_b16 v[30:31], v21 offset:38912
    s_waitcnt vmcnt(2)
    v_mfma_f32_32x32x16_bf16 v[56:71], v[36:39], v[204:207], v[56:71]
    ds_read_b64_tr_b16 v[32:33], v21 offset:37888
    ds_read_b64_tr_b16 v[34:35], v21 offset:39936
    s_waitcnt vmcnt(1)
    s_waitcnt lgkmcnt(8)
    v_mfma_f32_32x32x16_bf16 v[56:71], v[40:43], v[208:211], v[56:71]
    ds_read_b64_tr_b16 v[36:37], v21 offset:40960
    ds_read_b64_tr_b16 v[38:39], v21 offset:43008
    s_waitcnt vmcnt(0)
    v_mfma_f32_32x32x16_bf16 v[56:71], v[44:47], v[212:215], v[56:71]
    ds_read_b64_tr_b16 v[40:41], v21 offset:41984
    ds_read_b64_tr_b16 v[42:43], v21 offset:44032
    s_waitcnt lgkmcnt(8)
    v_mfma_f32_32x32x16_bf16 v[72:87], v[48:51], v[216:219], v[72:87]
    ds_read_b64_tr_b16 v[44:45], v21 offset:45056
    ds_read_b64_tr_b16 v[46:47], v21 offset:47104
    v_mfma_f32_32x32x16_bf16 v[72:87], v[52:55], v[220:223], v[72:87]
    s_nop 4
    v_cvt_pk_bf16_f32 v56, v56, v57
    v_cvt_pk_bf16_f32 v57, v58, v59
    ds_read_b64_tr_b16 v[48:49], v21 offset:46080
    ds_read_b64_tr_b16 v[50:51], v21 offset:48128
    s_waitcnt lgkmcnt(8)
    v_mfma_f32_32x32x16_bf16 v[72:87], v[28:31], v[224:227], v[72:87]
    v_cvt_pk_bf16_f32 v58, v60, v61
    v_cvt_pk_bf16_f32 v59, v62, v63
    ds_read_b64_tr_b16 v[52:53], v21
    ds_read_b64_tr_b16 v[54:55], v21 offset:2048
    v_mfma_f32_32x32x16_bf16 v[72:87], v[32:35], v[228:231], v[72:87]
    ds_write_b128 v0, v[56:59]
    v_cvt_pk_bf16_f32 v60, v64, v65
    ds_read_b64_tr_b16 v[28:29], v21 offset:1024
    ds_read_b64_tr_b16 v[30:31], v21 offset:3072
    s_waitcnt lgkmcnt(9)
    v_mfma_f32_32x32x16_bf16 v[72:87], v[36:39], v[232:235], v[72:87]
    v_cvt_pk_bf16_f32 v61, v66, v67
    v_cvt_pk_bf16_f32 v62, v68, v69
    ds_read_b64_tr_b16 v[32:33], v21 offset:4096
    ds_read_b64_tr_b16 v[34:35], v21 offset:6144
    v_mfma_f32_32x32x16_bf16 v[72:87], v[40:43], v[236:239], v[72:87]
    v_cvt_pk_bf16_f32 v63, v70, v71
    ds_write_b128 v0, v[60:63] offset:1024
    ds_read_b64_tr_b16 v[36:37], v21 offset:5120
    ds_read_b64_tr_b16 v[38:39], v21 offset:7168
    s_waitcnt lgkmcnt(10)
    v_mfma_f32_32x32x16_bf16 v[72:87], v[44:47], v[240:243], v[72:87]
    v_subrev_u32 v0, 118784, v0
    ds_read_b64_tr_b16 v[40:41], v21 offset:8192
    ds_read_b64_tr_b16 v[42:43], v21 offset:10240
    v_mfma_f32_32x32x16_bf16 v[72:87], v[48:51], v[244:247], v[72:87]
    ds_read_b64_tr_b16 v[44:45], v21 offset:9216
    ds_read_b64_tr_b16 v[46:47], v21 offset:11264
    s_waitcnt lgkmcnt(6)
    s_barrier
    v_mfma_f32_32x32x16_bf16 v[72:87], v[52:55], v[152:155], v[72:87]
    ds_read_b64_tr_b16 v[48:49], v21 offset:12288
    ds_read_b64_tr_b16 v[50:51], v21 offset:14336
    v_mfma_f32_32x32x16_bf16 v[72:87], v[28:31], v[156:159], v[72:87]
    ds_read_b64_tr_b16 v[52:53], v21 offset:13312
    ds_read_b64_tr_b16 v[54:55], v21 offset:15360
    s_waitcnt lgkmcnt(8)
    v_mfma_f32_32x32x16_bf16 v[72:87], v[32:35], v[160:163], v[72:87]
    ds_read_b64_tr_b16 v[28:29], v21 offset:16384
    ds_read_b64_tr_b16 v[30:31], v21 offset:18432
    v_mfma_f32_32x32x16_bf16 v[72:87], v[36:39], v[164:167], v[72:87]
    ds_read_b64_tr_b16 v[32:33], v21 offset:17408
    ds_read_b64_tr_b16 v[34:35], v21 offset:19456
    s_waitcnt lgkmcnt(8)
    v_mfma_f32_32x32x16_bf16 v[72:87], v[40:43], v[168:171], v[72:87]
    ds_read_b64_tr_b16 v[36:37], v21 offset:20480
    ds_read_b64_tr_b16 v[38:39], v21 offset:22528
    v_mfma_f32_32x32x16_bf16 v[72:87], v[44:47], v[172:175], v[72:87]
    ds_read_b64_tr_b16 v[40:41], v21 offset:21504
    ds_read_b64_tr_b16 v[42:43], v21 offset:23552
    s_waitcnt lgkmcnt(8)
    v_mfma_f32_32x32x16_bf16 v[72:87], v[48:51], v[176:179], v[72:87]
    ds_read_b64_tr_b16 v[44:45], v21 offset:24576
    ds_read_b64_tr_b16 v[46:47], v21 offset:26624
    v_mfma_f32_32x32x16_bf16 v[72:87], v[52:55], v[180:183], v[72:87]
    ds_read_b64_tr_b16 v[48:49], v21 offset:25600
    ds_read_b64_tr_b16 v[50:51], v21 offset:27648
    s_waitcnt lgkmcnt(8)
    v_mfma_f32_32x32x16_bf16 v[72:87], v[28:31], v[184:187], v[72:87]
    ds_read_b64_tr_b16 v[52:53], v21 offset:28672
    ds_read_b64_tr_b16 v[54:55], v21 offset:30720
    v_mfma_f32_32x32x16_bf16 v[72:87], v[32:35], v[188:191], v[72:87]
    ds_read_b64_tr_b16 v[28:29], v21 offset:29696
    ds_read_b64_tr_b16 v[30:31], v21 offset:31744
    s_waitcnt lgkmcnt(8)
    v_mfma_f32_32x32x16_bf16 v[72:87], v[36:39], v[192:195], v[72:87]
    ds_read_b64_tr_b16 v[32:33], v22 offset:32768
    ds_read_b64_tr_b16 v[34:35], v22 offset:34816
    v_mfma_f32_32x32x16_bf16 v[72:87], v[40:43], v[196:199], v[72:87]
    ds_read_b64_tr_b16 v[36:37], v23 offset:32768
    ds_read_b64_tr_b16 v[38:39], v23 offset:34816
    s_waitcnt lgkmcnt(8)
    v_mfma_f32_32x32x16_bf16 v[72:87], v[44:47], v[200:203], v[72:87]
    ds_read_b64_tr_b16 v[40:41], v22 offset:33792
    ds_read_b64_tr_b16 v[42:43], v22 offset:35840
    v_mfma_f32_32x32x16_bf16 v[72:87], v[48:51], v[204:207], v[72:87]
    ds_read_b64_tr_b16 v[44:45], v23 offset:33792
    ds_read_b64_tr_b16 v[46:47], v23 offset:35840
    s_waitcnt lgkmcnt(8)
    v_mfma_f32_32x32x16_bf16 v[72:87], v[52:55], v[208:211], v[72:87]
    ds_read_b64_tr_b16 v[48:49], v22 offset:36864
    ds_read_b64_tr_b16 v[50:51], v22 offset:38912
    v_mfma_f32_32x32x16_bf16 v[72:87], v[28:31], v[212:215], v[72:87]
    ds_read_b64_tr_b16 v[52:53], v23 offset:36864
    ds_read_b64_tr_b16 v[54:55], v23 offset:38912
    s_waitcnt lgkmcnt(8)
    v_mfma_f32_32x32x16_bf16 v[88:103], v[32:35], v[216:219], v[88:103]
    ds_read_b64_tr_b16 v[28:29], v22 offset:37888
    ds_read_b64_tr_b16 v[30:31], v22 offset:39936
    v_mfma_f32_32x32x16_bf16 v[104:119], v[36:39], v[216:219], v[104:119]
    s_nop 4
    v_cvt_pk_bf16_f32 v72, v72, v73
    v_cvt_pk_bf16_f32 v73, v74, v75
    ds_read_b64_tr_b16 v[32:33], v23 offset:37888
    ds_read_b64_tr_b16 v[34:35], v23 offset:39936
    s_waitcnt lgkmcnt(8)
    v_mfma_f32_32x32x16_bf16 v[88:103], v[40:43], v[220:223], v[88:103]
    v_cvt_pk_bf16_f32 v74, v76, v77
    v_cvt_pk_bf16_f32 v75, v78, v79
    ds_read_b64_tr_b16 v[36:37], v22 offset:40960
    ds_read_b64_tr_b16 v[38:39], v22 offset:43008
    v_mfma_f32_32x32x16_bf16 v[104:119], v[44:47], v[220:223], v[104:119]
    ds_write_b128 v0, v[72:75]
    v_cvt_pk_bf16_f32 v76, v80, v81
    ds_read_b64_tr_b16 v[40:41], v23 offset:40960
    ds_read_b64_tr_b16 v[42:43], v23 offset:43008
    s_waitcnt lgkmcnt(9)
    v_mfma_f32_32x32x16_bf16 v[88:103], v[48:51], v[224:227], v[88:103]
    v_cvt_pk_bf16_f32 v77, v82, v83
    v_cvt_pk_bf16_f32 v78, v84, v85
    ds_read_b64_tr_b16 v[44:45], v22 offset:41984
    ds_read_b64_tr_b16 v[46:47], v22 offset:44032
    v_mfma_f32_32x32x16_bf16 v[104:119], v[52:55], v[224:227], v[104:119]
    v_cvt_pk_bf16_f32 v79, v86, v87
    ds_write_b128 v0, v[76:79] offset:1024
    ds_read_b64_tr_b16 v[48:49], v23 offset:41984
    ds_read_b64_tr_b16 v[50:51], v23 offset:44032
    s_waitcnt lgkmcnt(10)
    v_mfma_f32_32x32x16_bf16 v[88:103], v[28:31], v[228:231], v[88:103]
    ds_read_b64_tr_b16 v[52:53], v22 offset:45056
    ds_read_b64_tr_b16 v[54:55], v22 offset:47104
    v_mfma_f32_32x32x16_bf16 v[104:119], v[32:35], v[228:231], v[104:119]
    ds_read_b64_tr_b16 v[28:29], v23 offset:45056
    ds_read_b64_tr_b16 v[30:31], v23 offset:47104
    s_waitcnt lgkmcnt(6)
    s_barrier
    v_mfma_f32_32x32x16_bf16 v[88:103], v[36:39], v[232:235], v[88:103]
    s_lshl_b32 s96, s77, 11
    s_add_u32 s14, s96, 32768
    v_and_b32 v0, 7, v1
    ds_read_b64_tr_b16 v[32:33], v22 offset:46080
    ds_read_b64_tr_b16 v[34:35], v22 offset:48128
    v_mfma_f32_32x32x16_bf16 v[104:119], v[40:43], v[232:235], v[104:119]
    v_lshl_add_u32 v0, v0, 4, s14
    ds_read_b64_tr_b16 v[36:37], v23 offset:46080
    ds_read_b64_tr_b16 v[38:39], v23 offset:48128
    s_waitcnt lgkmcnt(8)
    v_mfma_f32_32x32x16_bf16 v[88:103], v[44:47], v[236:239], v[88:103]
    v_bfe_u32 v4, v1, 3, 2
    ds_read_b64_tr_b16 v[40:41], v22
    ds_read_b64_tr_b16 v[42:43], v22 offset:2048
    v_mfma_f32_32x32x16_bf16 v[104:119], v[48:51], v[236:239], v[104:119]
    v_lshl_add_u32 v0, v4, 8, v0
    v_lshrrev_b32 v4, 5, v1
    ds_read_b64_tr_b16 v[44:45], v23
    ds_read_b64_tr_b16 v[46:47], v23 offset:2048
    s_waitcnt lgkmcnt(8)
    v_mfma_f32_32x32x16_bf16 v[88:103], v[52:55], v[240:243], v[88:103]
    v_lshl_add_u32 v0, v4, 7, v0
    ds_read_b64_tr_b16 v[48:49], v22 offset:1024
    ds_read_b64_tr_b16 v[50:51], v22 offset:3072
    v_mfma_f32_32x32x16_bf16 v[104:119], v[28:31], v[240:243], v[104:119]
    ds_read_b64_tr_b16 v[52:53], v23 offset:1024
    ds_read_b64_tr_b16 v[54:55], v23 offset:3072
    s_waitcnt lgkmcnt(8)
    v_mfma_f32_32x32x16_bf16 v[88:103], v[32:35], v[244:247], v[88:103]
    ds_read_b64_tr_b16 v[28:29], v22 offset:4096
    ds_read_b64_tr_b16 v[30:31], v22 offset:6144
    v_mfma_f32_32x32x16_bf16 v[104:119], v[36:39], v[244:247], v[104:119]
    ds_read_b64_tr_b16 v[32:33], v23 offset:4096
    ds_read_b64_tr_b16 v[34:35], v23 offset:6144
    s_waitcnt lgkmcnt(8)
    v_mfma_f32_32x32x16_bf16 v[88:103], v[40:43], v[152:155], v[88:103]
    ds_read_b64_tr_b16 v[36:37], v22 offset:5120
    ds_read_b64_tr_b16 v[38:39], v22 offset:7168
    v_mfma_f32_32x32x16_bf16 v[104:119], v[44:47], v[152:155], v[104:119]
    ds_read_b64_tr_b16 v[40:41], v23 offset:5120
    ds_read_b64_tr_b16 v[42:43], v23 offset:7168
    s_waitcnt lgkmcnt(8)
    v_mfma_f32_32x32x16_bf16 v[88:103], v[48:51], v[156:159], v[88:103]
    ds_read_b64_tr_b16 v[44:45], v22 offset:8192
    ds_read_b64_tr_b16 v[46:47], v22 offset:10240
    v_mfma_f32_32x32x16_bf16 v[104:119], v[52:55], v[156:159], v[104:119]
    ds_read_b64_tr_b16 v[48:49], v23 offset:8192
    ds_read_b64_tr_b16 v[50:51], v23 offset:10240
    s_waitcnt lgkmcnt(8)
    v_mfma_f32_32x32x16_bf16 v[88:103], v[28:31], v[160:163], v[88:103]
    ds_read_b64_tr_b16 v[52:53], v22 offset:9216
    ds_read_b64_tr_b16 v[54:55], v22 offset:11264
    v_mfma_f32_32x32x16_bf16 v[104:119], v[32:35], v[160:163], v[104:119]
    ds_read_b64_tr_b16 v[28:29], v23 offset:9216
    ds_read_b64_tr_b16 v[30:31], v23 offset:11264
    s_waitcnt lgkmcnt(8)
    v_mfma_f32_32x32x16_bf16 v[88:103], v[36:39], v[164:167], v[88:103]
    ds_read_b64_tr_b16 v[32:33], v22 offset:12288
    ds_read_b64_tr_b16 v[34:35], v22 offset:14336
    v_mfma_f32_32x32x16_bf16 v[104:119], v[40:43], v[164:167], v[104:119]
    ds_read_b64_tr_b16 v[36:37], v23 offset:12288
    ds_read_b64_tr_b16 v[38:39], v23 offset:14336
    s_waitcnt lgkmcnt(8)
    v_mfma_f32_32x32x16_bf16 v[88:103], v[44:47], v[168:171], v[88:103]
    ds_read_b64_tr_b16 v[40:41], v22 offset:13312
    ds_read_b64_tr_b16 v[42:43], v22 offset:15360
    v_mfma_f32_32x32x16_bf16 v[104:119], v[48:51], v[168:171], v[104:119]
    ds_read_b64_tr_b16 v[44:45], v23 offset:13312
    ds_read_b64_tr_b16 v[46:47], v23 offset:15360
    s_waitcnt lgkmcnt(8)
    v_mfma_f32_32x32x16_bf16 v[88:103], v[52:55], v[172:175], v[88:103]
    ds_read_b64_tr_b16 v[48:49], v22 offset:16384
    ds_read_b64_tr_b16 v[50:51], v22 offset:18432
    v_mfma_f32_32x32x16_bf16 v[104:119], v[28:31], v[172:175], v[104:119]
    ds_read_b64_tr_b16 v[52:53], v23 offset:16384
    ds_read_b64_tr_b16 v[54:55], v23 offset:18432
    s_waitcnt lgkmcnt(8)
    v_mfma_f32_32x32x16_bf16 v[88:103], v[32:35], v[176:179], v[88:103]
    ds_read_b64_tr_b16 v[28:29], v22 offset:17408
    ds_read_b64_tr_b16 v[30:31], v22 offset:19456
    v_mfma_f32_32x32x16_bf16 v[104:119], v[36:39], v[176:179], v[104:119]
    ds_read_b64_tr_b16 v[32:33], v23 offset:17408
    ds_read_b64_tr_b16 v[34:35], v23 offset:19456
    s_waitcnt lgkmcnt(8)
    v_mfma_f32_32x32x16_bf16 v[88:103], v[40:43], v[180:183], v[88:103]
    ds_read_b64_tr_b16 v[36:37], v22 offset:20480
    ds_read_b64_tr_b16 v[38:39], v22 offset:22528
    v_mfma_f32_32x32x16_bf16 v[104:119], v[44:47], v[180:183], v[104:119]
    ds_read_b64_tr_b16 v[40:41], v23 offset:20480
    ds_read_b64_tr_b16 v[42:43], v23 offset:22528
    s_waitcnt lgkmcnt(8)
    v_mfma_f32_32x32x16_bf16 v[88:103], v[48:51], v[184:187], v[88:103]
    ds_read_b64_tr_b16 v[44:45], v22 offset:21504
    ds_read_b64_tr_b16 v[46:47], v22 offset:23552
    v_mfma_f32_32x32x16_bf16 v[104:119], v[52:55], v[184:187], v[104:119]
    ds_read_b64_tr_b16 v[48:49], v23 offset:21504
    ds_read_b64_tr_b16 v[50:51], v23 offset:23552
    s_waitcnt lgkmcnt(8)
    v_mfma_f32_32x32x16_bf16 v[88:103], v[28:31], v[188:191], v[88:103]
    ds_read_b64_tr_b16 v[52:53], v22 offset:24576
    ds_read_b64_tr_b16 v[54:55], v22 offset:26624
    v_mfma_f32_32x32x16_bf16 v[104:119], v[32:35], v[188:191], v[104:119]
    ds_read_b64_tr_b16 v[28:29], v23 offset:24576
    ds_read_b64_tr_b16 v[30:31], v23 offset:26624
    s_waitcnt lgkmcnt(8)
    v_mfma_f32_32x32x16_bf16 v[88:103], v[36:39], v[192:195], v[88:103]
    ds_read_b64_tr_b16 v[32:33], v22 offset:25600
    ds_read_b64_tr_b16 v[34:35], v22 offset:27648
    v_mfma_f32_32x32x16_bf16 v[104:119], v[40:43], v[192:195], v[104:119]
    ds_read_b64_tr_b16 v[36:37], v23 offset:25600
    ds_read_b64_tr_b16 v[38:39], v23 offset:27648
    s_waitcnt lgkmcnt(8)
    v_mfma_f32_32x32x16_bf16 v[88:103], v[44:47], v[196:199], v[88:103]
    ds_read_b64_tr_b16 v[40:41], v22 offset:28672
    ds_read_b64_tr_b16 v[42:43], v22 offset:30720
    v_mfma_f32_32x32x16_bf16 v[104:119], v[48:51], v[196:199], v[104:119]
    ds_read_b64_tr_b16 v[44:45], v23 offset:28672
    ds_read_b64_tr_b16 v[46:47], v23 offset:30720
    s_waitcnt lgkmcnt(8)
    v_mfma_f32_32x32x16_bf16 v[88:103], v[52:55], v[200:203], v[88:103]
    ds_read_b64_tr_b16 v[48:49], v22 offset:29696
    ds_read_b64_tr_b16 v[50:51], v22 offset:31744
    v_mfma_f32_32x32x16_bf16 v[104:119], v[28:31], v[200:203], v[104:119]
    ds_read_b64_tr_b16 v[52:53], v23 offset:29696
    ds_read_b64_tr_b16 v[54:55], v23 offset:31744
    s_waitcnt lgkmcnt(8)
    v_mfma_f32_32x32x16_bf16 v[88:103], v[32:35], v[204:207], v[88:103]
    ds_read_b64_tr_b16 v[28:29], v24 offset:32768
    ds_read_b64_tr_b16 v[30:31], v24 offset:34816
    v_mfma_f32_32x32x16_bf16 v[104:119], v[36:39], v[204:207], v[104:119]
    ds_read_b64_tr_b16 v[32:33], v25 offset:32768
    ds_read_b64_tr_b16 v[34:35], v25 offset:34816
    s_waitcnt lgkmcnt(8)
    v_mfma_f32_32x32x16_bf16 v[88:103], v[40:43], v[208:211], v[88:103]
    ds_read_b64_tr_b16 v[36:37], v24 offset:33792
    ds_read_b64_tr_b16 v[38:39], v24 offset:35840
    v_mfma_f32_32x32x16_bf16 v[104:119], v[44:47], v[208:211], v[104:119]
    ds_read_b64_tr_b16 v[40:41], v25 offset:33792
    ds_read_b64_tr_b16 v[42:43], v25 offset:35840
    s_waitcnt lgkmcnt(8)
    v_mfma_f32_32x32x16_bf16 v[88:103], v[48:51], v[212:215], v[88:103]
    ds_read_b64_tr_b16 v[44:45], v24 offset:36864
    ds_read_b64_tr_b16 v[46:47], v24 offset:38912
    v_mfma_f32_32x32x16_bf16 v[104:119], v[52:55], v[212:215], v[104:119]
    ds_read_b64_tr_b16 v[48:49], v25 offset:36864
    ds_read_b64_tr_b16 v[50:51], v25 offset:38912
    s_barrier
    s_waitcnt lgkmcnt(8)
    v_mfma_f32_32x32x16_bf16 v[120:135], v[28:31], v[216:219], v[120:135]
    ds_read_b64_tr_b16 v[52:53], v24 offset:37888
    ds_read_b64_tr_b16 v[54:55], v24 offset:39936
    v_mfma_f32_32x32x16_bf16 v[136:151], v[32:35], v[216:219], v[136:151]
    ds_read_b64_tr_b16 v[28:29], v25 offset:37888
    ds_read_b64_tr_b16 v[30:31], v25 offset:39936
    s_waitcnt lgkmcnt(8)
    v_mfma_f32_32x32x16_bf16 v[120:135], v[36:39], v[220:223], v[120:135]
    v_cvt_pk_bf16_f32 v88, v88, v89
    ds_read_b64_tr_b16 v[32:33], v24 offset:40960
    ds_read_b64_tr_b16 v[34:35], v24 offset:43008
    v_mfma_f32_32x32x16_bf16 v[136:151], v[40:43], v[220:223], v[136:151]
    v_cvt_pk_bf16_f32 v89, v90, v91
    ds_read_b64_tr_b16 v[36:37], v25 offset:40960
    ds_read_b64_tr_b16 v[38:39], v25 offset:43008
    s_waitcnt lgkmcnt(8)
    v_mfma_f32_32x32x16_bf16 v[120:135], v[44:47], v[224:227], v[120:135]
    v_cvt_pk_bf16_f32 v90, v92, v93
    ds_read_b64_tr_b16 v[40:41], v24 offset:41984
    ds_read_b64_tr_b16 v[42:43], v24 offset:44032
    v_mfma_f32_32x32x16_bf16 v[136:151], v[48:51], v[224:227], v[136:151]
    v_cvt_pk_bf16_f32 v91, v94, v95
    ds_read_b64_tr_b16 v[44:45], v25 offset:41984
    ds_read_b64_tr_b16 v[46:47], v25 offset:44032
    s_waitcnt lgkmcnt(8)
    v_mfma_f32_32x32x16_bf16 v[120:135], v[52:55], v[228:231], v[120:135]
    ds_write_b128 v0, v[88:91]
    ds_read_b64_tr_b16 v[48:49], v24 offset:45056
    ds_read_b64_tr_b16 v[50:51], v24 offset:47104
    v_mfma_f32_32x32x16_bf16 v[136:151], v[28:31], v[228:231], v[136:151]
    v_cvt_pk_bf16_f32 v92, v96, v97
    ds_read_b64_tr_b16 v[52:53], v25 offset:45056
    ds_read_b64_tr_b16 v[54:55], v25 offset:47104
    s_waitcnt lgkmcnt(9)
    v_mfma_f32_32x32x16_bf16 v[120:135], v[32:35], v[232:235], v[120:135]
    v_cvt_pk_bf16_f32 v93, v98, v99
    ds_read_b64_tr_b16 v[28:29], v24 offset:46080
    ds_read_b64_tr_b16 v[30:31], v24 offset:48128
    v_mfma_f32_32x32x16_bf16 v[136:151], v[36:39], v[232:235], v[136:151]
    v_cvt_pk_bf16_f32 v94, v100, v101
    ds_read_b64_tr_b16 v[32:33], v25 offset:46080
    ds_read_b64_tr_b16 v[34:35], v25 offset:48128
    s_waitcnt lgkmcnt(9)
    v_mfma_f32_32x32x16_bf16 v[120:135], v[40:43], v[236:239], v[120:135]
    v_cvt_pk_bf16_f32 v95, v102, v103
    ds_read_b64_tr_b16 v[36:37], v24
    ds_read_b64_tr_b16 v[38:39], v24 offset:2048
    v_mfma_f32_32x32x16_bf16 v[136:151], v[44:47], v[236:239], v[136:151]
    ds_write_b128 v0, v[92:95] offset:1024
    ds_read_b64_tr_b16 v[40:41], v25
    ds_read_b64_tr_b16 v[42:43], v25 offset:2048
    s_waitcnt lgkmcnt(9)
    v_mfma_f32_32x32x16_bf16 v[120:135], v[48:51], v[240:243], v[120:135]
    v_cvt_pk_bf16_f32 v104, v104, v105
    ds_read_b64_tr_b16 v[44:45], v24 offset:1024
    ds_read_b64_tr_b16 v[46:47], v24 offset:3072
    v_mfma_f32_32x32x16_bf16 v[136:151], v[52:55], v[240:243], v[136:151]
    v_cvt_pk_bf16_f32 v105, v106, v107
    ds_read_b64_tr_b16 v[48:49], v25 offset:1024
    ds_read_b64_tr_b16 v[50:51], v25 offset:3072
    s_waitcnt lgkmcnt(9)
    v_mfma_f32_32x32x16_bf16 v[120:135], v[28:31], v[244:247], v[120:135]
    v_cvt_pk_bf16_f32 v106, v108, v109
    ds_read_b64_tr_b16 v[52:53], v24 offset:4096
    ds_read_b64_tr_b16 v[54:55], v24 offset:6144
    v_mfma_f32_32x32x16_bf16 v[136:151], v[32:35], v[244:247], v[136:151]
    v_cvt_pk_bf16_f32 v107, v110, v111
    ds_read_b64_tr_b16 v[28:29], v25 offset:4096
    ds_read_b64_tr_b16 v[30:31], v25 offset:6144
    s_waitcnt lgkmcnt(8)
    v_mfma_f32_32x32x16_bf16 v[120:135], v[36:39], v[152:155], v[120:135]
    ds_write_b128 v0, v[104:107] offset:8192
    ds_read_b64_tr_b16 v[32:33], v24 offset:5120
L_PAD4:
    s_cbranch_execz L_RET4
    ds_read_b64_tr_b16 v[34:35], v24 offset:7168
    v_mfma_f32_32x32x16_bf16 v[136:151], v[40:43], v[152:155], v[136:151]
    v_cvt_pk_bf16_f32 v108, v112, v113
    ds_read_b64_tr_b16 v[36:37], v25 offset:5120
    ds_read_b64_tr_b16 v[38:39], v25 offset:7168
    s_waitcnt lgkmcnt(9)
    v_mfma_f32_32x32x16_bf16 v[120:135], v[44:47], v[156:159], v[120:135]
    v_cvt_pk_bf16_f32 v109, v114, v115
    ds_read_b64_tr_b16 v[40:41], v24 offset:8192
    ds_read_b64_tr_b16 v[42:43], v24 offset:10240
    v_mfma_f32_32x32x16_bf16 v[136:151], v[48:51], v[156:159], v[136:151]
    v_cvt_pk_bf16_f32 v110, v116, v117
    ds_read_b64_tr_b16 v[44:45], v25 offset:8192
    ds_read_b64_tr_b16 v[46:47], v25 offset:10240
    s_waitcnt lgkmcnt(9)
    v_mfma_f32_32x32x16_bf16 v[120:135], v[52:55], v[160:163], v[120:135]
    v_cvt_pk_bf16_f32 v111, v118, v119
    ds_read_b64_tr_b16 v[48:49], v24 offset:9216
    ds_read_b64_tr_b16 v[50:51], v24 offset:11264
    v_mfma_f32_32x32x16_bf16 v[136:151], v[28:31], v[160:163], v[136:151]
    ds_write_b128 v0, v[108:111] offset:9216
    ds_read_b64_tr_b16 v[52:53], v25 offset:9216
    ds_read_b64_tr_b16 v[54:55], v25 offset:11264
    s_waitcnt lgkmcnt(9)
    v_mfma_f32_32x32x16_bf16 v[120:135], v[32:35], v[164:167], v[120:135]
    v_and_b32 v85, 1, v1
    ds_read_b64_tr_b16 v[28:29], v24 offset:12288
    ds_read_b64_tr_b16 v[30:31], v24 offset:14336
    v_mfma_f32_32x32x16_bf16 v[136:151], v[36:39], v[164:167], v[136:151]
    v_lshlrev_b32 v85, 3, v85
    ds_read_b64_tr_b16 v[32:33], v25 offset:12288
    ds_read_b64_tr_b16 v[34:35], v25 offset:14336
    s_waitcnt lgkmcnt(9)
    v_mfma_f32_32x32x16_bf16 v[120:135], v[40:43], v[168:171], v[120:135]
    v_bfe_u32 v84, v1, 2, 2
    ds_read_b64_tr_b16 v[36:37], v24 offset:13312
    ds_read_b64_tr_b16 v[38:39], v24 offset:15360
    v_mfma_f32_32x32x16_bf16 v[136:151], v[44:47], v[168:171], v[136:151]
    v_lshl_add_u32 v85, v84, 4, v85
    ds_read_b64_tr_b16 v[40:41], v25 offset:13312
    ds_read_b64_tr_b16 v[42:43], v25 offset:15360
    s_waitcnt lgkmcnt(8)
    v_mfma_f32_32x32x16_bf16 v[120:135], v[48:51], v[172:175], v[120:135]
    v_bfe_u32 v84, v1, 4, 1
    ds_read_b64_tr_b16 v[44:45], v24 offset:16384
    ds_read_b64_tr_b16 v[46:47], v24 offset:18432
    v_mfma_f32_32x32x16_bf16 v[136:151], v[52:55], v[172:175], v[136:151]
    v_lshl_add_u32 v85, v84, 6, v85
    ds_read_b64_tr_b16 v[48:49], v25 offset:16384
    ds_read_b64_tr_b16 v[50:51], v25 offset:18432
    s_waitcnt lgkmcnt(8)
    v_mfma_f32_32x32x16_bf16 v[120:135], v[28:31], v[176:179], v[120:135]
    v_bfe_u32 v84, v1, 1, 1
    ds_read_b64_tr_b16 v[52:53], v24 offset:17408
    ds_read_b64_tr_b16 v[54:55], v24 offset:19456
    v_mfma_f32_32x32x16_bf16 v[136:151], v[32:35], v[176:179], v[136:151]
    v_lshl_add_u32 v85, v84, 7, v85
    ds_read_b64_tr_b16 v[28:29], v25 offset:17408
    ds_read_b64_tr_b16 v[30:31], v25 offset:19456
    s_waitcnt lgkmcnt(8)
    v_mfma_f32_32x32x16_bf16 v[120:135], v[36:39], v[180:183], v[120:135]
    v_lshrrev_b32 v84, 5, v1
    ds_read_b64_tr_b16 v[32:33], v24 offset:20480
    ds_read_b64_tr_b16 v[34:35], v24 offset:22528
    v_mfma_f32_32x32x16_bf16 v[136:151], v[40:43], v[180:183], v[136:151]
    v_lshl_add_u32 v85, v84, 8, v85
    ds_read_b64_tr_b16 v[36:37], v25 offset:20480
    ds_read_b64_tr_b16 v[38:39], v25 offset:22528
    s_waitcnt lgkmcnt(8)
    v_mfma_f32_32x32x16_bf16 v[120:135], v[44:47], v[184:187], v[120:135]
    s_lshl_b32 s13, s3, 12
    v_add_u32 v84, s13, v85
    ds_read_b64_tr_b16 v[40:41], v24 offset:21504
    ds_read_b64_tr_b16 v[42:43], v24 offset:23552
    v_mfma_f32_32x32x16_bf16 v[136:151], v[48:51], v[184:187], v[136:151]
    s_lshl_b32 s96, s76, 13
    s_add_u32 s13, s96, 32768
    v_add_u32 v85, s13, v85
    ds_read_b64_tr_b16 v[44:45], v25 offset:21504
    ds_read_b64_tr_b16 v[46:47], v25 offset:23552
    s_waitcnt lgkmcnt(8)
    v_mfma_f32_32x32x16_bf16 v[120:135], v[52:55], v[188:191], v[120:135]
    v_mov_b32 v80, 0x3f803f80
    ds_read_b64_tr_b16 v[48:49], v24 offset:24576
    ds_read_b64_tr_b16 v[50:51], v24 offset:26624
    v_mfma_f32_32x32x16_bf16 v[136:151], v[28:31], v[188:191], v[136:151]
    v_mov_b32 v81, 0x3f803f80
    ds_read_b64_tr_b16 v[52:53], v25 offset:24576
    ds_read_b64_tr_b16 v[54:55], v25 offset:26624
    s_waitcnt lgkmcnt(8)
    v_mfma_f32_32x32x16_bf16 v[120:135], v[32:35], v[192:195], v[120:135]
    v_mov_b32 v82, 0x3f803f80
    ds_read_b64_tr_b16 v[28:29], v24 offset:25600
    ds_read_b64_tr_b16 v[30:31], v24 offset:27648
    v_mfma_f32_32x32x16_bf16 v[136:151], v[36:39], v[192:195], v[136:151]
    v_mov_b32 v83, 0x3f803f80
    ds_read_b64_tr_b16 v[32:33], v25 offset:25600
    ds_read_b64_tr_b16 v[34:35], v25 offset:27648
    s_waitcnt lgkmcnt(8)
    v_mfma_f32_32x32x16_bf16 v[120:135], v[40:43], v[196:199], v[120:135]
    s_lshl3_add_u32 s96, s11, s3
    s_lshl_b32 s97, s96, 5
    s_add_u32 s98, s97, s10
    s_lshl_b32 s99, s98, 10
    s_add_u32 s13, s99, 25165824
    s_add_u32 s15, s13, 16384
    s_lshl3_add_u32 s96, s11, s3
    s_lshl_b32 s97, s96, 10
    s_add_u32 s16, s97, 21495808
    s_lshl_b32 s96, s10, 6
    s_add_u32 s14, s96, s16
    ds_read_b64_tr_b16 v[36:37], v24 offset:28672
    ds_read_b64_tr_b16 v[38:39], v24 offset:30720
    v_mfma_f32_32x32x16_bf16 v[136:151], v[44:47], v[196:199], v[136:151]
    ds_read_b64_tr_b16 v[40:41], v25 offset:28672
    ds_read_b64_tr_b16 v[42:43], v25 offset:30720
    s_waitcnt lgkmcnt(8)
    v_mfma_f32_32x32x16_bf16 v[120:135], v[48:51], v[200:203], v[120:135]
    ds_read_b64_tr_b16 v[44:45], v25 offset:29696
    ds_read_b64_tr_b16 v[46:47], v25 offset:31744
    v_mfma_f32_32x32x16_bf16 v[136:151], v[52:55], v[200:203], v[136:151]
    ds_read_b64_tr_b16 v[48:49], v24 offset:29696
    ds_read_b64_tr_b16 v[50:51], v24 offset:31744
    s_waitcnt lgkmcnt(8)
    v_mfma_f32_32x32x16_bf16 v[120:135], v[28:31], v[204:207], v[120:135]
    v_mfma_f32_32x32x16_bf16 v[136:151], v[32:35], v[204:207], v[136:151]
    s_waitcnt lgkmcnt(4)
    v_mfma_f32_32x32x16_bf16 v[120:135], v[36:39], v[208:211], v[120:135]
    v_mfma_f32_32x32x16_bf16 v[136:151], v[40:43], v[208:211], v[136:151]
    s_waitcnt lgkmcnt(0)
    v_mfma_f32_32x32x16_bf16 v[136:151], v[44:47], v[212:215], v[136:151]
    v_mfma_f32_32x32x16_bf16 v[120:135], v[48:51], v[212:215], v[120:135]
    s_lshl_b32 s96, s77, 11
    s_add_u32 s17, s96, 151552
    v_add_u32 v0, s17, v2
    v_bfe_u32 v4, v1, 2, 2
    v_lshlrev_b32 v4, 6, v4
    v_bfe_u32 v9, v1, 4, 1
    v_lshl_add_u32 v4, v9, 5, v4
    v_and_b32 v9, 3, v1
    v_lshl_add_u32 v4, v9, 3, v4
    v_lshrrev_b32 v9, 5, v1
    v_lshl_add_u32 v4, v9, 8, v4
    v_add_u32 v4, 159744, v4
    ds_read_b64_tr_b16 v[176:177], v4
    ds_read_b64_tr_b16 v[178:179], v4 offset:512
    ds_read_b64_tr_b16 v[180:181], v4 offset:1024
    ds_read_b64_tr_b16 v[182:183], v4 offset:1536
    v_cvt_pk_bf16_f32 v152, v136, v137
    v_cvt_pk_bf16_f32 v153, v138, v139
    v_cvt_pk_bf16_f32 v154, v140, v141
    v_cvt_pk_bf16_f32 v155, v142, v143
    v_cvt_pk_bf16_f32 v156, v144, v145
    v_cvt_pk_bf16_f32 v157, v146, v147
    v_cvt_pk_bf16_f32 v158, v148, v149
    v_cvt_pk_bf16_f32 v159, v150, v151
    ds_write_b128 v0, v[152:155]
    ds_write_b128 v0, v[156:159] offset:1024
    v_cvt_pk_bf16_f32 v168, v120, v121
    v_cvt_pk_bf16_f32 v169, v122, v123
    v_cvt_pk_bf16_f32 v170, v124, v125
    v_cvt_pk_bf16_f32 v171, v126, v127
    v_cvt_pk_bf16_f32 v172, v128, v129
    v_cvt_pk_bf16_f32 v173, v130, v131
    v_cvt_pk_bf16_f32 v174, v132, v133
    v_cvt_pk_bf16_f32 v175, v134, v135
    s_setprio 0
    s_branch L_JOIN
L_HELP:
    s_waitcnt vmcnt(0)
    s_barrier
    s_waitcnt lgkmcnt(0)
    s_load_dwordx2 s[24:25], s[32:33], s19 offset:0 glc
    s_load_dwordx2 s[26:27], s[32:33], s19 offset:64 glc
    s_add_u32 s96, s84, 4
    s_and_b32 s97, s96, 15
    s_mul_i32 s98, s97, 393216
    s_add_u32 s99, s98, s85
    s_add_u32 s82, s99, 4294772736
    s_add_u32 m0, s83, 28672
    s_nop 0
    buffer_load_dwordx4 v3, s[40:43], s82 offen lds
    s_add_u32 s96, s84, 4
    s_and_b32 s97, s96, 15
    s_mul_i32 s98, s97, 393216
    s_add_u32 s99, s98, s85
    s_add_u32 s82, s99, 2048
    s_add_u32 m0, s83, 32768
    s_nop 0
    buffer_load_dwordx4 v3, s[40:43], s82 offen lds
    s_add_u32 s96, s84, 4
    s_and_b32 s97, s96, 15
    s_mul_i32 s98, s97, 393216
    s_add_u32 s99, s98, s85
    s_add_u32 s82, s99, 4294774784
    s_add_u32 m0, s83, 77824
    s_nop 0
    buffer_load_dwordx4 v3, s[40:43], s82 offen lds
    s_add_u32 s96, s84, 4
    s_and_b32 s97, s96, 15
    s_mul_i32 s98, s97, 393216
    s_add_u32 s99, s98, s85
    s_add_u32 s82, s99, 4096
    s_add_u32 m0, s83, 81920
    s_nop 0
    buffer_load_dwordx4 v3, s[40:43], s82 offen lds
    s_add_u32 s96, s84, 4
    s_and_b32 s97, s96, 15
    s_mul_i32 s98, s97, 393216
    s_add_u32 s99, s98, s85
    s_add_u32 s82, s99, 4294770688
    s_add_u32 m0, s83, 126976
    s_nop 0
    buffer_load_dwordx4 v3, s[40:43], s82 offen lds
    s_add_u32 s96, s84, 4
    s_and_b32 s97, s96, 15
    s_mul_i32 s98, s97, 393216
    s_add_u32 s82, s98, s85
    s_add_u32 m0, s83, 131072
    s_nop 0
    buffer_load_dwordx4 v3, s[40:43], s82 offen lds
    s_add_u32 s96, s84, 5
    s_and_b32 s97, s96, 15
    s_mul_i32 s98, s97, 393216
    s_add_u32 s99, s98, s85
    s_add_u32 s82, s99, 4294772736
    s_add_u32 m0, s83, 36864
    s_nop 0
    buffer_load_dwordx4 v3, s[40:43], s82 offen lds
    s_add_u32 s96, s84, 5
    s_and_b32 s97, s96, 15
    s_mul_i32 s98, s97, 393216
    s_add_u32 s99, s98, s85
    s_add_u32 s82, s99, 2048
    s_add_u32 m0, s83, 40960
    s_nop 0
    buffer_load_dwordx4 v3, s[40:43], s82 offen lds
    s_add_u32 s96, s84, 5
    s_and_b32 s97, s96, 15
    s_mul_i32 s98, s97, 393216
    s_add_u32 s99, s98, s85
    s_add_u32 s82, s99, 4294774784
    s_add_u32 m0, s83, 86016
    s_nop 0
    buffer_load_dwordx4 v3, s[40:43], s82 offen lds
    s_add_u32 s96, s84, 5
    s_and_b32 s97, s96, 15
    s_mul_i32 s98, s97, 393216
    s_add_u32 s99, s98, s85
    s_add_u32 s82, s99, 4096
    s_add_u32 m0, s83, 90112
    s_nop 0
    buffer_load_dwordx4 v3, s[40:43], s82 offen lds
    s_add_u32 s96, s84, 5
    s_and_b32 s97, s96, 15
    s_mul_i32 s98, s97, 393216
    s_add_u32 s99, s98, s85
    s_add_u32 s82, s99, 4294770688
    s_add_u32 m0, s83, 135168
    s_nop 0
    buffer_load_dwordx4 v3, s[40:43], s82 offen lds
    s_add_u32 s96, s84, 5
    s_and_b32 s97, s96, 15
    s_mul_i32 s98, s97, 393216
    s_add_u32 s82, s98, s85
    s_add_u32 m0, s83, 139264
    s_nop 0
    buffer_load_dwordx4 v3, s[40:43], s82 offen lds
    s_branch SCHK_17
SPOLL_16:
    s_load_dwordx2 s[24:25], s[32:33], s19 offset:0 glc
    s_load_dwordx2 s[26:27], s[32:33], s19 offset:64 glc
SCHK_17:
    s_add_u32 s5, s5, 1
    s_cmp_ge_u32 s5, 200000
    s_waitcnt lgkmcnt(0)
    s_cbranch_scc1 SDONE_18
    s_cmp_lg_u32 s24, s4
    s_cbranch_scc1 SPOLL_16
    s_cmp_lg_u32 s25, s4
    s_cbranch_scc1 SPOLL_16
    s_cmp_lg_u32 s26, s4
    s_cbranch_scc1 SPOLL_16
    s_cmp_lg_u32 s27, s4
    s_cbranch_scc1 SPOLL_16
SDONE_18:
    s_barrier
    s_add_u32 s96, s84, 6
    s_and_b32 s97, s96, 15
    s_mul_i32 s98, s97, 393216
    s_add_u32 s99, s98, s85
    s_add_u32 s82, s99, 4294772736
    s_add_u32 m0, s83, 4294963200
    s_nop 0
    buffer_load_dwordx4 v3, s[40:43], s82 offen lds
    s_add_u32 s96, s84, 6
    s_and_b32 s97, s96, 15
    s_mul_i32 s98, s97, 393216
    s_add_u32 s99, s98, s85
    s_add_u32 s82, s99, 2048
    s_mov_b32 m0, s83
    s_nop 0
    buffer_load_dwordx4 v3, s[40:43], s82 offen lds
    s_add_u32 s96, s84, 6
    s_and_b32 s97, s96, 15
    s_mul_i32 s98, s97, 393216
    s_add_u32 s99, s98, s85
    s_add_u32 s82, s99, 4294770688
    s_add_u32 m0, s83, 94208
    s_nop 0
    buffer_load_dwordx4 v3, s[40:43], s82 offen lds
    s_add_u32 s96, s84, 6
    s_and_b32 s97, s96, 15
    s_mul_i32 s98, s97, 393216
    s_add_u32 s82, s98, s85
    s_add_u32 m0, s83, 98304
    s_nop 0
    buffer_load_dwordx4 v3, s[40:43], s82 offen lds
    s_add_u32 s96, s84, 6
    s_and_b32 s97, s96, 15
    s_mul_i32 s98, s97, 393216
    s_add_u32 s99, s98, s85
    s_add_u32 s82, s99, 4294774784
    s_add_u32 m0, s83, 45056
    s_nop 0
    buffer_load_dwordx4 v3, s[40:43], s82 offen lds
    s_add_u32 s96, s84, 6
    s_and_b32 s97, s96, 15
    s_mul_i32 s98, s97, 393216
    s_add_u32 s99, s98, s85
    s_add_u32 s82, s99, 4096
    s_add_u32 m0, s83, 49152
    s_nop 0
    buffer_load_dwordx4 v3, s[40:43], s82 offen lds
    v_bfe_u32 v4, v1, 2, 2
    v_lshlrev_b32 v4, 6, v4
    v_bfe_u32 v9, v1, 4, 1
    v_lshl_add_u32 v4, v9, 5, v4
    v_and_b32 v9, 3, v1
    v_lshl_add_u32 v4, v9, 3, v4
    v_lshrrev_b32 v9, 5, v1
    v_lshl_add_u32 v4, v9, 8, v4
    v_add_u32 v4, 159744, v4
    ds_read_b64_tr_b16 v[168:169], v4
    ds_read_b64_tr_b16 v[170:171], v4 offset:512
    ds_read_b64_tr_b16 v[172:173], v4 offset:1024
    ds_read_b64_tr_b16 v[174:175], v4 offset:1536
    ds_read_b64_tr_b16 v[176:177], v4 offset:2048
    ds_read_b64_tr_b16 v[178:179], v4 offset:2560
    ds_read_b64_tr_b16 v[180:181], v4 offset:3072
    ds_read_b64_tr_b16 v[182:183], v4 offset:3584
    s_lshl_b32 s14, s77, 10
    v_and_b32 v232, 7, v1
    v_lshl_add_u32 v232, v232, 4, s14
    v_bfe_u32 v9, v1, 3, 2
    v_lshl_add_u32 v232, v9, 8, v232
    v_lshrrev_b32 v9, 5, v1
    v_lshl_add_u32 v232, v9, 7, v232
    s_and_b32 s96, s9, 1
    s_lshl1_add_u32 s18, s96, 1
    s_and_b32 s96, s8, 3
    s_lshl2_add_u32 s97, s96, s3
    s_sub_u32 s98, s97, 4
    s_lshl_b32 s82, s98, 7
    v_lshrrev_b32 v8, 3, v1
    v_lshl_add_u32 v8, v8, 4, s82
    global_load_dwordx4 v[40:43], v8, s[86:87]
    v_lshrrev_b32 v248, 3, v1
    v_mul_u32_u24 v248, 98304, v248
    v_and_b32 v9, 7, v1
    v_lshl_add_u32 v248, v9, 4, v248
    s_and_b32 s96, s8, 3
    s_lshl2_add_u32 s97, s96, s3
    s_sub_u32 s98, s97, 4
    s_mul_i32 s99, s98, 786432
    s_lshr_b32 s96, s8, 2
    s_lshl1_add_u32 s97, s9, s96
    s_lshl_b32 s98, s97, 7
    s_add_u32 s96, s99, s98
    s_add_u32 s19, s96, 4096
    s_waitcnt lgkmcnt(0)
    s_load_dword s24, s[32:33], s92 offset:512 glc
    s_load_dword s25, s[32:33], s92 offset:256 glc
    s_load_dword s26, s[32:33], s92 offset:3584 glc
    s_load_dword s27, s[32:33], s92 offset:3328 glc
    s_barrier
    s_add_u32 s96, s84, 7
    s_and_b32 s97, s96, 15
    s_mul_i32 s98, s97, 393216
    s_add_u32 s99, s98, s85
    s_add_u32 s82, s99, 4294772736
    s_add_u32 m0, s83, 4096
    s_nop 0
    buffer_load_dwordx4 v3, s[40:43], s82 offen lds
    s_add_u32 s96, s84, 7
    s_and_b32 s97, s96, 15
    s_mul_i32 s98, s97, 393216
    s_add_u32 s99, s98, s85
    s_add_u32 s82, s99, 2048
    s_add_u32 m0, s83, 8192
    s_nop 0
    buffer_load_dwordx4 v3, s[40:43], s82 offen lds
    s_add_u32 s96, s84, 7
    s_and_b32 s97, s96, 15
    s_mul_i32 s98, s97, 393216
    s_add_u32 s99, s98, s85
    s_add_u32 s82, s99, 4294770688
    s_add_u32 m0, s83, 102400
    s_nop 0
    buffer_load_dwordx4 v3, s[40:43], s82 offen lds
    s_add_u32 s96, s84, 7
    s_and_b32 s97, s96, 15
    s_mul_i32 s98, s97, 393216
    s_add_u32 s82, s98, s85
    s_add_u32 m0, s83, 106496
    s_nop 0
    buffer_load_dwordx4 v3, s[40:43], s82 offen lds
    s_add_u32 s96, s84, 7
    s_and_b32 s97, s96, 15
    s_mul_i32 s98, s97, 393216
    s_add_u32 s99, s98, s85
    s_add_u32 s82, s99, 4294774784
    s_add_u32 m0, s83, 53248
    s_nop 0
    buffer_load_dwordx4 v3, s[40:43], s82 offen lds
    s_add_u32 s96, s84, 7
    s_and_b32 s97, s96, 15
    s_mul_i32 s98, s97, 393216
    s_add_u32 s99, s98, s85
    s_add_u32 s82, s99, 4096
    s_add_u32 m0, s83, 57344
    s_nop 0
    buffer_load_dwordx4 v3, s[40:43], s82 offen lds
    s_waitcnt vmcnt(23)
    s_waitcnt vmcnt(19)
    s_barrier
    s_add_u32 s96, s84, 8
    s_and_b32 s97, s96, 15
    s_mul_i32 s98, s97, 393216
    s_add_u32 s99, s98, s85
    s_add_u32 s82, s99, 4294772736
    s_add_u32 m0, s83, 12288
    s_nop 0
    buffer_load_dwordx4 v3, s[40:43], s82 offen lds
    s_add_u32 s96, s84, 8
    s_and_b32 s97, s96, 15
    s_mul_i32 s98, s97, 393216
    s_add_u32 s99, s98, s85
    s_add_u32 s82, s99, 2048
    s_add_u32 m0, s83, 16384
    s_nop 0
    buffer_load_dwordx4 v3, s[40:43], s82 offen lds
    s_add_u32 s96, s84, 8
    s_and_b32 s97, s96, 15
    s_mul_i32 s98, s97, 393216
    s_add_u32 s99, s98, s85
    s_add_u32 s82, s99, 4294770688
    s_add_u32 m0, s83, 110592
    s_nop 0
    buffer_load_dwordx4 v3, s[40:43], s82 offen lds
    s_add_u32 s96, s84, 8
    s_and_b32 s97, s96, 15
    s_mul_i32 s98, s97, 393216
    s_add_u32 s82, s98, s85
    s_add_u32 m0, s83, 114688
    s_nop 0
    buffer_load_dwordx4 v3, s[40:43], s82 offen lds
    s_add_u32 s96, s84, 8
    s_and_b32 s97, s96, 15
    s_mul_i32 s98, s97, 393216
    s_add_u32 s99, s98, s85
    s_add_u32 s82, s99, 4294774784
    s_add_u32 m0, s83, 61440
    s_nop 0
    buffer_load_dwordx4 v3, s[40:43], s82 offen lds
    s_add_u32 s96, s84, 8
    s_and_b32 s97, s96, 15
    s_mul_i32 s98, s97, 393216
    s_add_u32 s99, s98, s85
    s_add_u32 s82, s99, 4096
    s_add_u32 m0, s83, 65536
    s_nop 0
    buffer_load_dwordx4 v3, s[40:43], s82 offen lds
    s_waitcnt vmcnt(12)
    v_lshlrev_b32 v36, 16, v40
    v_and_b32 v37, s6, v40
    v_lshlrev_b32 v38, 16, v41
    v_and_b32 v39, s6, v41
    v_lshlrev_b32 v40, 16, v42
    v_and_b32 v41, s6, v42
    v_lshlrev_b32 v42, 16, v43
    v_and_b32 v43, s6, v43
    v_mul_f32 v8, s7, v36
    v_exp_f32 v8, -v8
    s_nop 0
    v_add_f32 v8, 1.0, v8
    v_rcp_f32 v8, v8
    s_nop 0
    v_mul_f32 v36, v36, v8
    v_cvt_pk_bf16_f32 v36, 0, v36
    v_mul_f32 v9, s7, v37
    v_exp_f32 v9, -v9
    s_nop 0
    v_add_f32 v9, 1.0, v9
    v_rcp_f32 v9, v9
    s_nop 0
    v_mul_f32 v37, v37, v9
    v_cvt_pk_bf16_f32 v37, 0, v37
    v_mul_f32 v8, s7, v38
    v_exp_f32 v8, -v8
    s_nop 0
    v_add_f32 v8, 1.0, v8
    v_rcp_f32 v8, v8
    s_nop 0
    v_mul_f32 v38, v38, v8
    v_cvt_pk_bf16_f32 v38, 0, v38
    v_mul_f32 v9, s7, v39
    v_exp_f32 v9, -v9
    s_nop 0
    v_add_f32 v9, 1.0, v9
    v_rcp_f32 v9, v9
    s_nop 0
    v_mul_f32 v39, v39, v9
    v_cvt_pk_bf16_f32 v39, 0, v39
    v_mul_f32 v8, s7, v40
    v_exp_f32 v8, -v8
    s_nop 0
    v_add_f32 v8, 1.0, v8
    v_rcp_f32 v8, v8
    s_nop 0
    v_mul_f32 v40, v40, v8
    v_cvt_pk_bf16_f32 v40, 0, v40
    v_mul_f32 v9, s7, v41
    v_exp_f32 v9, -v9
    s_nop 0
    v_add_f32 v9, 1.0, v9
    v_rcp_f32 v9, v9
    s_nop 0
    v_mul_f32 v41, v41, v9
    v_cvt_pk_bf16_f32 v41, 0, v41
    v_mul_f32 v8, s7, v42
    v_exp_f32 v8, -v8
    s_nop 0
    v_add_f32 v8, 1.0, v8
    v_rcp_f32 v8, v8
    s_nop 0
    v_mul_f32 v42, v42, v8
    v_cvt_pk_bf16_f32 v42, 0, v42
    v_mul_f32 v9, s7, v43
    v_exp_f32 v9, -v9
    s_nop 0
    v_add_f32 v9, 1.0, v9
    v_rcp_f32 v9, v9
    s_nop 0
    v_mul_f32 v43, v43, v9
    v_cvt_pk_bf16_f32 v43, 0, v43
    s_waitcnt lgkmcnt(0)
    s_load_dword s24, s[32:33], s92 offset:1024 glc
    s_load_dword s25, s[32:33], s92 offset:768 glc
    s_load_dword s26, s[32:33], s92 offset:1536 glc
    s_load_dword s27, s[32:33], s92 offset:1280 glc
    s_barrier
    s_add_u32 s96, s84, 9
    s_and_b32 s97, s96, 15
    s_mul_i32 s98, s97, 393216
    s_add_u32 s99, s98, s85
    s_add_u32 s82, s99, 4294772736
    s_add_u32 m0, s83, 20480
    s_nop 0
    buffer_load_dwordx4 v3, s[40:43], s82 offen lds
    s_add_u32 s96, s84, 9
    s_and_b32 s97, s96, 15
    s_mul_i32 s98, s97, 393216
    s_add_u32 s99, s98, s85
    s_add_u32 s82, s99, 2048
    s_add_u32 m0, s83, 24576
    s_nop 0
    buffer_load_dwordx4 v3, s[40:43], s82 offen lds
    s_add_u32 s96, s84, 9
    s_and_b32 s97, s96, 15
    s_mul_i32 s98, s97, 393216
    s_add_u32 s99, s98, s85
    s_add_u32 s82, s99, 4294770688
    s_add_u32 m0, s83, 118784
    s_nop 0
    buffer_load_dwordx4 v3, s[40:43], s82 offen lds
    s_add_u32 s96, s84, 9
    s_and_b32 s97, s96, 15
    s_mul_i32 s98, s97, 393216
    s_add_u32 s82, s98, s85
    s_add_u32 m0, s83, 122880
    s_nop 0
    buffer_load_dwordx4 v3, s[40:43], s82 offen lds
    s_add_u32 s96, s84, 9
    s_and_b32 s97, s96, 15
    s_mul_i32 s98, s97, 393216
    s_add_u32 s99, s98, s85
    s_add_u32 s82, s99, 4294774784
    s_add_u32 m0, s83, 69632
    s_nop 0
    buffer_load_dwordx4 v3, s[40:43], s82 offen lds
    s_add_u32 s96, s84, 9
    s_and_b32 s97, s96, 15
    s_mul_i32 s98, s97, 393216
    s_add_u32 s99, s98, s85
    s_add_u32 s82, s99, 4096
    s_add_u32 m0, s83, 73728
    s_nop 0
    buffer_load_dwordx4 v3, s[40:43], s82 offen lds
    s_barrier
    s_add_u32 s96, s84, 10
    s_and_b32 s97, s96, 15
    s_mul_i32 s98, s97, 393216
    s_add_u32 s99, s98, s85
    s_add_u32 s82, s99, 4294772736
    s_add_u32 m0, s83, 28672
    s_nop 0
    buffer_load_dwordx4 v3, s[40:43], s82 offen lds
    s_add_u32 s96, s84, 10
    s_and_b32 s97, s96, 15
    s_mul_i32 s98, s97, 393216
    s_add_u32 s99, s98, s85
    s_add_u32 s82, s99, 2048
    s_add_u32 m0, s83, 32768
    s_nop 0
    buffer_load_dwordx4 v3, s[40:43], s82 offen lds
    s_add_u32 s96, s84, 10
    s_and_b32 s97, s96, 15
    s_mul_i32 s98, s97, 393216
    s_add_u32 s99, s98, s85
    s_add_u32 s82, s99, 4294774784
    s_add_u32 m0, s83, 77824
    s_nop 0
    buffer_load_dwordx4 v3, s[40:43], s82 offen lds
    s_add_u32 s96, s84, 10
    s_and_b32 s97, s96, 15
    s_mul_i32 s98, s97, 393216
    s_add_u32 s99, s98, s85
    s_add_u32 s82, s99, 4096
    s_add_u32 m0, s83, 81920
    s_nop 0
    buffer_load_dwordx4 v3, s[40:43], s82 offen lds
    s_add_u32 s96, s84, 10
    s_and_b32 s97, s96, 15
    s_mul_i32 s98, s97, 393216
    s_add_u32 s99, s98, s85
    s_add_u32 s82, s99, 4294770688
    s_add_u32 m0, s83, 126976
    s_nop 0
    buffer_load_dwordx4 v3, s[40:43], s82 offen lds
    s_add_u32 s96, s84, 10
    s_and_b32 s97, s96, 15
    s_mul_i32 s98, s97, 393216
    s_add_u32 s82, s98, s85
    s_add_u32 m0, s83, 131072
    s_nop 0
    buffer_load_dwordx4 v3, s[40:43], s82 offen lds
    s_waitcnt lgkmcnt(0)
    s_load_dword s24, s[32:33], s92 offset:2560 glc
    s_load_dword s25, s[32:33], s92 offset:2304 glc
    s_load_dword s26, s[32:33], s92 offset:3072 glc
    s_load_dword s27, s[32:33], s92 offset:2816 glc
    s_waitcnt vmcnt(22)
    s_waitcnt vmcnt(20)
    s_waitcnt vmcnt(18)
    s_barrier
    s_add_u32 s96, s84, 11
    s_and_b32 s97, s96, 15
    s_mul_i32 s98, s97, 393216
    s_add_u32 s99, s98, s85
    s_add_u32 s82, s99, 4294772736
    s_add_u32 m0, s83, 36864
    s_nop 0
    buffer_load_dwordx4 v3, s[40:43], s82 offen lds
L_PAD5:
    s_cbranch_execz L_RET5
    s_add_u32 s96, s84, 11
    s_and_b32 s97, s96, 15
    s_mul_i32 s98, s97, 393216
    s_add_u32 s99, s98, s85
    s_add_u32 s82, s99, 2048
    s_add_u32 m0, s83, 40960
    s_nop 0
    buffer_load_dwordx4 v3, s[40:43], s82 offen lds
    s_add_u32 s96, s84, 11
    s_and_b32 s97, s96, 15
    s_mul_i32 s98, s97, 393216
    s_add_u32 s99, s98, s85
    s_add_u32 s82, s99, 4294774784
    s_add_u32 m0, s83, 86016
    s_nop 0
    buffer_load_dwordx4 v3, s[40:43], s82 offen lds
    s_add_u32 s96, s84, 11
    s_and_b32 s97, s96, 15
    s_mul_i32 s98, s97, 393216
    s_add_u32 s99, s98, s85
    s_add_u32 s82, s99, 4096
    s_add_u32 m0, s83, 90112
    s_nop 0
    buffer_load_dwordx4 v3, s[40:43], s82 offen lds
    s_add_u32 s96, s84, 11
    s_and_b32 s97, s96, 15
    s_mul_i32 s98, s97, 393216
    s_add_u32 s99, s98, s85
    s_add_u32 s82, s99, 4294770688
    s_add_u32 m0, s83, 135168
    s_nop 0
    buffer_load_dwordx4 v3, s[40:43], s82 offen lds
    s_add_u32 s96, s84, 11
    s_and_b32 s97, s96, 15
    s_mul_i32 s98, s97, 393216
    s_add_u32 s82, s98, s85
    s_add_u32 m0, s83, 139264
    s_nop 0
    buffer_load_dwordx4 v3, s[40:43], s82 offen lds
    s_waitcnt vmcnt(22)
    s_waitcnt vmcnt(20)
    s_waitcnt vmcnt(18)
    s_barrier
    s_add_u32 s96, s84, 12
    s_and_b32 s97, s96, 15
    s_mul_i32 s98, s97, 393216
    s_add_u32 s99, s98, s85
    s_add_u32 s82, s99, 4294772736
    s_add_u32 m0, s83, 4294963200
    s_nop 0
    buffer_load_dwordx4 v3, s[40:43], s82 offen lds
    s_add_u32 s96, s84, 12
    s_and_b32 s97, s96, 15
    s_mul_i32 s98, s97, 393216
    s_add_u32 s99, s98, s85
    s_add_u32 s82, s99, 2048
    s_mov_b32 m0, s83
    s_nop 0
    buffer_load_dwordx4 v3, s[40:43], s82 offen lds
    s_add_u32 s96, s84, 12
    s_and_b32 s97, s96, 15
    s_mul_i32 s98, s97, 393216
    s_add_u32 s99, s98, s85
    s_add_u32 s82, s99, 4294774784
    s_add_u32 m0, s83, 45056
    s_nop 0
    buffer_load_dwordx4 v3, s[40:43], s82 offen lds
    s_add_u32 s96, s84, 12
    s_and_b32 s97, s96, 15
    s_mul_i32 s98, s97, 393216
    s_add_u32 s99, s98, s85
    s_add_u32 s82, s99, 4096
    s_add_u32 m0, s83, 49152
    s_nop 0
    buffer_load_dwordx4 v3, s[40:43], s82 offen lds
    s_waitcnt vmcnt(20)
    s_barrier
    s_add_u32 s96, s84, 13
    s_and_b32 s97, s96, 15
    s_mul_i32 s98, s97, 393216
    s_add_u32 s99, s98, s85
    s_add_u32 s82, s99, 4294772736
    s_add_u32 m0, s83, 4096
    s_nop 0
    buffer_load_dwordx4 v3, s[40:43], s82 offen lds
    s_add_u32 s96, s84, 13
    s_and_b32 s97, s96, 15
    s_mul_i32 s98, s97, 393216
    s_add_u32 s99, s98, s85
    s_add_u32 s82, s99, 2048
    s_add_u32 m0, s83, 8192
    s_nop 0
    buffer_load_dwordx4 v3, s[40:43], s82 offen lds
    s_add_u32 s96, s84, 13
    s_and_b32 s97, s96, 15
    s_mul_i32 s98, s97, 393216
    s_add_u32 s99, s98, s85
    s_add_u32 s82, s99, 4294774784
    s_add_u32 m0, s83, 53248
    s_nop 0
    buffer_load_dwordx4 v3, s[40:43], s82 offen lds
    s_add_u32 s96, s84, 13
    s_and_b32 s97, s96, 15
    s_mul_i32 s98, s97, 393216
    s_add_u32 s99, s98, s85
    s_add_u32 s82, s99, 4096
    s_add_u32 m0, s83, 57344
    s_nop 0
    buffer_load_dwordx4 v3, s[40:43], s82 offen lds
    s_add_u32 s96, s84, 12
    s_and_b32 s97, s96, 15
    s_mul_i32 s98, s97, 393216
    s_add_u32 s99, s98, s85
    s_add_u32 s82, s99, 4294770688
    s_add_u32 m0, s83, 94208
    s_nop 0
    buffer_load_dwordx4 v3, s[40:43], s82 offen lds
    s_add_u32 s96, s84, 12
    s_and_b32 s97, s96, 15
    s_mul_i32 s98, s97, 393216
    s_add_u32 s82, s98, s85
    s_add_u32 m0, s83, 98304
    s_nop 0
    buffer_load_dwordx4 v3, s[40:43], s82 offen lds
    s_lshl_b32 s96, s74, 13
    s_sub_u32 s97, s3, 4
    s_lshl_b32 s98, s97, 8
    s_add_u32 s99, s96, s98
    s_add_u32 s13, s99, 20971520
    s_waitcnt lgkmcnt(0)
    s_load_dword s24, s[32:33], s13 offset:1276 glc
    s_load_dword s25, s[32:33], s13 offset:3324 glc
    s_load_dword s26, s[32:33], s13 offset:5372 glc
    s_load_dword s27, s[32:33], s13 offset:7420 glc
    s_waitcnt vmcnt(24)
    s_waitcnt vmcnt(22)
    s_barrier
    s_add_u32 s96, s84, 14
    s_and_b32 s97, s96, 15
    s_mul_i32 s98, s97, 393216
    s_add_u32 s99, s98, s85
    s_add_u32 s82, s99, 4294772736
    s_add_u32 m0, s83, 12288
    s_nop 0
    buffer_load_dwordx4 v3, s[40:43], s82 offen lds
    s_add_u32 s96, s84, 14
    s_and_b32 s97, s96, 15
    s_mul_i32 s98, s97, 393216
    s_add_u32 s99, s98, s85
    s_add_u32 s82, s99, 2048
    s_add_u32 m0, s83, 16384
    s_nop 0
    buffer_load_dwordx4 v3, s[40:43], s82 offen lds
    s_add_u32 s96, s84, 14
    s_and_b32 s97, s96, 15
    s_mul_i32 s98, s97, 393216
    s_add_u32 s99, s98, s85
    s_add_u32 s82, s99, 4294774784
    s_add_u32 m0, s83, 61440
    s_nop 0
    buffer_load_dwordx4 v3, s[40:43], s82 offen lds
    s_add_u32 s96, s84, 14
    s_and_b32 s97, s96, 15
    s_mul_i32 s98, s97, 393216
    s_add_u32 s99, s98, s85
    s_add_u32 s82, s99, 4096
    s_add_u32 m0, s83, 65536
    s_nop 0
    buffer_load_dwordx4 v3, s[40:43], s82 offen lds
    s_waitcnt vmcnt(24)
    s_waitcnt vmcnt(18)
    s_barrier
    s_add_u32 s96, s84, 15
    s_and_b32 s97, s96, 15
    s_mul_i32 s98, s97, 393216
    s_add_u32 s99, s98, s85
    s_add_u32 s82, s99, 4294772736
    s_add_u32 m0, s83, 20480
    s_nop 0
    buffer_load_dwordx4 v3, s[40:43], s82 offen lds
    s_add_u32 s96, s84, 15
    s_and_b32 s97, s96, 15
    s_mul_i32 s98, s97, 393216
    s_add_u32 s99, s98, s85
    s_add_u32 s82, s99, 2048
    s_add_u32 m0, s83, 24576
    s_nop 0
    buffer_load_dwordx4 v3, s[40:43], s82 offen lds
    s_waitcnt vmcnt(14)
    s_waitcnt vmcnt(10)
    s_waitcnt vmcnt(4)
    s_barrier
    s_add_u32 s96, s84, 15
    s_and_b32 s97, s96, 15
    s_mul_i32 s98, s97, 393216
    s_add_u32 s99, s98, s85
    s_add_u32 s82, s99, 4294774784
    s_add_u32 m0, s83, 69632
    s_nop 0
    buffer_load_dwordx4 v3, s[40:43], s82 offen lds
    s_add_u32 s96, s84, 15
    s_and_b32 s97, s96, 15
    s_mul_i32 s98, s97, 393216
    s_add_u32 s99, s98, s85
    s_add_u32 s82, s99, 4096
    s_add_u32 m0, s83, 73728
    s_nop 0
    buffer_load_dwordx4 v3, s[40:43], s82 offen lds
    s_add_u32 s96, s84, 13
    s_and_b32 s97, s96, 15
    s_mul_i32 s98, s97, 393216
    s_add_u32 s99, s98, s85
    s_add_u32 s82, s99, 4294770688
    s_add_u32 m0, s83, 102400
    s_nop 0
    buffer_load_dwordx4 v3, s[40:43], s82 offen lds
    s_add_u32 s96, s84, 13
    s_and_b32 s97, s96, 15
    s_mul_i32 s98, s97, 393216
    s_add_u32 s82, s98, s85
    s_add_u32 m0, s83, 106496
    s_nop 0
    buffer_load_dwordx4 v3, s[40:43], s82 offen lds
    s_mov_b32 s82, s19
    buffer_load_dwordx4 v[88:91], v248, s[48:51], s82 offen nt
    s_add_u32 s82, s19, 12288
    buffer_load_dwordx4 v[92:95], v248, s[48:51], s82 offen nt
    s_add_u32 s82, s19, 24576
    buffer_load_dwordx4 v[96:99], v248, s[48:51], s82 offen nt
    s_add_u32 s82, s19, 36864
    buffer_load_dwordx4 v[100:103], v248, s[48:51], s82 offen nt
    s_waitcnt vmcnt(8)
    s_barrier
    s_add_u32 s96, s84, 14
    s_and_b32 s97, s96, 15
    s_mul_i32 s98, s97, 393216
    s_add_u32 s99, s98, s85
    s_add_u32 s82, s99, 4294770688
    s_add_u32 m0, s83, 110592
    s_nop 0
    buffer_load_dwordx4 v3, s[40:43], s82 offen lds
    s_add_u32 s96, s84, 14
    s_and_b32 s97, s96, 15
    s_mul_i32 s98, s97, 393216
    s_add_u32 s82, s98, s85
    s_add_u32 m0, s83, 114688
    s_nop 0
    buffer_load_dwordx4 v3, s[40:43], s82 offen lds
    s_add_u32 s96, s84, 15
    s_and_b32 s97, s96, 15
    s_mul_i32 s98, s97, 393216
    s_add_u32 s99, s98, s85
    s_add_u32 s82, s99, 4294770688
    s_add_u32 m0, s83, 118784
    s_nop 0
    buffer_load_dwordx4 v3, s[40:43], s82 offen lds
    s_add_u32 s96, s84, 15
    s_and_b32 s97, s96, 15
    s_mul_i32 s98, s97, 393216
    s_add_u32 s82, s98, s85
    s_add_u32 m0, s83, 122880
    s_nop 0
    buffer_load_dwordx4 v3, s[40:43], s82 offen lds
    v_and_b32 v85, 1, v1
    v_lshlrev_b32 v85, 3, v85
    v_bfe_u32 v84, v1, 2, 2
    v_lshl_add_u32 v85, v84, 4, v85
    v_bfe_u32 v84, v1, 4, 1
    v_lshl_add_u32 v85, v84, 6, v85
    v_bfe_u32 v84, v1, 1, 1
    v_lshl_add_u32 v85, v84, 7, v85
    v_lshrrev_b32 v84, 5, v1
    v_lshl_add_u32 v85, v84, 8, v85
    s_lshl_b32 s13, s3, 12
    v_add_u32 v84, s13, v85
    s_lshl_b32 s96, s76, 13
    s_add_u32 s13, s96, 32768
    v_add_u32 v85, s13, v85
    v_mov_b32 v80, 0x3f803f80
    v_mov_b32 v81, 0x3f803f80
    v_mov_b32 v82, 0x3f803f80
    v_mov_b32 v83, 0x3f803f80
    s_lshl3_add_u32 s96, s11, s3
    s_lshl_b32 s97, s96, 5
    s_add_u32 s98, s97, s10
    s_lshl_b32 s99, s98, 10
    s_add_u32 s13, s99, 25165824
    s_add_u32 s15, s13, 16384
    s_lshl3_add_u32 s96, s11, s3
    s_lshl_b32 s97, s96, 10
    s_add_u32 s16, s97, 21495808
    s_lshl_b32 s96, s10, 6
    s_add_u32 s14, s96, s16
    s_waitcnt lgkmcnt(0)
    s_barrier
    s_setprio 3
    ds_read_b128 v[152:155], v0
    ds_read_b128 v[156:159], v0 offset:1024
    v_subrev_u32 v0, 118784, v0
    s_waitcnt lgkmcnt(1)
    v_mfma_f32_32x32x16_bf16 v[184:199], v[168:171], v[152:155], 0
    s_waitcnt lgkmcnt(0)
    v_mfma_f32_32x32x16_bf16 v[184:199], v[172:175], v[156:159], v[184:199]
    s_setprio 0
    s_nop 10
    v_cvt_pk_bf16_f32 v184, 0, v184
    v_cvt_pk_bf16_f32 v185, 0, v185
    v_cvt_pk_bf16_f32 v186, 0, v186
    s_add_u32 s82, s19, 49152
    buffer_load_dwordx4 v[104:107], v248, s[48:51], s82 offen nt
    v_cvt_pk_bf16_f32 v187, 0, v187
    v_cvt_pk_bf16_f32 v188, 0, v188
    v_cvt_pk_bf16_f32 v189, 0, v189
    v_cvt_pk_bf16_f32 v190, 0, v190
    v_cvt_pk_bf16_f32 v191, 0, v191
    v_cvt_pk_bf16_f32 v192, 0, v192
    v_cvt_pk_bf16_f32 v193, 0, v193
    v_cvt_pk_bf16_f32 v194, 0, v194
    v_cvt_pk_bf16_f32 v195, 0, v195
    v_cvt_pk_bf16_f32 v196, 0, v196
    s_add_u32 s82, s19, 61440
    buffer_load_dwordx4 v[108:111], v248, s[48:51], s82 offen nt
    v_cvt_pk_bf16_f32 v197, 0, v197
    v_cvt_pk_bf16_f32 v198, 0, v198
    v_cvt_pk_bf16_f32 v199, 0, v199
    v_max3_f32 v4, v184, v185, v186
    v_min3_f32 v5, v184, v185, v186
    v_max3_f32 v4, v4, v187, v188
    v_min3_f32 v5, v5, v187, v188
    v_max3_f32 v4, v4, v189, v190
    v_min3_f32 v5, v5, v189, v190
    v_max3_f32 v4, v4, v191, v192
    s_add_u32 s82, s19, 73728
    buffer_load_dwordx4 v[112:115], v248, s[48:51], s82 offen nt
    v_min3_f32 v5, v5, v191, v192
    v_max3_f32 v4, v4, v193, v194
    v_min3_f32 v5, v5, v193, v194
    v_max3_f32 v4, v4, v195, v196
    v_min3_f32 v5, v5, v195, v196
    v_max3_f32 v4, v4, v197, v198
    v_min3_f32 v5, v5, v197, v198
    v_max_f32 v6, v4, v199
    v_min_f32 v7, v5, v199
    v_max_f32 v4, v4, v199
    s_add_u32 s82, s19, 86016
    buffer_load_dwordx4 v[116:119], v248, s[48:51], s82 offen nt
    v_min_f32 v5, v5, v199
    v_permlane32_swap_b32 v4, v6
    s_nop 0
    v_permlane32_swap_b32 v5, v7
    v_max_f32 v4, v4, v6
    v_min_f32 v5, v5, v7
    v_mul_f32_e64 v4, v4, s7
    v_mul_f32_e64 v5, v5, s7
    v_fma_f32 v216, v184, s7, -v4
    v_fma_f32 v217, v185, s7, -v4
    v_fma_f32 v184, -v184, s7, v5
    v_fma_f32 v185, -v185, s7, v5
    v_fma_f32 v218, v186, s7, -v4
    v_fma_f32 v219, v187, s7, -v4
    v_fma_f32 v186, -v186, s7, v5
    v_fma_f32 v187, -v187, s7, v5
    s_waitcnt vmcnt(14)
    s_barrier
    s_setprio 3
    ds_read_b128 v[152:155], v0
    ds_read_b128 v[156:159], v0 offset:1024
    s_waitcnt lgkmcnt(1)
    v_mfma_f32_32x32x16_bf16 v[200:215], v[176:179], v[152:155], 0
    s_waitcnt lgkmcnt(0)
    v_mfma_f32_32x32x16_bf16 v[200:215], v[180:183], v[156:159], v[200:215]
    s_setprio 0
    v_fma_f32 v220, v188, s7, -v4
    v_fma_f32 v221, v189, s7, -v4
    v_fma_f32 v188, -v188, s7, v5
    v_fma_f32 v189, -v189, s7, v5
    v_fma_f32 v222, v190, s7, -v4
    s_mov_b32 s82, s80
    buffer_load_dwordx4 v[56:59], v27, s[52:55], s82 offen nt
    v_fma_f32 v223, v191, s7, -v4
    v_fma_f32 v190, -v190, s7, v5
    v_fma_f32 v191, -v191, s7, v5
    v_fma_f32 v224, v192, s7, -v4
    v_fma_f32 v225, v193, s7, -v4
    s_setprio 3
    v_fma_f32 v192, -v192, s7, v5
    v_fma_f32 v193, -v193, s7, v5
    v_fma_f32 v226, v194, s7, -v4
    v_fma_f32 v227, v195, s7, -v4
    v_fma_f32 v194, -v194, s7, v5
    v_fma_f32 v195, -v195, s7, v5
    v_fma_f32 v228, v196, s7, -v4
    v_fma_f32 v229, v197, s7, -v4
    v_fma_f32 v196, -v196, s7, v5
    v_fma_f32 v197, -v197, s7, v5
    v_fma_f32 v230, v198, s7, -v4
    v_fma_f32 v231, v199, s7, -v4
    v_fma_f32 v198, -v198, s7, v5
    v_fma_f32 v199, -v199, s7, v5
    v_exp_f32 v216, v216
    s_add_u32 s82, s80, 4294049792
    buffer_load_dwordx4 v[60:63], v27, s[52:55], s82 offen nt
    v_exp_f32 v184, v184
    v_exp_f32 v217, v217
    v_exp_f32 v185, v185
    v_exp_f32 v218, v218
    v_exp_f32 v186, v186
    v_exp_f32 v219, v219
    v_exp_f32 v187, v187
    v_exp_f32 v220, v220
    v_exp_f32 v188, v188
    v_exp_f32 v221, v221
    v_exp_f32 v189, v189
    v_exp_f32 v222, v222
    v_exp_f32 v190, v190
    v_exp_f32 v223, v223
    v_exp_f32 v191, v191
    v_exp_f32 v224, v224
    v_exp_f32 v192, v192
    v_exp_f32 v225, v225
    v_exp_f32 v193, v193
    v_exp_f32 v226, v226
    s_add_u32 s82, s80, 57344
    buffer_load_dwordx4 v[64:67], v27, s[52:55], s82 offen nt
    v_exp_f32 v194, v194
    v_exp_f32 v227, v227
    v_exp_f32 v195, v195
    v_exp_f32 v228, v228
    v_exp_f32 v196, v196
    v_exp_f32 v229, v229
    v_exp_f32 v197, v197
    v_exp_f32 v230, v230
    v_exp_f32 v198, v198
    v_exp_f32 v231, v231
    v_exp_f32 v199, v199
    v_add_f32 v8, v216, v218
    v_add_f32 v9, v217, v219
    v_add_f32 v10, v184, v186
    v_add_f32 v11, v185, v187
    v_add_f32 v8, v8, v220
    v_add_f32 v9, v9, v221
    v_add_f32 v10, v10, v188
    v_add_f32 v11, v11, v189
    v_add_f32 v8, v8, v222
    s_add_u32 s82, s80, 4294107136
    buffer_load_dwordx4 v[68:71], v27, s[52:55], s82 offen nt
    v_add_f32 v9, v9, v223
    v_add_f32 v10, v10, v190
    v_add_f32 v11, v11, v191
    v_add_f32 v8, v8, v224
    v_add_f32 v9, v9, v225
    v_add_f32 v10, v10, v192
    v_add_f32 v11, v11, v193
    v_add_f32 v8, v8, v226
    v_add_f32 v9, v9, v227
    v_add_f32 v10, v10, v194
    v_add_f32 v11, v11, v195
    v_add_f32 v8, v8, v228
    v_add_f32 v9, v9, v229
    v_add_f32 v10, v10, v196
    v_add_f32 v11, v11, v197
    v_add_f32 v8, v8, v230
    v_add_f32 v9, v9, v231
    v_add_f32 v10, v10, v198
    v_add_f32 v11, v11, v199
    v_add_f32 v6, v8, v9
    v_add_f32 v7, v10, v11
    v_add_f32 v4, v8, v9
    s_setprio 0
    v_add_f32 v5, v10, v11
    v_permlane32_swap_b32 v4, v6
    s_nop 0
    v_permlane32_swap_b32 v5, v7
    v_add_f32 v4, v4, v6
    v_add_f32 v5, v5, v7
    v_rcp_f32 v4, v4
    v_rcp_f32 v5, v5
    v_mul_f32 v216, v216, v4
    v_mul_f32 v217, v217, v4
    v_mul_f32 v184, v184, v5
    v_mul_f32 v185, v185, v5
    v_mul_f32 v218, v218, v4
    v_mul_f32 v219, v219, v4
    v_mul_f32 v186, v186, v5
    v_mul_f32 v187, v187, v5
    v_mul_f32 v220, v220, v4
    v_mul_f32 v221, v221, v4
    v_mul_f32 v188, v188, v5
    v_mul_f32 v189, v189, v5
    v_mul_f32 v222, v222, v4
    v_mul_f32 v223, v223, v4
    v_mul_f32 v190, v190, v5
    v_mul_f32 v191, v191, v5
    v_mul_f32 v224, v224, v4
    v_mul_f32 v225, v225, v4
    v_mul_f32 v192, v192, v5
    v_mul_f32 v193, v193, v5
    v_mul_f32 v226, v226, v4
    v_mul_f32 v227, v227, v4
    v_mul_f32 v194, v194, v5
    v_mul_f32 v195, v195, v5
    v_mul_f32 v228, v228, v4
    v_mul_f32 v229, v229, v4
    v_mul_f32 v196, v196, v5
    v_mul_f32 v197, v197, v5
    v_mul_f32 v230, v230, v4
    v_mul_f32 v231, v231, v4
    v_mul_f32 v198, v198, v5
    v_mul_f32 v199, v199, v5
    v_cvt_pk_bf16_f32 v216, v216, v217
    v_cvt_pk_bf16_f32 v217, v218, v219
    v_cvt_pk_bf16_f32 v218, v220, v221
    v_cvt_pk_bf16_f32 v219, v222, v223
    v_cvt_pk_bf16_f32 v220, v224, v225
    v_cvt_pk_bf16_f32 v221, v226, v227
    v_cvt_pk_bf16_f32 v222, v228, v229
    v_cvt_pk_bf16_f32 v223, v230, v231
    ds_write_b128 v232, v[216:219]
    v_cvt_pk_bf16_f32 v224, v184, v185
    v_cvt_pk_bf16_f32 v225, v186, v187
    v_cvt_pk_bf16_f32 v226, v188, v189
    v_cvt_pk_bf16_f32 v227, v190, v191
    ds_write_b128 v232, v[220:223] offset:4096
    s_waitcnt vmcnt(16)
    s_waitcnt vmcnt(10)
    s_waitcnt vmcnt(8)
    s_barrier
    ds_write_b128 v232, v[224:227] offset:8192
    v_cvt_pk_bf16_f32 v228, v192, v193
    v_cvt_pk_bf16_f32 v229, v194, v195
    v_cvt_pk_bf16_f32 v230, v196, v197
    v_cvt_pk_bf16_f32 v231, v198, v199
    s_xor_b32 s96, s95, 786432
    s_add_u32 s97, s96, s90
    s_sub_u32 s82, s97, 65536
    s_add_u32 m0, s83, 45056
    s_nop 0
    buffer_load_dwordx4 v26, s[44:47], s82 offen lds
    ds_write_b128 v232, v[228:231] offset:12288
    v_cvt_pk_bf16_f32 v200, 0, v200
    v_cvt_pk_bf16_f32 v201, 0, v201
    v_cvt_pk_bf16_f32 v202, 0, v202
    v_cvt_pk_bf16_f32 v203, 0, v203
    v_cvt_pk_bf16_f32 v204, 0, v204
    v_cvt_pk_bf16_f32 v205, 0, v205
    v_cvt_pk_bf16_f32 v206, 0, v206
    v_cvt_pk_bf16_f32 v207, 0, v207
    v_cvt_pk_bf16_f32 v208, 0, v208
    v_cvt_pk_bf16_f32 v209, 0, v209
    v_cvt_pk_bf16_f32 v210, 0, v210
    v_cvt_pk_bf16_f32 v211, 0, v211
    s_xor_b32 s96, s95, 786432
    s_add_u32 s82, s96, s90
    s_add_u32 m0, s83, 49152
    s_nop 0
    buffer_load_dwordx4 v26, s[44:47], s82 offen lds
    v_cvt_pk_bf16_f32 v212, 0, v212
    v_cvt_pk_bf16_f32 v213, 0, v213
    v_cvt_pk_bf16_f32 v214, 0, v214
    v_cvt_pk_bf16_f32 v215, 0, v215
    v_max3_f32 v4, v200, v201, v202
    v_min3_f32 v5, v200, v201, v202
    v_max3_f32 v4, v4, v203, v204
    v_min3_f32 v5, v5, v203, v204
    v_max3_f32 v4, v4, v205, v206
    v_min3_f32 v5, v5, v205, v206
    v_max3_f32 v4, v4, v207, v208
    v_min3_f32 v5, v5, v207, v208
    v_max3_f32 v4, v4, v209, v210
    v_min3_f32 v5, v5, v209, v210
    s_xor_b32 s96, s95, 917504
    s_add_u32 s97, s96, s90
    s_sub_u32 s82, s97, 65536
    s_add_u32 m0, s83, 53248
    s_nop 0
    buffer_load_dwordx4 v26, s[44:47], s82 offen lds
    v_max3_f32 v4, v4, v211, v212
    v_min3_f32 v5, v5, v211, v212
    v_max3_f32 v4, v4, v213, v214
    v_min3_f32 v5, v5, v213, v214
    v_max_f32 v6, v4, v215
    v_min_f32 v7, v5, v215
    v_max_f32 v4, v4, v215
    s_waitcnt lgkmcnt(0)
    v_min_f32 v5, v5, v215
    v_permlane32_swap_b32 v4, v6
    s_nop 0
    v_permlane32_swap_b32 v5, v7
    v_max_f32 v4, v4, v6
    v_min_f32 v5, v5, v7
    v_mul_f32_e64 v4, v4, s7
    s_xor_b32 s96, s95, 917504
    s_add_u32 s82, s96, s90
    s_add_u32 m0, s83, 57344
    s_nop 0
    buffer_load_dwordx4 v26, s[44:47], s82 offen lds
    v_mul_f32_e64 v5, v5, s7
    v_fma_f32 v216, v200, s7, -v4
    v_fma_f32 v217, v201, s7, -v4
    v_fma_f32 v200, -v200, s7, v5
    v_fma_f32 v201, -v201, s7, v5
    v_fma_f32 v218, v202, s7, -v4
    v_fma_f32 v219, v203, s7, -v4
    v_fma_f32 v202, -v202, s7, v5
    v_fma_f32 v203, -v203, s7, v5
    v_fma_f32 v220, v204, s7, -v4
    v_fma_f32 v221, v205, s7, -v4
    v_fma_f32 v204, -v204, s7, v5
    v_fma_f32 v205, -v205, s7, v5
    v_fma_f32 v222, v206, s7, -v4
    s_xor_b32 s96, s95, 1048576
    s_add_u32 s97, s96, s90
    s_sub_u32 s82, s97, 65536
    s_add_u32 m0, s83, 61440
    s_nop 0
    buffer_load_dwordx4 v26, s[44:47], s82 offen lds
    v_fma_f32 v223, v207, s7, -v4
    v_fma_f32 v206, -v206, s7, v5
    v_fma_f32 v207, -v207, s7, v5
    v_fma_f32 v224, v208, s7, -v4
    v_fma_f32 v225, v209, s7, -v4
    v_fma_f32 v208, -v208, s7, v5
    v_fma_f32 v209, -v209, s7, v5
    v_fma_f32 v226, v210, s7, -v4
    v_fma_f32 v227, v211, s7, -v4
    v_fma_f32 v210, -v210, s7, v5
    v_fma_f32 v211, -v211, s7, v5
    v_fma_f32 v228, v212, s7, -v4
    v_fma_f32 v229, v213, s7, -v4
    v_fma_f32 v212, -v212, s7, v5
    s_xor_b32 s96, s95, 1048576
    s_add_u32 s82, s96, s90
    s_add_u32 m0, s83, 65536
    s_nop 0
    buffer_load_dwordx4 v26, s[44:47], s82 offen lds
    v_fma_f32 v213, -v213, s7, v5
    v_fma_f32 v230, v214, s7, -v4
    v_fma_f32 v231, v215, s7, -v4
    v_fma_f32 v214, -v214, s7, v5
    v_fma_f32 v215, -v215, s7, v5
    v_exp_f32 v216, v216
    v_exp_f32 v200, v200
    v_exp_f32 v217, v217
    v_exp_f32 v201, v201
    v_exp_f32 v218, v218
    v_exp_f32 v202, v202
    v_exp_f32 v219, v219
    v_exp_f32 v203, v203
    v_exp_f32 v220, v220
    s_xor_b32 s96, s95, 1179648
    s_add_u32 s97, s96, s90
    s_sub_u32 s82, s97, 65536
    s_add_u32 m0, s83, 69632
    s_nop 0
    buffer_load_dwordx4 v26, s[44:47], s82 offen lds
    v_exp_f32 v204, v204
    v_exp_f32 v221, v221
    v_exp_f32 v205, v205
    v_exp_f32 v222, v222
    v_exp_f32 v206, v206
    v_exp_f32 v223, v223
    v_exp_f32 v207, v207
    v_exp_f32 v224, v224
    v_exp_f32 v208, v208
    v_exp_f32 v225, v225
    v_exp_f32 v209, v209
    v_exp_f32 v226, v226
    v_exp_f32 v210, v210
    v_exp_f32 v227, v227
    s_xor_b32 s96, s95, 1179648
    s_add_u32 s82, s96, s90
    s_add_u32 m0, s83, 73728
    s_nop 0
    buffer_load_dwordx4 v26, s[44:47], s82 offen lds
    v_exp_f32 v211, v211
    v_exp_f32 v228, v228
    v_exp_f32 v212, v212
    v_exp_f32 v229, v229
    v_exp_f32 v213, v213
    v_exp_f32 v230, v230
    v_exp_f32 v214, v214
    v_exp_f32 v231, v231
    v_exp_f32 v215, v215
    v_add_f32 v8, v216, v218
    v_add_f32 v9, v217, v219
    v_add_f32 v10, v200, v202
L_PAD6:
    s_cbranch_execz L_RET6
    v_add_f32 v11, v201, v203
    v_add_f32 v8, v8, v220
    v_add_f32 v9, v9, v221
    v_add_f32 v10, v10, v204
    v_add_f32 v11, v11, v205
    v_add_f32 v8, v8, v222
    v_add_f32 v9, v9, v223
    v_add_f32 v10, v10, v206
    v_add_f32 v11, v11, v207
    v_add_f32 v8, v8, v224
    v_add_f32 v9, v9, v225
    v_add_f32 v10, v10, v208
    v_add_f32 v11, v11, v209
    v_add_f32 v8, v8, v226
    v_add_f32 v9, v9, v227
    v_add_f32 v10, v10, v210
    v_add_f32 v11, v11, v211
    v_add_f32 v8, v8, v228
    v_add_f32 v9, v9, v229
    v_add_f32 v10, v10, v212
    v_add_f32 v11, v11, v213
    v_add_f32 v8, v8, v230
    v_add_f32 v9, v9, v231
    v_add_f32 v10, v10, v214
    v_add_f32 v11, v11, v215
    v_add_f32 v6, v8, v9
    v_add_f32 v7, v10, v11
    v_add_f32 v4, v8, v9
    v_add_f32 v5, v10, v11
    s_nop 0
    v_permlane32_swap_b32 v4, v6
    v_permlane32_swap_b32 v5, v7
    v_add_f32 v4, v4, v6
    v_add_f32 v5, v5, v7
    v_rcp_f32 v4, v4
    v_rcp_f32 v5, v5
    v_mul_f32 v216, v216, v4
    v_mul_f32 v217, v217, v4
    v_mul_f32 v200, v200, v5
    v_mul_f32 v201, v201, v5
    v_mul_f32 v218, v218, v4
    v_mul_f32 v219, v219, v4
    v_mul_f32 v202, v202, v5
    v_mul_f32 v203, v203, v5
    v_mul_f32 v220, v220, v4
    v_mul_f32 v221, v221, v4
    v_mul_f32 v204, v204, v5
    v_mul_f32 v205, v205, v5
    v_mul_f32 v222, v222, v4
    v_mul_f32 v223, v223, v4
    v_mul_f32 v206, v206, v5
    v_mul_f32 v207, v207, v5
    v_mul_f32 v224, v224, v4
    v_mul_f32 v225, v225, v4
    v_mul_f32 v208, v208, v5
    v_mul_f32 v209, v209, v5
    v_mul_f32 v226, v226, v4
    v_mul_f32 v227, v227, v4
    v_mul_f32 v210, v210, v5
    v_mul_f32 v211, v211, v5
    v_mul_f32 v228, v228, v4
    v_mul_f32 v229, v229, v4
    v_mul_f32 v212, v212, v5
    v_mul_f32 v213, v213, v5
    v_mul_f32 v230, v230, v4
    v_mul_f32 v231, v231, v4
    v_mul_f32 v214, v214, v5
    v_mul_f32 v215, v215, v5
    v_cvt_pk_bf16_f32 v216, v216, v217
    v_cvt_pk_bf16_f32 v217, v218, v219
    v_cvt_pk_bf16_f32 v218, v220, v221
    v_cvt_pk_bf16_f32 v219, v222, v223
    v_cvt_pk_bf16_f32 v220, v224, v225
    v_cvt_pk_bf16_f32 v221, v226, v227
    v_cvt_pk_bf16_f32 v222, v228, v229
    v_cvt_pk_bf16_f32 v223, v230, v231
    ds_write_b128 v232, v[216:219] offset:16384
    v_cvt_pk_bf16_f32 v224, v200, v201
    v_cvt_pk_bf16_f32 v225, v202, v203
    v_cvt_pk_bf16_f32 v226, v204, v205
    v_cvt_pk_bf16_f32 v227, v206, v207
    ds_write_b128 v232, v[220:223] offset:20480
    ds_write_b128 v232, v[224:227] offset:24576
    v_cvt_pk_bf16_f32 v228, v208, v209
    v_cvt_pk_bf16_f32 v229, v210, v211
    v_cvt_pk_bf16_f32 v230, v212, v213
    v_cvt_pk_bf16_f32 v231, v214, v215
    ds_write_b128 v232, v[228:231] offset:28672
    s_lshl_b32 s96, s77, 11
    s_add_u32 s17, s96, 151552
    v_add_u32 v0, s17, v2
    s_setprio 0
L_JOIN:
    s_waitcnt lgkmcnt(0)
    s_barrier
    ds_read_b64_tr_b16 v[184:185], v84
    ds_read_b64_tr_b16 v[186:187], v84 offset:512
    ds_read_b64_tr_b16 v[200:201], v85
    ds_read_b64_tr_b16 v[202:203], v85 offset:512
    ds_read_b64_tr_b16 v[204:205], v85 offset:1024
    ds_read_b64_tr_b16 v[206:207], v85 offset:1536
    ds_read_b64_tr_b16 v[188:189], v84 offset:1024
    ds_read_b64_tr_b16 v[190:191], v84 offset:1536
    ds_read_b64_tr_b16 v[208:209], v85 offset:2048
    ds_read_b64_tr_b16 v[210:211], v85 offset:2560
    ds_read_b64_tr_b16 v[212:213], v85 offset:3072
    ds_read_b64_tr_b16 v[214:215], v85 offset:3584
    ds_read_b64_tr_b16 v[192:193], v84 offset:2048
    ds_read_b64_tr_b16 v[194:195], v84 offset:2560
    ds_read_b64_tr_b16 v[216:217], v85 offset:4096
    ds_read_b64_tr_b16 v[218:219], v85 offset:4608
    ds_read_b64_tr_b16 v[220:221], v85 offset:5120
    ds_read_b64_tr_b16 v[222:223], v85 offset:5632
    s_waitcnt lgkmcnt(12)
    v_mfma_f32_16x16x32_bf16 v[232:235], v[184:187], v[200:203], 0
    v_mfma_f32_16x16x32_bf16 v[236:239], v[184:187], v[204:207], 0
    v_mfma_f32_16x16x32_bf16 v[240:243], v[184:187], v[80:83], 0
    ds_read_b64_tr_b16 v[196:197], v84 offset:3072
    ds_read_b64_tr_b16 v[198:199], v84 offset:3584
    ds_read_b64_tr_b16 v[224:225], v85 offset:6144
    ds_read_b64_tr_b16 v[226:227], v85 offset:6656
    ds_read_b64_tr_b16 v[228:229], v85 offset:7168
    ds_read_b64_tr_b16 v[230:231], v85 offset:7680
    s_waitcnt lgkmcnt(12)
    v_mfma_f32_16x16x32_bf16 v[232:235], v[188:191], v[208:211], v[232:235]
    v_mfma_f32_16x16x32_bf16 v[236:239], v[188:191], v[212:215], v[236:239]
    v_mfma_f32_16x16x32_bf16 v[240:243], v[188:191], v[80:83], v[240:243]
    s_waitcnt lgkmcnt(6)
    v_mfma_f32_16x16x32_bf16 v[232:235], v[192:195], v[216:219], v[232:235]
    v_mfma_f32_16x16x32_bf16 v[236:239], v[192:195], v[220:223], v[236:239]
    v_mfma_f32_16x16x32_bf16 v[240:243], v[192:195], v[80:83], v[240:243]
    s_waitcnt lgkmcnt(0)
    v_mfma_f32_16x16x32_bf16 v[232:235], v[196:199], v[224:227], v[232:235]
    v_mfma_f32_16x16x32_bf16 v[236:239], v[196:199], v[228:231], v[236:239]
    v_mfma_f32_16x16x32_bf16 v[240:243], v[196:199], v[80:83], v[240:243]
    s_cmp_lt_u32 s3, 4
    s_cbranch_scc1 L_NOQX
    ds_read_b128 v[168:171], v0
    ds_read_b128 v[172:175], v0 offset:1024
L_NOQX:
    s_nop 3
    buffer_store_dwordx4 v[232:235], v2, s[32:35], s13 offen sc1
    buffer_store_dwordx4 v[236:239], v2, s[32:35], s15 offen sc1
    s_mov_b32 exec_lo, 0x00010001
    s_mov_b32 exec_hi, 0x00010001
    buffer_store_dwordx4 v[240:243], v1, s[32:35], s14 offen sc1
    s_mov_b64 exec, -1
    s_waitcnt lgkmcnt(0)
    v_mfma_f32_32x32x16_bf16 v[120:135], v[176:179], v[168:171], 0
    v_mfma_f32_32x32x16_bf16 v[120:135], v[180:183], v[172:175], v[120:135]
    v_and_b32 v46, 7, v1
    v_lshlrev_b32 v46, 17, v46
    v_bfe_u32 v9, v1, 3, 1
    v_lshl_add_u32 v46, v9, 14, v46
    s_and_b32 s96, s10, 1
    s_and_b32 s97, s2, 27
    s_lshl_b32 s98, s97, 12
    s_lshr_b32 s99, s10, 1
    s_lshl_b32 s97, s99, 6
    s_add_u32 s99, s98, s97
    s_lshl2_add_u32 s98, s96, s99
    s_add_u32 s97, s98, 1048576
    s_add_u32 s17, s97, 512
    v_lshrrev_b32 v47, 3, v1
    v_lshlrev_b32 v47, 10, v47
    v_and_b32 v9, 7, v1
    v_lshl_add_u32 v47, v9, 4, v47
    v_and_b32 v48, 7, v1
    v_lshlrev_b32 v48, 4, v48
    v_lshrrev_b32 v9, 5, v1
    v_lshl_add_u32 v48, v9, 3, v48
    v_cvt_pk_bf16_f32 v120, 0, v120
    v_cvt_pk_bf16_f32 v121, 0, v121
    v_cvt_pk_bf16_f32 v122, 0, v122
    v_cvt_pk_bf16_f32 v123, 0, v123
    v_cvt_pk_bf16_f32 v124, 0, v124
    v_cvt_pk_bf16_f32 v125, 0, v125
    v_cvt_pk_bf16_f32 v126, 0, v126
    v_cvt_pk_bf16_f32 v127, 0, v127
    v_cvt_pk_bf16_f32 v128, 0, v128
    v_cvt_pk_bf16_f32 v129, 0, v129
    v_cvt_pk_bf16_f32 v130, 0, v130
    v_cvt_pk_bf16_f32 v131, 0, v131
    v_cvt_pk_bf16_f32 v132, 0, v132
    v_cvt_pk_bf16_f32 v133, 0, v133
    v_cvt_pk_bf16_f32 v134, 0, v134
    v_cvt_pk_bf16_f32 v135, 0, v135
    v_max3_f32 v4, v120, v121, v122
    v_min3_f32 v5, v120, v121, v122
    v_max3_f32 v4, v4, v123, v124
    v_min3_f32 v5, v5, v123, v124
    v_max3_f32 v4, v4, v125, v126
    v_min3_f32 v5, v5, v125, v126
    v_max3_f32 v4, v4, v127, v128
    v_min3_f32 v5, v5, v127, v128
    v_max3_f32 v4, v4, v129, v130
    v_min3_f32 v5, v5, v129, v130
    v_max3_f32 v4, v4, v131, v132
    v_min3_f32 v5, v5, v131, v132
    v_max3_f32 v4, v4, v133, v134
    v_min3_f32 v5, v5, v133, v134
    v_max_f32 v6, v4, v135
    v_min_f32 v7, v5, v135
    v_max_f32 v4, v4, v135
    v_min_f32 v5, v5, v135
    s_nop 0
    v_permlane32_swap_b32 v4, v6
    v_permlane32_swap_b32 v5, v7
    v_max_f32 v4, v4, v6
    v_min_f32 v5, v5, v7
    v_pk_mul_f32 v[4:5], v[4:5], s[6:7] op_sel:[0,1]
    v_mov_b32 v6, v5
    v_pk_fma_f32 v[136:137], v[120:121], s[6:7], v[4:5] op_sel:[0,1,0] op_sel_hi:[1,1,0] neg_lo:[0,0,1] neg_hi:[0,0,1]
    v_pk_fma_f32 v[120:121], v[120:121], s[6:7], v[6:7] op_sel:[0,1,0] op_sel_hi:[1,1,0] neg_lo:[1,0,0] neg_hi:[1,0,0]
    v_pk_fma_f32 v[138:139], v[122:123], s[6:7], v[4:5] op_sel:[0,1,0] op_sel_hi:[1,1,0] neg_lo:[0,0,1] neg_hi:[0,0,1]
    v_pk_fma_f32 v[122:123], v[122:123], s[6:7], v[6:7] op_sel:[0,1,0] op_sel_hi:[1,1,0] neg_lo:[1,0,0] neg_hi:[1,0,0]
    v_pk_fma_f32 v[140:141], v[124:125], s[6:7], v[4:5] op_sel:[0,1,0] op_sel_hi:[1,1,0] neg_lo:[0,0,1] neg_hi:[0,0,1]
    v_pk_fma_f32 v[124:125], v[124:125], s[6:7], v[6:7] op_sel:[0,1,0] op_sel_hi:[1,1,0] neg_lo:[1,0,0] neg_hi:[1,0,0]
    v_pk_fma_f32 v[142:143], v[126:127], s[6:7], v[4:5] op_sel:[0,1,0] op_sel_hi:[1,1,0] neg_lo:[0,0,1] neg_hi:[0,0,1]
    v_pk_fma_f32 v[126:127], v[126:127], s[6:7], v[6:7] op_sel:[0,1,0] op_sel_hi:[1,1,0] neg_lo:[1,0,0] neg_hi:[1,0,0]
    v_pk_fma_f32 v[144:145], v[128:129], s[6:7], v[4:5] op_sel:[0,1,0] op_sel_hi:[1,1,0] neg_lo:[0,0,1] neg_hi:[0,0,1]
    v_pk_fma_f32 v[128:129], v[128:129], s[6:7], v[6:7] op_sel:[0,1,0] op_sel_hi:[1,1,0] neg_lo:[1,0,0] neg_hi:[1,0,0]
    v_pk_fma_f32 v[146:147], v[130:131], s[6:7], v[4:5] op_sel:[0,1,0] op_sel_hi:[1,1,0] neg_lo:[0,0,1] neg_hi:[0,0,1]
    v_pk_fma_f32 v[130:131], v[130:131], s[6:7], v[6:7] op_sel:[0,1,0] op_sel_hi:[1,1,0] neg_lo:[1,0,0] neg_hi:[1,0,0]
    v_pk_fma_f32 v[148:149], v[132:133], s[6:7], v[4:5] op_sel:[0,1,0] op_sel_hi:[1,1,0] neg_lo:[0,0,1] neg_hi:[0,0,1]
    v_pk_fma_f32 v[132:133], v[132:133], s[6:7], v[6:7] op_sel:[0,1,0] op_sel_hi:[1,1,0] neg_lo:[1,0,0] neg_hi:[1,0,0]
    v_pk_fma_f32 v[150:151], v[134:135], s[6:7], v[4:5] op_sel:[0,1,0] op_sel_hi:[1,1,0] neg_lo:[0,0,1] neg_hi:[0,0,1]
    v_pk_fma_f32 v[134:135], v[134:135], s[6:7], v[6:7] op_sel:[0,1,0] op_sel_hi:[1,1,0] neg_lo:[1,0,0] neg_hi:[1,0,0]
    v_exp_f32 v136, v136
    v_exp_f32 v120, v120
    v_exp_f32 v137, v137
    v_exp_f32 v121, v121
    v_exp_f32 v138, v138
    v_exp_f32 v122, v122
    v_exp_f32 v139, v139
    v_exp_f32 v123, v123
    v_exp_f32 v140, v140
    v_exp_f32 v124, v124
    v_exp_f32 v141, v141
    v_exp_f32 v125, v125
    v_exp_f32 v142, v142
    v_exp_f32 v126, v126
    v_exp_f32 v143, v143
    v_exp_f32 v127, v127
    s_waitcnt vmcnt(0)
    s_barrier
    s_cmp_lg_u32 s3, 0
    s_cbranch_scc1 L_PC
    v_mov_b32 v85, s4
    s_mov_b32 exec_hi, 0
    s_mov_b32 exec_lo, 65535
    buffer_store_dword v85, v46, s[32:35], s17 offen sc1
    s_mov_b64 exec, -1
L_PC:
    s_xor_b32 s96, s95, 1310720
    s_add_u32 s82, s96, s90
    s_add_u32 m0, s83, 81920
    s_nop 0
    buffer_load_dwordx4 v26, s[44:47], s82 offen lds
    v_exp_f32 v144, v144
    v_exp_f32 v128, v128
    v_exp_f32 v145, v145
    v_exp_f32 v129, v129
    s_xor_b32 s96, s95, 1441792
    s_add_u32 s82, s96, s90
    s_add_u32 m0, s83, 90112
    s_nop 0
    buffer_load_dwordx4 v26, s[44:47], s82 offen lds
    v_exp_f32 v146, v146
    v_exp_f32 v130, v130
    v_exp_f32 v147, v147
    v_exp_f32 v131, v131
    s_xor_b32 s96, s95, 1572864
    s_add_u32 s82, s96, s90
    s_add_u32 m0, s83, 98304
    s_nop 0
    buffer_load_dwordx4 v26, s[44:47], s82 offen lds
    v_exp_f32 v148, v148
    v_exp_f32 v132, v132
    v_exp_f32 v149, v149
    v_exp_f32 v133, v133
    s_xor_b32 s96, s95, 1703936
    s_add_u32 s82, s96, s90
    s_add_u32 m0, s83, 106496
    s_nop 0
    buffer_load_dwordx4 v26, s[44:47], s82 offen lds
    v_exp_f32 v150, v150
    v_exp_f32 v134, v134
    v_exp_f32 v151, v151
    v_exp_f32 v135, v135
    s_lshl4_add_u32 s96, s11, s10
    s_lshl_b32 s97, s96, 14
    s_lshl_b32 s98, s3, 7
    s_add_u32 s99, s97, s98
    s_add_u32 s13, s99, 25165824
    s_add_u32 s14, s13, 8192
    s_lshl4_add_u32 s96, s11, s10
    s_lshl_b32 s97, s96, 10
    s_lshl_b32 s98, s3, 7
    s_add_u32 s99, s97, s98
    s_add_u32 s15, s99, 29360128
    s_add_u32 s17, s17, 3072
    s_load_dwordx2 s[24:25], s[32:33], s92 offset:512 glc
    s_xor_b32 s96, s95, 1835008
    s_add_u32 s82, s96, s90
    s_add_u32 m0, s83, 114688
    s_nop 0
    buffer_load_dwordx4 v26, s[44:47], s82 offen lds
    v_pk_add_f32 v[8:9], v[136:137], v[138:139]
    v_pk_add_f32 v[10:11], v[120:121], v[122:123]
    v_pk_add_f32 v[8:9], v[8:9], v[140:141]
    v_pk_add_f32 v[10:11], v[10:11], v[124:125]
    v_pk_add_f32 v[8:9], v[8:9], v[142:143]
    v_pk_add_f32 v[10:11], v[10:11], v[126:127]
    v_pk_add_f32 v[8:9], v[8:9], v[144:145]
    v_pk_add_f32 v[10:11], v[10:11], v[128:129]
    v_pk_add_f32 v[8:9], v[8:9], v[146:147]
    v_pk_add_f32 v[10:11], v[10:11], v[130:131]
    v_pk_add_f32 v[8:9], v[8:9], v[148:149]
    v_pk_add_f32 v[10:11], v[10:11], v[132:133]
    v_pk_add_f32 v[8:9], v[8:9], v[150:151]
    v_pk_add_f32 v[10:11], v[10:11], v[134:135]
    s_xor_b32 s96, s95, 1966080
    s_add_u32 s82, s96, s90
    s_add_u32 m0, s83, 122880
    s_nop 0
    buffer_load_dwordx4 v26, s[44:47], s82 offen lds
    v_add_f32 v6, v8, v9
    v_add_f32 v7, v10, v11
    v_add_f32 v4, v8, v9
    v_add_f32 v5, v10, v11
    s_nop 0
    v_permlane32_swap_b32 v4, v6
    v_permlane32_swap_b32 v5, v7
    v_pk_add_f32 v[4:5], v[4:5], v[6:7]
    v_rcp_f32 v4, v4
    v_rcp_f32 v5, v5
    s_nop 0
    v_pk_mul_f32 v[136:137], v[136:137], v[4:5] op_sel_hi:[1,0]
    v_pk_mul_f32 v[120:121], v[4:5], v[120:121] op_sel:[1,0]
    v_pk_mul_f32 v[138:139], v[138:139], v[4:5] op_sel_hi:[1,0]
    v_pk_mul_f32 v[122:123], v[4:5], v[122:123] op_sel:[1,0]
    v_pk_mul_f32 v[140:141], v[140:141], v[4:5] op_sel_hi:[1,0]
    s_add_u32 s82, s95, s90
    s_mov_b32 m0, s83
    s_nop 0
    buffer_load_dwordx4 v26, s[44:47], s82 offen lds
    v_pk_mul_f32 v[124:125], v[4:5], v[124:125] op_sel:[1,0]
    v_pk_mul_f32 v[142:143], v[142:143], v[4:5] op_sel_hi:[1,0]
    v_pk_mul_f32 v[126:127], v[4:5], v[126:127] op_sel:[1,0]
    v_pk_mul_f32 v[144:145], v[144:145], v[4:5] op_sel_hi:[1,0]
    v_pk_mul_f32 v[128:129], v[4:5], v[128:129] op_sel:[1,0]
    v_pk_mul_f32 v[146:147], v[146:147], v[4:5] op_sel_hi:[1,0]
    v_pk_mul_f32 v[130:131], v[4:5], v[130:131] op_sel:[1,0]
    v_pk_mul_f32 v[148:149], v[148:149], v[4:5] op_sel_hi:[1,0]
    v_pk_mul_f32 v[132:133], v[4:5], v[132:133] op_sel:[1,0]
    v_pk_mul_f32 v[150:151], v[150:151], v[4:5] op_sel_hi:[1,0]
    v_pk_mul_f32 v[134:135], v[4:5], v[134:135] op_sel:[1,0]
    v_cvt_pk_bf16_f32 v152, v136, v137
    v_cvt_pk_bf16_f32 v153, v138, v139
    v_cvt_pk_bf16_f32 v154, v140, v141
    s_xor_b32 s96, s95, 131072
    s_add_u32 s82, s96, s90
    s_add_u32 m0, s83, 8192
    s_nop 0
    buffer_load_dwordx4 v26, s[44:47], s82 offen lds
    v_cvt_pk_bf16_f32 v155, v142, v143
    v_cvt_pk_bf16_f32 v156, v144, v145
    v_cvt_pk_bf16_f32 v157, v146, v147
    v_cvt_pk_bf16_f32 v158, v148, v149
    v_cvt_pk_bf16_f32 v159, v150, v151
    v_cvt_pk_bf16_f32 v160, v120, v121
    v_cvt_pk_bf16_f32 v161, v122, v123
    v_cvt_pk_bf16_f32 v162, v124, v125
    v_cvt_pk_bf16_f32 v163, v126, v127
    v_cvt_pk_bf16_f32 v164, v128, v129
    v_cvt_pk_bf16_f32 v165, v130, v131
    v_cvt_pk_bf16_f32 v166, v132, v133
    v_cvt_pk_bf16_f32 v167, v134, v135
    s_branch SCHK_20
SPOLL_19:
    s_load_dwordx2 s[24:25], s[32:33], s92 offset:512 glc
SCHK_20:
    s_add_u32 s5, s5, 1
    s_cmp_ge_u32 s5, 200000
    s_waitcnt lgkmcnt(0)
    s_cbranch_scc1 SDONE_21
    s_cmp_lg_u32 s24, s4
    s_cbranch_scc1 SPOLL_19
    s_cmp_lg_u32 s25, s4
    s_cbranch_scc1 SPOLL_19
SDONE_21:
    s_barrier
    buffer_load_dwordx4 v[184:187], v47, s[32:35], s13 offen sc1
    buffer_load_dwordx4 v[188:191], v47, s[32:35], s14 offen sc1
    buffer_load_dwordx4 v[192:195], v2, s[32:35], s16 offen sc1
    s_lshl_b32 s19, s12, 7
    v_and_b32 v32, 3, v1
    v_lshl_add_u32 v32, v32, 1, s19
    v_lshrrev_b32 v28, 5, v1
    v_lshl_add_u32 v32, v28, 3, v32
    v_bfe_u32 v28, v1, 4, 1
    v_lshl_add_u32 v32, v28, 4, v32
    v_bfe_u32 v28, v1, 2, 2
    v_lshl_add_u32 v32, v28, 5, v32
    global_load_ushort v32, v32, s[78:79]
    s_lshl_b32 s96, s3, 5
    s_add_u32 s14, s96, 155648
    v_and_b32 v6, 3, v1
    v_lshl_add_u32 v6, v6, 3, s14
    v_lshrrev_b32 v9, 5, v1
    v_lshl_add_u32 v6, v9, 2, v6
    s_lshl_b32 s96, s3, 10
    s_add_u32 s14, s96, 147456
    v_and_b32 v5, 15, v1
    v_lshl_add_u32 v5, v5, 4, s14
    v_lshrrev_b32 v9, 5, v1
    v_lshl_add_u32 v5, v9, 9, v5
    v_bfe_u32 v9, v1, 4, 1
    v_lshl_add_u32 v5, v9, 3, v5
    s_lshl_b32 s96, s76, 7
    s_add_u32 s14, s96, 155648
    v_lshrrev_b32 v7, 5, v1
    v_lshl_add_u32 v7, v7, 4, s14
    s_lshl_b32 s96, s76, 12
    s_add_u32 s14, s96, 147456
    v_add_u32 v84, s14, v2
    s_cmp_lt_u32 s3, 4
    s_cbranch_scc1 L_HG1
    v_lshlrev_b32 v8, 16, v88
    v_and_b32 v9, s6, v88
    v_pk_mul_f32 v[196:197], v[36:37], v[8:9] op_sel:[0,0] op_sel_hi:[0,1]
    v_lshlrev_b32 v10, 16, v89
    v_and_b32 v11, s6, v89
    v_pk_mul_f32 v[198:199], v[36:37], v[10:11] op_sel:[0,0] op_sel_hi:[0,1]
    v_lshlrev_b32 v8, 16, v90
    v_and_b32 v9, s6, v90
    v_pk_mul_f32 v[200:201], v[36:37], v[8:9] op_sel:[0,0] op_sel_hi:[0,1]
    v_lshlrev_b32 v10, 16, v91
    v_and_b32 v11, s6, v91
    v_pk_mul_f32 v[202:203], v[36:37], v[10:11] op_sel:[0,0] op_sel_hi:[0,1]
    v_lshlrev_b32 v8, 16, v92
    v_and_b32 v9, s6, v92
    v_pk_fma_f32 v[196:197], v[36:37], v[8:9], v[196:197] op_sel:[1,0,0] op_sel_hi:[1,1,1]
    v_lshlrev_b32 v10, 16, v93
    v_and_b32 v11, s6, v93
    v_pk_fma_f32 v[198:199], v[36:37], v[10:11], v[198:199] op_sel:[1,0,0] op_sel_hi:[1,1,1]
    v_lshlrev_b32 v8, 16, v94
    v_and_b32 v9, s6, v94
    v_pk_fma_f32 v[200:201], v[36:37], v[8:9], v[200:201] op_sel:[1,0,0] op_sel_hi:[1,1,1]
    v_lshlrev_b32 v10, 16, v95
    v_and_b32 v11, s6, v95
    v_pk_fma_f32 v[202:203], v[36:37], v[10:11], v[202:203] op_sel:[1,0,0] op_sel_hi:[1,1,1]
    v_lshlrev_b32 v8, 16, v96
    v_and_b32 v9, s6, v96
    v_pk_fma_f32 v[196:197], v[38:39], v[8:9], v[196:197] op_sel:[0,0,0] op_sel_hi:[0,1,1]
    v_lshlrev_b32 v10, 16, v97
    v_and_b32 v11, s6, v97
    v_pk_fma_f32 v[198:199], v[38:39], v[10:11], v[198:199] op_sel:[0,0,0] op_sel_hi:[0,1,1]
    v_lshlrev_b32 v8, 16, v98
    v_and_b32 v9, s6, v98
    v_pk_fma_f32 v[200:201], v[38:39], v[8:9], v[200:201] op_sel:[0,0,0] op_sel_hi:[0,1,1]
    v_lshlrev_b32 v10, 16, v99
    v_and_b32 v11, s6, v99
    v_pk_fma_f32 v[202:203], v[38:39], v[10:11], v[202:203] op_sel:[0,0,0] op_sel_hi:[0,1,1]
    v_lshlrev_b32 v8, 16, v100
    v_and_b32 v9, s6, v100
    v_pk_fma_f32 v[196:197], v[38:39], v[8:9], v[196:197] op_sel:[1,0,0] op_sel_hi:[1,1,1]
    v_lshlrev_b32 v10, 16, v101
    v_and_b32 v11, s6, v101
    v_pk_fma_f32 v[198:199], v[38:39], v[10:11], v[198:199] op_sel:[1,0,0] op_sel_hi:[1,1,1]
    v_lshlrev_b32 v8, 16, v102
    v_and_b32 v9, s6, v102
    v_pk_fma_f32 v[200:201], v[38:39], v[8:9], v[200:201] op_sel:[1,0,0] op_sel_hi:[1,1,1]
    v_lshlrev_b32 v10, 16, v103
    v_and_b32 v11, s6, v103
    v_pk_fma_f32 v[202:203], v[38:39], v[10:11], v[202:203] op_sel:[1,0,0] op_sel_hi:[1,1,1]
    v_lshlrev_b32 v8, 16, v104
    v_and_b32 v9, s6, v104
    v_pk_fma_f32 v[196:197], v[40:41], v[8:9], v[196:197] op_sel:[0,0,0] op_sel_hi:[0,1,1]
    v_lshlrev_b32 v10, 16, v105
    v_and_b32 v11, s6, v105
    v_pk_fma_f32 v[198:199], v[40:41], v[10:11], v[198:199] op_sel:[0,0,0] op_sel_hi:[0,1,1]
    v_lshlrev_b32 v8, 16, v106
    v_and_b32 v9, s6, v106
    v_pk_fma_f32 v[200:201], v[40:41], v[8:9], v[200:201] op_sel:[0,0,0] op_sel_hi:[0,1,1]
    v_lshlrev_b32 v10, 16, v107
    v_and_b32 v11, s6, v107
    v_pk_fma_f32 v[202:203], v[40:41], v[10:11], v[202:203] op_sel:[0,0,0] op_sel_hi:[0,1,1]
    v_lshlrev_b32 v8, 16, v108
    v_and_b32 v9, s6, v108
    v_pk_fma_f32 v[196:197], v[40:41], v[8:9], v[196:197] op_sel:[1,0,0] op_sel_hi:[1,1,1]
    v_lshlrev_b32 v10, 16, v109
    v_and_b32 v11, s6, v109
    v_pk_fma_f32 v[198:199], v[40:41], v[10:11], v[198:199] op_sel:[1,0,0] op_sel_hi:[1,1,1]
    v_lshlrev_b32 v8, 16, v110
    v_and_b32 v9, s6, v110
    v_pk_fma_f32 v[200:201], v[40:41], v[8:9], v[200:201] op_sel:[1,0,0] op_sel_hi:[1,1,1]
    v_lshlrev_b32 v10, 16, v111
    v_and_b32 v11, s6, v111
    v_pk_fma_f32 v[202:203], v[40:41], v[10:11], v[202:203] op_sel:[1,0,0] op_sel_hi:[1,1,1]
    v_lshlrev_b32 v8, 16, v112
    v_and_b32 v9, s6, v112
    v_pk_fma_f32 v[196:197], v[42:43], v[8:9], v[196:197] op_sel:[0,0,0] op_sel_hi:[0,1,1]
    v_lshlrev_b32 v10, 16, v113
    v_and_b32 v11, s6, v113
    v_pk_fma_f32 v[198:199], v[42:43], v[10:11], v[198:199] op_sel:[0,0,0] op_sel_hi:[0,1,1]
    v_lshlrev_b32 v8, 16, v114
    v_and_b32 v9, s6, v114
    v_pk_fma_f32 v[200:201], v[42:43], v[8:9], v[200:201] op_sel:[0,0,0] op_sel_hi:[0,1,1]
    v_lshlrev_b32 v10, 16, v115
    v_and_b32 v11, s6, v115
    v_pk_fma_f32 v[202:203], v[42:43], v[10:11], v[202:203] op_sel:[0,0,0] op_sel_hi:[0,1,1]
    v_lshlrev_b32 v8, 16, v116
    v_and_b32 v9, s6, v116
    v_pk_fma_f32 v[196:197], v[42:43], v[8:9], v[196:197] op_sel:[1,0,0] op_sel_hi:[1,1,1]
    v_lshlrev_b32 v10, 16, v117
    v_and_b32 v11, s6, v117
    v_pk_fma_f32 v[198:199], v[42:43], v[10:11], v[198:199] op_sel:[1,0,0] op_sel_hi:[1,1,1]
    v_lshlrev_b32 v8, 16, v118
    v_and_b32 v9, s6, v118
    v_pk_fma_f32 v[200:201], v[42:43], v[8:9], v[200:201] op_sel:[1,0,0] op_sel_hi:[1,1,1]
    v_lshlrev_b32 v10, 16, v119
    v_and_b32 v11, s6, v119
    v_pk_fma_f32 v[202:203], v[42:43], v[10:11], v[202:203] op_sel:[1,0,0] op_sel_hi:[1,1,1]
    v_permlane32_swap_b32 v196, v200
    v_permlane32_swap_b32 v197, v201
    v_permlane32_swap_b32 v198, v202
    v_permlane32_swap_b32 v199, v203
    v_add_f32 v196, v196, v200
    v_add_f32 v197, v197, v201
    v_add_f32 v198, v198, v202
    v_add_f32 v199, v199, v203
    s_nop 0
    v_permlane16_swap_b32 v196, v198
    v_permlane16_swap_b32 v197, v199
    v_add_f32 v196, v196, v198
    v_add_f32 v197, v197, v199
    s_nop 0
    v_add_f32_dpp v196, v196, v196 row_ror:8 row_mask:0xf bank_mask:0xf
    v_add_f32_dpp v197, v197, v197 row_ror:8 row_mask:0xf bank_mask:0xf
    s_nop 1
    v_mov_b32_dpp v196, v197 quad_perm:[0,1,2,3] row_mask:0xf bank_mask:0xc
    ds_write_b32 v252, v196 offset:9984
L_HG1:
    s_waitcnt vmcnt(2)
    v_pk_add_f32 v[184:185], v[184:185], v[188:189]
    v_pk_add_f32 v[186:187], v[186:187], v[190:191]
    s_nop 1
    v_permlane32_swap_b32 v184, v186
    v_permlane32_swap_b32 v185, v187
    v_pk_add_f32 v[184:185], v[184:185], v[186:187]
    s_nop 1
    v_add_f32_dpp v184, v184, v184 row_ror:8 row_mask:0xf bank_mask:0xf
    v_add_f32_dpp v185, v185, v185 row_ror:8 row_mask:0xf bank_mask:0xf
    v_mov_b32 v186, v184
    v_mov_b32 v187, v185
    s_nop 0
    v_permlane16_swap_b32 v184, v186
    v_permlane16_swap_b32 v185, v187
    v_pk_add_f32 v[184:185], v[184:185], v[186:187]
    v_cvt_pk_bf16_f32 v184, v184, v185
    v_mov_b32 v185, s4
    s_mov_b32 exec_lo, 0xff
    s_mov_b32 exec_hi, 0xff
    buffer_store_dwordx2 v[184:185], v48, s[32:35], s15 offen sc1
    s_mov_b64 exec, -1
    s_waitcnt lgkmcnt(0)
    s_barrier
    s_cmp_lg_u32 s3, 0
    s_cbranch_scc1 L_PC2
    v_mov_b32 v85, s4
    s_mov_b32 exec_hi, 0
    s_mov_b32 exec_lo, 65535
    buffer_store_dword v85, v46, s[32:35], s17 offen sc1
    s_mov_b64 exec, -1
L_PC2:
    s_cmp_lg_u32 s3, 3
    s_cbranch_scc1 L_M2F
    ds_read_b128 v[196:199], v251 offset:11008
    s_lshr_b32 s96, s8, 2
    s_lshl1_add_u32 s97, s9, s96
    s_and_b32 s98, s8, 3
    s_lshl2_add_u32 s99, s97, s98
    s_lshl_b32 s96, s99, 9
    s_add_u32 s18, s96, 131072
    s_waitcnt lgkmcnt(0)
    v_add_f32 v196, v196, v197
    v_add_f32 v198, v198, v199
    v_mov_b32 v197, s4
    v_add_f32 v196, v196, v198
    buffer_store_dwordx2 v[196:197], v250, s[32:35], s18 offen sc1
L_M2F:
    s_waitcnt vmcnt(2)
    s_xor_b32 s96, s95, 262144
    s_add_u32 s82, s96, s90
    s_add_u32 m0, s83, 16384
    s_nop 0
    buffer_load_dwordx4 v26, s[44:47], s82 offen lds
    v_permlane32_swap_b32 v192, v194
    v_permlane32_swap_b32 v193, v195
    v_pk_add_f32 v[192:193], v[192:193], v[194:195]
    s_nop 1
    v_add_f32_dpp v192, v192, v192 row_ror:4 row_mask:0xf bank_mask:0xf
    s_xor_b32 s96, s95, 393216
    s_add_u32 s82, s96, s90
    s_add_u32 m0, s83, 24576
    s_nop 0
    buffer_load_dwordx4 v26, s[44:47], s82 offen lds
    v_add_f32_dpp v193, v193, v193 row_ror:4 row_mask:0xf bank_mask:0xf
    v_add_f32_dpp v192, v192, v192 row_ror:8 row_mask:0xf bank_mask:0xf
    s_nop 0
    v_add_f32_dpp v193, v193, v193 row_ror:8 row_mask:0xf bank_mask:0xf
    s_xor_b32 s96, s95, 524288
    s_add_u32 s82, s96, s90
    s_add_u32 m0, s83, 32768
    s_nop 0
    buffer_load_dwordx4 v26, s[44:47], s82 offen lds
    v_mov_b32 v194, v192
    v_mov_b32 v195, v193
    s_nop 0
    v_permlane16_swap_b32 v192, v194
    s_xor_b32 s96, s95, 655360
    s_add_u32 s82, s96, s90
    s_add_u32 m0, s83, 40960
    s_nop 0
    buffer_load_dwordx4 v26, s[44:47], s82 offen lds
    v_permlane16_swap_b32 v193, v195
    v_pk_add_f32 v[192:193], v[192:193], v[194:195]
    v_cvt_pk_bf16_f32 v192, v192, v193
    ds_write_b32 v6, v192
    s_waitcnt lgkmcnt(0)
    s_barrier
    ds_read_b128 v[196:199], v7
    ds_read_b128 v[200:203], v7 offset:32
    ds_read_b128 v[204:207], v7 offset:64
    ds_read_b128 v[208:211], v7 offset:96
    s_lshr_b32 s96, s8, 2
    s_lshl1_add_u32 s97, s9, s96
    s_and_b32 s98, s8, 3
    s_lshl2_add_u32 s99, s97, s98
    s_lshl_b32 s96, s99, 9
    s_add_u32 s18, s96, 131072
    s_waitcnt lgkmcnt(0)
    s_lshl3_add_u32 s96, s11, s3
    s_lshl_b32 s97, s96, 11
    s_add_u32 s13, s97, 29360128
    s_load_dwordx2 s[24:25], s[32:33], s92 offset:3584 glc
    v_mfma_f32_32x32x16_bf16 v[136:151], v[196:199], v[152:155], 0
    v_mfma_f32_32x32x16_bf16 v[136:151], v[200:203], v[156:159], v[136:151]
    v_mfma_f32_32x32x16_bf16 v[136:151], v[204:207], v[160:163], v[136:151]
    v_mfma_f32_32x32x16_bf16 v[136:151], v[208:211], v[164:167], v[136:151]
    s_lshr_b32 s96, s3, 2
    s_lshl_b32 s97, s96, 15
    s_and_b32 s98, s3, 3
    s_lshl_b32 s99, s98, 5
    s_add_u32 s19, s97, s99
    v_lshrrev_b32 v34, 4, v1
    v_lshlrev_b32 v34, 13, v34
    v_bfe_u32 v9, v1, 2, 2
    v_lshl_add_u32 v34, v9, 7, v34
    v_bfe_u32 v9, v1, 3, 2
    v_lshl_add_u32 v34, v9, 5, v34
    v_and_b32 v9, 3, v1
    v_lshl_add_u32 v34, v9, 3, v34
    v_xor_b32 v34, s19, v34
    s_lshl_b32 s96, s75, 11
    s_add_u32 s19, s96, 13631488
    v_and_b32 v52, 7, v1
    v_lshl_add_u32 v52, v52, 4, s19
    v_lshrrev_b32 v9, 4, v1
    v_lshl_add_u32 v52, v9, 9, v52
    v_and_b32 v53, 15, v1
    v_lshlrev_b32 v53, 9, v53
    v_add_u32 v53, 13631744, v53
    s_lshl_b32 s96, s74, 13
    s_add_u32 s72, s96, 20971520
    s_lshl3_add_u32 s96, s75, s3
    s_lshl_b32 s97, s96, 8
    s_add_u32 s73, s97, s72
    s_lshl3_add_u32 s96, s21, s3
    s_lshl4_add_u32 s97, s96, s12
    s_lshl_b32 s98, s97, 8
    s_add_u32 s86, s98, 12582912
    s_and_b32 s96, s12, 1
    s_lshr_b32 s97, s21, 2
    s_and_b32 s98, s21, 3
    s_lshl_b32 s99, s98, 6
    s_lshl1_add_u32 s98, s97, s99
    s_lshl_b32 s97, s98, 12
    s_lshr_b32 s99, s12, 1
    s_lshl_b32 s98, s99, 6
    s_add_u32 s99, s97, s98
    s_lshl2_add_u32 s97, s96, s99
    s_add_u32 s98, s97, 1048576
    s_add_u32 s87, s98, 1536
    s_lshl3_add_u32 s96, s21, s3
    s_lshl_b32 s97, s96, 15
    s_lshl_b32 s98, s12, 7
    s_add_u32 s70, s97, s98
    s_add_u32 s71, s70, 16384
    v_cvt_pk_bf16_f32 v136, 0, v136
    v_add_f32 v136, 0x358637bd, v136
    v_cvt_pk_bf16_f32 v136, 0, v136
    v_rcp_f32 v136, v136
    s_branch SCHK_23
SPOLL_22:
    s_load_dwordx2 s[24:25], s[32:33], s92 offset:3584 glc
SCHK_23:
    s_add_u32 s5, s5, 1
    s_cmp_ge_u32 s5, 200000
    s_waitcnt lgkmcnt(0)
    s_cbranch_scc1 SDONE_24
    s_cmp_lg_u32 s24, s4
    s_cbranch_scc1 SPOLL_22
L_PAD7:
    s_cbranch_execz L_RET7
    s_cmp_lg_u32 s25, s4
    s_cbranch_scc1 SPOLL_22
SDONE_24:
    buffer_load_dwordx4 v[228:231], v2, s[32:35], s13 offen sc1
    buffer_load_dwordx4 v[232:235], v2, s[32:35], s13 offen offset:1024 sc1
    s_lshl_b32 s19, s3, 6
    v_bfe_u32 v35, v1, 2, 1
    v_lshlrev_b32 v35, 9, v35
    v_bfe_u32 v9, v1, 3, 1
    v_lshl_add_u32 v35, v9, 12, v35
    v_lshrrev_b32 v9, 5, v1
    v_lshl_add_u32 v35, v9, 11, v35
    v_bfe_u32 v9, v1, 2, 2
    v_lshl_add_u32 v35, v9, 6, v35
    v_bfe_u32 v9, v1, 4, 1
    v_lshl_add_u32 v35, v9, 5, v35
    v_and_b32 v9, 3, v1
    v_lshl_add_u32 v35, v9, 3, v35
    v_xor_b32 v35, s19, v35
    v_add_u32 v35, 65536, v35
    s_waitcnt vmcnt(0)
    v_bitop3_b32 v4, v229, v231, s4 bitop3:0x7e
    v_bitop3_b32 v4, v4, v233, s4 bitop3:0xf6
    v_bitop3_b32 v4, v4, v235, s4 bitop3:0xf6
    v_cmp_ne_u32 vcc, 0, v4
    s_cbranch_vccz TOK_26
POLL_27:
    buffer_load_dwordx4 v[228:231], v2, s[32:35], s13 offen sc1
    buffer_load_dwordx4 v[232:235], v2, s[32:35], s13 offen offset:1024 sc1
    s_waitcnt vmcnt(0)
    v_bitop3_b32 v4, v229, v231, s4 bitop3:0x7e
    v_bitop3_b32 v4, v4, v233, s4 bitop3:0xf6
    v_bitop3_b32 v4, v4, v235, s4 bitop3:0xf6
    v_cmp_ne_u32 vcc, 0, v4
    s_cbranch_vccz PDONE_28
    s_add_u32 s5, s5, 1
    s_cmp_lt_u32 s5, 200000
    s_cbranch_scc1 POLL_27
PDONE_28:
TOK_26:
    ds_write2_b32 v5, v228, v230 offset0:0 offset1:1
    ds_write2_b32 v5, v232, v234 offset0:64 offset1:65
    s_waitcnt lgkmcnt(0)
    s_barrier
    ds_read_b128 v[212:215], v84
    ds_read_b128 v[216:219], v84 offset:1024
    ds_read_b128 v[220:223], v84 offset:2048
    ds_read_b128 v[224:227], v84 offset:3072
    s_lshl_b32 s96, s77, 1
    s_lshl3_add_u32 s97, s10, s96
    s_lshl_b32 s98, s97, 5
    s_lshl1_add_u32 s99, s11, s98
    s_add_u32 s96, s99, s76
    s_lshl_b32 s97, s96, 10
    s_add_u32 s13, s97, 8388608
    v_and_b32 v47, 15, v1
    v_lshlrev_b32 v47, 4, v47
    v_bfe_u32 v9, v1, 4, 1
    v_lshl_add_u32 v47, v9, 15, v47
    v_lshrrev_b32 v9, 5, v1
    v_lshl_add_u32 v47, v9, 8, v47
    s_waitcnt lgkmcnt(3)
    v_mfma_f32_32x32x16_bf16 v[120:135], v[212:215], v[152:155], 0
    s_waitcnt lgkmcnt(2)
    v_mfma_f32_32x32x16_bf16 v[120:135], v[216:219], v[156:159], v[120:135]
    s_waitcnt lgkmcnt(1)
    v_mfma_f32_32x32x16_bf16 v[120:135], v[220:223], v[160:163], v[120:135]
    s_waitcnt lgkmcnt(0)
    v_mfma_f32_32x32x16_bf16 v[120:135], v[224:227], v[164:167], v[120:135]
    s_lshr_b32 s96, s3, 1
    s_lshl4_add_u32 s97, s96, s12
    s_lshl_b32 s98, s97, 11
    s_and_b32 s99, s3, 1
    s_lshl_b32 s96, s99, 10
    s_add_u32 s97, s98, s96
    s_add_u32 s18, s97, 131072
    buffer_load_dwordx4 v[28:31], v2, s[32:35], s18 offen sc1
    s_nop 3
    v_cvt_pk_bf16_f32 v120, 0, v120
    v_cvt_pk_bf16_f32 v121, 0, v121
    v_cvt_pk_bf16_f32 v122, 0, v122
    v_cvt_pk_bf16_f32 v123, 0, v123
    v_cvt_pk_bf16_f32 v124, 0, v124
    v_cvt_pk_bf16_f32 v125, 0, v125
    v_cvt_pk_bf16_f32 v126, 0, v126
    v_cvt_pk_bf16_f32 v127, 0, v127
    v_pk_mul_f32 v[120:121], v[120:121], v[136:137] op_sel_hi:[1,0]
    v_pk_mul_f32 v[122:123], v[122:123], v[136:137] op_sel_hi:[1,0]
    v_pk_mul_f32 v[124:125], v[124:125], v[136:137] op_sel_hi:[1,0]
    v_pk_mul_f32 v[126:127], v[126:127], v[136:137] op_sel_hi:[1,0]
    v_cvt_pk_bf16_f32 v168, v120, v121
    v_cvt_pk_bf16_f32 v169, v122, v123
    v_cvt_pk_bf16_f32 v170, v124, v125
    v_cvt_pk_bf16_f32 v171, v126, v127
    buffer_store_dwordx4 v[168:171], v47, s[32:35], s13 offen sc1
    v_cvt_pk_bf16_f32 v128, 0, v128
    v_cvt_pk_bf16_f32 v129, 0, v129
    v_cvt_pk_bf16_f32 v130, 0, v130
    v_cvt_pk_bf16_f32 v131, 0, v131
    v_cvt_pk_bf16_f32 v132, 0, v132
    v_cvt_pk_bf16_f32 v133, 0, v133
    v_cvt_pk_bf16_f32 v134, 0, v134
    v_cvt_pk_bf16_f32 v135, 0, v135
    v_pk_mul_f32 v[128:129], v[128:129], v[136:137] op_sel_hi:[1,0]
    v_pk_mul_f32 v[130:131], v[130:131], v[136:137] op_sel_hi:[1,0]
    v_pk_mul_f32 v[132:133], v[132:133], v[136:137] op_sel_hi:[1,0]
    v_pk_mul_f32 v[134:135], v[134:135], v[136:137] op_sel_hi:[1,0]
    v_cvt_pk_bf16_f32 v172, v128, v129
    v_cvt_pk_bf16_f32 v173, v130, v131
    v_cvt_pk_bf16_f32 v174, v132, v133
    v_cvt_pk_bf16_f32 v175, v134, v135
    buffer_store_dwordx4 v[172:175], v47, s[32:35], s13 offen offset:512 sc1
    v_bfe_u32 v36, v1, 2, 2
    v_lshlrev_b32 v36, 7, v36
    v_lshrrev_b32 v9, 4, v1
    v_lshl_add_u32 v36, v9, 10, v36
    v_and_b32 v9, 1, v1
    v_lshl_add_u32 v36, v9, 4, v36
    v_bfe_u32 v9, v1, 1, 1
    v_lshl_add_u32 v36, v9, 3, v36
    v_bfe_u32 v9, v1, 3, 2
    v_lshl_add_u32 v36, v9, 5, v36
    s_and_b32 s96, s9, 1
    s_lshl_b32 s97, s96, 2
    s_xor_b32 s98, s3, s97
    s_lshl_b32 s17, s98, 12
    s_lshl_b32 s96, s17, 2
    s_lshr_b32 s97, s95, 4
    s_xor_b32 s14, s96, s97
    v_add_u32 v36, s14, v36
    v_xor_b32 v37, 32, v36
    v_xor_b32 v38, 64, v36
    v_xor_b32 v39, 96, v36
    v_and_b32 v5, 7, v1
    v_lshlrev_b32 v5, 15, v5
    v_bfe_u32 v9, v1, 3, 1
    v_lshl_add_u32 v5, v9, 12, v5
    s_and_b32 s96, s11, 1
    s_lshr_b32 s97, s10, 2
    s_and_b32 s98, s10, 3
    s_lshl_b32 s99, s98, 6
    s_lshl1_add_u32 s98, s97, s99
    s_lshl_b32 s97, s98, 12
    s_lshr_b32 s99, s11, 1
    s_lshl_b32 s98, s99, 6
    s_add_u32 s99, s97, s98
    s_lshl2_add_u32 s97, s96, s99
    s_add_u32 s98, s97, 1048576
    s_add_u32 s15, s98, 1024
    v_lshlrev_b32 v152, 16, v12
    v_and_b32 v153, s6, v12
    v_lshlrev_b32 v154, 16, v13
    v_and_b32 v155, s6, v13
    v_lshlrev_b32 v156, 16, v14
    v_and_b32 v157, s6, v14
    v_lshlrev_b32 v158, 16, v15
    v_and_b32 v159, s6, v15
    v_lshlrev_b32 v160, 16, v16
    v_and_b32 v161, s6, v16
    v_lshlrev_b32 v162, 16, v17
    v_and_b32 v163, s6, v17
    v_lshlrev_b32 v164, 16, v18
    v_and_b32 v165, s6, v18
    v_lshlrev_b32 v166, 16, v19
    v_and_b32 v167, s6, v19
    s_lshl3_add_u32 s96, s21, s3
    s_lshl_b32 s97, s96, 15
    s_add_u32 s19, s97, 8388608
    s_and_b32 s96, s3, 1
    s_lshl_b32 s14, s96, 1
    s_lshr_b32 s96, s3, 1
    s_lshl_b32 s97, s96, 10
    s_add_u32 s16, s97, 159744
    v_bfe_u32 v4, v1, 4, 1
    v_bfe_u32 v9, v1, 2, 1
    v_lshl_add_u32 v4, v9, 1, v4
    v_lshrrev_b32 v7, 5, v1
    v_lshl_add_u32 v7, v7, 0, s14
    v_xor_b32 v4, v4, v7
    v_lshl_add_u32 v4, v4, 2, s16
    v_and_b32 v7, 1, v1
    v_lshlrev_b32 v7, 5, v7
    v_bfe_u32 v9, v1, 3, 2
    v_lshl_add_u32 v7, v9, 6, v7
    v_bfe_u32 v9, v1, 2, 1
    v_lshl_add_u32 v7, v9, 8, v7
    v_bfe_u32 v9, v1, 1, 1
    v_lshl_add_u32 v7, v9, 9, v7
    v_add_u32 v4, v4, v7
    s_waitcnt vmcnt(2)
    v_bitop3_b32 v6, v29, v31, s4 bitop3:0x7e
    v_cmp_ne_u32 vcc, 0, v6
    s_cbranch_vccz L_MGOK
POLL_29:
    buffer_load_dwordx4 v[28:31], v2, s[32:35], s18 offen sc1
    s_waitcnt vmcnt(0)
    v_bitop3_b32 v6, v29, v31, s4 bitop3:0x7e
    v_cmp_ne_u32 vcc, 0, v6
    s_cbranch_vccz PDONE_30
    s_add_u32 s5, s5, 1
    s_cmp_lt_u32 s5, 200000
    s_cbranch_scc1 POLL_29
PDONE_30:
L_MGOK:
    ds_write2_b32 v4, v28, v30 offset0:0 offset1:4
    s_waitcnt vmcnt(0)
    s_waitcnt lgkmcnt(0)
    s_barrier
    s_cmp_lg_u32 s3, 0
    s_cbranch_scc1 L_PD
    v_mov_b32 v6, s4
    s_mov_b32 exec_hi, 0
    s_mov_b32 exec_lo, 65535
    buffer_store_dword v6, v5, s[32:35], s15 offen sc1
    s_mov_b64 exec, -1
L_PD:
    v_mov_b32 v236, -1
    v_mov_b32 v237, -1
    v_mov_b32 v238, -1
    v_mov_b32 v239, -1
    s_mov_b64 exec, 0xffff
    buffer_store_dwordx4 v[236:239], v2, s[32:35], s86 offen sc1
    s_mov_b64 exec, -1
    s_cmp_lg_u32 s3, 5
    s_cbranch_scc1 L_NOPO
    s_lshl_b32 s96, s21, 14
    s_lshl_b32 s97, s12, 9
    s_add_u32 s98, s96, s97
    s_add_u32 s16, s98, 13631488
    v_and_b32 v240, 31, v1
    v_lshlrev_b32 v240, 4, v240
    v_lshrrev_b32 v241, 5, v1
    v_lshl_add_u32 v240, v241, 13, v240
    buffer_store_dwordx4 v[236:239], v240, s[32:35], s16 offen sc1
L_NOPO:
    s_lshl_b32 s96, s2, 12
    s_lshr_b32 s97, s17, 6
    s_add_u32 s98, s96, s97
    s_add_u32 s99, s98, 1048576
    s_add_u32 s18, s99, 1024
    ds_read_b128 v[192:195], v251 offset:12288
    ds_read_b128 v[196:199], v251 offset:13312
    ds_read_b128 v[200:203], v251 offset:14336
    ds_read_b128 v[204:207], v251 offset:15360
    v_and_b32 v8, 3, v1
    v_lshlrev_b32 v8, 2, v8
    v_lshrrev_b32 v9, 5, v1
    v_lshl_add_u32 v8, v9, 4, v8
    v_bfe_u32 v9, v1, 4, 1
    v_lshl_add_u32 v8, v9, 5, v8
    v_bfe_u32 v9, v1, 2, 2
    v_lshl_add_u32 v8, v9, 6, v8
    v_add_u32 v8, 157184, v8
    s_lshl4_add_u32 s96, s21, s12
    s_lshl_b32 s97, s96, 6
    s_add_u32 s13, s97, 14155776
    v_lshlrev_b32 v10, 1, v1
    v_add_u32 v10, 157440, v10
    v_and_b32 v11, 3, v1
    v_lshlrev_b32 v11, 7, v11
    v_lshrrev_b32 v9, 4, v1
    v_lshl_add_u32 v11, v9, 5, v11
    v_add_u32 v11, 157440, v11
    s_waitcnt lgkmcnt(0)
    s_load_dwordx2 s[24:25], s[32:33], s18 offset:0 glc
    v_pk_add_f32 v[192:193], v[192:193], v[194:195]
    v_add_f32 v28, v192, v193
    v_pk_add_f32 v[196:197], v[196:197], v[198:199]
    v_add_f32 v29, v196, v197
    v_pk_add_f32 v[200:201], v[200:201], v[202:203]
    v_add_f32 v30, v200, v201
    v_pk_add_f32 v[204:205], v[204:205], v[206:207]
    v_add_f32 v31, v204, v205
    v_cvt_pk_bf16_f32 v28, 0, v28
    v_cvt_pk_bf16_f32 v29, 0, v29
    v_cvt_pk_bf16_f32 v30, 0, v30
    v_cvt_pk_bf16_f32 v31, 0, v31
    v_add_f32 v30, 1.0, v30
    v_lshlrev_b32 v32, 16, v32
    v_cvt_pk_bf16_f32 v30, 0, v30
    ds_write_b32 v8, v31
    v_mul_f32 v192, v30, v32
    v_cvt_pk_bf16_f32 v193, 0, v192
    v_sub_f32 v194, v192, v193
    v_add_f32_dpp v192, v192, v192 quad_perm:[1,0,3,2] row_mask:0xf bank_mask:0xf
    s_nop 1
    v_add_f32_dpp v192, v192, v192 quad_perm:[2,3,0,1] row_mask:0xf bank_mask:0xf
    s_nop 1
    v_add_f32_dpp v192, v192, v192 row_half_mirror row_mask:0xf bank_mask:0xf
    s_nop 1
    v_add_f32_dpp v192, v192, v192 row_ror:8 row_mask:0xf bank_mask:0xf
    v_mov_b32 v199, v192
    s_nop 1
    v_permlane16_swap_b32 v192, v199
    v_add_f32 v192, v192, v199
    v_mov_b32 v199, v192
    s_nop 1
    v_permlane32_swap_b32 v192, v199
    v_add_f32 v192, v192, v199
    v_mov_b32_dpp v196, v193 row_shl:1 row_mask:0xf bank_mask:0xf
    v_mov_b32_dpp v197, v194 row_shl:1 row_mask:0xf bank_mask:0xf
    v_mov_b32_dpp v198, v32 row_shl:1 row_mask:0xf bank_mask:0xf
    v_cvt_pk_bf16_f32 v196, v193, v196
    v_cvt_pk_bf16_f32 v197, v194, v197
    v_cvt_pk_bf16_f32 v198, v32, v198
    v_mov_b32 v193, s4
    v_mov_b32 v194, 0
    s_cmp_lg_u32 s3, 2
    s_cbranch_scc1 L_NOUP
    s_mov_b64 exec, 1
    buffer_store_dwordx2 v[192:193], v194, s[32:35], s13 offen sc1
    s_mov_b64 exec, -1
L_NOUP:
    v_mov_b32 v199, 0x3f803f80
    s_mov_b32 exec_lo, 0x55555555
    s_mov_b32 exec_hi, 0x55555555
    ds_write_b32 v10, v199 offset:0
    ds_write_b32 v10, v196 offset:128
    ds_write_b32 v10, v197 offset:256
    ds_write_b32 v10, v198 offset:384
    s_mov_b64 exec, -1
    ds_read_b128 v[184:187], v11
    ds_read_b128 v[188:191], v11 offset:16
    v_mov_b32 v42, v29
    v_mov_b32 v43, v31
    v_mov_b32 v33, v30
    v_mov_b32_dpp v136, v28 row_newbcast:0 row_mask:0xf bank_mask:0xf
    v_mov_b32_dpp v137, v28 row_newbcast:1 row_mask:0xf bank_mask:0xf
    v_mov_b32_dpp v138, v28 row_newbcast:2 row_mask:0xf bank_mask:0xf
    v_mov_b32_dpp v139, v28 row_newbcast:3 row_mask:0xf bank_mask:0xf
    v_mov_b32_dpp v140, v28 row_newbcast:4 row_mask:0xf bank_mask:0xf
    v_mov_b32_dpp v141, v28 row_newbcast:5 row_mask:0xf bank_mask:0xf
    v_mov_b32_dpp v142, v28 row_newbcast:6 row_mask:0xf bank_mask:0xf
    v_mov_b32_dpp v143, v28 row_newbcast:7 row_mask:0xf bank_mask:0xf
    v_mov_b32_dpp v144, v28 row_newbcast:8 row_mask:0xf bank_mask:0xf
    v_mov_b32_dpp v145, v28 row_newbcast:9 row_mask:0xf bank_mask:0xf
    v_mov_b32_dpp v146, v28 row_newbcast:10 row_mask:0xf bank_mask:0xf
    v_mov_b32_dpp v147, v28 row_newbcast:11 row_mask:0xf bank_mask:0xf
    v_mov_b32_dpp v148, v28 row_newbcast:12 row_mask:0xf bank_mask:0xf
    v_mov_b32_dpp v149, v28 row_newbcast:13 row_mask:0xf bank_mask:0xf
    v_mov_b32_dpp v150, v28 row_newbcast:14 row_mask:0xf bank_mask:0xf
    v_mov_b32_dpp v151, v28 row_newbcast:15 row_mask:0xf bank_mask:0xf
    v_mov_b32 v29, v5
    s_branch SCHK_32
SPOLL_31:
    s_load_dwordx2 s[24:25], s[32:33], s18 offset:0 glc
SCHK_32:
    s_add_u32 s5, s5, 1
    s_cmp_ge_u32 s5, 200000
    s_waitcnt lgkmcnt(0)
    s_cbranch_scc1 SDONE_33
    s_cmp_lg_u32 s24, s4
    s_cbranch_scc1 SPOLL_31
    s_cmp_lg_u32 s25, s4
    s_cbranch_scc1 SPOLL_31
SDONE_33:
    s_add_u32 s20, s17, s19
    buffer_load_dwordx4 v[224:227], v2, s[32:35], s20 offen sc1
    ds_read_b64_tr_b16 v[192:193], v36
    ds_read_b64_tr_b16 v[194:195], v36 offset:512
    ds_read_b64_tr_b16 v[196:197], v37
    ds_read_b64_tr_b16 v[198:199], v37 offset:512
    ds_read_b64_tr_b16 v[200:201], v38
    ds_read_b64_tr_b16 v[202:203], v38 offset:512
    ds_read_b64_tr_b16 v[204:205], v39
    ds_read_b64_tr_b16 v[206:207], v39 offset:512
    ds_read_b64_tr_b16 v[208:209], v36 offset:4096
    ds_read_b64_tr_b16 v[210:211], v36 offset:4608
    ds_read_b64_tr_b16 v[212:213], v37 offset:4096
    ds_read_b64_tr_b16 v[214:215], v37 offset:4608
    ds_read_b64_tr_b16 v[216:217], v38 offset:4096
    ds_read_b64_tr_b16 v[218:219], v38 offset:4608
    buffer_load_dwordx4 v[228:231], v2, s[32:35], s20 offen offset:1024 sc1
    buffer_load_dwordx4 v[232:235], v2, s[32:35], s20 offen offset:2048 sc1
    buffer_load_dwordx4 v[236:239], v2, s[32:35], s20 offen offset:3072 sc1
    s_barrier
    s_xor_b32 s96, s17, 4096
    s_add_u32 s20, s96, s19
    buffer_load_dwordx4 v[240:243], v2, s[32:35], s20 offen sc1
    buffer_load_dwordx4 v[244:247], v2, s[32:35], s20 offen offset:1024 sc1
    buffer_load_dwordx4 v[44:47], v2, s[32:35], s20 offen offset:2048 sc1
    buffer_load_dwordx4 v[48:51], v2, s[32:35], s20 offen offset:3072 sc1
    s_lshl_b32 s96, s21, 10
    s_add_u32 s13, s96, 14155776
    v_and_b32 v10, 15, v1
    v_lshlrev_b32 v10, 6, v10
    s_cmp_lt_u32 s3, 4
    s_cbranch_scc1 L_G2P0
    s_setprio 1
L_G2P0:
    s_waitcnt vmcnt(7)
    s_waitcnt lgkmcnt(6)
    v_mfma_f32_16x16x32_bf16 v[120:123], v[192:195], v[224:227], 0
    ds_read_b64_tr_b16 v[220:221], v39 offset:4096
    ds_read_b64_tr_b16 v[222:223], v39 offset:4608
    v_mfma_f32_16x16x32_bf16 v[124:127], v[196:199], v[224:227], 0
    ds_read_b64_tr_b16 v[192:193], v36 offset:8192
    ds_read_b64_tr_b16 v[194:195], v36 offset:8704
    v_mfma_f32_16x16x32_bf16 v[128:131], v[200:203], v[224:227], 0
    ds_read_b64_tr_b16 v[196:197], v37 offset:8192
    ds_read_b64_tr_b16 v[198:199], v37 offset:8704
    v_mfma_f32_16x16x32_bf16 v[132:135], v[204:207], v[224:227], 0
    ds_read_b64_tr_b16 v[200:201], v38 offset:8192
    ds_read_b64_tr_b16 v[202:203], v38 offset:8704
    s_xor_b32 s96, s17, 8192
    s_add_u32 s20, s96, s19
    buffer_load_dwordx4 v[224:227], v2, s[32:35], s20 offen sc1
    s_waitcnt vmcnt(7)
    s_waitcnt lgkmcnt(6)
    v_mfma_f32_16x16x32_bf16 v[120:123], v[208:211], v[228:231], v[120:123]
    ds_read_b64_tr_b16 v[204:205], v39 offset:8192
    ds_read_b64_tr_b16 v[206:207], v39 offset:8704
    v_mfma_f32_16x16x32_bf16 v[124:127], v[212:215], v[228:231], v[124:127]
    ds_read_b64_tr_b16 v[208:209], v36 offset:12288
    ds_read_b64_tr_b16 v[210:211], v36 offset:12800
    v_xor_b32 v36, 16384, v36
    v_mfma_f32_16x16x32_bf16 v[128:131], v[216:219], v[228:231], v[128:131]
    ds_read_b64_tr_b16 v[212:213], v37 offset:12288
    ds_read_b64_tr_b16 v[214:215], v37 offset:12800
    v_xor_b32 v37, 16384, v37
    v_mfma_f32_16x16x32_bf16 v[132:135], v[220:223], v[228:231], v[132:135]
    ds_read_b64_tr_b16 v[216:217], v38 offset:12288
    ds_read_b64_tr_b16 v[218:219], v38 offset:12800
    v_xor_b32 v38, 16384, v38
    buffer_load_dwordx4 v[228:231], v2, s[32:35], s20 offen offset:1024 sc1
    s_waitcnt vmcnt(7)
    s_waitcnt lgkmcnt(6)
    v_mfma_f32_16x16x32_bf16 v[120:123], v[192:195], v[232:235], v[120:123]
    ds_read_b64_tr_b16 v[220:221], v39 offset:12288
    ds_read_b64_tr_b16 v[222:223], v39 offset:12800
    v_xor_b32 v39, 16384, v39
    v_mfma_f32_16x16x32_bf16 v[124:127], v[196:199], v[232:235], v[124:127]
    ds_read_b64_tr_b16 v[192:193], v36
    ds_read_b64_tr_b16 v[194:195], v36 offset:512
    v_mfma_f32_16x16x32_bf16 v[128:131], v[200:203], v[232:235], v[128:131]
    ds_read_b64_tr_b16 v[196:197], v37
    ds_read_b64_tr_b16 v[198:199], v37 offset:512
    v_mfma_f32_16x16x32_bf16 v[132:135], v[204:207], v[232:235], v[132:135]
    ds_read_b64_tr_b16 v[200:201], v38
    ds_read_b64_tr_b16 v[202:203], v38 offset:512
    buffer_load_dwordx4 v[232:235], v2, s[32:35], s20 offen offset:2048 sc1
    s_waitcnt vmcnt(7)
    s_waitcnt lgkmcnt(6)
    v_mfma_f32_16x16x32_bf16 v[120:123], v[208:211], v[236:239], v[120:123]
    ds_read_b64_tr_b16 v[204:205], v39
    ds_read_b64_tr_b16 v[206:207], v39 offset:512
    v_mfma_f32_16x16x32_bf16 v[124:127], v[212:215], v[236:239], v[124:127]
    ds_read_b64_tr_b16 v[208:209], v36 offset:4096
    ds_read_b64_tr_b16 v[210:211], v36 offset:4608
    v_mfma_f32_16x16x32_bf16 v[128:131], v[216:219], v[236:239], v[128:131]
    ds_read_b64_tr_b16 v[212:213], v37 offset:4096
    ds_read_b64_tr_b16 v[214:215], v37 offset:4608
    v_mfma_f32_16x16x32_bf16 v[132:135], v[220:223], v[236:239], v[132:135]
    ds_read_b64_tr_b16 v[216:217], v38 offset:4096
    ds_read_b64_tr_b16 v[218:219], v38 offset:4608
    buffer_load_dwordx4 v[236:239], v2, s[32:35], s20 offen offset:3072 sc1
    s_waitcnt vmcnt(7)
    s_waitcnt lgkmcnt(6)
    v_mfma_f32_16x16x32_bf16 v[120:123], v[192:195], v[240:243], v[120:123]
    ds_read_b64_tr_b16 v[220:221], v39 offset:4096
    ds_read_b64_tr_b16 v[222:223], v39 offset:4608
    v_mfma_f32_16x16x32_bf16 v[124:127], v[196:199], v[240:243], v[124:127]
    ds_read_b64_tr_b16 v[192:193], v36 offset:8192
    ds_read_b64_tr_b16 v[194:195], v36 offset:8704
    v_mfma_f32_16x16x32_bf16 v[128:131], v[200:203], v[240:243], v[128:131]
    ds_read_b64_tr_b16 v[196:197], v37 offset:8192
    ds_read_b64_tr_b16 v[198:199], v37 offset:8704
    v_mfma_f32_16x16x32_bf16 v[132:135], v[204:207], v[240:243], v[132:135]
    ds_read_b64_tr_b16 v[200:201], v38 offset:8192
    ds_read_b64_tr_b16 v[202:203], v38 offset:8704
    s_xor_b32 s96, s17, 12288
    s_add_u32 s20, s96, s19
    buffer_load_dwordx4 v[240:243], v2, s[32:35], s20 offen sc1
    s_waitcnt vmcnt(7)
    s_waitcnt lgkmcnt(6)
    v_mfma_f32_16x16x32_bf16 v[120:123], v[208:211], v[244:247], v[120:123]
    ds_read_b64_tr_b16 v[204:205], v39 offset:8192
    ds_read_b64_tr_b16 v[206:207], v39 offset:8704
    v_mfma_f32_16x16x32_bf16 v[124:127], v[212:215], v[244:247], v[124:127]
    ds_read_b64_tr_b16 v[208:209], v36 offset:12288
    ds_read_b64_tr_b16 v[210:211], v36 offset:12800
    v_xor_b32 v36, 49152, v36
    v_mfma_f32_16x16x32_bf16 v[128:131], v[216:219], v[244:247], v[128:131]
    ds_read_b64_tr_b16 v[212:213], v37 offset:12288
    ds_read_b64_tr_b16 v[214:215], v37 offset:12800
    v_xor_b32 v37, 49152, v37
    v_mfma_f32_16x16x32_bf16 v[132:135], v[220:223], v[244:247], v[132:135]
    ds_read_b64_tr_b16 v[216:217], v38 offset:12288
    ds_read_b64_tr_b16 v[218:219], v38 offset:12800
    v_xor_b32 v38, 49152, v38
    buffer_load_dwordx4 v[244:247], v2, s[32:35], s20 offen offset:1024 sc1
    s_waitcnt vmcnt(7)
    s_waitcnt lgkmcnt(6)
    v_mfma_f32_16x16x32_bf16 v[120:123], v[192:195], v[44:47], v[120:123]
    ds_read_b64_tr_b16 v[220:221], v39 offset:12288
    ds_read_b64_tr_b16 v[222:223], v39 offset:12800
    v_xor_b32 v39, 49152, v39
    v_mfma_f32_16x16x32_bf16 v[124:127], v[196:199], v[44:47], v[124:127]
    ds_read_b64_tr_b16 v[192:193], v36
    ds_read_b64_tr_b16 v[194:195], v36 offset:512
    v_mfma_f32_16x16x32_bf16 v[128:131], v[200:203], v[44:47], v[128:131]
    ds_read_b64_tr_b16 v[196:197], v37
    ds_read_b64_tr_b16 v[198:199], v37 offset:512
    v_mfma_f32_16x16x32_bf16 v[132:135], v[204:207], v[44:47], v[132:135]
    ds_read_b64_tr_b16 v[200:201], v38
    ds_read_b64_tr_b16 v[202:203], v38 offset:512
    buffer_load_dwordx4 v[44:47], v2, s[32:35], s20 offen offset:2048 sc1
    s_waitcnt vmcnt(7)
    s_waitcnt lgkmcnt(6)
    v_mfma_f32_16x16x32_bf16 v[120:123], v[208:211], v[48:51], v[120:123]
    ds_read_b64_tr_b16 v[204:205], v39
    ds_read_b64_tr_b16 v[206:207], v39 offset:512
    v_mfma_f32_16x16x32_bf16 v[124:127], v[212:215], v[48:51], v[124:127]
    ds_read_b64_tr_b16 v[208:209], v36 offset:4096
    ds_read_b64_tr_b16 v[210:211], v36 offset:4608
    v_mfma_f32_16x16x32_bf16 v[128:131], v[216:219], v[48:51], v[128:131]
    ds_read_b64_tr_b16 v[212:213], v37 offset:4096
    ds_read_b64_tr_b16 v[214:215], v37 offset:4608
    v_mfma_f32_16x16x32_bf16 v[132:135], v[220:223], v[48:51], v[132:135]
    ds_read_b64_tr_b16 v[216:217], v38 offset:4096
    ds_read_b64_tr_b16 v[218:219], v38 offset:4608
    buffer_load_dwordx4 v[48:51], v2, s[32:35], s20 offen offset:3072 sc1
    s_waitcnt vmcnt(7)
    s_waitcnt lgkmcnt(6)
    v_mfma_f32_16x16x32_bf16 v[120:123], v[192:195], v[224:227], v[120:123]
    ds_read_b64_tr_b16 v[220:221], v39 offset:4096
    ds_read_b64_tr_b16 v[222:223], v39 offset:4608
    v_mfma_f32_16x16x32_bf16 v[124:127], v[196:199], v[224:227], v[124:127]
    ds_read_b64_tr_b16 v[192:193], v36 offset:8192
    ds_read_b64_tr_b16 v[194:195], v36 offset:8704
    v_mfma_f32_16x16x32_bf16 v[128:131], v[200:203], v[224:227], v[128:131]
    ds_read_b64_tr_b16 v[196:197], v37 offset:8192
    ds_read_b64_tr_b16 v[198:199], v37 offset:8704
    v_mfma_f32_16x16x32_bf16 v[132:135], v[204:207], v[224:227], v[132:135]
    ds_read_b64_tr_b16 v[200:201], v38 offset:8192
    ds_read_b64_tr_b16 v[202:203], v38 offset:8704
    s_xor_b32 s96, s17, 16384
    s_add_u32 s20, s96, s19
    buffer_load_dwordx4 v[224:227], v2, s[32:35], s20 offen sc1
    s_waitcnt vmcnt(7)
    s_waitcnt lgkmcnt(6)
    v_mfma_f32_16x16x32_bf16 v[120:123], v[208:211], v[228:231], v[120:123]
    ds_read_b64_tr_b16 v[204:205], v39 offset:8192
    ds_read_b64_tr_b16 v[206:207], v39 offset:8704
    v_mfma_f32_16x16x32_bf16 v[124:127], v[212:215], v[228:231], v[124:127]
    ds_read_b64_tr_b16 v[208:209], v36 offset:12288
    ds_read_b64_tr_b16 v[210:211], v36 offset:12800
    v_xor_b32 v36, 16384, v36
    v_mfma_f32_16x16x32_bf16 v[128:131], v[216:219], v[228:231], v[128:131]
    ds_read_b64_tr_b16 v[212:213], v37 offset:12288
    ds_read_b64_tr_b16 v[214:215], v37 offset:12800
    v_xor_b32 v37, 16384, v37
    v_mfma_f32_16x16x32_bf16 v[132:135], v[220:223], v[228:231], v[132:135]
    ds_read_b64_tr_b16 v[216:217], v38 offset:12288
    ds_read_b64_tr_b16 v[218:219], v38 offset:12800
    v_xor_b32 v38, 16384, v38
    buffer_load_dwordx4 v[228:231], v2, s[32:35], s20 offen offset:1024 sc1
    s_waitcnt vmcnt(7)
    s_waitcnt lgkmcnt(6)
    v_mfma_f32_16x16x32_bf16 v[120:123], v[192:195], v[232:235], v[120:123]
    ds_read_b64_tr_b16 v[220:221], v39 offset:12288
    ds_read_b64_tr_b16 v[222:223], v39 offset:12800
    v_xor_b32 v39, 16384, v39
    v_mfma_f32_16x16x32_bf16 v[124:127], v[196:199], v[232:235], v[124:127]
    ds_read_b64_tr_b16 v[192:193], v36
    ds_read_b64_tr_b16 v[194:195], v36 offset:512
    v_mfma_f32_16x16x32_bf16 v[128:131], v[200:203], v[232:235], v[128:131]
    ds_read_b64_tr_b16 v[196:197], v37
    ds_read_b64_tr_b16 v[198:199], v37 offset:512
    v_mfma_f32_16x16x32_bf16 v[132:135], v[204:207], v[232:235], v[132:135]
    ds_read_b64_tr_b16 v[200:201], v38
    ds_read_b64_tr_b16 v[202:203], v38 offset:512
    buffer_load_dwordx4 v[232:235], v2, s[32:35], s20 offen offset:2048 sc1
    s_waitcnt vmcnt(7)
    s_waitcnt lgkmcnt(6)
    v_mfma_f32_16x16x32_bf16 v[120:123], v[208:211], v[236:239], v[120:123]
    ds_read_b64_tr_b16 v[204:205], v39
    ds_read_b64_tr_b16 v[206:207], v39 offset:512
    v_mfma_f32_16x16x32_bf16 v[124:127], v[212:215], v[236:239], v[124:127]
    ds_read_b64_tr_b16 v[208:209], v36 offset:4096
    ds_read_b64_tr_b16 v[210:211], v36 offset:4608
    v_mfma_f32_16x16x32_bf16 v[128:131], v[216:219], v[236:239], v[128:131]
    ds_read_b64_tr_b16 v[212:213], v37 offset:4096
    ds_read_b64_tr_b16 v[214:215], v37 offset:4608
    v_mfma_f32_16x16x32_bf16 v[132:135], v[220:223], v[236:239], v[132:135]
    ds_read_b64_tr_b16 v[216:217], v38 offset:4096
    ds_read_b64_tr_b16 v[218:219], v38 offset:4608
    buffer_load_dwordx4 v[236:239], v2, s[32:35], s20 offen offset:3072 sc1
    s_waitcnt vmcnt(7)
    s_waitcnt lgkmcnt(6)
    v_mfma_f32_16x16x32_bf16 v[120:123], v[192:195], v[240:243], v[120:123]
    ds_read_b64_tr_b16 v[220:221], v39 offset:4096
    ds_read_b64_tr_b16 v[222:223], v39 offset:4608
    v_mfma_f32_16x16x32_bf16 v[124:127], v[196:199], v[240:243], v[124:127]
    ds_read_b64_tr_b16 v[192:193], v36 offset:8192
    ds_read_b64_tr_b16 v[194:195], v36 offset:8704
    v_mfma_f32_16x16x32_bf16 v[128:131], v[200:203], v[240:243], v[128:131]
    ds_read_b64_tr_b16 v[196:197], v37 offset:8192
    ds_read_b64_tr_b16 v[198:199], v37 offset:8704
    v_mfma_f32_16x16x32_bf16 v[132:135], v[204:207], v[240:243], v[132:135]
    ds_read_b64_tr_b16 v[200:201], v38 offset:8192
    ds_read_b64_tr_b16 v[202:203], v38 offset:8704
    s_xor_b32 s96, s17, 20480
    s_add_u32 s20, s96, s19
    buffer_load_dwordx4 v[240:243], v2, s[32:35], s20 offen sc1
    s_waitcnt vmcnt(7)
    s_waitcnt lgkmcnt(6)
    v_mfma_f32_16x16x32_bf16 v[120:123], v[208:211], v[244:247], v[120:123]
    ds_read_b64_tr_b16 v[204:205], v39 offset:8192
    ds_read_b64_tr_b16 v[206:207], v39 offset:8704
    v_mfma_f32_16x16x32_bf16 v[124:127], v[212:215], v[244:247], v[124:127]
    ds_read_b64_tr_b16 v[208:209], v36 offset:12288
    ds_read_b64_tr_b16 v[210:211], v36 offset:12800
    v_xor_b32 v36, 114688, v36
    v_mfma_f32_16x16x32_bf16 v[128:131], v[216:219], v[244:247], v[128:131]
    ds_read_b64_tr_b16 v[212:213], v37 offset:12288
    ds_read_b64_tr_b16 v[214:215], v37 offset:12800
    v_xor_b32 v37, 114688, v37
    v_mfma_f32_16x16x32_bf16 v[132:135], v[220:223], v[244:247], v[132:135]
    ds_read_b64_tr_b16 v[216:217], v38 offset:12288
    ds_read_b64_tr_b16 v[218:219], v38 offset:12800
    v_xor_b32 v38, 114688, v38
    buffer_load_dwordx4 v[244:247], v2, s[32:35], s20 offen offset:1024 sc1
    s_waitcnt vmcnt(7)
    s_waitcnt lgkmcnt(6)
    v_mfma_f32_16x16x32_bf16 v[120:123], v[192:195], v[44:47], v[120:123]
    ds_read_b64_tr_b16 v[220:221], v39 offset:12288
    ds_read_b64_tr_b16 v[222:223], v39 offset:12800
    v_xor_b32 v39, 114688, v39
    v_mfma_f32_16x16x32_bf16 v[124:127], v[196:199], v[44:47], v[124:127]
    ds_read_b64_tr_b16 v[192:193], v36
    ds_read_b64_tr_b16 v[194:195], v36 offset:512
L_PAD8:
    s_cbranch_execz L_RET8
    v_mfma_f32_16x16x32_bf16 v[128:131], v[200:203], v[44:47], v[128:131]
    ds_read_b64_tr_b16 v[196:197], v37
    ds_read_b64_tr_b16 v[198:199], v37 offset:512
    v_mfma_f32_16x16x32_bf16 v[132:135], v[204:207], v[44:47], v[132:135]
    ds_read_b64_tr_b16 v[200:201], v38
    ds_read_b64_tr_b16 v[202:203], v38 offset:512
    buffer_load_dwordx4 v[44:47], v2, s[32:35], s20 offen offset:2048 sc1
    s_waitcnt vmcnt(7)
    s_waitcnt lgkmcnt(6)
    v_mfma_f32_16x16x32_bf16 v[120:123], v[208:211], v[48:51], v[120:123]
    ds_read_b64_tr_b16 v[204:205], v39
    ds_read_b64_tr_b16 v[206:207], v39 offset:512
    v_mfma_f32_16x16x32_bf16 v[124:127], v[212:215], v[48:51], v[124:127]
    ds_read_b64_tr_b16 v[208:209], v36 offset:4096
    ds_read_b64_tr_b16 v[210:211], v36 offset:4608
    v_mfma_f32_16x16x32_bf16 v[128:131], v[216:219], v[48:51], v[128:131]
    ds_read_b64_tr_b16 v[212:213], v37 offset:4096
    ds_read_b64_tr_b16 v[214:215], v37 offset:4608
    v_mfma_f32_16x16x32_bf16 v[132:135], v[220:223], v[48:51], v[132:135]
    ds_read_b64_tr_b16 v[216:217], v38 offset:4096
    ds_read_b64_tr_b16 v[218:219], v38 offset:4608
    buffer_load_dwordx4 v[48:51], v2, s[32:35], s20 offen offset:3072 sc1
    s_waitcnt vmcnt(7)
    s_waitcnt lgkmcnt(6)
    v_mfma_f32_16x16x32_bf16 v[120:123], v[192:195], v[224:227], v[120:123]
    ds_read_b64_tr_b16 v[220:221], v39 offset:4096
    ds_read_b64_tr_b16 v[222:223], v39 offset:4608
    v_mfma_f32_16x16x32_bf16 v[124:127], v[196:199], v[224:227], v[124:127]
    ds_read_b64_tr_b16 v[192:193], v36 offset:8192
    ds_read_b64_tr_b16 v[194:195], v36 offset:8704
    v_mfma_f32_16x16x32_bf16 v[128:131], v[200:203], v[224:227], v[128:131]
    ds_read_b64_tr_b16 v[196:197], v37 offset:8192
    ds_read_b64_tr_b16 v[198:199], v37 offset:8704
    v_mfma_f32_16x16x32_bf16 v[132:135], v[204:207], v[224:227], v[132:135]
    ds_read_b64_tr_b16 v[200:201], v38 offset:8192
    ds_read_b64_tr_b16 v[202:203], v38 offset:8704
    s_xor_b32 s96, s17, 24576
    s_add_u32 s20, s96, s19
    buffer_load_dwordx4 v[224:227], v2, s[32:35], s20 offen sc1
    s_waitcnt vmcnt(7)
    s_waitcnt lgkmcnt(6)
    v_mfma_f32_16x16x32_bf16 v[120:123], v[208:211], v[228:231], v[120:123]
    ds_read_b64_tr_b16 v[204:205], v39 offset:8192
    ds_read_b64_tr_b16 v[206:207], v39 offset:8704
    v_mfma_f32_16x16x32_bf16 v[124:127], v[212:215], v[228:231], v[124:127]
    ds_read_b64_tr_b16 v[208:209], v36 offset:12288
    ds_read_b64_tr_b16 v[210:211], v36 offset:12800
    v_xor_b32 v36, 16384, v36
    v_mfma_f32_16x16x32_bf16 v[128:131], v[216:219], v[228:231], v[128:131]
    ds_read_b64_tr_b16 v[212:213], v37 offset:12288
    ds_read_b64_tr_b16 v[214:215], v37 offset:12800
    v_xor_b32 v37, 16384, v37
    v_mfma_f32_16x16x32_bf16 v[132:135], v[220:223], v[228:231], v[132:135]
    ds_read_b64_tr_b16 v[216:217], v38 offset:12288
    ds_read_b64_tr_b16 v[218:219], v38 offset:12800
    v_xor_b32 v38, 16384, v38
    buffer_load_dwordx4 v[228:231], v2, s[32:35], s20 offen offset:1024 sc1
    s_waitcnt vmcnt(7)
    s_waitcnt lgkmcnt(6)
    v_mfma_f32_16x16x32_bf16 v[120:123], v[192:195], v[232:235], v[120:123]
    ds_read_b64_tr_b16 v[220:221], v39 offset:12288
    ds_read_b64_tr_b16 v[222:223], v39 offset:12800
    v_xor_b32 v39, 16384, v39
    v_mfma_f32_16x16x32_bf16 v[124:127], v[196:199], v[232:235], v[124:127]
    ds_read_b64_tr_b16 v[192:193], v36
    ds_read_b64_tr_b16 v[194:195], v36 offset:512
    v_mfma_f32_16x16x32_bf16 v[128:131], v[200:203], v[232:235], v[128:131]
    ds_read_b64_tr_b16 v[196:197], v37
    ds_read_b64_tr_b16 v[198:199], v37 offset:512
    v_mfma_f32_16x16x32_bf16 v[132:135], v[204:207], v[232:235], v[132:135]
    ds_read_b64_tr_b16 v[200:201], v38
    ds_read_b64_tr_b16 v[202:203], v38 offset:512
    buffer_load_dwordx4 v[232:235], v2, s[32:35], s20 offen offset:2048 sc1
    s_waitcnt vmcnt(7)
    s_waitcnt lgkmcnt(6)
    v_mfma_f32_16x16x32_bf16 v[120:123], v[208:211], v[236:239], v[120:123]
    ds_read_b64_tr_b16 v[204:205], v39
    ds_read_b64_tr_b16 v[206:207], v39 offset:512
    v_mfma_f32_16x16x32_bf16 v[124:127], v[212:215], v[236:239], v[124:127]
    ds_read_b64_tr_b16 v[208:209], v36 offset:4096
    ds_read_b64_tr_b16 v[210:211], v36 offset:4608
    v_mfma_f32_16x16x32_bf16 v[128:131], v[216:219], v[236:239], v[128:131]
    ds_read_b64_tr_b16 v[212:213], v37 offset:4096
    ds_read_b64_tr_b16 v[214:215], v37 offset:4608
    v_mfma_f32_16x16x32_bf16 v[132:135], v[220:223], v[236:239], v[132:135]
    ds_read_b64_tr_b16 v[216:217], v38 offset:4096
    ds_read_b64_tr_b16 v[218:219], v38 offset:4608
    buffer_load_dwordx4 v[236:239], v2, s[32:35], s20 offen offset:3072 sc1
    s_waitcnt vmcnt(7)
    s_waitcnt lgkmcnt(6)
    v_mfma_f32_16x16x32_bf16 v[120:123], v[192:195], v[240:243], v[120:123]
    ds_read_b64_tr_b16 v[220:221], v39 offset:4096
    ds_read_b64_tr_b16 v[222:223], v39 offset:4608
    v_mfma_f32_16x16x32_bf16 v[124:127], v[196:199], v[240:243], v[124:127]
    ds_read_b64_tr_b16 v[192:193], v36 offset:8192
    ds_read_b64_tr_b16 v[194:195], v36 offset:8704
    v_mfma_f32_16x16x32_bf16 v[128:131], v[200:203], v[240:243], v[128:131]
    ds_read_b64_tr_b16 v[196:197], v37 offset:8192
    ds_read_b64_tr_b16 v[198:199], v37 offset:8704
    v_mfma_f32_16x16x32_bf16 v[132:135], v[204:207], v[240:243], v[132:135]
    ds_read_b64_tr_b16 v[200:201], v38 offset:8192
    ds_read_b64_tr_b16 v[202:203], v38 offset:8704
    s_xor_b32 s96, s17, 28672
    s_add_u32 s20, s96, s19
    buffer_load_dwordx4 v[240:243], v2, s[32:35], s20 offen sc1
    s_waitcnt vmcnt(7)
    s_waitcnt lgkmcnt(6)
    v_mfma_f32_16x16x32_bf16 v[120:123], v[208:211], v[244:247], v[120:123]
    ds_read_b64_tr_b16 v[204:205], v39 offset:8192
    ds_read_b64_tr_b16 v[206:207], v39 offset:8704
    v_mfma_f32_16x16x32_bf16 v[124:127], v[212:215], v[244:247], v[124:127]
    ds_read_b64_tr_b16 v[208:209], v36 offset:12288
    ds_read_b64_tr_b16 v[210:211], v36 offset:12800
    v_xor_b32 v36, 49152, v36
    v_mfma_f32_16x16x32_bf16 v[128:131], v[216:219], v[244:247], v[128:131]
    ds_read_b64_tr_b16 v[212:213], v37 offset:12288
    ds_read_b64_tr_b16 v[214:215], v37 offset:12800
    v_xor_b32 v37, 49152, v37
    v_mfma_f32_16x16x32_bf16 v[132:135], v[220:223], v[244:247], v[132:135]
    ds_read_b64_tr_b16 v[216:217], v38 offset:12288
    ds_read_b64_tr_b16 v[218:219], v38 offset:12800
    v_xor_b32 v38, 49152, v38
    buffer_load_dwordx4 v[244:247], v2, s[32:35], s20 offen offset:1024 sc1
    s_cmp_lt_u32 s3, 4
    s_cbranch_scc1 L_G2P22
    s_setprio 0
L_G2P22:
    s_waitcnt vmcnt(7)
    s_waitcnt lgkmcnt(6)
    v_mfma_f32_16x16x32_bf16 v[120:123], v[192:195], v[44:47], v[120:123]
    ds_read_b64_tr_b16 v[220:221], v39 offset:12288
    ds_read_b64_tr_b16 v[222:223], v39 offset:12800
    v_xor_b32 v39, 49152, v39
    v_mfma_f32_16x16x32_bf16 v[124:127], v[196:199], v[44:47], v[124:127]
    ds_read_b64_tr_b16 v[192:193], v36
    ds_read_b64_tr_b16 v[194:195], v36 offset:512
    v_mfma_f32_16x16x32_bf16 v[128:131], v[200:203], v[44:47], v[128:131]
    ds_read_b64_tr_b16 v[196:197], v37
    ds_read_b64_tr_b16 v[198:199], v37 offset:512
    v_mfma_f32_16x16x32_bf16 v[132:135], v[204:207], v[44:47], v[132:135]
    ds_read_b64_tr_b16 v[200:201], v38
    ds_read_b64_tr_b16 v[202:203], v38 offset:512
    buffer_load_dwordx4 v[44:47], v2, s[32:35], s20 offen offset:2048 sc1
    s_waitcnt vmcnt(7)
    s_waitcnt lgkmcnt(6)
    v_mfma_f32_16x16x32_bf16 v[120:123], v[208:211], v[48:51], v[120:123]
    ds_read_b64_tr_b16 v[204:205], v39
    ds_read_b64_tr_b16 v[206:207], v39 offset:512
    v_mfma_f32_16x16x32_bf16 v[124:127], v[212:215], v[48:51], v[124:127]
    ds_read_b64_tr_b16 v[208:209], v36 offset:4096
    ds_read_b64_tr_b16 v[210:211], v36 offset:4608
    v_mfma_f32_16x16x32_bf16 v[128:131], v[216:219], v[48:51], v[128:131]
    ds_read_b64_tr_b16 v[212:213], v37 offset:4096
    ds_read_b64_tr_b16 v[214:215], v37 offset:4608
    v_mfma_f32_16x16x32_bf16 v[132:135], v[220:223], v[48:51], v[132:135]
    ds_read_b64_tr_b16 v[216:217], v38 offset:4096
    ds_read_b64_tr_b16 v[218:219], v38 offset:4608
    buffer_load_dwordx4 v[48:51], v2, s[32:35], s20 offen offset:3072 sc1
    buffer_load_dwordx2 v[40:41], v10, s[32:35], s13 offen sc1
    s_waitcnt vmcnt(8)
    s_waitcnt lgkmcnt(6)
    v_mfma_f32_16x16x32_bf16 v[120:123], v[192:195], v[224:227], v[120:123]
    ds_read_b64_tr_b16 v[220:221], v39 offset:4096
    ds_read_b64_tr_b16 v[222:223], v39 offset:4608
    v_mfma_f32_16x16x32_bf16 v[124:127], v[196:199], v[224:227], v[124:127]
    ds_read_b64_tr_b16 v[192:193], v36 offset:8192
    ds_read_b64_tr_b16 v[194:195], v36 offset:8704
    v_mfma_f32_16x16x32_bf16 v[128:131], v[200:203], v[224:227], v[128:131]
    ds_read_b64_tr_b16 v[196:197], v37 offset:8192
    ds_read_b64_tr_b16 v[198:199], v37 offset:8704
    v_mfma_f32_16x16x32_bf16 v[132:135], v[204:207], v[224:227], v[132:135]
    ds_read_b64_tr_b16 v[200:201], v38 offset:8192
    ds_read_b64_tr_b16 v[202:203], v38 offset:8704
    s_waitcnt vmcnt(7)
    s_waitcnt lgkmcnt(6)
    v_mfma_f32_16x16x32_bf16 v[120:123], v[208:211], v[228:231], v[120:123]
    ds_read_b64_tr_b16 v[204:205], v39 offset:8192
    ds_read_b64_tr_b16 v[206:207], v39 offset:8704
    v_mfma_f32_16x16x32_bf16 v[124:127], v[212:215], v[228:231], v[124:127]
    ds_read_b64_tr_b16 v[208:209], v36 offset:12288
    ds_read_b64_tr_b16 v[210:211], v36 offset:12800
    v_xor_b32 v36, 16384, v36
    v_mfma_f32_16x16x32_bf16 v[128:131], v[216:219], v[228:231], v[128:131]
    ds_read_b64_tr_b16 v[212:213], v37 offset:12288
    ds_read_b64_tr_b16 v[214:215], v37 offset:12800
    v_xor_b32 v37, 16384, v37
    v_mfma_f32_16x16x32_bf16 v[132:135], v[220:223], v[228:231], v[132:135]
    ds_read_b64_tr_b16 v[216:217], v38 offset:12288
    ds_read_b64_tr_b16 v[218:219], v38 offset:12800
    v_xor_b32 v38, 16384, v38
    s_waitcnt vmcnt(6)
    s_waitcnt lgkmcnt(6)
    v_mfma_f32_16x16x32_bf16 v[120:123], v[192:195], v[232:235], v[120:123]
    ds_read_b64_tr_b16 v[220:221], v39 offset:12288
    ds_read_b64_tr_b16 v[222:223], v39 offset:12800
    v_xor_b32 v39, 16384, v39
    v_mfma_f32_16x16x32_bf16 v[124:127], v[196:199], v[232:235], v[124:127]
    ds_read_b64_tr_b16 v[192:193], v36
    ds_read_b64_tr_b16 v[194:195], v36 offset:512
    v_mfma_f32_16x16x32_bf16 v[128:131], v[200:203], v[232:235], v[128:131]
    ds_read_b64_tr_b16 v[196:197], v37
    ds_read_b64_tr_b16 v[198:199], v37 offset:512
    v_mfma_f32_16x16x32_bf16 v[132:135], v[204:207], v[232:235], v[132:135]
    ds_read_b64_tr_b16 v[200:201], v38
    ds_read_b64_tr_b16 v[202:203], v38 offset:512
    s_waitcnt vmcnt(5)
    s_waitcnt lgkmcnt(6)
    v_mfma_f32_16x16x32_bf16 v[120:123], v[208:211], v[236:239], v[120:123]
    ds_read_b64_tr_b16 v[204:205], v39
    ds_read_b64_tr_b16 v[206:207], v39 offset:512
    v_mfma_f32_16x16x32_bf16 v[124:127], v[212:215], v[236:239], v[124:127]
    ds_read_b64_tr_b16 v[208:209], v36 offset:4096
    ds_read_b64_tr_b16 v[210:211], v36 offset:4608
    v_mfma_f32_16x16x32_bf16 v[128:131], v[216:219], v[236:239], v[128:131]
    ds_read_b64_tr_b16 v[212:213], v37 offset:4096
    ds_read_b64_tr_b16 v[214:215], v37 offset:4608
    v_mfma_f32_16x16x32_bf16 v[132:135], v[220:223], v[236:239], v[132:135]
    ds_read_b64_tr_b16 v[216:217], v38 offset:4096
    ds_read_b64_tr_b16 v[218:219], v38 offset:4608
    s_add_u32 s82, s80, 114688
    buffer_load_dwordx4 v[72:75], v27, s[52:55], s82 offen nt
    s_add_u32 s82, s80, 172032
    buffer_load_dwordx4 v[76:79], v27, s[52:55], s82 offen nt
    s_mov_b32 s82, s80
    buffer_load_dwordx4 v[80:83], v27, s[56:59], s82 offen nt
    s_waitcnt vmcnt(7)
    s_waitcnt lgkmcnt(6)
    v_mfma_f32_16x16x32_bf16 v[120:123], v[192:195], v[240:243], v[120:123]
    ds_read_b64_tr_b16 v[220:221], v39 offset:4096
    ds_read_b64_tr_b16 v[222:223], v39 offset:4608
    v_mfma_f32_16x16x32_bf16 v[124:127], v[196:199], v[240:243], v[124:127]
    ds_read_b64_tr_b16 v[192:193], v36 offset:8192
    ds_read_b64_tr_b16 v[194:195], v36 offset:8704
    v_mfma_f32_16x16x32_bf16 v[128:131], v[200:203], v[240:243], v[128:131]
    ds_read_b64_tr_b16 v[196:197], v37 offset:8192
    ds_read_b64_tr_b16 v[198:199], v37 offset:8704
    v_mfma_f32_16x16x32_bf16 v[132:135], v[204:207], v[240:243], v[132:135]
    ds_read_b64_tr_b16 v[200:201], v38 offset:8192
    ds_read_b64_tr_b16 v[202:203], v38 offset:8704
    s_waitcnt vmcnt(6)
    s_waitcnt lgkmcnt(6)
    v_mfma_f32_16x16x32_bf16 v[120:123], v[208:211], v[244:247], v[120:123]
    ds_read_b64_tr_b16 v[204:205], v39 offset:8192
    ds_read_b64_tr_b16 v[206:207], v39 offset:8704
    v_mfma_f32_16x16x32_bf16 v[124:127], v[212:215], v[244:247], v[124:127]
    ds_read_b64_tr_b16 v[208:209], v36 offset:12288
    ds_read_b64_tr_b16 v[210:211], v36 offset:12800
    v_mfma_f32_16x16x32_bf16 v[128:131], v[216:219], v[244:247], v[128:131]
    ds_read_b64_tr_b16 v[212:213], v37 offset:12288
    ds_read_b64_tr_b16 v[214:215], v37 offset:12800
    v_mfma_f32_16x16x32_bf16 v[132:135], v[220:223], v[244:247], v[132:135]
    ds_read_b64_tr_b16 v[216:217], v38 offset:12288
    ds_read_b64_tr_b16 v[218:219], v38 offset:12800
    s_waitcnt vmcnt(5)
    s_waitcnt lgkmcnt(6)
    v_mfma_f32_16x16x32_bf16 v[120:123], v[192:195], v[44:47], v[120:123]
    ds_read_b64_tr_b16 v[220:221], v39 offset:12288
    ds_read_b64_tr_b16 v[222:223], v39 offset:12800
    v_mfma_f32_16x16x32_bf16 v[124:127], v[196:199], v[44:47], v[124:127]
    v_mfma_f32_16x16x32_bf16 v[128:131], v[200:203], v[44:47], v[128:131]
    v_mfma_f32_16x16x32_bf16 v[132:135], v[204:207], v[44:47], v[132:135]
    s_waitcnt vmcnt(4)
    s_waitcnt lgkmcnt(0)
    v_mfma_f32_16x16x32_bf16 v[120:123], v[208:211], v[48:51], v[120:123]
    v_mfma_f32_16x16x32_bf16 v[124:127], v[212:215], v[48:51], v[124:127]
    v_mfma_f32_16x16x32_bf16 v[128:131], v[216:219], v[48:51], v[128:131]
    v_mfma_f32_16x16x32_bf16 v[132:135], v[220:223], v[48:51], v[132:135]
    s_nop 4
    v_cvt_pk_bf16_f32 v120, 0, v120
    v_cvt_pk_bf16_f32 v121, 0, v121
    v_cvt_pk_bf16_f32 v122, 0, v122
    v_cvt_pk_bf16_f32 v123, 0, v123
    v_cvt_pk_bf16_f32 v124, 0, v124
    v_cvt_pk_bf16_f32 v125, 0, v125
    v_cvt_pk_bf16_f32 v126, 0, v126
    v_cvt_pk_bf16_f32 v127, 0, v127
    v_pk_mul_f32 v[120:121], v[120:121], v[136:137]
    v_pk_mul_f32 v[122:123], v[122:123], v[138:139]
    v_pk_mul_f32 v[124:125], v[124:125], v[140:141]
    v_pk_mul_f32 v[126:127], v[126:127], v[142:143]
    v_cvt_pk_bf16_f32 v120, 0, v120
    v_cvt_pk_bf16_f32 v121, 0, v121
    v_cvt_pk_bf16_f32 v122, 0, v122
    v_cvt_pk_bf16_f32 v123, 0, v123
    v_cvt_pk_bf16_f32 v124, 0, v124
    v_cvt_pk_bf16_f32 v125, 0, v125
    v_cvt_pk_bf16_f32 v126, 0, v126
    v_cvt_pk_bf16_f32 v127, 0, v127
    v_pk_add_f32 v[120:121], v[120:121], v[152:153]
    v_pk_add_f32 v[122:123], v[122:123], v[154:155]
    v_pk_add_f32 v[124:125], v[124:125], v[156:157]
    v_pk_add_f32 v[126:127], v[126:127], v[158:159]
    v_cvt_pk_bf16_f32 v12, v120, v121
    v_cvt_pk_bf16_f32 v13, v122, v123
    v_cvt_pk_bf16_f32 v14, v124, v125
    v_cvt_pk_bf16_f32 v15, v126, v127
    v_dot2_f32_bf16 v4, v12, v12, 0
    v_dot2_f32_bf16 v5, v13, v13, 0
    v_dot2_f32_bf16 v4, v14, v14, v4
    v_dot2_f32_bf16 v5, v15, v15, v5
    v_mfma_f32_16x16x32_bf16 v[240:243], v[184:187], v[12:15], 0
    v_cvt_pk_bf16_f32 v128, 0, v128
    v_cvt_pk_bf16_f32 v129, 0, v129
    v_cvt_pk_bf16_f32 v130, 0, v130
    v_cvt_pk_bf16_f32 v131, 0, v131
    v_cvt_pk_bf16_f32 v132, 0, v132
    v_cvt_pk_bf16_f32 v133, 0, v133
    v_cvt_pk_bf16_f32 v134, 0, v134
    v_cvt_pk_bf16_f32 v135, 0, v135
    v_pk_mul_f32 v[128:129], v[128:129], v[144:145]
    v_pk_mul_f32 v[130:131], v[130:131], v[146:147]
    v_pk_mul_f32 v[132:133], v[132:133], v[148:149]
    v_pk_mul_f32 v[134:135], v[134:135], v[150:151]
    v_cvt_pk_bf16_f32 v128, 0, v128
    v_cvt_pk_bf16_f32 v129, 0, v129
    v_cvt_pk_bf16_f32 v130, 0, v130
    v_cvt_pk_bf16_f32 v131, 0, v131
    v_cvt_pk_bf16_f32 v132, 0, v132
    v_cvt_pk_bf16_f32 v133, 0, v133
    v_cvt_pk_bf16_f32 v134, 0, v134
    v_cvt_pk_bf16_f32 v135, 0, v135
    v_pk_add_f32 v[128:129], v[128:129], v[160:161]
    v_pk_add_f32 v[130:131], v[130:131], v[162:163]
    v_pk_add_f32 v[132:133], v[132:133], v[164:165]
    v_pk_add_f32 v[134:135], v[134:135], v[166:167]
    v_cvt_pk_bf16_f32 v16, v128, v129
    v_cvt_pk_bf16_f32 v17, v130, v131
    v_cvt_pk_bf16_f32 v18, v132, v133
    v_cvt_pk_bf16_f32 v19, v134, v135
    v_dot2_f32_bf16 v4, v16, v16, v4
    v_dot2_f32_bf16 v5, v17, v17, v5
    v_dot2_f32_bf16 v4, v18, v18, v4
    v_dot2_f32_bf16 v5, v19, v19, v5
    v_mfma_f32_16x16x32_bf16 v[240:243], v[188:191], v[16:19], v[240:243]
    s_nop 1
    v_add_f32 v4, v4, v5
    v_mov_b32 v5, v4
    s_nop 1
    v_permlane32_swap_b32 v4, v5
    v_add_f32 v4, v4, v5
    v_mov_b32 v5, v4
    s_nop 1
    v_permlane16_swap_b32 v4, v5
    v_add_f32 v243, v4, v5
    s_mov_b64 exec, 0xffff
    buffer_store_dwordx4 v[240:243], v2, s[32:35], s86 offen sc1
    s_mov_b64 exec, -1
    s_barrier
    s_cmp_lg_u32 s3, 0
    s_cbranch_scc1 L_PE
    v_mov_b32 v6, s4
    s_mov_b32 exec_hi, 0
    s_mov_b32 exec_lo, 65535
    buffer_store_dword v6, v29, s[32:35], s87 offen sc1
    s_mov_b64 exec, -1
L_PE:
    s_add_u32 s82, s80, 57344
    s_lshl2_add_u32 m0, s83, 33792
    s_nop 0
    buffer_load_dwordx4 v27, s[56:59], s82 offen nt lds
    s_add_u32 s82, s80, 114688
    s_lshl2_add_u32 m0, s83, 34816
    s_nop 0
    buffer_load_dwordx4 v27, s[56:59], s82 offen nt lds
    s_lshl_b32 s15, s3, 12
    v_add_u32 v4, s15, v2
    v_add_u32 v7, 65536, v4
    s_waitcnt vmcnt(6)
    v_cmp_ne_u32 vcc, s4, v41
    s_cbranch_vccz L_UPOK
POLL_34:
    buffer_load_dwordx2 v[40:41], v10, s[32:35], s13 offen sc1
    s_waitcnt vmcnt(0)
    v_cmp_ne_u32 vcc, s4, v41
    s_cbranch_vccz PDONE_35
    s_add_u32 s5, s5, 1
    s_cmp_lt_u32 s5, 200000
    s_cbranch_scc1 POLL_34
PDONE_35:
L_UPOK:
    s_lshl3_add_u32 s96, s21, s3
    s_lshl_b32 s97, s96, 12
    s_add_u32 s14, s97, 12582912
    s_load_dwordx2 s[24:25], s[32:33], s92 offset:1536 glc
    v_add_f32_dpp v40, v40, v40 quad_perm:[1,0,3,2] row_mask:0xf bank_mask:0xf
    s_nop 1
    v_add_f32_dpp v40, v40, v40 quad_perm:[2,3,0,1] row_mask:0xf bank_mask:0xf
    s_nop 1
    v_add_f32_dpp v40, v40, v40 row_half_mirror row_mask:0xf bank_mask:0xf
    s_nop 1
    v_add_f32_dpp v40, v40, v40 row_mirror row_mask:0xf bank_mask:0xf
    v_lshlrev_b32 v152, 16, v12
    v_and_b32 v153, s6, v12
    v_lshlrev_b32 v154, 16, v13
    v_and_b32 v155, s6, v13
    v_lshlrev_b32 v156, 16, v14
    v_and_b32 v157, s6, v14
    v_lshlrev_b32 v158, 16, v15
    v_and_b32 v159, s6, v15
    v_lshlrev_b32 v160, 16, v16
    v_and_b32 v161, s6, v16
    v_lshlrev_b32 v162, 16, v17
    v_and_b32 v163, s6, v17
    v_lshlrev_b32 v164, 16, v18
    v_and_b32 v165, s6, v18
    v_lshlrev_b32 v166, 16, v19
    v_and_b32 v167, s6, v19
    s_lshl_b32 s96, s3, 9
    s_lshl1_add_u32 s15, s21, s96
    v_and_b32 v29, 15, v1
    v_lshl_add_u32 v29, v29, 5, s15
    v_xor_b32 v5, 0x4000, v4
    v_xor_b32 v8, 0x4000, v7
    s_waitcnt vmcnt(3)
    ds_write_b128 v4, v[72:75] offset:2048
    ds_write_b128 v4, v[76:79] offset:3072
    ds_write_b128 v4, v[80:83] offset:32768
    s_cmp_lt_u32 s3, 4
    s_cbranch_scc1 L_FW1
    ds_write_b128 v4, v[56:59] offset:0
    ds_write_b128 v5, v[60:63] offset:0
    ds_write_b128 v4, v[64:67] offset:1024
    ds_write_b128 v5, v[68:71] offset:1024
L_FW1:
    s_branch SCHK_37
SPOLL_36:
    s_load_dwordx2 s[24:25], s[32:33], s92 offset:1536 glc
SCHK_37:
    s_add_u32 s5, s5, 1
    s_cmp_ge_u32 s5, 200000
    s_waitcnt lgkmcnt(0)
    s_cbranch_scc1 SDONE_38
    s_cmp_lg_u32 s24, s4
    s_cbranch_scc1 SPOLL_36
    s_cmp_lg_u32 s25, s4
    s_cbranch_scc1 SPOLL_36
SDONE_38:
    s_barrier
    buffer_load_dwordx4 v[192:195], v2, s[32:35], s14 offen sc1
    buffer_load_dwordx4 v[196:199], v2, s[32:35], s14 offen offset:1024 sc1
    buffer_load_dwordx4 v[200:203], v2, s[32:35], s14 offen offset:2048 sc1
    buffer_load_dwordx4 v[204:207], v2, s[32:35], s14 offen offset:3072 sc1
    s_barrier
    s_add_u32 s82, s80, 172032
    s_lshl2_add_u32 m0, s83, 35840
    s_nop 0
    buffer_load_dwordx4 v27, s[56:59], s82 offen nt lds
    s_mov_b32 s82, s81
    s_lshl2_add_u32 m0, s83, 65536
    s_nop 0
    buffer_load_dwordx4 v253, s[60:63], s82 offen nt lds
    s_add_u32 s82, s81, 4096
    s_lshl2_add_u32 m0, s83, 66560
    s_nop 0
    buffer_load_dwordx4 v253, s[60:63], s82 offen nt lds
    v_mov_b32_dpp v168, v33 row_newbcast:0 row_mask:0xf bank_mask:0xf
    v_mov_b32_dpp v169, v33 row_newbcast:1 row_mask:0xf bank_mask:0xf
    v_mov_b32_dpp v170, v33 row_newbcast:2 row_mask:0xf bank_mask:0xf
    v_mov_b32_dpp v171, v33 row_newbcast:3 row_mask:0xf bank_mask:0xf
    v_mov_b32_dpp v172, v33 row_newbcast:4 row_mask:0xf bank_mask:0xf
    v_mov_b32_dpp v173, v33 row_newbcast:5 row_mask:0xf bank_mask:0xf
    v_mov_b32_dpp v174, v33 row_newbcast:6 row_mask:0xf bank_mask:0xf
    v_mov_b32_dpp v175, v33 row_newbcast:7 row_mask:0xf bank_mask:0xf
    v_mov_b32_dpp v176, v33 row_newbcast:8 row_mask:0xf bank_mask:0xf
    v_mov_b32_dpp v177, v33 row_newbcast:9 row_mask:0xf bank_mask:0xf
    v_mov_b32_dpp v178, v33 row_newbcast:10 row_mask:0xf bank_mask:0xf
    v_mov_b32_dpp v179, v33 row_newbcast:11 row_mask:0xf bank_mask:0xf
    v_mov_b32_dpp v180, v33 row_newbcast:12 row_mask:0xf bank_mask:0xf
    v_mov_b32_dpp v181, v33 row_newbcast:13 row_mask:0xf bank_mask:0xf
    v_mov_b32_dpp v182, v33 row_newbcast:14 row_mask:0xf bank_mask:0xf
    v_mov_b32_dpp v183, v33 row_newbcast:15 row_mask:0xf bank_mask:0xf
    v_mov_b32_dpp v88, v42 row_newbcast:0 row_mask:0xf bank_mask:0xf
    v_mov_b32_dpp v89, v42 row_newbcast:1 row_mask:0xf bank_mask:0xf
    v_mov_b32_dpp v90, v42 row_newbcast:2 row_mask:0xf bank_mask:0xf
    v_mov_b32_dpp v91, v42 row_newbcast:3 row_mask:0xf bank_mask:0xf
    v_mov_b32_dpp v92, v42 row_newbcast:4 row_mask:0xf bank_mask:0xf
    v_mov_b32_dpp v93, v42 row_newbcast:5 row_mask:0xf bank_mask:0xf
    v_mov_b32_dpp v94, v42 row_newbcast:6 row_mask:0xf bank_mask:0xf
    v_mov_b32_dpp v95, v42 row_newbcast:7 row_mask:0xf bank_mask:0xf
    v_mov_b32_dpp v96, v42 row_newbcast:8 row_mask:0xf bank_mask:0xf
    v_mov_b32_dpp v97, v42 row_newbcast:9 row_mask:0xf bank_mask:0xf
    v_mov_b32_dpp v98, v42 row_newbcast:10 row_mask:0xf bank_mask:0xf
    v_mov_b32_dpp v99, v42 row_newbcast:11 row_mask:0xf bank_mask:0xf
    v_mov_b32_dpp v100, v42 row_newbcast:12 row_mask:0xf bank_mask:0xf
    v_mov_b32_dpp v101, v42 row_newbcast:13 row_mask:0xf bank_mask:0xf
    v_mov_b32_dpp v102, v42 row_newbcast:14 row_mask:0xf bank_mask:0xf
    v_mov_b32_dpp v103, v42 row_newbcast:15 row_mask:0xf bank_mask:0xf
    v_mov_b32_dpp v104, v43 row_newbcast:0 row_mask:0xf bank_mask:0xf
    v_mov_b32_dpp v105, v43 row_newbcast:1 row_mask:0xf bank_mask:0xf
    v_mov_b32_dpp v106, v43 row_newbcast:2 row_mask:0xf bank_mask:0xf
    v_mov_b32_dpp v107, v43 row_newbcast:3 row_mask:0xf bank_mask:0xf
    v_mov_b32_dpp v108, v43 row_newbcast:4 row_mask:0xf bank_mask:0xf
    v_mov_b32_dpp v109, v43 row_newbcast:5 row_mask:0xf bank_mask:0xf
    v_mov_b32_dpp v110, v43 row_newbcast:6 row_mask:0xf bank_mask:0xf
    v_mov_b32_dpp v111, v43 row_newbcast:7 row_mask:0xf bank_mask:0xf
    v_mov_b32_dpp v112, v43 row_newbcast:8 row_mask:0xf bank_mask:0xf
    v_mov_b32_dpp v113, v43 row_newbcast:9 row_mask:0xf bank_mask:0xf
    v_mov_b32_dpp v114, v43 row_newbcast:10 row_mask:0xf bank_mask:0xf
    v_mov_b32_dpp v115, v43 row_newbcast:11 row_mask:0xf bank_mask:0xf
    v_mov_b32_dpp v116, v43 row_newbcast:12 row_mask:0xf bank_mask:0xf
    v_mov_b32_dpp v117, v43 row_newbcast:13 row_mask:0xf bank_mask:0xf
    v_mov_b32_dpp v118, v43 row_newbcast:14 row_mask:0xf bank_mask:0xf
    v_mov_b32_dpp v119, v43 row_newbcast:15 row_mask:0xf bank_mask:0xf
    s_lshl3_add_u32 s15, s3, 156160
    v_mov_b32 v4, s15
    v_and_b32 v5, 7, v1
    v_lshlrev_b32 v5, 3, v5
    v_add_u32 v5, 156160, v5
    v_and_b32 v6, 3, v1
    v_lshlrev_b32 v6, 18, v6
    v_bfe_u32 v9, v1, 2, 2
    v_lshl_add_u32 v6, v9, 13, v6
    s_and_b32 s96, s21, 1
    s_and_b32 s97, s12, 7
    s_lshr_b32 s98, s12, 3
    s_lshl3_add_u32 s99, s97, s98
    s_lshl_b32 s97, s99, 12
    s_lshr_b32 s98, s21, 1
    s_lshl_b32 s99, s98, 6
    s_add_u32 s98, s97, s99
    s_lshl4_add_u32 s97, s96, s98
    s_add_u32 s99, s97, 1048576
    s_add_u32 s16, s99, 2560
    s_waitcnt vmcnt(3)
    v_pk_add_f32 v[192:193], v[192:193], v[196:197]
    v_pk_add_f32 v[200:201], v[200:201], v[204:205]
    v_pk_add_f32 v[194:195], v[194:195], v[198:199]
    v_pk_add_f32 v[202:203], v[202:203], v[206:207]
    v_pk_add_f32 v[192:193], v[192:193], v[200:201]
    v_pk_add_f32 v[194:195], v[194:195], v[202:203]
    v_add_f32 v193, v193, v194
    v_add_f32 v197, v192, v195
    v_cmp_u_f32 vcc, v193, v197
    s_cbranch_vccz POK_40
PRE_41:
    buffer_load_dwordx4 v[192:195], v2, s[32:35], s14 offen sc1
    buffer_load_dwordx4 v[196:199], v2, s[32:35], s14 offen offset:1024 sc1
    buffer_load_dwordx4 v[200:203], v2, s[32:35], s14 offen offset:2048 sc1
    buffer_load_dwordx4 v[204:207], v2, s[32:35], s14 offen offset:3072 sc1
    s_waitcnt vmcnt(0)
    v_pk_add_f32 v[192:193], v[192:193], v[196:197]
    v_pk_add_f32 v[200:201], v[200:201], v[204:205]
    v_pk_add_f32 v[194:195], v[194:195], v[198:199]
    v_pk_add_f32 v[202:203], v[202:203], v[206:207]
    v_pk_add_f32 v[192:193], v[192:193], v[200:201]
    v_pk_add_f32 v[194:195], v[194:195], v[202:203]
    v_add_f32 v193, v193, v194
    v_add_f32 v197, v192, v195
    v_cmp_u_f32 vcc, v193, v197
    s_cbranch_vccz POK_40
    s_add_u32 s5, s5, 1
    s_cmp_lt_u32 s5, 200000
    s_cbranch_scc1 PRE_41
POK_40:
    v_mov_b32 v196, v195
    s_nop 1
    v_permlane32_swap_b32 v195, v196
    v_permlane32_swap_b32 v192, v193
    v_add_f32 v195, v195, v196
    v_add_f32 v192, v192, v193
    s_nop 1
    v_permlane16_swap_b32 v192, v195
    v_add_f32 v193, v192, v195
    v_add_f32 v195, v192, v195
    s_nop 1
    v_permlane16_swap_b32 v193, v195
    v_mov_b32 v192, v193
    v_mul_f32 v195, 0x3a800000, v195
    s_nop 0
    v_permlane32_swap_b32 v192, v193
    v_mul_f32 v192, 0x3a800000, v192
    v_fma_f32 v31, -v192, v192, v195
    v_cvt_pk_bf16_f32 v30, 0, v192
    v_max_f32 v31, 0, v31
    v_cvt_pk_bf16_f32 v31, 0, v31
    v_fma_f32 v193, -v30, v40, v193
    v_add_f32 v31, 0x3727c5ac, v31
    v_cvt_pk_bf16_f32 v31, 0, v31
    v_sqrt_f32 v31, v31
    s_nop 0
    v_cvt_pk_bf16_f32 v31, 0, v31
    v_rcp_f32 v31, v31
    s_nop 0
    v_mul_f32 v32, v193, v31
    v_ashrrev_i32 v196, 31, v32
    v_or_b32 v196, 0x80000000, v196
    v_xor_b32 v32, v32, v196
    s_mov_b32 s15, 0xfffff000
    v_and_or_b32 v32, v32, s15, v29
    s_nop 1
    v_max_u32_dpp v244, v32, v32 quad_perm:[1,0,3,2] row_mask:0xf bank_mask:0xf
    v_min_u32_dpp v245, v32, v32 quad_perm:[1,0,3,2] row_mask:0xf bank_mask:0xf
    s_nop 0
    v_min_u32_dpp v196, v244, v244 quad_perm:[2,3,0,1] row_mask:0xf bank_mask:0xf
    v_max_u32_dpp v245, v245, v245 quad_perm:[2,3,0,1] row_mask:0xf bank_mask:0xf
    v_max_u32_dpp v244, v244, v244 quad_perm:[2,3,0,1] row_mask:0xf bank_mask:0xf
    v_max_u32 v245, v245, v196
    s_nop 0
    v_min_u32_dpp v196, v244, v244 row_half_mirror row_mask:0xf bank_mask:0xf
    v_max_u32_dpp v245, v245, v245 row_half_mirror row_mask:0xf bank_mask:0xf
    v_max_u32_dpp v244, v244, v244 row_half_mirror row_mask:0xf bank_mask:0xf
    v_max_u32 v245, v245, v196
    s_nop 0
    v_min_u32_dpp v196, v244, v244 row_mirror row_mask:0xf bank_mask:0xf
    v_max_u32_dpp v245, v245, v245 row_mirror row_mask:0xf bank_mask:0xf
L_PAD9:
    s_cbranch_execz L_RET9
    v_max_u32_dpp v244, v244, v244 row_mirror row_mask:0xf bank_mask:0xf
    v_max_u32 v245, v245, v196
    ds_write_b64 v4, v[244:245]
    s_waitcnt lgkmcnt(0)
    s_barrier
    ds_read_b64 v[244:245], v5
    v_pk_add_f32 v[208:209], v[152:153], v[30:31] op_sel_hi:[1,0] neg_lo:[0,1] neg_hi:[0,1]
    v_pk_add_f32 v[210:211], v[154:155], v[30:31] op_sel_hi:[1,0] neg_lo:[0,1] neg_hi:[0,1]
    v_pk_add_f32 v[212:213], v[156:157], v[30:31] op_sel_hi:[1,0] neg_lo:[0,1] neg_hi:[0,1]
    v_pk_add_f32 v[214:215], v[158:159], v[30:31] op_sel_hi:[1,0] neg_lo:[0,1] neg_hi:[0,1]
    v_pk_add_f32 v[216:217], v[160:161], v[30:31] op_sel_hi:[1,0] neg_lo:[0,1] neg_hi:[0,1]
    v_pk_add_f32 v[218:219], v[162:163], v[30:31] op_sel_hi:[1,0] neg_lo:[0,1] neg_hi:[0,1]
    v_pk_add_f32 v[220:221], v[164:165], v[30:31] op_sel_hi:[1,0] neg_lo:[0,1] neg_hi:[0,1]
    v_pk_add_f32 v[222:223], v[166:167], v[30:31] op_sel_hi:[1,0] neg_lo:[0,1] neg_hi:[0,1]
    s_waitcnt lgkmcnt(0)
    v_min_u32_dpp v196, v244, v244 quad_perm:[1,0,3,2] row_mask:0xf bank_mask:0xf
    v_max_u32_dpp v245, v245, v245 quad_perm:[1,0,3,2] row_mask:0xf bank_mask:0xf
    v_max_u32_dpp v244, v244, v244 quad_perm:[1,0,3,2] row_mask:0xf bank_mask:0xf
    v_max_u32 v245, v245, v196
    s_nop 0
    v_min_u32_dpp v196, v244, v244 quad_perm:[2,3,0,1] row_mask:0xf bank_mask:0xf
    v_max_u32_dpp v245, v245, v245 quad_perm:[2,3,0,1] row_mask:0xf bank_mask:0xf
    v_max_u32_dpp v244, v244, v244 quad_perm:[2,3,0,1] row_mask:0xf bank_mask:0xf
    v_max_u32 v245, v245, v196
    s_nop 0
    v_min_u32_dpp v196, v244, v244 row_half_mirror row_mask:0xf bank_mask:0xf
    v_max_u32_dpp v245, v245, v245 row_half_mirror row_mask:0xf bank_mask:0xf
    v_max_u32_dpp v244, v244, v244 row_half_mirror row_mask:0xf bank_mask:0xf
    v_max_u32 v245, v245, v196
    v_cmp_eq_u32 s[88:89], v32, v245
    v_cmp_eq_u32 vcc, v32, v244
    v_or_b32 v246, 1, v245
    v_mov_b32 v245, s4
    v_mov_b32 v247, s4
    s_or_b64 s[84:85], vcc, s[88:89]
    s_cmp_lg_u32 s3, 0
    s_cbranch_scc1 L_NOF
    s_mov_b64 exec, 0xffff
    buffer_store_dwordx4 v[244:247], v6, s[32:35], s16 offen sc1
    s_mov_b64 exec, -1
L_NOF:
    s_cmp_eq_u64 s[84:85], 0
    s_cbranch_scc1 L_NOPR
    s_setprio 1
L_NOPR:
    s_lshl4_add_u32 s13, s3, 156288
    v_mov_b32 v4, s13
    v_and_b32 v5, 7, v1
    v_lshlrev_b32 v5, 4, v5
    v_add_u32 v5, 156288, v5
    s_load_dwordx8 s[24:31], s[32:33], s92 offset:2560 glc
    v_cvt_pk_bf16_f32 v208, 0, v208
    v_cvt_pk_bf16_f32 v209, 0, v209
    v_cvt_pk_bf16_f32 v210, 0, v210
    v_cvt_pk_bf16_f32 v211, 0, v211
    v_cvt_pk_bf16_f32 v212, 0, v212
    v_cvt_pk_bf16_f32 v213, 0, v213
    v_cvt_pk_bf16_f32 v214, 0, v214
    v_cvt_pk_bf16_f32 v215, 0, v215
    v_cvt_pk_bf16_f32 v216, 0, v216
    v_cvt_pk_bf16_f32 v217, 0, v217
    v_cvt_pk_bf16_f32 v218, 0, v218
    v_cvt_pk_bf16_f32 v219, 0, v219
    v_cvt_pk_bf16_f32 v220, 0, v220
    v_cvt_pk_bf16_f32 v221, 0, v221
    v_cvt_pk_bf16_f32 v222, 0, v222
    v_cvt_pk_bf16_f32 v223, 0, v223
    v_pk_mul_f32 v[208:209], v[30:31], v[208:209] op_sel:[1,0]
    v_pk_mul_f32 v[210:211], v[30:31], v[210:211] op_sel:[1,0]
    v_pk_mul_f32 v[212:213], v[30:31], v[212:213] op_sel:[1,0]
    v_pk_mul_f32 v[214:215], v[30:31], v[214:215] op_sel:[1,0]
    v_pk_mul_f32 v[216:217], v[30:31], v[216:217] op_sel:[1,0]
    v_pk_mul_f32 v[218:219], v[30:31], v[218:219] op_sel:[1,0]
    v_pk_mul_f32 v[220:221], v[30:31], v[220:221] op_sel:[1,0]
    v_pk_mul_f32 v[222:223], v[30:31], v[222:223] op_sel:[1,0]
    v_cvt_pk_bf16_f32 v208, 0, v208
    v_cvt_pk_bf16_f32 v209, 0, v209
    v_cvt_pk_bf16_f32 v210, 0, v210
    v_cvt_pk_bf16_f32 v211, 0, v211
    v_cvt_pk_bf16_f32 v212, 0, v212
    v_cvt_pk_bf16_f32 v213, 0, v213
    v_cvt_pk_bf16_f32 v214, 0, v214
    v_cvt_pk_bf16_f32 v215, 0, v215
    v_cvt_pk_bf16_f32 v216, 0, v216
    v_cvt_pk_bf16_f32 v217, 0, v217
    v_cvt_pk_bf16_f32 v218, 0, v218
    v_cvt_pk_bf16_f32 v219, 0, v219
    v_cvt_pk_bf16_f32 v220, 0, v220
    v_cvt_pk_bf16_f32 v221, 0, v221
    v_cvt_pk_bf16_f32 v222, 0, v222
    v_cvt_pk_bf16_f32 v223, 0, v223
    v_pk_mul_f32 v[208:209], v[208:209], v[168:169]
    v_pk_mul_f32 v[210:211], v[210:211], v[170:171]
    v_pk_mul_f32 v[212:213], v[212:213], v[172:173]
    v_pk_mul_f32 v[214:215], v[214:215], v[174:175]
    v_pk_mul_f32 v[216:217], v[216:217], v[176:177]
    v_pk_mul_f32 v[218:219], v[218:219], v[178:179]
    v_pk_mul_f32 v[220:221], v[220:221], v[180:181]
    v_pk_mul_f32 v[222:223], v[222:223], v[182:183]
    v_cvt_pk_bf16_f32 v208, 0, v208
    v_cvt_pk_bf16_f32 v209, 0, v209
    v_cvt_pk_bf16_f32 v210, 0, v210
    v_cvt_pk_bf16_f32 v211, 0, v211
    v_cvt_pk_bf16_f32 v212, 0, v212
    v_cvt_pk_bf16_f32 v213, 0, v213
    v_cvt_pk_bf16_f32 v214, 0, v214
    v_cvt_pk_bf16_f32 v215, 0, v215
    v_cvt_pk_bf16_f32 v216, 0, v216
    v_cvt_pk_bf16_f32 v217, 0, v217
    v_cvt_pk_bf16_f32 v218, 0, v218
    v_cvt_pk_bf16_f32 v219, 0, v219
    v_cvt_pk_bf16_f32 v220, 0, v220
    v_cvt_pk_bf16_f32 v221, 0, v221
    v_cvt_pk_bf16_f32 v222, 0, v222
    v_cvt_pk_bf16_f32 v223, 0, v223
    v_pk_add_f32 v[208:209], v[208:209], v[88:89]
    v_pk_add_f32 v[210:211], v[210:211], v[90:91]
    v_pk_add_f32 v[212:213], v[212:213], v[92:93]
    v_pk_add_f32 v[214:215], v[214:215], v[94:95]
    v_pk_add_f32 v[216:217], v[216:217], v[96:97]
    v_pk_add_f32 v[218:219], v[218:219], v[98:99]
    v_pk_add_f32 v[220:221], v[220:221], v[100:101]
    v_pk_add_f32 v[222:223], v[222:223], v[102:103]
    v_cvt_pk_bf16_f32 v224, v208, v209
    v_cvt_pk_bf16_f32 v225, v210, v211
    v_cvt_pk_bf16_f32 v226, v212, v213
    v_cvt_pk_bf16_f32 v227, v214, v215
    v_cvt_pk_bf16_f32 v228, v216, v217
    v_cvt_pk_bf16_f32 v229, v218, v219
    v_cvt_pk_bf16_f32 v230, v220, v221
    v_cvt_pk_bf16_f32 v231, v222, v223
    s_cmp_eq_u64 s[84:85], 0
    s_cbranch_scc1 L_NOCAND
    v_mfma_f32_16x16x32_bf16 v[240:243], v[184:187], v[224:227], 0
    v_mfma_f32_16x16x32_bf16 v[240:243], v[188:191], v[228:231], v[240:243]
    v_mov_b32 v232, v224
    v_mov_b32 v233, v225
    v_mov_b32 v234, v226
    v_mov_b32 v235, v227
    v_mov_b32 v236, v228
    v_mov_b32 v237, v229
    v_mov_b32 v238, v230
    v_mov_b32 v239, v231
    s_lshl_b32 s96, s21, 14
    s_lshl_b32 s97, s12, 9
    s_add_u32 s98, s96, s97
    s_add_u32 s15, s98, 13631488
    v_lshrrev_b32 v7, 4, v1
    v_lshlrev_b32 v7, 4, v7
    v_add_u32 v8, 8192, v7
    v_permlane32_swap_b32 v232, v234
    v_permlane32_swap_b32 v233, v235
    v_permlane32_swap_b32 v236, v238
    v_permlane32_swap_b32 v237, v239
    v_permlane32_swap_b32 v12, v14
    v_permlane32_swap_b32 v13, v15
    v_permlane32_swap_b32 v16, v18
    v_permlane32_swap_b32 v17, v19
    v_cndmask_b32 v7, v7, v8, s[88:89]
    s_mov_b64 exec, s[84:85]
    buffer_store_dwordx4 v[232:235], v7, s[32:35], s15 offen sc1
    buffer_store_dwordx4 v[236:239], v7, s[32:35], s15 offen offset:64 sc1
    s_mov_b32 exec_hi, 0
    s_and_b32 exec_lo, s84, 0xffff
    buffer_store_dword v243, v7, s[32:35], s15 offen offset:256 sc1
    s_mov_b64 exec, s[84:85]
    buffer_store_dwordx4 v[12:15], v7, s[32:35], s15 offen offset:128 sc1
    buffer_store_dwordx4 v[16:19], v7, s[32:35], s15 offen offset:192 sc1
    s_mov_b64 exec, -1
    s_setprio 0
L_NOCAND:
    s_add_u32 s82, s81, 8192
    s_lshl2_add_u32 m0, s83, 67584
    s_nop 0
    buffer_load_dwordx4 v253, s[60:63], s82 offen nt lds
    s_add_u32 s82, s81, 12288
    s_lshl2_add_u32 m0, s83, 68608
    s_nop 0
    buffer_load_dwordx4 v253, s[60:63], s82 offen nt lds
    v_lshlrev_b32 v208, 16, v224
    v_and_b32 v209, s6, v224
    v_lshlrev_b32 v210, 16, v225
    v_and_b32 v211, s6, v225
    v_lshlrev_b32 v212, 16, v226
    v_and_b32 v213, s6, v226
    v_lshlrev_b32 v214, 16, v227
    v_and_b32 v215, s6, v227
    v_lshlrev_b32 v216, 16, v228
    v_and_b32 v217, s6, v228
    v_lshlrev_b32 v218, 16, v229
    v_and_b32 v219, s6, v229
    v_lshlrev_b32 v220, 16, v230
    v_and_b32 v221, s6, v230
    v_lshlrev_b32 v222, 16, v231
    v_and_b32 v223, s6, v231
    v_pk_mul_f32 v[208:209], v[208:209], v[104:105]
    v_pk_mul_f32 v[210:211], v[210:211], v[106:107]
    v_pk_mul_f32 v[212:213], v[212:213], v[108:109]
    v_pk_mul_f32 v[214:215], v[214:215], v[110:111]
    v_pk_mul_f32 v[216:217], v[216:217], v[112:113]
    v_pk_mul_f32 v[218:219], v[218:219], v[114:115]
    v_pk_mul_f32 v[220:221], v[220:221], v[116:117]
    v_pk_mul_f32 v[222:223], v[222:223], v[118:119]
    v_cvt_pk_bf16_f32 v208, 0, v208
    v_cvt_pk_bf16_f32 v209, 0, v209
    v_cvt_pk_bf16_f32 v210, 0, v210
    v_cvt_pk_bf16_f32 v211, 0, v211
    v_cvt_pk_bf16_f32 v212, 0, v212
    v_cvt_pk_bf16_f32 v213, 0, v213
    v_cvt_pk_bf16_f32 v214, 0, v214
    v_cvt_pk_bf16_f32 v215, 0, v215
    v_cvt_pk_bf16_f32 v216, 0, v216
    v_cvt_pk_bf16_f32 v217, 0, v217
    v_cvt_pk_bf16_f32 v218, 0, v218
    v_cvt_pk_bf16_f32 v219, 0, v219
    v_cvt_pk_bf16_f32 v220, 0, v220
    v_cvt_pk_bf16_f32 v221, 0, v221
    v_cvt_pk_bf16_f32 v222, 0, v222
    v_cvt_pk_bf16_f32 v223, 0, v223
    s_branch SCHK_43
SPOLL_42:
    s_load_dwordx8 s[24:31], s[32:33], s92 offset:2560 glc
SCHK_43:
    s_add_u32 s5, s5, 1
    s_cmp_ge_u32 s5, 200000
    s_waitcnt lgkmcnt(0)
    s_cbranch_scc1 SDONE_44
    s_cmp_lg_u32 s25, s4
    s_cbranch_scc1 SPOLL_42
    s_cmp_lg_u32 s27, s4
    s_cbranch_scc1 SPOLL_42
    s_cmp_lg_u32 s29, s4
    s_cbranch_scc1 SPOLL_42
    s_cmp_lg_u32 s31, s4
    s_cbranch_scc1 SPOLL_42
SDONE_44:
    s_min_u32 s25, s24, s28
    s_min_u32 s27, s26, s28
    s_min_u32 s29, s24, s30
    s_max_u32 s24, s24, s28
    s_max_u32 s26, s26, s30
    s_max_u32 s27, s27, s29
    s_max_u32 s25, s25, s26
    v_mov_b32 v244, s24
    v_mov_b32 v246, s27
    v_mov_b32 v245, s25
    ds_write_b128 v4, v[244:247]
    s_waitcnt vmcnt(4)
    s_waitcnt lgkmcnt(0)
    s_barrier
    ds_read_b128 v[244:247], v5
    v_and_b32 v8, 8, v1
    v_cmp_eq_u32 s[22:23], 0, v8
    v_cmp_gt_u32 s[24:25], 16, v1
    v_cmp_gt_u32 s[26:27], 32, v1
    s_waitcnt lgkmcnt(0)
    v_min_u32_dpp v192, v244, v244 quad_perm:[1,0,3,2] row_mask:0xf bank_mask:0xf
    v_min_u32_dpp v193, v245, v244 quad_perm:[1,0,3,2] row_mask:0xf bank_mask:0xf
    v_min_u32_dpp v194, v244, v245 quad_perm:[1,0,3,2] row_mask:0xf bank_mask:0xf
    v_max_u32_dpp v246, v246, v246 quad_perm:[1,0,3,2] row_mask:0xf bank_mask:0xf
    v_max_u32_dpp v245, v245, v245 quad_perm:[1,0,3,2] row_mask:0xf bank_mask:0xf
    v_max_u32_dpp v244, v244, v244 quad_perm:[1,0,3,2] row_mask:0xf bank_mask:0xf
    v_max3_u32 v246, v246, v193, v194
    v_max_u32 v245, v245, v192
    v_min_u32_dpp v192, v244, v244 quad_perm:[2,3,0,1] row_mask:0xf bank_mask:0xf
    s_nop 0
    v_min_u32_dpp v193, v245, v244 quad_perm:[2,3,0,1] row_mask:0xf bank_mask:0xf
    v_min_u32_dpp v194, v244, v245 quad_perm:[2,3,0,1] row_mask:0xf bank_mask:0xf
    v_max_u32_dpp v246, v246, v246 quad_perm:[2,3,0,1] row_mask:0xf bank_mask:0xf
    v_max_u32_dpp v245, v245, v245 quad_perm:[2,3,0,1] row_mask:0xf bank_mask:0xf
    v_max_u32_dpp v244, v244, v244 quad_perm:[2,3,0,1] row_mask:0xf bank_mask:0xf
    v_max3_u32 v246, v246, v193, v194
    v_max_u32 v245, v245, v192
    v_min_u32_dpp v192, v244, v244 row_half_mirror row_mask:0xf bank_mask:0xf
    s_nop 0
    v_min_u32_dpp v193, v245, v244 row_half_mirror row_mask:0xf bank_mask:0xf
    v_min_u32_dpp v194, v244, v245 row_half_mirror row_mask:0xf bank_mask:0xf
    v_max_u32_dpp v246, v246, v246 row_half_mirror row_mask:0xf bank_mask:0xf
    v_max_u32_dpp v245, v245, v245 row_half_mirror row_mask:0xf bank_mask:0xf
    v_max_u32_dpp v244, v244, v244 row_half_mirror row_mask:0xf bank_mask:0xf
    v_max3_u32 v246, v246, v193, v194
    v_max_u32 v245, v245, v192
    v_cndmask_b32 v192, v245, v244, s[22:23]
    v_cndmask_b32 v201, v246, v245, s[26:27]
    v_and_b32 v193, 31, v246
    v_and_b32 v192, 31, v192
    v_cndmask_b32 v201, v201, v244, s[24:25]
    v_lshl_add_u32 v4, v192, 13, v52
    v_lshl_add_u32 v5, v193, 13, v52
    v_and_b32 v194, 31, v201
    v_lshl_add_u32 v6, v194, 13, v53
    buffer_load_dwordx4 v[192:195], v4, s[32:35], 0 offen sc1
    buffer_load_dwordx4 v[196:199], v5, s[32:35], 0 offen sc1
    buffer_load_dword v200, v6, s[32:35], 0 offen sc1
    v_readfirstlane_b32 s91, v244
    v_readfirstlane_b32 s94, v245
    v_readfirstlane_b32 s95, v246
    ds_read_b64_tr_b16 v[56:57], v34
    ds_read_b64_tr_b16 v[58:59], v34 offset:512
    ds_read_b64_tr_b16 v[60:61], v34 offset:1024
    ds_read_b64_tr_b16 v[62:63], v34 offset:1536
    ds_read_b64_tr_b16 v[64:65], v34 offset:2048
    ds_read_b64_tr_b16 v[66:67], v34 offset:2560
    ds_read_b64_tr_b16 v[68:69], v34 offset:3072
    ds_read_b64_tr_b16 v[70:71], v34 offset:3584
    ds_read_b64_tr_b16 v[72:73], v34 offset:4096
    ds_read_b64_tr_b16 v[74:75], v34 offset:4608
    ds_read_b64_tr_b16 v[76:77], v34 offset:5120
    ds_read_b64_tr_b16 v[78:79], v34 offset:5632
    ds_read_b64_tr_b16 v[80:81], v34 offset:6144
    ds_read_b64_tr_b16 v[82:83], v34 offset:6656
    ds_read_b64_tr_b16 v[84:85], v34 offset:7168
    ds_read_b64_tr_b16 v[86:87], v34 offset:7680
    s_lshl_b32 s96, s3, 11
    s_add_u32 s13, s96, 98304
    v_lshrrev_b32 v44, 4, v1
    v_lshlrev_b32 v44, 4, v44
    v_and_b32 v45, 7, v1
    v_lshlrev_b32 v45, 4, v45
    v_xor_b32 v44, v44, v45
    v_and_b32 v46, 15, v1
    v_lshl_add_u32 v46, v46, 7, s13
    v_add_u32 v44, v44, v46
    v_xor_b32 v46, 64, v44
    v_lshrrev_b32 v47, 3, v1
    v_lshlrev_b32 v47, 4, v47
    v_xor_b32 v45, v47, v45
    v_lshrrev_b32 v47, 3, v1
    v_lshl_add_u32 v47, v47, 7, s13
    v_add_u32 v45, v45, v47
    s_lshl_b32 s96, s21, 7
    s_sub_u32 s97, 2047, s96
    s_lshl_b32 s98, s3, 4
    s_sub_u32 s13, s97, s98
    v_lshrrev_b32 v43, 3, v1
    v_sub_u32 v42, s13, v43
    v_subrev_u32 v43, 8, v42
    v_lshrrev_b32 v33, 3, v1
    v_lshlrev_b32 v33, 11, v33
    v_and_b32 v9, 7, v1
    v_lshl_add_u32 v33, v9, 4, v33
    v_pk_add_f32 v[208:209], v[208:209], v[152:153]
    v_pk_add_f32 v[210:211], v[210:211], v[154:155]
    v_pk_add_f32 v[212:213], v[212:213], v[156:157]
    v_pk_add_f32 v[214:215], v[214:215], v[158:159]
    v_pk_add_f32 v[216:217], v[216:217], v[160:161]
    v_pk_add_f32 v[218:219], v[218:219], v[162:163]
    v_pk_add_f32 v[220:221], v[220:221], v[164:165]
    v_pk_add_f32 v[222:223], v[222:223], v[166:167]
    v_cvt_pk_bf16_f32 v232, v208, v209
    v_cvt_pk_bf16_f32 v233, v210, v211
    v_cvt_pk_bf16_f32 v234, v212, v213
    v_cvt_pk_bf16_f32 v235, v214, v215
    v_cvt_pk_bf16_f32 v236, v216, v217
    v_cvt_pk_bf16_f32 v237, v218, v219
    v_cvt_pk_bf16_f32 v238, v220, v221
    v_cvt_pk_bf16_f32 v239, v222, v223
    v_permlane32_swap_b32 v232, v234
    v_permlane32_swap_b32 v233, v235
    v_permlane32_swap_b32 v236, v238
    v_permlane32_swap_b32 v237, v239
    ds_write_b128 v44, v[232:235]
    ds_write_b128 v46, v[236:239]
    ds_read_b128 v[232:235], v45
    ds_read_b128 v[236:239], v45 offset:1024
    s_waitcnt lgkmcnt(0)
    v_bfe_u32 v7, v201, 1, 4
    v_bfe_u32 v201, v201, 5, 7
    v_lshl_or_b32 v201, v7, 7, v201
    v_xor_b32 v201, 0x7ff, v201
    s_waitcnt vmcnt(0)
    v_max3_u32 v7, v192, v196, v200
    v_cmp_eq_u32 vcc, -1, v7
    s_cbranch_vccz POK_46
PRE_47:
    buffer_load_dwordx4 v[192:195], v4, s[32:35], 0 offen sc1
    buffer_load_dwordx4 v[196:199], v5, s[32:35], 0 offen sc1
    buffer_load_dword v200, v6, s[32:35], 0 offen sc1
    s_waitcnt vmcnt(0)
    v_max3_u32 v7, v192, v196, v200
    v_cmp_eq_u32 vcc, -1, v7
    s_cbranch_vccz POK_46
    s_add_u32 s5, s5, 1
    s_cmp_lt_u32 s5, 200000
    s_cbranch_scc1 PRE_47
POK_46:
    v_add_f32_dpp v200, v200, v200 quad_perm:[1,0,3,2] row_mask:0xf bank_mask:0xf
    s_nop 1
    v_add_f32_dpp v200, v200, v200 quad_perm:[2,3,0,1] row_mask:0xf bank_mask:0xf
    s_nop 1
    v_add_f32_dpp v200, v200, v200 row_half_mirror row_mask:0xf bank_mask:0xf
    s_nop 1
    v_add_f32_dpp v200, v200, v200 row_mirror row_mask:0xf bank_mask:0xf
    v_cvt_pk_bf16_f32 v200, 0, v200
    v_ashrrev_i32 v7, 31, v200
    v_or_b32 v7, 0x80000000, v7
    v_xor_b32 v200, v200, v7
    v_lshrrev_b32 v200, 16, v200
    v_lshl_or_b32 v200, v200, 11, v201
    s_nop 0
    v_readlane_b32 s24, v200, 0
    v_readlane_b32 s25, v200, 16
    v_readlane_b32 s26, v200, 32
    s_not_b64 s[28:29], s[22:23]
    s_cmp_lt_u32 s24, s25
    s_cselect_b64 s[28:29], s[22:23], s[28:29]
    s_cselect_b32 s27, s24, s25
    s_cmp_gt_u32 s26, s27
    s_cselect_b64 vcc, s[28:29], 0
    v_cndmask_b32 v192, v192, v196, vcc
    v_cndmask_b32 v193, v193, v197, vcc
    v_cndmask_b32 v194, v194, v198, vcc
    v_cndmask_b32 v195, v195, v199, vcc
    s_bitcmp1_b32 vcc_lo, 0
    s_cselect_b32 s24, s26, s24
    s_cselect_b32 s19, s17, s19
    s_cselect_b32 s17, s95, s91
    s_bitcmp1_b32 vcc_lo, 8
    s_cselect_b32 s25, s26, s25
    s_cselect_b32 s19, s18, s19
    s_cselect_b32 s18, s95, s94
    s_waitcnt lgkmcnt(0)
    v_mfma_f32_16x16x32_bf16 v[136:139], v[192:195], v[56:59], 0
    v_mfma_f32_16x16x32_bf16 v[140:143], v[192:195], v[60:63], 0
    v_mfma_f32_16x16x32_bf16 v[144:147], v[192:195], v[64:67], 0
    v_mfma_f32_16x16x32_bf16 v[148:151], v[192:195], v[68:71], 0
    v_mfma_f32_16x16x32_bf16 v[168:171], v[192:195], v[72:75], 0
    v_mfma_f32_16x16x32_bf16 v[172:175], v[192:195], v[76:79], 0
    v_mfma_f32_16x16x32_bf16 v[176:179], v[192:195], v[80:83], 0
    v_mfma_f32_16x16x32_bf16 v[180:183], v[192:195], v[84:87], 0
    s_nop 1
    v_add_f32 v196, v136, v141
    s_nop 0
    v_add_f32 v197, v146, v151
    s_nop 0
    v_add_f32 v198, v168, v173
    s_nop 0
    v_add_f32 v199, v178, v183
    v_add_f32 v196, v196, v197
    v_add_f32 v198, v198, v199
    v_mov_b32 v197, s4
    s_nop 0
    v_permlane16_swap_b32 v198, v199
    s_cmp_ge_u32 s9, 28
    s_cbranch_scc1 L_NOHP
    v_add_f32 v196, v196, v199
    v_add_f32 v198, v196, 0
    v_mov_b32 v199, s4
    s_nop 0
    v_permlane32_swap_b32 v196, v198
    s_mov_b64 exec, 0xffff
    buffer_store_dwordx4 v[196:199], v2, s[32:35], s73 offen sc1
    s_mov_b64 exec, -1
L_NOHP:
    s_and_b32 s68, s24, 2047
    s_and_b32 s69, s25, 2047
    s_waitcnt lgkmcnt(0)
    s_cmp_lg_u32 s93, 7
    s_cbranch_scc1 L_NONON
    v_mov_b32 v6, s4
    v_mov_b32 v7, 0
    s_mov_b64 exec, 1
    buffer_store_dword v6, v7, s[32:35], 0 offen sc1
    s_mov_b64 exec, -1
L_NONON:
    s_cmp_ge_u32 s9, 28
    s_cbranch_scc1 L_FIN3
    v_bfe_u32 v192, v1, 2, 1
    v_lshlrev_b32 v192, 7, v192
    v_lshrrev_b32 v9, 5, v1
    v_lshl_add_u32 v192, v9, 4, v192
    v_add_u32 v192, 156672, v192
    v_lshrrev_b32 v193, 4, v1
    v_mul_u32_u24 v193, 7168, v193
    v_and_b32 v9, 15, v1
    v_lshl_add_u32 v193, v9, 3, v193
    s_lshl3_add_u32 s96, s75, s3
    s_mul_i32 s97, s96, 28672
    s_lshl_b32 s98, s74, 7
    s_add_u32 s99, s97, s98
    s_add_u32 s80, s99, 22020096
    v_and_b32 v194, 1, v1
    v_lshlrev_b32 v194, 13, v194
    v_bfe_u32 v9, v1, 1, 1
    v_lshl_add_u32 v194, v9, 18, v194
    s_lshr_b32 s96, s9, 2
    s_and_b32 s97, s75, 1
    s_lshr_b32 s98, s3, 1
    s_lshl2_add_u32 s99, s97, s98
    s_and_b32 s97, s3, 1
    s_lshr_b32 s98, s75, 1
    s_lshl2_add_u32 s97, s97, s98
    s_lshl3_add_u32 s98, s99, s97
    s_lshl_b32 s99, s98, 12
    s_lshl_b32 s97, s8, 6
    s_add_u32 s98, s99, s97
    s_lshl2_add_u32 s99, s96, s98
    s_add_u32 s97, s99, 1048576
    s_add_u32 s81, s97, 3072
    s_cmp_lt_u32 s3, 4
    s_cbranch_scc1 L_HW
    s_barrier
    ds_read_b64_tr_b16 v[120:121], v35
    ds_read_b64_tr_b16 v[122:123], v35 offset:1024
    ds_read_b64_tr_b16 v[124:125], v35 offset:8192
    ds_read_b64_tr_b16 v[126:127], v35 offset:9216
    ds_read_b64_tr_b16 v[128:129], v35 offset:16384
    ds_read_b64_tr_b16 v[130:131], v35 offset:17408
    ds_read_b64_tr_b16 v[132:133], v35 offset:24576
    ds_read_b64_tr_b16 v[134:135], v35 offset:25600
    s_cmp_lg_u32 s3, 7
    s_cbranch_scc1 L_NOH
    s_bitcmp1_b32 s9, 3
    s_cselect_b32 s15, s25, s24
    s_cselect_b32 s17, s18, s17
    s_andn2_b32 s18, 2047, s15
    s_lshr_b32 s96, s8, 1
    s_lshl2_add_u32 s19, s12, s96
    s_lshr_b32 s96, s19, 1
    s_lshr_b32 s97, s9, 3
    s_lshl_b32 s98, s97, 1
    s_lshl2_add_u32 s99, s96, s98
    s_and_b32 s97, s19, 1
    s_add_u32 s96, s99, s97
    s_mul_i32 s98, s96, 7168
    s_add_u32 s20, s98, 22020096
    s_lshl_b32 s96, s18, 11
    s_lshl_b32 s97, s19, 5
    s_add_u32 s82, s96, s97
    v_and_b32 v10, 7, v1
    v_lshlrev_b32 v10, 2, v10
    s_lshr_b32 s96, s8, 1
    s_lshl_b32 s97, s96, 6
    s_add_u32 s13, s97, 157184
    v_and_b32 v5, 7, v1
    v_lshl_add_u32 v5, v5, 3, s13
    ds_read_b64 v[206:207], v5
    s_and_b32 s96, s17, 31
    s_lshl_b32 s97, s96, 13
    s_lshl_b32 s98, s12, 9
    s_add_u32 s99, s97, s98
    s_lshr_b32 s96, s8, 1
    s_lshl_b32 s97, s96, 5
    s_add_u32 s98, s99, s97
    s_add_u32 s91, s98, 13631488
    s_lshr_b32 s13, s15, 11
    s_lshl_b32 s13, s13, 16
    s_ashr_i32 s15, s13, 31
    s_andn2_b32 s15, 0x7fff0000, s15
    s_or_b32 s15, s15, 0x80000000
    s_xor_b32 s13, s13, s15
    v_mov_b32 v204, s13
    v_mul_f32 v204, s7, v204
    v_exp_f32 v204, -v204
    s_nop 0
    v_add_f32 v204, 1.0, v204
    v_rcp_f32 v204, v204
    s_nop 0
    v_cvt_pk_bf16_f32 v204, 0, v204
    v_mov_b32 v5, s4
    v_not_b32 v6, v5
POLL_48:
    buffer_load_dword v244, v10, s[32:35], s91 offen sc1
    buffer_load_dword v245, v10, s[32:35], s91 offen offset:128 sc1
    s_waitcnt vmcnt(0)
    v_max_u32 v246, v244, v245
    v_cmp_ne_u32 vcc, -1, v246
    s_nop 1
    v_cndmask_b32 v246, v6, v5, vcc
    v_cmp_ne_u32 vcc, s4, v246
    s_cbranch_vccz PDONE_49
    s_add_u32 s5, s5, 1
    s_cmp_lt_u32 s5, 200000
    s_cbranch_scc1 POLL_48
PDONE_49:
    v_lshlrev_b32 v246, 16, v245
    v_and_b32 v247, s6, v245
    v_and_b32 v245, s6, v244
    v_lshlrev_b32 v244, 16, v244
    s_branch L_NOH
L_HW:
    s_lshl_b32 s96, s3, 8
    s_add_u32 s13, s96, s72
    v_lshrrev_b32 v4, 4, v1
    v_lshlrev_b32 v4, 11, v4
    v_and_b32 v9, 15, v1
    v_lshl_add_u32 v4, v9, 4, v4
    s_lshl_b32 s96, s3, 5
    s_add_u32 s15, s96, 156672
    v_lshrrev_b32 v5, 5, v1
    v_lshl_add_u32 v5, v5, 7, s15
    v_bfe_u32 v9, v1, 2, 1
    v_lshl_add_u32 v5, v9, 4, v5
    v_bfe_u32 v9, v1, 1, 1
    v_lshl_add_u32 v5, v9, 3, v5
    v_bfe_u32 v9, v1, 3, 1
    v_lshl_add_u32 v5, v9, 2, v5
    v_and_b32 v9, 1, v1
    v_lshl_add_u32 v5, v9, 1, v5
    s_load_dword s24, s[32:33], s13 offset:1276 glc
    s_load_dword s25, s[32:33], s13 offset:3324 glc
    s_load_dword s26, s[32:33], s13 offset:5372 glc
    s_load_dword s27, s[32:33], s13 offset:7420 glc
    s_barrier
    ds_read_b64_tr_b16 v[120:121], v35
    ds_read_b64_tr_b16 v[122:123], v35 offset:1024
    ds_read_b64_tr_b16 v[124:125], v35 offset:8192
    ds_read_b64_tr_b16 v[126:127], v35 offset:9216
    ds_read_b64_tr_b16 v[128:129], v35 offset:16384
    ds_read_b64_tr_b16 v[130:131], v35 offset:17408
    ds_read_b64_tr_b16 v[132:133], v35 offset:24576
    ds_read_b64_tr_b16 v[134:135], v35 offset:25600
    s_branch SCHK_51
SPOLL_50:
    s_load_dword s24, s[32:33], s13 offset:1276 glc
    s_load_dword s25, s[32:33], s13 offset:3324 glc
    s_load_dword s26, s[32:33], s13 offset:5372 glc
    s_load_dword s27, s[32:33], s13 offset:7420 glc
SCHK_51:
    s_add_u32 s5, s5, 1
    s_cmp_ge_u32 s5, 200000
    s_waitcnt lgkmcnt(0)
    s_cbranch_scc1 SDONE_52
    s_cmp_lg_u32 s24, s4
    s_cbranch_scc1 SPOLL_50
    s_cmp_lg_u32 s25, s4
    s_cbranch_scc1 SPOLL_50
    s_cmp_lg_u32 s26, s4
    s_cbranch_scc1 SPOLL_50
    s_cmp_lg_u32 s27, s4
    s_cbranch_scc1 SPOLL_50
SDONE_52:
POLL_53:
    buffer_load_dwordx4 v[88:91], v4, s[32:35], s13 offen sc1
    buffer_load_dwordx4 v[92:95], v4, s[32:35], s13 offen offset:1024 sc1
    s_waitcnt vmcnt(0)
    v_bitop3_b32 v6, v89, v91, s4 bitop3:0x7e
    v_bitop3_b32 v6, v6, v93, s4 bitop3:0xf6
    v_bitop3_b32 v6, v6, v95, s4 bitop3:0xf6
    v_cmp_ne_u32 vcc, 0, v6
    s_cbranch_vccz PDONE_54
    s_add_u32 s5, s5, 1
    s_cmp_lt_u32 s5, 200000
    s_cbranch_scc1 POLL_53
PDONE_54:
    v_permlane32_swap_b32 v88, v90
    v_permlane32_swap_b32 v92, v94
    v_add_f32 v88, v88, v90
    v_add_f32 v92, v92, v94
    v_mov_b32 v90, v88
    v_mov_b32 v94, v92
    s_nop 0
    v_permlane16_swap_b32 v88, v90
    v_permlane16_swap_b32 v92, v94
    v_add_f32 v88, v88, v90
    v_add_f32 v92, v92, v94
    v_cvt_pk_bf16_f32 v88, 0, v88
    v_cvt_pk_bf16_f32 v92, 0, v92
    v_mul_f32 v6, s7, v88
    v_exp_f32 v6, -v6
    s_nop 0
    v_add_f32 v6, 1.0, v6
    v_rcp_f32 v6, v6
    s_nop 0
    v_mul_f32 v88, v88, v6
    v_cvt_pk_bf16_f32 v88, 0, v88
    v_mul_f32 v88, v88, v92
    v_cvt_pk_bf16_f32 v88, v88, v88
    ds_write_b16 v5, v88
L_NOH:
    s_waitcnt lgkmcnt(0)
    s_barrier
    ds_read_b128 v[88:91], v192
    ds_read_b128 v[92:95], v192 offset:32
    ds_read_b128 v[96:99], v192 offset:64
    ds_read_b128 v[100:103], v192 offset:96
    s_waitcnt lgkmcnt(3)
    v_mfma_f32_32x32x16_bf16 v[208:223], v[88:91], v[120:123], 0
    s_waitcnt lgkmcnt(2)
    v_mfma_f32_32x32x16_bf16 v[208:223], v[92:95], v[124:127], v[208:223]
    s_waitcnt lgkmcnt(1)
    v_mfma_f32_32x32x16_bf16 v[208:223], v[96:99], v[128:131], v[208:223]
    s_waitcnt lgkmcnt(0)
    v_mfma_f32_32x32x16_bf16 v[208:223], v[100:103], v[132:135], v[208:223]
    s_nop 11
    v_mov_b32 v209, s4
    buffer_store_dwordx2 v[208:209], v193, s[32:35], s80 offen sc1
    s_mov_b64 exec, 15
    buffer_store_dword v209, v194, s[32:35], s81 offen sc1
    s_mov_b64 exec, -1
    s_barrier
    s_branch L_FIN2
L_FIN3:
    s_waitcnt lgkmcnt(0)
L_FIN2:
    v_cmp_ne_u32 vcc, s68, v42
    v_cmp_ne_u32 s[22:23], s69, v42
    s_nop 0
    s_and_b64 exec, vcc, s[22:23]
    buffer_store_dwordx4 v[232:235], v33, s[64:67], s70 offen sc1
    s_mov_b64 exec, -1
L_PAD10:
    s_cbranch_execz L_RET10
    v_cmp_ne_u32 vcc, s68, v43
    v_cmp_ne_u32 s[22:23], s69, v43
    s_nop 0
    s_and_b64 exec, vcc, s[22:23]
    buffer_store_dwordx4 v[236:239], v33, s[64:67], s71 offen sc1
    s_mov_b64 exec, -1
    s_cmp_ge_u32 s9, 16
    s_cbranch_scc1 L_FIN
SPOLL_55:
    s_load_dwordx8 s[24:31], s[32:33], s92 offset:3072 glc
SCHK_56:
    s_add_u32 s5, s5, 1
    s_cmp_ge_u32 s5, 200000
    s_waitcnt lgkmcnt(0)
    s_cbranch_scc1 SDONE_57
    s_cmp_lg_u32 s24, s4
    s_cbranch_scc1 SPOLL_55
    s_cmp_lg_u32 s25, s4
    s_cbranch_scc1 SPOLL_55
    s_cmp_lg_u32 s26, s4
    s_cbranch_scc1 SPOLL_55
    s_cmp_lg_u32 s27, s4
    s_cbranch_scc1 SPOLL_55
    s_cmp_lg_u32 s28, s4
    s_cbranch_scc1 SPOLL_55
    s_cmp_lg_u32 s29, s4
    s_cbranch_scc1 SPOLL_55
    s_cmp_lg_u32 s30, s4
    s_cbranch_scc1 SPOLL_55
SDONE_57:
    s_barrier
    s_cmp_lg_u32 s3, 7
    s_cbranch_scc1 L_FIN
    s_add_u32 s13, s20, 4096
POLL_58:
    buffer_load_dwordx4 v[88:91], v2, s[32:35], s20 offen sc1
    buffer_load_dwordx4 v[92:95], v2, s[32:35], s20 offen offset:1024 sc1
    buffer_load_dwordx4 v[96:99], v2, s[32:35], s20 offen offset:2048 sc1
    buffer_load_dwordx4 v[100:103], v2, s[32:35], s20 offen offset:3072 sc1
    buffer_load_dwordx4 v[104:107], v2, s[32:35], s13 offen sc1
    buffer_load_dwordx4 v[108:111], v2, s[32:35], s13 offen offset:1024 sc1
    buffer_load_dwordx4 v[112:115], v2, s[32:35], s13 offen offset:2048 sc1
    s_waitcnt vmcnt(0)
    v_bitop3_b32 v4, v89, v91, s4 bitop3:0x7e
    v_bitop3_b32 v4, v4, v93, s4 bitop3:0xf6
    v_bitop3_b32 v4, v4, v95, s4 bitop3:0xf6
    v_bitop3_b32 v4, v4, v97, s4 bitop3:0xf6
    v_bitop3_b32 v4, v4, v99, s4 bitop3:0xf6
    v_bitop3_b32 v4, v4, v101, s4 bitop3:0xf6
    v_bitop3_b32 v4, v4, v103, s4 bitop3:0xf6
    v_bitop3_b32 v4, v4, v105, s4 bitop3:0xf6
    v_bitop3_b32 v4, v4, v107, s4 bitop3:0xf6
    v_bitop3_b32 v4, v4, v109, s4 bitop3:0xf6
    v_bitop3_b32 v4, v4, v111, s4 bitop3:0xf6
    v_bitop3_b32 v4, v4, v113, s4 bitop3:0xf6
    v_bitop3_b32 v4, v4, v115, s4 bitop3:0xf6
    v_cmp_ne_u32 vcc, 0, v4
    s_cbranch_vccz PDONE_59
    s_add_u32 s5, s5, 1
    s_cmp_lt_u32 s5, 200000
    s_cbranch_scc1 POLL_58
PDONE_59:
    v_add_f32 v88, v88, v92
    v_add_f32 v90, v90, v94
    v_add_f32 v96, v96, v100
    v_add_f32 v98, v98, v102
    v_add_f32 v104, v104, v108
    v_add_f32 v106, v106, v110
    v_add_f32 v88, v88, v96
    v_add_f32 v90, v90, v98
    v_add_f32 v104, v104, v112
    v_add_f32 v106, v106, v114
    v_add_f32 v88, v88, v104
    v_add_f32 v89, v90, v106
    s_nop 1
    v_permlane32_swap_b32 v88, v89
    v_add_f32 v88, v88, v89
    s_nop 1
    v_add_f32_dpp v88, v88, v88 row_ror:8 row_mask:0xf bank_mask:0xf
    v_mov_b32 v89, v88
    s_nop 1
    v_permlane16_swap_b32 v88, v89
    v_add_f32 v89, v88, v89
    v_cvt_pk_bf16_f32 v88, 0, v89
    v_cvt_pk_bf16_f32 v89, 0, v89
    s_nop 1
    v_permlane32_swap_b32 v88, v89
    v_pk_mul_f32 v[88:89], v[88:89], v[204:205] op_sel_hi:[1,0]
    v_cvt_pk_bf16_f32 v88, 0, v88
    v_cvt_pk_bf16_f32 v89, 0, v89
    v_pk_add_f32 v[88:89], v[88:89], v[244:245]
    v_cvt_pk_bf16_f32 v88, 0, v88
    v_cvt_pk_bf16_f32 v89, 0, v89
    v_pk_mul_f32 v[88:89], v[88:89], v[206:207]
    v_cvt_pk_bf16_f32 v88, 0, v88
    v_cvt_pk_bf16_f32 v89, 0, v89
    v_pk_add_f32 v[88:89], v[88:89], v[246:247]
    v_cvt_pk_bf16_f32 v88, v88, v89
    s_mov_b64 exec, 0xff
    buffer_store_dword v88, v10, s[64:67], s82 offen
    s_mov_b64 exec, -1
L_FIN:
L_END:
    s_endpgm
.p2align 10
.fill 768, 4, 0xbf800000
.section .rodata,"a"
.p2align 6
.amdhsa_kernel adaLN_cond__linear_kernel_hedgehog__moe_arch_mod__prompt_kernel
  .amdhsa_next_free_vgpr 256
  .amdhsa_next_free_sgpr 102
  .amdhsa_accum_offset 256
  .amdhsa_group_segment_fixed_size 0
  .amdhsa_kernarg_size 112
  .amdhsa_user_sgpr_count 2
  .amdhsa_user_sgpr_kernarg_segment_ptr 1
  .amdhsa_system_sgpr_workgroup_id_x 1
  .amdhsa_float_denorm_mode_32 3
  .amdhsa_float_denorm_mode_16_64 3
.end_amdhsa_kernel
```
